```python
import torch

def _softmax(x, axis=-1):
    return torch.softmax(x, dim=axis)

def _gelu(x):
    return torch.nn.functional.gelu(x, approximate='tanh')

def _silu(x):
    return torch.nn.functional.silu(x)

def _sigmoid(x):
    return torch.sigmoid(x)

def _layernorm(x, axis=-1, eps=1e-05):
    m = x.mean(dim=axis, keepdim=True)
    v = x.var(dim=axis, keepdim=True, unbiased=False)
    return (x - m) / torch.sqrt(v + eps)

def _scatter_add(tgt, idx, src, axis=0):
    return tgt.clone().index_add_(axis, idx, src)

def _segment_sum(src, seg, n):
    out = torch.zeros((n,) + src.shape[1:], dtype=src.dtype)
    return out.index_add_(0, seg, src)

def _pad(x, pw):
    flat = tuple((v for pair in reversed(pw) for v in pair))
    return torch.nn.functional.pad(x, flat)
kernel_name = 'concat_heads__memory_aug_recurrent_mem_tr__sliding_local_dilated__prompt'

def setup_inputs():

    _w = lambda a: (lambda t: t.to(torch.bfloat16) if t.is_floating_point() else t)(torch.as_tensor(a))

    def _A_setup():
        B, S, Dm = (1, 2048, 1024)
        H, Dh = (32, 128)
        M, seg = (8, 32)
        seg = min(seg, S)
        S = S // seg * seg
        return {'x': _w((lambda *s: torch.randn(*s, dtype=torch.bfloat16) * 0.05)(B, S, Dm)), 'mem0': _w((lambda *s: torch.randn(*s, dtype=torch.bfloat16) * 1.6)(B, M, Dm)), 'Wq': _w((lambda *s: torch.randn(*s, dtype=torch.bfloat16) * 0.8)(Dm, H, Dh) * Dm ** (-0.5)), 'Wk': _w((lambda *s: torch.randn(*s, dtype=torch.bfloat16) * 0.8)(Dm, H, Dh) * Dm ** (-0.5)), 'Wv': _w((lambda *s: torch.randn(*s, dtype=torch.bfloat16) * 1.6)(Dm, H, Dh) * Dm ** (-0.5)), 'Wo': _w((lambda *s: torch.randn(*s, dtype=torch.bfloat16) * 1.6)(H, Dh, Dm) * (H * Dh) ** (-0.5)), 'seg_len': seg}
    _A_in = _A_setup()

    def _B_setup():
        B, S, D = (1, 2048, 1024)
        return {'x': _w((lambda *s: torch.randn(*s, dtype=torch.bfloat16) * 0.2)(B, S, D)), 'wqkv': _w((lambda *s: torch.randn(*s, dtype=torch.bfloat16) * 0.2)(D, 3 * D)), 'wo': _w((lambda *s: torch.randn(*s, dtype=torch.bfloat16) * 0.05)(D, D))}
    _B_in = _B_setup()
    return {'A_x': _A_in['x'], 'A_mem0': _A_in['mem0'], 'A_Wq': _A_in['Wq'], 'A_Wk': _A_in['Wk'], 'A_Wv': _A_in['Wv'], 'A_Wo': _A_in['Wo'], 'A_seg_len': _A_in['seg_len'], 'B_x': _B_in['x'], 'B_wqkv': _B_in['wqkv'], 'B_wo': _B_in['wo']}

def reference(A_x, A_mem0, A_Wq, A_Wk, A_Wv, A_Wo, A_seg_len, B_x, B_wqkv, B_wo):

    def _A_ref(x, mem0, Wq, Wk, Wv, Wo, seg_len):
        B, S, Dm = x.shape
        H, Dh = (Wq.shape[1], Wq.shape[2])
        M = mem0.shape[1]
        scale = Dh ** (-0.5)
        n_seg = S // seg_len
        L = M + seg_len
        idx = torch.arange(L)
        mask = (idx[:, None] < M) | (idx[:, None] >= idx[None, :])
        mem = mem0
        outs = []
        for s in range(n_seg):
            xs = x[:, s * seg_len:(s + 1) * seg_len, :].clone()
            h = torch.concatenate([mem, xs], axis=1)
            q = torch.einsum('btd,dhe->bhte', h, Wq)
            k = torch.einsum('btd,dhe->bhte', h, Wk)
            v = torch.einsum('btd,dhe->bhte', h, Wv)
            scores = torch.einsum('bhqe,bhke->bhqk', q, k) * scale
            scores = torch.where(mask[None, None], scores, -1000000000.0)
            p = _softmax(scores, axis=-1)
            o = torch.einsum('bhqk,bhke->bhqe', p, v)
            o = torch.einsum('bhte,hed->btd', o, Wo)
            mem = o[:, :M, :].clone()
            outs.append(o[:, M:, :])
        return torch.concatenate(outs, axis=1)

    def _B_ref(x, wqkv, wo):
        B, S, D = x.shape
        H = 32
        Dh = D // H
        W, dil = (8, 2)
        qkv = (lambda x, *d: x.permute(*d))((x @ wqkv).reshape(B, S, 3, H, Dh), 2, 0, 3, 1, 4)
        q, k, v = (qkv[0], qkv[1], qkv[2])
        scale = Dh ** (-0.5)
        pos = torch.arange(S)
        off = torch.arange(W) * dil
        idx = pos[:, None] - off[None, :]
        mask = idx >= 0
        idx_c = torch.where(mask, idx, 0).reshape(-1)
        kg = k[:, :, idx_c, :].reshape(B, H, S, W, Dh)
        vg = v[:, :, idx_c, :].reshape(B, H, S, W, Dh)
        logits = torch.einsum('bhsd,bhswd->bhsw', q, kg) * scale
        logits = torch.where(mask[None, None, :, :], logits, -1000000000.0)
        attn = _softmax(logits, axis=-1)
        o = torch.einsum('bhsw,bhswd->bhsd', attn, vg)
        return (lambda x, *d: x.permute(*d))(o, 0, 2, 1, 3).reshape(B, S, D) @ wo
    a = _A_ref(A_x, A_mem0, A_Wq, A_Wk, A_Wv, A_Wo, A_seg_len)
    b = _B_ref(B_x, B_wqkv, B_wo)
    return torch.concatenate([a, b], axis=-1)
```

```asm
; @launch kernel=qkv_kernel grid=(480,1,1) block=(256,1,1) lds=131072
; @launch kernel=rec_kernel grid=(256,1,1) block=(256,1,1) lds=102400
; @launch kernel=attn_kernel grid=(640,1,1) block=(256,1,1) lds=0
; @launch kernel=outp_kernel grid=(256,1,1) block=(256,1,1) lds=65536
.amdgcn_target "amdgcn-amd-amdhsa--gfx950"
.text
.globl qkv_kernel
.p2align 8
.type qkv_kernel,@function
qkv_kernel:
  s_cmp_ge_u32 s2, 480
  s_cbranch_scc1 L_k1_end
  s_load_dwordx16 s[64:79], s[0:1], 0
  s_load_dwordx2 s[80:81], s[0:1], 64
  s_load_dwordx2 s[82:83], s[0:1], 96
  s_waitcnt lgkmcnt(0)
  s_mov_b32 s16, s82
  s_and_b32 s17, s83, 0xffff
  s_mov_b32 s18, 0x10000000
  s_mov_b32 s19, 0x20000
  s_cmp_ge_u32 s2, 256
  s_cbranch_scc1 L_k1_noinit
  s_lshl_b32 s90, s2, 14
  s_add_u32 s90, s90, 0x3800000
  v_lshlrev_b32 v1, 4, v0
  v_mov_b32 v4, -1
  v_mov_b32 v5, -1
  v_mov_b32 v6, -1
  v_mov_b32 v7, -1
  buffer_store_dwordx4 v[4:7], v1, s[16:19], s90 offen
  s_add_u32 s90, s90, 4096
  buffer_store_dwordx4 v[4:7], v1, s[16:19], s90 offen
  s_add_u32 s90, s90, 4096
  buffer_store_dwordx4 v[4:7], v1, s[16:19], s90 offen
  s_add_u32 s90, s90, 4096
  buffer_store_dwordx4 v[4:7], v1, s[16:19], s90 offen
  s_add_u32 s90, s90, 4096
L_k1_noinit:
  s_mov_b32 s23, 2048
  s_mov_b32 s25, 8
  s_cmp_ge_u32 s2, 384
  s_cbranch_scc1 L_k1_B
  s_lshr_b32 s84, s2, 7
  s_lshr_b32 s85, s2, 4
  s_and_b32 s85, s85, 7
  s_and_b32 s86, s2, 15
  s_mov_b32 s8, s64
  s_and_b32 s9, s65, 0xffff
  s_mov_b32 s10, 0x400000
  s_mov_b32 s11, 0x20000
  s_cmp_eq_u32 s84, 0
  s_cselect_b64 s[88:89], s[68:69], s[70:71]
  s_cmp_eq_u32 s84, 2
  s_cselect_b64 s[88:89], s[72:73], s[88:89]
  s_mov_b32 s12, s88
  s_and_b32 s13, s89, 0xffff
  s_mov_b32 s14, 0x800000
  s_mov_b32 s15, 0x20000
  s_mov_b32 s24, 8192
  s_mov_b32 s26, 262144
  s_lshl_b32 s20, s85, 19
  s_lshl_b32 s21, s86, 9
  s_lshl_b32 s22, s84, 24
  s_lshl_b32 s90, s85, 21
  s_add_u32 s22, s22, s90
  s_lshl_b32 s90, s86, 14
  s_add_u32 s22, s22, s90
  s_branch L_k1_go
L_k1_B:
  s_sub_u32 s87, s2, 384
  s_and_b32 s85, s87, 7
  s_lshr_b32 s86, s87, 3
  s_lshr_b32 s84, s86, 2
  s_mov_b32 s8, s78
  s_and_b32 s9, s79, 0xffff
  s_mov_b32 s10, 0x400000
  s_mov_b32 s11, 0x20000
  s_mov_b32 s12, s80
  s_and_b32 s13, s81, 0xffff
  s_mov_b32 s14, 0x600000
  s_mov_b32 s15, 0x20000
  s_mov_b32 s24, 6144
  s_mov_b32 s26, 65536
  s_lshl_b32 s20, s85, 19
  s_lshl_b32 s21, s86, 9
  s_lshl_b32 s22, s84, 22
  s_lshl_b32 s90, s85, 19
  s_add_u32 s22, s22, s90
  s_and_b32 s90, s86, 3
  s_lshl_b32 s90, s90, 14
  s_add_u32 s22, s22, s90
  s_add_u32 s22, s22, 0x4000000
L_k1_go:
  s_cmp_eq_u32 s84, 2
  s_cbranch_scc1 L_k1_V
  v_and_b32 v1, 63, v0
  v_lshrrev_b32 v34, 6, v0
  s_nop 0
  v_readfirstlane_b32 s27, v34
  s_mul_i32 s90, s27, 64
  v_lshrrev_b32 v34, 3, v1
  v_add_u32 v34, s90, v34
  v_mul_lo_u32 v34, v34, s23
  v_lshrrev_b32 v35, 4, v1
  v_xor_b32 v35, v35, v1
  v_and_b32 v35, 7, v35
  v_lshl_add_u32 v2, v35, 4, v34
  s_lshl_b32 s91, s23, 3
  v_add_u32 v3, s91, v2
  v_xor_b32 v3, 64, v3
  v_add_u32 v4, s91, v3
  v_xor_b32 v4, 64, v4
  v_add_u32 v5, s91, v4
  v_xor_b32 v5, 64, v5
  v_add_u32 v6, s91, v5
  v_xor_b32 v6, 64, v6
  v_add_u32 v7, s91, v6
  v_xor_b32 v7, 64, v7
  v_add_u32 v8, s91, v7
  v_xor_b32 v8, 64, v8
  v_add_u32 v9, s91, v8
  v_xor_b32 v9, 64, v9
  s_mul_i32 s90, s27, 16
  v_lshrrev_b32 v34, 5, v1
  v_add_u32 v34, 0, v34
  v_and_b32 v35, 3, v34
  v_lshlrev_b32 v35, 2, v35
  v_xor_b32 v35, v35, v1
  v_and_b32 v35, 31, v35
  v_add_u32 v34, s90, v34
  v_mul_lo_u32 v34, v34, s24
  v_lshl_add_u32 v10, v35, 4, v34
  v_lshrrev_b32 v34, 5, v1
  v_add_u32 v34, 2, v34
  v_and_b32 v35, 3, v34
  v_lshlrev_b32 v35, 2, v35
  v_xor_b32 v35, v35, v1
  v_and_b32 v35, 31, v35
  v_add_u32 v34, s90, v34
  v_mul_lo_u32 v34, v34, s24
  v_lshl_add_u32 v11, v35, 4, v34
  v_lshrrev_b32 v34, 5, v1
  v_add_u32 v34, 4, v34
  v_and_b32 v35, 3, v34
  v_lshlrev_b32 v35, 2, v35
  v_xor_b32 v35, v35, v1
  v_and_b32 v35, 31, v35
  v_add_u32 v34, s90, v34
  v_mul_lo_u32 v34, v34, s24
  v_lshl_add_u32 v12, v35, 4, v34
  v_lshrrev_b32 v34, 5, v1
  v_add_u32 v34, 6, v34
  v_and_b32 v35, 3, v34
  v_lshlrev_b32 v35, 2, v35
  v_xor_b32 v35, v35, v1
  v_and_b32 v35, 31, v35
  v_add_u32 v34, s90, v34
  v_mul_lo_u32 v34, v34, s24
  v_lshl_add_u32 v13, v35, 4, v34
  v_lshrrev_b32 v34, 5, v1
  v_add_u32 v34, 8, v34
  v_and_b32 v35, 3, v34
  v_lshlrev_b32 v35, 2, v35
  v_xor_b32 v35, v35, v1
  v_and_b32 v35, 31, v35
  v_add_u32 v34, s90, v34
  v_mul_lo_u32 v34, v34, s24
  v_lshl_add_u32 v14, v35, 4, v34
  v_lshrrev_b32 v34, 5, v1
  v_add_u32 v34, 10, v34
  v_and_b32 v35, 3, v34
  v_lshlrev_b32 v35, 2, v35
  v_xor_b32 v35, v35, v1
  v_and_b32 v35, 31, v35
  v_add_u32 v34, s90, v34
  v_mul_lo_u32 v34, v34, s24
  v_lshl_add_u32 v15, v35, 4, v34
  v_lshrrev_b32 v34, 5, v1
  v_add_u32 v34, 12, v34
  v_and_b32 v35, 3, v34
  v_lshlrev_b32 v35, 2, v35
  v_xor_b32 v35, v35, v1
  v_and_b32 v35, 31, v35
  v_add_u32 v34, s90, v34
  v_mul_lo_u32 v34, v34, s24
  v_lshl_add_u32 v16, v35, 4, v34
  v_lshrrev_b32 v34, 5, v1
  v_add_u32 v34, 14, v34
  v_and_b32 v35, 3, v34
  v_lshlrev_b32 v35, 2, v35
  v_xor_b32 v35, v35, v1
  v_and_b32 v35, 31, v35
  v_add_u32 v34, s90, v34
  v_mul_lo_u32 v34, v34, s24
  v_lshl_add_u32 v17, v35, 4, v34
  s_lshl_b32 s28, s24, 6
  s_mul_i32 s29, s27, 8192
  s_mul_i32 s30, s27, 8192
  s_add_u32 s30, s30, 32768
  s_add_u32 m0, s29, 0
  s_nop 0
  buffer_load_dwordx4 v2, s[8:11], s20 offen lds
  s_add_u32 m0, s29, 1024
  s_nop 0
  buffer_load_dwordx4 v3, s[8:11], s20 offen lds
  s_add_u32 m0, s29, 2048
  s_nop 0
  buffer_load_dwordx4 v4, s[8:11], s20 offen lds
  s_add_u32 m0, s29, 3072
  s_nop 0
  buffer_load_dwordx4 v5, s[8:11], s20 offen lds
  s_add_u32 m0, s29, 4096
  s_nop 0
  buffer_load_dwordx4 v6, s[8:11], s20 offen lds
  s_add_u32 m0, s29, 5120
  s_nop 0
  buffer_load_dwordx4 v7, s[8:11], s20 offen lds
  s_add_u32 m0, s29, 6144
  s_nop 0
  buffer_load_dwordx4 v8, s[8:11], s20 offen lds
  s_add_u32 m0, s29, 7168
  s_nop 0
  buffer_load_dwordx4 v9, s[8:11], s20 offen lds
  s_add_u32 m0, s30, 0
  s_nop 0
  buffer_load_dwordx4 v10, s[12:15], s21 offen lds
  s_add_u32 m0, s30, 1024
  s_nop 0
  buffer_load_dwordx4 v11, s[12:15], s21 offen lds
  s_add_u32 m0, s30, 2048
  s_nop 0
  buffer_load_dwordx4 v12, s[12:15], s21 offen lds
  s_add_u32 m0, s30, 3072
  s_nop 0
  buffer_load_dwordx4 v13, s[12:15], s21 offen lds
  s_add_u32 m0, s30, 4096
  s_nop 0
  buffer_load_dwordx4 v14, s[12:15], s21 offen lds
  s_add_u32 m0, s30, 5120
  s_nop 0
  buffer_load_dwordx4 v15, s[12:15], s21 offen lds
  s_add_u32 m0, s30, 6144
  s_nop 0
  buffer_load_dwordx4 v16, s[12:15], s21 offen lds
  s_add_u32 m0, s30, 7168
  s_nop 0
  buffer_load_dwordx4 v17, s[12:15], s21 offen lds
  s_add_u32 s20, s20, 128
  s_add_u32 s21, s21, s28
  s_add_u32 m0, s29, 65536
  s_nop 0
  buffer_load_dwordx4 v2, s[8:11], s20 offen lds
  s_add_u32 m0, s29, 66560
  s_nop 0
  buffer_load_dwordx4 v3, s[8:11], s20 offen lds
  s_add_u32 m0, s29, 67584
  s_nop 0
  buffer_load_dwordx4 v4, s[8:11], s20 offen lds
  s_add_u32 m0, s29, 68608
  s_nop 0
  buffer_load_dwordx4 v5, s[8:11], s20 offen lds
  s_add_u32 m0, s29, 69632
  s_nop 0
  buffer_load_dwordx4 v6, s[8:11], s20 offen lds
  s_add_u32 m0, s29, 70656
  s_nop 0
  buffer_load_dwordx4 v7, s[8:11], s20 offen lds
  s_add_u32 m0, s29, 71680
  s_nop 0
  buffer_load_dwordx4 v8, s[8:11], s20 offen lds
  s_add_u32 m0, s29, 72704
  s_nop 0
  buffer_load_dwordx4 v9, s[8:11], s20 offen lds
  s_add_u32 m0, s30, 65536
  s_nop 0
  buffer_load_dwordx4 v10, s[12:15], s21 offen lds
  s_add_u32 m0, s30, 66560
  s_nop 0
  buffer_load_dwordx4 v11, s[12:15], s21 offen lds
  s_add_u32 m0, s30, 67584
  s_nop 0
  buffer_load_dwordx4 v12, s[12:15], s21 offen lds
  s_add_u32 m0, s30, 68608
  s_nop 0
  buffer_load_dwordx4 v13, s[12:15], s21 offen lds
  s_add_u32 m0, s30, 69632
  s_nop 0
  buffer_load_dwordx4 v14, s[12:15], s21 offen lds
  s_add_u32 m0, s30, 70656
  s_nop 0
  buffer_load_dwordx4 v15, s[12:15], s21 offen lds
  s_add_u32 m0, s30, 71680
  s_nop 0
  buffer_load_dwordx4 v16, s[12:15], s21 offen lds
  s_add_u32 m0, s30, 72704
  s_nop 0
  buffer_load_dwordx4 v17, s[12:15], s21 offen lds
  s_add_u32 s20, s20, 128
  s_add_u32 s21, s21, s28
  s_lshr_b32 s90, s27, 1
  s_and_b32 s91, s27, 1
  s_mul_i32 s92, s90, 16384
  v_mov_b32 v34, 0x0
  v_bfe_u32 v35, v1, 0, 5
  v_lshl_add_u32 v34, v35, 7, v34
  v_add_u32 v34, s92, v34
  v_lshrrev_b32 v35, 1, v1
  v_and_b32 v35, 7, v35
  v_lshrrev_b32 v36, 5, v1
  v_xor_b32 v35, v35, v36
  v_lshl_add_u32 v18, v35, 4, v34
  v_xor_b32 v19, 32, v18
  v_xor_b32 v20, 64, v18
  v_xor_b32 v21, 96, v18
  v_add_u32 v22, 65536, v18
  v_add_u32 v23, 65536, v19
  v_add_u32 v24, 65536, v20
  v_add_u32 v25, 65536, v21
  v_mov_b32 v34, 0x8000
  v_bfe_u32 v35, v1, 2, 2
  v_lshl_add_u32 v34, v35, 9, v34
  v_bfe_u32 v35, v1, 5, 1
  v_lshl_add_u32 v34, v35, 12, v34
  v_bfe_u32 v35, v1, 4, 1
  v_lshl_add_u32 v34, v35, 5, v34
  v_bfe_u32 v35, v1, 0, 2
  v_lshl_add_u32 v34, v35, 3, v34
  s_mul_i32 s92, s91, 4
  s_add_u32 s93, s92, 0
  v_bfe_u32 v35, v1, 2, 2
  v_xor_b32 v35, s93, v35
  v_lshl_add_u32 v26, v35, 6, v34
  v_add_u32 v30, 65536, v26
  s_add_u32 s93, s92, 1
  v_bfe_u32 v35, v1, 2, 2
  v_xor_b32 v35, s93, v35
  v_lshl_add_u32 v27, v35, 6, v34
  v_add_u32 v31, 65536, v27
  s_add_u32 s93, s92, 2
  v_bfe_u32 v35, v1, 2, 2
  v_xor_b32 v35, s93, v35
  v_lshl_add_u32 v28, v35, 6, v34
  v_add_u32 v32, 65536, v28
  s_add_u32 s93, s92, 3
  v_bfe_u32 v35, v1, 2, 2
  v_xor_b32 v35, s93, v35
  v_lshl_add_u32 v29, v35, 6, v34
  v_add_u32 v33, 65536, v29
  v_accvgpr_write_b32 a0, 0
  v_accvgpr_write_b32 a1, 0
  v_accvgpr_write_b32 a2, 0
  v_accvgpr_write_b32 a3, 0
  v_accvgpr_write_b32 a4, 0
  v_accvgpr_write_b32 a5, 0
  v_accvgpr_write_b32 a6, 0
  v_accvgpr_write_b32 a7, 0
  v_accvgpr_write_b32 a8, 0
  v_accvgpr_write_b32 a9, 0
  v_accvgpr_write_b32 a10, 0
  v_accvgpr_write_b32 a11, 0
  v_accvgpr_write_b32 a12, 0
  v_accvgpr_write_b32 a13, 0
  v_accvgpr_write_b32 a14, 0
  v_accvgpr_write_b32 a15, 0
  v_accvgpr_write_b32 a16, 0
  v_accvgpr_write_b32 a17, 0
  v_accvgpr_write_b32 a18, 0
  v_accvgpr_write_b32 a19, 0
  v_accvgpr_write_b32 a20, 0
  v_accvgpr_write_b32 a21, 0
  v_accvgpr_write_b32 a22, 0
  v_accvgpr_write_b32 a23, 0
  v_accvgpr_write_b32 a24, 0
  v_accvgpr_write_b32 a25, 0
  v_accvgpr_write_b32 a26, 0
  v_accvgpr_write_b32 a27, 0
  v_accvgpr_write_b32 a28, 0
  v_accvgpr_write_b32 a29, 0
  v_accvgpr_write_b32 a30, 0
  v_accvgpr_write_b32 a31, 0
  v_accvgpr_write_b32 a32, 0
  v_accvgpr_write_b32 a33, 0
  v_accvgpr_write_b32 a34, 0
  v_accvgpr_write_b32 a35, 0
  v_accvgpr_write_b32 a36, 0
  v_accvgpr_write_b32 a37, 0
  v_accvgpr_write_b32 a38, 0
  v_accvgpr_write_b32 a39, 0
  v_accvgpr_write_b32 a40, 0
  v_accvgpr_write_b32 a41, 0
  v_accvgpr_write_b32 a42, 0
  v_accvgpr_write_b32 a43, 0
  v_accvgpr_write_b32 a44, 0
  v_accvgpr_write_b32 a45, 0
  v_accvgpr_write_b32 a46, 0
  v_accvgpr_write_b32 a47, 0
  v_accvgpr_write_b32 a48, 0
  v_accvgpr_write_b32 a49, 0
  v_accvgpr_write_b32 a50, 0
  v_accvgpr_write_b32 a51, 0
  v_accvgpr_write_b32 a52, 0
  v_accvgpr_write_b32 a53, 0
  v_accvgpr_write_b32 a54, 0
  v_accvgpr_write_b32 a55, 0
  v_accvgpr_write_b32 a56, 0
  v_accvgpr_write_b32 a57, 0
  v_accvgpr_write_b32 a58, 0
  v_accvgpr_write_b32 a59, 0
  v_accvgpr_write_b32 a60, 0
  v_accvgpr_write_b32 a61, 0
  v_accvgpr_write_b32 a62, 0
  v_accvgpr_write_b32 a63, 0
  v_accvgpr_write_b32 a64, 0
  v_accvgpr_write_b32 a65, 0
  v_accvgpr_write_b32 a66, 0
  v_accvgpr_write_b32 a67, 0
  v_accvgpr_write_b32 a68, 0
  v_accvgpr_write_b32 a69, 0
  v_accvgpr_write_b32 a70, 0
  v_accvgpr_write_b32 a71, 0
  v_accvgpr_write_b32 a72, 0
  v_accvgpr_write_b32 a73, 0
  v_accvgpr_write_b32 a74, 0
  v_accvgpr_write_b32 a75, 0
  v_accvgpr_write_b32 a76, 0
  v_accvgpr_write_b32 a77, 0
  v_accvgpr_write_b32 a78, 0
  v_accvgpr_write_b32 a79, 0
  v_accvgpr_write_b32 a80, 0
  v_accvgpr_write_b32 a81, 0
  v_accvgpr_write_b32 a82, 0
  v_accvgpr_write_b32 a83, 0
  v_accvgpr_write_b32 a84, 0
  v_accvgpr_write_b32 a85, 0
  v_accvgpr_write_b32 a86, 0
  v_accvgpr_write_b32 a87, 0
  v_accvgpr_write_b32 a88, 0
  v_accvgpr_write_b32 a89, 0
  v_accvgpr_write_b32 a90, 0
  v_accvgpr_write_b32 a91, 0
  v_accvgpr_write_b32 a92, 0
  v_accvgpr_write_b32 a93, 0
  v_accvgpr_write_b32 a94, 0
  v_accvgpr_write_b32 a95, 0
  v_accvgpr_write_b32 a96, 0
  v_accvgpr_write_b32 a97, 0
  v_accvgpr_write_b32 a98, 0
  v_accvgpr_write_b32 a99, 0
  v_accvgpr_write_b32 a100, 0
  v_accvgpr_write_b32 a101, 0
  v_accvgpr_write_b32 a102, 0
  v_accvgpr_write_b32 a103, 0
  v_accvgpr_write_b32 a104, 0
  v_accvgpr_write_b32 a105, 0
  v_accvgpr_write_b32 a106, 0
  v_accvgpr_write_b32 a107, 0
  v_accvgpr_write_b32 a108, 0
  v_accvgpr_write_b32 a109, 0
  v_accvgpr_write_b32 a110, 0
  v_accvgpr_write_b32 a111, 0
  v_accvgpr_write_b32 a112, 0
  v_accvgpr_write_b32 a113, 0
  v_accvgpr_write_b32 a114, 0
  v_accvgpr_write_b32 a115, 0
  v_accvgpr_write_b32 a116, 0
  v_accvgpr_write_b32 a117, 0
  v_accvgpr_write_b32 a118, 0
  v_accvgpr_write_b32 a119, 0
  v_accvgpr_write_b32 a120, 0
  v_accvgpr_write_b32 a121, 0
  v_accvgpr_write_b32 a122, 0
  v_accvgpr_write_b32 a123, 0
  v_accvgpr_write_b32 a124, 0
  v_accvgpr_write_b32 a125, 0
  v_accvgpr_write_b32 a126, 0
  v_accvgpr_write_b32 a127, 0
  v_accvgpr_write_b32 a128, 0
  v_accvgpr_write_b32 a129, 0
  v_accvgpr_write_b32 a130, 0
  v_accvgpr_write_b32 a131, 0
  v_accvgpr_write_b32 a132, 0
  v_accvgpr_write_b32 a133, 0
  v_accvgpr_write_b32 a134, 0
  v_accvgpr_write_b32 a135, 0
  v_accvgpr_write_b32 a136, 0
  v_accvgpr_write_b32 a137, 0
  v_accvgpr_write_b32 a138, 0
  v_accvgpr_write_b32 a139, 0
  v_accvgpr_write_b32 a140, 0
  v_accvgpr_write_b32 a141, 0
  v_accvgpr_write_b32 a142, 0
  v_accvgpr_write_b32 a143, 0
  v_accvgpr_write_b32 a144, 0
  v_accvgpr_write_b32 a145, 0
  v_accvgpr_write_b32 a146, 0
  v_accvgpr_write_b32 a147, 0
  v_accvgpr_write_b32 a148, 0
  v_accvgpr_write_b32 a149, 0
  v_accvgpr_write_b32 a150, 0
  v_accvgpr_write_b32 a151, 0
  v_accvgpr_write_b32 a152, 0
  v_accvgpr_write_b32 a153, 0
  v_accvgpr_write_b32 a154, 0
  v_accvgpr_write_b32 a155, 0
  v_accvgpr_write_b32 a156, 0
  v_accvgpr_write_b32 a157, 0
  v_accvgpr_write_b32 a158, 0
  v_accvgpr_write_b32 a159, 0
  v_accvgpr_write_b32 a160, 0
  v_accvgpr_write_b32 a161, 0
  v_accvgpr_write_b32 a162, 0
  v_accvgpr_write_b32 a163, 0
  v_accvgpr_write_b32 a164, 0
  v_accvgpr_write_b32 a165, 0
  v_accvgpr_write_b32 a166, 0
  v_accvgpr_write_b32 a167, 0
  v_accvgpr_write_b32 a168, 0
  v_accvgpr_write_b32 a169, 0
  v_accvgpr_write_b32 a170, 0
  v_accvgpr_write_b32 a171, 0
  v_accvgpr_write_b32 a172, 0
  v_accvgpr_write_b32 a173, 0
  v_accvgpr_write_b32 a174, 0
  v_accvgpr_write_b32 a175, 0
  v_accvgpr_write_b32 a176, 0
  v_accvgpr_write_b32 a177, 0
  v_accvgpr_write_b32 a178, 0
  v_accvgpr_write_b32 a179, 0
  v_accvgpr_write_b32 a180, 0
  v_accvgpr_write_b32 a181, 0
  v_accvgpr_write_b32 a182, 0
  v_accvgpr_write_b32 a183, 0
  v_accvgpr_write_b32 a184, 0
  v_accvgpr_write_b32 a185, 0
  v_accvgpr_write_b32 a186, 0
  v_accvgpr_write_b32 a187, 0
  v_accvgpr_write_b32 a188, 0
  v_accvgpr_write_b32 a189, 0
  v_accvgpr_write_b32 a190, 0
  v_accvgpr_write_b32 a191, 0
  v_accvgpr_write_b32 a192, 0
  v_accvgpr_write_b32 a193, 0
  v_accvgpr_write_b32 a194, 0
  v_accvgpr_write_b32 a195, 0
  v_accvgpr_write_b32 a196, 0
  v_accvgpr_write_b32 a197, 0
  v_accvgpr_write_b32 a198, 0
  v_accvgpr_write_b32 a199, 0
  v_accvgpr_write_b32 a200, 0
  v_accvgpr_write_b32 a201, 0
  v_accvgpr_write_b32 a202, 0
  v_accvgpr_write_b32 a203, 0
  v_accvgpr_write_b32 a204, 0
  v_accvgpr_write_b32 a205, 0
  v_accvgpr_write_b32 a206, 0
  v_accvgpr_write_b32 a207, 0
  v_accvgpr_write_b32 a208, 0
  v_accvgpr_write_b32 a209, 0
  v_accvgpr_write_b32 a210, 0
  v_accvgpr_write_b32 a211, 0
  v_accvgpr_write_b32 a212, 0
  v_accvgpr_write_b32 a213, 0
  v_accvgpr_write_b32 a214, 0
  v_accvgpr_write_b32 a215, 0
  v_accvgpr_write_b32 a216, 0
  v_accvgpr_write_b32 a217, 0
  v_accvgpr_write_b32 a218, 0
  v_accvgpr_write_b32 a219, 0
  v_accvgpr_write_b32 a220, 0
  v_accvgpr_write_b32 a221, 0
  v_accvgpr_write_b32 a222, 0
  v_accvgpr_write_b32 a223, 0
  v_accvgpr_write_b32 a224, 0
  v_accvgpr_write_b32 a225, 0
  v_accvgpr_write_b32 a226, 0
  v_accvgpr_write_b32 a227, 0
  v_accvgpr_write_b32 a228, 0
  v_accvgpr_write_b32 a229, 0
  v_accvgpr_write_b32 a230, 0
  v_accvgpr_write_b32 a231, 0
  v_accvgpr_write_b32 a232, 0
  v_accvgpr_write_b32 a233, 0
  v_accvgpr_write_b32 a234, 0
  v_accvgpr_write_b32 a235, 0
  v_accvgpr_write_b32 a236, 0
  v_accvgpr_write_b32 a237, 0
  v_accvgpr_write_b32 a238, 0
  v_accvgpr_write_b32 a239, 0
  v_accvgpr_write_b32 a240, 0
  v_accvgpr_write_b32 a241, 0
  v_accvgpr_write_b32 a242, 0
  v_accvgpr_write_b32 a243, 0
  v_accvgpr_write_b32 a244, 0
  v_accvgpr_write_b32 a245, 0
  v_accvgpr_write_b32 a246, 0
  v_accvgpr_write_b32 a247, 0
  v_accvgpr_write_b32 a248, 0
  v_accvgpr_write_b32 a249, 0
  v_accvgpr_write_b32 a250, 0
  v_accvgpr_write_b32 a251, 0
  v_accvgpr_write_b32 a252, 0
  v_accvgpr_write_b32 a253, 0
  v_accvgpr_write_b32 a254, 0
  v_accvgpr_write_b32 a255, 0
  s_waitcnt vmcnt(16)
  s_barrier
  ds_read_b128 v[40:43], v18 offset:0
  ds_read_b64_tr_b16 v[72:73], v26 offset:0
  ds_read_b64_tr_b16 v[74:75], v26 offset:2048
  ds_read_b128 v[44:47], v18 offset:4096
  ds_read_b64_tr_b16 v[76:77], v27 offset:0
  ds_read_b64_tr_b16 v[78:79], v27 offset:2048
  ds_read_b128 v[48:51], v18 offset:8192
  ds_read_b64_tr_b16 v[80:81], v28 offset:0
  ds_read_b64_tr_b16 v[82:83], v28 offset:2048
  ds_read_b128 v[52:55], v18 offset:12288
  ds_read_b64_tr_b16 v[84:85], v29 offset:0
  ds_read_b64_tr_b16 v[86:87], v29 offset:2048
  s_sub_u32 s25, s25, 1
  s_waitcnt lgkmcnt(0)
  v_mfma_f32_32x32x16_bf16 a[0:15], v[72:75], v[40:43], a[0:15]
  ds_read_b128 v[56:59], v19 offset:0
  v_mfma_f32_32x32x16_bf16 a[16:31], v[76:79], v[40:43], a[16:31]
  ds_read_b64_tr_b16 v[88:89], v26 offset:8192
  v_mfma_f32_32x32x16_bf16 a[32:47], v[80:83], v[40:43], a[32:47]
  ds_read_b64_tr_b16 v[90:91], v26 offset:10240
  v_mfma_f32_32x32x16_bf16 a[48:63], v[84:87], v[40:43], a[48:63]
  ds_read_b128 v[60:63], v19 offset:4096
  v_mfma_f32_32x32x16_bf16 a[64:79], v[72:75], v[44:47], a[64:79]
  ds_read_b64_tr_b16 v[92:93], v27 offset:8192
  v_mfma_f32_32x32x16_bf16 a[80:95], v[76:79], v[44:47], a[80:95]
  ds_read_b64_tr_b16 v[94:95], v27 offset:10240
  v_mfma_f32_32x32x16_bf16 a[96:111], v[80:83], v[44:47], a[96:111]
  ds_read_b128 v[64:67], v19 offset:8192
  v_mfma_f32_32x32x16_bf16 a[112:127], v[84:87], v[44:47], a[112:127]
  ds_read_b64_tr_b16 v[96:97], v28 offset:8192
  v_mfma_f32_32x32x16_bf16 a[128:143], v[72:75], v[48:51], a[128:143]
  ds_read_b64_tr_b16 v[98:99], v28 offset:10240
  v_mfma_f32_32x32x16_bf16 a[144:159], v[76:79], v[48:51], a[144:159]
  ds_read_b128 v[68:71], v19 offset:12288
  v_mfma_f32_32x32x16_bf16 a[160:175], v[80:83], v[48:51], a[160:175]
  ds_read_b64_tr_b16 v[100:101], v29 offset:8192
  v_mfma_f32_32x32x16_bf16 a[176:191], v[84:87], v[48:51], a[176:191]
  ds_read_b64_tr_b16 v[102:103], v29 offset:10240
  v_mfma_f32_32x32x16_bf16 a[192:207], v[72:75], v[52:55], a[192:207]
  v_mfma_f32_32x32x16_bf16 a[208:223], v[76:79], v[52:55], a[208:223]
  v_mfma_f32_32x32x16_bf16 a[224:239], v[80:83], v[52:55], a[224:239]
  v_mfma_f32_32x32x16_bf16 a[240:255], v[84:87], v[52:55], a[240:255]
  s_waitcnt lgkmcnt(0)
  v_mfma_f32_32x32x16_bf16 a[0:15], v[88:91], v[56:59], a[0:15]
  ds_read_b128 v[40:43], v20 offset:0
  v_mfma_f32_32x32x16_bf16 a[16:31], v[92:95], v[56:59], a[16:31]
  ds_read_b64_tr_b16 v[72:73], v26 offset:16384
  v_mfma_f32_32x32x16_bf16 a[32:47], v[96:99], v[56:59], a[32:47]
  ds_read_b64_tr_b16 v[74:75], v26 offset:18432
  v_mfma_f32_32x32x16_bf16 a[48:63], v[100:103], v[56:59], a[48:63]
  ds_read_b128 v[44:47], v20 offset:4096
  v_mfma_f32_32x32x16_bf16 a[64:79], v[88:91], v[60:63], a[64:79]
  ds_read_b64_tr_b16 v[76:77], v27 offset:16384
  v_mfma_f32_32x32x16_bf16 a[80:95], v[92:95], v[60:63], a[80:95]
  ds_read_b64_tr_b16 v[78:79], v27 offset:18432
  v_mfma_f32_32x32x16_bf16 a[96:111], v[96:99], v[60:63], a[96:111]
  ds_read_b128 v[48:51], v20 offset:8192
  v_mfma_f32_32x32x16_bf16 a[112:127], v[100:103], v[60:63], a[112:127]
  ds_read_b64_tr_b16 v[80:81], v28 offset:16384
  v_mfma_f32_32x32x16_bf16 a[128:143], v[88:91], v[64:67], a[128:143]
  ds_read_b64_tr_b16 v[82:83], v28 offset:18432
  v_mfma_f32_32x32x16_bf16 a[144:159], v[92:95], v[64:67], a[144:159]
  ds_read_b128 v[52:55], v20 offset:12288
  v_mfma_f32_32x32x16_bf16 a[160:175], v[96:99], v[64:67], a[160:175]
  ds_read_b64_tr_b16 v[84:85], v29 offset:16384
  v_mfma_f32_32x32x16_bf16 a[176:191], v[100:103], v[64:67], a[176:191]
  ds_read_b64_tr_b16 v[86:87], v29 offset:18432
  v_mfma_f32_32x32x16_bf16 a[192:207], v[88:91], v[68:71], a[192:207]
  v_mfma_f32_32x32x16_bf16 a[208:223], v[92:95], v[68:71], a[208:223]
  v_mfma_f32_32x32x16_bf16 a[224:239], v[96:99], v[68:71], a[224:239]
  v_mfma_f32_32x32x16_bf16 a[240:255], v[100:103], v[68:71], a[240:255]
  s_waitcnt lgkmcnt(0)
  v_mfma_f32_32x32x16_bf16 a[0:15], v[72:75], v[40:43], a[0:15]
  ds_read_b128 v[56:59], v21 offset:0
  v_mfma_f32_32x32x16_bf16 a[16:31], v[76:79], v[40:43], a[16:31]
  ds_read_b64_tr_b16 v[88:89], v26 offset:24576
  v_mfma_f32_32x32x16_bf16 a[32:47], v[80:83], v[40:43], a[32:47]
  ds_read_b64_tr_b16 v[90:91], v26 offset:26624
  v_mfma_f32_32x32x16_bf16 a[48:63], v[84:87], v[40:43], a[48:63]
  ds_read_b128 v[60:63], v21 offset:4096
  v_mfma_f32_32x32x16_bf16 a[64:79], v[72:75], v[44:47], a[64:79]
  ds_read_b64_tr_b16 v[92:93], v27 offset:24576
  v_mfma_f32_32x32x16_bf16 a[80:95], v[76:79], v[44:47], a[80:95]
  ds_read_b64_tr_b16 v[94:95], v27 offset:26624
  v_mfma_f32_32x32x16_bf16 a[96:111], v[80:83], v[44:47], a[96:111]
  ds_read_b128 v[64:67], v21 offset:8192
  v_mfma_f32_32x32x16_bf16 a[112:127], v[84:87], v[44:47], a[112:127]
  ds_read_b64_tr_b16 v[96:97], v28 offset:24576
  v_mfma_f32_32x32x16_bf16 a[128:143], v[72:75], v[48:51], a[128:143]
  ds_read_b64_tr_b16 v[98:99], v28 offset:26624
  v_mfma_f32_32x32x16_bf16 a[144:159], v[76:79], v[48:51], a[144:159]
  ds_read_b128 v[68:71], v21 offset:12288
  v_mfma_f32_32x32x16_bf16 a[160:175], v[80:83], v[48:51], a[160:175]
  ds_read_b64_tr_b16 v[100:101], v29 offset:24576
  v_mfma_f32_32x32x16_bf16 a[176:191], v[84:87], v[48:51], a[176:191]
  ds_read_b64_tr_b16 v[102:103], v29 offset:26624
  v_mfma_f32_32x32x16_bf16 a[192:207], v[72:75], v[52:55], a[192:207]
  v_mfma_f32_32x32x16_bf16 a[208:223], v[76:79], v[52:55], a[208:223]
  v_mfma_f32_32x32x16_bf16 a[224:239], v[80:83], v[52:55], a[224:239]
  v_mfma_f32_32x32x16_bf16 a[240:255], v[84:87], v[52:55], a[240:255]
  s_waitcnt lgkmcnt(0)
  v_mfma_f32_32x32x16_bf16 a[0:15], v[88:91], v[56:59], a[0:15]
  s_waitcnt vmcnt(0)
  s_barrier
  v_mfma_f32_32x32x16_bf16 a[16:31], v[92:95], v[56:59], a[16:31]
  ds_read_b128 v[40:43], v22 offset:0
  s_add_u32 m0, s29, 0
  s_nop 0
  buffer_load_dwordx4 v2, s[8:11], s20 offen lds
  v_mfma_f32_32x32x16_bf16 a[32:47], v[96:99], v[56:59], a[32:47]
  ds_read_b64_tr_b16 v[72:73], v30 offset:0
  s_add_u32 m0, s29, 1024
  s_nop 0
  buffer_load_dwordx4 v3, s[8:11], s20 offen lds
  v_mfma_f32_32x32x16_bf16 a[48:63], v[100:103], v[56:59], a[48:63]
  ds_read_b64_tr_b16 v[74:75], v30 offset:2048
  s_add_u32 m0, s29, 2048
  s_nop 0
  buffer_load_dwordx4 v4, s[8:11], s20 offen lds
  v_mfma_f32_32x32x16_bf16 a[64:79], v[88:91], v[60:63], a[64:79]
  ds_read_b128 v[44:47], v22 offset:4096
  s_add_u32 m0, s29, 3072
  s_nop 0
  buffer_load_dwordx4 v5, s[8:11], s20 offen lds
  v_mfma_f32_32x32x16_bf16 a[80:95], v[92:95], v[60:63], a[80:95]
  ds_read_b64_tr_b16 v[76:77], v31 offset:0
  s_add_u32 m0, s29, 4096
  s_nop 0
  buffer_load_dwordx4 v6, s[8:11], s20 offen lds
  v_mfma_f32_32x32x16_bf16 a[96:111], v[96:99], v[60:63], a[96:111]
  ds_read_b64_tr_b16 v[78:79], v31 offset:2048
  s_add_u32 m0, s29, 5120
  s_nop 0
  buffer_load_dwordx4 v7, s[8:11], s20 offen lds
  v_mfma_f32_32x32x16_bf16 a[112:127], v[100:103], v[60:63], a[112:127]
  ds_read_b128 v[48:51], v22 offset:8192
  s_add_u32 m0, s29, 6144
  s_nop 0
  buffer_load_dwordx4 v8, s[8:11], s20 offen lds
  v_mfma_f32_32x32x16_bf16 a[128:143], v[88:91], v[64:67], a[128:143]
  ds_read_b64_tr_b16 v[80:81], v32 offset:0
  v_mfma_f32_32x32x16_bf16 a[144:159], v[92:95], v[64:67], a[144:159]
  ds_read_b64_tr_b16 v[82:83], v32 offset:2048
  v_mfma_f32_32x32x16_bf16 a[160:175], v[96:99], v[64:67], a[160:175]
  ds_read_b128 v[52:55], v22 offset:12288
  v_mfma_f32_32x32x16_bf16 a[176:191], v[100:103], v[64:67], a[176:191]
  ds_read_b64_tr_b16 v[84:85], v33 offset:0
  v_mfma_f32_32x32x16_bf16 a[192:207], v[88:91], v[68:71], a[192:207]
  ds_read_b64_tr_b16 v[86:87], v33 offset:2048
  v_mfma_f32_32x32x16_bf16 a[208:223], v[92:95], v[68:71], a[208:223]
  v_mfma_f32_32x32x16_bf16 a[224:239], v[96:99], v[68:71], a[224:239]
  v_mfma_f32_32x32x16_bf16 a[240:255], v[100:103], v[68:71], a[240:255]
L_g1_loop:
  s_waitcnt lgkmcnt(0)
  v_mfma_f32_32x32x16_bf16 a[0:15], v[72:75], v[40:43], a[0:15]
  ds_read_b128 v[56:59], v23 offset:0
  s_add_u32 m0, s29, 7168
  s_nop 0
  buffer_load_dwordx4 v9, s[8:11], s20 offen lds
  v_mfma_f32_32x32x16_bf16 a[16:31], v[76:79], v[40:43], a[16:31]
  ds_read_b64_tr_b16 v[88:89], v30 offset:8192
  s_add_u32 m0, s30, 0
  s_nop 0
  buffer_load_dwordx4 v10, s[12:15], s21 offen lds
  v_mfma_f32_32x32x16_bf16 a[32:47], v[80:83], v[40:43], a[32:47]
  ds_read_b64_tr_b16 v[90:91], v30 offset:10240
  s_add_u32 m0, s30, 1024
  s_nop 0
  buffer_load_dwordx4 v11, s[12:15], s21 offen lds
  v_mfma_f32_32x32x16_bf16 a[48:63], v[84:87], v[40:43], a[48:63]
  ds_read_b128 v[60:63], v23 offset:4096
  s_add_u32 m0, s30, 2048
  s_nop 0
  buffer_load_dwordx4 v12, s[12:15], s21 offen lds
  v_mfma_f32_32x32x16_bf16 a[64:79], v[72:75], v[44:47], a[64:79]
  ds_read_b64_tr_b16 v[92:93], v31 offset:8192
  s_add_u32 m0, s30, 3072
  s_nop 0
  buffer_load_dwordx4 v13, s[12:15], s21 offen lds
  v_mfma_f32_32x32x16_bf16 a[80:95], v[76:79], v[44:47], a[80:95]
  ds_read_b64_tr_b16 v[94:95], v31 offset:10240
  s_add_u32 m0, s30, 4096
  s_nop 0
  buffer_load_dwordx4 v14, s[12:15], s21 offen lds
  v_mfma_f32_32x32x16_bf16 a[96:111], v[80:83], v[44:47], a[96:111]
  ds_read_b128 v[64:67], v23 offset:8192
  s_add_u32 m0, s30, 5120
  s_nop 0
  buffer_load_dwordx4 v15, s[12:15], s21 offen lds
  v_mfma_f32_32x32x16_bf16 a[112:127], v[84:87], v[44:47], a[112:127]
  ds_read_b64_tr_b16 v[96:97], v32 offset:8192
  v_mfma_f32_32x32x16_bf16 a[128:143], v[72:75], v[48:51], a[128:143]
  ds_read_b64_tr_b16 v[98:99], v32 offset:10240
  v_mfma_f32_32x32x16_bf16 a[144:159], v[76:79], v[48:51], a[144:159]
  ds_read_b128 v[68:71], v23 offset:12288
  v_mfma_f32_32x32x16_bf16 a[160:175], v[80:83], v[48:51], a[160:175]
  ds_read_b64_tr_b16 v[100:101], v33 offset:8192
  v_mfma_f32_32x32x16_bf16 a[176:191], v[84:87], v[48:51], a[176:191]
  ds_read_b64_tr_b16 v[102:103], v33 offset:10240
  v_mfma_f32_32x32x16_bf16 a[192:207], v[72:75], v[52:55], a[192:207]
  v_mfma_f32_32x32x16_bf16 a[208:223], v[76:79], v[52:55], a[208:223]
  v_mfma_f32_32x32x16_bf16 a[224:239], v[80:83], v[52:55], a[224:239]
  v_mfma_f32_32x32x16_bf16 a[240:255], v[84:87], v[52:55], a[240:255]
  s_waitcnt lgkmcnt(0)
  v_mfma_f32_32x32x16_bf16 a[0:15], v[88:91], v[56:59], a[0:15]
  ds_read_b128 v[40:43], v24 offset:0
  s_add_u32 m0, s30, 6144
  s_nop 0
  buffer_load_dwordx4 v16, s[12:15], s21 offen lds
  v_mfma_f32_32x32x16_bf16 a[16:31], v[92:95], v[56:59], a[16:31]
  ds_read_b64_tr_b16 v[72:73], v30 offset:16384
  s_add_u32 m0, s30, 7168
  s_nop 0
  buffer_load_dwordx4 v17, s[12:15], s21 offen lds
  v_mfma_f32_32x32x16_bf16 a[32:47], v[96:99], v[56:59], a[32:47]
  ds_read_b64_tr_b16 v[74:75], v30 offset:18432
  s_add_u32 s20, s20, 128
  s_add_u32 s21, s21, s28
  v_mfma_f32_32x32x16_bf16 a[48:63], v[100:103], v[56:59], a[48:63]
  ds_read_b128 v[44:47], v24 offset:4096
  v_mfma_f32_32x32x16_bf16 a[64:79], v[88:91], v[60:63], a[64:79]
  ds_read_b64_tr_b16 v[76:77], v31 offset:16384
  v_mfma_f32_32x32x16_bf16 a[80:95], v[92:95], v[60:63], a[80:95]
  ds_read_b64_tr_b16 v[78:79], v31 offset:18432
  v_mfma_f32_32x32x16_bf16 a[96:111], v[96:99], v[60:63], a[96:111]
  ds_read_b128 v[48:51], v24 offset:8192
  v_mfma_f32_32x32x16_bf16 a[112:127], v[100:103], v[60:63], a[112:127]
  ds_read_b64_tr_b16 v[80:81], v32 offset:16384
  v_mfma_f32_32x32x16_bf16 a[128:143], v[88:91], v[64:67], a[128:143]
  ds_read_b64_tr_b16 v[82:83], v32 offset:18432
  v_mfma_f32_32x32x16_bf16 a[144:159], v[92:95], v[64:67], a[144:159]
  ds_read_b128 v[52:55], v24 offset:12288
  v_mfma_f32_32x32x16_bf16 a[160:175], v[96:99], v[64:67], a[160:175]
  ds_read_b64_tr_b16 v[84:85], v33 offset:16384
  v_mfma_f32_32x32x16_bf16 a[176:191], v[100:103], v[64:67], a[176:191]
  ds_read_b64_tr_b16 v[86:87], v33 offset:18432
  v_mfma_f32_32x32x16_bf16 a[192:207], v[88:91], v[68:71], a[192:207]
  v_mfma_f32_32x32x16_bf16 a[208:223], v[92:95], v[68:71], a[208:223]
  v_mfma_f32_32x32x16_bf16 a[224:239], v[96:99], v[68:71], a[224:239]
  v_mfma_f32_32x32x16_bf16 a[240:255], v[100:103], v[68:71], a[240:255]
  s_waitcnt lgkmcnt(0)
  v_mfma_f32_32x32x16_bf16 a[0:15], v[72:75], v[40:43], a[0:15]
  ds_read_b128 v[56:59], v25 offset:0
  v_mfma_f32_32x32x16_bf16 a[16:31], v[76:79], v[40:43], a[16:31]
  ds_read_b64_tr_b16 v[88:89], v30 offset:24576
  v_mfma_f32_32x32x16_bf16 a[32:47], v[80:83], v[40:43], a[32:47]
  ds_read_b64_tr_b16 v[90:91], v30 offset:26624
  v_mfma_f32_32x32x16_bf16 a[48:63], v[84:87], v[40:43], a[48:63]
  ds_read_b128 v[60:63], v25 offset:4096
  v_mfma_f32_32x32x16_bf16 a[64:79], v[72:75], v[44:47], a[64:79]
  ds_read_b64_tr_b16 v[92:93], v31 offset:24576
  v_mfma_f32_32x32x16_bf16 a[80:95], v[76:79], v[44:47], a[80:95]
  ds_read_b64_tr_b16 v[94:95], v31 offset:26624
  v_mfma_f32_32x32x16_bf16 a[96:111], v[80:83], v[44:47], a[96:111]
  ds_read_b128 v[64:67], v25 offset:8192
  v_mfma_f32_32x32x16_bf16 a[112:127], v[84:87], v[44:47], a[112:127]
  ds_read_b64_tr_b16 v[96:97], v32 offset:24576
  v_mfma_f32_32x32x16_bf16 a[128:143], v[72:75], v[48:51], a[128:143]
  ds_read_b64_tr_b16 v[98:99], v32 offset:26624
  v_mfma_f32_32x32x16_bf16 a[144:159], v[76:79], v[48:51], a[144:159]
  ds_read_b128 v[68:71], v25 offset:12288
  v_mfma_f32_32x32x16_bf16 a[160:175], v[80:83], v[48:51], a[160:175]
  ds_read_b64_tr_b16 v[100:101], v33 offset:24576
  v_mfma_f32_32x32x16_bf16 a[176:191], v[84:87], v[48:51], a[176:191]
  ds_read_b64_tr_b16 v[102:103], v33 offset:26624
  v_mfma_f32_32x32x16_bf16 a[192:207], v[72:75], v[52:55], a[192:207]
  v_mfma_f32_32x32x16_bf16 a[208:223], v[76:79], v[52:55], a[208:223]
  v_mfma_f32_32x32x16_bf16 a[224:239], v[80:83], v[52:55], a[224:239]
  v_mfma_f32_32x32x16_bf16 a[240:255], v[84:87], v[52:55], a[240:255]
  s_waitcnt lgkmcnt(0)
  v_mfma_f32_32x32x16_bf16 a[0:15], v[88:91], v[56:59], a[0:15]
  s_waitcnt vmcnt(0)
  s_barrier
  v_mfma_f32_32x32x16_bf16 a[16:31], v[92:95], v[56:59], a[16:31]
  ds_read_b128 v[40:43], v18 offset:0
  s_add_u32 m0, s29, 65536
  s_nop 0
  buffer_load_dwordx4 v2, s[8:11], s20 offen lds
  v_mfma_f32_32x32x16_bf16 a[32:47], v[96:99], v[56:59], a[32:47]
  ds_read_b64_tr_b16 v[72:73], v26 offset:0
  s_add_u32 m0, s29, 66560
  s_nop 0
  buffer_load_dwordx4 v3, s[8:11], s20 offen lds
  v_mfma_f32_32x32x16_bf16 a[48:63], v[100:103], v[56:59], a[48:63]
  ds_read_b64_tr_b16 v[74:75], v26 offset:2048
  s_add_u32 m0, s29, 67584
  s_nop 0
  buffer_load_dwordx4 v4, s[8:11], s20 offen lds
  v_mfma_f32_32x32x16_bf16 a[64:79], v[88:91], v[60:63], a[64:79]
  ds_read_b128 v[44:47], v18 offset:4096
  s_add_u32 m0, s29, 68608
  s_nop 0
  buffer_load_dwordx4 v5, s[8:11], s20 offen lds
  v_mfma_f32_32x32x16_bf16 a[80:95], v[92:95], v[60:63], a[80:95]
  ds_read_b64_tr_b16 v[76:77], v27 offset:0
  s_add_u32 m0, s29, 69632
  s_nop 0
  buffer_load_dwordx4 v6, s[8:11], s20 offen lds
  v_mfma_f32_32x32x16_bf16 a[96:111], v[96:99], v[60:63], a[96:111]
  ds_read_b64_tr_b16 v[78:79], v27 offset:2048
  s_add_u32 m0, s29, 70656
  s_nop 0
  buffer_load_dwordx4 v7, s[8:11], s20 offen lds
  v_mfma_f32_32x32x16_bf16 a[112:127], v[100:103], v[60:63], a[112:127]
  ds_read_b128 v[48:51], v18 offset:8192
  s_add_u32 m0, s29, 71680
  s_nop 0
  buffer_load_dwordx4 v8, s[8:11], s20 offen lds
  v_mfma_f32_32x32x16_bf16 a[128:143], v[88:91], v[64:67], a[128:143]
  ds_read_b64_tr_b16 v[80:81], v28 offset:0
  v_mfma_f32_32x32x16_bf16 a[144:159], v[92:95], v[64:67], a[144:159]
  ds_read_b64_tr_b16 v[82:83], v28 offset:2048
  v_mfma_f32_32x32x16_bf16 a[160:175], v[96:99], v[64:67], a[160:175]
  ds_read_b128 v[52:55], v18 offset:12288
  v_mfma_f32_32x32x16_bf16 a[176:191], v[100:103], v[64:67], a[176:191]
  ds_read_b64_tr_b16 v[84:85], v29 offset:0
  v_mfma_f32_32x32x16_bf16 a[192:207], v[88:91], v[68:71], a[192:207]
  ds_read_b64_tr_b16 v[86:87], v29 offset:2048
  v_mfma_f32_32x32x16_bf16 a[208:223], v[92:95], v[68:71], a[208:223]
  v_mfma_f32_32x32x16_bf16 a[224:239], v[96:99], v[68:71], a[224:239]
  v_mfma_f32_32x32x16_bf16 a[240:255], v[100:103], v[68:71], a[240:255]
  s_sub_u32 s25, s25, 1
  s_cmp_eq_u32 s25, 0
  s_cbranch_scc1 L_g1_fin
  s_waitcnt lgkmcnt(0)
  v_mfma_f32_32x32x16_bf16 a[0:15], v[72:75], v[40:43], a[0:15]
  ds_read_b128 v[56:59], v19 offset:0
  s_add_u32 m0, s29, 72704
  s_nop 0
  buffer_load_dwordx4 v9, s[8:11], s20 offen lds
  v_mfma_f32_32x32x16_bf16 a[16:31], v[76:79], v[40:43], a[16:31]
  ds_read_b64_tr_b16 v[88:89], v26 offset:8192
  s_add_u32 m0, s30, 65536
  s_nop 0
  buffer_load_dwordx4 v10, s[12:15], s21 offen lds
  v_mfma_f32_32x32x16_bf16 a[32:47], v[80:83], v[40:43], a[32:47]
  ds_read_b64_tr_b16 v[90:91], v26 offset:10240
  s_add_u32 m0, s30, 66560
  s_nop 0
  buffer_load_dwordx4 v11, s[12:15], s21 offen lds
  v_mfma_f32_32x32x16_bf16 a[48:63], v[84:87], v[40:43], a[48:63]
  ds_read_b128 v[60:63], v19 offset:4096
  s_add_u32 m0, s30, 67584
  s_nop 0
  buffer_load_dwordx4 v12, s[12:15], s21 offen lds
  v_mfma_f32_32x32x16_bf16 a[64:79], v[72:75], v[44:47], a[64:79]
  ds_read_b64_tr_b16 v[92:93], v27 offset:8192
  s_add_u32 m0, s30, 68608
  s_nop 0
  buffer_load_dwordx4 v13, s[12:15], s21 offen lds
  v_mfma_f32_32x32x16_bf16 a[80:95], v[76:79], v[44:47], a[80:95]
  ds_read_b64_tr_b16 v[94:95], v27 offset:10240
  s_add_u32 m0, s30, 69632
  s_nop 0
  buffer_load_dwordx4 v14, s[12:15], s21 offen lds
  v_mfma_f32_32x32x16_bf16 a[96:111], v[80:83], v[44:47], a[96:111]
  ds_read_b128 v[64:67], v19 offset:8192
  s_add_u32 m0, s30, 70656
  s_nop 0
  buffer_load_dwordx4 v15, s[12:15], s21 offen lds
  v_mfma_f32_32x32x16_bf16 a[112:127], v[84:87], v[44:47], a[112:127]
  ds_read_b64_tr_b16 v[96:97], v28 offset:8192
  v_mfma_f32_32x32x16_bf16 a[128:143], v[72:75], v[48:51], a[128:143]
  ds_read_b64_tr_b16 v[98:99], v28 offset:10240
  v_mfma_f32_32x32x16_bf16 a[144:159], v[76:79], v[48:51], a[144:159]
  ds_read_b128 v[68:71], v19 offset:12288
  v_mfma_f32_32x32x16_bf16 a[160:175], v[80:83], v[48:51], a[160:175]
  ds_read_b64_tr_b16 v[100:101], v29 offset:8192
  v_mfma_f32_32x32x16_bf16 a[176:191], v[84:87], v[48:51], a[176:191]
  ds_read_b64_tr_b16 v[102:103], v29 offset:10240
  v_mfma_f32_32x32x16_bf16 a[192:207], v[72:75], v[52:55], a[192:207]
  v_mfma_f32_32x32x16_bf16 a[208:223], v[76:79], v[52:55], a[208:223]
  v_mfma_f32_32x32x16_bf16 a[224:239], v[80:83], v[52:55], a[224:239]
  v_mfma_f32_32x32x16_bf16 a[240:255], v[84:87], v[52:55], a[240:255]
  s_waitcnt lgkmcnt(0)
  v_mfma_f32_32x32x16_bf16 a[0:15], v[88:91], v[56:59], a[0:15]
  ds_read_b128 v[40:43], v20 offset:0
  s_add_u32 m0, s30, 71680
  s_nop 0
  buffer_load_dwordx4 v16, s[12:15], s21 offen lds
  v_mfma_f32_32x32x16_bf16 a[16:31], v[92:95], v[56:59], a[16:31]
  ds_read_b64_tr_b16 v[72:73], v26 offset:16384
  s_add_u32 m0, s30, 72704
  s_nop 0
  buffer_load_dwordx4 v17, s[12:15], s21 offen lds
  v_mfma_f32_32x32x16_bf16 a[32:47], v[96:99], v[56:59], a[32:47]
  ds_read_b64_tr_b16 v[74:75], v26 offset:18432
  s_add_u32 s20, s20, 128
  s_add_u32 s21, s21, s28
  v_mfma_f32_32x32x16_bf16 a[48:63], v[100:103], v[56:59], a[48:63]
  ds_read_b128 v[44:47], v20 offset:4096
  v_mfma_f32_32x32x16_bf16 a[64:79], v[88:91], v[60:63], a[64:79]
  ds_read_b64_tr_b16 v[76:77], v27 offset:16384
  v_mfma_f32_32x32x16_bf16 a[80:95], v[92:95], v[60:63], a[80:95]
  ds_read_b64_tr_b16 v[78:79], v27 offset:18432
  v_mfma_f32_32x32x16_bf16 a[96:111], v[96:99], v[60:63], a[96:111]
  ds_read_b128 v[48:51], v20 offset:8192
  v_mfma_f32_32x32x16_bf16 a[112:127], v[100:103], v[60:63], a[112:127]
  ds_read_b64_tr_b16 v[80:81], v28 offset:16384
  v_mfma_f32_32x32x16_bf16 a[128:143], v[88:91], v[64:67], a[128:143]
  ds_read_b64_tr_b16 v[82:83], v28 offset:18432
  v_mfma_f32_32x32x16_bf16 a[144:159], v[92:95], v[64:67], a[144:159]
  ds_read_b128 v[52:55], v20 offset:12288
  v_mfma_f32_32x32x16_bf16 a[160:175], v[96:99], v[64:67], a[160:175]
  ds_read_b64_tr_b16 v[84:85], v29 offset:16384
  v_mfma_f32_32x32x16_bf16 a[176:191], v[100:103], v[64:67], a[176:191]
  ds_read_b64_tr_b16 v[86:87], v29 offset:18432
  v_mfma_f32_32x32x16_bf16 a[192:207], v[88:91], v[68:71], a[192:207]
  v_mfma_f32_32x32x16_bf16 a[208:223], v[92:95], v[68:71], a[208:223]
  v_mfma_f32_32x32x16_bf16 a[224:239], v[96:99], v[68:71], a[224:239]
  v_mfma_f32_32x32x16_bf16 a[240:255], v[100:103], v[68:71], a[240:255]
  s_waitcnt lgkmcnt(0)
  v_mfma_f32_32x32x16_bf16 a[0:15], v[72:75], v[40:43], a[0:15]
  ds_read_b128 v[56:59], v21 offset:0
  v_mfma_f32_32x32x16_bf16 a[16:31], v[76:79], v[40:43], a[16:31]
  ds_read_b64_tr_b16 v[88:89], v26 offset:24576
  v_mfma_f32_32x32x16_bf16 a[32:47], v[80:83], v[40:43], a[32:47]
  ds_read_b64_tr_b16 v[90:91], v26 offset:26624
  v_mfma_f32_32x32x16_bf16 a[48:63], v[84:87], v[40:43], a[48:63]
  ds_read_b128 v[60:63], v21 offset:4096
  v_mfma_f32_32x32x16_bf16 a[64:79], v[72:75], v[44:47], a[64:79]
  ds_read_b64_tr_b16 v[92:93], v27 offset:24576
  v_mfma_f32_32x32x16_bf16 a[80:95], v[76:79], v[44:47], a[80:95]
  ds_read_b64_tr_b16 v[94:95], v27 offset:26624
  v_mfma_f32_32x32x16_bf16 a[96:111], v[80:83], v[44:47], a[96:111]
  ds_read_b128 v[64:67], v21 offset:8192
  v_mfma_f32_32x32x16_bf16 a[112:127], v[84:87], v[44:47], a[112:127]
  ds_read_b64_tr_b16 v[96:97], v28 offset:24576
  v_mfma_f32_32x32x16_bf16 a[128:143], v[72:75], v[48:51], a[128:143]
  ds_read_b64_tr_b16 v[98:99], v28 offset:26624
  v_mfma_f32_32x32x16_bf16 a[144:159], v[76:79], v[48:51], a[144:159]
  ds_read_b128 v[68:71], v21 offset:12288
  v_mfma_f32_32x32x16_bf16 a[160:175], v[80:83], v[48:51], a[160:175]
  ds_read_b64_tr_b16 v[100:101], v29 offset:24576
  v_mfma_f32_32x32x16_bf16 a[176:191], v[84:87], v[48:51], a[176:191]
  ds_read_b64_tr_b16 v[102:103], v29 offset:26624
  v_mfma_f32_32x32x16_bf16 a[192:207], v[72:75], v[52:55], a[192:207]
  v_mfma_f32_32x32x16_bf16 a[208:223], v[76:79], v[52:55], a[208:223]
  v_mfma_f32_32x32x16_bf16 a[224:239], v[80:83], v[52:55], a[224:239]
  v_mfma_f32_32x32x16_bf16 a[240:255], v[84:87], v[52:55], a[240:255]
  s_waitcnt lgkmcnt(0)
  v_mfma_f32_32x32x16_bf16 a[0:15], v[88:91], v[56:59], a[0:15]
  s_waitcnt vmcnt(0)
  s_barrier
  v_mfma_f32_32x32x16_bf16 a[16:31], v[92:95], v[56:59], a[16:31]
  ds_read_b128 v[40:43], v22 offset:0
  s_add_u32 m0, s29, 0
  s_nop 0
  buffer_load_dwordx4 v2, s[8:11], s20 offen lds
  v_mfma_f32_32x32x16_bf16 a[32:47], v[96:99], v[56:59], a[32:47]
  ds_read_b64_tr_b16 v[72:73], v30 offset:0
  s_add_u32 m0, s29, 1024
  s_nop 0
  buffer_load_dwordx4 v3, s[8:11], s20 offen lds
  v_mfma_f32_32x32x16_bf16 a[48:63], v[100:103], v[56:59], a[48:63]
  ds_read_b64_tr_b16 v[74:75], v30 offset:2048
  s_add_u32 m0, s29, 2048
  s_nop 0
  buffer_load_dwordx4 v4, s[8:11], s20 offen lds
  v_mfma_f32_32x32x16_bf16 a[64:79], v[88:91], v[60:63], a[64:79]
  ds_read_b128 v[44:47], v22 offset:4096
  s_add_u32 m0, s29, 3072
  s_nop 0
  buffer_load_dwordx4 v5, s[8:11], s20 offen lds
  v_mfma_f32_32x32x16_bf16 a[80:95], v[92:95], v[60:63], a[80:95]
  ds_read_b64_tr_b16 v[76:77], v31 offset:0
  s_add_u32 m0, s29, 4096
  s_nop 0
  buffer_load_dwordx4 v6, s[8:11], s20 offen lds
  v_mfma_f32_32x32x16_bf16 a[96:111], v[96:99], v[60:63], a[96:111]
  ds_read_b64_tr_b16 v[78:79], v31 offset:2048
  s_add_u32 m0, s29, 5120
  s_nop 0
  buffer_load_dwordx4 v7, s[8:11], s20 offen lds
  v_mfma_f32_32x32x16_bf16 a[112:127], v[100:103], v[60:63], a[112:127]
  ds_read_b128 v[48:51], v22 offset:8192
  s_add_u32 m0, s29, 6144
  s_nop 0
  buffer_load_dwordx4 v8, s[8:11], s20 offen lds
  v_mfma_f32_32x32x16_bf16 a[128:143], v[88:91], v[64:67], a[128:143]
  ds_read_b64_tr_b16 v[80:81], v32 offset:0
  v_mfma_f32_32x32x16_bf16 a[144:159], v[92:95], v[64:67], a[144:159]
  ds_read_b64_tr_b16 v[82:83], v32 offset:2048
  v_mfma_f32_32x32x16_bf16 a[160:175], v[96:99], v[64:67], a[160:175]
  ds_read_b128 v[52:55], v22 offset:12288
  v_mfma_f32_32x32x16_bf16 a[176:191], v[100:103], v[64:67], a[176:191]
  ds_read_b64_tr_b16 v[84:85], v33 offset:0
  v_mfma_f32_32x32x16_bf16 a[192:207], v[88:91], v[68:71], a[192:207]
  ds_read_b64_tr_b16 v[86:87], v33 offset:2048
  v_mfma_f32_32x32x16_bf16 a[208:223], v[92:95], v[68:71], a[208:223]
  v_mfma_f32_32x32x16_bf16 a[224:239], v[96:99], v[68:71], a[224:239]
  v_mfma_f32_32x32x16_bf16 a[240:255], v[100:103], v[68:71], a[240:255]
  s_branch L_g1_loop
L_g1_fin:
  s_waitcnt lgkmcnt(0)
  v_mfma_f32_32x32x16_bf16 a[0:15], v[72:75], v[40:43], a[0:15]
  ds_read_b128 v[56:59], v19 offset:0
  s_add_u32 m0, s29, 72704
  s_nop 0
  buffer_load_dwordx4 v9, s[8:11], s20 offen lds
  v_mfma_f32_32x32x16_bf16 a[16:31], v[76:79], v[40:43], a[16:31]
  ds_read_b64_tr_b16 v[88:89], v26 offset:8192
  s_add_u32 m0, s30, 65536
  s_nop 0
  buffer_load_dwordx4 v10, s[12:15], s21 offen lds
  v_mfma_f32_32x32x16_bf16 a[32:47], v[80:83], v[40:43], a[32:47]
  ds_read_b64_tr_b16 v[90:91], v26 offset:10240
  s_add_u32 m0, s30, 66560
  s_nop 0
  buffer_load_dwordx4 v11, s[12:15], s21 offen lds
  v_mfma_f32_32x32x16_bf16 a[48:63], v[84:87], v[40:43], a[48:63]
  ds_read_b128 v[60:63], v19 offset:4096
  s_add_u32 m0, s30, 67584
  s_nop 0
  buffer_load_dwordx4 v12, s[12:15], s21 offen lds
  v_mfma_f32_32x32x16_bf16 a[64:79], v[72:75], v[44:47], a[64:79]
  ds_read_b64_tr_b16 v[92:93], v27 offset:8192
  s_add_u32 m0, s30, 68608
  s_nop 0
  buffer_load_dwordx4 v13, s[12:15], s21 offen lds
  v_mfma_f32_32x32x16_bf16 a[80:95], v[76:79], v[44:47], a[80:95]
  ds_read_b64_tr_b16 v[94:95], v27 offset:10240
  s_add_u32 m0, s30, 69632
  s_nop 0
  buffer_load_dwordx4 v14, s[12:15], s21 offen lds
  v_mfma_f32_32x32x16_bf16 a[96:111], v[80:83], v[44:47], a[96:111]
  ds_read_b128 v[64:67], v19 offset:8192
  s_add_u32 m0, s30, 70656
  s_nop 0
  buffer_load_dwordx4 v15, s[12:15], s21 offen lds
  v_mfma_f32_32x32x16_bf16 a[112:127], v[84:87], v[44:47], a[112:127]
  ds_read_b64_tr_b16 v[96:97], v28 offset:8192
  v_mfma_f32_32x32x16_bf16 a[128:143], v[72:75], v[48:51], a[128:143]
  ds_read_b64_tr_b16 v[98:99], v28 offset:10240
  v_mfma_f32_32x32x16_bf16 a[144:159], v[76:79], v[48:51], a[144:159]
  ds_read_b128 v[68:71], v19 offset:12288
  v_mfma_f32_32x32x16_bf16 a[160:175], v[80:83], v[48:51], a[160:175]
  ds_read_b64_tr_b16 v[100:101], v29 offset:8192
  v_mfma_f32_32x32x16_bf16 a[176:191], v[84:87], v[48:51], a[176:191]
  ds_read_b64_tr_b16 v[102:103], v29 offset:10240
  v_mfma_f32_32x32x16_bf16 a[192:207], v[72:75], v[52:55], a[192:207]
  v_mfma_f32_32x32x16_bf16 a[208:223], v[76:79], v[52:55], a[208:223]
  v_mfma_f32_32x32x16_bf16 a[224:239], v[80:83], v[52:55], a[224:239]
  v_mfma_f32_32x32x16_bf16 a[240:255], v[84:87], v[52:55], a[240:255]
  s_waitcnt lgkmcnt(0)
  v_mfma_f32_32x32x16_bf16 a[0:15], v[88:91], v[56:59], a[0:15]
  ds_read_b128 v[40:43], v20 offset:0
  s_add_u32 m0, s30, 71680
  s_nop 0
  buffer_load_dwordx4 v16, s[12:15], s21 offen lds
  v_mfma_f32_32x32x16_bf16 a[16:31], v[92:95], v[56:59], a[16:31]
  ds_read_b64_tr_b16 v[72:73], v26 offset:16384
  s_add_u32 m0, s30, 72704
  s_nop 0
  buffer_load_dwordx4 v17, s[12:15], s21 offen lds
  v_mfma_f32_32x32x16_bf16 a[32:47], v[96:99], v[56:59], a[32:47]
  ds_read_b64_tr_b16 v[74:75], v26 offset:18432
  s_add_u32 s20, s20, 128
  s_add_u32 s21, s21, s28
  v_mfma_f32_32x32x16_bf16 a[48:63], v[100:103], v[56:59], a[48:63]
  ds_read_b128 v[44:47], v20 offset:4096
  v_mfma_f32_32x32x16_bf16 a[64:79], v[88:91], v[60:63], a[64:79]
  ds_read_b64_tr_b16 v[76:77], v27 offset:16384
  v_mfma_f32_32x32x16_bf16 a[80:95], v[92:95], v[60:63], a[80:95]
  ds_read_b64_tr_b16 v[78:79], v27 offset:18432
  v_mfma_f32_32x32x16_bf16 a[96:111], v[96:99], v[60:63], a[96:111]
  ds_read_b128 v[48:51], v20 offset:8192
  v_mfma_f32_32x32x16_bf16 a[112:127], v[100:103], v[60:63], a[112:127]
  ds_read_b64_tr_b16 v[80:81], v28 offset:16384
  v_mfma_f32_32x32x16_bf16 a[128:143], v[88:91], v[64:67], a[128:143]
  ds_read_b64_tr_b16 v[82:83], v28 offset:18432
  v_mfma_f32_32x32x16_bf16 a[144:159], v[92:95], v[64:67], a[144:159]
  ds_read_b128 v[52:55], v20 offset:12288
  v_mfma_f32_32x32x16_bf16 a[160:175], v[96:99], v[64:67], a[160:175]
  ds_read_b64_tr_b16 v[84:85], v29 offset:16384
  v_mfma_f32_32x32x16_bf16 a[176:191], v[100:103], v[64:67], a[176:191]
  ds_read_b64_tr_b16 v[86:87], v29 offset:18432
  v_mfma_f32_32x32x16_bf16 a[192:207], v[88:91], v[68:71], a[192:207]
  v_mfma_f32_32x32x16_bf16 a[208:223], v[92:95], v[68:71], a[208:223]
  v_mfma_f32_32x32x16_bf16 a[224:239], v[96:99], v[68:71], a[224:239]
  v_mfma_f32_32x32x16_bf16 a[240:255], v[100:103], v[68:71], a[240:255]
  s_waitcnt lgkmcnt(0)
  v_mfma_f32_32x32x16_bf16 a[0:15], v[72:75], v[40:43], a[0:15]
  ds_read_b128 v[56:59], v21 offset:0
  v_mfma_f32_32x32x16_bf16 a[16:31], v[76:79], v[40:43], a[16:31]
  ds_read_b64_tr_b16 v[88:89], v26 offset:24576
  v_mfma_f32_32x32x16_bf16 a[32:47], v[80:83], v[40:43], a[32:47]
  ds_read_b64_tr_b16 v[90:91], v26 offset:26624
  v_mfma_f32_32x32x16_bf16 a[48:63], v[84:87], v[40:43], a[48:63]
  ds_read_b128 v[60:63], v21 offset:4096
  v_mfma_f32_32x32x16_bf16 a[64:79], v[72:75], v[44:47], a[64:79]
  ds_read_b64_tr_b16 v[92:93], v27 offset:24576
  v_mfma_f32_32x32x16_bf16 a[80:95], v[76:79], v[44:47], a[80:95]
  ds_read_b64_tr_b16 v[94:95], v27 offset:26624
  v_mfma_f32_32x32x16_bf16 a[96:111], v[80:83], v[44:47], a[96:111]
  ds_read_b128 v[64:67], v21 offset:8192
  v_mfma_f32_32x32x16_bf16 a[112:127], v[84:87], v[44:47], a[112:127]
  ds_read_b64_tr_b16 v[96:97], v28 offset:24576
  v_mfma_f32_32x32x16_bf16 a[128:143], v[72:75], v[48:51], a[128:143]
  ds_read_b64_tr_b16 v[98:99], v28 offset:26624
  v_mfma_f32_32x32x16_bf16 a[144:159], v[76:79], v[48:51], a[144:159]
  ds_read_b128 v[68:71], v21 offset:12288
  v_mfma_f32_32x32x16_bf16 a[160:175], v[80:83], v[48:51], a[160:175]
  ds_read_b64_tr_b16 v[100:101], v29 offset:24576
  v_mfma_f32_32x32x16_bf16 a[176:191], v[84:87], v[48:51], a[176:191]
  ds_read_b64_tr_b16 v[102:103], v29 offset:26624
  v_mfma_f32_32x32x16_bf16 a[192:207], v[72:75], v[52:55], a[192:207]
  v_mfma_f32_32x32x16_bf16 a[208:223], v[76:79], v[52:55], a[208:223]
  v_mfma_f32_32x32x16_bf16 a[224:239], v[80:83], v[52:55], a[224:239]
  v_mfma_f32_32x32x16_bf16 a[240:255], v[84:87], v[52:55], a[240:255]
  s_waitcnt lgkmcnt(0)
  v_mfma_f32_32x32x16_bf16 a[0:15], v[88:91], v[56:59], a[0:15]
  s_waitcnt vmcnt(0)
  s_barrier
  v_mfma_f32_32x32x16_bf16 a[16:31], v[92:95], v[56:59], a[16:31]
  ds_read_b128 v[40:43], v22 offset:0
  v_mfma_f32_32x32x16_bf16 a[32:47], v[96:99], v[56:59], a[32:47]
  ds_read_b64_tr_b16 v[72:73], v30 offset:0
  v_mfma_f32_32x32x16_bf16 a[48:63], v[100:103], v[56:59], a[48:63]
  ds_read_b64_tr_b16 v[74:75], v30 offset:2048
  v_mfma_f32_32x32x16_bf16 a[64:79], v[88:91], v[60:63], a[64:79]
  ds_read_b128 v[44:47], v22 offset:4096
  v_mfma_f32_32x32x16_bf16 a[80:95], v[92:95], v[60:63], a[80:95]
  ds_read_b64_tr_b16 v[76:77], v31 offset:0
  v_mfma_f32_32x32x16_bf16 a[96:111], v[96:99], v[60:63], a[96:111]
  ds_read_b64_tr_b16 v[78:79], v31 offset:2048
  v_mfma_f32_32x32x16_bf16 a[112:127], v[100:103], v[60:63], a[112:127]
  ds_read_b128 v[48:51], v22 offset:8192
  v_mfma_f32_32x32x16_bf16 a[128:143], v[88:91], v[64:67], a[128:143]
  ds_read_b64_tr_b16 v[80:81], v32 offset:0
  v_mfma_f32_32x32x16_bf16 a[144:159], v[92:95], v[64:67], a[144:159]
  ds_read_b64_tr_b16 v[82:83], v32 offset:2048
  v_mfma_f32_32x32x16_bf16 a[160:175], v[96:99], v[64:67], a[160:175]
  ds_read_b128 v[52:55], v22 offset:12288
  v_mfma_f32_32x32x16_bf16 a[176:191], v[100:103], v[64:67], a[176:191]
  ds_read_b64_tr_b16 v[84:85], v33 offset:0
  v_mfma_f32_32x32x16_bf16 a[192:207], v[88:91], v[68:71], a[192:207]
  ds_read_b64_tr_b16 v[86:87], v33 offset:2048
  v_mfma_f32_32x32x16_bf16 a[208:223], v[92:95], v[68:71], a[208:223]
  v_mfma_f32_32x32x16_bf16 a[224:239], v[96:99], v[68:71], a[224:239]
  v_mfma_f32_32x32x16_bf16 a[240:255], v[100:103], v[68:71], a[240:255]
  s_waitcnt lgkmcnt(0)
  v_mfma_f32_32x32x16_bf16 a[0:15], v[72:75], v[40:43], a[0:15]
  ds_read_b128 v[56:59], v23 offset:0
  v_mfma_f32_32x32x16_bf16 a[16:31], v[76:79], v[40:43], a[16:31]
  ds_read_b64_tr_b16 v[88:89], v30 offset:8192
  v_mfma_f32_32x32x16_bf16 a[32:47], v[80:83], v[40:43], a[32:47]
  ds_read_b64_tr_b16 v[90:91], v30 offset:10240
  v_mfma_f32_32x32x16_bf16 a[48:63], v[84:87], v[40:43], a[48:63]
  ds_read_b128 v[60:63], v23 offset:4096
  v_mfma_f32_32x32x16_bf16 a[64:79], v[72:75], v[44:47], a[64:79]
  ds_read_b64_tr_b16 v[92:93], v31 offset:8192
  v_mfma_f32_32x32x16_bf16 a[80:95], v[76:79], v[44:47], a[80:95]
  ds_read_b64_tr_b16 v[94:95], v31 offset:10240
  v_mfma_f32_32x32x16_bf16 a[96:111], v[80:83], v[44:47], a[96:111]
  ds_read_b128 v[64:67], v23 offset:8192
  v_mfma_f32_32x32x16_bf16 a[112:127], v[84:87], v[44:47], a[112:127]
  ds_read_b64_tr_b16 v[96:97], v32 offset:8192
  v_mfma_f32_32x32x16_bf16 a[128:143], v[72:75], v[48:51], a[128:143]
  ds_read_b64_tr_b16 v[98:99], v32 offset:10240
  v_mfma_f32_32x32x16_bf16 a[144:159], v[76:79], v[48:51], a[144:159]
  ds_read_b128 v[68:71], v23 offset:12288
  v_mfma_f32_32x32x16_bf16 a[160:175], v[80:83], v[48:51], a[160:175]
  ds_read_b64_tr_b16 v[100:101], v33 offset:8192
  v_mfma_f32_32x32x16_bf16 a[176:191], v[84:87], v[48:51], a[176:191]
  ds_read_b64_tr_b16 v[102:103], v33 offset:10240
  v_mfma_f32_32x32x16_bf16 a[192:207], v[72:75], v[52:55], a[192:207]
  v_mfma_f32_32x32x16_bf16 a[208:223], v[76:79], v[52:55], a[208:223]
  v_mfma_f32_32x32x16_bf16 a[224:239], v[80:83], v[52:55], a[224:239]
  v_mfma_f32_32x32x16_bf16 a[240:255], v[84:87], v[52:55], a[240:255]
  s_waitcnt lgkmcnt(0)
  v_mfma_f32_32x32x16_bf16 a[0:15], v[88:91], v[56:59], a[0:15]
  ds_read_b128 v[40:43], v24 offset:0
  v_mfma_f32_32x32x16_bf16 a[16:31], v[92:95], v[56:59], a[16:31]
  ds_read_b64_tr_b16 v[72:73], v30 offset:16384
  v_mfma_f32_32x32x16_bf16 a[32:47], v[96:99], v[56:59], a[32:47]
  ds_read_b64_tr_b16 v[74:75], v30 offset:18432
  v_mfma_f32_32x32x16_bf16 a[48:63], v[100:103], v[56:59], a[48:63]
  ds_read_b128 v[44:47], v24 offset:4096
  v_mfma_f32_32x32x16_bf16 a[64:79], v[88:91], v[60:63], a[64:79]
  ds_read_b64_tr_b16 v[76:77], v31 offset:16384
  v_mfma_f32_32x32x16_bf16 a[80:95], v[92:95], v[60:63], a[80:95]
  ds_read_b64_tr_b16 v[78:79], v31 offset:18432
  v_mfma_f32_32x32x16_bf16 a[96:111], v[96:99], v[60:63], a[96:111]
  ds_read_b128 v[48:51], v24 offset:8192
  v_mfma_f32_32x32x16_bf16 a[112:127], v[100:103], v[60:63], a[112:127]
  ds_read_b64_tr_b16 v[80:81], v32 offset:16384
  v_mfma_f32_32x32x16_bf16 a[128:143], v[88:91], v[64:67], a[128:143]
  ds_read_b64_tr_b16 v[82:83], v32 offset:18432
  v_mfma_f32_32x32x16_bf16 a[144:159], v[92:95], v[64:67], a[144:159]
  ds_read_b128 v[52:55], v24 offset:12288
  v_mfma_f32_32x32x16_bf16 a[160:175], v[96:99], v[64:67], a[160:175]
  ds_read_b64_tr_b16 v[84:85], v33 offset:16384
  v_mfma_f32_32x32x16_bf16 a[176:191], v[100:103], v[64:67], a[176:191]
  ds_read_b64_tr_b16 v[86:87], v33 offset:18432
  v_mfma_f32_32x32x16_bf16 a[192:207], v[88:91], v[68:71], a[192:207]
  v_mfma_f32_32x32x16_bf16 a[208:223], v[92:95], v[68:71], a[208:223]
  v_mfma_f32_32x32x16_bf16 a[224:239], v[96:99], v[68:71], a[224:239]
  v_mfma_f32_32x32x16_bf16 a[240:255], v[100:103], v[68:71], a[240:255]
  s_waitcnt lgkmcnt(0)
  v_mfma_f32_32x32x16_bf16 a[0:15], v[72:75], v[40:43], a[0:15]
  ds_read_b128 v[56:59], v25 offset:0
  v_mfma_f32_32x32x16_bf16 a[16:31], v[76:79], v[40:43], a[16:31]
  ds_read_b64_tr_b16 v[88:89], v30 offset:24576
  v_mfma_f32_32x32x16_bf16 a[32:47], v[80:83], v[40:43], a[32:47]
  ds_read_b64_tr_b16 v[90:91], v30 offset:26624
  v_mfma_f32_32x32x16_bf16 a[48:63], v[84:87], v[40:43], a[48:63]
  ds_read_b128 v[60:63], v25 offset:4096
  v_mfma_f32_32x32x16_bf16 a[64:79], v[72:75], v[44:47], a[64:79]
  ds_read_b64_tr_b16 v[92:93], v31 offset:24576
  v_mfma_f32_32x32x16_bf16 a[80:95], v[76:79], v[44:47], a[80:95]
  ds_read_b64_tr_b16 v[94:95], v31 offset:26624
  v_mfma_f32_32x32x16_bf16 a[96:111], v[80:83], v[44:47], a[96:111]
  ds_read_b128 v[64:67], v25 offset:8192
  v_mfma_f32_32x32x16_bf16 a[112:127], v[84:87], v[44:47], a[112:127]
  ds_read_b64_tr_b16 v[96:97], v32 offset:24576
  v_mfma_f32_32x32x16_bf16 a[128:143], v[72:75], v[48:51], a[128:143]
  ds_read_b64_tr_b16 v[98:99], v32 offset:26624
  v_mfma_f32_32x32x16_bf16 a[144:159], v[76:79], v[48:51], a[144:159]
  ds_read_b128 v[68:71], v25 offset:12288
  v_mfma_f32_32x32x16_bf16 a[160:175], v[80:83], v[48:51], a[160:175]
  ds_read_b64_tr_b16 v[100:101], v33 offset:24576
  v_mfma_f32_32x32x16_bf16 a[176:191], v[84:87], v[48:51], a[176:191]
  ds_read_b64_tr_b16 v[102:103], v33 offset:26624
  v_mfma_f32_32x32x16_bf16 a[192:207], v[72:75], v[52:55], a[192:207]
  v_mfma_f32_32x32x16_bf16 a[208:223], v[76:79], v[52:55], a[208:223]
  v_mfma_f32_32x32x16_bf16 a[224:239], v[80:83], v[52:55], a[224:239]
  v_mfma_f32_32x32x16_bf16 a[240:255], v[84:87], v[52:55], a[240:255]
  s_waitcnt lgkmcnt(0)
  v_mfma_f32_32x32x16_bf16 a[0:15], v[88:91], v[56:59], a[0:15]
  v_mfma_f32_32x32x16_bf16 a[16:31], v[92:95], v[56:59], a[16:31]
  v_mfma_f32_32x32x16_bf16 a[32:47], v[96:99], v[56:59], a[32:47]
  v_mfma_f32_32x32x16_bf16 a[48:63], v[100:103], v[56:59], a[48:63]
  v_mfma_f32_32x32x16_bf16 a[64:79], v[88:91], v[60:63], a[64:79]
  v_mfma_f32_32x32x16_bf16 a[80:95], v[92:95], v[60:63], a[80:95]
  v_mfma_f32_32x32x16_bf16 a[96:111], v[96:99], v[60:63], a[96:111]
  v_mfma_f32_32x32x16_bf16 a[112:127], v[100:103], v[60:63], a[112:127]
  v_mfma_f32_32x32x16_bf16 a[128:143], v[88:91], v[64:67], a[128:143]
  v_mfma_f32_32x32x16_bf16 a[144:159], v[92:95], v[64:67], a[144:159]
  v_mfma_f32_32x32x16_bf16 a[160:175], v[96:99], v[64:67], a[160:175]
  v_mfma_f32_32x32x16_bf16 a[176:191], v[100:103], v[64:67], a[176:191]
  v_mfma_f32_32x32x16_bf16 a[192:207], v[88:91], v[68:71], a[192:207]
  v_mfma_f32_32x32x16_bf16 a[208:223], v[92:95], v[68:71], a[208:223]
  v_mfma_f32_32x32x16_bf16 a[224:239], v[96:99], v[68:71], a[224:239]
  v_mfma_f32_32x32x16_bf16 a[240:255], v[100:103], v[68:71], a[240:255]
  s_lshr_b32 s90, s27, 1
  s_and_b32 s91, s27, 1
  v_mov_b32 v36, 0x0
  v_bfe_u32 v35, v1, 0, 4
  v_lshl_add_u32 v36, v35, 4, v36
  v_bfe_u32 v35, v1, 4, 1
  v_lshl_add_u32 v36, v35, 12, v36
  v_bfe_u32 v35, v1, 5, 1
  v_lshl_add_u32 v36, v35, 8, v36
  s_mul_i32 s92, s90, 4
  s_mul_i32 s92, s92, s26
  s_add_u32 s92, s92, s22
  s_mul_i32 s93, s91, 8192
  s_add_u32 s92, s92, s93
  s_add_u32 s93, s92, 0
  v_accvgpr_read_b32 v108, a0
  v_accvgpr_read_b32 v109, a1
  v_accvgpr_read_b32 v110, a2
  v_accvgpr_read_b32 v111, a3
  v_accvgpr_read_b32 v112, a8
  v_accvgpr_read_b32 v113, a9
  v_accvgpr_read_b32 v114, a10
  v_accvgpr_read_b32 v115, a11
  v_cvt_pk_bf16_f32 v104, v108, v109
  v_cvt_pk_bf16_f32 v105, v110, v111
  v_cvt_pk_bf16_f32 v106, v112, v113
  v_cvt_pk_bf16_f32 v107, v114, v115
  buffer_store_dwordx4 v[104:107], v36, s[16:19], s93 offen offset:0
  v_accvgpr_read_b32 v120, a4
  v_accvgpr_read_b32 v121, a5
  v_accvgpr_read_b32 v122, a6
  v_accvgpr_read_b32 v123, a7
  v_accvgpr_read_b32 v124, a12
  v_accvgpr_read_b32 v125, a13
  v_accvgpr_read_b32 v126, a14
  v_accvgpr_read_b32 v127, a15
  v_cvt_pk_bf16_f32 v116, v120, v121
  v_cvt_pk_bf16_f32 v117, v122, v123
  v_cvt_pk_bf16_f32 v118, v124, v125
  v_cvt_pk_bf16_f32 v119, v126, v127
  buffer_store_dwordx4 v[116:119], v36, s[16:19], s93 offen offset:512
  s_add_u32 s93, s92, 1024
  v_accvgpr_read_b32 v132, a16
  v_accvgpr_read_b32 v133, a17
  v_accvgpr_read_b32 v134, a18
  v_accvgpr_read_b32 v135, a19
  v_accvgpr_read_b32 v136, a24
  v_accvgpr_read_b32 v137, a25
  v_accvgpr_read_b32 v138, a26
  v_accvgpr_read_b32 v139, a27
  v_cvt_pk_bf16_f32 v128, v132, v133
  v_cvt_pk_bf16_f32 v129, v134, v135
  v_cvt_pk_bf16_f32 v130, v136, v137
  v_cvt_pk_bf16_f32 v131, v138, v139
  buffer_store_dwordx4 v[128:131], v36, s[16:19], s93 offen offset:0
  v_accvgpr_read_b32 v144, a20
  v_accvgpr_read_b32 v145, a21
  v_accvgpr_read_b32 v146, a22
  v_accvgpr_read_b32 v147, a23
  v_accvgpr_read_b32 v148, a28
  v_accvgpr_read_b32 v149, a29
  v_accvgpr_read_b32 v150, a30
  v_accvgpr_read_b32 v151, a31
  v_cvt_pk_bf16_f32 v140, v144, v145
  v_cvt_pk_bf16_f32 v141, v146, v147
  v_cvt_pk_bf16_f32 v142, v148, v149
  v_cvt_pk_bf16_f32 v143, v150, v151
  buffer_store_dwordx4 v[140:143], v36, s[16:19], s93 offen offset:512
  s_add_u32 s93, s92, 2048
  v_accvgpr_read_b32 v108, a32
  v_accvgpr_read_b32 v109, a33
  v_accvgpr_read_b32 v110, a34
  v_accvgpr_read_b32 v111, a35
  v_accvgpr_read_b32 v112, a40
  v_accvgpr_read_b32 v113, a41
  v_accvgpr_read_b32 v114, a42
  v_accvgpr_read_b32 v115, a43
  v_cvt_pk_bf16_f32 v104, v108, v109
  v_cvt_pk_bf16_f32 v105, v110, v111
  v_cvt_pk_bf16_f32 v106, v112, v113
  v_cvt_pk_bf16_f32 v107, v114, v115
  buffer_store_dwordx4 v[104:107], v36, s[16:19], s93 offen offset:0
  v_accvgpr_read_b32 v120, a36
  v_accvgpr_read_b32 v121, a37
  v_accvgpr_read_b32 v122, a38
  v_accvgpr_read_b32 v123, a39
  v_accvgpr_read_b32 v124, a44
  v_accvgpr_read_b32 v125, a45
  v_accvgpr_read_b32 v126, a46
  v_accvgpr_read_b32 v127, a47
  v_cvt_pk_bf16_f32 v116, v120, v121
  v_cvt_pk_bf16_f32 v117, v122, v123
  v_cvt_pk_bf16_f32 v118, v124, v125
  v_cvt_pk_bf16_f32 v119, v126, v127
  buffer_store_dwordx4 v[116:119], v36, s[16:19], s93 offen offset:512
  s_add_u32 s93, s92, 3072
  v_accvgpr_read_b32 v132, a48
  v_accvgpr_read_b32 v133, a49
  v_accvgpr_read_b32 v134, a50
  v_accvgpr_read_b32 v135, a51
  v_accvgpr_read_b32 v136, a56
  v_accvgpr_read_b32 v137, a57
  v_accvgpr_read_b32 v138, a58
  v_accvgpr_read_b32 v139, a59
  v_cvt_pk_bf16_f32 v128, v132, v133
  v_cvt_pk_bf16_f32 v129, v134, v135
  v_cvt_pk_bf16_f32 v130, v136, v137
  v_cvt_pk_bf16_f32 v131, v138, v139
  buffer_store_dwordx4 v[128:131], v36, s[16:19], s93 offen offset:0
  v_accvgpr_read_b32 v144, a52
  v_accvgpr_read_b32 v145, a53
  v_accvgpr_read_b32 v146, a54
  v_accvgpr_read_b32 v147, a55
  v_accvgpr_read_b32 v148, a60
  v_accvgpr_read_b32 v149, a61
  v_accvgpr_read_b32 v150, a62
  v_accvgpr_read_b32 v151, a63
  v_cvt_pk_bf16_f32 v140, v144, v145
  v_cvt_pk_bf16_f32 v141, v146, v147
  v_cvt_pk_bf16_f32 v142, v148, v149
  v_cvt_pk_bf16_f32 v143, v150, v151
  buffer_store_dwordx4 v[140:143], v36, s[16:19], s93 offen offset:512
  s_add_u32 s92, s92, s26
  s_add_u32 s93, s92, 0
  v_accvgpr_read_b32 v108, a64
  v_accvgpr_read_b32 v109, a65
  v_accvgpr_read_b32 v110, a66
  v_accvgpr_read_b32 v111, a67
  v_accvgpr_read_b32 v112, a72
  v_accvgpr_read_b32 v113, a73
  v_accvgpr_read_b32 v114, a74
  v_accvgpr_read_b32 v115, a75
  v_cvt_pk_bf16_f32 v104, v108, v109
  v_cvt_pk_bf16_f32 v105, v110, v111
  v_cvt_pk_bf16_f32 v106, v112, v113
  v_cvt_pk_bf16_f32 v107, v114, v115
  buffer_store_dwordx4 v[104:107], v36, s[16:19], s93 offen offset:0
  v_accvgpr_read_b32 v120, a68
  v_accvgpr_read_b32 v121, a69
  v_accvgpr_read_b32 v122, a70
  v_accvgpr_read_b32 v123, a71
  v_accvgpr_read_b32 v124, a76
  v_accvgpr_read_b32 v125, a77
  v_accvgpr_read_b32 v126, a78
  v_accvgpr_read_b32 v127, a79
  v_cvt_pk_bf16_f32 v116, v120, v121
  v_cvt_pk_bf16_f32 v117, v122, v123
  v_cvt_pk_bf16_f32 v118, v124, v125
  v_cvt_pk_bf16_f32 v119, v126, v127
  buffer_store_dwordx4 v[116:119], v36, s[16:19], s93 offen offset:512
  s_add_u32 s93, s92, 1024
  v_accvgpr_read_b32 v132, a80
  v_accvgpr_read_b32 v133, a81
  v_accvgpr_read_b32 v134, a82
  v_accvgpr_read_b32 v135, a83
  v_accvgpr_read_b32 v136, a88
  v_accvgpr_read_b32 v137, a89
  v_accvgpr_read_b32 v138, a90
  v_accvgpr_read_b32 v139, a91
  v_cvt_pk_bf16_f32 v128, v132, v133
  v_cvt_pk_bf16_f32 v129, v134, v135
  v_cvt_pk_bf16_f32 v130, v136, v137
  v_cvt_pk_bf16_f32 v131, v138, v139
  buffer_store_dwordx4 v[128:131], v36, s[16:19], s93 offen offset:0
  v_accvgpr_read_b32 v144, a84
  v_accvgpr_read_b32 v145, a85
  v_accvgpr_read_b32 v146, a86
  v_accvgpr_read_b32 v147, a87
  v_accvgpr_read_b32 v148, a92
  v_accvgpr_read_b32 v149, a93
  v_accvgpr_read_b32 v150, a94
  v_accvgpr_read_b32 v151, a95
  v_cvt_pk_bf16_f32 v140, v144, v145
  v_cvt_pk_bf16_f32 v141, v146, v147
  v_cvt_pk_bf16_f32 v142, v148, v149
  v_cvt_pk_bf16_f32 v143, v150, v151
  buffer_store_dwordx4 v[140:143], v36, s[16:19], s93 offen offset:512
  s_add_u32 s93, s92, 2048
  v_accvgpr_read_b32 v108, a96
  v_accvgpr_read_b32 v109, a97
  v_accvgpr_read_b32 v110, a98
  v_accvgpr_read_b32 v111, a99
  v_accvgpr_read_b32 v112, a104
  v_accvgpr_read_b32 v113, a105
  v_accvgpr_read_b32 v114, a106
  v_accvgpr_read_b32 v115, a107
  v_cvt_pk_bf16_f32 v104, v108, v109
  v_cvt_pk_bf16_f32 v105, v110, v111
  v_cvt_pk_bf16_f32 v106, v112, v113
  v_cvt_pk_bf16_f32 v107, v114, v115
  buffer_store_dwordx4 v[104:107], v36, s[16:19], s93 offen offset:0
  v_accvgpr_read_b32 v120, a100
  v_accvgpr_read_b32 v121, a101
  v_accvgpr_read_b32 v122, a102
  v_accvgpr_read_b32 v123, a103
  v_accvgpr_read_b32 v124, a108
  v_accvgpr_read_b32 v125, a109
  v_accvgpr_read_b32 v126, a110
  v_accvgpr_read_b32 v127, a111
  v_cvt_pk_bf16_f32 v116, v120, v121
  v_cvt_pk_bf16_f32 v117, v122, v123
  v_cvt_pk_bf16_f32 v118, v124, v125
  v_cvt_pk_bf16_f32 v119, v126, v127
  buffer_store_dwordx4 v[116:119], v36, s[16:19], s93 offen offset:512
  s_add_u32 s93, s92, 3072
  v_accvgpr_read_b32 v132, a112
  v_accvgpr_read_b32 v133, a113
  v_accvgpr_read_b32 v134, a114
  v_accvgpr_read_b32 v135, a115
  v_accvgpr_read_b32 v136, a120
  v_accvgpr_read_b32 v137, a121
  v_accvgpr_read_b32 v138, a122
  v_accvgpr_read_b32 v139, a123
  v_cvt_pk_bf16_f32 v128, v132, v133
  v_cvt_pk_bf16_f32 v129, v134, v135
  v_cvt_pk_bf16_f32 v130, v136, v137
  v_cvt_pk_bf16_f32 v131, v138, v139
  buffer_store_dwordx4 v[128:131], v36, s[16:19], s93 offen offset:0
  v_accvgpr_read_b32 v144, a116
  v_accvgpr_read_b32 v145, a117
  v_accvgpr_read_b32 v146, a118
  v_accvgpr_read_b32 v147, a119
  v_accvgpr_read_b32 v148, a124
  v_accvgpr_read_b32 v149, a125
  v_accvgpr_read_b32 v150, a126
  v_accvgpr_read_b32 v151, a127
  v_cvt_pk_bf16_f32 v140, v144, v145
  v_cvt_pk_bf16_f32 v141, v146, v147
  v_cvt_pk_bf16_f32 v142, v148, v149
  v_cvt_pk_bf16_f32 v143, v150, v151
  buffer_store_dwordx4 v[140:143], v36, s[16:19], s93 offen offset:512
  s_add_u32 s92, s92, s26
  s_add_u32 s93, s92, 0
  v_accvgpr_read_b32 v108, a128
  v_accvgpr_read_b32 v109, a129
  v_accvgpr_read_b32 v110, a130
  v_accvgpr_read_b32 v111, a131
  v_accvgpr_read_b32 v112, a136
  v_accvgpr_read_b32 v113, a137
  v_accvgpr_read_b32 v114, a138
  v_accvgpr_read_b32 v115, a139
  v_cvt_pk_bf16_f32 v104, v108, v109
  v_cvt_pk_bf16_f32 v105, v110, v111
  v_cvt_pk_bf16_f32 v106, v112, v113
  v_cvt_pk_bf16_f32 v107, v114, v115
  buffer_store_dwordx4 v[104:107], v36, s[16:19], s93 offen offset:0
  v_accvgpr_read_b32 v120, a132
  v_accvgpr_read_b32 v121, a133
  v_accvgpr_read_b32 v122, a134
  v_accvgpr_read_b32 v123, a135
  v_accvgpr_read_b32 v124, a140
  v_accvgpr_read_b32 v125, a141
  v_accvgpr_read_b32 v126, a142
  v_accvgpr_read_b32 v127, a143
  v_cvt_pk_bf16_f32 v116, v120, v121
  v_cvt_pk_bf16_f32 v117, v122, v123
  v_cvt_pk_bf16_f32 v118, v124, v125
  v_cvt_pk_bf16_f32 v119, v126, v127
  buffer_store_dwordx4 v[116:119], v36, s[16:19], s93 offen offset:512
  s_add_u32 s93, s92, 1024
  v_accvgpr_read_b32 v132, a144
  v_accvgpr_read_b32 v133, a145
  v_accvgpr_read_b32 v134, a146
  v_accvgpr_read_b32 v135, a147
  v_accvgpr_read_b32 v136, a152
  v_accvgpr_read_b32 v137, a153
  v_accvgpr_read_b32 v138, a154
  v_accvgpr_read_b32 v139, a155
  v_cvt_pk_bf16_f32 v128, v132, v133
  v_cvt_pk_bf16_f32 v129, v134, v135
  v_cvt_pk_bf16_f32 v130, v136, v137
  v_cvt_pk_bf16_f32 v131, v138, v139
  buffer_store_dwordx4 v[128:131], v36, s[16:19], s93 offen offset:0
  v_accvgpr_read_b32 v144, a148
  v_accvgpr_read_b32 v145, a149
  v_accvgpr_read_b32 v146, a150
  v_accvgpr_read_b32 v147, a151
  v_accvgpr_read_b32 v148, a156
  v_accvgpr_read_b32 v149, a157
  v_accvgpr_read_b32 v150, a158
  v_accvgpr_read_b32 v151, a159
  v_cvt_pk_bf16_f32 v140, v144, v145
  v_cvt_pk_bf16_f32 v141, v146, v147
  v_cvt_pk_bf16_f32 v142, v148, v149
  v_cvt_pk_bf16_f32 v143, v150, v151
  buffer_store_dwordx4 v[140:143], v36, s[16:19], s93 offen offset:512
  s_add_u32 s93, s92, 2048
  v_accvgpr_read_b32 v108, a160
  v_accvgpr_read_b32 v109, a161
  v_accvgpr_read_b32 v110, a162
  v_accvgpr_read_b32 v111, a163
  v_accvgpr_read_b32 v112, a168
  v_accvgpr_read_b32 v113, a169
  v_accvgpr_read_b32 v114, a170
  v_accvgpr_read_b32 v115, a171
  v_cvt_pk_bf16_f32 v104, v108, v109
  v_cvt_pk_bf16_f32 v105, v110, v111
  v_cvt_pk_bf16_f32 v106, v112, v113
  v_cvt_pk_bf16_f32 v107, v114, v115
  buffer_store_dwordx4 v[104:107], v36, s[16:19], s93 offen offset:0
  v_accvgpr_read_b32 v120, a164
  v_accvgpr_read_b32 v121, a165
  v_accvgpr_read_b32 v122, a166
  v_accvgpr_read_b32 v123, a167
  v_accvgpr_read_b32 v124, a172
  v_accvgpr_read_b32 v125, a173
  v_accvgpr_read_b32 v126, a174
  v_accvgpr_read_b32 v127, a175
  v_cvt_pk_bf16_f32 v116, v120, v121
  v_cvt_pk_bf16_f32 v117, v122, v123
  v_cvt_pk_bf16_f32 v118, v124, v125
  v_cvt_pk_bf16_f32 v119, v126, v127
  buffer_store_dwordx4 v[116:119], v36, s[16:19], s93 offen offset:512
  s_add_u32 s93, s92, 3072
  v_accvgpr_read_b32 v132, a176
  v_accvgpr_read_b32 v133, a177
  v_accvgpr_read_b32 v134, a178
  v_accvgpr_read_b32 v135, a179
  v_accvgpr_read_b32 v136, a184
  v_accvgpr_read_b32 v137, a185
  v_accvgpr_read_b32 v138, a186
  v_accvgpr_read_b32 v139, a187
  v_cvt_pk_bf16_f32 v128, v132, v133
  v_cvt_pk_bf16_f32 v129, v134, v135
  v_cvt_pk_bf16_f32 v130, v136, v137
  v_cvt_pk_bf16_f32 v131, v138, v139
  buffer_store_dwordx4 v[128:131], v36, s[16:19], s93 offen offset:0
  v_accvgpr_read_b32 v144, a180
  v_accvgpr_read_b32 v145, a181
  v_accvgpr_read_b32 v146, a182
  v_accvgpr_read_b32 v147, a183
  v_accvgpr_read_b32 v148, a188
  v_accvgpr_read_b32 v149, a189
  v_accvgpr_read_b32 v150, a190
  v_accvgpr_read_b32 v151, a191
  v_cvt_pk_bf16_f32 v140, v144, v145
  v_cvt_pk_bf16_f32 v141, v146, v147
  v_cvt_pk_bf16_f32 v142, v148, v149
  v_cvt_pk_bf16_f32 v143, v150, v151
  buffer_store_dwordx4 v[140:143], v36, s[16:19], s93 offen offset:512
  s_add_u32 s92, s92, s26
  s_add_u32 s93, s92, 0
  v_accvgpr_read_b32 v108, a192
  v_accvgpr_read_b32 v109, a193
  v_accvgpr_read_b32 v110, a194
  v_accvgpr_read_b32 v111, a195
  v_accvgpr_read_b32 v112, a200
  v_accvgpr_read_b32 v113, a201
  v_accvgpr_read_b32 v114, a202
  v_accvgpr_read_b32 v115, a203
  v_cvt_pk_bf16_f32 v104, v108, v109
  v_cvt_pk_bf16_f32 v105, v110, v111
  v_cvt_pk_bf16_f32 v106, v112, v113
  v_cvt_pk_bf16_f32 v107, v114, v115
  buffer_store_dwordx4 v[104:107], v36, s[16:19], s93 offen offset:0
  v_accvgpr_read_b32 v120, a196
  v_accvgpr_read_b32 v121, a197
  v_accvgpr_read_b32 v122, a198
  v_accvgpr_read_b32 v123, a199
  v_accvgpr_read_b32 v124, a204
  v_accvgpr_read_b32 v125, a205
  v_accvgpr_read_b32 v126, a206
  v_accvgpr_read_b32 v127, a207
  v_cvt_pk_bf16_f32 v116, v120, v121
  v_cvt_pk_bf16_f32 v117, v122, v123
  v_cvt_pk_bf16_f32 v118, v124, v125
  v_cvt_pk_bf16_f32 v119, v126, v127
  buffer_store_dwordx4 v[116:119], v36, s[16:19], s93 offen offset:512
  s_add_u32 s93, s92, 1024
  v_accvgpr_read_b32 v132, a208
  v_accvgpr_read_b32 v133, a209
  v_accvgpr_read_b32 v134, a210
  v_accvgpr_read_b32 v135, a211
  v_accvgpr_read_b32 v136, a216
  v_accvgpr_read_b32 v137, a217
  v_accvgpr_read_b32 v138, a218
  v_accvgpr_read_b32 v139, a219
  v_cvt_pk_bf16_f32 v128, v132, v133
  v_cvt_pk_bf16_f32 v129, v134, v135
  v_cvt_pk_bf16_f32 v130, v136, v137
  v_cvt_pk_bf16_f32 v131, v138, v139
  buffer_store_dwordx4 v[128:131], v36, s[16:19], s93 offen offset:0
  v_accvgpr_read_b32 v144, a212
  v_accvgpr_read_b32 v145, a213
  v_accvgpr_read_b32 v146, a214
  v_accvgpr_read_b32 v147, a215
  v_accvgpr_read_b32 v148, a220
  v_accvgpr_read_b32 v149, a221
  v_accvgpr_read_b32 v150, a222
  v_accvgpr_read_b32 v151, a223
  v_cvt_pk_bf16_f32 v140, v144, v145
  v_cvt_pk_bf16_f32 v141, v146, v147
  v_cvt_pk_bf16_f32 v142, v148, v149
  v_cvt_pk_bf16_f32 v143, v150, v151
  buffer_store_dwordx4 v[140:143], v36, s[16:19], s93 offen offset:512
  s_add_u32 s93, s92, 2048
  v_accvgpr_read_b32 v108, a224
  v_accvgpr_read_b32 v109, a225
  v_accvgpr_read_b32 v110, a226
  v_accvgpr_read_b32 v111, a227
  v_accvgpr_read_b32 v112, a232
  v_accvgpr_read_b32 v113, a233
  v_accvgpr_read_b32 v114, a234
  v_accvgpr_read_b32 v115, a235
  v_cvt_pk_bf16_f32 v104, v108, v109
  v_cvt_pk_bf16_f32 v105, v110, v111
  v_cvt_pk_bf16_f32 v106, v112, v113
  v_cvt_pk_bf16_f32 v107, v114, v115
  buffer_store_dwordx4 v[104:107], v36, s[16:19], s93 offen offset:0
  v_accvgpr_read_b32 v120, a228
  v_accvgpr_read_b32 v121, a229
  v_accvgpr_read_b32 v122, a230
  v_accvgpr_read_b32 v123, a231
  v_accvgpr_read_b32 v124, a236
  v_accvgpr_read_b32 v125, a237
  v_accvgpr_read_b32 v126, a238
  v_accvgpr_read_b32 v127, a239
  v_cvt_pk_bf16_f32 v116, v120, v121
  v_cvt_pk_bf16_f32 v117, v122, v123
  v_cvt_pk_bf16_f32 v118, v124, v125
  v_cvt_pk_bf16_f32 v119, v126, v127
  buffer_store_dwordx4 v[116:119], v36, s[16:19], s93 offen offset:512
  s_add_u32 s93, s92, 3072
  v_accvgpr_read_b32 v132, a240
  v_accvgpr_read_b32 v133, a241
  v_accvgpr_read_b32 v134, a242
  v_accvgpr_read_b32 v135, a243
  v_accvgpr_read_b32 v136, a248
  v_accvgpr_read_b32 v137, a249
  v_accvgpr_read_b32 v138, a250
  v_accvgpr_read_b32 v139, a251
  v_cvt_pk_bf16_f32 v128, v132, v133
  v_cvt_pk_bf16_f32 v129, v134, v135
  v_cvt_pk_bf16_f32 v130, v136, v137
  v_cvt_pk_bf16_f32 v131, v138, v139
  buffer_store_dwordx4 v[128:131], v36, s[16:19], s93 offen offset:0
  v_accvgpr_read_b32 v144, a244
  v_accvgpr_read_b32 v145, a245
  v_accvgpr_read_b32 v146, a246
  v_accvgpr_read_b32 v147, a247
  v_accvgpr_read_b32 v148, a252
  v_accvgpr_read_b32 v149, a253
  v_accvgpr_read_b32 v150, a254
  v_accvgpr_read_b32 v151, a255
  v_cvt_pk_bf16_f32 v140, v144, v145
  v_cvt_pk_bf16_f32 v141, v146, v147
  v_cvt_pk_bf16_f32 v142, v148, v149
  v_cvt_pk_bf16_f32 v143, v150, v151
  buffer_store_dwordx4 v[140:143], v36, s[16:19], s93 offen offset:512
  s_add_u32 s92, s92, s26
  s_endpgm
L_k1_V:
  v_and_b32 v1, 63, v0
  v_lshrrev_b32 v34, 6, v0
  s_nop 0
  v_readfirstlane_b32 s27, v34
  s_mul_i32 s90, s27, 64
  v_lshrrev_b32 v34, 3, v1
  v_add_u32 v34, s90, v34
  v_mul_lo_u32 v34, v34, s23
  v_lshrrev_b32 v35, 4, v1
  v_xor_b32 v35, v35, v1
  v_and_b32 v35, 7, v35
  v_lshl_add_u32 v2, v35, 4, v34
  s_lshl_b32 s91, s23, 3
  v_add_u32 v3, s91, v2
  v_xor_b32 v3, 64, v3
  v_add_u32 v4, s91, v3
  v_xor_b32 v4, 64, v4
  v_add_u32 v5, s91, v4
  v_xor_b32 v5, 64, v5
  v_add_u32 v6, s91, v5
  v_xor_b32 v6, 64, v6
  v_add_u32 v7, s91, v6
  v_xor_b32 v7, 64, v7
  v_add_u32 v8, s91, v7
  v_xor_b32 v8, 64, v8
  v_add_u32 v9, s91, v8
  v_xor_b32 v9, 64, v9
  s_mul_i32 s90, s27, 16
  v_lshrrev_b32 v34, 5, v1
  v_add_u32 v34, 0, v34
  v_and_b32 v35, 3, v34
  v_lshlrev_b32 v35, 2, v35
  v_xor_b32 v35, v35, v1
  v_and_b32 v35, 31, v35
  v_add_u32 v34, s90, v34
  v_mul_lo_u32 v34, v34, s24
  v_lshl_add_u32 v10, v35, 4, v34
  v_lshrrev_b32 v34, 5, v1
  v_add_u32 v34, 2, v34
  v_and_b32 v35, 3, v34
  v_lshlrev_b32 v35, 2, v35
  v_xor_b32 v35, v35, v1
  v_and_b32 v35, 31, v35
  v_add_u32 v34, s90, v34
  v_mul_lo_u32 v34, v34, s24
  v_lshl_add_u32 v11, v35, 4, v34
  v_lshrrev_b32 v34, 5, v1
  v_add_u32 v34, 4, v34
  v_and_b32 v35, 3, v34
  v_lshlrev_b32 v35, 2, v35
  v_xor_b32 v35, v35, v1
  v_and_b32 v35, 31, v35
  v_add_u32 v34, s90, v34
  v_mul_lo_u32 v34, v34, s24
  v_lshl_add_u32 v12, v35, 4, v34
  v_lshrrev_b32 v34, 5, v1
  v_add_u32 v34, 6, v34
  v_and_b32 v35, 3, v34
  v_lshlrev_b32 v35, 2, v35
  v_xor_b32 v35, v35, v1
  v_and_b32 v35, 31, v35
  v_add_u32 v34, s90, v34
  v_mul_lo_u32 v34, v34, s24
  v_lshl_add_u32 v13, v35, 4, v34
  v_lshrrev_b32 v34, 5, v1
  v_add_u32 v34, 8, v34
  v_and_b32 v35, 3, v34
  v_lshlrev_b32 v35, 2, v35
  v_xor_b32 v35, v35, v1
  v_and_b32 v35, 31, v35
  v_add_u32 v34, s90, v34
  v_mul_lo_u32 v34, v34, s24
  v_lshl_add_u32 v14, v35, 4, v34
  v_lshrrev_b32 v34, 5, v1
  v_add_u32 v34, 10, v34
  v_and_b32 v35, 3, v34
  v_lshlrev_b32 v35, 2, v35
  v_xor_b32 v35, v35, v1
  v_and_b32 v35, 31, v35
  v_add_u32 v34, s90, v34
  v_mul_lo_u32 v34, v34, s24
  v_lshl_add_u32 v15, v35, 4, v34
  v_lshrrev_b32 v34, 5, v1
  v_add_u32 v34, 12, v34
  v_and_b32 v35, 3, v34
  v_lshlrev_b32 v35, 2, v35
  v_xor_b32 v35, v35, v1
  v_and_b32 v35, 31, v35
  v_add_u32 v34, s90, v34
  v_mul_lo_u32 v34, v34, s24
  v_lshl_add_u32 v16, v35, 4, v34
  v_lshrrev_b32 v34, 5, v1
  v_add_u32 v34, 14, v34
  v_and_b32 v35, 3, v34
  v_lshlrev_b32 v35, 2, v35
  v_xor_b32 v35, v35, v1
  v_and_b32 v35, 31, v35
  v_add_u32 v34, s90, v34
  v_mul_lo_u32 v34, v34, s24
  v_lshl_add_u32 v17, v35, 4, v34
  s_lshl_b32 s28, s24, 6
  s_mul_i32 s29, s27, 8192
  s_mul_i32 s30, s27, 8192
  s_add_u32 s30, s30, 32768
  s_add_u32 m0, s29, 0
  s_nop 0
  buffer_load_dwordx4 v2, s[8:11], s20 offen lds
  s_add_u32 m0, s29, 1024
  s_nop 0
  buffer_load_dwordx4 v3, s[8:11], s20 offen lds
  s_add_u32 m0, s29, 2048
  s_nop 0
  buffer_load_dwordx4 v4, s[8:11], s20 offen lds
  s_add_u32 m0, s29, 3072
  s_nop 0
  buffer_load_dwordx4 v5, s[8:11], s20 offen lds
  s_add_u32 m0, s29, 4096
  s_nop 0
  buffer_load_dwordx4 v6, s[8:11], s20 offen lds
  s_add_u32 m0, s29, 5120
  s_nop 0
  buffer_load_dwordx4 v7, s[8:11], s20 offen lds
  s_add_u32 m0, s29, 6144
  s_nop 0
  buffer_load_dwordx4 v8, s[8:11], s20 offen lds
  s_add_u32 m0, s29, 7168
  s_nop 0
  buffer_load_dwordx4 v9, s[8:11], s20 offen lds
  s_add_u32 m0, s30, 0
  s_nop 0
  buffer_load_dwordx4 v10, s[12:15], s21 offen lds
  s_add_u32 m0, s30, 1024
  s_nop 0
  buffer_load_dwordx4 v11, s[12:15], s21 offen lds
  s_add_u32 m0, s30, 2048
  s_nop 0
  buffer_load_dwordx4 v12, s[12:15], s21 offen lds
  s_add_u32 m0, s30, 3072
  s_nop 0
  buffer_load_dwordx4 v13, s[12:15], s21 offen lds
  s_add_u32 m0, s30, 4096
  s_nop 0
  buffer_load_dwordx4 v14, s[12:15], s21 offen lds
  s_add_u32 m0, s30, 5120
  s_nop 0
  buffer_load_dwordx4 v15, s[12:15], s21 offen lds
  s_add_u32 m0, s30, 6144
  s_nop 0
  buffer_load_dwordx4 v16, s[12:15], s21 offen lds
  s_add_u32 m0, s30, 7168
  s_nop 0
  buffer_load_dwordx4 v17, s[12:15], s21 offen lds
  s_add_u32 s20, s20, 128
  s_add_u32 s21, s21, s28
  s_add_u32 m0, s29, 65536
  s_nop 0
  buffer_load_dwordx4 v2, s[8:11], s20 offen lds
  s_add_u32 m0, s29, 66560
  s_nop 0
  buffer_load_dwordx4 v3, s[8:11], s20 offen lds
  s_add_u32 m0, s29, 67584
  s_nop 0
  buffer_load_dwordx4 v4, s[8:11], s20 offen lds
  s_add_u32 m0, s29, 68608
  s_nop 0
  buffer_load_dwordx4 v5, s[8:11], s20 offen lds
  s_add_u32 m0, s29, 69632
  s_nop 0
  buffer_load_dwordx4 v6, s[8:11], s20 offen lds
  s_add_u32 m0, s29, 70656
  s_nop 0
  buffer_load_dwordx4 v7, s[8:11], s20 offen lds
  s_add_u32 m0, s29, 71680
  s_nop 0
  buffer_load_dwordx4 v8, s[8:11], s20 offen lds
  s_add_u32 m0, s29, 72704
  s_nop 0
  buffer_load_dwordx4 v9, s[8:11], s20 offen lds
  s_add_u32 m0, s30, 65536
  s_nop 0
  buffer_load_dwordx4 v10, s[12:15], s21 offen lds
  s_add_u32 m0, s30, 66560
  s_nop 0
  buffer_load_dwordx4 v11, s[12:15], s21 offen lds
  s_add_u32 m0, s30, 67584
  s_nop 0
  buffer_load_dwordx4 v12, s[12:15], s21 offen lds
  s_add_u32 m0, s30, 68608
  s_nop 0
  buffer_load_dwordx4 v13, s[12:15], s21 offen lds
  s_add_u32 m0, s30, 69632
  s_nop 0
  buffer_load_dwordx4 v14, s[12:15], s21 offen lds
  s_add_u32 m0, s30, 70656
  s_nop 0
  buffer_load_dwordx4 v15, s[12:15], s21 offen lds
  s_add_u32 m0, s30, 71680
  s_nop 0
  buffer_load_dwordx4 v16, s[12:15], s21 offen lds
  s_add_u32 m0, s30, 72704
  s_nop 0
  buffer_load_dwordx4 v17, s[12:15], s21 offen lds
  s_add_u32 s20, s20, 128
  s_add_u32 s21, s21, s28
  s_lshr_b32 s90, s27, 1
  s_and_b32 s91, s27, 1
  s_mul_i32 s92, s90, 16384
  v_mov_b32 v34, 0x0
  v_bfe_u32 v35, v1, 0, 5
  v_lshl_add_u32 v34, v35, 7, v34
  v_add_u32 v34, s92, v34
  v_lshrrev_b32 v35, 1, v1
  v_and_b32 v35, 7, v35
  v_lshrrev_b32 v36, 5, v1
  v_xor_b32 v35, v35, v36
  v_lshl_add_u32 v18, v35, 4, v34
  v_xor_b32 v19, 32, v18
  v_xor_b32 v20, 64, v18
  v_xor_b32 v21, 96, v18
  v_add_u32 v22, 65536, v18
  v_add_u32 v23, 65536, v19
  v_add_u32 v24, 65536, v20
  v_add_u32 v25, 65536, v21
  v_mov_b32 v34, 0x8000
  v_bfe_u32 v35, v1, 2, 2
  v_lshl_add_u32 v34, v35, 9, v34
  v_bfe_u32 v35, v1, 5, 1
  v_lshl_add_u32 v34, v35, 12, v34
  v_bfe_u32 v35, v1, 4, 1
  v_lshl_add_u32 v34, v35, 5, v34
  v_bfe_u32 v35, v1, 0, 2
  v_lshl_add_u32 v34, v35, 3, v34
  s_mul_i32 s92, s91, 4
  s_add_u32 s93, s92, 0
  v_bfe_u32 v35, v1, 2, 2
  v_xor_b32 v35, s93, v35
  v_lshl_add_u32 v26, v35, 6, v34
  v_add_u32 v30, 65536, v26
  s_add_u32 s93, s92, 1
  v_bfe_u32 v35, v1, 2, 2
  v_xor_b32 v35, s93, v35
  v_lshl_add_u32 v27, v35, 6, v34
  v_add_u32 v31, 65536, v27
  s_add_u32 s93, s92, 2
  v_bfe_u32 v35, v1, 2, 2
  v_xor_b32 v35, s93, v35
  v_lshl_add_u32 v28, v35, 6, v34
  v_add_u32 v32, 65536, v28
  s_add_u32 s93, s92, 3
  v_bfe_u32 v35, v1, 2, 2
  v_xor_b32 v35, s93, v35
  v_lshl_add_u32 v29, v35, 6, v34
  v_add_u32 v33, 65536, v29
  v_accvgpr_write_b32 a0, 0
  v_accvgpr_write_b32 a1, 0
  v_accvgpr_write_b32 a2, 0
  v_accvgpr_write_b32 a3, 0
  v_accvgpr_write_b32 a4, 0
  v_accvgpr_write_b32 a5, 0
  v_accvgpr_write_b32 a6, 0
  v_accvgpr_write_b32 a7, 0
  v_accvgpr_write_b32 a8, 0
  v_accvgpr_write_b32 a9, 0
  v_accvgpr_write_b32 a10, 0
  v_accvgpr_write_b32 a11, 0
  v_accvgpr_write_b32 a12, 0
  v_accvgpr_write_b32 a13, 0
  v_accvgpr_write_b32 a14, 0
  v_accvgpr_write_b32 a15, 0
  v_accvgpr_write_b32 a16, 0
  v_accvgpr_write_b32 a17, 0
  v_accvgpr_write_b32 a18, 0
  v_accvgpr_write_b32 a19, 0
  v_accvgpr_write_b32 a20, 0
  v_accvgpr_write_b32 a21, 0
  v_accvgpr_write_b32 a22, 0
  v_accvgpr_write_b32 a23, 0
  v_accvgpr_write_b32 a24, 0
  v_accvgpr_write_b32 a25, 0
  v_accvgpr_write_b32 a26, 0
  v_accvgpr_write_b32 a27, 0
  v_accvgpr_write_b32 a28, 0
  v_accvgpr_write_b32 a29, 0
  v_accvgpr_write_b32 a30, 0
  v_accvgpr_write_b32 a31, 0
  v_accvgpr_write_b32 a32, 0
  v_accvgpr_write_b32 a33, 0
  v_accvgpr_write_b32 a34, 0
  v_accvgpr_write_b32 a35, 0
  v_accvgpr_write_b32 a36, 0
  v_accvgpr_write_b32 a37, 0
  v_accvgpr_write_b32 a38, 0
  v_accvgpr_write_b32 a39, 0
  v_accvgpr_write_b32 a40, 0
  v_accvgpr_write_b32 a41, 0
  v_accvgpr_write_b32 a42, 0
  v_accvgpr_write_b32 a43, 0
  v_accvgpr_write_b32 a44, 0
  v_accvgpr_write_b32 a45, 0
  v_accvgpr_write_b32 a46, 0
  v_accvgpr_write_b32 a47, 0
  v_accvgpr_write_b32 a48, 0
  v_accvgpr_write_b32 a49, 0
  v_accvgpr_write_b32 a50, 0
  v_accvgpr_write_b32 a51, 0
  v_accvgpr_write_b32 a52, 0
  v_accvgpr_write_b32 a53, 0
  v_accvgpr_write_b32 a54, 0
  v_accvgpr_write_b32 a55, 0
  v_accvgpr_write_b32 a56, 0
  v_accvgpr_write_b32 a57, 0
  v_accvgpr_write_b32 a58, 0
  v_accvgpr_write_b32 a59, 0
  v_accvgpr_write_b32 a60, 0
  v_accvgpr_write_b32 a61, 0
  v_accvgpr_write_b32 a62, 0
  v_accvgpr_write_b32 a63, 0
  v_accvgpr_write_b32 a64, 0
  v_accvgpr_write_b32 a65, 0
  v_accvgpr_write_b32 a66, 0
  v_accvgpr_write_b32 a67, 0
  v_accvgpr_write_b32 a68, 0
  v_accvgpr_write_b32 a69, 0
  v_accvgpr_write_b32 a70, 0
  v_accvgpr_write_b32 a71, 0
  v_accvgpr_write_b32 a72, 0
  v_accvgpr_write_b32 a73, 0
  v_accvgpr_write_b32 a74, 0
  v_accvgpr_write_b32 a75, 0
  v_accvgpr_write_b32 a76, 0
  v_accvgpr_write_b32 a77, 0
  v_accvgpr_write_b32 a78, 0
  v_accvgpr_write_b32 a79, 0
  v_accvgpr_write_b32 a80, 0
  v_accvgpr_write_b32 a81, 0
  v_accvgpr_write_b32 a82, 0
  v_accvgpr_write_b32 a83, 0
  v_accvgpr_write_b32 a84, 0
  v_accvgpr_write_b32 a85, 0
  v_accvgpr_write_b32 a86, 0
  v_accvgpr_write_b32 a87, 0
  v_accvgpr_write_b32 a88, 0
  v_accvgpr_write_b32 a89, 0
  v_accvgpr_write_b32 a90, 0
  v_accvgpr_write_b32 a91, 0
  v_accvgpr_write_b32 a92, 0
  v_accvgpr_write_b32 a93, 0
  v_accvgpr_write_b32 a94, 0
  v_accvgpr_write_b32 a95, 0
  v_accvgpr_write_b32 a96, 0
  v_accvgpr_write_b32 a97, 0
  v_accvgpr_write_b32 a98, 0
  v_accvgpr_write_b32 a99, 0
  v_accvgpr_write_b32 a100, 0
  v_accvgpr_write_b32 a101, 0
  v_accvgpr_write_b32 a102, 0
  v_accvgpr_write_b32 a103, 0
  v_accvgpr_write_b32 a104, 0
  v_accvgpr_write_b32 a105, 0
  v_accvgpr_write_b32 a106, 0
  v_accvgpr_write_b32 a107, 0
  v_accvgpr_write_b32 a108, 0
  v_accvgpr_write_b32 a109, 0
  v_accvgpr_write_b32 a110, 0
  v_accvgpr_write_b32 a111, 0
  v_accvgpr_write_b32 a112, 0
  v_accvgpr_write_b32 a113, 0
  v_accvgpr_write_b32 a114, 0
  v_accvgpr_write_b32 a115, 0
  v_accvgpr_write_b32 a116, 0
  v_accvgpr_write_b32 a117, 0
  v_accvgpr_write_b32 a118, 0
  v_accvgpr_write_b32 a119, 0
  v_accvgpr_write_b32 a120, 0
  v_accvgpr_write_b32 a121, 0
  v_accvgpr_write_b32 a122, 0
  v_accvgpr_write_b32 a123, 0
  v_accvgpr_write_b32 a124, 0
  v_accvgpr_write_b32 a125, 0
  v_accvgpr_write_b32 a126, 0
  v_accvgpr_write_b32 a127, 0
  v_accvgpr_write_b32 a128, 0
  v_accvgpr_write_b32 a129, 0
  v_accvgpr_write_b32 a130, 0
  v_accvgpr_write_b32 a131, 0
  v_accvgpr_write_b32 a132, 0
  v_accvgpr_write_b32 a133, 0
  v_accvgpr_write_b32 a134, 0
  v_accvgpr_write_b32 a135, 0
  v_accvgpr_write_b32 a136, 0
  v_accvgpr_write_b32 a137, 0
  v_accvgpr_write_b32 a138, 0
  v_accvgpr_write_b32 a139, 0
  v_accvgpr_write_b32 a140, 0
  v_accvgpr_write_b32 a141, 0
  v_accvgpr_write_b32 a142, 0
  v_accvgpr_write_b32 a143, 0
  v_accvgpr_write_b32 a144, 0
  v_accvgpr_write_b32 a145, 0
  v_accvgpr_write_b32 a146, 0
  v_accvgpr_write_b32 a147, 0
  v_accvgpr_write_b32 a148, 0
  v_accvgpr_write_b32 a149, 0
  v_accvgpr_write_b32 a150, 0
  v_accvgpr_write_b32 a151, 0
  v_accvgpr_write_b32 a152, 0
  v_accvgpr_write_b32 a153, 0
  v_accvgpr_write_b32 a154, 0
  v_accvgpr_write_b32 a155, 0
  v_accvgpr_write_b32 a156, 0
  v_accvgpr_write_b32 a157, 0
  v_accvgpr_write_b32 a158, 0
  v_accvgpr_write_b32 a159, 0
  v_accvgpr_write_b32 a160, 0
  v_accvgpr_write_b32 a161, 0
  v_accvgpr_write_b32 a162, 0
  v_accvgpr_write_b32 a163, 0
  v_accvgpr_write_b32 a164, 0
  v_accvgpr_write_b32 a165, 0
  v_accvgpr_write_b32 a166, 0
  v_accvgpr_write_b32 a167, 0
  v_accvgpr_write_b32 a168, 0
  v_accvgpr_write_b32 a169, 0
  v_accvgpr_write_b32 a170, 0
  v_accvgpr_write_b32 a171, 0
  v_accvgpr_write_b32 a172, 0
  v_accvgpr_write_b32 a173, 0
  v_accvgpr_write_b32 a174, 0
  v_accvgpr_write_b32 a175, 0
  v_accvgpr_write_b32 a176, 0
  v_accvgpr_write_b32 a177, 0
  v_accvgpr_write_b32 a178, 0
  v_accvgpr_write_b32 a179, 0
  v_accvgpr_write_b32 a180, 0
  v_accvgpr_write_b32 a181, 0
  v_accvgpr_write_b32 a182, 0
  v_accvgpr_write_b32 a183, 0
  v_accvgpr_write_b32 a184, 0
  v_accvgpr_write_b32 a185, 0
  v_accvgpr_write_b32 a186, 0
  v_accvgpr_write_b32 a187, 0
  v_accvgpr_write_b32 a188, 0
  v_accvgpr_write_b32 a189, 0
  v_accvgpr_write_b32 a190, 0
  v_accvgpr_write_b32 a191, 0
  v_accvgpr_write_b32 a192, 0
  v_accvgpr_write_b32 a193, 0
  v_accvgpr_write_b32 a194, 0
  v_accvgpr_write_b32 a195, 0
  v_accvgpr_write_b32 a196, 0
  v_accvgpr_write_b32 a197, 0
  v_accvgpr_write_b32 a198, 0
  v_accvgpr_write_b32 a199, 0
  v_accvgpr_write_b32 a200, 0
  v_accvgpr_write_b32 a201, 0
  v_accvgpr_write_b32 a202, 0
  v_accvgpr_write_b32 a203, 0
  v_accvgpr_write_b32 a204, 0
  v_accvgpr_write_b32 a205, 0
  v_accvgpr_write_b32 a206, 0
  v_accvgpr_write_b32 a207, 0
  v_accvgpr_write_b32 a208, 0
  v_accvgpr_write_b32 a209, 0
  v_accvgpr_write_b32 a210, 0
  v_accvgpr_write_b32 a211, 0
  v_accvgpr_write_b32 a212, 0
  v_accvgpr_write_b32 a213, 0
  v_accvgpr_write_b32 a214, 0
  v_accvgpr_write_b32 a215, 0
  v_accvgpr_write_b32 a216, 0
  v_accvgpr_write_b32 a217, 0
  v_accvgpr_write_b32 a218, 0
  v_accvgpr_write_b32 a219, 0
  v_accvgpr_write_b32 a220, 0
  v_accvgpr_write_b32 a221, 0
  v_accvgpr_write_b32 a222, 0
  v_accvgpr_write_b32 a223, 0
  v_accvgpr_write_b32 a224, 0
  v_accvgpr_write_b32 a225, 0
  v_accvgpr_write_b32 a226, 0
  v_accvgpr_write_b32 a227, 0
  v_accvgpr_write_b32 a228, 0
  v_accvgpr_write_b32 a229, 0
  v_accvgpr_write_b32 a230, 0
  v_accvgpr_write_b32 a231, 0
  v_accvgpr_write_b32 a232, 0
  v_accvgpr_write_b32 a233, 0
  v_accvgpr_write_b32 a234, 0
  v_accvgpr_write_b32 a235, 0
  v_accvgpr_write_b32 a236, 0
  v_accvgpr_write_b32 a237, 0
  v_accvgpr_write_b32 a238, 0
  v_accvgpr_write_b32 a239, 0
  v_accvgpr_write_b32 a240, 0
  v_accvgpr_write_b32 a241, 0
  v_accvgpr_write_b32 a242, 0
  v_accvgpr_write_b32 a243, 0
  v_accvgpr_write_b32 a244, 0
  v_accvgpr_write_b32 a245, 0
  v_accvgpr_write_b32 a246, 0
  v_accvgpr_write_b32 a247, 0
  v_accvgpr_write_b32 a248, 0
  v_accvgpr_write_b32 a249, 0
  v_accvgpr_write_b32 a250, 0
  v_accvgpr_write_b32 a251, 0
  v_accvgpr_write_b32 a252, 0
  v_accvgpr_write_b32 a253, 0
  v_accvgpr_write_b32 a254, 0
  v_accvgpr_write_b32 a255, 0
  s_waitcnt vmcnt(16)
  s_barrier
  ds_read_b128 v[40:43], v18 offset:0
  ds_read_b64_tr_b16 v[72:73], v26 offset:0
  ds_read_b64_tr_b16 v[74:75], v26 offset:2048
  ds_read_b128 v[44:47], v18 offset:4096
  ds_read_b64_tr_b16 v[76:77], v27 offset:0
  ds_read_b64_tr_b16 v[78:79], v27 offset:2048
  ds_read_b128 v[48:51], v18 offset:8192
  ds_read_b64_tr_b16 v[80:81], v28 offset:0
  ds_read_b64_tr_b16 v[82:83], v28 offset:2048
  ds_read_b128 v[52:55], v18 offset:12288
  ds_read_b64_tr_b16 v[84:85], v29 offset:0
  ds_read_b64_tr_b16 v[86:87], v29 offset:2048
  s_sub_u32 s25, s25, 1
  s_waitcnt lgkmcnt(0)
  v_mfma_f32_32x32x16_bf16 a[0:15], v[40:43], v[72:75], a[0:15]
  ds_read_b128 v[56:59], v19 offset:0
  v_mfma_f32_32x32x16_bf16 a[16:31], v[40:43], v[76:79], a[16:31]
  ds_read_b64_tr_b16 v[88:89], v26 offset:8192
  v_mfma_f32_32x32x16_bf16 a[32:47], v[40:43], v[80:83], a[32:47]
  ds_read_b64_tr_b16 v[90:91], v26 offset:10240
  v_mfma_f32_32x32x16_bf16 a[48:63], v[40:43], v[84:87], a[48:63]
  ds_read_b128 v[60:63], v19 offset:4096
  v_mfma_f32_32x32x16_bf16 a[64:79], v[44:47], v[72:75], a[64:79]
  ds_read_b64_tr_b16 v[92:93], v27 offset:8192
  v_mfma_f32_32x32x16_bf16 a[80:95], v[44:47], v[76:79], a[80:95]
  ds_read_b64_tr_b16 v[94:95], v27 offset:10240
  v_mfma_f32_32x32x16_bf16 a[96:111], v[44:47], v[80:83], a[96:111]
  ds_read_b128 v[64:67], v19 offset:8192
  v_mfma_f32_32x32x16_bf16 a[112:127], v[44:47], v[84:87], a[112:127]
  ds_read_b64_tr_b16 v[96:97], v28 offset:8192
  v_mfma_f32_32x32x16_bf16 a[128:143], v[48:51], v[72:75], a[128:143]
  ds_read_b64_tr_b16 v[98:99], v28 offset:10240
  v_mfma_f32_32x32x16_bf16 a[144:159], v[48:51], v[76:79], a[144:159]
  ds_read_b128 v[68:71], v19 offset:12288
  v_mfma_f32_32x32x16_bf16 a[160:175], v[48:51], v[80:83], a[160:175]
  ds_read_b64_tr_b16 v[100:101], v29 offset:8192
  v_mfma_f32_32x32x16_bf16 a[176:191], v[48:51], v[84:87], a[176:191]
  ds_read_b64_tr_b16 v[102:103], v29 offset:10240
  v_mfma_f32_32x32x16_bf16 a[192:207], v[52:55], v[72:75], a[192:207]
  v_mfma_f32_32x32x16_bf16 a[208:223], v[52:55], v[76:79], a[208:223]
  v_mfma_f32_32x32x16_bf16 a[224:239], v[52:55], v[80:83], a[224:239]
  v_mfma_f32_32x32x16_bf16 a[240:255], v[52:55], v[84:87], a[240:255]
  s_waitcnt lgkmcnt(0)
  v_mfma_f32_32x32x16_bf16 a[0:15], v[56:59], v[88:91], a[0:15]
  ds_read_b128 v[40:43], v20 offset:0
  v_mfma_f32_32x32x16_bf16 a[16:31], v[56:59], v[92:95], a[16:31]
  ds_read_b64_tr_b16 v[72:73], v26 offset:16384
  v_mfma_f32_32x32x16_bf16 a[32:47], v[56:59], v[96:99], a[32:47]
  ds_read_b64_tr_b16 v[74:75], v26 offset:18432
  v_mfma_f32_32x32x16_bf16 a[48:63], v[56:59], v[100:103], a[48:63]
  ds_read_b128 v[44:47], v20 offset:4096
  v_mfma_f32_32x32x16_bf16 a[64:79], v[60:63], v[88:91], a[64:79]
  ds_read_b64_tr_b16 v[76:77], v27 offset:16384
  v_mfma_f32_32x32x16_bf16 a[80:95], v[60:63], v[92:95], a[80:95]
  ds_read_b64_tr_b16 v[78:79], v27 offset:18432
  v_mfma_f32_32x32x16_bf16 a[96:111], v[60:63], v[96:99], a[96:111]
  ds_read_b128 v[48:51], v20 offset:8192
  v_mfma_f32_32x32x16_bf16 a[112:127], v[60:63], v[100:103], a[112:127]
  ds_read_b64_tr_b16 v[80:81], v28 offset:16384
  v_mfma_f32_32x32x16_bf16 a[128:143], v[64:67], v[88:91], a[128:143]
  ds_read_b64_tr_b16 v[82:83], v28 offset:18432
  v_mfma_f32_32x32x16_bf16 a[144:159], v[64:67], v[92:95], a[144:159]
  ds_read_b128 v[52:55], v20 offset:12288
  v_mfma_f32_32x32x16_bf16 a[160:175], v[64:67], v[96:99], a[160:175]
  ds_read_b64_tr_b16 v[84:85], v29 offset:16384
  v_mfma_f32_32x32x16_bf16 a[176:191], v[64:67], v[100:103], a[176:191]
  ds_read_b64_tr_b16 v[86:87], v29 offset:18432
  v_mfma_f32_32x32x16_bf16 a[192:207], v[68:71], v[88:91], a[192:207]
  v_mfma_f32_32x32x16_bf16 a[208:223], v[68:71], v[92:95], a[208:223]
  v_mfma_f32_32x32x16_bf16 a[224:239], v[68:71], v[96:99], a[224:239]
  v_mfma_f32_32x32x16_bf16 a[240:255], v[68:71], v[100:103], a[240:255]
  s_waitcnt lgkmcnt(0)
  v_mfma_f32_32x32x16_bf16 a[0:15], v[40:43], v[72:75], a[0:15]
  ds_read_b128 v[56:59], v21 offset:0
  v_mfma_f32_32x32x16_bf16 a[16:31], v[40:43], v[76:79], a[16:31]
  ds_read_b64_tr_b16 v[88:89], v26 offset:24576
  v_mfma_f32_32x32x16_bf16 a[32:47], v[40:43], v[80:83], a[32:47]
  ds_read_b64_tr_b16 v[90:91], v26 offset:26624
  v_mfma_f32_32x32x16_bf16 a[48:63], v[40:43], v[84:87], a[48:63]
  ds_read_b128 v[60:63], v21 offset:4096
  v_mfma_f32_32x32x16_bf16 a[64:79], v[44:47], v[72:75], a[64:79]
  ds_read_b64_tr_b16 v[92:93], v27 offset:24576
  v_mfma_f32_32x32x16_bf16 a[80:95], v[44:47], v[76:79], a[80:95]
  ds_read_b64_tr_b16 v[94:95], v27 offset:26624
  v_mfma_f32_32x32x16_bf16 a[96:111], v[44:47], v[80:83], a[96:111]
  ds_read_b128 v[64:67], v21 offset:8192
  v_mfma_f32_32x32x16_bf16 a[112:127], v[44:47], v[84:87], a[112:127]
  ds_read_b64_tr_b16 v[96:97], v28 offset:24576
  v_mfma_f32_32x32x16_bf16 a[128:143], v[48:51], v[72:75], a[128:143]
  ds_read_b64_tr_b16 v[98:99], v28 offset:26624
  v_mfma_f32_32x32x16_bf16 a[144:159], v[48:51], v[76:79], a[144:159]
  ds_read_b128 v[68:71], v21 offset:12288
  v_mfma_f32_32x32x16_bf16 a[160:175], v[48:51], v[80:83], a[160:175]
  ds_read_b64_tr_b16 v[100:101], v29 offset:24576
  v_mfma_f32_32x32x16_bf16 a[176:191], v[48:51], v[84:87], a[176:191]
  ds_read_b64_tr_b16 v[102:103], v29 offset:26624
  v_mfma_f32_32x32x16_bf16 a[192:207], v[52:55], v[72:75], a[192:207]
  v_mfma_f32_32x32x16_bf16 a[208:223], v[52:55], v[76:79], a[208:223]
  v_mfma_f32_32x32x16_bf16 a[224:239], v[52:55], v[80:83], a[224:239]
  v_mfma_f32_32x32x16_bf16 a[240:255], v[52:55], v[84:87], a[240:255]
  s_waitcnt lgkmcnt(0)
  v_mfma_f32_32x32x16_bf16 a[0:15], v[56:59], v[88:91], a[0:15]
  s_waitcnt vmcnt(0)
  s_barrier
  v_mfma_f32_32x32x16_bf16 a[16:31], v[56:59], v[92:95], a[16:31]
  ds_read_b128 v[40:43], v22 offset:0
  s_add_u32 m0, s29, 0
  s_nop 0
  buffer_load_dwordx4 v2, s[8:11], s20 offen lds
  v_mfma_f32_32x32x16_bf16 a[32:47], v[56:59], v[96:99], a[32:47]
  ds_read_b64_tr_b16 v[72:73], v30 offset:0
  s_add_u32 m0, s29, 1024
  s_nop 0
  buffer_load_dwordx4 v3, s[8:11], s20 offen lds
  v_mfma_f32_32x32x16_bf16 a[48:63], v[56:59], v[100:103], a[48:63]
  ds_read_b64_tr_b16 v[74:75], v30 offset:2048
  s_add_u32 m0, s29, 2048
  s_nop 0
  buffer_load_dwordx4 v4, s[8:11], s20 offen lds
  v_mfma_f32_32x32x16_bf16 a[64:79], v[60:63], v[88:91], a[64:79]
  ds_read_b128 v[44:47], v22 offset:4096
  s_add_u32 m0, s29, 3072
  s_nop 0
  buffer_load_dwordx4 v5, s[8:11], s20 offen lds
  v_mfma_f32_32x32x16_bf16 a[80:95], v[60:63], v[92:95], a[80:95]
  ds_read_b64_tr_b16 v[76:77], v31 offset:0
  s_add_u32 m0, s29, 4096
  s_nop 0
  buffer_load_dwordx4 v6, s[8:11], s20 offen lds
  v_mfma_f32_32x32x16_bf16 a[96:111], v[60:63], v[96:99], a[96:111]
  ds_read_b64_tr_b16 v[78:79], v31 offset:2048
  s_add_u32 m0, s29, 5120
  s_nop 0
  buffer_load_dwordx4 v7, s[8:11], s20 offen lds
  v_mfma_f32_32x32x16_bf16 a[112:127], v[60:63], v[100:103], a[112:127]
  ds_read_b128 v[48:51], v22 offset:8192
  s_add_u32 m0, s29, 6144
  s_nop 0
  buffer_load_dwordx4 v8, s[8:11], s20 offen lds
  v_mfma_f32_32x32x16_bf16 a[128:143], v[64:67], v[88:91], a[128:143]
  ds_read_b64_tr_b16 v[80:81], v32 offset:0
  v_mfma_f32_32x32x16_bf16 a[144:159], v[64:67], v[92:95], a[144:159]
  ds_read_b64_tr_b16 v[82:83], v32 offset:2048
  v_mfma_f32_32x32x16_bf16 a[160:175], v[64:67], v[96:99], a[160:175]
  ds_read_b128 v[52:55], v22 offset:12288
  v_mfma_f32_32x32x16_bf16 a[176:191], v[64:67], v[100:103], a[176:191]
  ds_read_b64_tr_b16 v[84:85], v33 offset:0
  v_mfma_f32_32x32x16_bf16 a[192:207], v[68:71], v[88:91], a[192:207]
  ds_read_b64_tr_b16 v[86:87], v33 offset:2048
  v_mfma_f32_32x32x16_bf16 a[208:223], v[68:71], v[92:95], a[208:223]
  v_mfma_f32_32x32x16_bf16 a[224:239], v[68:71], v[96:99], a[224:239]
  v_mfma_f32_32x32x16_bf16 a[240:255], v[68:71], v[100:103], a[240:255]
L_g2_loop:
  s_waitcnt lgkmcnt(0)
  v_mfma_f32_32x32x16_bf16 a[0:15], v[40:43], v[72:75], a[0:15]
  ds_read_b128 v[56:59], v23 offset:0
  s_add_u32 m0, s29, 7168
  s_nop 0
  buffer_load_dwordx4 v9, s[8:11], s20 offen lds
  v_mfma_f32_32x32x16_bf16 a[16:31], v[40:43], v[76:79], a[16:31]
  ds_read_b64_tr_b16 v[88:89], v30 offset:8192
  s_add_u32 m0, s30, 0
  s_nop 0
  buffer_load_dwordx4 v10, s[12:15], s21 offen lds
  v_mfma_f32_32x32x16_bf16 a[32:47], v[40:43], v[80:83], a[32:47]
  ds_read_b64_tr_b16 v[90:91], v30 offset:10240
  s_add_u32 m0, s30, 1024
  s_nop 0
  buffer_load_dwordx4 v11, s[12:15], s21 offen lds
  v_mfma_f32_32x32x16_bf16 a[48:63], v[40:43], v[84:87], a[48:63]
  ds_read_b128 v[60:63], v23 offset:4096
  s_add_u32 m0, s30, 2048
  s_nop 0
  buffer_load_dwordx4 v12, s[12:15], s21 offen lds
  v_mfma_f32_32x32x16_bf16 a[64:79], v[44:47], v[72:75], a[64:79]
  ds_read_b64_tr_b16 v[92:93], v31 offset:8192
  s_add_u32 m0, s30, 3072
  s_nop 0
  buffer_load_dwordx4 v13, s[12:15], s21 offen lds
  v_mfma_f32_32x32x16_bf16 a[80:95], v[44:47], v[76:79], a[80:95]
  ds_read_b64_tr_b16 v[94:95], v31 offset:10240
  s_add_u32 m0, s30, 4096
  s_nop 0
  buffer_load_dwordx4 v14, s[12:15], s21 offen lds
  v_mfma_f32_32x32x16_bf16 a[96:111], v[44:47], v[80:83], a[96:111]
  ds_read_b128 v[64:67], v23 offset:8192
  s_add_u32 m0, s30, 5120
  s_nop 0
  buffer_load_dwordx4 v15, s[12:15], s21 offen lds
  v_mfma_f32_32x32x16_bf16 a[112:127], v[44:47], v[84:87], a[112:127]
  ds_read_b64_tr_b16 v[96:97], v32 offset:8192
  v_mfma_f32_32x32x16_bf16 a[128:143], v[48:51], v[72:75], a[128:143]
  ds_read_b64_tr_b16 v[98:99], v32 offset:10240
  v_mfma_f32_32x32x16_bf16 a[144:159], v[48:51], v[76:79], a[144:159]
  ds_read_b128 v[68:71], v23 offset:12288
  v_mfma_f32_32x32x16_bf16 a[160:175], v[48:51], v[80:83], a[160:175]
  ds_read_b64_tr_b16 v[100:101], v33 offset:8192
  v_mfma_f32_32x32x16_bf16 a[176:191], v[48:51], v[84:87], a[176:191]
  ds_read_b64_tr_b16 v[102:103], v33 offset:10240
  v_mfma_f32_32x32x16_bf16 a[192:207], v[52:55], v[72:75], a[192:207]
  v_mfma_f32_32x32x16_bf16 a[208:223], v[52:55], v[76:79], a[208:223]
  v_mfma_f32_32x32x16_bf16 a[224:239], v[52:55], v[80:83], a[224:239]
  v_mfma_f32_32x32x16_bf16 a[240:255], v[52:55], v[84:87], a[240:255]
  s_waitcnt lgkmcnt(0)
  v_mfma_f32_32x32x16_bf16 a[0:15], v[56:59], v[88:91], a[0:15]
  ds_read_b128 v[40:43], v24 offset:0
  s_add_u32 m0, s30, 6144
  s_nop 0
  buffer_load_dwordx4 v16, s[12:15], s21 offen lds
  v_mfma_f32_32x32x16_bf16 a[16:31], v[56:59], v[92:95], a[16:31]
  ds_read_b64_tr_b16 v[72:73], v30 offset:16384
  s_add_u32 m0, s30, 7168
  s_nop 0
  buffer_load_dwordx4 v17, s[12:15], s21 offen lds
  v_mfma_f32_32x32x16_bf16 a[32:47], v[56:59], v[96:99], a[32:47]
  ds_read_b64_tr_b16 v[74:75], v30 offset:18432
  s_add_u32 s20, s20, 128
  s_add_u32 s21, s21, s28
  v_mfma_f32_32x32x16_bf16 a[48:63], v[56:59], v[100:103], a[48:63]
  ds_read_b128 v[44:47], v24 offset:4096
  v_mfma_f32_32x32x16_bf16 a[64:79], v[60:63], v[88:91], a[64:79]
  ds_read_b64_tr_b16 v[76:77], v31 offset:16384
  v_mfma_f32_32x32x16_bf16 a[80:95], v[60:63], v[92:95], a[80:95]
  ds_read_b64_tr_b16 v[78:79], v31 offset:18432
  v_mfma_f32_32x32x16_bf16 a[96:111], v[60:63], v[96:99], a[96:111]
  ds_read_b128 v[48:51], v24 offset:8192
  v_mfma_f32_32x32x16_bf16 a[112:127], v[60:63], v[100:103], a[112:127]
  ds_read_b64_tr_b16 v[80:81], v32 offset:16384
  v_mfma_f32_32x32x16_bf16 a[128:143], v[64:67], v[88:91], a[128:143]
  ds_read_b64_tr_b16 v[82:83], v32 offset:18432
  v_mfma_f32_32x32x16_bf16 a[144:159], v[64:67], v[92:95], a[144:159]
  ds_read_b128 v[52:55], v24 offset:12288
  v_mfma_f32_32x32x16_bf16 a[160:175], v[64:67], v[96:99], a[160:175]
  ds_read_b64_tr_b16 v[84:85], v33 offset:16384
  v_mfma_f32_32x32x16_bf16 a[176:191], v[64:67], v[100:103], a[176:191]
  ds_read_b64_tr_b16 v[86:87], v33 offset:18432
  v_mfma_f32_32x32x16_bf16 a[192:207], v[68:71], v[88:91], a[192:207]
  v_mfma_f32_32x32x16_bf16 a[208:223], v[68:71], v[92:95], a[208:223]
  v_mfma_f32_32x32x16_bf16 a[224:239], v[68:71], v[96:99], a[224:239]
  v_mfma_f32_32x32x16_bf16 a[240:255], v[68:71], v[100:103], a[240:255]
  s_waitcnt lgkmcnt(0)
  v_mfma_f32_32x32x16_bf16 a[0:15], v[40:43], v[72:75], a[0:15]
  ds_read_b128 v[56:59], v25 offset:0
  v_mfma_f32_32x32x16_bf16 a[16:31], v[40:43], v[76:79], a[16:31]
  ds_read_b64_tr_b16 v[88:89], v30 offset:24576
  v_mfma_f32_32x32x16_bf16 a[32:47], v[40:43], v[80:83], a[32:47]
  ds_read_b64_tr_b16 v[90:91], v30 offset:26624
  v_mfma_f32_32x32x16_bf16 a[48:63], v[40:43], v[84:87], a[48:63]
  ds_read_b128 v[60:63], v25 offset:4096
  v_mfma_f32_32x32x16_bf16 a[64:79], v[44:47], v[72:75], a[64:79]
  ds_read_b64_tr_b16 v[92:93], v31 offset:24576
  v_mfma_f32_32x32x16_bf16 a[80:95], v[44:47], v[76:79], a[80:95]
  ds_read_b64_tr_b16 v[94:95], v31 offset:26624
  v_mfma_f32_32x32x16_bf16 a[96:111], v[44:47], v[80:83], a[96:111]
  ds_read_b128 v[64:67], v25 offset:8192
  v_mfma_f32_32x32x16_bf16 a[112:127], v[44:47], v[84:87], a[112:127]
  ds_read_b64_tr_b16 v[96:97], v32 offset:24576
  v_mfma_f32_32x32x16_bf16 a[128:143], v[48:51], v[72:75], a[128:143]
  ds_read_b64_tr_b16 v[98:99], v32 offset:26624
  v_mfma_f32_32x32x16_bf16 a[144:159], v[48:51], v[76:79], a[144:159]
  ds_read_b128 v[68:71], v25 offset:12288
  v_mfma_f32_32x32x16_bf16 a[160:175], v[48:51], v[80:83], a[160:175]
  ds_read_b64_tr_b16 v[100:101], v33 offset:24576
  v_mfma_f32_32x32x16_bf16 a[176:191], v[48:51], v[84:87], a[176:191]
  ds_read_b64_tr_b16 v[102:103], v33 offset:26624
  v_mfma_f32_32x32x16_bf16 a[192:207], v[52:55], v[72:75], a[192:207]
  v_mfma_f32_32x32x16_bf16 a[208:223], v[52:55], v[76:79], a[208:223]
  v_mfma_f32_32x32x16_bf16 a[224:239], v[52:55], v[80:83], a[224:239]
  v_mfma_f32_32x32x16_bf16 a[240:255], v[52:55], v[84:87], a[240:255]
  s_waitcnt lgkmcnt(0)
  v_mfma_f32_32x32x16_bf16 a[0:15], v[56:59], v[88:91], a[0:15]
  s_waitcnt vmcnt(0)
  s_barrier
  v_mfma_f32_32x32x16_bf16 a[16:31], v[56:59], v[92:95], a[16:31]
  ds_read_b128 v[40:43], v18 offset:0
  s_add_u32 m0, s29, 65536
  s_nop 0
  buffer_load_dwordx4 v2, s[8:11], s20 offen lds
  v_mfma_f32_32x32x16_bf16 a[32:47], v[56:59], v[96:99], a[32:47]
  ds_read_b64_tr_b16 v[72:73], v26 offset:0
  s_add_u32 m0, s29, 66560
  s_nop 0
  buffer_load_dwordx4 v3, s[8:11], s20 offen lds
  v_mfma_f32_32x32x16_bf16 a[48:63], v[56:59], v[100:103], a[48:63]
  ds_read_b64_tr_b16 v[74:75], v26 offset:2048
  s_add_u32 m0, s29, 67584
  s_nop 0
  buffer_load_dwordx4 v4, s[8:11], s20 offen lds
  v_mfma_f32_32x32x16_bf16 a[64:79], v[60:63], v[88:91], a[64:79]
  ds_read_b128 v[44:47], v18 offset:4096
  s_add_u32 m0, s29, 68608
  s_nop 0
  buffer_load_dwordx4 v5, s[8:11], s20 offen lds
  v_mfma_f32_32x32x16_bf16 a[80:95], v[60:63], v[92:95], a[80:95]
  ds_read_b64_tr_b16 v[76:77], v27 offset:0
  s_add_u32 m0, s29, 69632
  s_nop 0
  buffer_load_dwordx4 v6, s[8:11], s20 offen lds
  v_mfma_f32_32x32x16_bf16 a[96:111], v[60:63], v[96:99], a[96:111]
  ds_read_b64_tr_b16 v[78:79], v27 offset:2048
  s_add_u32 m0, s29, 70656
  s_nop 0
  buffer_load_dwordx4 v7, s[8:11], s20 offen lds
  v_mfma_f32_32x32x16_bf16 a[112:127], v[60:63], v[100:103], a[112:127]
  ds_read_b128 v[48:51], v18 offset:8192
  s_add_u32 m0, s29, 71680
  s_nop 0
  buffer_load_dwordx4 v8, s[8:11], s20 offen lds
  v_mfma_f32_32x32x16_bf16 a[128:143], v[64:67], v[88:91], a[128:143]
  ds_read_b64_tr_b16 v[80:81], v28 offset:0
  v_mfma_f32_32x32x16_bf16 a[144:159], v[64:67], v[92:95], a[144:159]
  ds_read_b64_tr_b16 v[82:83], v28 offset:2048
  v_mfma_f32_32x32x16_bf16 a[160:175], v[64:67], v[96:99], a[160:175]
  ds_read_b128 v[52:55], v18 offset:12288
  v_mfma_f32_32x32x16_bf16 a[176:191], v[64:67], v[100:103], a[176:191]
  ds_read_b64_tr_b16 v[84:85], v29 offset:0
  v_mfma_f32_32x32x16_bf16 a[192:207], v[68:71], v[88:91], a[192:207]
  ds_read_b64_tr_b16 v[86:87], v29 offset:2048
  v_mfma_f32_32x32x16_bf16 a[208:223], v[68:71], v[92:95], a[208:223]
  v_mfma_f32_32x32x16_bf16 a[224:239], v[68:71], v[96:99], a[224:239]
  v_mfma_f32_32x32x16_bf16 a[240:255], v[68:71], v[100:103], a[240:255]
  s_sub_u32 s25, s25, 1
  s_cmp_eq_u32 s25, 0
  s_cbranch_scc1 L_g2_fin
  s_waitcnt lgkmcnt(0)
  v_mfma_f32_32x32x16_bf16 a[0:15], v[40:43], v[72:75], a[0:15]
  ds_read_b128 v[56:59], v19 offset:0
  s_add_u32 m0, s29, 72704
  s_nop 0
  buffer_load_dwordx4 v9, s[8:11], s20 offen lds
  v_mfma_f32_32x32x16_bf16 a[16:31], v[40:43], v[76:79], a[16:31]
  ds_read_b64_tr_b16 v[88:89], v26 offset:8192
  s_add_u32 m0, s30, 65536
  s_nop 0
  buffer_load_dwordx4 v10, s[12:15], s21 offen lds
  v_mfma_f32_32x32x16_bf16 a[32:47], v[40:43], v[80:83], a[32:47]
  ds_read_b64_tr_b16 v[90:91], v26 offset:10240
  s_add_u32 m0, s30, 66560
  s_nop 0
  buffer_load_dwordx4 v11, s[12:15], s21 offen lds
  v_mfma_f32_32x32x16_bf16 a[48:63], v[40:43], v[84:87], a[48:63]
  ds_read_b128 v[60:63], v19 offset:4096
  s_add_u32 m0, s30, 67584
  s_nop 0
  buffer_load_dwordx4 v12, s[12:15], s21 offen lds
  v_mfma_f32_32x32x16_bf16 a[64:79], v[44:47], v[72:75], a[64:79]
  ds_read_b64_tr_b16 v[92:93], v27 offset:8192
  s_add_u32 m0, s30, 68608
  s_nop 0
  buffer_load_dwordx4 v13, s[12:15], s21 offen lds
  v_mfma_f32_32x32x16_bf16 a[80:95], v[44:47], v[76:79], a[80:95]
  ds_read_b64_tr_b16 v[94:95], v27 offset:10240
  s_add_u32 m0, s30, 69632
  s_nop 0
  buffer_load_dwordx4 v14, s[12:15], s21 offen lds
  v_mfma_f32_32x32x16_bf16 a[96:111], v[44:47], v[80:83], a[96:111]
  ds_read_b128 v[64:67], v19 offset:8192
  s_add_u32 m0, s30, 70656
  s_nop 0
  buffer_load_dwordx4 v15, s[12:15], s21 offen lds
  v_mfma_f32_32x32x16_bf16 a[112:127], v[44:47], v[84:87], a[112:127]
  ds_read_b64_tr_b16 v[96:97], v28 offset:8192
  v_mfma_f32_32x32x16_bf16 a[128:143], v[48:51], v[72:75], a[128:143]
  ds_read_b64_tr_b16 v[98:99], v28 offset:10240
  v_mfma_f32_32x32x16_bf16 a[144:159], v[48:51], v[76:79], a[144:159]
  ds_read_b128 v[68:71], v19 offset:12288
  v_mfma_f32_32x32x16_bf16 a[160:175], v[48:51], v[80:83], a[160:175]
  ds_read_b64_tr_b16 v[100:101], v29 offset:8192
  v_mfma_f32_32x32x16_bf16 a[176:191], v[48:51], v[84:87], a[176:191]
  ds_read_b64_tr_b16 v[102:103], v29 offset:10240
  v_mfma_f32_32x32x16_bf16 a[192:207], v[52:55], v[72:75], a[192:207]
  v_mfma_f32_32x32x16_bf16 a[208:223], v[52:55], v[76:79], a[208:223]
  v_mfma_f32_32x32x16_bf16 a[224:239], v[52:55], v[80:83], a[224:239]
  v_mfma_f32_32x32x16_bf16 a[240:255], v[52:55], v[84:87], a[240:255]
  s_waitcnt lgkmcnt(0)
  v_mfma_f32_32x32x16_bf16 a[0:15], v[56:59], v[88:91], a[0:15]
  ds_read_b128 v[40:43], v20 offset:0
  s_add_u32 m0, s30, 71680
  s_nop 0
  buffer_load_dwordx4 v16, s[12:15], s21 offen lds
  v_mfma_f32_32x32x16_bf16 a[16:31], v[56:59], v[92:95], a[16:31]
  ds_read_b64_tr_b16 v[72:73], v26 offset:16384
  s_add_u32 m0, s30, 72704
  s_nop 0
  buffer_load_dwordx4 v17, s[12:15], s21 offen lds
  v_mfma_f32_32x32x16_bf16 a[32:47], v[56:59], v[96:99], a[32:47]
  ds_read_b64_tr_b16 v[74:75], v26 offset:18432
  s_add_u32 s20, s20, 128
  s_add_u32 s21, s21, s28
  v_mfma_f32_32x32x16_bf16 a[48:63], v[56:59], v[100:103], a[48:63]
  ds_read_b128 v[44:47], v20 offset:4096
  v_mfma_f32_32x32x16_bf16 a[64:79], v[60:63], v[88:91], a[64:79]
  ds_read_b64_tr_b16 v[76:77], v27 offset:16384
  v_mfma_f32_32x32x16_bf16 a[80:95], v[60:63], v[92:95], a[80:95]
  ds_read_b64_tr_b16 v[78:79], v27 offset:18432
  v_mfma_f32_32x32x16_bf16 a[96:111], v[60:63], v[96:99], a[96:111]
  ds_read_b128 v[48:51], v20 offset:8192
  v_mfma_f32_32x32x16_bf16 a[112:127], v[60:63], v[100:103], a[112:127]
  ds_read_b64_tr_b16 v[80:81], v28 offset:16384
  v_mfma_f32_32x32x16_bf16 a[128:143], v[64:67], v[88:91], a[128:143]
  ds_read_b64_tr_b16 v[82:83], v28 offset:18432
  v_mfma_f32_32x32x16_bf16 a[144:159], v[64:67], v[92:95], a[144:159]
  ds_read_b128 v[52:55], v20 offset:12288
  v_mfma_f32_32x32x16_bf16 a[160:175], v[64:67], v[96:99], a[160:175]
  ds_read_b64_tr_b16 v[84:85], v29 offset:16384
  v_mfma_f32_32x32x16_bf16 a[176:191], v[64:67], v[100:103], a[176:191]
  ds_read_b64_tr_b16 v[86:87], v29 offset:18432
  v_mfma_f32_32x32x16_bf16 a[192:207], v[68:71], v[88:91], a[192:207]
  v_mfma_f32_32x32x16_bf16 a[208:223], v[68:71], v[92:95], a[208:223]
  v_mfma_f32_32x32x16_bf16 a[224:239], v[68:71], v[96:99], a[224:239]
  v_mfma_f32_32x32x16_bf16 a[240:255], v[68:71], v[100:103], a[240:255]
  s_waitcnt lgkmcnt(0)
  v_mfma_f32_32x32x16_bf16 a[0:15], v[40:43], v[72:75], a[0:15]
  ds_read_b128 v[56:59], v21 offset:0
  v_mfma_f32_32x32x16_bf16 a[16:31], v[40:43], v[76:79], a[16:31]
  ds_read_b64_tr_b16 v[88:89], v26 offset:24576
  v_mfma_f32_32x32x16_bf16 a[32:47], v[40:43], v[80:83], a[32:47]
  ds_read_b64_tr_b16 v[90:91], v26 offset:26624
  v_mfma_f32_32x32x16_bf16 a[48:63], v[40:43], v[84:87], a[48:63]
  ds_read_b128 v[60:63], v21 offset:4096
  v_mfma_f32_32x32x16_bf16 a[64:79], v[44:47], v[72:75], a[64:79]
  ds_read_b64_tr_b16 v[92:93], v27 offset:24576
  v_mfma_f32_32x32x16_bf16 a[80:95], v[44:47], v[76:79], a[80:95]
  ds_read_b64_tr_b16 v[94:95], v27 offset:26624
  v_mfma_f32_32x32x16_bf16 a[96:111], v[44:47], v[80:83], a[96:111]
  ds_read_b128 v[64:67], v21 offset:8192
  v_mfma_f32_32x32x16_bf16 a[112:127], v[44:47], v[84:87], a[112:127]
  ds_read_b64_tr_b16 v[96:97], v28 offset:24576
  v_mfma_f32_32x32x16_bf16 a[128:143], v[48:51], v[72:75], a[128:143]
  ds_read_b64_tr_b16 v[98:99], v28 offset:26624
  v_mfma_f32_32x32x16_bf16 a[144:159], v[48:51], v[76:79], a[144:159]
  ds_read_b128 v[68:71], v21 offset:12288
  v_mfma_f32_32x32x16_bf16 a[160:175], v[48:51], v[80:83], a[160:175]
  ds_read_b64_tr_b16 v[100:101], v29 offset:24576
  v_mfma_f32_32x32x16_bf16 a[176:191], v[48:51], v[84:87], a[176:191]
  ds_read_b64_tr_b16 v[102:103], v29 offset:26624
  v_mfma_f32_32x32x16_bf16 a[192:207], v[52:55], v[72:75], a[192:207]
  v_mfma_f32_32x32x16_bf16 a[208:223], v[52:55], v[76:79], a[208:223]
  v_mfma_f32_32x32x16_bf16 a[224:239], v[52:55], v[80:83], a[224:239]
  v_mfma_f32_32x32x16_bf16 a[240:255], v[52:55], v[84:87], a[240:255]
  s_waitcnt lgkmcnt(0)
  v_mfma_f32_32x32x16_bf16 a[0:15], v[56:59], v[88:91], a[0:15]
  s_waitcnt vmcnt(0)
  s_barrier
  v_mfma_f32_32x32x16_bf16 a[16:31], v[56:59], v[92:95], a[16:31]
  ds_read_b128 v[40:43], v22 offset:0
  s_add_u32 m0, s29, 0
  s_nop 0
  buffer_load_dwordx4 v2, s[8:11], s20 offen lds
  v_mfma_f32_32x32x16_bf16 a[32:47], v[56:59], v[96:99], a[32:47]
  ds_read_b64_tr_b16 v[72:73], v30 offset:0
  s_add_u32 m0, s29, 1024
  s_nop 0
  buffer_load_dwordx4 v3, s[8:11], s20 offen lds
  v_mfma_f32_32x32x16_bf16 a[48:63], v[56:59], v[100:103], a[48:63]
  ds_read_b64_tr_b16 v[74:75], v30 offset:2048
  s_add_u32 m0, s29, 2048
  s_nop 0
  buffer_load_dwordx4 v4, s[8:11], s20 offen lds
  v_mfma_f32_32x32x16_bf16 a[64:79], v[60:63], v[88:91], a[64:79]
  ds_read_b128 v[44:47], v22 offset:4096
  s_add_u32 m0, s29, 3072
  s_nop 0
  buffer_load_dwordx4 v5, s[8:11], s20 offen lds
  v_mfma_f32_32x32x16_bf16 a[80:95], v[60:63], v[92:95], a[80:95]
  ds_read_b64_tr_b16 v[76:77], v31 offset:0
  s_add_u32 m0, s29, 4096
  s_nop 0
  buffer_load_dwordx4 v6, s[8:11], s20 offen lds
  v_mfma_f32_32x32x16_bf16 a[96:111], v[60:63], v[96:99], a[96:111]
  ds_read_b64_tr_b16 v[78:79], v31 offset:2048
  s_add_u32 m0, s29, 5120
  s_nop 0
  buffer_load_dwordx4 v7, s[8:11], s20 offen lds
  v_mfma_f32_32x32x16_bf16 a[112:127], v[60:63], v[100:103], a[112:127]
  ds_read_b128 v[48:51], v22 offset:8192
  s_add_u32 m0, s29, 6144
  s_nop 0
  buffer_load_dwordx4 v8, s[8:11], s20 offen lds
  v_mfma_f32_32x32x16_bf16 a[128:143], v[64:67], v[88:91], a[128:143]
  ds_read_b64_tr_b16 v[80:81], v32 offset:0
  v_mfma_f32_32x32x16_bf16 a[144:159], v[64:67], v[92:95], a[144:159]
  ds_read_b64_tr_b16 v[82:83], v32 offset:2048
  v_mfma_f32_32x32x16_bf16 a[160:175], v[64:67], v[96:99], a[160:175]
  ds_read_b128 v[52:55], v22 offset:12288
  v_mfma_f32_32x32x16_bf16 a[176:191], v[64:67], v[100:103], a[176:191]
  ds_read_b64_tr_b16 v[84:85], v33 offset:0
  v_mfma_f32_32x32x16_bf16 a[192:207], v[68:71], v[88:91], a[192:207]
  ds_read_b64_tr_b16 v[86:87], v33 offset:2048
  v_mfma_f32_32x32x16_bf16 a[208:223], v[68:71], v[92:95], a[208:223]
  v_mfma_f32_32x32x16_bf16 a[224:239], v[68:71], v[96:99], a[224:239]
  v_mfma_f32_32x32x16_bf16 a[240:255], v[68:71], v[100:103], a[240:255]
  s_branch L_g2_loop
L_g2_fin:
  s_waitcnt lgkmcnt(0)
  v_mfma_f32_32x32x16_bf16 a[0:15], v[40:43], v[72:75], a[0:15]
  ds_read_b128 v[56:59], v19 offset:0
  s_add_u32 m0, s29, 72704
  s_nop 0
  buffer_load_dwordx4 v9, s[8:11], s20 offen lds
  v_mfma_f32_32x32x16_bf16 a[16:31], v[40:43], v[76:79], a[16:31]
  ds_read_b64_tr_b16 v[88:89], v26 offset:8192
  s_add_u32 m0, s30, 65536
  s_nop 0
  buffer_load_dwordx4 v10, s[12:15], s21 offen lds
  v_mfma_f32_32x32x16_bf16 a[32:47], v[40:43], v[80:83], a[32:47]
  ds_read_b64_tr_b16 v[90:91], v26 offset:10240
  s_add_u32 m0, s30, 66560
  s_nop 0
  buffer_load_dwordx4 v11, s[12:15], s21 offen lds
  v_mfma_f32_32x32x16_bf16 a[48:63], v[40:43], v[84:87], a[48:63]
  ds_read_b128 v[60:63], v19 offset:4096
  s_add_u32 m0, s30, 67584
  s_nop 0
  buffer_load_dwordx4 v12, s[12:15], s21 offen lds
  v_mfma_f32_32x32x16_bf16 a[64:79], v[44:47], v[72:75], a[64:79]
  ds_read_b64_tr_b16 v[92:93], v27 offset:8192
  s_add_u32 m0, s30, 68608
  s_nop 0
  buffer_load_dwordx4 v13, s[12:15], s21 offen lds
  v_mfma_f32_32x32x16_bf16 a[80:95], v[44:47], v[76:79], a[80:95]
  ds_read_b64_tr_b16 v[94:95], v27 offset:10240
  s_add_u32 m0, s30, 69632
  s_nop 0
  buffer_load_dwordx4 v14, s[12:15], s21 offen lds
  v_mfma_f32_32x32x16_bf16 a[96:111], v[44:47], v[80:83], a[96:111]
  ds_read_b128 v[64:67], v19 offset:8192
  s_add_u32 m0, s30, 70656
  s_nop 0
  buffer_load_dwordx4 v15, s[12:15], s21 offen lds
  v_mfma_f32_32x32x16_bf16 a[112:127], v[44:47], v[84:87], a[112:127]
  ds_read_b64_tr_b16 v[96:97], v28 offset:8192
  v_mfma_f32_32x32x16_bf16 a[128:143], v[48:51], v[72:75], a[128:143]
  ds_read_b64_tr_b16 v[98:99], v28 offset:10240
  v_mfma_f32_32x32x16_bf16 a[144:159], v[48:51], v[76:79], a[144:159]
  ds_read_b128 v[68:71], v19 offset:12288
  v_mfma_f32_32x32x16_bf16 a[160:175], v[48:51], v[80:83], a[160:175]
  ds_read_b64_tr_b16 v[100:101], v29 offset:8192
  v_mfma_f32_32x32x16_bf16 a[176:191], v[48:51], v[84:87], a[176:191]
  ds_read_b64_tr_b16 v[102:103], v29 offset:10240
  v_mfma_f32_32x32x16_bf16 a[192:207], v[52:55], v[72:75], a[192:207]
  v_mfma_f32_32x32x16_bf16 a[208:223], v[52:55], v[76:79], a[208:223]
  v_mfma_f32_32x32x16_bf16 a[224:239], v[52:55], v[80:83], a[224:239]
  v_mfma_f32_32x32x16_bf16 a[240:255], v[52:55], v[84:87], a[240:255]
  s_waitcnt lgkmcnt(0)
  v_mfma_f32_32x32x16_bf16 a[0:15], v[56:59], v[88:91], a[0:15]
  ds_read_b128 v[40:43], v20 offset:0
  s_add_u32 m0, s30, 71680
  s_nop 0
  buffer_load_dwordx4 v16, s[12:15], s21 offen lds
  v_mfma_f32_32x32x16_bf16 a[16:31], v[56:59], v[92:95], a[16:31]
  ds_read_b64_tr_b16 v[72:73], v26 offset:16384
  s_add_u32 m0, s30, 72704
  s_nop 0
  buffer_load_dwordx4 v17, s[12:15], s21 offen lds
  v_mfma_f32_32x32x16_bf16 a[32:47], v[56:59], v[96:99], a[32:47]
  ds_read_b64_tr_b16 v[74:75], v26 offset:18432
  s_add_u32 s20, s20, 128
  s_add_u32 s21, s21, s28
  v_mfma_f32_32x32x16_bf16 a[48:63], v[56:59], v[100:103], a[48:63]
  ds_read_b128 v[44:47], v20 offset:4096
  v_mfma_f32_32x32x16_bf16 a[64:79], v[60:63], v[88:91], a[64:79]
  ds_read_b64_tr_b16 v[76:77], v27 offset:16384
  v_mfma_f32_32x32x16_bf16 a[80:95], v[60:63], v[92:95], a[80:95]
  ds_read_b64_tr_b16 v[78:79], v27 offset:18432
  v_mfma_f32_32x32x16_bf16 a[96:111], v[60:63], v[96:99], a[96:111]
  ds_read_b128 v[48:51], v20 offset:8192
  v_mfma_f32_32x32x16_bf16 a[112:127], v[60:63], v[100:103], a[112:127]
  ds_read_b64_tr_b16 v[80:81], v28 offset:16384
  v_mfma_f32_32x32x16_bf16 a[128:143], v[64:67], v[88:91], a[128:143]
  ds_read_b64_tr_b16 v[82:83], v28 offset:18432
  v_mfma_f32_32x32x16_bf16 a[144:159], v[64:67], v[92:95], a[144:159]
  ds_read_b128 v[52:55], v20 offset:12288
  v_mfma_f32_32x32x16_bf16 a[160:175], v[64:67], v[96:99], a[160:175]
  ds_read_b64_tr_b16 v[84:85], v29 offset:16384
  v_mfma_f32_32x32x16_bf16 a[176:191], v[64:67], v[100:103], a[176:191]
  ds_read_b64_tr_b16 v[86:87], v29 offset:18432
  v_mfma_f32_32x32x16_bf16 a[192:207], v[68:71], v[88:91], a[192:207]
  v_mfma_f32_32x32x16_bf16 a[208:223], v[68:71], v[92:95], a[208:223]
  v_mfma_f32_32x32x16_bf16 a[224:239], v[68:71], v[96:99], a[224:239]
  v_mfma_f32_32x32x16_bf16 a[240:255], v[68:71], v[100:103], a[240:255]
  s_waitcnt lgkmcnt(0)
  v_mfma_f32_32x32x16_bf16 a[0:15], v[40:43], v[72:75], a[0:15]
  ds_read_b128 v[56:59], v21 offset:0
  v_mfma_f32_32x32x16_bf16 a[16:31], v[40:43], v[76:79], a[16:31]
  ds_read_b64_tr_b16 v[88:89], v26 offset:24576
  v_mfma_f32_32x32x16_bf16 a[32:47], v[40:43], v[80:83], a[32:47]
  ds_read_b64_tr_b16 v[90:91], v26 offset:26624
  v_mfma_f32_32x32x16_bf16 a[48:63], v[40:43], v[84:87], a[48:63]
  ds_read_b128 v[60:63], v21 offset:4096
  v_mfma_f32_32x32x16_bf16 a[64:79], v[44:47], v[72:75], a[64:79]
  ds_read_b64_tr_b16 v[92:93], v27 offset:24576
  v_mfma_f32_32x32x16_bf16 a[80:95], v[44:47], v[76:79], a[80:95]
  ds_read_b64_tr_b16 v[94:95], v27 offset:26624
  v_mfma_f32_32x32x16_bf16 a[96:111], v[44:47], v[80:83], a[96:111]
  ds_read_b128 v[64:67], v21 offset:8192
  v_mfma_f32_32x32x16_bf16 a[112:127], v[44:47], v[84:87], a[112:127]
  ds_read_b64_tr_b16 v[96:97], v28 offset:24576
  v_mfma_f32_32x32x16_bf16 a[128:143], v[48:51], v[72:75], a[128:143]
  ds_read_b64_tr_b16 v[98:99], v28 offset:26624
  v_mfma_f32_32x32x16_bf16 a[144:159], v[48:51], v[76:79], a[144:159]
  ds_read_b128 v[68:71], v21 offset:12288
  v_mfma_f32_32x32x16_bf16 a[160:175], v[48:51], v[80:83], a[160:175]
  ds_read_b64_tr_b16 v[100:101], v29 offset:24576
  v_mfma_f32_32x32x16_bf16 a[176:191], v[48:51], v[84:87], a[176:191]
  ds_read_b64_tr_b16 v[102:103], v29 offset:26624
  v_mfma_f32_32x32x16_bf16 a[192:207], v[52:55], v[72:75], a[192:207]
  v_mfma_f32_32x32x16_bf16 a[208:223], v[52:55], v[76:79], a[208:223]
  v_mfma_f32_32x32x16_bf16 a[224:239], v[52:55], v[80:83], a[224:239]
  v_mfma_f32_32x32x16_bf16 a[240:255], v[52:55], v[84:87], a[240:255]
  s_waitcnt lgkmcnt(0)
  v_mfma_f32_32x32x16_bf16 a[0:15], v[56:59], v[88:91], a[0:15]
  s_waitcnt vmcnt(0)
  s_barrier
  v_mfma_f32_32x32x16_bf16 a[16:31], v[56:59], v[92:95], a[16:31]
  ds_read_b128 v[40:43], v22 offset:0
  v_mfma_f32_32x32x16_bf16 a[32:47], v[56:59], v[96:99], a[32:47]
  ds_read_b64_tr_b16 v[72:73], v30 offset:0
  v_mfma_f32_32x32x16_bf16 a[48:63], v[56:59], v[100:103], a[48:63]
  ds_read_b64_tr_b16 v[74:75], v30 offset:2048
  v_mfma_f32_32x32x16_bf16 a[64:79], v[60:63], v[88:91], a[64:79]
  ds_read_b128 v[44:47], v22 offset:4096
  v_mfma_f32_32x32x16_bf16 a[80:95], v[60:63], v[92:95], a[80:95]
  ds_read_b64_tr_b16 v[76:77], v31 offset:0
  v_mfma_f32_32x32x16_bf16 a[96:111], v[60:63], v[96:99], a[96:111]
  ds_read_b64_tr_b16 v[78:79], v31 offset:2048
  v_mfma_f32_32x32x16_bf16 a[112:127], v[60:63], v[100:103], a[112:127]
  ds_read_b128 v[48:51], v22 offset:8192
  v_mfma_f32_32x32x16_bf16 a[128:143], v[64:67], v[88:91], a[128:143]
  ds_read_b64_tr_b16 v[80:81], v32 offset:0
  v_mfma_f32_32x32x16_bf16 a[144:159], v[64:67], v[92:95], a[144:159]
  ds_read_b64_tr_b16 v[82:83], v32 offset:2048
  v_mfma_f32_32x32x16_bf16 a[160:175], v[64:67], v[96:99], a[160:175]
  ds_read_b128 v[52:55], v22 offset:12288
  v_mfma_f32_32x32x16_bf16 a[176:191], v[64:67], v[100:103], a[176:191]
  ds_read_b64_tr_b16 v[84:85], v33 offset:0
  v_mfma_f32_32x32x16_bf16 a[192:207], v[68:71], v[88:91], a[192:207]
  ds_read_b64_tr_b16 v[86:87], v33 offset:2048
  v_mfma_f32_32x32x16_bf16 a[208:223], v[68:71], v[92:95], a[208:223]
  v_mfma_f32_32x32x16_bf16 a[224:239], v[68:71], v[96:99], a[224:239]
  v_mfma_f32_32x32x16_bf16 a[240:255], v[68:71], v[100:103], a[240:255]
  s_waitcnt lgkmcnt(0)
  v_mfma_f32_32x32x16_bf16 a[0:15], v[40:43], v[72:75], a[0:15]
  ds_read_b128 v[56:59], v23 offset:0
  v_mfma_f32_32x32x16_bf16 a[16:31], v[40:43], v[76:79], a[16:31]
  ds_read_b64_tr_b16 v[88:89], v30 offset:8192
  v_mfma_f32_32x32x16_bf16 a[32:47], v[40:43], v[80:83], a[32:47]
  ds_read_b64_tr_b16 v[90:91], v30 offset:10240
  v_mfma_f32_32x32x16_bf16 a[48:63], v[40:43], v[84:87], a[48:63]
  ds_read_b128 v[60:63], v23 offset:4096
  v_mfma_f32_32x32x16_bf16 a[64:79], v[44:47], v[72:75], a[64:79]
  ds_read_b64_tr_b16 v[92:93], v31 offset:8192
  v_mfma_f32_32x32x16_bf16 a[80:95], v[44:47], v[76:79], a[80:95]
  ds_read_b64_tr_b16 v[94:95], v31 offset:10240
  v_mfma_f32_32x32x16_bf16 a[96:111], v[44:47], v[80:83], a[96:111]
  ds_read_b128 v[64:67], v23 offset:8192
  v_mfma_f32_32x32x16_bf16 a[112:127], v[44:47], v[84:87], a[112:127]
  ds_read_b64_tr_b16 v[96:97], v32 offset:8192
  v_mfma_f32_32x32x16_bf16 a[128:143], v[48:51], v[72:75], a[128:143]
  ds_read_b64_tr_b16 v[98:99], v32 offset:10240
  v_mfma_f32_32x32x16_bf16 a[144:159], v[48:51], v[76:79], a[144:159]
  ds_read_b128 v[68:71], v23 offset:12288
  v_mfma_f32_32x32x16_bf16 a[160:175], v[48:51], v[80:83], a[160:175]
  ds_read_b64_tr_b16 v[100:101], v33 offset:8192
  v_mfma_f32_32x32x16_bf16 a[176:191], v[48:51], v[84:87], a[176:191]
  ds_read_b64_tr_b16 v[102:103], v33 offset:10240
  v_mfma_f32_32x32x16_bf16 a[192:207], v[52:55], v[72:75], a[192:207]
  v_mfma_f32_32x32x16_bf16 a[208:223], v[52:55], v[76:79], a[208:223]
  v_mfma_f32_32x32x16_bf16 a[224:239], v[52:55], v[80:83], a[224:239]
  v_mfma_f32_32x32x16_bf16 a[240:255], v[52:55], v[84:87], a[240:255]
  s_waitcnt lgkmcnt(0)
  v_mfma_f32_32x32x16_bf16 a[0:15], v[56:59], v[88:91], a[0:15]
  ds_read_b128 v[40:43], v24 offset:0
  v_mfma_f32_32x32x16_bf16 a[16:31], v[56:59], v[92:95], a[16:31]
  ds_read_b64_tr_b16 v[72:73], v30 offset:16384
  v_mfma_f32_32x32x16_bf16 a[32:47], v[56:59], v[96:99], a[32:47]
  ds_read_b64_tr_b16 v[74:75], v30 offset:18432
  v_mfma_f32_32x32x16_bf16 a[48:63], v[56:59], v[100:103], a[48:63]
  ds_read_b128 v[44:47], v24 offset:4096
  v_mfma_f32_32x32x16_bf16 a[64:79], v[60:63], v[88:91], a[64:79]
  ds_read_b64_tr_b16 v[76:77], v31 offset:16384
  v_mfma_f32_32x32x16_bf16 a[80:95], v[60:63], v[92:95], a[80:95]
  ds_read_b64_tr_b16 v[78:79], v31 offset:18432
  v_mfma_f32_32x32x16_bf16 a[96:111], v[60:63], v[96:99], a[96:111]
  ds_read_b128 v[48:51], v24 offset:8192
  v_mfma_f32_32x32x16_bf16 a[112:127], v[60:63], v[100:103], a[112:127]
  ds_read_b64_tr_b16 v[80:81], v32 offset:16384
  v_mfma_f32_32x32x16_bf16 a[128:143], v[64:67], v[88:91], a[128:143]
  ds_read_b64_tr_b16 v[82:83], v32 offset:18432
  v_mfma_f32_32x32x16_bf16 a[144:159], v[64:67], v[92:95], a[144:159]
  ds_read_b128 v[52:55], v24 offset:12288
  v_mfma_f32_32x32x16_bf16 a[160:175], v[64:67], v[96:99], a[160:175]
  ds_read_b64_tr_b16 v[84:85], v33 offset:16384
  v_mfma_f32_32x32x16_bf16 a[176:191], v[64:67], v[100:103], a[176:191]
  ds_read_b64_tr_b16 v[86:87], v33 offset:18432
  v_mfma_f32_32x32x16_bf16 a[192:207], v[68:71], v[88:91], a[192:207]
  v_mfma_f32_32x32x16_bf16 a[208:223], v[68:71], v[92:95], a[208:223]
  v_mfma_f32_32x32x16_bf16 a[224:239], v[68:71], v[96:99], a[224:239]
  v_mfma_f32_32x32x16_bf16 a[240:255], v[68:71], v[100:103], a[240:255]
  s_waitcnt lgkmcnt(0)
  v_mfma_f32_32x32x16_bf16 a[0:15], v[40:43], v[72:75], a[0:15]
  ds_read_b128 v[56:59], v25 offset:0
  v_mfma_f32_32x32x16_bf16 a[16:31], v[40:43], v[76:79], a[16:31]
  ds_read_b64_tr_b16 v[88:89], v30 offset:24576
  v_mfma_f32_32x32x16_bf16 a[32:47], v[40:43], v[80:83], a[32:47]
  ds_read_b64_tr_b16 v[90:91], v30 offset:26624
  v_mfma_f32_32x32x16_bf16 a[48:63], v[40:43], v[84:87], a[48:63]
  ds_read_b128 v[60:63], v25 offset:4096
  v_mfma_f32_32x32x16_bf16 a[64:79], v[44:47], v[72:75], a[64:79]
  ds_read_b64_tr_b16 v[92:93], v31 offset:24576
  v_mfma_f32_32x32x16_bf16 a[80:95], v[44:47], v[76:79], a[80:95]
  ds_read_b64_tr_b16 v[94:95], v31 offset:26624
  v_mfma_f32_32x32x16_bf16 a[96:111], v[44:47], v[80:83], a[96:111]
  ds_read_b128 v[64:67], v25 offset:8192
  v_mfma_f32_32x32x16_bf16 a[112:127], v[44:47], v[84:87], a[112:127]
  ds_read_b64_tr_b16 v[96:97], v32 offset:24576
  v_mfma_f32_32x32x16_bf16 a[128:143], v[48:51], v[72:75], a[128:143]
  ds_read_b64_tr_b16 v[98:99], v32 offset:26624
  v_mfma_f32_32x32x16_bf16 a[144:159], v[48:51], v[76:79], a[144:159]
  ds_read_b128 v[68:71], v25 offset:12288
  v_mfma_f32_32x32x16_bf16 a[160:175], v[48:51], v[80:83], a[160:175]
  ds_read_b64_tr_b16 v[100:101], v33 offset:24576
  v_mfma_f32_32x32x16_bf16 a[176:191], v[48:51], v[84:87], a[176:191]
  ds_read_b64_tr_b16 v[102:103], v33 offset:26624
  v_mfma_f32_32x32x16_bf16 a[192:207], v[52:55], v[72:75], a[192:207]
  v_mfma_f32_32x32x16_bf16 a[208:223], v[52:55], v[76:79], a[208:223]
  v_mfma_f32_32x32x16_bf16 a[224:239], v[52:55], v[80:83], a[224:239]
  v_mfma_f32_32x32x16_bf16 a[240:255], v[52:55], v[84:87], a[240:255]
  s_waitcnt lgkmcnt(0)
  v_mfma_f32_32x32x16_bf16 a[0:15], v[56:59], v[88:91], a[0:15]
  v_mfma_f32_32x32x16_bf16 a[16:31], v[56:59], v[92:95], a[16:31]
  v_mfma_f32_32x32x16_bf16 a[32:47], v[56:59], v[96:99], a[32:47]
  v_mfma_f32_32x32x16_bf16 a[48:63], v[56:59], v[100:103], a[48:63]
  v_mfma_f32_32x32x16_bf16 a[64:79], v[60:63], v[88:91], a[64:79]
  v_mfma_f32_32x32x16_bf16 a[80:95], v[60:63], v[92:95], a[80:95]
  v_mfma_f32_32x32x16_bf16 a[96:111], v[60:63], v[96:99], a[96:111]
  v_mfma_f32_32x32x16_bf16 a[112:127], v[60:63], v[100:103], a[112:127]
  v_mfma_f32_32x32x16_bf16 a[128:143], v[64:67], v[88:91], a[128:143]
  v_mfma_f32_32x32x16_bf16 a[144:159], v[64:67], v[92:95], a[144:159]
  v_mfma_f32_32x32x16_bf16 a[160:175], v[64:67], v[96:99], a[160:175]
  v_mfma_f32_32x32x16_bf16 a[176:191], v[64:67], v[100:103], a[176:191]
  v_mfma_f32_32x32x16_bf16 a[192:207], v[68:71], v[88:91], a[192:207]
  v_mfma_f32_32x32x16_bf16 a[208:223], v[68:71], v[92:95], a[208:223]
  v_mfma_f32_32x32x16_bf16 a[224:239], v[68:71], v[96:99], a[224:239]
  v_mfma_f32_32x32x16_bf16 a[240:255], v[68:71], v[100:103], a[240:255]
  s_lshr_b32 s90, s27, 1
  s_and_b32 s91, s27, 1
  v_mov_b32 v36, 0x0
  v_bfe_u32 v35, v1, 0, 4
  v_lshl_add_u32 v36, v35, 4, v36
  v_bfe_u32 v35, v1, 4, 1
  v_lshl_add_u32 v36, v35, 10, v36
  v_bfe_u32 v35, v1, 5, 1
  v_lshl_add_u32 v36, v35, 8, v36
  s_mul_i32 s92, s90, 4
  s_mul_i32 s92, s92, s26
  s_add_u32 s92, s92, s22
  s_mul_i32 s93, s91, 8192
  s_add_u32 s92, s92, s93
  s_add_u32 s93, s92, 0
  v_accvgpr_read_b32 v108, a0
  v_accvgpr_read_b32 v109, a1
  v_accvgpr_read_b32 v110, a2
  v_accvgpr_read_b32 v111, a3
  v_accvgpr_read_b32 v112, a8
  v_accvgpr_read_b32 v113, a9
  v_accvgpr_read_b32 v114, a10
  v_accvgpr_read_b32 v115, a11
  v_cvt_pk_bf16_f32 v104, v108, v109
  v_cvt_pk_bf16_f32 v105, v110, v111
  v_cvt_pk_bf16_f32 v106, v112, v113
  v_cvt_pk_bf16_f32 v107, v114, v115
  buffer_store_dwordx4 v[104:107], v36, s[16:19], s93 offen offset:0
  v_accvgpr_read_b32 v120, a4
  v_accvgpr_read_b32 v121, a5
  v_accvgpr_read_b32 v122, a6
  v_accvgpr_read_b32 v123, a7
  v_accvgpr_read_b32 v124, a12
  v_accvgpr_read_b32 v125, a13
  v_accvgpr_read_b32 v126, a14
  v_accvgpr_read_b32 v127, a15
  v_cvt_pk_bf16_f32 v116, v120, v121
  v_cvt_pk_bf16_f32 v117, v122, v123
  v_cvt_pk_bf16_f32 v118, v124, v125
  v_cvt_pk_bf16_f32 v119, v126, v127
  buffer_store_dwordx4 v[116:119], v36, s[16:19], s93 offen offset:512
  s_add_u32 s93, s92, 2048
  v_accvgpr_read_b32 v132, a16
  v_accvgpr_read_b32 v133, a17
  v_accvgpr_read_b32 v134, a18
  v_accvgpr_read_b32 v135, a19
  v_accvgpr_read_b32 v136, a24
  v_accvgpr_read_b32 v137, a25
  v_accvgpr_read_b32 v138, a26
  v_accvgpr_read_b32 v139, a27
  v_cvt_pk_bf16_f32 v128, v132, v133
  v_cvt_pk_bf16_f32 v129, v134, v135
  v_cvt_pk_bf16_f32 v130, v136, v137
  v_cvt_pk_bf16_f32 v131, v138, v139
  buffer_store_dwordx4 v[128:131], v36, s[16:19], s93 offen offset:0
  v_accvgpr_read_b32 v144, a20
  v_accvgpr_read_b32 v145, a21
  v_accvgpr_read_b32 v146, a22
  v_accvgpr_read_b32 v147, a23
  v_accvgpr_read_b32 v148, a28
  v_accvgpr_read_b32 v149, a29
  v_accvgpr_read_b32 v150, a30
  v_accvgpr_read_b32 v151, a31
  v_cvt_pk_bf16_f32 v140, v144, v145
  v_cvt_pk_bf16_f32 v141, v146, v147
  v_cvt_pk_bf16_f32 v142, v148, v149
  v_cvt_pk_bf16_f32 v143, v150, v151
  buffer_store_dwordx4 v[140:143], v36, s[16:19], s93 offen offset:512
  s_add_u32 s93, s92, 4096
  v_accvgpr_read_b32 v108, a32
  v_accvgpr_read_b32 v109, a33
  v_accvgpr_read_b32 v110, a34
  v_accvgpr_read_b32 v111, a35
  v_accvgpr_read_b32 v112, a40
  v_accvgpr_read_b32 v113, a41
  v_accvgpr_read_b32 v114, a42
  v_accvgpr_read_b32 v115, a43
  v_cvt_pk_bf16_f32 v104, v108, v109
  v_cvt_pk_bf16_f32 v105, v110, v111
  v_cvt_pk_bf16_f32 v106, v112, v113
  v_cvt_pk_bf16_f32 v107, v114, v115
  buffer_store_dwordx4 v[104:107], v36, s[16:19], s93 offen offset:0
  v_accvgpr_read_b32 v120, a36
  v_accvgpr_read_b32 v121, a37
  v_accvgpr_read_b32 v122, a38
  v_accvgpr_read_b32 v123, a39
  v_accvgpr_read_b32 v124, a44
  v_accvgpr_read_b32 v125, a45
  v_accvgpr_read_b32 v126, a46
  v_accvgpr_read_b32 v127, a47
  v_cvt_pk_bf16_f32 v116, v120, v121
  v_cvt_pk_bf16_f32 v117, v122, v123
  v_cvt_pk_bf16_f32 v118, v124, v125
  v_cvt_pk_bf16_f32 v119, v126, v127
  buffer_store_dwordx4 v[116:119], v36, s[16:19], s93 offen offset:512
  s_add_u32 s93, s92, 6144
  v_accvgpr_read_b32 v132, a48
  v_accvgpr_read_b32 v133, a49
  v_accvgpr_read_b32 v134, a50
  v_accvgpr_read_b32 v135, a51
  v_accvgpr_read_b32 v136, a56
  v_accvgpr_read_b32 v137, a57
  v_accvgpr_read_b32 v138, a58
  v_accvgpr_read_b32 v139, a59
  v_cvt_pk_bf16_f32 v128, v132, v133
  v_cvt_pk_bf16_f32 v129, v134, v135
  v_cvt_pk_bf16_f32 v130, v136, v137
  v_cvt_pk_bf16_f32 v131, v138, v139
  buffer_store_dwordx4 v[128:131], v36, s[16:19], s93 offen offset:0
  v_accvgpr_read_b32 v144, a52
  v_accvgpr_read_b32 v145, a53
  v_accvgpr_read_b32 v146, a54
  v_accvgpr_read_b32 v147, a55
  v_accvgpr_read_b32 v148, a60
  v_accvgpr_read_b32 v149, a61
  v_accvgpr_read_b32 v150, a62
  v_accvgpr_read_b32 v151, a63
  v_cvt_pk_bf16_f32 v140, v144, v145
  v_cvt_pk_bf16_f32 v141, v146, v147
  v_cvt_pk_bf16_f32 v142, v148, v149
  v_cvt_pk_bf16_f32 v143, v150, v151
  buffer_store_dwordx4 v[140:143], v36, s[16:19], s93 offen offset:512
  s_add_u32 s92, s92, s26
  s_add_u32 s93, s92, 0
  v_accvgpr_read_b32 v108, a64
  v_accvgpr_read_b32 v109, a65
  v_accvgpr_read_b32 v110, a66
  v_accvgpr_read_b32 v111, a67
  v_accvgpr_read_b32 v112, a72
  v_accvgpr_read_b32 v113, a73
  v_accvgpr_read_b32 v114, a74
  v_accvgpr_read_b32 v115, a75
  v_cvt_pk_bf16_f32 v104, v108, v109
  v_cvt_pk_bf16_f32 v105, v110, v111
  v_cvt_pk_bf16_f32 v106, v112, v113
  v_cvt_pk_bf16_f32 v107, v114, v115
  buffer_store_dwordx4 v[104:107], v36, s[16:19], s93 offen offset:0
  v_accvgpr_read_b32 v120, a68
  v_accvgpr_read_b32 v121, a69
  v_accvgpr_read_b32 v122, a70
  v_accvgpr_read_b32 v123, a71
  v_accvgpr_read_b32 v124, a76
  v_accvgpr_read_b32 v125, a77
  v_accvgpr_read_b32 v126, a78
  v_accvgpr_read_b32 v127, a79
  v_cvt_pk_bf16_f32 v116, v120, v121
  v_cvt_pk_bf16_f32 v117, v122, v123
  v_cvt_pk_bf16_f32 v118, v124, v125
  v_cvt_pk_bf16_f32 v119, v126, v127
  buffer_store_dwordx4 v[116:119], v36, s[16:19], s93 offen offset:512
  s_add_u32 s93, s92, 2048
  v_accvgpr_read_b32 v132, a80
  v_accvgpr_read_b32 v133, a81
  v_accvgpr_read_b32 v134, a82
  v_accvgpr_read_b32 v135, a83
  v_accvgpr_read_b32 v136, a88
  v_accvgpr_read_b32 v137, a89
  v_accvgpr_read_b32 v138, a90
  v_accvgpr_read_b32 v139, a91
  v_cvt_pk_bf16_f32 v128, v132, v133
  v_cvt_pk_bf16_f32 v129, v134, v135
  v_cvt_pk_bf16_f32 v130, v136, v137
  v_cvt_pk_bf16_f32 v131, v138, v139
  buffer_store_dwordx4 v[128:131], v36, s[16:19], s93 offen offset:0
  v_accvgpr_read_b32 v144, a84
  v_accvgpr_read_b32 v145, a85
  v_accvgpr_read_b32 v146, a86
  v_accvgpr_read_b32 v147, a87
  v_accvgpr_read_b32 v148, a92
  v_accvgpr_read_b32 v149, a93
  v_accvgpr_read_b32 v150, a94
  v_accvgpr_read_b32 v151, a95
  v_cvt_pk_bf16_f32 v140, v144, v145
  v_cvt_pk_bf16_f32 v141, v146, v147
  v_cvt_pk_bf16_f32 v142, v148, v149
  v_cvt_pk_bf16_f32 v143, v150, v151
  buffer_store_dwordx4 v[140:143], v36, s[16:19], s93 offen offset:512
  s_add_u32 s93, s92, 4096
  v_accvgpr_read_b32 v108, a96
  v_accvgpr_read_b32 v109, a97
  v_accvgpr_read_b32 v110, a98
  v_accvgpr_read_b32 v111, a99
  v_accvgpr_read_b32 v112, a104
  v_accvgpr_read_b32 v113, a105
  v_accvgpr_read_b32 v114, a106
  v_accvgpr_read_b32 v115, a107
  v_cvt_pk_bf16_f32 v104, v108, v109
  v_cvt_pk_bf16_f32 v105, v110, v111
  v_cvt_pk_bf16_f32 v106, v112, v113
  v_cvt_pk_bf16_f32 v107, v114, v115
  buffer_store_dwordx4 v[104:107], v36, s[16:19], s93 offen offset:0
  v_accvgpr_read_b32 v120, a100
  v_accvgpr_read_b32 v121, a101
  v_accvgpr_read_b32 v122, a102
  v_accvgpr_read_b32 v123, a103
  v_accvgpr_read_b32 v124, a108
  v_accvgpr_read_b32 v125, a109
  v_accvgpr_read_b32 v126, a110
  v_accvgpr_read_b32 v127, a111
  v_cvt_pk_bf16_f32 v116, v120, v121
  v_cvt_pk_bf16_f32 v117, v122, v123
  v_cvt_pk_bf16_f32 v118, v124, v125
  v_cvt_pk_bf16_f32 v119, v126, v127
  buffer_store_dwordx4 v[116:119], v36, s[16:19], s93 offen offset:512
  s_add_u32 s93, s92, 6144
  v_accvgpr_read_b32 v132, a112
  v_accvgpr_read_b32 v133, a113
  v_accvgpr_read_b32 v134, a114
  v_accvgpr_read_b32 v135, a115
  v_accvgpr_read_b32 v136, a120
  v_accvgpr_read_b32 v137, a121
  v_accvgpr_read_b32 v138, a122
  v_accvgpr_read_b32 v139, a123
  v_cvt_pk_bf16_f32 v128, v132, v133
  v_cvt_pk_bf16_f32 v129, v134, v135
  v_cvt_pk_bf16_f32 v130, v136, v137
  v_cvt_pk_bf16_f32 v131, v138, v139
  buffer_store_dwordx4 v[128:131], v36, s[16:19], s93 offen offset:0
  v_accvgpr_read_b32 v144, a116
  v_accvgpr_read_b32 v145, a117
  v_accvgpr_read_b32 v146, a118
  v_accvgpr_read_b32 v147, a119
  v_accvgpr_read_b32 v148, a124
  v_accvgpr_read_b32 v149, a125
  v_accvgpr_read_b32 v150, a126
  v_accvgpr_read_b32 v151, a127
  v_cvt_pk_bf16_f32 v140, v144, v145
  v_cvt_pk_bf16_f32 v141, v146, v147
  v_cvt_pk_bf16_f32 v142, v148, v149
  v_cvt_pk_bf16_f32 v143, v150, v151
  buffer_store_dwordx4 v[140:143], v36, s[16:19], s93 offen offset:512
  s_add_u32 s92, s92, s26
  s_add_u32 s93, s92, 0
  v_accvgpr_read_b32 v108, a128
  v_accvgpr_read_b32 v109, a129
  v_accvgpr_read_b32 v110, a130
  v_accvgpr_read_b32 v111, a131
  v_accvgpr_read_b32 v112, a136
  v_accvgpr_read_b32 v113, a137
  v_accvgpr_read_b32 v114, a138
  v_accvgpr_read_b32 v115, a139
  v_cvt_pk_bf16_f32 v104, v108, v109
  v_cvt_pk_bf16_f32 v105, v110, v111
  v_cvt_pk_bf16_f32 v106, v112, v113
  v_cvt_pk_bf16_f32 v107, v114, v115
  buffer_store_dwordx4 v[104:107], v36, s[16:19], s93 offen offset:0
  v_accvgpr_read_b32 v120, a132
  v_accvgpr_read_b32 v121, a133
  v_accvgpr_read_b32 v122, a134
  v_accvgpr_read_b32 v123, a135
  v_accvgpr_read_b32 v124, a140
  v_accvgpr_read_b32 v125, a141
  v_accvgpr_read_b32 v126, a142
  v_accvgpr_read_b32 v127, a143
  v_cvt_pk_bf16_f32 v116, v120, v121
  v_cvt_pk_bf16_f32 v117, v122, v123
  v_cvt_pk_bf16_f32 v118, v124, v125
  v_cvt_pk_bf16_f32 v119, v126, v127
  buffer_store_dwordx4 v[116:119], v36, s[16:19], s93 offen offset:512
  s_add_u32 s93, s92, 2048
  v_accvgpr_read_b32 v132, a144
  v_accvgpr_read_b32 v133, a145
  v_accvgpr_read_b32 v134, a146
  v_accvgpr_read_b32 v135, a147
  v_accvgpr_read_b32 v136, a152
  v_accvgpr_read_b32 v137, a153
  v_accvgpr_read_b32 v138, a154
  v_accvgpr_read_b32 v139, a155
  v_cvt_pk_bf16_f32 v128, v132, v133
  v_cvt_pk_bf16_f32 v129, v134, v135
  v_cvt_pk_bf16_f32 v130, v136, v137
  v_cvt_pk_bf16_f32 v131, v138, v139
  buffer_store_dwordx4 v[128:131], v36, s[16:19], s93 offen offset:0
  v_accvgpr_read_b32 v144, a148
  v_accvgpr_read_b32 v145, a149
  v_accvgpr_read_b32 v146, a150
  v_accvgpr_read_b32 v147, a151
  v_accvgpr_read_b32 v148, a156
  v_accvgpr_read_b32 v149, a157
  v_accvgpr_read_b32 v150, a158
  v_accvgpr_read_b32 v151, a159
  v_cvt_pk_bf16_f32 v140, v144, v145
  v_cvt_pk_bf16_f32 v141, v146, v147
  v_cvt_pk_bf16_f32 v142, v148, v149
  v_cvt_pk_bf16_f32 v143, v150, v151
  buffer_store_dwordx4 v[140:143], v36, s[16:19], s93 offen offset:512
  s_add_u32 s93, s92, 4096
  v_accvgpr_read_b32 v108, a160
  v_accvgpr_read_b32 v109, a161
  v_accvgpr_read_b32 v110, a162
  v_accvgpr_read_b32 v111, a163
  v_accvgpr_read_b32 v112, a168
  v_accvgpr_read_b32 v113, a169
  v_accvgpr_read_b32 v114, a170
  v_accvgpr_read_b32 v115, a171
  v_cvt_pk_bf16_f32 v104, v108, v109
  v_cvt_pk_bf16_f32 v105, v110, v111
  v_cvt_pk_bf16_f32 v106, v112, v113
  v_cvt_pk_bf16_f32 v107, v114, v115
  buffer_store_dwordx4 v[104:107], v36, s[16:19], s93 offen offset:0
  v_accvgpr_read_b32 v120, a164
  v_accvgpr_read_b32 v121, a165
  v_accvgpr_read_b32 v122, a166
  v_accvgpr_read_b32 v123, a167
  v_accvgpr_read_b32 v124, a172
  v_accvgpr_read_b32 v125, a173
  v_accvgpr_read_b32 v126, a174
  v_accvgpr_read_b32 v127, a175
  v_cvt_pk_bf16_f32 v116, v120, v121
  v_cvt_pk_bf16_f32 v117, v122, v123
  v_cvt_pk_bf16_f32 v118, v124, v125
  v_cvt_pk_bf16_f32 v119, v126, v127
  buffer_store_dwordx4 v[116:119], v36, s[16:19], s93 offen offset:512
  s_add_u32 s93, s92, 6144
  v_accvgpr_read_b32 v132, a176
  v_accvgpr_read_b32 v133, a177
  v_accvgpr_read_b32 v134, a178
  v_accvgpr_read_b32 v135, a179
  v_accvgpr_read_b32 v136, a184
  v_accvgpr_read_b32 v137, a185
  v_accvgpr_read_b32 v138, a186
  v_accvgpr_read_b32 v139, a187
  v_cvt_pk_bf16_f32 v128, v132, v133
  v_cvt_pk_bf16_f32 v129, v134, v135
  v_cvt_pk_bf16_f32 v130, v136, v137
  v_cvt_pk_bf16_f32 v131, v138, v139
  buffer_store_dwordx4 v[128:131], v36, s[16:19], s93 offen offset:0
  v_accvgpr_read_b32 v144, a180
  v_accvgpr_read_b32 v145, a181
  v_accvgpr_read_b32 v146, a182
  v_accvgpr_read_b32 v147, a183
  v_accvgpr_read_b32 v148, a188
  v_accvgpr_read_b32 v149, a189
  v_accvgpr_read_b32 v150, a190
  v_accvgpr_read_b32 v151, a191
  v_cvt_pk_bf16_f32 v140, v144, v145
  v_cvt_pk_bf16_f32 v141, v146, v147
  v_cvt_pk_bf16_f32 v142, v148, v149
  v_cvt_pk_bf16_f32 v143, v150, v151
  buffer_store_dwordx4 v[140:143], v36, s[16:19], s93 offen offset:512
  s_add_u32 s92, s92, s26
  s_add_u32 s93, s92, 0
  v_accvgpr_read_b32 v108, a192
  v_accvgpr_read_b32 v109, a193
  v_accvgpr_read_b32 v110, a194
  v_accvgpr_read_b32 v111, a195
  v_accvgpr_read_b32 v112, a200
  v_accvgpr_read_b32 v113, a201
  v_accvgpr_read_b32 v114, a202
  v_accvgpr_read_b32 v115, a203
  v_cvt_pk_bf16_f32 v104, v108, v109
  v_cvt_pk_bf16_f32 v105, v110, v111
  v_cvt_pk_bf16_f32 v106, v112, v113
  v_cvt_pk_bf16_f32 v107, v114, v115
  buffer_store_dwordx4 v[104:107], v36, s[16:19], s93 offen offset:0
  v_accvgpr_read_b32 v120, a196
  v_accvgpr_read_b32 v121, a197
  v_accvgpr_read_b32 v122, a198
  v_accvgpr_read_b32 v123, a199
  v_accvgpr_read_b32 v124, a204
  v_accvgpr_read_b32 v125, a205
  v_accvgpr_read_b32 v126, a206
  v_accvgpr_read_b32 v127, a207
  v_cvt_pk_bf16_f32 v116, v120, v121
  v_cvt_pk_bf16_f32 v117, v122, v123
  v_cvt_pk_bf16_f32 v118, v124, v125
  v_cvt_pk_bf16_f32 v119, v126, v127
  buffer_store_dwordx4 v[116:119], v36, s[16:19], s93 offen offset:512
  s_add_u32 s93, s92, 2048
  v_accvgpr_read_b32 v132, a208
  v_accvgpr_read_b32 v133, a209
  v_accvgpr_read_b32 v134, a210
  v_accvgpr_read_b32 v135, a211
  v_accvgpr_read_b32 v136, a216
  v_accvgpr_read_b32 v137, a217
  v_accvgpr_read_b32 v138, a218
  v_accvgpr_read_b32 v139, a219
  v_cvt_pk_bf16_f32 v128, v132, v133
  v_cvt_pk_bf16_f32 v129, v134, v135
  v_cvt_pk_bf16_f32 v130, v136, v137
  v_cvt_pk_bf16_f32 v131, v138, v139
  buffer_store_dwordx4 v[128:131], v36, s[16:19], s93 offen offset:0
  v_accvgpr_read_b32 v144, a212
  v_accvgpr_read_b32 v145, a213
  v_accvgpr_read_b32 v146, a214
  v_accvgpr_read_b32 v147, a215
  v_accvgpr_read_b32 v148, a220
  v_accvgpr_read_b32 v149, a221
  v_accvgpr_read_b32 v150, a222
  v_accvgpr_read_b32 v151, a223
  v_cvt_pk_bf16_f32 v140, v144, v145
  v_cvt_pk_bf16_f32 v141, v146, v147
  v_cvt_pk_bf16_f32 v142, v148, v149
  v_cvt_pk_bf16_f32 v143, v150, v151
  buffer_store_dwordx4 v[140:143], v36, s[16:19], s93 offen offset:512
  s_add_u32 s93, s92, 4096
  v_accvgpr_read_b32 v108, a224
  v_accvgpr_read_b32 v109, a225
  v_accvgpr_read_b32 v110, a226
  v_accvgpr_read_b32 v111, a227
  v_accvgpr_read_b32 v112, a232
  v_accvgpr_read_b32 v113, a233
  v_accvgpr_read_b32 v114, a234
  v_accvgpr_read_b32 v115, a235
  v_cvt_pk_bf16_f32 v104, v108, v109
  v_cvt_pk_bf16_f32 v105, v110, v111
  v_cvt_pk_bf16_f32 v106, v112, v113
  v_cvt_pk_bf16_f32 v107, v114, v115
  buffer_store_dwordx4 v[104:107], v36, s[16:19], s93 offen offset:0
  v_accvgpr_read_b32 v120, a228
  v_accvgpr_read_b32 v121, a229
  v_accvgpr_read_b32 v122, a230
  v_accvgpr_read_b32 v123, a231
  v_accvgpr_read_b32 v124, a236
  v_accvgpr_read_b32 v125, a237
  v_accvgpr_read_b32 v126, a238
  v_accvgpr_read_b32 v127, a239
  v_cvt_pk_bf16_f32 v116, v120, v121
  v_cvt_pk_bf16_f32 v117, v122, v123
  v_cvt_pk_bf16_f32 v118, v124, v125
  v_cvt_pk_bf16_f32 v119, v126, v127
  buffer_store_dwordx4 v[116:119], v36, s[16:19], s93 offen offset:512
  s_add_u32 s93, s92, 6144
  v_accvgpr_read_b32 v132, a240
  v_accvgpr_read_b32 v133, a241
  v_accvgpr_read_b32 v134, a242
  v_accvgpr_read_b32 v135, a243
  v_accvgpr_read_b32 v136, a248
  v_accvgpr_read_b32 v137, a249
  v_accvgpr_read_b32 v138, a250
  v_accvgpr_read_b32 v139, a251
  v_cvt_pk_bf16_f32 v128, v132, v133
  v_cvt_pk_bf16_f32 v129, v134, v135
  v_cvt_pk_bf16_f32 v130, v136, v137
  v_cvt_pk_bf16_f32 v131, v138, v139
  buffer_store_dwordx4 v[128:131], v36, s[16:19], s93 offen offset:0
  v_accvgpr_read_b32 v144, a244
  v_accvgpr_read_b32 v145, a245
  v_accvgpr_read_b32 v146, a246
  v_accvgpr_read_b32 v147, a247
  v_accvgpr_read_b32 v148, a252
  v_accvgpr_read_b32 v149, a253
  v_accvgpr_read_b32 v150, a254
  v_accvgpr_read_b32 v151, a255
  v_cvt_pk_bf16_f32 v140, v144, v145
  v_cvt_pk_bf16_f32 v141, v146, v147
  v_cvt_pk_bf16_f32 v142, v148, v149
  v_cvt_pk_bf16_f32 v143, v150, v151
  buffer_store_dwordx4 v[140:143], v36, s[16:19], s93 offen offset:512
  s_add_u32 s92, s92, s26
L_k1_end:
  s_endpgm
.globl rec_kernel
.p2align 8
.type rec_kernel,@function
rec_kernel:
  s_load_dwordx4 s[92:95], s[0:1], 88
  s_cmp_ge_u32 s2, 256
  s_cbranch_scc1 L_rec_exit
  s_getreg_b32 s33, hwreg(HW_REG_XCC_ID, 0, 4)
  s_cmp_ge_u32 s33, 4
  s_cbranch_scc1 L_rec_exit
  s_waitcnt lgkmcnt(0)
  s_mov_b32 s4, s94
  s_and_b32 s5, s95, 0xffff
  s_mov_b32 s6, 0x10000000
  s_mov_b32 s7, 0x20000
  s_mov_b32 s28, s92
  s_and_b32 s29, s93, 0xffff
  s_mov_b32 s30, 0x100
  s_mov_b32 s31, 0x20000
  v_cmp_eq_u32 vcc, 0, v0
  s_and_saveexec_b64 s[96:97], vcc
  s_cbranch_execz L_tk
  s_lshl_b32 s90, s33, 6
  v_mov_b32 v1, 1
  v_mov_b32 v2, 0
  buffer_atomic_add v1, v2, s[28:31], s90 offen sc0 sc1
  s_waitcnt vmcnt(0)
  ds_write_b32 v2, v1
  s_waitcnt lgkmcnt(0)
L_tk:
  s_mov_b64 exec, s[96:97]
  s_barrier
  v_mov_b32 v2, 0
  ds_read_b32 v1, v2
  s_waitcnt lgkmcnt(0)
  v_readfirstlane_b32 s34, v1
  s_barrier
  s_cmp_ge_u32 s34, 32
  s_cbranch_scc1 L_rec_exit
  s_load_dwordx4 s[80:83], s[0:1], 8
  s_load_dwordx4 s[84:87], s[0:1], 24
  s_load_dwordx2 s[88:89], s[0:1], 40
  v_lshrrev_b32 v31, 6, v0
  s_nop 0
  v_readfirstlane_b32 s32, v31
  v_and_b32 v0, 63, v0
  s_lshr_b32 s35, s34, 4
  s_lshl_b32 s90, s33, 1
  s_add_u32 s35, s35, s90
  s_and_b32 s36, s34, 15
  s_lshr_b32 s37, s36, 2
  s_lshl_b32 s90, s35, 2
  s_add_u32 s37, s37, s90
  s_and_b32 s38, s36, 3
  s_waitcnt lgkmcnt(0)
  s_mov_b32 s24, s80
  s_and_b32 s25, s81, 0xffff
  s_mov_b32 s26, 0x4000
  s_mov_b32 s27, 0x20000
  s_mov_b32 s8, s82
  s_and_b32 s9, s83, 0xffff
  s_mov_b32 s10, 0x800000
  s_mov_b32 s11, 0x20000
  s_mov_b32 s12, s84
  s_and_b32 s13, s85, 0xffff
  s_mov_b32 s14, 0x800000
  s_mov_b32 s15, 0x20000
  s_mov_b32 s16, s86
  s_and_b32 s17, s87, 0xffff
  s_mov_b32 s18, 0x800000
  s_mov_b32 s19, 0x20000
  s_mov_b32 s20, s88
  s_and_b32 s21, s89, 0xffff
  s_mov_b32 s22, 0x800000
  s_mov_b32 s23, 0x20000
  s_lshl_b32 s90, s32, 21
  s_lshl_b32 s91, s37, 8
  s_add_u32 s90, s90, s91
  s_lshl_b32 s91, s38, 6
  s_add_u32 s90, s90, s91
  v_mov_b32 v1, 0x0
  v_bfe_u32 v31, v0, 5, 1
  v_lshl_add_u32 v1, v31, 17, v1
  v_bfe_u32 v31, v0, 4, 1
  v_lshl_add_u32 v1, v31, 15, v1
  v_bfe_u32 v31, v0, 0, 4
  v_lshl_add_u32 v1, v31, 2, v1
  v_add_u32 v1, s90, v1
  v_add_u32 v2, 0x2000, v1
  v_mov_b32 v3, 0x0
  v_bfe_u32 v31, v0, 5, 1
  v_lshl_add_u32 v3, v31, 17, v3
  v_bfe_u32 v31, v0, 4, 1
  v_lshl_add_u32 v3, v31, 15, v3
  v_bfe_u32 v31, v0, 1, 3
  v_lshl_add_u32 v3, v31, 2, v3
  v_add_u32 v3, s90, v3
  v_add_u32 v4, 0x2000, v3
  s_lshl_b32 s90, s35, 20
  s_lshl_b32 s91, s36, 7
  s_add_u32 s90, s90, s91
  s_lshl_b32 s91, s32, 5
  s_add_u32 s90, s90, s91
  v_mov_b32 v5, 0x0
  v_bfe_u32 v31, v0, 4, 1
  v_lshl_add_u32 v5, v31, 17, v5
  v_bfe_u32 v31, v0, 5, 1
  v_lshl_add_u32 v5, v31, 12, v5
  v_bfe_u32 v31, v0, 1, 3
  v_lshl_add_u32 v5, v31, 2, v5
  v_add_u32 v5, s90, v5
  v_add_u32 v6, 0x8000, v5
  v_mov_b32 v7, 0x05040100
  v_mov_b32 v8, 0x07060302
  v_and_b32 v31, 1, v0
  v_cmp_eq_u32 vcc, 1, v31
  s_nop 1
  v_cndmask_b32 v9, v7, v8, vcc
  s_mov_b32 s90, 0x0
  buffer_load_dword v40, v1, s[8:11], s90 offen offset:0
  buffer_load_dword v41, v2, s[8:11], s90 offen offset:0
  s_mov_b32 s90, 0x0
  buffer_load_dword v42, v1, s[12:15], s90 offen offset:0
  buffer_load_dword v43, v2, s[12:15], s90 offen offset:0
  s_mov_b32 s90, 0x0
  buffer_load_dword v44, v3, s[16:19], s90 offen offset:0
  buffer_load_dword v45, v4, s[16:19], s90 offen offset:0
  s_mov_b32 s90, 0x0
  buffer_load_dword v46, v3, s[16:19], s90 offen offset:32
  buffer_load_dword v47, v4, s[16:19], s90 offen offset:32
  s_mov_b32 s90, 0x10000
  buffer_load_dword v48, v1, s[8:11], s90 offen offset:0
  buffer_load_dword v49, v2, s[8:11], s90 offen offset:0
  s_mov_b32 s90, 0x10000
  buffer_load_dword v50, v1, s[12:15], s90 offen offset:0
  buffer_load_dword v51, v2, s[12:15], s90 offen offset:0
  s_mov_b32 s90, 0x10000
  buffer_load_dword v52, v3, s[16:19], s90 offen offset:0
  buffer_load_dword v53, v4, s[16:19], s90 offen offset:0
  s_mov_b32 s90, 0x10000
  buffer_load_dword v54, v3, s[16:19], s90 offen offset:32
  buffer_load_dword v55, v4, s[16:19], s90 offen offset:32
  s_mov_b32 s90, 0x4000
  buffer_load_dword v56, v1, s[8:11], s90 offen offset:0
  buffer_load_dword v57, v2, s[8:11], s90 offen offset:0
  s_mov_b32 s90, 0x4000
  buffer_load_dword v58, v1, s[12:15], s90 offen offset:0
  buffer_load_dword v59, v2, s[12:15], s90 offen offset:0
  s_mov_b32 s90, 0x4000
  buffer_load_dword v60, v3, s[16:19], s90 offen offset:0
  buffer_load_dword v61, v4, s[16:19], s90 offen offset:0
  s_mov_b32 s90, 0x4000
  buffer_load_dword v62, v3, s[16:19], s90 offen offset:32
  buffer_load_dword v63, v4, s[16:19], s90 offen offset:32
  s_mov_b32 s90, 0x14000
  buffer_load_dword v64, v1, s[8:11], s90 offen offset:0
  buffer_load_dword v65, v2, s[8:11], s90 offen offset:0
  s_mov_b32 s90, 0x14000
  buffer_load_dword v66, v1, s[12:15], s90 offen offset:0
  buffer_load_dword v67, v2, s[12:15], s90 offen offset:0
  s_mov_b32 s90, 0x14000
  buffer_load_dword v68, v3, s[16:19], s90 offen offset:0
  buffer_load_dword v69, v4, s[16:19], s90 offen offset:0
  s_mov_b32 s90, 0x14000
  buffer_load_dword v70, v3, s[16:19], s90 offen offset:32
  buffer_load_dword v71, v4, s[16:19], s90 offen offset:32
  s_mov_b32 s90, 0x40000
  buffer_load_dword v72, v1, s[8:11], s90 offen offset:0
  buffer_load_dword v73, v2, s[8:11], s90 offen offset:0
  s_mov_b32 s90, 0x40000
  buffer_load_dword v74, v1, s[12:15], s90 offen offset:0
  buffer_load_dword v75, v2, s[12:15], s90 offen offset:0
  s_mov_b32 s90, 0x40000
  buffer_load_dword v76, v3, s[16:19], s90 offen offset:0
  buffer_load_dword v77, v4, s[16:19], s90 offen offset:0
  s_mov_b32 s90, 0x40000
  buffer_load_dword v78, v3, s[16:19], s90 offen offset:32
  buffer_load_dword v79, v4, s[16:19], s90 offen offset:32
  s_mov_b32 s90, 0x50000
  buffer_load_dword v80, v1, s[8:11], s90 offen offset:0
  buffer_load_dword v81, v2, s[8:11], s90 offen offset:0
  s_mov_b32 s90, 0x50000
  buffer_load_dword v82, v1, s[12:15], s90 offen offset:0
  buffer_load_dword v83, v2, s[12:15], s90 offen offset:0
  s_mov_b32 s90, 0x50000
  buffer_load_dword v84, v3, s[16:19], s90 offen offset:0
  buffer_load_dword v85, v4, s[16:19], s90 offen offset:0
  s_mov_b32 s90, 0x50000
  buffer_load_dword v86, v3, s[16:19], s90 offen offset:32
  buffer_load_dword v87, v4, s[16:19], s90 offen offset:32
  s_mov_b32 s90, 0x44000
  buffer_load_dword v88, v1, s[8:11], s90 offen offset:0
  buffer_load_dword v89, v2, s[8:11], s90 offen offset:0
  s_mov_b32 s90, 0x44000
  buffer_load_dword v90, v1, s[12:15], s90 offen offset:0
  buffer_load_dword v91, v2, s[12:15], s90 offen offset:0
  s_mov_b32 s90, 0x44000
  buffer_load_dword v92, v3, s[16:19], s90 offen offset:0
  buffer_load_dword v93, v4, s[16:19], s90 offen offset:0
  s_mov_b32 s90, 0x44000
  buffer_load_dword v94, v3, s[16:19], s90 offen offset:32
  buffer_load_dword v95, v4, s[16:19], s90 offen offset:32
  s_mov_b32 s90, 0x54000
  buffer_load_dword v96, v1, s[8:11], s90 offen offset:0
  buffer_load_dword v97, v2, s[8:11], s90 offen offset:0
  s_waitcnt vmcnt(56)
  v_perm_b32 v10, v41, v40, v7
  v_perm_b32 v11, v41, v40, v8
  v_accvgpr_write_b32 a0, v10
  v_accvgpr_write_b32 a8, v11
  s_mov_b32 s90, 0x54000
  buffer_load_dword v98, v1, s[12:15], s90 offen offset:0
  buffer_load_dword v99, v2, s[12:15], s90 offen offset:0
  s_waitcnt vmcnt(56)
  v_perm_b32 v10, v43, v42, v7
  v_perm_b32 v11, v43, v42, v8
  v_accvgpr_write_b32 a16, v10
  v_accvgpr_write_b32 a24, v11
  s_mov_b32 s90, 0x54000
  buffer_load_dword v40, v3, s[16:19], s90 offen offset:0
  buffer_load_dword v41, v4, s[16:19], s90 offen offset:0
  s_waitcnt vmcnt(56)
  v_perm_b32 v10, v45, v44, v9
  v_accvgpr_write_b32 a32, v10
  s_mov_b32 s90, 0x54000
  buffer_load_dword v42, v3, s[16:19], s90 offen offset:32
  buffer_load_dword v43, v4, s[16:19], s90 offen offset:32
  s_waitcnt vmcnt(56)
  v_perm_b32 v10, v47, v46, v9
  v_accvgpr_write_b32 a40, v10
  s_mov_b32 s90, 0x80000
  buffer_load_dword v44, v1, s[8:11], s90 offen offset:0
  buffer_load_dword v45, v2, s[8:11], s90 offen offset:0
  s_waitcnt vmcnt(56)
  v_perm_b32 v10, v49, v48, v7
  v_perm_b32 v11, v49, v48, v8
  v_accvgpr_write_b32 a1, v10
  v_accvgpr_write_b32 a9, v11
  s_mov_b32 s90, 0x80000
  buffer_load_dword v46, v1, s[12:15], s90 offen offset:0
  buffer_load_dword v47, v2, s[12:15], s90 offen offset:0
  s_waitcnt vmcnt(56)
  v_perm_b32 v10, v51, v50, v7
  v_perm_b32 v11, v51, v50, v8
  v_accvgpr_write_b32 a17, v10
  v_accvgpr_write_b32 a25, v11
  s_mov_b32 s90, 0x80000
  buffer_load_dword v48, v3, s[16:19], s90 offen offset:0
  buffer_load_dword v49, v4, s[16:19], s90 offen offset:0
  s_waitcnt vmcnt(56)
  v_perm_b32 v10, v53, v52, v9
  v_accvgpr_write_b32 a33, v10
  s_mov_b32 s90, 0x80000
  buffer_load_dword v50, v3, s[16:19], s90 offen offset:32
  buffer_load_dword v51, v4, s[16:19], s90 offen offset:32
  s_waitcnt vmcnt(56)
  v_perm_b32 v10, v55, v54, v9
  v_accvgpr_write_b32 a41, v10
  s_mov_b32 s90, 0x90000
  buffer_load_dword v52, v1, s[8:11], s90 offen offset:0
  buffer_load_dword v53, v2, s[8:11], s90 offen offset:0
  s_waitcnt vmcnt(56)
  v_perm_b32 v10, v57, v56, v7
  v_perm_b32 v11, v57, v56, v8
  v_accvgpr_write_b32 a2, v10
  v_accvgpr_write_b32 a10, v11
  s_mov_b32 s90, 0x90000
  buffer_load_dword v54, v1, s[12:15], s90 offen offset:0
  buffer_load_dword v55, v2, s[12:15], s90 offen offset:0
  s_waitcnt vmcnt(56)
  v_perm_b32 v10, v59, v58, v7
  v_perm_b32 v11, v59, v58, v8
  v_accvgpr_write_b32 a18, v10
  v_accvgpr_write_b32 a26, v11
  s_mov_b32 s90, 0x90000
  buffer_load_dword v56, v3, s[16:19], s90 offen offset:0
  buffer_load_dword v57, v4, s[16:19], s90 offen offset:0
  s_waitcnt vmcnt(56)
  v_perm_b32 v10, v61, v60, v9
  v_accvgpr_write_b32 a34, v10
  s_mov_b32 s90, 0x90000
  buffer_load_dword v58, v3, s[16:19], s90 offen offset:32
  buffer_load_dword v59, v4, s[16:19], s90 offen offset:32
  s_waitcnt vmcnt(56)
  v_perm_b32 v10, v63, v62, v9
  v_accvgpr_write_b32 a42, v10
  s_mov_b32 s90, 0x84000
  buffer_load_dword v60, v1, s[8:11], s90 offen offset:0
  buffer_load_dword v61, v2, s[8:11], s90 offen offset:0
  s_waitcnt vmcnt(56)
  v_perm_b32 v10, v65, v64, v7
  v_perm_b32 v11, v65, v64, v8
  v_accvgpr_write_b32 a3, v10
  v_accvgpr_write_b32 a11, v11
  s_mov_b32 s90, 0x84000
  buffer_load_dword v62, v1, s[12:15], s90 offen offset:0
  buffer_load_dword v63, v2, s[12:15], s90 offen offset:0
  s_waitcnt vmcnt(56)
  v_perm_b32 v10, v67, v66, v7
  v_perm_b32 v11, v67, v66, v8
  v_accvgpr_write_b32 a19, v10
  v_accvgpr_write_b32 a27, v11
  s_mov_b32 s90, 0x84000
  buffer_load_dword v64, v3, s[16:19], s90 offen offset:0
  buffer_load_dword v65, v4, s[16:19], s90 offen offset:0
  s_waitcnt vmcnt(56)
  v_perm_b32 v10, v69, v68, v9
  v_accvgpr_write_b32 a35, v10
  s_mov_b32 s90, 0x84000
  buffer_load_dword v66, v3, s[16:19], s90 offen offset:32
  buffer_load_dword v67, v4, s[16:19], s90 offen offset:32
  s_waitcnt vmcnt(56)
  v_perm_b32 v10, v71, v70, v9
  v_accvgpr_write_b32 a43, v10
  s_mov_b32 s90, 0x94000
  buffer_load_dword v68, v1, s[8:11], s90 offen offset:0
  buffer_load_dword v69, v2, s[8:11], s90 offen offset:0
  s_waitcnt vmcnt(56)
  v_perm_b32 v10, v73, v72, v7
  v_perm_b32 v11, v73, v72, v8
  v_accvgpr_write_b32 a4, v10
  v_accvgpr_write_b32 a12, v11
  s_mov_b32 s90, 0x94000
  buffer_load_dword v70, v1, s[12:15], s90 offen offset:0
  buffer_load_dword v71, v2, s[12:15], s90 offen offset:0
  s_waitcnt vmcnt(56)
  v_perm_b32 v10, v75, v74, v7
  v_perm_b32 v11, v75, v74, v8
  v_accvgpr_write_b32 a20, v10
  v_accvgpr_write_b32 a28, v11
  s_mov_b32 s90, 0x94000
  buffer_load_dword v72, v3, s[16:19], s90 offen offset:0
  buffer_load_dword v73, v4, s[16:19], s90 offen offset:0
  s_waitcnt vmcnt(56)
  v_perm_b32 v10, v77, v76, v9
  v_accvgpr_write_b32 a36, v10
  s_mov_b32 s90, 0x94000
  buffer_load_dword v74, v3, s[16:19], s90 offen offset:32
  buffer_load_dword v75, v4, s[16:19], s90 offen offset:32
  s_waitcnt vmcnt(56)
  v_perm_b32 v10, v79, v78, v9
  v_accvgpr_write_b32 a44, v10
  s_mov_b32 s90, 0xc0000
  buffer_load_dword v76, v1, s[8:11], s90 offen offset:0
  buffer_load_dword v77, v2, s[8:11], s90 offen offset:0
  s_waitcnt vmcnt(56)
  v_perm_b32 v10, v81, v80, v7
  v_perm_b32 v11, v81, v80, v8
  v_accvgpr_write_b32 a5, v10
  v_accvgpr_write_b32 a13, v11
  s_mov_b32 s90, 0xc0000
  buffer_load_dword v78, v1, s[12:15], s90 offen offset:0
  buffer_load_dword v79, v2, s[12:15], s90 offen offset:0
  s_waitcnt vmcnt(56)
  v_perm_b32 v10, v83, v82, v7
  v_perm_b32 v11, v83, v82, v8
  v_accvgpr_write_b32 a21, v10
  v_accvgpr_write_b32 a29, v11
  s_mov_b32 s90, 0xc0000
  buffer_load_dword v80, v3, s[16:19], s90 offen offset:0
  buffer_load_dword v81, v4, s[16:19], s90 offen offset:0
  s_waitcnt vmcnt(56)
  v_perm_b32 v10, v85, v84, v9
  v_accvgpr_write_b32 a37, v10
  s_mov_b32 s90, 0xc0000
  buffer_load_dword v82, v3, s[16:19], s90 offen offset:32
  buffer_load_dword v83, v4, s[16:19], s90 offen offset:32
  s_waitcnt vmcnt(56)
  v_perm_b32 v10, v87, v86, v9
  v_accvgpr_write_b32 a45, v10
  s_mov_b32 s90, 0xd0000
  buffer_load_dword v84, v1, s[8:11], s90 offen offset:0
  buffer_load_dword v85, v2, s[8:11], s90 offen offset:0
  s_waitcnt vmcnt(56)
  v_perm_b32 v10, v89, v88, v7
  v_perm_b32 v11, v89, v88, v8
  v_accvgpr_write_b32 a6, v10
  v_accvgpr_write_b32 a14, v11
  s_mov_b32 s90, 0xd0000
  buffer_load_dword v86, v1, s[12:15], s90 offen offset:0
  buffer_load_dword v87, v2, s[12:15], s90 offen offset:0
  s_waitcnt vmcnt(56)
  v_perm_b32 v10, v91, v90, v7
  v_perm_b32 v11, v91, v90, v8
  v_accvgpr_write_b32 a22, v10
  v_accvgpr_write_b32 a30, v11
  s_mov_b32 s90, 0xd0000
  buffer_load_dword v88, v3, s[16:19], s90 offen offset:0
  buffer_load_dword v89, v4, s[16:19], s90 offen offset:0
  s_waitcnt vmcnt(56)
  v_perm_b32 v10, v93, v92, v9
  v_accvgpr_write_b32 a38, v10
  s_mov_b32 s90, 0xd0000
  buffer_load_dword v90, v3, s[16:19], s90 offen offset:32
  buffer_load_dword v91, v4, s[16:19], s90 offen offset:32
  s_waitcnt vmcnt(56)
  v_perm_b32 v10, v95, v94, v9
  v_accvgpr_write_b32 a46, v10
  s_mov_b32 s90, 0xc4000
  buffer_load_dword v92, v1, s[8:11], s90 offen offset:0
  buffer_load_dword v93, v2, s[8:11], s90 offen offset:0
  s_waitcnt vmcnt(56)
  v_perm_b32 v10, v97, v96, v7
  v_perm_b32 v11, v97, v96, v8
  v_accvgpr_write_b32 a7, v10
  v_accvgpr_write_b32 a15, v11
  s_mov_b32 s90, 0xc4000
  buffer_load_dword v94, v1, s[12:15], s90 offen offset:0
  buffer_load_dword v95, v2, s[12:15], s90 offen offset:0
  s_waitcnt vmcnt(56)
  v_perm_b32 v10, v99, v98, v7
  v_perm_b32 v11, v99, v98, v8
  v_accvgpr_write_b32 a23, v10
  v_accvgpr_write_b32 a31, v11
  s_mov_b32 s90, 0xc4000
  buffer_load_dword v96, v3, s[16:19], s90 offen offset:0
  buffer_load_dword v97, v4, s[16:19], s90 offen offset:0
  s_waitcnt vmcnt(56)
  v_perm_b32 v10, v41, v40, v9
  v_accvgpr_write_b32 a39, v10
  s_mov_b32 s90, 0xc4000
  buffer_load_dword v98, v3, s[16:19], s90 offen offset:32
  buffer_load_dword v99, v4, s[16:19], s90 offen offset:32
  s_waitcnt vmcnt(56)
  v_perm_b32 v10, v43, v42, v9
  v_accvgpr_write_b32 a47, v10
  s_mov_b32 s90, 0xd4000
  buffer_load_dword v40, v1, s[8:11], s90 offen offset:0
  buffer_load_dword v41, v2, s[8:11], s90 offen offset:0
  s_waitcnt vmcnt(56)
  v_perm_b32 v10, v45, v44, v7
  v_perm_b32 v11, v45, v44, v8
  v_accvgpr_write_b32 a48, v10
  v_accvgpr_write_b32 a56, v11
  s_mov_b32 s90, 0xd4000
  buffer_load_dword v42, v1, s[12:15], s90 offen offset:0
  buffer_load_dword v43, v2, s[12:15], s90 offen offset:0
  s_waitcnt vmcnt(56)
  v_perm_b32 v10, v47, v46, v7
  v_perm_b32 v11, v47, v46, v8
  v_accvgpr_write_b32 a64, v10
  v_accvgpr_write_b32 a72, v11
  s_mov_b32 s90, 0xd4000
  buffer_load_dword v44, v3, s[16:19], s90 offen offset:0
  buffer_load_dword v45, v4, s[16:19], s90 offen offset:0
  s_waitcnt vmcnt(56)
  v_perm_b32 v10, v49, v48, v9
  v_accvgpr_write_b32 a80, v10
  s_mov_b32 s90, 0xd4000
  buffer_load_dword v46, v3, s[16:19], s90 offen offset:32
  buffer_load_dword v47, v4, s[16:19], s90 offen offset:32
  s_waitcnt vmcnt(56)
  v_perm_b32 v10, v51, v50, v9
  v_accvgpr_write_b32 a88, v10
  s_mov_b32 s90, 0x100000
  buffer_load_dword v48, v1, s[8:11], s90 offen offset:0
  buffer_load_dword v49, v2, s[8:11], s90 offen offset:0
  s_waitcnt vmcnt(56)
  v_perm_b32 v10, v53, v52, v7
  v_perm_b32 v11, v53, v52, v8
  v_accvgpr_write_b32 a49, v10
  v_accvgpr_write_b32 a57, v11
  s_mov_b32 s90, 0x100000
  buffer_load_dword v50, v1, s[12:15], s90 offen offset:0
  buffer_load_dword v51, v2, s[12:15], s90 offen offset:0
  s_waitcnt vmcnt(56)
  v_perm_b32 v10, v55, v54, v7
  v_perm_b32 v11, v55, v54, v8
  v_accvgpr_write_b32 a65, v10
  v_accvgpr_write_b32 a73, v11
  s_mov_b32 s90, 0x100000
  buffer_load_dword v52, v3, s[16:19], s90 offen offset:0
  buffer_load_dword v53, v4, s[16:19], s90 offen offset:0
  s_waitcnt vmcnt(56)
  v_perm_b32 v10, v57, v56, v9
  v_accvgpr_write_b32 a81, v10
  s_mov_b32 s90, 0x100000
  buffer_load_dword v54, v3, s[16:19], s90 offen offset:32
  buffer_load_dword v55, v4, s[16:19], s90 offen offset:32
  s_waitcnt vmcnt(56)
  v_perm_b32 v10, v59, v58, v9
  v_accvgpr_write_b32 a89, v10
  s_mov_b32 s90, 0x110000
  buffer_load_dword v56, v1, s[8:11], s90 offen offset:0
  buffer_load_dword v57, v2, s[8:11], s90 offen offset:0
  s_waitcnt vmcnt(56)
  v_perm_b32 v10, v61, v60, v7
  v_perm_b32 v11, v61, v60, v8
  v_accvgpr_write_b32 a50, v10
  v_accvgpr_write_b32 a58, v11
  s_mov_b32 s90, 0x110000
  buffer_load_dword v58, v1, s[12:15], s90 offen offset:0
  buffer_load_dword v59, v2, s[12:15], s90 offen offset:0
  s_waitcnt vmcnt(56)
  v_perm_b32 v10, v63, v62, v7
  v_perm_b32 v11, v63, v62, v8
  v_accvgpr_write_b32 a66, v10
  v_accvgpr_write_b32 a74, v11
  s_mov_b32 s90, 0x110000
  buffer_load_dword v60, v3, s[16:19], s90 offen offset:0
  buffer_load_dword v61, v4, s[16:19], s90 offen offset:0
  s_waitcnt vmcnt(56)
  v_perm_b32 v10, v65, v64, v9
  v_accvgpr_write_b32 a82, v10
  s_mov_b32 s90, 0x110000
  buffer_load_dword v62, v3, s[16:19], s90 offen offset:32
  buffer_load_dword v63, v4, s[16:19], s90 offen offset:32
  s_waitcnt vmcnt(56)
  v_perm_b32 v10, v67, v66, v9
  v_accvgpr_write_b32 a90, v10
  s_mov_b32 s90, 0x104000
  buffer_load_dword v64, v1, s[8:11], s90 offen offset:0
  buffer_load_dword v65, v2, s[8:11], s90 offen offset:0
  s_waitcnt vmcnt(56)
  v_perm_b32 v10, v69, v68, v7
  v_perm_b32 v11, v69, v68, v8
  v_accvgpr_write_b32 a51, v10
  v_accvgpr_write_b32 a59, v11
  s_mov_b32 s90, 0x104000
  buffer_load_dword v66, v1, s[12:15], s90 offen offset:0
  buffer_load_dword v67, v2, s[12:15], s90 offen offset:0
  s_waitcnt vmcnt(56)
  v_perm_b32 v10, v71, v70, v7
  v_perm_b32 v11, v71, v70, v8
  v_accvgpr_write_b32 a67, v10
  v_accvgpr_write_b32 a75, v11
  s_mov_b32 s90, 0x104000
  buffer_load_dword v68, v3, s[16:19], s90 offen offset:0
  buffer_load_dword v69, v4, s[16:19], s90 offen offset:0
  s_waitcnt vmcnt(56)
  v_perm_b32 v10, v73, v72, v9
  v_accvgpr_write_b32 a83, v10
  s_mov_b32 s90, 0x104000
  buffer_load_dword v70, v3, s[16:19], s90 offen offset:32
  buffer_load_dword v71, v4, s[16:19], s90 offen offset:32
  s_waitcnt vmcnt(56)
  v_perm_b32 v10, v75, v74, v9
  v_accvgpr_write_b32 a91, v10
  s_mov_b32 s90, 0x114000
  buffer_load_dword v72, v1, s[8:11], s90 offen offset:0
  buffer_load_dword v73, v2, s[8:11], s90 offen offset:0
  s_waitcnt vmcnt(56)
  v_perm_b32 v10, v77, v76, v7
  v_perm_b32 v11, v77, v76, v8
  v_accvgpr_write_b32 a52, v10
  v_accvgpr_write_b32 a60, v11
  s_mov_b32 s90, 0x114000
  buffer_load_dword v74, v1, s[12:15], s90 offen offset:0
  buffer_load_dword v75, v2, s[12:15], s90 offen offset:0
  s_waitcnt vmcnt(56)
  v_perm_b32 v10, v79, v78, v7
  v_perm_b32 v11, v79, v78, v8
  v_accvgpr_write_b32 a68, v10
  v_accvgpr_write_b32 a76, v11
  s_mov_b32 s90, 0x114000
  buffer_load_dword v76, v3, s[16:19], s90 offen offset:0
  buffer_load_dword v77, v4, s[16:19], s90 offen offset:0
  s_waitcnt vmcnt(56)
  v_perm_b32 v10, v81, v80, v9
  v_accvgpr_write_b32 a84, v10
  s_mov_b32 s90, 0x114000
  buffer_load_dword v78, v3, s[16:19], s90 offen offset:32
  buffer_load_dword v79, v4, s[16:19], s90 offen offset:32
  s_waitcnt vmcnt(56)
  v_perm_b32 v10, v83, v82, v9
  v_accvgpr_write_b32 a92, v10
  s_mov_b32 s90, 0x140000
  buffer_load_dword v80, v1, s[8:11], s90 offen offset:0
  buffer_load_dword v81, v2, s[8:11], s90 offen offset:0
  s_waitcnt vmcnt(56)
  v_perm_b32 v10, v85, v84, v7
  v_perm_b32 v11, v85, v84, v8
  v_accvgpr_write_b32 a53, v10
  v_accvgpr_write_b32 a61, v11
  s_mov_b32 s90, 0x140000
  buffer_load_dword v82, v1, s[12:15], s90 offen offset:0
  buffer_load_dword v83, v2, s[12:15], s90 offen offset:0
  s_waitcnt vmcnt(56)
  v_perm_b32 v10, v87, v86, v7
  v_perm_b32 v11, v87, v86, v8
  v_accvgpr_write_b32 a69, v10
  v_accvgpr_write_b32 a77, v11
  s_mov_b32 s90, 0x140000
  buffer_load_dword v84, v3, s[16:19], s90 offen offset:0
  buffer_load_dword v85, v4, s[16:19], s90 offen offset:0
  s_waitcnt vmcnt(56)
  v_perm_b32 v10, v89, v88, v9
  v_accvgpr_write_b32 a85, v10
  s_mov_b32 s90, 0x140000
  buffer_load_dword v86, v3, s[16:19], s90 offen offset:32
  buffer_load_dword v87, v4, s[16:19], s90 offen offset:32
  s_waitcnt vmcnt(56)
  v_perm_b32 v10, v91, v90, v9
  v_accvgpr_write_b32 a93, v10
  s_mov_b32 s90, 0x150000
  buffer_load_dword v88, v1, s[8:11], s90 offen offset:0
  buffer_load_dword v89, v2, s[8:11], s90 offen offset:0
  s_waitcnt vmcnt(56)
  v_perm_b32 v10, v93, v92, v7
  v_perm_b32 v11, v93, v92, v8
  v_accvgpr_write_b32 a54, v10
  v_accvgpr_write_b32 a62, v11
  s_mov_b32 s90, 0x150000
  buffer_load_dword v90, v1, s[12:15], s90 offen offset:0
  buffer_load_dword v91, v2, s[12:15], s90 offen offset:0
  s_waitcnt vmcnt(56)
  v_perm_b32 v10, v95, v94, v7
  v_perm_b32 v11, v95, v94, v8
  v_accvgpr_write_b32 a70, v10
  v_accvgpr_write_b32 a78, v11
  s_mov_b32 s90, 0x150000
  buffer_load_dword v92, v3, s[16:19], s90 offen offset:0
  buffer_load_dword v93, v4, s[16:19], s90 offen offset:0
  s_waitcnt vmcnt(56)
  v_perm_b32 v10, v97, v96, v9
  v_accvgpr_write_b32 a86, v10
  s_mov_b32 s90, 0x150000
  buffer_load_dword v94, v3, s[16:19], s90 offen offset:32
  buffer_load_dword v95, v4, s[16:19], s90 offen offset:32
  s_waitcnt vmcnt(56)
  v_perm_b32 v10, v99, v98, v9
  v_accvgpr_write_b32 a94, v10
  s_mov_b32 s90, 0x144000
  buffer_load_dword v96, v1, s[8:11], s90 offen offset:0
  buffer_load_dword v97, v2, s[8:11], s90 offen offset:0
  s_waitcnt vmcnt(56)
  v_perm_b32 v10, v41, v40, v7
  v_perm_b32 v11, v41, v40, v8
  v_accvgpr_write_b32 a55, v10
  v_accvgpr_write_b32 a63, v11
  s_mov_b32 s90, 0x144000
  buffer_load_dword v98, v1, s[12:15], s90 offen offset:0
  buffer_load_dword v99, v2, s[12:15], s90 offen offset:0
  s_waitcnt vmcnt(56)
  v_perm_b32 v10, v43, v42, v7
  v_perm_b32 v11, v43, v42, v8
  v_accvgpr_write_b32 a71, v10
  v_accvgpr_write_b32 a79, v11
  s_mov_b32 s90, 0x144000
  buffer_load_dword v40, v3, s[16:19], s90 offen offset:0
  buffer_load_dword v41, v4, s[16:19], s90 offen offset:0
  s_waitcnt vmcnt(56)
  v_perm_b32 v10, v45, v44, v9
  v_accvgpr_write_b32 a87, v10
  s_mov_b32 s90, 0x144000
  buffer_load_dword v42, v3, s[16:19], s90 offen offset:32
  buffer_load_dword v43, v4, s[16:19], s90 offen offset:32
  s_waitcnt vmcnt(56)
  v_perm_b32 v10, v47, v46, v9
  v_accvgpr_write_b32 a95, v10
  s_mov_b32 s90, 0x154000
  buffer_load_dword v44, v1, s[8:11], s90 offen offset:0
  buffer_load_dword v45, v2, s[8:11], s90 offen offset:0
  s_waitcnt vmcnt(56)
  v_perm_b32 v10, v49, v48, v7
  v_perm_b32 v11, v49, v48, v8
  v_accvgpr_write_b32 a96, v10
  v_accvgpr_write_b32 a104, v11
  s_mov_b32 s90, 0x154000
  buffer_load_dword v46, v1, s[12:15], s90 offen offset:0
  buffer_load_dword v47, v2, s[12:15], s90 offen offset:0
  s_waitcnt vmcnt(56)
  v_perm_b32 v10, v51, v50, v7
  v_perm_b32 v11, v51, v50, v8
  v_accvgpr_write_b32 a112, v10
  v_accvgpr_write_b32 a120, v11
  s_mov_b32 s90, 0x154000
  buffer_load_dword v48, v3, s[16:19], s90 offen offset:0
  buffer_load_dword v49, v4, s[16:19], s90 offen offset:0
  s_waitcnt vmcnt(56)
  v_perm_b32 v10, v53, v52, v9
  v_accvgpr_write_b32 a128, v10
  s_mov_b32 s90, 0x154000
  buffer_load_dword v50, v3, s[16:19], s90 offen offset:32
  buffer_load_dword v51, v4, s[16:19], s90 offen offset:32
  s_waitcnt vmcnt(56)
  v_perm_b32 v10, v55, v54, v9
  v_accvgpr_write_b32 a136, v10
  s_mov_b32 s90, 0x180000
  buffer_load_dword v52, v1, s[8:11], s90 offen offset:0
  buffer_load_dword v53, v2, s[8:11], s90 offen offset:0
  s_waitcnt vmcnt(56)
  v_perm_b32 v10, v57, v56, v7
  v_perm_b32 v11, v57, v56, v8
  v_accvgpr_write_b32 a97, v10
  v_accvgpr_write_b32 a105, v11
  s_mov_b32 s90, 0x180000
  buffer_load_dword v54, v1, s[12:15], s90 offen offset:0
  buffer_load_dword v55, v2, s[12:15], s90 offen offset:0
  s_waitcnt vmcnt(56)
  v_perm_b32 v10, v59, v58, v7
  v_perm_b32 v11, v59, v58, v8
  v_accvgpr_write_b32 a113, v10
  v_accvgpr_write_b32 a121, v11
  s_mov_b32 s90, 0x180000
  buffer_load_dword v56, v3, s[16:19], s90 offen offset:0
  buffer_load_dword v57, v4, s[16:19], s90 offen offset:0
  s_waitcnt vmcnt(56)
  v_perm_b32 v10, v61, v60, v9
  v_accvgpr_write_b32 a129, v10
  s_mov_b32 s90, 0x180000
  buffer_load_dword v58, v3, s[16:19], s90 offen offset:32
  buffer_load_dword v59, v4, s[16:19], s90 offen offset:32
  s_waitcnt vmcnt(56)
  v_perm_b32 v10, v63, v62, v9
  v_accvgpr_write_b32 a137, v10
  s_mov_b32 s90, 0x190000
  buffer_load_dword v60, v1, s[8:11], s90 offen offset:0
  buffer_load_dword v61, v2, s[8:11], s90 offen offset:0
  s_waitcnt vmcnt(56)
  v_perm_b32 v10, v65, v64, v7
  v_perm_b32 v11, v65, v64, v8
  v_accvgpr_write_b32 a98, v10
  v_accvgpr_write_b32 a106, v11
  s_mov_b32 s90, 0x190000
  buffer_load_dword v62, v1, s[12:15], s90 offen offset:0
  buffer_load_dword v63, v2, s[12:15], s90 offen offset:0
  s_waitcnt vmcnt(56)
  v_perm_b32 v10, v67, v66, v7
  v_perm_b32 v11, v67, v66, v8
  v_accvgpr_write_b32 a114, v10
  v_accvgpr_write_b32 a122, v11
  s_mov_b32 s90, 0x190000
  buffer_load_dword v64, v3, s[16:19], s90 offen offset:0
  buffer_load_dword v65, v4, s[16:19], s90 offen offset:0
  s_waitcnt vmcnt(56)
  v_perm_b32 v10, v69, v68, v9
  v_accvgpr_write_b32 a130, v10
  s_mov_b32 s90, 0x190000
  buffer_load_dword v66, v3, s[16:19], s90 offen offset:32
  buffer_load_dword v67, v4, s[16:19], s90 offen offset:32
  s_waitcnt vmcnt(56)
  v_perm_b32 v10, v71, v70, v9
  v_accvgpr_write_b32 a138, v10
  s_mov_b32 s90, 0x184000
  buffer_load_dword v68, v1, s[8:11], s90 offen offset:0
  buffer_load_dword v69, v2, s[8:11], s90 offen offset:0
  s_waitcnt vmcnt(56)
  v_perm_b32 v10, v73, v72, v7
  v_perm_b32 v11, v73, v72, v8
  v_accvgpr_write_b32 a99, v10
  v_accvgpr_write_b32 a107, v11
  s_mov_b32 s90, 0x184000
  buffer_load_dword v70, v1, s[12:15], s90 offen offset:0
  buffer_load_dword v71, v2, s[12:15], s90 offen offset:0
  s_waitcnt vmcnt(56)
  v_perm_b32 v10, v75, v74, v7
  v_perm_b32 v11, v75, v74, v8
  v_accvgpr_write_b32 a115, v10
  v_accvgpr_write_b32 a123, v11
  s_mov_b32 s90, 0x184000
  buffer_load_dword v72, v3, s[16:19], s90 offen offset:0
  buffer_load_dword v73, v4, s[16:19], s90 offen offset:0
  s_waitcnt vmcnt(56)
  v_perm_b32 v10, v77, v76, v9
  v_accvgpr_write_b32 a131, v10
  s_mov_b32 s90, 0x184000
  buffer_load_dword v74, v3, s[16:19], s90 offen offset:32
  buffer_load_dword v75, v4, s[16:19], s90 offen offset:32
  s_waitcnt vmcnt(56)
  v_perm_b32 v10, v79, v78, v9
  v_accvgpr_write_b32 a139, v10
  s_mov_b32 s90, 0x194000
  buffer_load_dword v76, v1, s[8:11], s90 offen offset:0
  buffer_load_dword v77, v2, s[8:11], s90 offen offset:0
  s_waitcnt vmcnt(56)
  v_perm_b32 v10, v81, v80, v7
  v_perm_b32 v11, v81, v80, v8
  v_accvgpr_write_b32 a100, v10
  v_accvgpr_write_b32 a108, v11
  s_mov_b32 s90, 0x194000
  buffer_load_dword v78, v1, s[12:15], s90 offen offset:0
  buffer_load_dword v79, v2, s[12:15], s90 offen offset:0
  s_waitcnt vmcnt(56)
  v_perm_b32 v10, v83, v82, v7
  v_perm_b32 v11, v83, v82, v8
  v_accvgpr_write_b32 a116, v10
  v_accvgpr_write_b32 a124, v11
  s_mov_b32 s90, 0x194000
  buffer_load_dword v80, v3, s[16:19], s90 offen offset:0
  buffer_load_dword v81, v4, s[16:19], s90 offen offset:0
  s_waitcnt vmcnt(56)
  v_perm_b32 v10, v85, v84, v9
  v_accvgpr_write_b32 a132, v10
  s_mov_b32 s90, 0x194000
  buffer_load_dword v82, v3, s[16:19], s90 offen offset:32
  buffer_load_dword v83, v4, s[16:19], s90 offen offset:32
  s_waitcnt vmcnt(56)
  v_perm_b32 v10, v87, v86, v9
  v_accvgpr_write_b32 a140, v10
  s_mov_b32 s90, 0x1c0000
  buffer_load_dword v84, v1, s[8:11], s90 offen offset:0
  buffer_load_dword v85, v2, s[8:11], s90 offen offset:0
  s_waitcnt vmcnt(56)
  v_perm_b32 v10, v89, v88, v7
  v_perm_b32 v11, v89, v88, v8
  v_accvgpr_write_b32 a101, v10
  v_accvgpr_write_b32 a109, v11
  s_mov_b32 s90, 0x1c0000
  buffer_load_dword v86, v1, s[12:15], s90 offen offset:0
  buffer_load_dword v87, v2, s[12:15], s90 offen offset:0
  s_waitcnt vmcnt(56)
  v_perm_b32 v10, v91, v90, v7
  v_perm_b32 v11, v91, v90, v8
  v_accvgpr_write_b32 a117, v10
  v_accvgpr_write_b32 a125, v11
  s_mov_b32 s90, 0x1c0000
  buffer_load_dword v88, v3, s[16:19], s90 offen offset:0
  buffer_load_dword v89, v4, s[16:19], s90 offen offset:0
  s_waitcnt vmcnt(56)
  v_perm_b32 v10, v93, v92, v9
  v_accvgpr_write_b32 a133, v10
  s_mov_b32 s90, 0x1c0000
  buffer_load_dword v90, v3, s[16:19], s90 offen offset:32
  buffer_load_dword v91, v4, s[16:19], s90 offen offset:32
  s_waitcnt vmcnt(56)
  v_perm_b32 v10, v95, v94, v9
  v_accvgpr_write_b32 a141, v10
  s_mov_b32 s90, 0x1d0000
  buffer_load_dword v92, v1, s[8:11], s90 offen offset:0
  buffer_load_dword v93, v2, s[8:11], s90 offen offset:0
  s_waitcnt vmcnt(56)
  v_perm_b32 v10, v97, v96, v7
  v_perm_b32 v11, v97, v96, v8
  v_accvgpr_write_b32 a102, v10
  v_accvgpr_write_b32 a110, v11
  s_mov_b32 s90, 0x1d0000
  buffer_load_dword v94, v1, s[12:15], s90 offen offset:0
  buffer_load_dword v95, v2, s[12:15], s90 offen offset:0
  s_waitcnt vmcnt(56)
  v_perm_b32 v10, v99, v98, v7
  v_perm_b32 v11, v99, v98, v8
  v_accvgpr_write_b32 a118, v10
  v_accvgpr_write_b32 a126, v11
  s_mov_b32 s90, 0x1d0000
  buffer_load_dword v96, v3, s[16:19], s90 offen offset:0
  buffer_load_dword v97, v4, s[16:19], s90 offen offset:0
  s_waitcnt vmcnt(56)
  v_perm_b32 v10, v41, v40, v9
  v_accvgpr_write_b32 a134, v10
  s_mov_b32 s90, 0x1d0000
  buffer_load_dword v98, v3, s[16:19], s90 offen offset:32
  buffer_load_dword v99, v4, s[16:19], s90 offen offset:32
  s_waitcnt vmcnt(56)
  v_perm_b32 v10, v43, v42, v9
  v_accvgpr_write_b32 a142, v10
  s_mov_b32 s90, 0x1c4000
  buffer_load_dword v40, v1, s[8:11], s90 offen offset:0
  buffer_load_dword v41, v2, s[8:11], s90 offen offset:0
  s_waitcnt vmcnt(56)
  v_perm_b32 v10, v45, v44, v7
  v_perm_b32 v11, v45, v44, v8
  v_accvgpr_write_b32 a103, v10
  v_accvgpr_write_b32 a111, v11
  s_mov_b32 s90, 0x1c4000
  buffer_load_dword v42, v1, s[12:15], s90 offen offset:0
  buffer_load_dword v43, v2, s[12:15], s90 offen offset:0
  s_waitcnt vmcnt(56)
  v_perm_b32 v10, v47, v46, v7
  v_perm_b32 v11, v47, v46, v8
  v_accvgpr_write_b32 a119, v10
  v_accvgpr_write_b32 a127, v11
  s_mov_b32 s90, 0x1c4000
  buffer_load_dword v44, v3, s[16:19], s90 offen offset:0
  buffer_load_dword v45, v4, s[16:19], s90 offen offset:0
  s_waitcnt vmcnt(56)
  v_perm_b32 v10, v49, v48, v9
  v_accvgpr_write_b32 a135, v10
  s_mov_b32 s90, 0x1c4000
  buffer_load_dword v46, v3, s[16:19], s90 offen offset:32
  buffer_load_dword v47, v4, s[16:19], s90 offen offset:32
  s_waitcnt vmcnt(56)
  v_perm_b32 v10, v51, v50, v9
  v_accvgpr_write_b32 a143, v10
  s_mov_b32 s90, 0x1d4000
  buffer_load_dword v48, v1, s[8:11], s90 offen offset:0
  buffer_load_dword v49, v2, s[8:11], s90 offen offset:0
  s_waitcnt vmcnt(56)
  v_perm_b32 v10, v53, v52, v7
  v_perm_b32 v11, v53, v52, v8
  v_accvgpr_write_b32 a144, v10
  v_accvgpr_write_b32 a152, v11
  s_mov_b32 s90, 0x1d4000
  buffer_load_dword v50, v1, s[12:15], s90 offen offset:0
  buffer_load_dword v51, v2, s[12:15], s90 offen offset:0
  s_waitcnt vmcnt(56)
  v_perm_b32 v10, v55, v54, v7
  v_perm_b32 v11, v55, v54, v8
  v_accvgpr_write_b32 a160, v10
  v_accvgpr_write_b32 a168, v11
  s_mov_b32 s90, 0x1d4000
  buffer_load_dword v52, v3, s[16:19], s90 offen offset:0
  buffer_load_dword v53, v4, s[16:19], s90 offen offset:0
  s_waitcnt vmcnt(56)
  v_perm_b32 v10, v57, v56, v9
  v_accvgpr_write_b32 a176, v10
  s_mov_b32 s90, 0x1d4000
  buffer_load_dword v54, v3, s[16:19], s90 offen offset:32
  buffer_load_dword v55, v4, s[16:19], s90 offen offset:32
  s_waitcnt vmcnt(56)
  v_perm_b32 v10, v59, v58, v9
  v_accvgpr_write_b32 a184, v10
  s_mov_b32 s90, 0x0
  buffer_load_dword v56, v5, s[20:23], s90 offen offset:0
  buffer_load_dword v57, v6, s[20:23], s90 offen offset:0
  s_waitcnt vmcnt(56)
  v_perm_b32 v10, v61, v60, v7
  v_perm_b32 v11, v61, v60, v8
  v_accvgpr_write_b32 a145, v10
  v_accvgpr_write_b32 a153, v11
  s_mov_b32 s90, 0x800
  buffer_load_dword v58, v5, s[20:23], s90 offen offset:0
  buffer_load_dword v59, v6, s[20:23], s90 offen offset:0
  s_waitcnt vmcnt(56)
  v_perm_b32 v10, v63, v62, v7
  v_perm_b32 v11, v63, v62, v8
  v_accvgpr_write_b32 a161, v10
  v_accvgpr_write_b32 a169, v11
  s_mov_b32 s90, 0x10000
  buffer_load_dword v60, v5, s[20:23], s90 offen offset:0
  buffer_load_dword v61, v6, s[20:23], s90 offen offset:0
  s_waitcnt vmcnt(56)
  v_perm_b32 v10, v65, v64, v9
  v_accvgpr_write_b32 a177, v10
  s_mov_b32 s90, 0x10800
  buffer_load_dword v62, v5, s[20:23], s90 offen offset:0
  buffer_load_dword v63, v6, s[20:23], s90 offen offset:0
  s_waitcnt vmcnt(56)
  v_perm_b32 v10, v67, v66, v9
  v_accvgpr_write_b32 a185, v10
  s_mov_b32 s90, 0x2000
  buffer_load_dword v64, v5, s[20:23], s90 offen offset:0
  buffer_load_dword v65, v6, s[20:23], s90 offen offset:0
  s_waitcnt vmcnt(56)
  v_perm_b32 v10, v69, v68, v7
  v_perm_b32 v11, v69, v68, v8
  v_accvgpr_write_b32 a146, v10
  v_accvgpr_write_b32 a154, v11
  s_mov_b32 s90, 0x2800
  buffer_load_dword v66, v5, s[20:23], s90 offen offset:0
  buffer_load_dword v67, v6, s[20:23], s90 offen offset:0
  s_waitcnt vmcnt(56)
  v_perm_b32 v10, v71, v70, v7
  v_perm_b32 v11, v71, v70, v8
  v_accvgpr_write_b32 a162, v10
  v_accvgpr_write_b32 a170, v11
  s_mov_b32 s90, 0x12000
  buffer_load_dword v68, v5, s[20:23], s90 offen offset:0
  buffer_load_dword v69, v6, s[20:23], s90 offen offset:0
  s_waitcnt vmcnt(56)
  v_perm_b32 v10, v73, v72, v9
  v_accvgpr_write_b32 a178, v10
  s_mov_b32 s90, 0x12800
  buffer_load_dword v70, v5, s[20:23], s90 offen offset:0
  buffer_load_dword v71, v6, s[20:23], s90 offen offset:0
  s_waitcnt vmcnt(56)
  v_perm_b32 v10, v75, v74, v9
  v_accvgpr_write_b32 a186, v10
  s_mov_b32 s90, 0x4000
  buffer_load_dword v72, v5, s[20:23], s90 offen offset:0
  buffer_load_dword v73, v6, s[20:23], s90 offen offset:0
  s_waitcnt vmcnt(56)
  v_perm_b32 v10, v77, v76, v7
  v_perm_b32 v11, v77, v76, v8
  v_accvgpr_write_b32 a147, v10
  v_accvgpr_write_b32 a155, v11
  s_mov_b32 s90, 0x4800
  buffer_load_dword v74, v5, s[20:23], s90 offen offset:0
  buffer_load_dword v75, v6, s[20:23], s90 offen offset:0
  s_waitcnt vmcnt(56)
  v_perm_b32 v10, v79, v78, v7
  v_perm_b32 v11, v79, v78, v8
  v_accvgpr_write_b32 a163, v10
  v_accvgpr_write_b32 a171, v11
  s_mov_b32 s90, 0x14000
  buffer_load_dword v76, v5, s[20:23], s90 offen offset:0
  buffer_load_dword v77, v6, s[20:23], s90 offen offset:0
  s_waitcnt vmcnt(56)
  v_perm_b32 v10, v81, v80, v9
  v_accvgpr_write_b32 a179, v10
  s_mov_b32 s90, 0x14800
  buffer_load_dword v78, v5, s[20:23], s90 offen offset:0
  buffer_load_dword v79, v6, s[20:23], s90 offen offset:0
  s_waitcnt vmcnt(56)
  v_perm_b32 v10, v83, v82, v9
  v_accvgpr_write_b32 a187, v10
  s_mov_b32 s90, 0x6000
  buffer_load_dword v80, v5, s[20:23], s90 offen offset:0
  buffer_load_dword v81, v6, s[20:23], s90 offen offset:0
  s_waitcnt vmcnt(56)
  v_perm_b32 v10, v85, v84, v7
  v_perm_b32 v11, v85, v84, v8
  v_accvgpr_write_b32 a148, v10
  v_accvgpr_write_b32 a156, v11
  s_mov_b32 s90, 0x6800
  buffer_load_dword v82, v5, s[20:23], s90 offen offset:0
  buffer_load_dword v83, v6, s[20:23], s90 offen offset:0
  s_waitcnt vmcnt(56)
  v_perm_b32 v10, v87, v86, v7
  v_perm_b32 v11, v87, v86, v8
  v_accvgpr_write_b32 a164, v10
  v_accvgpr_write_b32 a172, v11
  s_mov_b32 s90, 0x16000
  buffer_load_dword v84, v5, s[20:23], s90 offen offset:0
  buffer_load_dword v85, v6, s[20:23], s90 offen offset:0
  s_waitcnt vmcnt(56)
  v_perm_b32 v10, v89, v88, v9
  v_accvgpr_write_b32 a180, v10
  s_mov_b32 s90, 0x16800
  buffer_load_dword v86, v5, s[20:23], s90 offen offset:0
  buffer_load_dword v87, v6, s[20:23], s90 offen offset:0
  s_waitcnt vmcnt(56)
  v_perm_b32 v10, v91, v90, v9
  v_accvgpr_write_b32 a188, v10
  s_mov_b32 s90, 0x40000
  buffer_load_dword v88, v5, s[20:23], s90 offen offset:0
  buffer_load_dword v89, v6, s[20:23], s90 offen offset:0
  s_waitcnt vmcnt(56)
  v_perm_b32 v10, v93, v92, v7
  v_perm_b32 v11, v93, v92, v8
  v_accvgpr_write_b32 a149, v10
  v_accvgpr_write_b32 a157, v11
  s_mov_b32 s90, 0x40800
  buffer_load_dword v90, v5, s[20:23], s90 offen offset:0
  buffer_load_dword v91, v6, s[20:23], s90 offen offset:0
  s_waitcnt vmcnt(56)
  v_perm_b32 v10, v95, v94, v7
  v_perm_b32 v11, v95, v94, v8
  v_accvgpr_write_b32 a165, v10
  v_accvgpr_write_b32 a173, v11
  s_mov_b32 s90, 0x50000
  buffer_load_dword v92, v5, s[20:23], s90 offen offset:0
  buffer_load_dword v93, v6, s[20:23], s90 offen offset:0
  s_waitcnt vmcnt(56)
  v_perm_b32 v10, v97, v96, v9
  v_accvgpr_write_b32 a181, v10
  s_mov_b32 s90, 0x50800
  buffer_load_dword v94, v5, s[20:23], s90 offen offset:0
  buffer_load_dword v95, v6, s[20:23], s90 offen offset:0
  s_waitcnt vmcnt(56)
  v_perm_b32 v10, v99, v98, v9
  v_accvgpr_write_b32 a189, v10
  s_mov_b32 s90, 0x42000
  buffer_load_dword v96, v5, s[20:23], s90 offen offset:0
  buffer_load_dword v97, v6, s[20:23], s90 offen offset:0
  s_waitcnt vmcnt(56)
  v_perm_b32 v10, v41, v40, v7
  v_perm_b32 v11, v41, v40, v8
  v_accvgpr_write_b32 a150, v10
  v_accvgpr_write_b32 a158, v11
  s_mov_b32 s90, 0x42800
  buffer_load_dword v98, v5, s[20:23], s90 offen offset:0
  buffer_load_dword v99, v6, s[20:23], s90 offen offset:0
  s_waitcnt vmcnt(56)
  v_perm_b32 v10, v43, v42, v7
  v_perm_b32 v11, v43, v42, v8
  v_accvgpr_write_b32 a166, v10
  v_accvgpr_write_b32 a174, v11
  s_mov_b32 s90, 0x52000
  buffer_load_dword v40, v5, s[20:23], s90 offen offset:0
  buffer_load_dword v41, v6, s[20:23], s90 offen offset:0
  s_waitcnt vmcnt(56)
  v_perm_b32 v10, v45, v44, v9
  v_accvgpr_write_b32 a182, v10
  s_mov_b32 s90, 0x52800
  buffer_load_dword v42, v5, s[20:23], s90 offen offset:0
  buffer_load_dword v43, v6, s[20:23], s90 offen offset:0
  s_waitcnt vmcnt(56)
  v_perm_b32 v10, v47, v46, v9
  v_accvgpr_write_b32 a190, v10
  s_mov_b32 s90, 0x44000
  buffer_load_dword v44, v5, s[20:23], s90 offen offset:0
  buffer_load_dword v45, v6, s[20:23], s90 offen offset:0
  s_waitcnt vmcnt(56)
  v_perm_b32 v10, v49, v48, v7
  v_perm_b32 v11, v49, v48, v8
  v_accvgpr_write_b32 a151, v10
  v_accvgpr_write_b32 a159, v11
  s_mov_b32 s90, 0x44800
  buffer_load_dword v46, v5, s[20:23], s90 offen offset:0
  buffer_load_dword v47, v6, s[20:23], s90 offen offset:0
  s_waitcnt vmcnt(56)
  v_perm_b32 v10, v51, v50, v7
  v_perm_b32 v11, v51, v50, v8
  v_accvgpr_write_b32 a167, v10
  v_accvgpr_write_b32 a175, v11
  s_mov_b32 s90, 0x54000
  buffer_load_dword v48, v5, s[20:23], s90 offen offset:0
  buffer_load_dword v49, v6, s[20:23], s90 offen offset:0
  s_waitcnt vmcnt(56)
  v_perm_b32 v10, v53, v52, v9
  v_accvgpr_write_b32 a183, v10
  s_mov_b32 s90, 0x54800
  buffer_load_dword v50, v5, s[20:23], s90 offen offset:0
  buffer_load_dword v51, v6, s[20:23], s90 offen offset:0
  s_waitcnt vmcnt(56)
  v_perm_b32 v10, v55, v54, v9
  v_accvgpr_write_b32 a191, v10
  s_mov_b32 s90, 0x46000
  buffer_load_dword v52, v5, s[20:23], s90 offen offset:0
  buffer_load_dword v53, v6, s[20:23], s90 offen offset:0
  s_waitcnt vmcnt(56)
  v_perm_b32 v10, v57, v56, v9
  v_accvgpr_write_b32 a192, v10
  s_mov_b32 s90, 0x46800
  buffer_load_dword v54, v5, s[20:23], s90 offen offset:0
  buffer_load_dword v55, v6, s[20:23], s90 offen offset:0
  s_waitcnt vmcnt(56)
  v_perm_b32 v10, v59, v58, v9
  v_accvgpr_write_b32 a193, v10
  s_mov_b32 s90, 0x56000
  buffer_load_dword v56, v5, s[20:23], s90 offen offset:0
  buffer_load_dword v57, v6, s[20:23], s90 offen offset:0
  s_waitcnt vmcnt(56)
  v_perm_b32 v10, v61, v60, v9
  v_accvgpr_write_b32 a194, v10
  s_mov_b32 s90, 0x56800
  buffer_load_dword v58, v5, s[20:23], s90 offen offset:0
  buffer_load_dword v59, v6, s[20:23], s90 offen offset:0
  s_waitcnt vmcnt(56)
  v_perm_b32 v10, v63, v62, v9
  v_accvgpr_write_b32 a195, v10
  s_mov_b32 s90, 0x80000
  buffer_load_dword v60, v5, s[20:23], s90 offen offset:0
  buffer_load_dword v61, v6, s[20:23], s90 offen offset:0
  s_waitcnt vmcnt(56)
  v_perm_b32 v10, v65, v64, v9
  v_accvgpr_write_b32 a196, v10
  s_mov_b32 s90, 0x80800
  buffer_load_dword v62, v5, s[20:23], s90 offen offset:0
  buffer_load_dword v63, v6, s[20:23], s90 offen offset:0
  s_waitcnt vmcnt(56)
  v_perm_b32 v10, v67, v66, v9
  v_accvgpr_write_b32 a197, v10
  s_mov_b32 s90, 0x90000
  buffer_load_dword v64, v5, s[20:23], s90 offen offset:0
  buffer_load_dword v65, v6, s[20:23], s90 offen offset:0
  s_waitcnt vmcnt(56)
  v_perm_b32 v10, v69, v68, v9
  v_accvgpr_write_b32 a198, v10
  s_mov_b32 s90, 0x90800
  buffer_load_dword v66, v5, s[20:23], s90 offen offset:0
  buffer_load_dword v67, v6, s[20:23], s90 offen offset:0
  s_waitcnt vmcnt(56)
  v_perm_b32 v10, v71, v70, v9
  v_accvgpr_write_b32 a199, v10
  s_mov_b32 s90, 0x82000
  buffer_load_dword v68, v5, s[20:23], s90 offen offset:0
  buffer_load_dword v69, v6, s[20:23], s90 offen offset:0
  s_waitcnt vmcnt(56)
  v_perm_b32 v10, v73, v72, v9
  v_accvgpr_write_b32 a200, v10
  s_mov_b32 s90, 0x82800
  buffer_load_dword v70, v5, s[20:23], s90 offen offset:0
  buffer_load_dword v71, v6, s[20:23], s90 offen offset:0
  s_waitcnt vmcnt(56)
  v_perm_b32 v10, v75, v74, v9
  v_accvgpr_write_b32 a201, v10
  s_mov_b32 s90, 0x92000
  buffer_load_dword v72, v5, s[20:23], s90 offen offset:0
  buffer_load_dword v73, v6, s[20:23], s90 offen offset:0
  s_waitcnt vmcnt(56)
  v_perm_b32 v10, v77, v76, v9
  v_accvgpr_write_b32 a202, v10
  s_mov_b32 s90, 0x92800
  buffer_load_dword v74, v5, s[20:23], s90 offen offset:0
  buffer_load_dword v75, v6, s[20:23], s90 offen offset:0
  s_waitcnt vmcnt(56)
  v_perm_b32 v10, v79, v78, v9
  v_accvgpr_write_b32 a203, v10
  s_mov_b32 s90, 0x84000
  buffer_load_dword v76, v5, s[20:23], s90 offen offset:0
  buffer_load_dword v77, v6, s[20:23], s90 offen offset:0
  s_waitcnt vmcnt(56)
  v_perm_b32 v10, v81, v80, v9
  v_accvgpr_write_b32 a204, v10
  s_mov_b32 s90, 0x84800
  buffer_load_dword v78, v5, s[20:23], s90 offen offset:0
  buffer_load_dword v79, v6, s[20:23], s90 offen offset:0
  s_waitcnt vmcnt(56)
  v_perm_b32 v10, v83, v82, v9
  v_accvgpr_write_b32 a205, v10
  s_mov_b32 s90, 0x94000
  buffer_load_dword v80, v5, s[20:23], s90 offen offset:0
  buffer_load_dword v81, v6, s[20:23], s90 offen offset:0
  s_waitcnt vmcnt(56)
  v_perm_b32 v10, v85, v84, v9
  v_accvgpr_write_b32 a206, v10
  s_mov_b32 s90, 0x94800
  buffer_load_dword v82, v5, s[20:23], s90 offen offset:0
  buffer_load_dword v83, v6, s[20:23], s90 offen offset:0
  s_waitcnt vmcnt(56)
  v_perm_b32 v10, v87, v86, v9
  v_accvgpr_write_b32 a207, v10
  s_mov_b32 s90, 0x86000
  buffer_load_dword v84, v5, s[20:23], s90 offen offset:0
  buffer_load_dword v85, v6, s[20:23], s90 offen offset:0
  s_waitcnt vmcnt(56)
  v_perm_b32 v10, v89, v88, v9
  v_accvgpr_write_b32 a208, v10
  s_mov_b32 s90, 0x86800
  buffer_load_dword v86, v5, s[20:23], s90 offen offset:0
  buffer_load_dword v87, v6, s[20:23], s90 offen offset:0
  s_waitcnt vmcnt(56)
  v_perm_b32 v10, v91, v90, v9
  v_accvgpr_write_b32 a209, v10
  s_mov_b32 s90, 0x96000
  buffer_load_dword v88, v5, s[20:23], s90 offen offset:0
  buffer_load_dword v89, v6, s[20:23], s90 offen offset:0
  s_waitcnt vmcnt(56)
  v_perm_b32 v10, v93, v92, v9
  v_accvgpr_write_b32 a210, v10
  s_mov_b32 s90, 0x96800
  buffer_load_dword v90, v5, s[20:23], s90 offen offset:0
  buffer_load_dword v91, v6, s[20:23], s90 offen offset:0
  s_waitcnt vmcnt(56)
  v_perm_b32 v10, v95, v94, v9
  v_accvgpr_write_b32 a211, v10
  s_mov_b32 s90, 0xc0000
  buffer_load_dword v92, v5, s[20:23], s90 offen offset:0
  buffer_load_dword v93, v6, s[20:23], s90 offen offset:0
  s_waitcnt vmcnt(56)
  v_perm_b32 v10, v97, v96, v9
  v_accvgpr_write_b32 a212, v10
  s_mov_b32 s90, 0xc0800
  buffer_load_dword v94, v5, s[20:23], s90 offen offset:0
  buffer_load_dword v95, v6, s[20:23], s90 offen offset:0
  s_waitcnt vmcnt(56)
  v_perm_b32 v10, v99, v98, v9
  v_accvgpr_write_b32 a213, v10
  s_mov_b32 s90, 0xd0000
  buffer_load_dword v96, v5, s[20:23], s90 offen offset:0
  buffer_load_dword v97, v6, s[20:23], s90 offen offset:0
  s_waitcnt vmcnt(56)
  v_perm_b32 v10, v41, v40, v9
  v_accvgpr_write_b32 a214, v10
  s_mov_b32 s90, 0xd0800
  buffer_load_dword v98, v5, s[20:23], s90 offen offset:0
  buffer_load_dword v99, v6, s[20:23], s90 offen offset:0
  s_waitcnt vmcnt(56)
  v_perm_b32 v10, v43, v42, v9
  v_accvgpr_write_b32 a215, v10
  s_mov_b32 s90, 0xc2000
  buffer_load_dword v40, v5, s[20:23], s90 offen offset:0
  buffer_load_dword v41, v6, s[20:23], s90 offen offset:0
  s_waitcnt vmcnt(56)
  v_perm_b32 v10, v45, v44, v9
  v_accvgpr_write_b32 a216, v10
  s_mov_b32 s90, 0xc2800
  buffer_load_dword v42, v5, s[20:23], s90 offen offset:0
  buffer_load_dword v43, v6, s[20:23], s90 offen offset:0
  s_waitcnt vmcnt(56)
  v_perm_b32 v10, v47, v46, v9
  v_accvgpr_write_b32 a217, v10
  s_mov_b32 s90, 0xd2000
  buffer_load_dword v44, v5, s[20:23], s90 offen offset:0
  buffer_load_dword v45, v6, s[20:23], s90 offen offset:0
  s_waitcnt vmcnt(56)
  v_perm_b32 v10, v49, v48, v9
  v_accvgpr_write_b32 a218, v10
  s_mov_b32 s90, 0xd2800
  buffer_load_dword v46, v5, s[20:23], s90 offen offset:0
  buffer_load_dword v47, v6, s[20:23], s90 offen offset:0
  s_waitcnt vmcnt(56)
  v_perm_b32 v10, v51, v50, v9
  v_accvgpr_write_b32 a219, v10
  s_mov_b32 s90, 0xc4000
  buffer_load_dword v48, v5, s[20:23], s90 offen offset:0
  buffer_load_dword v49, v6, s[20:23], s90 offen offset:0
  s_waitcnt vmcnt(56)
  v_perm_b32 v10, v53, v52, v9
  v_accvgpr_write_b32 a220, v10
  s_mov_b32 s90, 0xc4800
  buffer_load_dword v50, v5, s[20:23], s90 offen offset:0
  buffer_load_dword v51, v6, s[20:23], s90 offen offset:0
  s_waitcnt vmcnt(56)
  v_perm_b32 v10, v55, v54, v9
  v_accvgpr_write_b32 a221, v10
  s_mov_b32 s90, 0xd4000
  buffer_load_dword v52, v5, s[20:23], s90 offen offset:0
  buffer_load_dword v53, v6, s[20:23], s90 offen offset:0
  s_waitcnt vmcnt(56)
  v_perm_b32 v10, v57, v56, v9
  v_accvgpr_write_b32 a222, v10
  s_mov_b32 s90, 0xd4800
  buffer_load_dword v54, v5, s[20:23], s90 offen offset:0
  buffer_load_dword v55, v6, s[20:23], s90 offen offset:0
  s_waitcnt vmcnt(56)
  v_perm_b32 v10, v59, v58, v9
  v_accvgpr_write_b32 a223, v10
  s_mov_b32 s90, 0xc6000
  buffer_load_dword v56, v5, s[20:23], s90 offen offset:0
  buffer_load_dword v57, v6, s[20:23], s90 offen offset:0
  s_waitcnt vmcnt(56)
  v_perm_b32 v10, v61, v60, v9
  v_accvgpr_write_b32 a224, v10
  s_mov_b32 s90, 0xc6800
  buffer_load_dword v58, v5, s[20:23], s90 offen offset:0
  buffer_load_dword v59, v6, s[20:23], s90 offen offset:0
  s_waitcnt vmcnt(56)
  v_perm_b32 v10, v63, v62, v9
  v_accvgpr_write_b32 a225, v10
  s_mov_b32 s90, 0xd6000
  buffer_load_dword v60, v5, s[20:23], s90 offen offset:0
  buffer_load_dword v61, v6, s[20:23], s90 offen offset:0
  s_waitcnt vmcnt(56)
  v_perm_b32 v10, v65, v64, v9
  v_accvgpr_write_b32 a226, v10
  s_mov_b32 s90, 0xd6800
  buffer_load_dword v62, v5, s[20:23], s90 offen offset:0
  buffer_load_dword v63, v6, s[20:23], s90 offen offset:0
  s_waitcnt vmcnt(56)
  v_perm_b32 v10, v67, v66, v9
  v_accvgpr_write_b32 a227, v10
  s_waitcnt vmcnt(54)
  v_perm_b32 v10, v69, v68, v9
  v_accvgpr_write_b32 a228, v10
  s_waitcnt vmcnt(52)
  v_perm_b32 v10, v71, v70, v9
  v_accvgpr_write_b32 a229, v10
  s_waitcnt vmcnt(50)
  v_perm_b32 v10, v73, v72, v9
  v_accvgpr_write_b32 a230, v10
  s_waitcnt vmcnt(48)
  v_perm_b32 v10, v75, v74, v9
  v_accvgpr_write_b32 a231, v10
  s_waitcnt vmcnt(46)
  v_perm_b32 v10, v77, v76, v9
  v_accvgpr_write_b32 a232, v10
  s_waitcnt vmcnt(44)
  v_perm_b32 v10, v79, v78, v9
  v_accvgpr_write_b32 a233, v10
  s_waitcnt vmcnt(42)
  v_perm_b32 v10, v81, v80, v9
  v_accvgpr_write_b32 a234, v10
  s_waitcnt vmcnt(40)
  v_perm_b32 v10, v83, v82, v9
  v_accvgpr_write_b32 a235, v10
  s_waitcnt vmcnt(38)
  v_perm_b32 v10, v85, v84, v9
  v_accvgpr_write_b32 a236, v10
  s_waitcnt vmcnt(36)
  v_perm_b32 v10, v87, v86, v9
  v_accvgpr_write_b32 a237, v10
  s_waitcnt vmcnt(34)
  v_perm_b32 v10, v89, v88, v9
  v_accvgpr_write_b32 a238, v10
  s_waitcnt vmcnt(32)
  v_perm_b32 v10, v91, v90, v9
  v_accvgpr_write_b32 a239, v10
  s_waitcnt vmcnt(30)
  v_perm_b32 v10, v93, v92, v9
  v_accvgpr_write_b32 a240, v10
  s_waitcnt vmcnt(28)
  v_perm_b32 v10, v95, v94, v9
  v_accvgpr_write_b32 a241, v10
  s_waitcnt vmcnt(26)
  v_perm_b32 v10, v97, v96, v9
  v_accvgpr_write_b32 a242, v10
  s_waitcnt vmcnt(24)
  v_perm_b32 v10, v99, v98, v9
  v_accvgpr_write_b32 a243, v10
  s_waitcnt vmcnt(22)
  v_perm_b32 v10, v41, v40, v9
  v_accvgpr_write_b32 a244, v10
  s_waitcnt vmcnt(20)
  v_perm_b32 v10, v43, v42, v9
  v_accvgpr_write_b32 a245, v10
  s_waitcnt vmcnt(18)
  v_perm_b32 v10, v45, v44, v9
  v_accvgpr_write_b32 a246, v10
  s_waitcnt vmcnt(16)
  v_perm_b32 v10, v47, v46, v9
  v_accvgpr_write_b32 a247, v10
  s_waitcnt vmcnt(14)
  v_perm_b32 v10, v49, v48, v9
  v_accvgpr_write_b32 a248, v10
  s_waitcnt vmcnt(12)
  v_perm_b32 v10, v51, v50, v9
  v_accvgpr_write_b32 a249, v10
  s_waitcnt vmcnt(10)
  v_perm_b32 v10, v53, v52, v9
  v_accvgpr_write_b32 a250, v10
  s_waitcnt vmcnt(8)
  v_perm_b32 v10, v55, v54, v9
  v_accvgpr_write_b32 a251, v10
  s_waitcnt vmcnt(6)
  v_perm_b32 v10, v57, v56, v9
  v_accvgpr_write_b32 a252, v10
  s_waitcnt vmcnt(4)
  v_perm_b32 v10, v59, v58, v9
  v_accvgpr_write_b32 a253, v10
  s_waitcnt vmcnt(2)
  v_perm_b32 v10, v61, v60, v9
  v_accvgpr_write_b32 a254, v10
  s_waitcnt vmcnt(0)
  v_perm_b32 v10, v63, v62, v9
  v_accvgpr_write_b32 a255, v10
  s_lshl_b32 s90, s34, 2
  s_add_u32 s90, s90, s32
  s_lshl_b32 s91, s34, 14
  s_lshl_b32 s92, s32, 11
  s_add_u32 s91, s91, s92
  v_mov_b32 v1, 0x0
  v_bfe_u32 v31, v0, 0, 3
  v_lshl_add_u32 v1, v31, 4, v1
  v_bfe_u32 v31, v0, 4, 1
  v_lshl_add_u32 v1, v31, 7, v1
  v_bfe_u32 v31, v0, 3, 1
  v_lshl_add_u32 v1, v31, 8, v1
  v_bfe_u32 v31, v0, 5, 1
  v_lshl_add_u32 v1, v31, 9, v1
  v_add_u32 v1, s91, v1
  s_lshl_b32 s91, s33, 14
  s_lshr_b32 s92, s90, 1
  s_lshl_b32 s92, s92, 8
  s_add_u32 s91, s91, s92
  s_and_b32 s92, s90, 1
  s_lshl_b32 s92, s92, 5
  s_add_u32 s91, s91, s92
  v_mov_b32 v2, 0x200000
  v_bfe_u32 v31, v0, 0, 2
  v_lshl_add_u32 v2, v31, 2, v2
  v_bfe_u32 v31, v0, 2, 1
  v_lshl_add_u32 v2, v31, 6, v2
  v_bfe_u32 v31, v0, 4, 1
  v_lshl_add_u32 v2, v31, 7, v2
  v_bfe_u32 v31, v0, 5, 1
  v_lshl_add_u32 v2, v31, 4, v2
  v_bfe_u32 v31, v0, 3, 1
  v_lshl_add_u32 v2, v31, 31, v2
  v_add_u32 v2, s91, v2
  s_lshl_b32 s92, s90, 4
  v_mov_b32 v30, 0x0
  v_bfe_u32 v31, v0, 0, 2
  v_lshl_add_u32 v30, v31, 2, v30
  v_bfe_u32 v31, v0, 2, 1
  v_lshl_add_u32 v30, v31, 12, v30
  v_bfe_u32 v31, v0, 4, 1
  v_lshl_add_u32 v30, v31, 13, v30
  v_bfe_u32 v31, v0, 5, 1
  v_lshl_add_u32 v30, v31, 11, v30
  v_add_u32 v30, s92, v30
  buffer_load_dword v32, v30, s[24:27], 0 offen
  s_lshl_b32 s91, s33, 14
  s_lshl_b32 s92, s32, 12
  s_add_u32 s91, s91, s92
  v_mov_b32 v3, 0x200000
  v_bfe_u32 v31, v0, 0, 6
  v_lshl_add_u32 v3, v31, 4, v3
  v_add_u32 v3, s91, v3
  s_mul_i32 s91, s32, 3072
  v_mov_b32 v4, 0x0
  v_bfe_u32 v31, v0, 0, 6
  v_lshl_add_u32 v4, v31, 4, v4
  v_add_u32 v4, s91, v4
  v_lshrrev_b32 v31, 5, v0
  v_lshlrev_b32 v31, 7, v31
  v_xor_b32 v5, v4, v31
  v_add_u32 v5, 2048, v5
  s_lshl_b32 s93, s37, 13
  s_cmp_eq_u32 s32, 2
  s_cbranch_scc1 L_av_2
  s_lshl_b32 s91, s32, 10
  v_mov_b32 v6, 0x0
  v_bfe_u32 v31, v0, 0, 1
  v_lshl_add_u32 v6, v31, 4, v6
  v_bfe_u32 v31, v0, 2, 2
  v_lshl_add_u32 v6, v31, 5, v6
  v_bfe_u32 v31, v0, 1, 1
  v_lshl_add_u32 v6, v31, 7, v6
  v_bfe_u32 v31, v0, 4, 2
  v_lshl_add_u32 v6, v31, 8, v6
  v_add_u32 v6, s91, v6
  s_lshl_b32 s91, s38, 10
  s_add_u32 s91, s91, s93
  s_lshl_b32 s92, s32, 5
  s_add_u32 s91, s91, s92
  v_mov_b32 v7, 0x210000
  v_bfe_u32 v31, v0, 0, 2
  v_lshl_add_u32 v7, v31, 2, v7
  v_bfe_u32 v31, v0, 2, 2
  v_lshl_add_u32 v7, v31, 8, v7
  v_bfe_u32 v31, v0, 4, 2
  v_lshl_add_u32 v7, v31, 6, v7
  v_add_u32 v7, s91, v7
  v_add_u32 v8, 16, v7
  s_lshl_b32 s91, s37, 11
  s_lshl_b32 s92, s38, 9
  s_add_u32 s91, s91, s92
  v_mov_b32 v18, 0x3000000
  v_bfe_u32 v31, v0, 0, 2
  v_lshl_add_u32 v18, v31, 2, v18
  v_bfe_u32 v31, v0, 2, 2
  v_lshl_add_u32 v18, v31, 7, v18
  v_bfe_u32 v31, v0, 4, 2
  v_lshl_add_u32 v18, v31, 5, v18
  v_add_u32 v18, s91, v18
  v_add_u32 v19, 16, v18
  s_branch L_ad_3
L_av_2:
  v_mov_b32 v6, 0x800
  v_bfe_u32 v31, v0, 1, 4
  v_lshl_add_u32 v6, v31, 4, v6
  v_bfe_u32 v31, v0, 5, 1
  v_lshl_add_u32 v6, v31, 8, v6
  v_bfe_u32 v31, v0, 0, 1
  v_lshl_add_u32 v6, v31, 9, v6
  v_and_b32 v31, 1, v0
  v_lshlrev_b32 v31, 7, v31
  v_xor_b32 v6, v6, v31
  s_lshr_b32 s91, s38, 1
  s_lshl_b32 s91, s91, 10
  s_add_u32 s91, s91, s93
  s_and_b32 s92, s38, 1
  s_lshl_b32 s92, s92, 8
  s_add_u32 s91, s91, s92
  v_mov_b32 v7, 0x211000
  v_bfe_u32 v31, v0, 0, 1
  v_lshl_add_u32 v7, v31, 3, v7
  v_bfe_u32 v31, v0, 1, 4
  v_lshl_add_u32 v7, v31, 4, v7
  v_bfe_u32 v31, v0, 5, 1
  v_lshl_add_u32 v7, v31, 9, v7
  v_add_u32 v7, s91, v7
  v_mov_b32 v8, v7
  s_lshl_b32 s91, s37, 11
  s_lshl_b32 s92, s38, 9
  s_add_u32 s91, s91, s92
  v_mov_b32 v18, 0x3400000
  v_bfe_u32 v31, v0, 1, 4
  v_lshl_add_u32 v18, v31, 4, v18
  v_bfe_u32 v31, v0, 5, 1
  v_lshl_add_u32 v18, v31, 2, v18
  v_bfe_u32 v31, v0, 0, 1
  v_lshl_add_u32 v18, v31, 3, v18
  v_add_u32 v18, s91, v18
  v_add_u32 v19, 256, v18
L_ad_3:
  s_lshl_b32 s94, s35, 2
  s_add_u32 s94, s94, s32
  s_lshl_b32 s94, s94, 13
  v_mov_b32 v9, 0x210000
  v_bfe_u32 v31, v0, 0, 6
  v_lshl_add_u32 v9, v31, 4, v9
  v_add_u32 v9, s94, v9
  v_add_u32 v10, 4096, v9
  v_mov_b32 v11, 0x1000000
  v_bfe_u32 v31, v0, 0, 2
  v_lshl_add_u32 v11, v31, 4, v11
  v_bfe_u32 v31, v0, 2, 1
  v_lshl_add_u32 v11, v31, 7, v11
  v_bfe_u32 v31, v0, 3, 1
  v_lshl_add_u32 v11, v31, 12, v11
  v_bfe_u32 v31, v0, 4, 2
  v_lshl_add_u32 v11, v31, 8, v11
  v_add_u32 v11, s94, v11
  v_mov_b32 v12, 0x2000000
  v_bfe_u32 v31, v0, 0, 6
  v_lshl_add_u32 v12, v31, 4, v12
  v_add_u32 v12, s94, v12
  v_add_u32 v13, 4096, v12
  s_lshl_b32 s91, s32, 11
  v_mov_b32 v30, 0x0
  v_bfe_u32 v31, v0, 2, 1
  v_lshl_add_u32 v30, v31, 6, v30
  v_bfe_u32 v31, v0, 0, 1
  v_lshl_add_u32 v30, v31, 5, v30
  v_bfe_u32 v31, v0, 1, 1
  v_lshl_add_u32 v30, v31, 4, v30
  v_mov_b32 v29, 0x0
  v_bfe_u32 v31, v0, 4, 2
  v_lshl_add_u32 v29, v31, 5, v29
  v_xor_b32 v30, v30, v29
  v_mov_b32 v14, 0x3000
  v_bfe_u32 v31, v0, 0, 4
  v_lshl_add_u32 v14, v31, 7, v14
  v_add_u32 v14, s91, v14
  v_add_u32 v14, v14, v30
  v_xor_b32 v15, 16, v14
  v_mov_b32 v30, 0x0
  v_bfe_u32 v31, v0, 5, 1
  v_lshl_add_u32 v30, v31, 6, v30
  v_bfe_u32 v31, v0, 1, 1
  v_lshl_add_u32 v30, v31, 5, v30
  v_bfe_u32 v31, v0, 4, 1
  v_lshl_add_u32 v30, v31, 4, v30
  v_mov_b32 v29, 0x0
  v_bfe_u32 v31, v0, 2, 2
  v_lshl_add_u32 v29, v31, 5, v29
  v_bfe_u32 v31, v0, 0, 1
  v_lshl_add_u32 v29, v31, 4, v29
  v_xor_b32 v30, v30, v29
  v_mov_b32 v16, 0x3000
  v_bfe_u32 v31, v0, 4, 2
  v_lshl_add_u32 v16, v31, 8, v16
  v_bfe_u32 v31, v0, 1, 1
  v_lshl_add_u32 v16, v31, 7, v16
  v_add_u32 v16, v16, v30
  s_lshl_b32 s91, s36, 15
  s_lshr_b32 s92, s32, 1
  s_lshl_b32 s92, s92, 14
  s_add_u32 s91, s91, s92
  s_and_b32 s92, s32, 1
  s_lshl_b32 s92, s92, 12
  s_add_u32 s91, s91, s92
  s_lshl_b32 s92, s35, 8
  s_add_u32 s91, s91, s92
  v_mov_b32 v17, 0x0
  v_bfe_u32 v31, v0, 0, 3
  v_lshl_add_u32 v17, v31, 3, v17
  v_bfe_u32 v31, v0, 3, 1
  v_lshl_add_u32 v17, v31, 11, v17
  v_bfe_u32 v31, v0, 4, 2
  v_lshl_add_u32 v17, v31, 6, v17
  v_add_u32 v17, s91, v17
  s_mov_b32 s48, 0x33333333
  s_mov_b32 s49, 0x33333333
  s_mov_b32 s50, 0xffff0000
  s_mov_b32 s51, 0xffff0000
  s_mov_b32 s52, 0x0000ffff
  s_mov_b32 s53, 0x0000ffff
  s_mov_b32 s54, 0xfffffffe
  s_mov_b32 s47, 0x3e0293ee
  v_mov_b32 v30, 0x4444
  v_mov_b32 v31, 0xeeee
  v_cndmask_b32 v20, v31, v30, s[48:49]
  v_mov_b32 v22, -1
  v_mov_b32 v23, -1
  v_mov_b32 v30, 0x3f803f80
  v_mov_b32 v248, v30
  v_cndmask_b32 v249, 0, v30, s[52:53]
  v_mov_b32 v250, v30
  v_mov_b32 v251, 0
  v_mov_b32 v252, v30
  v_cndmask_b32 v253, 0, v30, s[52:53]
  v_mov_b32 v254, v30
  v_mov_b32 v255, 0
  v_mov_b32 v152, 0
  v_mov_b32 v153, 0
  v_mov_b32 v154, 0
  v_mov_b32 v155, 0
  v_mov_b32 v156, 0
  v_mov_b32 v157, 0
  v_mov_b32 v158, 0
  v_mov_b32 v159, 0
  v_mov_b32 v160, 0
  v_mov_b32 v161, 0
  v_mov_b32 v162, 0
  v_mov_b32 v163, 0
  v_mov_b32 v164, 0
  v_mov_b32 v165, 0
  v_mov_b32 v166, 0
  v_mov_b32 v167, 0
  v_mov_b32 v168, 0
  v_mov_b32 v169, 0
  v_mov_b32 v170, 0
  v_mov_b32 v171, 0
  v_mov_b32 v172, 0
  v_mov_b32 v173, 0
  v_mov_b32 v174, 0
  v_mov_b32 v175, 0
  v_mov_b32 v176, 0
  v_mov_b32 v177, 0
  v_mov_b32 v178, 0
  v_mov_b32 v179, 0
  v_mov_b32 v180, 0
  v_mov_b32 v181, 0
  v_mov_b32 v182, 0
  v_mov_b32 v183, 0
  v_mov_b32 v184, 0
  v_mov_b32 v185, 0
  v_mov_b32 v186, 0
  v_mov_b32 v187, 0
  v_mov_b32 v188, 0
  v_mov_b32 v189, 0
  v_mov_b32 v190, 0
  v_mov_b32 v191, 0
  v_mov_b32 v192, 0
  v_mov_b32 v193, 0
  v_mov_b32 v194, 0
  v_mov_b32 v195, 0
  v_mov_b32 v196, 0
  v_mov_b32 v197, 0
  v_mov_b32 v198, 0
  v_mov_b32 v199, 0
  v_mov_b32 v200, 0
  v_mov_b32 v201, 0
  v_mov_b32 v202, 0
  v_mov_b32 v203, 0
  v_mov_b32 v204, 0
  v_mov_b32 v205, 0
  v_mov_b32 v206, 0
  v_mov_b32 v207, 0
  v_mov_b32 v208, 0
  v_mov_b32 v209, 0
  v_mov_b32 v210, 0
  v_mov_b32 v211, 0
  v_mov_b32 v212, 0
  v_mov_b32 v213, 0
  v_mov_b32 v214, 0
  v_mov_b32 v215, 0
  s_mov_b32 s40, 0
  s_mov_b32 s41, 0x3800000
  s_mov_b32 s43, 0x3900000
  s_mov_b32 s44, 0
  s_mov_b32 s45, 0
  s_mov_b32 s46, 0
  buffer_load_dwordx4 v[120:123], v11, s[4:7], s44 offen offset:0
  buffer_load_dwordx4 v[124:127], v11, s[4:7], s44 offen offset:1024
  buffer_load_dwordx4 v[128:131], v11, s[4:7], s44 offen offset:2048
  buffer_load_dwordx4 v[132:135], v11, s[4:7], s44 offen offset:3072
  buffer_load_dwordx4 v[136:139], v11, s[4:7], s44 offen offset:64
  buffer_load_dwordx4 v[140:143], v11, s[4:7], s44 offen offset:1088
  buffer_load_dwordx4 v[144:147], v11, s[4:7], s44 offen offset:2112
  buffer_load_dwordx4 v[148:151], v11, s[4:7], s44 offen offset:3136
  buffer_load_dwordx4 v[216:219], v12, s[4:7], s44 offen offset:0
  buffer_load_dwordx4 v[220:223], v12, s[4:7], s44 offen offset:1024
  buffer_load_dwordx4 v[224:227], v12, s[4:7], s44 offen offset:2048
  buffer_load_dwordx4 v[228:231], v12, s[4:7], s44 offen offset:3072
  buffer_load_dwordx4 v[232:235], v13, s[4:7], s44 offen offset:0
  buffer_load_dwordx4 v[236:239], v13, s[4:7], s44 offen offset:1024
  buffer_load_dwordx4 v[240:243], v13, s[4:7], s44 offen offset:2048
  buffer_load_dwordx4 v[244:247], v13, s[4:7], s44 offen offset:3072
  s_add_u32 s44, s44, 0x40000
  s_waitcnt vmcnt(0)
  v_mov_b32 v152, v216
  v_mov_b32 v154, v217
  v_mov_b32 v156, v218
  v_mov_b32 v158, v219
  v_mov_b32 v160, v220
  v_mov_b32 v162, v221
  v_mov_b32 v164, v222
  v_mov_b32 v166, v223
  v_mov_b32 v168, v224
  v_mov_b32 v170, v225
  v_mov_b32 v172, v226
  v_mov_b32 v174, v227
  v_mov_b32 v176, v228
  v_mov_b32 v178, v229
  v_mov_b32 v180, v230
  v_mov_b32 v182, v231
  v_mov_b32 v184, v232
  v_mov_b32 v186, v233
  v_mov_b32 v188, v234
  v_mov_b32 v190, v235
  v_mov_b32 v192, v236
  v_mov_b32 v194, v237
  v_mov_b32 v196, v238
  v_mov_b32 v198, v239
  v_mov_b32 v200, v240
  v_mov_b32 v202, v241
  v_mov_b32 v204, v242
  v_mov_b32 v206, v243
  v_mov_b32 v208, v244
  v_mov_b32 v210, v245
  v_mov_b32 v212, v246
  v_mov_b32 v214, v247
  v_mov_b32 v56, 0
  v_mov_b32 v57, 0
  v_mov_b32 v58, 0
  v_mov_b32 v59, 0
  v_mov_b32 v60, 0
  v_mov_b32 v61, 0
  v_mov_b32 v62, 0
  v_mov_b32 v63, 0
  v_mov_b32 v64, 0
  v_mov_b32 v65, 0
  v_mov_b32 v66, 0
  v_mov_b32 v67, 0
  v_mov_b32 v68, 0
  v_mov_b32 v69, 0
  v_mov_b32 v70, 0
  v_mov_b32 v71, 0
  v_mov_b32 v72, 0
  v_mov_b32 v73, 0
  v_mov_b32 v74, 0
  v_mov_b32 v75, 0
  v_mov_b32 v76, 0
  v_mov_b32 v77, 0
  v_mov_b32 v78, 0
  v_mov_b32 v79, 0
  v_mov_b32 v24, 0
  v_mov_b32 v25, 0
  v_mov_b32 v26, 0
  v_mov_b32 v27, 0
  v_min_u32 v32, s54, v32
  s_branch L_pubmem
L_step:
  v_mov_b32 v56, 0
  v_mov_b32 v57, 0
  v_mov_b32 v58, 0
  v_mov_b32 v59, 0
  v_mov_b32 v60, 0
  v_mov_b32 v61, 0
  v_mov_b32 v62, 0
  v_mov_b32 v63, 0
  v_mov_b32 v64, 0
  v_mov_b32 v65, 0
  v_mov_b32 v66, 0
  v_mov_b32 v67, 0
  v_mov_b32 v68, 0
  v_mov_b32 v69, 0
  v_mov_b32 v70, 0
  v_mov_b32 v71, 0
  v_mov_b32 v72, 0
  v_mov_b32 v73, 0
  v_mov_b32 v74, 0
  v_mov_b32 v75, 0
  v_mov_b32 v76, 0
  v_mov_b32 v77, 0
  v_mov_b32 v78, 0
  v_mov_b32 v79, 0
  v_mov_b32 v24, 0
  v_mov_b32 v25, 0
  v_mov_b32 v26, 0
  v_mov_b32 v27, 0
  s_nop 15
  s_nop 13
  buffer_load_dwordx4 v[32:35], v1, s[4:7], s42 offen offset:0 sc1
  buffer_load_dwordx4 v[36:39], v1, s[4:7], s42 offen offset:1024 sc1
  s_waitcnt vmcnt(2)
  v_mov_b32 v152, v216
  v_mov_b32 v154, v217
  v_mov_b32 v156, v218
  v_mov_b32 v158, v219
  v_mov_b32 v160, v220
  v_mov_b32 v162, v221
  v_mov_b32 v164, v222
  v_mov_b32 v166, v223
  v_mov_b32 v168, v224
  v_mov_b32 v170, v225
  v_mov_b32 v172, v226
  v_mov_b32 v174, v227
  v_mov_b32 v176, v228
  v_mov_b32 v178, v229
  v_mov_b32 v180, v230
  v_mov_b32 v182, v231
  v_mov_b32 v184, v232
  v_mov_b32 v186, v233
  v_mov_b32 v188, v234
  v_mov_b32 v190, v235
  v_mov_b32 v192, v236
  v_mov_b32 v194, v237
  v_mov_b32 v196, v238
  v_mov_b32 v198, v239
  v_mov_b32 v200, v240
  v_mov_b32 v202, v241
  v_mov_b32 v204, v242
  v_mov_b32 v206, v243
  v_mov_b32 v208, v244
  v_mov_b32 v210, v245
  v_mov_b32 v212, v246
  v_mov_b32 v214, v247
L_g_wait:
  s_waitcnt vmcnt(0)
  v_max3_u32 v31, v32, v33, v34
  v_max3_u32 v31, v31, v35, v36
  v_max3_u32 v31, v31, v37, v38
  v_max_u32 v31, v31, v39
  v_cmp_eq_u32 vcc, -1, v31
  s_cbranch_vccnz L_g_retry
  v_pk_add_f32 v[32:33], v[32:33], v[36:37]
  v_pk_add_f32 v[34:35], v[34:35], v[38:39]
  s_nop 0
  v_permlane32_swap_b32 v32, v33
  v_permlane32_swap_b32 v34, v35
  v_add_f32 v32, v32, v33
  v_add_f32 v34, v34, v35
  s_nop 0
  v_add_f32_dpp v33, v32, v32 row_ror:8 row_mask:0xf bank_mask:0xf
  v_add_f32_dpp v35, v34, v34 row_ror:8 row_mask:0xf bank_mask:0xf
  v_cvt_pk_bf16_f32 v32, v33, v35
  v_min_u32 v32, s54, v32
L_pubmem:
  buffer_store_dword v32, v2, s[4:7], s41 offen
  s_nop 15
  s_nop 15
  s_nop 15
  s_nop 1
  buffer_load_dwordx4 v[40:43], v3, s[4:7], s41 offen offset:0 sc1
  buffer_load_dwordx4 v[44:47], v3, s[4:7], s41 offen offset:1024 sc1
  buffer_load_dwordx4 v[48:51], v3, s[4:7], s41 offen offset:2048 sc1
  buffer_load_dwordx4 v[52:55], v3, s[4:7], s41 offen offset:3072 sc1
L_m_wait0:
  s_waitcnt vmcnt(3)
  v_max3_u32 v31, v40, v41, v42
  v_max_u32 v31, v31, v43
  v_cmp_eq_u32 vcc, -1, v31
  s_cbranch_vccnz L_m_retry0
  v_smfmac_f32_16x16x64_bf16 v[56:59], v[40:43], a[0:7], v20
  v_smfmac_f32_16x16x64_bf16 v[60:63], v[40:43], a[8:15], v20
  v_smfmac_f32_16x16x64_bf16 v[64:67], v[40:43], a[16:23], v20
  v_smfmac_f32_16x16x64_bf16 v[68:71], v[40:43], a[24:31], v20
  v_smfmac_f32_16x16x64_bf16 v[72:75], v[40:43], a[32:39], v20
  v_smfmac_f32_16x16x64_bf16 v[76:79], v[40:43], a[40:47], v20
L_m_wait1:
  s_waitcnt vmcnt(2)
  v_max3_u32 v31, v44, v45, v46
  v_max_u32 v31, v31, v47
  v_cmp_eq_u32 vcc, -1, v31
  s_cbranch_vccnz L_m_retry1
  v_smfmac_f32_16x16x64_bf16 v[56:59], v[44:47], a[48:55], v20
  v_smfmac_f32_16x16x64_bf16 v[60:63], v[44:47], a[56:63], v20
  v_smfmac_f32_16x16x64_bf16 v[64:67], v[44:47], a[64:71], v20
  v_smfmac_f32_16x16x64_bf16 v[68:71], v[44:47], a[72:79], v20
  v_smfmac_f32_16x16x64_bf16 v[72:75], v[44:47], a[80:87], v20
  v_smfmac_f32_16x16x64_bf16 v[76:79], v[44:47], a[88:95], v20
L_m_wait2:
  s_waitcnt vmcnt(1)
  v_max3_u32 v31, v48, v49, v50
  v_max_u32 v31, v31, v51
  v_cmp_eq_u32 vcc, -1, v31
  s_cbranch_vccnz L_m_retry2
  v_smfmac_f32_16x16x64_bf16 v[56:59], v[48:51], a[96:103], v20
  v_smfmac_f32_16x16x64_bf16 v[60:63], v[48:51], a[104:111], v20
  v_smfmac_f32_16x16x64_bf16 v[64:67], v[48:51], a[112:119], v20
  v_smfmac_f32_16x16x64_bf16 v[68:71], v[48:51], a[120:127], v20
  v_smfmac_f32_16x16x64_bf16 v[72:75], v[48:51], a[128:135], v20
  v_smfmac_f32_16x16x64_bf16 v[76:79], v[48:51], a[136:143], v20
L_m_wait3:
  s_waitcnt vmcnt(0)
  v_max3_u32 v31, v52, v53, v54
  v_max_u32 v31, v31, v55
  v_cmp_eq_u32 vcc, -1, v31
  s_cbranch_vccnz L_m_retry3
  v_smfmac_f32_16x16x64_bf16 v[56:59], v[52:55], a[144:151], v20
  v_smfmac_f32_16x16x64_bf16 v[60:63], v[52:55], a[152:159], v20
  v_smfmac_f32_16x16x64_bf16 v[64:67], v[52:55], a[160:167], v20
  v_smfmac_f32_16x16x64_bf16 v[68:71], v[52:55], a[168:175], v20
  v_smfmac_f32_16x16x64_bf16 v[72:75], v[52:55], a[176:183], v20
  v_smfmac_f32_16x16x64_bf16 v[76:79], v[52:55], a[184:191], v20
  s_nop 2
  v_pk_add_f32 v[80:81], v[56:57], v[58:59]
  v_pk_add_f32 v[82:83], v[60:61], v[62:63]
  ds_write_b128 v4, v[80:83]
  v_pk_add_f32 v[84:85], v[64:65], v[66:67]
  v_pk_add_f32 v[86:87], v[68:69], v[70:71]
  ds_write_b128 v4, v[84:87] offset:1024
  v_pk_add_f32 v[88:89], v[72:73], v[74:75]
  v_pk_add_f32 v[90:91], v[76:77], v[78:79]
  ds_write_b128 v5, v[88:91]
  s_cmp_eq_u32 s32, 3
  s_cbranch_scc1 L_red3
  s_cmp_eq_u32 s32, 2
  s_cbranch_scc1 L_red2
  s_waitcnt lgkmcnt(0)
  s_barrier
  ds_read_b128 v[92:95], v6 offset:0
  ds_read_b128 v[96:99], v6 offset:3072
  ds_read_b128 v[100:103], v6 offset:6144
  ds_read_b128 v[104:107], v6 offset:9216
  s_waitcnt lgkmcnt(2)
  v_pk_add_f32 v[92:93], v[92:93], v[96:97]
  v_pk_add_f32 v[94:95], v[94:95], v[98:99]
  s_waitcnt lgkmcnt(1)
  v_pk_add_f32 v[92:93], v[92:93], v[100:101]
  v_pk_add_f32 v[94:95], v[94:95], v[102:103]
  s_waitcnt lgkmcnt(0)
  v_pk_add_f32 v[92:93], v[92:93], v[104:105]
  v_pk_add_f32 v[94:95], v[94:95], v[106:107]
  v_cvt_pk_bf16_f32 v108, v92, v94
  v_cvt_pk_bf16_f32 v109, v93, v95
  v_min_u32 v108, s54, v108
  v_min_u32 v109, s54, v109
  buffer_store_dword v108, v7, s[4:7], s41 offen
  buffer_store_dword v109, v8, s[4:7], s41 offen
  s_branch L_red_done
L_red2:
  s_waitcnt lgkmcnt(0)
  s_barrier
  ds_read_b128 v[92:95], v6 offset:0
  ds_read_b128 v[96:99], v6 offset:3072
  ds_read_b128 v[100:103], v6 offset:6144
  ds_read_b128 v[104:107], v6 offset:9216
  s_waitcnt lgkmcnt(2)
  v_pk_add_f32 v[92:93], v[92:93], v[96:97]
  v_pk_add_f32 v[94:95], v[94:95], v[98:99]
  s_waitcnt lgkmcnt(1)
  v_pk_add_f32 v[92:93], v[92:93], v[100:101]
  v_pk_add_f32 v[94:95], v[94:95], v[102:103]
  s_waitcnt lgkmcnt(0)
  v_pk_add_f32 v[92:93], v[92:93], v[104:105]
  v_pk_add_f32 v[94:95], v[94:95], v[106:107]
  v_cvt_pk_bf16_f32 v108, v92, v93
  v_cvt_pk_bf16_f32 v109, v94, v95
  v_min_u32 v108, s54, v108
  v_min_u32 v109, s54, v109
  buffer_store_dwordx2 v[108:109], v7, s[4:7], s41 offen
  s_branch L_red_done
L_red3:
  s_waitcnt lgkmcnt(0)
  s_barrier
L_red_done:
  s_cmp_eq_u32 s40, 63
  s_cbranch_scc1 L_last
  v_mov_b32 v80, 0
  v_mov_b32 v81, 0
  v_mov_b32 v82, 0
  v_mov_b32 v83, 0
  v_mov_b32 v84, 0
  v_mov_b32 v85, 0
  v_mov_b32 v86, 0
  v_mov_b32 v87, 0
  v_mov_b32 v88, 0
  v_mov_b32 v89, 0
  v_mov_b32 v90, 0
  v_mov_b32 v91, 0
  v_mov_b32 v92, 0
  v_mov_b32 v93, 0
  v_mov_b32 v94, 0
  v_mov_b32 v95, 0
  v_mov_b32 v96, 0
  v_mov_b32 v97, 0
  v_mov_b32 v98, 0
  v_mov_b32 v99, 0
  v_mov_b32 v100, 0
  v_mov_b32 v101, 0
  v_mov_b32 v102, 0
  v_mov_b32 v103, 0
  v_mov_b32 v104, 0
  v_mov_b32 v105, 0
  v_mov_b32 v106, 0
  v_mov_b32 v107, 0
  v_mov_b32 v32, 0
  v_mov_b32 v33, 0
  v_mov_b32 v34, 0
  v_mov_b32 v35, 0
  v_mov_b32 v36, 0
  v_mov_b32 v37, 0
  v_mov_b32 v38, 0
  v_mov_b32 v39, 0
  s_nop 15
  s_nop 15
  s_nop 6
  buffer_load_dwordx4 v[40:43], v9, s[4:7], s41 offen offset:0 sc1
  buffer_load_dwordx4 v[44:47], v9, s[4:7], s41 offen offset:1024 sc1
  buffer_load_dwordx4 v[48:51], v9, s[4:7], s41 offen offset:2048 sc1
  buffer_load_dwordx4 v[52:55], v9, s[4:7], s41 offen offset:3072 sc1
  buffer_load_dwordx4 v[110:113], v10, s[4:7], s41 offen offset:0 sc1
  buffer_load_dwordx4 v[114:117], v10, s[4:7], s41 offen offset:1024 sc1
L_x_wait0:
  s_waitcnt vmcnt(5)
  v_max3_u32 v31, v40, v41, v42
  v_max_u32 v31, v31, v43
  v_cmp_eq_u32 vcc, -1, v31
  s_cbranch_vccnz L_x_retry0
  v_mfma_f32_16x16x32_bf16 v[56:59], v[120:123], v[40:43], 0
  v_mfma_f32_16x16x32_bf16 v[60:63], v[136:139], v[40:43], 0
  v_mfma_f32_16x16x32_bf16 v[64:67], v[40:43], v[40:43], 0
L_x_wait1:
  s_waitcnt vmcnt(4)
  v_max3_u32 v31, v44, v45, v46
  v_max_u32 v31, v31, v47
  v_cmp_eq_u32 vcc, -1, v31
  s_cbranch_vccnz L_x_retry1
  v_mfma_f32_16x16x32_bf16 v[56:59], v[124:127], v[44:47], v[56:59]
  v_mfma_f32_16x16x32_bf16 v[60:63], v[140:143], v[44:47], v[60:63]
  v_mfma_f32_16x16x32_bf16 v[64:67], v[44:47], v[44:47], v[64:67]
L_x_wait2:
  s_waitcnt vmcnt(3)
  v_max3_u32 v31, v48, v49, v50
  v_max_u32 v31, v31, v51
  v_cmp_eq_u32 vcc, -1, v31
  s_cbranch_vccnz L_x_retry2
  v_mfma_f32_16x16x32_bf16 v[56:59], v[128:131], v[48:51], v[56:59]
  v_mfma_f32_16x16x32_bf16 v[60:63], v[144:147], v[48:51], v[60:63]
  v_mfma_f32_16x16x32_bf16 v[64:67], v[48:51], v[48:51], v[64:67]
L_x_wait3:
  s_waitcnt vmcnt(2)
  v_max3_u32 v31, v52, v53, v54
  v_max_u32 v31, v31, v55
  v_cmp_eq_u32 vcc, -1, v31
  s_cbranch_vccnz L_x_retry3
  v_mfma_f32_16x16x32_bf16 v[56:59], v[132:135], v[52:55], v[56:59]
  v_mfma_f32_16x16x32_bf16 v[60:63], v[148:151], v[52:55], v[60:63]
  v_mfma_f32_16x16x32_bf16 v[64:67], v[52:55], v[52:55], v[64:67]
L_v_wait:
  s_waitcnt vmcnt(0)
  v_max3_u32 v31, v110, v111, v112
  v_max3_u32 v31, v31, v113, v114
  v_max3_u32 v31, v31, v115, v116
  v_max_u32 v31, v31, v117
  v_cmp_eq_u32 vcc, -1, v31
  s_cbranch_vccnz L_v_retry
  buffer_load_dwordx4 v[120:123], v11, s[4:7], s44 offen offset:0
  buffer_load_dwordx4 v[124:127], v11, s[4:7], s44 offen offset:1024
  buffer_load_dwordx4 v[128:131], v11, s[4:7], s44 offen offset:2048
  buffer_load_dwordx4 v[132:135], v11, s[4:7], s44 offen offset:3072
  buffer_load_dwordx4 v[136:139], v11, s[4:7], s44 offen offset:64
  buffer_load_dwordx4 v[140:143], v11, s[4:7], s44 offen offset:1088
  buffer_load_dwordx4 v[144:147], v11, s[4:7], s44 offen offset:2112
  buffer_load_dwordx4 v[148:151], v11, s[4:7], s44 offen offset:3136
  v_max3_f32 v28, v56, v57, v58
  v_max3_f32 v29, v59, v60, v61
  v_max3_f32 v28, v28, v62, v63
  v_max3_f32 v29, v29, v66, v67
  v_max_f32 v28, v28, v29
  v_mov_b32 v29, v28
  v_cndmask_b32 v153, 0, v110, s[52:53]
  v_cndmask_b32 v157, 0, v112, s[52:53]
  v_permlane32_swap_b32 v28, v29
  v_max_f32 v28, v28, v29
  v_mov_b32 v29, v28
  v_cndmask_b32 v161, 0, v111, s[52:53]
  v_cndmask_b32 v165, 0, v113, s[52:53]
  v_permlane16_swap_b32 v28, v29
  v_max_f32 v28, v28, v29
  v_mul_f32 v28, s47, v28
  v_fma_f32 v56, v56, s47, -v28
  v_fma_f32 v57, v57, s47, -v28
  v_fma_f32 v58, v58, s47, -v28
  v_fma_f32 v59, v59, s47, -v28
  v_fma_f32 v60, v60, s47, -v28
  v_fma_f32 v61, v61, s47, -v28
  v_fma_f32 v62, v62, s47, -v28
  v_fma_f32 v63, v63, s47, -v28
  v_fma_f32 v66, v66, s47, -v28
  v_fma_f32 v67, v67, s47, -v28
  s_mov_b64 vcc, s[48:49]
  v_exp_f32 v66, v66
  v_exp_f32 v67, v67
  v_exp_f32 v56, v56
  v_exp_f32 v57, v57
  v_exp_f32 v58, v58
  v_exp_f32 v59, v59
  v_exp_f32 v60, v60
  v_exp_f32 v61, v61
  v_exp_f32 v62, v62
  v_exp_f32 v63, v63
  v_cvt_pk_bf16_f32 v76, v66, v67
  v_cvt_pk_bf16_f32 v72, v56, v57
  v_cvt_pk_bf16_f32 v73, v58, v59
  v_cvt_pk_bf16_f32 v74, v60, v61
  v_cvt_pk_bf16_f32 v75, v62, v63
  v_cndmask_b32_dpp v68, v76, v72, vcc quad_perm:[0,1,0,1] row_mask:0xf bank_mask:0xf
  v_cndmask_b32 v69, 0, v73, vcc
  v_cndmask_b32_dpp v70, v76, v74, vcc quad_perm:[0,1,0,1] row_mask:0xf bank_mask:0xf
  v_cndmask_b32 v71, 0, v75, vcc
  v_cndmask_b32 v169, 0, v110, s[50:51]
  v_cndmask_b32 v173, 0, v112, s[50:51]
  v_smfmac_f32_16x16x64_bf16 v[36:39], v[68:71], v[248:255], v20
  v_smfmac_f32_16x16x64_bf16 v[80:83], v[68:71], v[152:159], v20
  v_cndmask_b32 v177, 0, v111, s[50:51]
  v_cndmask_b32 v181, 0, v113, s[50:51]
  v_smfmac_f32_16x16x64_bf16 v[84:87], v[68:71], v[160:167], v20
  v_cndmask_b32 v185, 0, v114, s[52:53]
  v_cndmask_b32 v189, 0, v116, s[52:53]
  v_smfmac_f32_16x16x64_bf16 v[88:91], v[68:71], v[168:175], v20
  v_cndmask_b32 v193, 0, v115, s[52:53]
  v_cndmask_b32 v197, 0, v117, s[52:53]
  v_smfmac_f32_16x16x64_bf16 v[92:95], v[68:71], v[176:183], v20
  v_cndmask_b32 v201, 0, v114, s[50:51]
  v_cndmask_b32 v205, 0, v116, s[50:51]
  v_smfmac_f32_16x16x64_bf16 v[96:99], v[68:71], v[184:191], v20
  v_cndmask_b32 v209, 0, v115, s[50:51]
  v_cndmask_b32 v213, 0, v117, s[50:51]
  v_smfmac_f32_16x16x64_bf16 v[100:103], v[68:71], v[192:199], v20
  v_pk_add_f32 v[28:29], v[36:37], v[38:39]
  v_smfmac_f32_16x16x64_bf16 v[104:107], v[68:71], v[200:207], v20
  v_rcp_f32 v28, v28
  v_smfmac_f32_16x16x64_bf16 v[32:35], v[68:71], v[208:215], v20
  v_rcp_f32 v29, v29
  v_pk_add_f32 v[80:81], v[80:81], v[82:83]
  v_pk_add_f32 v[84:85], v[84:85], v[86:87]
  v_pk_mul_f32 v[80:81], v[80:81], v[28:29]
  v_pk_mul_f32 v[84:85], v[84:85], v[28:29]
  v_cvt_pk_bf16_f32 v72, v80, v84
  v_cvt_pk_bf16_f32 v76, v81, v85
  v_pk_add_f32 v[88:89], v[88:89], v[90:91]
  v_pk_add_f32 v[92:93], v[92:93], v[94:95]
  v_pk_mul_f32 v[88:89], v[88:89], v[28:29]
  v_pk_mul_f32 v[92:93], v[92:93], v[28:29]
  v_cvt_pk_bf16_f32 v73, v88, v92
  v_cvt_pk_bf16_f32 v77, v89, v93
  v_pk_add_f32 v[96:97], v[96:97], v[98:99]
  v_pk_add_f32 v[100:101], v[100:101], v[102:103]
  v_pk_mul_f32 v[96:97], v[96:97], v[28:29]
  v_pk_mul_f32 v[100:101], v[100:101], v[28:29]
  v_cvt_pk_bf16_f32 v74, v96, v100
  v_cvt_pk_bf16_f32 v78, v97, v101
  v_pk_add_f32 v[104:105], v[104:105], v[106:107]
  v_pk_add_f32 v[32:33], v[32:33], v[34:35]
  v_pk_mul_f32 v[104:105], v[104:105], v[28:29]
  v_pk_mul_f32 v[32:33], v[32:33], v[28:29]
  v_cvt_pk_bf16_f32 v75, v104, v32
  v_cvt_pk_bf16_f32 v79, v105, v33
  ds_write_b128 v14, v[72:75]
  ds_write_b128 v15, v[76:79]
  s_waitcnt lgkmcnt(0)
  s_barrier
  ds_read_b128 v[40:43], v16 offset:0
  ds_read_b128 v[44:47], v16 offset:1024
  ds_read_b128 v[48:51], v16 offset:2048
  ds_read_b128 v[52:55], v16 offset:3072
  ds_read_b128 v[56:59], v16 offset:4096
  ds_read_b128 v[60:63], v16 offset:5120
  ds_read_b128 v[64:67], v16 offset:6144
  ds_read_b128 v[68:71], v16 offset:7168
  s_waitcnt lgkmcnt(7)
  v_smfmac_f32_16x16x64_bf16 v[24:27], v[40:43], a[192:199], v20
  s_waitcnt lgkmcnt(6)
  v_smfmac_f32_16x16x64_bf16 v[24:27], v[44:47], a[200:207], v20
  s_waitcnt lgkmcnt(5)
  v_smfmac_f32_16x16x64_bf16 v[24:27], v[48:51], a[208:215], v20
  s_waitcnt lgkmcnt(4)
  v_smfmac_f32_16x16x64_bf16 v[24:27], v[52:55], a[216:223], v20
  s_waitcnt lgkmcnt(3)
  v_smfmac_f32_16x16x64_bf16 v[24:27], v[56:59], a[224:231], v20
  s_waitcnt lgkmcnt(2)
  v_smfmac_f32_16x16x64_bf16 v[24:27], v[60:63], a[232:239], v20
  s_waitcnt lgkmcnt(1)
  v_smfmac_f32_16x16x64_bf16 v[24:27], v[64:67], a[240:247], v20
  s_waitcnt lgkmcnt(0)
  v_smfmac_f32_16x16x64_bf16 v[24:27], v[68:71], a[248:255], v20
  s_nop 7
  v_pk_add_f32 v[28:29], v[24:25], v[26:27]
  v_min_u32 v28, s54, v28
  v_min_u32 v29, s54, v29
  buffer_store_dwordx2 v[28:29], v17, s[4:7], s41 offen sc1
  buffer_load_dwordx4 v[216:219], v12, s[4:7], s44 offen offset:0
  buffer_load_dwordx4 v[220:223], v12, s[4:7], s44 offen offset:1024
  buffer_load_dwordx4 v[224:227], v12, s[4:7], s44 offen offset:2048
  buffer_load_dwordx4 v[228:231], v12, s[4:7], s44 offen offset:3072
  buffer_load_dwordx4 v[232:235], v13, s[4:7], s44 offen offset:0
  buffer_load_dwordx4 v[236:239], v13, s[4:7], s44 offen offset:1024
  buffer_load_dwordx4 v[240:243], v13, s[4:7], s44 offen offset:2048
  buffer_load_dwordx4 v[244:247], v13, s[4:7], s44 offen offset:3072
  s_cmp_eq_u32 s32, 0
  s_cbranch_scc1 L_noexp_4
  s_cmp_eq_u32 s32, 3
  s_cbranch_scc1 L_noexp_4
  buffer_store_dword v108, v18, s[4:7], s45 offen
  buffer_store_dword v109, v19, s[4:7], s45 offen
L_noexp_4:
  buffer_store_dwordx2 v[22:23], v17, s[4:7], s43 offen sc1
  buffer_store_dword v22, v2, s[4:7], s43 offen
  s_cmp_eq_u32 s32, 3
  s_cbranch_scc1 L_rs_6
  s_cmp_eq_u32 s32, 2
  s_cbranch_scc1 L_rs_7
  buffer_store_dword v22, v7, s[4:7], s43 offen
  buffer_store_dword v22, v8, s[4:7], s43 offen
  s_branch L_rs_6
L_rs_7:
  buffer_store_dwordx2 v[22:23], v7, s[4:7], s43 offen
L_rs_6:
L_rs_5:
  s_mov_b32 s42, s41
  s_add_u32 s40, s40, 1
  s_and_b32 s90, s40, 3
  s_lshl_b32 s90, s90, 19
  s_add_u32 s41, s90, 0x3800000
  s_xor_b32 s43, s41, 0x100000
  s_add_u32 s44, s44, 0x40000
  s_min_u32 s44, s44, 0xfc0000
  s_add_u32 s45, s45, 0x10000
  s_branch L_step
L_last:
  s_cmp_eq_u32 s32, 0
  s_cbranch_scc1 L_noexp_8
  s_cmp_eq_u32 s32, 3
  s_cbranch_scc1 L_noexp_8
  buffer_store_dword v108, v18, s[4:7], s45 offen
  buffer_store_dword v109, v19, s[4:7], s45 offen
L_noexp_8:
  s_waitcnt vmcnt(0)
  s_branch L_rec_exit
L_g_retry:
  buffer_load_dwordx4 v[32:35], v1, s[4:7], s42 offen offset:0 sc1
  buffer_load_dwordx4 v[36:39], v1, s[4:7], s42 offen offset:1024 sc1
  s_add_u32 s46, s46, 1
  s_cmp_lt_u32 s46, 1048576
  s_cbranch_scc1 L_g_wait
  s_branch L_rec_abort
L_m_retry0:
  buffer_load_dwordx4 v[40:43], v3, s[4:7], s41 offen offset:0 sc1
  buffer_load_dwordx4 v[44:47], v3, s[4:7], s41 offen offset:1024 sc1
  buffer_load_dwordx4 v[48:51], v3, s[4:7], s41 offen offset:2048 sc1
  buffer_load_dwordx4 v[52:55], v3, s[4:7], s41 offen offset:3072 sc1
  s_add_u32 s46, s46, 1
  s_cmp_lt_u32 s46, 1048576
  s_cbranch_scc1 L_m_wait0
  s_branch L_rec_abort
L_m_retry1:
  buffer_load_dwordx4 v[44:47], v3, s[4:7], s41 offen offset:1024 sc1
  buffer_load_dwordx4 v[48:51], v3, s[4:7], s41 offen offset:2048 sc1
  buffer_load_dwordx4 v[52:55], v3, s[4:7], s41 offen offset:3072 sc1
  s_add_u32 s46, s46, 1
  s_cmp_lt_u32 s46, 1048576
  s_cbranch_scc1 L_m_wait1
  s_branch L_rec_abort
L_m_retry2:
  buffer_load_dwordx4 v[48:51], v3, s[4:7], s41 offen offset:2048 sc1
  buffer_load_dwordx4 v[52:55], v3, s[4:7], s41 offen offset:3072 sc1
  s_add_u32 s46, s46, 1
  s_cmp_lt_u32 s46, 1048576
  s_cbranch_scc1 L_m_wait2
  s_branch L_rec_abort
L_m_retry3:
  buffer_load_dwordx4 v[52:55], v3, s[4:7], s41 offen offset:3072 sc1
  s_add_u32 s46, s46, 1
  s_cmp_lt_u32 s46, 1048576
  s_cbranch_scc1 L_m_wait3
  s_branch L_rec_abort
L_x_retry0:
  buffer_load_dwordx4 v[40:43], v9, s[4:7], s41 offen offset:0 sc1
  buffer_load_dwordx4 v[44:47], v9, s[4:7], s41 offen offset:1024 sc1
  buffer_load_dwordx4 v[48:51], v9, s[4:7], s41 offen offset:2048 sc1
  buffer_load_dwordx4 v[52:55], v9, s[4:7], s41 offen offset:3072 sc1
  buffer_load_dwordx4 v[110:113], v10, s[4:7], s41 offen offset:0 sc1
  buffer_load_dwordx4 v[114:117], v10, s[4:7], s41 offen offset:1024 sc1
  s_add_u32 s46, s46, 1
  s_cmp_lt_u32 s46, 1048576
  s_cbranch_scc1 L_x_wait0
  s_branch L_rec_abort
L_x_retry1:
  buffer_load_dwordx4 v[44:47], v9, s[4:7], s41 offen offset:1024 sc1
  buffer_load_dwordx4 v[48:51], v9, s[4:7], s41 offen offset:2048 sc1
  buffer_load_dwordx4 v[52:55], v9, s[4:7], s41 offen offset:3072 sc1
  buffer_load_dwordx4 v[110:113], v10, s[4:7], s41 offen offset:0 sc1
  buffer_load_dwordx4 v[114:117], v10, s[4:7], s41 offen offset:1024 sc1
  s_add_u32 s46, s46, 1
  s_cmp_lt_u32 s46, 1048576
  s_cbranch_scc1 L_x_wait1
  s_branch L_rec_abort
L_x_retry2:
  buffer_load_dwordx4 v[48:51], v9, s[4:7], s41 offen offset:2048 sc1
  buffer_load_dwordx4 v[52:55], v9, s[4:7], s41 offen offset:3072 sc1
  buffer_load_dwordx4 v[110:113], v10, s[4:7], s41 offen offset:0 sc1
  buffer_load_dwordx4 v[114:117], v10, s[4:7], s41 offen offset:1024 sc1
  s_add_u32 s46, s46, 1
  s_cmp_lt_u32 s46, 1048576
  s_cbranch_scc1 L_x_wait2
  s_branch L_rec_abort
L_x_retry3:
  buffer_load_dwordx4 v[52:55], v9, s[4:7], s41 offen offset:3072 sc1
  buffer_load_dwordx4 v[110:113], v10, s[4:7], s41 offen offset:0 sc1
  buffer_load_dwordx4 v[114:117], v10, s[4:7], s41 offen offset:1024 sc1
  s_add_u32 s46, s46, 1
  s_cmp_lt_u32 s46, 1048576
  s_cbranch_scc1 L_x_wait3
  s_branch L_rec_abort
L_v_retry:
  buffer_load_dwordx4 v[110:113], v10, s[4:7], s41 offen offset:0 sc1
  buffer_load_dwordx4 v[114:117], v10, s[4:7], s41 offen offset:1024 sc1
  s_add_u32 s46, s46, 1
  s_cmp_lt_u32 s46, 1048576
  s_cbranch_scc1 L_v_wait
  s_branch L_rec_abort
L_rec_abort:
  s_waitcnt vmcnt(0)
  s_endpgm
L_rec_exit:
  s_endpgm
.globl attn_kernel
.p2align 8
.type attn_kernel,@function
attn_kernel:
  s_cmp_ge_u32 s2, 640
  s_cbranch_scc1 L_k3_end
  s_load_dwordx2 s[82:83], s[0:1], 96
  v_and_b32 v1, 63, v0
  v_lshrrev_b32 v2, 6, v0
  s_nop 0
  v_readfirstlane_b32 s84, v2
  s_waitcnt lgkmcnt(0)
  s_mov_b32 s4, s82
  s_and_b32 s5, s83, 0xffff
  s_mov_b32 s6, 0x10000000
  s_mov_b32 s7, 0x20000
  s_lshl_b32 s85, s2, 2
  s_add_u32 s85, s85, s84
  s_cmp_ge_u32 s2, 512
  s_cbranch_scc1 L_k3_B
  s_lshl_b32 s90, s85, 13
  s_lshl_b32 s91, s85, 11
  v_mov_b32 v2, 0x0
  v_bfe_u32 v7, v1, 0, 6
  v_lshl_add_u32 v2, v7, 4, v2
  v_add_u32 v3, 4096, v2
  v_mov_b32 v4, 0x3000000
  v_bfe_u32 v7, v1, 0, 3
  v_lshl_add_u32 v4, v7, 4, v4
  v_bfe_u32 v7, v1, 4, 2
  v_lshl_add_u32 v4, v7, 7, v4
  v_mov_b32 v5, 0x3400000
  v_bfe_u32 v7, v1, 0, 4
  v_lshl_add_u32 v5, v7, 4, v5
  v_bfe_u32 v7, v1, 4, 1
  v_lshl_add_u32 v5, v7, 3, v5
  s_add_u32 s92, s90, 16777216
  s_add_u32 s93, s90, 33554432
  s_add_u32 s94, s90, 0
  s_add_u32 s95, s90, 83886080
  buffer_load_dwordx4 v[8:11], v2, s[4:7], s94 offen offset:0
  buffer_load_dwordx4 v[12:15], v2, s[4:7], s94 offen offset:1024
  buffer_load_dwordx4 v[16:19], v2, s[4:7], s94 offen offset:2048
  buffer_load_dwordx4 v[20:23], v2, s[4:7], s94 offen offset:3072
  buffer_load_dwordx4 v[24:27], v3, s[4:7], s94 offen offset:0
  buffer_load_dwordx4 v[28:31], v3, s[4:7], s94 offen offset:1024
  buffer_load_dwordx4 v[32:35], v3, s[4:7], s94 offen offset:2048
  buffer_load_dwordx4 v[36:39], v3, s[4:7], s94 offen offset:3072
  buffer_load_dwordx4 v[104:107], v4, s[4:7], s91 offen offset:0
  buffer_load_dwordx4 v[108:111], v4, s[4:7], s91 offen offset:512
  buffer_load_dwordx4 v[112:115], v4, s[4:7], s91 offen offset:1024
  buffer_load_dwordx4 v[116:119], v4, s[4:7], s91 offen offset:1536
  buffer_load_dwordx4 v[40:43], v2, s[4:7], s92 offen offset:0
  buffer_load_dwordx4 v[44:47], v2, s[4:7], s92 offen offset:1024
  buffer_load_dwordx4 v[48:51], v2, s[4:7], s92 offen offset:2048
  buffer_load_dwordx4 v[52:55], v2, s[4:7], s92 offen offset:3072
  buffer_load_dwordx4 v[56:59], v3, s[4:7], s92 offen offset:0
  buffer_load_dwordx4 v[60:63], v3, s[4:7], s92 offen offset:1024
  buffer_load_dwordx4 v[64:67], v3, s[4:7], s92 offen offset:2048
  buffer_load_dwordx4 v[68:71], v3, s[4:7], s92 offen offset:3072
  buffer_load_dwordx4 v[72:75], v2, s[4:7], s93 offen offset:0
  buffer_load_dwordx4 v[76:79], v2, s[4:7], s93 offen offset:1024
  buffer_load_dwordx4 v[80:83], v2, s[4:7], s93 offen offset:2048
  buffer_load_dwordx4 v[84:87], v2, s[4:7], s93 offen offset:3072
  buffer_load_dwordx4 v[88:91], v3, s[4:7], s93 offen offset:0
  buffer_load_dwordx4 v[92:95], v3, s[4:7], s93 offen offset:1024
  buffer_load_dwordx4 v[96:99], v3, s[4:7], s93 offen offset:2048
  buffer_load_dwordx4 v[100:103], v3, s[4:7], s93 offen offset:3072
  buffer_load_dwordx2 v[120:121], v5, s[4:7], s91 offen offset:0
  buffer_load_dwordx2 v[122:123], v5, s[4:7], s91 offen offset:256
  buffer_load_dwordx2 v[124:125], v5, s[4:7], s91 offen offset:512
  buffer_load_dwordx2 v[126:127], v5, s[4:7], s91 offen offset:768
  buffer_load_dwordx2 v[128:129], v5, s[4:7], s91 offen offset:1024
  buffer_load_dwordx2 v[130:131], v5, s[4:7], s91 offen offset:1280
  buffer_load_dwordx2 v[132:133], v5, s[4:7], s91 offen offset:1536
  buffer_load_dwordx2 v[134:135], v5, s[4:7], s91 offen offset:1792
  s_mov_b32 s40, 0xfff0ffff
  s_mov_b32 s41, 0xf000ff00
  s_mov_b32 s42, 0xffe0fffe
  s_mov_b32 s43, 0xe000fe00
  s_mov_b32 s44, 0xffc0fffc
  s_mov_b32 s45, 0xc000fc00
  s_mov_b32 s46, 0xff80fff8
  s_mov_b32 s47, 0x8000f800
  s_mov_b32 s48, 0xffffffff
  s_mov_b32 s49, 0x0
  s_mov_b32 s50, 0x3e0293ee
  v_mov_b32 v6, 0xd028965f
  s_waitcnt vmcnt(16)
  v_mfma_f32_16x16x32_bf16 v[136:139], v[104:107], v[8:11], 0
  v_mfma_f32_16x16x32_bf16 v[140:143], v[40:43], v[8:11], 0
  v_mfma_f32_16x16x32_bf16 v[144:147], v[104:107], v[24:27], 0
  v_mfma_f32_16x16x32_bf16 v[148:151], v[40:43], v[24:27], 0
  v_mfma_f32_16x16x32_bf16 v[152:155], v[56:59], v[24:27], 0
  v_mfma_f32_16x16x32_bf16 v[136:139], v[108:111], v[12:15], v[136:139]
  v_mfma_f32_16x16x32_bf16 v[140:143], v[44:47], v[12:15], v[140:143]
  v_mfma_f32_16x16x32_bf16 v[144:147], v[108:111], v[28:31], v[144:147]
  v_mfma_f32_16x16x32_bf16 v[148:151], v[44:47], v[28:31], v[148:151]
  v_mfma_f32_16x16x32_bf16 v[152:155], v[60:63], v[28:31], v[152:155]
  v_mfma_f32_16x16x32_bf16 v[136:139], v[112:115], v[16:19], v[136:139]
  v_mfma_f32_16x16x32_bf16 v[140:143], v[48:51], v[16:19], v[140:143]
  v_mfma_f32_16x16x32_bf16 v[144:147], v[112:115], v[32:35], v[144:147]
  v_mfma_f32_16x16x32_bf16 v[148:151], v[48:51], v[32:35], v[148:151]
  v_mfma_f32_16x16x32_bf16 v[152:155], v[64:67], v[32:35], v[152:155]
  v_mfma_f32_16x16x32_bf16 v[136:139], v[116:119], v[20:23], v[136:139]
  v_mfma_f32_16x16x32_bf16 v[140:143], v[52:55], v[20:23], v[140:143]
  v_mfma_f32_16x16x32_bf16 v[144:147], v[116:119], v[36:39], v[144:147]
  v_mfma_f32_16x16x32_bf16 v[148:151], v[52:55], v[36:39], v[148:151]
  v_mfma_f32_16x16x32_bf16 v[152:155], v[68:71], v[36:39], v[152:155]
  s_nop 3
  v_cndmask_b32 v136, v6, v136, s[48:49]
  v_cndmask_b32 v140, v6, v140, s[40:41]
  v_cndmask_b32 v137, v6, v137, s[48:49]
  v_cndmask_b32 v141, v6, v141, s[42:43]
  v_cndmask_b32 v138, v6, v138, s[48:49]
  v_cndmask_b32 v142, v6, v142, s[44:45]
  v_cndmask_b32 v139, v6, v139, s[48:49]
  v_cndmask_b32 v143, v6, v143, s[46:47]
  v_max3_f32 v168, v136, v137, v138
  v_max3_f32 v168, v168, v139, v140
  v_max3_f32 v168, v168, v141, v142
  v_max_f32 v168, v168, v143
  v_mov_b32 v169, v168
  s_nop 1
  v_permlane32_swap_b32 v168, v169
  v_max_f32 v168, v168, v169
  v_mov_b32 v169, v168
  s_nop 1
  v_permlane16_swap_b32 v168, v169
  v_max_f32 v168, v168, v169
  v_mul_f32 v168, s50, v168
  v_fma_f32 v136, v136, s50, -v168
  v_fma_f32 v137, v137, s50, -v168
  v_fma_f32 v138, v138, s50, -v168
  v_fma_f32 v139, v139, s50, -v168
  v_fma_f32 v140, v140, s50, -v168
  v_fma_f32 v141, v141, s50, -v168
  v_fma_f32 v142, v142, s50, -v168
  v_fma_f32 v143, v143, s50, -v168
  v_exp_f32 v136, v136
  v_exp_f32 v137, v137
  v_exp_f32 v138, v138
  v_exp_f32 v139, v139
  v_exp_f32 v140, v140
  v_exp_f32 v141, v141
  v_exp_f32 v142, v142
  v_exp_f32 v143, v143
  v_add_f32 v168, v136, v137
  v_add_f32 v168, v168, v138
  v_add_f32 v168, v168, v139
  v_add_f32 v168, v168, v140
  v_add_f32 v168, v168, v141
  v_add_f32 v168, v168, v142
  v_add_f32 v168, v168, v143
  v_mov_b32 v169, v168
  s_nop 1
  v_permlane32_swap_b32 v168, v169
  v_add_f32 v168, v168, v169
  v_mov_b32 v169, v168
  s_nop 1
  v_permlane16_swap_b32 v168, v169
  v_add_f32 v168, v168, v169
  v_rcp_f32 v168, v168
  s_nop 0
  v_mul_f32 v136, v136, v168
  v_mul_f32 v137, v137, v168
  v_mul_f32 v138, v138, v168
  v_mul_f32 v139, v139, v168
  v_mul_f32 v140, v140, v168
  v_mul_f32 v141, v141, v168
  v_mul_f32 v142, v142, v168
  v_mul_f32 v143, v143, v168
  v_cvt_pk_bf16_f32 v160, v136, v137
  v_cvt_pk_bf16_f32 v161, v138, v139
  v_cvt_pk_bf16_f32 v156, v140, v141
  v_cvt_pk_bf16_f32 v157, v142, v143
  v_mov_b32 v158, 0
  v_mov_b32 v159, 0
  v_cndmask_b32 v144, v6, v144, s[48:49]
  v_cndmask_b32 v152, v6, v152, s[40:41]
  v_cndmask_b32 v145, v6, v145, s[48:49]
  v_cndmask_b32 v153, v6, v153, s[42:43]
  v_cndmask_b32 v146, v6, v146, s[48:49]
  v_cndmask_b32 v154, v6, v154, s[44:45]
  v_cndmask_b32 v147, v6, v147, s[48:49]
  v_cndmask_b32 v155, v6, v155, s[46:47]
  v_max3_f32 v168, v144, v145, v146
  v_max3_f32 v168, v168, v147, v148
  v_max3_f32 v168, v168, v149, v150
  v_max3_f32 v168, v168, v151, v152
  v_max3_f32 v168, v168, v153, v154
  v_max_f32 v168, v168, v155
  v_mov_b32 v169, v168
  s_nop 1
  v_permlane32_swap_b32 v168, v169
  v_max_f32 v168, v168, v169
  v_mov_b32 v169, v168
  s_nop 1
  v_permlane16_swap_b32 v168, v169
  v_max_f32 v168, v168, v169
  v_mul_f32 v168, s50, v168
  v_fma_f32 v144, v144, s50, -v168
  v_fma_f32 v145, v145, s50, -v168
  v_fma_f32 v146, v146, s50, -v168
  v_fma_f32 v147, v147, s50, -v168
  v_fma_f32 v148, v148, s50, -v168
  v_fma_f32 v149, v149, s50, -v168
  v_fma_f32 v150, v150, s50, -v168
  v_fma_f32 v151, v151, s50, -v168
  v_fma_f32 v152, v152, s50, -v168
  v_fma_f32 v153, v153, s50, -v168
  v_fma_f32 v154, v154, s50, -v168
  v_fma_f32 v155, v155, s50, -v168
  v_exp_f32 v144, v144
  v_exp_f32 v145, v145
  v_exp_f32 v146, v146
  v_exp_f32 v147, v147
  v_exp_f32 v148, v148
  v_exp_f32 v149, v149
  v_exp_f32 v150, v150
  v_exp_f32 v151, v151
  v_exp_f32 v152, v152
  v_exp_f32 v153, v153
  v_exp_f32 v154, v154
  v_exp_f32 v155, v155
  v_add_f32 v168, v144, v145
  v_add_f32 v168, v168, v146
  v_add_f32 v168, v168, v147
  v_add_f32 v168, v168, v148
  v_add_f32 v168, v168, v149
  v_add_f32 v168, v168, v150
  v_add_f32 v168, v168, v151
  v_add_f32 v168, v168, v152
  v_add_f32 v168, v168, v153
  v_add_f32 v168, v168, v154
  v_add_f32 v168, v168, v155
  v_mov_b32 v169, v168
  s_nop 1
  v_permlane32_swap_b32 v168, v169
  v_add_f32 v168, v168, v169
  v_mov_b32 v169, v168
  s_nop 1
  v_permlane16_swap_b32 v168, v169
  v_add_f32 v168, v168, v169
  v_rcp_f32 v168, v168
  s_nop 0
  v_mul_f32 v144, v144, v168
  v_mul_f32 v145, v145, v168
  v_mul_f32 v146, v146, v168
  v_mul_f32 v147, v147, v168
  v_mul_f32 v148, v148, v168
  v_mul_f32 v149, v149, v168
  v_mul_f32 v150, v150, v168
  v_mul_f32 v151, v151, v168
  v_mul_f32 v152, v152, v168
  v_mul_f32 v153, v153, v168
  v_mul_f32 v154, v154, v168
  v_mul_f32 v155, v155, v168
  v_cvt_pk_bf16_f32 v166, v144, v145
  v_cvt_pk_bf16_f32 v167, v146, v147
  v_cvt_pk_bf16_f32 v162, v148, v149
  v_cvt_pk_bf16_f32 v163, v150, v151
  v_cvt_pk_bf16_f32 v164, v152, v153
  v_cvt_pk_bf16_f32 v165, v154, v155
  s_waitcnt vmcnt(0)
  v_mfma_f32_16x16x32_bf16 v[8:11], v[72:75], v[156:159], 0
  v_mfma_f32_16x16x32_bf16 v[12:15], v[76:79], v[156:159], 0
  v_mfma_f32_16x16x32_bf16 v[16:19], v[80:83], v[156:159], 0
  v_mfma_f32_16x16x32_bf16 v[20:23], v[84:87], v[156:159], 0
  v_mfma_f32_16x16x32_bf16 v[24:27], v[88:91], v[156:159], 0
  v_mfma_f32_16x16x32_bf16 v[28:31], v[92:95], v[156:159], 0
  v_mfma_f32_16x16x32_bf16 v[32:35], v[96:99], v[156:159], 0
  v_mfma_f32_16x16x32_bf16 v[36:39], v[100:103], v[156:159], 0
  v_mfma_f32_16x16x16_bf16 v[8:11], v[120:121], v[160:161], v[8:11]
  v_mfma_f32_16x16x16_bf16 v[12:15], v[122:123], v[160:161], v[12:15]
  v_mfma_f32_16x16x16_bf16 v[16:19], v[124:125], v[160:161], v[16:19]
  v_mfma_f32_16x16x16_bf16 v[20:23], v[126:127], v[160:161], v[20:23]
  v_mfma_f32_16x16x16_bf16 v[24:27], v[128:129], v[160:161], v[24:27]
  v_mfma_f32_16x16x16_bf16 v[28:31], v[130:131], v[160:161], v[28:31]
  v_mfma_f32_16x16x16_bf16 v[32:35], v[132:133], v[160:161], v[32:35]
  v_mfma_f32_16x16x16_bf16 v[36:39], v[134:135], v[160:161], v[36:39]
  v_mfma_f32_16x16x32_bf16 v[40:43], v[72:75], v[162:165], 0
  v_mfma_f32_16x16x32_bf16 v[44:47], v[76:79], v[162:165], 0
  v_mfma_f32_16x16x32_bf16 v[48:51], v[80:83], v[162:165], 0
  v_mfma_f32_16x16x32_bf16 v[52:55], v[84:87], v[162:165], 0
  v_mfma_f32_16x16x32_bf16 v[56:59], v[88:91], v[162:165], 0
  v_mfma_f32_16x16x32_bf16 v[60:63], v[92:95], v[162:165], 0
  v_mfma_f32_16x16x32_bf16 v[64:67], v[96:99], v[162:165], 0
  v_mfma_f32_16x16x32_bf16 v[68:71], v[100:103], v[162:165], 0
  v_mfma_f32_16x16x16_bf16 v[40:43], v[120:121], v[166:167], v[40:43]
  v_mfma_f32_16x16x16_bf16 v[44:47], v[122:123], v[166:167], v[44:47]
  v_mfma_f32_16x16x16_bf16 v[48:51], v[124:125], v[166:167], v[48:51]
  v_mfma_f32_16x16x16_bf16 v[52:55], v[126:127], v[166:167], v[52:55]
  v_mfma_f32_16x16x16_bf16 v[56:59], v[128:129], v[166:167], v[56:59]
  v_mfma_f32_16x16x16_bf16 v[60:63], v[130:131], v[166:167], v[60:63]
  v_mfma_f32_16x16x16_bf16 v[64:67], v[132:133], v[166:167], v[64:67]
  v_mfma_f32_16x16x16_bf16 v[68:71], v[134:135], v[166:167], v[68:71]
  v_cvt_pk_bf16_f32 v136, v8, v9
  v_cvt_pk_bf16_f32 v137, v10, v11
  v_cvt_pk_bf16_f32 v138, v12, v13
  v_cvt_pk_bf16_f32 v139, v14, v15
  buffer_store_dwordx4 v[136:139], v2, s[4:7], s95 offen offset:0
  v_cvt_pk_bf16_f32 v140, v16, v17
  v_cvt_pk_bf16_f32 v141, v18, v19
  v_cvt_pk_bf16_f32 v142, v20, v21
  v_cvt_pk_bf16_f32 v143, v22, v23
  buffer_store_dwordx4 v[140:143], v2, s[4:7], s95 offen offset:1024
  v_cvt_pk_bf16_f32 v144, v24, v25
  v_cvt_pk_bf16_f32 v145, v26, v27
  v_cvt_pk_bf16_f32 v146, v28, v29
  v_cvt_pk_bf16_f32 v147, v30, v31
  buffer_store_dwordx4 v[144:147], v2, s[4:7], s95 offen offset:2048
  v_cvt_pk_bf16_f32 v148, v32, v33
  v_cvt_pk_bf16_f32 v149, v34, v35
  v_cvt_pk_bf16_f32 v150, v36, v37
  v_cvt_pk_bf16_f32 v151, v38, v39
  buffer_store_dwordx4 v[148:151], v2, s[4:7], s95 offen offset:3072
  v_cvt_pk_bf16_f32 v136, v40, v41
  v_cvt_pk_bf16_f32 v137, v42, v43
  v_cvt_pk_bf16_f32 v138, v44, v45
  v_cvt_pk_bf16_f32 v139, v46, v47
  buffer_store_dwordx4 v[136:139], v3, s[4:7], s95 offen offset:0
  v_cvt_pk_bf16_f32 v140, v48, v49
  v_cvt_pk_bf16_f32 v141, v50, v51
  v_cvt_pk_bf16_f32 v142, v52, v53
  v_cvt_pk_bf16_f32 v143, v54, v55
  buffer_store_dwordx4 v[140:143], v3, s[4:7], s95 offen offset:1024
  v_cvt_pk_bf16_f32 v144, v56, v57
  v_cvt_pk_bf16_f32 v145, v58, v59
  v_cvt_pk_bf16_f32 v146, v60, v61
  v_cvt_pk_bf16_f32 v147, v62, v63
  buffer_store_dwordx4 v[144:147], v3, s[4:7], s95 offen offset:2048
  v_cvt_pk_bf16_f32 v148, v64, v65
  v_cvt_pk_bf16_f32 v149, v66, v67
  v_cvt_pk_bf16_f32 v150, v68, v69
  v_cvt_pk_bf16_f32 v151, v70, v71
  buffer_store_dwordx4 v[148:151], v3, s[4:7], s95 offen offset:3072
  s_endpgm
L_k3_B:
  s_sub_u32 s85, s85, 2048
  s_lshl_b32 s90, s85, 13
  s_sub_u32 s91, s90, 65536
  s_cmp_lt_u32 s85, 8
  s_cselect_b32 s91, s90, s91
  v_mov_b32 v2, 0x0
  v_bfe_u32 v7, v1, 0, 6
  v_lshl_add_u32 v2, v7, 4, v2
  v_add_u32 v3, 4096, v2
  s_add_u32 s92, s90, 67108864
  s_add_u32 s93, s90, 71303168
  s_add_u32 s94, s91, 71303168
  s_add_u32 s95, s90, 75497472
  s_add_u32 s96, s91, 75497472
  s_add_u32 s97, s90, 100663296
  buffer_load_dwordx4 v[8:11], v2, s[4:7], s92 offen offset:0
  buffer_load_dwordx4 v[12:15], v2, s[4:7], s92 offen offset:1024
  buffer_load_dwordx4 v[16:19], v2, s[4:7], s92 offen offset:2048
  buffer_load_dwordx4 v[20:23], v2, s[4:7], s92 offen offset:3072
  buffer_load_dwordx4 v[24:27], v3, s[4:7], s92 offen offset:0
  buffer_load_dwordx4 v[28:31], v3, s[4:7], s92 offen offset:1024
  buffer_load_dwordx4 v[32:35], v3, s[4:7], s92 offen offset:2048
  buffer_load_dwordx4 v[36:39], v3, s[4:7], s92 offen offset:3072
  buffer_load_dwordx4 v[40:43], v3, s[4:7], s94 offen offset:0
  buffer_load_dwordx4 v[44:47], v3, s[4:7], s94 offen offset:1024
  buffer_load_dwordx4 v[48:51], v3, s[4:7], s94 offen offset:2048
  buffer_load_dwordx4 v[52:55], v3, s[4:7], s94 offen offset:3072
  buffer_load_dwordx4 v[56:59], v2, s[4:7], s93 offen offset:0
  buffer_load_dwordx4 v[60:63], v2, s[4:7], s93 offen offset:1024
  buffer_load_dwordx4 v[64:67], v2, s[4:7], s93 offen offset:2048
  buffer_load_dwordx4 v[68:71], v2, s[4:7], s93 offen offset:3072
  buffer_load_dwordx4 v[72:75], v3, s[4:7], s93 offen offset:0
  buffer_load_dwordx4 v[76:79], v3, s[4:7], s93 offen offset:1024
  buffer_load_dwordx4 v[80:83], v3, s[4:7], s93 offen offset:2048
  buffer_load_dwordx4 v[84:87], v3, s[4:7], s93 offen offset:3072
  buffer_load_dwordx2 v[88:89], v2, s[4:7], s96 offen offset:8
  buffer_load_dwordx2 v[94:95], v2, s[4:7], s96 offen offset:1032
  buffer_load_dwordx2 v[100:101], v2, s[4:7], s96 offen offset:2056
  buffer_load_dwordx2 v[106:107], v2, s[4:7], s96 offen offset:3080
  buffer_load_dwordx2 v[112:113], v3, s[4:7], s96 offen offset:8
  buffer_load_dwordx2 v[118:119], v3, s[4:7], s96 offen offset:1032
  buffer_load_dwordx2 v[124:125], v3, s[4:7], s96 offen offset:2056
  buffer_load_dwordx2 v[130:131], v3, s[4:7], s96 offen offset:3080
  buffer_load_dwordx4 v[90:93], v2, s[4:7], s95 offen offset:0
  buffer_load_dwordx4 v[96:99], v2, s[4:7], s95 offen offset:1024
  buffer_load_dwordx4 v[102:105], v2, s[4:7], s95 offen offset:2048
  buffer_load_dwordx4 v[108:111], v2, s[4:7], s95 offen offset:3072
  buffer_load_dwordx4 v[114:117], v3, s[4:7], s95 offen offset:0
  buffer_load_dwordx4 v[120:123], v3, s[4:7], s95 offen offset:1024
  buffer_load_dwordx4 v[126:129], v3, s[4:7], s95 offen offset:2048
  buffer_load_dwordx4 v[132:135], v3, s[4:7], s95 offen offset:3072
  s_mov_b32 s40, 0x50000
  s_mov_b32 s41, 0x5550055
  s_mov_b32 s42, 0xa0000
  s_mov_b32 s43, 0xaaa00aa
  s_mov_b32 s44, 0x150001
  s_mov_b32 s45, 0x15550155
  s_mov_b32 s46, 0x2a0002
  s_mov_b32 s47, 0x2aaa02aa
  s_mov_b32 s48, 0x55505555
  s_mov_b32 s49, 0x50005500
  s_mov_b32 s50, 0xaaa0aaaa
  s_mov_b32 s51, 0xa000aa00
  s_mov_b32 s52, 0x55405554
  s_mov_b32 s53, 0x40005400
  s_mov_b32 s54, 0xaa80aaa8
  s_mov_b32 s55, 0x8000a800
  s_cmp_lt_u32 s85, 8
  s_cselect_b64 s[56:57], 0, s[40:41]
  s_cselect_b64 s[58:59], 0, s[42:43]
  s_cselect_b64 s[60:61], 0, s[44:45]
  s_cselect_b64 s[62:63], 0, s[46:47]
  s_mov_b32 s64, 0x3e8293ee
  v_mov_b32 v6, 0xcfa8965f
  s_waitcnt vmcnt(16)
  v_mfma_f32_16x16x32_bf16 v[136:139], v[40:43], v[8:11], 0
  v_mfma_f32_16x16x32_bf16 v[140:143], v[56:59], v[8:11], 0
  v_mfma_f32_16x16x32_bf16 v[144:147], v[44:47], v[12:15], 0
  v_mfma_f32_16x16x32_bf16 v[148:151], v[60:63], v[12:15], 0
  v_mfma_f32_16x16x32_bf16 v[152:155], v[48:51], v[16:19], 0
  v_mfma_f32_16x16x32_bf16 v[156:159], v[64:67], v[16:19], 0
  v_mfma_f32_16x16x32_bf16 v[160:163], v[52:55], v[20:23], 0
  v_mfma_f32_16x16x32_bf16 v[164:167], v[68:71], v[20:23], 0
  v_mfma_f32_16x16x32_bf16 v[168:171], v[56:59], v[24:27], 0
  v_mfma_f32_16x16x32_bf16 v[172:175], v[72:75], v[24:27], 0
  v_mfma_f32_16x16x32_bf16 v[176:179], v[60:63], v[28:31], 0
  v_mfma_f32_16x16x32_bf16 v[180:183], v[76:79], v[28:31], 0
  v_mfma_f32_16x16x32_bf16 v[184:187], v[64:67], v[32:35], 0
  v_mfma_f32_16x16x32_bf16 v[188:191], v[80:83], v[32:35], 0
  v_mfma_f32_16x16x32_bf16 v[192:195], v[68:71], v[36:39], 0
  v_mfma_f32_16x16x32_bf16 v[196:199], v[84:87], v[36:39], 0
  v_cndmask_b32 v136, v6, v136, s[56:57]
  v_cndmask_b32 v137, v6, v137, s[58:59]
  v_cndmask_b32 v138, v6, v138, s[60:61]
  v_cndmask_b32 v139, v6, v139, s[62:63]
  v_cndmask_b32 v140, v6, v140, s[48:49]
  v_cndmask_b32 v141, v6, v141, s[50:51]
  v_cndmask_b32 v142, v6, v142, s[52:53]
  v_cndmask_b32 v143, v6, v143, s[54:55]
  v_max3_f32 v4, v136, v137, v138
  v_max3_f32 v4, v4, v139, v140
  v_max3_f32 v4, v4, v141, v142
  v_max_f32 v4, v4, v143
  v_mov_b32 v5, v4
  s_nop 1
  v_permlane32_swap_b32 v4, v5
  v_max_f32 v4, v4, v5
  v_mov_b32 v5, v4
  s_nop 1
  v_permlane16_swap_b32 v4, v5
  v_max_f32 v4, v4, v5
  v_mul_f32 v4, s64, v4
  v_fma_f32 v136, v136, s64, -v4
  v_fma_f32 v137, v137, s64, -v4
  v_fma_f32 v138, v138, s64, -v4
  v_fma_f32 v139, v139, s64, -v4
  v_fma_f32 v140, v140, s64, -v4
  v_fma_f32 v141, v141, s64, -v4
  v_fma_f32 v142, v142, s64, -v4
  v_fma_f32 v143, v143, s64, -v4
  v_exp_f32 v136, v136
  v_exp_f32 v137, v137
  v_exp_f32 v138, v138
  v_exp_f32 v139, v139
  v_exp_f32 v140, v140
  v_exp_f32 v141, v141
  v_exp_f32 v142, v142
  v_exp_f32 v143, v143
  v_add_f32 v4, v136, v137
  v_add_f32 v4, v4, v138
  v_add_f32 v4, v4, v139
  v_add_f32 v4, v4, v140
  v_add_f32 v4, v4, v141
  v_add_f32 v4, v4, v142
  v_add_f32 v4, v4, v143
  v_mov_b32 v5, v4
  s_nop 1
  v_permlane32_swap_b32 v4, v5
  v_add_f32 v4, v4, v5
  v_mov_b32 v5, v4
  s_nop 1
  v_permlane16_swap_b32 v4, v5
  v_add_f32 v4, v4, v5
  v_rcp_f32 v4, v4
  s_nop 0
  v_mul_f32 v136, v136, v4
  v_mul_f32 v137, v137, v4
  v_mul_f32 v138, v138, v4
  v_mul_f32 v139, v139, v4
  v_mul_f32 v140, v140, v4
  v_mul_f32 v141, v141, v4
  v_mul_f32 v142, v142, v4
  v_mul_f32 v143, v143, v4
  v_cvt_pk_bf16_f32 v8, v136, v137
  v_cvt_pk_bf16_f32 v9, v138, v139
  v_cvt_pk_bf16_f32 v10, v140, v141
  v_cvt_pk_bf16_f32 v11, v142, v143
  v_cndmask_b32 v144, v6, v144, s[56:57]
  v_cndmask_b32 v145, v6, v145, s[58:59]
  v_cndmask_b32 v146, v6, v146, s[60:61]
  v_cndmask_b32 v147, v6, v147, s[62:63]
  v_cndmask_b32 v148, v6, v148, s[48:49]
  v_cndmask_b32 v149, v6, v149, s[50:51]
  v_cndmask_b32 v150, v6, v150, s[52:53]
  v_cndmask_b32 v151, v6, v151, s[54:55]
  v_max3_f32 v4, v144, v145, v146
  v_max3_f32 v4, v4, v147, v148
  v_max3_f32 v4, v4, v149, v150
  v_max_f32 v4, v4, v151
  v_mov_b32 v5, v4
  s_nop 1
  v_permlane32_swap_b32 v4, v5
  v_max_f32 v4, v4, v5
  v_mov_b32 v5, v4
  s_nop 1
  v_permlane16_swap_b32 v4, v5
  v_max_f32 v4, v4, v5
  v_mul_f32 v4, s64, v4
  v_fma_f32 v144, v144, s64, -v4
  v_fma_f32 v145, v145, s64, -v4
  v_fma_f32 v146, v146, s64, -v4
  v_fma_f32 v147, v147, s64, -v4
  v_fma_f32 v148, v148, s64, -v4
  v_fma_f32 v149, v149, s64, -v4
  v_fma_f32 v150, v150, s64, -v4
  v_fma_f32 v151, v151, s64, -v4
  v_exp_f32 v144, v144
  v_exp_f32 v145, v145
  v_exp_f32 v146, v146
  v_exp_f32 v147, v147
  v_exp_f32 v148, v148
  v_exp_f32 v149, v149
  v_exp_f32 v150, v150
  v_exp_f32 v151, v151
  v_add_f32 v4, v144, v145
  v_add_f32 v4, v4, v146
  v_add_f32 v4, v4, v147
  v_add_f32 v4, v4, v148
  v_add_f32 v4, v4, v149
  v_add_f32 v4, v4, v150
  v_add_f32 v4, v4, v151
  v_mov_b32 v5, v4
  s_nop 1
  v_permlane32_swap_b32 v4, v5
  v_add_f32 v4, v4, v5
  v_mov_b32 v5, v4
  s_nop 1
  v_permlane16_swap_b32 v4, v5
  v_add_f32 v4, v4, v5
  v_rcp_f32 v4, v4
  s_nop 0
  v_mul_f32 v144, v144, v4
  v_mul_f32 v145, v145, v4
  v_mul_f32 v146, v146, v4
  v_mul_f32 v147, v147, v4
  v_mul_f32 v148, v148, v4
  v_mul_f32 v149, v149, v4
  v_mul_f32 v150, v150, v4
  v_mul_f32 v151, v151, v4
  v_cvt_pk_bf16_f32 v12, v144, v145
  v_cvt_pk_bf16_f32 v13, v146, v147
  v_cvt_pk_bf16_f32 v14, v148, v149
  v_cvt_pk_bf16_f32 v15, v150, v151
  v_cndmask_b32 v152, v6, v152, s[56:57]
  v_cndmask_b32 v153, v6, v153, s[58:59]
  v_cndmask_b32 v154, v6, v154, s[60:61]
  v_cndmask_b32 v155, v6, v155, s[62:63]
  v_cndmask_b32 v156, v6, v156, s[48:49]
  v_cndmask_b32 v157, v6, v157, s[50:51]
  v_cndmask_b32 v158, v6, v158, s[52:53]
  v_cndmask_b32 v159, v6, v159, s[54:55]
  v_max3_f32 v4, v152, v153, v154
  v_max3_f32 v4, v4, v155, v156
  v_max3_f32 v4, v4, v157, v158
  v_max_f32 v4, v4, v159
  v_mov_b32 v5, v4
  s_nop 1
  v_permlane32_swap_b32 v4, v5
  v_max_f32 v4, v4, v5
  v_mov_b32 v5, v4
  s_nop 1
  v_permlane16_swap_b32 v4, v5
  v_max_f32 v4, v4, v5
  v_mul_f32 v4, s64, v4
  v_fma_f32 v152, v152, s64, -v4
  v_fma_f32 v153, v153, s64, -v4
  v_fma_f32 v154, v154, s64, -v4
  v_fma_f32 v155, v155, s64, -v4
  v_fma_f32 v156, v156, s64, -v4
  v_fma_f32 v157, v157, s64, -v4
  v_fma_f32 v158, v158, s64, -v4
  v_fma_f32 v159, v159, s64, -v4
  v_exp_f32 v152, v152
  v_exp_f32 v153, v153
  v_exp_f32 v154, v154
  v_exp_f32 v155, v155
  v_exp_f32 v156, v156
  v_exp_f32 v157, v157
  v_exp_f32 v158, v158
  v_exp_f32 v159, v159
  v_add_f32 v4, v152, v153
  v_add_f32 v4, v4, v154
  v_add_f32 v4, v4, v155
  v_add_f32 v4, v4, v156
  v_add_f32 v4, v4, v157
  v_add_f32 v4, v4, v158
  v_add_f32 v4, v4, v159
  v_mov_b32 v5, v4
  s_nop 1
  v_permlane32_swap_b32 v4, v5
  v_add_f32 v4, v4, v5
  v_mov_b32 v5, v4
  s_nop 1
  v_permlane16_swap_b32 v4, v5
  v_add_f32 v4, v4, v5
  v_rcp_f32 v4, v4
  s_nop 0
  v_mul_f32 v152, v152, v4
  v_mul_f32 v153, v153, v4
  v_mul_f32 v154, v154, v4
  v_mul_f32 v155, v155, v4
  v_mul_f32 v156, v156, v4
  v_mul_f32 v157, v157, v4
  v_mul_f32 v158, v158, v4
  v_mul_f32 v159, v159, v4
  v_cvt_pk_bf16_f32 v16, v152, v153
  v_cvt_pk_bf16_f32 v17, v154, v155
  v_cvt_pk_bf16_f32 v18, v156, v157
  v_cvt_pk_bf16_f32 v19, v158, v159
  v_cndmask_b32 v160, v6, v160, s[56:57]
  v_cndmask_b32 v161, v6, v161, s[58:59]
  v_cndmask_b32 v162, v6, v162, s[60:61]
  v_cndmask_b32 v163, v6, v163, s[62:63]
  v_cndmask_b32 v164, v6, v164, s[48:49]
  v_cndmask_b32 v165, v6, v165, s[50:51]
  v_cndmask_b32 v166, v6, v166, s[52:53]
  v_cndmask_b32 v167, v6, v167, s[54:55]
  v_max3_f32 v4, v160, v161, v162
  v_max3_f32 v4, v4, v163, v164
  v_max3_f32 v4, v4, v165, v166
  v_max_f32 v4, v4, v167
  v_mov_b32 v5, v4
  s_nop 1
  v_permlane32_swap_b32 v4, v5
  v_max_f32 v4, v4, v5
  v_mov_b32 v5, v4
  s_nop 1
  v_permlane16_swap_b32 v4, v5
  v_max_f32 v4, v4, v5
  v_mul_f32 v4, s64, v4
  v_fma_f32 v160, v160, s64, -v4
  v_fma_f32 v161, v161, s64, -v4
  v_fma_f32 v162, v162, s64, -v4
  v_fma_f32 v163, v163, s64, -v4
  v_fma_f32 v164, v164, s64, -v4
  v_fma_f32 v165, v165, s64, -v4
  v_fma_f32 v166, v166, s64, -v4
  v_fma_f32 v167, v167, s64, -v4
  v_exp_f32 v160, v160
  v_exp_f32 v161, v161
  v_exp_f32 v162, v162
  v_exp_f32 v163, v163
  v_exp_f32 v164, v164
  v_exp_f32 v165, v165
  v_exp_f32 v166, v166
  v_exp_f32 v167, v167
  v_add_f32 v4, v160, v161
  v_add_f32 v4, v4, v162
  v_add_f32 v4, v4, v163
  v_add_f32 v4, v4, v164
  v_add_f32 v4, v4, v165
  v_add_f32 v4, v4, v166
  v_add_f32 v4, v4, v167
  v_mov_b32 v5, v4
  s_nop 1
  v_permlane32_swap_b32 v4, v5
  v_add_f32 v4, v4, v5
  v_mov_b32 v5, v4
  s_nop 1
  v_permlane16_swap_b32 v4, v5
  v_add_f32 v4, v4, v5
  v_rcp_f32 v4, v4
  s_nop 0
  v_mul_f32 v160, v160, v4
  v_mul_f32 v161, v161, v4
  v_mul_f32 v162, v162, v4
  v_mul_f32 v163, v163, v4
  v_mul_f32 v164, v164, v4
  v_mul_f32 v165, v165, v4
  v_mul_f32 v166, v166, v4
  v_mul_f32 v167, v167, v4
  v_cvt_pk_bf16_f32 v20, v160, v161
  v_cvt_pk_bf16_f32 v21, v162, v163
  v_cvt_pk_bf16_f32 v22, v164, v165
  v_cvt_pk_bf16_f32 v23, v166, v167
  v_cndmask_b32 v168, v6, v168, s[40:41]
  v_cndmask_b32 v169, v6, v169, s[42:43]
  v_cndmask_b32 v170, v6, v170, s[44:45]
  v_cndmask_b32 v171, v6, v171, s[46:47]
  v_cndmask_b32 v172, v6, v172, s[48:49]
  v_cndmask_b32 v173, v6, v173, s[50:51]
  v_cndmask_b32 v174, v6, v174, s[52:53]
  v_cndmask_b32 v175, v6, v175, s[54:55]
  v_max3_f32 v4, v168, v169, v170
  v_max3_f32 v4, v4, v171, v172
  v_max3_f32 v4, v4, v173, v174
  v_max_f32 v4, v4, v175
  v_mov_b32 v5, v4
  s_nop 1
  v_permlane32_swap_b32 v4, v5
  v_max_f32 v4, v4, v5
  v_mov_b32 v5, v4
  s_nop 1
  v_permlane16_swap_b32 v4, v5
  v_max_f32 v4, v4, v5
  v_mul_f32 v4, s64, v4
  v_fma_f32 v168, v168, s64, -v4
  v_fma_f32 v169, v169, s64, -v4
  v_fma_f32 v170, v170, s64, -v4
  v_fma_f32 v171, v171, s64, -v4
  v_fma_f32 v172, v172, s64, -v4
  v_fma_f32 v173, v173, s64, -v4
  v_fma_f32 v174, v174, s64, -v4
  v_fma_f32 v175, v175, s64, -v4
  v_exp_f32 v168, v168
  v_exp_f32 v169, v169
  v_exp_f32 v170, v170
  v_exp_f32 v171, v171
  v_exp_f32 v172, v172
  v_exp_f32 v173, v173
  v_exp_f32 v174, v174
  v_exp_f32 v175, v175
  v_add_f32 v4, v168, v169
  v_add_f32 v4, v4, v170
  v_add_f32 v4, v4, v171
  v_add_f32 v4, v4, v172
  v_add_f32 v4, v4, v173
  v_add_f32 v4, v4, v174
  v_add_f32 v4, v4, v175
  v_mov_b32 v5, v4
  s_nop 1
  v_permlane32_swap_b32 v4, v5
  v_add_f32 v4, v4, v5
  v_mov_b32 v5, v4
  s_nop 1
  v_permlane16_swap_b32 v4, v5
  v_add_f32 v4, v4, v5
  v_rcp_f32 v4, v4
  s_nop 0
  v_mul_f32 v168, v168, v4
  v_mul_f32 v169, v169, v4
  v_mul_f32 v170, v170, v4
  v_mul_f32 v171, v171, v4
  v_mul_f32 v172, v172, v4
  v_mul_f32 v173, v173, v4
  v_mul_f32 v174, v174, v4
  v_mul_f32 v175, v175, v4
  v_cvt_pk_bf16_f32 v24, v168, v169
  v_cvt_pk_bf16_f32 v25, v170, v171
  v_cvt_pk_bf16_f32 v26, v172, v173
  v_cvt_pk_bf16_f32 v27, v174, v175
  v_cndmask_b32 v176, v6, v176, s[40:41]
  v_cndmask_b32 v177, v6, v177, s[42:43]
  v_cndmask_b32 v178, v6, v178, s[44:45]
  v_cndmask_b32 v179, v6, v179, s[46:47]
  v_cndmask_b32 v180, v6, v180, s[48:49]
  v_cndmask_b32 v181, v6, v181, s[50:51]
  v_cndmask_b32 v182, v6, v182, s[52:53]
  v_cndmask_b32 v183, v6, v183, s[54:55]
  v_max3_f32 v4, v176, v177, v178
  v_max3_f32 v4, v4, v179, v180
  v_max3_f32 v4, v4, v181, v182
  v_max_f32 v4, v4, v183
  v_mov_b32 v5, v4
  s_nop 1
  v_permlane32_swap_b32 v4, v5
  v_max_f32 v4, v4, v5
  v_mov_b32 v5, v4
  s_nop 1
  v_permlane16_swap_b32 v4, v5
  v_max_f32 v4, v4, v5
  v_mul_f32 v4, s64, v4
  v_fma_f32 v176, v176, s64, -v4
  v_fma_f32 v177, v177, s64, -v4
  v_fma_f32 v178, v178, s64, -v4
  v_fma_f32 v179, v179, s64, -v4
  v_fma_f32 v180, v180, s64, -v4
  v_fma_f32 v181, v181, s64, -v4
  v_fma_f32 v182, v182, s64, -v4
  v_fma_f32 v183, v183, s64, -v4
  v_exp_f32 v176, v176
  v_exp_f32 v177, v177
  v_exp_f32 v178, v178
  v_exp_f32 v179, v179
  v_exp_f32 v180, v180
  v_exp_f32 v181, v181
  v_exp_f32 v182, v182
  v_exp_f32 v183, v183
  v_add_f32 v4, v176, v177
  v_add_f32 v4, v4, v178
  v_add_f32 v4, v4, v179
  v_add_f32 v4, v4, v180
  v_add_f32 v4, v4, v181
  v_add_f32 v4, v4, v182
  v_add_f32 v4, v4, v183
  v_mov_b32 v5, v4
  s_nop 1
  v_permlane32_swap_b32 v4, v5
  v_add_f32 v4, v4, v5
  v_mov_b32 v5, v4
  s_nop 1
  v_permlane16_swap_b32 v4, v5
  v_add_f32 v4, v4, v5
  v_rcp_f32 v4, v4
  s_nop 0
  v_mul_f32 v176, v176, v4
  v_mul_f32 v177, v177, v4
  v_mul_f32 v178, v178, v4
  v_mul_f32 v179, v179, v4
  v_mul_f32 v180, v180, v4
  v_mul_f32 v181, v181, v4
  v_mul_f32 v182, v182, v4
  v_mul_f32 v183, v183, v4
  v_cvt_pk_bf16_f32 v28, v176, v177
  v_cvt_pk_bf16_f32 v29, v178, v179
  v_cvt_pk_bf16_f32 v30, v180, v181
  v_cvt_pk_bf16_f32 v31, v182, v183
  v_cndmask_b32 v184, v6, v184, s[40:41]
  v_cndmask_b32 v185, v6, v185, s[42:43]
  v_cndmask_b32 v186, v6, v186, s[44:45]
  v_cndmask_b32 v187, v6, v187, s[46:47]
  v_cndmask_b32 v188, v6, v188, s[48:49]
  v_cndmask_b32 v189, v6, v189, s[50:51]
  v_cndmask_b32 v190, v6, v190, s[52:53]
  v_cndmask_b32 v191, v6, v191, s[54:55]
  v_max3_f32 v4, v184, v185, v186
  v_max3_f32 v4, v4, v187, v188
  v_max3_f32 v4, v4, v189, v190
  v_max_f32 v4, v4, v191
  v_mov_b32 v5, v4
  s_nop 1
  v_permlane32_swap_b32 v4, v5
  v_max_f32 v4, v4, v5
  v_mov_b32 v5, v4
  s_nop 1
  v_permlane16_swap_b32 v4, v5
  v_max_f32 v4, v4, v5
  v_mul_f32 v4, s64, v4
  v_fma_f32 v184, v184, s64, -v4
  v_fma_f32 v185, v185, s64, -v4
  v_fma_f32 v186, v186, s64, -v4
  v_fma_f32 v187, v187, s64, -v4
  v_fma_f32 v188, v188, s64, -v4
  v_fma_f32 v189, v189, s64, -v4
  v_fma_f32 v190, v190, s64, -v4
  v_fma_f32 v191, v191, s64, -v4
  v_exp_f32 v184, v184
  v_exp_f32 v185, v185
  v_exp_f32 v186, v186
  v_exp_f32 v187, v187
  v_exp_f32 v188, v188
  v_exp_f32 v189, v189
  v_exp_f32 v190, v190
  v_exp_f32 v191, v191
  v_add_f32 v4, v184, v185
  v_add_f32 v4, v4, v186
  v_add_f32 v4, v4, v187
  v_add_f32 v4, v4, v188
  v_add_f32 v4, v4, v189
  v_add_f32 v4, v4, v190
  v_add_f32 v4, v4, v191
  v_mov_b32 v5, v4
  s_nop 1
  v_permlane32_swap_b32 v4, v5
  v_add_f32 v4, v4, v5
  v_mov_b32 v5, v4
  s_nop 1
  v_permlane16_swap_b32 v4, v5
  v_add_f32 v4, v4, v5
  v_rcp_f32 v4, v4
  s_nop 0
  v_mul_f32 v184, v184, v4
  v_mul_f32 v185, v185, v4
  v_mul_f32 v186, v186, v4
  v_mul_f32 v187, v187, v4
  v_mul_f32 v188, v188, v4
  v_mul_f32 v189, v189, v4
  v_mul_f32 v190, v190, v4
  v_mul_f32 v191, v191, v4
  v_cvt_pk_bf16_f32 v32, v184, v185
  v_cvt_pk_bf16_f32 v33, v186, v187
  v_cvt_pk_bf16_f32 v34, v188, v189
  v_cvt_pk_bf16_f32 v35, v190, v191
  v_cndmask_b32 v192, v6, v192, s[40:41]
  v_cndmask_b32 v193, v6, v193, s[42:43]
  v_cndmask_b32 v194, v6, v194, s[44:45]
  v_cndmask_b32 v195, v6, v195, s[46:47]
  v_cndmask_b32 v196, v6, v196, s[48:49]
  v_cndmask_b32 v197, v6, v197, s[50:51]
  v_cndmask_b32 v198, v6, v198, s[52:53]
  v_cndmask_b32 v199, v6, v199, s[54:55]
  v_max3_f32 v4, v192, v193, v194
  v_max3_f32 v4, v4, v195, v196
  v_max3_f32 v4, v4, v197, v198
  v_max_f32 v4, v4, v199
  v_mov_b32 v5, v4
  s_nop 1
  v_permlane32_swap_b32 v4, v5
  v_max_f32 v4, v4, v5
  v_mov_b32 v5, v4
  s_nop 1
  v_permlane16_swap_b32 v4, v5
  v_max_f32 v4, v4, v5
  v_mul_f32 v4, s64, v4
  v_fma_f32 v192, v192, s64, -v4
  v_fma_f32 v193, v193, s64, -v4
  v_fma_f32 v194, v194, s64, -v4
  v_fma_f32 v195, v195, s64, -v4
  v_fma_f32 v196, v196, s64, -v4
  v_fma_f32 v197, v197, s64, -v4
  v_fma_f32 v198, v198, s64, -v4
  v_fma_f32 v199, v199, s64, -v4
  v_exp_f32 v192, v192
  v_exp_f32 v193, v193
  v_exp_f32 v194, v194
  v_exp_f32 v195, v195
  v_exp_f32 v196, v196
  v_exp_f32 v197, v197
  v_exp_f32 v198, v198
  v_exp_f32 v199, v199
  v_add_f32 v4, v192, v193
  v_add_f32 v4, v4, v194
  v_add_f32 v4, v4, v195
  v_add_f32 v4, v4, v196
  v_add_f32 v4, v4, v197
  v_add_f32 v4, v4, v198
  v_add_f32 v4, v4, v199
  v_mov_b32 v5, v4
  s_nop 1
  v_permlane32_swap_b32 v4, v5
  v_add_f32 v4, v4, v5
  v_mov_b32 v5, v4
  s_nop 1
  v_permlane16_swap_b32 v4, v5
  v_add_f32 v4, v4, v5
  v_rcp_f32 v4, v4
  s_nop 0
  v_mul_f32 v192, v192, v4
  v_mul_f32 v193, v193, v4
  v_mul_f32 v194, v194, v4
  v_mul_f32 v195, v195, v4
  v_mul_f32 v196, v196, v4
  v_mul_f32 v197, v197, v4
  v_mul_f32 v198, v198, v4
  v_mul_f32 v199, v199, v4
  v_cvt_pk_bf16_f32 v36, v192, v193
  v_cvt_pk_bf16_f32 v37, v194, v195
  v_cvt_pk_bf16_f32 v38, v196, v197
  v_cvt_pk_bf16_f32 v39, v198, v199
  s_waitcnt vmcnt(0)
  v_mfma_f32_16x16x32_bf16 v[136:139], v[88:91], v[8:11], 0
  v_mfma_f32_16x16x32_bf16 v[140:143], v[94:97], v[8:11], 0
  v_mfma_f32_16x16x32_bf16 v[144:147], v[100:103], v[12:15], 0
  v_mfma_f32_16x16x32_bf16 v[148:151], v[106:109], v[12:15], 0
  v_mfma_f32_16x16x32_bf16 v[152:155], v[112:115], v[16:19], 0
  v_mfma_f32_16x16x32_bf16 v[156:159], v[118:121], v[16:19], 0
  v_mfma_f32_16x16x32_bf16 v[160:163], v[124:127], v[20:23], 0
  v_mfma_f32_16x16x32_bf16 v[164:167], v[130:133], v[20:23], 0
  v_mfma_f32_16x16x32_bf16 v[168:171], v[90:93], v[24:27], 0
  v_mfma_f32_16x16x32_bf16 v[172:175], v[96:99], v[24:27], 0
  v_mfma_f32_16x16x32_bf16 v[176:179], v[102:105], v[28:31], 0
  v_mfma_f32_16x16x32_bf16 v[180:183], v[108:111], v[28:31], 0
  v_mfma_f32_16x16x32_bf16 v[184:187], v[114:117], v[32:35], 0
  v_mfma_f32_16x16x32_bf16 v[188:191], v[120:123], v[32:35], 0
  v_mfma_f32_16x16x32_bf16 v[192:195], v[126:129], v[36:39], 0
  v_mfma_f32_16x16x32_bf16 v[196:199], v[132:135], v[36:39], 0
  v_cvt_pk_bf16_f32 v40, v136, v137
  v_cvt_pk_bf16_f32 v41, v138, v139
  v_cvt_pk_bf16_f32 v42, v140, v141
  v_cvt_pk_bf16_f32 v43, v142, v143
  buffer_store_dwordx4 v[40:43], v2, s[4:7], s97 offen offset:0
  v_cvt_pk_bf16_f32 v44, v144, v145
  v_cvt_pk_bf16_f32 v45, v146, v147
  v_cvt_pk_bf16_f32 v46, v148, v149
  v_cvt_pk_bf16_f32 v47, v150, v151
  buffer_store_dwordx4 v[44:47], v2, s[4:7], s97 offen offset:1024
  v_cvt_pk_bf16_f32 v48, v152, v153
  v_cvt_pk_bf16_f32 v49, v154, v155
  v_cvt_pk_bf16_f32 v50, v156, v157
  v_cvt_pk_bf16_f32 v51, v158, v159
  buffer_store_dwordx4 v[48:51], v2, s[4:7], s97 offen offset:2048
  v_cvt_pk_bf16_f32 v52, v160, v161
  v_cvt_pk_bf16_f32 v53, v162, v163
  v_cvt_pk_bf16_f32 v54, v164, v165
  v_cvt_pk_bf16_f32 v55, v166, v167
  buffer_store_dwordx4 v[52:55], v2, s[4:7], s97 offen offset:3072
  v_cvt_pk_bf16_f32 v56, v168, v169
  v_cvt_pk_bf16_f32 v57, v170, v171
  v_cvt_pk_bf16_f32 v58, v172, v173
  v_cvt_pk_bf16_f32 v59, v174, v175
  buffer_store_dwordx4 v[56:59], v3, s[4:7], s97 offen offset:0
  v_cvt_pk_bf16_f32 v60, v176, v177
  v_cvt_pk_bf16_f32 v61, v178, v179
  v_cvt_pk_bf16_f32 v62, v180, v181
  v_cvt_pk_bf16_f32 v63, v182, v183
  buffer_store_dwordx4 v[60:63], v3, s[4:7], s97 offen offset:1024
  v_cvt_pk_bf16_f32 v64, v184, v185
  v_cvt_pk_bf16_f32 v65, v186, v187
  v_cvt_pk_bf16_f32 v66, v188, v189
  v_cvt_pk_bf16_f32 v67, v190, v191
  buffer_store_dwordx4 v[64:67], v3, s[4:7], s97 offen offset:2048
  v_cvt_pk_bf16_f32 v68, v192, v193
  v_cvt_pk_bf16_f32 v69, v194, v195
  v_cvt_pk_bf16_f32 v70, v196, v197
  v_cvt_pk_bf16_f32 v71, v198, v199
  buffer_store_dwordx4 v[68:71], v3, s[4:7], s97 offen offset:3072
L_k3_end:
  s_endpgm
.globl outp_kernel
.p2align 8
.type outp_kernel,@function
outp_kernel:
  s_cmp_ge_u32 s2, 256
  s_cbranch_scc1 L_k4_end
  s_load_dwordx2 s[64:65], s[0:1], 40
  s_load_dwordx4 s[68:71], s[0:1], 72
  s_load_dwordx2 s[82:83], s[0:1], 96
  s_waitcnt lgkmcnt(0)
  s_mov_b32 s8, s82
  s_and_b32 s9, s83, 0xffff
  s_mov_b32 s10, 0x10000000
  s_mov_b32 s11, 0x20000
  s_mov_b32 s16, s70
  s_and_b32 s17, s71, 0xffff
  s_mov_b32 s18, 0x800000
  s_mov_b32 s19, 0x20000
  s_and_b32 s86, s2, 7
  s_lshr_b32 s85, s2, 3
  s_and_b32 s85, s85, 15
  s_mov_b32 s24, 2048
  s_mov_b32 s26, 4096
  s_lshl_b32 s21, s86, 8
  s_lshl_b32 s22, s85, 19
  s_add_u32 s22, s22, s21
  s_cmp_ge_u32 s2, 128
  s_cbranch_scc1 L_k4_B
  s_mov_b32 s12, s64
  s_and_b32 s13, s65, 0xffff
  s_mov_b32 s14, 0x800000
  s_mov_b32 s15, 0x20000
  s_mov_b32 s23, 262144
  s_mov_b32 s25, 32
  s_lshl_b32 s20, s85, 20
  s_add_u32 s20, s20, 0x5000000
  s_branch L_k4_go
L_k4_B:
  s_mov_b32 s12, s68
  s_and_b32 s13, s69, 0xffff
  s_mov_b32 s14, 0x200000
  s_mov_b32 s15, 0x20000
  s_mov_b32 s23, 65536
  s_mov_b32 s25, 8
  s_lshl_b32 s20, s85, 18
  s_add_u32 s20, s20, 0x6000000
  s_add_u32 s22, s22, 2048
L_k4_go:
  v_and_b32 v1, 63, v0
  v_lshrrev_b32 v22, 6, v0
  s_nop 0
  v_readfirstlane_b32 s27, v22
  s_mul_i32 s90, s27, 1
  s_mul_i32 s90, s90, s23
  v_mov_b32 v2, 0x0
  v_bfe_u32 v23, v1, 0, 6
  v_lshl_add_u32 v2, v23, 4, v2
  v_add_u32 v2, s90, v2
  v_mov_b32 v3, 0x400
  v_bfe_u32 v23, v1, 0, 6
  v_lshl_add_u32 v3, v23, 4, v3
  v_add_u32 v3, s90, v3
  v_mov_b32 v4, 0x1000
  v_bfe_u32 v23, v1, 0, 6
  v_lshl_add_u32 v4, v23, 4, v4
  v_add_u32 v4, s90, v4
  v_mov_b32 v5, 0x1400
  v_bfe_u32 v23, v1, 0, 6
  v_lshl_add_u32 v5, v23, 4, v5
  v_add_u32 v5, s90, v5
  s_mul_i32 s90, s27, 16
  v_lshrrev_b32 v22, 4, v1
  v_add_u32 v22, 0, v22
  v_and_b32 v23, 3, v22
  v_lshlrev_b32 v23, 2, v23
  v_xor_b32 v23, v23, v1
  v_and_b32 v23, 15, v23
  v_add_u32 v22, s90, v22
  v_mul_lo_u32 v22, v22, s24
  v_lshl_add_u32 v6, v23, 4, v22
  v_lshrrev_b32 v22, 4, v1
  v_add_u32 v22, 4, v22
  v_and_b32 v23, 3, v22
  v_lshlrev_b32 v23, 2, v23
  v_xor_b32 v23, v23, v1
  v_and_b32 v23, 15, v23
  v_add_u32 v22, s90, v22
  v_mul_lo_u32 v22, v22, s24
  v_lshl_add_u32 v7, v23, 4, v22
  v_lshrrev_b32 v22, 4, v1
  v_add_u32 v22, 8, v22
  v_and_b32 v23, 3, v22
  v_lshlrev_b32 v23, 2, v23
  v_xor_b32 v23, v23, v1
  v_and_b32 v23, 15, v23
  v_add_u32 v22, s90, v22
  v_mul_lo_u32 v22, v22, s24
  v_lshl_add_u32 v8, v23, 4, v22
  v_lshrrev_b32 v22, 4, v1
  v_add_u32 v22, 12, v22
  v_and_b32 v23, 3, v22
  v_lshlrev_b32 v23, 2, v23
  v_xor_b32 v23, v23, v1
  v_and_b32 v23, 15, v23
  v_add_u32 v22, s90, v22
  v_mul_lo_u32 v22, v22, s24
  v_lshl_add_u32 v9, v23, 4, v22
  s_lshl_b32 s28, s24, 6
  s_mul_i32 s29, s27, 4096
  s_mul_i32 s30, s27, 4096
  s_add_u32 s30, s30, 16384
  s_add_u32 m0, s29, 0
  s_nop 0
  buffer_load_dwordx4 v2, s[8:11], s20 offen lds
  s_add_u32 m0, s29, 1024
  s_nop 0
  buffer_load_dwordx4 v3, s[8:11], s20 offen lds
  s_add_u32 m0, s29, 2048
  s_nop 0
  buffer_load_dwordx4 v4, s[8:11], s20 offen lds
  s_add_u32 m0, s29, 3072
  s_nop 0
  buffer_load_dwordx4 v5, s[8:11], s20 offen lds
  s_add_u32 m0, s30, 0
  s_nop 0
  buffer_load_dwordx4 v6, s[12:15], s21 offen lds
  s_add_u32 m0, s30, 1024
  s_nop 0
  buffer_load_dwordx4 v7, s[12:15], s21 offen lds
  s_add_u32 m0, s30, 2048
  s_nop 0
  buffer_load_dwordx4 v8, s[12:15], s21 offen lds
  s_add_u32 m0, s30, 3072
  s_nop 0
  buffer_load_dwordx4 v9, s[12:15], s21 offen lds
  s_add_u32 s20, s20, 2048
  s_add_u32 s21, s21, s28
  s_add_u32 m0, s29, 32768
  s_nop 0
  buffer_load_dwordx4 v2, s[8:11], s20 offen lds
  s_add_u32 m0, s29, 33792
  s_nop 0
  buffer_load_dwordx4 v3, s[8:11], s20 offen lds
  s_add_u32 m0, s29, 34816
  s_nop 0
  buffer_load_dwordx4 v4, s[8:11], s20 offen lds
  s_add_u32 m0, s29, 35840
  s_nop 0
  buffer_load_dwordx4 v5, s[8:11], s20 offen lds
  s_add_u32 m0, s30, 32768
  s_nop 0
  buffer_load_dwordx4 v6, s[12:15], s21 offen lds
  s_add_u32 m0, s30, 33792
  s_nop 0
  buffer_load_dwordx4 v7, s[12:15], s21 offen lds
  s_add_u32 m0, s30, 34816
  s_nop 0
  buffer_load_dwordx4 v8, s[12:15], s21 offen lds
  s_add_u32 m0, s30, 35840
  s_nop 0
  buffer_load_dwordx4 v9, s[12:15], s21 offen lds
  s_add_u32 s20, s20, 6144
  s_add_u32 s21, s21, s28
  s_lshr_b32 s90, s27, 1
  s_and_b32 s91, s27, 1
  s_mul_i32 s92, s90, 8192
  v_mov_b32 v10, 0x0
  v_bfe_u32 v23, v1, 0, 4
  v_lshl_add_u32 v10, v23, 4, v10
  v_bfe_u32 v23, v1, 4, 1
  v_lshl_add_u32 v10, v23, 11, v10
  v_bfe_u32 v23, v1, 5, 1
  v_lshl_add_u32 v10, v23, 8, v10
  v_add_u32 v10, s92, v10
  v_add_u32 v14, 32768, v10
  v_mov_b32 v22, 0x4000
  v_bfe_u32 v23, v1, 2, 2
  v_lshl_add_u32 v22, v23, 8, v22
  v_bfe_u32 v23, v1, 5, 1
  v_lshl_add_u32 v22, v23, 10, v22
  v_bfe_u32 v23, v1, 0, 1
  v_lshl_add_u32 v22, v23, 5, v22
  v_bfe_u32 v23, v1, 4, 1
  v_lshl_add_u32 v22, v23, 4, v22
  v_bfe_u32 v23, v1, 1, 1
  v_lshl_add_u32 v22, v23, 3, v22
  s_mul_i32 s92, s91, 2
  s_add_u32 s93, s92, 0
  v_bfe_u32 v23, v1, 2, 2
  v_xor_b32 v23, s93, v23
  v_lshl_add_u32 v18, v23, 6, v22
  v_add_u32 v20, 32768, v18
  s_add_u32 s93, s92, 1
  v_bfe_u32 v23, v1, 2, 2
  v_xor_b32 v23, s93, v23
  v_lshl_add_u32 v19, v23, 6, v22
  v_add_u32 v21, 32768, v19
  v_accvgpr_write_b32 a0, 0
  v_accvgpr_write_b32 a1, 0
  v_accvgpr_write_b32 a2, 0
  v_accvgpr_write_b32 a3, 0
  v_accvgpr_write_b32 a4, 0
  v_accvgpr_write_b32 a5, 0
  v_accvgpr_write_b32 a6, 0
  v_accvgpr_write_b32 a7, 0
  v_accvgpr_write_b32 a8, 0
  v_accvgpr_write_b32 a9, 0
  v_accvgpr_write_b32 a10, 0
  v_accvgpr_write_b32 a11, 0
  v_accvgpr_write_b32 a12, 0
  v_accvgpr_write_b32 a13, 0
  v_accvgpr_write_b32 a14, 0
  v_accvgpr_write_b32 a15, 0
  v_accvgpr_write_b32 a16, 0
  v_accvgpr_write_b32 a17, 0
  v_accvgpr_write_b32 a18, 0
  v_accvgpr_write_b32 a19, 0
  v_accvgpr_write_b32 a20, 0
  v_accvgpr_write_b32 a21, 0
  v_accvgpr_write_b32 a22, 0
  v_accvgpr_write_b32 a23, 0
  v_accvgpr_write_b32 a24, 0
  v_accvgpr_write_b32 a25, 0
  v_accvgpr_write_b32 a26, 0
  v_accvgpr_write_b32 a27, 0
  v_accvgpr_write_b32 a28, 0
  v_accvgpr_write_b32 a29, 0
  v_accvgpr_write_b32 a30, 0
  v_accvgpr_write_b32 a31, 0
  v_accvgpr_write_b32 a32, 0
  v_accvgpr_write_b32 a33, 0
  v_accvgpr_write_b32 a34, 0
  v_accvgpr_write_b32 a35, 0
  v_accvgpr_write_b32 a36, 0
  v_accvgpr_write_b32 a37, 0
  v_accvgpr_write_b32 a38, 0
  v_accvgpr_write_b32 a39, 0
  v_accvgpr_write_b32 a40, 0
  v_accvgpr_write_b32 a41, 0
  v_accvgpr_write_b32 a42, 0
  v_accvgpr_write_b32 a43, 0
  v_accvgpr_write_b32 a44, 0
  v_accvgpr_write_b32 a45, 0
  v_accvgpr_write_b32 a46, 0
  v_accvgpr_write_b32 a47, 0
  v_accvgpr_write_b32 a48, 0
  v_accvgpr_write_b32 a49, 0
  v_accvgpr_write_b32 a50, 0
  v_accvgpr_write_b32 a51, 0
  v_accvgpr_write_b32 a52, 0
  v_accvgpr_write_b32 a53, 0
  v_accvgpr_write_b32 a54, 0
  v_accvgpr_write_b32 a55, 0
  v_accvgpr_write_b32 a56, 0
  v_accvgpr_write_b32 a57, 0
  v_accvgpr_write_b32 a58, 0
  v_accvgpr_write_b32 a59, 0
  v_accvgpr_write_b32 a60, 0
  v_accvgpr_write_b32 a61, 0
  v_accvgpr_write_b32 a62, 0
  v_accvgpr_write_b32 a63, 0
  s_waitcnt vmcnt(8)
  s_barrier
  ds_read_b128 v[28:31], v10 offset:0
  ds_read_b64_tr_b16 v[44:45], v18 offset:0
  ds_read_b64_tr_b16 v[46:47], v18 offset:4096
  ds_read_b128 v[32:35], v10 offset:4096
  ds_read_b64_tr_b16 v[48:49], v19 offset:0
  ds_read_b64_tr_b16 v[50:51], v19 offset:4096
  s_sub_u32 s25, s25, 1
  s_waitcnt lgkmcnt(0)
  v_mfma_f32_32x32x16_bf16 a[0:15], v[44:47], v[28:31], a[0:15]
  ds_read_b128 v[36:39], v10 offset:512
  ds_read_b64_tr_b16 v[52:53], v18 offset:2048
  v_mfma_f32_32x32x16_bf16 a[16:31], v[48:51], v[28:31], a[16:31]
  ds_read_b64_tr_b16 v[54:55], v18 offset:6144
  ds_read_b128 v[40:43], v10 offset:4608
  v_mfma_f32_32x32x16_bf16 a[32:47], v[44:47], v[32:35], a[32:47]
  ds_read_b64_tr_b16 v[56:57], v19 offset:2048
  ds_read_b64_tr_b16 v[58:59], v19 offset:6144
  v_mfma_f32_32x32x16_bf16 a[48:63], v[48:51], v[32:35], a[48:63]
  s_waitcnt lgkmcnt(0)
  v_mfma_f32_32x32x16_bf16 a[0:15], v[52:55], v[36:39], a[0:15]
  ds_read_b128 v[28:31], v10 offset:1024
  ds_read_b64_tr_b16 v[44:45], v18 offset:8192
  v_mfma_f32_32x32x16_bf16 a[16:31], v[56:59], v[36:39], a[16:31]
  ds_read_b64_tr_b16 v[46:47], v18 offset:12288
  ds_read_b128 v[32:35], v10 offset:5120
  v_mfma_f32_32x32x16_bf16 a[32:47], v[52:55], v[40:43], a[32:47]
  ds_read_b64_tr_b16 v[48:49], v19 offset:8192
  ds_read_b64_tr_b16 v[50:51], v19 offset:12288
  v_mfma_f32_32x32x16_bf16 a[48:63], v[56:59], v[40:43], a[48:63]
  s_waitcnt lgkmcnt(0)
  v_mfma_f32_32x32x16_bf16 a[0:15], v[44:47], v[28:31], a[0:15]
  ds_read_b128 v[36:39], v10 offset:1536
  ds_read_b64_tr_b16 v[52:53], v18 offset:10240
  v_mfma_f32_32x32x16_bf16 a[16:31], v[48:51], v[28:31], a[16:31]
  ds_read_b64_tr_b16 v[54:55], v18 offset:14336
  ds_read_b128 v[40:43], v10 offset:5632
  v_mfma_f32_32x32x16_bf16 a[32:47], v[44:47], v[32:35], a[32:47]
  ds_read_b64_tr_b16 v[56:57], v19 offset:10240
  ds_read_b64_tr_b16 v[58:59], v19 offset:14336
  v_mfma_f32_32x32x16_bf16 a[48:63], v[48:51], v[32:35], a[48:63]
  s_waitcnt lgkmcnt(0)
  v_mfma_f32_32x32x16_bf16 a[0:15], v[52:55], v[36:39], a[0:15]
  s_waitcnt vmcnt(0)
  s_barrier
  v_mfma_f32_32x32x16_bf16 a[16:31], v[56:59], v[36:39], a[16:31]
  ds_read_b128 v[28:31], v14 offset:0
  ds_read_b64_tr_b16 v[44:45], v20 offset:0
  s_add_u32 m0, s29, 0
  s_nop 0
  buffer_load_dwordx4 v2, s[8:11], s20 offen lds
  s_add_u32 m0, s29, 1024
  s_nop 0
  buffer_load_dwordx4 v3, s[8:11], s20 offen lds
  v_mfma_f32_32x32x16_bf16 a[32:47], v[52:55], v[40:43], a[32:47]
  ds_read_b64_tr_b16 v[46:47], v20 offset:4096
  ds_read_b128 v[32:35], v14 offset:4096
  s_add_u32 m0, s29, 2048
  s_nop 0
  buffer_load_dwordx4 v4, s[8:11], s20 offen lds
  v_mfma_f32_32x32x16_bf16 a[48:63], v[56:59], v[40:43], a[48:63]
  ds_read_b64_tr_b16 v[48:49], v21 offset:0
  ds_read_b64_tr_b16 v[50:51], v21 offset:4096
  s_add_u32 m0, s29, 3072
  s_nop 0
  buffer_load_dwordx4 v5, s[8:11], s20 offen lds
L_g3_loop:
  s_waitcnt lgkmcnt(0)
  v_mfma_f32_32x32x16_bf16 a[0:15], v[44:47], v[28:31], a[0:15]
  ds_read_b128 v[36:39], v14 offset:512
  ds_read_b64_tr_b16 v[52:53], v20 offset:2048
  s_add_u32 m0, s30, 0
  s_nop 0
  buffer_load_dwordx4 v6, s[12:15], s21 offen lds
  v_mfma_f32_32x32x16_bf16 a[16:31], v[48:51], v[28:31], a[16:31]
  ds_read_b64_tr_b16 v[54:55], v20 offset:6144
  ds_read_b128 v[40:43], v14 offset:4608
  s_add_u32 m0, s30, 1024
  s_nop 0
  buffer_load_dwordx4 v7, s[12:15], s21 offen lds
  v_mfma_f32_32x32x16_bf16 a[32:47], v[44:47], v[32:35], a[32:47]
  ds_read_b64_tr_b16 v[56:57], v21 offset:2048
  ds_read_b64_tr_b16 v[58:59], v21 offset:6144
  s_add_u32 m0, s30, 2048
  s_nop 0
  buffer_load_dwordx4 v8, s[12:15], s21 offen lds
  v_mfma_f32_32x32x16_bf16 a[48:63], v[48:51], v[32:35], a[48:63]
  s_add_u32 m0, s30, 3072
  s_nop 0
  buffer_load_dwordx4 v9, s[12:15], s21 offen lds
  s_waitcnt lgkmcnt(0)
  v_mfma_f32_32x32x16_bf16 a[0:15], v[52:55], v[36:39], a[0:15]
  ds_read_b128 v[28:31], v14 offset:1024
  ds_read_b64_tr_b16 v[44:45], v20 offset:8192
  s_add_u32 s20, s20, 2048
  s_add_u32 s21, s21, s28
  v_mfma_f32_32x32x16_bf16 a[16:31], v[56:59], v[36:39], a[16:31]
  ds_read_b64_tr_b16 v[46:47], v20 offset:12288
  ds_read_b128 v[32:35], v14 offset:5120
  v_mfma_f32_32x32x16_bf16 a[32:47], v[52:55], v[40:43], a[32:47]
  ds_read_b64_tr_b16 v[48:49], v21 offset:8192
  ds_read_b64_tr_b16 v[50:51], v21 offset:12288
  v_mfma_f32_32x32x16_bf16 a[48:63], v[56:59], v[40:43], a[48:63]
  s_waitcnt lgkmcnt(0)
  v_mfma_f32_32x32x16_bf16 a[0:15], v[44:47], v[28:31], a[0:15]
  ds_read_b128 v[36:39], v14 offset:1536
  ds_read_b64_tr_b16 v[52:53], v20 offset:10240
  v_mfma_f32_32x32x16_bf16 a[16:31], v[48:51], v[28:31], a[16:31]
  ds_read_b64_tr_b16 v[54:55], v20 offset:14336
  ds_read_b128 v[40:43], v14 offset:5632
  v_mfma_f32_32x32x16_bf16 a[32:47], v[44:47], v[32:35], a[32:47]
  ds_read_b64_tr_b16 v[56:57], v21 offset:10240
  ds_read_b64_tr_b16 v[58:59], v21 offset:14336
  v_mfma_f32_32x32x16_bf16 a[48:63], v[48:51], v[32:35], a[48:63]
  s_waitcnt lgkmcnt(0)
  v_mfma_f32_32x32x16_bf16 a[0:15], v[52:55], v[36:39], a[0:15]
  s_waitcnt vmcnt(0)
  s_barrier
  v_mfma_f32_32x32x16_bf16 a[16:31], v[56:59], v[36:39], a[16:31]
  ds_read_b128 v[28:31], v10 offset:0
  ds_read_b64_tr_b16 v[44:45], v18 offset:0
  s_add_u32 m0, s29, 32768
  s_nop 0
  buffer_load_dwordx4 v2, s[8:11], s20 offen lds
  s_add_u32 m0, s29, 33792
  s_nop 0
  buffer_load_dwordx4 v3, s[8:11], s20 offen lds
  v_mfma_f32_32x32x16_bf16 a[32:47], v[52:55], v[40:43], a[32:47]
  ds_read_b64_tr_b16 v[46:47], v18 offset:4096
  ds_read_b128 v[32:35], v10 offset:4096
  s_add_u32 m0, s29, 34816
  s_nop 0
  buffer_load_dwordx4 v4, s[8:11], s20 offen lds
  v_mfma_f32_32x32x16_bf16 a[48:63], v[56:59], v[40:43], a[48:63]
  ds_read_b64_tr_b16 v[48:49], v19 offset:0
  ds_read_b64_tr_b16 v[50:51], v19 offset:4096
  s_add_u32 m0, s29, 35840
  s_nop 0
  buffer_load_dwordx4 v5, s[8:11], s20 offen lds
  s_sub_u32 s25, s25, 1
  s_cmp_eq_u32 s25, 0
  s_cbranch_scc1 L_g3_fin
  s_waitcnt lgkmcnt(0)
  v_mfma_f32_32x32x16_bf16 a[0:15], v[44:47], v[28:31], a[0:15]
  ds_read_b128 v[36:39], v10 offset:512
  ds_read_b64_tr_b16 v[52:53], v18 offset:2048
  s_add_u32 m0, s30, 32768
  s_nop 0
  buffer_load_dwordx4 v6, s[12:15], s21 offen lds
  v_mfma_f32_32x32x16_bf16 a[16:31], v[48:51], v[28:31], a[16:31]
  ds_read_b64_tr_b16 v[54:55], v18 offset:6144
  ds_read_b128 v[40:43], v10 offset:4608
  s_add_u32 m0, s30, 33792
  s_nop 0
  buffer_load_dwordx4 v7, s[12:15], s21 offen lds
  v_mfma_f32_32x32x16_bf16 a[32:47], v[44:47], v[32:35], a[32:47]
  ds_read_b64_tr_b16 v[56:57], v19 offset:2048
  ds_read_b64_tr_b16 v[58:59], v19 offset:6144
  s_add_u32 m0, s30, 34816
  s_nop 0
  buffer_load_dwordx4 v8, s[12:15], s21 offen lds
  v_mfma_f32_32x32x16_bf16 a[48:63], v[48:51], v[32:35], a[48:63]
  s_add_u32 m0, s30, 35840
  s_nop 0
  buffer_load_dwordx4 v9, s[12:15], s21 offen lds
  s_waitcnt lgkmcnt(0)
  v_mfma_f32_32x32x16_bf16 a[0:15], v[52:55], v[36:39], a[0:15]
  ds_read_b128 v[28:31], v10 offset:1024
  ds_read_b64_tr_b16 v[44:45], v18 offset:8192
  s_add_u32 s20, s20, 6144
  s_add_u32 s21, s21, s28
  v_mfma_f32_32x32x16_bf16 a[16:31], v[56:59], v[36:39], a[16:31]
  ds_read_b64_tr_b16 v[46:47], v18 offset:12288
  ds_read_b128 v[32:35], v10 offset:5120
  v_mfma_f32_32x32x16_bf16 a[32:47], v[52:55], v[40:43], a[32:47]
  ds_read_b64_tr_b16 v[48:49], v19 offset:8192
  ds_read_b64_tr_b16 v[50:51], v19 offset:12288
  v_mfma_f32_32x32x16_bf16 a[48:63], v[56:59], v[40:43], a[48:63]
  s_waitcnt lgkmcnt(0)
  v_mfma_f32_32x32x16_bf16 a[0:15], v[44:47], v[28:31], a[0:15]
  ds_read_b128 v[36:39], v10 offset:1536
  ds_read_b64_tr_b16 v[52:53], v18 offset:10240
  v_mfma_f32_32x32x16_bf16 a[16:31], v[48:51], v[28:31], a[16:31]
  ds_read_b64_tr_b16 v[54:55], v18 offset:14336
  ds_read_b128 v[40:43], v10 offset:5632
  v_mfma_f32_32x32x16_bf16 a[32:47], v[44:47], v[32:35], a[32:47]
  ds_read_b64_tr_b16 v[56:57], v19 offset:10240
  ds_read_b64_tr_b16 v[58:59], v19 offset:14336
  v_mfma_f32_32x32x16_bf16 a[48:63], v[48:51], v[32:35], a[48:63]
  s_waitcnt lgkmcnt(0)
  v_mfma_f32_32x32x16_bf16 a[0:15], v[52:55], v[36:39], a[0:15]
  s_waitcnt vmcnt(0)
  s_barrier
  v_mfma_f32_32x32x16_bf16 a[16:31], v[56:59], v[36:39], a[16:31]
  ds_read_b128 v[28:31], v14 offset:0
  ds_read_b64_tr_b16 v[44:45], v20 offset:0
  s_add_u32 m0, s29, 0
  s_nop 0
  buffer_load_dwordx4 v2, s[8:11], s20 offen lds
  s_add_u32 m0, s29, 1024
  s_nop 0
  buffer_load_dwordx4 v3, s[8:11], s20 offen lds
  v_mfma_f32_32x32x16_bf16 a[32:47], v[52:55], v[40:43], a[32:47]
  ds_read_b64_tr_b16 v[46:47], v20 offset:4096
  ds_read_b128 v[32:35], v14 offset:4096
  s_add_u32 m0, s29, 2048
  s_nop 0
  buffer_load_dwordx4 v4, s[8:11], s20 offen lds
  v_mfma_f32_32x32x16_bf16 a[48:63], v[56:59], v[40:43], a[48:63]
  ds_read_b64_tr_b16 v[48:49], v21 offset:0
  ds_read_b64_tr_b16 v[50:51], v21 offset:4096
  s_add_u32 m0, s29, 3072
  s_nop 0
  buffer_load_dwordx4 v5, s[8:11], s20 offen lds
  s_branch L_g3_loop
L_g3_fin:
  s_waitcnt lgkmcnt(0)
  v_mfma_f32_32x32x16_bf16 a[0:15], v[44:47], v[28:31], a[0:15]
  ds_read_b128 v[36:39], v10 offset:512
  ds_read_b64_tr_b16 v[52:53], v18 offset:2048
  s_add_u32 m0, s30, 32768
  s_nop 0
  buffer_load_dwordx4 v6, s[12:15], s21 offen lds
  v_mfma_f32_32x32x16_bf16 a[16:31], v[48:51], v[28:31], a[16:31]
  ds_read_b64_tr_b16 v[54:55], v18 offset:6144
  ds_read_b128 v[40:43], v10 offset:4608
  s_add_u32 m0, s30, 33792
  s_nop 0
  buffer_load_dwordx4 v7, s[12:15], s21 offen lds
  v_mfma_f32_32x32x16_bf16 a[32:47], v[44:47], v[32:35], a[32:47]
  ds_read_b64_tr_b16 v[56:57], v19 offset:2048
  ds_read_b64_tr_b16 v[58:59], v19 offset:6144
  s_add_u32 m0, s30, 34816
  s_nop 0
  buffer_load_dwordx4 v8, s[12:15], s21 offen lds
  v_mfma_f32_32x32x16_bf16 a[48:63], v[48:51], v[32:35], a[48:63]
  s_add_u32 m0, s30, 35840
  s_nop 0
  buffer_load_dwordx4 v9, s[12:15], s21 offen lds
  s_waitcnt lgkmcnt(0)
  v_mfma_f32_32x32x16_bf16 a[0:15], v[52:55], v[36:39], a[0:15]
  ds_read_b128 v[28:31], v10 offset:1024
  ds_read_b64_tr_b16 v[44:45], v18 offset:8192
  s_add_u32 s20, s20, 6144
  s_add_u32 s21, s21, s28
  v_mfma_f32_32x32x16_bf16 a[16:31], v[56:59], v[36:39], a[16:31]
  ds_read_b64_tr_b16 v[46:47], v18 offset:12288
  ds_read_b128 v[32:35], v10 offset:5120
  v_mfma_f32_32x32x16_bf16 a[32:47], v[52:55], v[40:43], a[32:47]
  ds_read_b64_tr_b16 v[48:49], v19 offset:8192
  ds_read_b64_tr_b16 v[50:51], v19 offset:12288
  v_mfma_f32_32x32x16_bf16 a[48:63], v[56:59], v[40:43], a[48:63]
  s_waitcnt lgkmcnt(0)
  v_mfma_f32_32x32x16_bf16 a[0:15], v[44:47], v[28:31], a[0:15]
  ds_read_b128 v[36:39], v10 offset:1536
  ds_read_b64_tr_b16 v[52:53], v18 offset:10240
  v_mfma_f32_32x32x16_bf16 a[16:31], v[48:51], v[28:31], a[16:31]
  ds_read_b64_tr_b16 v[54:55], v18 offset:14336
  ds_read_b128 v[40:43], v10 offset:5632
  v_mfma_f32_32x32x16_bf16 a[32:47], v[44:47], v[32:35], a[32:47]
  ds_read_b64_tr_b16 v[56:57], v19 offset:10240
  ds_read_b64_tr_b16 v[58:59], v19 offset:14336
  v_mfma_f32_32x32x16_bf16 a[48:63], v[48:51], v[32:35], a[48:63]
  s_waitcnt lgkmcnt(0)
  v_mfma_f32_32x32x16_bf16 a[0:15], v[52:55], v[36:39], a[0:15]
  s_waitcnt vmcnt(0)
  s_barrier
  v_mfma_f32_32x32x16_bf16 a[16:31], v[56:59], v[36:39], a[16:31]
  ds_read_b128 v[28:31], v14 offset:0
  ds_read_b64_tr_b16 v[44:45], v20 offset:0
  v_mfma_f32_32x32x16_bf16 a[32:47], v[52:55], v[40:43], a[32:47]
  ds_read_b64_tr_b16 v[46:47], v20 offset:4096
  ds_read_b128 v[32:35], v14 offset:4096
  v_mfma_f32_32x32x16_bf16 a[48:63], v[56:59], v[40:43], a[48:63]
  ds_read_b64_tr_b16 v[48:49], v21 offset:0
  ds_read_b64_tr_b16 v[50:51], v21 offset:4096
  s_waitcnt lgkmcnt(0)
  v_mfma_f32_32x32x16_bf16 a[0:15], v[44:47], v[28:31], a[0:15]
  ds_read_b128 v[36:39], v14 offset:512
  ds_read_b64_tr_b16 v[52:53], v20 offset:2048
  v_mfma_f32_32x32x16_bf16 a[16:31], v[48:51], v[28:31], a[16:31]
  ds_read_b64_tr_b16 v[54:55], v20 offset:6144
  ds_read_b128 v[40:43], v14 offset:4608
  v_mfma_f32_32x32x16_bf16 a[32:47], v[44:47], v[32:35], a[32:47]
  ds_read_b64_tr_b16 v[56:57], v21 offset:2048
  ds_read_b64_tr_b16 v[58:59], v21 offset:6144
  v_mfma_f32_32x32x16_bf16 a[48:63], v[48:51], v[32:35], a[48:63]
  s_waitcnt lgkmcnt(0)
  v_mfma_f32_32x32x16_bf16 a[0:15], v[52:55], v[36:39], a[0:15]
  ds_read_b128 v[28:31], v14 offset:1024
  ds_read_b64_tr_b16 v[44:45], v20 offset:8192
  v_mfma_f32_32x32x16_bf16 a[16:31], v[56:59], v[36:39], a[16:31]
  ds_read_b64_tr_b16 v[46:47], v20 offset:12288
  ds_read_b128 v[32:35], v14 offset:5120
  v_mfma_f32_32x32x16_bf16 a[32:47], v[52:55], v[40:43], a[32:47]
  ds_read_b64_tr_b16 v[48:49], v21 offset:8192
  ds_read_b64_tr_b16 v[50:51], v21 offset:12288
  v_mfma_f32_32x32x16_bf16 a[48:63], v[56:59], v[40:43], a[48:63]
  s_waitcnt lgkmcnt(0)
  v_mfma_f32_32x32x16_bf16 a[0:15], v[44:47], v[28:31], a[0:15]
  ds_read_b128 v[36:39], v14 offset:1536
  ds_read_b64_tr_b16 v[52:53], v20 offset:10240
  v_mfma_f32_32x32x16_bf16 a[16:31], v[48:51], v[28:31], a[16:31]
  ds_read_b64_tr_b16 v[54:55], v20 offset:14336
  ds_read_b128 v[40:43], v14 offset:5632
  v_mfma_f32_32x32x16_bf16 a[32:47], v[44:47], v[32:35], a[32:47]
  ds_read_b64_tr_b16 v[56:57], v21 offset:10240
  ds_read_b64_tr_b16 v[58:59], v21 offset:14336
  v_mfma_f32_32x32x16_bf16 a[48:63], v[48:51], v[32:35], a[48:63]
  s_waitcnt lgkmcnt(0)
  v_mfma_f32_32x32x16_bf16 a[0:15], v[52:55], v[36:39], a[0:15]
  v_mfma_f32_32x32x16_bf16 a[16:31], v[56:59], v[36:39], a[16:31]
  v_mfma_f32_32x32x16_bf16 a[32:47], v[52:55], v[40:43], a[32:47]
  v_mfma_f32_32x32x16_bf16 a[48:63], v[56:59], v[40:43], a[48:63]
  s_lshr_b32 s90, s27, 1
  s_and_b32 s91, s27, 1
  v_and_b32 v22, 31, v1
  v_mul_lo_u32 v22, v22, s26
  v_lshrrev_b32 v23, 5, v1
  v_lshl_add_u32 v24, v23, 5, v22
  s_mul_i32 s92, s90, 64
  s_mul_i32 s92, s92, s26
  s_add_u32 s92, s92, s22
  s_mul_i32 s93, s91, 128
  s_add_u32 s92, s92, s93
  s_lshl_b32 s94, s26, 5
  v_accvgpr_read_b32 v64, a0
  v_accvgpr_read_b32 v65, a1
  v_accvgpr_read_b32 v66, a2
  v_accvgpr_read_b32 v67, a3
  v_accvgpr_read_b32 v68, a4
  v_accvgpr_read_b32 v69, a5
  v_accvgpr_read_b32 v70, a6
  v_accvgpr_read_b32 v71, a7
  v_cvt_pk_bf16_f32 v60, v64, v65
  v_cvt_pk_bf16_f32 v61, v66, v67
  v_cvt_pk_bf16_f32 v62, v68, v69
  v_cvt_pk_bf16_f32 v63, v70, v71
  buffer_store_dwordx4 v[60:63], v24, s[16:19], s92 offen offset:0
  v_accvgpr_read_b32 v76, a8
  v_accvgpr_read_b32 v77, a9
  v_accvgpr_read_b32 v78, a10
  v_accvgpr_read_b32 v79, a11
  v_accvgpr_read_b32 v80, a12
  v_accvgpr_read_b32 v81, a13
  v_accvgpr_read_b32 v82, a14
  v_accvgpr_read_b32 v83, a15
  v_cvt_pk_bf16_f32 v72, v76, v77
  v_cvt_pk_bf16_f32 v73, v78, v79
  v_cvt_pk_bf16_f32 v74, v80, v81
  v_cvt_pk_bf16_f32 v75, v82, v83
  buffer_store_dwordx4 v[72:75], v24, s[16:19], s92 offen offset:16
  v_accvgpr_read_b32 v88, a16
  v_accvgpr_read_b32 v89, a17
  v_accvgpr_read_b32 v90, a18
  v_accvgpr_read_b32 v91, a19
  v_accvgpr_read_b32 v92, a20
  v_accvgpr_read_b32 v93, a21
  v_accvgpr_read_b32 v94, a22
  v_accvgpr_read_b32 v95, a23
  v_cvt_pk_bf16_f32 v84, v88, v89
  v_cvt_pk_bf16_f32 v85, v90, v91
  v_cvt_pk_bf16_f32 v86, v92, v93
  v_cvt_pk_bf16_f32 v87, v94, v95
  buffer_store_dwordx4 v[84:87], v24, s[16:19], s92 offen offset:64
  v_accvgpr_read_b32 v100, a24
  v_accvgpr_read_b32 v101, a25
  v_accvgpr_read_b32 v102, a26
  v_accvgpr_read_b32 v103, a27
  v_accvgpr_read_b32 v104, a28
  v_accvgpr_read_b32 v105, a29
  v_accvgpr_read_b32 v106, a30
  v_accvgpr_read_b32 v107, a31
  v_cvt_pk_bf16_f32 v96, v100, v101
  v_cvt_pk_bf16_f32 v97, v102, v103
  v_cvt_pk_bf16_f32 v98, v104, v105
  v_cvt_pk_bf16_f32 v99, v106, v107
  buffer_store_dwordx4 v[96:99], v24, s[16:19], s92 offen offset:80
  s_add_u32 s92, s92, s94
  v_accvgpr_read_b32 v64, a32
  v_accvgpr_read_b32 v65, a33
  v_accvgpr_read_b32 v66, a34
  v_accvgpr_read_b32 v67, a35
  v_accvgpr_read_b32 v68, a36
  v_accvgpr_read_b32 v69, a37
  v_accvgpr_read_b32 v70, a38
  v_accvgpr_read_b32 v71, a39
  v_cvt_pk_bf16_f32 v60, v64, v65
  v_cvt_pk_bf16_f32 v61, v66, v67
  v_cvt_pk_bf16_f32 v62, v68, v69
  v_cvt_pk_bf16_f32 v63, v70, v71
  buffer_store_dwordx4 v[60:63], v24, s[16:19], s92 offen offset:0
  v_accvgpr_read_b32 v76, a40
  v_accvgpr_read_b32 v77, a41
  v_accvgpr_read_b32 v78, a42
  v_accvgpr_read_b32 v79, a43
  v_accvgpr_read_b32 v80, a44
  v_accvgpr_read_b32 v81, a45
  v_accvgpr_read_b32 v82, a46
  v_accvgpr_read_b32 v83, a47
  v_cvt_pk_bf16_f32 v72, v76, v77
  v_cvt_pk_bf16_f32 v73, v78, v79
  v_cvt_pk_bf16_f32 v74, v80, v81
  v_cvt_pk_bf16_f32 v75, v82, v83
  buffer_store_dwordx4 v[72:75], v24, s[16:19], s92 offen offset:16
  v_accvgpr_read_b32 v88, a48
  v_accvgpr_read_b32 v89, a49
  v_accvgpr_read_b32 v90, a50
  v_accvgpr_read_b32 v91, a51
  v_accvgpr_read_b32 v92, a52
  v_accvgpr_read_b32 v93, a53
  v_accvgpr_read_b32 v94, a54
  v_accvgpr_read_b32 v95, a55
  v_cvt_pk_bf16_f32 v84, v88, v89
  v_cvt_pk_bf16_f32 v85, v90, v91
  v_cvt_pk_bf16_f32 v86, v92, v93
  v_cvt_pk_bf16_f32 v87, v94, v95
  buffer_store_dwordx4 v[84:87], v24, s[16:19], s92 offen offset:64
  v_accvgpr_read_b32 v100, a56
  v_accvgpr_read_b32 v101, a57
  v_accvgpr_read_b32 v102, a58
  v_accvgpr_read_b32 v103, a59
  v_accvgpr_read_b32 v104, a60
  v_accvgpr_read_b32 v105, a61
  v_accvgpr_read_b32 v106, a62
  v_accvgpr_read_b32 v107, a63
  v_cvt_pk_bf16_f32 v96, v100, v101
  v_cvt_pk_bf16_f32 v97, v102, v103
  v_cvt_pk_bf16_f32 v98, v104, v105
  v_cvt_pk_bf16_f32 v99, v106, v107
  buffer_store_dwordx4 v[96:99], v24, s[16:19], s92 offen offset:80
  s_add_u32 s92, s92, s94
L_k4_end:
  s_endpgm
.section .rodata,"a"
.p2align 6
.amdhsa_kernel qkv_kernel
  .amdhsa_next_free_vgpr 512
  .amdhsa_next_free_sgpr 102
  .amdhsa_accum_offset 256
  .amdhsa_group_segment_fixed_size 0
  .amdhsa_kernarg_size 104
  .amdhsa_user_sgpr_count 2
  .amdhsa_user_sgpr_kernarg_segment_ptr 1
  .amdhsa_system_sgpr_workgroup_id_x 1
  .amdhsa_float_denorm_mode_32 3
  .amdhsa_float_denorm_mode_16_64 3
.end_amdhsa_kernel
.p2align 6
.amdhsa_kernel rec_kernel
  .amdhsa_next_free_vgpr 512
  .amdhsa_next_free_sgpr 102
  .amdhsa_accum_offset 256
  .amdhsa_group_segment_fixed_size 0
  .amdhsa_kernarg_size 104
  .amdhsa_user_sgpr_count 2
  .amdhsa_user_sgpr_kernarg_segment_ptr 1
  .amdhsa_system_sgpr_workgroup_id_x 1
  .amdhsa_float_denorm_mode_32 3
  .amdhsa_float_denorm_mode_16_64 3
.end_amdhsa_kernel
.p2align 6
.amdhsa_kernel attn_kernel
  .amdhsa_next_free_vgpr 200
  .amdhsa_next_free_sgpr 102
  .amdhsa_accum_offset 200
  .amdhsa_group_segment_fixed_size 0
  .amdhsa_kernarg_size 104
  .amdhsa_user_sgpr_count 2
  .amdhsa_user_sgpr_kernarg_segment_ptr 1
  .amdhsa_system_sgpr_workgroup_id_x 1
  .amdhsa_float_denorm_mode_32 3
  .amdhsa_float_denorm_mode_16_64 3
.end_amdhsa_kernel
.p2align 6
.amdhsa_kernel outp_kernel
  .amdhsa_next_free_vgpr 256
  .amdhsa_next_free_sgpr 102
  .amdhsa_accum_offset 192
  .amdhsa_group_segment_fixed_size 0
  .amdhsa_kernarg_size 104
  .amdhsa_user_sgpr_count 2
  .amdhsa_user_sgpr_kernarg_segment_ptr 1
  .amdhsa_system_sgpr_workgroup_id_x 1
  .amdhsa_float_denorm_mode_32 3
  .amdhsa_float_denorm_mode_16_64 3
.end_amdhsa_kernel
```

```asm
; @launch grid=(256,1,1) block=(256,1,1) lds=131136
.amdgcn_target "amdgcn-amd-amdhsa--gfx950"
.text
.globl concat_heads__memory_aug_recurrent_mem_tr__sliding_local_dilated__prompt_kernel
.p2align 8
.type concat_heads__memory_aug_recurrent_mem_tr__sliding_local_dilated__prompt_kernel,@function
concat_heads__memory_aug_recurrent_mem_tr__sliding_local_dilated__prompt_kernel:
  s_cmp_ge_u32 s2, 256
  s_cbranch_scc1 L_exit
  s_load_dwordx4 s[92:95], s[0:1], 88
  s_load_dwordx16 s[64:79], s[0:1], 0
  s_getreg_b32 s39, hwreg(HW_REG_XCC_ID, 0, 3)
  v_lshrrev_b32 v2, 6, v0
  s_nop 0
  v_readfirstlane_b32 s32, v2
  s_mov_b32 s3, 0
  s_waitcnt lgkmcnt(0)
  s_mov_b32 s4, s94
  s_and_b32 s5, s95, 0xffff
  s_mov_b32 s6, 0x10000000
  s_mov_b32 s7, 0x20000
  s_mov_b32 s28, s92
  s_and_b32 s29, s93, 0xffff
  s_mov_b32 s30, 0x100
  s_mov_b32 s31, 0x20000
  s_cmp_lg_u32 s32, 0
  s_cbranch_scc1 L_sweep
  s_lshl_b32 s90, s39, 2
  v_mov_b32 v1, 1
  v_mov_b32 v2, 0
  v_lshlrev_b32 v3, 2, v0
  s_mov_b64 exec, 1
  buffer_atomic_add v1, v2, s[28:31], s90 offen sc0 sc1
  s_mov_b64 exec, 0xff
L_tkw:
  buffer_load_dword v4, v3, s[28:31], 0 offen sc1
  s_waitcnt vmcnt(0)
  v_readfirstlane_b32 s40, v1
  s_mov_b32 s41, 0
  s_mov_b32 s42, 0
  s_mov_b32 s43, 1
  v_readlane_b32 s44, v4, 0
  s_add_u32 s41, s41, s44
  s_cmp_gt_u32 s39, 0
  s_cselect_b32 s45, s44, 0
  s_add_u32 s42, s42, s45
  s_cmp_eq_u32 s44, 32
  s_cselect_b32 s43, s43, 0
  v_readlane_b32 s44, v4, 1
  s_add_u32 s41, s41, s44
  s_cmp_gt_u32 s39, 1
  s_cselect_b32 s45, s44, 0
  s_add_u32 s42, s42, s45
  s_cmp_eq_u32 s44, 32
  s_cselect_b32 s43, s43, 0
  v_readlane_b32 s44, v4, 2
  s_add_u32 s41, s41, s44
  s_cmp_gt_u32 s39, 2
  s_cselect_b32 s45, s44, 0
  s_add_u32 s42, s42, s45
  s_cmp_eq_u32 s44, 32
  s_cselect_b32 s43, s43, 0
  v_readlane_b32 s44, v4, 3
  s_add_u32 s41, s41, s44
  s_cmp_gt_u32 s39, 3
  s_cselect_b32 s45, s44, 0
  s_add_u32 s42, s42, s45
  s_cmp_eq_u32 s44, 32
  s_cselect_b32 s43, s43, 0
  v_readlane_b32 s44, v4, 4
  s_add_u32 s41, s41, s44
  s_cmp_gt_u32 s39, 4
  s_cselect_b32 s45, s44, 0
  s_add_u32 s42, s42, s45
  v_readlane_b32 s44, v4, 5
  s_add_u32 s41, s41, s44
  s_cmp_gt_u32 s39, 5
  s_cselect_b32 s45, s44, 0
  s_add_u32 s42, s42, s45
  v_readlane_b32 s44, v4, 6
  s_add_u32 s41, s41, s44
  s_cmp_gt_u32 s39, 6
  s_cselect_b32 s45, s44, 0
  s_add_u32 s42, s42, s45
  v_readlane_b32 s44, v4, 7
  s_add_u32 s41, s41, s44
  s_cmp_gt_u32 s39, 7
  s_cselect_b32 s45, s44, 0
  s_add_u32 s42, s42, s45
  s_add_u32 s3, s3, 1
  s_cmp_ge_u32 s3, 2097152
  s_cbranch_scc1 L_tkbad
  s_cmp_lt_u32 s41, 256
  s_cbranch_scc1 L_tkw
  s_add_u32 s40, s40, s42
  s_lshl_b32 s43, s43, 16
  s_or_b32 s40, s40, s43
  s_branch L_tkok
L_tkbad:
  s_mov_b32 s40, 0xffff
L_tkok:
  s_mov_b64 exec, -1
  v_mov_b32 v1, s40
  v_mov_b32 v2, 131072
  ds_write_b32 v2, v1
  s_waitcnt lgkmcnt(0)
  s_branch L_tkd
L_sweep:
  s_mov_b32 s8, s64
  s_and_b32 s9, s65, 0xffff
  s_mov_b32 s10, 0x400000
  s_mov_b32 s11, 0x20000
  s_mov_b32 s12, s70
  s_and_b32 s13, s71, 0xffff
  s_mov_b32 s14, 0x800000
  s_mov_b32 s15, 0x20000
  s_mov_b32 s16, s72
  s_and_b32 s17, s73, 0xffff
  s_mov_b32 s18, 0x800000
  s_mov_b32 s19, 0x20000
  v_and_b32 v1, 63, v0
  v_lshlrev_b32 v1, 6, v1
  s_lshl_b32 s90, s2, 14
  s_lshl_b32 s91, s2, 15
  s_cmp_lg_u32 s32, 1
  s_cbranch_scc1 L_sw_1
  buffer_load_dword v200, v1, s[8:11], s90 offen
  s_add_u32 s90, s90, 4096
  buffer_load_dword v201, v1, s[8:11], s90 offen
  s_add_u32 s90, s90, 4096
  buffer_load_dword v202, v1, s[8:11], s90 offen
  s_add_u32 s90, s90, 4096
  buffer_load_dword v203, v1, s[8:11], s90 offen
  s_add_u32 s90, s90, 4096
L_sw_1:
  s_cmp_lg_u32 s32, 2
  s_cbranch_scc1 L_sw_2
  buffer_load_dword v200, v1, s[12:15], s91 offen
  s_add_u32 s91, s91, 4096
  buffer_load_dword v201, v1, s[12:15], s91 offen
  s_add_u32 s91, s91, 4096
  buffer_load_dword v202, v1, s[12:15], s91 offen
  s_add_u32 s91, s91, 4096
  buffer_load_dword v203, v1, s[12:15], s91 offen
  s_add_u32 s91, s91, 4096
  buffer_load_dword v204, v1, s[12:15], s91 offen
  s_add_u32 s91, s91, 4096
  buffer_load_dword v205, v1, s[12:15], s91 offen
  s_add_u32 s91, s91, 4096
  buffer_load_dword v206, v1, s[12:15], s91 offen
  s_add_u32 s91, s91, 4096
  buffer_load_dword v207, v1, s[12:15], s91 offen
  s_add_u32 s91, s91, 4096
L_sw_2:
  s_cmp_lg_u32 s32, 3
  s_cbranch_scc1 L_sw_3
  buffer_load_dword v200, v1, s[16:19], s91 offen
  s_add_u32 s91, s91, 4096
  buffer_load_dword v201, v1, s[16:19], s91 offen
  s_add_u32 s91, s91, 4096
  buffer_load_dword v202, v1, s[16:19], s91 offen
  s_add_u32 s91, s91, 4096
  buffer_load_dword v203, v1, s[16:19], s91 offen
  s_add_u32 s91, s91, 4096
  buffer_load_dword v204, v1, s[16:19], s91 offen
  s_add_u32 s91, s91, 4096
  buffer_load_dword v205, v1, s[16:19], s91 offen
  s_add_u32 s91, s91, 4096
  buffer_load_dword v206, v1, s[16:19], s91 offen
  s_add_u32 s91, s91, 4096
  buffer_load_dword v207, v1, s[16:19], s91 offen
  s_add_u32 s91, s91, 4096
L_sw_3:
L_tkd:
  s_barrier
  v_mov_b32 v2, 131072
  ds_read_b32 v1, v2
  s_waitcnt lgkmcnt(0)
  v_readfirstlane_b32 s40, v1
  s_barrier
  s_lshr_b32 s43, s40, 16
  s_and_b32 s40, s40, 0xffff
  s_cmp_ge_u32 s40, 256
  s_cbranch_scc1 L_exit
  s_cmp_ge_u32 s40, 128
  s_cbranch_scc1 L_worker
  s_lshr_b32 s33, s40, 5
  s_and_b32 s34, s40, 31
  s_cmp_eq_u32 s43, 0
  s_cbranch_scc1 L_recslow
  s_load_dwordx4 s[80:83], s[0:1], 8
  s_load_dwordx4 s[84:87], s[0:1], 24
  s_load_dwordx2 s[88:89], s[0:1], 40
  v_lshrrev_b32 v31, 6, v0
  s_nop 0
  v_readfirstlane_b32 s32, v31
  v_and_b32 v0, 63, v0
  s_lshr_b32 s35, s34, 4
  s_lshl_b32 s90, s33, 1
  s_add_u32 s35, s35, s90
  s_and_b32 s36, s34, 15
  s_lshr_b32 s37, s36, 2
  s_lshl_b32 s90, s35, 2
  s_add_u32 s37, s37, s90
  s_and_b32 s38, s36, 3
  s_waitcnt lgkmcnt(0)
  s_mov_b32 s24, s80
  s_and_b32 s25, s81, 0xffff
  s_mov_b32 s26, 0x4000
  s_mov_b32 s27, 0x20000
  s_mov_b32 s8, s82
  s_and_b32 s9, s83, 0xffff
  s_mov_b32 s10, 0x800000
  s_mov_b32 s11, 0x20000
  s_mov_b32 s12, s84
  s_and_b32 s13, s85, 0xffff
  s_mov_b32 s14, 0x800000
  s_mov_b32 s15, 0x20000
  s_mov_b32 s16, s86
  s_and_b32 s17, s87, 0xffff
  s_mov_b32 s18, 0x800000
  s_mov_b32 s19, 0x20000
  s_mov_b32 s20, s88
  s_and_b32 s21, s89, 0xffff
  s_mov_b32 s22, 0x800000
  s_mov_b32 s23, 0x20000
  s_lshl_b32 s90, s32, 21
  s_lshl_b32 s91, s37, 8
  s_add_u32 s90, s90, s91
  s_lshl_b32 s91, s38, 6
  s_add_u32 s90, s90, s91
  v_mov_b32 v1, 0x0
  v_bfe_u32 v31, v0, 2, 4
  v_lshl_add_u32 v1, v31, 13, v1
  v_bfe_u32 v31, v0, 0, 2
  v_lshl_add_u32 v1, v31, 4, v1
  v_add_u32 v1, s90, v1
  s_lshl_b32 s90, s35, 2
  s_add_u32 s90, s90, s32
  s_lshl_b32 s90, s90, 18
  s_lshl_b32 s91, s36, 7
  s_add_u32 s90, s90, s91
  v_mov_b32 v2, 0x0
  v_bfe_u32 v31, v0, 3, 3
  v_lshl_add_u32 v2, v31, 11, v2
  v_bfe_u32 v31, v0, 0, 3
  v_lshl_add_u32 v2, v31, 4, v2
  v_add_u32 v2, s90, v2
  s_lshl_b32 s96, s32, 15
  v_mov_b32 v3, 0x0
  v_bfe_u32 v31, v0, 5, 1
  v_lshl_add_u32 v3, v31, 10, v3
  v_bfe_u32 v31, v0, 4, 1
  v_lshl_add_u32 v3, v31, 9, v3
  v_bfe_u32 v31, v0, 2, 2
  v_lshl_add_u32 v3, v31, 6, v3
  v_bfe_u32 v31, v0, 0, 2
  v_lshl_add_u32 v3, v31, 3, v3
  v_add_u32 v3, s96, v3
  s_lshl_b32 s91, s32, 5
  v_mov_b32 v4, 0x4000
  v_bfe_u32 v31, v0, 4, 1
  v_lshl_add_u32 v4, v31, 13, v4
  v_bfe_u32 v31, v0, 5, 1
  v_lshl_add_u32 v4, v31, 8, v4
  v_bfe_u32 v31, v0, 2, 1
  v_lshl_add_u32 v4, v31, 10, v4
  v_bfe_u32 v31, v0, 3, 1
  v_lshl_add_u32 v4, v31, 7, v4
  v_bfe_u32 v31, v0, 0, 2
  v_lshl_add_u32 v4, v31, 3, v4
  v_add_u32 v4, s91, v4
  v_add_u32 v5, 0x10000, v4
  s_lshl_b32 s58, s33, 5
  s_add_u32 s58, s58, s34
  s_lshl_b32 s59, s32, 19
  s_add_u32 s59, s59, 0x3800000
  s_lshl_b32 s90, s58, 11
  s_add_u32 s90, s90, s59
  s_mul_i32 s91, s58, 3072
  s_add_u32 s91, s91, s59
  s_add_u32 s91, s91, 0x200000
  v_lshlrev_b32 v6, 4, v0
  v_mov_b32 v8, -1
  v_mov_b32 v9, -1
  v_mov_b32 v10, -1
  v_mov_b32 v11, -1
  buffer_store_dwordx4 v[8:11], v6, s[4:7], s90 offen offset:0 sc1
  buffer_store_dwordx4 v[8:11], v6, s[4:7], s90 offen offset:1024 sc1
  buffer_store_dwordx4 v[8:11], v6, s[4:7], s91 offen offset:0 sc1
  buffer_store_dwordx4 v[8:11], v6, s[4:7], s91 offen offset:1024 sc1
  buffer_store_dwordx4 v[8:11], v6, s[4:7], s91 offen offset:2048 sc1
  s_lshl_b32 s58, s33, 5
  s_add_u32 s58, s58, s34
  s_lshl_b32 s58, s58, 2
  s_add_u32 s58, s58, s32
  s_cmp_lg_u32 s58, 3
  s_cbranch_scc1 FL_np_1
  v_mov_b32 v6, 0x3800000
  v_bfe_u32 v31, v0, 0, 1
  v_lshl_add_u32 v6, v31, 13, v6
  v_bfe_u32 v31, v0, 1, 1
  s_mov_b32 s99, 4352
  v_mad_u32_u24 v6, v31, s99, v6
  v_bfe_u32 v31, v0, 2, 2
  s_mov_b32 s99, 82432
  v_mad_u32_u24 v6, v31, s99, v6
  v_mov_b32 v7, -1
  s_mov_b64 exec, 0xffff
  buffer_store_dword v7, v6, s[4:7], 0 offen sc1
  s_mov_b64 exec, -1
  s_waitcnt vmcnt(0)
FL_np_1:
  s_add_u32 m0, s96, 0
  s_mov_b32 s90, 0x0
  buffer_load_dwordx4 v1, s[8:11], s90 offen lds
  s_add_u32 m0, s96, 1024
  s_mov_b32 s90, 0x20000
  buffer_load_dwordx4 v1, s[8:11], s90 offen lds
  s_add_u32 m0, s96, 2048
  s_mov_b32 s90, 0x0
  buffer_load_dwordx4 v1, s[12:15], s90 offen lds
  s_add_u32 m0, s96, 3072
  s_mov_b32 s90, 0x20000
  buffer_load_dwordx4 v1, s[12:15], s90 offen lds
  s_add_u32 m0, s96, 4096
  s_mov_b32 s90, 0x0
  buffer_load_dwordx4 v1, s[16:19], s90 offen lds
  s_add_u32 m0, s96, 5120
  s_mov_b32 s90, 0x20000
  buffer_load_dwordx4 v1, s[16:19], s90 offen lds
  s_add_u32 m0, s96, 6144
  s_mov_b32 s90, 0x40000
  buffer_load_dwordx4 v1, s[8:11], s90 offen lds
  s_add_u32 m0, s96, 7168
  s_mov_b32 s90, 0x60000
  buffer_load_dwordx4 v1, s[8:11], s90 offen lds
  s_add_u32 m0, s96, 8192
  s_mov_b32 s90, 0x40000
  buffer_load_dwordx4 v1, s[12:15], s90 offen lds
  s_add_u32 m0, s96, 9216
  s_mov_b32 s90, 0x60000
  buffer_load_dwordx4 v1, s[12:15], s90 offen lds
  s_add_u32 m0, s96, 10240
  s_mov_b32 s90, 0x40000
  buffer_load_dwordx4 v1, s[16:19], s90 offen lds
  s_add_u32 m0, s96, 11264
  s_mov_b32 s90, 0x60000
  buffer_load_dwordx4 v1, s[16:19], s90 offen lds
  s_add_u32 m0, s96, 12288
  s_mov_b32 s90, 0x80000
  buffer_load_dwordx4 v1, s[8:11], s90 offen lds
  s_add_u32 m0, s96, 13312
  s_mov_b32 s90, 0xa0000
  buffer_load_dwordx4 v1, s[8:11], s90 offen lds
  s_add_u32 m0, s96, 14336
  s_mov_b32 s90, 0x80000
  buffer_load_dwordx4 v1, s[12:15], s90 offen lds
  s_add_u32 m0, s96, 15360
  s_mov_b32 s90, 0xa0000
  buffer_load_dwordx4 v1, s[12:15], s90 offen lds
  s_add_u32 m0, s96, 16384
  s_mov_b32 s90, 0x80000
  buffer_load_dwordx4 v1, s[16:19], s90 offen lds
  s_add_u32 m0, s96, 17408
  s_mov_b32 s90, 0xa0000
  buffer_load_dwordx4 v1, s[16:19], s90 offen lds
  s_add_u32 m0, s96, 18432
  s_mov_b32 s90, 0xc0000
  buffer_load_dwordx4 v1, s[8:11], s90 offen lds
  s_add_u32 m0, s96, 19456
  s_mov_b32 s90, 0xe0000
  buffer_load_dwordx4 v1, s[8:11], s90 offen lds
  s_add_u32 m0, s96, 20480
  s_mov_b32 s90, 0xc0000
  buffer_load_dwordx4 v1, s[12:15], s90 offen lds
  s_add_u32 m0, s96, 21504
  s_mov_b32 s90, 0xe0000
  buffer_load_dwordx4 v1, s[12:15], s90 offen lds
  s_add_u32 m0, s96, 22528
  s_mov_b32 s90, 0xc0000
  buffer_load_dwordx4 v1, s[16:19], s90 offen lds
  s_add_u32 m0, s96, 23552
  s_mov_b32 s90, 0xe0000
  buffer_load_dwordx4 v1, s[16:19], s90 offen lds
  s_add_u32 m0, s96, 24576
  s_mov_b32 s90, 0x100000
  buffer_load_dwordx4 v1, s[8:11], s90 offen lds
  s_add_u32 m0, s96, 25600
  s_mov_b32 s90, 0x120000
  buffer_load_dwordx4 v1, s[8:11], s90 offen lds
  s_add_u32 m0, s96, 26624
  s_mov_b32 s90, 0x100000
  buffer_load_dwordx4 v1, s[12:15], s90 offen lds
  s_add_u32 m0, s96, 27648
  s_mov_b32 s90, 0x120000
  buffer_load_dwordx4 v1, s[12:15], s90 offen lds
  s_add_u32 m0, s96, 28672
  s_mov_b32 s90, 0x100000
  buffer_load_dwordx4 v1, s[16:19], s90 offen lds
  s_add_u32 m0, s96, 29696
  s_mov_b32 s90, 0x120000
  buffer_load_dwordx4 v1, s[16:19], s90 offen lds
  s_add_u32 m0, s96, 30720
  s_mov_b32 s90, 0x140000
  buffer_load_dwordx4 v1, s[8:11], s90 offen lds
  s_add_u32 m0, s96, 31744
  s_mov_b32 s90, 0x160000
  buffer_load_dwordx4 v1, s[8:11], s90 offen lds
  s_cmp_lg_u32 s58, 3
  s_cbranch_scc1 FL_np_2
  s_add_u32 s92, s94, 0x3800000
  s_addc_u32 s93, s95, 0
  s_mov_b32 s62, -1
  s_mov_b32 s63, -1
  s_memtime s[56:57]
  s_waitcnt lgkmcnt(0)
  s_load_dword s60, s[92:93], 0x0
  s_waitcnt lgkmcnt(0)
  s_memtime s[58:59]
  s_waitcnt lgkmcnt(0)
  s_sub_u32 s58, s58, s56
  s_min_u32 s62, s62, s58
  s_memtime s[56:57]
  s_waitcnt lgkmcnt(0)
  s_load_dword s60, s[92:93], 0x2000
  s_waitcnt lgkmcnt(0)
  s_memtime s[58:59]
  s_waitcnt lgkmcnt(0)
  s_sub_u32 s58, s58, s56
  s_min_u32 s63, s63, s58
  s_memtime s[56:57]
  s_waitcnt lgkmcnt(0)
  s_load_dword s60, s[92:93], 0x1100
  s_waitcnt lgkmcnt(0)
  s_memtime s[58:59]
  s_waitcnt lgkmcnt(0)
  s_sub_u32 s58, s58, s56
  s_min_u32 s62, s62, s58
  s_memtime s[56:57]
  s_waitcnt lgkmcnt(0)
  s_load_dword s60, s[92:93], 0x3100
  s_waitcnt lgkmcnt(0)
  s_memtime s[58:59]
  s_waitcnt lgkmcnt(0)
  s_sub_u32 s58, s58, s56
  s_min_u32 s63, s63, s58
  s_memtime s[56:57]
  s_waitcnt lgkmcnt(0)
  s_load_dword s60, s[92:93], 0x14200
  s_waitcnt lgkmcnt(0)
  s_memtime s[58:59]
  s_waitcnt lgkmcnt(0)
  s_sub_u32 s58, s58, s56
  s_min_u32 s62, s62, s58
  s_memtime s[56:57]
  s_waitcnt lgkmcnt(0)
  s_load_dword s60, s[92:93], 0x16200
  s_waitcnt lgkmcnt(0)
  s_memtime s[58:59]
  s_waitcnt lgkmcnt(0)
  s_sub_u32 s58, s58, s56
  s_min_u32 s63, s63, s58
  s_memtime s[56:57]
  s_waitcnt lgkmcnt(0)
  s_load_dword s60, s[92:93], 0x15300
  s_waitcnt lgkmcnt(0)
  s_memtime s[58:59]
  s_waitcnt lgkmcnt(0)
  s_sub_u32 s58, s58, s56
  s_min_u32 s62, s62, s58
  s_memtime s[56:57]
  s_waitcnt lgkmcnt(0)
  s_load_dword s60, s[92:93], 0x17300
  s_waitcnt lgkmcnt(0)
  s_memtime s[58:59]
  s_waitcnt lgkmcnt(0)
  s_sub_u32 s58, s58, s56
  s_min_u32 s63, s63, s58
  s_memtime s[56:57]
  s_waitcnt lgkmcnt(0)
  s_load_dword s60, s[92:93], 0x28400
  s_waitcnt lgkmcnt(0)
  s_memtime s[58:59]
  s_waitcnt lgkmcnt(0)
  s_sub_u32 s58, s58, s56
  s_min_u32 s62, s62, s58
  s_memtime s[56:57]
  s_waitcnt lgkmcnt(0)
  s_load_dword s60, s[92:93], 0x2a400
  s_waitcnt lgkmcnt(0)
  s_memtime s[58:59]
  s_waitcnt lgkmcnt(0)
  s_sub_u32 s58, s58, s56
  s_min_u32 s63, s63, s58
  s_memtime s[56:57]
  s_waitcnt lgkmcnt(0)
  s_load_dword s60, s[92:93], 0x29500
  s_waitcnt lgkmcnt(0)
  s_memtime s[58:59]
  s_waitcnt lgkmcnt(0)
  s_sub_u32 s58, s58, s56
  s_min_u32 s62, s62, s58
  s_memtime s[56:57]
  s_waitcnt lgkmcnt(0)
  s_load_dword s60, s[92:93], 0x2b500
  s_waitcnt lgkmcnt(0)
  s_memtime s[58:59]
  s_waitcnt lgkmcnt(0)
  s_sub_u32 s58, s58, s56
  s_min_u32 s63, s63, s58
  s_memtime s[56:57]
  s_waitcnt lgkmcnt(0)
  s_load_dword s60, s[92:93], 0x3c600
  s_waitcnt lgkmcnt(0)
  s_memtime s[58:59]
  s_waitcnt lgkmcnt(0)
  s_sub_u32 s58, s58, s56
  s_min_u32 s62, s62, s58
  s_memtime s[56:57]
  s_waitcnt lgkmcnt(0)
  s_load_dword s60, s[92:93], 0x3e600
  s_waitcnt lgkmcnt(0)
  s_memtime s[58:59]
  s_waitcnt lgkmcnt(0)
  s_sub_u32 s58, s58, s56
  s_min_u32 s63, s63, s58
  s_memtime s[56:57]
  s_waitcnt lgkmcnt(0)
  s_load_dword s60, s[92:93], 0x3d700
  s_waitcnt lgkmcnt(0)
  s_memtime s[58:59]
  s_waitcnt lgkmcnt(0)
  s_sub_u32 s58, s58, s56
  s_min_u32 s62, s62, s58
  s_memtime s[56:57]
  s_waitcnt lgkmcnt(0)
  s_load_dword s60, s[92:93], 0x3f700
  s_waitcnt lgkmcnt(0)
  s_memtime s[58:59]
  s_waitcnt lgkmcnt(0)
  s_sub_u32 s58, s58, s56
  s_min_u32 s63, s63, s58
  s_cmp_lt_u32 s63, s62
  s_cselect_b32 s60, 2, 1
  v_mov_b32 v6, s60
  v_mov_b32 v7, s62
  v_mov_b32 v8, s63
  v_mov_b32 v9, 0
  s_mov_b64 exec, 1
  buffer_store_dword v6, v9, s[28:31], 0 offen offset:32 sc1
  s_mov_b64 exec, -1
  s_waitcnt vmcnt(0)
FL_np_2:
  s_waitcnt vmcnt(28)
  s_barrier
  s_cmp_lg_u32 s32, 0
  s_cbranch_scc1 FL_sig_3
  v_mov_b32 v254, 1
  v_mov_b32 v255, 0
  s_mov_b64 exec, 1
  buffer_atomic_add v254, v255, s[28:31], 0 offen offset:36 sc1
  s_mov_b64 exec, -1
FL_sig_3:
  ds_read_b64_tr_b16 a[0:1], v3 offset:0
  ds_read_b64_tr_b16 a[2:3], v3 offset:256
  ds_read_b64_tr_b16 a[8:9], v3 offset:32
  ds_read_b64_tr_b16 a[10:11], v3 offset:288
  ds_read_b64_tr_b16 a[16:17], v3 offset:2048
  ds_read_b64_tr_b16 a[18:19], v3 offset:2304
  ds_read_b64_tr_b16 a[24:25], v3 offset:2080
  ds_read_b64_tr_b16 a[26:27], v3 offset:2336
  s_waitcnt lgkmcnt(0)
  s_add_u32 m0, s96, 0
  s_mov_b32 s90, 0x140000
  buffer_load_dwordx4 v1, s[12:15], s90 offen lds
  s_add_u32 m0, s96, 1024
  s_mov_b32 s90, 0x160000
  buffer_load_dwordx4 v1, s[12:15], s90 offen lds
  s_add_u32 m0, s96, 2048
  s_mov_b32 s90, 0x140000
  buffer_load_dwordx4 v1, s[16:19], s90 offen lds
  s_add_u32 m0, s96, 3072
  s_mov_b32 s90, 0x160000
  buffer_load_dwordx4 v1, s[16:19], s90 offen lds
  s_waitcnt vmcnt(28)
  ds_read_b64_tr_b16 a[32:33], v3 offset:4096
  ds_read_b64_tr_b16 a[34:35], v3 offset:4352
  ds_read_b64_tr_b16 a[40:41], v3 offset:4128
  ds_read_b64_tr_b16 a[42:43], v3 offset:4384
  ds_read_b64_tr_b16 a[4:5], v3 offset:6144
  ds_read_b64_tr_b16 a[6:7], v3 offset:6400
  ds_read_b64_tr_b16 a[12:13], v3 offset:6176
  ds_read_b64_tr_b16 a[14:15], v3 offset:6432
  s_waitcnt lgkmcnt(0)
  s_add_u32 m0, s96, 4096
  s_mov_b32 s90, 0x180000
  buffer_load_dwordx4 v1, s[8:11], s90 offen lds
  s_add_u32 m0, s96, 5120
  s_mov_b32 s90, 0x1a0000
  buffer_load_dwordx4 v1, s[8:11], s90 offen lds
  s_add_u32 m0, s96, 6144
  s_mov_b32 s90, 0x180000
  buffer_load_dwordx4 v1, s[12:15], s90 offen lds
  s_add_u32 m0, s96, 7168
  s_mov_b32 s90, 0x1a0000
  buffer_load_dwordx4 v1, s[12:15], s90 offen lds
  s_waitcnt vmcnt(28)
  ds_read_b64_tr_b16 a[20:21], v3 offset:8192
  ds_read_b64_tr_b16 a[22:23], v3 offset:8448
  ds_read_b64_tr_b16 a[28:29], v3 offset:8224
  ds_read_b64_tr_b16 a[30:31], v3 offset:8480
  ds_read_b64_tr_b16 a[36:37], v3 offset:10240
  ds_read_b64_tr_b16 a[38:39], v3 offset:10496
  ds_read_b64_tr_b16 a[44:45], v3 offset:10272
  ds_read_b64_tr_b16 a[46:47], v3 offset:10528
  s_waitcnt lgkmcnt(0)
  s_add_u32 m0, s96, 8192
  s_mov_b32 s90, 0x180000
  buffer_load_dwordx4 v1, s[16:19], s90 offen lds
  s_add_u32 m0, s96, 9216
  s_mov_b32 s90, 0x1a0000
  buffer_load_dwordx4 v1, s[16:19], s90 offen lds
  s_add_u32 m0, s96, 10240
  s_mov_b32 s90, 0x1c0000
  buffer_load_dwordx4 v1, s[8:11], s90 offen lds
  s_add_u32 m0, s96, 11264
  s_mov_b32 s90, 0x1e0000
  buffer_load_dwordx4 v1, s[8:11], s90 offen lds
  s_waitcnt vmcnt(28)
  ds_read_b64_tr_b16 a[48:49], v3 offset:12288
  ds_read_b64_tr_b16 a[50:51], v3 offset:12544
  ds_read_b64_tr_b16 a[56:57], v3 offset:12320
  ds_read_b64_tr_b16 a[58:59], v3 offset:12576
  ds_read_b64_tr_b16 a[64:65], v3 offset:14336
  ds_read_b64_tr_b16 a[66:67], v3 offset:14592
  ds_read_b64_tr_b16 a[72:73], v3 offset:14368
  ds_read_b64_tr_b16 a[74:75], v3 offset:14624
  s_waitcnt lgkmcnt(0)
  s_add_u32 m0, s96, 12288
  s_mov_b32 s90, 0x1c0000
  buffer_load_dwordx4 v1, s[12:15], s90 offen lds
  s_add_u32 m0, s96, 13312
  s_mov_b32 s90, 0x1e0000
  buffer_load_dwordx4 v1, s[12:15], s90 offen lds
  s_add_u32 m0, s96, 14336
  s_mov_b32 s90, 0x1c0000
  buffer_load_dwordx4 v1, s[16:19], s90 offen lds
  s_add_u32 m0, s96, 15360
  s_mov_b32 s90, 0x1e0000
  buffer_load_dwordx4 v1, s[16:19], s90 offen lds
  s_waitcnt vmcnt(28)
  ds_read_b64_tr_b16 a[80:81], v3 offset:16384
  ds_read_b64_tr_b16 a[82:83], v3 offset:16640
  ds_read_b64_tr_b16 a[88:89], v3 offset:16416
  ds_read_b64_tr_b16 a[90:91], v3 offset:16672
  ds_read_b64_tr_b16 a[52:53], v3 offset:18432
  ds_read_b64_tr_b16 a[54:55], v3 offset:18688
  ds_read_b64_tr_b16 a[60:61], v3 offset:18464
  ds_read_b64_tr_b16 a[62:63], v3 offset:18720
  s_waitcnt lgkmcnt(0)
  s_add_u32 m0, s96, 16384
  s_mov_b32 s90, 0x0
  buffer_load_dwordx4 v2, s[20:23], s90 offen lds
  s_add_u32 m0, s96, 17408
  s_mov_b32 s90, 0x4000
  buffer_load_dwordx4 v2, s[20:23], s90 offen lds
  s_add_u32 m0, s96, 18432
  s_mov_b32 s90, 0x8000
  buffer_load_dwordx4 v2, s[20:23], s90 offen lds
  s_add_u32 m0, s96, 19456
  s_mov_b32 s90, 0xc000
  buffer_load_dwordx4 v2, s[20:23], s90 offen lds
  s_waitcnt vmcnt(28)
  ds_read_b64_tr_b16 a[68:69], v3 offset:20480
  ds_read_b64_tr_b16 a[70:71], v3 offset:20736
  ds_read_b64_tr_b16 a[76:77], v3 offset:20512
  ds_read_b64_tr_b16 a[78:79], v3 offset:20768
  ds_read_b64_tr_b16 a[84:85], v3 offset:22528
  ds_read_b64_tr_b16 a[86:87], v3 offset:22784
  ds_read_b64_tr_b16 a[92:93], v3 offset:22560
  ds_read_b64_tr_b16 a[94:95], v3 offset:22816
  s_waitcnt lgkmcnt(0)
  s_add_u32 m0, s96, 20480
  s_mov_b32 s90, 0x10000
  buffer_load_dwordx4 v2, s[20:23], s90 offen lds
  s_add_u32 m0, s96, 21504
  s_mov_b32 s90, 0x14000
  buffer_load_dwordx4 v2, s[20:23], s90 offen lds
  s_add_u32 m0, s96, 22528
  s_mov_b32 s90, 0x18000
  buffer_load_dwordx4 v2, s[20:23], s90 offen lds
  s_add_u32 m0, s96, 23552
  s_mov_b32 s90, 0x1c000
  buffer_load_dwordx4 v2, s[20:23], s90 offen lds
  s_waitcnt vmcnt(28)
  ds_read_b64_tr_b16 a[96:97], v3 offset:24576
  ds_read_b64_tr_b16 a[98:99], v3 offset:24832
  ds_read_b64_tr_b16 a[104:105], v3 offset:24608
  ds_read_b64_tr_b16 a[106:107], v3 offset:24864
  ds_read_b64_tr_b16 a[112:113], v3 offset:26624
  ds_read_b64_tr_b16 a[114:115], v3 offset:26880
  ds_read_b64_tr_b16 a[120:121], v3 offset:26656
  ds_read_b64_tr_b16 a[122:123], v3 offset:26912
  s_waitcnt lgkmcnt(0)
  s_add_u32 m0, s96, 24576
  s_mov_b32 s90, 0x20000
  buffer_load_dwordx4 v2, s[20:23], s90 offen lds
  s_add_u32 m0, s96, 25600
  s_mov_b32 s90, 0x24000
  buffer_load_dwordx4 v2, s[20:23], s90 offen lds
  s_add_u32 m0, s96, 26624
  s_mov_b32 s90, 0x28000
  buffer_load_dwordx4 v2, s[20:23], s90 offen lds
  s_add_u32 m0, s96, 27648
  s_mov_b32 s90, 0x2c000
  buffer_load_dwordx4 v2, s[20:23], s90 offen lds
  s_waitcnt vmcnt(28)
  ds_read_b64_tr_b16 a[128:129], v3 offset:28672
  ds_read_b64_tr_b16 a[130:131], v3 offset:28928
  ds_read_b64_tr_b16 a[136:137], v3 offset:28704
  ds_read_b64_tr_b16 a[138:139], v3 offset:28960
  ds_read_b64_tr_b16 a[100:101], v3 offset:30720
  ds_read_b64_tr_b16 a[102:103], v3 offset:30976
  ds_read_b64_tr_b16 a[108:109], v3 offset:30752
  ds_read_b64_tr_b16 a[110:111], v3 offset:31008
  s_waitcnt lgkmcnt(0)
  s_add_u32 m0, s96, 28672
  s_mov_b32 s90, 0x30000
  buffer_load_dwordx4 v2, s[20:23], s90 offen lds
  s_add_u32 m0, s96, 29696
  s_mov_b32 s90, 0x34000
  buffer_load_dwordx4 v2, s[20:23], s90 offen lds
  s_add_u32 m0, s96, 30720
  s_mov_b32 s90, 0x38000
  buffer_load_dwordx4 v2, s[20:23], s90 offen lds
  s_add_u32 m0, s96, 31744
  s_mov_b32 s90, 0x3c000
  buffer_load_dwordx4 v2, s[20:23], s90 offen lds
  s_waitcnt vmcnt(28)
  ds_read_b64_tr_b16 a[116:117], v3 offset:0
  ds_read_b64_tr_b16 a[118:119], v3 offset:256
  ds_read_b64_tr_b16 a[124:125], v3 offset:32
  ds_read_b64_tr_b16 a[126:127], v3 offset:288
  ds_read_b64_tr_b16 a[132:133], v3 offset:2048
  ds_read_b64_tr_b16 a[134:135], v3 offset:2304
  ds_read_b64_tr_b16 a[140:141], v3 offset:2080
  ds_read_b64_tr_b16 a[142:143], v3 offset:2336
  s_waitcnt vmcnt(24)
  ds_read_b64_tr_b16 a[144:145], v3 offset:4096
  ds_read_b64_tr_b16 a[146:147], v3 offset:4352
  ds_read_b64_tr_b16 a[152:153], v3 offset:4128
  ds_read_b64_tr_b16 a[154:155], v3 offset:4384
  ds_read_b64_tr_b16 a[160:161], v3 offset:6144
  ds_read_b64_tr_b16 a[162:163], v3 offset:6400
  ds_read_b64_tr_b16 a[168:169], v3 offset:6176
  ds_read_b64_tr_b16 a[170:171], v3 offset:6432
  s_waitcnt vmcnt(20)
  ds_read_b64_tr_b16 a[176:177], v3 offset:8192
  ds_read_b64_tr_b16 a[178:179], v3 offset:8448
  ds_read_b64_tr_b16 a[184:185], v3 offset:8224
  ds_read_b64_tr_b16 a[186:187], v3 offset:8480
  ds_read_b64_tr_b16 a[148:149], v3 offset:10240
  ds_read_b64_tr_b16 a[150:151], v3 offset:10496
  ds_read_b64_tr_b16 a[156:157], v3 offset:10272
  ds_read_b64_tr_b16 a[158:159], v3 offset:10528
  s_waitcnt vmcnt(16)
  ds_read_b64_tr_b16 a[164:165], v3 offset:12288
  ds_read_b64_tr_b16 a[166:167], v3 offset:12544
  ds_read_b64_tr_b16 a[172:173], v3 offset:12320
  ds_read_b64_tr_b16 a[174:175], v3 offset:12576
  ds_read_b64_tr_b16 a[180:181], v3 offset:14336
  ds_read_b64_tr_b16 a[182:183], v3 offset:14592
  ds_read_b64_tr_b16 a[188:189], v3 offset:14368
  ds_read_b64_tr_b16 a[190:191], v3 offset:14624
  s_waitcnt vmcnt(0)
  s_barrier
  ds_read_b64_tr_b16 a[192:193], v4 offset:0
  ds_read_b64_tr_b16 a[194:195], v4 offset:2048
  ds_read_b64_tr_b16 a[196:197], v4 offset:512
  ds_read_b64_tr_b16 a[198:199], v4 offset:2560
  ds_read_b64_tr_b16 a[200:201], v4 offset:4096
  ds_read_b64_tr_b16 a[202:203], v4 offset:6144
  ds_read_b64_tr_b16 a[204:205], v4 offset:4608
  ds_read_b64_tr_b16 a[206:207], v4 offset:6656
  s_waitcnt lgkmcnt(0)
  ds_read_b64_tr_b16 a[208:209], v4 offset:32768
  ds_read_b64_tr_b16 a[210:211], v4 offset:34816
  ds_read_b64_tr_b16 a[212:213], v4 offset:33280
  ds_read_b64_tr_b16 a[214:215], v4 offset:35328
  ds_read_b64_tr_b16 a[216:217], v4 offset:36864
  ds_read_b64_tr_b16 a[218:219], v4 offset:38912
  ds_read_b64_tr_b16 a[220:221], v4 offset:37376
  ds_read_b64_tr_b16 a[222:223], v4 offset:39424
  s_waitcnt lgkmcnt(0)
  ds_read_b64_tr_b16 a[224:225], v5 offset:0
  ds_read_b64_tr_b16 a[226:227], v5 offset:2048
  ds_read_b64_tr_b16 a[228:229], v5 offset:512
  ds_read_b64_tr_b16 a[230:231], v5 offset:2560
  ds_read_b64_tr_b16 a[232:233], v5 offset:4096
  ds_read_b64_tr_b16 a[234:235], v5 offset:6144
  ds_read_b64_tr_b16 a[236:237], v5 offset:4608
  ds_read_b64_tr_b16 a[238:239], v5 offset:6656
  s_waitcnt lgkmcnt(0)
  ds_read_b64_tr_b16 a[240:241], v5 offset:32768
  ds_read_b64_tr_b16 a[242:243], v5 offset:34816
  ds_read_b64_tr_b16 a[244:245], v5 offset:33280
  ds_read_b64_tr_b16 a[246:247], v5 offset:35328
  ds_read_b64_tr_b16 a[248:249], v5 offset:36864
  ds_read_b64_tr_b16 a[250:251], v5 offset:38912
  ds_read_b64_tr_b16 a[252:253], v5 offset:37376
  ds_read_b64_tr_b16 a[254:255], v5 offset:39424
  s_waitcnt lgkmcnt(0)
  s_barrier
  s_mov_b32 s46, 0
  v_mov_b32 v9, 0
FL_polwait:
  buffer_load_dwordx2 v[6:7], v9, s[28:31], 0 offen offset:32 sc1
  buffer_load_dword v8, v9, s[28:31], 0 offen offset:64 sc1
  s_waitcnt vmcnt(0)
  v_readfirstlane_b32 s39, v6
  s_add_u32 s46, s46, 1
  s_cmp_ge_u32 s46, 2097152
  s_cbranch_scc1 FL_rec_abort
  s_sleep 4
  v_readfirstlane_b32 s90, v7
  v_readfirstlane_b32 s91, v8
  s_cmp_lt_u32 s90, 128
  s_cbranch_scc1 FL_polwait
  s_cmp_lt_u32 s91, 32
  s_cbranch_scc1 FL_polwait
  s_cmp_eq_u32 s39, 0
  s_cbranch_scc1 FL_polwait
  s_sub_u32 s39, s39, 1
  s_and_b32 s39, s39, 1
  s_lshl_b32 s39, s39, 13
  s_lshl_b32 s90, s34, 2
  s_add_u32 s90, s90, s32
  s_lshr_b32 s91, s90, 3
  s_lshl_b32 s91, s91, 14
  s_and_b32 s92, s90, 7
  s_lshl_b32 s92, s92, 10
  s_add_u32 s91, s91, s92
  s_add_u32 s91, s91, s39
  v_mov_b32 v1, 0x0
  v_bfe_u32 v31, v0, 0, 6
  v_lshl_add_u32 v1, v31, 4, v1
  v_add_u32 v1, s91, v1
  v_lshrrev_b32 v30, 4, v0
  v_cmp_eq_u32 vcc, s33, v30
  v_xor_b32 v29, 0x2000, v1
  s_nop 0
  v_cndmask_b32 v1, v1, v29, vcc
  s_lshl_b32 s91, s33, 14
  s_lshl_b32 s92, s90, 7
  s_add_u32 s91, s91, s92
  v_mov_b32 v2, 0x200000
  v_bfe_u32 v31, v0, 0, 2
  v_lshl_add_u32 v2, v31, 2, v2
  v_bfe_u32 v31, v0, 2, 1
  v_lshl_add_u32 v2, v31, 6, v2
  v_bfe_u32 v31, v0, 4, 1
  v_lshl_add_u32 v2, v31, 4, v2
  v_bfe_u32 v31, v0, 5, 1
  v_lshl_add_u32 v2, v31, 5, v2
  v_bfe_u32 v31, v0, 3, 1
  v_lshl_add_u32 v2, v31, 31, v2
  v_add_u32 v2, s91, v2
  s_lshr_b32 s92, s90, 1
  s_lshl_b32 s92, s92, 5
  s_and_b32 s91, s90, 1
  s_lshl_b32 s91, s91, 13
  s_add_u32 s92, s92, s91
  v_mov_b32 v30, 0x0
  v_bfe_u32 v31, v0, 2, 1
  v_lshl_add_u32 v30, v31, 12, v30
  v_bfe_u32 v31, v0, 4, 1
  v_lshl_add_u32 v30, v31, 11, v30
  v_bfe_u32 v31, v0, 0, 2
  v_lshl_add_u32 v30, v31, 3, v30
  v_bfe_u32 v31, v0, 5, 1
  v_lshl_add_u32 v30, v31, 2, v30
  v_add_u32 v30, s92, v30
  buffer_load_dword v44, v30, s[24:27], 0 offen
  s_lshl_b32 s91, s33, 14
  s_lshl_b32 s92, s32, 12
  s_add_u32 s91, s91, s92
  v_mov_b32 v3, 0x200000
  v_bfe_u32 v31, v0, 0, 6
  v_lshl_add_u32 v3, v31, 4, v3
  v_add_u32 v3, s91, v3
  s_mul_i32 s91, s32, 3264
  v_mov_b32 v4, 0x0
  v_bfe_u32 v31, v0, 0, 6
  v_lshl_add_u32 v4, v31, 4, v4
  v_add_u32 v4, s91, v4
  s_lshl_b32 s91, s32, 6
  v_mov_b32 v6, 0x0
  v_bfe_u32 v31, v0, 0, 2
  v_lshl_add_u32 v6, v31, 4, v6
  v_bfe_u32 v31, v0, 2, 1
  v_lshl_add_u32 v6, v31, 2, v6
  v_bfe_u32 v31, v0, 3, 1
  s_mov_b32 s99, 1088
  v_mad_u32_u24 v6, v31, s99, v6
  v_bfe_u32 v31, v0, 4, 2
  v_lshl_add_u32 v6, v31, 8, v6
  v_add_u32 v6, s91, v6
  v_add_u32 v240, 3264, v6
  v_add_u32 v241, 6528, v6
  v_add_u32 v242, 9792, v6
  s_lshl_b32 s93, s37, 13
  s_lshl_b32 s91, s38, 10
  s_add_u32 s91, s91, s93
  s_lshl_b32 s92, s32, 8
  s_add_u32 s91, s91, s92
  v_mov_b32 v7, 0x210000
  v_bfe_u32 v31, v0, 0, 6
  v_lshl_add_u32 v7, v31, 2, v7
  v_add_u32 v7, s91, v7
  s_lshl_b32 s91, s37, 11
  s_lshl_b32 s92, s38, 9
  s_add_u32 s96, s91, s92
  s_lshl_b32 s92, s32, 7
  s_add_u32 s91, s96, s92
  v_mov_b32 v19, 0x83000000
  v_bfe_u32 v31, v0, 0, 3
  v_lshl_add_u32 v19, v31, 2, v19
  v_bfe_u32 v31, v0, 4, 2
  v_lshl_add_u32 v19, v31, 5, v19
  v_bfe_u32 v31, v0, 3, 1
  v_lshl_add_u32 v19, v31, 31, v19
  v_add_u32 v19, s91, v19
  s_lshl_b32 s91, s32, 8
  v_mov_b32 v5, 0x880
  v_bfe_u32 v31, v0, 0, 1
  v_lshl_add_u32 v5, v31, 7, v5
  v_bfe_u32 v31, v0, 1, 1
  v_lshl_add_u32 v5, v31, 3, v5
  v_bfe_u32 v31, v0, 2, 3
  v_lshl_add_u32 v5, v31, 4, v5
  v_add_u32 v5, s91, v5
  s_lshr_b32 s92, s38, 1
  s_lshl_b32 s92, s92, 10
  s_add_u32 s91, s91, s92
  s_add_u32 s91, s91, s93
  s_and_b32 s92, s38, 1
  s_lshl_b32 s92, s92, 7
  s_add_u32 s91, s91, s92
  v_mov_b32 v8, 0x211000
  v_bfe_u32 v31, v0, 0, 5
  v_lshl_add_u32 v8, v31, 2, v8
  v_bfe_u32 v31, v0, 5, 1
  v_lshl_add_u32 v8, v31, 31, v8
  v_add_u32 v8, s91, v8
  s_sub_u32 s91, s91, s93
  s_lshl_b32 s92, s37, 11
  s_add_u32 s91, s91, s92
  v_mov_b32 v20, 0x3400000
  v_bfe_u32 v31, v0, 0, 5
  v_lshl_add_u32 v20, v31, 2, v20
  v_bfe_u32 v31, v0, 5, 1
  v_lshl_add_u32 v20, v31, 31, v20
  v_add_u32 v20, s91, v20
  s_lshl_b32 s97, s35, 2
  s_add_u32 s97, s97, s32
  s_lshl_b32 s97, s97, 13
  v_mov_b32 v9, 0x210000
  v_bfe_u32 v31, v0, 0, 6
  v_lshl_add_u32 v9, v31, 4, v9
  v_add_u32 v9, s97, v9
  v_add_u32 v10, 4096, v9
  v_mov_b32 v11, 0x1000000
  v_bfe_u32 v31, v0, 0, 2
  v_lshl_add_u32 v11, v31, 4, v11
  v_bfe_u32 v31, v0, 2, 1
  v_lshl_add_u32 v11, v31, 7, v11
  v_bfe_u32 v31, v0, 3, 1
  v_lshl_add_u32 v11, v31, 12, v11
  v_bfe_u32 v31, v0, 4, 2
  v_lshl_add_u32 v11, v31, 8, v11
  v_add_u32 v11, s97, v11
  v_mov_b32 v12, 0x2000000
  v_bfe_u32 v31, v0, 0, 3
  v_lshl_add_u32 v12, v31, 4, v12
  v_bfe_u32 v31, v0, 3, 1
  v_lshl_add_u32 v12, v31, 11, v12
  v_bfe_u32 v31, v0, 4, 2
  v_lshl_add_u32 v12, v31, 8, v12
  v_add_u32 v12, s97, v12
  v_add_u32 v13, 4096, v12
  s_lshl_b32 s91, s36, 9
  s_add_u32 s91, s91, s97
  v_mov_b32 v21, 0x1000000
  v_bfe_u32 v31, v0, 0, 3
  v_lshl_add_u32 v21, v31, 6, v21
  v_bfe_u32 v31, v0, 3, 1
  v_lshl_add_u32 v21, v31, 24, v21
  v_add_u32 v21, s91, v21
  v_cmp_gt_u32 vcc, 16, v0
  v_mov_b32 v30, 0x80000000
  s_nop 0
  v_cndmask_b32 v21, v30, v21, vcc
  s_lshl_b32 s91, s32, 11
  v_mov_b32 v30, 0x0
  v_bfe_u32 v31, v0, 2, 1
  v_lshl_add_u32 v30, v31, 6, v30
  v_bfe_u32 v31, v0, 0, 1
  v_lshl_add_u32 v30, v31, 5, v30
  v_bfe_u32 v31, v0, 1, 1
  v_lshl_add_u32 v30, v31, 4, v30
  v_mov_b32 v29, 0x0
  v_bfe_u32 v31, v0, 4, 2
  v_lshl_add_u32 v29, v31, 5, v29
  v_xor_b32 v30, v30, v29
  v_mov_b32 v14, 0x3400
  v_bfe_u32 v31, v0, 0, 4
  v_lshl_add_u32 v14, v31, 7, v14
  v_add_u32 v14, s91, v14
  v_add_u32 v14, v14, v30
  v_xor_b32 v15, 16, v14
  v_mov_b32 v30, 0x0
  v_bfe_u32 v31, v0, 5, 1
  v_lshl_add_u32 v30, v31, 6, v30
  v_bfe_u32 v31, v0, 1, 1
  v_lshl_add_u32 v30, v31, 5, v30
  v_bfe_u32 v31, v0, 4, 1
  v_lshl_add_u32 v30, v31, 4, v30
  v_mov_b32 v29, 0x0
  v_bfe_u32 v31, v0, 2, 2
  v_lshl_add_u32 v29, v31, 5, v29
  v_bfe_u32 v31, v0, 0, 1
  v_lshl_add_u32 v29, v31, 4, v29
  v_xor_b32 v30, v30, v29
  v_mov_b32 v16, 0x3400
  v_bfe_u32 v31, v0, 4, 2
  v_lshl_add_u32 v16, v31, 8, v16
  v_bfe_u32 v31, v0, 1, 1
  v_lshl_add_u32 v16, v31, 7, v16
  v_add_u32 v16, v16, v30
  s_lshl_b32 s98, s36, 14
  s_lshl_b32 s92, s35, 7
  s_add_u32 s98, s98, s92
  s_add_u32 s98, s98, s39
  s_lshl_b32 s92, s32, 11
  s_add_u32 s91, s98, s92
  v_mov_b32 v17, 0x0
  v_bfe_u32 v31, v0, 0, 5
  v_lshl_add_u32 v17, v31, 2, v17
  v_bfe_u32 v31, v0, 5, 1
  v_lshl_add_u32 v17, v31, 10, v17
  v_add_u32 v17, s91, v17
  v_xor_b32 v18, 0x2000, v17
  s_mov_b32 s48, 0x33333333
  s_mov_b32 s49, 0x33333333
  s_mov_b32 s50, 0xffff0000
  s_mov_b32 s51, 0xffff0000
  s_mov_b32 s52, 0x0000ffff
  s_mov_b32 s53, 0x0000ffff
  s_mov_b32 s54, 0xfffffffe
  s_mov_b32 s47, 0x3e0293ee
  v_mov_b32 v30, 0x4444
  v_mov_b32 v31, 0xeeee
  v_cndmask_b32 v23, v31, v30, s[48:49]
  v_mov_b32 v22, -1
  v_mov_b32 v248, 0x3f803f80
  v_mov_b32 v249, 0x3f803f80
  v_mov_b32 v250, 0x3f803f80
  v_mov_b32 v251, 0x3f803f80
  v_mov_b32 v252, 0x3f803f80
  v_mov_b32 v253, 0x3f803f80
  v_mov_b32 v254, 0x3f803f80
  v_mov_b32 v255, 0x3f803f80
  v_mov_b32 v232, 0
  v_mov_b32 v233, 0
  v_mov_b32 v234, 0
  v_mov_b32 v235, 0
  v_mov_b32 v112, 0
  v_mov_b32 v113, 0
  s_mov_b32 s56, 0xf0f0f0f0
  s_mov_b32 s57, 0xf0f0f0f0
  v_mov_b32 v30, 0x3f80
  v_mov_b32 v31, 1.0
  v_cndmask_b32 v30, v30, v31, s[56:57]
  s_mov_b32 s56, 0x110011
  s_mov_b32 s57, 0x110011
  v_cndmask_b32 v24, 0, v30, s[56:57]
  s_mov_b32 s56, 0x220022
  s_mov_b32 s57, 0x220022
  v_cndmask_b32 v25, 0, v30, s[56:57]
  s_mov_b32 s56, 0x11001100
  s_mov_b32 s57, 0x11001100
  v_cndmask_b32 v26, 0, v30, s[56:57]
  s_mov_b32 s56, 0x22002200
  s_mov_b32 s57, 0x22002200
  v_cndmask_b32 v27, 0, v30, s[56:57]
  s_mov_b32 s40, 0
  s_mov_b32 s41, 0x3800000
  s_mov_b32 s43, 0x3900000
  s_mov_b32 s44, 0
  s_mov_b32 s55, 0x40000
  s_mov_b32 s45, 0
  buffer_load_dwordx4 v[180:183], v12, s[4:7], s44 offen offset:0
  buffer_load_dwordx4 v[184:187], v12, s[4:7], s44 offen offset:128
  buffer_load_dwordx4 v[188:191], v12, s[4:7], s44 offen offset:1024
  buffer_load_dwordx4 v[192:195], v12, s[4:7], s44 offen offset:1152
  buffer_load_dwordx4 v[196:199], v13, s[4:7], s44 offen offset:0
  buffer_load_dwordx4 v[200:203], v13, s[4:7], s44 offen offset:128
  buffer_load_dwordx4 v[204:207], v13, s[4:7], s44 offen offset:1024
  buffer_load_dwordx4 v[208:211], v13, s[4:7], s44 offen offset:1152
  buffer_load_dwordx4 v[116:119], v11, s[4:7], s44 offen offset:0
  buffer_load_dwordx4 v[132:135], v11, s[4:7], s44 offen offset:64
  buffer_load_dwordx4 v[120:123], v11, s[4:7], s44 offen offset:1024
  buffer_load_dwordx4 v[136:139], v11, s[4:7], s44 offen offset:1088
  buffer_load_dwordx4 v[124:127], v11, s[4:7], s44 offen offset:2048
  buffer_load_dwordx4 v[140:143], v11, s[4:7], s44 offen offset:2112
  buffer_load_dwordx4 v[128:131], v11, s[4:7], s44 offen offset:3072
  buffer_load_dwordx4 v[144:147], v11, s[4:7], s44 offen offset:3136
  s_add_u32 s44, s44, 0x40000
  v_mov_b64 v[64:65], 0
  v_mov_b64 v[66:67], 0
  v_mov_b64 v[68:69], 0
  v_mov_b64 v[70:71], 0
  v_mov_b64 v[72:73], 0
  v_mov_b64 v[74:75], 0
  v_mov_b64 v[76:77], 0
  v_mov_b64 v[78:79], 0
  v_mov_b64 v[80:81], 0
  v_mov_b64 v[82:83], 0
  v_mov_b64 v[84:85], 0
  v_mov_b64 v[86:87], 0
  v_mov_b64 v[32:33], 0
  v_mov_b64 v[34:35], 0
  v_mov_b64 v[212:213], 0
  v_mov_b64 v[214:215], 0
  v_mov_b64 v[216:217], 0
  v_mov_b64 v[218:219], 0
  v_mov_b64 v[220:221], 0
  v_mov_b64 v[222:223], 0
  v_mov_b64 v[224:225], 0
  v_mov_b64 v[226:227], 0
  v_mov_b64 v[228:229], 0
  v_mov_b64 v[230:231], 0
  s_waitcnt vmcnt(0)
  v_min_u32 v44, s54, v44
  v_mov_b32 v244, 0
  s_lshl_b32 s90, s33, 5
  s_add_u32 s90, s90, s34
  s_lshl_b32 s90, s90, 2
  s_add_u32 s90, s90, s32
  v_mbcnt_lo_u32_b32 v30, -1, 0
  v_mbcnt_hi_u32_b32 v30, -1, v30
  v_add_u32 v30, s90, v30
  v_cmp_eq_u32 vcc, 0, v30
  v_mov_b32 v30, 0x80000000
  v_mov_b32 v31, 40
  v_cndmask_b32 v245, v30, v31, vcc
  s_branch FL_pubmem
FL_step:
  buffer_load_dwordx4 v[192:195], v12, s[4:7], s44 offen offset:1152
  buffer_load_dwordx4 v[196:199], v13, s[4:7], s44 offen offset:0
  buffer_load_dwordx4 v[200:203], v13, s[4:7], s44 offen offset:128
  buffer_load_dwordx4 v[204:207], v13, s[4:7], s44 offen offset:1024
  v_mov_b64 v[64:65], 0
  v_mov_b64 v[66:67], 0
  v_mov_b64 v[68:69], 0
  v_mov_b64 v[70:71], 0
  v_mov_b64 v[72:73], 0
  v_mov_b64 v[74:75], 0
  v_mov_b64 v[76:77], 0
  v_mov_b64 v[78:79], 0
  v_mov_b64 v[80:81], 0
  v_mov_b64 v[82:83], 0
  v_mov_b64 v[84:85], 0
  v_mov_b64 v[86:87], 0
  v_mov_b64 v[32:33], 0
  v_mov_b64 v[34:35], 0
  buffer_load_dwordx4 v[36:39], v1, s[4:7], s42 offen sc1
  buffer_load_dwordx4 v[208:211], v13, s[4:7], s44 offen offset:1152
  buffer_load_dwordx4 v[124:127], v11, s[4:7], s44 offen offset:2048
  buffer_load_dwordx4 v[140:143], v11, s[4:7], s44 offen offset:2112
  buffer_load_dwordx4 v[128:131], v11, s[4:7], s44 offen offset:3072
  buffer_load_dwordx4 v[144:147], v11, s[4:7], s44 offen offset:3136
  s_add_u32 s44, s44, 0x40000
  s_min_u32 s44, s44, 0xfc0000
  s_add_u32 s45, s45, 0x10000
  s_waitcnt vmcnt(12)
FL_kv_chk:
  v_readfirstlane_b32 s90, v243
  s_cmp_lt_u32 s90, 32
  s_cbranch_scc1 FL_kv_f
  s_waitcnt vmcnt(5)
FL_g_chk:
  v_max3_u32 v31, v36, v37, v38
  v_max_u32 v31, v31, v39
  v_cmp_eq_u32 vcc, -1, v31
  v_mfma_f32_16x16x32_bf16 v[40:43], v[24:27], v[36:39], 0
  s_cbranch_vccnz FL_g_f
  s_nop 6
  v_add_f32_dpp v45, v40, v40 row_ror:8 row_mask:0xf bank_mask:0xf
  v_add_f32_dpp v46, v41, v41 row_ror:8 row_mask:0xf bank_mask:0xf
  v_cvt_pk_bf16_f32 v44, v45, v46
  v_min_u32 v44, s54, v44
FL_pubmem:
  buffer_store_dword v44, v2, s[4:7], s41 offen
  s_waitcnt vmcnt(5)
  v_mov_b32 v148, v180
  v_mov_b32 v150, v181
  v_mov_b32 v152, v182
  v_mov_b32 v154, v183
  v_mov_b32 v149, v184
  v_mov_b32 v151, v185
  v_mov_b32 v153, v186
  v_mov_b32 v155, v187
  v_mov_b32 v156, v188
  v_mov_b32 v158, v189
  v_mov_b32 v160, v190
  v_mov_b32 v162, v191
  v_mov_b32 v157, v192
  v_mov_b32 v159, v193
  v_mov_b32 v161, v194
  v_mov_b32 v163, v195
  v_mov_b32 v164, v196
  v_mov_b32 v166, v197
  v_mov_b32 v168, v198
  v_mov_b32 v170, v199
  v_mov_b32 v165, v200
  v_mov_b32 v167, v201
  v_mov_b32 v169, v202
  v_mov_b32 v171, v203
  buffer_load_dwordx4 v[48:51], v3, s[4:7], s41 offen offset:0 sc1
  v_mov_b32 v172, v204
  v_mov_b32 v174, v205
  buffer_load_dwordx4 v[52:55], v3, s[4:7], s41 offen offset:1024 sc1
  v_mov_b32 v176, v206
  v_mov_b32 v178, v207
  buffer_load_dwordx4 v[56:59], v3, s[4:7], s41 offen offset:2048 sc1
  v_mov_b32 v173, v208
  v_mov_b32 v175, v209
  buffer_load_dwordx4 v[60:63], v3, s[4:7], s41 offen offset:3072 sc1
  v_mov_b32 v177, v210
  v_mov_b32 v179, v211
  s_waitcnt vmcnt(3)
  v_max3_u32 v31, v48, v49, v50
  v_max_u32 v31, v31, v51
  v_cmp_eq_u32 vcc, -1, v31
  s_cbranch_vccnz FL_m_f0
  v_smfmac_f32_16x16x64_bf16 v[64:67], v[48:51], a[0:7], v23
  s_waitcnt vmcnt(2)
  v_max3_u32 v31, v52, v53, v54
  v_max_u32 v31, v31, v55
  v_cmp_eq_u32 vcc, -1, v31
  v_smfmac_f32_16x16x64_bf16 v[68:71], v[48:51], a[8:15], v23
  v_smfmac_f32_16x16x64_bf16 v[72:75], v[48:51], a[16:23], v23
  v_smfmac_f32_16x16x64_bf16 v[76:79], v[48:51], a[24:31], v23
  v_smfmac_f32_16x16x64_bf16 v[80:83], v[48:51], a[32:39], v23
  v_smfmac_f32_16x16x64_bf16 v[84:87], v[48:51], a[40:47], v23
  s_cbranch_vccnz FL_m_f1
  v_smfmac_f32_16x16x64_bf16 v[64:67], v[52:55], a[48:55], v23
  s_waitcnt vmcnt(1)
  v_max3_u32 v31, v56, v57, v58
  v_max_u32 v31, v31, v59
  v_cmp_eq_u32 vcc, -1, v31
  v_smfmac_f32_16x16x64_bf16 v[68:71], v[52:55], a[56:63], v23
  v_smfmac_f32_16x16x64_bf16 v[72:75], v[52:55], a[64:71], v23
  v_smfmac_f32_16x16x64_bf16 v[76:79], v[52:55], a[72:79], v23
  v_smfmac_f32_16x16x64_bf16 v[80:83], v[52:55], a[80:87], v23
  v_smfmac_f32_16x16x64_bf16 v[84:87], v[52:55], a[88:95], v23
  s_cbranch_vccnz FL_m_f2
  v_smfmac_f32_16x16x64_bf16 v[64:67], v[56:59], a[96:103], v23
  s_waitcnt vmcnt(0)
  v_max3_u32 v31, v60, v61, v62
  v_max_u32 v31, v31, v63
  v_cmp_eq_u32 vcc, -1, v31
  v_smfmac_f32_16x16x64_bf16 v[68:71], v[56:59], a[104:111], v23
  v_smfmac_f32_16x16x64_bf16 v[72:75], v[56:59], a[112:119], v23
  v_smfmac_f32_16x16x64_bf16 v[76:79], v[56:59], a[120:127], v23
  v_smfmac_f32_16x16x64_bf16 v[80:83], v[56:59], a[128:135], v23
  v_smfmac_f32_16x16x64_bf16 v[84:87], v[56:59], a[136:143], v23
  s_cbranch_vccnz FL_m_f3
  v_smfmac_f32_16x16x64_bf16 v[64:67], v[60:63], a[144:151], v23
  v_smfmac_f32_16x16x64_bf16 v[68:71], v[60:63], a[152:159], v23
  v_smfmac_f32_16x16x64_bf16 v[72:75], v[60:63], a[160:167], v23
  v_smfmac_f32_16x16x64_bf16 v[76:79], v[60:63], a[168:175], v23
  v_smfmac_f32_16x16x64_bf16 v[80:83], v[60:63], a[176:183], v23
  v_smfmac_f32_16x16x64_bf16 v[84:87], v[60:63], a[184:191], v23
FL_m_done:
  s_nop 2
  v_pk_add_f32 v[88:89], v[64:65], v[66:67]
  v_pk_add_f32 v[90:91], v[68:69], v[70:71]
  ds_write_b128 v4, v[88:91] offset:0
  v_pk_add_f32 v[92:93], v[72:73], v[74:75]
  v_pk_add_f32 v[94:95], v[76:77], v[78:79]
  ds_write_b128 v4, v[92:95] offset:1088
  v_pk_add_f32 v[96:97], v[80:81], v[82:83]
  v_pk_add_f32 v[98:99], v[84:85], v[86:87]
  ds_write_b128 v4, v[96:99] offset:2176
  buffer_load_dwordx4 v[180:183], v12, s[4:7], s44 offen offset:0
  buffer_load_dwordx4 v[184:187], v12, s[4:7], s44 offen offset:128
  buffer_load_dwordx4 v[188:191], v12, s[4:7], s44 offen offset:1024
  v_mov_b64 v[36:37], 0
  v_mov_b64 v[38:39], 0
  v_mov_b64 v[40:41], 0
  v_mov_b64 v[42:43], 0
  v_mov_b64 v[44:45], 0
  v_mov_b64 v[46:47], 0
  s_waitcnt lgkmcnt(0)
  s_barrier
  ds_read2_b32 v[100:101], v6 offset0:0 offset1:2
  ds_read2_b32 v[102:103], v240 offset0:0 offset1:2
  ds_read2_b32 v[104:105], v241 offset0:0 offset1:2
  ds_read2_b32 v[106:107], v242 offset0:0 offset1:2
  ds_read_b64 v[88:89], v5 offset:0
  ds_read_b64 v[90:91], v5 offset:3264
  ds_read_b64 v[92:93], v5 offset:6528
  ds_read_b64 v[94:95], v5 offset:9792
  s_waitcnt lgkmcnt(6)
  v_pk_add_f32 v[100:101], v[100:101], v[102:103]
  s_waitcnt lgkmcnt(4)
  v_pk_add_f32 v[104:105], v[104:105], v[106:107]
  v_pk_add_f32 v[100:101], v[100:101], v[104:105]
  v_cvt_pk_bf16_f32 v112, v100, v101
  v_min_u32 v112, s54, v112
  buffer_store_dword v112, v7, s[4:7], s41 offen
  s_waitcnt lgkmcnt(2)
  v_pk_add_f32 v[88:89], v[88:89], v[90:91]
  s_waitcnt lgkmcnt(0)
  v_pk_add_f32 v[92:93], v[92:93], v[94:95]
  v_pk_add_f32 v[88:89], v[88:89], v[92:93]
  v_cvt_pk_bf16_f32 v113, v88, v89
  v_min_u32 v113, s54, v113
  buffer_store_dword v113, v8, s[4:7], s41 offen
  v_mov_b64 v[212:213], 0
  v_mov_b64 v[214:215], 0
  v_mov_b64 v[216:217], 0
  v_mov_b64 v[218:219], 0
  v_mov_b64 v[220:221], 0
  v_mov_b64 v[222:223], 0
  v_mov_b64 v[224:225], 0
  v_mov_b64 v[226:227], 0
  v_mov_b64 v[228:229], 0
  v_mov_b64 v[230:231], 0
  buffer_load_dwordx4 v[64:67], v9, s[4:7], s41 offen offset:0 sc1
  s_mov_b32 s42, s41
  s_add_u32 s90, s40, 1
  buffer_load_dwordx4 v[68:71], v9, s[4:7], s41 offen offset:1024 sc1
  s_and_b32 s90, s90, 3
  s_lshl_b32 s90, s90, 19
  buffer_load_dwordx4 v[72:75], v9, s[4:7], s41 offen offset:2048 sc1
  s_add_u32 s91, s90, 0x3800000
  s_add_u32 s55, s55, 0x40000
  buffer_load_dwordx4 v[76:79], v9, s[4:7], s41 offen offset:3072 sc1
  s_min_u32 s55, s55, 0xfc0000
  s_nop 0
  s_cmp_eq_u32 s40, 63
  s_cbranch_scc1 FL_last
  s_waitcnt vmcnt(3)
  v_max3_u32 v31, v64, v65, v66
  v_max_u32 v31, v31, v67
  v_cmp_eq_u32 vcc, -1, v31
  s_cbranch_vccnz FL_x_f0
  v_mfma_f32_16x16x32_bf16 v[44:47], v[64:67], v[64:67], v[44:47]
  s_waitcnt vmcnt(2)
  v_max3_u32 v31, v68, v69, v70
  v_max_u32 v31, v31, v71
  v_cmp_eq_u32 vcc, -1, v31
  v_mfma_f32_16x16x32_bf16 v[36:39], v[116:119], v[64:67], v[36:39]
  v_mfma_f32_16x16x32_bf16 v[40:43], v[132:135], v[64:67], v[40:43]
  s_cbranch_vccnz FL_x_f1
  v_mfma_f32_16x16x32_bf16 v[44:47], v[68:71], v[68:71], v[44:47]
  s_waitcnt vmcnt(1)
  v_max3_u32 v31, v72, v73, v74
  v_max_u32 v31, v31, v75
  v_cmp_eq_u32 vcc, -1, v31
  v_mfma_f32_16x16x32_bf16 v[36:39], v[120:123], v[68:71], v[36:39]
  v_mfma_f32_16x16x32_bf16 v[40:43], v[136:139], v[68:71], v[40:43]
  s_cbranch_vccnz FL_x_f2
  v_mfma_f32_16x16x32_bf16 v[44:47], v[72:75], v[72:75], v[44:47]
  s_waitcnt vmcnt(0)
  v_max3_u32 v31, v76, v77, v78
  v_max_u32 v31, v31, v79
  v_cmp_eq_u32 vcc, -1, v31
  v_mfma_f32_16x16x32_bf16 v[36:39], v[124:127], v[72:75], v[36:39]
  v_mfma_f32_16x16x32_bf16 v[40:43], v[140:143], v[72:75], v[40:43]
  s_cbranch_vccnz FL_x_f3
  v_mfma_f32_16x16x32_bf16 v[44:47], v[76:79], v[76:79], v[44:47]
  v_mfma_f32_16x16x32_bf16 v[36:39], v[128:131], v[76:79], v[36:39]
  v_mfma_f32_16x16x32_bf16 v[40:43], v[144:147], v[76:79], v[40:43]
FL_x_done:
  buffer_load_dwordx4 v[88:91], v10, s[4:7], s41 offen offset:0 sc1
  buffer_load_dwordx4 v[92:95], v10, s[4:7], s41 offen offset:1024 sc1
  s_mov_b64 vcc, s[48:49]
  s_nop 2
  v_max_f32 v30, v46, v47
  s_nop 0
  v_cndmask_b32_dpp v96, v40, v36, vcc quad_perm:[0,1,0,1] row_mask:0xf bank_mask:0xf
  v_cndmask_b32_dpp v97, v41, v37, vcc quad_perm:[0,1,0,1] row_mask:0xf bank_mask:0xf
  v_cndmask_b32_dpp v98, v42, v38, vcc quad_perm:[0,1,0,1] row_mask:0xf bank_mask:0xf
  v_cndmask_b32_dpp v99, v43, v39, vcc quad_perm:[0,1,0,1] row_mask:0xf bank_mask:0xf
  v_max3_f32 v29, v96, v97, v98
  s_nop 0
  v_max_f32_dpp v28, v30, v99 quad_perm:[0,1,0,1] row_mask:0xf bank_mask:0xf
  v_max_f32 v29, v29, v28
  s_nop 1
  v_max_f32_dpp v28, v29, v29 quad_perm:[2,3,0,1] row_mask:0xf bank_mask:0xf
  v_mov_b32 v29, v28
  s_nop 1
  v_permlane32_swap_b32 v28, v29
  v_max_f32 v28, v28, v29
  v_mov_b32 v29, v28
  s_nop 1
  v_permlane16_swap_b32 v28, v29
  v_max_f32 v28, v28, v29
  v_mul_f32 v28, s47, v28
  v_fma_f32 v96, v96, s47, -v28
  v_fma_f32 v97, v97, s47, -v28
  v_fma_f32 v98, v98, s47, -v28
  v_fma_f32 v99, v99, s47, -v28
  v_fma_f32 v46, v46, s47, -v28
  v_fma_f32 v47, v47, s47, -v28
  v_exp_f32 v96, v96
  v_exp_f32 v97, v97
  v_exp_f32 v98, v98
  v_exp_f32 v99, v99
  v_cvt_pk_bf16_f32 v236, v96, v97
  v_cvt_pk_bf16_f32 v237, v98, v99
  v_exp_f32 v46, v46
  v_mov_b32_dpp v100, v236 quad_perm:[0,1,0,1] row_mask:0xf bank_mask:0xf
  v_mov_b32_dpp v102, v236 quad_perm:[2,3,2,3] row_mask:0xf bank_mask:0xf
  v_mov_b32_dpp v101, v237 quad_perm:[0,1,0,1] row_mask:0xf bank_mask:0xf
  v_mov_b32_dpp v103, v237 quad_perm:[2,3,2,3] row_mask:0xf bank_mask:0xf
  v_exp_f32 v47, v47
  s_nop 0
  v_smfmac_f32_16x16x64_bf16 v[228:231], v[100:103], v[248:255], v23
  v_cvt_pk_bf16_f32 v238, v46, v47
  buffer_load_dwordx4 v[116:119], v11, s[4:7], s44 offen offset:0
  v_smfmac_f32_16x16x64_bf16 v[212:215], v[100:103], v[148:155], v23
  buffer_load_dwordx4 v[132:135], v11, s[4:7], s44 offen offset:64
  v_mov_b32_dpp v232, v238 quad_perm:[0,1,0,1] row_mask:0xf bank_mask:0xf
  v_smfmac_f32_16x16x64_bf16 v[216:219], v[100:103], v[156:163], v23
  buffer_load_dwordx4 v[120:123], v11, s[4:7], s44 offen offset:1024
  v_mov_b32_dpp v235, v238 quad_perm:[0,1,0,1] row_mask:0xf bank_mask:0xf
  v_smfmac_f32_16x16x64_bf16 v[220:223], v[100:103], v[164:171], v23
  buffer_load_dwordx4 v[136:139], v11, s[4:7], s44 offen offset:1088
  s_waitcnt vmcnt(4)
  v_max3_u32 v31, v88, v89, v90
  v_max3_u32 v31, v31, v91, v92
  v_smfmac_f32_16x16x32_bf16 v[228:231], v[232:233], v[248:251], v23
  v_max3_u32 v31, v31, v93, v94
  v_max_u32 v31, v31, v95
  v_cmp_eq_u32 vcc, -1, v31
  v_smfmac_f32_16x16x64_bf16 v[224:227], v[100:103], v[172:179], v23
  s_cbranch_vccnz FL_v_f
FL_v_ok:
  v_smfmac_f32_16x16x32_bf16 v[212:215], v[232:233], v[88:91], v23
  buffer_store_dword v22, v18, s[4:7], s43 offen
  buffer_store_dword v22, v2, s[4:7], s43 offen
  v_smfmac_f32_16x16x32_bf16 v[216:219], v[234:235], v[88:91], v23
  buffer_store_dword v22, v7, s[4:7], s43 offen
  v_rcp_f32 v28, v228
  v_smfmac_f32_16x16x32_bf16 v[220:223], v[232:233], v[92:95], v23
  buffer_store_dword v22, v8, s[4:7], s43 offen
  v_rcp_f32 v29, v229
  v_smfmac_f32_16x16x32_bf16 v[224:227], v[234:235], v[92:95], v23
  v_pk_mul_f32 v[212:213], v[212:213], v[28:29]
  v_pk_mul_f32 v[214:215], v[214:215], v[28:29]
  v_cvt_pk_bf16_f32 v104, v212, v214
  v_cvt_pk_bf16_f32 v108, v213, v215
  v_pk_mul_f32 v[216:217], v[216:217], v[28:29]
  v_pk_mul_f32 v[218:219], v[218:219], v[28:29]
  v_cvt_pk_bf16_f32 v105, v216, v218
  v_cvt_pk_bf16_f32 v109, v217, v219
  v_pk_mul_f32 v[220:221], v[220:221], v[28:29]
  v_pk_mul_f32 v[222:223], v[222:223], v[28:29]
  v_cvt_pk_bf16_f32 v106, v220, v222
  v_cvt_pk_bf16_f32 v110, v221, v223
  v_pk_mul_f32 v[224:225], v[224:225], v[28:29]
  v_pk_mul_f32 v[226:227], v[226:227], v[28:29]
  v_cvt_pk_bf16_f32 v107, v224, v226
  v_cvt_pk_bf16_f32 v111, v225, v227
  ds_write_b128 v14, v[104:107]
  ds_write_b128 v15, v[108:111]
  s_add_u32 s92, s40, 3
  s_min_u32 s92, s92, 63
  s_lshr_b32 s92, s92, 3
  s_lshl_b32 s92, s92, 2
  s_max_u32 s93, s40, 1
  s_sub_u32 s93, s93, 1
  v_mov_b32 v246, s93
  s_waitcnt lgkmcnt(0)
  s_barrier
  ds_read_b128 v[48:51], v16 offset:0
  ds_read_b128 v[52:55], v16 offset:1024
  ds_read_b128 v[56:59], v16 offset:2048
  ds_read_b128 v[60:63], v16 offset:3072
  ds_read_b128 v[64:67], v16 offset:4096
  buffer_load_dword v0, v21, s[4:7], s55 offen
  buffer_store_dword v22, v17, s[4:7], s43 offen sc1
  s_waitcnt lgkmcnt(4)
  v_smfmac_f32_16x16x64_bf16 v[32:35], v[48:51], a[192:199], v23
  ds_read_b128 v[68:71], v16 offset:5120
  buffer_store_dword v112, v19, s[4:7], s45 offen sc1
  s_waitcnt lgkmcnt(4)
  v_smfmac_f32_16x16x64_bf16 v[32:35], v[52:55], a[200:207], v23
  ds_read_b128 v[72:75], v16 offset:6144
  buffer_store_dword v113, v20, s[4:7], s45 offen sc1
  s_waitcnt lgkmcnt(4)
  v_smfmac_f32_16x16x64_bf16 v[32:35], v[56:59], a[208:215], v23
  ds_read_b128 v[76:79], v16 offset:7168
  buffer_store_dword v246, v245, s[28:31], 0 offen sc1
  s_waitcnt lgkmcnt(4)
  v_smfmac_f32_16x16x64_bf16 v[32:35], v[60:63], a[216:223], v23
  buffer_load_dword v243, v244, s[28:31], s92 offen offset:64 sc1
  s_waitcnt lgkmcnt(3)
  v_smfmac_f32_16x16x64_bf16 v[32:35], v[64:67], a[224:231], v23
  s_add_u32 s40, s40, 1
  s_waitcnt lgkmcnt(2)
  v_smfmac_f32_16x16x64_bf16 v[32:35], v[68:71], a[232:239], v23
  s_mov_b32 s41, s91
  s_waitcnt lgkmcnt(1)
  v_smfmac_f32_16x16x64_bf16 v[32:35], v[72:75], a[240:247], v23
  s_xor_b32 s43, s91, 0x100000
  s_waitcnt lgkmcnt(0)
  v_smfmac_f32_16x16x64_bf16 v[32:35], v[76:79], a[248:255], v23
  s_nop 7
  v_pk_add_f32 v[28:29], v[32:33], v[34:35]
  v_cvt_pk_bf16_f32 v28, v28, v29
  v_min_u32 v28, s54, v28
  buffer_store_dword v28, v17, s[4:7], s42 offen sc1
  buffer_store_dword v28, v18, s[4:7], s42 offen
  s_branch FL_step
FL_last:
  buffer_store_dword v112, v19, s[4:7], s45 offen sc1
  buffer_store_dword v113, v20, s[4:7], s45 offen sc1
  s_waitcnt vmcnt(0)
  s_barrier
  s_cmp_lg_u32 s32, 0
  s_cbranch_scc1 FL_sig_4
  v_mov_b32 v254, 1
  v_mov_b32 v255, 0
  s_mov_b64 exec, 1
  buffer_atomic_add v254, v255, s[28:31], 0 offen offset:44 sc1
  s_mov_b64 exec, -1
FL_sig_4:
  s_waitcnt vmcnt(0)
  s_branch L_exit
FL_kv_f:
  s_sleep 8
  buffer_load_dword v243, v244, s[28:31], s92 offen offset:64 sc1
  s_add_u32 s46, s46, 1
  s_cmp_ge_u32 s46, 2097152
  s_cbranch_scc1 FL_rec_abort
  s_waitcnt vmcnt(0)
  s_branch FL_kv_chk
FL_g_f:
  s_mov_b64 exec, vcc
  buffer_load_dwordx4 v[36:39], v1, s[4:7], s42 offen sc1
  s_mov_b64 exec, -1
  s_add_u32 s46, s46, 1
  s_cmp_ge_u32 s46, 2097152
  s_cbranch_scc1 FL_rec_abort
  s_waitcnt vmcnt(0)
  s_branch FL_g_chk
FL_m_f0:
  s_mov_b64 exec, vcc
  buffer_load_dwordx4 v[48:51], v3, s[4:7], s41 offen offset:0 sc1
  s_mov_b64 exec, -1
  s_waitcnt vmcnt(1)
  s_branch FL_m_0123_c1
FL_m_f1:
  s_mov_b64 exec, vcc
  buffer_load_dwordx4 v[52:55], v3, s[4:7], s41 offen offset:1024 sc1
  s_mov_b64 exec, -1
  s_waitcnt vmcnt(1)
  s_branch FL_m_123_c2
FL_m_f2:
  s_mov_b64 exec, vcc
  buffer_load_dwordx4 v[56:59], v3, s[4:7], s41 offen offset:2048 sc1
  s_mov_b64 exec, -1
  s_waitcnt vmcnt(1)
  s_branch FL_m_23_c3
FL_m_f3:
  s_mov_b64 exec, vcc
  buffer_load_dwordx4 v[60:63], v3, s[4:7], s41 offen offset:3072 sc1
  s_mov_b64 exec, -1
  s_nop 7
  s_branch FL_m_3_c3
FL_m_0_c0:
  v_max3_u32 v31, v48, v49, v50
  v_max_u32 v31, v31, v51
  v_cmp_eq_u32 vcc, -1, v31
  s_cbranch_vccz FL_m_0_ok0
FL_m_0_x0:
  s_mov_b64 exec, vcc
  buffer_load_dwordx4 v[48:51], v3, s[4:7], s41 offen offset:0 sc1
  s_mov_b64 exec, -1
  s_add_u32 s46, s46, 1
  s_cmp_ge_u32 s46, 2097152
  s_cbranch_scc1 FL_rec_abort
  s_waitcnt vmcnt(2)
  s_branch FL_m_0_c0
FL_m_0_ok0:
  v_smfmac_f32_16x16x64_bf16 v[64:67], v[48:51], a[0:7], v23
  v_smfmac_f32_16x16x64_bf16 v[68:71], v[48:51], a[8:15], v23
  v_smfmac_f32_16x16x64_bf16 v[72:75], v[48:51], a[16:23], v23
  v_smfmac_f32_16x16x64_bf16 v[76:79], v[48:51], a[24:31], v23
  v_smfmac_f32_16x16x64_bf16 v[80:83], v[48:51], a[32:39], v23
  v_smfmac_f32_16x16x64_bf16 v[84:87], v[48:51], a[40:47], v23
  s_branch FL_m_done
FL_m_1_c1:
  v_max3_u32 v31, v52, v53, v54
  v_max_u32 v31, v31, v55
  v_cmp_eq_u32 vcc, -1, v31
  s_cbranch_vccz FL_m_1_ok1
FL_m_1_x1:
  s_mov_b64 exec, vcc
  buffer_load_dwordx4 v[52:55], v3, s[4:7], s41 offen offset:1024 sc1
  s_mov_b64 exec, -1
  s_add_u32 s46, s46, 1
  s_cmp_ge_u32 s46, 2097152
  s_cbranch_scc1 FL_rec_abort
  s_waitcnt vmcnt(2)
  s_branch FL_m_1_c1
FL_m_1_ok1:
  v_smfmac_f32_16x16x64_bf16 v[64:67], v[52:55], a[48:55], v23
  v_smfmac_f32_16x16x64_bf16 v[68:71], v[52:55], a[56:63], v23
  v_smfmac_f32_16x16x64_bf16 v[72:75], v[52:55], a[64:71], v23
  v_smfmac_f32_16x16x64_bf16 v[76:79], v[52:55], a[72:79], v23
  v_smfmac_f32_16x16x64_bf16 v[80:83], v[52:55], a[80:87], v23
  v_smfmac_f32_16x16x64_bf16 v[84:87], v[52:55], a[88:95], v23
  s_branch FL_m_done
FL_m_2_c2:
  v_max3_u32 v31, v56, v57, v58
  v_max_u32 v31, v31, v59
  v_cmp_eq_u32 vcc, -1, v31
  s_cbranch_vccz FL_m_2_ok2
FL_m_2_x2:
  s_mov_b64 exec, vcc
  buffer_load_dwordx4 v[56:59], v3, s[4:7], s41 offen offset:2048 sc1
  s_mov_b64 exec, -1
  s_add_u32 s46, s46, 1
  s_cmp_ge_u32 s46, 2097152
  s_cbranch_scc1 FL_rec_abort
  s_waitcnt vmcnt(2)
  s_branch FL_m_2_c2
FL_m_2_ok2:
  v_smfmac_f32_16x16x64_bf16 v[64:67], v[56:59], a[96:103], v23
  v_smfmac_f32_16x16x64_bf16 v[68:71], v[56:59], a[104:111], v23
  v_smfmac_f32_16x16x64_bf16 v[72:75], v[56:59], a[112:119], v23
  v_smfmac_f32_16x16x64_bf16 v[76:79], v[56:59], a[120:127], v23
  v_smfmac_f32_16x16x64_bf16 v[80:83], v[56:59], a[128:135], v23
  v_smfmac_f32_16x16x64_bf16 v[84:87], v[56:59], a[136:143], v23
  s_branch FL_m_done
FL_m_3_c3:
  v_max3_u32 v31, v60, v61, v62
  v_max_u32 v31, v31, v63
  v_cmp_eq_u32 vcc, -1, v31
  s_cbranch_vccz FL_m_3_ok3
FL_m_3_x3:
  s_mov_b64 exec, vcc
  buffer_load_dwordx4 v[60:63], v3, s[4:7], s41 offen offset:3072 sc1
  s_mov_b64 exec, -1
  s_add_u32 s46, s46, 1
  s_cmp_ge_u32 s46, 2097152
  s_cbranch_scc1 FL_rec_abort
  s_waitcnt vmcnt(2)
  s_branch FL_m_3_c3
FL_m_3_ok3:
  v_smfmac_f32_16x16x64_bf16 v[64:67], v[60:63], a[144:151], v23
  v_smfmac_f32_16x16x64_bf16 v[68:71], v[60:63], a[152:159], v23
  v_smfmac_f32_16x16x64_bf16 v[72:75], v[60:63], a[160:167], v23
  v_smfmac_f32_16x16x64_bf16 v[76:79], v[60:63], a[168:175], v23
  v_smfmac_f32_16x16x64_bf16 v[80:83], v[60:63], a[176:183], v23
  v_smfmac_f32_16x16x64_bf16 v[84:87], v[60:63], a[184:191], v23
  s_branch FL_m_done
FL_m_01_c0:
  v_max3_u32 v31, v48, v49, v50
  v_max_u32 v31, v31, v51
  v_cmp_eq_u32 vcc, -1, v31
  s_cbranch_vccz FL_m_01_ok0
FL_m_01_x0:
  s_mov_b64 exec, vcc
  buffer_load_dwordx4 v[48:51], v3, s[4:7], s41 offen offset:0 sc1
  s_mov_b64 exec, -1
FL_m_01_c1:
  v_max3_u32 v31, v52, v53, v54
  v_max_u32 v31, v31, v55
  v_cmp_eq_u32 vcc, -1, v31
  s_cbranch_vccz FL_m_01_ok1
FL_m_01_x1:
  s_mov_b64 exec, vcc
  buffer_load_dwordx4 v[52:55], v3, s[4:7], s41 offen offset:1024 sc1
  s_mov_b64 exec, -1
  s_add_u32 s46, s46, 1
  s_cmp_ge_u32 s46, 2097152
  s_cbranch_scc1 FL_rec_abort
  s_waitcnt vmcnt(4)
  s_branch FL_m_01_c0
FL_m_01_ok0:
  v_smfmac_f32_16x16x64_bf16 v[64:67], v[48:51], a[0:7], v23
  v_max3_u32 v31, v52, v53, v54
  v_max_u32 v31, v31, v55
  v_cmp_eq_u32 vcc, -1, v31
  v_smfmac_f32_16x16x64_bf16 v[68:71], v[48:51], a[8:15], v23
  v_smfmac_f32_16x16x64_bf16 v[72:75], v[48:51], a[16:23], v23
  v_smfmac_f32_16x16x64_bf16 v[76:79], v[48:51], a[24:31], v23
  v_smfmac_f32_16x16x64_bf16 v[80:83], v[48:51], a[32:39], v23
  v_smfmac_f32_16x16x64_bf16 v[84:87], v[48:51], a[40:47], v23
  s_cbranch_vccz FL_m_1_ok1
  s_branch FL_m_1_x1
FL_m_01_ok1:
  v_smfmac_f32_16x16x64_bf16 v[64:67], v[52:55], a[48:55], v23
  v_max3_u32 v31, v48, v49, v50
  v_max_u32 v31, v31, v51
  v_cmp_eq_u32 vcc, -1, v31
  v_smfmac_f32_16x16x64_bf16 v[68:71], v[52:55], a[56:63], v23
  v_smfmac_f32_16x16x64_bf16 v[72:75], v[52:55], a[64:71], v23
  v_smfmac_f32_16x16x64_bf16 v[76:79], v[52:55], a[72:79], v23
  v_smfmac_f32_16x16x64_bf16 v[80:83], v[52:55], a[80:87], v23
  v_smfmac_f32_16x16x64_bf16 v[84:87], v[52:55], a[88:95], v23
  s_cbranch_vccz FL_m_0_ok0
  s_branch FL_m_0_x0
FL_m_02_c0:
  v_max3_u32 v31, v48, v49, v50
  v_max_u32 v31, v31, v51
  v_cmp_eq_u32 vcc, -1, v31
  s_cbranch_vccz FL_m_02_ok0
FL_m_02_x0:
  s_mov_b64 exec, vcc
  buffer_load_dwordx4 v[48:51], v3, s[4:7], s41 offen offset:0 sc1
  s_mov_b64 exec, -1
FL_m_02_c2:
  v_max3_u32 v31, v56, v57, v58
  v_max_u32 v31, v31, v59
  v_cmp_eq_u32 vcc, -1, v31
  s_cbranch_vccz FL_m_02_ok2
FL_m_02_x2:
  s_mov_b64 exec, vcc
  buffer_load_dwordx4 v[56:59], v3, s[4:7], s41 offen offset:2048 sc1
  s_mov_b64 exec, -1
  s_add_u32 s46, s46, 1
  s_cmp_ge_u32 s46, 2097152
  s_cbranch_scc1 FL_rec_abort
  s_waitcnt vmcnt(4)
  s_branch FL_m_02_c0
FL_m_02_ok0:
  v_smfmac_f32_16x16x64_bf16 v[64:67], v[48:51], a[0:7], v23
  v_max3_u32 v31, v56, v57, v58
  v_max_u32 v31, v31, v59
  v_cmp_eq_u32 vcc, -1, v31
  v_smfmac_f32_16x16x64_bf16 v[68:71], v[48:51], a[8:15], v23
  v_smfmac_f32_16x16x64_bf16 v[72:75], v[48:51], a[16:23], v23
  v_smfmac_f32_16x16x64_bf16 v[76:79], v[48:51], a[24:31], v23
  v_smfmac_f32_16x16x64_bf16 v[80:83], v[48:51], a[32:39], v23
  v_smfmac_f32_16x16x64_bf16 v[84:87], v[48:51], a[40:47], v23
  s_cbranch_vccz FL_m_2_ok2
  s_branch FL_m_2_x2
FL_m_02_ok2:
  v_smfmac_f32_16x16x64_bf16 v[64:67], v[56:59], a[96:103], v23
  v_max3_u32 v31, v48, v49, v50
  v_max_u32 v31, v31, v51
  v_cmp_eq_u32 vcc, -1, v31
  v_smfmac_f32_16x16x64_bf16 v[68:71], v[56:59], a[104:111], v23
  v_smfmac_f32_16x16x64_bf16 v[72:75], v[56:59], a[112:119], v23
  v_smfmac_f32_16x16x64_bf16 v[76:79], v[56:59], a[120:127], v23
  v_smfmac_f32_16x16x64_bf16 v[80:83], v[56:59], a[128:135], v23
  v_smfmac_f32_16x16x64_bf16 v[84:87], v[56:59], a[136:143], v23
  s_cbranch_vccz FL_m_0_ok0
  s_branch FL_m_0_x0
FL_m_03_c0:
  v_max3_u32 v31, v48, v49, v50
  v_max_u32 v31, v31, v51
  v_cmp_eq_u32 vcc, -1, v31
  s_cbranch_vccz FL_m_03_ok0
FL_m_03_x0:
  s_mov_b64 exec, vcc
  buffer_load_dwordx4 v[48:51], v3, s[4:7], s41 offen offset:0 sc1
  s_mov_b64 exec, -1
FL_m_03_c3:
  v_max3_u32 v31, v60, v61, v62
  v_max_u32 v31, v31, v63
  v_cmp_eq_u32 vcc, -1, v31
  s_cbranch_vccz FL_m_03_ok3
FL_m_03_x3:
  s_mov_b64 exec, vcc
  buffer_load_dwordx4 v[60:63], v3, s[4:7], s41 offen offset:3072 sc1
  s_mov_b64 exec, -1
  s_add_u32 s46, s46, 1
  s_cmp_ge_u32 s46, 2097152
  s_cbranch_scc1 FL_rec_abort
  s_waitcnt vmcnt(4)
  s_branch FL_m_03_c0
FL_m_03_ok0:
  v_smfmac_f32_16x16x64_bf16 v[64:67], v[48:51], a[0:7], v23
  v_max3_u32 v31, v60, v61, v62
  v_max_u32 v31, v31, v63
  v_cmp_eq_u32 vcc, -1, v31
  v_smfmac_f32_16x16x64_bf16 v[68:71], v[48:51], a[8:15], v23
  v_smfmac_f32_16x16x64_bf16 v[72:75], v[48:51], a[16:23], v23
  v_smfmac_f32_16x16x64_bf16 v[76:79], v[48:51], a[24:31], v23
  v_smfmac_f32_16x16x64_bf16 v[80:83], v[48:51], a[32:39], v23
  v_smfmac_f32_16x16x64_bf16 v[84:87], v[48:51], a[40:47], v23
  s_cbranch_vccz FL_m_3_ok3
  s_branch FL_m_3_x3
FL_m_03_ok3:
  v_smfmac_f32_16x16x64_bf16 v[64:67], v[60:63], a[144:151], v23
  v_max3_u32 v31, v48, v49, v50
  v_max_u32 v31, v31, v51
  v_cmp_eq_u32 vcc, -1, v31
  v_smfmac_f32_16x16x64_bf16 v[68:71], v[60:63], a[152:159], v23
  v_smfmac_f32_16x16x64_bf16 v[72:75], v[60:63], a[160:167], v23
  v_smfmac_f32_16x16x64_bf16 v[76:79], v[60:63], a[168:175], v23
  v_smfmac_f32_16x16x64_bf16 v[80:83], v[60:63], a[176:183], v23
  v_smfmac_f32_16x16x64_bf16 v[84:87], v[60:63], a[184:191], v23
  s_cbranch_vccz FL_m_0_ok0
  s_branch FL_m_0_x0
FL_m_12_c1:
  v_max3_u32 v31, v52, v53, v54
  v_max_u32 v31, v31, v55
  v_cmp_eq_u32 vcc, -1, v31
  s_cbranch_vccz FL_m_12_ok1
FL_m_12_x1:
  s_mov_b64 exec, vcc
  buffer_load_dwordx4 v[52:55], v3, s[4:7], s41 offen offset:1024 sc1
  s_mov_b64 exec, -1
FL_m_12_c2:
  v_max3_u32 v31, v56, v57, v58
  v_max_u32 v31, v31, v59
  v_cmp_eq_u32 vcc, -1, v31
  s_cbranch_vccz FL_m_12_ok2
FL_m_12_x2:
  s_mov_b64 exec, vcc
  buffer_load_dwordx4 v[56:59], v3, s[4:7], s41 offen offset:2048 sc1
  s_mov_b64 exec, -1
  s_add_u32 s46, s46, 1
  s_cmp_ge_u32 s46, 2097152
  s_cbranch_scc1 FL_rec_abort
  s_waitcnt vmcnt(4)
  s_branch FL_m_12_c1
FL_m_12_ok1:
  v_smfmac_f32_16x16x64_bf16 v[64:67], v[52:55], a[48:55], v23
  v_max3_u32 v31, v56, v57, v58
  v_max_u32 v31, v31, v59
  v_cmp_eq_u32 vcc, -1, v31
  v_smfmac_f32_16x16x64_bf16 v[68:71], v[52:55], a[56:63], v23
  v_smfmac_f32_16x16x64_bf16 v[72:75], v[52:55], a[64:71], v23
  v_smfmac_f32_16x16x64_bf16 v[76:79], v[52:55], a[72:79], v23
  v_smfmac_f32_16x16x64_bf16 v[80:83], v[52:55], a[80:87], v23
  v_smfmac_f32_16x16x64_bf16 v[84:87], v[52:55], a[88:95], v23
  s_cbranch_vccz FL_m_2_ok2
  s_branch FL_m_2_x2
FL_m_12_ok2:
  v_smfmac_f32_16x16x64_bf16 v[64:67], v[56:59], a[96:103], v23
  v_max3_u32 v31, v52, v53, v54
  v_max_u32 v31, v31, v55
  v_cmp_eq_u32 vcc, -1, v31
  v_smfmac_f32_16x16x64_bf16 v[68:71], v[56:59], a[104:111], v23
  v_smfmac_f32_16x16x64_bf16 v[72:75], v[56:59], a[112:119], v23
  v_smfmac_f32_16x16x64_bf16 v[76:79], v[56:59], a[120:127], v23
  v_smfmac_f32_16x16x64_bf16 v[80:83], v[56:59], a[128:135], v23
  v_smfmac_f32_16x16x64_bf16 v[84:87], v[56:59], a[136:143], v23
  s_cbranch_vccz FL_m_1_ok1
  s_branch FL_m_1_x1
FL_m_13_c1:
  v_max3_u32 v31, v52, v53, v54
  v_max_u32 v31, v31, v55
  v_cmp_eq_u32 vcc, -1, v31
  s_cbranch_vccz FL_m_13_ok1
FL_m_13_x1:
  s_mov_b64 exec, vcc
  buffer_load_dwordx4 v[52:55], v3, s[4:7], s41 offen offset:1024 sc1
  s_mov_b64 exec, -1
FL_m_13_c3:
  v_max3_u32 v31, v60, v61, v62
  v_max_u32 v31, v31, v63
  v_cmp_eq_u32 vcc, -1, v31
  s_cbranch_vccz FL_m_13_ok3
FL_m_13_x3:
  s_mov_b64 exec, vcc
  buffer_load_dwordx4 v[60:63], v3, s[4:7], s41 offen offset:3072 sc1
  s_mov_b64 exec, -1
  s_add_u32 s46, s46, 1
  s_cmp_ge_u32 s46, 2097152
  s_cbranch_scc1 FL_rec_abort
  s_waitcnt vmcnt(4)
  s_branch FL_m_13_c1
FL_m_13_ok1:
  v_smfmac_f32_16x16x64_bf16 v[64:67], v[52:55], a[48:55], v23
  v_max3_u32 v31, v60, v61, v62
  v_max_u32 v31, v31, v63
  v_cmp_eq_u32 vcc, -1, v31
  v_smfmac_f32_16x16x64_bf16 v[68:71], v[52:55], a[56:63], v23
  v_smfmac_f32_16x16x64_bf16 v[72:75], v[52:55], a[64:71], v23
  v_smfmac_f32_16x16x64_bf16 v[76:79], v[52:55], a[72:79], v23
  v_smfmac_f32_16x16x64_bf16 v[80:83], v[52:55], a[80:87], v23
  v_smfmac_f32_16x16x64_bf16 v[84:87], v[52:55], a[88:95], v23
  s_cbranch_vccz FL_m_3_ok3
  s_branch FL_m_3_x3
FL_m_13_ok3:
  v_smfmac_f32_16x16x64_bf16 v[64:67], v[60:63], a[144:151], v23
  v_max3_u32 v31, v52, v53, v54
  v_max_u32 v31, v31, v55
  v_cmp_eq_u32 vcc, -1, v31
  v_smfmac_f32_16x16x64_bf16 v[68:71], v[60:63], a[152:159], v23
  v_smfmac_f32_16x16x64_bf16 v[72:75], v[60:63], a[160:167], v23
  v_smfmac_f32_16x16x64_bf16 v[76:79], v[60:63], a[168:175], v23
  v_smfmac_f32_16x16x64_bf16 v[80:83], v[60:63], a[176:183], v23
  v_smfmac_f32_16x16x64_bf16 v[84:87], v[60:63], a[184:191], v23
  s_cbranch_vccz FL_m_1_ok1
  s_branch FL_m_1_x1
FL_m_23_c2:
  v_max3_u32 v31, v56, v57, v58
  v_max_u32 v31, v31, v59
  v_cmp_eq_u32 vcc, -1, v31
  s_cbranch_vccz FL_m_23_ok2
FL_m_23_x2:
  s_mov_b64 exec, vcc
  buffer_load_dwordx4 v[56:59], v3, s[4:7], s41 offen offset:2048 sc1
  s_mov_b64 exec, -1
FL_m_23_c3:
  v_max3_u32 v31, v60, v61, v62
  v_max_u32 v31, v31, v63
  v_cmp_eq_u32 vcc, -1, v31
  s_cbranch_vccz FL_m_23_ok3
FL_m_23_x3:
  s_mov_b64 exec, vcc
  buffer_load_dwordx4 v[60:63], v3, s[4:7], s41 offen offset:3072 sc1
  s_mov_b64 exec, -1
  s_add_u32 s46, s46, 1
  s_cmp_ge_u32 s46, 2097152
  s_cbranch_scc1 FL_rec_abort
  s_waitcnt vmcnt(4)
  s_branch FL_m_23_c2
FL_m_23_ok2:
  v_smfmac_f32_16x16x64_bf16 v[64:67], v[56:59], a[96:103], v23
  v_max3_u32 v31, v60, v61, v62
  v_max_u32 v31, v31, v63
  v_cmp_eq_u32 vcc, -1, v31
  v_smfmac_f32_16x16x64_bf16 v[68:71], v[56:59], a[104:111], v23
  v_smfmac_f32_16x16x64_bf16 v[72:75], v[56:59], a[112:119], v23
  v_smfmac_f32_16x16x64_bf16 v[76:79], v[56:59], a[120:127], v23
  v_smfmac_f32_16x16x64_bf16 v[80:83], v[56:59], a[128:135], v23
  v_smfmac_f32_16x16x64_bf16 v[84:87], v[56:59], a[136:143], v23
  s_cbranch_vccz FL_m_3_ok3
  s_branch FL_m_3_x3
FL_m_23_ok3:
  v_smfmac_f32_16x16x64_bf16 v[64:67], v[60:63], a[144:151], v23
  v_max3_u32 v31, v56, v57, v58
  v_max_u32 v31, v31, v59
  v_cmp_eq_u32 vcc, -1, v31
  v_smfmac_f32_16x16x64_bf16 v[68:71], v[60:63], a[152:159], v23
  v_smfmac_f32_16x16x64_bf16 v[72:75], v[60:63], a[160:167], v23
  v_smfmac_f32_16x16x64_bf16 v[76:79], v[60:63], a[168:175], v23
  v_smfmac_f32_16x16x64_bf16 v[80:83], v[60:63], a[176:183], v23
  v_smfmac_f32_16x16x64_bf16 v[84:87], v[60:63], a[184:191], v23
  s_cbranch_vccz FL_m_2_ok2
  s_branch FL_m_2_x2
FL_m_012_c0:
  v_max3_u32 v31, v48, v49, v50
  v_max_u32 v31, v31, v51
  v_cmp_eq_u32 vcc, -1, v31
  s_cbranch_vccz FL_m_012_ok0
FL_m_012_x0:
  s_mov_b64 exec, vcc
  buffer_load_dwordx4 v[48:51], v3, s[4:7], s41 offen offset:0 sc1
  s_mov_b64 exec, -1
FL_m_012_c1:
  v_max3_u32 v31, v52, v53, v54
  v_max_u32 v31, v31, v55
  v_cmp_eq_u32 vcc, -1, v31
  s_cbranch_vccz FL_m_012_ok1
FL_m_012_x1:
  s_mov_b64 exec, vcc
  buffer_load_dwordx4 v[52:55], v3, s[4:7], s41 offen offset:1024 sc1
  s_mov_b64 exec, -1
FL_m_012_c2:
  v_max3_u32 v31, v56, v57, v58
  v_max_u32 v31, v31, v59
  v_cmp_eq_u32 vcc, -1, v31
  s_cbranch_vccz FL_m_012_ok2
FL_m_012_x2:
  s_mov_b64 exec, vcc
  buffer_load_dwordx4 v[56:59], v3, s[4:7], s41 offen offset:2048 sc1
  s_mov_b64 exec, -1
  s_add_u32 s46, s46, 1
  s_cmp_ge_u32 s46, 2097152
  s_cbranch_scc1 FL_rec_abort
  s_waitcnt vmcnt(4)
  s_branch FL_m_012_c0
FL_m_012_ok0:
  v_smfmac_f32_16x16x64_bf16 v[64:67], v[48:51], a[0:7], v23
  v_max3_u32 v31, v52, v53, v54
  v_max_u32 v31, v31, v55
  v_cmp_eq_u32 vcc, -1, v31
  v_smfmac_f32_16x16x64_bf16 v[68:71], v[48:51], a[8:15], v23
  v_smfmac_f32_16x16x64_bf16 v[72:75], v[48:51], a[16:23], v23
  v_smfmac_f32_16x16x64_bf16 v[76:79], v[48:51], a[24:31], v23
  v_smfmac_f32_16x16x64_bf16 v[80:83], v[48:51], a[32:39], v23
  v_smfmac_f32_16x16x64_bf16 v[84:87], v[48:51], a[40:47], v23
  s_cbranch_vccz FL_m_12_ok1
  s_branch FL_m_12_x1
FL_m_012_ok1:
  v_smfmac_f32_16x16x64_bf16 v[64:67], v[52:55], a[48:55], v23
  v_max3_u32 v31, v56, v57, v58
  v_max_u32 v31, v31, v59
  v_cmp_eq_u32 vcc, -1, v31
  v_smfmac_f32_16x16x64_bf16 v[68:71], v[52:55], a[56:63], v23
  v_smfmac_f32_16x16x64_bf16 v[72:75], v[52:55], a[64:71], v23
  v_smfmac_f32_16x16x64_bf16 v[76:79], v[52:55], a[72:79], v23
  v_smfmac_f32_16x16x64_bf16 v[80:83], v[52:55], a[80:87], v23
  v_smfmac_f32_16x16x64_bf16 v[84:87], v[52:55], a[88:95], v23
  s_cbranch_vccz FL_m_02_ok2
  s_branch FL_m_02_x2
FL_m_012_ok2:
  v_smfmac_f32_16x16x64_bf16 v[64:67], v[56:59], a[96:103], v23
  v_max3_u32 v31, v48, v49, v50
  v_max_u32 v31, v31, v51
  v_cmp_eq_u32 vcc, -1, v31
  v_smfmac_f32_16x16x64_bf16 v[68:71], v[56:59], a[104:111], v23
  v_smfmac_f32_16x16x64_bf16 v[72:75], v[56:59], a[112:119], v23
  v_smfmac_f32_16x16x64_bf16 v[76:79], v[56:59], a[120:127], v23
  v_smfmac_f32_16x16x64_bf16 v[80:83], v[56:59], a[128:135], v23
  v_smfmac_f32_16x16x64_bf16 v[84:87], v[56:59], a[136:143], v23
  s_cbranch_vccz FL_m_01_ok0
  s_branch FL_m_01_x0
FL_m_013_c0:
  v_max3_u32 v31, v48, v49, v50
  v_max_u32 v31, v31, v51
  v_cmp_eq_u32 vcc, -1, v31
  s_cbranch_vccz FL_m_013_ok0
FL_m_013_x0:
  s_mov_b64 exec, vcc
  buffer_load_dwordx4 v[48:51], v3, s[4:7], s41 offen offset:0 sc1
  s_mov_b64 exec, -1
FL_m_013_c1:
  v_max3_u32 v31, v52, v53, v54
  v_max_u32 v31, v31, v55
  v_cmp_eq_u32 vcc, -1, v31
  s_cbranch_vccz FL_m_013_ok1
FL_m_013_x1:
  s_mov_b64 exec, vcc
  buffer_load_dwordx4 v[52:55], v3, s[4:7], s41 offen offset:1024 sc1
  s_mov_b64 exec, -1
FL_m_013_c3:
  v_max3_u32 v31, v60, v61, v62
  v_max_u32 v31, v31, v63
  v_cmp_eq_u32 vcc, -1, v31
  s_cbranch_vccz FL_m_013_ok3
FL_m_013_x3:
  s_mov_b64 exec, vcc
  buffer_load_dwordx4 v[60:63], v3, s[4:7], s41 offen offset:3072 sc1
  s_mov_b64 exec, -1
  s_add_u32 s46, s46, 1
  s_cmp_ge_u32 s46, 2097152
  s_cbranch_scc1 FL_rec_abort
  s_waitcnt vmcnt(4)
  s_branch FL_m_013_c0
FL_m_013_ok0:
  v_smfmac_f32_16x16x64_bf16 v[64:67], v[48:51], a[0:7], v23
  v_max3_u32 v31, v52, v53, v54
  v_max_u32 v31, v31, v55
  v_cmp_eq_u32 vcc, -1, v31
  v_smfmac_f32_16x16x64_bf16 v[68:71], v[48:51], a[8:15], v23
  v_smfmac_f32_16x16x64_bf16 v[72:75], v[48:51], a[16:23], v23
  v_smfmac_f32_16x16x64_bf16 v[76:79], v[48:51], a[24:31], v23
  v_smfmac_f32_16x16x64_bf16 v[80:83], v[48:51], a[32:39], v23
  v_smfmac_f32_16x16x64_bf16 v[84:87], v[48:51], a[40:47], v23
  s_cbranch_vccz FL_m_13_ok1
  s_branch FL_m_13_x1
FL_m_013_ok1:
  v_smfmac_f32_16x16x64_bf16 v[64:67], v[52:55], a[48:55], v23
  v_max3_u32 v31, v60, v61, v62
  v_max_u32 v31, v31, v63
  v_cmp_eq_u32 vcc, -1, v31
  v_smfmac_f32_16x16x64_bf16 v[68:71], v[52:55], a[56:63], v23
  v_smfmac_f32_16x16x64_bf16 v[72:75], v[52:55], a[64:71], v23
  v_smfmac_f32_16x16x64_bf16 v[76:79], v[52:55], a[72:79], v23
  v_smfmac_f32_16x16x64_bf16 v[80:83], v[52:55], a[80:87], v23
  v_smfmac_f32_16x16x64_bf16 v[84:87], v[52:55], a[88:95], v23
  s_cbranch_vccz FL_m_03_ok3
  s_branch FL_m_03_x3
FL_m_013_ok3:
  v_smfmac_f32_16x16x64_bf16 v[64:67], v[60:63], a[144:151], v23
  v_max3_u32 v31, v48, v49, v50
  v_max_u32 v31, v31, v51
  v_cmp_eq_u32 vcc, -1, v31
  v_smfmac_f32_16x16x64_bf16 v[68:71], v[60:63], a[152:159], v23
  v_smfmac_f32_16x16x64_bf16 v[72:75], v[60:63], a[160:167], v23
  v_smfmac_f32_16x16x64_bf16 v[76:79], v[60:63], a[168:175], v23
  v_smfmac_f32_16x16x64_bf16 v[80:83], v[60:63], a[176:183], v23
  v_smfmac_f32_16x16x64_bf16 v[84:87], v[60:63], a[184:191], v23
  s_cbranch_vccz FL_m_01_ok0
  s_branch FL_m_01_x0
FL_m_023_c0:
  v_max3_u32 v31, v48, v49, v50
  v_max_u32 v31, v31, v51
  v_cmp_eq_u32 vcc, -1, v31
  s_cbranch_vccz FL_m_023_ok0
FL_m_023_x0:
  s_mov_b64 exec, vcc
  buffer_load_dwordx4 v[48:51], v3, s[4:7], s41 offen offset:0 sc1
  s_mov_b64 exec, -1
FL_m_023_c2:
  v_max3_u32 v31, v56, v57, v58
  v_max_u32 v31, v31, v59
  v_cmp_eq_u32 vcc, -1, v31
  s_cbranch_vccz FL_m_023_ok2
FL_m_023_x2:
  s_mov_b64 exec, vcc
  buffer_load_dwordx4 v[56:59], v3, s[4:7], s41 offen offset:2048 sc1
  s_mov_b64 exec, -1
FL_m_023_c3:
  v_max3_u32 v31, v60, v61, v62
  v_max_u32 v31, v31, v63
  v_cmp_eq_u32 vcc, -1, v31
  s_cbranch_vccz FL_m_023_ok3
FL_m_023_x3:
  s_mov_b64 exec, vcc
  buffer_load_dwordx4 v[60:63], v3, s[4:7], s41 offen offset:3072 sc1
  s_mov_b64 exec, -1
  s_add_u32 s46, s46, 1
  s_cmp_ge_u32 s46, 2097152
  s_cbranch_scc1 FL_rec_abort
  s_waitcnt vmcnt(4)
  s_branch FL_m_023_c0
FL_m_023_ok0:
  v_smfmac_f32_16x16x64_bf16 v[64:67], v[48:51], a[0:7], v23
  v_max3_u32 v31, v56, v57, v58
  v_max_u32 v31, v31, v59
  v_cmp_eq_u32 vcc, -1, v31
  v_smfmac_f32_16x16x64_bf16 v[68:71], v[48:51], a[8:15], v23
  v_smfmac_f32_16x16x64_bf16 v[72:75], v[48:51], a[16:23], v23
  v_smfmac_f32_16x16x64_bf16 v[76:79], v[48:51], a[24:31], v23
  v_smfmac_f32_16x16x64_bf16 v[80:83], v[48:51], a[32:39], v23
  v_smfmac_f32_16x16x64_bf16 v[84:87], v[48:51], a[40:47], v23
  s_cbranch_vccz FL_m_23_ok2
  s_branch FL_m_23_x2
FL_m_023_ok2:
  v_smfmac_f32_16x16x64_bf16 v[64:67], v[56:59], a[96:103], v23
  v_max3_u32 v31, v60, v61, v62
  v_max_u32 v31, v31, v63
  v_cmp_eq_u32 vcc, -1, v31
  v_smfmac_f32_16x16x64_bf16 v[68:71], v[56:59], a[104:111], v23
  v_smfmac_f32_16x16x64_bf16 v[72:75], v[56:59], a[112:119], v23
  v_smfmac_f32_16x16x64_bf16 v[76:79], v[56:59], a[120:127], v23
  v_smfmac_f32_16x16x64_bf16 v[80:83], v[56:59], a[128:135], v23
  v_smfmac_f32_16x16x64_bf16 v[84:87], v[56:59], a[136:143], v23
  s_cbranch_vccz FL_m_03_ok3
  s_branch FL_m_03_x3
FL_m_023_ok3:
  v_smfmac_f32_16x16x64_bf16 v[64:67], v[60:63], a[144:151], v23
  v_max3_u32 v31, v48, v49, v50
  v_max_u32 v31, v31, v51
  v_cmp_eq_u32 vcc, -1, v31
  v_smfmac_f32_16x16x64_bf16 v[68:71], v[60:63], a[152:159], v23
  v_smfmac_f32_16x16x64_bf16 v[72:75], v[60:63], a[160:167], v23
  v_smfmac_f32_16x16x64_bf16 v[76:79], v[60:63], a[168:175], v23
  v_smfmac_f32_16x16x64_bf16 v[80:83], v[60:63], a[176:183], v23
  v_smfmac_f32_16x16x64_bf16 v[84:87], v[60:63], a[184:191], v23
  s_cbranch_vccz FL_m_02_ok0
  s_branch FL_m_02_x0
FL_m_123_c1:
  v_max3_u32 v31, v52, v53, v54
  v_max_u32 v31, v31, v55
  v_cmp_eq_u32 vcc, -1, v31
  s_cbranch_vccz FL_m_123_ok1
FL_m_123_x1:
  s_mov_b64 exec, vcc
  buffer_load_dwordx4 v[52:55], v3, s[4:7], s41 offen offset:1024 sc1
  s_mov_b64 exec, -1
FL_m_123_c2:
  v_max3_u32 v31, v56, v57, v58
  v_max_u32 v31, v31, v59
  v_cmp_eq_u32 vcc, -1, v31
  s_cbranch_vccz FL_m_123_ok2
FL_m_123_x2:
  s_mov_b64 exec, vcc
  buffer_load_dwordx4 v[56:59], v3, s[4:7], s41 offen offset:2048 sc1
  s_mov_b64 exec, -1
FL_m_123_c3:
  v_max3_u32 v31, v60, v61, v62
  v_max_u32 v31, v31, v63
  v_cmp_eq_u32 vcc, -1, v31
  s_cbranch_vccz FL_m_123_ok3
FL_m_123_x3:
  s_mov_b64 exec, vcc
  buffer_load_dwordx4 v[60:63], v3, s[4:7], s41 offen offset:3072 sc1
  s_mov_b64 exec, -1
  s_add_u32 s46, s46, 1
  s_cmp_ge_u32 s46, 2097152
  s_cbranch_scc1 FL_rec_abort
  s_waitcnt vmcnt(4)
  s_branch FL_m_123_c1
FL_m_123_ok1:
  v_smfmac_f32_16x16x64_bf16 v[64:67], v[52:55], a[48:55], v23
  v_max3_u32 v31, v56, v57, v58
  v_max_u32 v31, v31, v59
  v_cmp_eq_u32 vcc, -1, v31
  v_smfmac_f32_16x16x64_bf16 v[68:71], v[52:55], a[56:63], v23
  v_smfmac_f32_16x16x64_bf16 v[72:75], v[52:55], a[64:71], v23
  v_smfmac_f32_16x16x64_bf16 v[76:79], v[52:55], a[72:79], v23
  v_smfmac_f32_16x16x64_bf16 v[80:83], v[52:55], a[80:87], v23
  v_smfmac_f32_16x16x64_bf16 v[84:87], v[52:55], a[88:95], v23
  s_cbranch_vccz FL_m_23_ok2
  s_branch FL_m_23_x2
FL_m_123_ok2:
  v_smfmac_f32_16x16x64_bf16 v[64:67], v[56:59], a[96:103], v23
  v_max3_u32 v31, v60, v61, v62
  v_max_u32 v31, v31, v63
  v_cmp_eq_u32 vcc, -1, v31
  v_smfmac_f32_16x16x64_bf16 v[68:71], v[56:59], a[104:111], v23
  v_smfmac_f32_16x16x64_bf16 v[72:75], v[56:59], a[112:119], v23
  v_smfmac_f32_16x16x64_bf16 v[76:79], v[56:59], a[120:127], v23
  v_smfmac_f32_16x16x64_bf16 v[80:83], v[56:59], a[128:135], v23
  v_smfmac_f32_16x16x64_bf16 v[84:87], v[56:59], a[136:143], v23
  s_cbranch_vccz FL_m_13_ok3
  s_branch FL_m_13_x3
FL_m_123_ok3:
  v_smfmac_f32_16x16x64_bf16 v[64:67], v[60:63], a[144:151], v23
  v_max3_u32 v31, v52, v53, v54
  v_max_u32 v31, v31, v55
  v_cmp_eq_u32 vcc, -1, v31
  v_smfmac_f32_16x16x64_bf16 v[68:71], v[60:63], a[152:159], v23
  v_smfmac_f32_16x16x64_bf16 v[72:75], v[60:63], a[160:167], v23
  v_smfmac_f32_16x16x64_bf16 v[76:79], v[60:63], a[168:175], v23
  v_smfmac_f32_16x16x64_bf16 v[80:83], v[60:63], a[176:183], v23
  v_smfmac_f32_16x16x64_bf16 v[84:87], v[60:63], a[184:191], v23
  s_cbranch_vccz FL_m_12_ok1
  s_branch FL_m_12_x1
FL_m_0123_c0:
  v_max3_u32 v31, v48, v49, v50
  v_max_u32 v31, v31, v51
  v_cmp_eq_u32 vcc, -1, v31
  s_cbranch_vccz FL_m_0123_ok0
FL_m_0123_x0:
  s_mov_b64 exec, vcc
  buffer_load_dwordx4 v[48:51], v3, s[4:7], s41 offen offset:0 sc1
  s_mov_b64 exec, -1
FL_m_0123_c1:
  v_max3_u32 v31, v52, v53, v54
  v_max_u32 v31, v31, v55
  v_cmp_eq_u32 vcc, -1, v31
  s_cbranch_vccz FL_m_0123_ok1
FL_m_0123_x1:
  s_mov_b64 exec, vcc
  buffer_load_dwordx4 v[52:55], v3, s[4:7], s41 offen offset:1024 sc1
  s_mov_b64 exec, -1
FL_m_0123_c2:
  v_max3_u32 v31, v56, v57, v58
  v_max_u32 v31, v31, v59
  v_cmp_eq_u32 vcc, -1, v31
  s_cbranch_vccz FL_m_0123_ok2
FL_m_0123_x2:
  s_mov_b64 exec, vcc
  buffer_load_dwordx4 v[56:59], v3, s[4:7], s41 offen offset:2048 sc1
  s_mov_b64 exec, -1
FL_m_0123_c3:
  v_max3_u32 v31, v60, v61, v62
  v_max_u32 v31, v31, v63
  v_cmp_eq_u32 vcc, -1, v31
  s_cbranch_vccz FL_m_0123_ok3
FL_m_0123_x3:
  s_mov_b64 exec, vcc
  buffer_load_dwordx4 v[60:63], v3, s[4:7], s41 offen offset:3072 sc1
  s_mov_b64 exec, -1
  s_add_u32 s46, s46, 1
  s_cmp_ge_u32 s46, 2097152
  s_cbranch_scc1 FL_rec_abort
  s_waitcnt vmcnt(4)
  s_branch FL_m_0123_c0
FL_m_0123_ok0:
  v_smfmac_f32_16x16x64_bf16 v[64:67], v[48:51], a[0:7], v23
  v_max3_u32 v31, v52, v53, v54
  v_max_u32 v31, v31, v55
  v_cmp_eq_u32 vcc, -1, v31
  v_smfmac_f32_16x16x64_bf16 v[68:71], v[48:51], a[8:15], v23
  v_smfmac_f32_16x16x64_bf16 v[72:75], v[48:51], a[16:23], v23
  v_smfmac_f32_16x16x64_bf16 v[76:79], v[48:51], a[24:31], v23
  v_smfmac_f32_16x16x64_bf16 v[80:83], v[48:51], a[32:39], v23
  v_smfmac_f32_16x16x64_bf16 v[84:87], v[48:51], a[40:47], v23
  s_cbranch_vccz FL_m_123_ok1
  s_branch FL_m_123_x1
FL_m_0123_ok1:
  v_smfmac_f32_16x16x64_bf16 v[64:67], v[52:55], a[48:55], v23
  v_max3_u32 v31, v56, v57, v58
  v_max_u32 v31, v31, v59
  v_cmp_eq_u32 vcc, -1, v31
  v_smfmac_f32_16x16x64_bf16 v[68:71], v[52:55], a[56:63], v23
  v_smfmac_f32_16x16x64_bf16 v[72:75], v[52:55], a[64:71], v23
  v_smfmac_f32_16x16x64_bf16 v[76:79], v[52:55], a[72:79], v23
  v_smfmac_f32_16x16x64_bf16 v[80:83], v[52:55], a[80:87], v23
  v_smfmac_f32_16x16x64_bf16 v[84:87], v[52:55], a[88:95], v23
  s_cbranch_vccz FL_m_023_ok2
  s_branch FL_m_023_x2
FL_m_0123_ok2:
  v_smfmac_f32_16x16x64_bf16 v[64:67], v[56:59], a[96:103], v23
  v_max3_u32 v31, v60, v61, v62
  v_max_u32 v31, v31, v63
  v_cmp_eq_u32 vcc, -1, v31
  v_smfmac_f32_16x16x64_bf16 v[68:71], v[56:59], a[104:111], v23
  v_smfmac_f32_16x16x64_bf16 v[72:75], v[56:59], a[112:119], v23
  v_smfmac_f32_16x16x64_bf16 v[76:79], v[56:59], a[120:127], v23
  v_smfmac_f32_16x16x64_bf16 v[80:83], v[56:59], a[128:135], v23
  v_smfmac_f32_16x16x64_bf16 v[84:87], v[56:59], a[136:143], v23
  s_cbranch_vccz FL_m_013_ok3
  s_branch FL_m_013_x3
FL_m_0123_ok3:
  v_smfmac_f32_16x16x64_bf16 v[64:67], v[60:63], a[144:151], v23
  v_max3_u32 v31, v48, v49, v50
  v_max_u32 v31, v31, v51
  v_cmp_eq_u32 vcc, -1, v31
  v_smfmac_f32_16x16x64_bf16 v[68:71], v[60:63], a[152:159], v23
  v_smfmac_f32_16x16x64_bf16 v[72:75], v[60:63], a[160:167], v23
  v_smfmac_f32_16x16x64_bf16 v[76:79], v[60:63], a[168:175], v23
  v_smfmac_f32_16x16x64_bf16 v[80:83], v[60:63], a[176:183], v23
  v_smfmac_f32_16x16x64_bf16 v[84:87], v[60:63], a[184:191], v23
  s_cbranch_vccz FL_m_012_ok0
  s_branch FL_m_012_x0
FL_x_f0:
  s_mov_b64 exec, vcc
  buffer_load_dwordx4 v[64:67], v9, s[4:7], s41 offen offset:0 sc1
  s_mov_b64 exec, -1
  s_waitcnt vmcnt(1)
  s_branch FL_x_0123_c1
FL_x_f1:
  s_mov_b64 exec, vcc
  buffer_load_dwordx4 v[68:71], v9, s[4:7], s41 offen offset:1024 sc1
  s_mov_b64 exec, -1
  s_waitcnt vmcnt(1)
  s_branch FL_x_123_c2
FL_x_f2:
  s_mov_b64 exec, vcc
  buffer_load_dwordx4 v[72:75], v9, s[4:7], s41 offen offset:2048 sc1
  s_mov_b64 exec, -1
  s_waitcnt vmcnt(1)
  s_branch FL_x_23_c3
FL_x_f3:
  s_mov_b64 exec, vcc
  buffer_load_dwordx4 v[76:79], v9, s[4:7], s41 offen offset:3072 sc1
  s_mov_b64 exec, -1
  s_nop 7
  s_branch FL_x_3_c3
FL_x_0_c0:
  v_max3_u32 v31, v64, v65, v66
  v_max_u32 v31, v31, v67
  v_cmp_eq_u32 vcc, -1, v31
  s_cbranch_vccz FL_x_0_ok0
FL_x_0_x0:
  s_mov_b64 exec, vcc
  buffer_load_dwordx4 v[64:67], v9, s[4:7], s41 offen offset:0 sc1
  s_mov_b64 exec, -1
  s_add_u32 s46, s46, 1
  s_cmp_ge_u32 s46, 2097152
  s_cbranch_scc1 FL_rec_abort
  s_waitcnt vmcnt(2)
  s_branch FL_x_0_c0
FL_x_0_ok0:
  v_mfma_f32_16x16x32_bf16 v[44:47], v[64:67], v[64:67], v[44:47]
  v_mfma_f32_16x16x32_bf16 v[36:39], v[116:119], v[64:67], v[36:39]
  v_mfma_f32_16x16x32_bf16 v[40:43], v[132:135], v[64:67], v[40:43]
  s_branch FL_x_done
FL_x_1_c1:
  v_max3_u32 v31, v68, v69, v70
  v_max_u32 v31, v31, v71
  v_cmp_eq_u32 vcc, -1, v31
  s_cbranch_vccz FL_x_1_ok1
FL_x_1_x1:
  s_mov_b64 exec, vcc
  buffer_load_dwordx4 v[68:71], v9, s[4:7], s41 offen offset:1024 sc1
  s_mov_b64 exec, -1
  s_add_u32 s46, s46, 1
  s_cmp_ge_u32 s46, 2097152
  s_cbranch_scc1 FL_rec_abort
  s_waitcnt vmcnt(2)
  s_branch FL_x_1_c1
FL_x_1_ok1:
  v_mfma_f32_16x16x32_bf16 v[44:47], v[68:71], v[68:71], v[44:47]
  v_mfma_f32_16x16x32_bf16 v[36:39], v[120:123], v[68:71], v[36:39]
  v_mfma_f32_16x16x32_bf16 v[40:43], v[136:139], v[68:71], v[40:43]
  s_branch FL_x_done
FL_x_2_c2:
  v_max3_u32 v31, v72, v73, v74
  v_max_u32 v31, v31, v75
  v_cmp_eq_u32 vcc, -1, v31
  s_cbranch_vccz FL_x_2_ok2
FL_x_2_x2:
  s_mov_b64 exec, vcc
  buffer_load_dwordx4 v[72:75], v9, s[4:7], s41 offen offset:2048 sc1
  s_mov_b64 exec, -1
  s_add_u32 s46, s46, 1
  s_cmp_ge_u32 s46, 2097152
  s_cbranch_scc1 FL_rec_abort
  s_waitcnt vmcnt(2)
  s_branch FL_x_2_c2
FL_x_2_ok2:
  v_mfma_f32_16x16x32_bf16 v[44:47], v[72:75], v[72:75], v[44:47]
  v_mfma_f32_16x16x32_bf16 v[36:39], v[124:127], v[72:75], v[36:39]
  v_mfma_f32_16x16x32_bf16 v[40:43], v[140:143], v[72:75], v[40:43]
  s_branch FL_x_done
FL_x_3_c3:
  v_max3_u32 v31, v76, v77, v78
  v_max_u32 v31, v31, v79
  v_cmp_eq_u32 vcc, -1, v31
  s_cbranch_vccz FL_x_3_ok3
FL_x_3_x3:
  s_mov_b64 exec, vcc
  buffer_load_dwordx4 v[76:79], v9, s[4:7], s41 offen offset:3072 sc1
  s_mov_b64 exec, -1
  s_add_u32 s46, s46, 1
  s_cmp_ge_u32 s46, 2097152
  s_cbranch_scc1 FL_rec_abort
  s_waitcnt vmcnt(2)
  s_branch FL_x_3_c3
FL_x_3_ok3:
  v_mfma_f32_16x16x32_bf16 v[44:47], v[76:79], v[76:79], v[44:47]
  v_mfma_f32_16x16x32_bf16 v[36:39], v[128:131], v[76:79], v[36:39]
  v_mfma_f32_16x16x32_bf16 v[40:43], v[144:147], v[76:79], v[40:43]
  s_branch FL_x_done
FL_x_01_c0:
  v_max3_u32 v31, v64, v65, v66
  v_max_u32 v31, v31, v67
  v_cmp_eq_u32 vcc, -1, v31
  s_cbranch_vccz FL_x_01_ok0
FL_x_01_x0:
  s_mov_b64 exec, vcc
  buffer_load_dwordx4 v[64:67], v9, s[4:7], s41 offen offset:0 sc1
  s_mov_b64 exec, -1
FL_x_01_c1:
  v_max3_u32 v31, v68, v69, v70
  v_max_u32 v31, v31, v71
  v_cmp_eq_u32 vcc, -1, v31
  s_cbranch_vccz FL_x_01_ok1
FL_x_01_x1:
  s_mov_b64 exec, vcc
  buffer_load_dwordx4 v[68:71], v9, s[4:7], s41 offen offset:1024 sc1
  s_mov_b64 exec, -1
  s_add_u32 s46, s46, 1
  s_cmp_ge_u32 s46, 2097152
  s_cbranch_scc1 FL_rec_abort
  s_waitcnt vmcnt(4)
  s_branch FL_x_01_c0
FL_x_01_ok0:
  v_mfma_f32_16x16x32_bf16 v[44:47], v[64:67], v[64:67], v[44:47]
  v_max3_u32 v31, v68, v69, v70
  v_max_u32 v31, v31, v71
  v_cmp_eq_u32 vcc, -1, v31
  v_mfma_f32_16x16x32_bf16 v[36:39], v[116:119], v[64:67], v[36:39]
  v_mfma_f32_16x16x32_bf16 v[40:43], v[132:135], v[64:67], v[40:43]
  s_cbranch_vccz FL_x_1_ok1
  s_branch FL_x_1_x1
FL_x_01_ok1:
  v_mfma_f32_16x16x32_bf16 v[44:47], v[68:71], v[68:71], v[44:47]
  v_max3_u32 v31, v64, v65, v66
  v_max_u32 v31, v31, v67
  v_cmp_eq_u32 vcc, -1, v31
  v_mfma_f32_16x16x32_bf16 v[36:39], v[120:123], v[68:71], v[36:39]
  v_mfma_f32_16x16x32_bf16 v[40:43], v[136:139], v[68:71], v[40:43]
  s_cbranch_vccz FL_x_0_ok0
  s_branch FL_x_0_x0
FL_x_02_c0:
  v_max3_u32 v31, v64, v65, v66
  v_max_u32 v31, v31, v67
  v_cmp_eq_u32 vcc, -1, v31
  s_cbranch_vccz FL_x_02_ok0
FL_x_02_x0:
  s_mov_b64 exec, vcc
  buffer_load_dwordx4 v[64:67], v9, s[4:7], s41 offen offset:0 sc1
  s_mov_b64 exec, -1
FL_x_02_c2:
  v_max3_u32 v31, v72, v73, v74
  v_max_u32 v31, v31, v75
  v_cmp_eq_u32 vcc, -1, v31
  s_cbranch_vccz FL_x_02_ok2
FL_x_02_x2:
  s_mov_b64 exec, vcc
  buffer_load_dwordx4 v[72:75], v9, s[4:7], s41 offen offset:2048 sc1
  s_mov_b64 exec, -1
  s_add_u32 s46, s46, 1
  s_cmp_ge_u32 s46, 2097152
  s_cbranch_scc1 FL_rec_abort
  s_waitcnt vmcnt(4)
  s_branch FL_x_02_c0
FL_x_02_ok0:
  v_mfma_f32_16x16x32_bf16 v[44:47], v[64:67], v[64:67], v[44:47]
  v_max3_u32 v31, v72, v73, v74
  v_max_u32 v31, v31, v75
  v_cmp_eq_u32 vcc, -1, v31
  v_mfma_f32_16x16x32_bf16 v[36:39], v[116:119], v[64:67], v[36:39]
  v_mfma_f32_16x16x32_bf16 v[40:43], v[132:135], v[64:67], v[40:43]
  s_cbranch_vccz FL_x_2_ok2
  s_branch FL_x_2_x2
FL_x_02_ok2:
  v_mfma_f32_16x16x32_bf16 v[44:47], v[72:75], v[72:75], v[44:47]
  v_max3_u32 v31, v64, v65, v66
  v_max_u32 v31, v31, v67
  v_cmp_eq_u32 vcc, -1, v31
  v_mfma_f32_16x16x32_bf16 v[36:39], v[124:127], v[72:75], v[36:39]
  v_mfma_f32_16x16x32_bf16 v[40:43], v[140:143], v[72:75], v[40:43]
  s_cbranch_vccz FL_x_0_ok0
  s_branch FL_x_0_x0
FL_x_03_c0:
  v_max3_u32 v31, v64, v65, v66
  v_max_u32 v31, v31, v67
  v_cmp_eq_u32 vcc, -1, v31
  s_cbranch_vccz FL_x_03_ok0
FL_x_03_x0:
  s_mov_b64 exec, vcc
  buffer_load_dwordx4 v[64:67], v9, s[4:7], s41 offen offset:0 sc1
  s_mov_b64 exec, -1
FL_x_03_c3:
  v_max3_u32 v31, v76, v77, v78
  v_max_u32 v31, v31, v79
  v_cmp_eq_u32 vcc, -1, v31
  s_cbranch_vccz FL_x_03_ok3
FL_x_03_x3:
  s_mov_b64 exec, vcc
  buffer_load_dwordx4 v[76:79], v9, s[4:7], s41 offen offset:3072 sc1
  s_mov_b64 exec, -1
  s_add_u32 s46, s46, 1
  s_cmp_ge_u32 s46, 2097152
  s_cbranch_scc1 FL_rec_abort
  s_waitcnt vmcnt(4)
  s_branch FL_x_03_c0
FL_x_03_ok0:
  v_mfma_f32_16x16x32_bf16 v[44:47], v[64:67], v[64:67], v[44:47]
  v_max3_u32 v31, v76, v77, v78
  v_max_u32 v31, v31, v79
  v_cmp_eq_u32 vcc, -1, v31
  v_mfma_f32_16x16x32_bf16 v[36:39], v[116:119], v[64:67], v[36:39]
  v_mfma_f32_16x16x32_bf16 v[40:43], v[132:135], v[64:67], v[40:43]
  s_cbranch_vccz FL_x_3_ok3
  s_branch FL_x_3_x3
FL_x_03_ok3:
  v_mfma_f32_16x16x32_bf16 v[44:47], v[76:79], v[76:79], v[44:47]
  v_max3_u32 v31, v64, v65, v66
  v_max_u32 v31, v31, v67
  v_cmp_eq_u32 vcc, -1, v31
  v_mfma_f32_16x16x32_bf16 v[36:39], v[128:131], v[76:79], v[36:39]
  v_mfma_f32_16x16x32_bf16 v[40:43], v[144:147], v[76:79], v[40:43]
  s_cbranch_vccz FL_x_0_ok0
  s_branch FL_x_0_x0
FL_x_12_c1:
  v_max3_u32 v31, v68, v69, v70
  v_max_u32 v31, v31, v71
  v_cmp_eq_u32 vcc, -1, v31
  s_cbranch_vccz FL_x_12_ok1
FL_x_12_x1:
  s_mov_b64 exec, vcc
  buffer_load_dwordx4 v[68:71], v9, s[4:7], s41 offen offset:1024 sc1
  s_mov_b64 exec, -1
FL_x_12_c2:
  v_max3_u32 v31, v72, v73, v74
  v_max_u32 v31, v31, v75
  v_cmp_eq_u32 vcc, -1, v31
  s_cbranch_vccz FL_x_12_ok2
FL_x_12_x2:
  s_mov_b64 exec, vcc
  buffer_load_dwordx4 v[72:75], v9, s[4:7], s41 offen offset:2048 sc1
  s_mov_b64 exec, -1
  s_add_u32 s46, s46, 1
  s_cmp_ge_u32 s46, 2097152
  s_cbranch_scc1 FL_rec_abort
  s_waitcnt vmcnt(4)
  s_branch FL_x_12_c1
FL_x_12_ok1:
  v_mfma_f32_16x16x32_bf16 v[44:47], v[68:71], v[68:71], v[44:47]
  v_max3_u32 v31, v72, v73, v74
  v_max_u32 v31, v31, v75
  v_cmp_eq_u32 vcc, -1, v31
  v_mfma_f32_16x16x32_bf16 v[36:39], v[120:123], v[68:71], v[36:39]
  v_mfma_f32_16x16x32_bf16 v[40:43], v[136:139], v[68:71], v[40:43]
  s_cbranch_vccz FL_x_2_ok2
  s_branch FL_x_2_x2
FL_x_12_ok2:
  v_mfma_f32_16x16x32_bf16 v[44:47], v[72:75], v[72:75], v[44:47]
  v_max3_u32 v31, v68, v69, v70
  v_max_u32 v31, v31, v71
  v_cmp_eq_u32 vcc, -1, v31
  v_mfma_f32_16x16x32_bf16 v[36:39], v[124:127], v[72:75], v[36:39]
  v_mfma_f32_16x16x32_bf16 v[40:43], v[140:143], v[72:75], v[40:43]
  s_cbranch_vccz FL_x_1_ok1
  s_branch FL_x_1_x1
FL_x_13_c1:
  v_max3_u32 v31, v68, v69, v70
  v_max_u32 v31, v31, v71
  v_cmp_eq_u32 vcc, -1, v31
  s_cbranch_vccz FL_x_13_ok1
FL_x_13_x1:
  s_mov_b64 exec, vcc
  buffer_load_dwordx4 v[68:71], v9, s[4:7], s41 offen offset:1024 sc1
  s_mov_b64 exec, -1
FL_x_13_c3:
  v_max3_u32 v31, v76, v77, v78
  v_max_u32 v31, v31, v79
  v_cmp_eq_u32 vcc, -1, v31
  s_cbranch_vccz FL_x_13_ok3
FL_x_13_x3:
  s_mov_b64 exec, vcc
  buffer_load_dwordx4 v[76:79], v9, s[4:7], s41 offen offset:3072 sc1
  s_mov_b64 exec, -1
  s_add_u32 s46, s46, 1
  s_cmp_ge_u32 s46, 2097152
  s_cbranch_scc1 FL_rec_abort
  s_waitcnt vmcnt(4)
  s_branch FL_x_13_c1
FL_x_13_ok1:
  v_mfma_f32_16x16x32_bf16 v[44:47], v[68:71], v[68:71], v[44:47]
  v_max3_u32 v31, v76, v77, v78
  v_max_u32 v31, v31, v79
  v_cmp_eq_u32 vcc, -1, v31
  v_mfma_f32_16x16x32_bf16 v[36:39], v[120:123], v[68:71], v[36:39]
  v_mfma_f32_16x16x32_bf16 v[40:43], v[136:139], v[68:71], v[40:43]
  s_cbranch_vccz FL_x_3_ok3
  s_branch FL_x_3_x3
FL_x_13_ok3:
  v_mfma_f32_16x16x32_bf16 v[44:47], v[76:79], v[76:79], v[44:47]
  v_max3_u32 v31, v68, v69, v70
  v_max_u32 v31, v31, v71
  v_cmp_eq_u32 vcc, -1, v31
  v_mfma_f32_16x16x32_bf16 v[36:39], v[128:131], v[76:79], v[36:39]
  v_mfma_f32_16x16x32_bf16 v[40:43], v[144:147], v[76:79], v[40:43]
  s_cbranch_vccz FL_x_1_ok1
  s_branch FL_x_1_x1
FL_x_23_c2:
  v_max3_u32 v31, v72, v73, v74
  v_max_u32 v31, v31, v75
  v_cmp_eq_u32 vcc, -1, v31
  s_cbranch_vccz FL_x_23_ok2
FL_x_23_x2:
  s_mov_b64 exec, vcc
  buffer_load_dwordx4 v[72:75], v9, s[4:7], s41 offen offset:2048 sc1
  s_mov_b64 exec, -1
FL_x_23_c3:
  v_max3_u32 v31, v76, v77, v78
  v_max_u32 v31, v31, v79
  v_cmp_eq_u32 vcc, -1, v31
  s_cbranch_vccz FL_x_23_ok3
FL_x_23_x3:
  s_mov_b64 exec, vcc
  buffer_load_dwordx4 v[76:79], v9, s[4:7], s41 offen offset:3072 sc1
  s_mov_b64 exec, -1
  s_add_u32 s46, s46, 1
  s_cmp_ge_u32 s46, 2097152
  s_cbranch_scc1 FL_rec_abort
  s_waitcnt vmcnt(4)
  s_branch FL_x_23_c2
FL_x_23_ok2:
  v_mfma_f32_16x16x32_bf16 v[44:47], v[72:75], v[72:75], v[44:47]
  v_max3_u32 v31, v76, v77, v78
  v_max_u32 v31, v31, v79
  v_cmp_eq_u32 vcc, -1, v31
  v_mfma_f32_16x16x32_bf16 v[36:39], v[124:127], v[72:75], v[36:39]
  v_mfma_f32_16x16x32_bf16 v[40:43], v[140:143], v[72:75], v[40:43]
  s_cbranch_vccz FL_x_3_ok3
  s_branch FL_x_3_x3
FL_x_23_ok3:
  v_mfma_f32_16x16x32_bf16 v[44:47], v[76:79], v[76:79], v[44:47]
  v_max3_u32 v31, v72, v73, v74
  v_max_u32 v31, v31, v75
  v_cmp_eq_u32 vcc, -1, v31
  v_mfma_f32_16x16x32_bf16 v[36:39], v[128:131], v[76:79], v[36:39]
  v_mfma_f32_16x16x32_bf16 v[40:43], v[144:147], v[76:79], v[40:43]
  s_cbranch_vccz FL_x_2_ok2
  s_branch FL_x_2_x2
FL_x_012_c0:
  v_max3_u32 v31, v64, v65, v66
  v_max_u32 v31, v31, v67
  v_cmp_eq_u32 vcc, -1, v31
  s_cbranch_vccz FL_x_012_ok0
FL_x_012_x0:
  s_mov_b64 exec, vcc
  buffer_load_dwordx4 v[64:67], v9, s[4:7], s41 offen offset:0 sc1
  s_mov_b64 exec, -1
FL_x_012_c1:
  v_max3_u32 v31, v68, v69, v70
  v_max_u32 v31, v31, v71
  v_cmp_eq_u32 vcc, -1, v31
  s_cbranch_vccz FL_x_012_ok1
FL_x_012_x1:
  s_mov_b64 exec, vcc
  buffer_load_dwordx4 v[68:71], v9, s[4:7], s41 offen offset:1024 sc1
  s_mov_b64 exec, -1
FL_x_012_c2:
  v_max3_u32 v31, v72, v73, v74
  v_max_u32 v31, v31, v75
  v_cmp_eq_u32 vcc, -1, v31
  s_cbranch_vccz FL_x_012_ok2
FL_x_012_x2:
  s_mov_b64 exec, vcc
  buffer_load_dwordx4 v[72:75], v9, s[4:7], s41 offen offset:2048 sc1
  s_mov_b64 exec, -1
  s_add_u32 s46, s46, 1
  s_cmp_ge_u32 s46, 2097152
  s_cbranch_scc1 FL_rec_abort
  s_waitcnt vmcnt(4)
  s_branch FL_x_012_c0
FL_x_012_ok0:
  v_mfma_f32_16x16x32_bf16 v[44:47], v[64:67], v[64:67], v[44:47]
  v_max3_u32 v31, v68, v69, v70
  v_max_u32 v31, v31, v71
  v_cmp_eq_u32 vcc, -1, v31
  v_mfma_f32_16x16x32_bf16 v[36:39], v[116:119], v[64:67], v[36:39]
  v_mfma_f32_16x16x32_bf16 v[40:43], v[132:135], v[64:67], v[40:43]
  s_cbranch_vccz FL_x_12_ok1
  s_branch FL_x_12_x1
FL_x_012_ok1:
  v_mfma_f32_16x16x32_bf16 v[44:47], v[68:71], v[68:71], v[44:47]
  v_max3_u32 v31, v72, v73, v74
  v_max_u32 v31, v31, v75
  v_cmp_eq_u32 vcc, -1, v31
  v_mfma_f32_16x16x32_bf16 v[36:39], v[120:123], v[68:71], v[36:39]
  v_mfma_f32_16x16x32_bf16 v[40:43], v[136:139], v[68:71], v[40:43]
  s_cbranch_vccz FL_x_02_ok2
  s_branch FL_x_02_x2
FL_x_012_ok2:
  v_mfma_f32_16x16x32_bf16 v[44:47], v[72:75], v[72:75], v[44:47]
  v_max3_u32 v31, v64, v65, v66
  v_max_u32 v31, v31, v67
  v_cmp_eq_u32 vcc, -1, v31
  v_mfma_f32_16x16x32_bf16 v[36:39], v[124:127], v[72:75], v[36:39]
  v_mfma_f32_16x16x32_bf16 v[40:43], v[140:143], v[72:75], v[40:43]
  s_cbranch_vccz FL_x_01_ok0
  s_branch FL_x_01_x0
FL_x_013_c0:
  v_max3_u32 v31, v64, v65, v66
  v_max_u32 v31, v31, v67
  v_cmp_eq_u32 vcc, -1, v31
  s_cbranch_vccz FL_x_013_ok0
FL_x_013_x0:
  s_mov_b64 exec, vcc
  buffer_load_dwordx4 v[64:67], v9, s[4:7], s41 offen offset:0 sc1
  s_mov_b64 exec, -1
FL_x_013_c1:
  v_max3_u32 v31, v68, v69, v70
  v_max_u32 v31, v31, v71
  v_cmp_eq_u32 vcc, -1, v31
  s_cbranch_vccz FL_x_013_ok1
FL_x_013_x1:
  s_mov_b64 exec, vcc
  buffer_load_dwordx4 v[68:71], v9, s[4:7], s41 offen offset:1024 sc1
  s_mov_b64 exec, -1
FL_x_013_c3:
  v_max3_u32 v31, v76, v77, v78
  v_max_u32 v31, v31, v79
  v_cmp_eq_u32 vcc, -1, v31
  s_cbranch_vccz FL_x_013_ok3
FL_x_013_x3:
  s_mov_b64 exec, vcc
  buffer_load_dwordx4 v[76:79], v9, s[4:7], s41 offen offset:3072 sc1
  s_mov_b64 exec, -1
  s_add_u32 s46, s46, 1
  s_cmp_ge_u32 s46, 2097152
  s_cbranch_scc1 FL_rec_abort
  s_waitcnt vmcnt(4)
  s_branch FL_x_013_c0
FL_x_013_ok0:
  v_mfma_f32_16x16x32_bf16 v[44:47], v[64:67], v[64:67], v[44:47]
  v_max3_u32 v31, v68, v69, v70
  v_max_u32 v31, v31, v71
  v_cmp_eq_u32 vcc, -1, v31
  v_mfma_f32_16x16x32_bf16 v[36:39], v[116:119], v[64:67], v[36:39]
  v_mfma_f32_16x16x32_bf16 v[40:43], v[132:135], v[64:67], v[40:43]
  s_cbranch_vccz FL_x_13_ok1
  s_branch FL_x_13_x1
FL_x_013_ok1:
  v_mfma_f32_16x16x32_bf16 v[44:47], v[68:71], v[68:71], v[44:47]
  v_max3_u32 v31, v76, v77, v78
  v_max_u32 v31, v31, v79
  v_cmp_eq_u32 vcc, -1, v31
  v_mfma_f32_16x16x32_bf16 v[36:39], v[120:123], v[68:71], v[36:39]
  v_mfma_f32_16x16x32_bf16 v[40:43], v[136:139], v[68:71], v[40:43]
  s_cbranch_vccz FL_x_03_ok3
  s_branch FL_x_03_x3
FL_x_013_ok3:
  v_mfma_f32_16x16x32_bf16 v[44:47], v[76:79], v[76:79], v[44:47]
  v_max3_u32 v31, v64, v65, v66
  v_max_u32 v31, v31, v67
  v_cmp_eq_u32 vcc, -1, v31
  v_mfma_f32_16x16x32_bf16 v[36:39], v[128:131], v[76:79], v[36:39]
  v_mfma_f32_16x16x32_bf16 v[40:43], v[144:147], v[76:79], v[40:43]
  s_cbranch_vccz FL_x_01_ok0
  s_branch FL_x_01_x0
FL_x_023_c0:
  v_max3_u32 v31, v64, v65, v66
  v_max_u32 v31, v31, v67
  v_cmp_eq_u32 vcc, -1, v31
  s_cbranch_vccz FL_x_023_ok0
FL_x_023_x0:
  s_mov_b64 exec, vcc
  buffer_load_dwordx4 v[64:67], v9, s[4:7], s41 offen offset:0 sc1
  s_mov_b64 exec, -1
FL_x_023_c2:
  v_max3_u32 v31, v72, v73, v74
  v_max_u32 v31, v31, v75
  v_cmp_eq_u32 vcc, -1, v31
  s_cbranch_vccz FL_x_023_ok2
FL_x_023_x2:
  s_mov_b64 exec, vcc
  buffer_load_dwordx4 v[72:75], v9, s[4:7], s41 offen offset:2048 sc1
  s_mov_b64 exec, -1
FL_x_023_c3:
  v_max3_u32 v31, v76, v77, v78
  v_max_u32 v31, v31, v79
  v_cmp_eq_u32 vcc, -1, v31
  s_cbranch_vccz FL_x_023_ok3
FL_x_023_x3:
  s_mov_b64 exec, vcc
  buffer_load_dwordx4 v[76:79], v9, s[4:7], s41 offen offset:3072 sc1
  s_mov_b64 exec, -1
  s_add_u32 s46, s46, 1
  s_cmp_ge_u32 s46, 2097152
  s_cbranch_scc1 FL_rec_abort
  s_waitcnt vmcnt(4)
  s_branch FL_x_023_c0
FL_x_023_ok0:
  v_mfma_f32_16x16x32_bf16 v[44:47], v[64:67], v[64:67], v[44:47]
  v_max3_u32 v31, v72, v73, v74
  v_max_u32 v31, v31, v75
  v_cmp_eq_u32 vcc, -1, v31
  v_mfma_f32_16x16x32_bf16 v[36:39], v[116:119], v[64:67], v[36:39]
  v_mfma_f32_16x16x32_bf16 v[40:43], v[132:135], v[64:67], v[40:43]
  s_cbranch_vccz FL_x_23_ok2
  s_branch FL_x_23_x2
FL_x_023_ok2:
  v_mfma_f32_16x16x32_bf16 v[44:47], v[72:75], v[72:75], v[44:47]
  v_max3_u32 v31, v76, v77, v78
  v_max_u32 v31, v31, v79
  v_cmp_eq_u32 vcc, -1, v31
  v_mfma_f32_16x16x32_bf16 v[36:39], v[124:127], v[72:75], v[36:39]
  v_mfma_f32_16x16x32_bf16 v[40:43], v[140:143], v[72:75], v[40:43]
  s_cbranch_vccz FL_x_03_ok3
  s_branch FL_x_03_x3
FL_x_023_ok3:
  v_mfma_f32_16x16x32_bf16 v[44:47], v[76:79], v[76:79], v[44:47]
  v_max3_u32 v31, v64, v65, v66
  v_max_u32 v31, v31, v67
  v_cmp_eq_u32 vcc, -1, v31
  v_mfma_f32_16x16x32_bf16 v[36:39], v[128:131], v[76:79], v[36:39]
  v_mfma_f32_16x16x32_bf16 v[40:43], v[144:147], v[76:79], v[40:43]
  s_cbranch_vccz FL_x_02_ok0
  s_branch FL_x_02_x0
FL_x_123_c1:
  v_max3_u32 v31, v68, v69, v70
  v_max_u32 v31, v31, v71
  v_cmp_eq_u32 vcc, -1, v31
  s_cbranch_vccz FL_x_123_ok1
FL_x_123_x1:
  s_mov_b64 exec, vcc
  buffer_load_dwordx4 v[68:71], v9, s[4:7], s41 offen offset:1024 sc1
  s_mov_b64 exec, -1
FL_x_123_c2:
  v_max3_u32 v31, v72, v73, v74
  v_max_u32 v31, v31, v75
  v_cmp_eq_u32 vcc, -1, v31
  s_cbranch_vccz FL_x_123_ok2
FL_x_123_x2:
  s_mov_b64 exec, vcc
  buffer_load_dwordx4 v[72:75], v9, s[4:7], s41 offen offset:2048 sc1
  s_mov_b64 exec, -1
FL_x_123_c3:
  v_max3_u32 v31, v76, v77, v78
  v_max_u32 v31, v31, v79
  v_cmp_eq_u32 vcc, -1, v31
  s_cbranch_vccz FL_x_123_ok3
FL_x_123_x3:
  s_mov_b64 exec, vcc
  buffer_load_dwordx4 v[76:79], v9, s[4:7], s41 offen offset:3072 sc1
  s_mov_b64 exec, -1
  s_add_u32 s46, s46, 1
  s_cmp_ge_u32 s46, 2097152
  s_cbranch_scc1 FL_rec_abort
  s_waitcnt vmcnt(4)
  s_branch FL_x_123_c1
FL_x_123_ok1:
  v_mfma_f32_16x16x32_bf16 v[44:47], v[68:71], v[68:71], v[44:47]
  v_max3_u32 v31, v72, v73, v74
  v_max_u32 v31, v31, v75
  v_cmp_eq_u32 vcc, -1, v31
  v_mfma_f32_16x16x32_bf16 v[36:39], v[120:123], v[68:71], v[36:39]
  v_mfma_f32_16x16x32_bf16 v[40:43], v[136:139], v[68:71], v[40:43]
  s_cbranch_vccz FL_x_23_ok2
  s_branch FL_x_23_x2
FL_x_123_ok2:
  v_mfma_f32_16x16x32_bf16 v[44:47], v[72:75], v[72:75], v[44:47]
  v_max3_u32 v31, v76, v77, v78
  v_max_u32 v31, v31, v79
  v_cmp_eq_u32 vcc, -1, v31
  v_mfma_f32_16x16x32_bf16 v[36:39], v[124:127], v[72:75], v[36:39]
  v_mfma_f32_16x16x32_bf16 v[40:43], v[140:143], v[72:75], v[40:43]
  s_cbranch_vccz FL_x_13_ok3
  s_branch FL_x_13_x3
FL_x_123_ok3:
  v_mfma_f32_16x16x32_bf16 v[44:47], v[76:79], v[76:79], v[44:47]
  v_max3_u32 v31, v68, v69, v70
  v_max_u32 v31, v31, v71
  v_cmp_eq_u32 vcc, -1, v31
  v_mfma_f32_16x16x32_bf16 v[36:39], v[128:131], v[76:79], v[36:39]
  v_mfma_f32_16x16x32_bf16 v[40:43], v[144:147], v[76:79], v[40:43]
  s_cbranch_vccz FL_x_12_ok1
  s_branch FL_x_12_x1
FL_x_0123_c0:
  v_max3_u32 v31, v64, v65, v66
  v_max_u32 v31, v31, v67
  v_cmp_eq_u32 vcc, -1, v31
  s_cbranch_vccz FL_x_0123_ok0
FL_x_0123_x0:
  s_mov_b64 exec, vcc
  buffer_load_dwordx4 v[64:67], v9, s[4:7], s41 offen offset:0 sc1
  s_mov_b64 exec, -1
FL_x_0123_c1:
  v_max3_u32 v31, v68, v69, v70
  v_max_u32 v31, v31, v71
  v_cmp_eq_u32 vcc, -1, v31
  s_cbranch_vccz FL_x_0123_ok1
FL_x_0123_x1:
  s_mov_b64 exec, vcc
  buffer_load_dwordx4 v[68:71], v9, s[4:7], s41 offen offset:1024 sc1
  s_mov_b64 exec, -1
FL_x_0123_c2:
  v_max3_u32 v31, v72, v73, v74
  v_max_u32 v31, v31, v75
  v_cmp_eq_u32 vcc, -1, v31
  s_cbranch_vccz FL_x_0123_ok2
FL_x_0123_x2:
  s_mov_b64 exec, vcc
  buffer_load_dwordx4 v[72:75], v9, s[4:7], s41 offen offset:2048 sc1
  s_mov_b64 exec, -1
FL_x_0123_c3:
  v_max3_u32 v31, v76, v77, v78
  v_max_u32 v31, v31, v79
  v_cmp_eq_u32 vcc, -1, v31
  s_cbranch_vccz FL_x_0123_ok3
FL_x_0123_x3:
  s_mov_b64 exec, vcc
  buffer_load_dwordx4 v[76:79], v9, s[4:7], s41 offen offset:3072 sc1
  s_mov_b64 exec, -1
  s_add_u32 s46, s46, 1
  s_cmp_ge_u32 s46, 2097152
  s_cbranch_scc1 FL_rec_abort
  s_waitcnt vmcnt(4)
  s_branch FL_x_0123_c0
FL_x_0123_ok0:
  v_mfma_f32_16x16x32_bf16 v[44:47], v[64:67], v[64:67], v[44:47]
  v_max3_u32 v31, v68, v69, v70
  v_max_u32 v31, v31, v71
  v_cmp_eq_u32 vcc, -1, v31
  v_mfma_f32_16x16x32_bf16 v[36:39], v[116:119], v[64:67], v[36:39]
  v_mfma_f32_16x16x32_bf16 v[40:43], v[132:135], v[64:67], v[40:43]
  s_cbranch_vccz FL_x_123_ok1
  s_branch FL_x_123_x1
FL_x_0123_ok1:
  v_mfma_f32_16x16x32_bf16 v[44:47], v[68:71], v[68:71], v[44:47]
  v_max3_u32 v31, v72, v73, v74
  v_max_u32 v31, v31, v75
  v_cmp_eq_u32 vcc, -1, v31
  v_mfma_f32_16x16x32_bf16 v[36:39], v[120:123], v[68:71], v[36:39]
  v_mfma_f32_16x16x32_bf16 v[40:43], v[136:139], v[68:71], v[40:43]
  s_cbranch_vccz FL_x_023_ok2
  s_branch FL_x_023_x2
FL_x_0123_ok2:
  v_mfma_f32_16x16x32_bf16 v[44:47], v[72:75], v[72:75], v[44:47]
  v_max3_u32 v31, v76, v77, v78
  v_max_u32 v31, v31, v79
  v_cmp_eq_u32 vcc, -1, v31
  v_mfma_f32_16x16x32_bf16 v[36:39], v[124:127], v[72:75], v[36:39]
  v_mfma_f32_16x16x32_bf16 v[40:43], v[140:143], v[72:75], v[40:43]
  s_cbranch_vccz FL_x_013_ok3
  s_branch FL_x_013_x3
FL_x_0123_ok3:
  v_mfma_f32_16x16x32_bf16 v[44:47], v[76:79], v[76:79], v[44:47]
  v_max3_u32 v31, v64, v65, v66
  v_max_u32 v31, v31, v67
  v_cmp_eq_u32 vcc, -1, v31
  v_mfma_f32_16x16x32_bf16 v[36:39], v[128:131], v[76:79], v[36:39]
  v_mfma_f32_16x16x32_bf16 v[40:43], v[144:147], v[76:79], v[40:43]
  s_cbranch_vccz FL_x_012_ok0
  s_branch FL_x_012_x0
FL_v_f:
  buffer_load_dwordx4 v[88:91], v10, s[4:7], s41 offen offset:0 sc1
  buffer_load_dwordx4 v[92:95], v10, s[4:7], s41 offen offset:1024 sc1
  s_add_u32 s46, s46, 1
  s_cmp_ge_u32 s46, 2097152
  s_cbranch_scc1 FL_rec_abort
  s_waitcnt vmcnt(0)
  v_max3_u32 v31, v88, v89, v90
  v_max3_u32 v31, v31, v91, v92
  v_max3_u32 v31, v31, v93, v94
  v_max_u32 v31, v31, v95
  v_cmp_eq_u32 vcc, -1, v31
  s_cbranch_vccnz FL_v_f
  s_branch FL_v_ok
FL_rec_abort:
  s_waitcnt vmcnt(0)
  s_endpgm
L_recslow:
  s_load_dwordx4 s[80:83], s[0:1], 8
  s_load_dwordx4 s[84:87], s[0:1], 24
  s_load_dwordx2 s[88:89], s[0:1], 40
  v_lshrrev_b32 v31, 6, v0
  s_nop 0
  v_readfirstlane_b32 s32, v31
  v_and_b32 v0, 63, v0
  s_lshr_b32 s35, s34, 4
  s_lshl_b32 s90, s33, 1
  s_add_u32 s35, s35, s90
  s_and_b32 s36, s34, 15
  s_lshr_b32 s37, s36, 2
  s_lshl_b32 s90, s35, 2
  s_add_u32 s37, s37, s90
  s_and_b32 s38, s36, 3
  s_waitcnt lgkmcnt(0)
  s_mov_b32 s24, s80
  s_and_b32 s25, s81, 0xffff
  s_mov_b32 s26, 0x4000
  s_mov_b32 s27, 0x20000
  s_mov_b32 s8, s82
  s_and_b32 s9, s83, 0xffff
  s_mov_b32 s10, 0x800000
  s_mov_b32 s11, 0x20000
  s_mov_b32 s12, s84
  s_and_b32 s13, s85, 0xffff
  s_mov_b32 s14, 0x800000
  s_mov_b32 s15, 0x20000
  s_mov_b32 s16, s86
  s_and_b32 s17, s87, 0xffff
  s_mov_b32 s18, 0x800000
  s_mov_b32 s19, 0x20000
  s_mov_b32 s20, s88
  s_and_b32 s21, s89, 0xffff
  s_mov_b32 s22, 0x800000
  s_mov_b32 s23, 0x20000
  s_lshl_b32 s90, s32, 21
  s_lshl_b32 s91, s37, 8
  s_add_u32 s90, s90, s91
  s_lshl_b32 s91, s38, 6
  s_add_u32 s90, s90, s91
  v_mov_b32 v1, 0x0
  v_bfe_u32 v31, v0, 2, 4
  v_lshl_add_u32 v1, v31, 13, v1
  v_bfe_u32 v31, v0, 0, 2
  v_lshl_add_u32 v1, v31, 4, v1
  v_add_u32 v1, s90, v1
  s_lshl_b32 s90, s35, 2
  s_add_u32 s90, s90, s32
  s_lshl_b32 s90, s90, 18
  s_lshl_b32 s91, s36, 7
  s_add_u32 s90, s90, s91
  v_mov_b32 v2, 0x0
  v_bfe_u32 v31, v0, 3, 3
  v_lshl_add_u32 v2, v31, 11, v2
  v_bfe_u32 v31, v0, 0, 3
  v_lshl_add_u32 v2, v31, 4, v2
  v_add_u32 v2, s90, v2
  s_lshl_b32 s96, s32, 15
  v_mov_b32 v3, 0x0
  v_bfe_u32 v31, v0, 5, 1
  v_lshl_add_u32 v3, v31, 10, v3
  v_bfe_u32 v31, v0, 4, 1
  v_lshl_add_u32 v3, v31, 9, v3
  v_bfe_u32 v31, v0, 2, 2
  v_lshl_add_u32 v3, v31, 6, v3
  v_bfe_u32 v31, v0, 0, 2
  v_lshl_add_u32 v3, v31, 3, v3
  v_add_u32 v3, s96, v3
  s_lshl_b32 s91, s32, 5
  v_mov_b32 v4, 0x4000
  v_bfe_u32 v31, v0, 4, 1
  v_lshl_add_u32 v4, v31, 13, v4
  v_bfe_u32 v31, v0, 5, 1
  v_lshl_add_u32 v4, v31, 8, v4
  v_bfe_u32 v31, v0, 2, 1
  v_lshl_add_u32 v4, v31, 10, v4
  v_bfe_u32 v31, v0, 3, 1
  v_lshl_add_u32 v4, v31, 7, v4
  v_bfe_u32 v31, v0, 0, 2
  v_lshl_add_u32 v4, v31, 3, v4
  v_add_u32 v4, s91, v4
  v_add_u32 v5, 0x10000, v4
  s_lshl_b32 s58, s33, 5
  s_add_u32 s58, s58, s34
  s_lshl_b32 s59, s32, 19
  s_add_u32 s59, s59, 0x3800000
  s_lshl_b32 s90, s58, 11
  s_add_u32 s90, s90, s59
  s_mul_i32 s91, s58, 3072
  s_add_u32 s91, s91, s59
  s_add_u32 s91, s91, 0x200000
  v_lshlrev_b32 v6, 4, v0
  v_mov_b32 v8, -1
  v_mov_b32 v9, -1
  v_mov_b32 v10, -1
  v_mov_b32 v11, -1
  buffer_store_dwordx4 v[8:11], v6, s[4:7], s90 offen offset:0 sc1
  buffer_store_dwordx4 v[8:11], v6, s[4:7], s90 offen offset:1024 sc1
  buffer_store_dwordx4 v[8:11], v6, s[4:7], s91 offen offset:0 sc1
  buffer_store_dwordx4 v[8:11], v6, s[4:7], s91 offen offset:1024 sc1
  buffer_store_dwordx4 v[8:11], v6, s[4:7], s91 offen offset:2048 sc1
  s_lshl_b32 s58, s33, 5
  s_add_u32 s58, s58, s34
  s_lshl_b32 s58, s58, 2
  s_add_u32 s58, s58, s32
  s_cmp_lg_u32 s58, 3
  s_cbranch_scc1 SL_np_1
  v_mov_b32 v6, 0x3800000
  v_bfe_u32 v31, v0, 0, 1
  v_lshl_add_u32 v6, v31, 13, v6
  v_bfe_u32 v31, v0, 1, 1
  s_mov_b32 s99, 4352
  v_mad_u32_u24 v6, v31, s99, v6
  v_bfe_u32 v31, v0, 2, 2
  s_mov_b32 s99, 82432
  v_mad_u32_u24 v6, v31, s99, v6
  v_mov_b32 v7, -1
  s_mov_b64 exec, 0xffff
  buffer_store_dword v7, v6, s[4:7], 0 offen sc1
  s_mov_b64 exec, -1
  s_waitcnt vmcnt(0)
SL_np_1:
  s_add_u32 m0, s96, 0
  s_mov_b32 s90, 0x0
  buffer_load_dwordx4 v1, s[8:11], s90 offen lds
  s_add_u32 m0, s96, 1024
  s_mov_b32 s90, 0x20000
  buffer_load_dwordx4 v1, s[8:11], s90 offen lds
  s_add_u32 m0, s96, 2048
  s_mov_b32 s90, 0x0
  buffer_load_dwordx4 v1, s[12:15], s90 offen lds
  s_add_u32 m0, s96, 3072
  s_mov_b32 s90, 0x20000
  buffer_load_dwordx4 v1, s[12:15], s90 offen lds
  s_add_u32 m0, s96, 4096
  s_mov_b32 s90, 0x0
  buffer_load_dwordx4 v1, s[16:19], s90 offen lds
  s_add_u32 m0, s96, 5120
  s_mov_b32 s90, 0x20000
  buffer_load_dwordx4 v1, s[16:19], s90 offen lds
  s_add_u32 m0, s96, 6144
  s_mov_b32 s90, 0x40000
  buffer_load_dwordx4 v1, s[8:11], s90 offen lds
  s_add_u32 m0, s96, 7168
  s_mov_b32 s90, 0x60000
  buffer_load_dwordx4 v1, s[8:11], s90 offen lds
  s_add_u32 m0, s96, 8192
  s_mov_b32 s90, 0x40000
  buffer_load_dwordx4 v1, s[12:15], s90 offen lds
  s_add_u32 m0, s96, 9216
  s_mov_b32 s90, 0x60000
  buffer_load_dwordx4 v1, s[12:15], s90 offen lds
  s_add_u32 m0, s96, 10240
  s_mov_b32 s90, 0x40000
  buffer_load_dwordx4 v1, s[16:19], s90 offen lds
  s_add_u32 m0, s96, 11264
  s_mov_b32 s90, 0x60000
  buffer_load_dwordx4 v1, s[16:19], s90 offen lds
  s_add_u32 m0, s96, 12288
  s_mov_b32 s90, 0x80000
  buffer_load_dwordx4 v1, s[8:11], s90 offen lds
  s_add_u32 m0, s96, 13312
  s_mov_b32 s90, 0xa0000
  buffer_load_dwordx4 v1, s[8:11], s90 offen lds
  s_add_u32 m0, s96, 14336
  s_mov_b32 s90, 0x80000
  buffer_load_dwordx4 v1, s[12:15], s90 offen lds
  s_add_u32 m0, s96, 15360
  s_mov_b32 s90, 0xa0000
  buffer_load_dwordx4 v1, s[12:15], s90 offen lds
  s_add_u32 m0, s96, 16384
  s_mov_b32 s90, 0x80000
  buffer_load_dwordx4 v1, s[16:19], s90 offen lds
  s_add_u32 m0, s96, 17408
  s_mov_b32 s90, 0xa0000
  buffer_load_dwordx4 v1, s[16:19], s90 offen lds
  s_add_u32 m0, s96, 18432
  s_mov_b32 s90, 0xc0000
  buffer_load_dwordx4 v1, s[8:11], s90 offen lds
  s_add_u32 m0, s96, 19456
  s_mov_b32 s90, 0xe0000
  buffer_load_dwordx4 v1, s[8:11], s90 offen lds
  s_add_u32 m0, s96, 20480
  s_mov_b32 s90, 0xc0000
  buffer_load_dwordx4 v1, s[12:15], s90 offen lds
  s_add_u32 m0, s96, 21504
  s_mov_b32 s90, 0xe0000
  buffer_load_dwordx4 v1, s[12:15], s90 offen lds
  s_add_u32 m0, s96, 22528
  s_mov_b32 s90, 0xc0000
  buffer_load_dwordx4 v1, s[16:19], s90 offen lds
  s_add_u32 m0, s96, 23552
  s_mov_b32 s90, 0xe0000
  buffer_load_dwordx4 v1, s[16:19], s90 offen lds
  s_add_u32 m0, s96, 24576
  s_mov_b32 s90, 0x100000
  buffer_load_dwordx4 v1, s[8:11], s90 offen lds
  s_add_u32 m0, s96, 25600
  s_mov_b32 s90, 0x120000
  buffer_load_dwordx4 v1, s[8:11], s90 offen lds
  s_add_u32 m0, s96, 26624
  s_mov_b32 s90, 0x100000
  buffer_load_dwordx4 v1, s[12:15], s90 offen lds
  s_add_u32 m0, s96, 27648
  s_mov_b32 s90, 0x120000
  buffer_load_dwordx4 v1, s[12:15], s90 offen lds
  s_add_u32 m0, s96, 28672
  s_mov_b32 s90, 0x100000
  buffer_load_dwordx4 v1, s[16:19], s90 offen lds
  s_add_u32 m0, s96, 29696
  s_mov_b32 s90, 0x120000
  buffer_load_dwordx4 v1, s[16:19], s90 offen lds
  s_add_u32 m0, s96, 30720
  s_mov_b32 s90, 0x140000
  buffer_load_dwordx4 v1, s[8:11], s90 offen lds
  s_add_u32 m0, s96, 31744
  s_mov_b32 s90, 0x160000
  buffer_load_dwordx4 v1, s[8:11], s90 offen lds
  s_cmp_lg_u32 s58, 3
  s_cbranch_scc1 SL_np_2
  s_add_u32 s92, s94, 0x3800000
  s_addc_u32 s93, s95, 0
  s_mov_b32 s62, -1
  s_mov_b32 s63, -1
  s_memtime s[56:57]
  s_waitcnt lgkmcnt(0)
  s_load_dword s60, s[92:93], 0x0
  s_waitcnt lgkmcnt(0)
  s_memtime s[58:59]
  s_waitcnt lgkmcnt(0)
  s_sub_u32 s58, s58, s56
  s_min_u32 s62, s62, s58
  s_memtime s[56:57]
  s_waitcnt lgkmcnt(0)
  s_load_dword s60, s[92:93], 0x2000
  s_waitcnt lgkmcnt(0)
  s_memtime s[58:59]
  s_waitcnt lgkmcnt(0)
  s_sub_u32 s58, s58, s56
  s_min_u32 s63, s63, s58
  s_memtime s[56:57]
  s_waitcnt lgkmcnt(0)
  s_load_dword s60, s[92:93], 0x1100
  s_waitcnt lgkmcnt(0)
  s_memtime s[58:59]
  s_waitcnt lgkmcnt(0)
  s_sub_u32 s58, s58, s56
  s_min_u32 s62, s62, s58
  s_memtime s[56:57]
  s_waitcnt lgkmcnt(0)
  s_load_dword s60, s[92:93], 0x3100
  s_waitcnt lgkmcnt(0)
  s_memtime s[58:59]
  s_waitcnt lgkmcnt(0)
  s_sub_u32 s58, s58, s56
  s_min_u32 s63, s63, s58
  s_memtime s[56:57]
  s_waitcnt lgkmcnt(0)
  s_load_dword s60, s[92:93], 0x14200
  s_waitcnt lgkmcnt(0)
  s_memtime s[58:59]
  s_waitcnt lgkmcnt(0)
  s_sub_u32 s58, s58, s56
  s_min_u32 s62, s62, s58
  s_memtime s[56:57]
  s_waitcnt lgkmcnt(0)
  s_load_dword s60, s[92:93], 0x16200
  s_waitcnt lgkmcnt(0)
  s_memtime s[58:59]
  s_waitcnt lgkmcnt(0)
  s_sub_u32 s58, s58, s56
  s_min_u32 s63, s63, s58
  s_memtime s[56:57]
  s_waitcnt lgkmcnt(0)
  s_load_dword s60, s[92:93], 0x15300
  s_waitcnt lgkmcnt(0)
  s_memtime s[58:59]
  s_waitcnt lgkmcnt(0)
  s_sub_u32 s58, s58, s56
  s_min_u32 s62, s62, s58
  s_memtime s[56:57]
  s_waitcnt lgkmcnt(0)
  s_load_dword s60, s[92:93], 0x17300
  s_waitcnt lgkmcnt(0)
  s_memtime s[58:59]
  s_waitcnt lgkmcnt(0)
  s_sub_u32 s58, s58, s56
  s_min_u32 s63, s63, s58
  s_memtime s[56:57]
  s_waitcnt lgkmcnt(0)
  s_load_dword s60, s[92:93], 0x28400
  s_waitcnt lgkmcnt(0)
  s_memtime s[58:59]
  s_waitcnt lgkmcnt(0)
  s_sub_u32 s58, s58, s56
  s_min_u32 s62, s62, s58
  s_memtime s[56:57]
  s_waitcnt lgkmcnt(0)
  s_load_dword s60, s[92:93], 0x2a400
  s_waitcnt lgkmcnt(0)
  s_memtime s[58:59]
  s_waitcnt lgkmcnt(0)
  s_sub_u32 s58, s58, s56
  s_min_u32 s63, s63, s58
  s_memtime s[56:57]
  s_waitcnt lgkmcnt(0)
  s_load_dword s60, s[92:93], 0x29500
  s_waitcnt lgkmcnt(0)
  s_memtime s[58:59]
  s_waitcnt lgkmcnt(0)
  s_sub_u32 s58, s58, s56
  s_min_u32 s62, s62, s58
  s_memtime s[56:57]
  s_waitcnt lgkmcnt(0)
  s_load_dword s60, s[92:93], 0x2b500
  s_waitcnt lgkmcnt(0)
  s_memtime s[58:59]
  s_waitcnt lgkmcnt(0)
  s_sub_u32 s58, s58, s56
  s_min_u32 s63, s63, s58
  s_memtime s[56:57]
  s_waitcnt lgkmcnt(0)
  s_load_dword s60, s[92:93], 0x3c600
  s_waitcnt lgkmcnt(0)
  s_memtime s[58:59]
  s_waitcnt lgkmcnt(0)
  s_sub_u32 s58, s58, s56
  s_min_u32 s62, s62, s58
  s_memtime s[56:57]
  s_waitcnt lgkmcnt(0)
  s_load_dword s60, s[92:93], 0x3e600
  s_waitcnt lgkmcnt(0)
  s_memtime s[58:59]
  s_waitcnt lgkmcnt(0)
  s_sub_u32 s58, s58, s56
  s_min_u32 s63, s63, s58
  s_memtime s[56:57]
  s_waitcnt lgkmcnt(0)
  s_load_dword s60, s[92:93], 0x3d700
  s_waitcnt lgkmcnt(0)
  s_memtime s[58:59]
  s_waitcnt lgkmcnt(0)
  s_sub_u32 s58, s58, s56
  s_min_u32 s62, s62, s58
  s_memtime s[56:57]
  s_waitcnt lgkmcnt(0)
  s_load_dword s60, s[92:93], 0x3f700
  s_waitcnt lgkmcnt(0)
  s_memtime s[58:59]
  s_waitcnt lgkmcnt(0)
  s_sub_u32 s58, s58, s56
  s_min_u32 s63, s63, s58
  s_cmp_lt_u32 s63, s62
  s_cselect_b32 s60, 2, 1
  v_mov_b32 v6, s60
  v_mov_b32 v7, s62
  v_mov_b32 v8, s63
  v_mov_b32 v9, 0
  s_mov_b64 exec, 1
  buffer_store_dword v6, v9, s[28:31], 0 offen offset:32 sc1
  s_mov_b64 exec, -1
  s_waitcnt vmcnt(0)
SL_np_2:
  s_waitcnt vmcnt(28)
  s_barrier
  s_cmp_lg_u32 s32, 0
  s_cbranch_scc1 SL_sig_3
  v_mov_b32 v254, 1
  v_mov_b32 v255, 0
  s_mov_b64 exec, 1
  buffer_atomic_add v254, v255, s[28:31], 0 offen offset:36 sc1
  s_mov_b64 exec, -1
SL_sig_3:
  ds_read_b64_tr_b16 a[0:1], v3 offset:0
  ds_read_b64_tr_b16 a[2:3], v3 offset:256
  ds_read_b64_tr_b16 a[8:9], v3 offset:32
  ds_read_b64_tr_b16 a[10:11], v3 offset:288
  ds_read_b64_tr_b16 a[16:17], v3 offset:2048
  ds_read_b64_tr_b16 a[18:19], v3 offset:2304
  ds_read_b64_tr_b16 a[24:25], v3 offset:2080
  ds_read_b64_tr_b16 a[26:27], v3 offset:2336
  s_waitcnt lgkmcnt(0)
  s_add_u32 m0, s96, 0
  s_mov_b32 s90, 0x140000
  buffer_load_dwordx4 v1, s[12:15], s90 offen lds
  s_add_u32 m0, s96, 1024
  s_mov_b32 s90, 0x160000
  buffer_load_dwordx4 v1, s[12:15], s90 offen lds
  s_add_u32 m0, s96, 2048
  s_mov_b32 s90, 0x140000
  buffer_load_dwordx4 v1, s[16:19], s90 offen lds
  s_add_u32 m0, s96, 3072
  s_mov_b32 s90, 0x160000
  buffer_load_dwordx4 v1, s[16:19], s90 offen lds
  s_waitcnt vmcnt(28)
  ds_read_b64_tr_b16 a[32:33], v3 offset:4096
  ds_read_b64_tr_b16 a[34:35], v3 offset:4352
  ds_read_b64_tr_b16 a[40:41], v3 offset:4128
  ds_read_b64_tr_b16 a[42:43], v3 offset:4384
  ds_read_b64_tr_b16 a[4:5], v3 offset:6144
  ds_read_b64_tr_b16 a[6:7], v3 offset:6400
  ds_read_b64_tr_b16 a[12:13], v3 offset:6176
  ds_read_b64_tr_b16 a[14:15], v3 offset:6432
  s_waitcnt lgkmcnt(0)
  s_add_u32 m0, s96, 4096
  s_mov_b32 s90, 0x180000
  buffer_load_dwordx4 v1, s[8:11], s90 offen lds
  s_add_u32 m0, s96, 5120
  s_mov_b32 s90, 0x1a0000
  buffer_load_dwordx4 v1, s[8:11], s90 offen lds
  s_add_u32 m0, s96, 6144
  s_mov_b32 s90, 0x180000
  buffer_load_dwordx4 v1, s[12:15], s90 offen lds
  s_add_u32 m0, s96, 7168
  s_mov_b32 s90, 0x1a0000
  buffer_load_dwordx4 v1, s[12:15], s90 offen lds
  s_waitcnt vmcnt(28)
  ds_read_b64_tr_b16 a[20:21], v3 offset:8192
  ds_read_b64_tr_b16 a[22:23], v3 offset:8448
  ds_read_b64_tr_b16 a[28:29], v3 offset:8224
  ds_read_b64_tr_b16 a[30:31], v3 offset:8480
  ds_read_b64_tr_b16 a[36:37], v3 offset:10240
  ds_read_b64_tr_b16 a[38:39], v3 offset:10496
  ds_read_b64_tr_b16 a[44:45], v3 offset:10272
  ds_read_b64_tr_b16 a[46:47], v3 offset:10528
  s_waitcnt lgkmcnt(0)
  s_add_u32 m0, s96, 8192
  s_mov_b32 s90, 0x180000
  buffer_load_dwordx4 v1, s[16:19], s90 offen lds
  s_add_u32 m0, s96, 9216
  s_mov_b32 s90, 0x1a0000
  buffer_load_dwordx4 v1, s[16:19], s90 offen lds
  s_add_u32 m0, s96, 10240
  s_mov_b32 s90, 0x1c0000
  buffer_load_dwordx4 v1, s[8:11], s90 offen lds
  s_add_u32 m0, s96, 11264
  s_mov_b32 s90, 0x1e0000
  buffer_load_dwordx4 v1, s[8:11], s90 offen lds
  s_waitcnt vmcnt(28)
  ds_read_b64_tr_b16 a[48:49], v3 offset:12288
  ds_read_b64_tr_b16 a[50:51], v3 offset:12544
  ds_read_b64_tr_b16 a[56:57], v3 offset:12320
  ds_read_b64_tr_b16 a[58:59], v3 offset:12576
  ds_read_b64_tr_b16 a[64:65], v3 offset:14336
  ds_read_b64_tr_b16 a[66:67], v3 offset:14592
  ds_read_b64_tr_b16 a[72:73], v3 offset:14368
  ds_read_b64_tr_b16 a[74:75], v3 offset:14624
  s_waitcnt lgkmcnt(0)
  s_add_u32 m0, s96, 12288
  s_mov_b32 s90, 0x1c0000
  buffer_load_dwordx4 v1, s[12:15], s90 offen lds
  s_add_u32 m0, s96, 13312
  s_mov_b32 s90, 0x1e0000
  buffer_load_dwordx4 v1, s[12:15], s90 offen lds
  s_add_u32 m0, s96, 14336
  s_mov_b32 s90, 0x1c0000
  buffer_load_dwordx4 v1, s[16:19], s90 offen lds
  s_add_u32 m0, s96, 15360
  s_mov_b32 s90, 0x1e0000
  buffer_load_dwordx4 v1, s[16:19], s90 offen lds
  s_waitcnt vmcnt(28)
  ds_read_b64_tr_b16 a[80:81], v3 offset:16384
  ds_read_b64_tr_b16 a[82:83], v3 offset:16640
  ds_read_b64_tr_b16 a[88:89], v3 offset:16416
  ds_read_b64_tr_b16 a[90:91], v3 offset:16672
  ds_read_b64_tr_b16 a[52:53], v3 offset:18432
  ds_read_b64_tr_b16 a[54:55], v3 offset:18688
  ds_read_b64_tr_b16 a[60:61], v3 offset:18464
  ds_read_b64_tr_b16 a[62:63], v3 offset:18720
  s_waitcnt lgkmcnt(0)
  s_add_u32 m0, s96, 16384
  s_mov_b32 s90, 0x0
  buffer_load_dwordx4 v2, s[20:23], s90 offen lds
  s_add_u32 m0, s96, 17408
  s_mov_b32 s90, 0x4000
  buffer_load_dwordx4 v2, s[20:23], s90 offen lds
  s_add_u32 m0, s96, 18432
  s_mov_b32 s90, 0x8000
  buffer_load_dwordx4 v2, s[20:23], s90 offen lds
  s_add_u32 m0, s96, 19456
  s_mov_b32 s90, 0xc000
  buffer_load_dwordx4 v2, s[20:23], s90 offen lds
  s_waitcnt vmcnt(28)
  ds_read_b64_tr_b16 a[68:69], v3 offset:20480
  ds_read_b64_tr_b16 a[70:71], v3 offset:20736
  ds_read_b64_tr_b16 a[76:77], v3 offset:20512
  ds_read_b64_tr_b16 a[78:79], v3 offset:20768
  ds_read_b64_tr_b16 a[84:85], v3 offset:22528
  ds_read_b64_tr_b16 a[86:87], v3 offset:22784
  ds_read_b64_tr_b16 a[92:93], v3 offset:22560
  ds_read_b64_tr_b16 a[94:95], v3 offset:22816
  s_waitcnt lgkmcnt(0)
  s_add_u32 m0, s96, 20480
  s_mov_b32 s90, 0x10000
  buffer_load_dwordx4 v2, s[20:23], s90 offen lds
  s_add_u32 m0, s96, 21504
  s_mov_b32 s90, 0x14000
  buffer_load_dwordx4 v2, s[20:23], s90 offen lds
  s_add_u32 m0, s96, 22528
  s_mov_b32 s90, 0x18000
  buffer_load_dwordx4 v2, s[20:23], s90 offen lds
  s_add_u32 m0, s96, 23552
  s_mov_b32 s90, 0x1c000
  buffer_load_dwordx4 v2, s[20:23], s90 offen lds
  s_waitcnt vmcnt(28)
  ds_read_b64_tr_b16 a[96:97], v3 offset:24576
  ds_read_b64_tr_b16 a[98:99], v3 offset:24832
  ds_read_b64_tr_b16 a[104:105], v3 offset:24608
  ds_read_b64_tr_b16 a[106:107], v3 offset:24864
  ds_read_b64_tr_b16 a[112:113], v3 offset:26624
  ds_read_b64_tr_b16 a[114:115], v3 offset:26880
  ds_read_b64_tr_b16 a[120:121], v3 offset:26656
  ds_read_b64_tr_b16 a[122:123], v3 offset:26912
  s_waitcnt lgkmcnt(0)
  s_add_u32 m0, s96, 24576
  s_mov_b32 s90, 0x20000
  buffer_load_dwordx4 v2, s[20:23], s90 offen lds
  s_add_u32 m0, s96, 25600
  s_mov_b32 s90, 0x24000
  buffer_load_dwordx4 v2, s[20:23], s90 offen lds
  s_add_u32 m0, s96, 26624
  s_mov_b32 s90, 0x28000
  buffer_load_dwordx4 v2, s[20:23], s90 offen lds
  s_add_u32 m0, s96, 27648
  s_mov_b32 s90, 0x2c000
  buffer_load_dwordx4 v2, s[20:23], s90 offen lds
  s_waitcnt vmcnt(28)
  ds_read_b64_tr_b16 a[128:129], v3 offset:28672
  ds_read_b64_tr_b16 a[130:131], v3 offset:28928
  ds_read_b64_tr_b16 a[136:137], v3 offset:28704
  ds_read_b64_tr_b16 a[138:139], v3 offset:28960
  ds_read_b64_tr_b16 a[100:101], v3 offset:30720
  ds_read_b64_tr_b16 a[102:103], v3 offset:30976
  ds_read_b64_tr_b16 a[108:109], v3 offset:30752
  ds_read_b64_tr_b16 a[110:111], v3 offset:31008
  s_waitcnt lgkmcnt(0)
  s_add_u32 m0, s96, 28672
  s_mov_b32 s90, 0x30000
  buffer_load_dwordx4 v2, s[20:23], s90 offen lds
  s_add_u32 m0, s96, 29696
  s_mov_b32 s90, 0x34000
  buffer_load_dwordx4 v2, s[20:23], s90 offen lds
  s_add_u32 m0, s96, 30720
  s_mov_b32 s90, 0x38000
  buffer_load_dwordx4 v2, s[20:23], s90 offen lds
  s_add_u32 m0, s96, 31744
  s_mov_b32 s90, 0x3c000
  buffer_load_dwordx4 v2, s[20:23], s90 offen lds
  s_waitcnt vmcnt(28)
  ds_read_b64_tr_b16 a[116:117], v3 offset:0
  ds_read_b64_tr_b16 a[118:119], v3 offset:256
  ds_read_b64_tr_b16 a[124:125], v3 offset:32
  ds_read_b64_tr_b16 a[126:127], v3 offset:288
  ds_read_b64_tr_b16 a[132:133], v3 offset:2048
  ds_read_b64_tr_b16 a[134:135], v3 offset:2304
  ds_read_b64_tr_b16 a[140:141], v3 offset:2080
  ds_read_b64_tr_b16 a[142:143], v3 offset:2336
  s_waitcnt vmcnt(24)
  ds_read_b64_tr_b16 a[144:145], v3 offset:4096
  ds_read_b64_tr_b16 a[146:147], v3 offset:4352
  ds_read_b64_tr_b16 a[152:153], v3 offset:4128
  ds_read_b64_tr_b16 a[154:155], v3 offset:4384
  ds_read_b64_tr_b16 a[160:161], v3 offset:6144
  ds_read_b64_tr_b16 a[162:163], v3 offset:6400
  ds_read_b64_tr_b16 a[168:169], v3 offset:6176
  ds_read_b64_tr_b16 a[170:171], v3 offset:6432
  s_waitcnt vmcnt(20)
  ds_read_b64_tr_b16 a[176:177], v3 offset:8192
  ds_read_b64_tr_b16 a[178:179], v3 offset:8448
  ds_read_b64_tr_b16 a[184:185], v3 offset:8224
  ds_read_b64_tr_b16 a[186:187], v3 offset:8480
  ds_read_b64_tr_b16 a[148:149], v3 offset:10240
  ds_read_b64_tr_b16 a[150:151], v3 offset:10496
  ds_read_b64_tr_b16 a[156:157], v3 offset:10272
  ds_read_b64_tr_b16 a[158:159], v3 offset:10528
  s_waitcnt vmcnt(16)
  ds_read_b64_tr_b16 a[164:165], v3 offset:12288
  ds_read_b64_tr_b16 a[166:167], v3 offset:12544
  ds_read_b64_tr_b16 a[172:173], v3 offset:12320
  ds_read_b64_tr_b16 a[174:175], v3 offset:12576
  ds_read_b64_tr_b16 a[180:181], v3 offset:14336
  ds_read_b64_tr_b16 a[182:183], v3 offset:14592
  ds_read_b64_tr_b16 a[188:189], v3 offset:14368
  ds_read_b64_tr_b16 a[190:191], v3 offset:14624
  s_waitcnt vmcnt(0)
  s_barrier
  ds_read_b64_tr_b16 a[192:193], v4 offset:0
  ds_read_b64_tr_b16 a[194:195], v4 offset:2048
  ds_read_b64_tr_b16 a[196:197], v4 offset:512
  ds_read_b64_tr_b16 a[198:199], v4 offset:2560
  ds_read_b64_tr_b16 a[200:201], v4 offset:4096
  ds_read_b64_tr_b16 a[202:203], v4 offset:6144
  ds_read_b64_tr_b16 a[204:205], v4 offset:4608
  ds_read_b64_tr_b16 a[206:207], v4 offset:6656
  s_waitcnt lgkmcnt(0)
  ds_read_b64_tr_b16 a[208:209], v4 offset:32768
  ds_read_b64_tr_b16 a[210:211], v4 offset:34816
  ds_read_b64_tr_b16 a[212:213], v4 offset:33280
  ds_read_b64_tr_b16 a[214:215], v4 offset:35328
  ds_read_b64_tr_b16 a[216:217], v4 offset:36864
  ds_read_b64_tr_b16 a[218:219], v4 offset:38912
  ds_read_b64_tr_b16 a[220:221], v4 offset:37376
  ds_read_b64_tr_b16 a[222:223], v4 offset:39424
  s_waitcnt lgkmcnt(0)
  ds_read_b64_tr_b16 a[224:225], v5 offset:0
  ds_read_b64_tr_b16 a[226:227], v5 offset:2048
  ds_read_b64_tr_b16 a[228:229], v5 offset:512
  ds_read_b64_tr_b16 a[230:231], v5 offset:2560
  ds_read_b64_tr_b16 a[232:233], v5 offset:4096
  ds_read_b64_tr_b16 a[234:235], v5 offset:6144
  ds_read_b64_tr_b16 a[236:237], v5 offset:4608
  ds_read_b64_tr_b16 a[238:239], v5 offset:6656
  s_waitcnt lgkmcnt(0)
  ds_read_b64_tr_b16 a[240:241], v5 offset:32768
  ds_read_b64_tr_b16 a[242:243], v5 offset:34816
  ds_read_b64_tr_b16 a[244:245], v5 offset:33280
  ds_read_b64_tr_b16 a[246:247], v5 offset:35328
  ds_read_b64_tr_b16 a[248:249], v5 offset:36864
  ds_read_b64_tr_b16 a[250:251], v5 offset:38912
  ds_read_b64_tr_b16 a[252:253], v5 offset:37376
  ds_read_b64_tr_b16 a[254:255], v5 offset:39424
  s_waitcnt lgkmcnt(0)
  s_barrier
  s_mov_b32 s46, 0
  v_mov_b32 v9, 0
SL_polwait:
  buffer_load_dwordx2 v[6:7], v9, s[28:31], 0 offen offset:32 sc1
  buffer_load_dword v8, v9, s[28:31], 0 offen offset:64 sc1
  s_waitcnt vmcnt(0)
  v_readfirstlane_b32 s39, v6
  s_add_u32 s46, s46, 1
  s_cmp_ge_u32 s46, 2097152
  s_cbranch_scc1 SL_rec_abort
  s_sleep 4
  v_readfirstlane_b32 s90, v7
  v_readfirstlane_b32 s91, v8
  s_cmp_lt_u32 s90, 128
  s_cbranch_scc1 SL_polwait
  s_cmp_lt_u32 s91, 32
  s_cbranch_scc1 SL_polwait
  s_cmp_eq_u32 s39, 0
  s_cbranch_scc1 SL_polwait
  s_sub_u32 s39, s39, 1
  s_and_b32 s39, s39, 1
  s_lshl_b32 s39, s39, 13
  s_lshl_b32 s90, s34, 2
  s_add_u32 s90, s90, s32
  s_lshr_b32 s91, s90, 3
  s_lshl_b32 s91, s91, 14
  s_and_b32 s92, s90, 7
  s_lshl_b32 s92, s92, 10
  s_add_u32 s91, s91, s92
  s_add_u32 s91, s91, s39
  v_mov_b32 v1, 0x0
  v_bfe_u32 v31, v0, 0, 6
  v_lshl_add_u32 v1, v31, 4, v1
  v_add_u32 v1, s91, v1
  v_lshrrev_b32 v30, 4, v0
  v_cmp_eq_u32 vcc, s33, v30
  v_xor_b32 v29, 0x2000, v1
  s_nop 0
  v_cndmask_b32 v1, v1, v29, vcc
  s_lshl_b32 s91, s33, 14
  s_lshl_b32 s92, s90, 7
  s_add_u32 s91, s91, s92
  v_mov_b32 v2, 0x200000
  v_bfe_u32 v31, v0, 0, 2
  v_lshl_add_u32 v2, v31, 2, v2
  v_bfe_u32 v31, v0, 2, 1
  v_lshl_add_u32 v2, v31, 6, v2
  v_bfe_u32 v31, v0, 4, 1
  v_lshl_add_u32 v2, v31, 4, v2
  v_bfe_u32 v31, v0, 5, 1
  v_lshl_add_u32 v2, v31, 5, v2
  v_bfe_u32 v31, v0, 3, 1
  v_lshl_add_u32 v2, v31, 31, v2
  v_add_u32 v2, s91, v2
  s_lshr_b32 s92, s90, 1
  s_lshl_b32 s92, s92, 5
  s_and_b32 s91, s90, 1
  s_lshl_b32 s91, s91, 13
  s_add_u32 s92, s92, s91
  v_mov_b32 v30, 0x0
  v_bfe_u32 v31, v0, 2, 1
  v_lshl_add_u32 v30, v31, 12, v30
  v_bfe_u32 v31, v0, 4, 1
  v_lshl_add_u32 v30, v31, 11, v30
  v_bfe_u32 v31, v0, 0, 2
  v_lshl_add_u32 v30, v31, 3, v30
  v_bfe_u32 v31, v0, 5, 1
  v_lshl_add_u32 v30, v31, 2, v30
  v_add_u32 v30, s92, v30
  buffer_load_dword v44, v30, s[24:27], 0 offen
  s_lshl_b32 s91, s33, 14
  s_lshl_b32 s92, s32, 12
  s_add_u32 s91, s91, s92
  v_mov_b32 v3, 0x200000
  v_bfe_u32 v31, v0, 0, 6
  v_lshl_add_u32 v3, v31, 4, v3
  v_add_u32 v3, s91, v3
  s_mul_i32 s91, s32, 3264
  v_mov_b32 v4, 0x0
  v_bfe_u32 v31, v0, 0, 6
  v_lshl_add_u32 v4, v31, 4, v4
  v_add_u32 v4, s91, v4
  s_lshl_b32 s91, s32, 6
  v_mov_b32 v6, 0x0
  v_bfe_u32 v31, v0, 0, 2
  v_lshl_add_u32 v6, v31, 4, v6
  v_bfe_u32 v31, v0, 2, 1
  v_lshl_add_u32 v6, v31, 2, v6
  v_bfe_u32 v31, v0, 3, 1
  s_mov_b32 s99, 1088
  v_mad_u32_u24 v6, v31, s99, v6
  v_bfe_u32 v31, v0, 4, 2
  v_lshl_add_u32 v6, v31, 8, v6
  v_add_u32 v6, s91, v6
  v_add_u32 v240, 3264, v6
  v_add_u32 v241, 6528, v6
  v_add_u32 v242, 9792, v6
  s_lshl_b32 s93, s37, 13
  s_lshl_b32 s91, s38, 10
  s_add_u32 s91, s91, s93
  s_lshl_b32 s92, s32, 8
  s_add_u32 s91, s91, s92
  v_mov_b32 v7, 0x210000
  v_bfe_u32 v31, v0, 0, 6
  v_lshl_add_u32 v7, v31, 2, v7
  v_add_u32 v7, s91, v7
  s_lshl_b32 s91, s37, 11
  s_lshl_b32 s92, s38, 9
  s_add_u32 s96, s91, s92
  s_lshl_b32 s92, s32, 7
  s_add_u32 s91, s96, s92
  v_mov_b32 v19, 0x83000000
  v_bfe_u32 v31, v0, 0, 3
  v_lshl_add_u32 v19, v31, 2, v19
  v_bfe_u32 v31, v0, 4, 2
  v_lshl_add_u32 v19, v31, 5, v19
  v_bfe_u32 v31, v0, 3, 1
  v_lshl_add_u32 v19, v31, 31, v19
  v_add_u32 v19, s91, v19
  s_lshl_b32 s91, s32, 8
  v_mov_b32 v5, 0x880
  v_bfe_u32 v31, v0, 0, 1
  v_lshl_add_u32 v5, v31, 7, v5
  v_bfe_u32 v31, v0, 1, 1
  v_lshl_add_u32 v5, v31, 3, v5
  v_bfe_u32 v31, v0, 2, 3
  v_lshl_add_u32 v5, v31, 4, v5
  v_add_u32 v5, s91, v5
  s_lshr_b32 s92, s38, 1
  s_lshl_b32 s92, s92, 10
  s_add_u32 s91, s91, s92
  s_add_u32 s91, s91, s93
  s_and_b32 s92, s38, 1
  s_lshl_b32 s92, s92, 7
  s_add_u32 s91, s91, s92
  v_mov_b32 v8, 0x211000
  v_bfe_u32 v31, v0, 0, 5
  v_lshl_add_u32 v8, v31, 2, v8
  v_bfe_u32 v31, v0, 5, 1
  v_lshl_add_u32 v8, v31, 31, v8
  v_add_u32 v8, s91, v8
  s_sub_u32 s91, s91, s93
  s_lshl_b32 s92, s37, 11
  s_add_u32 s91, s91, s92
  v_mov_b32 v20, 0x3400000
  v_bfe_u32 v31, v0, 0, 5
  v_lshl_add_u32 v20, v31, 2, v20
  v_bfe_u32 v31, v0, 5, 1
  v_lshl_add_u32 v20, v31, 31, v20
  v_add_u32 v20, s91, v20
  s_lshl_b32 s97, s35, 2
  s_add_u32 s97, s97, s32
  s_lshl_b32 s97, s97, 13
  v_mov_b32 v9, 0x210000
  v_bfe_u32 v31, v0, 0, 6
  v_lshl_add_u32 v9, v31, 4, v9
  v_add_u32 v9, s97, v9
  v_add_u32 v10, 4096, v9
  v_mov_b32 v11, 0x1000000
  v_bfe_u32 v31, v0, 0, 2
  v_lshl_add_u32 v11, v31, 4, v11
  v_bfe_u32 v31, v0, 2, 1
  v_lshl_add_u32 v11, v31, 7, v11
  v_bfe_u32 v31, v0, 3, 1
  v_lshl_add_u32 v11, v31, 12, v11
  v_bfe_u32 v31, v0, 4, 2
  v_lshl_add_u32 v11, v31, 8, v11
  v_add_u32 v11, s97, v11
  v_mov_b32 v12, 0x2000000
  v_bfe_u32 v31, v0, 0, 3
  v_lshl_add_u32 v12, v31, 4, v12
  v_bfe_u32 v31, v0, 3, 1
  v_lshl_add_u32 v12, v31, 11, v12
  v_bfe_u32 v31, v0, 4, 2
  v_lshl_add_u32 v12, v31, 8, v12
  v_add_u32 v12, s97, v12
  v_add_u32 v13, 4096, v12
  s_lshl_b32 s91, s36, 9
  s_add_u32 s91, s91, s97
  v_mov_b32 v21, 0x1000000
  v_bfe_u32 v31, v0, 0, 3
  v_lshl_add_u32 v21, v31, 6, v21
  v_bfe_u32 v31, v0, 3, 1
  v_lshl_add_u32 v21, v31, 24, v21
  v_add_u32 v21, s91, v21
  v_cmp_gt_u32 vcc, 16, v0
  v_mov_b32 v30, 0x80000000
  s_nop 0
  v_cndmask_b32 v21, v30, v21, vcc
  s_lshl_b32 s91, s32, 11
  v_mov_b32 v30, 0x0
  v_bfe_u32 v31, v0, 2, 1
  v_lshl_add_u32 v30, v31, 6, v30
  v_bfe_u32 v31, v0, 0, 1
  v_lshl_add_u32 v30, v31, 5, v30
  v_bfe_u32 v31, v0, 1, 1
  v_lshl_add_u32 v30, v31, 4, v30
  v_mov_b32 v29, 0x0
  v_bfe_u32 v31, v0, 4, 2
  v_lshl_add_u32 v29, v31, 5, v29
  v_xor_b32 v30, v30, v29
  v_mov_b32 v14, 0x3400
  v_bfe_u32 v31, v0, 0, 4
  v_lshl_add_u32 v14, v31, 7, v14
  v_add_u32 v14, s91, v14
  v_add_u32 v14, v14, v30
  v_xor_b32 v15, 16, v14
  v_mov_b32 v30, 0x0
  v_bfe_u32 v31, v0, 5, 1
  v_lshl_add_u32 v30, v31, 6, v30
  v_bfe_u32 v31, v0, 1, 1
  v_lshl_add_u32 v30, v31, 5, v30
  v_bfe_u32 v31, v0, 4, 1
  v_lshl_add_u32 v30, v31, 4, v30
  v_mov_b32 v29, 0x0
  v_bfe_u32 v31, v0, 2, 2
  v_lshl_add_u32 v29, v31, 5, v29
  v_bfe_u32 v31, v0, 0, 1
  v_lshl_add_u32 v29, v31, 4, v29
  v_xor_b32 v30, v30, v29
  v_mov_b32 v16, 0x3400
  v_bfe_u32 v31, v0, 4, 2
  v_lshl_add_u32 v16, v31, 8, v16
  v_bfe_u32 v31, v0, 1, 1
  v_lshl_add_u32 v16, v31, 7, v16
  v_add_u32 v16, v16, v30
  s_lshl_b32 s98, s36, 14
  s_lshl_b32 s92, s35, 7
  s_add_u32 s98, s98, s92
  s_add_u32 s98, s98, s39
  s_lshl_b32 s92, s32, 11
  s_add_u32 s91, s98, s92
  v_mov_b32 v17, 0x0
  v_bfe_u32 v31, v0, 0, 5
  v_lshl_add_u32 v17, v31, 2, v17
  v_bfe_u32 v31, v0, 5, 1
  v_lshl_add_u32 v17, v31, 10, v17
  v_add_u32 v17, s91, v17
  v_xor_b32 v18, 0x2000, v17
  s_mov_b32 s48, 0x33333333
  s_mov_b32 s49, 0x33333333
  s_mov_b32 s50, 0xffff0000
  s_mov_b32 s51, 0xffff0000
  s_mov_b32 s52, 0x0000ffff
  s_mov_b32 s53, 0x0000ffff
  s_mov_b32 s54, 0xfffffffe
  s_mov_b32 s47, 0x3e0293ee
  v_mov_b32 v30, 0x4444
  v_mov_b32 v31, 0xeeee
  v_cndmask_b32 v23, v31, v30, s[48:49]
  v_mov_b32 v22, -1
  v_mov_b32 v248, 0x3f803f80
  v_mov_b32 v249, 0x3f803f80
  v_mov_b32 v250, 0x3f803f80
  v_mov_b32 v251, 0x3f803f80
  v_mov_b32 v252, 0x3f803f80
  v_mov_b32 v253, 0x3f803f80
  v_mov_b32 v254, 0x3f803f80
  v_mov_b32 v255, 0x3f803f80
  v_mov_b32 v232, 0
  v_mov_b32 v233, 0
  v_mov_b32 v234, 0
  v_mov_b32 v235, 0
  v_mov_b32 v112, 0
  v_mov_b32 v113, 0
  s_mov_b32 s56, 0xf0f0f0f0
  s_mov_b32 s57, 0xf0f0f0f0
  v_mov_b32 v30, 0x3f80
  v_mov_b32 v31, 1.0
  v_cndmask_b32 v30, v30, v31, s[56:57]
  s_mov_b32 s56, 0x110011
  s_mov_b32 s57, 0x110011
  v_cndmask_b32 v24, 0, v30, s[56:57]
  s_mov_b32 s56, 0x220022
  s_mov_b32 s57, 0x220022
  v_cndmask_b32 v25, 0, v30, s[56:57]
  s_mov_b32 s56, 0x11001100
  s_mov_b32 s57, 0x11001100
  v_cndmask_b32 v26, 0, v30, s[56:57]
  s_mov_b32 s56, 0x22002200
  s_mov_b32 s57, 0x22002200
  v_cndmask_b32 v27, 0, v30, s[56:57]
  s_mov_b32 s40, 0
  s_mov_b32 s41, 0x3800000
  s_mov_b32 s43, 0x3900000
  s_mov_b32 s44, 0
  s_mov_b32 s55, 0x40000
  s_mov_b32 s45, 0
  buffer_load_dwordx4 v[180:183], v12, s[4:7], s44 offen offset:0
  buffer_load_dwordx4 v[184:187], v12, s[4:7], s44 offen offset:128
  buffer_load_dwordx4 v[188:191], v12, s[4:7], s44 offen offset:1024
  buffer_load_dwordx4 v[192:195], v12, s[4:7], s44 offen offset:1152
  buffer_load_dwordx4 v[196:199], v13, s[4:7], s44 offen offset:0
  buffer_load_dwordx4 v[200:203], v13, s[4:7], s44 offen offset:128
  buffer_load_dwordx4 v[204:207], v13, s[4:7], s44 offen offset:1024
  buffer_load_dwordx4 v[208:211], v13, s[4:7], s44 offen offset:1152
  buffer_load_dwordx4 v[116:119], v11, s[4:7], s44 offen offset:0
  buffer_load_dwordx4 v[132:135], v11, s[4:7], s44 offen offset:64
  buffer_load_dwordx4 v[120:123], v11, s[4:7], s44 offen offset:1024
  buffer_load_dwordx4 v[136:139], v11, s[4:7], s44 offen offset:1088
  buffer_load_dwordx4 v[124:127], v11, s[4:7], s44 offen offset:2048
  buffer_load_dwordx4 v[140:143], v11, s[4:7], s44 offen offset:2112
  buffer_load_dwordx4 v[128:131], v11, s[4:7], s44 offen offset:3072
  buffer_load_dwordx4 v[144:147], v11, s[4:7], s44 offen offset:3136
  s_add_u32 s44, s44, 0x40000
  v_mov_b64 v[64:65], 0
  v_mov_b64 v[66:67], 0
  v_mov_b64 v[68:69], 0
  v_mov_b64 v[70:71], 0
  v_mov_b64 v[72:73], 0
  v_mov_b64 v[74:75], 0
  v_mov_b64 v[76:77], 0
  v_mov_b64 v[78:79], 0
  v_mov_b64 v[80:81], 0
  v_mov_b64 v[82:83], 0
  v_mov_b64 v[84:85], 0
  v_mov_b64 v[86:87], 0
  v_mov_b64 v[32:33], 0
  v_mov_b64 v[34:35], 0
  v_mov_b64 v[212:213], 0
  v_mov_b64 v[214:215], 0
  v_mov_b64 v[216:217], 0
  v_mov_b64 v[218:219], 0
  v_mov_b64 v[220:221], 0
  v_mov_b64 v[222:223], 0
  v_mov_b64 v[224:225], 0
  v_mov_b64 v[226:227], 0
  v_mov_b64 v[228:229], 0
  v_mov_b64 v[230:231], 0
  s_waitcnt vmcnt(0)
  v_min_u32 v44, s54, v44
  v_mov_b32 v244, 0
  s_lshl_b32 s90, s33, 5
  s_add_u32 s90, s90, s34
  s_lshl_b32 s90, s90, 2
  s_add_u32 s90, s90, s32
  v_mbcnt_lo_u32_b32 v30, -1, 0
  v_mbcnt_hi_u32_b32 v30, -1, v30
  v_add_u32 v30, s90, v30
  v_cmp_eq_u32 vcc, 0, v30
  v_mov_b32 v30, 0x80000000
  v_mov_b32 v31, 40
  v_cndmask_b32 v245, v30, v31, vcc
  s_branch SL_pubmem
SL_step:
  buffer_load_dwordx4 v[192:195], v12, s[4:7], s44 offen offset:1152
  buffer_load_dwordx4 v[196:199], v13, s[4:7], s44 offen offset:0
  buffer_load_dwordx4 v[200:203], v13, s[4:7], s44 offen offset:128
  buffer_load_dwordx4 v[204:207], v13, s[4:7], s44 offen offset:1024
  v_mov_b64 v[64:65], 0
  v_mov_b64 v[66:67], 0
  v_mov_b64 v[68:69], 0
  v_mov_b64 v[70:71], 0
  v_mov_b64 v[72:73], 0
  v_mov_b64 v[74:75], 0
  v_mov_b64 v[76:77], 0
  v_mov_b64 v[78:79], 0
  v_mov_b64 v[80:81], 0
  v_mov_b64 v[82:83], 0
  v_mov_b64 v[84:85], 0
  v_mov_b64 v[86:87], 0
  v_mov_b64 v[32:33], 0
  v_mov_b64 v[34:35], 0
  buffer_load_dwordx4 v[36:39], v1, s[4:7], s42 offen sc1
  buffer_load_dwordx4 v[208:211], v13, s[4:7], s44 offen offset:1152
  buffer_load_dwordx4 v[124:127], v11, s[4:7], s44 offen offset:2048
  buffer_load_dwordx4 v[140:143], v11, s[4:7], s44 offen offset:2112
  buffer_load_dwordx4 v[128:131], v11, s[4:7], s44 offen offset:3072
  buffer_load_dwordx4 v[144:147], v11, s[4:7], s44 offen offset:3136
  s_add_u32 s44, s44, 0x40000
  s_min_u32 s44, s44, 0xfc0000
  s_add_u32 s45, s45, 0x10000
  s_waitcnt vmcnt(12)
SL_kv_chk:
  v_readfirstlane_b32 s90, v243
  s_cmp_lt_u32 s90, 32
  s_cbranch_scc1 SL_kv_f
  s_waitcnt vmcnt(5)
SL_g_chk:
  v_max3_u32 v31, v36, v37, v38
  v_max_u32 v31, v31, v39
  v_cmp_eq_u32 vcc, -1, v31
  v_mfma_f32_16x16x32_bf16 v[40:43], v[24:27], v[36:39], 0
  s_cbranch_vccnz SL_g_f
  s_nop 6
  v_add_f32_dpp v45, v40, v40 row_ror:8 row_mask:0xf bank_mask:0xf
  v_add_f32_dpp v46, v41, v41 row_ror:8 row_mask:0xf bank_mask:0xf
  v_cvt_pk_bf16_f32 v44, v45, v46
  v_min_u32 v44, s54, v44
SL_pubmem:
  buffer_store_dword v44, v2, s[4:7], s41 offen sc1
  s_waitcnt vmcnt(5)
  v_mov_b32 v148, v180
  v_mov_b32 v150, v181
  v_mov_b32 v152, v182
  v_mov_b32 v154, v183
  v_mov_b32 v149, v184
  v_mov_b32 v151, v185
  v_mov_b32 v153, v186
  v_mov_b32 v155, v187
  v_mov_b32 v156, v188
  v_mov_b32 v158, v189
  v_mov_b32 v160, v190
  v_mov_b32 v162, v191
  v_mov_b32 v157, v192
  v_mov_b32 v159, v193
  v_mov_b32 v161, v194
  v_mov_b32 v163, v195
  v_mov_b32 v164, v196
  v_mov_b32 v166, v197
  v_mov_b32 v168, v198
  v_mov_b32 v170, v199
  v_mov_b32 v165, v200
  v_mov_b32 v167, v201
  v_mov_b32 v169, v202
  v_mov_b32 v171, v203
  buffer_load_dwordx4 v[48:51], v3, s[4:7], s41 offen offset:0 sc1
  v_mov_b32 v172, v204
  v_mov_b32 v174, v205
  buffer_load_dwordx4 v[52:55], v3, s[4:7], s41 offen offset:1024 sc1
  v_mov_b32 v176, v206
  v_mov_b32 v178, v207
  buffer_load_dwordx4 v[56:59], v3, s[4:7], s41 offen offset:2048 sc1
  v_mov_b32 v173, v208
  v_mov_b32 v175, v209
  buffer_load_dwordx4 v[60:63], v3, s[4:7], s41 offen offset:3072 sc1
  v_mov_b32 v177, v210
  v_mov_b32 v179, v211
  s_waitcnt vmcnt(3)
  v_max3_u32 v31, v48, v49, v50
  v_max_u32 v31, v31, v51
  v_cmp_eq_u32 vcc, -1, v31
  s_cbranch_vccnz SL_m_f0
  v_smfmac_f32_16x16x64_bf16 v[64:67], v[48:51], a[0:7], v23
  s_waitcnt vmcnt(2)
  v_max3_u32 v31, v52, v53, v54
  v_max_u32 v31, v31, v55
  v_cmp_eq_u32 vcc, -1, v31
  v_smfmac_f32_16x16x64_bf16 v[68:71], v[48:51], a[8:15], v23
  v_smfmac_f32_16x16x64_bf16 v[72:75], v[48:51], a[16:23], v23
  v_smfmac_f32_16x16x64_bf16 v[76:79], v[48:51], a[24:31], v23
  v_smfmac_f32_16x16x64_bf16 v[80:83], v[48:51], a[32:39], v23
  v_smfmac_f32_16x16x64_bf16 v[84:87], v[48:51], a[40:47], v23
  s_cbranch_vccnz SL_m_f1
  v_smfmac_f32_16x16x64_bf16 v[64:67], v[52:55], a[48:55], v23
  s_waitcnt vmcnt(1)
  v_max3_u32 v31, v56, v57, v58
  v_max_u32 v31, v31, v59
  v_cmp_eq_u32 vcc, -1, v31
  v_smfmac_f32_16x16x64_bf16 v[68:71], v[52:55], a[56:63], v23
  v_smfmac_f32_16x16x64_bf16 v[72:75], v[52:55], a[64:71], v23
  v_smfmac_f32_16x16x64_bf16 v[76:79], v[52:55], a[72:79], v23
  v_smfmac_f32_16x16x64_bf16 v[80:83], v[52:55], a[80:87], v23
  v_smfmac_f32_16x16x64_bf16 v[84:87], v[52:55], a[88:95], v23
  s_cbranch_vccnz SL_m_f2
  v_smfmac_f32_16x16x64_bf16 v[64:67], v[56:59], a[96:103], v23
  s_waitcnt vmcnt(0)
  v_max3_u32 v31, v60, v61, v62
  v_max_u32 v31, v31, v63
  v_cmp_eq_u32 vcc, -1, v31
  v_smfmac_f32_16x16x64_bf16 v[68:71], v[56:59], a[104:111], v23
  v_smfmac_f32_16x16x64_bf16 v[72:75], v[56:59], a[112:119], v23
  v_smfmac_f32_16x16x64_bf16 v[76:79], v[56:59], a[120:127], v23
  v_smfmac_f32_16x16x64_bf16 v[80:83], v[56:59], a[128:135], v23
  v_smfmac_f32_16x16x64_bf16 v[84:87], v[56:59], a[136:143], v23
  s_cbranch_vccnz SL_m_f3
  v_smfmac_f32_16x16x64_bf16 v[64:67], v[60:63], a[144:151], v23
  v_smfmac_f32_16x16x64_bf16 v[68:71], v[60:63], a[152:159], v23
  v_smfmac_f32_16x16x64_bf16 v[72:75], v[60:63], a[160:167], v23
  v_smfmac_f32_16x16x64_bf16 v[76:79], v[60:63], a[168:175], v23
  v_smfmac_f32_16x16x64_bf16 v[80:83], v[60:63], a[176:183], v23
  v_smfmac_f32_16x16x64_bf16 v[84:87], v[60:63], a[184:191], v23
SL_m_done:
  s_nop 2
  v_pk_add_f32 v[88:89], v[64:65], v[66:67]
  v_pk_add_f32 v[90:91], v[68:69], v[70:71]
  ds_write_b128 v4, v[88:91] offset:0
  v_pk_add_f32 v[92:93], v[72:73], v[74:75]
  v_pk_add_f32 v[94:95], v[76:77], v[78:79]
  ds_write_b128 v4, v[92:95] offset:1088
  v_pk_add_f32 v[96:97], v[80:81], v[82:83]
  v_pk_add_f32 v[98:99], v[84:85], v[86:87]
  ds_write_b128 v4, v[96:99] offset:2176
  buffer_load_dwordx4 v[180:183], v12, s[4:7], s44 offen offset:0
  buffer_load_dwordx4 v[184:187], v12, s[4:7], s44 offen offset:128
  buffer_load_dwordx4 v[188:191], v12, s[4:7], s44 offen offset:1024
  v_mov_b64 v[36:37], 0
  v_mov_b64 v[38:39], 0
  v_mov_b64 v[40:41], 0
  v_mov_b64 v[42:43], 0
  v_mov_b64 v[44:45], 0
  v_mov_b64 v[46:47], 0
  s_waitcnt lgkmcnt(0)
  s_barrier
  ds_read2_b32 v[100:101], v6 offset0:0 offset1:2
  ds_read2_b32 v[102:103], v240 offset0:0 offset1:2
  ds_read2_b32 v[104:105], v241 offset0:0 offset1:2
  ds_read2_b32 v[106:107], v242 offset0:0 offset1:2
  ds_read_b64 v[88:89], v5 offset:0
  ds_read_b64 v[90:91], v5 offset:3264
  ds_read_b64 v[92:93], v5 offset:6528
  ds_read_b64 v[94:95], v5 offset:9792
  s_waitcnt lgkmcnt(6)
  v_pk_add_f32 v[100:101], v[100:101], v[102:103]
  s_waitcnt lgkmcnt(4)
  v_pk_add_f32 v[104:105], v[104:105], v[106:107]
  v_pk_add_f32 v[100:101], v[100:101], v[104:105]
  v_cvt_pk_bf16_f32 v112, v100, v101
  v_min_u32 v112, s54, v112
  buffer_store_dword v112, v7, s[4:7], s41 offen sc1
  s_waitcnt lgkmcnt(2)
  v_pk_add_f32 v[88:89], v[88:89], v[90:91]
  s_waitcnt lgkmcnt(0)
  v_pk_add_f32 v[92:93], v[92:93], v[94:95]
  v_pk_add_f32 v[88:89], v[88:89], v[92:93]
  v_cvt_pk_bf16_f32 v113, v88, v89
  v_min_u32 v113, s54, v113
  buffer_store_dword v113, v8, s[4:7], s41 offen sc1
  v_mov_b64 v[212:213], 0
  v_mov_b64 v[214:215], 0
  v_mov_b64 v[216:217], 0
  v_mov_b64 v[218:219], 0
  v_mov_b64 v[220:221], 0
  v_mov_b64 v[222:223], 0
  v_mov_b64 v[224:225], 0
  v_mov_b64 v[226:227], 0
  v_mov_b64 v[228:229], 0
  v_mov_b64 v[230:231], 0
  buffer_load_dwordx4 v[64:67], v9, s[4:7], s41 offen offset:0 sc1
  s_mov_b32 s42, s41
  s_add_u32 s90, s40, 1
  buffer_load_dwordx4 v[68:71], v9, s[4:7], s41 offen offset:1024 sc1
  s_and_b32 s90, s90, 3
  s_lshl_b32 s90, s90, 19
  buffer_load_dwordx4 v[72:75], v9, s[4:7], s41 offen offset:2048 sc1
  s_add_u32 s91, s90, 0x3800000
  s_add_u32 s55, s55, 0x40000
  buffer_load_dwordx4 v[76:79], v9, s[4:7], s41 offen offset:3072 sc1
  s_min_u32 s55, s55, 0xfc0000
  s_nop 0
  s_cmp_eq_u32 s40, 63
  s_cbranch_scc1 SL_last
  s_waitcnt vmcnt(3)
  v_max3_u32 v31, v64, v65, v66
  v_max_u32 v31, v31, v67
  v_cmp_eq_u32 vcc, -1, v31
  s_cbranch_vccnz SL_x_f0
  v_mfma_f32_16x16x32_bf16 v[44:47], v[64:67], v[64:67], v[44:47]
  s_waitcnt vmcnt(2)
  v_max3_u32 v31, v68, v69, v70
  v_max_u32 v31, v31, v71
  v_cmp_eq_u32 vcc, -1, v31
  v_mfma_f32_16x16x32_bf16 v[36:39], v[116:119], v[64:67], v[36:39]
  v_mfma_f32_16x16x32_bf16 v[40:43], v[132:135], v[64:67], v[40:43]
  s_cbranch_vccnz SL_x_f1
  v_mfma_f32_16x16x32_bf16 v[44:47], v[68:71], v[68:71], v[44:47]
  s_waitcnt vmcnt(1)
  v_max3_u32 v31, v72, v73, v74
  v_max_u32 v31, v31, v75
  v_cmp_eq_u32 vcc, -1, v31
  v_mfma_f32_16x16x32_bf16 v[36:39], v[120:123], v[68:71], v[36:39]
  v_mfma_f32_16x16x32_bf16 v[40:43], v[136:139], v[68:71], v[40:43]
  s_cbranch_vccnz SL_x_f2
  v_mfma_f32_16x16x32_bf16 v[44:47], v[72:75], v[72:75], v[44:47]
  s_waitcnt vmcnt(0)
  v_max3_u32 v31, v76, v77, v78
  v_max_u32 v31, v31, v79
  v_cmp_eq_u32 vcc, -1, v31
  v_mfma_f32_16x16x32_bf16 v[36:39], v[124:127], v[72:75], v[36:39]
  v_mfma_f32_16x16x32_bf16 v[40:43], v[140:143], v[72:75], v[40:43]
  s_cbranch_vccnz SL_x_f3
  v_mfma_f32_16x16x32_bf16 v[44:47], v[76:79], v[76:79], v[44:47]
  v_mfma_f32_16x16x32_bf16 v[36:39], v[128:131], v[76:79], v[36:39]
  v_mfma_f32_16x16x32_bf16 v[40:43], v[144:147], v[76:79], v[40:43]
SL_x_done:
  buffer_load_dwordx4 v[88:91], v10, s[4:7], s41 offen offset:0 sc1
  buffer_load_dwordx4 v[92:95], v10, s[4:7], s41 offen offset:1024 sc1
  s_mov_b64 vcc, s[48:49]
  s_nop 2
  v_max_f32 v30, v46, v47
  s_nop 0
  v_cndmask_b32_dpp v96, v40, v36, vcc quad_perm:[0,1,0,1] row_mask:0xf bank_mask:0xf
  v_cndmask_b32_dpp v97, v41, v37, vcc quad_perm:[0,1,0,1] row_mask:0xf bank_mask:0xf
  v_cndmask_b32_dpp v98, v42, v38, vcc quad_perm:[0,1,0,1] row_mask:0xf bank_mask:0xf
  v_cndmask_b32_dpp v99, v43, v39, vcc quad_perm:[0,1,0,1] row_mask:0xf bank_mask:0xf
  v_max3_f32 v29, v96, v97, v98
  s_nop 0
  v_max_f32_dpp v28, v30, v99 quad_perm:[0,1,0,1] row_mask:0xf bank_mask:0xf
  v_max_f32 v29, v29, v28
  s_nop 1
  v_max_f32_dpp v28, v29, v29 quad_perm:[2,3,0,1] row_mask:0xf bank_mask:0xf
  v_mov_b32 v29, v28
  s_nop 1
  v_permlane32_swap_b32 v28, v29
  v_max_f32 v28, v28, v29
  v_mov_b32 v29, v28
  s_nop 1
  v_permlane16_swap_b32 v28, v29
  v_max_f32 v28, v28, v29
  v_mul_f32 v28, s47, v28
  v_fma_f32 v96, v96, s47, -v28
  v_fma_f32 v97, v97, s47, -v28
  v_fma_f32 v98, v98, s47, -v28
  v_fma_f32 v99, v99, s47, -v28
  v_fma_f32 v46, v46, s47, -v28
  v_fma_f32 v47, v47, s47, -v28
  v_exp_f32 v96, v96
  v_exp_f32 v97, v97
  v_exp_f32 v98, v98
  v_exp_f32 v99, v99
  v_cvt_pk_bf16_f32 v236, v96, v97
  v_cvt_pk_bf16_f32 v237, v98, v99
  v_exp_f32 v46, v46
  v_mov_b32_dpp v100, v236 quad_perm:[0,1,0,1] row_mask:0xf bank_mask:0xf
  v_mov_b32_dpp v102, v236 quad_perm:[2,3,2,3] row_mask:0xf bank_mask:0xf
  v_mov_b32_dpp v101, v237 quad_perm:[0,1,0,1] row_mask:0xf bank_mask:0xf
  v_mov_b32_dpp v103, v237 quad_perm:[2,3,2,3] row_mask:0xf bank_mask:0xf
  v_exp_f32 v47, v47
  s_nop 0
  v_smfmac_f32_16x16x64_bf16 v[228:231], v[100:103], v[248:255], v23
  v_cvt_pk_bf16_f32 v238, v46, v47
  buffer_load_dwordx4 v[116:119], v11, s[4:7], s44 offen offset:0
  v_smfmac_f32_16x16x64_bf16 v[212:215], v[100:103], v[148:155], v23
  buffer_load_dwordx4 v[132:135], v11, s[4:7], s44 offen offset:64
  v_mov_b32_dpp v232, v238 quad_perm:[0,1,0,1] row_mask:0xf bank_mask:0xf
  v_smfmac_f32_16x16x64_bf16 v[216:219], v[100:103], v[156:163], v23
  buffer_load_dwordx4 v[120:123], v11, s[4:7], s44 offen offset:1024
  v_mov_b32_dpp v235, v238 quad_perm:[0,1,0,1] row_mask:0xf bank_mask:0xf
  v_smfmac_f32_16x16x64_bf16 v[220:223], v[100:103], v[164:171], v23
  buffer_load_dwordx4 v[136:139], v11, s[4:7], s44 offen offset:1088
  s_waitcnt vmcnt(4)
  v_max3_u32 v31, v88, v89, v90
  v_max3_u32 v31, v31, v91, v92
  v_smfmac_f32_16x16x32_bf16 v[228:231], v[232:233], v[248:251], v23
  v_max3_u32 v31, v31, v93, v94
  v_max_u32 v31, v31, v95
  v_cmp_eq_u32 vcc, -1, v31
  v_smfmac_f32_16x16x64_bf16 v[224:227], v[100:103], v[172:179], v23
  s_cbranch_vccnz SL_v_f
SL_v_ok:
  v_smfmac_f32_16x16x32_bf16 v[212:215], v[232:233], v[88:91], v23
  buffer_store_dword v22, v18, s[4:7], s43 offen sc1
  buffer_store_dword v22, v2, s[4:7], s43 offen sc1
  v_smfmac_f32_16x16x32_bf16 v[216:219], v[234:235], v[88:91], v23
  buffer_store_dword v22, v7, s[4:7], s43 offen sc1
  v_rcp_f32 v28, v228
  v_smfmac_f32_16x16x32_bf16 v[220:223], v[232:233], v[92:95], v23
  buffer_store_dword v22, v8, s[4:7], s43 offen sc1
  v_rcp_f32 v29, v229
  v_smfmac_f32_16x16x32_bf16 v[224:227], v[234:235], v[92:95], v23
  v_pk_mul_f32 v[212:213], v[212:213], v[28:29]
  v_pk_mul_f32 v[214:215], v[214:215], v[28:29]
  v_cvt_pk_bf16_f32 v104, v212, v214
  v_cvt_pk_bf16_f32 v108, v213, v215
  v_pk_mul_f32 v[216:217], v[216:217], v[28:29]
  v_pk_mul_f32 v[218:219], v[218:219], v[28:29]
  v_cvt_pk_bf16_f32 v105, v216, v218
  v_cvt_pk_bf16_f32 v109, v217, v219
  v_pk_mul_f32 v[220:221], v[220:221], v[28:29]
  v_pk_mul_f32 v[222:223], v[222:223], v[28:29]
  v_cvt_pk_bf16_f32 v106, v220, v222
  v_cvt_pk_bf16_f32 v110, v221, v223
  v_pk_mul_f32 v[224:225], v[224:225], v[28:29]
  v_pk_mul_f32 v[226:227], v[226:227], v[28:29]
  v_cvt_pk_bf16_f32 v107, v224, v226
  v_cvt_pk_bf16_f32 v111, v225, v227
  ds_write_b128 v14, v[104:107]
  ds_write_b128 v15, v[108:111]
  s_add_u32 s92, s40, 3
  s_min_u32 s92, s92, 63
  s_lshr_b32 s92, s92, 3
  s_lshl_b32 s92, s92, 2
  s_max_u32 s93, s40, 1
  s_sub_u32 s93, s93, 1
  v_mov_b32 v246, s93
  s_waitcnt lgkmcnt(0)
  s_barrier
  ds_read_b128 v[48:51], v16 offset:0
  ds_read_b128 v[52:55], v16 offset:1024
  ds_read_b128 v[56:59], v16 offset:2048
  ds_read_b128 v[60:63], v16 offset:3072
  ds_read_b128 v[64:67], v16 offset:4096
  buffer_load_dword v0, v21, s[4:7], s55 offen
  buffer_store_dword v22, v17, s[4:7], s43 offen sc1
  s_waitcnt lgkmcnt(4)
  v_smfmac_f32_16x16x64_bf16 v[32:35], v[48:51], a[192:199], v23
  ds_read_b128 v[68:71], v16 offset:5120
  buffer_store_dword v112, v19, s[4:7], s45 offen sc1
  s_waitcnt lgkmcnt(4)
  v_smfmac_f32_16x16x64_bf16 v[32:35], v[52:55], a[200:207], v23
  ds_read_b128 v[72:75], v16 offset:6144
  buffer_store_dword v113, v20, s[4:7], s45 offen sc1
  s_waitcnt lgkmcnt(4)
  v_smfmac_f32_16x16x64_bf16 v[32:35], v[56:59], a[208:215], v23
  ds_read_b128 v[76:79], v16 offset:7168
  buffer_store_dword v246, v245, s[28:31], 0 offen sc1
  s_waitcnt lgkmcnt(4)
  v_smfmac_f32_16x16x64_bf16 v[32:35], v[60:63], a[216:223], v23
  buffer_load_dword v243, v244, s[28:31], s92 offen offset:64 sc1
  s_waitcnt lgkmcnt(3)
  v_smfmac_f32_16x16x64_bf16 v[32:35], v[64:67], a[224:231], v23
  s_add_u32 s40, s40, 1
  s_waitcnt lgkmcnt(2)
  v_smfmac_f32_16x16x64_bf16 v[32:35], v[68:71], a[232:239], v23
  s_mov_b32 s41, s91
  s_waitcnt lgkmcnt(1)
  v_smfmac_f32_16x16x64_bf16 v[32:35], v[72:75], a[240:247], v23
  s_xor_b32 s43, s91, 0x100000
  s_waitcnt lgkmcnt(0)
  v_smfmac_f32_16x16x64_bf16 v[32:35], v[76:79], a[248:255], v23
  s_nop 7
  v_pk_add_f32 v[28:29], v[32:33], v[34:35]
  v_cvt_pk_bf16_f32 v28, v28, v29
  v_min_u32 v28, s54, v28
  buffer_store_dword v28, v17, s[4:7], s42 offen sc1
  buffer_store_dword v28, v18, s[4:7], s42 offen sc1
  s_branch SL_step
SL_last:
  buffer_store_dword v112, v19, s[4:7], s45 offen sc1
  buffer_store_dword v113, v20, s[4:7], s45 offen sc1
  s_waitcnt vmcnt(0)
  s_barrier
  s_cmp_lg_u32 s32, 0
  s_cbranch_scc1 SL_sig_4
  v_mov_b32 v254, 1
  v_mov_b32 v255, 0
  s_mov_b64 exec, 1
  buffer_atomic_add v254, v255, s[28:31], 0 offen offset:44 sc1
  s_mov_b64 exec, -1
SL_sig_4:
  s_waitcnt vmcnt(0)
  s_branch L_exit
SL_kv_f:
  s_sleep 8
  buffer_load_dword v243, v244, s[28:31], s92 offen offset:64 sc1
  s_add_u32 s46, s46, 1
  s_cmp_ge_u32 s46, 2097152
  s_cbranch_scc1 SL_rec_abort
  s_waitcnt vmcnt(0)
  s_branch SL_kv_chk
SL_g_f:
  s_mov_b64 exec, vcc
  buffer_load_dwordx4 v[36:39], v1, s[4:7], s42 offen sc1
  s_mov_b64 exec, -1
  s_add_u32 s46, s46, 1
  s_cmp_ge_u32 s46, 2097152
  s_cbranch_scc1 SL_rec_abort
  s_waitcnt vmcnt(0)
  s_branch SL_g_chk
SL_m_f0:
  s_mov_b64 exec, vcc
  buffer_load_dwordx4 v[48:51], v3, s[4:7], s41 offen offset:0 sc1
  s_mov_b64 exec, -1
  s_waitcnt vmcnt(1)
  s_branch SL_m_0123_c1
SL_m_f1:
  s_mov_b64 exec, vcc
  buffer_load_dwordx4 v[52:55], v3, s[4:7], s41 offen offset:1024 sc1
  s_mov_b64 exec, -1
  s_waitcnt vmcnt(1)
  s_branch SL_m_123_c2
SL_m_f2:
  s_mov_b64 exec, vcc
  buffer_load_dwordx4 v[56:59], v3, s[4:7], s41 offen offset:2048 sc1
  s_mov_b64 exec, -1
  s_waitcnt vmcnt(1)
  s_branch SL_m_23_c3
SL_m_f3:
  s_mov_b64 exec, vcc
  buffer_load_dwordx4 v[60:63], v3, s[4:7], s41 offen offset:3072 sc1
  s_mov_b64 exec, -1
  s_nop 7
  s_branch SL_m_3_c3
SL_m_0_c0:
  v_max3_u32 v31, v48, v49, v50
  v_max_u32 v31, v31, v51
  v_cmp_eq_u32 vcc, -1, v31
  s_cbranch_vccz SL_m_0_ok0
SL_m_0_x0:
  s_mov_b64 exec, vcc
  buffer_load_dwordx4 v[48:51], v3, s[4:7], s41 offen offset:0 sc1
  s_mov_b64 exec, -1
  s_add_u32 s46, s46, 1
  s_cmp_ge_u32 s46, 2097152
  s_cbranch_scc1 SL_rec_abort
  s_waitcnt vmcnt(2)
  s_branch SL_m_0_c0
SL_m_0_ok0:
  v_smfmac_f32_16x16x64_bf16 v[64:67], v[48:51], a[0:7], v23
  v_smfmac_f32_16x16x64_bf16 v[68:71], v[48:51], a[8:15], v23
  v_smfmac_f32_16x16x64_bf16 v[72:75], v[48:51], a[16:23], v23
  v_smfmac_f32_16x16x64_bf16 v[76:79], v[48:51], a[24:31], v23
  v_smfmac_f32_16x16x64_bf16 v[80:83], v[48:51], a[32:39], v23
  v_smfmac_f32_16x16x64_bf16 v[84:87], v[48:51], a[40:47], v23
  s_branch SL_m_done
SL_m_1_c1:
  v_max3_u32 v31, v52, v53, v54
  v_max_u32 v31, v31, v55
  v_cmp_eq_u32 vcc, -1, v31
  s_cbranch_vccz SL_m_1_ok1
SL_m_1_x1:
  s_mov_b64 exec, vcc
  buffer_load_dwordx4 v[52:55], v3, s[4:7], s41 offen offset:1024 sc1
  s_mov_b64 exec, -1
  s_add_u32 s46, s46, 1
  s_cmp_ge_u32 s46, 2097152
  s_cbranch_scc1 SL_rec_abort
  s_waitcnt vmcnt(2)
  s_branch SL_m_1_c1
SL_m_1_ok1:
  v_smfmac_f32_16x16x64_bf16 v[64:67], v[52:55], a[48:55], v23
  v_smfmac_f32_16x16x64_bf16 v[68:71], v[52:55], a[56:63], v23
  v_smfmac_f32_16x16x64_bf16 v[72:75], v[52:55], a[64:71], v23
  v_smfmac_f32_16x16x64_bf16 v[76:79], v[52:55], a[72:79], v23
  v_smfmac_f32_16x16x64_bf16 v[80:83], v[52:55], a[80:87], v23
  v_smfmac_f32_16x16x64_bf16 v[84:87], v[52:55], a[88:95], v23
  s_branch SL_m_done
SL_m_2_c2:
  v_max3_u32 v31, v56, v57, v58
  v_max_u32 v31, v31, v59
  v_cmp_eq_u32 vcc, -1, v31
  s_cbranch_vccz SL_m_2_ok2
SL_m_2_x2:
  s_mov_b64 exec, vcc
  buffer_load_dwordx4 v[56:59], v3, s[4:7], s41 offen offset:2048 sc1
  s_mov_b64 exec, -1
  s_add_u32 s46, s46, 1
  s_cmp_ge_u32 s46, 2097152
  s_cbranch_scc1 SL_rec_abort
  s_waitcnt vmcnt(2)
  s_branch SL_m_2_c2
SL_m_2_ok2:
  v_smfmac_f32_16x16x64_bf16 v[64:67], v[56:59], a[96:103], v23
  v_smfmac_f32_16x16x64_bf16 v[68:71], v[56:59], a[104:111], v23
  v_smfmac_f32_16x16x64_bf16 v[72:75], v[56:59], a[112:119], v23
  v_smfmac_f32_16x16x64_bf16 v[76:79], v[56:59], a[120:127], v23
  v_smfmac_f32_16x16x64_bf16 v[80:83], v[56:59], a[128:135], v23
  v_smfmac_f32_16x16x64_bf16 v[84:87], v[56:59], a[136:143], v23
  s_branch SL_m_done
SL_m_3_c3:
  v_max3_u32 v31, v60, v61, v62
  v_max_u32 v31, v31, v63
  v_cmp_eq_u32 vcc, -1, v31
  s_cbranch_vccz SL_m_3_ok3
SL_m_3_x3:
  s_mov_b64 exec, vcc
  buffer_load_dwordx4 v[60:63], v3, s[4:7], s41 offen offset:3072 sc1
  s_mov_b64 exec, -1
  s_add_u32 s46, s46, 1
  s_cmp_ge_u32 s46, 2097152
  s_cbranch_scc1 SL_rec_abort
  s_waitcnt vmcnt(2)
  s_branch SL_m_3_c3
SL_m_3_ok3:
  v_smfmac_f32_16x16x64_bf16 v[64:67], v[60:63], a[144:151], v23
  v_smfmac_f32_16x16x64_bf16 v[68:71], v[60:63], a[152:159], v23
  v_smfmac_f32_16x16x64_bf16 v[72:75], v[60:63], a[160:167], v23
  v_smfmac_f32_16x16x64_bf16 v[76:79], v[60:63], a[168:175], v23
  v_smfmac_f32_16x16x64_bf16 v[80:83], v[60:63], a[176:183], v23
  v_smfmac_f32_16x16x64_bf16 v[84:87], v[60:63], a[184:191], v23
  s_branch SL_m_done
SL_m_01_c0:
  v_max3_u32 v31, v48, v49, v50
  v_max_u32 v31, v31, v51
  v_cmp_eq_u32 vcc, -1, v31
  s_cbranch_vccz SL_m_01_ok0
SL_m_01_x0:
  s_mov_b64 exec, vcc
  buffer_load_dwordx4 v[48:51], v3, s[4:7], s41 offen offset:0 sc1
  s_mov_b64 exec, -1
SL_m_01_c1:
  v_max3_u32 v31, v52, v53, v54
  v_max_u32 v31, v31, v55
  v_cmp_eq_u32 vcc, -1, v31
  s_cbranch_vccz SL_m_01_ok1
SL_m_01_x1:
  s_mov_b64 exec, vcc
  buffer_load_dwordx4 v[52:55], v3, s[4:7], s41 offen offset:1024 sc1
  s_mov_b64 exec, -1
  s_add_u32 s46, s46, 1
  s_cmp_ge_u32 s46, 2097152
  s_cbranch_scc1 SL_rec_abort
  s_waitcnt vmcnt(4)
  s_branch SL_m_01_c0
SL_m_01_ok0:
  v_smfmac_f32_16x16x64_bf16 v[64:67], v[48:51], a[0:7], v23
  v_max3_u32 v31, v52, v53, v54
  v_max_u32 v31, v31, v55
  v_cmp_eq_u32 vcc, -1, v31
  v_smfmac_f32_16x16x64_bf16 v[68:71], v[48:51], a[8:15], v23
  v_smfmac_f32_16x16x64_bf16 v[72:75], v[48:51], a[16:23], v23
  v_smfmac_f32_16x16x64_bf16 v[76:79], v[48:51], a[24:31], v23
  v_smfmac_f32_16x16x64_bf16 v[80:83], v[48:51], a[32:39], v23
  v_smfmac_f32_16x16x64_bf16 v[84:87], v[48:51], a[40:47], v23
  s_cbranch_vccz SL_m_1_ok1
  s_branch SL_m_1_x1
SL_m_01_ok1:
  v_smfmac_f32_16x16x64_bf16 v[64:67], v[52:55], a[48:55], v23
  v_max3_u32 v31, v48, v49, v50
  v_max_u32 v31, v31, v51
  v_cmp_eq_u32 vcc, -1, v31
  v_smfmac_f32_16x16x64_bf16 v[68:71], v[52:55], a[56:63], v23
  v_smfmac_f32_16x16x64_bf16 v[72:75], v[52:55], a[64:71], v23
  v_smfmac_f32_16x16x64_bf16 v[76:79], v[52:55], a[72:79], v23
  v_smfmac_f32_16x16x64_bf16 v[80:83], v[52:55], a[80:87], v23
  v_smfmac_f32_16x16x64_bf16 v[84:87], v[52:55], a[88:95], v23
  s_cbranch_vccz SL_m_0_ok0
  s_branch SL_m_0_x0
SL_m_02_c0:
  v_max3_u32 v31, v48, v49, v50
  v_max_u32 v31, v31, v51
  v_cmp_eq_u32 vcc, -1, v31
  s_cbranch_vccz SL_m_02_ok0
SL_m_02_x0:
  s_mov_b64 exec, vcc
  buffer_load_dwordx4 v[48:51], v3, s[4:7], s41 offen offset:0 sc1
  s_mov_b64 exec, -1
SL_m_02_c2:
  v_max3_u32 v31, v56, v57, v58
  v_max_u32 v31, v31, v59
  v_cmp_eq_u32 vcc, -1, v31
  s_cbranch_vccz SL_m_02_ok2
SL_m_02_x2:
  s_mov_b64 exec, vcc
  buffer_load_dwordx4 v[56:59], v3, s[4:7], s41 offen offset:2048 sc1
  s_mov_b64 exec, -1
  s_add_u32 s46, s46, 1
  s_cmp_ge_u32 s46, 2097152
  s_cbranch_scc1 SL_rec_abort
  s_waitcnt vmcnt(4)
  s_branch SL_m_02_c0
SL_m_02_ok0:
  v_smfmac_f32_16x16x64_bf16 v[64:67], v[48:51], a[0:7], v23
  v_max3_u32 v31, v56, v57, v58
  v_max_u32 v31, v31, v59
  v_cmp_eq_u32 vcc, -1, v31
  v_smfmac_f32_16x16x64_bf16 v[68:71], v[48:51], a[8:15], v23
  v_smfmac_f32_16x16x64_bf16 v[72:75], v[48:51], a[16:23], v23
  v_smfmac_f32_16x16x64_bf16 v[76:79], v[48:51], a[24:31], v23
  v_smfmac_f32_16x16x64_bf16 v[80:83], v[48:51], a[32:39], v23
  v_smfmac_f32_16x16x64_bf16 v[84:87], v[48:51], a[40:47], v23
  s_cbranch_vccz SL_m_2_ok2
  s_branch SL_m_2_x2
SL_m_02_ok2:
  v_smfmac_f32_16x16x64_bf16 v[64:67], v[56:59], a[96:103], v23
  v_max3_u32 v31, v48, v49, v50
  v_max_u32 v31, v31, v51
  v_cmp_eq_u32 vcc, -1, v31
  v_smfmac_f32_16x16x64_bf16 v[68:71], v[56:59], a[104:111], v23
  v_smfmac_f32_16x16x64_bf16 v[72:75], v[56:59], a[112:119], v23
  v_smfmac_f32_16x16x64_bf16 v[76:79], v[56:59], a[120:127], v23
  v_smfmac_f32_16x16x64_bf16 v[80:83], v[56:59], a[128:135], v23
  v_smfmac_f32_16x16x64_bf16 v[84:87], v[56:59], a[136:143], v23
  s_cbranch_vccz SL_m_0_ok0
  s_branch SL_m_0_x0
SL_m_03_c0:
  v_max3_u32 v31, v48, v49, v50
  v_max_u32 v31, v31, v51
  v_cmp_eq_u32 vcc, -1, v31
  s_cbranch_vccz SL_m_03_ok0
SL_m_03_x0:
  s_mov_b64 exec, vcc
  buffer_load_dwordx4 v[48:51], v3, s[4:7], s41 offen offset:0 sc1
  s_mov_b64 exec, -1
SL_m_03_c3:
  v_max3_u32 v31, v60, v61, v62
  v_max_u32 v31, v31, v63
  v_cmp_eq_u32 vcc, -1, v31
  s_cbranch_vccz SL_m_03_ok3
SL_m_03_x3:
  s_mov_b64 exec, vcc
  buffer_load_dwordx4 v[60:63], v3, s[4:7], s41 offen offset:3072 sc1
  s_mov_b64 exec, -1
  s_add_u32 s46, s46, 1
  s_cmp_ge_u32 s46, 2097152
  s_cbranch_scc1 SL_rec_abort
  s_waitcnt vmcnt(4)
  s_branch SL_m_03_c0
SL_m_03_ok0:
  v_smfmac_f32_16x16x64_bf16 v[64:67], v[48:51], a[0:7], v23
  v_max3_u32 v31, v60, v61, v62
  v_max_u32 v31, v31, v63
  v_cmp_eq_u32 vcc, -1, v31
  v_smfmac_f32_16x16x64_bf16 v[68:71], v[48:51], a[8:15], v23
  v_smfmac_f32_16x16x64_bf16 v[72:75], v[48:51], a[16:23], v23
  v_smfmac_f32_16x16x64_bf16 v[76:79], v[48:51], a[24:31], v23
  v_smfmac_f32_16x16x64_bf16 v[80:83], v[48:51], a[32:39], v23
  v_smfmac_f32_16x16x64_bf16 v[84:87], v[48:51], a[40:47], v23
  s_cbranch_vccz SL_m_3_ok3
  s_branch SL_m_3_x3
SL_m_03_ok3:
  v_smfmac_f32_16x16x64_bf16 v[64:67], v[60:63], a[144:151], v23
  v_max3_u32 v31, v48, v49, v50
  v_max_u32 v31, v31, v51
  v_cmp_eq_u32 vcc, -1, v31
  v_smfmac_f32_16x16x64_bf16 v[68:71], v[60:63], a[152:159], v23
  v_smfmac_f32_16x16x64_bf16 v[72:75], v[60:63], a[160:167], v23
  v_smfmac_f32_16x16x64_bf16 v[76:79], v[60:63], a[168:175], v23
  v_smfmac_f32_16x16x64_bf16 v[80:83], v[60:63], a[176:183], v23
  v_smfmac_f32_16x16x64_bf16 v[84:87], v[60:63], a[184:191], v23
  s_cbranch_vccz SL_m_0_ok0
  s_branch SL_m_0_x0
SL_m_12_c1:
  v_max3_u32 v31, v52, v53, v54
  v_max_u32 v31, v31, v55
  v_cmp_eq_u32 vcc, -1, v31
  s_cbranch_vccz SL_m_12_ok1
SL_m_12_x1:
  s_mov_b64 exec, vcc
  buffer_load_dwordx4 v[52:55], v3, s[4:7], s41 offen offset:1024 sc1
  s_mov_b64 exec, -1
SL_m_12_c2:
  v_max3_u32 v31, v56, v57, v58
  v_max_u32 v31, v31, v59
  v_cmp_eq_u32 vcc, -1, v31
  s_cbranch_vccz SL_m_12_ok2
SL_m_12_x2:
  s_mov_b64 exec, vcc
  buffer_load_dwordx4 v[56:59], v3, s[4:7], s41 offen offset:2048 sc1
  s_mov_b64 exec, -1
  s_add_u32 s46, s46, 1
  s_cmp_ge_u32 s46, 2097152
  s_cbranch_scc1 SL_rec_abort
  s_waitcnt vmcnt(4)
  s_branch SL_m_12_c1
SL_m_12_ok1:
  v_smfmac_f32_16x16x64_bf16 v[64:67], v[52:55], a[48:55], v23
  v_max3_u32 v31, v56, v57, v58
  v_max_u32 v31, v31, v59
  v_cmp_eq_u32 vcc, -1, v31
  v_smfmac_f32_16x16x64_bf16 v[68:71], v[52:55], a[56:63], v23
  v_smfmac_f32_16x16x64_bf16 v[72:75], v[52:55], a[64:71], v23
  v_smfmac_f32_16x16x64_bf16 v[76:79], v[52:55], a[72:79], v23
  v_smfmac_f32_16x16x64_bf16 v[80:83], v[52:55], a[80:87], v23
  v_smfmac_f32_16x16x64_bf16 v[84:87], v[52:55], a[88:95], v23
  s_cbranch_vccz SL_m_2_ok2
  s_branch SL_m_2_x2
SL_m_12_ok2:
  v_smfmac_f32_16x16x64_bf16 v[64:67], v[56:59], a[96:103], v23
  v_max3_u32 v31, v52, v53, v54
  v_max_u32 v31, v31, v55
  v_cmp_eq_u32 vcc, -1, v31
  v_smfmac_f32_16x16x64_bf16 v[68:71], v[56:59], a[104:111], v23
  v_smfmac_f32_16x16x64_bf16 v[72:75], v[56:59], a[112:119], v23
  v_smfmac_f32_16x16x64_bf16 v[76:79], v[56:59], a[120:127], v23
  v_smfmac_f32_16x16x64_bf16 v[80:83], v[56:59], a[128:135], v23
  v_smfmac_f32_16x16x64_bf16 v[84:87], v[56:59], a[136:143], v23
  s_cbranch_vccz SL_m_1_ok1
  s_branch SL_m_1_x1
SL_m_13_c1:
  v_max3_u32 v31, v52, v53, v54
  v_max_u32 v31, v31, v55
  v_cmp_eq_u32 vcc, -1, v31
  s_cbranch_vccz SL_m_13_ok1
SL_m_13_x1:
  s_mov_b64 exec, vcc
  buffer_load_dwordx4 v[52:55], v3, s[4:7], s41 offen offset:1024 sc1
  s_mov_b64 exec, -1
SL_m_13_c3:
  v_max3_u32 v31, v60, v61, v62
  v_max_u32 v31, v31, v63
  v_cmp_eq_u32 vcc, -1, v31
  s_cbranch_vccz SL_m_13_ok3
SL_m_13_x3:
  s_mov_b64 exec, vcc
  buffer_load_dwordx4 v[60:63], v3, s[4:7], s41 offen offset:3072 sc1
  s_mov_b64 exec, -1
  s_add_u32 s46, s46, 1
  s_cmp_ge_u32 s46, 2097152
  s_cbranch_scc1 SL_rec_abort
  s_waitcnt vmcnt(4)
  s_branch SL_m_13_c1
SL_m_13_ok1:
  v_smfmac_f32_16x16x64_bf16 v[64:67], v[52:55], a[48:55], v23
  v_max3_u32 v31, v60, v61, v62
  v_max_u32 v31, v31, v63
  v_cmp_eq_u32 vcc, -1, v31
  v_smfmac_f32_16x16x64_bf16 v[68:71], v[52:55], a[56:63], v23
  v_smfmac_f32_16x16x64_bf16 v[72:75], v[52:55], a[64:71], v23
  v_smfmac_f32_16x16x64_bf16 v[76:79], v[52:55], a[72:79], v23
  v_smfmac_f32_16x16x64_bf16 v[80:83], v[52:55], a[80:87], v23
  v_smfmac_f32_16x16x64_bf16 v[84:87], v[52:55], a[88:95], v23
  s_cbranch_vccz SL_m_3_ok3
  s_branch SL_m_3_x3
SL_m_13_ok3:
  v_smfmac_f32_16x16x64_bf16 v[64:67], v[60:63], a[144:151], v23
  v_max3_u32 v31, v52, v53, v54
  v_max_u32 v31, v31, v55
  v_cmp_eq_u32 vcc, -1, v31
  v_smfmac_f32_16x16x64_bf16 v[68:71], v[60:63], a[152:159], v23
  v_smfmac_f32_16x16x64_bf16 v[72:75], v[60:63], a[160:167], v23
  v_smfmac_f32_16x16x64_bf16 v[76:79], v[60:63], a[168:175], v23
  v_smfmac_f32_16x16x64_bf16 v[80:83], v[60:63], a[176:183], v23
  v_smfmac_f32_16x16x64_bf16 v[84:87], v[60:63], a[184:191], v23
  s_cbranch_vccz SL_m_1_ok1
  s_branch SL_m_1_x1
SL_m_23_c2:
  v_max3_u32 v31, v56, v57, v58
  v_max_u32 v31, v31, v59
  v_cmp_eq_u32 vcc, -1, v31
  s_cbranch_vccz SL_m_23_ok2
SL_m_23_x2:
  s_mov_b64 exec, vcc
  buffer_load_dwordx4 v[56:59], v3, s[4:7], s41 offen offset:2048 sc1
  s_mov_b64 exec, -1
SL_m_23_c3:
  v_max3_u32 v31, v60, v61, v62
  v_max_u32 v31, v31, v63
  v_cmp_eq_u32 vcc, -1, v31
  s_cbranch_vccz SL_m_23_ok3
SL_m_23_x3:
  s_mov_b64 exec, vcc
  buffer_load_dwordx4 v[60:63], v3, s[4:7], s41 offen offset:3072 sc1
  s_mov_b64 exec, -1
  s_add_u32 s46, s46, 1
  s_cmp_ge_u32 s46, 2097152
  s_cbranch_scc1 SL_rec_abort
  s_waitcnt vmcnt(4)
  s_branch SL_m_23_c2
SL_m_23_ok2:
  v_smfmac_f32_16x16x64_bf16 v[64:67], v[56:59], a[96:103], v23
  v_max3_u32 v31, v60, v61, v62
  v_max_u32 v31, v31, v63
  v_cmp_eq_u32 vcc, -1, v31
  v_smfmac_f32_16x16x64_bf16 v[68:71], v[56:59], a[104:111], v23
  v_smfmac_f32_16x16x64_bf16 v[72:75], v[56:59], a[112:119], v23
  v_smfmac_f32_16x16x64_bf16 v[76:79], v[56:59], a[120:127], v23
  v_smfmac_f32_16x16x64_bf16 v[80:83], v[56:59], a[128:135], v23
  v_smfmac_f32_16x16x64_bf16 v[84:87], v[56:59], a[136:143], v23
  s_cbranch_vccz SL_m_3_ok3
  s_branch SL_m_3_x3
SL_m_23_ok3:
  v_smfmac_f32_16x16x64_bf16 v[64:67], v[60:63], a[144:151], v23
  v_max3_u32 v31, v56, v57, v58
  v_max_u32 v31, v31, v59
  v_cmp_eq_u32 vcc, -1, v31
  v_smfmac_f32_16x16x64_bf16 v[68:71], v[60:63], a[152:159], v23
  v_smfmac_f32_16x16x64_bf16 v[72:75], v[60:63], a[160:167], v23
  v_smfmac_f32_16x16x64_bf16 v[76:79], v[60:63], a[168:175], v23
  v_smfmac_f32_16x16x64_bf16 v[80:83], v[60:63], a[176:183], v23
  v_smfmac_f32_16x16x64_bf16 v[84:87], v[60:63], a[184:191], v23
  s_cbranch_vccz SL_m_2_ok2
  s_branch SL_m_2_x2
SL_m_012_c0:
  v_max3_u32 v31, v48, v49, v50
  v_max_u32 v31, v31, v51
  v_cmp_eq_u32 vcc, -1, v31
  s_cbranch_vccz SL_m_012_ok0
SL_m_012_x0:
  s_mov_b64 exec, vcc
  buffer_load_dwordx4 v[48:51], v3, s[4:7], s41 offen offset:0 sc1
  s_mov_b64 exec, -1
SL_m_012_c1:
  v_max3_u32 v31, v52, v53, v54
  v_max_u32 v31, v31, v55
  v_cmp_eq_u32 vcc, -1, v31
  s_cbranch_vccz SL_m_012_ok1
SL_m_012_x1:
  s_mov_b64 exec, vcc
  buffer_load_dwordx4 v[52:55], v3, s[4:7], s41 offen offset:1024 sc1
  s_mov_b64 exec, -1
SL_m_012_c2:
  v_max3_u32 v31, v56, v57, v58
  v_max_u32 v31, v31, v59
  v_cmp_eq_u32 vcc, -1, v31
  s_cbranch_vccz SL_m_012_ok2
SL_m_012_x2:
  s_mov_b64 exec, vcc
  buffer_load_dwordx4 v[56:59], v3, s[4:7], s41 offen offset:2048 sc1
  s_mov_b64 exec, -1
  s_add_u32 s46, s46, 1
  s_cmp_ge_u32 s46, 2097152
  s_cbranch_scc1 SL_rec_abort
  s_waitcnt vmcnt(4)
  s_branch SL_m_012_c0
SL_m_012_ok0:
  v_smfmac_f32_16x16x64_bf16 v[64:67], v[48:51], a[0:7], v23
  v_max3_u32 v31, v52, v53, v54
  v_max_u32 v31, v31, v55
  v_cmp_eq_u32 vcc, -1, v31
  v_smfmac_f32_16x16x64_bf16 v[68:71], v[48:51], a[8:15], v23
  v_smfmac_f32_16x16x64_bf16 v[72:75], v[48:51], a[16:23], v23
  v_smfmac_f32_16x16x64_bf16 v[76:79], v[48:51], a[24:31], v23
  v_smfmac_f32_16x16x64_bf16 v[80:83], v[48:51], a[32:39], v23
  v_smfmac_f32_16x16x64_bf16 v[84:87], v[48:51], a[40:47], v23
  s_cbranch_vccz SL_m_12_ok1
  s_branch SL_m_12_x1
SL_m_012_ok1:
  v_smfmac_f32_16x16x64_bf16 v[64:67], v[52:55], a[48:55], v23
  v_max3_u32 v31, v56, v57, v58
  v_max_u32 v31, v31, v59
  v_cmp_eq_u32 vcc, -1, v31
  v_smfmac_f32_16x16x64_bf16 v[68:71], v[52:55], a[56:63], v23
  v_smfmac_f32_16x16x64_bf16 v[72:75], v[52:55], a[64:71], v23
  v_smfmac_f32_16x16x64_bf16 v[76:79], v[52:55], a[72:79], v23
  v_smfmac_f32_16x16x64_bf16 v[80:83], v[52:55], a[80:87], v23
  v_smfmac_f32_16x16x64_bf16 v[84:87], v[52:55], a[88:95], v23
  s_cbranch_vccz SL_m_02_ok2
  s_branch SL_m_02_x2
SL_m_012_ok2:
  v_smfmac_f32_16x16x64_bf16 v[64:67], v[56:59], a[96:103], v23
  v_max3_u32 v31, v48, v49, v50
  v_max_u32 v31, v31, v51
  v_cmp_eq_u32 vcc, -1, v31
  v_smfmac_f32_16x16x64_bf16 v[68:71], v[56:59], a[104:111], v23
  v_smfmac_f32_16x16x64_bf16 v[72:75], v[56:59], a[112:119], v23
  v_smfmac_f32_16x16x64_bf16 v[76:79], v[56:59], a[120:127], v23
  v_smfmac_f32_16x16x64_bf16 v[80:83], v[56:59], a[128:135], v23
  v_smfmac_f32_16x16x64_bf16 v[84:87], v[56:59], a[136:143], v23
  s_cbranch_vccz SL_m_01_ok0
  s_branch SL_m_01_x0
SL_m_013_c0:
  v_max3_u32 v31, v48, v49, v50
  v_max_u32 v31, v31, v51
  v_cmp_eq_u32 vcc, -1, v31
  s_cbranch_vccz SL_m_013_ok0
SL_m_013_x0:
  s_mov_b64 exec, vcc
  buffer_load_dwordx4 v[48:51], v3, s[4:7], s41 offen offset:0 sc1
  s_mov_b64 exec, -1
SL_m_013_c1:
  v_max3_u32 v31, v52, v53, v54
  v_max_u32 v31, v31, v55
  v_cmp_eq_u32 vcc, -1, v31
  s_cbranch_vccz SL_m_013_ok1
SL_m_013_x1:
  s_mov_b64 exec, vcc
  buffer_load_dwordx4 v[52:55], v3, s[4:7], s41 offen offset:1024 sc1
  s_mov_b64 exec, -1
SL_m_013_c3:
  v_max3_u32 v31, v60, v61, v62
  v_max_u32 v31, v31, v63
  v_cmp_eq_u32 vcc, -1, v31
  s_cbranch_vccz SL_m_013_ok3
SL_m_013_x3:
  s_mov_b64 exec, vcc
  buffer_load_dwordx4 v[60:63], v3, s[4:7], s41 offen offset:3072 sc1
  s_mov_b64 exec, -1
  s_add_u32 s46, s46, 1
  s_cmp_ge_u32 s46, 2097152
  s_cbranch_scc1 SL_rec_abort
  s_waitcnt vmcnt(4)
  s_branch SL_m_013_c0
SL_m_013_ok0:
  v_smfmac_f32_16x16x64_bf16 v[64:67], v[48:51], a[0:7], v23
  v_max3_u32 v31, v52, v53, v54
  v_max_u32 v31, v31, v55
  v_cmp_eq_u32 vcc, -1, v31
  v_smfmac_f32_16x16x64_bf16 v[68:71], v[48:51], a[8:15], v23
  v_smfmac_f32_16x16x64_bf16 v[72:75], v[48:51], a[16:23], v23
  v_smfmac_f32_16x16x64_bf16 v[76:79], v[48:51], a[24:31], v23
  v_smfmac_f32_16x16x64_bf16 v[80:83], v[48:51], a[32:39], v23
  v_smfmac_f32_16x16x64_bf16 v[84:87], v[48:51], a[40:47], v23
  s_cbranch_vccz SL_m_13_ok1
  s_branch SL_m_13_x1
SL_m_013_ok1:
  v_smfmac_f32_16x16x64_bf16 v[64:67], v[52:55], a[48:55], v23
  v_max3_u32 v31, v60, v61, v62
  v_max_u32 v31, v31, v63
  v_cmp_eq_u32 vcc, -1, v31
  v_smfmac_f32_16x16x64_bf16 v[68:71], v[52:55], a[56:63], v23
  v_smfmac_f32_16x16x64_bf16 v[72:75], v[52:55], a[64:71], v23
  v_smfmac_f32_16x16x64_bf16 v[76:79], v[52:55], a[72:79], v23
  v_smfmac_f32_16x16x64_bf16 v[80:83], v[52:55], a[80:87], v23
  v_smfmac_f32_16x16x64_bf16 v[84:87], v[52:55], a[88:95], v23
  s_cbranch_vccz SL_m_03_ok3
  s_branch SL_m_03_x3
SL_m_013_ok3:
  v_smfmac_f32_16x16x64_bf16 v[64:67], v[60:63], a[144:151], v23
  v_max3_u32 v31, v48, v49, v50
  v_max_u32 v31, v31, v51
  v_cmp_eq_u32 vcc, -1, v31
  v_smfmac_f32_16x16x64_bf16 v[68:71], v[60:63], a[152:159], v23
  v_smfmac_f32_16x16x64_bf16 v[72:75], v[60:63], a[160:167], v23
  v_smfmac_f32_16x16x64_bf16 v[76:79], v[60:63], a[168:175], v23
  v_smfmac_f32_16x16x64_bf16 v[80:83], v[60:63], a[176:183], v23
  v_smfmac_f32_16x16x64_bf16 v[84:87], v[60:63], a[184:191], v23
  s_cbranch_vccz SL_m_01_ok0
  s_branch SL_m_01_x0
SL_m_023_c0:
  v_max3_u32 v31, v48, v49, v50
  v_max_u32 v31, v31, v51
  v_cmp_eq_u32 vcc, -1, v31
  s_cbranch_vccz SL_m_023_ok0
SL_m_023_x0:
  s_mov_b64 exec, vcc
  buffer_load_dwordx4 v[48:51], v3, s[4:7], s41 offen offset:0 sc1
  s_mov_b64 exec, -1
SL_m_023_c2:
  v_max3_u32 v31, v56, v57, v58
  v_max_u32 v31, v31, v59
  v_cmp_eq_u32 vcc, -1, v31
  s_cbranch_vccz SL_m_023_ok2
SL_m_023_x2:
  s_mov_b64 exec, vcc
  buffer_load_dwordx4 v[56:59], v3, s[4:7], s41 offen offset:2048 sc1
  s_mov_b64 exec, -1
SL_m_023_c3:
  v_max3_u32 v31, v60, v61, v62
  v_max_u32 v31, v31, v63
  v_cmp_eq_u32 vcc, -1, v31
  s_cbranch_vccz SL_m_023_ok3
SL_m_023_x3:
  s_mov_b64 exec, vcc
  buffer_load_dwordx4 v[60:63], v3, s[4:7], s41 offen offset:3072 sc1
  s_mov_b64 exec, -1
  s_add_u32 s46, s46, 1
  s_cmp_ge_u32 s46, 2097152
  s_cbranch_scc1 SL_rec_abort
  s_waitcnt vmcnt(4)
  s_branch SL_m_023_c0
SL_m_023_ok0:
  v_smfmac_f32_16x16x64_bf16 v[64:67], v[48:51], a[0:7], v23
  v_max3_u32 v31, v56, v57, v58
  v_max_u32 v31, v31, v59
  v_cmp_eq_u32 vcc, -1, v31
  v_smfmac_f32_16x16x64_bf16 v[68:71], v[48:51], a[8:15], v23
  v_smfmac_f32_16x16x64_bf16 v[72:75], v[48:51], a[16:23], v23
  v_smfmac_f32_16x16x64_bf16 v[76:79], v[48:51], a[24:31], v23
  v_smfmac_f32_16x16x64_bf16 v[80:83], v[48:51], a[32:39], v23
  v_smfmac_f32_16x16x64_bf16 v[84:87], v[48:51], a[40:47], v23
  s_cbranch_vccz SL_m_23_ok2
  s_branch SL_m_23_x2
SL_m_023_ok2:
  v_smfmac_f32_16x16x64_bf16 v[64:67], v[56:59], a[96:103], v23
  v_max3_u32 v31, v60, v61, v62
  v_max_u32 v31, v31, v63
  v_cmp_eq_u32 vcc, -1, v31
  v_smfmac_f32_16x16x64_bf16 v[68:71], v[56:59], a[104:111], v23
  v_smfmac_f32_16x16x64_bf16 v[72:75], v[56:59], a[112:119], v23
  v_smfmac_f32_16x16x64_bf16 v[76:79], v[56:59], a[120:127], v23
  v_smfmac_f32_16x16x64_bf16 v[80:83], v[56:59], a[128:135], v23
  v_smfmac_f32_16x16x64_bf16 v[84:87], v[56:59], a[136:143], v23
  s_cbranch_vccz SL_m_03_ok3
  s_branch SL_m_03_x3
SL_m_023_ok3:
  v_smfmac_f32_16x16x64_bf16 v[64:67], v[60:63], a[144:151], v23
  v_max3_u32 v31, v48, v49, v50
  v_max_u32 v31, v31, v51
  v_cmp_eq_u32 vcc, -1, v31
  v_smfmac_f32_16x16x64_bf16 v[68:71], v[60:63], a[152:159], v23
  v_smfmac_f32_16x16x64_bf16 v[72:75], v[60:63], a[160:167], v23
  v_smfmac_f32_16x16x64_bf16 v[76:79], v[60:63], a[168:175], v23
  v_smfmac_f32_16x16x64_bf16 v[80:83], v[60:63], a[176:183], v23
  v_smfmac_f32_16x16x64_bf16 v[84:87], v[60:63], a[184:191], v23
  s_cbranch_vccz SL_m_02_ok0
  s_branch SL_m_02_x0
SL_m_123_c1:
  v_max3_u32 v31, v52, v53, v54
  v_max_u32 v31, v31, v55
  v_cmp_eq_u32 vcc, -1, v31
  s_cbranch_vccz SL_m_123_ok1
SL_m_123_x1:
  s_mov_b64 exec, vcc
  buffer_load_dwordx4 v[52:55], v3, s[4:7], s41 offen offset:1024 sc1
  s_mov_b64 exec, -1
SL_m_123_c2:
  v_max3_u32 v31, v56, v57, v58
  v_max_u32 v31, v31, v59
  v_cmp_eq_u32 vcc, -1, v31
  s_cbranch_vccz SL_m_123_ok2
SL_m_123_x2:
  s_mov_b64 exec, vcc
  buffer_load_dwordx4 v[56:59], v3, s[4:7], s41 offen offset:2048 sc1
  s_mov_b64 exec, -1
SL_m_123_c3:
  v_max3_u32 v31, v60, v61, v62
  v_max_u32 v31, v31, v63
  v_cmp_eq_u32 vcc, -1, v31
  s_cbranch_vccz SL_m_123_ok3
SL_m_123_x3:
  s_mov_b64 exec, vcc
  buffer_load_dwordx4 v[60:63], v3, s[4:7], s41 offen offset:3072 sc1
  s_mov_b64 exec, -1
  s_add_u32 s46, s46, 1
  s_cmp_ge_u32 s46, 2097152
  s_cbranch_scc1 SL_rec_abort
  s_waitcnt vmcnt(4)
  s_branch SL_m_123_c1
SL_m_123_ok1:
  v_smfmac_f32_16x16x64_bf16 v[64:67], v[52:55], a[48:55], v23
  v_max3_u32 v31, v56, v57, v58
  v_max_u32 v31, v31, v59
  v_cmp_eq_u32 vcc, -1, v31
  v_smfmac_f32_16x16x64_bf16 v[68:71], v[52:55], a[56:63], v23
  v_smfmac_f32_16x16x64_bf16 v[72:75], v[52:55], a[64:71], v23
  v_smfmac_f32_16x16x64_bf16 v[76:79], v[52:55], a[72:79], v23
  v_smfmac_f32_16x16x64_bf16 v[80:83], v[52:55], a[80:87], v23
  v_smfmac_f32_16x16x64_bf16 v[84:87], v[52:55], a[88:95], v23
  s_cbranch_vccz SL_m_23_ok2
  s_branch SL_m_23_x2
SL_m_123_ok2:
  v_smfmac_f32_16x16x64_bf16 v[64:67], v[56:59], a[96:103], v23
  v_max3_u32 v31, v60, v61, v62
  v_max_u32 v31, v31, v63
  v_cmp_eq_u32 vcc, -1, v31
  v_smfmac_f32_16x16x64_bf16 v[68:71], v[56:59], a[104:111], v23
  v_smfmac_f32_16x16x64_bf16 v[72:75], v[56:59], a[112:119], v23
  v_smfmac_f32_16x16x64_bf16 v[76:79], v[56:59], a[120:127], v23
  v_smfmac_f32_16x16x64_bf16 v[80:83], v[56:59], a[128:135], v23
  v_smfmac_f32_16x16x64_bf16 v[84:87], v[56:59], a[136:143], v23
  s_cbranch_vccz SL_m_13_ok3
  s_branch SL_m_13_x3
SL_m_123_ok3:
  v_smfmac_f32_16x16x64_bf16 v[64:67], v[60:63], a[144:151], v23
  v_max3_u32 v31, v52, v53, v54
  v_max_u32 v31, v31, v55
  v_cmp_eq_u32 vcc, -1, v31
  v_smfmac_f32_16x16x64_bf16 v[68:71], v[60:63], a[152:159], v23
  v_smfmac_f32_16x16x64_bf16 v[72:75], v[60:63], a[160:167], v23
  v_smfmac_f32_16x16x64_bf16 v[76:79], v[60:63], a[168:175], v23
  v_smfmac_f32_16x16x64_bf16 v[80:83], v[60:63], a[176:183], v23
  v_smfmac_f32_16x16x64_bf16 v[84:87], v[60:63], a[184:191], v23
  s_cbranch_vccz SL_m_12_ok1
  s_branch SL_m_12_x1
SL_m_0123_c0:
  v_max3_u32 v31, v48, v49, v50
  v_max_u32 v31, v31, v51
  v_cmp_eq_u32 vcc, -1, v31
  s_cbranch_vccz SL_m_0123_ok0
SL_m_0123_x0:
  s_mov_b64 exec, vcc
  buffer_load_dwordx4 v[48:51], v3, s[4:7], s41 offen offset:0 sc1
  s_mov_b64 exec, -1
SL_m_0123_c1:
  v_max3_u32 v31, v52, v53, v54
  v_max_u32 v31, v31, v55
  v_cmp_eq_u32 vcc, -1, v31
  s_cbranch_vccz SL_m_0123_ok1
SL_m_0123_x1:
  s_mov_b64 exec, vcc
  buffer_load_dwordx4 v[52:55], v3, s[4:7], s41 offen offset:1024 sc1
  s_mov_b64 exec, -1
SL_m_0123_c2:
  v_max3_u32 v31, v56, v57, v58
  v_max_u32 v31, v31, v59
  v_cmp_eq_u32 vcc, -1, v31
  s_cbranch_vccz SL_m_0123_ok2
SL_m_0123_x2:
  s_mov_b64 exec, vcc
  buffer_load_dwordx4 v[56:59], v3, s[4:7], s41 offen offset:2048 sc1
  s_mov_b64 exec, -1
SL_m_0123_c3:
  v_max3_u32 v31, v60, v61, v62
  v_max_u32 v31, v31, v63
  v_cmp_eq_u32 vcc, -1, v31
  s_cbranch_vccz SL_m_0123_ok3
SL_m_0123_x3:
  s_mov_b64 exec, vcc
  buffer_load_dwordx4 v[60:63], v3, s[4:7], s41 offen offset:3072 sc1
  s_mov_b64 exec, -1
  s_add_u32 s46, s46, 1
  s_cmp_ge_u32 s46, 2097152
  s_cbranch_scc1 SL_rec_abort
  s_waitcnt vmcnt(4)
  s_branch SL_m_0123_c0
SL_m_0123_ok0:
  v_smfmac_f32_16x16x64_bf16 v[64:67], v[48:51], a[0:7], v23
  v_max3_u32 v31, v52, v53, v54
  v_max_u32 v31, v31, v55
  v_cmp_eq_u32 vcc, -1, v31
  v_smfmac_f32_16x16x64_bf16 v[68:71], v[48:51], a[8:15], v23
  v_smfmac_f32_16x16x64_bf16 v[72:75], v[48:51], a[16:23], v23
  v_smfmac_f32_16x16x64_bf16 v[76:79], v[48:51], a[24:31], v23
  v_smfmac_f32_16x16x64_bf16 v[80:83], v[48:51], a[32:39], v23
  v_smfmac_f32_16x16x64_bf16 v[84:87], v[48:51], a[40:47], v23
  s_cbranch_vccz SL_m_123_ok1
  s_branch SL_m_123_x1
SL_m_0123_ok1:
  v_smfmac_f32_16x16x64_bf16 v[64:67], v[52:55], a[48:55], v23
  v_max3_u32 v31, v56, v57, v58
  v_max_u32 v31, v31, v59
  v_cmp_eq_u32 vcc, -1, v31
  v_smfmac_f32_16x16x64_bf16 v[68:71], v[52:55], a[56:63], v23
  v_smfmac_f32_16x16x64_bf16 v[72:75], v[52:55], a[64:71], v23
  v_smfmac_f32_16x16x64_bf16 v[76:79], v[52:55], a[72:79], v23
  v_smfmac_f32_16x16x64_bf16 v[80:83], v[52:55], a[80:87], v23
  v_smfmac_f32_16x16x64_bf16 v[84:87], v[52:55], a[88:95], v23
  s_cbranch_vccz SL_m_023_ok2
  s_branch SL_m_023_x2
SL_m_0123_ok2:
  v_smfmac_f32_16x16x64_bf16 v[64:67], v[56:59], a[96:103], v23
  v_max3_u32 v31, v60, v61, v62
  v_max_u32 v31, v31, v63
  v_cmp_eq_u32 vcc, -1, v31
  v_smfmac_f32_16x16x64_bf16 v[68:71], v[56:59], a[104:111], v23
  v_smfmac_f32_16x16x64_bf16 v[72:75], v[56:59], a[112:119], v23
  v_smfmac_f32_16x16x64_bf16 v[76:79], v[56:59], a[120:127], v23
  v_smfmac_f32_16x16x64_bf16 v[80:83], v[56:59], a[128:135], v23
  v_smfmac_f32_16x16x64_bf16 v[84:87], v[56:59], a[136:143], v23
  s_cbranch_vccz SL_m_013_ok3
  s_branch SL_m_013_x3
SL_m_0123_ok3:
  v_smfmac_f32_16x16x64_bf16 v[64:67], v[60:63], a[144:151], v23
  v_max3_u32 v31, v48, v49, v50
  v_max_u32 v31, v31, v51
  v_cmp_eq_u32 vcc, -1, v31
  v_smfmac_f32_16x16x64_bf16 v[68:71], v[60:63], a[152:159], v23
  v_smfmac_f32_16x16x64_bf16 v[72:75], v[60:63], a[160:167], v23
  v_smfmac_f32_16x16x64_bf16 v[76:79], v[60:63], a[168:175], v23
  v_smfmac_f32_16x16x64_bf16 v[80:83], v[60:63], a[176:183], v23
  v_smfmac_f32_16x16x64_bf16 v[84:87], v[60:63], a[184:191], v23
  s_cbranch_vccz SL_m_012_ok0
  s_branch SL_m_012_x0
SL_x_f0:
  s_mov_b64 exec, vcc
  buffer_load_dwordx4 v[64:67], v9, s[4:7], s41 offen offset:0 sc1
  s_mov_b64 exec, -1
  s_waitcnt vmcnt(1)
  s_branch SL_x_0123_c1
SL_x_f1:
  s_mov_b64 exec, vcc
  buffer_load_dwordx4 v[68:71], v9, s[4:7], s41 offen offset:1024 sc1
  s_mov_b64 exec, -1
  s_waitcnt vmcnt(1)
  s_branch SL_x_123_c2
SL_x_f2:
  s_mov_b64 exec, vcc
  buffer_load_dwordx4 v[72:75], v9, s[4:7], s41 offen offset:2048 sc1
  s_mov_b64 exec, -1
  s_waitcnt vmcnt(1)
  s_branch SL_x_23_c3
SL_x_f3:
  s_mov_b64 exec, vcc
  buffer_load_dwordx4 v[76:79], v9, s[4:7], s41 offen offset:3072 sc1
  s_mov_b64 exec, -1
  s_nop 7
  s_branch SL_x_3_c3
SL_x_0_c0:
  v_max3_u32 v31, v64, v65, v66
  v_max_u32 v31, v31, v67
  v_cmp_eq_u32 vcc, -1, v31
  s_cbranch_vccz SL_x_0_ok0
SL_x_0_x0:
  s_mov_b64 exec, vcc
  buffer_load_dwordx4 v[64:67], v9, s[4:7], s41 offen offset:0 sc1
  s_mov_b64 exec, -1
  s_add_u32 s46, s46, 1
  s_cmp_ge_u32 s46, 2097152
  s_cbranch_scc1 SL_rec_abort
  s_waitcnt vmcnt(2)
  s_branch SL_x_0_c0
SL_x_0_ok0:
  v_mfma_f32_16x16x32_bf16 v[44:47], v[64:67], v[64:67], v[44:47]
  v_mfma_f32_16x16x32_bf16 v[36:39], v[116:119], v[64:67], v[36:39]
  v_mfma_f32_16x16x32_bf16 v[40:43], v[132:135], v[64:67], v[40:43]
  s_branch SL_x_done
SL_x_1_c1:
  v_max3_u32 v31, v68, v69, v70
  v_max_u32 v31, v31, v71
  v_cmp_eq_u32 vcc, -1, v31
  s_cbranch_vccz SL_x_1_ok1
SL_x_1_x1:
  s_mov_b64 exec, vcc
  buffer_load_dwordx4 v[68:71], v9, s[4:7], s41 offen offset:1024 sc1
  s_mov_b64 exec, -1
  s_add_u32 s46, s46, 1
  s_cmp_ge_u32 s46, 2097152
  s_cbranch_scc1 SL_rec_abort
  s_waitcnt vmcnt(2)
  s_branch SL_x_1_c1
SL_x_1_ok1:
  v_mfma_f32_16x16x32_bf16 v[44:47], v[68:71], v[68:71], v[44:47]
  v_mfma_f32_16x16x32_bf16 v[36:39], v[120:123], v[68:71], v[36:39]
  v_mfma_f32_16x16x32_bf16 v[40:43], v[136:139], v[68:71], v[40:43]
  s_branch SL_x_done
SL_x_2_c2:
  v_max3_u32 v31, v72, v73, v74
  v_max_u32 v31, v31, v75
  v_cmp_eq_u32 vcc, -1, v31
  s_cbranch_vccz SL_x_2_ok2
SL_x_2_x2:
  s_mov_b64 exec, vcc
  buffer_load_dwordx4 v[72:75], v9, s[4:7], s41 offen offset:2048 sc1
  s_mov_b64 exec, -1
  s_add_u32 s46, s46, 1
  s_cmp_ge_u32 s46, 2097152
  s_cbranch_scc1 SL_rec_abort
  s_waitcnt vmcnt(2)
  s_branch SL_x_2_c2
SL_x_2_ok2:
  v_mfma_f32_16x16x32_bf16 v[44:47], v[72:75], v[72:75], v[44:47]
  v_mfma_f32_16x16x32_bf16 v[36:39], v[124:127], v[72:75], v[36:39]
  v_mfma_f32_16x16x32_bf16 v[40:43], v[140:143], v[72:75], v[40:43]
  s_branch SL_x_done
SL_x_3_c3:
  v_max3_u32 v31, v76, v77, v78
  v_max_u32 v31, v31, v79
  v_cmp_eq_u32 vcc, -1, v31
  s_cbranch_vccz SL_x_3_ok3
SL_x_3_x3:
  s_mov_b64 exec, vcc
  buffer_load_dwordx4 v[76:79], v9, s[4:7], s41 offen offset:3072 sc1
  s_mov_b64 exec, -1
  s_add_u32 s46, s46, 1
  s_cmp_ge_u32 s46, 2097152
  s_cbranch_scc1 SL_rec_abort
  s_waitcnt vmcnt(2)
  s_branch SL_x_3_c3
SL_x_3_ok3:
  v_mfma_f32_16x16x32_bf16 v[44:47], v[76:79], v[76:79], v[44:47]
  v_mfma_f32_16x16x32_bf16 v[36:39], v[128:131], v[76:79], v[36:39]
  v_mfma_f32_16x16x32_bf16 v[40:43], v[144:147], v[76:79], v[40:43]
  s_branch SL_x_done
SL_x_01_c0:
  v_max3_u32 v31, v64, v65, v66
  v_max_u32 v31, v31, v67
  v_cmp_eq_u32 vcc, -1, v31
  s_cbranch_vccz SL_x_01_ok0
SL_x_01_x0:
  s_mov_b64 exec, vcc
  buffer_load_dwordx4 v[64:67], v9, s[4:7], s41 offen offset:0 sc1
  s_mov_b64 exec, -1
SL_x_01_c1:
  v_max3_u32 v31, v68, v69, v70
  v_max_u32 v31, v31, v71
  v_cmp_eq_u32 vcc, -1, v31
  s_cbranch_vccz SL_x_01_ok1
SL_x_01_x1:
  s_mov_b64 exec, vcc
  buffer_load_dwordx4 v[68:71], v9, s[4:7], s41 offen offset:1024 sc1
  s_mov_b64 exec, -1
  s_add_u32 s46, s46, 1
  s_cmp_ge_u32 s46, 2097152
  s_cbranch_scc1 SL_rec_abort
  s_waitcnt vmcnt(4)
  s_branch SL_x_01_c0
SL_x_01_ok0:
  v_mfma_f32_16x16x32_bf16 v[44:47], v[64:67], v[64:67], v[44:47]
  v_max3_u32 v31, v68, v69, v70
  v_max_u32 v31, v31, v71
  v_cmp_eq_u32 vcc, -1, v31
  v_mfma_f32_16x16x32_bf16 v[36:39], v[116:119], v[64:67], v[36:39]
  v_mfma_f32_16x16x32_bf16 v[40:43], v[132:135], v[64:67], v[40:43]
  s_cbranch_vccz SL_x_1_ok1
  s_branch SL_x_1_x1
SL_x_01_ok1:
  v_mfma_f32_16x16x32_bf16 v[44:47], v[68:71], v[68:71], v[44:47]
  v_max3_u32 v31, v64, v65, v66
  v_max_u32 v31, v31, v67
  v_cmp_eq_u32 vcc, -1, v31
  v_mfma_f32_16x16x32_bf16 v[36:39], v[120:123], v[68:71], v[36:39]
  v_mfma_f32_16x16x32_bf16 v[40:43], v[136:139], v[68:71], v[40:43]
  s_cbranch_vccz SL_x_0_ok0
  s_branch SL_x_0_x0
SL_x_02_c0:
  v_max3_u32 v31, v64, v65, v66
  v_max_u32 v31, v31, v67
  v_cmp_eq_u32 vcc, -1, v31
  s_cbranch_vccz SL_x_02_ok0
SL_x_02_x0:
  s_mov_b64 exec, vcc
  buffer_load_dwordx4 v[64:67], v9, s[4:7], s41 offen offset:0 sc1
  s_mov_b64 exec, -1
SL_x_02_c2:
  v_max3_u32 v31, v72, v73, v74
  v_max_u32 v31, v31, v75
  v_cmp_eq_u32 vcc, -1, v31
  s_cbranch_vccz SL_x_02_ok2
SL_x_02_x2:
  s_mov_b64 exec, vcc
  buffer_load_dwordx4 v[72:75], v9, s[4:7], s41 offen offset:2048 sc1
  s_mov_b64 exec, -1
  s_add_u32 s46, s46, 1
  s_cmp_ge_u32 s46, 2097152
  s_cbranch_scc1 SL_rec_abort
  s_waitcnt vmcnt(4)
  s_branch SL_x_02_c0
SL_x_02_ok0:
  v_mfma_f32_16x16x32_bf16 v[44:47], v[64:67], v[64:67], v[44:47]
  v_max3_u32 v31, v72, v73, v74
  v_max_u32 v31, v31, v75
  v_cmp_eq_u32 vcc, -1, v31
  v_mfma_f32_16x16x32_bf16 v[36:39], v[116:119], v[64:67], v[36:39]
  v_mfma_f32_16x16x32_bf16 v[40:43], v[132:135], v[64:67], v[40:43]
  s_cbranch_vccz SL_x_2_ok2
  s_branch SL_x_2_x2
SL_x_02_ok2:
  v_mfma_f32_16x16x32_bf16 v[44:47], v[72:75], v[72:75], v[44:47]
  v_max3_u32 v31, v64, v65, v66
  v_max_u32 v31, v31, v67
  v_cmp_eq_u32 vcc, -1, v31
  v_mfma_f32_16x16x32_bf16 v[36:39], v[124:127], v[72:75], v[36:39]
  v_mfma_f32_16x16x32_bf16 v[40:43], v[140:143], v[72:75], v[40:43]
  s_cbranch_vccz SL_x_0_ok0
  s_branch SL_x_0_x0
SL_x_03_c0:
  v_max3_u32 v31, v64, v65, v66
  v_max_u32 v31, v31, v67
  v_cmp_eq_u32 vcc, -1, v31
  s_cbranch_vccz SL_x_03_ok0
SL_x_03_x0:
  s_mov_b64 exec, vcc
  buffer_load_dwordx4 v[64:67], v9, s[4:7], s41 offen offset:0 sc1
  s_mov_b64 exec, -1
SL_x_03_c3:
  v_max3_u32 v31, v76, v77, v78
  v_max_u32 v31, v31, v79
  v_cmp_eq_u32 vcc, -1, v31
  s_cbranch_vccz SL_x_03_ok3
SL_x_03_x3:
  s_mov_b64 exec, vcc
  buffer_load_dwordx4 v[76:79], v9, s[4:7], s41 offen offset:3072 sc1
  s_mov_b64 exec, -1
  s_add_u32 s46, s46, 1
  s_cmp_ge_u32 s46, 2097152
  s_cbranch_scc1 SL_rec_abort
  s_waitcnt vmcnt(4)
  s_branch SL_x_03_c0
SL_x_03_ok0:
  v_mfma_f32_16x16x32_bf16 v[44:47], v[64:67], v[64:67], v[44:47]
  v_max3_u32 v31, v76, v77, v78
  v_max_u32 v31, v31, v79
  v_cmp_eq_u32 vcc, -1, v31
  v_mfma_f32_16x16x32_bf16 v[36:39], v[116:119], v[64:67], v[36:39]
  v_mfma_f32_16x16x32_bf16 v[40:43], v[132:135], v[64:67], v[40:43]
  s_cbranch_vccz SL_x_3_ok3
  s_branch SL_x_3_x3
SL_x_03_ok3:
  v_mfma_f32_16x16x32_bf16 v[44:47], v[76:79], v[76:79], v[44:47]
  v_max3_u32 v31, v64, v65, v66
  v_max_u32 v31, v31, v67
  v_cmp_eq_u32 vcc, -1, v31
  v_mfma_f32_16x16x32_bf16 v[36:39], v[128:131], v[76:79], v[36:39]
  v_mfma_f32_16x16x32_bf16 v[40:43], v[144:147], v[76:79], v[40:43]
  s_cbranch_vccz SL_x_0_ok0
  s_branch SL_x_0_x0
SL_x_12_c1:
  v_max3_u32 v31, v68, v69, v70
  v_max_u32 v31, v31, v71
  v_cmp_eq_u32 vcc, -1, v31
  s_cbranch_vccz SL_x_12_ok1
SL_x_12_x1:
  s_mov_b64 exec, vcc
  buffer_load_dwordx4 v[68:71], v9, s[4:7], s41 offen offset:1024 sc1
  s_mov_b64 exec, -1
SL_x_12_c2:
  v_max3_u32 v31, v72, v73, v74
  v_max_u32 v31, v31, v75
  v_cmp_eq_u32 vcc, -1, v31
  s_cbranch_vccz SL_x_12_ok2
SL_x_12_x2:
  s_mov_b64 exec, vcc
  buffer_load_dwordx4 v[72:75], v9, s[4:7], s41 offen offset:2048 sc1
  s_mov_b64 exec, -1
  s_add_u32 s46, s46, 1
  s_cmp_ge_u32 s46, 2097152
  s_cbranch_scc1 SL_rec_abort
  s_waitcnt vmcnt(4)
  s_branch SL_x_12_c1
SL_x_12_ok1:
  v_mfma_f32_16x16x32_bf16 v[44:47], v[68:71], v[68:71], v[44:47]
  v_max3_u32 v31, v72, v73, v74
  v_max_u32 v31, v31, v75
  v_cmp_eq_u32 vcc, -1, v31
  v_mfma_f32_16x16x32_bf16 v[36:39], v[120:123], v[68:71], v[36:39]
  v_mfma_f32_16x16x32_bf16 v[40:43], v[136:139], v[68:71], v[40:43]
  s_cbranch_vccz SL_x_2_ok2
  s_branch SL_x_2_x2
SL_x_12_ok2:
  v_mfma_f32_16x16x32_bf16 v[44:47], v[72:75], v[72:75], v[44:47]
  v_max3_u32 v31, v68, v69, v70
  v_max_u32 v31, v31, v71
  v_cmp_eq_u32 vcc, -1, v31
  v_mfma_f32_16x16x32_bf16 v[36:39], v[124:127], v[72:75], v[36:39]
  v_mfma_f32_16x16x32_bf16 v[40:43], v[140:143], v[72:75], v[40:43]
  s_cbranch_vccz SL_x_1_ok1
  s_branch SL_x_1_x1
SL_x_13_c1:
  v_max3_u32 v31, v68, v69, v70
  v_max_u32 v31, v31, v71
  v_cmp_eq_u32 vcc, -1, v31
  s_cbranch_vccz SL_x_13_ok1
SL_x_13_x1:
  s_mov_b64 exec, vcc
  buffer_load_dwordx4 v[68:71], v9, s[4:7], s41 offen offset:1024 sc1
  s_mov_b64 exec, -1
SL_x_13_c3:
  v_max3_u32 v31, v76, v77, v78
  v_max_u32 v31, v31, v79
  v_cmp_eq_u32 vcc, -1, v31
  s_cbranch_vccz SL_x_13_ok3
SL_x_13_x3:
  s_mov_b64 exec, vcc
  buffer_load_dwordx4 v[76:79], v9, s[4:7], s41 offen offset:3072 sc1
  s_mov_b64 exec, -1
  s_add_u32 s46, s46, 1
  s_cmp_ge_u32 s46, 2097152
  s_cbranch_scc1 SL_rec_abort
  s_waitcnt vmcnt(4)
  s_branch SL_x_13_c1
SL_x_13_ok1:
  v_mfma_f32_16x16x32_bf16 v[44:47], v[68:71], v[68:71], v[44:47]
  v_max3_u32 v31, v76, v77, v78
  v_max_u32 v31, v31, v79
  v_cmp_eq_u32 vcc, -1, v31
  v_mfma_f32_16x16x32_bf16 v[36:39], v[120:123], v[68:71], v[36:39]
  v_mfma_f32_16x16x32_bf16 v[40:43], v[136:139], v[68:71], v[40:43]
  s_cbranch_vccz SL_x_3_ok3
  s_branch SL_x_3_x3
SL_x_13_ok3:
  v_mfma_f32_16x16x32_bf16 v[44:47], v[76:79], v[76:79], v[44:47]
  v_max3_u32 v31, v68, v69, v70
  v_max_u32 v31, v31, v71
  v_cmp_eq_u32 vcc, -1, v31
  v_mfma_f32_16x16x32_bf16 v[36:39], v[128:131], v[76:79], v[36:39]
  v_mfma_f32_16x16x32_bf16 v[40:43], v[144:147], v[76:79], v[40:43]
  s_cbranch_vccz SL_x_1_ok1
  s_branch SL_x_1_x1
SL_x_23_c2:
  v_max3_u32 v31, v72, v73, v74
  v_max_u32 v31, v31, v75
  v_cmp_eq_u32 vcc, -1, v31
  s_cbranch_vccz SL_x_23_ok2
SL_x_23_x2:
  s_mov_b64 exec, vcc
  buffer_load_dwordx4 v[72:75], v9, s[4:7], s41 offen offset:2048 sc1
  s_mov_b64 exec, -1
SL_x_23_c3:
  v_max3_u32 v31, v76, v77, v78
  v_max_u32 v31, v31, v79
  v_cmp_eq_u32 vcc, -1, v31
  s_cbranch_vccz SL_x_23_ok3
SL_x_23_x3:
  s_mov_b64 exec, vcc
  buffer_load_dwordx4 v[76:79], v9, s[4:7], s41 offen offset:3072 sc1
  s_mov_b64 exec, -1
  s_add_u32 s46, s46, 1
  s_cmp_ge_u32 s46, 2097152
  s_cbranch_scc1 SL_rec_abort
  s_waitcnt vmcnt(4)
  s_branch SL_x_23_c2
SL_x_23_ok2:
  v_mfma_f32_16x16x32_bf16 v[44:47], v[72:75], v[72:75], v[44:47]
  v_max3_u32 v31, v76, v77, v78
  v_max_u32 v31, v31, v79
  v_cmp_eq_u32 vcc, -1, v31
  v_mfma_f32_16x16x32_bf16 v[36:39], v[124:127], v[72:75], v[36:39]
  v_mfma_f32_16x16x32_bf16 v[40:43], v[140:143], v[72:75], v[40:43]
  s_cbranch_vccz SL_x_3_ok3
  s_branch SL_x_3_x3
SL_x_23_ok3:
  v_mfma_f32_16x16x32_bf16 v[44:47], v[76:79], v[76:79], v[44:47]
  v_max3_u32 v31, v72, v73, v74
  v_max_u32 v31, v31, v75
  v_cmp_eq_u32 vcc, -1, v31
  v_mfma_f32_16x16x32_bf16 v[36:39], v[128:131], v[76:79], v[36:39]
  v_mfma_f32_16x16x32_bf16 v[40:43], v[144:147], v[76:79], v[40:43]
  s_cbranch_vccz SL_x_2_ok2
  s_branch SL_x_2_x2
SL_x_012_c0:
  v_max3_u32 v31, v64, v65, v66
  v_max_u32 v31, v31, v67
  v_cmp_eq_u32 vcc, -1, v31
  s_cbranch_vccz SL_x_012_ok0
SL_x_012_x0:
  s_mov_b64 exec, vcc
  buffer_load_dwordx4 v[64:67], v9, s[4:7], s41 offen offset:0 sc1
  s_mov_b64 exec, -1
SL_x_012_c1:
  v_max3_u32 v31, v68, v69, v70
  v_max_u32 v31, v31, v71
  v_cmp_eq_u32 vcc, -1, v31
  s_cbranch_vccz SL_x_012_ok1
SL_x_012_x1:
  s_mov_b64 exec, vcc
  buffer_load_dwordx4 v[68:71], v9, s[4:7], s41 offen offset:1024 sc1
  s_mov_b64 exec, -1
SL_x_012_c2:
  v_max3_u32 v31, v72, v73, v74
  v_max_u32 v31, v31, v75
  v_cmp_eq_u32 vcc, -1, v31
  s_cbranch_vccz SL_x_012_ok2
SL_x_012_x2:
  s_mov_b64 exec, vcc
  buffer_load_dwordx4 v[72:75], v9, s[4:7], s41 offen offset:2048 sc1
  s_mov_b64 exec, -1
  s_add_u32 s46, s46, 1
  s_cmp_ge_u32 s46, 2097152
  s_cbranch_scc1 SL_rec_abort
  s_waitcnt vmcnt(4)
  s_branch SL_x_012_c0
SL_x_012_ok0:
  v_mfma_f32_16x16x32_bf16 v[44:47], v[64:67], v[64:67], v[44:47]
  v_max3_u32 v31, v68, v69, v70
  v_max_u32 v31, v31, v71
  v_cmp_eq_u32 vcc, -1, v31
  v_mfma_f32_16x16x32_bf16 v[36:39], v[116:119], v[64:67], v[36:39]
  v_mfma_f32_16x16x32_bf16 v[40:43], v[132:135], v[64:67], v[40:43]
  s_cbranch_vccz SL_x_12_ok1
  s_branch SL_x_12_x1
SL_x_012_ok1:
  v_mfma_f32_16x16x32_bf16 v[44:47], v[68:71], v[68:71], v[44:47]
  v_max3_u32 v31, v72, v73, v74
  v_max_u32 v31, v31, v75
  v_cmp_eq_u32 vcc, -1, v31
  v_mfma_f32_16x16x32_bf16 v[36:39], v[120:123], v[68:71], v[36:39]
  v_mfma_f32_16x16x32_bf16 v[40:43], v[136:139], v[68:71], v[40:43]
  s_cbranch_vccz SL_x_02_ok2
  s_branch SL_x_02_x2
SL_x_012_ok2:
  v_mfma_f32_16x16x32_bf16 v[44:47], v[72:75], v[72:75], v[44:47]
  v_max3_u32 v31, v64, v65, v66
  v_max_u32 v31, v31, v67
  v_cmp_eq_u32 vcc, -1, v31
  v_mfma_f32_16x16x32_bf16 v[36:39], v[124:127], v[72:75], v[36:39]
  v_mfma_f32_16x16x32_bf16 v[40:43], v[140:143], v[72:75], v[40:43]
  s_cbranch_vccz SL_x_01_ok0
  s_branch SL_x_01_x0
SL_x_013_c0:
  v_max3_u32 v31, v64, v65, v66
  v_max_u32 v31, v31, v67
  v_cmp_eq_u32 vcc, -1, v31
  s_cbranch_vccz SL_x_013_ok0
SL_x_013_x0:
  s_mov_b64 exec, vcc
  buffer_load_dwordx4 v[64:67], v9, s[4:7], s41 offen offset:0 sc1
  s_mov_b64 exec, -1
SL_x_013_c1:
  v_max3_u32 v31, v68, v69, v70
  v_max_u32 v31, v31, v71
  v_cmp_eq_u32 vcc, -1, v31
  s_cbranch_vccz SL_x_013_ok1
SL_x_013_x1:
  s_mov_b64 exec, vcc
  buffer_load_dwordx4 v[68:71], v9, s[4:7], s41 offen offset:1024 sc1
  s_mov_b64 exec, -1
SL_x_013_c3:
  v_max3_u32 v31, v76, v77, v78
  v_max_u32 v31, v31, v79
  v_cmp_eq_u32 vcc, -1, v31
  s_cbranch_vccz SL_x_013_ok3
SL_x_013_x3:
  s_mov_b64 exec, vcc
  buffer_load_dwordx4 v[76:79], v9, s[4:7], s41 offen offset:3072 sc1
  s_mov_b64 exec, -1
  s_add_u32 s46, s46, 1
  s_cmp_ge_u32 s46, 2097152
  s_cbranch_scc1 SL_rec_abort
  s_waitcnt vmcnt(4)
  s_branch SL_x_013_c0
SL_x_013_ok0:
  v_mfma_f32_16x16x32_bf16 v[44:47], v[64:67], v[64:67], v[44:47]
  v_max3_u32 v31, v68, v69, v70
  v_max_u32 v31, v31, v71
  v_cmp_eq_u32 vcc, -1, v31
  v_mfma_f32_16x16x32_bf16 v[36:39], v[116:119], v[64:67], v[36:39]
  v_mfma_f32_16x16x32_bf16 v[40:43], v[132:135], v[64:67], v[40:43]
  s_cbranch_vccz SL_x_13_ok1
  s_branch SL_x_13_x1
SL_x_013_ok1:
  v_mfma_f32_16x16x32_bf16 v[44:47], v[68:71], v[68:71], v[44:47]
  v_max3_u32 v31, v76, v77, v78
  v_max_u32 v31, v31, v79
  v_cmp_eq_u32 vcc, -1, v31
  v_mfma_f32_16x16x32_bf16 v[36:39], v[120:123], v[68:71], v[36:39]
  v_mfma_f32_16x16x32_bf16 v[40:43], v[136:139], v[68:71], v[40:43]
  s_cbranch_vccz SL_x_03_ok3
  s_branch SL_x_03_x3
SL_x_013_ok3:
  v_mfma_f32_16x16x32_bf16 v[44:47], v[76:79], v[76:79], v[44:47]
  v_max3_u32 v31, v64, v65, v66
  v_max_u32 v31, v31, v67
  v_cmp_eq_u32 vcc, -1, v31
  v_mfma_f32_16x16x32_bf16 v[36:39], v[128:131], v[76:79], v[36:39]
  v_mfma_f32_16x16x32_bf16 v[40:43], v[144:147], v[76:79], v[40:43]
  s_cbranch_vccz SL_x_01_ok0
  s_branch SL_x_01_x0
SL_x_023_c0:
  v_max3_u32 v31, v64, v65, v66
  v_max_u32 v31, v31, v67
  v_cmp_eq_u32 vcc, -1, v31
  s_cbranch_vccz SL_x_023_ok0
SL_x_023_x0:
  s_mov_b64 exec, vcc
  buffer_load_dwordx4 v[64:67], v9, s[4:7], s41 offen offset:0 sc1
  s_mov_b64 exec, -1
SL_x_023_c2:
  v_max3_u32 v31, v72, v73, v74
  v_max_u32 v31, v31, v75
  v_cmp_eq_u32 vcc, -1, v31
  s_cbranch_vccz SL_x_023_ok2
SL_x_023_x2:
  s_mov_b64 exec, vcc
  buffer_load_dwordx4 v[72:75], v9, s[4:7], s41 offen offset:2048 sc1
  s_mov_b64 exec, -1
SL_x_023_c3:
  v_max3_u32 v31, v76, v77, v78
  v_max_u32 v31, v31, v79
  v_cmp_eq_u32 vcc, -1, v31
  s_cbranch_vccz SL_x_023_ok3
SL_x_023_x3:
  s_mov_b64 exec, vcc
  buffer_load_dwordx4 v[76:79], v9, s[4:7], s41 offen offset:3072 sc1
  s_mov_b64 exec, -1
  s_add_u32 s46, s46, 1
  s_cmp_ge_u32 s46, 2097152
  s_cbranch_scc1 SL_rec_abort
  s_waitcnt vmcnt(4)
  s_branch SL_x_023_c0
SL_x_023_ok0:
  v_mfma_f32_16x16x32_bf16 v[44:47], v[64:67], v[64:67], v[44:47]
  v_max3_u32 v31, v72, v73, v74
  v_max_u32 v31, v31, v75
  v_cmp_eq_u32 vcc, -1, v31
  v_mfma_f32_16x16x32_bf16 v[36:39], v[116:119], v[64:67], v[36:39]
  v_mfma_f32_16x16x32_bf16 v[40:43], v[132:135], v[64:67], v[40:43]
  s_cbranch_vccz SL_x_23_ok2
  s_branch SL_x_23_x2
SL_x_023_ok2:
  v_mfma_f32_16x16x32_bf16 v[44:47], v[72:75], v[72:75], v[44:47]
  v_max3_u32 v31, v76, v77, v78
  v_max_u32 v31, v31, v79
  v_cmp_eq_u32 vcc, -1, v31
  v_mfma_f32_16x16x32_bf16 v[36:39], v[124:127], v[72:75], v[36:39]
  v_mfma_f32_16x16x32_bf16 v[40:43], v[140:143], v[72:75], v[40:43]
  s_cbranch_vccz SL_x_03_ok3
  s_branch SL_x_03_x3
SL_x_023_ok3:
  v_mfma_f32_16x16x32_bf16 v[44:47], v[76:79], v[76:79], v[44:47]
  v_max3_u32 v31, v64, v65, v66
  v_max_u32 v31, v31, v67
  v_cmp_eq_u32 vcc, -1, v31
  v_mfma_f32_16x16x32_bf16 v[36:39], v[128:131], v[76:79], v[36:39]
  v_mfma_f32_16x16x32_bf16 v[40:43], v[144:147], v[76:79], v[40:43]
  s_cbranch_vccz SL_x_02_ok0
  s_branch SL_x_02_x0
SL_x_123_c1:
  v_max3_u32 v31, v68, v69, v70
  v_max_u32 v31, v31, v71
  v_cmp_eq_u32 vcc, -1, v31
  s_cbranch_vccz SL_x_123_ok1
SL_x_123_x1:
  s_mov_b64 exec, vcc
  buffer_load_dwordx4 v[68:71], v9, s[4:7], s41 offen offset:1024 sc1
  s_mov_b64 exec, -1
SL_x_123_c2:
  v_max3_u32 v31, v72, v73, v74
  v_max_u32 v31, v31, v75
  v_cmp_eq_u32 vcc, -1, v31
  s_cbranch_vccz SL_x_123_ok2
SL_x_123_x2:
  s_mov_b64 exec, vcc
  buffer_load_dwordx4 v[72:75], v9, s[4:7], s41 offen offset:2048 sc1
  s_mov_b64 exec, -1
SL_x_123_c3:
  v_max3_u32 v31, v76, v77, v78
  v_max_u32 v31, v31, v79
  v_cmp_eq_u32 vcc, -1, v31
  s_cbranch_vccz SL_x_123_ok3
SL_x_123_x3:
  s_mov_b64 exec, vcc
  buffer_load_dwordx4 v[76:79], v9, s[4:7], s41 offen offset:3072 sc1
  s_mov_b64 exec, -1
  s_add_u32 s46, s46, 1
  s_cmp_ge_u32 s46, 2097152
  s_cbranch_scc1 SL_rec_abort
  s_waitcnt vmcnt(4)
  s_branch SL_x_123_c1
SL_x_123_ok1:
  v_mfma_f32_16x16x32_bf16 v[44:47], v[68:71], v[68:71], v[44:47]
  v_max3_u32 v31, v72, v73, v74
  v_max_u32 v31, v31, v75
  v_cmp_eq_u32 vcc, -1, v31
  v_mfma_f32_16x16x32_bf16 v[36:39], v[120:123], v[68:71], v[36:39]
  v_mfma_f32_16x16x32_bf16 v[40:43], v[136:139], v[68:71], v[40:43]
  s_cbranch_vccz SL_x_23_ok2
  s_branch SL_x_23_x2
SL_x_123_ok2:
  v_mfma_f32_16x16x32_bf16 v[44:47], v[72:75], v[72:75], v[44:47]
  v_max3_u32 v31, v76, v77, v78
  v_max_u32 v31, v31, v79
  v_cmp_eq_u32 vcc, -1, v31
  v_mfma_f32_16x16x32_bf16 v[36:39], v[124:127], v[72:75], v[36:39]
  v_mfma_f32_16x16x32_bf16 v[40:43], v[140:143], v[72:75], v[40:43]
  s_cbranch_vccz SL_x_13_ok3
  s_branch SL_x_13_x3
SL_x_123_ok3:
  v_mfma_f32_16x16x32_bf16 v[44:47], v[76:79], v[76:79], v[44:47]
  v_max3_u32 v31, v68, v69, v70
  v_max_u32 v31, v31, v71
  v_cmp_eq_u32 vcc, -1, v31
  v_mfma_f32_16x16x32_bf16 v[36:39], v[128:131], v[76:79], v[36:39]
  v_mfma_f32_16x16x32_bf16 v[40:43], v[144:147], v[76:79], v[40:43]
  s_cbranch_vccz SL_x_12_ok1
  s_branch SL_x_12_x1
SL_x_0123_c0:
  v_max3_u32 v31, v64, v65, v66
  v_max_u32 v31, v31, v67
  v_cmp_eq_u32 vcc, -1, v31
  s_cbranch_vccz SL_x_0123_ok0
SL_x_0123_x0:
  s_mov_b64 exec, vcc
  buffer_load_dwordx4 v[64:67], v9, s[4:7], s41 offen offset:0 sc1
  s_mov_b64 exec, -1
SL_x_0123_c1:
  v_max3_u32 v31, v68, v69, v70
  v_max_u32 v31, v31, v71
  v_cmp_eq_u32 vcc, -1, v31
  s_cbranch_vccz SL_x_0123_ok1
SL_x_0123_x1:
  s_mov_b64 exec, vcc
  buffer_load_dwordx4 v[68:71], v9, s[4:7], s41 offen offset:1024 sc1
  s_mov_b64 exec, -1
SL_x_0123_c2:
  v_max3_u32 v31, v72, v73, v74
  v_max_u32 v31, v31, v75
  v_cmp_eq_u32 vcc, -1, v31
  s_cbranch_vccz SL_x_0123_ok2
SL_x_0123_x2:
  s_mov_b64 exec, vcc
  buffer_load_dwordx4 v[72:75], v9, s[4:7], s41 offen offset:2048 sc1
  s_mov_b64 exec, -1
SL_x_0123_c3:
  v_max3_u32 v31, v76, v77, v78
  v_max_u32 v31, v31, v79
  v_cmp_eq_u32 vcc, -1, v31
  s_cbranch_vccz SL_x_0123_ok3
SL_x_0123_x3:
  s_mov_b64 exec, vcc
  buffer_load_dwordx4 v[76:79], v9, s[4:7], s41 offen offset:3072 sc1
  s_mov_b64 exec, -1
  s_add_u32 s46, s46, 1
  s_cmp_ge_u32 s46, 2097152
  s_cbranch_scc1 SL_rec_abort
  s_waitcnt vmcnt(4)
  s_branch SL_x_0123_c0
SL_x_0123_ok0:
  v_mfma_f32_16x16x32_bf16 v[44:47], v[64:67], v[64:67], v[44:47]
  v_max3_u32 v31, v68, v69, v70
  v_max_u32 v31, v31, v71
  v_cmp_eq_u32 vcc, -1, v31
  v_mfma_f32_16x16x32_bf16 v[36:39], v[116:119], v[64:67], v[36:39]
  v_mfma_f32_16x16x32_bf16 v[40:43], v[132:135], v[64:67], v[40:43]
  s_cbranch_vccz SL_x_123_ok1
  s_branch SL_x_123_x1
SL_x_0123_ok1:
  v_mfma_f32_16x16x32_bf16 v[44:47], v[68:71], v[68:71], v[44:47]
  v_max3_u32 v31, v72, v73, v74
  v_max_u32 v31, v31, v75
  v_cmp_eq_u32 vcc, -1, v31
  v_mfma_f32_16x16x32_bf16 v[36:39], v[120:123], v[68:71], v[36:39]
  v_mfma_f32_16x16x32_bf16 v[40:43], v[136:139], v[68:71], v[40:43]
  s_cbranch_vccz SL_x_023_ok2
  s_branch SL_x_023_x2
SL_x_0123_ok2:
  v_mfma_f32_16x16x32_bf16 v[44:47], v[72:75], v[72:75], v[44:47]
  v_max3_u32 v31, v76, v77, v78
  v_max_u32 v31, v31, v79
  v_cmp_eq_u32 vcc, -1, v31
  v_mfma_f32_16x16x32_bf16 v[36:39], v[124:127], v[72:75], v[36:39]
  v_mfma_f32_16x16x32_bf16 v[40:43], v[140:143], v[72:75], v[40:43]
  s_cbranch_vccz SL_x_013_ok3
  s_branch SL_x_013_x3
SL_x_0123_ok3:
  v_mfma_f32_16x16x32_bf16 v[44:47], v[76:79], v[76:79], v[44:47]
  v_max3_u32 v31, v64, v65, v66
  v_max_u32 v31, v31, v67
  v_cmp_eq_u32 vcc, -1, v31
  v_mfma_f32_16x16x32_bf16 v[36:39], v[128:131], v[76:79], v[36:39]
  v_mfma_f32_16x16x32_bf16 v[40:43], v[144:147], v[76:79], v[40:43]
  s_cbranch_vccz SL_x_012_ok0
  s_branch SL_x_012_x0
SL_v_f:
  buffer_load_dwordx4 v[88:91], v10, s[4:7], s41 offen offset:0 sc1
  buffer_load_dwordx4 v[92:95], v10, s[4:7], s41 offen offset:1024 sc1
  s_add_u32 s46, s46, 1
  s_cmp_ge_u32 s46, 2097152
  s_cbranch_scc1 SL_rec_abort
  s_waitcnt vmcnt(0)
  v_max3_u32 v31, v88, v89, v90
  v_max3_u32 v31, v31, v91, v92
  v_max3_u32 v31, v31, v93, v94
  v_max_u32 v31, v31, v95
  v_cmp_eq_u32 vcc, -1, v31
  s_cbranch_vccnz SL_v_f
  s_branch SL_v_ok
SL_rec_abort:
  s_waitcnt vmcnt(0)
  s_endpgm
L_worker:
  s_load_dwordx4 s[80:83], s[0:1], 64
  s_load_dwordx2 s[84:85], s[0:1], 80
  s_sub_u32 s33, s40, 128
  s_lshr_b32 s33, s33, 5
  s_mov_b32 s39, s40
  s_getpc_b64 s[86:87]
L_pc:
  s_add_u32 s86, s86, L_table-L_pc
  s_addc_u32 s87, s87, 0
  s_waitcnt lgkmcnt(0)
L_next:
  s_cmp_lg_u32 s32, 0
  s_cbranch_scc1 L_nx1
  s_lshl_b32 s90, s33, 2
  v_mov_b32 v1, 1
  v_mov_b32 v2, 0
  s_mov_b64 exec, 1
  buffer_atomic_add v1, v2, s[28:31], s90 offen offset:48 sc0 sc1
  s_waitcnt vmcnt(0)
  v_mov_b32 v2, 131072
  ds_write_b32 v2, v1
  s_waitcnt lgkmcnt(0)
  s_mov_b64 exec, -1
L_nx1:
  s_barrier
  v_mov_b32 v2, 131072
  ds_read_b32 v1, v2
  s_waitcnt lgkmcnt(0)
  v_readfirstlane_b32 s34, v1
  s_cmp_ge_u32 s34, 344
  s_cbranch_scc1 L_exit
  s_lshl_b32 s90, s34, 2
  s_load_dword s91, s[86:87], s90
  s_waitcnt lgkmcnt(0)
  s_and_b32 s35, s91, 255
  s_lshr_b32 s36, s91, 8
  s_and_b32 s36, s36, 255
  s_lshr_b32 s37, s91, 16
  s_cmp_eq_u32 s35, 3
  s_cbranch_scc1 L_bqkv
  s_cmp_eq_u32 s35, 4
  s_cbranch_scc1 L_atb
  s_cmp_eq_u32 s35, 5
  s_cbranch_scc1 L_bo
  s_cmp_eq_u32 s35, 6
  s_cbranch_scc1 L_ata
  s_cmp_eq_u32 s35, 7
  s_cbranch_scc1 L_ao
  s_mov_b32 s8, s64
  s_and_b32 s9, s65, 0xffff
  s_mov_b32 s10, 0x400000
  s_mov_b32 s11, 0x20000
  s_mov_b32 s16, s4
  s_and_b32 s17, s5, 0xffff
  s_mov_b32 s18, 0x10000000
  s_mov_b32 s19, 0x20000
  s_cmp_eq_u32 s35, 0
  s_cselect_b64 s[88:89], s[68:69], s[70:71]
  s_cmp_eq_u32 s35, 2
  s_cselect_b64 s[88:89], s[72:73], s[88:89]
  s_mov_b32 s12, s88
  s_and_b32 s13, s89, 0xffff
  s_mov_b32 s14, 0x800000
  s_mov_b32 s15, 0x20000
  s_lshl_b32 s91, s33, 2
  s_add_u32 s91, s91, s37
  s_mov_b32 s24, 8192
  s_mov_b32 s26, 262144
  s_lshl_b32 s20, s36, 19
  s_lshl_b32 s21, s91, 9
  s_lshl_b32 s22, s35, 24
  s_lshl_b32 s90, s36, 21
  s_add_u32 s22, s22, s90
  s_lshl_b32 s90, s91, 14
  s_add_u32 s22, s22, s90
  s_cmp_eq_u32 s35, 0
  s_cselect_b32 s38, 96, 64
  s_mov_b32 s47, s35
  s_branch L_g1
L_bqkv:
  s_mov_b32 s8, s78
  s_and_b32 s9, s79, 0xffff
  s_mov_b32 s10, 0x400000
  s_mov_b32 s11, 0x20000
  s_mov_b32 s12, s80
  s_and_b32 s13, s81, 0xffff
  s_mov_b32 s14, 0x600000
  s_mov_b32 s15, 0x20000
  s_mov_b32 s16, s4
  s_and_b32 s17, s5, 0xffff
  s_mov_b32 s18, 0x10000000
  s_mov_b32 s19, 0x20000
  s_lshl_b32 s91, s37, 2
  s_add_u32 s91, s91, s33
  s_mov_b32 s24, 6144
  s_mov_b32 s26, 65536
  s_lshl_b32 s20, s36, 19
  s_lshl_b32 s21, s91, 9
  s_lshl_b32 s22, s37, 22
  s_lshl_b32 s90, s36, 19
  s_add_u32 s22, s22, s90
  s_lshl_b32 s90, s33, 14
  s_add_u32 s22, s22, s90
  s_add_u32 s22, s22, 0x4000000
  s_mov_b32 s38, 128
  s_mov_b32 s47, s37
L_g1:
  s_lshl_b32 s90, s36, 2
  s_add_u32 s38, s38, s90
  s_mov_b32 s23, 2048
  s_mov_b32 s25, 8
  v_and_b32 v1, 63, v0
  v_lshrrev_b32 v34, 6, v0
  s_nop 0
  v_readfirstlane_b32 s27, v34
  s_mul_i32 s90, s27, 64
  v_lshrrev_b32 v34, 3, v1
  v_add_u32 v34, s90, v34
  v_mul_lo_u32 v34, v34, s23
  v_lshrrev_b32 v35, 4, v1
  v_xor_b32 v35, v35, v1
  v_and_b32 v35, 7, v35
  v_lshl_add_u32 v2, v35, 4, v34
  s_mul_i32 s91, s23, 8
  v_add_u32 v3, s91, v2
  v_xor_b32 v3, 64, v3
  v_add_u32 v4, s91, v3
  v_xor_b32 v4, 64, v4
  v_add_u32 v5, s91, v4
  v_xor_b32 v5, 64, v5
  v_add_u32 v6, s91, v5
  v_xor_b32 v6, 64, v6
  v_add_u32 v7, s91, v6
  v_xor_b32 v7, 64, v7
  v_add_u32 v8, s91, v7
  v_xor_b32 v8, 64, v8
  v_add_u32 v9, s91, v8
  v_xor_b32 v9, 64, v9
  s_mul_i32 s90, s27, 16
  v_lshrrev_b32 v34, 5, v1
  v_add_u32 v34, 0, v34
  v_and_b32 v35, 3, v34
  v_lshlrev_b32 v35, 2, v35
  v_xor_b32 v35, v35, v1
  v_and_b32 v35, 31, v35
  v_add_u32 v34, s90, v34
  v_mul_lo_u32 v34, v34, s24
  v_lshl_add_u32 v10, v35, 4, v34
  v_lshrrev_b32 v34, 5, v1
  v_add_u32 v34, 2, v34
  v_and_b32 v35, 3, v34
  v_lshlrev_b32 v35, 2, v35
  v_xor_b32 v35, v35, v1
  v_and_b32 v35, 31, v35
  v_add_u32 v34, s90, v34
  v_mul_lo_u32 v34, v34, s24
  v_lshl_add_u32 v11, v35, 4, v34
  v_lshrrev_b32 v34, 5, v1
  v_add_u32 v34, 4, v34
  v_and_b32 v35, 3, v34
  v_lshlrev_b32 v35, 2, v35
  v_xor_b32 v35, v35, v1
  v_and_b32 v35, 31, v35
  v_add_u32 v34, s90, v34
  v_mul_lo_u32 v34, v34, s24
  v_lshl_add_u32 v12, v35, 4, v34
  v_lshrrev_b32 v34, 5, v1
  v_add_u32 v34, 6, v34
  v_and_b32 v35, 3, v34
  v_lshlrev_b32 v35, 2, v35
  v_xor_b32 v35, v35, v1
  v_and_b32 v35, 31, v35
  v_add_u32 v34, s90, v34
  v_mul_lo_u32 v34, v34, s24
  v_lshl_add_u32 v13, v35, 4, v34
  v_lshrrev_b32 v34, 5, v1
  v_add_u32 v34, 8, v34
  v_and_b32 v35, 3, v34
  v_lshlrev_b32 v35, 2, v35
  v_xor_b32 v35, v35, v1
  v_and_b32 v35, 31, v35
  v_add_u32 v34, s90, v34
  v_mul_lo_u32 v34, v34, s24
  v_lshl_add_u32 v14, v35, 4, v34
  v_lshrrev_b32 v34, 5, v1
  v_add_u32 v34, 10, v34
  v_and_b32 v35, 3, v34
  v_lshlrev_b32 v35, 2, v35
  v_xor_b32 v35, v35, v1
  v_and_b32 v35, 31, v35
  v_add_u32 v34, s90, v34
  v_mul_lo_u32 v34, v34, s24
  v_lshl_add_u32 v15, v35, 4, v34
  v_lshrrev_b32 v34, 5, v1
  v_add_u32 v34, 12, v34
  v_and_b32 v35, 3, v34
  v_lshlrev_b32 v35, 2, v35
  v_xor_b32 v35, v35, v1
  v_and_b32 v35, 31, v35
  v_add_u32 v34, s90, v34
  v_mul_lo_u32 v34, v34, s24
  v_lshl_add_u32 v16, v35, 4, v34
  v_lshrrev_b32 v34, 5, v1
  v_add_u32 v34, 14, v34
  v_and_b32 v35, 3, v34
  v_lshlrev_b32 v35, 2, v35
  v_xor_b32 v35, v35, v1
  v_and_b32 v35, 31, v35
  v_add_u32 v34, s90, v34
  v_mul_lo_u32 v34, v34, s24
  v_lshl_add_u32 v17, v35, 4, v34
  s_mul_i32 s51, s24, 64
  s_mul_i32 s52, s27, 8192
  s_mul_i32 s53, s27, 8192
  s_add_u32 s53, s53, 32768
  s_add_u32 m0, s52, 0
  s_nop 0
  buffer_load_dwordx4 v2, s[8:11], s20 offen  lds
  s_add_u32 m0, s53, 0
  s_nop 0
  buffer_load_dwordx4 v10, s[12:15], s21 offen lds
  s_add_u32 m0, s52, 1024
  s_nop 0
  buffer_load_dwordx4 v3, s[8:11], s20 offen  lds
  s_add_u32 m0, s53, 1024
  s_nop 0
  buffer_load_dwordx4 v11, s[12:15], s21 offen lds
  s_add_u32 m0, s52, 2048
  s_nop 0
  buffer_load_dwordx4 v4, s[8:11], s20 offen  lds
  s_add_u32 m0, s53, 2048
  s_nop 0
  buffer_load_dwordx4 v12, s[12:15], s21 offen lds
  s_add_u32 m0, s52, 3072
  s_nop 0
  buffer_load_dwordx4 v5, s[8:11], s20 offen  lds
  s_add_u32 m0, s53, 3072
  s_nop 0
  buffer_load_dwordx4 v13, s[12:15], s21 offen lds
  s_add_u32 m0, s52, 4096
  s_nop 0
  buffer_load_dwordx4 v6, s[8:11], s20 offen  lds
  s_add_u32 m0, s53, 4096
  s_nop 0
  buffer_load_dwordx4 v14, s[12:15], s21 offen lds
  s_add_u32 m0, s52, 5120
  s_nop 0
  buffer_load_dwordx4 v7, s[8:11], s20 offen  lds
  s_add_u32 m0, s53, 5120
  s_nop 0
  buffer_load_dwordx4 v15, s[12:15], s21 offen lds
  s_add_u32 m0, s52, 6144
  s_nop 0
  buffer_load_dwordx4 v8, s[8:11], s20 offen  lds
  s_add_u32 m0, s53, 6144
  s_nop 0
  buffer_load_dwordx4 v16, s[12:15], s21 offen lds
  s_add_u32 m0, s52, 7168
  s_nop 0
  buffer_load_dwordx4 v9, s[8:11], s20 offen  lds
  s_add_u32 m0, s53, 7168
  s_nop 0
  buffer_load_dwordx4 v17, s[12:15], s21 offen lds
  s_add_u32 s20, s20, 128
  s_add_u32 s21, s21, s51
  s_add_u32 m0, s52, 65536
  s_nop 0
  buffer_load_dwordx4 v2, s[8:11], s20 offen  lds
  s_add_u32 m0, s53, 65536
  s_nop 0
  buffer_load_dwordx4 v10, s[12:15], s21 offen lds
  s_add_u32 m0, s52, 66560
  s_nop 0
  buffer_load_dwordx4 v3, s[8:11], s20 offen  lds
  s_add_u32 m0, s53, 66560
  s_nop 0
  buffer_load_dwordx4 v11, s[12:15], s21 offen lds
  s_add_u32 m0, s52, 67584
  s_nop 0
  buffer_load_dwordx4 v4, s[8:11], s20 offen  lds
  s_add_u32 m0, s53, 67584
  s_nop 0
  buffer_load_dwordx4 v12, s[12:15], s21 offen lds
  s_add_u32 m0, s52, 68608
  s_nop 0
  buffer_load_dwordx4 v5, s[8:11], s20 offen  lds
  s_add_u32 m0, s53, 68608
  s_nop 0
  buffer_load_dwordx4 v13, s[12:15], s21 offen lds
  s_add_u32 m0, s52, 69632
  s_nop 0
  buffer_load_dwordx4 v6, s[8:11], s20 offen  lds
  s_add_u32 m0, s53, 69632
  s_nop 0
  buffer_load_dwordx4 v14, s[12:15], s21 offen lds
  s_add_u32 m0, s52, 70656
  s_nop 0
  buffer_load_dwordx4 v7, s[8:11], s20 offen  lds
  s_add_u32 m0, s53, 70656
  s_nop 0
  buffer_load_dwordx4 v15, s[12:15], s21 offen lds
  s_add_u32 m0, s52, 71680
  s_nop 0
  buffer_load_dwordx4 v8, s[8:11], s20 offen  lds
  s_add_u32 m0, s53, 71680
  s_nop 0
  buffer_load_dwordx4 v16, s[12:15], s21 offen lds
  s_add_u32 m0, s52, 72704
  s_nop 0
  buffer_load_dwordx4 v9, s[8:11], s20 offen  lds
  s_add_u32 m0, s53, 72704
  s_nop 0
  buffer_load_dwordx4 v17, s[12:15], s21 offen lds
  s_add_u32 s20, s20, 128
  s_add_u32 s21, s21, s51
  s_lshr_b32 s90, s27, 1
  s_and_b32 s91, s27, 1
  s_mul_i32 s92, s90, 16384
  v_mov_b32 v34, 0x0
  v_bfe_u32 v35, v1, 0, 5
  v_lshl_add_u32 v34, v35, 7, v34
  v_add_u32 v34, s92, v34
  v_lshrrev_b32 v35, 1, v1
  v_and_b32 v35, 7, v35
  v_lshrrev_b32 v36, 5, v1
  v_xor_b32 v35, v35, v36
  v_lshl_add_u32 v18, v35, 4, v34
  v_xor_b32 v19, 32, v18
  v_xor_b32 v20, 64, v18
  v_xor_b32 v21, 96, v18
  v_add_u32 v22, 65536, v18
  v_add_u32 v23, 65536, v19
  v_add_u32 v24, 65536, v20
  v_add_u32 v25, 65536, v21
  v_mov_b32 v34, 0x0
  v_bfe_u32 v35, v1, 2, 2
  v_lshl_add_u32 v34, v35, 9, v34
  v_bfe_u32 v35, v1, 5, 1
  v_lshl_add_u32 v34, v35, 12, v34
  v_bfe_u32 v35, v1, 4, 1
  v_lshl_add_u32 v34, v35, 5, v34
  v_bfe_u32 v35, v1, 0, 2
  v_lshl_add_u32 v34, v35, 3, v34
  s_mul_i32 s92, s91, 4
  s_add_u32 s93, s92, 0
  v_bfe_u32 v35, v1, 2, 2
  v_xor_b32 v35, s93, v35
  v_lshl_add_u32 v26, v35, 6, v34
  v_add_u32 v30, 65536, v26
  s_add_u32 s93, s92, 1
  v_bfe_u32 v35, v1, 2, 2
  v_xor_b32 v35, s93, v35
  v_lshl_add_u32 v27, v35, 6, v34
  v_add_u32 v31, 65536, v27
  s_add_u32 s93, s92, 2
  v_bfe_u32 v35, v1, 2, 2
  v_xor_b32 v35, s93, v35
  v_lshl_add_u32 v28, v35, 6, v34
  v_add_u32 v32, 65536, v28
  s_add_u32 s93, s92, 3
  v_bfe_u32 v35, v1, 2, 2
  v_xor_b32 v35, s93, v35
  v_lshl_add_u32 v29, v35, 6, v34
  v_add_u32 v33, 65536, v29
  s_cmp_eq_u32 s47, 2
  s_cbranch_scc1 L_g2
  s_waitcnt vmcnt(16)
  s_barrier
  ds_read_b128 v[40:43], v18 offset:0
  ds_read_b64_tr_b16 v[72:73], v26 offset:32768
  ds_read_b64_tr_b16 v[74:75], v26 offset:34816
  ds_read_b128 v[44:47], v18 offset:4096
  ds_read_b64_tr_b16 v[76:77], v27 offset:32768
  ds_read_b64_tr_b16 v[78:79], v27 offset:34816
  ds_read_b128 v[48:51], v18 offset:8192
  ds_read_b64_tr_b16 v[80:81], v28 offset:32768
  ds_read_b64_tr_b16 v[82:83], v28 offset:34816
  ds_read_b128 v[52:55], v18 offset:12288
  ds_read_b64_tr_b16 v[84:85], v29 offset:32768
  ds_read_b64_tr_b16 v[86:87], v29 offset:34816
  s_sub_u32 s25, s25, 1
  s_waitcnt lgkmcnt(0)
  v_mfma_f32_32x32x16_bf16 a[0:15], v[72:75], v[40:43], 0
  ds_read_b128 v[56:59], v19 offset:0
  v_mfma_f32_32x32x16_bf16 a[16:31], v[76:79], v[40:43], 0
  ds_read_b64_tr_b16 v[88:89], v26 offset:40960
  v_mfma_f32_32x32x16_bf16 a[32:47], v[80:83], v[40:43], 0
  ds_read_b64_tr_b16 v[90:91], v26 offset:43008
  v_mfma_f32_32x32x16_bf16 a[48:63], v[84:87], v[40:43], 0
  ds_read_b128 v[60:63], v19 offset:4096
  v_mfma_f32_32x32x16_bf16 a[64:79], v[72:75], v[44:47], 0
  ds_read_b64_tr_b16 v[92:93], v27 offset:40960
  v_mfma_f32_32x32x16_bf16 a[80:95], v[76:79], v[44:47], 0
  ds_read_b64_tr_b16 v[94:95], v27 offset:43008
  v_mfma_f32_32x32x16_bf16 a[96:111], v[80:83], v[44:47], 0
  ds_read_b128 v[64:67], v19 offset:8192
  v_mfma_f32_32x32x16_bf16 a[112:127], v[84:87], v[44:47], 0
  ds_read_b64_tr_b16 v[96:97], v28 offset:40960
  v_mfma_f32_32x32x16_bf16 a[128:143], v[72:75], v[48:51], 0
  ds_read_b64_tr_b16 v[98:99], v28 offset:43008
  v_mfma_f32_32x32x16_bf16 a[144:159], v[76:79], v[48:51], 0
  ds_read_b128 v[68:71], v19 offset:12288
  v_mfma_f32_32x32x16_bf16 a[160:175], v[80:83], v[48:51], 0
  ds_read_b64_tr_b16 v[100:101], v29 offset:40960
  v_mfma_f32_32x32x16_bf16 a[176:191], v[84:87], v[48:51], 0
  ds_read_b64_tr_b16 v[102:103], v29 offset:43008
  v_mfma_f32_32x32x16_bf16 a[192:207], v[72:75], v[52:55], 0
  v_mfma_f32_32x32x16_bf16 a[208:223], v[76:79], v[52:55], 0
  v_mfma_f32_32x32x16_bf16 a[224:239], v[80:83], v[52:55], 0
  v_mfma_f32_32x32x16_bf16 a[240:255], v[84:87], v[52:55], 0
  s_waitcnt lgkmcnt(0)
  v_mfma_f32_32x32x16_bf16 a[0:15], v[88:91], v[56:59], a[0:15]
  ds_read_b128 v[40:43], v20 offset:0
  v_mfma_f32_32x32x16_bf16 a[16:31], v[92:95], v[56:59], a[16:31]
  ds_read_b64_tr_b16 v[72:73], v26 offset:49152
  v_mfma_f32_32x32x16_bf16 a[32:47], v[96:99], v[56:59], a[32:47]
  ds_read_b64_tr_b16 v[74:75], v26 offset:51200
  v_mfma_f32_32x32x16_bf16 a[48:63], v[100:103], v[56:59], a[48:63]
  ds_read_b128 v[44:47], v20 offset:4096
  v_mfma_f32_32x32x16_bf16 a[64:79], v[88:91], v[60:63], a[64:79]
  ds_read_b64_tr_b16 v[76:77], v27 offset:49152
  v_mfma_f32_32x32x16_bf16 a[80:95], v[92:95], v[60:63], a[80:95]
  ds_read_b64_tr_b16 v[78:79], v27 offset:51200
  v_mfma_f32_32x32x16_bf16 a[96:111], v[96:99], v[60:63], a[96:111]
  ds_read_b128 v[48:51], v20 offset:8192
  v_mfma_f32_32x32x16_bf16 a[112:127], v[100:103], v[60:63], a[112:127]
  ds_read_b64_tr_b16 v[80:81], v28 offset:49152
  v_mfma_f32_32x32x16_bf16 a[128:143], v[88:91], v[64:67], a[128:143]
  ds_read_b64_tr_b16 v[82:83], v28 offset:51200
  v_mfma_f32_32x32x16_bf16 a[144:159], v[92:95], v[64:67], a[144:159]
  ds_read_b128 v[52:55], v20 offset:12288
  v_mfma_f32_32x32x16_bf16 a[160:175], v[96:99], v[64:67], a[160:175]
  ds_read_b64_tr_b16 v[84:85], v29 offset:49152
  v_mfma_f32_32x32x16_bf16 a[176:191], v[100:103], v[64:67], a[176:191]
  ds_read_b64_tr_b16 v[86:87], v29 offset:51200
  v_mfma_f32_32x32x16_bf16 a[192:207], v[88:91], v[68:71], a[192:207]
  v_mfma_f32_32x32x16_bf16 a[208:223], v[92:95], v[68:71], a[208:223]
  v_mfma_f32_32x32x16_bf16 a[224:239], v[96:99], v[68:71], a[224:239]
  v_mfma_f32_32x32x16_bf16 a[240:255], v[100:103], v[68:71], a[240:255]
  s_waitcnt lgkmcnt(0)
  v_mfma_f32_32x32x16_bf16 a[0:15], v[72:75], v[40:43], a[0:15]
  ds_read_b128 v[56:59], v21 offset:0
  v_mfma_f32_32x32x16_bf16 a[16:31], v[76:79], v[40:43], a[16:31]
  ds_read_b64_tr_b16 v[88:89], v26 offset:57344
  v_mfma_f32_32x32x16_bf16 a[32:47], v[80:83], v[40:43], a[32:47]
  ds_read_b64_tr_b16 v[90:91], v26 offset:59392
  v_mfma_f32_32x32x16_bf16 a[48:63], v[84:87], v[40:43], a[48:63]
  ds_read_b128 v[60:63], v21 offset:4096
  v_mfma_f32_32x32x16_bf16 a[64:79], v[72:75], v[44:47], a[64:79]
  ds_read_b64_tr_b16 v[92:93], v27 offset:57344
  v_mfma_f32_32x32x16_bf16 a[80:95], v[76:79], v[44:47], a[80:95]
  ds_read_b64_tr_b16 v[94:95], v27 offset:59392
  v_mfma_f32_32x32x16_bf16 a[96:111], v[80:83], v[44:47], a[96:111]
  ds_read_b128 v[64:67], v21 offset:8192
  v_mfma_f32_32x32x16_bf16 a[112:127], v[84:87], v[44:47], a[112:127]
  ds_read_b64_tr_b16 v[96:97], v28 offset:57344
  v_mfma_f32_32x32x16_bf16 a[128:143], v[72:75], v[48:51], a[128:143]
  ds_read_b64_tr_b16 v[98:99], v28 offset:59392
  v_mfma_f32_32x32x16_bf16 a[144:159], v[76:79], v[48:51], a[144:159]
  ds_read_b128 v[68:71], v21 offset:12288
  v_mfma_f32_32x32x16_bf16 a[160:175], v[80:83], v[48:51], a[160:175]
  ds_read_b64_tr_b16 v[100:101], v29 offset:57344
  v_mfma_f32_32x32x16_bf16 a[176:191], v[84:87], v[48:51], a[176:191]
  ds_read_b64_tr_b16 v[102:103], v29 offset:59392
  v_mfma_f32_32x32x16_bf16 a[192:207], v[72:75], v[52:55], a[192:207]
  v_mfma_f32_32x32x16_bf16 a[208:223], v[76:79], v[52:55], a[208:223]
  v_mfma_f32_32x32x16_bf16 a[224:239], v[80:83], v[52:55], a[224:239]
  v_mfma_f32_32x32x16_bf16 a[240:255], v[84:87], v[52:55], a[240:255]
  s_waitcnt lgkmcnt(0)
  v_mfma_f32_32x32x16_bf16 a[0:15], v[88:91], v[56:59], a[0:15]
  s_waitcnt vmcnt(0)
  s_barrier
  s_add_u32 m0, s52, 0
  v_mfma_f32_32x32x16_bf16 a[16:31], v[92:95], v[56:59], a[16:31]
  buffer_load_dwordx4 v2, s[8:11], s20 offen  lds
  ds_read_b128 v[40:43], v22 offset:0
  s_add_u32 m0, s53, 0
  v_mfma_f32_32x32x16_bf16 a[32:47], v[96:99], v[56:59], a[32:47]
  buffer_load_dwordx4 v10, s[12:15], s21 offen lds
  ds_read_b64_tr_b16 v[72:73], v30 offset:32768
  v_mfma_f32_32x32x16_bf16 a[48:63], v[100:103], v[56:59], a[48:63]
  ds_read_b64_tr_b16 v[74:75], v30 offset:34816
  s_add_u32 m0, s52, 1024
  v_mfma_f32_32x32x16_bf16 a[64:79], v[88:91], v[60:63], a[64:79]
  buffer_load_dwordx4 v3, s[8:11], s20 offen  lds
  ds_read_b128 v[44:47], v22 offset:4096
  v_mfma_f32_32x32x16_bf16 a[80:95], v[92:95], v[60:63], a[80:95]
  ds_read_b64_tr_b16 v[76:77], v31 offset:32768
  s_add_u32 m0, s53, 1024
  v_mfma_f32_32x32x16_bf16 a[96:111], v[96:99], v[60:63], a[96:111]
  buffer_load_dwordx4 v11, s[12:15], s21 offen lds
  ds_read_b64_tr_b16 v[78:79], v31 offset:34816
  s_add_u32 m0, s52, 2048
  v_mfma_f32_32x32x16_bf16 a[112:127], v[100:103], v[60:63], a[112:127]
  buffer_load_dwordx4 v4, s[8:11], s20 offen  lds
  ds_read_b128 v[48:51], v22 offset:8192
  v_mfma_f32_32x32x16_bf16 a[128:143], v[88:91], v[64:67], a[128:143]
  ds_read_b64_tr_b16 v[80:81], v32 offset:32768
  s_add_u32 m0, s53, 2048
  v_mfma_f32_32x32x16_bf16 a[144:159], v[92:95], v[64:67], a[144:159]
  buffer_load_dwordx4 v12, s[12:15], s21 offen lds
  ds_read_b64_tr_b16 v[82:83], v32 offset:34816
  v_mfma_f32_32x32x16_bf16 a[160:175], v[96:99], v[64:67], a[160:175]
  ds_read_b128 v[52:55], v22 offset:12288
  s_add_u32 m0, s52, 3072
  v_mfma_f32_32x32x16_bf16 a[176:191], v[100:103], v[64:67], a[176:191]
  buffer_load_dwordx4 v5, s[8:11], s20 offen  lds
  ds_read_b64_tr_b16 v[84:85], v33 offset:32768
  s_add_u32 m0, s53, 3072
  v_mfma_f32_32x32x16_bf16 a[192:207], v[88:91], v[68:71], a[192:207]
  buffer_load_dwordx4 v13, s[12:15], s21 offen lds
  ds_read_b64_tr_b16 v[86:87], v33 offset:34816
  v_mfma_f32_32x32x16_bf16 a[208:223], v[92:95], v[68:71], a[208:223]
  s_add_u32 m0, s52, 4096
  v_mfma_f32_32x32x16_bf16 a[224:239], v[96:99], v[68:71], a[224:239]
  buffer_load_dwordx4 v6, s[8:11], s20 offen  lds
  v_mfma_f32_32x32x16_bf16 a[240:255], v[100:103], v[68:71], a[240:255]
  s_waitcnt lgkmcnt(0)
  s_add_u32 m0, s53, 4096
  v_mfma_f32_32x32x16_bf16 a[0:15], v[72:75], v[40:43], a[0:15]
  buffer_load_dwordx4 v14, s[12:15], s21 offen lds
  ds_read_b128 v[56:59], v23 offset:0
  v_mfma_f32_32x32x16_bf16 a[16:31], v[76:79], v[40:43], a[16:31]
  ds_read_b64_tr_b16 v[88:89], v30 offset:40960
  s_add_u32 m0, s52, 5120
  v_mfma_f32_32x32x16_bf16 a[32:47], v[80:83], v[40:43], a[32:47]
  buffer_load_dwordx4 v7, s[8:11], s20 offen  lds
  ds_read_b64_tr_b16 v[90:91], v30 offset:43008
  v_mfma_f32_32x32x16_bf16 a[48:63], v[84:87], v[40:43], a[48:63]
  ds_read_b128 v[60:63], v23 offset:4096
  s_add_u32 m0, s53, 5120
  v_mfma_f32_32x32x16_bf16 a[64:79], v[72:75], v[44:47], a[64:79]
  buffer_load_dwordx4 v15, s[12:15], s21 offen lds
  ds_read_b64_tr_b16 v[92:93], v31 offset:40960
  v_mfma_f32_32x32x16_bf16 a[80:95], v[76:79], v[44:47], a[80:95]
  ds_read_b64_tr_b16 v[94:95], v31 offset:43008
  s_add_u32 m0, s52, 6144
  v_mfma_f32_32x32x16_bf16 a[96:111], v[80:83], v[44:47], a[96:111]
  buffer_load_dwordx4 v8, s[8:11], s20 offen  lds
  ds_read_b128 v[64:67], v23 offset:8192
  v_mfma_f32_32x32x16_bf16 a[112:127], v[84:87], v[44:47], a[112:127]
  ds_read_b64_tr_b16 v[96:97], v32 offset:40960
  s_add_u32 m0, s53, 6144
  v_mfma_f32_32x32x16_bf16 a[128:143], v[72:75], v[48:51], a[128:143]
  buffer_load_dwordx4 v16, s[12:15], s21 offen lds
  ds_read_b64_tr_b16 v[98:99], v32 offset:43008
  v_mfma_f32_32x32x16_bf16 a[144:159], v[76:79], v[48:51], a[144:159]
  ds_read_b128 v[68:71], v23 offset:12288
  s_add_u32 m0, s52, 7168
  v_mfma_f32_32x32x16_bf16 a[160:175], v[80:83], v[48:51], a[160:175]
  buffer_load_dwordx4 v9, s[8:11], s20 offen  lds
  ds_read_b64_tr_b16 v[100:101], v33 offset:40960
  v_mfma_f32_32x32x16_bf16 a[176:191], v[84:87], v[48:51], a[176:191]
  ds_read_b64_tr_b16 v[102:103], v33 offset:43008
  s_add_u32 m0, s53, 7168
  v_mfma_f32_32x32x16_bf16 a[192:207], v[72:75], v[52:55], a[192:207]
  buffer_load_dwordx4 v17, s[12:15], s21 offen lds
  v_mfma_f32_32x32x16_bf16 a[208:223], v[76:79], v[52:55], a[208:223]
  s_add_u32 s20, s20, 128
  v_mfma_f32_32x32x16_bf16 a[224:239], v[80:83], v[52:55], a[224:239]
  s_add_u32 s21, s21, s51
  v_mfma_f32_32x32x16_bf16 a[240:255], v[84:87], v[52:55], a[240:255]
  s_waitcnt lgkmcnt(0)
  v_mfma_f32_32x32x16_bf16 a[0:15], v[88:91], v[56:59], a[0:15]
  ds_read_b128 v[40:43], v24 offset:0
  v_mfma_f32_32x32x16_bf16 a[16:31], v[92:95], v[56:59], a[16:31]
  ds_read_b64_tr_b16 v[72:73], v30 offset:49152
  v_mfma_f32_32x32x16_bf16 a[32:47], v[96:99], v[56:59], a[32:47]
  ds_read_b64_tr_b16 v[74:75], v30 offset:51200
  v_mfma_f32_32x32x16_bf16 a[48:63], v[100:103], v[56:59], a[48:63]
  ds_read_b128 v[44:47], v24 offset:4096
  v_mfma_f32_32x32x16_bf16 a[64:79], v[88:91], v[60:63], a[64:79]
  ds_read_b64_tr_b16 v[76:77], v31 offset:49152
  v_mfma_f32_32x32x16_bf16 a[80:95], v[92:95], v[60:63], a[80:95]
  ds_read_b64_tr_b16 v[78:79], v31 offset:51200
  v_mfma_f32_32x32x16_bf16 a[96:111], v[96:99], v[60:63], a[96:111]
  ds_read_b128 v[48:51], v24 offset:8192
  v_mfma_f32_32x32x16_bf16 a[112:127], v[100:103], v[60:63], a[112:127]
  ds_read_b64_tr_b16 v[80:81], v32 offset:49152
  v_mfma_f32_32x32x16_bf16 a[128:143], v[88:91], v[64:67], a[128:143]
  ds_read_b64_tr_b16 v[82:83], v32 offset:51200
  v_mfma_f32_32x32x16_bf16 a[144:159], v[92:95], v[64:67], a[144:159]
  ds_read_b128 v[52:55], v24 offset:12288
  v_mfma_f32_32x32x16_bf16 a[160:175], v[96:99], v[64:67], a[160:175]
  ds_read_b64_tr_b16 v[84:85], v33 offset:49152
  v_mfma_f32_32x32x16_bf16 a[176:191], v[100:103], v[64:67], a[176:191]
  ds_read_b64_tr_b16 v[86:87], v33 offset:51200
  v_mfma_f32_32x32x16_bf16 a[192:207], v[88:91], v[68:71], a[192:207]
  v_mfma_f32_32x32x16_bf16 a[208:223], v[92:95], v[68:71], a[208:223]
  v_mfma_f32_32x32x16_bf16 a[224:239], v[96:99], v[68:71], a[224:239]
  v_mfma_f32_32x32x16_bf16 a[240:255], v[100:103], v[68:71], a[240:255]
  s_waitcnt lgkmcnt(0)
  v_mfma_f32_32x32x16_bf16 a[0:15], v[72:75], v[40:43], a[0:15]
  ds_read_b128 v[56:59], v25 offset:0
  v_mfma_f32_32x32x16_bf16 a[16:31], v[76:79], v[40:43], a[16:31]
  ds_read_b64_tr_b16 v[88:89], v30 offset:57344
  v_mfma_f32_32x32x16_bf16 a[32:47], v[80:83], v[40:43], a[32:47]
  ds_read_b64_tr_b16 v[90:91], v30 offset:59392
  v_mfma_f32_32x32x16_bf16 a[48:63], v[84:87], v[40:43], a[48:63]
  ds_read_b128 v[60:63], v25 offset:4096
  v_mfma_f32_32x32x16_bf16 a[64:79], v[72:75], v[44:47], a[64:79]
  ds_read_b64_tr_b16 v[92:93], v31 offset:57344
  v_mfma_f32_32x32x16_bf16 a[80:95], v[76:79], v[44:47], a[80:95]
  ds_read_b64_tr_b16 v[94:95], v31 offset:59392
  v_mfma_f32_32x32x16_bf16 a[96:111], v[80:83], v[44:47], a[96:111]
  ds_read_b128 v[64:67], v25 offset:8192
  v_mfma_f32_32x32x16_bf16 a[112:127], v[84:87], v[44:47], a[112:127]
  ds_read_b64_tr_b16 v[96:97], v32 offset:57344
  v_mfma_f32_32x32x16_bf16 a[128:143], v[72:75], v[48:51], a[128:143]
  ds_read_b64_tr_b16 v[98:99], v32 offset:59392
  v_mfma_f32_32x32x16_bf16 a[144:159], v[76:79], v[48:51], a[144:159]
  ds_read_b128 v[68:71], v25 offset:12288
  v_mfma_f32_32x32x16_bf16 a[160:175], v[80:83], v[48:51], a[160:175]
  ds_read_b64_tr_b16 v[100:101], v33 offset:57344
  v_mfma_f32_32x32x16_bf16 a[176:191], v[84:87], v[48:51], a[176:191]
  ds_read_b64_tr_b16 v[102:103], v33 offset:59392
  v_mfma_f32_32x32x16_bf16 a[192:207], v[72:75], v[52:55], a[192:207]
  v_mfma_f32_32x32x16_bf16 a[208:223], v[76:79], v[52:55], a[208:223]
  v_mfma_f32_32x32x16_bf16 a[224:239], v[80:83], v[52:55], a[224:239]
  v_mfma_f32_32x32x16_bf16 a[240:255], v[84:87], v[52:55], a[240:255]
  s_waitcnt lgkmcnt(0)
  v_mfma_f32_32x32x16_bf16 a[0:15], v[88:91], v[56:59], a[0:15]
  s_waitcnt vmcnt(0)
  s_barrier
  s_add_u32 m0, s52, 65536
  v_mfma_f32_32x32x16_bf16 a[16:31], v[92:95], v[56:59], a[16:31]
  buffer_load_dwordx4 v2, s[8:11], s20 offen  lds
  ds_read_b128 v[40:43], v18 offset:0
  s_add_u32 m0, s53, 65536
  v_mfma_f32_32x32x16_bf16 a[32:47], v[96:99], v[56:59], a[32:47]
  buffer_load_dwordx4 v10, s[12:15], s21 offen lds
  ds_read_b64_tr_b16 v[72:73], v26 offset:32768
  v_mfma_f32_32x32x16_bf16 a[48:63], v[100:103], v[56:59], a[48:63]
  ds_read_b64_tr_b16 v[74:75], v26 offset:34816
  s_add_u32 m0, s52, 66560
  v_mfma_f32_32x32x16_bf16 a[64:79], v[88:91], v[60:63], a[64:79]
  buffer_load_dwordx4 v3, s[8:11], s20 offen  lds
  ds_read_b128 v[44:47], v18 offset:4096
  v_mfma_f32_32x32x16_bf16 a[80:95], v[92:95], v[60:63], a[80:95]
  ds_read_b64_tr_b16 v[76:77], v27 offset:32768
  s_add_u32 m0, s53, 66560
  v_mfma_f32_32x32x16_bf16 a[96:111], v[96:99], v[60:63], a[96:111]
  buffer_load_dwordx4 v11, s[12:15], s21 offen lds
  ds_read_b64_tr_b16 v[78:79], v27 offset:34816
  s_add_u32 m0, s52, 67584
  v_mfma_f32_32x32x16_bf16 a[112:127], v[100:103], v[60:63], a[112:127]
  buffer_load_dwordx4 v4, s[8:11], s20 offen  lds
  ds_read_b128 v[48:51], v18 offset:8192
  v_mfma_f32_32x32x16_bf16 a[128:143], v[88:91], v[64:67], a[128:143]
  ds_read_b64_tr_b16 v[80:81], v28 offset:32768
  s_add_u32 m0, s53, 67584
  v_mfma_f32_32x32x16_bf16 a[144:159], v[92:95], v[64:67], a[144:159]
  buffer_load_dwordx4 v12, s[12:15], s21 offen lds
  ds_read_b64_tr_b16 v[82:83], v28 offset:34816
  v_mfma_f32_32x32x16_bf16 a[160:175], v[96:99], v[64:67], a[160:175]
  ds_read_b128 v[52:55], v18 offset:12288
  s_add_u32 m0, s52, 68608
  v_mfma_f32_32x32x16_bf16 a[176:191], v[100:103], v[64:67], a[176:191]
  buffer_load_dwordx4 v5, s[8:11], s20 offen  lds
  ds_read_b64_tr_b16 v[84:85], v29 offset:32768
  s_add_u32 m0, s53, 68608
  v_mfma_f32_32x32x16_bf16 a[192:207], v[88:91], v[68:71], a[192:207]
  buffer_load_dwordx4 v13, s[12:15], s21 offen lds
  ds_read_b64_tr_b16 v[86:87], v29 offset:34816
  v_mfma_f32_32x32x16_bf16 a[208:223], v[92:95], v[68:71], a[208:223]
  s_add_u32 m0, s52, 69632
  v_mfma_f32_32x32x16_bf16 a[224:239], v[96:99], v[68:71], a[224:239]
  buffer_load_dwordx4 v6, s[8:11], s20 offen  lds
  v_mfma_f32_32x32x16_bf16 a[240:255], v[100:103], v[68:71], a[240:255]
L_g1_loop:
  s_sub_u32 s25, s25, 1
  s_cmp_eq_u32 s25, 0
  s_cbranch_scc1 L_g1_fin
  s_waitcnt lgkmcnt(0)
  s_add_u32 m0, s53, 69632
  v_mfma_f32_32x32x16_bf16 a[0:15], v[72:75], v[40:43], a[0:15]
  buffer_load_dwordx4 v14, s[12:15], s21 offen lds
  ds_read_b128 v[56:59], v19 offset:0
  v_mfma_f32_32x32x16_bf16 a[16:31], v[76:79], v[40:43], a[16:31]
  ds_read_b64_tr_b16 v[88:89], v26 offset:40960
  s_add_u32 m0, s52, 70656
  v_mfma_f32_32x32x16_bf16 a[32:47], v[80:83], v[40:43], a[32:47]
  buffer_load_dwordx4 v7, s[8:11], s20 offen  lds
  ds_read_b64_tr_b16 v[90:91], v26 offset:43008
  v_mfma_f32_32x32x16_bf16 a[48:63], v[84:87], v[40:43], a[48:63]
  ds_read_b128 v[60:63], v19 offset:4096
  s_add_u32 m0, s53, 70656
  v_mfma_f32_32x32x16_bf16 a[64:79], v[72:75], v[44:47], a[64:79]
  buffer_load_dwordx4 v15, s[12:15], s21 offen lds
  ds_read_b64_tr_b16 v[92:93], v27 offset:40960
  v_mfma_f32_32x32x16_bf16 a[80:95], v[76:79], v[44:47], a[80:95]
  ds_read_b64_tr_b16 v[94:95], v27 offset:43008
  s_add_u32 m0, s52, 71680
  v_mfma_f32_32x32x16_bf16 a[96:111], v[80:83], v[44:47], a[96:111]
  buffer_load_dwordx4 v8, s[8:11], s20 offen  lds
  ds_read_b128 v[64:67], v19 offset:8192
  v_mfma_f32_32x32x16_bf16 a[112:127], v[84:87], v[44:47], a[112:127]
  ds_read_b64_tr_b16 v[96:97], v28 offset:40960
  s_add_u32 m0, s53, 71680
  v_mfma_f32_32x32x16_bf16 a[128:143], v[72:75], v[48:51], a[128:143]
  buffer_load_dwordx4 v16, s[12:15], s21 offen lds
  ds_read_b64_tr_b16 v[98:99], v28 offset:43008
  v_mfma_f32_32x32x16_bf16 a[144:159], v[76:79], v[48:51], a[144:159]
  ds_read_b128 v[68:71], v19 offset:12288
  s_add_u32 m0, s52, 72704
  v_mfma_f32_32x32x16_bf16 a[160:175], v[80:83], v[48:51], a[160:175]
  buffer_load_dwordx4 v9, s[8:11], s20 offen  lds
  ds_read_b64_tr_b16 v[100:101], v29 offset:40960
  v_mfma_f32_32x32x16_bf16 a[176:191], v[84:87], v[48:51], a[176:191]
  ds_read_b64_tr_b16 v[102:103], v29 offset:43008
  s_add_u32 m0, s53, 72704
  v_mfma_f32_32x32x16_bf16 a[192:207], v[72:75], v[52:55], a[192:207]
  buffer_load_dwordx4 v17, s[12:15], s21 offen lds
  v_mfma_f32_32x32x16_bf16 a[208:223], v[76:79], v[52:55], a[208:223]
  s_add_u32 s20, s20, 128
  v_mfma_f32_32x32x16_bf16 a[224:239], v[80:83], v[52:55], a[224:239]
  s_add_u32 s21, s21, s51
  v_mfma_f32_32x32x16_bf16 a[240:255], v[84:87], v[52:55], a[240:255]
  s_waitcnt lgkmcnt(0)
  v_mfma_f32_32x32x16_bf16 a[0:15], v[88:91], v[56:59], a[0:15]
  ds_read_b128 v[40:43], v20 offset:0
  v_mfma_f32_32x32x16_bf16 a[16:31], v[92:95], v[56:59], a[16:31]
  ds_read_b64_tr_b16 v[72:73], v26 offset:49152
  v_mfma_f32_32x32x16_bf16 a[32:47], v[96:99], v[56:59], a[32:47]
  ds_read_b64_tr_b16 v[74:75], v26 offset:51200
  v_mfma_f32_32x32x16_bf16 a[48:63], v[100:103], v[56:59], a[48:63]
  ds_read_b128 v[44:47], v20 offset:4096
  v_mfma_f32_32x32x16_bf16 a[64:79], v[88:91], v[60:63], a[64:79]
  ds_read_b64_tr_b16 v[76:77], v27 offset:49152
  v_mfma_f32_32x32x16_bf16 a[80:95], v[92:95], v[60:63], a[80:95]
  ds_read_b64_tr_b16 v[78:79], v27 offset:51200
  v_mfma_f32_32x32x16_bf16 a[96:111], v[96:99], v[60:63], a[96:111]
  ds_read_b128 v[48:51], v20 offset:8192
  v_mfma_f32_32x32x16_bf16 a[112:127], v[100:103], v[60:63], a[112:127]
  ds_read_b64_tr_b16 v[80:81], v28 offset:49152
  v_mfma_f32_32x32x16_bf16 a[128:143], v[88:91], v[64:67], a[128:143]
  ds_read_b64_tr_b16 v[82:83], v28 offset:51200
  v_mfma_f32_32x32x16_bf16 a[144:159], v[92:95], v[64:67], a[144:159]
  ds_read_b128 v[52:55], v20 offset:12288
  v_mfma_f32_32x32x16_bf16 a[160:175], v[96:99], v[64:67], a[160:175]
  ds_read_b64_tr_b16 v[84:85], v29 offset:49152
  v_mfma_f32_32x32x16_bf16 a[176:191], v[100:103], v[64:67], a[176:191]
  ds_read_b64_tr_b16 v[86:87], v29 offset:51200
  v_mfma_f32_32x32x16_bf16 a[192:207], v[88:91], v[68:71], a[192:207]
  v_mfma_f32_32x32x16_bf16 a[208:223], v[92:95], v[68:71], a[208:223]
  v_mfma_f32_32x32x16_bf16 a[224:239], v[96:99], v[68:71], a[224:239]
  v_mfma_f32_32x32x16_bf16 a[240:255], v[100:103], v[68:71], a[240:255]
  s_waitcnt lgkmcnt(0)
  v_mfma_f32_32x32x16_bf16 a[0:15], v[72:75], v[40:43], a[0:15]
  ds_read_b128 v[56:59], v21 offset:0
  v_mfma_f32_32x32x16_bf16 a[16:31], v[76:79], v[40:43], a[16:31]
  ds_read_b64_tr_b16 v[88:89], v26 offset:57344
  v_mfma_f32_32x32x16_bf16 a[32:47], v[80:83], v[40:43], a[32:47]
  ds_read_b64_tr_b16 v[90:91], v26 offset:59392
  v_mfma_f32_32x32x16_bf16 a[48:63], v[84:87], v[40:43], a[48:63]
  ds_read_b128 v[60:63], v21 offset:4096
  v_mfma_f32_32x32x16_bf16 a[64:79], v[72:75], v[44:47], a[64:79]
  ds_read_b64_tr_b16 v[92:93], v27 offset:57344
  v_mfma_f32_32x32x16_bf16 a[80:95], v[76:79], v[44:47], a[80:95]
  ds_read_b64_tr_b16 v[94:95], v27 offset:59392
  v_mfma_f32_32x32x16_bf16 a[96:111], v[80:83], v[44:47], a[96:111]
  ds_read_b128 v[64:67], v21 offset:8192
  v_mfma_f32_32x32x16_bf16 a[112:127], v[84:87], v[44:47], a[112:127]
  ds_read_b64_tr_b16 v[96:97], v28 offset:57344
  v_mfma_f32_32x32x16_bf16 a[128:143], v[72:75], v[48:51], a[128:143]
  ds_read_b64_tr_b16 v[98:99], v28 offset:59392
  v_mfma_f32_32x32x16_bf16 a[144:159], v[76:79], v[48:51], a[144:159]
  ds_read_b128 v[68:71], v21 offset:12288
  v_mfma_f32_32x32x16_bf16 a[160:175], v[80:83], v[48:51], a[160:175]
  ds_read_b64_tr_b16 v[100:101], v29 offset:57344
  v_mfma_f32_32x32x16_bf16 a[176:191], v[84:87], v[48:51], a[176:191]
  ds_read_b64_tr_b16 v[102:103], v29 offset:59392
  v_mfma_f32_32x32x16_bf16 a[192:207], v[72:75], v[52:55], a[192:207]
  v_mfma_f32_32x32x16_bf16 a[208:223], v[76:79], v[52:55], a[208:223]
  v_mfma_f32_32x32x16_bf16 a[224:239], v[80:83], v[52:55], a[224:239]
  v_mfma_f32_32x32x16_bf16 a[240:255], v[84:87], v[52:55], a[240:255]
  s_waitcnt lgkmcnt(0)
  v_mfma_f32_32x32x16_bf16 a[0:15], v[88:91], v[56:59], a[0:15]
  s_waitcnt vmcnt(0)
  s_barrier
  s_add_u32 m0, s52, 0
  v_mfma_f32_32x32x16_bf16 a[16:31], v[92:95], v[56:59], a[16:31]
  buffer_load_dwordx4 v2, s[8:11], s20 offen  lds
  ds_read_b128 v[40:43], v22 offset:0
  s_add_u32 m0, s53, 0
  v_mfma_f32_32x32x16_bf16 a[32:47], v[96:99], v[56:59], a[32:47]
  buffer_load_dwordx4 v10, s[12:15], s21 offen lds
  ds_read_b64_tr_b16 v[72:73], v30 offset:32768
  v_mfma_f32_32x32x16_bf16 a[48:63], v[100:103], v[56:59], a[48:63]
  ds_read_b64_tr_b16 v[74:75], v30 offset:34816
  s_add_u32 m0, s52, 1024
  v_mfma_f32_32x32x16_bf16 a[64:79], v[88:91], v[60:63], a[64:79]
  buffer_load_dwordx4 v3, s[8:11], s20 offen  lds
  ds_read_b128 v[44:47], v22 offset:4096
  v_mfma_f32_32x32x16_bf16 a[80:95], v[92:95], v[60:63], a[80:95]
  ds_read_b64_tr_b16 v[76:77], v31 offset:32768
  s_add_u32 m0, s53, 1024
  v_mfma_f32_32x32x16_bf16 a[96:111], v[96:99], v[60:63], a[96:111]
  buffer_load_dwordx4 v11, s[12:15], s21 offen lds
  ds_read_b64_tr_b16 v[78:79], v31 offset:34816
  s_add_u32 m0, s52, 2048
  v_mfma_f32_32x32x16_bf16 a[112:127], v[100:103], v[60:63], a[112:127]
  buffer_load_dwordx4 v4, s[8:11], s20 offen  lds
  ds_read_b128 v[48:51], v22 offset:8192
  v_mfma_f32_32x32x16_bf16 a[128:143], v[88:91], v[64:67], a[128:143]
  ds_read_b64_tr_b16 v[80:81], v32 offset:32768
  s_add_u32 m0, s53, 2048
  v_mfma_f32_32x32x16_bf16 a[144:159], v[92:95], v[64:67], a[144:159]
  buffer_load_dwordx4 v12, s[12:15], s21 offen lds
  ds_read_b64_tr_b16 v[82:83], v32 offset:34816
  v_mfma_f32_32x32x16_bf16 a[160:175], v[96:99], v[64:67], a[160:175]
  ds_read_b128 v[52:55], v22 offset:12288
  s_add_u32 m0, s52, 3072
  v_mfma_f32_32x32x16_bf16 a[176:191], v[100:103], v[64:67], a[176:191]
  buffer_load_dwordx4 v5, s[8:11], s20 offen  lds
  ds_read_b64_tr_b16 v[84:85], v33 offset:32768
  s_add_u32 m0, s53, 3072
  v_mfma_f32_32x32x16_bf16 a[192:207], v[88:91], v[68:71], a[192:207]
  buffer_load_dwordx4 v13, s[12:15], s21 offen lds
  ds_read_b64_tr_b16 v[86:87], v33 offset:34816
  v_mfma_f32_32x32x16_bf16 a[208:223], v[92:95], v[68:71], a[208:223]
  s_add_u32 m0, s52, 4096
  v_mfma_f32_32x32x16_bf16 a[224:239], v[96:99], v[68:71], a[224:239]
  buffer_load_dwordx4 v6, s[8:11], s20 offen  lds
  v_mfma_f32_32x32x16_bf16 a[240:255], v[100:103], v[68:71], a[240:255]
  s_waitcnt lgkmcnt(0)
  s_add_u32 m0, s53, 4096
  v_mfma_f32_32x32x16_bf16 a[0:15], v[72:75], v[40:43], a[0:15]
  buffer_load_dwordx4 v14, s[12:15], s21 offen lds
  ds_read_b128 v[56:59], v23 offset:0
  v_mfma_f32_32x32x16_bf16 a[16:31], v[76:79], v[40:43], a[16:31]
  ds_read_b64_tr_b16 v[88:89], v30 offset:40960
  s_add_u32 m0, s52, 5120
  v_mfma_f32_32x32x16_bf16 a[32:47], v[80:83], v[40:43], a[32:47]
  buffer_load_dwordx4 v7, s[8:11], s20 offen  lds
  ds_read_b64_tr_b16 v[90:91], v30 offset:43008
  v_mfma_f32_32x32x16_bf16 a[48:63], v[84:87], v[40:43], a[48:63]
  ds_read_b128 v[60:63], v23 offset:4096
  s_add_u32 m0, s53, 5120
  v_mfma_f32_32x32x16_bf16 a[64:79], v[72:75], v[44:47], a[64:79]
  buffer_load_dwordx4 v15, s[12:15], s21 offen lds
  ds_read_b64_tr_b16 v[92:93], v31 offset:40960
  v_mfma_f32_32x32x16_bf16 a[80:95], v[76:79], v[44:47], a[80:95]
  ds_read_b64_tr_b16 v[94:95], v31 offset:43008
  s_add_u32 m0, s52, 6144
  v_mfma_f32_32x32x16_bf16 a[96:111], v[80:83], v[44:47], a[96:111]
  buffer_load_dwordx4 v8, s[8:11], s20 offen  lds
  ds_read_b128 v[64:67], v23 offset:8192
  v_mfma_f32_32x32x16_bf16 a[112:127], v[84:87], v[44:47], a[112:127]
  ds_read_b64_tr_b16 v[96:97], v32 offset:40960
  s_add_u32 m0, s53, 6144
  v_mfma_f32_32x32x16_bf16 a[128:143], v[72:75], v[48:51], a[128:143]
  buffer_load_dwordx4 v16, s[12:15], s21 offen lds
  ds_read_b64_tr_b16 v[98:99], v32 offset:43008
  v_mfma_f32_32x32x16_bf16 a[144:159], v[76:79], v[48:51], a[144:159]
  ds_read_b128 v[68:71], v23 offset:12288
  s_add_u32 m0, s52, 7168
  v_mfma_f32_32x32x16_bf16 a[160:175], v[80:83], v[48:51], a[160:175]
  buffer_load_dwordx4 v9, s[8:11], s20 offen  lds
  ds_read_b64_tr_b16 v[100:101], v33 offset:40960
  v_mfma_f32_32x32x16_bf16 a[176:191], v[84:87], v[48:51], a[176:191]
  ds_read_b64_tr_b16 v[102:103], v33 offset:43008
  s_add_u32 m0, s53, 7168
  v_mfma_f32_32x32x16_bf16 a[192:207], v[72:75], v[52:55], a[192:207]
  buffer_load_dwordx4 v17, s[12:15], s21 offen lds
  v_mfma_f32_32x32x16_bf16 a[208:223], v[76:79], v[52:55], a[208:223]
  s_add_u32 s20, s20, 128
  v_mfma_f32_32x32x16_bf16 a[224:239], v[80:83], v[52:55], a[224:239]
  s_add_u32 s21, s21, s51
  v_mfma_f32_32x32x16_bf16 a[240:255], v[84:87], v[52:55], a[240:255]
  s_waitcnt lgkmcnt(0)
  v_mfma_f32_32x32x16_bf16 a[0:15], v[88:91], v[56:59], a[0:15]
  ds_read_b128 v[40:43], v24 offset:0
  v_mfma_f32_32x32x16_bf16 a[16:31], v[92:95], v[56:59], a[16:31]
  ds_read_b64_tr_b16 v[72:73], v30 offset:49152
  v_mfma_f32_32x32x16_bf16 a[32:47], v[96:99], v[56:59], a[32:47]
  ds_read_b64_tr_b16 v[74:75], v30 offset:51200
  v_mfma_f32_32x32x16_bf16 a[48:63], v[100:103], v[56:59], a[48:63]
  ds_read_b128 v[44:47], v24 offset:4096
  v_mfma_f32_32x32x16_bf16 a[64:79], v[88:91], v[60:63], a[64:79]
  ds_read_b64_tr_b16 v[76:77], v31 offset:49152
  v_mfma_f32_32x32x16_bf16 a[80:95], v[92:95], v[60:63], a[80:95]
  ds_read_b64_tr_b16 v[78:79], v31 offset:51200
  v_mfma_f32_32x32x16_bf16 a[96:111], v[96:99], v[60:63], a[96:111]
  ds_read_b128 v[48:51], v24 offset:8192
  v_mfma_f32_32x32x16_bf16 a[112:127], v[100:103], v[60:63], a[112:127]
  ds_read_b64_tr_b16 v[80:81], v32 offset:49152
  v_mfma_f32_32x32x16_bf16 a[128:143], v[88:91], v[64:67], a[128:143]
  ds_read_b64_tr_b16 v[82:83], v32 offset:51200
  v_mfma_f32_32x32x16_bf16 a[144:159], v[92:95], v[64:67], a[144:159]
  ds_read_b128 v[52:55], v24 offset:12288
  v_mfma_f32_32x32x16_bf16 a[160:175], v[96:99], v[64:67], a[160:175]
  ds_read_b64_tr_b16 v[84:85], v33 offset:49152
  v_mfma_f32_32x32x16_bf16 a[176:191], v[100:103], v[64:67], a[176:191]
  ds_read_b64_tr_b16 v[86:87], v33 offset:51200
  v_mfma_f32_32x32x16_bf16 a[192:207], v[88:91], v[68:71], a[192:207]
  v_mfma_f32_32x32x16_bf16 a[208:223], v[92:95], v[68:71], a[208:223]
  v_mfma_f32_32x32x16_bf16 a[224:239], v[96:99], v[68:71], a[224:239]
  v_mfma_f32_32x32x16_bf16 a[240:255], v[100:103], v[68:71], a[240:255]
  s_waitcnt lgkmcnt(0)
  v_mfma_f32_32x32x16_bf16 a[0:15], v[72:75], v[40:43], a[0:15]
  ds_read_b128 v[56:59], v25 offset:0
  v_mfma_f32_32x32x16_bf16 a[16:31], v[76:79], v[40:43], a[16:31]
  ds_read_b64_tr_b16 v[88:89], v30 offset:57344
  v_mfma_f32_32x32x16_bf16 a[32:47], v[80:83], v[40:43], a[32:47]
  ds_read_b64_tr_b16 v[90:91], v30 offset:59392
  v_mfma_f32_32x32x16_bf16 a[48:63], v[84:87], v[40:43], a[48:63]
  ds_read_b128 v[60:63], v25 offset:4096
  v_mfma_f32_32x32x16_bf16 a[64:79], v[72:75], v[44:47], a[64:79]
  ds_read_b64_tr_b16 v[92:93], v31 offset:57344
  v_mfma_f32_32x32x16_bf16 a[80:95], v[76:79], v[44:47], a[80:95]
  ds_read_b64_tr_b16 v[94:95], v31 offset:59392
  v_mfma_f32_32x32x16_bf16 a[96:111], v[80:83], v[44:47], a[96:111]
  ds_read_b128 v[64:67], v25 offset:8192
  v_mfma_f32_32x32x16_bf16 a[112:127], v[84:87], v[44:47], a[112:127]
  ds_read_b64_tr_b16 v[96:97], v32 offset:57344
  v_mfma_f32_32x32x16_bf16 a[128:143], v[72:75], v[48:51], a[128:143]
  ds_read_b64_tr_b16 v[98:99], v32 offset:59392
  v_mfma_f32_32x32x16_bf16 a[144:159], v[76:79], v[48:51], a[144:159]
  ds_read_b128 v[68:71], v25 offset:12288
  v_mfma_f32_32x32x16_bf16 a[160:175], v[80:83], v[48:51], a[160:175]
  ds_read_b64_tr_b16 v[100:101], v33 offset:57344
  v_mfma_f32_32x32x16_bf16 a[176:191], v[84:87], v[48:51], a[176:191]
  ds_read_b64_tr_b16 v[102:103], v33 offset:59392
  v_mfma_f32_32x32x16_bf16 a[192:207], v[72:75], v[52:55], a[192:207]
  v_mfma_f32_32x32x16_bf16 a[208:223], v[76:79], v[52:55], a[208:223]
  v_mfma_f32_32x32x16_bf16 a[224:239], v[80:83], v[52:55], a[224:239]
  v_mfma_f32_32x32x16_bf16 a[240:255], v[84:87], v[52:55], a[240:255]
  s_waitcnt lgkmcnt(0)
  v_mfma_f32_32x32x16_bf16 a[0:15], v[88:91], v[56:59], a[0:15]
  s_waitcnt vmcnt(0)
  s_barrier
  s_add_u32 m0, s52, 65536
  v_mfma_f32_32x32x16_bf16 a[16:31], v[92:95], v[56:59], a[16:31]
  buffer_load_dwordx4 v2, s[8:11], s20 offen  lds
  ds_read_b128 v[40:43], v18 offset:0
  s_add_u32 m0, s53, 65536
  v_mfma_f32_32x32x16_bf16 a[32:47], v[96:99], v[56:59], a[32:47]
  buffer_load_dwordx4 v10, s[12:15], s21 offen lds
  ds_read_b64_tr_b16 v[72:73], v26 offset:32768
  v_mfma_f32_32x32x16_bf16 a[48:63], v[100:103], v[56:59], a[48:63]
  ds_read_b64_tr_b16 v[74:75], v26 offset:34816
  s_add_u32 m0, s52, 66560
  v_mfma_f32_32x32x16_bf16 a[64:79], v[88:91], v[60:63], a[64:79]
  buffer_load_dwordx4 v3, s[8:11], s20 offen  lds
  ds_read_b128 v[44:47], v18 offset:4096
  v_mfma_f32_32x32x16_bf16 a[80:95], v[92:95], v[60:63], a[80:95]
  ds_read_b64_tr_b16 v[76:77], v27 offset:32768
  s_add_u32 m0, s53, 66560
  v_mfma_f32_32x32x16_bf16 a[96:111], v[96:99], v[60:63], a[96:111]
  buffer_load_dwordx4 v11, s[12:15], s21 offen lds
  ds_read_b64_tr_b16 v[78:79], v27 offset:34816
  s_add_u32 m0, s52, 67584
  v_mfma_f32_32x32x16_bf16 a[112:127], v[100:103], v[60:63], a[112:127]
  buffer_load_dwordx4 v4, s[8:11], s20 offen  lds
  ds_read_b128 v[48:51], v18 offset:8192
  v_mfma_f32_32x32x16_bf16 a[128:143], v[88:91], v[64:67], a[128:143]
  ds_read_b64_tr_b16 v[80:81], v28 offset:32768
  s_add_u32 m0, s53, 67584
  v_mfma_f32_32x32x16_bf16 a[144:159], v[92:95], v[64:67], a[144:159]
  buffer_load_dwordx4 v12, s[12:15], s21 offen lds
  ds_read_b64_tr_b16 v[82:83], v28 offset:34816
  v_mfma_f32_32x32x16_bf16 a[160:175], v[96:99], v[64:67], a[160:175]
  ds_read_b128 v[52:55], v18 offset:12288
  s_add_u32 m0, s52, 68608
  v_mfma_f32_32x32x16_bf16 a[176:191], v[100:103], v[64:67], a[176:191]
  buffer_load_dwordx4 v5, s[8:11], s20 offen  lds
  ds_read_b64_tr_b16 v[84:85], v29 offset:32768
  s_add_u32 m0, s53, 68608
  v_mfma_f32_32x32x16_bf16 a[192:207], v[88:91], v[68:71], a[192:207]
  buffer_load_dwordx4 v13, s[12:15], s21 offen lds
  ds_read_b64_tr_b16 v[86:87], v29 offset:34816
  v_mfma_f32_32x32x16_bf16 a[208:223], v[92:95], v[68:71], a[208:223]
  s_add_u32 m0, s52, 69632
  v_mfma_f32_32x32x16_bf16 a[224:239], v[96:99], v[68:71], a[224:239]
  buffer_load_dwordx4 v6, s[8:11], s20 offen  lds
  v_mfma_f32_32x32x16_bf16 a[240:255], v[100:103], v[68:71], a[240:255]
  s_branch L_g1_loop
L_g1_fin:
  s_waitcnt lgkmcnt(0)
  s_add_u32 m0, s53, 69632
  v_mfma_f32_32x32x16_bf16 a[0:15], v[72:75], v[40:43], a[0:15]
  buffer_load_dwordx4 v14, s[12:15], s21 offen lds
  ds_read_b128 v[56:59], v19 offset:0
  v_mfma_f32_32x32x16_bf16 a[16:31], v[76:79], v[40:43], a[16:31]
  ds_read_b64_tr_b16 v[88:89], v26 offset:40960
  s_add_u32 m0, s52, 70656
  v_mfma_f32_32x32x16_bf16 a[32:47], v[80:83], v[40:43], a[32:47]
  buffer_load_dwordx4 v7, s[8:11], s20 offen  lds
  ds_read_b64_tr_b16 v[90:91], v26 offset:43008
  v_mfma_f32_32x32x16_bf16 a[48:63], v[84:87], v[40:43], a[48:63]
  ds_read_b128 v[60:63], v19 offset:4096
  s_add_u32 m0, s53, 70656
  v_mfma_f32_32x32x16_bf16 a[64:79], v[72:75], v[44:47], a[64:79]
  buffer_load_dwordx4 v15, s[12:15], s21 offen lds
  ds_read_b64_tr_b16 v[92:93], v27 offset:40960
  v_mfma_f32_32x32x16_bf16 a[80:95], v[76:79], v[44:47], a[80:95]
  ds_read_b64_tr_b16 v[94:95], v27 offset:43008
  s_add_u32 m0, s52, 71680
  v_mfma_f32_32x32x16_bf16 a[96:111], v[80:83], v[44:47], a[96:111]
  buffer_load_dwordx4 v8, s[8:11], s20 offen  lds
  ds_read_b128 v[64:67], v19 offset:8192
  v_mfma_f32_32x32x16_bf16 a[112:127], v[84:87], v[44:47], a[112:127]
  ds_read_b64_tr_b16 v[96:97], v28 offset:40960
  s_add_u32 m0, s53, 71680
  v_mfma_f32_32x32x16_bf16 a[128:143], v[72:75], v[48:51], a[128:143]
  buffer_load_dwordx4 v16, s[12:15], s21 offen lds
  ds_read_b64_tr_b16 v[98:99], v28 offset:43008
  v_mfma_f32_32x32x16_bf16 a[144:159], v[76:79], v[48:51], a[144:159]
  ds_read_b128 v[68:71], v19 offset:12288
  s_add_u32 m0, s52, 72704
  v_mfma_f32_32x32x16_bf16 a[160:175], v[80:83], v[48:51], a[160:175]
  buffer_load_dwordx4 v9, s[8:11], s20 offen  lds
  ds_read_b64_tr_b16 v[100:101], v29 offset:40960
  v_mfma_f32_32x32x16_bf16 a[176:191], v[84:87], v[48:51], a[176:191]
  ds_read_b64_tr_b16 v[102:103], v29 offset:43008
  s_add_u32 m0, s53, 72704
  v_mfma_f32_32x32x16_bf16 a[192:207], v[72:75], v[52:55], a[192:207]
  buffer_load_dwordx4 v17, s[12:15], s21 offen lds
  v_mfma_f32_32x32x16_bf16 a[208:223], v[76:79], v[52:55], a[208:223]
  s_add_u32 s20, s20, 128
  v_mfma_f32_32x32x16_bf16 a[224:239], v[80:83], v[52:55], a[224:239]
  s_add_u32 s21, s21, s51
  v_mfma_f32_32x32x16_bf16 a[240:255], v[84:87], v[52:55], a[240:255]
  s_waitcnt lgkmcnt(0)
  v_mfma_f32_32x32x16_bf16 a[0:15], v[88:91], v[56:59], a[0:15]
  ds_read_b128 v[40:43], v20 offset:0
  v_mfma_f32_32x32x16_bf16 a[16:31], v[92:95], v[56:59], a[16:31]
  ds_read_b64_tr_b16 v[72:73], v26 offset:49152
  v_mfma_f32_32x32x16_bf16 a[32:47], v[96:99], v[56:59], a[32:47]
  ds_read_b64_tr_b16 v[74:75], v26 offset:51200
  v_mfma_f32_32x32x16_bf16 a[48:63], v[100:103], v[56:59], a[48:63]
  ds_read_b128 v[44:47], v20 offset:4096
  v_mfma_f32_32x32x16_bf16 a[64:79], v[88:91], v[60:63], a[64:79]
  ds_read_b64_tr_b16 v[76:77], v27 offset:49152
  v_mfma_f32_32x32x16_bf16 a[80:95], v[92:95], v[60:63], a[80:95]
  ds_read_b64_tr_b16 v[78:79], v27 offset:51200
  v_mfma_f32_32x32x16_bf16 a[96:111], v[96:99], v[60:63], a[96:111]
  ds_read_b128 v[48:51], v20 offset:8192
  v_mfma_f32_32x32x16_bf16 a[112:127], v[100:103], v[60:63], a[112:127]
  ds_read_b64_tr_b16 v[80:81], v28 offset:49152
  v_mfma_f32_32x32x16_bf16 a[128:143], v[88:91], v[64:67], a[128:143]
  ds_read_b64_tr_b16 v[82:83], v28 offset:51200
  v_mfma_f32_32x32x16_bf16 a[144:159], v[92:95], v[64:67], a[144:159]
  ds_read_b128 v[52:55], v20 offset:12288
  v_mfma_f32_32x32x16_bf16 a[160:175], v[96:99], v[64:67], a[160:175]
  ds_read_b64_tr_b16 v[84:85], v29 offset:49152
  v_mfma_f32_32x32x16_bf16 a[176:191], v[100:103], v[64:67], a[176:191]
  ds_read_b64_tr_b16 v[86:87], v29 offset:51200
  v_mfma_f32_32x32x16_bf16 a[192:207], v[88:91], v[68:71], a[192:207]
  v_mfma_f32_32x32x16_bf16 a[208:223], v[92:95], v[68:71], a[208:223]
  v_mfma_f32_32x32x16_bf16 a[224:239], v[96:99], v[68:71], a[224:239]
  v_mfma_f32_32x32x16_bf16 a[240:255], v[100:103], v[68:71], a[240:255]
  s_waitcnt lgkmcnt(0)
  v_mfma_f32_32x32x16_bf16 a[0:15], v[72:75], v[40:43], a[0:15]
  ds_read_b128 v[56:59], v21 offset:0
  v_mfma_f32_32x32x16_bf16 a[16:31], v[76:79], v[40:43], a[16:31]
  ds_read_b64_tr_b16 v[88:89], v26 offset:57344
  v_mfma_f32_32x32x16_bf16 a[32:47], v[80:83], v[40:43], a[32:47]
  ds_read_b64_tr_b16 v[90:91], v26 offset:59392
  v_mfma_f32_32x32x16_bf16 a[48:63], v[84:87], v[40:43], a[48:63]
  ds_read_b128 v[60:63], v21 offset:4096
  v_mfma_f32_32x32x16_bf16 a[64:79], v[72:75], v[44:47], a[64:79]
  ds_read_b64_tr_b16 v[92:93], v27 offset:57344
  v_mfma_f32_32x32x16_bf16 a[80:95], v[76:79], v[44:47], a[80:95]
  ds_read_b64_tr_b16 v[94:95], v27 offset:59392
  v_mfma_f32_32x32x16_bf16 a[96:111], v[80:83], v[44:47], a[96:111]
  ds_read_b128 v[64:67], v21 offset:8192
  v_mfma_f32_32x32x16_bf16 a[112:127], v[84:87], v[44:47], a[112:127]
  ds_read_b64_tr_b16 v[96:97], v28 offset:57344
  v_mfma_f32_32x32x16_bf16 a[128:143], v[72:75], v[48:51], a[128:143]
  ds_read_b64_tr_b16 v[98:99], v28 offset:59392
  v_mfma_f32_32x32x16_bf16 a[144:159], v[76:79], v[48:51], a[144:159]
  ds_read_b128 v[68:71], v21 offset:12288
  v_mfma_f32_32x32x16_bf16 a[160:175], v[80:83], v[48:51], a[160:175]
  ds_read_b64_tr_b16 v[100:101], v29 offset:57344
  v_mfma_f32_32x32x16_bf16 a[176:191], v[84:87], v[48:51], a[176:191]
  ds_read_b64_tr_b16 v[102:103], v29 offset:59392
  v_mfma_f32_32x32x16_bf16 a[192:207], v[72:75], v[52:55], a[192:207]
  v_mfma_f32_32x32x16_bf16 a[208:223], v[76:79], v[52:55], a[208:223]
  v_mfma_f32_32x32x16_bf16 a[224:239], v[80:83], v[52:55], a[224:239]
  v_mfma_f32_32x32x16_bf16 a[240:255], v[84:87], v[52:55], a[240:255]
  s_waitcnt lgkmcnt(0)
  v_mfma_f32_32x32x16_bf16 a[0:15], v[88:91], v[56:59], a[0:15]
  s_waitcnt vmcnt(0)
  s_barrier
  v_mfma_f32_32x32x16_bf16 a[16:31], v[92:95], v[56:59], a[16:31]
  ds_read_b128 v[40:43], v22 offset:0
  v_mfma_f32_32x32x16_bf16 a[32:47], v[96:99], v[56:59], a[32:47]
  ds_read_b64_tr_b16 v[72:73], v30 offset:32768
  v_mfma_f32_32x32x16_bf16 a[48:63], v[100:103], v[56:59], a[48:63]
  ds_read_b64_tr_b16 v[74:75], v30 offset:34816
  v_mfma_f32_32x32x16_bf16 a[64:79], v[88:91], v[60:63], a[64:79]
  ds_read_b128 v[44:47], v22 offset:4096
  v_mfma_f32_32x32x16_bf16 a[80:95], v[92:95], v[60:63], a[80:95]
  ds_read_b64_tr_b16 v[76:77], v31 offset:32768
  v_mfma_f32_32x32x16_bf16 a[96:111], v[96:99], v[60:63], a[96:111]
  ds_read_b64_tr_b16 v[78:79], v31 offset:34816
  v_mfma_f32_32x32x16_bf16 a[112:127], v[100:103], v[60:63], a[112:127]
  ds_read_b128 v[48:51], v22 offset:8192
  v_mfma_f32_32x32x16_bf16 a[128:143], v[88:91], v[64:67], a[128:143]
  ds_read_b64_tr_b16 v[80:81], v32 offset:32768
  v_mfma_f32_32x32x16_bf16 a[144:159], v[92:95], v[64:67], a[144:159]
  ds_read_b64_tr_b16 v[82:83], v32 offset:34816
  v_mfma_f32_32x32x16_bf16 a[160:175], v[96:99], v[64:67], a[160:175]
  ds_read_b128 v[52:55], v22 offset:12288
  v_mfma_f32_32x32x16_bf16 a[176:191], v[100:103], v[64:67], a[176:191]
  ds_read_b64_tr_b16 v[84:85], v33 offset:32768
  v_mfma_f32_32x32x16_bf16 a[192:207], v[88:91], v[68:71], a[192:207]
  ds_read_b64_tr_b16 v[86:87], v33 offset:34816
  v_mfma_f32_32x32x16_bf16 a[208:223], v[92:95], v[68:71], a[208:223]
  v_mfma_f32_32x32x16_bf16 a[224:239], v[96:99], v[68:71], a[224:239]
  v_mfma_f32_32x32x16_bf16 a[240:255], v[100:103], v[68:71], a[240:255]
  s_waitcnt lgkmcnt(0)
  v_mfma_f32_32x32x16_bf16 a[0:15], v[72:75], v[40:43], a[0:15]
  ds_read_b128 v[56:59], v23 offset:0
  v_mfma_f32_32x32x16_bf16 a[16:31], v[76:79], v[40:43], a[16:31]
  ds_read_b64_tr_b16 v[88:89], v30 offset:40960
  v_mfma_f32_32x32x16_bf16 a[32:47], v[80:83], v[40:43], a[32:47]
  ds_read_b64_tr_b16 v[90:91], v30 offset:43008
  v_mfma_f32_32x32x16_bf16 a[48:63], v[84:87], v[40:43], a[48:63]
  ds_read_b128 v[60:63], v23 offset:4096
  v_mfma_f32_32x32x16_bf16 a[64:79], v[72:75], v[44:47], a[64:79]
  ds_read_b64_tr_b16 v[92:93], v31 offset:40960
  v_mfma_f32_32x32x16_bf16 a[80:95], v[76:79], v[44:47], a[80:95]
  ds_read_b64_tr_b16 v[94:95], v31 offset:43008
  v_mfma_f32_32x32x16_bf16 a[96:111], v[80:83], v[44:47], a[96:111]
  ds_read_b128 v[64:67], v23 offset:8192
  v_mfma_f32_32x32x16_bf16 a[112:127], v[84:87], v[44:47], a[112:127]
  ds_read_b64_tr_b16 v[96:97], v32 offset:40960
  v_mfma_f32_32x32x16_bf16 a[128:143], v[72:75], v[48:51], a[128:143]
  ds_read_b64_tr_b16 v[98:99], v32 offset:43008
  v_mfma_f32_32x32x16_bf16 a[144:159], v[76:79], v[48:51], a[144:159]
  ds_read_b128 v[68:71], v23 offset:12288
  v_mfma_f32_32x32x16_bf16 a[160:175], v[80:83], v[48:51], a[160:175]
  ds_read_b64_tr_b16 v[100:101], v33 offset:40960
  v_mfma_f32_32x32x16_bf16 a[176:191], v[84:87], v[48:51], a[176:191]
  ds_read_b64_tr_b16 v[102:103], v33 offset:43008
  v_mfma_f32_32x32x16_bf16 a[192:207], v[72:75], v[52:55], a[192:207]
  v_mfma_f32_32x32x16_bf16 a[208:223], v[76:79], v[52:55], a[208:223]
  v_mfma_f32_32x32x16_bf16 a[224:239], v[80:83], v[52:55], a[224:239]
  v_mfma_f32_32x32x16_bf16 a[240:255], v[84:87], v[52:55], a[240:255]
  s_waitcnt lgkmcnt(0)
  v_mfma_f32_32x32x16_bf16 a[0:15], v[88:91], v[56:59], a[0:15]
  ds_read_b128 v[40:43], v24 offset:0
  v_mfma_f32_32x32x16_bf16 a[16:31], v[92:95], v[56:59], a[16:31]
  ds_read_b64_tr_b16 v[72:73], v30 offset:49152
  v_mfma_f32_32x32x16_bf16 a[32:47], v[96:99], v[56:59], a[32:47]
  ds_read_b64_tr_b16 v[74:75], v30 offset:51200
  v_mfma_f32_32x32x16_bf16 a[48:63], v[100:103], v[56:59], a[48:63]
  ds_read_b128 v[44:47], v24 offset:4096
  v_mfma_f32_32x32x16_bf16 a[64:79], v[88:91], v[60:63], a[64:79]
  ds_read_b64_tr_b16 v[76:77], v31 offset:49152
  v_mfma_f32_32x32x16_bf16 a[80:95], v[92:95], v[60:63], a[80:95]
  ds_read_b64_tr_b16 v[78:79], v31 offset:51200
  v_mfma_f32_32x32x16_bf16 a[96:111], v[96:99], v[60:63], a[96:111]
  ds_read_b128 v[48:51], v24 offset:8192
  v_mfma_f32_32x32x16_bf16 a[112:127], v[100:103], v[60:63], a[112:127]
  ds_read_b64_tr_b16 v[80:81], v32 offset:49152
  v_mfma_f32_32x32x16_bf16 a[128:143], v[88:91], v[64:67], a[128:143]
  ds_read_b64_tr_b16 v[82:83], v32 offset:51200
  v_mfma_f32_32x32x16_bf16 a[144:159], v[92:95], v[64:67], a[144:159]
  ds_read_b128 v[52:55], v24 offset:12288
  v_mfma_f32_32x32x16_bf16 a[160:175], v[96:99], v[64:67], a[160:175]
  ds_read_b64_tr_b16 v[84:85], v33 offset:49152
  v_mfma_f32_32x32x16_bf16 a[176:191], v[100:103], v[64:67], a[176:191]
  ds_read_b64_tr_b16 v[86:87], v33 offset:51200
  v_mfma_f32_32x32x16_bf16 a[192:207], v[88:91], v[68:71], a[192:207]
  v_mfma_f32_32x32x16_bf16 a[208:223], v[92:95], v[68:71], a[208:223]
  v_mfma_f32_32x32x16_bf16 a[224:239], v[96:99], v[68:71], a[224:239]
  v_mfma_f32_32x32x16_bf16 a[240:255], v[100:103], v[68:71], a[240:255]
  s_waitcnt lgkmcnt(0)
  v_mfma_f32_32x32x16_bf16 a[0:15], v[72:75], v[40:43], a[0:15]
  ds_read_b128 v[56:59], v25 offset:0
  v_mfma_f32_32x32x16_bf16 a[16:31], v[76:79], v[40:43], a[16:31]
  ds_read_b64_tr_b16 v[88:89], v30 offset:57344
  v_mfma_f32_32x32x16_bf16 a[32:47], v[80:83], v[40:43], a[32:47]
  ds_read_b64_tr_b16 v[90:91], v30 offset:59392
  v_mfma_f32_32x32x16_bf16 a[48:63], v[84:87], v[40:43], a[48:63]
  ds_read_b128 v[60:63], v25 offset:4096
  v_mfma_f32_32x32x16_bf16 a[64:79], v[72:75], v[44:47], a[64:79]
  ds_read_b64_tr_b16 v[92:93], v31 offset:57344
  v_mfma_f32_32x32x16_bf16 a[80:95], v[76:79], v[44:47], a[80:95]
  ds_read_b64_tr_b16 v[94:95], v31 offset:59392
  v_mfma_f32_32x32x16_bf16 a[96:111], v[80:83], v[44:47], a[96:111]
  ds_read_b128 v[64:67], v25 offset:8192
  v_mfma_f32_32x32x16_bf16 a[112:127], v[84:87], v[44:47], a[112:127]
  ds_read_b64_tr_b16 v[96:97], v32 offset:57344
  v_mfma_f32_32x32x16_bf16 a[128:143], v[72:75], v[48:51], a[128:143]
  ds_read_b64_tr_b16 v[98:99], v32 offset:59392
  v_mfma_f32_32x32x16_bf16 a[144:159], v[76:79], v[48:51], a[144:159]
  ds_read_b128 v[68:71], v25 offset:12288
  v_mfma_f32_32x32x16_bf16 a[160:175], v[80:83], v[48:51], a[160:175]
  ds_read_b64_tr_b16 v[100:101], v33 offset:57344
  v_mfma_f32_32x32x16_bf16 a[176:191], v[84:87], v[48:51], a[176:191]
  ds_read_b64_tr_b16 v[102:103], v33 offset:59392
  v_mfma_f32_32x32x16_bf16 a[192:207], v[72:75], v[52:55], a[192:207]
  v_mfma_f32_32x32x16_bf16 a[208:223], v[76:79], v[52:55], a[208:223]
  v_mfma_f32_32x32x16_bf16 a[224:239], v[80:83], v[52:55], a[224:239]
  v_mfma_f32_32x32x16_bf16 a[240:255], v[84:87], v[52:55], a[240:255]
  s_waitcnt lgkmcnt(0)
  v_mfma_f32_32x32x16_bf16 a[0:15], v[88:91], v[56:59], a[0:15]
  v_mfma_f32_32x32x16_bf16 a[16:31], v[92:95], v[56:59], a[16:31]
  v_mfma_f32_32x32x16_bf16 a[32:47], v[96:99], v[56:59], a[32:47]
  v_mfma_f32_32x32x16_bf16 a[48:63], v[100:103], v[56:59], a[48:63]
  v_mfma_f32_32x32x16_bf16 a[64:79], v[88:91], v[60:63], a[64:79]
  v_mfma_f32_32x32x16_bf16 a[80:95], v[92:95], v[60:63], a[80:95]
  v_mfma_f32_32x32x16_bf16 a[96:111], v[96:99], v[60:63], a[96:111]
  v_mfma_f32_32x32x16_bf16 a[112:127], v[100:103], v[60:63], a[112:127]
  v_mfma_f32_32x32x16_bf16 a[128:143], v[88:91], v[64:67], a[128:143]
  v_mfma_f32_32x32x16_bf16 a[144:159], v[92:95], v[64:67], a[144:159]
  v_mfma_f32_32x32x16_bf16 a[160:175], v[96:99], v[64:67], a[160:175]
  v_mfma_f32_32x32x16_bf16 a[176:191], v[100:103], v[64:67], a[176:191]
  v_mfma_f32_32x32x16_bf16 a[192:207], v[88:91], v[68:71], a[192:207]
  v_mfma_f32_32x32x16_bf16 a[208:223], v[92:95], v[68:71], a[208:223]
  v_mfma_f32_32x32x16_bf16 a[224:239], v[96:99], v[68:71], a[224:239]
  v_mfma_f32_32x32x16_bf16 a[240:255], v[100:103], v[68:71], a[240:255]
  s_lshr_b32 s90, s27, 1
  s_and_b32 s91, s27, 1
  v_mov_b32 v106, 0x0
  v_bfe_u32 v105, v1, 0, 4
  v_lshl_add_u32 v106, v105, 4, v106
  v_bfe_u32 v105, v1, 4, 1
  v_lshl_add_u32 v106, v105, 12, v106
  v_bfe_u32 v105, v1, 5, 1
  v_lshl_add_u32 v106, v105, 8, v106
  s_mul_i32 s92, s90, 4
  s_mul_i32 s92, s92, s26
  s_add_u32 s92, s92, s22
  s_mul_i32 s93, s91, 8192
  s_add_u32 s92, s92, s93
  s_add_u32 s93, s92, 0
  v_accvgpr_read_b32 v112, a0
  v_accvgpr_read_b32 v113, a8
  v_accvgpr_read_b32 v114, a1
  v_accvgpr_read_b32 v115, a9
  v_accvgpr_read_b32 v116, a2
  v_accvgpr_read_b32 v117, a10
  v_accvgpr_read_b32 v118, a3
  v_accvgpr_read_b32 v119, a11
  v_cvt_pk_bf16_f32 v108, v112, v113
  v_cvt_pk_bf16_f32 v109, v114, v115
  v_cvt_pk_bf16_f32 v110, v116, v117
  v_cvt_pk_bf16_f32 v111, v118, v119
  buffer_store_dwordx4 v[108:111], v106, s[16:19], s93 offen offset:0 sc1
  v_accvgpr_read_b32 v124, a4
  v_accvgpr_read_b32 v125, a12
  v_accvgpr_read_b32 v126, a5
  v_accvgpr_read_b32 v127, a13
  v_accvgpr_read_b32 v128, a6
  v_accvgpr_read_b32 v129, a14
  v_accvgpr_read_b32 v130, a7
  v_accvgpr_read_b32 v131, a15
  v_cvt_pk_bf16_f32 v120, v124, v125
  v_cvt_pk_bf16_f32 v121, v126, v127
  v_cvt_pk_bf16_f32 v122, v128, v129
  v_cvt_pk_bf16_f32 v123, v130, v131
  buffer_store_dwordx4 v[120:123], v106, s[16:19], s93 offen offset:512 sc1
  s_add_u32 s93, s92, 1024
  v_accvgpr_read_b32 v136, a16
  v_accvgpr_read_b32 v137, a24
  v_accvgpr_read_b32 v138, a17
  v_accvgpr_read_b32 v139, a25
  v_accvgpr_read_b32 v140, a18
  v_accvgpr_read_b32 v141, a26
  v_accvgpr_read_b32 v142, a19
  v_accvgpr_read_b32 v143, a27
  v_cvt_pk_bf16_f32 v132, v136, v137
  v_cvt_pk_bf16_f32 v133, v138, v139
  v_cvt_pk_bf16_f32 v134, v140, v141
  v_cvt_pk_bf16_f32 v135, v142, v143
  buffer_store_dwordx4 v[132:135], v106, s[16:19], s93 offen offset:0 sc1
  v_accvgpr_read_b32 v148, a20
  v_accvgpr_read_b32 v149, a28
  v_accvgpr_read_b32 v150, a21
  v_accvgpr_read_b32 v151, a29
  v_accvgpr_read_b32 v152, a22
  v_accvgpr_read_b32 v153, a30
  v_accvgpr_read_b32 v154, a23
  v_accvgpr_read_b32 v155, a31
  v_cvt_pk_bf16_f32 v144, v148, v149
  v_cvt_pk_bf16_f32 v145, v150, v151
  v_cvt_pk_bf16_f32 v146, v152, v153
  v_cvt_pk_bf16_f32 v147, v154, v155
  buffer_store_dwordx4 v[144:147], v106, s[16:19], s93 offen offset:512 sc1
  s_add_u32 s93, s92, 2048
  v_accvgpr_read_b32 v112, a32
  v_accvgpr_read_b32 v113, a40
  v_accvgpr_read_b32 v114, a33
  v_accvgpr_read_b32 v115, a41
  v_accvgpr_read_b32 v116, a34
  v_accvgpr_read_b32 v117, a42
  v_accvgpr_read_b32 v118, a35
  v_accvgpr_read_b32 v119, a43
  v_cvt_pk_bf16_f32 v108, v112, v113
  v_cvt_pk_bf16_f32 v109, v114, v115
  v_cvt_pk_bf16_f32 v110, v116, v117
  v_cvt_pk_bf16_f32 v111, v118, v119
  buffer_store_dwordx4 v[108:111], v106, s[16:19], s93 offen offset:0 sc1
  v_accvgpr_read_b32 v124, a36
  v_accvgpr_read_b32 v125, a44
  v_accvgpr_read_b32 v126, a37
  v_accvgpr_read_b32 v127, a45
  v_accvgpr_read_b32 v128, a38
  v_accvgpr_read_b32 v129, a46
  v_accvgpr_read_b32 v130, a39
  v_accvgpr_read_b32 v131, a47
  v_cvt_pk_bf16_f32 v120, v124, v125
  v_cvt_pk_bf16_f32 v121, v126, v127
  v_cvt_pk_bf16_f32 v122, v128, v129
  v_cvt_pk_bf16_f32 v123, v130, v131
  buffer_store_dwordx4 v[120:123], v106, s[16:19], s93 offen offset:512 sc1
  s_add_u32 s93, s92, 3072
  v_accvgpr_read_b32 v136, a48
  v_accvgpr_read_b32 v137, a56
  v_accvgpr_read_b32 v138, a49
  v_accvgpr_read_b32 v139, a57
  v_accvgpr_read_b32 v140, a50
  v_accvgpr_read_b32 v141, a58
  v_accvgpr_read_b32 v142, a51
  v_accvgpr_read_b32 v143, a59
  v_cvt_pk_bf16_f32 v132, v136, v137
  v_cvt_pk_bf16_f32 v133, v138, v139
  v_cvt_pk_bf16_f32 v134, v140, v141
  v_cvt_pk_bf16_f32 v135, v142, v143
  buffer_store_dwordx4 v[132:135], v106, s[16:19], s93 offen offset:0 sc1
  v_accvgpr_read_b32 v148, a52
  v_accvgpr_read_b32 v149, a60
  v_accvgpr_read_b32 v150, a53
  v_accvgpr_read_b32 v151, a61
  v_accvgpr_read_b32 v152, a54
  v_accvgpr_read_b32 v153, a62
  v_accvgpr_read_b32 v154, a55
  v_accvgpr_read_b32 v155, a63
  v_cvt_pk_bf16_f32 v144, v148, v149
  v_cvt_pk_bf16_f32 v145, v150, v151
  v_cvt_pk_bf16_f32 v146, v152, v153
  v_cvt_pk_bf16_f32 v147, v154, v155
  buffer_store_dwordx4 v[144:147], v106, s[16:19], s93 offen offset:512 sc1
  s_add_u32 s92, s92, s26
  s_add_u32 s93, s92, 0
  v_accvgpr_read_b32 v112, a64
  v_accvgpr_read_b32 v113, a72
  v_accvgpr_read_b32 v114, a65
  v_accvgpr_read_b32 v115, a73
  v_accvgpr_read_b32 v116, a66
  v_accvgpr_read_b32 v117, a74
  v_accvgpr_read_b32 v118, a67
  v_accvgpr_read_b32 v119, a75
  v_cvt_pk_bf16_f32 v108, v112, v113
  v_cvt_pk_bf16_f32 v109, v114, v115
  v_cvt_pk_bf16_f32 v110, v116, v117
  v_cvt_pk_bf16_f32 v111, v118, v119
  buffer_store_dwordx4 v[108:111], v106, s[16:19], s93 offen offset:0 sc1
  v_accvgpr_read_b32 v124, a68
  v_accvgpr_read_b32 v125, a76
  v_accvgpr_read_b32 v126, a69
  v_accvgpr_read_b32 v127, a77
  v_accvgpr_read_b32 v128, a70
  v_accvgpr_read_b32 v129, a78
  v_accvgpr_read_b32 v130, a71
  v_accvgpr_read_b32 v131, a79
  v_cvt_pk_bf16_f32 v120, v124, v125
  v_cvt_pk_bf16_f32 v121, v126, v127
  v_cvt_pk_bf16_f32 v122, v128, v129
  v_cvt_pk_bf16_f32 v123, v130, v131
  buffer_store_dwordx4 v[120:123], v106, s[16:19], s93 offen offset:512 sc1
  s_add_u32 s93, s92, 1024
  v_accvgpr_read_b32 v136, a80
  v_accvgpr_read_b32 v137, a88
  v_accvgpr_read_b32 v138, a81
  v_accvgpr_read_b32 v139, a89
  v_accvgpr_read_b32 v140, a82
  v_accvgpr_read_b32 v141, a90
  v_accvgpr_read_b32 v142, a83
  v_accvgpr_read_b32 v143, a91
  v_cvt_pk_bf16_f32 v132, v136, v137
  v_cvt_pk_bf16_f32 v133, v138, v139
  v_cvt_pk_bf16_f32 v134, v140, v141
  v_cvt_pk_bf16_f32 v135, v142, v143
  buffer_store_dwordx4 v[132:135], v106, s[16:19], s93 offen offset:0 sc1
  v_accvgpr_read_b32 v148, a84
  v_accvgpr_read_b32 v149, a92
  v_accvgpr_read_b32 v150, a85
  v_accvgpr_read_b32 v151, a93
  v_accvgpr_read_b32 v152, a86
  v_accvgpr_read_b32 v153, a94
  v_accvgpr_read_b32 v154, a87
  v_accvgpr_read_b32 v155, a95
  v_cvt_pk_bf16_f32 v144, v148, v149
  v_cvt_pk_bf16_f32 v145, v150, v151
  v_cvt_pk_bf16_f32 v146, v152, v153
  v_cvt_pk_bf16_f32 v147, v154, v155
  buffer_store_dwordx4 v[144:147], v106, s[16:19], s93 offen offset:512 sc1
  s_add_u32 s93, s92, 2048
  v_accvgpr_read_b32 v112, a96
  v_accvgpr_read_b32 v113, a104
  v_accvgpr_read_b32 v114, a97
  v_accvgpr_read_b32 v115, a105
  v_accvgpr_read_b32 v116, a98
  v_accvgpr_read_b32 v117, a106
  v_accvgpr_read_b32 v118, a99
  v_accvgpr_read_b32 v119, a107
  v_cvt_pk_bf16_f32 v108, v112, v113
  v_cvt_pk_bf16_f32 v109, v114, v115
  v_cvt_pk_bf16_f32 v110, v116, v117
  v_cvt_pk_bf16_f32 v111, v118, v119
  buffer_store_dwordx4 v[108:111], v106, s[16:19], s93 offen offset:0 sc1
  v_accvgpr_read_b32 v124, a100
  v_accvgpr_read_b32 v125, a108
  v_accvgpr_read_b32 v126, a101
  v_accvgpr_read_b32 v127, a109
  v_accvgpr_read_b32 v128, a102
  v_accvgpr_read_b32 v129, a110
  v_accvgpr_read_b32 v130, a103
  v_accvgpr_read_b32 v131, a111
  v_cvt_pk_bf16_f32 v120, v124, v125
  v_cvt_pk_bf16_f32 v121, v126, v127
  v_cvt_pk_bf16_f32 v122, v128, v129
  v_cvt_pk_bf16_f32 v123, v130, v131
  buffer_store_dwordx4 v[120:123], v106, s[16:19], s93 offen offset:512 sc1
  s_add_u32 s93, s92, 3072
  v_accvgpr_read_b32 v136, a112
  v_accvgpr_read_b32 v137, a120
  v_accvgpr_read_b32 v138, a113
  v_accvgpr_read_b32 v139, a121
  v_accvgpr_read_b32 v140, a114
  v_accvgpr_read_b32 v141, a122
  v_accvgpr_read_b32 v142, a115
  v_accvgpr_read_b32 v143, a123
  v_cvt_pk_bf16_f32 v132, v136, v137
  v_cvt_pk_bf16_f32 v133, v138, v139
  v_cvt_pk_bf16_f32 v134, v140, v141
  v_cvt_pk_bf16_f32 v135, v142, v143
  buffer_store_dwordx4 v[132:135], v106, s[16:19], s93 offen offset:0 sc1
  v_accvgpr_read_b32 v148, a116
  v_accvgpr_read_b32 v149, a124
  v_accvgpr_read_b32 v150, a117
  v_accvgpr_read_b32 v151, a125
  v_accvgpr_read_b32 v152, a118
  v_accvgpr_read_b32 v153, a126
  v_accvgpr_read_b32 v154, a119
  v_accvgpr_read_b32 v155, a127
  v_cvt_pk_bf16_f32 v144, v148, v149
  v_cvt_pk_bf16_f32 v145, v150, v151
  v_cvt_pk_bf16_f32 v146, v152, v153
  v_cvt_pk_bf16_f32 v147, v154, v155
  buffer_store_dwordx4 v[144:147], v106, s[16:19], s93 offen offset:512 sc1
  s_add_u32 s92, s92, s26
  s_add_u32 s93, s92, 0
  v_accvgpr_read_b32 v112, a128
  v_accvgpr_read_b32 v113, a136
  v_accvgpr_read_b32 v114, a129
  v_accvgpr_read_b32 v115, a137
  v_accvgpr_read_b32 v116, a130
  v_accvgpr_read_b32 v117, a138
  v_accvgpr_read_b32 v118, a131
  v_accvgpr_read_b32 v119, a139
  v_cvt_pk_bf16_f32 v108, v112, v113
  v_cvt_pk_bf16_f32 v109, v114, v115
  v_cvt_pk_bf16_f32 v110, v116, v117
  v_cvt_pk_bf16_f32 v111, v118, v119
  buffer_store_dwordx4 v[108:111], v106, s[16:19], s93 offen offset:0 sc1
  v_accvgpr_read_b32 v124, a132
  v_accvgpr_read_b32 v125, a140
  v_accvgpr_read_b32 v126, a133
  v_accvgpr_read_b32 v127, a141
  v_accvgpr_read_b32 v128, a134
  v_accvgpr_read_b32 v129, a142
  v_accvgpr_read_b32 v130, a135
  v_accvgpr_read_b32 v131, a143
  v_cvt_pk_bf16_f32 v120, v124, v125
  v_cvt_pk_bf16_f32 v121, v126, v127
  v_cvt_pk_bf16_f32 v122, v128, v129
  v_cvt_pk_bf16_f32 v123, v130, v131
  buffer_store_dwordx4 v[120:123], v106, s[16:19], s93 offen offset:512 sc1
  s_add_u32 s93, s92, 1024
  v_accvgpr_read_b32 v136, a144
  v_accvgpr_read_b32 v137, a152
  v_accvgpr_read_b32 v138, a145
  v_accvgpr_read_b32 v139, a153
  v_accvgpr_read_b32 v140, a146
  v_accvgpr_read_b32 v141, a154
  v_accvgpr_read_b32 v142, a147
  v_accvgpr_read_b32 v143, a155
  v_cvt_pk_bf16_f32 v132, v136, v137
  v_cvt_pk_bf16_f32 v133, v138, v139
  v_cvt_pk_bf16_f32 v134, v140, v141
  v_cvt_pk_bf16_f32 v135, v142, v143
  buffer_store_dwordx4 v[132:135], v106, s[16:19], s93 offen offset:0 sc1
  v_accvgpr_read_b32 v148, a148
  v_accvgpr_read_b32 v149, a156
  v_accvgpr_read_b32 v150, a149
  v_accvgpr_read_b32 v151, a157
  v_accvgpr_read_b32 v152, a150
  v_accvgpr_read_b32 v153, a158
  v_accvgpr_read_b32 v154, a151
  v_accvgpr_read_b32 v155, a159
  v_cvt_pk_bf16_f32 v144, v148, v149
  v_cvt_pk_bf16_f32 v145, v150, v151
  v_cvt_pk_bf16_f32 v146, v152, v153
  v_cvt_pk_bf16_f32 v147, v154, v155
  buffer_store_dwordx4 v[144:147], v106, s[16:19], s93 offen offset:512 sc1
  s_add_u32 s93, s92, 2048
  v_accvgpr_read_b32 v112, a160
  v_accvgpr_read_b32 v113, a168
  v_accvgpr_read_b32 v114, a161
  v_accvgpr_read_b32 v115, a169
  v_accvgpr_read_b32 v116, a162
  v_accvgpr_read_b32 v117, a170
  v_accvgpr_read_b32 v118, a163
  v_accvgpr_read_b32 v119, a171
  v_cvt_pk_bf16_f32 v108, v112, v113
  v_cvt_pk_bf16_f32 v109, v114, v115
  v_cvt_pk_bf16_f32 v110, v116, v117
  v_cvt_pk_bf16_f32 v111, v118, v119
  buffer_store_dwordx4 v[108:111], v106, s[16:19], s93 offen offset:0 sc1
  v_accvgpr_read_b32 v124, a164
  v_accvgpr_read_b32 v125, a172
  v_accvgpr_read_b32 v126, a165
  v_accvgpr_read_b32 v127, a173
  v_accvgpr_read_b32 v128, a166
  v_accvgpr_read_b32 v129, a174
  v_accvgpr_read_b32 v130, a167
  v_accvgpr_read_b32 v131, a175
  v_cvt_pk_bf16_f32 v120, v124, v125
  v_cvt_pk_bf16_f32 v121, v126, v127
  v_cvt_pk_bf16_f32 v122, v128, v129
  v_cvt_pk_bf16_f32 v123, v130, v131
  buffer_store_dwordx4 v[120:123], v106, s[16:19], s93 offen offset:512 sc1
  s_add_u32 s93, s92, 3072
  v_accvgpr_read_b32 v136, a176
  v_accvgpr_read_b32 v137, a184
  v_accvgpr_read_b32 v138, a177
  v_accvgpr_read_b32 v139, a185
  v_accvgpr_read_b32 v140, a178
  v_accvgpr_read_b32 v141, a186
  v_accvgpr_read_b32 v142, a179
  v_accvgpr_read_b32 v143, a187
  v_cvt_pk_bf16_f32 v132, v136, v137
  v_cvt_pk_bf16_f32 v133, v138, v139
  v_cvt_pk_bf16_f32 v134, v140, v141
  v_cvt_pk_bf16_f32 v135, v142, v143
  buffer_store_dwordx4 v[132:135], v106, s[16:19], s93 offen offset:0 sc1
  v_accvgpr_read_b32 v148, a180
  v_accvgpr_read_b32 v149, a188
  v_accvgpr_read_b32 v150, a181
  v_accvgpr_read_b32 v151, a189
  v_accvgpr_read_b32 v152, a182
  v_accvgpr_read_b32 v153, a190
  v_accvgpr_read_b32 v154, a183
  v_accvgpr_read_b32 v155, a191
  v_cvt_pk_bf16_f32 v144, v148, v149
  v_cvt_pk_bf16_f32 v145, v150, v151
  v_cvt_pk_bf16_f32 v146, v152, v153
  v_cvt_pk_bf16_f32 v147, v154, v155
  buffer_store_dwordx4 v[144:147], v106, s[16:19], s93 offen offset:512 sc1
  s_add_u32 s92, s92, s26
  s_add_u32 s93, s92, 0
  v_accvgpr_read_b32 v112, a192
  v_accvgpr_read_b32 v113, a200
  v_accvgpr_read_b32 v114, a193
  v_accvgpr_read_b32 v115, a201
  v_accvgpr_read_b32 v116, a194
  v_accvgpr_read_b32 v117, a202
  v_accvgpr_read_b32 v118, a195
  v_accvgpr_read_b32 v119, a203
  v_cvt_pk_bf16_f32 v108, v112, v113
  v_cvt_pk_bf16_f32 v109, v114, v115
  v_cvt_pk_bf16_f32 v110, v116, v117
  v_cvt_pk_bf16_f32 v111, v118, v119
  buffer_store_dwordx4 v[108:111], v106, s[16:19], s93 offen offset:0 sc1
  v_accvgpr_read_b32 v124, a196
  v_accvgpr_read_b32 v125, a204
  v_accvgpr_read_b32 v126, a197
  v_accvgpr_read_b32 v127, a205
  v_accvgpr_read_b32 v128, a198
  v_accvgpr_read_b32 v129, a206
  v_accvgpr_read_b32 v130, a199
  v_accvgpr_read_b32 v131, a207
  v_cvt_pk_bf16_f32 v120, v124, v125
  v_cvt_pk_bf16_f32 v121, v126, v127
  v_cvt_pk_bf16_f32 v122, v128, v129
  v_cvt_pk_bf16_f32 v123, v130, v131
  buffer_store_dwordx4 v[120:123], v106, s[16:19], s93 offen offset:512 sc1
  s_add_u32 s93, s92, 1024
  v_accvgpr_read_b32 v136, a208
  v_accvgpr_read_b32 v137, a216
  v_accvgpr_read_b32 v138, a209
  v_accvgpr_read_b32 v139, a217
  v_accvgpr_read_b32 v140, a210
  v_accvgpr_read_b32 v141, a218
  v_accvgpr_read_b32 v142, a211
  v_accvgpr_read_b32 v143, a219
  v_cvt_pk_bf16_f32 v132, v136, v137
  v_cvt_pk_bf16_f32 v133, v138, v139
  v_cvt_pk_bf16_f32 v134, v140, v141
  v_cvt_pk_bf16_f32 v135, v142, v143
  buffer_store_dwordx4 v[132:135], v106, s[16:19], s93 offen offset:0 sc1
  v_accvgpr_read_b32 v148, a212
  v_accvgpr_read_b32 v149, a220
  v_accvgpr_read_b32 v150, a213
  v_accvgpr_read_b32 v151, a221
  v_accvgpr_read_b32 v152, a214
  v_accvgpr_read_b32 v153, a222
  v_accvgpr_read_b32 v154, a215
  v_accvgpr_read_b32 v155, a223
  v_cvt_pk_bf16_f32 v144, v148, v149
  v_cvt_pk_bf16_f32 v145, v150, v151
  v_cvt_pk_bf16_f32 v146, v152, v153
  v_cvt_pk_bf16_f32 v147, v154, v155
  buffer_store_dwordx4 v[144:147], v106, s[16:19], s93 offen offset:512 sc1
  s_add_u32 s93, s92, 2048
  v_accvgpr_read_b32 v112, a224
  v_accvgpr_read_b32 v113, a232
  v_accvgpr_read_b32 v114, a225
  v_accvgpr_read_b32 v115, a233
  v_accvgpr_read_b32 v116, a226
  v_accvgpr_read_b32 v117, a234
  v_accvgpr_read_b32 v118, a227
  v_accvgpr_read_b32 v119, a235
  v_cvt_pk_bf16_f32 v108, v112, v113
  v_cvt_pk_bf16_f32 v109, v114, v115
  v_cvt_pk_bf16_f32 v110, v116, v117
  v_cvt_pk_bf16_f32 v111, v118, v119
  buffer_store_dwordx4 v[108:111], v106, s[16:19], s93 offen offset:0 sc1
  v_accvgpr_read_b32 v124, a228
  v_accvgpr_read_b32 v125, a236
  v_accvgpr_read_b32 v126, a229
  v_accvgpr_read_b32 v127, a237
  v_accvgpr_read_b32 v128, a230
  v_accvgpr_read_b32 v129, a238
  v_accvgpr_read_b32 v130, a231
  v_accvgpr_read_b32 v131, a239
  v_cvt_pk_bf16_f32 v120, v124, v125
  v_cvt_pk_bf16_f32 v121, v126, v127
  v_cvt_pk_bf16_f32 v122, v128, v129
  v_cvt_pk_bf16_f32 v123, v130, v131
  buffer_store_dwordx4 v[120:123], v106, s[16:19], s93 offen offset:512 sc1
  s_add_u32 s93, s92, 3072
  v_accvgpr_read_b32 v136, a240
  v_accvgpr_read_b32 v137, a248
  v_accvgpr_read_b32 v138, a241
  v_accvgpr_read_b32 v139, a249
  v_accvgpr_read_b32 v140, a242
  v_accvgpr_read_b32 v141, a250
  v_accvgpr_read_b32 v142, a243
  v_accvgpr_read_b32 v143, a251
  v_cvt_pk_bf16_f32 v132, v136, v137
  v_cvt_pk_bf16_f32 v133, v138, v139
  v_cvt_pk_bf16_f32 v134, v140, v141
  v_cvt_pk_bf16_f32 v135, v142, v143
  buffer_store_dwordx4 v[132:135], v106, s[16:19], s93 offen offset:0 sc1
  v_accvgpr_read_b32 v148, a244
  v_accvgpr_read_b32 v149, a252
  v_accvgpr_read_b32 v150, a245
  v_accvgpr_read_b32 v151, a253
  v_accvgpr_read_b32 v152, a246
  v_accvgpr_read_b32 v153, a254
  v_accvgpr_read_b32 v154, a247
  v_accvgpr_read_b32 v155, a255
  v_cvt_pk_bf16_f32 v144, v148, v149
  v_cvt_pk_bf16_f32 v145, v150, v151
  v_cvt_pk_bf16_f32 v146, v152, v153
  v_cvt_pk_bf16_f32 v147, v154, v155
  buffer_store_dwordx4 v[144:147], v106, s[16:19], s93 offen offset:512 sc1
  s_add_u32 s92, s92, s26
  s_branch L_done
L_g2:
  s_waitcnt vmcnt(16)
  s_barrier
  ds_read_b128 v[40:43], v18 offset:0
  ds_read_b64_tr_b16 v[72:73], v26 offset:32768
  ds_read_b64_tr_b16 v[74:75], v26 offset:34816
  ds_read_b128 v[44:47], v18 offset:4096
  ds_read_b64_tr_b16 v[76:77], v27 offset:32768
  ds_read_b64_tr_b16 v[78:79], v27 offset:34816
  ds_read_b128 v[48:51], v18 offset:8192
  ds_read_b64_tr_b16 v[80:81], v28 offset:32768
  ds_read_b64_tr_b16 v[82:83], v28 offset:34816
  ds_read_b128 v[52:55], v18 offset:12288
  ds_read_b64_tr_b16 v[84:85], v29 offset:32768
  ds_read_b64_tr_b16 v[86:87], v29 offset:34816
  s_sub_u32 s25, s25, 1
  s_waitcnt lgkmcnt(0)
  v_mfma_f32_32x32x16_bf16 a[0:15], v[40:43], v[72:75], 0
  ds_read_b128 v[56:59], v19 offset:0
  v_mfma_f32_32x32x16_bf16 a[16:31], v[40:43], v[76:79], 0
  ds_read_b64_tr_b16 v[88:89], v26 offset:40960
  v_mfma_f32_32x32x16_bf16 a[32:47], v[40:43], v[80:83], 0
  ds_read_b64_tr_b16 v[90:91], v26 offset:43008
  v_mfma_f32_32x32x16_bf16 a[48:63], v[40:43], v[84:87], 0
  ds_read_b128 v[60:63], v19 offset:4096
  v_mfma_f32_32x32x16_bf16 a[64:79], v[44:47], v[72:75], 0
  ds_read_b64_tr_b16 v[92:93], v27 offset:40960
  v_mfma_f32_32x32x16_bf16 a[80:95], v[44:47], v[76:79], 0
  ds_read_b64_tr_b16 v[94:95], v27 offset:43008
  v_mfma_f32_32x32x16_bf16 a[96:111], v[44:47], v[80:83], 0
  ds_read_b128 v[64:67], v19 offset:8192
  v_mfma_f32_32x32x16_bf16 a[112:127], v[44:47], v[84:87], 0
  ds_read_b64_tr_b16 v[96:97], v28 offset:40960
  v_mfma_f32_32x32x16_bf16 a[128:143], v[48:51], v[72:75], 0
  ds_read_b64_tr_b16 v[98:99], v28 offset:43008
  v_mfma_f32_32x32x16_bf16 a[144:159], v[48:51], v[76:79], 0
  ds_read_b128 v[68:71], v19 offset:12288
  v_mfma_f32_32x32x16_bf16 a[160:175], v[48:51], v[80:83], 0
  ds_read_b64_tr_b16 v[100:101], v29 offset:40960
  v_mfma_f32_32x32x16_bf16 a[176:191], v[48:51], v[84:87], 0
  ds_read_b64_tr_b16 v[102:103], v29 offset:43008
  v_mfma_f32_32x32x16_bf16 a[192:207], v[52:55], v[72:75], 0
  v_mfma_f32_32x32x16_bf16 a[208:223], v[52:55], v[76:79], 0
  v_mfma_f32_32x32x16_bf16 a[224:239], v[52:55], v[80:83], 0
  v_mfma_f32_32x32x16_bf16 a[240:255], v[52:55], v[84:87], 0
  s_waitcnt lgkmcnt(0)
  v_mfma_f32_32x32x16_bf16 a[0:15], v[56:59], v[88:91], a[0:15]
  ds_read_b128 v[40:43], v20 offset:0
  v_mfma_f32_32x32x16_bf16 a[16:31], v[56:59], v[92:95], a[16:31]
  ds_read_b64_tr_b16 v[72:73], v26 offset:49152
  v_mfma_f32_32x32x16_bf16 a[32:47], v[56:59], v[96:99], a[32:47]
  ds_read_b64_tr_b16 v[74:75], v26 offset:51200
  v_mfma_f32_32x32x16_bf16 a[48:63], v[56:59], v[100:103], a[48:63]
  ds_read_b128 v[44:47], v20 offset:4096
  v_mfma_f32_32x32x16_bf16 a[64:79], v[60:63], v[88:91], a[64:79]
  ds_read_b64_tr_b16 v[76:77], v27 offset:49152
  v_mfma_f32_32x32x16_bf16 a[80:95], v[60:63], v[92:95], a[80:95]
  ds_read_b64_tr_b16 v[78:79], v27 offset:51200
  v_mfma_f32_32x32x16_bf16 a[96:111], v[60:63], v[96:99], a[96:111]
  ds_read_b128 v[48:51], v20 offset:8192
  v_mfma_f32_32x32x16_bf16 a[112:127], v[60:63], v[100:103], a[112:127]
  ds_read_b64_tr_b16 v[80:81], v28 offset:49152
  v_mfma_f32_32x32x16_bf16 a[128:143], v[64:67], v[88:91], a[128:143]
  ds_read_b64_tr_b16 v[82:83], v28 offset:51200
  v_mfma_f32_32x32x16_bf16 a[144:159], v[64:67], v[92:95], a[144:159]
  ds_read_b128 v[52:55], v20 offset:12288
  v_mfma_f32_32x32x16_bf16 a[160:175], v[64:67], v[96:99], a[160:175]
  ds_read_b64_tr_b16 v[84:85], v29 offset:49152
  v_mfma_f32_32x32x16_bf16 a[176:191], v[64:67], v[100:103], a[176:191]
  ds_read_b64_tr_b16 v[86:87], v29 offset:51200
  v_mfma_f32_32x32x16_bf16 a[192:207], v[68:71], v[88:91], a[192:207]
  v_mfma_f32_32x32x16_bf16 a[208:223], v[68:71], v[92:95], a[208:223]
  v_mfma_f32_32x32x16_bf16 a[224:239], v[68:71], v[96:99], a[224:239]
  v_mfma_f32_32x32x16_bf16 a[240:255], v[68:71], v[100:103], a[240:255]
  s_waitcnt lgkmcnt(0)
  v_mfma_f32_32x32x16_bf16 a[0:15], v[40:43], v[72:75], a[0:15]
  ds_read_b128 v[56:59], v21 offset:0
  v_mfma_f32_32x32x16_bf16 a[16:31], v[40:43], v[76:79], a[16:31]
  ds_read_b64_tr_b16 v[88:89], v26 offset:57344
  v_mfma_f32_32x32x16_bf16 a[32:47], v[40:43], v[80:83], a[32:47]
  ds_read_b64_tr_b16 v[90:91], v26 offset:59392
  v_mfma_f32_32x32x16_bf16 a[48:63], v[40:43], v[84:87], a[48:63]
  ds_read_b128 v[60:63], v21 offset:4096
  v_mfma_f32_32x32x16_bf16 a[64:79], v[44:47], v[72:75], a[64:79]
  ds_read_b64_tr_b16 v[92:93], v27 offset:57344
  v_mfma_f32_32x32x16_bf16 a[80:95], v[44:47], v[76:79], a[80:95]
  ds_read_b64_tr_b16 v[94:95], v27 offset:59392
  v_mfma_f32_32x32x16_bf16 a[96:111], v[44:47], v[80:83], a[96:111]
  ds_read_b128 v[64:67], v21 offset:8192
  v_mfma_f32_32x32x16_bf16 a[112:127], v[44:47], v[84:87], a[112:127]
  ds_read_b64_tr_b16 v[96:97], v28 offset:57344
  v_mfma_f32_32x32x16_bf16 a[128:143], v[48:51], v[72:75], a[128:143]
  ds_read_b64_tr_b16 v[98:99], v28 offset:59392
  v_mfma_f32_32x32x16_bf16 a[144:159], v[48:51], v[76:79], a[144:159]
  ds_read_b128 v[68:71], v21 offset:12288
  v_mfma_f32_32x32x16_bf16 a[160:175], v[48:51], v[80:83], a[160:175]
  ds_read_b64_tr_b16 v[100:101], v29 offset:57344
  v_mfma_f32_32x32x16_bf16 a[176:191], v[48:51], v[84:87], a[176:191]
  ds_read_b64_tr_b16 v[102:103], v29 offset:59392
  v_mfma_f32_32x32x16_bf16 a[192:207], v[52:55], v[72:75], a[192:207]
  v_mfma_f32_32x32x16_bf16 a[208:223], v[52:55], v[76:79], a[208:223]
  v_mfma_f32_32x32x16_bf16 a[224:239], v[52:55], v[80:83], a[224:239]
  v_mfma_f32_32x32x16_bf16 a[240:255], v[52:55], v[84:87], a[240:255]
  s_waitcnt lgkmcnt(0)
  v_mfma_f32_32x32x16_bf16 a[0:15], v[56:59], v[88:91], a[0:15]
  s_waitcnt vmcnt(0)
  s_barrier
  s_add_u32 m0, s52, 0
  v_mfma_f32_32x32x16_bf16 a[16:31], v[56:59], v[92:95], a[16:31]
  buffer_load_dwordx4 v2, s[8:11], s20 offen  lds
  ds_read_b128 v[40:43], v22 offset:0
  s_add_u32 m0, s53, 0
  v_mfma_f32_32x32x16_bf16 a[32:47], v[56:59], v[96:99], a[32:47]
  buffer_load_dwordx4 v10, s[12:15], s21 offen lds
  ds_read_b64_tr_b16 v[72:73], v30 offset:32768
  v_mfma_f32_32x32x16_bf16 a[48:63], v[56:59], v[100:103], a[48:63]
  ds_read_b64_tr_b16 v[74:75], v30 offset:34816
  s_add_u32 m0, s52, 1024
  v_mfma_f32_32x32x16_bf16 a[64:79], v[60:63], v[88:91], a[64:79]
  buffer_load_dwordx4 v3, s[8:11], s20 offen  lds
  ds_read_b128 v[44:47], v22 offset:4096
  v_mfma_f32_32x32x16_bf16 a[80:95], v[60:63], v[92:95], a[80:95]
  ds_read_b64_tr_b16 v[76:77], v31 offset:32768
  s_add_u32 m0, s53, 1024
  v_mfma_f32_32x32x16_bf16 a[96:111], v[60:63], v[96:99], a[96:111]
  buffer_load_dwordx4 v11, s[12:15], s21 offen lds
  ds_read_b64_tr_b16 v[78:79], v31 offset:34816
  s_add_u32 m0, s52, 2048
  v_mfma_f32_32x32x16_bf16 a[112:127], v[60:63], v[100:103], a[112:127]
  buffer_load_dwordx4 v4, s[8:11], s20 offen  lds
  ds_read_b128 v[48:51], v22 offset:8192
  v_mfma_f32_32x32x16_bf16 a[128:143], v[64:67], v[88:91], a[128:143]
  ds_read_b64_tr_b16 v[80:81], v32 offset:32768
  s_add_u32 m0, s53, 2048
  v_mfma_f32_32x32x16_bf16 a[144:159], v[64:67], v[92:95], a[144:159]
  buffer_load_dwordx4 v12, s[12:15], s21 offen lds
  ds_read_b64_tr_b16 v[82:83], v32 offset:34816
  v_mfma_f32_32x32x16_bf16 a[160:175], v[64:67], v[96:99], a[160:175]
  ds_read_b128 v[52:55], v22 offset:12288
  s_add_u32 m0, s52, 3072
  v_mfma_f32_32x32x16_bf16 a[176:191], v[64:67], v[100:103], a[176:191]
  buffer_load_dwordx4 v5, s[8:11], s20 offen  lds
  ds_read_b64_tr_b16 v[84:85], v33 offset:32768
  s_add_u32 m0, s53, 3072
  v_mfma_f32_32x32x16_bf16 a[192:207], v[68:71], v[88:91], a[192:207]
  buffer_load_dwordx4 v13, s[12:15], s21 offen lds
  ds_read_b64_tr_b16 v[86:87], v33 offset:34816
  v_mfma_f32_32x32x16_bf16 a[208:223], v[68:71], v[92:95], a[208:223]
  s_add_u32 m0, s52, 4096
  v_mfma_f32_32x32x16_bf16 a[224:239], v[68:71], v[96:99], a[224:239]
  buffer_load_dwordx4 v6, s[8:11], s20 offen  lds
  v_mfma_f32_32x32x16_bf16 a[240:255], v[68:71], v[100:103], a[240:255]
  s_waitcnt lgkmcnt(0)
  s_add_u32 m0, s53, 4096
  v_mfma_f32_32x32x16_bf16 a[0:15], v[40:43], v[72:75], a[0:15]
  buffer_load_dwordx4 v14, s[12:15], s21 offen lds
  ds_read_b128 v[56:59], v23 offset:0
  v_mfma_f32_32x32x16_bf16 a[16:31], v[40:43], v[76:79], a[16:31]
  ds_read_b64_tr_b16 v[88:89], v30 offset:40960
  s_add_u32 m0, s52, 5120
  v_mfma_f32_32x32x16_bf16 a[32:47], v[40:43], v[80:83], a[32:47]
  buffer_load_dwordx4 v7, s[8:11], s20 offen  lds
  ds_read_b64_tr_b16 v[90:91], v30 offset:43008
  v_mfma_f32_32x32x16_bf16 a[48:63], v[40:43], v[84:87], a[48:63]
  ds_read_b128 v[60:63], v23 offset:4096
  s_add_u32 m0, s53, 5120
  v_mfma_f32_32x32x16_bf16 a[64:79], v[44:47], v[72:75], a[64:79]
  buffer_load_dwordx4 v15, s[12:15], s21 offen lds
  ds_read_b64_tr_b16 v[92:93], v31 offset:40960
  v_mfma_f32_32x32x16_bf16 a[80:95], v[44:47], v[76:79], a[80:95]
  ds_read_b64_tr_b16 v[94:95], v31 offset:43008
  s_add_u32 m0, s52, 6144
  v_mfma_f32_32x32x16_bf16 a[96:111], v[44:47], v[80:83], a[96:111]
  buffer_load_dwordx4 v8, s[8:11], s20 offen  lds
  ds_read_b128 v[64:67], v23 offset:8192
  v_mfma_f32_32x32x16_bf16 a[112:127], v[44:47], v[84:87], a[112:127]
  ds_read_b64_tr_b16 v[96:97], v32 offset:40960
  s_add_u32 m0, s53, 6144
  v_mfma_f32_32x32x16_bf16 a[128:143], v[48:51], v[72:75], a[128:143]
  buffer_load_dwordx4 v16, s[12:15], s21 offen lds
  ds_read_b64_tr_b16 v[98:99], v32 offset:43008
  v_mfma_f32_32x32x16_bf16 a[144:159], v[48:51], v[76:79], a[144:159]
  ds_read_b128 v[68:71], v23 offset:12288
  s_add_u32 m0, s52, 7168
  v_mfma_f32_32x32x16_bf16 a[160:175], v[48:51], v[80:83], a[160:175]
  buffer_load_dwordx4 v9, s[8:11], s20 offen  lds
  ds_read_b64_tr_b16 v[100:101], v33 offset:40960
  v_mfma_f32_32x32x16_bf16 a[176:191], v[48:51], v[84:87], a[176:191]
  ds_read_b64_tr_b16 v[102:103], v33 offset:43008
  s_add_u32 m0, s53, 7168
  v_mfma_f32_32x32x16_bf16 a[192:207], v[52:55], v[72:75], a[192:207]
  buffer_load_dwordx4 v17, s[12:15], s21 offen lds
  v_mfma_f32_32x32x16_bf16 a[208:223], v[52:55], v[76:79], a[208:223]
  s_add_u32 s20, s20, 128
  v_mfma_f32_32x32x16_bf16 a[224:239], v[52:55], v[80:83], a[224:239]
  s_add_u32 s21, s21, s51
  v_mfma_f32_32x32x16_bf16 a[240:255], v[52:55], v[84:87], a[240:255]
  s_waitcnt lgkmcnt(0)
  v_mfma_f32_32x32x16_bf16 a[0:15], v[56:59], v[88:91], a[0:15]
  ds_read_b128 v[40:43], v24 offset:0
  v_mfma_f32_32x32x16_bf16 a[16:31], v[56:59], v[92:95], a[16:31]
  ds_read_b64_tr_b16 v[72:73], v30 offset:49152
  v_mfma_f32_32x32x16_bf16 a[32:47], v[56:59], v[96:99], a[32:47]
  ds_read_b64_tr_b16 v[74:75], v30 offset:51200
  v_mfma_f32_32x32x16_bf16 a[48:63], v[56:59], v[100:103], a[48:63]
  ds_read_b128 v[44:47], v24 offset:4096
  v_mfma_f32_32x32x16_bf16 a[64:79], v[60:63], v[88:91], a[64:79]
  ds_read_b64_tr_b16 v[76:77], v31 offset:49152
  v_mfma_f32_32x32x16_bf16 a[80:95], v[60:63], v[92:95], a[80:95]
  ds_read_b64_tr_b16 v[78:79], v31 offset:51200
  v_mfma_f32_32x32x16_bf16 a[96:111], v[60:63], v[96:99], a[96:111]
  ds_read_b128 v[48:51], v24 offset:8192
  v_mfma_f32_32x32x16_bf16 a[112:127], v[60:63], v[100:103], a[112:127]
  ds_read_b64_tr_b16 v[80:81], v32 offset:49152
  v_mfma_f32_32x32x16_bf16 a[128:143], v[64:67], v[88:91], a[128:143]
  ds_read_b64_tr_b16 v[82:83], v32 offset:51200
  v_mfma_f32_32x32x16_bf16 a[144:159], v[64:67], v[92:95], a[144:159]
  ds_read_b128 v[52:55], v24 offset:12288
  v_mfma_f32_32x32x16_bf16 a[160:175], v[64:67], v[96:99], a[160:175]
  ds_read_b64_tr_b16 v[84:85], v33 offset:49152
  v_mfma_f32_32x32x16_bf16 a[176:191], v[64:67], v[100:103], a[176:191]
  ds_read_b64_tr_b16 v[86:87], v33 offset:51200
  v_mfma_f32_32x32x16_bf16 a[192:207], v[68:71], v[88:91], a[192:207]
  v_mfma_f32_32x32x16_bf16 a[208:223], v[68:71], v[92:95], a[208:223]
  v_mfma_f32_32x32x16_bf16 a[224:239], v[68:71], v[96:99], a[224:239]
  v_mfma_f32_32x32x16_bf16 a[240:255], v[68:71], v[100:103], a[240:255]
  s_waitcnt lgkmcnt(0)
  v_mfma_f32_32x32x16_bf16 a[0:15], v[40:43], v[72:75], a[0:15]
  ds_read_b128 v[56:59], v25 offset:0
  v_mfma_f32_32x32x16_bf16 a[16:31], v[40:43], v[76:79], a[16:31]
  ds_read_b64_tr_b16 v[88:89], v30 offset:57344
  v_mfma_f32_32x32x16_bf16 a[32:47], v[40:43], v[80:83], a[32:47]
  ds_read_b64_tr_b16 v[90:91], v30 offset:59392
  v_mfma_f32_32x32x16_bf16 a[48:63], v[40:43], v[84:87], a[48:63]
  ds_read_b128 v[60:63], v25 offset:4096
  v_mfma_f32_32x32x16_bf16 a[64:79], v[44:47], v[72:75], a[64:79]
  ds_read_b64_tr_b16 v[92:93], v31 offset:57344
  v_mfma_f32_32x32x16_bf16 a[80:95], v[44:47], v[76:79], a[80:95]
  ds_read_b64_tr_b16 v[94:95], v31 offset:59392
  v_mfma_f32_32x32x16_bf16 a[96:111], v[44:47], v[80:83], a[96:111]
  ds_read_b128 v[64:67], v25 offset:8192
  v_mfma_f32_32x32x16_bf16 a[112:127], v[44:47], v[84:87], a[112:127]
  ds_read_b64_tr_b16 v[96:97], v32 offset:57344
  v_mfma_f32_32x32x16_bf16 a[128:143], v[48:51], v[72:75], a[128:143]
  ds_read_b64_tr_b16 v[98:99], v32 offset:59392
  v_mfma_f32_32x32x16_bf16 a[144:159], v[48:51], v[76:79], a[144:159]
  ds_read_b128 v[68:71], v25 offset:12288
  v_mfma_f32_32x32x16_bf16 a[160:175], v[48:51], v[80:83], a[160:175]
  ds_read_b64_tr_b16 v[100:101], v33 offset:57344
  v_mfma_f32_32x32x16_bf16 a[176:191], v[48:51], v[84:87], a[176:191]
  ds_read_b64_tr_b16 v[102:103], v33 offset:59392
  v_mfma_f32_32x32x16_bf16 a[192:207], v[52:55], v[72:75], a[192:207]
  v_mfma_f32_32x32x16_bf16 a[208:223], v[52:55], v[76:79], a[208:223]
  v_mfma_f32_32x32x16_bf16 a[224:239], v[52:55], v[80:83], a[224:239]
  v_mfma_f32_32x32x16_bf16 a[240:255], v[52:55], v[84:87], a[240:255]
  s_waitcnt lgkmcnt(0)
  v_mfma_f32_32x32x16_bf16 a[0:15], v[56:59], v[88:91], a[0:15]
  s_waitcnt vmcnt(0)
  s_barrier
  s_add_u32 m0, s52, 65536
  v_mfma_f32_32x32x16_bf16 a[16:31], v[56:59], v[92:95], a[16:31]
  buffer_load_dwordx4 v2, s[8:11], s20 offen  lds
  ds_read_b128 v[40:43], v18 offset:0
  s_add_u32 m0, s53, 65536
  v_mfma_f32_32x32x16_bf16 a[32:47], v[56:59], v[96:99], a[32:47]
  buffer_load_dwordx4 v10, s[12:15], s21 offen lds
  ds_read_b64_tr_b16 v[72:73], v26 offset:32768
  v_mfma_f32_32x32x16_bf16 a[48:63], v[56:59], v[100:103], a[48:63]
  ds_read_b64_tr_b16 v[74:75], v26 offset:34816
  s_add_u32 m0, s52, 66560
  v_mfma_f32_32x32x16_bf16 a[64:79], v[60:63], v[88:91], a[64:79]
  buffer_load_dwordx4 v3, s[8:11], s20 offen  lds
  ds_read_b128 v[44:47], v18 offset:4096
  v_mfma_f32_32x32x16_bf16 a[80:95], v[60:63], v[92:95], a[80:95]
  ds_read_b64_tr_b16 v[76:77], v27 offset:32768
  s_add_u32 m0, s53, 66560
  v_mfma_f32_32x32x16_bf16 a[96:111], v[60:63], v[96:99], a[96:111]
  buffer_load_dwordx4 v11, s[12:15], s21 offen lds
  ds_read_b64_tr_b16 v[78:79], v27 offset:34816
  s_add_u32 m0, s52, 67584
  v_mfma_f32_32x32x16_bf16 a[112:127], v[60:63], v[100:103], a[112:127]
  buffer_load_dwordx4 v4, s[8:11], s20 offen  lds
  ds_read_b128 v[48:51], v18 offset:8192
  v_mfma_f32_32x32x16_bf16 a[128:143], v[64:67], v[88:91], a[128:143]
  ds_read_b64_tr_b16 v[80:81], v28 offset:32768
  s_add_u32 m0, s53, 67584
  v_mfma_f32_32x32x16_bf16 a[144:159], v[64:67], v[92:95], a[144:159]
  buffer_load_dwordx4 v12, s[12:15], s21 offen lds
  ds_read_b64_tr_b16 v[82:83], v28 offset:34816
  v_mfma_f32_32x32x16_bf16 a[160:175], v[64:67], v[96:99], a[160:175]
  ds_read_b128 v[52:55], v18 offset:12288
  s_add_u32 m0, s52, 68608
  v_mfma_f32_32x32x16_bf16 a[176:191], v[64:67], v[100:103], a[176:191]
  buffer_load_dwordx4 v5, s[8:11], s20 offen  lds
  ds_read_b64_tr_b16 v[84:85], v29 offset:32768
  s_add_u32 m0, s53, 68608
  v_mfma_f32_32x32x16_bf16 a[192:207], v[68:71], v[88:91], a[192:207]
  buffer_load_dwordx4 v13, s[12:15], s21 offen lds
  ds_read_b64_tr_b16 v[86:87], v29 offset:34816
  v_mfma_f32_32x32x16_bf16 a[208:223], v[68:71], v[92:95], a[208:223]
  s_add_u32 m0, s52, 69632
  v_mfma_f32_32x32x16_bf16 a[224:239], v[68:71], v[96:99], a[224:239]
  buffer_load_dwordx4 v6, s[8:11], s20 offen  lds
  v_mfma_f32_32x32x16_bf16 a[240:255], v[68:71], v[100:103], a[240:255]
L_g2_loop:
  s_sub_u32 s25, s25, 1
  s_cmp_eq_u32 s25, 0
  s_cbranch_scc1 L_g2_fin
  s_waitcnt lgkmcnt(0)
  s_add_u32 m0, s53, 69632
  v_mfma_f32_32x32x16_bf16 a[0:15], v[40:43], v[72:75], a[0:15]
  buffer_load_dwordx4 v14, s[12:15], s21 offen lds
  ds_read_b128 v[56:59], v19 offset:0
  v_mfma_f32_32x32x16_bf16 a[16:31], v[40:43], v[76:79], a[16:31]
  ds_read_b64_tr_b16 v[88:89], v26 offset:40960
  s_add_u32 m0, s52, 70656
  v_mfma_f32_32x32x16_bf16 a[32:47], v[40:43], v[80:83], a[32:47]
  buffer_load_dwordx4 v7, s[8:11], s20 offen  lds
  ds_read_b64_tr_b16 v[90:91], v26 offset:43008
  v_mfma_f32_32x32x16_bf16 a[48:63], v[40:43], v[84:87], a[48:63]
  ds_read_b128 v[60:63], v19 offset:4096
  s_add_u32 m0, s53, 70656
  v_mfma_f32_32x32x16_bf16 a[64:79], v[44:47], v[72:75], a[64:79]
  buffer_load_dwordx4 v15, s[12:15], s21 offen lds
  ds_read_b64_tr_b16 v[92:93], v27 offset:40960
  v_mfma_f32_32x32x16_bf16 a[80:95], v[44:47], v[76:79], a[80:95]
  ds_read_b64_tr_b16 v[94:95], v27 offset:43008
  s_add_u32 m0, s52, 71680
  v_mfma_f32_32x32x16_bf16 a[96:111], v[44:47], v[80:83], a[96:111]
  buffer_load_dwordx4 v8, s[8:11], s20 offen  lds
  ds_read_b128 v[64:67], v19 offset:8192
  v_mfma_f32_32x32x16_bf16 a[112:127], v[44:47], v[84:87], a[112:127]
  ds_read_b64_tr_b16 v[96:97], v28 offset:40960
  s_add_u32 m0, s53, 71680
  v_mfma_f32_32x32x16_bf16 a[128:143], v[48:51], v[72:75], a[128:143]
  buffer_load_dwordx4 v16, s[12:15], s21 offen lds
  ds_read_b64_tr_b16 v[98:99], v28 offset:43008
  v_mfma_f32_32x32x16_bf16 a[144:159], v[48:51], v[76:79], a[144:159]
  ds_read_b128 v[68:71], v19 offset:12288
  s_add_u32 m0, s52, 72704
  v_mfma_f32_32x32x16_bf16 a[160:175], v[48:51], v[80:83], a[160:175]
  buffer_load_dwordx4 v9, s[8:11], s20 offen  lds
  ds_read_b64_tr_b16 v[100:101], v29 offset:40960
  v_mfma_f32_32x32x16_bf16 a[176:191], v[48:51], v[84:87], a[176:191]
  ds_read_b64_tr_b16 v[102:103], v29 offset:43008
  s_add_u32 m0, s53, 72704
  v_mfma_f32_32x32x16_bf16 a[192:207], v[52:55], v[72:75], a[192:207]
  buffer_load_dwordx4 v17, s[12:15], s21 offen lds
  v_mfma_f32_32x32x16_bf16 a[208:223], v[52:55], v[76:79], a[208:223]
  s_add_u32 s20, s20, 128
  v_mfma_f32_32x32x16_bf16 a[224:239], v[52:55], v[80:83], a[224:239]
  s_add_u32 s21, s21, s51
  v_mfma_f32_32x32x16_bf16 a[240:255], v[52:55], v[84:87], a[240:255]
  s_waitcnt lgkmcnt(0)
  v_mfma_f32_32x32x16_bf16 a[0:15], v[56:59], v[88:91], a[0:15]
  ds_read_b128 v[40:43], v20 offset:0
  v_mfma_f32_32x32x16_bf16 a[16:31], v[56:59], v[92:95], a[16:31]
  ds_read_b64_tr_b16 v[72:73], v26 offset:49152
  v_mfma_f32_32x32x16_bf16 a[32:47], v[56:59], v[96:99], a[32:47]
  ds_read_b64_tr_b16 v[74:75], v26 offset:51200
  v_mfma_f32_32x32x16_bf16 a[48:63], v[56:59], v[100:103], a[48:63]
  ds_read_b128 v[44:47], v20 offset:4096
  v_mfma_f32_32x32x16_bf16 a[64:79], v[60:63], v[88:91], a[64:79]
  ds_read_b64_tr_b16 v[76:77], v27 offset:49152
  v_mfma_f32_32x32x16_bf16 a[80:95], v[60:63], v[92:95], a[80:95]
  ds_read_b64_tr_b16 v[78:79], v27 offset:51200
  v_mfma_f32_32x32x16_bf16 a[96:111], v[60:63], v[96:99], a[96:111]
  ds_read_b128 v[48:51], v20 offset:8192
  v_mfma_f32_32x32x16_bf16 a[112:127], v[60:63], v[100:103], a[112:127]
  ds_read_b64_tr_b16 v[80:81], v28 offset:49152
  v_mfma_f32_32x32x16_bf16 a[128:143], v[64:67], v[88:91], a[128:143]
  ds_read_b64_tr_b16 v[82:83], v28 offset:51200
  v_mfma_f32_32x32x16_bf16 a[144:159], v[64:67], v[92:95], a[144:159]
  ds_read_b128 v[52:55], v20 offset:12288
  v_mfma_f32_32x32x16_bf16 a[160:175], v[64:67], v[96:99], a[160:175]
  ds_read_b64_tr_b16 v[84:85], v29 offset:49152
  v_mfma_f32_32x32x16_bf16 a[176:191], v[64:67], v[100:103], a[176:191]
  ds_read_b64_tr_b16 v[86:87], v29 offset:51200
  v_mfma_f32_32x32x16_bf16 a[192:207], v[68:71], v[88:91], a[192:207]
  v_mfma_f32_32x32x16_bf16 a[208:223], v[68:71], v[92:95], a[208:223]
  v_mfma_f32_32x32x16_bf16 a[224:239], v[68:71], v[96:99], a[224:239]
  v_mfma_f32_32x32x16_bf16 a[240:255], v[68:71], v[100:103], a[240:255]
  s_waitcnt lgkmcnt(0)
  v_mfma_f32_32x32x16_bf16 a[0:15], v[40:43], v[72:75], a[0:15]
  ds_read_b128 v[56:59], v21 offset:0
  v_mfma_f32_32x32x16_bf16 a[16:31], v[40:43], v[76:79], a[16:31]
  ds_read_b64_tr_b16 v[88:89], v26 offset:57344
  v_mfma_f32_32x32x16_bf16 a[32:47], v[40:43], v[80:83], a[32:47]
  ds_read_b64_tr_b16 v[90:91], v26 offset:59392
  v_mfma_f32_32x32x16_bf16 a[48:63], v[40:43], v[84:87], a[48:63]
  ds_read_b128 v[60:63], v21 offset:4096
  v_mfma_f32_32x32x16_bf16 a[64:79], v[44:47], v[72:75], a[64:79]
  ds_read_b64_tr_b16 v[92:93], v27 offset:57344
  v_mfma_f32_32x32x16_bf16 a[80:95], v[44:47], v[76:79], a[80:95]
  ds_read_b64_tr_b16 v[94:95], v27 offset:59392
  v_mfma_f32_32x32x16_bf16 a[96:111], v[44:47], v[80:83], a[96:111]
  ds_read_b128 v[64:67], v21 offset:8192
  v_mfma_f32_32x32x16_bf16 a[112:127], v[44:47], v[84:87], a[112:127]
  ds_read_b64_tr_b16 v[96:97], v28 offset:57344
  v_mfma_f32_32x32x16_bf16 a[128:143], v[48:51], v[72:75], a[128:143]
  ds_read_b64_tr_b16 v[98:99], v28 offset:59392
  v_mfma_f32_32x32x16_bf16 a[144:159], v[48:51], v[76:79], a[144:159]
  ds_read_b128 v[68:71], v21 offset:12288
  v_mfma_f32_32x32x16_bf16 a[160:175], v[48:51], v[80:83], a[160:175]
  ds_read_b64_tr_b16 v[100:101], v29 offset:57344
  v_mfma_f32_32x32x16_bf16 a[176:191], v[48:51], v[84:87], a[176:191]
  ds_read_b64_tr_b16 v[102:103], v29 offset:59392
  v_mfma_f32_32x32x16_bf16 a[192:207], v[52:55], v[72:75], a[192:207]
  v_mfma_f32_32x32x16_bf16 a[208:223], v[52:55], v[76:79], a[208:223]
  v_mfma_f32_32x32x16_bf16 a[224:239], v[52:55], v[80:83], a[224:239]
  v_mfma_f32_32x32x16_bf16 a[240:255], v[52:55], v[84:87], a[240:255]
  s_waitcnt lgkmcnt(0)
  v_mfma_f32_32x32x16_bf16 a[0:15], v[56:59], v[88:91], a[0:15]
  s_waitcnt vmcnt(0)
  s_barrier
  s_add_u32 m0, s52, 0
  v_mfma_f32_32x32x16_bf16 a[16:31], v[56:59], v[92:95], a[16:31]
  buffer_load_dwordx4 v2, s[8:11], s20 offen  lds
  ds_read_b128 v[40:43], v22 offset:0
  s_add_u32 m0, s53, 0
  v_mfma_f32_32x32x16_bf16 a[32:47], v[56:59], v[96:99], a[32:47]
  buffer_load_dwordx4 v10, s[12:15], s21 offen lds
  ds_read_b64_tr_b16 v[72:73], v30 offset:32768
  v_mfma_f32_32x32x16_bf16 a[48:63], v[56:59], v[100:103], a[48:63]
  ds_read_b64_tr_b16 v[74:75], v30 offset:34816
  s_add_u32 m0, s52, 1024
  v_mfma_f32_32x32x16_bf16 a[64:79], v[60:63], v[88:91], a[64:79]
  buffer_load_dwordx4 v3, s[8:11], s20 offen  lds
  ds_read_b128 v[44:47], v22 offset:4096
  v_mfma_f32_32x32x16_bf16 a[80:95], v[60:63], v[92:95], a[80:95]
  ds_read_b64_tr_b16 v[76:77], v31 offset:32768
  s_add_u32 m0, s53, 1024
  v_mfma_f32_32x32x16_bf16 a[96:111], v[60:63], v[96:99], a[96:111]
  buffer_load_dwordx4 v11, s[12:15], s21 offen lds
  ds_read_b64_tr_b16 v[78:79], v31 offset:34816
  s_add_u32 m0, s52, 2048
  v_mfma_f32_32x32x16_bf16 a[112:127], v[60:63], v[100:103], a[112:127]
  buffer_load_dwordx4 v4, s[8:11], s20 offen  lds
  ds_read_b128 v[48:51], v22 offset:8192
  v_mfma_f32_32x32x16_bf16 a[128:143], v[64:67], v[88:91], a[128:143]
  ds_read_b64_tr_b16 v[80:81], v32 offset:32768
  s_add_u32 m0, s53, 2048
  v_mfma_f32_32x32x16_bf16 a[144:159], v[64:67], v[92:95], a[144:159]
  buffer_load_dwordx4 v12, s[12:15], s21 offen lds
  ds_read_b64_tr_b16 v[82:83], v32 offset:34816
  v_mfma_f32_32x32x16_bf16 a[160:175], v[64:67], v[96:99], a[160:175]
  ds_read_b128 v[52:55], v22 offset:12288
  s_add_u32 m0, s52, 3072
  v_mfma_f32_32x32x16_bf16 a[176:191], v[64:67], v[100:103], a[176:191]
  buffer_load_dwordx4 v5, s[8:11], s20 offen  lds
  ds_read_b64_tr_b16 v[84:85], v33 offset:32768
  s_add_u32 m0, s53, 3072
  v_mfma_f32_32x32x16_bf16 a[192:207], v[68:71], v[88:91], a[192:207]
  buffer_load_dwordx4 v13, s[12:15], s21 offen lds
  ds_read_b64_tr_b16 v[86:87], v33 offset:34816
  v_mfma_f32_32x32x16_bf16 a[208:223], v[68:71], v[92:95], a[208:223]
  s_add_u32 m0, s52, 4096
  v_mfma_f32_32x32x16_bf16 a[224:239], v[68:71], v[96:99], a[224:239]
  buffer_load_dwordx4 v6, s[8:11], s20 offen  lds
  v_mfma_f32_32x32x16_bf16 a[240:255], v[68:71], v[100:103], a[240:255]
  s_waitcnt lgkmcnt(0)
  s_add_u32 m0, s53, 4096
  v_mfma_f32_32x32x16_bf16 a[0:15], v[40:43], v[72:75], a[0:15]
  buffer_load_dwordx4 v14, s[12:15], s21 offen lds
  ds_read_b128 v[56:59], v23 offset:0
  v_mfma_f32_32x32x16_bf16 a[16:31], v[40:43], v[76:79], a[16:31]
  ds_read_b64_tr_b16 v[88:89], v30 offset:40960
  s_add_u32 m0, s52, 5120
  v_mfma_f32_32x32x16_bf16 a[32:47], v[40:43], v[80:83], a[32:47]
  buffer_load_dwordx4 v7, s[8:11], s20 offen  lds
  ds_read_b64_tr_b16 v[90:91], v30 offset:43008
  v_mfma_f32_32x32x16_bf16 a[48:63], v[40:43], v[84:87], a[48:63]
  ds_read_b128 v[60:63], v23 offset:4096
  s_add_u32 m0, s53, 5120
  v_mfma_f32_32x32x16_bf16 a[64:79], v[44:47], v[72:75], a[64:79]
  buffer_load_dwordx4 v15, s[12:15], s21 offen lds
  ds_read_b64_tr_b16 v[92:93], v31 offset:40960
  v_mfma_f32_32x32x16_bf16 a[80:95], v[44:47], v[76:79], a[80:95]
  ds_read_b64_tr_b16 v[94:95], v31 offset:43008
  s_add_u32 m0, s52, 6144
  v_mfma_f32_32x32x16_bf16 a[96:111], v[44:47], v[80:83], a[96:111]
  buffer_load_dwordx4 v8, s[8:11], s20 offen  lds
  ds_read_b128 v[64:67], v23 offset:8192
  v_mfma_f32_32x32x16_bf16 a[112:127], v[44:47], v[84:87], a[112:127]
  ds_read_b64_tr_b16 v[96:97], v32 offset:40960
  s_add_u32 m0, s53, 6144
  v_mfma_f32_32x32x16_bf16 a[128:143], v[48:51], v[72:75], a[128:143]
  buffer_load_dwordx4 v16, s[12:15], s21 offen lds
  ds_read_b64_tr_b16 v[98:99], v32 offset:43008
  v_mfma_f32_32x32x16_bf16 a[144:159], v[48:51], v[76:79], a[144:159]
  ds_read_b128 v[68:71], v23 offset:12288
  s_add_u32 m0, s52, 7168
  v_mfma_f32_32x32x16_bf16 a[160:175], v[48:51], v[80:83], a[160:175]
  buffer_load_dwordx4 v9, s[8:11], s20 offen  lds
  ds_read_b64_tr_b16 v[100:101], v33 offset:40960
  v_mfma_f32_32x32x16_bf16 a[176:191], v[48:51], v[84:87], a[176:191]
  ds_read_b64_tr_b16 v[102:103], v33 offset:43008
  s_add_u32 m0, s53, 7168
  v_mfma_f32_32x32x16_bf16 a[192:207], v[52:55], v[72:75], a[192:207]
  buffer_load_dwordx4 v17, s[12:15], s21 offen lds
  v_mfma_f32_32x32x16_bf16 a[208:223], v[52:55], v[76:79], a[208:223]
  s_add_u32 s20, s20, 128
  v_mfma_f32_32x32x16_bf16 a[224:239], v[52:55], v[80:83], a[224:239]
  s_add_u32 s21, s21, s51
  v_mfma_f32_32x32x16_bf16 a[240:255], v[52:55], v[84:87], a[240:255]
  s_waitcnt lgkmcnt(0)
  v_mfma_f32_32x32x16_bf16 a[0:15], v[56:59], v[88:91], a[0:15]
  ds_read_b128 v[40:43], v24 offset:0
  v_mfma_f32_32x32x16_bf16 a[16:31], v[56:59], v[92:95], a[16:31]
  ds_read_b64_tr_b16 v[72:73], v30 offset:49152
  v_mfma_f32_32x32x16_bf16 a[32:47], v[56:59], v[96:99], a[32:47]
  ds_read_b64_tr_b16 v[74:75], v30 offset:51200
  v_mfma_f32_32x32x16_bf16 a[48:63], v[56:59], v[100:103], a[48:63]
  ds_read_b128 v[44:47], v24 offset:4096
  v_mfma_f32_32x32x16_bf16 a[64:79], v[60:63], v[88:91], a[64:79]
  ds_read_b64_tr_b16 v[76:77], v31 offset:49152
  v_mfma_f32_32x32x16_bf16 a[80:95], v[60:63], v[92:95], a[80:95]
  ds_read_b64_tr_b16 v[78:79], v31 offset:51200
  v_mfma_f32_32x32x16_bf16 a[96:111], v[60:63], v[96:99], a[96:111]
  ds_read_b128 v[48:51], v24 offset:8192
  v_mfma_f32_32x32x16_bf16 a[112:127], v[60:63], v[100:103], a[112:127]
  ds_read_b64_tr_b16 v[80:81], v32 offset:49152
  v_mfma_f32_32x32x16_bf16 a[128:143], v[64:67], v[88:91], a[128:143]
  ds_read_b64_tr_b16 v[82:83], v32 offset:51200
  v_mfma_f32_32x32x16_bf16 a[144:159], v[64:67], v[92:95], a[144:159]
  ds_read_b128 v[52:55], v24 offset:12288
  v_mfma_f32_32x32x16_bf16 a[160:175], v[64:67], v[96:99], a[160:175]
  ds_read_b64_tr_b16 v[84:85], v33 offset:49152
  v_mfma_f32_32x32x16_bf16 a[176:191], v[64:67], v[100:103], a[176:191]
  ds_read_b64_tr_b16 v[86:87], v33 offset:51200
  v_mfma_f32_32x32x16_bf16 a[192:207], v[68:71], v[88:91], a[192:207]
  v_mfma_f32_32x32x16_bf16 a[208:223], v[68:71], v[92:95], a[208:223]
  v_mfma_f32_32x32x16_bf16 a[224:239], v[68:71], v[96:99], a[224:239]
  v_mfma_f32_32x32x16_bf16 a[240:255], v[68:71], v[100:103], a[240:255]
  s_waitcnt lgkmcnt(0)
  v_mfma_f32_32x32x16_bf16 a[0:15], v[40:43], v[72:75], a[0:15]
  ds_read_b128 v[56:59], v25 offset:0
  v_mfma_f32_32x32x16_bf16 a[16:31], v[40:43], v[76:79], a[16:31]
  ds_read_b64_tr_b16 v[88:89], v30 offset:57344
  v_mfma_f32_32x32x16_bf16 a[32:47], v[40:43], v[80:83], a[32:47]
  ds_read_b64_tr_b16 v[90:91], v30 offset:59392
  v_mfma_f32_32x32x16_bf16 a[48:63], v[40:43], v[84:87], a[48:63]
  ds_read_b128 v[60:63], v25 offset:4096
  v_mfma_f32_32x32x16_bf16 a[64:79], v[44:47], v[72:75], a[64:79]
  ds_read_b64_tr_b16 v[92:93], v31 offset:57344
  v_mfma_f32_32x32x16_bf16 a[80:95], v[44:47], v[76:79], a[80:95]
  ds_read_b64_tr_b16 v[94:95], v31 offset:59392
  v_mfma_f32_32x32x16_bf16 a[96:111], v[44:47], v[80:83], a[96:111]
  ds_read_b128 v[64:67], v25 offset:8192
  v_mfma_f32_32x32x16_bf16 a[112:127], v[44:47], v[84:87], a[112:127]
  ds_read_b64_tr_b16 v[96:97], v32 offset:57344
  v_mfma_f32_32x32x16_bf16 a[128:143], v[48:51], v[72:75], a[128:143]
  ds_read_b64_tr_b16 v[98:99], v32 offset:59392
  v_mfma_f32_32x32x16_bf16 a[144:159], v[48:51], v[76:79], a[144:159]
  ds_read_b128 v[68:71], v25 offset:12288
  v_mfma_f32_32x32x16_bf16 a[160:175], v[48:51], v[80:83], a[160:175]
  ds_read_b64_tr_b16 v[100:101], v33 offset:57344
  v_mfma_f32_32x32x16_bf16 a[176:191], v[48:51], v[84:87], a[176:191]
  ds_read_b64_tr_b16 v[102:103], v33 offset:59392
  v_mfma_f32_32x32x16_bf16 a[192:207], v[52:55], v[72:75], a[192:207]
  v_mfma_f32_32x32x16_bf16 a[208:223], v[52:55], v[76:79], a[208:223]
  v_mfma_f32_32x32x16_bf16 a[224:239], v[52:55], v[80:83], a[224:239]
  v_mfma_f32_32x32x16_bf16 a[240:255], v[52:55], v[84:87], a[240:255]
  s_waitcnt lgkmcnt(0)
  v_mfma_f32_32x32x16_bf16 a[0:15], v[56:59], v[88:91], a[0:15]
  s_waitcnt vmcnt(0)
  s_barrier
  s_add_u32 m0, s52, 65536
  v_mfma_f32_32x32x16_bf16 a[16:31], v[56:59], v[92:95], a[16:31]
  buffer_load_dwordx4 v2, s[8:11], s20 offen  lds
  ds_read_b128 v[40:43], v18 offset:0
  s_add_u32 m0, s53, 65536
  v_mfma_f32_32x32x16_bf16 a[32:47], v[56:59], v[96:99], a[32:47]
  buffer_load_dwordx4 v10, s[12:15], s21 offen lds
  ds_read_b64_tr_b16 v[72:73], v26 offset:32768
  v_mfma_f32_32x32x16_bf16 a[48:63], v[56:59], v[100:103], a[48:63]
  ds_read_b64_tr_b16 v[74:75], v26 offset:34816
  s_add_u32 m0, s52, 66560
  v_mfma_f32_32x32x16_bf16 a[64:79], v[60:63], v[88:91], a[64:79]
  buffer_load_dwordx4 v3, s[8:11], s20 offen  lds
  ds_read_b128 v[44:47], v18 offset:4096
  v_mfma_f32_32x32x16_bf16 a[80:95], v[60:63], v[92:95], a[80:95]
  ds_read_b64_tr_b16 v[76:77], v27 offset:32768
  s_add_u32 m0, s53, 66560
  v_mfma_f32_32x32x16_bf16 a[96:111], v[60:63], v[96:99], a[96:111]
  buffer_load_dwordx4 v11, s[12:15], s21 offen lds
  ds_read_b64_tr_b16 v[78:79], v27 offset:34816
  s_add_u32 m0, s52, 67584
  v_mfma_f32_32x32x16_bf16 a[112:127], v[60:63], v[100:103], a[112:127]
  buffer_load_dwordx4 v4, s[8:11], s20 offen  lds
  ds_read_b128 v[48:51], v18 offset:8192
  v_mfma_f32_32x32x16_bf16 a[128:143], v[64:67], v[88:91], a[128:143]
  ds_read_b64_tr_b16 v[80:81], v28 offset:32768
  s_add_u32 m0, s53, 67584
  v_mfma_f32_32x32x16_bf16 a[144:159], v[64:67], v[92:95], a[144:159]
  buffer_load_dwordx4 v12, s[12:15], s21 offen lds
  ds_read_b64_tr_b16 v[82:83], v28 offset:34816
  v_mfma_f32_32x32x16_bf16 a[160:175], v[64:67], v[96:99], a[160:175]
  ds_read_b128 v[52:55], v18 offset:12288
  s_add_u32 m0, s52, 68608
  v_mfma_f32_32x32x16_bf16 a[176:191], v[64:67], v[100:103], a[176:191]
  buffer_load_dwordx4 v5, s[8:11], s20 offen  lds
  ds_read_b64_tr_b16 v[84:85], v29 offset:32768
  s_add_u32 m0, s53, 68608
  v_mfma_f32_32x32x16_bf16 a[192:207], v[68:71], v[88:91], a[192:207]
  buffer_load_dwordx4 v13, s[12:15], s21 offen lds
  ds_read_b64_tr_b16 v[86:87], v29 offset:34816
  v_mfma_f32_32x32x16_bf16 a[208:223], v[68:71], v[92:95], a[208:223]
  s_add_u32 m0, s52, 69632
  v_mfma_f32_32x32x16_bf16 a[224:239], v[68:71], v[96:99], a[224:239]
  buffer_load_dwordx4 v6, s[8:11], s20 offen  lds
  v_mfma_f32_32x32x16_bf16 a[240:255], v[68:71], v[100:103], a[240:255]
  s_branch L_g2_loop
L_g2_fin:
  s_waitcnt lgkmcnt(0)
  s_add_u32 m0, s53, 69632
  v_mfma_f32_32x32x16_bf16 a[0:15], v[40:43], v[72:75], a[0:15]
  buffer_load_dwordx4 v14, s[12:15], s21 offen lds
  ds_read_b128 v[56:59], v19 offset:0
  v_mfma_f32_32x32x16_bf16 a[16:31], v[40:43], v[76:79], a[16:31]
  ds_read_b64_tr_b16 v[88:89], v26 offset:40960
  s_add_u32 m0, s52, 70656
  v_mfma_f32_32x32x16_bf16 a[32:47], v[40:43], v[80:83], a[32:47]
  buffer_load_dwordx4 v7, s[8:11], s20 offen  lds
  ds_read_b64_tr_b16 v[90:91], v26 offset:43008
  v_mfma_f32_32x32x16_bf16 a[48:63], v[40:43], v[84:87], a[48:63]
  ds_read_b128 v[60:63], v19 offset:4096
  s_add_u32 m0, s53, 70656
  v_mfma_f32_32x32x16_bf16 a[64:79], v[44:47], v[72:75], a[64:79]
  buffer_load_dwordx4 v15, s[12:15], s21 offen lds
  ds_read_b64_tr_b16 v[92:93], v27 offset:40960
  v_mfma_f32_32x32x16_bf16 a[80:95], v[44:47], v[76:79], a[80:95]
  ds_read_b64_tr_b16 v[94:95], v27 offset:43008
  s_add_u32 m0, s52, 71680
  v_mfma_f32_32x32x16_bf16 a[96:111], v[44:47], v[80:83], a[96:111]
  buffer_load_dwordx4 v8, s[8:11], s20 offen  lds
  ds_read_b128 v[64:67], v19 offset:8192
  v_mfma_f32_32x32x16_bf16 a[112:127], v[44:47], v[84:87], a[112:127]
  ds_read_b64_tr_b16 v[96:97], v28 offset:40960
  s_add_u32 m0, s53, 71680
  v_mfma_f32_32x32x16_bf16 a[128:143], v[48:51], v[72:75], a[128:143]
  buffer_load_dwordx4 v16, s[12:15], s21 offen lds
  ds_read_b64_tr_b16 v[98:99], v28 offset:43008
  v_mfma_f32_32x32x16_bf16 a[144:159], v[48:51], v[76:79], a[144:159]
  ds_read_b128 v[68:71], v19 offset:12288
  s_add_u32 m0, s52, 72704
  v_mfma_f32_32x32x16_bf16 a[160:175], v[48:51], v[80:83], a[160:175]
  buffer_load_dwordx4 v9, s[8:11], s20 offen  lds
  ds_read_b64_tr_b16 v[100:101], v29 offset:40960
  v_mfma_f32_32x32x16_bf16 a[176:191], v[48:51], v[84:87], a[176:191]
  ds_read_b64_tr_b16 v[102:103], v29 offset:43008
  s_add_u32 m0, s53, 72704
  v_mfma_f32_32x32x16_bf16 a[192:207], v[52:55], v[72:75], a[192:207]
  buffer_load_dwordx4 v17, s[12:15], s21 offen lds
  v_mfma_f32_32x32x16_bf16 a[208:223], v[52:55], v[76:79], a[208:223]
  s_add_u32 s20, s20, 128
  v_mfma_f32_32x32x16_bf16 a[224:239], v[52:55], v[80:83], a[224:239]
  s_add_u32 s21, s21, s51
  v_mfma_f32_32x32x16_bf16 a[240:255], v[52:55], v[84:87], a[240:255]
  s_waitcnt lgkmcnt(0)
  v_mfma_f32_32x32x16_bf16 a[0:15], v[56:59], v[88:91], a[0:15]
  ds_read_b128 v[40:43], v20 offset:0
  v_mfma_f32_32x32x16_bf16 a[16:31], v[56:59], v[92:95], a[16:31]
  ds_read_b64_tr_b16 v[72:73], v26 offset:49152
  v_mfma_f32_32x32x16_bf16 a[32:47], v[56:59], v[96:99], a[32:47]
  ds_read_b64_tr_b16 v[74:75], v26 offset:51200
  v_mfma_f32_32x32x16_bf16 a[48:63], v[56:59], v[100:103], a[48:63]
  ds_read_b128 v[44:47], v20 offset:4096
  v_mfma_f32_32x32x16_bf16 a[64:79], v[60:63], v[88:91], a[64:79]
  ds_read_b64_tr_b16 v[76:77], v27 offset:49152
  v_mfma_f32_32x32x16_bf16 a[80:95], v[60:63], v[92:95], a[80:95]
  ds_read_b64_tr_b16 v[78:79], v27 offset:51200
  v_mfma_f32_32x32x16_bf16 a[96:111], v[60:63], v[96:99], a[96:111]
  ds_read_b128 v[48:51], v20 offset:8192
  v_mfma_f32_32x32x16_bf16 a[112:127], v[60:63], v[100:103], a[112:127]
  ds_read_b64_tr_b16 v[80:81], v28 offset:49152
  v_mfma_f32_32x32x16_bf16 a[128:143], v[64:67], v[88:91], a[128:143]
  ds_read_b64_tr_b16 v[82:83], v28 offset:51200
  v_mfma_f32_32x32x16_bf16 a[144:159], v[64:67], v[92:95], a[144:159]
  ds_read_b128 v[52:55], v20 offset:12288
  v_mfma_f32_32x32x16_bf16 a[160:175], v[64:67], v[96:99], a[160:175]
  ds_read_b64_tr_b16 v[84:85], v29 offset:49152
  v_mfma_f32_32x32x16_bf16 a[176:191], v[64:67], v[100:103], a[176:191]
  ds_read_b64_tr_b16 v[86:87], v29 offset:51200
  v_mfma_f32_32x32x16_bf16 a[192:207], v[68:71], v[88:91], a[192:207]
  v_mfma_f32_32x32x16_bf16 a[208:223], v[68:71], v[92:95], a[208:223]
  v_mfma_f32_32x32x16_bf16 a[224:239], v[68:71], v[96:99], a[224:239]
  v_mfma_f32_32x32x16_bf16 a[240:255], v[68:71], v[100:103], a[240:255]
  s_waitcnt lgkmcnt(0)
  v_mfma_f32_32x32x16_bf16 a[0:15], v[40:43], v[72:75], a[0:15]
  ds_read_b128 v[56:59], v21 offset:0
  v_mfma_f32_32x32x16_bf16 a[16:31], v[40:43], v[76:79], a[16:31]
  ds_read_b64_tr_b16 v[88:89], v26 offset:57344
  v_mfma_f32_32x32x16_bf16 a[32:47], v[40:43], v[80:83], a[32:47]
  ds_read_b64_tr_b16 v[90:91], v26 offset:59392
  v_mfma_f32_32x32x16_bf16 a[48:63], v[40:43], v[84:87], a[48:63]
  ds_read_b128 v[60:63], v21 offset:4096
  v_mfma_f32_32x32x16_bf16 a[64:79], v[44:47], v[72:75], a[64:79]
  ds_read_b64_tr_b16 v[92:93], v27 offset:57344
  v_mfma_f32_32x32x16_bf16 a[80:95], v[44:47], v[76:79], a[80:95]
  ds_read_b64_tr_b16 v[94:95], v27 offset:59392
  v_mfma_f32_32x32x16_bf16 a[96:111], v[44:47], v[80:83], a[96:111]
  ds_read_b128 v[64:67], v21 offset:8192
  v_mfma_f32_32x32x16_bf16 a[112:127], v[44:47], v[84:87], a[112:127]
  ds_read_b64_tr_b16 v[96:97], v28 offset:57344
  v_mfma_f32_32x32x16_bf16 a[128:143], v[48:51], v[72:75], a[128:143]
  ds_read_b64_tr_b16 v[98:99], v28 offset:59392
  v_mfma_f32_32x32x16_bf16 a[144:159], v[48:51], v[76:79], a[144:159]
  ds_read_b128 v[68:71], v21 offset:12288
  v_mfma_f32_32x32x16_bf16 a[160:175], v[48:51], v[80:83], a[160:175]
  ds_read_b64_tr_b16 v[100:101], v29 offset:57344
  v_mfma_f32_32x32x16_bf16 a[176:191], v[48:51], v[84:87], a[176:191]
  ds_read_b64_tr_b16 v[102:103], v29 offset:59392
  v_mfma_f32_32x32x16_bf16 a[192:207], v[52:55], v[72:75], a[192:207]
  v_mfma_f32_32x32x16_bf16 a[208:223], v[52:55], v[76:79], a[208:223]
  v_mfma_f32_32x32x16_bf16 a[224:239], v[52:55], v[80:83], a[224:239]
  v_mfma_f32_32x32x16_bf16 a[240:255], v[52:55], v[84:87], a[240:255]
  s_waitcnt lgkmcnt(0)
  v_mfma_f32_32x32x16_bf16 a[0:15], v[56:59], v[88:91], a[0:15]
  s_waitcnt vmcnt(0)
  s_barrier
  v_mfma_f32_32x32x16_bf16 a[16:31], v[56:59], v[92:95], a[16:31]
  ds_read_b128 v[40:43], v22 offset:0
  v_mfma_f32_32x32x16_bf16 a[32:47], v[56:59], v[96:99], a[32:47]
  ds_read_b64_tr_b16 v[72:73], v30 offset:32768
  v_mfma_f32_32x32x16_bf16 a[48:63], v[56:59], v[100:103], a[48:63]
  ds_read_b64_tr_b16 v[74:75], v30 offset:34816
  v_mfma_f32_32x32x16_bf16 a[64:79], v[60:63], v[88:91], a[64:79]
  ds_read_b128 v[44:47], v22 offset:4096
  v_mfma_f32_32x32x16_bf16 a[80:95], v[60:63], v[92:95], a[80:95]
  ds_read_b64_tr_b16 v[76:77], v31 offset:32768
  v_mfma_f32_32x32x16_bf16 a[96:111], v[60:63], v[96:99], a[96:111]
  ds_read_b64_tr_b16 v[78:79], v31 offset:34816
  v_mfma_f32_32x32x16_bf16 a[112:127], v[60:63], v[100:103], a[112:127]
  ds_read_b128 v[48:51], v22 offset:8192
  v_mfma_f32_32x32x16_bf16 a[128:143], v[64:67], v[88:91], a[128:143]
  ds_read_b64_tr_b16 v[80:81], v32 offset:32768
  v_mfma_f32_32x32x16_bf16 a[144:159], v[64:67], v[92:95], a[144:159]
  ds_read_b64_tr_b16 v[82:83], v32 offset:34816
  v_mfma_f32_32x32x16_bf16 a[160:175], v[64:67], v[96:99], a[160:175]
  ds_read_b128 v[52:55], v22 offset:12288
  v_mfma_f32_32x32x16_bf16 a[176:191], v[64:67], v[100:103], a[176:191]
  ds_read_b64_tr_b16 v[84:85], v33 offset:32768
  v_mfma_f32_32x32x16_bf16 a[192:207], v[68:71], v[88:91], a[192:207]
  ds_read_b64_tr_b16 v[86:87], v33 offset:34816
  v_mfma_f32_32x32x16_bf16 a[208:223], v[68:71], v[92:95], a[208:223]
  v_mfma_f32_32x32x16_bf16 a[224:239], v[68:71], v[96:99], a[224:239]
  v_mfma_f32_32x32x16_bf16 a[240:255], v[68:71], v[100:103], a[240:255]
  s_waitcnt lgkmcnt(0)
  v_mfma_f32_32x32x16_bf16 a[0:15], v[40:43], v[72:75], a[0:15]
  ds_read_b128 v[56:59], v23 offset:0
  v_mfma_f32_32x32x16_bf16 a[16:31], v[40:43], v[76:79], a[16:31]
  ds_read_b64_tr_b16 v[88:89], v30 offset:40960
  v_mfma_f32_32x32x16_bf16 a[32:47], v[40:43], v[80:83], a[32:47]
  ds_read_b64_tr_b16 v[90:91], v30 offset:43008
  v_mfma_f32_32x32x16_bf16 a[48:63], v[40:43], v[84:87], a[48:63]
  ds_read_b128 v[60:63], v23 offset:4096
  v_mfma_f32_32x32x16_bf16 a[64:79], v[44:47], v[72:75], a[64:79]
  ds_read_b64_tr_b16 v[92:93], v31 offset:40960
  v_mfma_f32_32x32x16_bf16 a[80:95], v[44:47], v[76:79], a[80:95]
  ds_read_b64_tr_b16 v[94:95], v31 offset:43008
  v_mfma_f32_32x32x16_bf16 a[96:111], v[44:47], v[80:83], a[96:111]
  ds_read_b128 v[64:67], v23 offset:8192
  v_mfma_f32_32x32x16_bf16 a[112:127], v[44:47], v[84:87], a[112:127]
  ds_read_b64_tr_b16 v[96:97], v32 offset:40960
  v_mfma_f32_32x32x16_bf16 a[128:143], v[48:51], v[72:75], a[128:143]
  ds_read_b64_tr_b16 v[98:99], v32 offset:43008
  v_mfma_f32_32x32x16_bf16 a[144:159], v[48:51], v[76:79], a[144:159]
  ds_read_b128 v[68:71], v23 offset:12288
  v_mfma_f32_32x32x16_bf16 a[160:175], v[48:51], v[80:83], a[160:175]
  ds_read_b64_tr_b16 v[100:101], v33 offset:40960
  v_mfma_f32_32x32x16_bf16 a[176:191], v[48:51], v[84:87], a[176:191]
  ds_read_b64_tr_b16 v[102:103], v33 offset:43008
  v_mfma_f32_32x32x16_bf16 a[192:207], v[52:55], v[72:75], a[192:207]
  v_mfma_f32_32x32x16_bf16 a[208:223], v[52:55], v[76:79], a[208:223]
  v_mfma_f32_32x32x16_bf16 a[224:239], v[52:55], v[80:83], a[224:239]
  v_mfma_f32_32x32x16_bf16 a[240:255], v[52:55], v[84:87], a[240:255]
  s_waitcnt lgkmcnt(0)
  v_mfma_f32_32x32x16_bf16 a[0:15], v[56:59], v[88:91], a[0:15]
  ds_read_b128 v[40:43], v24 offset:0
  v_mfma_f32_32x32x16_bf16 a[16:31], v[56:59], v[92:95], a[16:31]
  ds_read_b64_tr_b16 v[72:73], v30 offset:49152
  v_mfma_f32_32x32x16_bf16 a[32:47], v[56:59], v[96:99], a[32:47]
  ds_read_b64_tr_b16 v[74:75], v30 offset:51200
  v_mfma_f32_32x32x16_bf16 a[48:63], v[56:59], v[100:103], a[48:63]
  ds_read_b128 v[44:47], v24 offset:4096
  v_mfma_f32_32x32x16_bf16 a[64:79], v[60:63], v[88:91], a[64:79]
  ds_read_b64_tr_b16 v[76:77], v31 offset:49152
  v_mfma_f32_32x32x16_bf16 a[80:95], v[60:63], v[92:95], a[80:95]
  ds_read_b64_tr_b16 v[78:79], v31 offset:51200
  v_mfma_f32_32x32x16_bf16 a[96:111], v[60:63], v[96:99], a[96:111]
  ds_read_b128 v[48:51], v24 offset:8192
  v_mfma_f32_32x32x16_bf16 a[112:127], v[60:63], v[100:103], a[112:127]
  ds_read_b64_tr_b16 v[80:81], v32 offset:49152
  v_mfma_f32_32x32x16_bf16 a[128:143], v[64:67], v[88:91], a[128:143]
  ds_read_b64_tr_b16 v[82:83], v32 offset:51200
  v_mfma_f32_32x32x16_bf16 a[144:159], v[64:67], v[92:95], a[144:159]
  ds_read_b128 v[52:55], v24 offset:12288
  v_mfma_f32_32x32x16_bf16 a[160:175], v[64:67], v[96:99], a[160:175]
  ds_read_b64_tr_b16 v[84:85], v33 offset:49152
  v_mfma_f32_32x32x16_bf16 a[176:191], v[64:67], v[100:103], a[176:191]
  ds_read_b64_tr_b16 v[86:87], v33 offset:51200
  v_mfma_f32_32x32x16_bf16 a[192:207], v[68:71], v[88:91], a[192:207]
  v_mfma_f32_32x32x16_bf16 a[208:223], v[68:71], v[92:95], a[208:223]
  v_mfma_f32_32x32x16_bf16 a[224:239], v[68:71], v[96:99], a[224:239]
  v_mfma_f32_32x32x16_bf16 a[240:255], v[68:71], v[100:103], a[240:255]
  s_waitcnt lgkmcnt(0)
  v_mfma_f32_32x32x16_bf16 a[0:15], v[40:43], v[72:75], a[0:15]
  ds_read_b128 v[56:59], v25 offset:0
  v_mfma_f32_32x32x16_bf16 a[16:31], v[40:43], v[76:79], a[16:31]
  ds_read_b64_tr_b16 v[88:89], v30 offset:57344
  v_mfma_f32_32x32x16_bf16 a[32:47], v[40:43], v[80:83], a[32:47]
  ds_read_b64_tr_b16 v[90:91], v30 offset:59392
  v_mfma_f32_32x32x16_bf16 a[48:63], v[40:43], v[84:87], a[48:63]
  ds_read_b128 v[60:63], v25 offset:4096
  v_mfma_f32_32x32x16_bf16 a[64:79], v[44:47], v[72:75], a[64:79]
  ds_read_b64_tr_b16 v[92:93], v31 offset:57344
  v_mfma_f32_32x32x16_bf16 a[80:95], v[44:47], v[76:79], a[80:95]
  ds_read_b64_tr_b16 v[94:95], v31 offset:59392
  v_mfma_f32_32x32x16_bf16 a[96:111], v[44:47], v[80:83], a[96:111]
  ds_read_b128 v[64:67], v25 offset:8192
  v_mfma_f32_32x32x16_bf16 a[112:127], v[44:47], v[84:87], a[112:127]
  ds_read_b64_tr_b16 v[96:97], v32 offset:57344
  v_mfma_f32_32x32x16_bf16 a[128:143], v[48:51], v[72:75], a[128:143]
  ds_read_b64_tr_b16 v[98:99], v32 offset:59392
  v_mfma_f32_32x32x16_bf16 a[144:159], v[48:51], v[76:79], a[144:159]
  ds_read_b128 v[68:71], v25 offset:12288
  v_mfma_f32_32x32x16_bf16 a[160:175], v[48:51], v[80:83], a[160:175]
  ds_read_b64_tr_b16 v[100:101], v33 offset:57344
  v_mfma_f32_32x32x16_bf16 a[176:191], v[48:51], v[84:87], a[176:191]
  ds_read_b64_tr_b16 v[102:103], v33 offset:59392
  v_mfma_f32_32x32x16_bf16 a[192:207], v[52:55], v[72:75], a[192:207]
  v_mfma_f32_32x32x16_bf16 a[208:223], v[52:55], v[76:79], a[208:223]
  v_mfma_f32_32x32x16_bf16 a[224:239], v[52:55], v[80:83], a[224:239]
  v_mfma_f32_32x32x16_bf16 a[240:255], v[52:55], v[84:87], a[240:255]
  s_waitcnt lgkmcnt(0)
  v_mfma_f32_32x32x16_bf16 a[0:15], v[56:59], v[88:91], a[0:15]
  v_mfma_f32_32x32x16_bf16 a[16:31], v[56:59], v[92:95], a[16:31]
  v_mfma_f32_32x32x16_bf16 a[32:47], v[56:59], v[96:99], a[32:47]
  v_mfma_f32_32x32x16_bf16 a[48:63], v[56:59], v[100:103], a[48:63]
  v_mfma_f32_32x32x16_bf16 a[64:79], v[60:63], v[88:91], a[64:79]
  v_mfma_f32_32x32x16_bf16 a[80:95], v[60:63], v[92:95], a[80:95]
  v_mfma_f32_32x32x16_bf16 a[96:111], v[60:63], v[96:99], a[96:111]
  v_mfma_f32_32x32x16_bf16 a[112:127], v[60:63], v[100:103], a[112:127]
  v_mfma_f32_32x32x16_bf16 a[128:143], v[64:67], v[88:91], a[128:143]
  v_mfma_f32_32x32x16_bf16 a[144:159], v[64:67], v[92:95], a[144:159]
  v_mfma_f32_32x32x16_bf16 a[160:175], v[64:67], v[96:99], a[160:175]
  v_mfma_f32_32x32x16_bf16 a[176:191], v[64:67], v[100:103], a[176:191]
  v_mfma_f32_32x32x16_bf16 a[192:207], v[68:71], v[88:91], a[192:207]
  v_mfma_f32_32x32x16_bf16 a[208:223], v[68:71], v[92:95], a[208:223]
  v_mfma_f32_32x32x16_bf16 a[224:239], v[68:71], v[96:99], a[224:239]
  v_mfma_f32_32x32x16_bf16 a[240:255], v[68:71], v[100:103], a[240:255]
  s_lshr_b32 s90, s27, 1
  s_and_b32 s91, s27, 1
  v_mov_b32 v106, 0x0
  v_bfe_u32 v105, v1, 0, 4
  v_lshl_add_u32 v106, v105, 4, v106
  v_bfe_u32 v105, v1, 4, 1
  v_lshl_add_u32 v106, v105, 10, v106
  v_bfe_u32 v105, v1, 5, 1
  v_lshl_add_u32 v106, v105, 8, v106
  s_mul_i32 s92, s90, 4
  s_mul_i32 s92, s92, s26
  s_add_u32 s92, s92, s22
  s_mul_i32 s93, s91, 8192
  s_add_u32 s92, s92, s93
  s_add_u32 s93, s92, 0
  v_accvgpr_read_b32 v112, a0
  v_accvgpr_read_b32 v113, a1
  v_accvgpr_read_b32 v114, a2
  v_accvgpr_read_b32 v115, a3
  v_accvgpr_read_b32 v116, a8
  v_accvgpr_read_b32 v117, a9
  v_accvgpr_read_b32 v118, a10
  v_accvgpr_read_b32 v119, a11
  v_cvt_pk_bf16_f32 v108, v112, v113
  v_cvt_pk_bf16_f32 v109, v114, v115
  v_cvt_pk_bf16_f32 v110, v116, v117
  v_cvt_pk_bf16_f32 v111, v118, v119
  buffer_store_dwordx4 v[108:111], v106, s[16:19], s93 offen offset:0 sc1
  v_accvgpr_read_b32 v124, a4
  v_accvgpr_read_b32 v125, a5
  v_accvgpr_read_b32 v126, a6
  v_accvgpr_read_b32 v127, a7
  v_accvgpr_read_b32 v128, a12
  v_accvgpr_read_b32 v129, a13
  v_accvgpr_read_b32 v130, a14
  v_accvgpr_read_b32 v131, a15
  v_cvt_pk_bf16_f32 v120, v124, v125
  v_cvt_pk_bf16_f32 v121, v126, v127
  v_cvt_pk_bf16_f32 v122, v128, v129
  v_cvt_pk_bf16_f32 v123, v130, v131
  buffer_store_dwordx4 v[120:123], v106, s[16:19], s93 offen offset:512 sc1
  s_add_u32 s93, s92, 2048
  v_accvgpr_read_b32 v136, a16
  v_accvgpr_read_b32 v137, a17
  v_accvgpr_read_b32 v138, a18
  v_accvgpr_read_b32 v139, a19
  v_accvgpr_read_b32 v140, a24
  v_accvgpr_read_b32 v141, a25
  v_accvgpr_read_b32 v142, a26
  v_accvgpr_read_b32 v143, a27
  v_cvt_pk_bf16_f32 v132, v136, v137
  v_cvt_pk_bf16_f32 v133, v138, v139
  v_cvt_pk_bf16_f32 v134, v140, v141
  v_cvt_pk_bf16_f32 v135, v142, v143
  buffer_store_dwordx4 v[132:135], v106, s[16:19], s93 offen offset:0 sc1
  v_accvgpr_read_b32 v148, a20
  v_accvgpr_read_b32 v149, a21
  v_accvgpr_read_b32 v150, a22
  v_accvgpr_read_b32 v151, a23
  v_accvgpr_read_b32 v152, a28
  v_accvgpr_read_b32 v153, a29
  v_accvgpr_read_b32 v154, a30
  v_accvgpr_read_b32 v155, a31
  v_cvt_pk_bf16_f32 v144, v148, v149
  v_cvt_pk_bf16_f32 v145, v150, v151
  v_cvt_pk_bf16_f32 v146, v152, v153
  v_cvt_pk_bf16_f32 v147, v154, v155
  buffer_store_dwordx4 v[144:147], v106, s[16:19], s93 offen offset:512 sc1
  s_add_u32 s93, s92, 4096
  v_accvgpr_read_b32 v112, a32
  v_accvgpr_read_b32 v113, a33
  v_accvgpr_read_b32 v114, a34
  v_accvgpr_read_b32 v115, a35
  v_accvgpr_read_b32 v116, a40
  v_accvgpr_read_b32 v117, a41
  v_accvgpr_read_b32 v118, a42
  v_accvgpr_read_b32 v119, a43
  v_cvt_pk_bf16_f32 v108, v112, v113
  v_cvt_pk_bf16_f32 v109, v114, v115
  v_cvt_pk_bf16_f32 v110, v116, v117
  v_cvt_pk_bf16_f32 v111, v118, v119
  buffer_store_dwordx4 v[108:111], v106, s[16:19], s93 offen offset:0 sc1
  v_accvgpr_read_b32 v124, a36
  v_accvgpr_read_b32 v125, a37
  v_accvgpr_read_b32 v126, a38
  v_accvgpr_read_b32 v127, a39
  v_accvgpr_read_b32 v128, a44
  v_accvgpr_read_b32 v129, a45
  v_accvgpr_read_b32 v130, a46
  v_accvgpr_read_b32 v131, a47
  v_cvt_pk_bf16_f32 v120, v124, v125
  v_cvt_pk_bf16_f32 v121, v126, v127
  v_cvt_pk_bf16_f32 v122, v128, v129
  v_cvt_pk_bf16_f32 v123, v130, v131
  buffer_store_dwordx4 v[120:123], v106, s[16:19], s93 offen offset:512 sc1
  s_add_u32 s93, s92, 6144
  v_accvgpr_read_b32 v136, a48
  v_accvgpr_read_b32 v137, a49
  v_accvgpr_read_b32 v138, a50
  v_accvgpr_read_b32 v139, a51
  v_accvgpr_read_b32 v140, a56
  v_accvgpr_read_b32 v141, a57
  v_accvgpr_read_b32 v142, a58
  v_accvgpr_read_b32 v143, a59
  v_cvt_pk_bf16_f32 v132, v136, v137
  v_cvt_pk_bf16_f32 v133, v138, v139
  v_cvt_pk_bf16_f32 v134, v140, v141
  v_cvt_pk_bf16_f32 v135, v142, v143
  buffer_store_dwordx4 v[132:135], v106, s[16:19], s93 offen offset:0 sc1
  v_accvgpr_read_b32 v148, a52
  v_accvgpr_read_b32 v149, a53
  v_accvgpr_read_b32 v150, a54
  v_accvgpr_read_b32 v151, a55
  v_accvgpr_read_b32 v152, a60
  v_accvgpr_read_b32 v153, a61
  v_accvgpr_read_b32 v154, a62
  v_accvgpr_read_b32 v155, a63
  v_cvt_pk_bf16_f32 v144, v148, v149
  v_cvt_pk_bf16_f32 v145, v150, v151
  v_cvt_pk_bf16_f32 v146, v152, v153
  v_cvt_pk_bf16_f32 v147, v154, v155
  buffer_store_dwordx4 v[144:147], v106, s[16:19], s93 offen offset:512 sc1
  s_add_u32 s92, s92, s26
  s_add_u32 s93, s92, 0
  v_accvgpr_read_b32 v112, a64
  v_accvgpr_read_b32 v113, a65
  v_accvgpr_read_b32 v114, a66
  v_accvgpr_read_b32 v115, a67
  v_accvgpr_read_b32 v116, a72
  v_accvgpr_read_b32 v117, a73
  v_accvgpr_read_b32 v118, a74
  v_accvgpr_read_b32 v119, a75
  v_cvt_pk_bf16_f32 v108, v112, v113
  v_cvt_pk_bf16_f32 v109, v114, v115
  v_cvt_pk_bf16_f32 v110, v116, v117
  v_cvt_pk_bf16_f32 v111, v118, v119
  buffer_store_dwordx4 v[108:111], v106, s[16:19], s93 offen offset:0 sc1
  v_accvgpr_read_b32 v124, a68
  v_accvgpr_read_b32 v125, a69
  v_accvgpr_read_b32 v126, a70
  v_accvgpr_read_b32 v127, a71
  v_accvgpr_read_b32 v128, a76
  v_accvgpr_read_b32 v129, a77
  v_accvgpr_read_b32 v130, a78
  v_accvgpr_read_b32 v131, a79
  v_cvt_pk_bf16_f32 v120, v124, v125
  v_cvt_pk_bf16_f32 v121, v126, v127
  v_cvt_pk_bf16_f32 v122, v128, v129
  v_cvt_pk_bf16_f32 v123, v130, v131
  buffer_store_dwordx4 v[120:123], v106, s[16:19], s93 offen offset:512 sc1
  s_add_u32 s93, s92, 2048
  v_accvgpr_read_b32 v136, a80
  v_accvgpr_read_b32 v137, a81
  v_accvgpr_read_b32 v138, a82
  v_accvgpr_read_b32 v139, a83
  v_accvgpr_read_b32 v140, a88
  v_accvgpr_read_b32 v141, a89
  v_accvgpr_read_b32 v142, a90
  v_accvgpr_read_b32 v143, a91
  v_cvt_pk_bf16_f32 v132, v136, v137
  v_cvt_pk_bf16_f32 v133, v138, v139
  v_cvt_pk_bf16_f32 v134, v140, v141
  v_cvt_pk_bf16_f32 v135, v142, v143
  buffer_store_dwordx4 v[132:135], v106, s[16:19], s93 offen offset:0 sc1
  v_accvgpr_read_b32 v148, a84
  v_accvgpr_read_b32 v149, a85
  v_accvgpr_read_b32 v150, a86
  v_accvgpr_read_b32 v151, a87
  v_accvgpr_read_b32 v152, a92
  v_accvgpr_read_b32 v153, a93
  v_accvgpr_read_b32 v154, a94
  v_accvgpr_read_b32 v155, a95
  v_cvt_pk_bf16_f32 v144, v148, v149
  v_cvt_pk_bf16_f32 v145, v150, v151
  v_cvt_pk_bf16_f32 v146, v152, v153
  v_cvt_pk_bf16_f32 v147, v154, v155
  buffer_store_dwordx4 v[144:147], v106, s[16:19], s93 offen offset:512 sc1
  s_add_u32 s93, s92, 4096
  v_accvgpr_read_b32 v112, a96
  v_accvgpr_read_b32 v113, a97
  v_accvgpr_read_b32 v114, a98
  v_accvgpr_read_b32 v115, a99
  v_accvgpr_read_b32 v116, a104
  v_accvgpr_read_b32 v117, a105
  v_accvgpr_read_b32 v118, a106
  v_accvgpr_read_b32 v119, a107
  v_cvt_pk_bf16_f32 v108, v112, v113
  v_cvt_pk_bf16_f32 v109, v114, v115
  v_cvt_pk_bf16_f32 v110, v116, v117
  v_cvt_pk_bf16_f32 v111, v118, v119
  buffer_store_dwordx4 v[108:111], v106, s[16:19], s93 offen offset:0 sc1
  v_accvgpr_read_b32 v124, a100
  v_accvgpr_read_b32 v125, a101
  v_accvgpr_read_b32 v126, a102
  v_accvgpr_read_b32 v127, a103
  v_accvgpr_read_b32 v128, a108
  v_accvgpr_read_b32 v129, a109
  v_accvgpr_read_b32 v130, a110
  v_accvgpr_read_b32 v131, a111
  v_cvt_pk_bf16_f32 v120, v124, v125
  v_cvt_pk_bf16_f32 v121, v126, v127
  v_cvt_pk_bf16_f32 v122, v128, v129
  v_cvt_pk_bf16_f32 v123, v130, v131
  buffer_store_dwordx4 v[120:123], v106, s[16:19], s93 offen offset:512 sc1
  s_add_u32 s93, s92, 6144
  v_accvgpr_read_b32 v136, a112
  v_accvgpr_read_b32 v137, a113
  v_accvgpr_read_b32 v138, a114
  v_accvgpr_read_b32 v139, a115
  v_accvgpr_read_b32 v140, a120
  v_accvgpr_read_b32 v141, a121
  v_accvgpr_read_b32 v142, a122
  v_accvgpr_read_b32 v143, a123
  v_cvt_pk_bf16_f32 v132, v136, v137
  v_cvt_pk_bf16_f32 v133, v138, v139
  v_cvt_pk_bf16_f32 v134, v140, v141
  v_cvt_pk_bf16_f32 v135, v142, v143
  buffer_store_dwordx4 v[132:135], v106, s[16:19], s93 offen offset:0 sc1
  v_accvgpr_read_b32 v148, a116
  v_accvgpr_read_b32 v149, a117
  v_accvgpr_read_b32 v150, a118
  v_accvgpr_read_b32 v151, a119
  v_accvgpr_read_b32 v152, a124
  v_accvgpr_read_b32 v153, a125
  v_accvgpr_read_b32 v154, a126
  v_accvgpr_read_b32 v155, a127
  v_cvt_pk_bf16_f32 v144, v148, v149
  v_cvt_pk_bf16_f32 v145, v150, v151
  v_cvt_pk_bf16_f32 v146, v152, v153
  v_cvt_pk_bf16_f32 v147, v154, v155
  buffer_store_dwordx4 v[144:147], v106, s[16:19], s93 offen offset:512 sc1
  s_add_u32 s92, s92, s26
  s_add_u32 s93, s92, 0
  v_accvgpr_read_b32 v112, a128
  v_accvgpr_read_b32 v113, a129
  v_accvgpr_read_b32 v114, a130
  v_accvgpr_read_b32 v115, a131
  v_accvgpr_read_b32 v116, a136
  v_accvgpr_read_b32 v117, a137
  v_accvgpr_read_b32 v118, a138
  v_accvgpr_read_b32 v119, a139
  v_cvt_pk_bf16_f32 v108, v112, v113
  v_cvt_pk_bf16_f32 v109, v114, v115
  v_cvt_pk_bf16_f32 v110, v116, v117
  v_cvt_pk_bf16_f32 v111, v118, v119
  buffer_store_dwordx4 v[108:111], v106, s[16:19], s93 offen offset:0 sc1
  v_accvgpr_read_b32 v124, a132
  v_accvgpr_read_b32 v125, a133
  v_accvgpr_read_b32 v126, a134
  v_accvgpr_read_b32 v127, a135
  v_accvgpr_read_b32 v128, a140
  v_accvgpr_read_b32 v129, a141
  v_accvgpr_read_b32 v130, a142
  v_accvgpr_read_b32 v131, a143
  v_cvt_pk_bf16_f32 v120, v124, v125
  v_cvt_pk_bf16_f32 v121, v126, v127
  v_cvt_pk_bf16_f32 v122, v128, v129
  v_cvt_pk_bf16_f32 v123, v130, v131
  buffer_store_dwordx4 v[120:123], v106, s[16:19], s93 offen offset:512 sc1
  s_add_u32 s93, s92, 2048
  v_accvgpr_read_b32 v136, a144
  v_accvgpr_read_b32 v137, a145
  v_accvgpr_read_b32 v138, a146
  v_accvgpr_read_b32 v139, a147
  v_accvgpr_read_b32 v140, a152
  v_accvgpr_read_b32 v141, a153
  v_accvgpr_read_b32 v142, a154
  v_accvgpr_read_b32 v143, a155
  v_cvt_pk_bf16_f32 v132, v136, v137
  v_cvt_pk_bf16_f32 v133, v138, v139
  v_cvt_pk_bf16_f32 v134, v140, v141
  v_cvt_pk_bf16_f32 v135, v142, v143
  buffer_store_dwordx4 v[132:135], v106, s[16:19], s93 offen offset:0 sc1
  v_accvgpr_read_b32 v148, a148
  v_accvgpr_read_b32 v149, a149
  v_accvgpr_read_b32 v150, a150
  v_accvgpr_read_b32 v151, a151
  v_accvgpr_read_b32 v152, a156
  v_accvgpr_read_b32 v153, a157
  v_accvgpr_read_b32 v154, a158
  v_accvgpr_read_b32 v155, a159
  v_cvt_pk_bf16_f32 v144, v148, v149
  v_cvt_pk_bf16_f32 v145, v150, v151
  v_cvt_pk_bf16_f32 v146, v152, v153
  v_cvt_pk_bf16_f32 v147, v154, v155
  buffer_store_dwordx4 v[144:147], v106, s[16:19], s93 offen offset:512 sc1
  s_add_u32 s93, s92, 4096
  v_accvgpr_read_b32 v112, a160
  v_accvgpr_read_b32 v113, a161
  v_accvgpr_read_b32 v114, a162
  v_accvgpr_read_b32 v115, a163
  v_accvgpr_read_b32 v116, a168
  v_accvgpr_read_b32 v117, a169
  v_accvgpr_read_b32 v118, a170
  v_accvgpr_read_b32 v119, a171
  v_cvt_pk_bf16_f32 v108, v112, v113
  v_cvt_pk_bf16_f32 v109, v114, v115
  v_cvt_pk_bf16_f32 v110, v116, v117
  v_cvt_pk_bf16_f32 v111, v118, v119
  buffer_store_dwordx4 v[108:111], v106, s[16:19], s93 offen offset:0 sc1
  v_accvgpr_read_b32 v124, a164
  v_accvgpr_read_b32 v125, a165
  v_accvgpr_read_b32 v126, a166
  v_accvgpr_read_b32 v127, a167
  v_accvgpr_read_b32 v128, a172
  v_accvgpr_read_b32 v129, a173
  v_accvgpr_read_b32 v130, a174
  v_accvgpr_read_b32 v131, a175
  v_cvt_pk_bf16_f32 v120, v124, v125
  v_cvt_pk_bf16_f32 v121, v126, v127
  v_cvt_pk_bf16_f32 v122, v128, v129
  v_cvt_pk_bf16_f32 v123, v130, v131
  buffer_store_dwordx4 v[120:123], v106, s[16:19], s93 offen offset:512 sc1
  s_add_u32 s93, s92, 6144
  v_accvgpr_read_b32 v136, a176
  v_accvgpr_read_b32 v137, a177
  v_accvgpr_read_b32 v138, a178
  v_accvgpr_read_b32 v139, a179
  v_accvgpr_read_b32 v140, a184
  v_accvgpr_read_b32 v141, a185
  v_accvgpr_read_b32 v142, a186
  v_accvgpr_read_b32 v143, a187
  v_cvt_pk_bf16_f32 v132, v136, v137
  v_cvt_pk_bf16_f32 v133, v138, v139
  v_cvt_pk_bf16_f32 v134, v140, v141
  v_cvt_pk_bf16_f32 v135, v142, v143
  buffer_store_dwordx4 v[132:135], v106, s[16:19], s93 offen offset:0 sc1
  v_accvgpr_read_b32 v148, a180
  v_accvgpr_read_b32 v149, a181
  v_accvgpr_read_b32 v150, a182
  v_accvgpr_read_b32 v151, a183
  v_accvgpr_read_b32 v152, a188
  v_accvgpr_read_b32 v153, a189
  v_accvgpr_read_b32 v154, a190
  v_accvgpr_read_b32 v155, a191
  v_cvt_pk_bf16_f32 v144, v148, v149
  v_cvt_pk_bf16_f32 v145, v150, v151
  v_cvt_pk_bf16_f32 v146, v152, v153
  v_cvt_pk_bf16_f32 v147, v154, v155
  buffer_store_dwordx4 v[144:147], v106, s[16:19], s93 offen offset:512 sc1
  s_add_u32 s92, s92, s26
  s_add_u32 s93, s92, 0
  v_accvgpr_read_b32 v112, a192
  v_accvgpr_read_b32 v113, a193
  v_accvgpr_read_b32 v114, a194
  v_accvgpr_read_b32 v115, a195
  v_accvgpr_read_b32 v116, a200
  v_accvgpr_read_b32 v117, a201
  v_accvgpr_read_b32 v118, a202
  v_accvgpr_read_b32 v119, a203
  v_cvt_pk_bf16_f32 v108, v112, v113
  v_cvt_pk_bf16_f32 v109, v114, v115
  v_cvt_pk_bf16_f32 v110, v116, v117
  v_cvt_pk_bf16_f32 v111, v118, v119
  buffer_store_dwordx4 v[108:111], v106, s[16:19], s93 offen offset:0 sc1
  v_accvgpr_read_b32 v124, a196
  v_accvgpr_read_b32 v125, a197
  v_accvgpr_read_b32 v126, a198
  v_accvgpr_read_b32 v127, a199
  v_accvgpr_read_b32 v128, a204
  v_accvgpr_read_b32 v129, a205
  v_accvgpr_read_b32 v130, a206
  v_accvgpr_read_b32 v131, a207
  v_cvt_pk_bf16_f32 v120, v124, v125
  v_cvt_pk_bf16_f32 v121, v126, v127
  v_cvt_pk_bf16_f32 v122, v128, v129
  v_cvt_pk_bf16_f32 v123, v130, v131
  buffer_store_dwordx4 v[120:123], v106, s[16:19], s93 offen offset:512 sc1
  s_add_u32 s93, s92, 2048
  v_accvgpr_read_b32 v136, a208
  v_accvgpr_read_b32 v137, a209
  v_accvgpr_read_b32 v138, a210
  v_accvgpr_read_b32 v139, a211
  v_accvgpr_read_b32 v140, a216
  v_accvgpr_read_b32 v141, a217
  v_accvgpr_read_b32 v142, a218
  v_accvgpr_read_b32 v143, a219
  v_cvt_pk_bf16_f32 v132, v136, v137
  v_cvt_pk_bf16_f32 v133, v138, v139
  v_cvt_pk_bf16_f32 v134, v140, v141
  v_cvt_pk_bf16_f32 v135, v142, v143
  buffer_store_dwordx4 v[132:135], v106, s[16:19], s93 offen offset:0 sc1
  v_accvgpr_read_b32 v148, a212
  v_accvgpr_read_b32 v149, a213
  v_accvgpr_read_b32 v150, a214
  v_accvgpr_read_b32 v151, a215
  v_accvgpr_read_b32 v152, a220
  v_accvgpr_read_b32 v153, a221
  v_accvgpr_read_b32 v154, a222
  v_accvgpr_read_b32 v155, a223
  v_cvt_pk_bf16_f32 v144, v148, v149
  v_cvt_pk_bf16_f32 v145, v150, v151
  v_cvt_pk_bf16_f32 v146, v152, v153
  v_cvt_pk_bf16_f32 v147, v154, v155
  buffer_store_dwordx4 v[144:147], v106, s[16:19], s93 offen offset:512 sc1
  s_add_u32 s93, s92, 4096
  v_accvgpr_read_b32 v112, a224
  v_accvgpr_read_b32 v113, a225
  v_accvgpr_read_b32 v114, a226
  v_accvgpr_read_b32 v115, a227
  v_accvgpr_read_b32 v116, a232
  v_accvgpr_read_b32 v117, a233
  v_accvgpr_read_b32 v118, a234
  v_accvgpr_read_b32 v119, a235
  v_cvt_pk_bf16_f32 v108, v112, v113
  v_cvt_pk_bf16_f32 v109, v114, v115
  v_cvt_pk_bf16_f32 v110, v116, v117
  v_cvt_pk_bf16_f32 v111, v118, v119
  buffer_store_dwordx4 v[108:111], v106, s[16:19], s93 offen offset:0 sc1
  v_accvgpr_read_b32 v124, a228
  v_accvgpr_read_b32 v125, a229
  v_accvgpr_read_b32 v126, a230
  v_accvgpr_read_b32 v127, a231
  v_accvgpr_read_b32 v128, a236
  v_accvgpr_read_b32 v129, a237
  v_accvgpr_read_b32 v130, a238
  v_accvgpr_read_b32 v131, a239
  v_cvt_pk_bf16_f32 v120, v124, v125
  v_cvt_pk_bf16_f32 v121, v126, v127
  v_cvt_pk_bf16_f32 v122, v128, v129
  v_cvt_pk_bf16_f32 v123, v130, v131
  buffer_store_dwordx4 v[120:123], v106, s[16:19], s93 offen offset:512 sc1
  s_add_u32 s93, s92, 6144
  v_accvgpr_read_b32 v136, a240
  v_accvgpr_read_b32 v137, a241
  v_accvgpr_read_b32 v138, a242
  v_accvgpr_read_b32 v139, a243
  v_accvgpr_read_b32 v140, a248
  v_accvgpr_read_b32 v141, a249
  v_accvgpr_read_b32 v142, a250
  v_accvgpr_read_b32 v143, a251
  v_cvt_pk_bf16_f32 v132, v136, v137
  v_cvt_pk_bf16_f32 v133, v138, v139
  v_cvt_pk_bf16_f32 v134, v140, v141
  v_cvt_pk_bf16_f32 v135, v142, v143
  buffer_store_dwordx4 v[132:135], v106, s[16:19], s93 offen offset:0 sc1
  v_accvgpr_read_b32 v148, a244
  v_accvgpr_read_b32 v149, a245
  v_accvgpr_read_b32 v150, a246
  v_accvgpr_read_b32 v151, a247
  v_accvgpr_read_b32 v152, a252
  v_accvgpr_read_b32 v153, a253
  v_accvgpr_read_b32 v154, a254
  v_accvgpr_read_b32 v155, a255
  v_cvt_pk_bf16_f32 v144, v148, v149
  v_cvt_pk_bf16_f32 v145, v150, v151
  v_cvt_pk_bf16_f32 v146, v152, v153
  v_cvt_pk_bf16_f32 v147, v154, v155
  buffer_store_dwordx4 v[144:147], v106, s[16:19], s93 offen offset:512 sc1
  s_add_u32 s92, s92, s26
  s_branch L_done
L_atb:
  s_lshl_b32 s40, s36, 2
  s_max_u32 s41, s36, 1
  s_sub_u32 s41, s41, 1
  s_lshl_b32 s41, s41, 2
  s_cmp_lg_u32 s32, 0
  s_cbranch_scc1 L_dd_5
  v_mov_b32 v2, 0
L_dw_4:
  buffer_load_dword v4, v2, s[28:31], s40 offen offset:128 sc1
  buffer_load_dword v5, v2, s[28:31], s41 offen offset:128 sc1
  s_waitcnt vmcnt(0)
  s_mov_b32 s44, 1
  v_readfirstlane_b32 s45, v4
  s_cmp_ge_u32 s45, 12
  s_cselect_b32 s44, s44, 0
  v_readfirstlane_b32 s45, v5
  s_cmp_ge_u32 s45, 12
  s_cselect_b32 s44, s44, 0
  s_cmp_eq_u32 s44, 1
  s_cbranch_scc1 L_dd_5
  s_sleep 8
  s_add_u32 s3, s3, 1
  s_cmp_lt_u32 s3, 2097152
  s_cbranch_scc1 L_dw_4
L_dd_5:
  s_barrier
  s_add_u32 s38, s40, 160
  s_lshl_b32 s46, s36, 3
  s_lshl_b32 s90, s37, 1
  s_add_u32 s99, s46, s90
  s_lshr_b32 s90, s32, 1
  s_add_u32 s99, s99, s90
  s_lshl_b32 s99, s99, 3
  s_lshl_b32 s90, s33, 1
  s_add_u32 s99, s99, s90
  s_and_b32 s90, s32, 1
  s_add_u32 s20, s99, s90
  v_and_b32 v1, 63, v0
  s_lshl_b32 s90, s20, 13
  s_sub_u32 s91, s90, 65536
  s_cmp_lt_u32 s20, 8
  s_cselect_b32 s91, s90, s91
  v_mov_b32 v2, 0x0
  v_bfe_u32 v7, v1, 0, 6
  v_lshl_add_u32 v2, v7, 4, v2
  v_add_u32 v3, 4096, v2
  s_add_u32 s92, s90, 67108864
  s_add_u32 s93, s90, 71303168
  s_add_u32 s94, s91, 71303168
  s_add_u32 s95, s90, 75497472
  s_add_u32 s96, s91, 75497472
  s_add_u32 s97, s90, 100663296
  buffer_load_dwordx4 v[8:11], v2, s[4:7], s92 offen offset:0 sc1
  buffer_load_dwordx4 v[12:15], v2, s[4:7], s92 offen offset:1024 sc1
  buffer_load_dwordx4 v[16:19], v2, s[4:7], s92 offen offset:2048 sc1
  buffer_load_dwordx4 v[20:23], v2, s[4:7], s92 offen offset:3072 sc1
  buffer_load_dwordx4 v[24:27], v3, s[4:7], s92 offen offset:0 sc1
  buffer_load_dwordx4 v[28:31], v3, s[4:7], s92 offen offset:1024 sc1
  buffer_load_dwordx4 v[32:35], v3, s[4:7], s92 offen offset:2048 sc1
  buffer_load_dwordx4 v[36:39], v3, s[4:7], s92 offen offset:3072 sc1
  buffer_load_dwordx4 v[40:43], v3, s[4:7], s94 offen offset:0 sc1
  buffer_load_dwordx4 v[44:47], v3, s[4:7], s94 offen offset:1024 sc1
  buffer_load_dwordx4 v[48:51], v3, s[4:7], s94 offen offset:2048 sc1
  buffer_load_dwordx4 v[52:55], v3, s[4:7], s94 offen offset:3072 sc1
  buffer_load_dwordx4 v[56:59], v2, s[4:7], s93 offen offset:0 sc1
  buffer_load_dwordx4 v[60:63], v2, s[4:7], s93 offen offset:1024 sc1
  buffer_load_dwordx4 v[64:67], v2, s[4:7], s93 offen offset:2048 sc1
  buffer_load_dwordx4 v[68:71], v2, s[4:7], s93 offen offset:3072 sc1
  buffer_load_dwordx4 v[72:75], v3, s[4:7], s93 offen offset:0 sc1
  buffer_load_dwordx4 v[76:79], v3, s[4:7], s93 offen offset:1024 sc1
  buffer_load_dwordx4 v[80:83], v3, s[4:7], s93 offen offset:2048 sc1
  buffer_load_dwordx4 v[84:87], v3, s[4:7], s93 offen offset:3072 sc1
  buffer_load_dwordx2 v[88:89], v2, s[4:7], s96 offen offset:8 sc1
  buffer_load_dwordx2 v[94:95], v2, s[4:7], s96 offen offset:1032 sc1
  buffer_load_dwordx2 v[100:101], v2, s[4:7], s96 offen offset:2056 sc1
  buffer_load_dwordx2 v[106:107], v2, s[4:7], s96 offen offset:3080 sc1
  buffer_load_dwordx2 v[112:113], v3, s[4:7], s96 offen offset:8 sc1
  buffer_load_dwordx2 v[118:119], v3, s[4:7], s96 offen offset:1032 sc1
  buffer_load_dwordx2 v[124:125], v3, s[4:7], s96 offen offset:2056 sc1
  buffer_load_dwordx2 v[130:131], v3, s[4:7], s96 offen offset:3080 sc1
  buffer_load_dwordx4 v[90:93], v2, s[4:7], s95 offen offset:0 sc1
  buffer_load_dwordx4 v[96:99], v2, s[4:7], s95 offen offset:1024 sc1
  buffer_load_dwordx4 v[102:105], v2, s[4:7], s95 offen offset:2048 sc1
  buffer_load_dwordx4 v[108:111], v2, s[4:7], s95 offen offset:3072 sc1
  buffer_load_dwordx4 v[114:117], v3, s[4:7], s95 offen offset:0 sc1
  buffer_load_dwordx4 v[120:123], v3, s[4:7], s95 offen offset:1024 sc1
  buffer_load_dwordx4 v[126:129], v3, s[4:7], s95 offen offset:2048 sc1
  buffer_load_dwordx4 v[132:135], v3, s[4:7], s95 offen offset:3072 sc1
  s_mov_b32 s40, 0x50000
  s_mov_b32 s41, 0x5550055
  s_mov_b32 s42, 0xa0000
  s_mov_b32 s43, 0xaaa00aa
  s_mov_b32 s44, 0x150001
  s_mov_b32 s45, 0x15550155
  s_mov_b32 s46, 0x2a0002
  s_mov_b32 s47, 0x2aaa02aa
  s_mov_b32 s48, 0x55505555
  s_mov_b32 s49, 0x50005500
  s_mov_b32 s50, 0xaaa0aaaa
  s_mov_b32 s51, 0xa000aa00
  s_mov_b32 s52, 0x55405554
  s_mov_b32 s53, 0x40005400
  s_mov_b32 s54, 0xaa80aaa8
  s_mov_b32 s55, 0x8000a800
  s_cmp_lt_u32 s20, 8
  s_cselect_b64 s[56:57], 0, s[40:41]
  s_cselect_b64 s[58:59], 0, s[42:43]
  s_cselect_b64 s[60:61], 0, s[44:45]
  s_cselect_b64 s[62:63], 0, s[46:47]
  s_mov_b32 s21, 0x3e8293ee
  v_mov_b32 v6, 0xcfa8965f
  s_waitcnt vmcnt(16)
  v_mfma_f32_16x16x32_bf16 v[136:139], v[40:43], v[8:11], 0
  v_mfma_f32_16x16x32_bf16 v[140:143], v[56:59], v[8:11], 0
  v_mfma_f32_16x16x32_bf16 v[144:147], v[44:47], v[12:15], 0
  v_mfma_f32_16x16x32_bf16 v[148:151], v[60:63], v[12:15], 0
  v_mfma_f32_16x16x32_bf16 v[152:155], v[48:51], v[16:19], 0
  v_mfma_f32_16x16x32_bf16 v[156:159], v[64:67], v[16:19], 0
  v_mfma_f32_16x16x32_bf16 v[160:163], v[52:55], v[20:23], 0
  v_mfma_f32_16x16x32_bf16 v[164:167], v[68:71], v[20:23], 0
  v_mfma_f32_16x16x32_bf16 v[168:171], v[56:59], v[24:27], 0
  v_mfma_f32_16x16x32_bf16 v[172:175], v[72:75], v[24:27], 0
  v_mfma_f32_16x16x32_bf16 v[176:179], v[60:63], v[28:31], 0
  v_mfma_f32_16x16x32_bf16 v[180:183], v[76:79], v[28:31], 0
  v_mfma_f32_16x16x32_bf16 v[184:187], v[64:67], v[32:35], 0
  v_mfma_f32_16x16x32_bf16 v[188:191], v[80:83], v[32:35], 0
  v_mfma_f32_16x16x32_bf16 v[192:195], v[68:71], v[36:39], 0
  v_mfma_f32_16x16x32_bf16 v[196:199], v[84:87], v[36:39], 0
  v_cndmask_b32 v136, v6, v136, s[56:57]
  v_cndmask_b32 v137, v6, v137, s[58:59]
  v_cndmask_b32 v138, v6, v138, s[60:61]
  v_cndmask_b32 v139, v6, v139, s[62:63]
  v_cndmask_b32 v140, v6, v140, s[48:49]
  v_cndmask_b32 v141, v6, v141, s[50:51]
  v_cndmask_b32 v142, v6, v142, s[52:53]
  v_cndmask_b32 v143, v6, v143, s[54:55]
  v_max3_f32 v4, v136, v137, v138
  v_max3_f32 v4, v4, v139, v140
  v_max3_f32 v4, v4, v141, v142
  v_max_f32 v4, v4, v143
  v_mov_b32 v5, v4
  s_nop 1
  v_permlane32_swap_b32 v4, v5
  v_max_f32 v4, v4, v5
  v_mov_b32 v5, v4
  s_nop 1
  v_permlane16_swap_b32 v4, v5
  v_max_f32 v4, v4, v5
  v_mul_f32 v4, s21, v4
  v_fma_f32 v136, v136, s21, -v4
  v_fma_f32 v137, v137, s21, -v4
  v_fma_f32 v138, v138, s21, -v4
  v_fma_f32 v139, v139, s21, -v4
  v_fma_f32 v140, v140, s21, -v4
  v_fma_f32 v141, v141, s21, -v4
  v_fma_f32 v142, v142, s21, -v4
  v_fma_f32 v143, v143, s21, -v4
  v_exp_f32 v136, v136
  v_exp_f32 v137, v137
  v_exp_f32 v138, v138
  v_exp_f32 v139, v139
  v_exp_f32 v140, v140
  v_exp_f32 v141, v141
  v_exp_f32 v142, v142
  v_exp_f32 v143, v143
  v_add_f32 v4, v136, v137
  v_add_f32 v4, v4, v138
  v_add_f32 v4, v4, v139
  v_add_f32 v4, v4, v140
  v_add_f32 v4, v4, v141
  v_add_f32 v4, v4, v142
  v_add_f32 v4, v4, v143
  v_mov_b32 v5, v4
  s_nop 1
  v_permlane32_swap_b32 v4, v5
  v_add_f32 v4, v4, v5
  v_mov_b32 v5, v4
  s_nop 1
  v_permlane16_swap_b32 v4, v5
  v_add_f32 v4, v4, v5
  v_rcp_f32 v4, v4
  s_nop 0
  v_mul_f32 v136, v136, v4
  v_mul_f32 v137, v137, v4
  v_mul_f32 v138, v138, v4
  v_mul_f32 v139, v139, v4
  v_mul_f32 v140, v140, v4
  v_mul_f32 v141, v141, v4
  v_mul_f32 v142, v142, v4
  v_mul_f32 v143, v143, v4
  v_cvt_pk_bf16_f32 v8, v136, v137
  v_cvt_pk_bf16_f32 v9, v138, v139
  v_cvt_pk_bf16_f32 v10, v140, v141
  v_cvt_pk_bf16_f32 v11, v142, v143
  v_cndmask_b32 v144, v6, v144, s[56:57]
  v_cndmask_b32 v145, v6, v145, s[58:59]
  v_cndmask_b32 v146, v6, v146, s[60:61]
  v_cndmask_b32 v147, v6, v147, s[62:63]
  v_cndmask_b32 v148, v6, v148, s[48:49]
  v_cndmask_b32 v149, v6, v149, s[50:51]
  v_cndmask_b32 v150, v6, v150, s[52:53]
  v_cndmask_b32 v151, v6, v151, s[54:55]
  v_max3_f32 v4, v144, v145, v146
  v_max3_f32 v4, v4, v147, v148
  v_max3_f32 v4, v4, v149, v150
  v_max_f32 v4, v4, v151
  v_mov_b32 v5, v4
  s_nop 1
  v_permlane32_swap_b32 v4, v5
  v_max_f32 v4, v4, v5
  v_mov_b32 v5, v4
  s_nop 1
  v_permlane16_swap_b32 v4, v5
  v_max_f32 v4, v4, v5
  v_mul_f32 v4, s21, v4
  v_fma_f32 v144, v144, s21, -v4
  v_fma_f32 v145, v145, s21, -v4
  v_fma_f32 v146, v146, s21, -v4
  v_fma_f32 v147, v147, s21, -v4
  v_fma_f32 v148, v148, s21, -v4
  v_fma_f32 v149, v149, s21, -v4
  v_fma_f32 v150, v150, s21, -v4
  v_fma_f32 v151, v151, s21, -v4
  v_exp_f32 v144, v144
  v_exp_f32 v145, v145
  v_exp_f32 v146, v146
  v_exp_f32 v147, v147
  v_exp_f32 v148, v148
  v_exp_f32 v149, v149
  v_exp_f32 v150, v150
  v_exp_f32 v151, v151
  v_add_f32 v4, v144, v145
  v_add_f32 v4, v4, v146
  v_add_f32 v4, v4, v147
  v_add_f32 v4, v4, v148
  v_add_f32 v4, v4, v149
  v_add_f32 v4, v4, v150
  v_add_f32 v4, v4, v151
  v_mov_b32 v5, v4
  s_nop 1
  v_permlane32_swap_b32 v4, v5
  v_add_f32 v4, v4, v5
  v_mov_b32 v5, v4
  s_nop 1
  v_permlane16_swap_b32 v4, v5
  v_add_f32 v4, v4, v5
  v_rcp_f32 v4, v4
  s_nop 0
  v_mul_f32 v144, v144, v4
  v_mul_f32 v145, v145, v4
  v_mul_f32 v146, v146, v4
  v_mul_f32 v147, v147, v4
  v_mul_f32 v148, v148, v4
  v_mul_f32 v149, v149, v4
  v_mul_f32 v150, v150, v4
  v_mul_f32 v151, v151, v4
  v_cvt_pk_bf16_f32 v12, v144, v145
  v_cvt_pk_bf16_f32 v13, v146, v147
  v_cvt_pk_bf16_f32 v14, v148, v149
  v_cvt_pk_bf16_f32 v15, v150, v151
  v_cndmask_b32 v152, v6, v152, s[56:57]
  v_cndmask_b32 v153, v6, v153, s[58:59]
  v_cndmask_b32 v154, v6, v154, s[60:61]
  v_cndmask_b32 v155, v6, v155, s[62:63]
  v_cndmask_b32 v156, v6, v156, s[48:49]
  v_cndmask_b32 v157, v6, v157, s[50:51]
  v_cndmask_b32 v158, v6, v158, s[52:53]
  v_cndmask_b32 v159, v6, v159, s[54:55]
  v_max3_f32 v4, v152, v153, v154
  v_max3_f32 v4, v4, v155, v156
  v_max3_f32 v4, v4, v157, v158
  v_max_f32 v4, v4, v159
  v_mov_b32 v5, v4
  s_nop 1
  v_permlane32_swap_b32 v4, v5
  v_max_f32 v4, v4, v5
  v_mov_b32 v5, v4
  s_nop 1
  v_permlane16_swap_b32 v4, v5
  v_max_f32 v4, v4, v5
  v_mul_f32 v4, s21, v4
  v_fma_f32 v152, v152, s21, -v4
  v_fma_f32 v153, v153, s21, -v4
  v_fma_f32 v154, v154, s21, -v4
  v_fma_f32 v155, v155, s21, -v4
  v_fma_f32 v156, v156, s21, -v4
  v_fma_f32 v157, v157, s21, -v4
  v_fma_f32 v158, v158, s21, -v4
  v_fma_f32 v159, v159, s21, -v4
  v_exp_f32 v152, v152
  v_exp_f32 v153, v153
  v_exp_f32 v154, v154
  v_exp_f32 v155, v155
  v_exp_f32 v156, v156
  v_exp_f32 v157, v157
  v_exp_f32 v158, v158
  v_exp_f32 v159, v159
  v_add_f32 v4, v152, v153
  v_add_f32 v4, v4, v154
  v_add_f32 v4, v4, v155
  v_add_f32 v4, v4, v156
  v_add_f32 v4, v4, v157
  v_add_f32 v4, v4, v158
  v_add_f32 v4, v4, v159
  v_mov_b32 v5, v4
  s_nop 1
  v_permlane32_swap_b32 v4, v5
  v_add_f32 v4, v4, v5
  v_mov_b32 v5, v4
  s_nop 1
  v_permlane16_swap_b32 v4, v5
  v_add_f32 v4, v4, v5
  v_rcp_f32 v4, v4
  s_nop 0
  v_mul_f32 v152, v152, v4
  v_mul_f32 v153, v153, v4
  v_mul_f32 v154, v154, v4
  v_mul_f32 v155, v155, v4
  v_mul_f32 v156, v156, v4
  v_mul_f32 v157, v157, v4
  v_mul_f32 v158, v158, v4
  v_mul_f32 v159, v159, v4
  v_cvt_pk_bf16_f32 v16, v152, v153
  v_cvt_pk_bf16_f32 v17, v154, v155
  v_cvt_pk_bf16_f32 v18, v156, v157
  v_cvt_pk_bf16_f32 v19, v158, v159
  v_cndmask_b32 v160, v6, v160, s[56:57]
  v_cndmask_b32 v161, v6, v161, s[58:59]
  v_cndmask_b32 v162, v6, v162, s[60:61]
  v_cndmask_b32 v163, v6, v163, s[62:63]
  v_cndmask_b32 v164, v6, v164, s[48:49]
  v_cndmask_b32 v165, v6, v165, s[50:51]
  v_cndmask_b32 v166, v6, v166, s[52:53]
  v_cndmask_b32 v167, v6, v167, s[54:55]
  v_max3_f32 v4, v160, v161, v162
  v_max3_f32 v4, v4, v163, v164
  v_max3_f32 v4, v4, v165, v166
  v_max_f32 v4, v4, v167
  v_mov_b32 v5, v4
  s_nop 1
  v_permlane32_swap_b32 v4, v5
  v_max_f32 v4, v4, v5
  v_mov_b32 v5, v4
  s_nop 1
  v_permlane16_swap_b32 v4, v5
  v_max_f32 v4, v4, v5
  v_mul_f32 v4, s21, v4
  v_fma_f32 v160, v160, s21, -v4
  v_fma_f32 v161, v161, s21, -v4
  v_fma_f32 v162, v162, s21, -v4
  v_fma_f32 v163, v163, s21, -v4
  v_fma_f32 v164, v164, s21, -v4
  v_fma_f32 v165, v165, s21, -v4
  v_fma_f32 v166, v166, s21, -v4
  v_fma_f32 v167, v167, s21, -v4
  v_exp_f32 v160, v160
  v_exp_f32 v161, v161
  v_exp_f32 v162, v162
  v_exp_f32 v163, v163
  v_exp_f32 v164, v164
  v_exp_f32 v165, v165
  v_exp_f32 v166, v166
  v_exp_f32 v167, v167
  v_add_f32 v4, v160, v161
  v_add_f32 v4, v4, v162
  v_add_f32 v4, v4, v163
  v_add_f32 v4, v4, v164
  v_add_f32 v4, v4, v165
  v_add_f32 v4, v4, v166
  v_add_f32 v4, v4, v167
  v_mov_b32 v5, v4
  s_nop 1
  v_permlane32_swap_b32 v4, v5
  v_add_f32 v4, v4, v5
  v_mov_b32 v5, v4
  s_nop 1
  v_permlane16_swap_b32 v4, v5
  v_add_f32 v4, v4, v5
  v_rcp_f32 v4, v4
  s_nop 0
  v_mul_f32 v160, v160, v4
  v_mul_f32 v161, v161, v4
  v_mul_f32 v162, v162, v4
  v_mul_f32 v163, v163, v4
  v_mul_f32 v164, v164, v4
  v_mul_f32 v165, v165, v4
  v_mul_f32 v166, v166, v4
  v_mul_f32 v167, v167, v4
  v_cvt_pk_bf16_f32 v20, v160, v161
  v_cvt_pk_bf16_f32 v21, v162, v163
  v_cvt_pk_bf16_f32 v22, v164, v165
  v_cvt_pk_bf16_f32 v23, v166, v167
  v_cndmask_b32 v168, v6, v168, s[40:41]
  v_cndmask_b32 v169, v6, v169, s[42:43]
  v_cndmask_b32 v170, v6, v170, s[44:45]
  v_cndmask_b32 v171, v6, v171, s[46:47]
  v_cndmask_b32 v172, v6, v172, s[48:49]
  v_cndmask_b32 v173, v6, v173, s[50:51]
  v_cndmask_b32 v174, v6, v174, s[52:53]
  v_cndmask_b32 v175, v6, v175, s[54:55]
  v_max3_f32 v4, v168, v169, v170
  v_max3_f32 v4, v4, v171, v172
  v_max3_f32 v4, v4, v173, v174
  v_max_f32 v4, v4, v175
  v_mov_b32 v5, v4
  s_nop 1
  v_permlane32_swap_b32 v4, v5
  v_max_f32 v4, v4, v5
  v_mov_b32 v5, v4
  s_nop 1
  v_permlane16_swap_b32 v4, v5
  v_max_f32 v4, v4, v5
  v_mul_f32 v4, s21, v4
  v_fma_f32 v168, v168, s21, -v4
  v_fma_f32 v169, v169, s21, -v4
  v_fma_f32 v170, v170, s21, -v4
  v_fma_f32 v171, v171, s21, -v4
  v_fma_f32 v172, v172, s21, -v4
  v_fma_f32 v173, v173, s21, -v4
  v_fma_f32 v174, v174, s21, -v4
  v_fma_f32 v175, v175, s21, -v4
  v_exp_f32 v168, v168
  v_exp_f32 v169, v169
  v_exp_f32 v170, v170
  v_exp_f32 v171, v171
  v_exp_f32 v172, v172
  v_exp_f32 v173, v173
  v_exp_f32 v174, v174
  v_exp_f32 v175, v175
  v_add_f32 v4, v168, v169
  v_add_f32 v4, v4, v170
  v_add_f32 v4, v4, v171
  v_add_f32 v4, v4, v172
  v_add_f32 v4, v4, v173
  v_add_f32 v4, v4, v174
  v_add_f32 v4, v4, v175
  v_mov_b32 v5, v4
  s_nop 1
  v_permlane32_swap_b32 v4, v5
  v_add_f32 v4, v4, v5
  v_mov_b32 v5, v4
  s_nop 1
  v_permlane16_swap_b32 v4, v5
  v_add_f32 v4, v4, v5
  v_rcp_f32 v4, v4
  s_nop 0
  v_mul_f32 v168, v168, v4
  v_mul_f32 v169, v169, v4
  v_mul_f32 v170, v170, v4
  v_mul_f32 v171, v171, v4
  v_mul_f32 v172, v172, v4
  v_mul_f32 v173, v173, v4
  v_mul_f32 v174, v174, v4
  v_mul_f32 v175, v175, v4
  v_cvt_pk_bf16_f32 v24, v168, v169
  v_cvt_pk_bf16_f32 v25, v170, v171
  v_cvt_pk_bf16_f32 v26, v172, v173
  v_cvt_pk_bf16_f32 v27, v174, v175
  v_cndmask_b32 v176, v6, v176, s[40:41]
  v_cndmask_b32 v177, v6, v177, s[42:43]
  v_cndmask_b32 v178, v6, v178, s[44:45]
  v_cndmask_b32 v179, v6, v179, s[46:47]
  v_cndmask_b32 v180, v6, v180, s[48:49]
  v_cndmask_b32 v181, v6, v181, s[50:51]
  v_cndmask_b32 v182, v6, v182, s[52:53]
  v_cndmask_b32 v183, v6, v183, s[54:55]
  v_max3_f32 v4, v176, v177, v178
  v_max3_f32 v4, v4, v179, v180
  v_max3_f32 v4, v4, v181, v182
  v_max_f32 v4, v4, v183
  v_mov_b32 v5, v4
  s_nop 1
  v_permlane32_swap_b32 v4, v5
  v_max_f32 v4, v4, v5
  v_mov_b32 v5, v4
  s_nop 1
  v_permlane16_swap_b32 v4, v5
  v_max_f32 v4, v4, v5
  v_mul_f32 v4, s21, v4
  v_fma_f32 v176, v176, s21, -v4
  v_fma_f32 v177, v177, s21, -v4
  v_fma_f32 v178, v178, s21, -v4
  v_fma_f32 v179, v179, s21, -v4
  v_fma_f32 v180, v180, s21, -v4
  v_fma_f32 v181, v181, s21, -v4
  v_fma_f32 v182, v182, s21, -v4
  v_fma_f32 v183, v183, s21, -v4
  v_exp_f32 v176, v176
  v_exp_f32 v177, v177
  v_exp_f32 v178, v178
  v_exp_f32 v179, v179
  v_exp_f32 v180, v180
  v_exp_f32 v181, v181
  v_exp_f32 v182, v182
  v_exp_f32 v183, v183
  v_add_f32 v4, v176, v177
  v_add_f32 v4, v4, v178
  v_add_f32 v4, v4, v179
  v_add_f32 v4, v4, v180
  v_add_f32 v4, v4, v181
  v_add_f32 v4, v4, v182
  v_add_f32 v4, v4, v183
  v_mov_b32 v5, v4
  s_nop 1
  v_permlane32_swap_b32 v4, v5
  v_add_f32 v4, v4, v5
  v_mov_b32 v5, v4
  s_nop 1
  v_permlane16_swap_b32 v4, v5
  v_add_f32 v4, v4, v5
  v_rcp_f32 v4, v4
  s_nop 0
  v_mul_f32 v176, v176, v4
  v_mul_f32 v177, v177, v4
  v_mul_f32 v178, v178, v4
  v_mul_f32 v179, v179, v4
  v_mul_f32 v180, v180, v4
  v_mul_f32 v181, v181, v4
  v_mul_f32 v182, v182, v4
  v_mul_f32 v183, v183, v4
  v_cvt_pk_bf16_f32 v28, v176, v177
  v_cvt_pk_bf16_f32 v29, v178, v179
  v_cvt_pk_bf16_f32 v30, v180, v181
  v_cvt_pk_bf16_f32 v31, v182, v183
  v_cndmask_b32 v184, v6, v184, s[40:41]
  v_cndmask_b32 v185, v6, v185, s[42:43]
  v_cndmask_b32 v186, v6, v186, s[44:45]
  v_cndmask_b32 v187, v6, v187, s[46:47]
  v_cndmask_b32 v188, v6, v188, s[48:49]
  v_cndmask_b32 v189, v6, v189, s[50:51]
  v_cndmask_b32 v190, v6, v190, s[52:53]
  v_cndmask_b32 v191, v6, v191, s[54:55]
  v_max3_f32 v4, v184, v185, v186
  v_max3_f32 v4, v4, v187, v188
  v_max3_f32 v4, v4, v189, v190
  v_max_f32 v4, v4, v191
  v_mov_b32 v5, v4
  s_nop 1
  v_permlane32_swap_b32 v4, v5
  v_max_f32 v4, v4, v5
  v_mov_b32 v5, v4
  s_nop 1
  v_permlane16_swap_b32 v4, v5
  v_max_f32 v4, v4, v5
  v_mul_f32 v4, s21, v4
  v_fma_f32 v184, v184, s21, -v4
  v_fma_f32 v185, v185, s21, -v4
  v_fma_f32 v186, v186, s21, -v4
  v_fma_f32 v187, v187, s21, -v4
  v_fma_f32 v188, v188, s21, -v4
  v_fma_f32 v189, v189, s21, -v4
  v_fma_f32 v190, v190, s21, -v4
  v_fma_f32 v191, v191, s21, -v4
  v_exp_f32 v184, v184
  v_exp_f32 v185, v185
  v_exp_f32 v186, v186
  v_exp_f32 v187, v187
  v_exp_f32 v188, v188
  v_exp_f32 v189, v189
  v_exp_f32 v190, v190
  v_exp_f32 v191, v191
  v_add_f32 v4, v184, v185
  v_add_f32 v4, v4, v186
  v_add_f32 v4, v4, v187
  v_add_f32 v4, v4, v188
  v_add_f32 v4, v4, v189
  v_add_f32 v4, v4, v190
  v_add_f32 v4, v4, v191
  v_mov_b32 v5, v4
  s_nop 1
  v_permlane32_swap_b32 v4, v5
  v_add_f32 v4, v4, v5
  v_mov_b32 v5, v4
  s_nop 1
  v_permlane16_swap_b32 v4, v5
  v_add_f32 v4, v4, v5
  v_rcp_f32 v4, v4
  s_nop 0
  v_mul_f32 v184, v184, v4
  v_mul_f32 v185, v185, v4
  v_mul_f32 v186, v186, v4
  v_mul_f32 v187, v187, v4
  v_mul_f32 v188, v188, v4
  v_mul_f32 v189, v189, v4
  v_mul_f32 v190, v190, v4
  v_mul_f32 v191, v191, v4
  v_cvt_pk_bf16_f32 v32, v184, v185
  v_cvt_pk_bf16_f32 v33, v186, v187
  v_cvt_pk_bf16_f32 v34, v188, v189
  v_cvt_pk_bf16_f32 v35, v190, v191
  v_cndmask_b32 v192, v6, v192, s[40:41]
  v_cndmask_b32 v193, v6, v193, s[42:43]
  v_cndmask_b32 v194, v6, v194, s[44:45]
  v_cndmask_b32 v195, v6, v195, s[46:47]
  v_cndmask_b32 v196, v6, v196, s[48:49]
  v_cndmask_b32 v197, v6, v197, s[50:51]
  v_cndmask_b32 v198, v6, v198, s[52:53]
  v_cndmask_b32 v199, v6, v199, s[54:55]
  v_max3_f32 v4, v192, v193, v194
  v_max3_f32 v4, v4, v195, v196
  v_max3_f32 v4, v4, v197, v198
  v_max_f32 v4, v4, v199
  v_mov_b32 v5, v4
  s_nop 1
  v_permlane32_swap_b32 v4, v5
  v_max_f32 v4, v4, v5
  v_mov_b32 v5, v4
  s_nop 1
  v_permlane16_swap_b32 v4, v5
  v_max_f32 v4, v4, v5
  v_mul_f32 v4, s21, v4
  v_fma_f32 v192, v192, s21, -v4
  v_fma_f32 v193, v193, s21, -v4
  v_fma_f32 v194, v194, s21, -v4
  v_fma_f32 v195, v195, s21, -v4
  v_fma_f32 v196, v196, s21, -v4
  v_fma_f32 v197, v197, s21, -v4
  v_fma_f32 v198, v198, s21, -v4
  v_fma_f32 v199, v199, s21, -v4
  v_exp_f32 v192, v192
  v_exp_f32 v193, v193
  v_exp_f32 v194, v194
  v_exp_f32 v195, v195
  v_exp_f32 v196, v196
  v_exp_f32 v197, v197
  v_exp_f32 v198, v198
  v_exp_f32 v199, v199
  v_add_f32 v4, v192, v193
  v_add_f32 v4, v4, v194
  v_add_f32 v4, v4, v195
  v_add_f32 v4, v4, v196
  v_add_f32 v4, v4, v197
  v_add_f32 v4, v4, v198
  v_add_f32 v4, v4, v199
  v_mov_b32 v5, v4
  s_nop 1
  v_permlane32_swap_b32 v4, v5
  v_add_f32 v4, v4, v5
  v_mov_b32 v5, v4
  s_nop 1
  v_permlane16_swap_b32 v4, v5
  v_add_f32 v4, v4, v5
  v_rcp_f32 v4, v4
  s_nop 0
  v_mul_f32 v192, v192, v4
  v_mul_f32 v193, v193, v4
  v_mul_f32 v194, v194, v4
  v_mul_f32 v195, v195, v4
  v_mul_f32 v196, v196, v4
  v_mul_f32 v197, v197, v4
  v_mul_f32 v198, v198, v4
  v_mul_f32 v199, v199, v4
  v_cvt_pk_bf16_f32 v36, v192, v193
  v_cvt_pk_bf16_f32 v37, v194, v195
  v_cvt_pk_bf16_f32 v38, v196, v197
  v_cvt_pk_bf16_f32 v39, v198, v199
  s_waitcnt vmcnt(0)
  v_mfma_f32_16x16x32_bf16 v[136:139], v[88:91], v[8:11], 0
  v_mfma_f32_16x16x32_bf16 v[140:143], v[94:97], v[8:11], 0
  v_mfma_f32_16x16x32_bf16 v[144:147], v[100:103], v[12:15], 0
  v_mfma_f32_16x16x32_bf16 v[148:151], v[106:109], v[12:15], 0
  v_mfma_f32_16x16x32_bf16 v[152:155], v[112:115], v[16:19], 0
  v_mfma_f32_16x16x32_bf16 v[156:159], v[118:121], v[16:19], 0
  v_mfma_f32_16x16x32_bf16 v[160:163], v[124:127], v[20:23], 0
  v_mfma_f32_16x16x32_bf16 v[164:167], v[130:133], v[20:23], 0
  v_mfma_f32_16x16x32_bf16 v[168:171], v[90:93], v[24:27], 0
  v_mfma_f32_16x16x32_bf16 v[172:175], v[96:99], v[24:27], 0
  v_mfma_f32_16x16x32_bf16 v[176:179], v[102:105], v[28:31], 0
  v_mfma_f32_16x16x32_bf16 v[180:183], v[108:111], v[28:31], 0
  v_mfma_f32_16x16x32_bf16 v[184:187], v[114:117], v[32:35], 0
  v_mfma_f32_16x16x32_bf16 v[188:191], v[120:123], v[32:35], 0
  v_mfma_f32_16x16x32_bf16 v[192:195], v[126:129], v[36:39], 0
  v_mfma_f32_16x16x32_bf16 v[196:199], v[132:135], v[36:39], 0
  v_cvt_pk_bf16_f32 v40, v136, v137
  v_cvt_pk_bf16_f32 v41, v138, v139
  v_cvt_pk_bf16_f32 v42, v140, v141
  v_cvt_pk_bf16_f32 v43, v142, v143
  buffer_store_dwordx4 v[40:43], v2, s[4:7], s97 offen offset:0 sc1
  v_cvt_pk_bf16_f32 v44, v144, v145
  v_cvt_pk_bf16_f32 v45, v146, v147
  v_cvt_pk_bf16_f32 v46, v148, v149
  v_cvt_pk_bf16_f32 v47, v150, v151
  buffer_store_dwordx4 v[44:47], v2, s[4:7], s97 offen offset:1024 sc1
  v_cvt_pk_bf16_f32 v48, v152, v153
  v_cvt_pk_bf16_f32 v49, v154, v155
  v_cvt_pk_bf16_f32 v50, v156, v157
  v_cvt_pk_bf16_f32 v51, v158, v159
  buffer_store_dwordx4 v[48:51], v2, s[4:7], s97 offen offset:2048 sc1
  v_cvt_pk_bf16_f32 v52, v160, v161
  v_cvt_pk_bf16_f32 v53, v162, v163
  v_cvt_pk_bf16_f32 v54, v164, v165
  v_cvt_pk_bf16_f32 v55, v166, v167
  buffer_store_dwordx4 v[52:55], v2, s[4:7], s97 offen offset:3072 sc1
  v_cvt_pk_bf16_f32 v56, v168, v169
  v_cvt_pk_bf16_f32 v57, v170, v171
  v_cvt_pk_bf16_f32 v58, v172, v173
  v_cvt_pk_bf16_f32 v59, v174, v175
  buffer_store_dwordx4 v[56:59], v3, s[4:7], s97 offen offset:0 sc1
  v_cvt_pk_bf16_f32 v60, v176, v177
  v_cvt_pk_bf16_f32 v61, v178, v179
  v_cvt_pk_bf16_f32 v62, v180, v181
  v_cvt_pk_bf16_f32 v63, v182, v183
  buffer_store_dwordx4 v[60:63], v3, s[4:7], s97 offen offset:1024 sc1
  v_cvt_pk_bf16_f32 v64, v184, v185
  v_cvt_pk_bf16_f32 v65, v186, v187
  v_cvt_pk_bf16_f32 v66, v188, v189
  v_cvt_pk_bf16_f32 v67, v190, v191
  buffer_store_dwordx4 v[64:67], v3, s[4:7], s97 offen offset:2048 sc1
  v_cvt_pk_bf16_f32 v68, v192, v193
  v_cvt_pk_bf16_f32 v69, v194, v195
  v_cvt_pk_bf16_f32 v70, v196, v197
  v_cvt_pk_bf16_f32 v71, v198, v199
  buffer_store_dwordx4 v[68:71], v3, s[4:7], s97 offen offset:3072 sc1
  s_branch L_done
L_ata:
  s_lshr_b32 s40, s36, 3
  s_lshl_b32 s40, s40, 2
  s_add_u32 s41, s36, 1
  s_cmp_lg_u32 s32, 0
  s_cbranch_scc1 L_dd_7
  v_mov_b32 v2, 0
L_dw_6:
  buffer_load_dword v4, v2, s[28:31], s40 offen offset:96 sc1
  buffer_load_dword v5, v2, s[28:31], s40 offen offset:64 sc1
  buffer_load_dwordx2 v[8:9], v2, s[28:31], 0 offen offset:40 sc1
  s_waitcnt vmcnt(0)
  s_mov_b32 s44, 1
  v_readfirstlane_b32 s45, v4
  s_cmp_ge_u32 s45, 16
  s_cselect_b32 s44, s44, 0
  v_readfirstlane_b32 s45, v5
  s_cmp_ge_u32 s45, 32
  s_cselect_b32 s44, s44, 0
  v_readfirstlane_b32 s45, v8
  v_readfirstlane_b32 s47, v9
  s_cmp_ge_u32 s47, 128
  s_cselect_b32 s45, 64, s45
  s_cmp_ge_u32 s45, s41
  s_cselect_b32 s44, s44, 0
  s_cmp_eq_u32 s44, 1
  s_cbranch_scc1 L_dd_7
  s_sleep 8
  s_add_u32 s3, s3, 1
  s_cmp_lt_u32 s3, 2097152
  s_cbranch_scc1 L_dw_6
L_dd_7:
  s_barrier
  s_lshr_b32 s38, s36, 2
  s_lshl_b32 s38, s38, 2
  s_add_u32 s38, s38, 192
  s_lshl_b32 s20, s36, 5
  s_lshl_b32 s90, s33, 3
  s_add_u32 s20, s20, s90
  s_lshl_b32 s90, s37, 2
  s_add_u32 s20, s20, s90
  s_add_u32 s20, s20, s32
  v_and_b32 v1, 63, v0
  s_lshl_b32 s90, s20, 13
  s_lshl_b32 s91, s20, 11
  v_mov_b32 v2, 0x0
  v_bfe_u32 v7, v1, 0, 6
  v_lshl_add_u32 v2, v7, 4, v2
  v_add_u32 v3, 4096, v2
  v_mov_b32 v4, 0x3000000
  v_bfe_u32 v7, v1, 0, 1
  v_lshl_add_u32 v4, v7, 4, v4
  v_bfe_u32 v7, v1, 2, 2
  v_lshl_add_u32 v4, v7, 5, v4
  v_bfe_u32 v7, v1, 4, 2
  v_lshl_add_u32 v4, v7, 7, v4
  v_add_u32 v5, 0x3400000, v2
  v_mov_b32 v8, 0x0
  v_bfe_u32 v7, v1, 0, 3
  v_lshl_add_u32 v8, v7, 4, v8
  v_bfe_u32 v7, v1, 3, 1
  v_lshl_add_u32 v8, v7, 11, v8
  v_bfe_u32 v7, v1, 4, 2
  v_lshl_add_u32 v8, v7, 8, v8
  v_add_u32 v9, 4096, v8
  v_mov_b32 v10, 0x0
  v_bfe_u32 v7, v1, 0, 4
  v_lshl_add_u32 v10, v7, 4, v10
  v_bfe_u32 v7, v1, 4, 1
  v_lshl_add_u32 v10, v7, 8, v10
  v_bfe_u32 v7, v1, 5, 1
  v_lshl_add_u32 v10, v7, 10, v10
  v_add_u32 v11, 4096, v10
  s_add_u32 s92, s90, 16777216
  s_add_u32 s93, s90, 33554432
  s_add_u32 s94, s90, 0
  s_add_u32 s95, s90, 83886080
  buffer_load_dwordx4 v[16:19], v2, s[4:7], s94 offen offset:0 sc1
  buffer_load_dwordx4 v[20:23], v2, s[4:7], s94 offen offset:1024 sc1
  buffer_load_dwordx4 v[24:27], v2, s[4:7], s94 offen offset:2048 sc1
  buffer_load_dwordx4 v[28:31], v2, s[4:7], s94 offen offset:3072 sc1
  buffer_load_dwordx4 v[32:35], v3, s[4:7], s94 offen offset:0 sc1
  buffer_load_dwordx4 v[36:39], v3, s[4:7], s94 offen offset:1024 sc1
  buffer_load_dwordx4 v[40:43], v3, s[4:7], s94 offen offset:2048 sc1
  buffer_load_dwordx4 v[44:47], v3, s[4:7], s94 offen offset:3072 sc1
  buffer_load_dwordx4 v[112:115], v4, s[4:7], s91 offen offset:0 sc1
  buffer_load_dwordx4 v[116:119], v4, s[4:7], s91 offen offset:512 sc1
  buffer_load_dwordx4 v[120:123], v4, s[4:7], s91 offen offset:1024 sc1
  buffer_load_dwordx4 v[124:127], v4, s[4:7], s91 offen offset:1536 sc1
  buffer_load_dwordx4 v[48:51], v2, s[4:7], s92 offen offset:0 sc1
  buffer_load_dwordx4 v[52:55], v2, s[4:7], s92 offen offset:1024 sc1
  buffer_load_dwordx4 v[56:59], v2, s[4:7], s92 offen offset:2048 sc1
  buffer_load_dwordx4 v[60:63], v2, s[4:7], s92 offen offset:3072 sc1
  buffer_load_dwordx4 v[64:67], v3, s[4:7], s92 offen offset:0 sc1
  buffer_load_dwordx4 v[68:71], v3, s[4:7], s92 offen offset:1024 sc1
  buffer_load_dwordx4 v[72:75], v3, s[4:7], s92 offen offset:2048 sc1
  buffer_load_dwordx4 v[76:79], v3, s[4:7], s92 offen offset:3072 sc1
  buffer_load_dwordx4 v[80:83], v8, s[4:7], s93 offen offset:0 sc1
  buffer_load_dwordx4 v[84:87], v8, s[4:7], s93 offen offset:128 sc1
  buffer_load_dwordx4 v[88:91], v8, s[4:7], s93 offen offset:1024 sc1
  buffer_load_dwordx4 v[92:95], v8, s[4:7], s93 offen offset:1152 sc1
  buffer_load_dwordx4 v[96:99], v9, s[4:7], s93 offen offset:0 sc1
  buffer_load_dwordx4 v[100:103], v9, s[4:7], s93 offen offset:128 sc1
  buffer_load_dwordx4 v[104:107], v9, s[4:7], s93 offen offset:1024 sc1
  buffer_load_dwordx4 v[108:111], v9, s[4:7], s93 offen offset:1152 sc1
  buffer_load_dwordx4 v[128:131], v5, s[4:7], s91 offen offset:0 sc1
  buffer_load_dwordx4 v[132:135], v5, s[4:7], s91 offen offset:1024 sc1
  s_mov_b32 s40, 0xfff0ffff
  s_mov_b32 s41, 0xf000ff00
  s_mov_b32 s42, 0xffe0fffe
  s_mov_b32 s43, 0xe000fe00
  s_mov_b32 s44, 0xffc0fffc
  s_mov_b32 s45, 0xc000fc00
  s_mov_b32 s46, 0xff80fff8
  s_mov_b32 s47, 0x8000f800
  s_mov_b32 s50, 0x3e0293ee
  v_mov_b32 v6, 0xd028965f
  s_waitcnt vmcnt(10)
  v_mfma_f32_16x16x32_bf16 v[136:139], v[112:115], v[16:19], 0
  v_mfma_f32_16x16x32_bf16 v[140:143], v[48:51], v[16:19], 0
  v_mfma_f32_16x16x32_bf16 v[144:147], v[112:115], v[32:35], 0
  v_mfma_f32_16x16x32_bf16 v[148:151], v[48:51], v[32:35], 0
  v_mfma_f32_16x16x32_bf16 v[152:155], v[64:67], v[32:35], 0
  v_mfma_f32_16x16x32_bf16 v[136:139], v[116:119], v[20:23], v[136:139]
  v_mfma_f32_16x16x32_bf16 v[140:143], v[52:55], v[20:23], v[140:143]
  v_mfma_f32_16x16x32_bf16 v[144:147], v[116:119], v[36:39], v[144:147]
  v_mfma_f32_16x16x32_bf16 v[148:151], v[52:55], v[36:39], v[148:151]
  v_mfma_f32_16x16x32_bf16 v[152:155], v[68:71], v[36:39], v[152:155]
  v_mfma_f32_16x16x32_bf16 v[136:139], v[120:123], v[24:27], v[136:139]
  v_mfma_f32_16x16x32_bf16 v[140:143], v[56:59], v[24:27], v[140:143]
  v_mfma_f32_16x16x32_bf16 v[144:147], v[120:123], v[40:43], v[144:147]
  v_mfma_f32_16x16x32_bf16 v[148:151], v[56:59], v[40:43], v[148:151]
  v_mfma_f32_16x16x32_bf16 v[152:155], v[72:75], v[40:43], v[152:155]
  v_mfma_f32_16x16x32_bf16 v[136:139], v[124:127], v[28:31], v[136:139]
  v_mfma_f32_16x16x32_bf16 v[140:143], v[60:63], v[28:31], v[140:143]
  v_mfma_f32_16x16x32_bf16 v[144:147], v[124:127], v[44:47], v[144:147]
  v_mfma_f32_16x16x32_bf16 v[148:151], v[60:63], v[44:47], v[148:151]
  v_mfma_f32_16x16x32_bf16 v[152:155], v[76:79], v[44:47], v[152:155]
  s_nop 4
  v_cndmask_b32 v140, v6, v140, s[40:41]
  v_cndmask_b32 v141, v6, v141, s[42:43]
  v_cndmask_b32 v142, v6, v142, s[44:45]
  v_cndmask_b32 v143, v6, v143, s[46:47]
  v_max3_f32 v12, v136, v137, v140
  v_max3_f32 v12, v12, v141, v142
  v_max_f32 v12, v12, v143
  v_mov_b32 v13, v12
  s_nop 1
  v_permlane32_swap_b32 v12, v13
  v_max_f32 v12, v12, v13
  v_mov_b32 v13, v12
  s_nop 1
  v_permlane16_swap_b32 v12, v13
  v_max_f32 v12, v12, v13
  v_mul_f32 v12, s50, v12
  v_fma_f32 v136, v136, s50, -v12
  v_fma_f32 v137, v137, s50, -v12
  v_fma_f32 v140, v140, s50, -v12
  v_fma_f32 v141, v141, s50, -v12
  v_fma_f32 v142, v142, s50, -v12
  v_fma_f32 v143, v143, s50, -v12
  v_exp_f32 v136, v136
  v_exp_f32 v137, v137
  v_exp_f32 v140, v140
  v_exp_f32 v141, v141
  v_exp_f32 v142, v142
  v_exp_f32 v143, v143
  v_add_f32 v12, v136, v137
  v_add_f32 v12, v12, v140
  v_add_f32 v12, v12, v141
  v_add_f32 v12, v12, v142
  v_add_f32 v12, v12, v143
  v_mov_b32 v13, v12
  s_nop 1
  v_permlane32_swap_b32 v12, v13
  v_add_f32 v12, v12, v13
  v_mov_b32 v13, v12
  s_nop 1
  v_permlane16_swap_b32 v12, v13
  v_add_f32 v12, v12, v13
  v_rcp_f32 v12, v12
  s_nop 0
  v_mul_f32 v136, v136, v12
  v_mul_f32 v137, v137, v12
  v_mul_f32 v140, v140, v12
  v_mul_f32 v141, v141, v12
  v_mul_f32 v142, v142, v12
  v_mul_f32 v143, v143, v12
  v_cvt_pk_bf16_f32 v160, v136, v137
  v_mov_b32 v161, 0
  v_mov_b32 v162, 0
  v_mov_b32 v163, v160
  v_cvt_pk_bf16_f32 v156, v140, v141
  v_cvt_pk_bf16_f32 v157, v142, v143
  v_mov_b32 v158, 0
  v_mov_b32 v159, 0
  v_cndmask_b32 v152, v6, v152, s[40:41]
  v_cndmask_b32 v153, v6, v153, s[42:43]
  v_cndmask_b32 v154, v6, v154, s[44:45]
  v_cndmask_b32 v155, v6, v155, s[46:47]
  v_max3_f32 v12, v144, v145, v148
  v_max3_f32 v12, v12, v149, v150
  v_max3_f32 v12, v12, v151, v152
  v_max3_f32 v12, v12, v153, v154
  v_max_f32 v12, v12, v155
  v_mov_b32 v13, v12
  s_nop 1
  v_permlane32_swap_b32 v12, v13
  v_max_f32 v12, v12, v13
  v_mov_b32 v13, v12
  s_nop 1
  v_permlane16_swap_b32 v12, v13
  v_max_f32 v12, v12, v13
  v_mul_f32 v12, s50, v12
  v_fma_f32 v144, v144, s50, -v12
  v_fma_f32 v145, v145, s50, -v12
  v_fma_f32 v148, v148, s50, -v12
  v_fma_f32 v149, v149, s50, -v12
  v_fma_f32 v150, v150, s50, -v12
  v_fma_f32 v151, v151, s50, -v12
  v_fma_f32 v152, v152, s50, -v12
  v_fma_f32 v153, v153, s50, -v12
  v_fma_f32 v154, v154, s50, -v12
  v_fma_f32 v155, v155, s50, -v12
  v_exp_f32 v144, v144
  v_exp_f32 v145, v145
  v_exp_f32 v148, v148
  v_exp_f32 v149, v149
  v_exp_f32 v150, v150
  v_exp_f32 v151, v151
  v_exp_f32 v152, v152
  v_exp_f32 v153, v153
  v_exp_f32 v154, v154
  v_exp_f32 v155, v155
  v_add_f32 v12, v144, v145
  v_add_f32 v12, v12, v148
  v_add_f32 v12, v12, v149
  v_add_f32 v12, v12, v150
  v_add_f32 v12, v12, v151
  v_add_f32 v12, v12, v152
  v_add_f32 v12, v12, v153
  v_add_f32 v12, v12, v154
  v_add_f32 v12, v12, v155
  v_mov_b32 v13, v12
  s_nop 1
  v_permlane32_swap_b32 v12, v13
  v_add_f32 v12, v12, v13
  v_mov_b32 v13, v12
  s_nop 1
  v_permlane16_swap_b32 v12, v13
  v_add_f32 v12, v12, v13
  v_rcp_f32 v12, v12
  s_nop 0
  v_mul_f32 v144, v144, v12
  v_mul_f32 v145, v145, v12
  v_mul_f32 v148, v148, v12
  v_mul_f32 v149, v149, v12
  v_mul_f32 v150, v150, v12
  v_mul_f32 v151, v151, v12
  v_mul_f32 v152, v152, v12
  v_mul_f32 v153, v153, v12
  v_mul_f32 v154, v154, v12
  v_mul_f32 v155, v155, v12
  v_cvt_pk_bf16_f32 v168, v144, v145
  v_mov_b32 v169, 0
  v_mov_b32 v170, 0
  v_mov_b32 v171, v168
  v_cvt_pk_bf16_f32 v164, v148, v149
  v_cvt_pk_bf16_f32 v165, v150, v151
  v_cvt_pk_bf16_f32 v166, v152, v153
  v_cvt_pk_bf16_f32 v167, v154, v155
  s_waitcnt vmcnt(0)
  v_mfma_f32_16x16x32_bf16 v[16:19], v[80:83], v[156:159], 0
  v_mfma_f32_16x16x32_bf16 v[20:23], v[84:87], v[156:159], 0
  v_mfma_f32_16x16x32_bf16 v[24:27], v[88:91], v[156:159], 0
  v_mfma_f32_16x16x32_bf16 v[28:31], v[92:95], v[156:159], 0
  v_mfma_f32_16x16x32_bf16 v[32:35], v[96:99], v[156:159], 0
  v_mfma_f32_16x16x32_bf16 v[36:39], v[100:103], v[156:159], 0
  v_mfma_f32_16x16x32_bf16 v[40:43], v[104:107], v[156:159], 0
  v_mfma_f32_16x16x32_bf16 v[44:47], v[108:111], v[156:159], 0
  v_mfma_f32_16x16x16_bf16 v[16:19], v[128:129], v[160:161], v[16:19]
  v_mfma_f32_16x16x16_bf16 v[20:23], v[128:129], v[162:163], v[20:23]
  v_mfma_f32_16x16x16_bf16 v[24:27], v[130:131], v[160:161], v[24:27]
  v_mfma_f32_16x16x16_bf16 v[28:31], v[130:131], v[162:163], v[28:31]
  v_mfma_f32_16x16x16_bf16 v[32:35], v[132:133], v[160:161], v[32:35]
  v_mfma_f32_16x16x16_bf16 v[36:39], v[132:133], v[162:163], v[36:39]
  v_mfma_f32_16x16x16_bf16 v[40:43], v[134:135], v[160:161], v[40:43]
  v_mfma_f32_16x16x16_bf16 v[44:47], v[134:135], v[162:163], v[44:47]
  v_mfma_f32_16x16x32_bf16 v[48:51], v[80:83], v[164:167], 0
  v_mfma_f32_16x16x32_bf16 v[52:55], v[84:87], v[164:167], 0
  v_mfma_f32_16x16x32_bf16 v[56:59], v[88:91], v[164:167], 0
  v_mfma_f32_16x16x32_bf16 v[60:63], v[92:95], v[164:167], 0
  v_mfma_f32_16x16x32_bf16 v[64:67], v[96:99], v[164:167], 0
  v_mfma_f32_16x16x32_bf16 v[68:71], v[100:103], v[164:167], 0
  v_mfma_f32_16x16x32_bf16 v[72:75], v[104:107], v[164:167], 0
  v_mfma_f32_16x16x32_bf16 v[76:79], v[108:111], v[164:167], 0
  v_mfma_f32_16x16x16_bf16 v[48:51], v[128:129], v[168:169], v[48:51]
  v_mfma_f32_16x16x16_bf16 v[52:55], v[128:129], v[170:171], v[52:55]
  v_mfma_f32_16x16x16_bf16 v[56:59], v[130:131], v[168:169], v[56:59]
  v_mfma_f32_16x16x16_bf16 v[60:63], v[130:131], v[170:171], v[60:63]
  v_mfma_f32_16x16x16_bf16 v[64:67], v[132:133], v[168:169], v[64:67]
  v_mfma_f32_16x16x16_bf16 v[68:71], v[132:133], v[170:171], v[68:71]
  v_mfma_f32_16x16x16_bf16 v[72:75], v[134:135], v[168:169], v[72:75]
  v_mfma_f32_16x16x16_bf16 v[76:79], v[134:135], v[170:171], v[76:79]
  v_cvt_pk_bf16_f32 v136, v16, v17
  v_cvt_pk_bf16_f32 v137, v18, v19
  v_cvt_pk_bf16_f32 v138, v24, v25
  v_cvt_pk_bf16_f32 v139, v26, v27
  buffer_store_dwordx4 v[136:139], v10, s[4:7], s95 offen offset:0 sc1
  v_cvt_pk_bf16_f32 v140, v20, v21
  v_cvt_pk_bf16_f32 v141, v22, v23
  v_cvt_pk_bf16_f32 v142, v28, v29
  v_cvt_pk_bf16_f32 v143, v30, v31
  buffer_store_dwordx4 v[140:143], v10, s[4:7], s95 offen offset:512 sc1
  v_cvt_pk_bf16_f32 v144, v32, v33
  v_cvt_pk_bf16_f32 v145, v34, v35
  v_cvt_pk_bf16_f32 v146, v40, v41
  v_cvt_pk_bf16_f32 v147, v42, v43
  buffer_store_dwordx4 v[144:147], v10, s[4:7], s95 offen offset:2048 sc1
  v_cvt_pk_bf16_f32 v148, v36, v37
  v_cvt_pk_bf16_f32 v149, v38, v39
  v_cvt_pk_bf16_f32 v150, v44, v45
  v_cvt_pk_bf16_f32 v151, v46, v47
  buffer_store_dwordx4 v[148:151], v10, s[4:7], s95 offen offset:2560 sc1
  v_cvt_pk_bf16_f32 v136, v48, v49
  v_cvt_pk_bf16_f32 v137, v50, v51
  v_cvt_pk_bf16_f32 v138, v56, v57
  v_cvt_pk_bf16_f32 v139, v58, v59
  buffer_store_dwordx4 v[136:139], v11, s[4:7], s95 offen offset:0 sc1
  v_cvt_pk_bf16_f32 v140, v52, v53
  v_cvt_pk_bf16_f32 v141, v54, v55
  v_cvt_pk_bf16_f32 v142, v60, v61
  v_cvt_pk_bf16_f32 v143, v62, v63
  buffer_store_dwordx4 v[140:143], v11, s[4:7], s95 offen offset:512 sc1
  v_cvt_pk_bf16_f32 v144, v64, v65
  v_cvt_pk_bf16_f32 v145, v66, v67
  v_cvt_pk_bf16_f32 v146, v72, v73
  v_cvt_pk_bf16_f32 v147, v74, v75
  buffer_store_dwordx4 v[144:147], v11, s[4:7], s95 offen offset:2048 sc1
  v_cvt_pk_bf16_f32 v148, v68, v69
  v_cvt_pk_bf16_f32 v149, v70, v71
  v_cvt_pk_bf16_f32 v150, v76, v77
  v_cvt_pk_bf16_f32 v151, v78, v79
  buffer_store_dwordx4 v[148:151], v11, s[4:7], s95 offen offset:2560 sc1
  s_branch L_done
L_bo:
  s_lshr_b32 s40, s36, 1
  s_lshl_b32 s40, s40, 2
  s_cmp_lg_u32 s32, 0
  s_cbranch_scc1 L_dd_9
  v_mov_b32 v2, 0
L_dw_8:
  buffer_load_dword v4, v2, s[28:31], s40 offen offset:160 sc1
  s_waitcnt vmcnt(0)
  s_mov_b32 s44, 1
  v_readfirstlane_b32 s45, v4
  s_cmp_ge_u32 s45, 16
  s_cselect_b32 s44, s44, 0
  s_cmp_eq_u32 s44, 1
  s_cbranch_scc1 L_dd_9
  s_sleep 8
  s_add_u32 s3, s3, 1
  s_cmp_lt_u32 s3, 2097152
  s_cbranch_scc1 L_dw_8
L_dd_9:
  s_barrier
  s_mov_b32 s12, s82
  s_and_b32 s13, s83, 0xffff
  s_mov_b32 s14, 0x200000
  s_mov_b32 s15, 0x20000
  s_mov_b32 s23, 65536
  s_mov_b32 s25, 4
  s_lshl_b32 s20, s36, 18
  s_add_u32 s20, s20, 0x6000000
  s_mov_b32 s22, 2048
  s_branch L_g3
L_ao:
  s_lshl_b32 s40, s36, 2
  s_cmp_lg_u32 s32, 0
  s_cbranch_scc1 L_dd_11
  v_mov_b32 v2, 0
L_dw_10:
  buffer_load_dword v4, v2, s[28:31], s40 offen offset:192 sc1
  s_waitcnt vmcnt(0)
  s_mov_b32 s44, 1
  v_readfirstlane_b32 s45, v4
  s_cmp_ge_u32 s45, 32
  s_cselect_b32 s44, s44, 0
  s_cmp_eq_u32 s44, 1
  s_cbranch_scc1 L_dd_11
  s_sleep 8
  s_add_u32 s3, s3, 1
  s_cmp_lt_u32 s3, 2097152
  s_cbranch_scc1 L_dw_10
L_dd_11:
  s_barrier
  s_mov_b32 s12, s74
  s_and_b32 s13, s75, 0xffff
  s_mov_b32 s14, 0x800000
  s_mov_b32 s15, 0x20000
  s_mov_b32 s23, 262144
  s_mov_b32 s25, 16
  s_lshl_b32 s20, s36, 20
  s_add_u32 s20, s20, 0x5000000
  s_mov_b32 s22, 0
L_g3:
  s_mov_b32 s8, s4
  s_and_b32 s9, s5, 0xffff
  s_mov_b32 s10, 0x10000000
  s_mov_b32 s11, 0x20000
  s_mov_b32 s16, s84
  s_and_b32 s17, s85, 0xffff
  s_mov_b32 s18, 0x800000
  s_mov_b32 s19, 0x20000
  s_lshl_b32 s91, s33, 1
  s_add_u32 s91, s91, s37
  s_mov_b32 s24, 2048
  s_mov_b32 s26, 4096
  s_lshl_b32 s21, s91, 8
  s_add_u32 s22, s22, s21
  s_lshl_b32 s90, s36, 19
  s_add_u32 s22, s22, s90
  v_and_b32 v1, 63, v0
  v_lshrrev_b32 v16, 6, v0
  s_nop 0
  v_readfirstlane_b32 s27, v16
  s_mul_i32 s90, s27, 1
  s_mul_i32 s90, s90, s23
  v_mov_b32 v2, 0x0
  v_bfe_u32 v17, v1, 0, 6
  v_lshl_add_u32 v2, v17, 4, v2
  v_add_u32 v2, s90, v2
  v_mov_b32 v3, 0x400
  v_bfe_u32 v17, v1, 0, 6
  v_lshl_add_u32 v3, v17, 4, v3
  v_add_u32 v3, s90, v3
  v_mov_b32 v4, 0x1000
  v_bfe_u32 v17, v1, 0, 6
  v_lshl_add_u32 v4, v17, 4, v4
  v_add_u32 v4, s90, v4
  v_mov_b32 v5, 0x1400
  v_bfe_u32 v17, v1, 0, 6
  v_lshl_add_u32 v5, v17, 4, v5
  v_add_u32 v5, s90, v5
  s_mul_i32 s90, s27, 16
  v_lshrrev_b32 v16, 4, v1
  v_add_u32 v16, 0, v16
  v_and_b32 v17, 3, v16
  v_lshlrev_b32 v17, 2, v17
  v_xor_b32 v17, v17, v1
  v_and_b32 v17, 15, v17
  v_add_u32 v16, s90, v16
  v_mul_lo_u32 v16, v16, s24
  v_lshl_add_u32 v6, v17, 4, v16
  v_lshrrev_b32 v16, 4, v1
  v_add_u32 v16, 4, v16
  v_and_b32 v17, 3, v16
  v_lshlrev_b32 v17, 2, v17
  v_xor_b32 v17, v17, v1
  v_and_b32 v17, 15, v17
  v_add_u32 v16, s90, v16
  v_mul_lo_u32 v16, v16, s24
  v_lshl_add_u32 v7, v17, 4, v16
  v_lshrrev_b32 v16, 4, v1
  v_add_u32 v16, 8, v16
  v_and_b32 v17, 3, v16
  v_lshlrev_b32 v17, 2, v17
  v_xor_b32 v17, v17, v1
  v_and_b32 v17, 15, v17
  v_add_u32 v16, s90, v16
  v_mul_lo_u32 v16, v16, s24
  v_lshl_add_u32 v8, v17, 4, v16
  v_lshrrev_b32 v16, 4, v1
  v_add_u32 v16, 12, v16
  v_and_b32 v17, 3, v16
  v_lshlrev_b32 v17, 2, v17
  v_xor_b32 v17, v17, v1
  v_and_b32 v17, 15, v17
  v_add_u32 v16, s90, v16
  v_mul_lo_u32 v16, v16, s24
  v_lshl_add_u32 v9, v17, 4, v16
  s_mul_i32 s51, s24, 64
  s_mul_i32 s52, s27, 4096
  s_mul_i32 s53, s27, 4096
  s_add_u32 s53, s53, 16384
  s_add_u32 m0, s52, 0
  s_nop 0
  buffer_load_dwordx4 v2, s[8:11], s20 offen sc1 lds
  s_add_u32 m0, s53, 0
  s_nop 0
  buffer_load_dwordx4 v6, s[12:15], s21 offen lds
  s_add_u32 m0, s52, 1024
  s_nop 0
  buffer_load_dwordx4 v3, s[8:11], s20 offen sc1 lds
  s_add_u32 m0, s53, 1024
  s_nop 0
  buffer_load_dwordx4 v7, s[12:15], s21 offen lds
  s_add_u32 m0, s52, 2048
  s_nop 0
  buffer_load_dwordx4 v4, s[8:11], s20 offen sc1 lds
  s_add_u32 m0, s53, 2048
  s_nop 0
  buffer_load_dwordx4 v8, s[12:15], s21 offen lds
  s_add_u32 m0, s52, 3072
  s_nop 0
  buffer_load_dwordx4 v5, s[8:11], s20 offen sc1 lds
  s_add_u32 m0, s53, 3072
  s_nop 0
  buffer_load_dwordx4 v9, s[12:15], s21 offen lds
  s_add_u32 s20, s20, 2048
  s_add_u32 s21, s21, s51
  s_add_u32 m0, s52, 32768
  s_nop 0
  buffer_load_dwordx4 v2, s[8:11], s20 offen sc1 lds
  s_add_u32 m0, s53, 32768
  s_nop 0
  buffer_load_dwordx4 v6, s[12:15], s21 offen lds
  s_add_u32 m0, s52, 33792
  s_nop 0
  buffer_load_dwordx4 v3, s[8:11], s20 offen sc1 lds
  s_add_u32 m0, s53, 33792
  s_nop 0
  buffer_load_dwordx4 v7, s[12:15], s21 offen lds
  s_add_u32 m0, s52, 34816
  s_nop 0
  buffer_load_dwordx4 v4, s[8:11], s20 offen sc1 lds
  s_add_u32 m0, s53, 34816
  s_nop 0
  buffer_load_dwordx4 v8, s[12:15], s21 offen lds
  s_add_u32 m0, s52, 35840
  s_nop 0
  buffer_load_dwordx4 v5, s[8:11], s20 offen sc1 lds
  s_add_u32 m0, s53, 35840
  s_nop 0
  buffer_load_dwordx4 v9, s[12:15], s21 offen lds
  s_add_u32 s20, s20, 6144
  s_add_u32 s21, s21, s51
  s_add_u32 m0, s52, 65536
  s_nop 0
  buffer_load_dwordx4 v2, s[8:11], s20 offen sc1 lds
  s_add_u32 m0, s53, 65536
  s_nop 0
  buffer_load_dwordx4 v6, s[12:15], s21 offen lds
  s_add_u32 m0, s52, 66560
  s_nop 0
  buffer_load_dwordx4 v3, s[8:11], s20 offen sc1 lds
  s_add_u32 m0, s53, 66560
  s_nop 0
  buffer_load_dwordx4 v7, s[12:15], s21 offen lds
  s_add_u32 m0, s52, 67584
  s_nop 0
  buffer_load_dwordx4 v4, s[8:11], s20 offen sc1 lds
  s_add_u32 m0, s53, 67584
  s_nop 0
  buffer_load_dwordx4 v8, s[12:15], s21 offen lds
  s_add_u32 m0, s52, 68608
  s_nop 0
  buffer_load_dwordx4 v5, s[8:11], s20 offen sc1 lds
  s_add_u32 m0, s53, 68608
  s_nop 0
  buffer_load_dwordx4 v9, s[12:15], s21 offen lds
  s_add_u32 s20, s20, 2048
  s_add_u32 s21, s21, s51
  s_add_u32 m0, s52, 98304
  s_nop 0
  buffer_load_dwordx4 v2, s[8:11], s20 offen sc1 lds
  s_add_u32 m0, s53, 98304
  s_nop 0
  buffer_load_dwordx4 v6, s[12:15], s21 offen lds
  s_add_u32 m0, s52, 99328
  s_nop 0
  buffer_load_dwordx4 v3, s[8:11], s20 offen sc1 lds
  s_add_u32 m0, s53, 99328
  s_nop 0
  buffer_load_dwordx4 v7, s[12:15], s21 offen lds
  s_add_u32 m0, s52, 100352
  s_nop 0
  buffer_load_dwordx4 v4, s[8:11], s20 offen sc1 lds
  s_add_u32 m0, s53, 100352
  s_nop 0
  buffer_load_dwordx4 v8, s[12:15], s21 offen lds
  s_add_u32 m0, s52, 101376
  s_nop 0
  buffer_load_dwordx4 v5, s[8:11], s20 offen sc1 lds
  s_add_u32 m0, s53, 101376
  s_nop 0
  buffer_load_dwordx4 v9, s[12:15], s21 offen lds
  s_add_u32 s20, s20, 6144
  s_add_u32 s21, s21, s51
  s_lshr_b32 s90, s27, 1
  s_and_b32 s91, s27, 1
  s_mul_i32 s92, s90, 8192
  v_mov_b32 v10, 0x0
  v_bfe_u32 v17, v1, 0, 4
  v_lshl_add_u32 v10, v17, 4, v10
  v_bfe_u32 v17, v1, 4, 1
  v_lshl_add_u32 v10, v17, 11, v10
  v_bfe_u32 v17, v1, 5, 1
  v_lshl_add_u32 v10, v17, 8, v10
  v_add_u32 v10, s92, v10
  v_add_u32 v11, 65536, v10
  v_mov_b32 v16, 0x0
  v_bfe_u32 v17, v1, 2, 2
  v_lshl_add_u32 v16, v17, 8, v16
  v_bfe_u32 v17, v1, 5, 1
  v_lshl_add_u32 v16, v17, 10, v16
  v_bfe_u32 v17, v1, 0, 1
  v_lshl_add_u32 v16, v17, 5, v16
  v_bfe_u32 v17, v1, 4, 1
  v_lshl_add_u32 v16, v17, 4, v16
  v_bfe_u32 v17, v1, 1, 1
  v_lshl_add_u32 v16, v17, 3, v16
  s_mul_i32 s92, s91, 2
  s_add_u32 s93, s92, 0
  v_bfe_u32 v17, v1, 2, 2
  v_xor_b32 v17, s93, v17
  v_lshl_add_u32 v12, v17, 6, v16
  v_add_u32 v14, 65536, v12
  s_add_u32 s93, s92, 1
  v_bfe_u32 v17, v1, 2, 2
  v_xor_b32 v17, s93, v17
  v_lshl_add_u32 v13, v17, 6, v16
  v_add_u32 v15, 65536, v13
  s_waitcnt vmcnt(24)
  s_barrier
  ds_read_b128 v[20:23], v10 offset:0
  ds_read_b64_tr_b16 v[36:37], v12 offset:16384
  ds_read_b64_tr_b16 v[38:39], v12 offset:20480
  ds_read_b128 v[24:27], v10 offset:4096
  ds_read_b64_tr_b16 v[40:41], v13 offset:16384
  ds_read_b64_tr_b16 v[42:43], v13 offset:20480
  s_sub_u32 s25, s25, 1
  s_waitcnt lgkmcnt(0)
  v_mfma_f32_32x32x16_bf16 a[0:15], v[36:39], v[20:23], 0
  ds_read_b128 v[28:31], v10 offset:512
  ds_read_b64_tr_b16 v[44:45], v12 offset:18432
  v_mfma_f32_32x32x16_bf16 a[16:31], v[40:43], v[20:23], 0
  ds_read_b64_tr_b16 v[46:47], v12 offset:22528
  ds_read_b128 v[32:35], v10 offset:4608
  v_mfma_f32_32x32x16_bf16 a[32:47], v[36:39], v[24:27], 0
  ds_read_b64_tr_b16 v[48:49], v13 offset:18432
  ds_read_b64_tr_b16 v[50:51], v13 offset:22528
  v_mfma_f32_32x32x16_bf16 a[48:63], v[40:43], v[24:27], 0
  s_waitcnt lgkmcnt(0)
  v_mfma_f32_32x32x16_bf16 a[0:15], v[44:47], v[28:31], a[0:15]
  ds_read_b128 v[20:23], v10 offset:1024
  ds_read_b64_tr_b16 v[36:37], v12 offset:24576
  v_mfma_f32_32x32x16_bf16 a[16:31], v[48:51], v[28:31], a[16:31]
  ds_read_b64_tr_b16 v[38:39], v12 offset:28672
  ds_read_b128 v[24:27], v10 offset:5120
  v_mfma_f32_32x32x16_bf16 a[32:47], v[44:47], v[32:35], a[32:47]
  ds_read_b64_tr_b16 v[40:41], v13 offset:24576
  ds_read_b64_tr_b16 v[42:43], v13 offset:28672
  v_mfma_f32_32x32x16_bf16 a[48:63], v[48:51], v[32:35], a[48:63]
  s_waitcnt lgkmcnt(0)
  v_mfma_f32_32x32x16_bf16 a[0:15], v[36:39], v[20:23], a[0:15]
  ds_read_b128 v[28:31], v10 offset:1536
  ds_read_b64_tr_b16 v[44:45], v12 offset:26624
  v_mfma_f32_32x32x16_bf16 a[16:31], v[40:43], v[20:23], a[16:31]
  ds_read_b64_tr_b16 v[46:47], v12 offset:30720
  ds_read_b128 v[32:35], v10 offset:5632
  v_mfma_f32_32x32x16_bf16 a[32:47], v[36:39], v[24:27], a[32:47]
  ds_read_b64_tr_b16 v[48:49], v13 offset:26624
  ds_read_b64_tr_b16 v[50:51], v13 offset:30720
  v_mfma_f32_32x32x16_bf16 a[48:63], v[40:43], v[24:27], a[48:63]
  s_waitcnt lgkmcnt(0)
  v_mfma_f32_32x32x16_bf16 a[0:15], v[44:47], v[28:31], a[0:15]
  s_waitcnt vmcnt(16)
  s_barrier
  s_add_u32 m0, s52, 0
  v_mfma_f32_32x32x16_bf16 a[16:31], v[48:51], v[28:31], a[16:31]
  buffer_load_dwordx4 v2, s[8:11], s20 offen sc1 lds
  ds_read_b128 v[20:23], v10 offset:32768
  ds_read_b64_tr_b16 v[36:37], v12 offset:49152
  s_add_u32 m0, s53, 0
  v_mfma_f32_32x32x16_bf16 a[32:47], v[44:47], v[32:35], a[32:47]
  buffer_load_dwordx4 v6, s[12:15], s21 offen lds
  ds_read_b64_tr_b16 v[38:39], v12 offset:53248
  ds_read_b128 v[24:27], v10 offset:36864
  s_add_u32 m0, s52, 1024
  v_mfma_f32_32x32x16_bf16 a[48:63], v[48:51], v[32:35], a[48:63]
  buffer_load_dwordx4 v3, s[8:11], s20 offen sc1 lds
  ds_read_b64_tr_b16 v[40:41], v13 offset:49152
  ds_read_b64_tr_b16 v[42:43], v13 offset:53248
  s_waitcnt lgkmcnt(0)
  s_add_u32 m0, s53, 1024
  v_mfma_f32_32x32x16_bf16 a[0:15], v[36:39], v[20:23], a[0:15]
  buffer_load_dwordx4 v7, s[12:15], s21 offen lds
  ds_read_b128 v[28:31], v10 offset:33280
  ds_read_b64_tr_b16 v[44:45], v12 offset:51200
  v_mfma_f32_32x32x16_bf16 a[16:31], v[40:43], v[20:23], a[16:31]
  ds_read_b64_tr_b16 v[46:47], v12 offset:55296
  ds_read_b128 v[32:35], v10 offset:37376
  s_add_u32 m0, s52, 2048
  v_mfma_f32_32x32x16_bf16 a[32:47], v[36:39], v[24:27], a[32:47]
  buffer_load_dwordx4 v4, s[8:11], s20 offen sc1 lds
  ds_read_b64_tr_b16 v[48:49], v13 offset:51200
  ds_read_b64_tr_b16 v[50:51], v13 offset:55296
  v_mfma_f32_32x32x16_bf16 a[48:63], v[40:43], v[24:27], a[48:63]
  s_waitcnt lgkmcnt(0)
  s_add_u32 m0, s53, 2048
  v_mfma_f32_32x32x16_bf16 a[0:15], v[44:47], v[28:31], a[0:15]
  buffer_load_dwordx4 v8, s[12:15], s21 offen lds
  ds_read_b128 v[20:23], v10 offset:33792
  ds_read_b64_tr_b16 v[36:37], v12 offset:57344
  v_mfma_f32_32x32x16_bf16 a[16:31], v[48:51], v[28:31], a[16:31]
  ds_read_b64_tr_b16 v[38:39], v12 offset:61440
  ds_read_b128 v[24:27], v10 offset:37888
  s_add_u32 m0, s52, 3072
  v_mfma_f32_32x32x16_bf16 a[32:47], v[44:47], v[32:35], a[32:47]
  buffer_load_dwordx4 v5, s[8:11], s20 offen sc1 lds
  ds_read_b64_tr_b16 v[40:41], v13 offset:57344
  ds_read_b64_tr_b16 v[42:43], v13 offset:61440
  v_mfma_f32_32x32x16_bf16 a[48:63], v[48:51], v[32:35], a[48:63]
  s_waitcnt lgkmcnt(0)
  s_add_u32 m0, s53, 3072
  v_mfma_f32_32x32x16_bf16 a[0:15], v[36:39], v[20:23], a[0:15]
  buffer_load_dwordx4 v9, s[12:15], s21 offen lds
  ds_read_b128 v[28:31], v10 offset:34304
  ds_read_b64_tr_b16 v[44:45], v12 offset:59392
  v_mfma_f32_32x32x16_bf16 a[16:31], v[40:43], v[20:23], a[16:31]
  ds_read_b64_tr_b16 v[46:47], v12 offset:63488
  ds_read_b128 v[32:35], v10 offset:38400
  s_add_u32 s20, s20, 2048
  v_mfma_f32_32x32x16_bf16 a[32:47], v[36:39], v[24:27], a[32:47]
  s_add_u32 s21, s21, s51
  ds_read_b64_tr_b16 v[48:49], v13 offset:59392
  ds_read_b64_tr_b16 v[50:51], v13 offset:63488
  v_mfma_f32_32x32x16_bf16 a[48:63], v[40:43], v[24:27], a[48:63]
  s_waitcnt lgkmcnt(0)
  v_mfma_f32_32x32x16_bf16 a[0:15], v[44:47], v[28:31], a[0:15]
  s_waitcnt vmcnt(16)
  s_barrier
  s_add_u32 m0, s52, 32768
  v_mfma_f32_32x32x16_bf16 a[16:31], v[48:51], v[28:31], a[16:31]
  buffer_load_dwordx4 v2, s[8:11], s20 offen sc1 lds
  ds_read_b128 v[20:23], v11 offset:0
  ds_read_b64_tr_b16 v[36:37], v14 offset:16384
  s_add_u32 m0, s53, 32768
  v_mfma_f32_32x32x16_bf16 a[32:47], v[44:47], v[32:35], a[32:47]
  buffer_load_dwordx4 v6, s[12:15], s21 offen lds
  ds_read_b64_tr_b16 v[38:39], v14 offset:20480
  ds_read_b128 v[24:27], v11 offset:4096
  s_add_u32 m0, s52, 33792
  v_mfma_f32_32x32x16_bf16 a[48:63], v[48:51], v[32:35], a[48:63]
  buffer_load_dwordx4 v3, s[8:11], s20 offen sc1 lds
  ds_read_b64_tr_b16 v[40:41], v15 offset:16384
  ds_read_b64_tr_b16 v[42:43], v15 offset:20480
  s_waitcnt lgkmcnt(0)
  s_add_u32 m0, s53, 33792
  v_mfma_f32_32x32x16_bf16 a[0:15], v[36:39], v[20:23], a[0:15]
  buffer_load_dwordx4 v7, s[12:15], s21 offen lds
  ds_read_b128 v[28:31], v11 offset:512
  ds_read_b64_tr_b16 v[44:45], v14 offset:18432
  v_mfma_f32_32x32x16_bf16 a[16:31], v[40:43], v[20:23], a[16:31]
  ds_read_b64_tr_b16 v[46:47], v14 offset:22528
  ds_read_b128 v[32:35], v11 offset:4608
  s_add_u32 m0, s52, 34816
  v_mfma_f32_32x32x16_bf16 a[32:47], v[36:39], v[24:27], a[32:47]
  buffer_load_dwordx4 v4, s[8:11], s20 offen sc1 lds
  ds_read_b64_tr_b16 v[48:49], v15 offset:18432
  ds_read_b64_tr_b16 v[50:51], v15 offset:22528
  v_mfma_f32_32x32x16_bf16 a[48:63], v[40:43], v[24:27], a[48:63]
  s_waitcnt lgkmcnt(0)
  s_add_u32 m0, s53, 34816
  v_mfma_f32_32x32x16_bf16 a[0:15], v[44:47], v[28:31], a[0:15]
  buffer_load_dwordx4 v8, s[12:15], s21 offen lds
  ds_read_b128 v[20:23], v11 offset:1024
  ds_read_b64_tr_b16 v[36:37], v14 offset:24576
  v_mfma_f32_32x32x16_bf16 a[16:31], v[48:51], v[28:31], a[16:31]
  ds_read_b64_tr_b16 v[38:39], v14 offset:28672
  ds_read_b128 v[24:27], v11 offset:5120
  s_add_u32 m0, s52, 35840
  v_mfma_f32_32x32x16_bf16 a[32:47], v[44:47], v[32:35], a[32:47]
  buffer_load_dwordx4 v5, s[8:11], s20 offen sc1 lds
  ds_read_b64_tr_b16 v[40:41], v15 offset:24576
  ds_read_b64_tr_b16 v[42:43], v15 offset:28672
  v_mfma_f32_32x32x16_bf16 a[48:63], v[48:51], v[32:35], a[48:63]
  s_waitcnt lgkmcnt(0)
  s_add_u32 m0, s53, 35840
  v_mfma_f32_32x32x16_bf16 a[0:15], v[36:39], v[20:23], a[0:15]
  buffer_load_dwordx4 v9, s[12:15], s21 offen lds
  ds_read_b128 v[28:31], v11 offset:1536
  ds_read_b64_tr_b16 v[44:45], v14 offset:26624
  v_mfma_f32_32x32x16_bf16 a[16:31], v[40:43], v[20:23], a[16:31]
  ds_read_b64_tr_b16 v[46:47], v14 offset:30720
  ds_read_b128 v[32:35], v11 offset:5632
  s_add_u32 s20, s20, 6144
  v_mfma_f32_32x32x16_bf16 a[32:47], v[36:39], v[24:27], a[32:47]
  s_add_u32 s21, s21, s51
  ds_read_b64_tr_b16 v[48:49], v15 offset:26624
  ds_read_b64_tr_b16 v[50:51], v15 offset:30720
  v_mfma_f32_32x32x16_bf16 a[48:63], v[40:43], v[24:27], a[48:63]
  s_waitcnt lgkmcnt(0)
  v_mfma_f32_32x32x16_bf16 a[0:15], v[44:47], v[28:31], a[0:15]
  s_waitcnt vmcnt(16)
  s_barrier
  s_add_u32 m0, s52, 65536
  v_mfma_f32_32x32x16_bf16 a[16:31], v[48:51], v[28:31], a[16:31]
  buffer_load_dwordx4 v2, s[8:11], s20 offen sc1 lds
  ds_read_b128 v[20:23], v11 offset:32768
  ds_read_b64_tr_b16 v[36:37], v14 offset:49152
  s_add_u32 m0, s53, 65536
  v_mfma_f32_32x32x16_bf16 a[32:47], v[44:47], v[32:35], a[32:47]
  buffer_load_dwordx4 v6, s[12:15], s21 offen lds
  ds_read_b64_tr_b16 v[38:39], v14 offset:53248
  ds_read_b128 v[24:27], v11 offset:36864
  s_add_u32 m0, s52, 66560
  v_mfma_f32_32x32x16_bf16 a[48:63], v[48:51], v[32:35], a[48:63]
  buffer_load_dwordx4 v3, s[8:11], s20 offen sc1 lds
  ds_read_b64_tr_b16 v[40:41], v15 offset:49152
  ds_read_b64_tr_b16 v[42:43], v15 offset:53248
  s_waitcnt lgkmcnt(0)
  s_add_u32 m0, s53, 66560
  v_mfma_f32_32x32x16_bf16 a[0:15], v[36:39], v[20:23], a[0:15]
  buffer_load_dwordx4 v7, s[12:15], s21 offen lds
  ds_read_b128 v[28:31], v11 offset:33280
  ds_read_b64_tr_b16 v[44:45], v14 offset:51200
  v_mfma_f32_32x32x16_bf16 a[16:31], v[40:43], v[20:23], a[16:31]
  ds_read_b64_tr_b16 v[46:47], v14 offset:55296
  ds_read_b128 v[32:35], v11 offset:37376
  s_add_u32 m0, s52, 67584
  v_mfma_f32_32x32x16_bf16 a[32:47], v[36:39], v[24:27], a[32:47]
  buffer_load_dwordx4 v4, s[8:11], s20 offen sc1 lds
  ds_read_b64_tr_b16 v[48:49], v15 offset:51200
  ds_read_b64_tr_b16 v[50:51], v15 offset:55296
  v_mfma_f32_32x32x16_bf16 a[48:63], v[40:43], v[24:27], a[48:63]
  s_waitcnt lgkmcnt(0)
  s_add_u32 m0, s53, 67584
  v_mfma_f32_32x32x16_bf16 a[0:15], v[44:47], v[28:31], a[0:15]
  buffer_load_dwordx4 v8, s[12:15], s21 offen lds
  ds_read_b128 v[20:23], v11 offset:33792
  ds_read_b64_tr_b16 v[36:37], v14 offset:57344
  v_mfma_f32_32x32x16_bf16 a[16:31], v[48:51], v[28:31], a[16:31]
  ds_read_b64_tr_b16 v[38:39], v14 offset:61440
  ds_read_b128 v[24:27], v11 offset:37888
  s_add_u32 m0, s52, 68608
  v_mfma_f32_32x32x16_bf16 a[32:47], v[44:47], v[32:35], a[32:47]
  buffer_load_dwordx4 v5, s[8:11], s20 offen sc1 lds
  ds_read_b64_tr_b16 v[40:41], v15 offset:57344
  ds_read_b64_tr_b16 v[42:43], v15 offset:61440
  v_mfma_f32_32x32x16_bf16 a[48:63], v[48:51], v[32:35], a[48:63]
  s_waitcnt lgkmcnt(0)
  s_add_u32 m0, s53, 68608
  v_mfma_f32_32x32x16_bf16 a[0:15], v[36:39], v[20:23], a[0:15]
  buffer_load_dwordx4 v9, s[12:15], s21 offen lds
  ds_read_b128 v[28:31], v11 offset:34304
  ds_read_b64_tr_b16 v[44:45], v14 offset:59392
  v_mfma_f32_32x32x16_bf16 a[16:31], v[40:43], v[20:23], a[16:31]
  ds_read_b64_tr_b16 v[46:47], v14 offset:63488
  ds_read_b128 v[32:35], v11 offset:38400
  s_add_u32 s20, s20, 2048
  v_mfma_f32_32x32x16_bf16 a[32:47], v[36:39], v[24:27], a[32:47]
  s_add_u32 s21, s21, s51
  ds_read_b64_tr_b16 v[48:49], v15 offset:59392
  ds_read_b64_tr_b16 v[50:51], v15 offset:63488
  v_mfma_f32_32x32x16_bf16 a[48:63], v[40:43], v[24:27], a[48:63]
  s_waitcnt lgkmcnt(0)
  v_mfma_f32_32x32x16_bf16 a[0:15], v[44:47], v[28:31], a[0:15]
  s_waitcnt vmcnt(16)
  s_barrier
  s_add_u32 m0, s52, 98304
  v_mfma_f32_32x32x16_bf16 a[16:31], v[48:51], v[28:31], a[16:31]
  buffer_load_dwordx4 v2, s[8:11], s20 offen sc1 lds
  ds_read_b128 v[20:23], v10 offset:0
  ds_read_b64_tr_b16 v[36:37], v12 offset:16384
  s_add_u32 m0, s53, 98304
  v_mfma_f32_32x32x16_bf16 a[32:47], v[44:47], v[32:35], a[32:47]
  buffer_load_dwordx4 v6, s[12:15], s21 offen lds
  ds_read_b64_tr_b16 v[38:39], v12 offset:20480
  ds_read_b128 v[24:27], v10 offset:4096
  s_add_u32 m0, s52, 99328
  v_mfma_f32_32x32x16_bf16 a[48:63], v[48:51], v[32:35], a[48:63]
  buffer_load_dwordx4 v3, s[8:11], s20 offen sc1 lds
  ds_read_b64_tr_b16 v[40:41], v13 offset:16384
  ds_read_b64_tr_b16 v[42:43], v13 offset:20480
L_g3_loop:
  s_sub_u32 s25, s25, 1
  s_cmp_eq_u32 s25, 0
  s_cbranch_scc1 L_g3_fin
  s_waitcnt lgkmcnt(0)
  s_add_u32 m0, s53, 99328
  v_mfma_f32_32x32x16_bf16 a[0:15], v[36:39], v[20:23], a[0:15]
  buffer_load_dwordx4 v7, s[12:15], s21 offen lds
  ds_read_b128 v[28:31], v10 offset:512
  ds_read_b64_tr_b16 v[44:45], v12 offset:18432
  v_mfma_f32_32x32x16_bf16 a[16:31], v[40:43], v[20:23], a[16:31]
  ds_read_b64_tr_b16 v[46:47], v12 offset:22528
  ds_read_b128 v[32:35], v10 offset:4608
  s_add_u32 m0, s52, 100352
  v_mfma_f32_32x32x16_bf16 a[32:47], v[36:39], v[24:27], a[32:47]
  buffer_load_dwordx4 v4, s[8:11], s20 offen sc1 lds
  ds_read_b64_tr_b16 v[48:49], v13 offset:18432
  ds_read_b64_tr_b16 v[50:51], v13 offset:22528
  v_mfma_f32_32x32x16_bf16 a[48:63], v[40:43], v[24:27], a[48:63]
  s_waitcnt lgkmcnt(0)
  s_add_u32 m0, s53, 100352
  v_mfma_f32_32x32x16_bf16 a[0:15], v[44:47], v[28:31], a[0:15]
  buffer_load_dwordx4 v8, s[12:15], s21 offen lds
  ds_read_b128 v[20:23], v10 offset:1024
  ds_read_b64_tr_b16 v[36:37], v12 offset:24576
  v_mfma_f32_32x32x16_bf16 a[16:31], v[48:51], v[28:31], a[16:31]
  ds_read_b64_tr_b16 v[38:39], v12 offset:28672
  ds_read_b128 v[24:27], v10 offset:5120
  s_add_u32 m0, s52, 101376
  v_mfma_f32_32x32x16_bf16 a[32:47], v[44:47], v[32:35], a[32:47]
  buffer_load_dwordx4 v5, s[8:11], s20 offen sc1 lds
  ds_read_b64_tr_b16 v[40:41], v13 offset:24576
  ds_read_b64_tr_b16 v[42:43], v13 offset:28672
  v_mfma_f32_32x32x16_bf16 a[48:63], v[48:51], v[32:35], a[48:63]
  s_waitcnt lgkmcnt(0)
  s_add_u32 m0, s53, 101376
  v_mfma_f32_32x32x16_bf16 a[0:15], v[36:39], v[20:23], a[0:15]
  buffer_load_dwordx4 v9, s[12:15], s21 offen lds
  ds_read_b128 v[28:31], v10 offset:1536
  ds_read_b64_tr_b16 v[44:45], v12 offset:26624
  v_mfma_f32_32x32x16_bf16 a[16:31], v[40:43], v[20:23], a[16:31]
  ds_read_b64_tr_b16 v[46:47], v12 offset:30720
  ds_read_b128 v[32:35], v10 offset:5632
  s_add_u32 s20, s20, 6144
  v_mfma_f32_32x32x16_bf16 a[32:47], v[36:39], v[24:27], a[32:47]
  s_add_u32 s21, s21, s51
  ds_read_b64_tr_b16 v[48:49], v13 offset:26624
  ds_read_b64_tr_b16 v[50:51], v13 offset:30720
  v_mfma_f32_32x32x16_bf16 a[48:63], v[40:43], v[24:27], a[48:63]
  s_waitcnt lgkmcnt(0)
  v_mfma_f32_32x32x16_bf16 a[0:15], v[44:47], v[28:31], a[0:15]
  s_waitcnt vmcnt(16)
  s_barrier
  s_add_u32 m0, s52, 0
  v_mfma_f32_32x32x16_bf16 a[16:31], v[48:51], v[28:31], a[16:31]
  buffer_load_dwordx4 v2, s[8:11], s20 offen sc1 lds
  ds_read_b128 v[20:23], v10 offset:32768
  ds_read_b64_tr_b16 v[36:37], v12 offset:49152
  s_add_u32 m0, s53, 0
  v_mfma_f32_32x32x16_bf16 a[32:47], v[44:47], v[32:35], a[32:47]
  buffer_load_dwordx4 v6, s[12:15], s21 offen lds
  ds_read_b64_tr_b16 v[38:39], v12 offset:53248
  ds_read_b128 v[24:27], v10 offset:36864
  s_add_u32 m0, s52, 1024
  v_mfma_f32_32x32x16_bf16 a[48:63], v[48:51], v[32:35], a[48:63]
  buffer_load_dwordx4 v3, s[8:11], s20 offen sc1 lds
  ds_read_b64_tr_b16 v[40:41], v13 offset:49152
  ds_read_b64_tr_b16 v[42:43], v13 offset:53248
  s_waitcnt lgkmcnt(0)
  s_add_u32 m0, s53, 1024
  v_mfma_f32_32x32x16_bf16 a[0:15], v[36:39], v[20:23], a[0:15]
  buffer_load_dwordx4 v7, s[12:15], s21 offen lds
  ds_read_b128 v[28:31], v10 offset:33280
  ds_read_b64_tr_b16 v[44:45], v12 offset:51200
  v_mfma_f32_32x32x16_bf16 a[16:31], v[40:43], v[20:23], a[16:31]
  ds_read_b64_tr_b16 v[46:47], v12 offset:55296
  ds_read_b128 v[32:35], v10 offset:37376
  s_add_u32 m0, s52, 2048
  v_mfma_f32_32x32x16_bf16 a[32:47], v[36:39], v[24:27], a[32:47]
  buffer_load_dwordx4 v4, s[8:11], s20 offen sc1 lds
  ds_read_b64_tr_b16 v[48:49], v13 offset:51200
  ds_read_b64_tr_b16 v[50:51], v13 offset:55296
  v_mfma_f32_32x32x16_bf16 a[48:63], v[40:43], v[24:27], a[48:63]
  s_waitcnt lgkmcnt(0)
  s_add_u32 m0, s53, 2048
  v_mfma_f32_32x32x16_bf16 a[0:15], v[44:47], v[28:31], a[0:15]
  buffer_load_dwordx4 v8, s[12:15], s21 offen lds
  ds_read_b128 v[20:23], v10 offset:33792
  ds_read_b64_tr_b16 v[36:37], v12 offset:57344
  v_mfma_f32_32x32x16_bf16 a[16:31], v[48:51], v[28:31], a[16:31]
  ds_read_b64_tr_b16 v[38:39], v12 offset:61440
  ds_read_b128 v[24:27], v10 offset:37888
  s_add_u32 m0, s52, 3072
  v_mfma_f32_32x32x16_bf16 a[32:47], v[44:47], v[32:35], a[32:47]
  buffer_load_dwordx4 v5, s[8:11], s20 offen sc1 lds
  ds_read_b64_tr_b16 v[40:41], v13 offset:57344
  ds_read_b64_tr_b16 v[42:43], v13 offset:61440
  v_mfma_f32_32x32x16_bf16 a[48:63], v[48:51], v[32:35], a[48:63]
  s_waitcnt lgkmcnt(0)
  s_add_u32 m0, s53, 3072
  v_mfma_f32_32x32x16_bf16 a[0:15], v[36:39], v[20:23], a[0:15]
  buffer_load_dwordx4 v9, s[12:15], s21 offen lds
  ds_read_b128 v[28:31], v10 offset:34304
  ds_read_b64_tr_b16 v[44:45], v12 offset:59392
  v_mfma_f32_32x32x16_bf16 a[16:31], v[40:43], v[20:23], a[16:31]
  ds_read_b64_tr_b16 v[46:47], v12 offset:63488
  ds_read_b128 v[32:35], v10 offset:38400
  s_add_u32 s20, s20, 2048
  v_mfma_f32_32x32x16_bf16 a[32:47], v[36:39], v[24:27], a[32:47]
  s_add_u32 s21, s21, s51
  ds_read_b64_tr_b16 v[48:49], v13 offset:59392
  ds_read_b64_tr_b16 v[50:51], v13 offset:63488
  v_mfma_f32_32x32x16_bf16 a[48:63], v[40:43], v[24:27], a[48:63]
  s_waitcnt lgkmcnt(0)
  v_mfma_f32_32x32x16_bf16 a[0:15], v[44:47], v[28:31], a[0:15]
  s_waitcnt vmcnt(16)
  s_barrier
  s_add_u32 m0, s52, 32768
  v_mfma_f32_32x32x16_bf16 a[16:31], v[48:51], v[28:31], a[16:31]
  buffer_load_dwordx4 v2, s[8:11], s20 offen sc1 lds
  ds_read_b128 v[20:23], v11 offset:0
  ds_read_b64_tr_b16 v[36:37], v14 offset:16384
  s_add_u32 m0, s53, 32768
  v_mfma_f32_32x32x16_bf16 a[32:47], v[44:47], v[32:35], a[32:47]
  buffer_load_dwordx4 v6, s[12:15], s21 offen lds
  ds_read_b64_tr_b16 v[38:39], v14 offset:20480
  ds_read_b128 v[24:27], v11 offset:4096
  s_add_u32 m0, s52, 33792
  v_mfma_f32_32x32x16_bf16 a[48:63], v[48:51], v[32:35], a[48:63]
  buffer_load_dwordx4 v3, s[8:11], s20 offen sc1 lds
  ds_read_b64_tr_b16 v[40:41], v15 offset:16384
  ds_read_b64_tr_b16 v[42:43], v15 offset:20480
  s_waitcnt lgkmcnt(0)
  s_add_u32 m0, s53, 33792
  v_mfma_f32_32x32x16_bf16 a[0:15], v[36:39], v[20:23], a[0:15]
  buffer_load_dwordx4 v7, s[12:15], s21 offen lds
  ds_read_b128 v[28:31], v11 offset:512
  ds_read_b64_tr_b16 v[44:45], v14 offset:18432
  v_mfma_f32_32x32x16_bf16 a[16:31], v[40:43], v[20:23], a[16:31]
  ds_read_b64_tr_b16 v[46:47], v14 offset:22528
  ds_read_b128 v[32:35], v11 offset:4608
  s_add_u32 m0, s52, 34816
  v_mfma_f32_32x32x16_bf16 a[32:47], v[36:39], v[24:27], a[32:47]
  buffer_load_dwordx4 v4, s[8:11], s20 offen sc1 lds
  ds_read_b64_tr_b16 v[48:49], v15 offset:18432
  ds_read_b64_tr_b16 v[50:51], v15 offset:22528
  v_mfma_f32_32x32x16_bf16 a[48:63], v[40:43], v[24:27], a[48:63]
  s_waitcnt lgkmcnt(0)
  s_add_u32 m0, s53, 34816
  v_mfma_f32_32x32x16_bf16 a[0:15], v[44:47], v[28:31], a[0:15]
  buffer_load_dwordx4 v8, s[12:15], s21 offen lds
  ds_read_b128 v[20:23], v11 offset:1024
  ds_read_b64_tr_b16 v[36:37], v14 offset:24576
  v_mfma_f32_32x32x16_bf16 a[16:31], v[48:51], v[28:31], a[16:31]
  ds_read_b64_tr_b16 v[38:39], v14 offset:28672
  ds_read_b128 v[24:27], v11 offset:5120
  s_add_u32 m0, s52, 35840
  v_mfma_f32_32x32x16_bf16 a[32:47], v[44:47], v[32:35], a[32:47]
  buffer_load_dwordx4 v5, s[8:11], s20 offen sc1 lds
  ds_read_b64_tr_b16 v[40:41], v15 offset:24576
  ds_read_b64_tr_b16 v[42:43], v15 offset:28672
  v_mfma_f32_32x32x16_bf16 a[48:63], v[48:51], v[32:35], a[48:63]
  s_waitcnt lgkmcnt(0)
  s_add_u32 m0, s53, 35840
  v_mfma_f32_32x32x16_bf16 a[0:15], v[36:39], v[20:23], a[0:15]
  buffer_load_dwordx4 v9, s[12:15], s21 offen lds
  ds_read_b128 v[28:31], v11 offset:1536
  ds_read_b64_tr_b16 v[44:45], v14 offset:26624
  v_mfma_f32_32x32x16_bf16 a[16:31], v[40:43], v[20:23], a[16:31]
  ds_read_b64_tr_b16 v[46:47], v14 offset:30720
  ds_read_b128 v[32:35], v11 offset:5632
  s_add_u32 s20, s20, 6144
  v_mfma_f32_32x32x16_bf16 a[32:47], v[36:39], v[24:27], a[32:47]
  s_add_u32 s21, s21, s51
  ds_read_b64_tr_b16 v[48:49], v15 offset:26624
  ds_read_b64_tr_b16 v[50:51], v15 offset:30720
  v_mfma_f32_32x32x16_bf16 a[48:63], v[40:43], v[24:27], a[48:63]
  s_waitcnt lgkmcnt(0)
  v_mfma_f32_32x32x16_bf16 a[0:15], v[44:47], v[28:31], a[0:15]
  s_waitcnt vmcnt(16)
  s_barrier
  s_add_u32 m0, s52, 65536
  v_mfma_f32_32x32x16_bf16 a[16:31], v[48:51], v[28:31], a[16:31]
  buffer_load_dwordx4 v2, s[8:11], s20 offen sc1 lds
  ds_read_b128 v[20:23], v11 offset:32768
  ds_read_b64_tr_b16 v[36:37], v14 offset:49152
  s_add_u32 m0, s53, 65536
  v_mfma_f32_32x32x16_bf16 a[32:47], v[44:47], v[32:35], a[32:47]
  buffer_load_dwordx4 v6, s[12:15], s21 offen lds
  ds_read_b64_tr_b16 v[38:39], v14 offset:53248
  ds_read_b128 v[24:27], v11 offset:36864
  s_add_u32 m0, s52, 66560
  v_mfma_f32_32x32x16_bf16 a[48:63], v[48:51], v[32:35], a[48:63]
  buffer_load_dwordx4 v3, s[8:11], s20 offen sc1 lds
  ds_read_b64_tr_b16 v[40:41], v15 offset:49152
  ds_read_b64_tr_b16 v[42:43], v15 offset:53248
  s_waitcnt lgkmcnt(0)
  s_add_u32 m0, s53, 66560
  v_mfma_f32_32x32x16_bf16 a[0:15], v[36:39], v[20:23], a[0:15]
  buffer_load_dwordx4 v7, s[12:15], s21 offen lds
  ds_read_b128 v[28:31], v11 offset:33280
  ds_read_b64_tr_b16 v[44:45], v14 offset:51200
  v_mfma_f32_32x32x16_bf16 a[16:31], v[40:43], v[20:23], a[16:31]
  ds_read_b64_tr_b16 v[46:47], v14 offset:55296
  ds_read_b128 v[32:35], v11 offset:37376
  s_add_u32 m0, s52, 67584
  v_mfma_f32_32x32x16_bf16 a[32:47], v[36:39], v[24:27], a[32:47]
  buffer_load_dwordx4 v4, s[8:11], s20 offen sc1 lds
  ds_read_b64_tr_b16 v[48:49], v15 offset:51200
  ds_read_b64_tr_b16 v[50:51], v15 offset:55296
  v_mfma_f32_32x32x16_bf16 a[48:63], v[40:43], v[24:27], a[48:63]
  s_waitcnt lgkmcnt(0)
  s_add_u32 m0, s53, 67584
  v_mfma_f32_32x32x16_bf16 a[0:15], v[44:47], v[28:31], a[0:15]
  buffer_load_dwordx4 v8, s[12:15], s21 offen lds
  ds_read_b128 v[20:23], v11 offset:33792
  ds_read_b64_tr_b16 v[36:37], v14 offset:57344
  v_mfma_f32_32x32x16_bf16 a[16:31], v[48:51], v[28:31], a[16:31]
  ds_read_b64_tr_b16 v[38:39], v14 offset:61440
  ds_read_b128 v[24:27], v11 offset:37888
  s_add_u32 m0, s52, 68608
  v_mfma_f32_32x32x16_bf16 a[32:47], v[44:47], v[32:35], a[32:47]
  buffer_load_dwordx4 v5, s[8:11], s20 offen sc1 lds
  ds_read_b64_tr_b16 v[40:41], v15 offset:57344
  ds_read_b64_tr_b16 v[42:43], v15 offset:61440
  v_mfma_f32_32x32x16_bf16 a[48:63], v[48:51], v[32:35], a[48:63]
  s_waitcnt lgkmcnt(0)
  s_add_u32 m0, s53, 68608
  v_mfma_f32_32x32x16_bf16 a[0:15], v[36:39], v[20:23], a[0:15]
  buffer_load_dwordx4 v9, s[12:15], s21 offen lds
  ds_read_b128 v[28:31], v11 offset:34304
  ds_read_b64_tr_b16 v[44:45], v14 offset:59392
  v_mfma_f32_32x32x16_bf16 a[16:31], v[40:43], v[20:23], a[16:31]
  ds_read_b64_tr_b16 v[46:47], v14 offset:63488
  ds_read_b128 v[32:35], v11 offset:38400
  s_add_u32 s20, s20, 2048
  v_mfma_f32_32x32x16_bf16 a[32:47], v[36:39], v[24:27], a[32:47]
  s_add_u32 s21, s21, s51
  ds_read_b64_tr_b16 v[48:49], v15 offset:59392
  ds_read_b64_tr_b16 v[50:51], v15 offset:63488
  v_mfma_f32_32x32x16_bf16 a[48:63], v[40:43], v[24:27], a[48:63]
  s_waitcnt lgkmcnt(0)
  v_mfma_f32_32x32x16_bf16 a[0:15], v[44:47], v[28:31], a[0:15]
  s_waitcnt vmcnt(16)
  s_barrier
  s_add_u32 m0, s52, 98304
  v_mfma_f32_32x32x16_bf16 a[16:31], v[48:51], v[28:31], a[16:31]
  buffer_load_dwordx4 v2, s[8:11], s20 offen sc1 lds
  ds_read_b128 v[20:23], v10 offset:0
  ds_read_b64_tr_b16 v[36:37], v12 offset:16384
  s_add_u32 m0, s53, 98304
  v_mfma_f32_32x32x16_bf16 a[32:47], v[44:47], v[32:35], a[32:47]
  buffer_load_dwordx4 v6, s[12:15], s21 offen lds
  ds_read_b64_tr_b16 v[38:39], v12 offset:20480
  ds_read_b128 v[24:27], v10 offset:4096
  s_add_u32 m0, s52, 99328
  v_mfma_f32_32x32x16_bf16 a[48:63], v[48:51], v[32:35], a[48:63]
  buffer_load_dwordx4 v3, s[8:11], s20 offen sc1 lds
  ds_read_b64_tr_b16 v[40:41], v13 offset:16384
  ds_read_b64_tr_b16 v[42:43], v13 offset:20480
  s_branch L_g3_loop
L_g3_fin:
  s_waitcnt lgkmcnt(0)
  s_add_u32 m0, s53, 99328
  v_mfma_f32_32x32x16_bf16 a[0:15], v[36:39], v[20:23], a[0:15]
  buffer_load_dwordx4 v7, s[12:15], s21 offen lds
  ds_read_b128 v[28:31], v10 offset:512
  ds_read_b64_tr_b16 v[44:45], v12 offset:18432
  v_mfma_f32_32x32x16_bf16 a[16:31], v[40:43], v[20:23], a[16:31]
  ds_read_b64_tr_b16 v[46:47], v12 offset:22528
  ds_read_b128 v[32:35], v10 offset:4608
  s_add_u32 m0, s52, 100352
  v_mfma_f32_32x32x16_bf16 a[32:47], v[36:39], v[24:27], a[32:47]
  buffer_load_dwordx4 v4, s[8:11], s20 offen sc1 lds
  ds_read_b64_tr_b16 v[48:49], v13 offset:18432
  ds_read_b64_tr_b16 v[50:51], v13 offset:22528
  v_mfma_f32_32x32x16_bf16 a[48:63], v[40:43], v[24:27], a[48:63]
  s_waitcnt lgkmcnt(0)
  s_add_u32 m0, s53, 100352
  v_mfma_f32_32x32x16_bf16 a[0:15], v[44:47], v[28:31], a[0:15]
  buffer_load_dwordx4 v8, s[12:15], s21 offen lds
  ds_read_b128 v[20:23], v10 offset:1024
  ds_read_b64_tr_b16 v[36:37], v12 offset:24576
  v_mfma_f32_32x32x16_bf16 a[16:31], v[48:51], v[28:31], a[16:31]
  ds_read_b64_tr_b16 v[38:39], v12 offset:28672
  ds_read_b128 v[24:27], v10 offset:5120
  s_add_u32 m0, s52, 101376
  v_mfma_f32_32x32x16_bf16 a[32:47], v[44:47], v[32:35], a[32:47]
  buffer_load_dwordx4 v5, s[8:11], s20 offen sc1 lds
  ds_read_b64_tr_b16 v[40:41], v13 offset:24576
  ds_read_b64_tr_b16 v[42:43], v13 offset:28672
  v_mfma_f32_32x32x16_bf16 a[48:63], v[48:51], v[32:35], a[48:63]
  s_waitcnt lgkmcnt(0)
  s_add_u32 m0, s53, 101376
  v_mfma_f32_32x32x16_bf16 a[0:15], v[36:39], v[20:23], a[0:15]
  buffer_load_dwordx4 v9, s[12:15], s21 offen lds
  ds_read_b128 v[28:31], v10 offset:1536
  ds_read_b64_tr_b16 v[44:45], v12 offset:26624
  v_mfma_f32_32x32x16_bf16 a[16:31], v[40:43], v[20:23], a[16:31]
  ds_read_b64_tr_b16 v[46:47], v12 offset:30720
  ds_read_b128 v[32:35], v10 offset:5632
  s_add_u32 s20, s20, 6144
  v_mfma_f32_32x32x16_bf16 a[32:47], v[36:39], v[24:27], a[32:47]
  s_add_u32 s21, s21, s51
  ds_read_b64_tr_b16 v[48:49], v13 offset:26624
  ds_read_b64_tr_b16 v[50:51], v13 offset:30720
  v_mfma_f32_32x32x16_bf16 a[48:63], v[40:43], v[24:27], a[48:63]
  s_waitcnt lgkmcnt(0)
  v_mfma_f32_32x32x16_bf16 a[0:15], v[44:47], v[28:31], a[0:15]
  s_waitcnt vmcnt(16)
  s_barrier
  v_mfma_f32_32x32x16_bf16 a[16:31], v[48:51], v[28:31], a[16:31]
  ds_read_b128 v[20:23], v10 offset:32768
  ds_read_b64_tr_b16 v[36:37], v12 offset:49152
  v_mfma_f32_32x32x16_bf16 a[32:47], v[44:47], v[32:35], a[32:47]
  ds_read_b64_tr_b16 v[38:39], v12 offset:53248
  ds_read_b128 v[24:27], v10 offset:36864
  v_mfma_f32_32x32x16_bf16 a[48:63], v[48:51], v[32:35], a[48:63]
  ds_read_b64_tr_b16 v[40:41], v13 offset:49152
  ds_read_b64_tr_b16 v[42:43], v13 offset:53248
  s_waitcnt lgkmcnt(0)
  v_mfma_f32_32x32x16_bf16 a[0:15], v[36:39], v[20:23], a[0:15]
  ds_read_b128 v[28:31], v10 offset:33280
  ds_read_b64_tr_b16 v[44:45], v12 offset:51200
  v_mfma_f32_32x32x16_bf16 a[16:31], v[40:43], v[20:23], a[16:31]
  ds_read_b64_tr_b16 v[46:47], v12 offset:55296
  ds_read_b128 v[32:35], v10 offset:37376
  v_mfma_f32_32x32x16_bf16 a[32:47], v[36:39], v[24:27], a[32:47]
  ds_read_b64_tr_b16 v[48:49], v13 offset:51200
  ds_read_b64_tr_b16 v[50:51], v13 offset:55296
  v_mfma_f32_32x32x16_bf16 a[48:63], v[40:43], v[24:27], a[48:63]
  s_waitcnt lgkmcnt(0)
  v_mfma_f32_32x32x16_bf16 a[0:15], v[44:47], v[28:31], a[0:15]
  ds_read_b128 v[20:23], v10 offset:33792
  ds_read_b64_tr_b16 v[36:37], v12 offset:57344
  v_mfma_f32_32x32x16_bf16 a[16:31], v[48:51], v[28:31], a[16:31]
  ds_read_b64_tr_b16 v[38:39], v12 offset:61440
  ds_read_b128 v[24:27], v10 offset:37888
  v_mfma_f32_32x32x16_bf16 a[32:47], v[44:47], v[32:35], a[32:47]
  ds_read_b64_tr_b16 v[40:41], v13 offset:57344
  ds_read_b64_tr_b16 v[42:43], v13 offset:61440
  v_mfma_f32_32x32x16_bf16 a[48:63], v[48:51], v[32:35], a[48:63]
  s_waitcnt lgkmcnt(0)
  v_mfma_f32_32x32x16_bf16 a[0:15], v[36:39], v[20:23], a[0:15]
  ds_read_b128 v[28:31], v10 offset:34304
  ds_read_b64_tr_b16 v[44:45], v12 offset:59392
  v_mfma_f32_32x32x16_bf16 a[16:31], v[40:43], v[20:23], a[16:31]
  ds_read_b64_tr_b16 v[46:47], v12 offset:63488
  ds_read_b128 v[32:35], v10 offset:38400
  v_mfma_f32_32x32x16_bf16 a[32:47], v[36:39], v[24:27], a[32:47]
  ds_read_b64_tr_b16 v[48:49], v13 offset:59392
  ds_read_b64_tr_b16 v[50:51], v13 offset:63488
  v_mfma_f32_32x32x16_bf16 a[48:63], v[40:43], v[24:27], a[48:63]
  s_waitcnt lgkmcnt(0)
  v_mfma_f32_32x32x16_bf16 a[0:15], v[44:47], v[28:31], a[0:15]
  s_waitcnt vmcnt(8)
  s_barrier
  v_mfma_f32_32x32x16_bf16 a[16:31], v[48:51], v[28:31], a[16:31]
  ds_read_b128 v[20:23], v11 offset:0
  ds_read_b64_tr_b16 v[36:37], v14 offset:16384
  v_mfma_f32_32x32x16_bf16 a[32:47], v[44:47], v[32:35], a[32:47]
  ds_read_b64_tr_b16 v[38:39], v14 offset:20480
  ds_read_b128 v[24:27], v11 offset:4096
  v_mfma_f32_32x32x16_bf16 a[48:63], v[48:51], v[32:35], a[48:63]
  ds_read_b64_tr_b16 v[40:41], v15 offset:16384
  ds_read_b64_tr_b16 v[42:43], v15 offset:20480
  s_waitcnt lgkmcnt(0)
  v_mfma_f32_32x32x16_bf16 a[0:15], v[36:39], v[20:23], a[0:15]
  ds_read_b128 v[28:31], v11 offset:512
  ds_read_b64_tr_b16 v[44:45], v14 offset:18432
  v_mfma_f32_32x32x16_bf16 a[16:31], v[40:43], v[20:23], a[16:31]
  ds_read_b64_tr_b16 v[46:47], v14 offset:22528
  ds_read_b128 v[32:35], v11 offset:4608
  v_mfma_f32_32x32x16_bf16 a[32:47], v[36:39], v[24:27], a[32:47]
  ds_read_b64_tr_b16 v[48:49], v15 offset:18432
  ds_read_b64_tr_b16 v[50:51], v15 offset:22528
  v_mfma_f32_32x32x16_bf16 a[48:63], v[40:43], v[24:27], a[48:63]
  s_waitcnt lgkmcnt(0)
  v_mfma_f32_32x32x16_bf16 a[0:15], v[44:47], v[28:31], a[0:15]
  ds_read_b128 v[20:23], v11 offset:1024
  ds_read_b64_tr_b16 v[36:37], v14 offset:24576
  v_mfma_f32_32x32x16_bf16 a[16:31], v[48:51], v[28:31], a[16:31]
  ds_read_b64_tr_b16 v[38:39], v14 offset:28672
  ds_read_b128 v[24:27], v11 offset:5120
  v_mfma_f32_32x32x16_bf16 a[32:47], v[44:47], v[32:35], a[32:47]
  ds_read_b64_tr_b16 v[40:41], v15 offset:24576
  ds_read_b64_tr_b16 v[42:43], v15 offset:28672
  v_mfma_f32_32x32x16_bf16 a[48:63], v[48:51], v[32:35], a[48:63]
  s_waitcnt lgkmcnt(0)
  v_mfma_f32_32x32x16_bf16 a[0:15], v[36:39], v[20:23], a[0:15]
  ds_read_b128 v[28:31], v11 offset:1536
  ds_read_b64_tr_b16 v[44:45], v14 offset:26624
  v_mfma_f32_32x32x16_bf16 a[16:31], v[40:43], v[20:23], a[16:31]
  ds_read_b64_tr_b16 v[46:47], v14 offset:30720
  ds_read_b128 v[32:35], v11 offset:5632
  v_mfma_f32_32x32x16_bf16 a[32:47], v[36:39], v[24:27], a[32:47]
  ds_read_b64_tr_b16 v[48:49], v15 offset:26624
  ds_read_b64_tr_b16 v[50:51], v15 offset:30720
  v_mfma_f32_32x32x16_bf16 a[48:63], v[40:43], v[24:27], a[48:63]
  s_waitcnt lgkmcnt(0)
  v_mfma_f32_32x32x16_bf16 a[0:15], v[44:47], v[28:31], a[0:15]
  s_waitcnt vmcnt(0)
  s_barrier
  v_mfma_f32_32x32x16_bf16 a[16:31], v[48:51], v[28:31], a[16:31]
  ds_read_b128 v[20:23], v11 offset:32768
  ds_read_b64_tr_b16 v[36:37], v14 offset:49152
  v_mfma_f32_32x32x16_bf16 a[32:47], v[44:47], v[32:35], a[32:47]
  ds_read_b64_tr_b16 v[38:39], v14 offset:53248
  ds_read_b128 v[24:27], v11 offset:36864
  v_mfma_f32_32x32x16_bf16 a[48:63], v[48:51], v[32:35], a[48:63]
  ds_read_b64_tr_b16 v[40:41], v15 offset:49152
  ds_read_b64_tr_b16 v[42:43], v15 offset:53248
  s_waitcnt lgkmcnt(0)
  v_mfma_f32_32x32x16_bf16 a[0:15], v[36:39], v[20:23], a[0:15]
  ds_read_b128 v[28:31], v11 offset:33280
  ds_read_b64_tr_b16 v[44:45], v14 offset:51200
  v_mfma_f32_32x32x16_bf16 a[16:31], v[40:43], v[20:23], a[16:31]
  ds_read_b64_tr_b16 v[46:47], v14 offset:55296
  ds_read_b128 v[32:35], v11 offset:37376
  v_mfma_f32_32x32x16_bf16 a[32:47], v[36:39], v[24:27], a[32:47]
  ds_read_b64_tr_b16 v[48:49], v15 offset:51200
  ds_read_b64_tr_b16 v[50:51], v15 offset:55296
  v_mfma_f32_32x32x16_bf16 a[48:63], v[40:43], v[24:27], a[48:63]
  s_waitcnt lgkmcnt(0)
  v_mfma_f32_32x32x16_bf16 a[0:15], v[44:47], v[28:31], a[0:15]
  ds_read_b128 v[20:23], v11 offset:33792
  ds_read_b64_tr_b16 v[36:37], v14 offset:57344
  v_mfma_f32_32x32x16_bf16 a[16:31], v[48:51], v[28:31], a[16:31]
  ds_read_b64_tr_b16 v[38:39], v14 offset:61440
  ds_read_b128 v[24:27], v11 offset:37888
  v_mfma_f32_32x32x16_bf16 a[32:47], v[44:47], v[32:35], a[32:47]
  ds_read_b64_tr_b16 v[40:41], v15 offset:57344
  ds_read_b64_tr_b16 v[42:43], v15 offset:61440
  v_mfma_f32_32x32x16_bf16 a[48:63], v[48:51], v[32:35], a[48:63]
  s_waitcnt lgkmcnt(0)
  v_mfma_f32_32x32x16_bf16 a[0:15], v[36:39], v[20:23], a[0:15]
  ds_read_b128 v[28:31], v11 offset:34304
  ds_read_b64_tr_b16 v[44:45], v14 offset:59392
  v_mfma_f32_32x32x16_bf16 a[16:31], v[40:43], v[20:23], a[16:31]
  ds_read_b64_tr_b16 v[46:47], v14 offset:63488
  ds_read_b128 v[32:35], v11 offset:38400
  v_mfma_f32_32x32x16_bf16 a[32:47], v[36:39], v[24:27], a[32:47]
  ds_read_b64_tr_b16 v[48:49], v15 offset:59392
  ds_read_b64_tr_b16 v[50:51], v15 offset:63488
  v_mfma_f32_32x32x16_bf16 a[48:63], v[40:43], v[24:27], a[48:63]
  s_waitcnt lgkmcnt(0)
  v_mfma_f32_32x32x16_bf16 a[0:15], v[44:47], v[28:31], a[0:15]
  v_mfma_f32_32x32x16_bf16 a[16:31], v[48:51], v[28:31], a[16:31]
  v_mfma_f32_32x32x16_bf16 a[32:47], v[44:47], v[32:35], a[32:47]
  v_mfma_f32_32x32x16_bf16 a[48:63], v[48:51], v[32:35], a[48:63]
  s_lshr_b32 s90, s27, 1
  s_and_b32 s91, s27, 1
  v_and_b32 v52, 31, v1
  v_mul_lo_u32 v52, v52, s26
  v_lshrrev_b32 v53, 5, v1
  v_lshl_add_u32 v54, v53, 5, v52
  s_mul_i32 s92, s90, 64
  s_mul_i32 s92, s92, s26
  s_add_u32 s92, s92, s22
  s_mul_i32 s93, s91, 128
  s_add_u32 s92, s92, s93
  s_lshl_b32 s94, s26, 5
  v_accvgpr_read_b32 v60, a0
  v_accvgpr_read_b32 v61, a1
  v_accvgpr_read_b32 v62, a2
  v_accvgpr_read_b32 v63, a3
  v_accvgpr_read_b32 v64, a4
  v_accvgpr_read_b32 v65, a5
  v_accvgpr_read_b32 v66, a6
  v_accvgpr_read_b32 v67, a7
  v_cvt_pk_bf16_f32 v56, v60, v61
  v_cvt_pk_bf16_f32 v57, v62, v63
  v_cvt_pk_bf16_f32 v58, v64, v65
  v_cvt_pk_bf16_f32 v59, v66, v67
  buffer_store_dwordx4 v[56:59], v54, s[16:19], s92 offen offset:0
  v_accvgpr_read_b32 v72, a8
  v_accvgpr_read_b32 v73, a9
  v_accvgpr_read_b32 v74, a10
  v_accvgpr_read_b32 v75, a11
  v_accvgpr_read_b32 v76, a12
  v_accvgpr_read_b32 v77, a13
  v_accvgpr_read_b32 v78, a14
  v_accvgpr_read_b32 v79, a15
  v_cvt_pk_bf16_f32 v68, v72, v73
  v_cvt_pk_bf16_f32 v69, v74, v75
  v_cvt_pk_bf16_f32 v70, v76, v77
  v_cvt_pk_bf16_f32 v71, v78, v79
  buffer_store_dwordx4 v[68:71], v54, s[16:19], s92 offen offset:16
  v_accvgpr_read_b32 v84, a16
  v_accvgpr_read_b32 v85, a17
  v_accvgpr_read_b32 v86, a18
  v_accvgpr_read_b32 v87, a19
  v_accvgpr_read_b32 v88, a20
  v_accvgpr_read_b32 v89, a21
  v_accvgpr_read_b32 v90, a22
  v_accvgpr_read_b32 v91, a23
  v_cvt_pk_bf16_f32 v80, v84, v85
  v_cvt_pk_bf16_f32 v81, v86, v87
  v_cvt_pk_bf16_f32 v82, v88, v89
  v_cvt_pk_bf16_f32 v83, v90, v91
  buffer_store_dwordx4 v[80:83], v54, s[16:19], s92 offen offset:64
  v_accvgpr_read_b32 v96, a24
  v_accvgpr_read_b32 v97, a25
  v_accvgpr_read_b32 v98, a26
  v_accvgpr_read_b32 v99, a27
  v_accvgpr_read_b32 v100, a28
  v_accvgpr_read_b32 v101, a29
  v_accvgpr_read_b32 v102, a30
  v_accvgpr_read_b32 v103, a31
  v_cvt_pk_bf16_f32 v92, v96, v97
  v_cvt_pk_bf16_f32 v93, v98, v99
  v_cvt_pk_bf16_f32 v94, v100, v101
  v_cvt_pk_bf16_f32 v95, v102, v103
  buffer_store_dwordx4 v[92:95], v54, s[16:19], s92 offen offset:80
  s_add_u32 s92, s92, s94
  v_accvgpr_read_b32 v60, a32
  v_accvgpr_read_b32 v61, a33
  v_accvgpr_read_b32 v62, a34
  v_accvgpr_read_b32 v63, a35
  v_accvgpr_read_b32 v64, a36
  v_accvgpr_read_b32 v65, a37
  v_accvgpr_read_b32 v66, a38
  v_accvgpr_read_b32 v67, a39
  v_cvt_pk_bf16_f32 v56, v60, v61
  v_cvt_pk_bf16_f32 v57, v62, v63
  v_cvt_pk_bf16_f32 v58, v64, v65
  v_cvt_pk_bf16_f32 v59, v66, v67
  buffer_store_dwordx4 v[56:59], v54, s[16:19], s92 offen offset:0
  v_accvgpr_read_b32 v72, a40
  v_accvgpr_read_b32 v73, a41
  v_accvgpr_read_b32 v74, a42
  v_accvgpr_read_b32 v75, a43
  v_accvgpr_read_b32 v76, a44
  v_accvgpr_read_b32 v77, a45
  v_accvgpr_read_b32 v78, a46
  v_accvgpr_read_b32 v79, a47
  v_cvt_pk_bf16_f32 v68, v72, v73
  v_cvt_pk_bf16_f32 v69, v74, v75
  v_cvt_pk_bf16_f32 v70, v76, v77
  v_cvt_pk_bf16_f32 v71, v78, v79
  buffer_store_dwordx4 v[68:71], v54, s[16:19], s92 offen offset:16
  v_accvgpr_read_b32 v84, a48
  v_accvgpr_read_b32 v85, a49
  v_accvgpr_read_b32 v86, a50
  v_accvgpr_read_b32 v87, a51
  v_accvgpr_read_b32 v88, a52
  v_accvgpr_read_b32 v89, a53
  v_accvgpr_read_b32 v90, a54
  v_accvgpr_read_b32 v91, a55
  v_cvt_pk_bf16_f32 v80, v84, v85
  v_cvt_pk_bf16_f32 v81, v86, v87
  v_cvt_pk_bf16_f32 v82, v88, v89
  v_cvt_pk_bf16_f32 v83, v90, v91
  buffer_store_dwordx4 v[80:83], v54, s[16:19], s92 offen offset:64
  v_accvgpr_read_b32 v96, a56
  v_accvgpr_read_b32 v97, a57
  v_accvgpr_read_b32 v98, a58
  v_accvgpr_read_b32 v99, a59
  v_accvgpr_read_b32 v100, a60
  v_accvgpr_read_b32 v101, a61
  v_accvgpr_read_b32 v102, a62
  v_accvgpr_read_b32 v103, a63
  v_cvt_pk_bf16_f32 v92, v96, v97
  v_cvt_pk_bf16_f32 v93, v98, v99
  v_cvt_pk_bf16_f32 v94, v100, v101
  v_cvt_pk_bf16_f32 v95, v102, v103
  buffer_store_dwordx4 v[92:95], v54, s[16:19], s92 offen offset:80
  s_add_u32 s92, s92, s94
  s_barrier
  s_branch L_next
L_done:
  s_waitcnt vmcnt(0)
  s_barrier
  s_cmp_lg_u32 s32, 0
  s_cbranch_scc1 L_sig_12
  v_mov_b32 v254, 1
  v_mov_b32 v255, 0
  s_mov_b64 exec, 1
  buffer_atomic_add v254, v255, s[28:31], s38 offen offset:0 sc1
  s_mov_b64 exec, -1
L_sig_12:
  s_branch L_next
L_exit:
  s_endpgm
.p2align 2
L_table:
.long 0x1
.long 0x2
.long 0x10001
.long 0x10002
.long 0x20001
.long 0x20002
.long 0x30001
.long 0x30002
.long 0x101
.long 0x102
.long 0x10101
.long 0x10102
.long 0x20101
.long 0x20102
.long 0x30101
.long 0x30102
.long 0x201
.long 0x202
.long 0x10201
.long 0x10202
.long 0x20201
.long 0x20202
.long 0x30201
.long 0x30202
.long 0x301
.long 0x302
.long 0x10301
.long 0x10302
.long 0x20301
.long 0x20302
.long 0x30301
.long 0x30302
.long 0x3
.long 0x10003
.long 0x20003
.long 0x103
.long 0x10103
.long 0x20103
.long 0x203
.long 0x10203
.long 0x20203
.long 0x303
.long 0x10303
.long 0x20303
.long 0x403
.long 0x10403
.long 0x20403
.long 0x503
.long 0x10503
.long 0x20503
.long 0x603
.long 0x10603
.long 0x20603
.long 0x703
.long 0x10703
.long 0x20703
.long 0x0
.long 0x10000
.long 0x20000
.long 0x30000
.long 0x100
.long 0x10100
.long 0x20100
.long 0x30100
.long 0x200
.long 0x10200
.long 0x20200
.long 0x30200
.long 0x300
.long 0x10300
.long 0x20300
.long 0x30300
.long 0x400
.long 0x10400
.long 0x20400
.long 0x30400
.long 0x500
.long 0x10500
.long 0x20500
.long 0x30500
.long 0x600
.long 0x10600
.long 0x20600
.long 0x30600
.long 0x700
.long 0x10700
.long 0x20700
.long 0x30700
.long 0x401
.long 0x402
.long 0x10401
.long 0x10402
.long 0x20401
.long 0x20402
.long 0x30401
.long 0x30402
.long 0x501
.long 0x502
.long 0x10501
.long 0x10502
.long 0x20501
.long 0x20502
.long 0x30501
.long 0x30502
.long 0x601
.long 0x602
.long 0x10601
.long 0x10602
.long 0x20601
.long 0x20602
.long 0x30601
.long 0x30602
.long 0x701
.long 0x702
.long 0x10701
.long 0x10702
.long 0x20701
.long 0x20702
.long 0x30701
.long 0x30702
.long 0x4
.long 0x10004
.long 0x20004
.long 0x30004
.long 0x104
.long 0x10104
.long 0x20104
.long 0x30104
.long 0x204
.long 0x10204
.long 0x20204
.long 0x30204
.long 0x304
.long 0x10304
.long 0x20304
.long 0x30304
.long 0x404
.long 0x10404
.long 0x20404
.long 0x30404
.long 0x504
.long 0x10504
.long 0x20504
.long 0x30504
.long 0x604
.long 0x10604
.long 0x20604
.long 0x30604
.long 0x704
.long 0x10704
.long 0x20704
.long 0x30704
.long 0x5
.long 0x10005
.long 0x105
.long 0x10105
.long 0x205
.long 0x10205
.long 0x305
.long 0x10305
.long 0x405
.long 0x10405
.long 0x505
.long 0x10505
.long 0x605
.long 0x10605
.long 0x705
.long 0x10705
.long 0x805
.long 0x10805
.long 0x905
.long 0x10905
.long 0xa05
.long 0x10a05
.long 0xb05
.long 0x10b05
.long 0xc05
.long 0x10c05
.long 0xd05
.long 0x10d05
.long 0xe05
.long 0x10e05
.long 0xf05
.long 0x10f05
.long 0x6
.long 0x10006
.long 0x106
.long 0x10106
.long 0x206
.long 0x10206
.long 0x306
.long 0x10306
.long 0x7
.long 0x10007
.long 0x406
.long 0x10406
.long 0x506
.long 0x10506
.long 0x606
.long 0x10606
.long 0x706
.long 0x10706
.long 0x107
.long 0x10107
.long 0x806
.long 0x10806
.long 0x906
.long 0x10906
.long 0xa06
.long 0x10a06
.long 0xb06
.long 0x10b06
.long 0x207
.long 0x10207
.long 0xc06
.long 0x10c06
.long 0xd06
.long 0x10d06
.long 0xe06
.long 0x10e06
.long 0xf06
.long 0x10f06
.long 0x307
.long 0x10307
.long 0x1006
.long 0x11006
.long 0x1106
.long 0x11106
.long 0x1206
.long 0x11206
.long 0x1306
.long 0x11306
.long 0x407
.long 0x10407
.long 0x1406
.long 0x11406
.long 0x1506
.long 0x11506
.long 0x1606
.long 0x11606
.long 0x1706
.long 0x11706
.long 0x507
.long 0x10507
.long 0x1806
.long 0x11806
.long 0x1906
.long 0x11906
.long 0x1a06
.long 0x11a06
.long 0x1b06
.long 0x11b06
.long 0x607
.long 0x10607
.long 0x1c06
.long 0x11c06
.long 0x1d06
.long 0x11d06
.long 0x1e06
.long 0x11e06
.long 0x1f06
.long 0x11f06
.long 0x707
.long 0x10707
.long 0x2006
.long 0x12006
.long 0x2106
.long 0x12106
.long 0x2206
.long 0x12206
.long 0x2306
.long 0x12306
.long 0x807
.long 0x10807
.long 0x2406
.long 0x12406
.long 0x2506
.long 0x12506
.long 0x2606
.long 0x12606
.long 0x2706
.long 0x12706
.long 0x907
.long 0x10907
.long 0x2806
.long 0x12806
.long 0x2906
.long 0x12906
.long 0x2a06
.long 0x12a06
.long 0x2b06
.long 0x12b06
.long 0xa07
.long 0x10a07
.long 0x2c06
.long 0x12c06
.long 0x2d06
.long 0x12d06
.long 0x2e06
.long 0x12e06
.long 0x2f06
.long 0x12f06
.long 0xb07
.long 0x10b07
.long 0x3006
.long 0x13006
.long 0x3106
.long 0x13106
.long 0x3206
.long 0x13206
.long 0x3306
.long 0x13306
.long 0xc07
.long 0x10c07
.long 0x3406
.long 0x13406
.long 0x3506
.long 0x13506
.long 0x3606
.long 0x13606
.long 0x3706
.long 0x13706
.long 0xd07
.long 0x10d07
.long 0x3806
.long 0x13806
.long 0x3906
.long 0x13906
.long 0x3a06
.long 0x13a06
.long 0x3b06
.long 0x13b06
.long 0xe07
.long 0x10e07
.long 0x3c06
.long 0x13c06
.long 0x3d06
.long 0x13d06
.long 0x3e06
.long 0x13e06
.long 0x3f06
.long 0x13f06
.long 0xf07
.long 0x10f07
.section .rodata,"a"
.p2align 6
.amdhsa_kernel concat_heads__memory_aug_recurrent_mem_tr__sliding_local_dilated__prompt_kernel
  .amdhsa_next_free_vgpr 512
  .amdhsa_next_free_sgpr 102
  .amdhsa_accum_offset 256
  .amdhsa_group_segment_fixed_size 0
  .amdhsa_kernarg_size 104
  .amdhsa_user_sgpr_count 2
  .amdhsa_user_sgpr_kernarg_segment_ptr 1
  .amdhsa_system_sgpr_workgroup_id_x 1
  .amdhsa_float_denorm_mode_32 3
  .amdhsa_float_denorm_mode_16_64 3
.end_amdhsa_kernel
```

```asm
; @launch grid=(256,1,1) block=(256,1,1) lds=131136
.amdgcn_target "amdgcn-amd-amdhsa--gfx950"
.text
.globl concat_heads__memory_aug_recurrent_mem_tr__sliding_local_dilated__prompt_kernel
.p2align 8
.type concat_heads__memory_aug_recurrent_mem_tr__sliding_local_dilated__prompt_kernel,@function
concat_heads__memory_aug_recurrent_mem_tr__sliding_local_dilated__prompt_kernel:
  s_cmp_ge_u32 s2, 256
  s_cbranch_scc1 L_exit
  s_load_dwordx4 s[92:95], s[0:1], 88
  s_load_dwordx16 s[64:79], s[0:1], 0
  s_getreg_b32 s39, hwreg(HW_REG_XCC_ID, 0, 3)
  v_lshrrev_b32 v2, 6, v0
  s_nop 0
  v_readfirstlane_b32 s32, v2
  s_mov_b32 s3, 0
  s_getpc_b64 s[86:87]
L_pc0:
  s_lshr_b32 s90, s2, 3
  s_lshl_b32 s90, s90, 2
  s_add_u32 s90, s90, s32
  s_and_b32 s90, s90, 31
  s_lshl_b32 s90, s90, 12
  v_and_b32 v1, 63, v0
  v_lshlrev_b32 v1, 6, v1
  v_add_u32 v1, s90, v1
  v_min_u32 v1, L_table-L_pc0, v1
  global_load_dword v199, v1, s[86:87]
  s_waitcnt lgkmcnt(0)
  s_mov_b32 s4, s94
  s_and_b32 s5, s95, 0xffff
  s_mov_b32 s6, 0x10000000
  s_mov_b32 s7, 0x20000
  s_mov_b32 s28, s92
  s_and_b32 s29, s93, 0xffff
  s_mov_b32 s30, 0x100
  s_mov_b32 s31, 0x20000
  s_mov_b32 s100, 0
  s_lshr_b32 s41, s2, 3
  s_lshl_b32 s101, 1, s41
  s_cmp_lg_u32 s32, 0
  s_cbranch_scc1 L_sweep
  s_lshl_b32 s90, s39, 2
  v_mov_b32 v247, s101
  v_mov_b32 v2, 0
  s_mov_b64 exec, 1
  buffer_atomic_or v247, v2, s[28:31], s90 offen offset:0 sc0 sc1
  s_mov_b64 exec, -1
L_sweep:
  s_lshl_b32 s40, s39, 5
  s_add_u32 s40, s40, s41
  s_mov_b32 s43, 1
  s_branch L_role
L_fallback:
  s_load_dwordx4 s[92:95], s[0:1], 88
  s_load_dwordx16 s[64:79], s[0:1], 0
  s_getreg_b32 s39, hwreg(HW_REG_XCC_ID, 0, 3)
  s_mov_b32 s100, 4
  v_mbcnt_lo_u32_b32 v0, -1, 0
  v_mbcnt_hi_u32_b32 v0, -1, v0
  s_lshl_b32 s90, s32, 6
  v_add_u32 v0, s90, v0
  s_waitcnt vmcnt(0) lgkmcnt(0)
  s_barrier
  s_cmp_lg_u32 s32, 0
  s_cbranch_scc1 L_tkd
  s_lshl_b32 s90, s39, 2
  v_mov_b32 v1, 1
  v_mov_b32 v2, 0
  v_lshlrev_b32 v3, 2, v0
  s_mov_b64 exec, 1
  buffer_atomic_add v1, v2, s[28:31], s90 offen offset:192 sc0 sc1
  s_mov_b64 exec, 0xff
L_tkw:
  buffer_load_dword v4, v3, s[28:31], 0 offen offset:192 sc1
  s_waitcnt vmcnt(0)
  v_readfirstlane_b32 s40, v1
  s_mov_b32 s41, 0
  s_mov_b32 s42, 0
  s_mov_b32 s43, 1
  v_readlane_b32 s44, v4, 0
  s_add_u32 s41, s41, s44
  s_cmp_gt_u32 s39, 0
  s_cselect_b32 s45, s44, 0
  s_add_u32 s42, s42, s45
  s_cmp_eq_u32 s44, 32
  s_cselect_b32 s43, s43, 0
  v_readlane_b32 s44, v4, 1
  s_add_u32 s41, s41, s44
  s_cmp_gt_u32 s39, 1
  s_cselect_b32 s45, s44, 0
  s_add_u32 s42, s42, s45
  s_cmp_eq_u32 s44, 32
  s_cselect_b32 s43, s43, 0
  v_readlane_b32 s44, v4, 2
  s_add_u32 s41, s41, s44
  s_cmp_gt_u32 s39, 2
  s_cselect_b32 s45, s44, 0
  s_add_u32 s42, s42, s45
  s_cmp_eq_u32 s44, 32
  s_cselect_b32 s43, s43, 0
  v_readlane_b32 s44, v4, 3
  s_add_u32 s41, s41, s44
  s_cmp_gt_u32 s39, 3
  s_cselect_b32 s45, s44, 0
  s_add_u32 s42, s42, s45
  s_cmp_eq_u32 s44, 32
  s_cselect_b32 s43, s43, 0
  v_readlane_b32 s44, v4, 4
  s_add_u32 s41, s41, s44
  s_cmp_gt_u32 s39, 4
  s_cselect_b32 s45, s44, 0
  s_add_u32 s42, s42, s45
  v_readlane_b32 s44, v4, 5
  s_add_u32 s41, s41, s44
  s_cmp_gt_u32 s39, 5
  s_cselect_b32 s45, s44, 0
  s_add_u32 s42, s42, s45
  v_readlane_b32 s44, v4, 6
  s_add_u32 s41, s41, s44
  s_cmp_gt_u32 s39, 6
  s_cselect_b32 s45, s44, 0
  s_add_u32 s42, s42, s45
  v_readlane_b32 s44, v4, 7
  s_add_u32 s41, s41, s44
  s_cmp_gt_u32 s39, 7
  s_cselect_b32 s45, s44, 0
  s_add_u32 s42, s42, s45
  s_add_u32 s3, s3, 1
  s_cmp_ge_u32 s3, 131072
  s_cbranch_scc1 L_tkbad
  s_sleep 4
  s_cmp_lt_u32 s41, 256
  s_cbranch_scc1 L_tkw
  s_add_u32 s40, s40, s42
  s_lshl_b32 s43, s43, 16
  s_or_b32 s40, s40, s43
  s_branch L_tkok
L_tkbad:
  s_mov_b32 s40, 0xffff
L_tkok:
  s_mov_b64 exec, -1
  v_mov_b32 v1, s40
  v_mov_b32 v2, 131072
  ds_write_b32 v2, v1
  s_waitcnt lgkmcnt(0)
L_tkd:
  s_barrier
  v_mov_b32 v2, 131072
  ds_read_b32 v1, v2
  s_waitcnt lgkmcnt(0)
  v_readfirstlane_b32 s40, v1
  s_barrier
  s_lshr_b32 s43, s40, 16
  s_and_b32 s40, s40, 0xffff
  s_cmp_ge_u32 s40, 256
  s_cbranch_scc1 L_exit
L_role:
  s_cmp_ge_u32 s40, 128
  s_cbranch_scc1 L_worker
  s_lshr_b32 s33, s40, 5
  s_and_b32 s34, s40, 31
  s_cmp_eq_u32 s43, 0
  s_cbranch_scc1 L_recslow
  s_load_dwordx4 s[80:83], s[0:1], 8
  s_load_dwordx4 s[84:87], s[0:1], 24
  s_load_dwordx2 s[88:89], s[0:1], 40
  v_lshrrev_b32 v31, 6, v0
  s_nop 0
  v_readfirstlane_b32 s32, v31
  v_and_b32 v0, 63, v0
  s_lshr_b32 s35, s34, 4
  s_lshl_b32 s90, s33, 1
  s_add_u32 s35, s35, s90
  s_and_b32 s36, s34, 15
  s_lshr_b32 s37, s36, 2
  s_lshl_b32 s90, s35, 2
  s_add_u32 s37, s37, s90
  s_and_b32 s38, s36, 3
  s_waitcnt lgkmcnt(0)
  s_mov_b32 s24, s80
  s_and_b32 s25, s81, 0xffff
  s_mov_b32 s26, 0x4000
  s_mov_b32 s27, 0x20000
  s_mov_b32 s8, s82
  s_and_b32 s9, s83, 0xffff
  s_mov_b32 s10, 0x800000
  s_mov_b32 s11, 0x20000
  s_mov_b32 s12, s84
  s_and_b32 s13, s85, 0xffff
  s_mov_b32 s14, 0x800000
  s_mov_b32 s15, 0x20000
  s_mov_b32 s16, s86
  s_and_b32 s17, s87, 0xffff
  s_mov_b32 s18, 0x800000
  s_mov_b32 s19, 0x20000
  s_mov_b32 s20, s88
  s_and_b32 s21, s89, 0xffff
  s_mov_b32 s22, 0x800000
  s_mov_b32 s23, 0x20000
  s_lshl_b32 s90, s32, 21
  s_lshl_b32 s91, s37, 8
  s_add_u32 s90, s90, s91
  s_lshr_b32 s91, s38, 1
  s_lshl_b32 s91, s91, 7
  s_add_u32 s90, s90, s91
  v_mov_b32 v1, 0x0
  v_bfe_u32 v31, v0, 3, 3
  v_lshl_add_u32 v1, v31, 13, v1
  v_bfe_u32 v31, v0, 0, 3
  v_lshl_add_u32 v1, v31, 4, v1
  v_add_u32 v1, s90, v1
  s_lshl_b32 s90, s35, 2
  s_add_u32 s90, s90, s32
  s_lshl_b32 s90, s90, 18
  s_lshl_b32 s91, s36, 7
  s_add_u32 s90, s90, s91
  v_mov_b32 v2, 0x0
  v_bfe_u32 v31, v0, 3, 3
  v_lshl_add_u32 v2, v31, 11, v2
  v_bfe_u32 v31, v0, 0, 3
  v_lshl_add_u32 v2, v31, 4, v2
  v_add_u32 v2, s90, v2
  s_lshl_b32 s96, s32, 15
  s_and_b32 s91, s38, 1
  s_lshl_b32 s91, s91, 6
  s_add_u32 s91, s91, s96
  v_mov_b32 v3, 0x0
  v_bfe_u32 v31, v0, 5, 1
  v_lshl_add_u32 v3, v31, 11, v3
  v_bfe_u32 v31, v0, 4, 1
  v_lshl_add_u32 v3, v31, 10, v3
  v_bfe_u32 v31, v0, 2, 2
  v_lshl_add_u32 v3, v31, 7, v3
  v_bfe_u32 v31, v0, 0, 2
  v_lshl_add_u32 v3, v31, 3, v3
  v_add_u32 v3, s91, v3
  s_lshl_b32 s91, s32, 5
  v_mov_b32 v4, 0x0
  v_bfe_u32 v31, v0, 4, 1
  v_lshl_add_u32 v4, v31, 13, v4
  v_bfe_u32 v31, v0, 5, 1
  v_lshl_add_u32 v4, v31, 8, v4
  v_bfe_u32 v31, v0, 2, 1
  v_lshl_add_u32 v4, v31, 10, v4
  v_bfe_u32 v31, v0, 3, 1
  v_lshl_add_u32 v4, v31, 7, v4
  v_bfe_u32 v31, v0, 0, 2
  v_lshl_add_u32 v4, v31, 3, v4
  v_add_u32 v4, s91, v4
  v_add_u32 v5, 0x10000, v4
  s_lshl_b32 s97, s34, 2
  s_add_u32 s97, s97, s32
  s_lshl_b32 s98, s97, 14
  s_lshl_b32 s91, s33, 21
  s_add_u32 s98, s98, s91
  s_lshl_b32 s97, s97, 16
  s_lshl_b32 s91, s33, 11
  s_add_u32 s97, s97, s91
  v_mov_b32 v16, 0x0
  v_bfe_u32 v31, v0, 0, 4
  v_lshl_add_u32 v16, v31, 7, v16
  v_bfe_u32 v31, v0, 4, 2
  v_lshl_add_u32 v16, v31, 13, v16
  v_add_u32 v17, 0x8000, v16
  v_lshlrev_b32 v18, 7, v0
  v_add_u32 v19, 0x2000, v18
  s_lshl_b32 s58, s33, 5
  s_add_u32 s58, s58, s34
  s_lshl_b32 s59, s32, 19
  s_add_u32 s59, s59, 0x3800000
  s_lshl_b32 s90, s58, 11
  s_add_u32 s90, s90, s59
  s_mul_i32 s91, s58, 3072
  s_add_u32 s91, s91, s59
  s_add_u32 s91, s91, 0x200000
  v_lshlrev_b32 v6, 4, v0
  v_mov_b32 v8, -1
  v_mov_b32 v12, 0
  v_mov_b32 v9, -1
  v_mov_b32 v13, 0
  v_mov_b32 v10, -1
  v_mov_b32 v14, 0
  v_mov_b32 v11, -1
  v_mov_b32 v15, 0
  buffer_store_dwordx4 v[8:11], v6, s[4:7], s90 offen offset:0 sc1
  buffer_store_dwordx4 v[8:11], v6, s[4:7], s90 offen offset:1024 sc1
  buffer_store_dwordx4 v[8:11], v6, s[4:7], s91 offen offset:0 sc1
  buffer_store_dwordx4 v[8:11], v6, s[4:7], s91 offen offset:1024 sc1
  buffer_store_dwordx4 v[8:11], v6, s[4:7], s91 offen offset:2048 sc1
  s_lshl_b32 s58, s58, 2
  s_add_u32 s58, s58, s32
  s_cmp_ge_u32 s58, 24
  s_cbranch_scc1 FL_nz_1
  s_lshl_b32 s90, s58, 10
  s_add_u32 s90, s90, 0x3d00000
  buffer_store_dwordx4 v[12:15], v6, s[4:7], s90 offen sc1
FL_nz_1:
  s_cmp_lg_u32 s58, 3
  s_cbranch_scc1 FL_np_2
  v_mov_b32 v6, 0x3840000
  v_bfe_u32 v31, v0, 0, 1
  v_lshl_add_u32 v6, v31, 13, v6
  v_bfe_u32 v31, v0, 1, 1
  s_mov_b32 s99, 4352
  v_mad_u32_u24 v6, v31, s99, v6
  v_bfe_u32 v31, v0, 2, 2
  s_mov_b32 s99, 82432
  v_mad_u32_u24 v6, v31, s99, v6
  v_mov_b32 v7, -1
  s_mov_b64 exec, 0xffff
  buffer_store_dword v7, v6, s[4:7], 0 offen sc1
  s_mov_b64 exec, -1
  s_waitcnt vmcnt(0)
FL_np_2:
  s_add_u32 m0, s96, 0
  s_mov_b32 s90, 0x0
  buffer_load_dwordx4 v1, s[12:15], s90 offen  lds
  s_add_u32 m0, s96, 1024
  s_mov_b32 s90, 0x10000
  buffer_load_dwordx4 v1, s[12:15], s90 offen  lds
  s_add_u32 m0, s96, 2048
  s_mov_b32 s90, 0x20000
  buffer_load_dwordx4 v1, s[12:15], s90 offen  lds
  s_add_u32 m0, s96, 3072
  s_mov_b32 s90, 0x30000
  buffer_load_dwordx4 v1, s[12:15], s90 offen  lds
  s_add_u32 m0, s96, 4096
  s_mov_b32 s90, 0x0
  buffer_load_dwordx4 v1, s[16:19], s90 offen  lds
  s_add_u32 m0, s96, 5120
  s_mov_b32 s90, 0x10000
  buffer_load_dwordx4 v1, s[16:19], s90 offen  lds
  s_add_u32 m0, s96, 6144
  s_mov_b32 s90, 0x20000
  buffer_load_dwordx4 v1, s[16:19], s90 offen  lds
  s_add_u32 m0, s96, 7168
  s_mov_b32 s90, 0x30000
  buffer_load_dwordx4 v1, s[16:19], s90 offen  lds
  s_add_u32 m0, s96, 8192
  s_mov_b32 s90, 0x40000
  buffer_load_dwordx4 v1, s[12:15], s90 offen  lds
  s_add_u32 m0, s96, 9216
  s_mov_b32 s90, 0x50000
  buffer_load_dwordx4 v1, s[12:15], s90 offen  lds
  s_add_u32 m0, s96, 10240
  s_mov_b32 s90, 0x60000
  buffer_load_dwordx4 v1, s[12:15], s90 offen  lds
  s_add_u32 m0, s96, 11264
  s_mov_b32 s90, 0x70000
  buffer_load_dwordx4 v1, s[12:15], s90 offen  lds
  s_add_u32 m0, s96, 12288
  s_mov_b32 s90, 0x40000
  buffer_load_dwordx4 v1, s[16:19], s90 offen  lds
  s_add_u32 m0, s96, 13312
  s_mov_b32 s90, 0x50000
  buffer_load_dwordx4 v1, s[16:19], s90 offen  lds
  s_add_u32 m0, s96, 14336
  s_mov_b32 s90, 0x60000
  buffer_load_dwordx4 v1, s[16:19], s90 offen  lds
  s_add_u32 m0, s96, 15360
  s_mov_b32 s90, 0x70000
  buffer_load_dwordx4 v1, s[16:19], s90 offen  lds
  s_add_u32 m0, s96, 16384
  s_mov_b32 s90, 0x80000
  buffer_load_dwordx4 v1, s[12:15], s90 offen  lds
  s_add_u32 m0, s96, 17408
  s_mov_b32 s90, 0x90000
  buffer_load_dwordx4 v1, s[12:15], s90 offen  lds
  s_add_u32 m0, s96, 18432
  s_mov_b32 s90, 0xa0000
  buffer_load_dwordx4 v1, s[12:15], s90 offen  lds
  s_add_u32 m0, s96, 19456
  s_mov_b32 s90, 0xb0000
  buffer_load_dwordx4 v1, s[12:15], s90 offen  lds
  s_add_u32 m0, s96, 20480
  s_mov_b32 s90, 0x80000
  buffer_load_dwordx4 v1, s[16:19], s90 offen  lds
  s_add_u32 m0, s96, 21504
  s_mov_b32 s90, 0x90000
  buffer_load_dwordx4 v1, s[16:19], s90 offen  lds
  s_add_u32 m0, s96, 22528
  s_mov_b32 s90, 0xa0000
  buffer_load_dwordx4 v1, s[16:19], s90 offen  lds
  s_add_u32 m0, s96, 23552
  s_mov_b32 s90, 0xb0000
  buffer_load_dwordx4 v1, s[16:19], s90 offen  lds
  s_add_u32 m0, s96, 24576
  s_mov_b32 s90, 0xc0000
  buffer_load_dwordx4 v1, s[12:15], s90 offen  lds
  s_add_u32 m0, s96, 25600
  s_mov_b32 s90, 0xd0000
  buffer_load_dwordx4 v1, s[12:15], s90 offen  lds
  s_add_u32 m0, s96, 26624
  s_mov_b32 s90, 0xe0000
  buffer_load_dwordx4 v1, s[12:15], s90 offen  lds
  s_add_u32 m0, s96, 27648
  s_mov_b32 s90, 0xf0000
  buffer_load_dwordx4 v1, s[12:15], s90 offen  lds
  s_add_u32 m0, s96, 28672
  s_mov_b32 s90, 0xc0000
  buffer_load_dwordx4 v1, s[16:19], s90 offen  lds
  s_add_u32 m0, s96, 29696
  s_mov_b32 s90, 0xd0000
  buffer_load_dwordx4 v1, s[16:19], s90 offen  lds
  s_add_u32 m0, s96, 30720
  s_mov_b32 s90, 0xe0000
  buffer_load_dwordx4 v1, s[16:19], s90 offen  lds
  s_add_u32 m0, s96, 31744
  s_mov_b32 s90, 0xf0000
  buffer_load_dwordx4 v1, s[16:19], s90 offen  lds
  s_cmp_lg_u32 s58, 3
  s_cbranch_scc1 FL_np_3
  s_add_u32 s92, s94, 0x3840000
  s_addc_u32 s93, s95, 0
  s_mov_b32 s62, -1
  s_mov_b32 s63, -1
  s_memtime s[56:57]
  s_waitcnt lgkmcnt(0)
  s_load_dword s60, s[92:93], 0x0
  s_waitcnt lgkmcnt(0)
  s_memtime s[58:59]
  s_waitcnt lgkmcnt(0)
  s_sub_u32 s58, s58, s56
  s_min_u32 s62, s62, s58
  s_memtime s[56:57]
  s_waitcnt lgkmcnt(0)
  s_load_dword s60, s[92:93], 0x2000
  s_waitcnt lgkmcnt(0)
  s_memtime s[58:59]
  s_waitcnt lgkmcnt(0)
  s_sub_u32 s58, s58, s56
  s_min_u32 s63, s63, s58
  s_memtime s[56:57]
  s_waitcnt lgkmcnt(0)
  s_load_dword s60, s[92:93], 0x1100
  s_waitcnt lgkmcnt(0)
  s_memtime s[58:59]
  s_waitcnt lgkmcnt(0)
  s_sub_u32 s58, s58, s56
  s_min_u32 s62, s62, s58
  s_memtime s[56:57]
  s_waitcnt lgkmcnt(0)
  s_load_dword s60, s[92:93], 0x3100
  s_waitcnt lgkmcnt(0)
  s_memtime s[58:59]
  s_waitcnt lgkmcnt(0)
  s_sub_u32 s58, s58, s56
  s_min_u32 s63, s63, s58
  s_memtime s[56:57]
  s_waitcnt lgkmcnt(0)
  s_load_dword s60, s[92:93], 0x14200
  s_waitcnt lgkmcnt(0)
  s_memtime s[58:59]
  s_waitcnt lgkmcnt(0)
  s_sub_u32 s58, s58, s56
  s_min_u32 s62, s62, s58
  s_memtime s[56:57]
  s_waitcnt lgkmcnt(0)
  s_load_dword s60, s[92:93], 0x16200
  s_waitcnt lgkmcnt(0)
  s_memtime s[58:59]
  s_waitcnt lgkmcnt(0)
  s_sub_u32 s58, s58, s56
  s_min_u32 s63, s63, s58
  s_memtime s[56:57]
  s_waitcnt lgkmcnt(0)
  s_load_dword s60, s[92:93], 0x15300
  s_waitcnt lgkmcnt(0)
  s_memtime s[58:59]
  s_waitcnt lgkmcnt(0)
  s_sub_u32 s58, s58, s56
  s_min_u32 s62, s62, s58
  s_memtime s[56:57]
  s_waitcnt lgkmcnt(0)
  s_load_dword s60, s[92:93], 0x17300
  s_waitcnt lgkmcnt(0)
  s_memtime s[58:59]
  s_waitcnt lgkmcnt(0)
  s_sub_u32 s58, s58, s56
  s_min_u32 s63, s63, s58
  s_cmp_lt_u32 s63, s62
  s_cselect_b32 s60, 2, 1
  v_mov_b32 v6, s60
  v_mov_b32 v7, s62
  v_mov_b32 v8, s63
  v_mov_b32 v9, 0
  s_mov_b64 exec, 1
  buffer_store_dword v6, v9, s[28:31], 0 offen offset:128 sc1
  s_mov_b64 exec, -1
FL_np_3:
  s_waitcnt vmcnt(32)
  s_barrier
  s_cmp_lg_u32 s32, 0
  s_cbranch_scc1 FL_sig_4
  v_mov_b32 v254, 1
  v_mov_b32 v255, 0
  s_mov_b64 exec, 1
  buffer_atomic_add v254, v255, s[28:31], s100 offen offset:132 sc1
  s_mov_b64 exec, -1
FL_sig_4:
  s_waitcnt vmcnt(28)
  ds_read_b64_tr_b16 a[16:17], v3 offset:0
  ds_read_b64_tr_b16 a[18:19], v3 offset:512
  ds_read_b64_tr_b16 a[24:25], v3 offset:32
  ds_read_b64_tr_b16 a[26:27], v3 offset:544
  s_waitcnt lgkmcnt(0)
  s_add_u32 m0, s96, 0
  s_mov_b32 s90, 0x100000
  buffer_load_dwordx4 v1, s[12:15], s90 offen  lds
  s_add_u32 m0, s96, 1024
  s_mov_b32 s90, 0x110000
  buffer_load_dwordx4 v1, s[12:15], s90 offen  lds
  s_add_u32 m0, s96, 2048
  s_mov_b32 s90, 0x120000
  buffer_load_dwordx4 v1, s[12:15], s90 offen  lds
  s_add_u32 m0, s96, 3072
  s_mov_b32 s90, 0x130000
  buffer_load_dwordx4 v1, s[12:15], s90 offen  lds
  s_waitcnt vmcnt(28)
  ds_read_b64_tr_b16 a[32:33], v3 offset:4096
  ds_read_b64_tr_b16 a[34:35], v3 offset:4608
  ds_read_b64_tr_b16 a[40:41], v3 offset:4128
  ds_read_b64_tr_b16 a[42:43], v3 offset:4640
  s_waitcnt lgkmcnt(0)
  s_add_u32 m0, s96, 4096
  s_mov_b32 s90, 0x100000
  buffer_load_dwordx4 v1, s[16:19], s90 offen  lds
  s_add_u32 m0, s96, 5120
  s_mov_b32 s90, 0x110000
  buffer_load_dwordx4 v1, s[16:19], s90 offen  lds
  s_add_u32 m0, s96, 6144
  s_mov_b32 s90, 0x120000
  buffer_load_dwordx4 v1, s[16:19], s90 offen  lds
  s_add_u32 m0, s96, 7168
  s_mov_b32 s90, 0x130000
  buffer_load_dwordx4 v1, s[16:19], s90 offen  lds
  s_waitcnt vmcnt(28)
  ds_read_b64_tr_b16 a[20:21], v3 offset:8192
  ds_read_b64_tr_b16 a[22:23], v3 offset:8704
  ds_read_b64_tr_b16 a[28:29], v3 offset:8224
  ds_read_b64_tr_b16 a[30:31], v3 offset:8736
  s_waitcnt lgkmcnt(0)
  s_add_u32 m0, s96, 8192
  s_mov_b32 s90, 0x140000
  buffer_load_dwordx4 v1, s[12:15], s90 offen  lds
  s_add_u32 m0, s96, 9216
  s_mov_b32 s90, 0x150000
  buffer_load_dwordx4 v1, s[12:15], s90 offen  lds
  s_add_u32 m0, s96, 10240
  s_mov_b32 s90, 0x160000
  buffer_load_dwordx4 v1, s[12:15], s90 offen  lds
  s_add_u32 m0, s96, 11264
  s_mov_b32 s90, 0x170000
  buffer_load_dwordx4 v1, s[12:15], s90 offen  lds
  s_waitcnt vmcnt(28)
  ds_read_b64_tr_b16 a[36:37], v3 offset:12288
  ds_read_b64_tr_b16 a[38:39], v3 offset:12800
  ds_read_b64_tr_b16 a[44:45], v3 offset:12320
  ds_read_b64_tr_b16 a[46:47], v3 offset:12832
  s_waitcnt lgkmcnt(0)
  s_add_u32 m0, s96, 12288
  s_mov_b32 s90, 0x140000
  buffer_load_dwordx4 v1, s[16:19], s90 offen  lds
  s_add_u32 m0, s96, 13312
  s_mov_b32 s90, 0x150000
  buffer_load_dwordx4 v1, s[16:19], s90 offen  lds
  s_add_u32 m0, s96, 14336
  s_mov_b32 s90, 0x160000
  buffer_load_dwordx4 v1, s[16:19], s90 offen  lds
  s_add_u32 m0, s96, 15360
  s_mov_b32 s90, 0x170000
  buffer_load_dwordx4 v1, s[16:19], s90 offen  lds
  s_waitcnt vmcnt(28)
  ds_read_b64_tr_b16 a[64:65], v3 offset:16384
  ds_read_b64_tr_b16 a[66:67], v3 offset:16896
  ds_read_b64_tr_b16 a[72:73], v3 offset:16416
  ds_read_b64_tr_b16 a[74:75], v3 offset:16928
  s_waitcnt lgkmcnt(0)
  s_add_u32 m0, s96, 16384
  s_mov_b32 s90, 0x180000
  buffer_load_dwordx4 v1, s[12:15], s90 offen  lds
  s_add_u32 m0, s96, 17408
  s_mov_b32 s90, 0x190000
  buffer_load_dwordx4 v1, s[12:15], s90 offen  lds
  s_add_u32 m0, s96, 18432
  s_mov_b32 s90, 0x1a0000
  buffer_load_dwordx4 v1, s[12:15], s90 offen  lds
  s_add_u32 m0, s96, 19456
  s_mov_b32 s90, 0x1b0000
  buffer_load_dwordx4 v1, s[12:15], s90 offen  lds
  s_waitcnt vmcnt(28)
  ds_read_b64_tr_b16 a[80:81], v3 offset:20480
  ds_read_b64_tr_b16 a[82:83], v3 offset:20992
  ds_read_b64_tr_b16 a[88:89], v3 offset:20512
  ds_read_b64_tr_b16 a[90:91], v3 offset:21024
  s_waitcnt lgkmcnt(0)
  s_add_u32 m0, s96, 20480
  s_mov_b32 s90, 0x180000
  buffer_load_dwordx4 v1, s[16:19], s90 offen  lds
  s_add_u32 m0, s96, 21504
  s_mov_b32 s90, 0x190000
  buffer_load_dwordx4 v1, s[16:19], s90 offen  lds
  s_add_u32 m0, s96, 22528
  s_mov_b32 s90, 0x1a0000
  buffer_load_dwordx4 v1, s[16:19], s90 offen  lds
  s_add_u32 m0, s96, 23552
  s_mov_b32 s90, 0x1b0000
  buffer_load_dwordx4 v1, s[16:19], s90 offen  lds
  s_waitcnt vmcnt(28)
  ds_read_b64_tr_b16 a[68:69], v3 offset:24576
  ds_read_b64_tr_b16 a[70:71], v3 offset:25088
  ds_read_b64_tr_b16 a[76:77], v3 offset:24608
  ds_read_b64_tr_b16 a[78:79], v3 offset:25120
  s_waitcnt lgkmcnt(0)
  s_add_u32 m0, s96, 24576
  s_mov_b32 s90, 0x1c0000
  buffer_load_dwordx4 v1, s[12:15], s90 offen  lds
  s_add_u32 m0, s96, 25600
  s_mov_b32 s90, 0x1d0000
  buffer_load_dwordx4 v1, s[12:15], s90 offen  lds
  s_add_u32 m0, s96, 26624
  s_mov_b32 s90, 0x1e0000
  buffer_load_dwordx4 v1, s[12:15], s90 offen  lds
  s_add_u32 m0, s96, 27648
  s_mov_b32 s90, 0x1f0000
  buffer_load_dwordx4 v1, s[12:15], s90 offen  lds
  s_waitcnt vmcnt(28)
  ds_read_b64_tr_b16 a[84:85], v3 offset:28672
  ds_read_b64_tr_b16 a[86:87], v3 offset:29184
  ds_read_b64_tr_b16 a[92:93], v3 offset:28704
  ds_read_b64_tr_b16 a[94:95], v3 offset:29216
  s_waitcnt lgkmcnt(0)
  s_add_u32 m0, s96, 28672
  s_mov_b32 s90, 0x1c0000
  buffer_load_dwordx4 v1, s[16:19], s90 offen  lds
  s_add_u32 m0, s96, 29696
  s_mov_b32 s90, 0x1d0000
  buffer_load_dwordx4 v1, s[16:19], s90 offen  lds
  s_add_u32 m0, s96, 30720
  s_mov_b32 s90, 0x1e0000
  buffer_load_dwordx4 v1, s[16:19], s90 offen  lds
  s_add_u32 m0, s96, 31744
  s_mov_b32 s90, 0x1f0000
  buffer_load_dwordx4 v1, s[16:19], s90 offen  lds
  s_waitcnt vmcnt(28)
  ds_read_b64_tr_b16 a[112:113], v3 offset:0
  ds_read_b64_tr_b16 a[114:115], v3 offset:512
  ds_read_b64_tr_b16 a[120:121], v3 offset:32
  ds_read_b64_tr_b16 a[122:123], v3 offset:544
  s_waitcnt lgkmcnt(0)
  s_add_u32 m0, s96, 0
  s_mov_b32 s90, 0x0
  buffer_load_dwordx4 v1, s[8:11], s90 offen  lds
  s_add_u32 m0, s96, 1024
  s_mov_b32 s90, 0x10000
  buffer_load_dwordx4 v1, s[8:11], s90 offen  lds
  s_add_u32 m0, s96, 2048
  s_mov_b32 s90, 0x20000
  buffer_load_dwordx4 v1, s[8:11], s90 offen  lds
  s_add_u32 m0, s96, 3072
  s_mov_b32 s90, 0x30000
  buffer_load_dwordx4 v1, s[8:11], s90 offen  lds
  s_waitcnt vmcnt(28)
  ds_read_b64_tr_b16 a[128:129], v3 offset:4096
  ds_read_b64_tr_b16 a[130:131], v3 offset:4608
  ds_read_b64_tr_b16 a[136:137], v3 offset:4128
  ds_read_b64_tr_b16 a[138:139], v3 offset:4640
  s_waitcnt lgkmcnt(0)
  s_add_u32 m0, s96, 4096
  s_mov_b32 s90, 0x40000
  buffer_load_dwordx4 v1, s[8:11], s90 offen  lds
  s_add_u32 m0, s96, 5120
  s_mov_b32 s90, 0x50000
  buffer_load_dwordx4 v1, s[8:11], s90 offen  lds
  s_add_u32 m0, s96, 6144
  s_mov_b32 s90, 0x60000
  buffer_load_dwordx4 v1, s[8:11], s90 offen  lds
  s_add_u32 m0, s96, 7168
  s_mov_b32 s90, 0x70000
  buffer_load_dwordx4 v1, s[8:11], s90 offen  lds
  s_waitcnt vmcnt(28)
  ds_read_b64_tr_b16 a[116:117], v3 offset:8192
  ds_read_b64_tr_b16 a[118:119], v3 offset:8704
  ds_read_b64_tr_b16 a[124:125], v3 offset:8224
  ds_read_b64_tr_b16 a[126:127], v3 offset:8736
  s_waitcnt lgkmcnt(0)
  s_add_u32 m0, s96, 8192
  s_mov_b32 s90, 0x80000
  buffer_load_dwordx4 v1, s[8:11], s90 offen  lds
  s_add_u32 m0, s96, 9216
  s_mov_b32 s90, 0x90000
  buffer_load_dwordx4 v1, s[8:11], s90 offen  lds
  s_add_u32 m0, s96, 10240
  s_mov_b32 s90, 0xa0000
  buffer_load_dwordx4 v1, s[8:11], s90 offen  lds
  s_add_u32 m0, s96, 11264
  s_mov_b32 s90, 0xb0000
  buffer_load_dwordx4 v1, s[8:11], s90 offen  lds
  s_waitcnt vmcnt(28)
  ds_read_b64_tr_b16 a[132:133], v3 offset:12288
  ds_read_b64_tr_b16 a[134:135], v3 offset:12800
  ds_read_b64_tr_b16 a[140:141], v3 offset:12320
  ds_read_b64_tr_b16 a[142:143], v3 offset:12832
  s_waitcnt lgkmcnt(0)
  s_add_u32 m0, s96, 12288
  s_mov_b32 s90, 0xc0000
  buffer_load_dwordx4 v1, s[8:11], s90 offen  lds
  s_add_u32 m0, s96, 13312
  s_mov_b32 s90, 0xd0000
  buffer_load_dwordx4 v1, s[8:11], s90 offen  lds
  s_add_u32 m0, s96, 14336
  s_mov_b32 s90, 0xe0000
  buffer_load_dwordx4 v1, s[8:11], s90 offen  lds
  s_add_u32 m0, s96, 15360
  s_mov_b32 s90, 0xf0000
  buffer_load_dwordx4 v1, s[8:11], s90 offen  lds
  s_waitcnt vmcnt(28)
  ds_read_b64_tr_b16 a[160:161], v3 offset:16384
  ds_read_b64_tr_b16 a[162:163], v3 offset:16896
  ds_read_b64_tr_b16 a[168:169], v3 offset:16416
  ds_read_b64_tr_b16 a[170:171], v3 offset:16928
  s_waitcnt lgkmcnt(0)
  s_add_u32 m0, s96, 16384
  s_mov_b32 s90, 0x100000
  buffer_load_dwordx4 v1, s[8:11], s90 offen  lds
  s_add_u32 m0, s96, 17408
  s_mov_b32 s90, 0x110000
  buffer_load_dwordx4 v1, s[8:11], s90 offen  lds
  s_add_u32 m0, s96, 18432
  s_mov_b32 s90, 0x120000
  buffer_load_dwordx4 v1, s[8:11], s90 offen  lds
  s_add_u32 m0, s96, 19456
  s_mov_b32 s90, 0x130000
  buffer_load_dwordx4 v1, s[8:11], s90 offen  lds
  s_waitcnt vmcnt(28)
  ds_read_b64_tr_b16 a[176:177], v3 offset:20480
  ds_read_b64_tr_b16 a[178:179], v3 offset:20992
  ds_read_b64_tr_b16 a[184:185], v3 offset:20512
  ds_read_b64_tr_b16 a[186:187], v3 offset:21024
  s_waitcnt lgkmcnt(0)
  s_add_u32 m0, s96, 20480
  s_mov_b32 s90, 0x140000
  buffer_load_dwordx4 v1, s[8:11], s90 offen  lds
  s_add_u32 m0, s96, 21504
  s_mov_b32 s90, 0x150000
  buffer_load_dwordx4 v1, s[8:11], s90 offen  lds
  s_add_u32 m0, s96, 22528
  s_mov_b32 s90, 0x160000
  buffer_load_dwordx4 v1, s[8:11], s90 offen  lds
  s_add_u32 m0, s96, 23552
  s_mov_b32 s90, 0x170000
  buffer_load_dwordx4 v1, s[8:11], s90 offen  lds
  s_waitcnt vmcnt(28)
  ds_read_b64_tr_b16 a[164:165], v3 offset:24576
  ds_read_b64_tr_b16 a[166:167], v3 offset:25088
  ds_read_b64_tr_b16 a[172:173], v3 offset:24608
  ds_read_b64_tr_b16 a[174:175], v3 offset:25120
  s_waitcnt lgkmcnt(0)
  s_add_u32 m0, s96, 24576
  s_mov_b32 s90, 0x180000
  buffer_load_dwordx4 v1, s[8:11], s90 offen  lds
  s_add_u32 m0, s96, 25600
  s_mov_b32 s90, 0x190000
  buffer_load_dwordx4 v1, s[8:11], s90 offen  lds
  s_add_u32 m0, s96, 26624
  s_mov_b32 s90, 0x1a0000
  buffer_load_dwordx4 v1, s[8:11], s90 offen  lds
  s_add_u32 m0, s96, 27648
  s_mov_b32 s90, 0x1b0000
  buffer_load_dwordx4 v1, s[8:11], s90 offen  lds
  s_waitcnt vmcnt(28)
  ds_read_b64_tr_b16 a[180:181], v3 offset:28672
  ds_read_b64_tr_b16 a[182:183], v3 offset:29184
  ds_read_b64_tr_b16 a[188:189], v3 offset:28704
  ds_read_b64_tr_b16 a[190:191], v3 offset:29216
  s_waitcnt lgkmcnt(0)
  s_add_u32 m0, s96, 28672
  s_mov_b32 s90, 0x1c0000
  buffer_load_dwordx4 v1, s[8:11], s90 offen  lds
  s_add_u32 m0, s96, 29696
  s_mov_b32 s90, 0x1d0000
  buffer_load_dwordx4 v1, s[8:11], s90 offen  lds
  s_add_u32 m0, s96, 30720
  s_mov_b32 s90, 0x1e0000
  buffer_load_dwordx4 v1, s[8:11], s90 offen  lds
  s_add_u32 m0, s96, 31744
  s_mov_b32 s90, 0x1f0000
  buffer_load_dwordx4 v1, s[8:11], s90 offen  lds
  s_waitcnt vmcnt(28)
  ds_read_b64_tr_b16 a[0:1], v3 offset:0
  ds_read_b64_tr_b16 a[2:3], v3 offset:512
  ds_read_b64_tr_b16 a[8:9], v3 offset:32
  ds_read_b64_tr_b16 a[10:11], v3 offset:544
  s_waitcnt lgkmcnt(0)
  s_add_u32 m0, s96, 0
  s_mov_b32 s90, 0x0
  buffer_load_dwordx4 v2, s[20:23], s90 offen  lds
  s_add_u32 m0, s96, 1024
  s_mov_b32 s90, 0x4000
  buffer_load_dwordx4 v2, s[20:23], s90 offen  lds
  s_add_u32 m0, s96, 2048
  s_mov_b32 s90, 0x8000
  buffer_load_dwordx4 v2, s[20:23], s90 offen  lds
  s_add_u32 m0, s96, 3072
  s_mov_b32 s90, 0xc000
  buffer_load_dwordx4 v2, s[20:23], s90 offen  lds
  s_waitcnt vmcnt(28)
  ds_read_b64_tr_b16 a[4:5], v3 offset:4096
  ds_read_b64_tr_b16 a[6:7], v3 offset:4608
  ds_read_b64_tr_b16 a[12:13], v3 offset:4128
  ds_read_b64_tr_b16 a[14:15], v3 offset:4640
  s_waitcnt lgkmcnt(0)
  s_add_u32 m0, s96, 4096
  s_mov_b32 s90, 0x10000
  buffer_load_dwordx4 v2, s[20:23], s90 offen  lds
  s_add_u32 m0, s96, 5120
  s_mov_b32 s90, 0x14000
  buffer_load_dwordx4 v2, s[20:23], s90 offen  lds
  s_add_u32 m0, s96, 6144
  s_mov_b32 s90, 0x18000
  buffer_load_dwordx4 v2, s[20:23], s90 offen  lds
  s_add_u32 m0, s96, 7168
  s_mov_b32 s90, 0x1c000
  buffer_load_dwordx4 v2, s[20:23], s90 offen  lds
  s_waitcnt vmcnt(28)
  ds_read_b64_tr_b16 a[48:49], v3 offset:8192
  ds_read_b64_tr_b16 a[50:51], v3 offset:8704
  ds_read_b64_tr_b16 a[56:57], v3 offset:8224
  ds_read_b64_tr_b16 a[58:59], v3 offset:8736
  s_waitcnt lgkmcnt(0)
  s_add_u32 m0, s96, 8192
  s_mov_b32 s90, 0x20000
  buffer_load_dwordx4 v2, s[20:23], s90 offen  lds
  s_add_u32 m0, s96, 9216
  s_mov_b32 s90, 0x24000
  buffer_load_dwordx4 v2, s[20:23], s90 offen  lds
  s_add_u32 m0, s96, 10240
  s_mov_b32 s90, 0x28000
  buffer_load_dwordx4 v2, s[20:23], s90 offen  lds
  s_add_u32 m0, s96, 11264
  s_mov_b32 s90, 0x2c000
  buffer_load_dwordx4 v2, s[20:23], s90 offen  lds
  s_waitcnt vmcnt(28)
  ds_read_b64_tr_b16 a[52:53], v3 offset:12288
  ds_read_b64_tr_b16 a[54:55], v3 offset:12800
  ds_read_b64_tr_b16 a[60:61], v3 offset:12320
  ds_read_b64_tr_b16 a[62:63], v3 offset:12832
  s_waitcnt lgkmcnt(0)
  s_add_u32 m0, s96, 12288
  s_mov_b32 s90, 0x30000
  buffer_load_dwordx4 v2, s[20:23], s90 offen  lds
  s_add_u32 m0, s96, 13312
  s_mov_b32 s90, 0x34000
  buffer_load_dwordx4 v2, s[20:23], s90 offen  lds
  s_add_u32 m0, s96, 14336
  s_mov_b32 s90, 0x38000
  buffer_load_dwordx4 v2, s[20:23], s90 offen  lds
  s_add_u32 m0, s96, 15360
  s_mov_b32 s90, 0x3c000
  buffer_load_dwordx4 v2, s[20:23], s90 offen  lds
  s_waitcnt vmcnt(28)
  ds_read_b64_tr_b16 a[96:97], v3 offset:16384
  ds_read_b64_tr_b16 a[98:99], v3 offset:16896
  ds_read_b64_tr_b16 a[104:105], v3 offset:16416
  ds_read_b64_tr_b16 a[106:107], v3 offset:16928
  s_waitcnt vmcnt(24)
  ds_read_b64_tr_b16 a[100:101], v3 offset:20480
  ds_read_b64_tr_b16 a[102:103], v3 offset:20992
  ds_read_b64_tr_b16 a[108:109], v3 offset:20512
  ds_read_b64_tr_b16 a[110:111], v3 offset:21024
  s_waitcnt vmcnt(20)
  ds_read_b64_tr_b16 a[144:145], v3 offset:24576
  ds_read_b64_tr_b16 a[146:147], v3 offset:25088
  ds_read_b64_tr_b16 a[152:153], v3 offset:24608
  ds_read_b64_tr_b16 a[154:155], v3 offset:25120
  s_waitcnt vmcnt(16)
  ds_read_b64_tr_b16 a[148:149], v3 offset:28672
  ds_read_b64_tr_b16 a[150:151], v3 offset:29184
  ds_read_b64_tr_b16 a[156:157], v3 offset:28704
  ds_read_b64_tr_b16 a[158:159], v3 offset:29216
  s_waitcnt vmcnt(0)
  s_barrier
  ds_read_b64_tr_b16 a[192:193], v4 offset:0
  ds_read_b64_tr_b16 a[194:195], v4 offset:2048
  ds_read_b64_tr_b16 a[196:197], v4 offset:512
  ds_read_b64_tr_b16 a[198:199], v4 offset:2560
  ds_read_b64_tr_b16 a[200:201], v4 offset:4096
  ds_read_b64_tr_b16 a[202:203], v4 offset:6144
  ds_read_b64_tr_b16 a[204:205], v4 offset:4608
  ds_read_b64_tr_b16 a[206:207], v4 offset:6656
  s_waitcnt lgkmcnt(0)
  ds_read_b64_tr_b16 a[208:209], v4 offset:32768
  ds_read_b64_tr_b16 a[210:211], v4 offset:34816
  ds_read_b64_tr_b16 a[212:213], v4 offset:33280
  ds_read_b64_tr_b16 a[214:215], v4 offset:35328
  ds_read_b64_tr_b16 a[216:217], v4 offset:36864
  ds_read_b64_tr_b16 a[218:219], v4 offset:38912
  ds_read_b64_tr_b16 a[220:221], v4 offset:37376
  ds_read_b64_tr_b16 a[222:223], v4 offset:39424
  s_waitcnt lgkmcnt(0)
  ds_read_b64_tr_b16 a[224:225], v5 offset:0
  ds_read_b64_tr_b16 a[226:227], v5 offset:2048
  ds_read_b64_tr_b16 a[228:229], v5 offset:512
  ds_read_b64_tr_b16 a[230:231], v5 offset:2560
  ds_read_b64_tr_b16 a[232:233], v5 offset:4096
  ds_read_b64_tr_b16 a[234:235], v5 offset:6144
  ds_read_b64_tr_b16 a[236:237], v5 offset:4608
  ds_read_b64_tr_b16 a[238:239], v5 offset:6656
  s_waitcnt lgkmcnt(0)
  ds_read_b64_tr_b16 a[240:241], v5 offset:32768
  ds_read_b64_tr_b16 a[242:243], v5 offset:34816
  ds_read_b64_tr_b16 a[244:245], v5 offset:33280
  ds_read_b64_tr_b16 a[246:247], v5 offset:35328
  ds_read_b64_tr_b16 a[248:249], v5 offset:36864
  ds_read_b64_tr_b16 a[250:251], v5 offset:38912
  ds_read_b64_tr_b16 a[252:253], v5 offset:37376
  ds_read_b64_tr_b16 a[254:255], v5 offset:39424
  s_waitcnt lgkmcnt(0)
  s_barrier
  s_mov_b32 s46, 0
  s_cmp_lg_u32 s32, 0
  s_cbranch_scc1 FL_vd_6
  v_mbcnt_lo_u32_b32 v250, -1, 0
  v_mbcnt_hi_u32_b32 v250, -1, v250
  v_lshlrev_b32 v250, 2, v250
  s_cmp_lg_u32 s100, 0
  s_cbranch_scc1 FL_vw_5
  v_readfirstlane_b32 s90, v247
  s_and_b32 s90, s90, s101
  s_cbranch_scc0 FL_vw_5
  v_mov_b32 v251, 1
  s_mov_b64 exec, 1
  buffer_store_dword v251, v250, s[28:31], 0 offen offset:32 sc1
  s_mov_b64 exec, -1
FL_vw_5:
  buffer_load_dword v251, v250, s[28:31], 0 offen sc1
  s_waitcnt vmcnt(0)
  v_cmp_eq_u32 vcc, -1, v251
  v_readlane_b32 s91, v251, 8
  v_readlane_b32 s92, v251, 32
  v_readlane_b32 s93, v251, 33
  v_readlane_b32 s90, v251, 34
  s_cmp_lg_u32 s100, 0
  s_cselect_b32 s93, s90, s93
  s_cselect_b32 s91, 0, s91
  s_cselect_b32 s92, 1, s92
  s_cselect_b32 s90, 0xff, vcc_lo
  s_cmp_lg_u32 s91, 0
  s_cselect_b32 s92, 3, s92
  s_cbranch_scc1 FL_vk_7
  s_add_u32 s3, s3, 1
  s_cmp_ge_u32 s3, 131072
  s_cselect_b32 s92, 4, s92
  s_cbranch_scc1 FL_vk_7
  s_sleep 8
  s_and_b32 s90, s90, 0xff
  s_cmp_lg_u32 s90, 0xff
  s_cbranch_scc1 FL_vw_5
  s_cmp_lt_u32 s93, 128
  s_cbranch_scc1 FL_vw_5
  s_cmp_eq_u32 s92, 0
  s_cbranch_scc1 FL_vw_5
FL_vk_7:
  v_mov_b32 v251, s92
  v_mov_b32 v250, 131072
  ds_write_b32 v250, v251
  s_waitcnt lgkmcnt(0)
FL_vd_6:
  s_barrier
  v_mov_b32 v250, 131072
  ds_read_b32 v251, v250
  s_waitcnt lgkmcnt(0)
  v_readfirstlane_b32 s92, v251
  s_barrier
  s_cmp_eq_u32 s92, 3
  s_cbranch_scc1 L_fallback
  s_cmp_eq_u32 s92, 4
  s_cbranch_scc1 L_exit
  s_sub_u32 s39, s92, 1
  s_and_b32 s39, s39, 1
  s_lshl_b32 s39, s39, 13
  s_lshl_b32 s90, s34, 2
  s_add_u32 s90, s90, s32
  s_lshr_b32 s91, s90, 3
  s_lshl_b32 s91, s91, 14
  s_and_b32 s92, s90, 7
  s_lshl_b32 s92, s92, 10
  s_add_u32 s91, s91, s92
  s_add_u32 s91, s91, s39
  v_mov_b32 v1, 0x0
  v_bfe_u32 v31, v0, 0, 6
  v_lshl_add_u32 v1, v31, 4, v1
  v_add_u32 v1, s91, v1
  v_lshrrev_b32 v30, 4, v0
  v_cmp_eq_u32 vcc, s33, v30
  v_xor_b32 v29, 0x2000, v1
  s_nop 0
  v_cndmask_b32 v1, v1, v29, vcc
  s_lshl_b32 s91, s33, 14
  s_lshl_b32 s92, s90, 7
  s_add_u32 s91, s91, s92
  v_mov_b32 v2, 0x200000
  v_bfe_u32 v31, v0, 0, 2
  v_lshl_add_u32 v2, v31, 2, v2
  v_bfe_u32 v31, v0, 2, 1
  v_lshl_add_u32 v2, v31, 6, v2
  v_bfe_u32 v31, v0, 4, 1
  v_lshl_add_u32 v2, v31, 4, v2
  v_bfe_u32 v31, v0, 5, 1
  v_lshl_add_u32 v2, v31, 5, v2
  v_bfe_u32 v31, v0, 3, 1
  v_lshl_add_u32 v2, v31, 31, v2
  v_add_u32 v2, s91, v2
  s_lshr_b32 s92, s90, 1
  s_lshl_b32 s92, s92, 5
  s_and_b32 s91, s90, 1
  s_lshl_b32 s91, s91, 13
  s_add_u32 s92, s92, s91
  v_mov_b32 v30, 0x0
  v_bfe_u32 v31, v0, 2, 1
  v_lshl_add_u32 v30, v31, 12, v30
  v_bfe_u32 v31, v0, 4, 1
  v_lshl_add_u32 v30, v31, 11, v30
  v_bfe_u32 v31, v0, 0, 2
  v_lshl_add_u32 v30, v31, 3, v30
  v_bfe_u32 v31, v0, 5, 1
  v_lshl_add_u32 v30, v31, 2, v30
  v_add_u32 v30, s92, v30
  buffer_load_dword v44, v30, s[24:27], 0 offen
  s_lshl_b32 s91, s33, 14
  s_lshl_b32 s92, s32, 12
  s_add_u32 s91, s91, s92
  v_mov_b32 v3, 0x200000
  v_bfe_u32 v31, v0, 0, 6
  v_lshl_add_u32 v3, v31, 4, v3
  v_add_u32 v3, s91, v3
  s_mul_i32 s91, s32, 3264
  v_mov_b32 v4, 0x0
  v_bfe_u32 v31, v0, 0, 6
  v_lshl_add_u32 v4, v31, 4, v4
  v_add_u32 v4, s91, v4
  s_lshl_b32 s91, s32, 6
  v_mov_b32 v6, 0x0
  v_bfe_u32 v31, v0, 0, 2
  v_lshl_add_u32 v6, v31, 4, v6
  v_bfe_u32 v31, v0, 2, 1
  v_lshl_add_u32 v6, v31, 2, v6
  v_bfe_u32 v31, v0, 3, 1
  s_mov_b32 s99, 1088
  v_mad_u32_u24 v6, v31, s99, v6
  v_bfe_u32 v31, v0, 4, 2
  v_lshl_add_u32 v6, v31, 8, v6
  v_add_u32 v6, s91, v6
  v_add_u32 v240, 3264, v6
  v_add_u32 v241, 6528, v6
  v_add_u32 v242, 9792, v6
  s_lshl_b32 s93, s37, 13
  s_lshl_b32 s91, s38, 10
  s_add_u32 s91, s91, s93
  s_lshl_b32 s92, s32, 8
  s_add_u32 s91, s91, s92
  v_mov_b32 v7, 0x210000
  v_bfe_u32 v31, v0, 0, 6
  v_lshl_add_u32 v7, v31, 2, v7
  v_add_u32 v7, s91, v7
  s_lshl_b32 s91, s37, 11
  s_lshl_b32 s92, s38, 9
  s_add_u32 s96, s91, s92
  s_lshl_b32 s92, s32, 7
  s_add_u32 s91, s96, s92
  v_mov_b32 v19, 0x83000000
  v_bfe_u32 v31, v0, 0, 3
  v_lshl_add_u32 v19, v31, 2, v19
  v_bfe_u32 v31, v0, 4, 2
  v_lshl_add_u32 v19, v31, 5, v19
  v_bfe_u32 v31, v0, 3, 1
  v_lshl_add_u32 v19, v31, 31, v19
  v_add_u32 v19, s91, v19
  s_lshl_b32 s91, s32, 8
  v_mov_b32 v5, 0x880
  v_bfe_u32 v31, v0, 0, 1
  v_lshl_add_u32 v5, v31, 7, v5
  v_bfe_u32 v31, v0, 1, 1
  v_lshl_add_u32 v5, v31, 3, v5
  v_bfe_u32 v31, v0, 2, 3
  v_lshl_add_u32 v5, v31, 4, v5
  v_add_u32 v5, s91, v5
  s_lshr_b32 s92, s38, 1
  s_lshl_b32 s92, s92, 10
  s_add_u32 s91, s91, s92
  s_add_u32 s91, s91, s93
  s_and_b32 s92, s38, 1
  s_lshl_b32 s92, s92, 7
  s_add_u32 s91, s91, s92
  v_mov_b32 v8, 0x211000
  v_bfe_u32 v31, v0, 0, 5
  v_lshl_add_u32 v8, v31, 2, v8
  v_bfe_u32 v31, v0, 5, 1
  v_lshl_add_u32 v8, v31, 31, v8
  v_add_u32 v8, s91, v8
  s_sub_u32 s91, s91, s93
  s_lshl_b32 s92, s37, 11
  s_add_u32 s91, s91, s92
  v_mov_b32 v20, 0x3400000
  v_bfe_u32 v31, v0, 0, 5
  v_lshl_add_u32 v20, v31, 2, v20
  v_bfe_u32 v31, v0, 5, 1
  v_lshl_add_u32 v20, v31, 31, v20
  v_add_u32 v20, s91, v20
  s_lshl_b32 s97, s35, 2
  s_add_u32 s97, s97, s32
  s_lshl_b32 s97, s97, 13
  v_mov_b32 v9, 0x210000
  v_bfe_u32 v31, v0, 0, 6
  v_lshl_add_u32 v9, v31, 4, v9
  v_add_u32 v9, s97, v9
  v_add_u32 v10, 4096, v9
  v_mov_b32 v11, 0x1000000
  v_bfe_u32 v31, v0, 0, 2
  v_lshl_add_u32 v11, v31, 4, v11
  v_bfe_u32 v31, v0, 2, 1
  v_lshl_add_u32 v11, v31, 7, v11
  v_bfe_u32 v31, v0, 3, 1
  v_lshl_add_u32 v11, v31, 12, v11
  v_bfe_u32 v31, v0, 4, 2
  v_lshl_add_u32 v11, v31, 8, v11
  v_add_u32 v11, s97, v11
  v_mov_b32 v12, 0x2000000
  v_bfe_u32 v31, v0, 0, 3
  v_lshl_add_u32 v12, v31, 4, v12
  v_bfe_u32 v31, v0, 3, 1
  v_lshl_add_u32 v12, v31, 11, v12
  v_bfe_u32 v31, v0, 4, 2
  v_lshl_add_u32 v12, v31, 8, v12
  v_add_u32 v12, s97, v12
  v_add_u32 v13, 4096, v12
  s_lshl_b32 s91, s36, 9
  s_add_u32 s91, s91, s97
  s_add_u32 s12, s91, 0x1000000
  v_mov_b32 v21, 0x1000000
  v_bfe_u32 v31, v0, 0, 2
  v_lshl_add_u32 v21, v31, 7, v21
  v_bfe_u32 v31, v0, 2, 1
  v_lshl_add_u32 v21, v31, 24, v21
  v_add_u32 v21, s91, v21
  v_cmp_gt_u32 vcc, 8, v0
  v_mov_b32 v30, 0x80000000
  s_nop 0
  v_cndmask_b32 v21, v30, v21, vcc
  s_lshl_b32 s91, s32, 11
  v_mov_b32 v30, 0x0
  v_bfe_u32 v31, v0, 2, 1
  v_lshl_add_u32 v30, v31, 6, v30
  v_bfe_u32 v31, v0, 0, 1
  v_lshl_add_u32 v30, v31, 5, v30
  v_bfe_u32 v31, v0, 1, 1
  v_lshl_add_u32 v30, v31, 4, v30
  v_mov_b32 v29, 0x0
  v_bfe_u32 v31, v0, 4, 2
  v_lshl_add_u32 v29, v31, 5, v29
  v_xor_b32 v30, v30, v29
  v_mov_b32 v14, 0x3400
  v_bfe_u32 v31, v0, 0, 4
  v_lshl_add_u32 v14, v31, 7, v14
  v_add_u32 v14, s91, v14
  v_add_u32 v14, v14, v30
  v_xor_b32 v15, 16, v14
  v_mov_b32 v30, 0x0
  v_bfe_u32 v31, v0, 5, 1
  v_lshl_add_u32 v30, v31, 6, v30
  v_bfe_u32 v31, v0, 1, 1
  v_lshl_add_u32 v30, v31, 5, v30
  v_bfe_u32 v31, v0, 4, 1
  v_lshl_add_u32 v30, v31, 4, v30
  v_mov_b32 v29, 0x0
  v_bfe_u32 v31, v0, 2, 2
  v_lshl_add_u32 v29, v31, 5, v29
  v_bfe_u32 v31, v0, 0, 1
  v_lshl_add_u32 v29, v31, 4, v29
  v_xor_b32 v30, v30, v29
  v_mov_b32 v16, 0x3400
  v_bfe_u32 v31, v0, 4, 2
  v_lshl_add_u32 v16, v31, 8, v16
  v_bfe_u32 v31, v0, 1, 1
  v_lshl_add_u32 v16, v31, 7, v16
  v_add_u32 v16, v16, v30
  s_lshl_b32 s98, s36, 14
  s_lshl_b32 s92, s35, 7
  s_add_u32 s98, s98, s92
  s_add_u32 s98, s98, s39
  s_lshl_b32 s92, s32, 11
  s_add_u32 s91, s98, s92
  v_mov_b32 v17, 0x0
  v_bfe_u32 v31, v0, 0, 5
  v_lshl_add_u32 v17, v31, 2, v17
  v_bfe_u32 v31, v0, 5, 1
  v_lshl_add_u32 v17, v31, 10, v17
  v_add_u32 v17, s91, v17
  v_xor_b32 v18, 0x2000, v17
  s_mov_b32 s48, 0x33333333
  s_mov_b32 s49, 0x33333333
  s_mov_b32 s50, 0xffff0000
  s_mov_b32 s51, 0xffff0000
  s_mov_b32 s52, 0x0000ffff
  s_mov_b32 s53, 0x0000ffff
  s_mov_b32 s54, 0xfffffffe
  s_mov_b32 s47, 0x3e0293ee
  v_mov_b32 v30, 0x4444
  v_mov_b32 v31, 0xeeee
  v_cndmask_b32 v23, v31, v30, s[48:49]
  v_mov_b32 v22, -1
  v_mov_b32 v248, 0x3f803f80
  v_mov_b32 v249, 0x3f803f80
  v_mov_b32 v250, 0x3f803f80
  v_mov_b32 v251, 0x3f803f80
  v_mov_b32 v252, 0x3f803f80
  v_mov_b32 v253, 0x3f803f80
  v_mov_b32 v254, 0x3f803f80
  v_mov_b32 v255, 0x3f803f80
  v_mov_b32 v232, 0
  v_mov_b32 v233, 0
  v_mov_b32 v234, 0
  v_mov_b32 v235, 0
  v_mov_b32 v112, 0
  v_mov_b32 v113, 0
  s_mov_b32 s56, 0xf0f0f0f0
  s_mov_b32 s57, 0xf0f0f0f0
  v_mov_b32 v30, 0x3f80
  v_mov_b32 v31, 1.0
  v_cndmask_b32 v30, v30, v31, s[56:57]
  s_mov_b32 s56, 0x110011
  s_mov_b32 s57, 0x110011
  v_cndmask_b32 v24, 0, v30, s[56:57]
  s_mov_b32 s56, 0x220022
  s_mov_b32 s57, 0x220022
  v_cndmask_b32 v25, 0, v30, s[56:57]
  s_mov_b32 s56, 0x11001100
  s_mov_b32 s57, 0x11001100
  v_cndmask_b32 v26, 0, v30, s[56:57]
  s_mov_b32 s56, 0x22002200
  s_mov_b32 s57, 0x22002200
  v_cndmask_b32 v27, 0, v30, s[56:57]
  s_mov_b32 s40, 0
  s_mov_b32 s41, 0x3800000
  s_mov_b32 s43, 0x3900000
  s_mov_b32 s44, 0
  s_mov_b32 s55, 0x40000
  s_mov_b32 s45, 0
  s_cmp_lg_u32 s32, 0
  s_cbranch_scc1 FL_kv0d
  s_lshl_b32 s90, s33, 7
  s_add_u32 s90, s90, 0x3d01000
  v_mov_b32 v30, s90
FL_kv0:
  buffer_load_dword v31, v30, s[4:7], 0 offen sc1
  s_waitcnt vmcnt(0)
  v_readfirstlane_b32 s90, v31
  s_add_u32 s46, s46, 1
  s_cmp_ge_u32 s46, 131072
  s_cbranch_scc1 FL_rec_abort
  s_sleep 2
  s_cmp_lt_u32 s90, 32
  s_cbranch_scc1 FL_kv0
FL_kv0d:
  s_barrier
  buffer_load_dwordx4 v[180:183], v12, s[4:7], s44 offen offset:0
  buffer_load_dwordx4 v[184:187], v12, s[4:7], s44 offen offset:128
  buffer_load_dwordx4 v[188:191], v12, s[4:7], s44 offen offset:1024
  buffer_load_dwordx4 v[192:195], v12, s[4:7], s44 offen offset:1152
  buffer_load_dwordx4 v[196:199], v13, s[4:7], s44 offen offset:0
  buffer_load_dwordx4 v[200:203], v13, s[4:7], s44 offen offset:128
  buffer_load_dwordx4 v[204:207], v13, s[4:7], s44 offen offset:1024
  buffer_load_dwordx4 v[208:211], v13, s[4:7], s44 offen offset:1152
  buffer_load_dwordx4 v[116:119], v11, s[4:7], s44 offen offset:0
  buffer_load_dwordx4 v[132:135], v11, s[4:7], s44 offen offset:64
  buffer_load_dwordx4 v[120:123], v11, s[4:7], s44 offen offset:1024
  buffer_load_dwordx4 v[136:139], v11, s[4:7], s44 offen offset:1088
  buffer_load_dwordx4 v[124:127], v11, s[4:7], s44 offen offset:2048
  buffer_load_dwordx4 v[140:143], v11, s[4:7], s44 offen offset:2112
  buffer_load_dwordx4 v[128:131], v11, s[4:7], s44 offen offset:3072
  buffer_load_dwordx4 v[144:147], v11, s[4:7], s44 offen offset:3136
  s_add_u32 s44, s44, 0x40000
  v_mov_b64 v[64:65], 0
  v_mov_b64 v[66:67], 0
  v_mov_b64 v[68:69], 0
  v_mov_b64 v[70:71], 0
  v_mov_b64 v[72:73], 0
  v_mov_b64 v[74:75], 0
  v_mov_b64 v[76:77], 0
  v_mov_b64 v[78:79], 0
  v_mov_b64 v[80:81], 0
  v_mov_b64 v[82:83], 0
  v_mov_b64 v[84:85], 0
  v_mov_b64 v[86:87], 0
  v_mov_b64 v[32:33], 0
  v_mov_b64 v[34:35], 0
  v_mov_b64 v[212:213], 0
  v_mov_b64 v[214:215], 0
  v_mov_b64 v[216:217], 0
  v_mov_b64 v[218:219], 0
  v_mov_b64 v[220:221], 0
  v_mov_b64 v[222:223], 0
  v_mov_b64 v[224:225], 0
  v_mov_b64 v[226:227], 0
  v_mov_b64 v[228:229], 0
  v_mov_b64 v[230:231], 0
  s_waitcnt vmcnt(0)
  v_min_u32 v44, s54, v44
  s_lshl_b32 s90, s33, 7
  s_add_u32 s90, s90, 0x3d01000
  v_mov_b32 v244, s90
  s_lshl_b32 s90, s33, 5
  s_add_u32 s90, s90, s34
  s_lshl_b32 s90, s90, 2
  s_add_u32 s90, s90, s32
  v_mbcnt_lo_u32_b32 v30, -1, 0
  v_mbcnt_hi_u32_b32 v30, -1, v30
  v_add_u32 v30, s90, v30
  v_cmp_eq_u32 vcc, 0, v30
  v_mov_b32 v30, 0x80000000
  v_mov_b32 v31, 0x3d00000
  v_cndmask_b32 v245, v30, v31, vcc
  s_branch FL_pubmem
FL_step:
  buffer_load_dwordx4 v[196:199], v13, s[4:7], s44 offen offset:0
  buffer_load_dwordx4 v[200:203], v13, s[4:7], s44 offen offset:128
  buffer_load_dwordx4 v[204:207], v13, s[4:7], s44 offen offset:1024
  buffer_load_dwordx4 v[208:211], v13, s[4:7], s44 offen offset:1152
  v_mov_b64 v[64:65], 0
  v_mov_b64 v[66:67], 0
  v_mov_b64 v[68:69], 0
  v_mov_b64 v[70:71], 0
  v_mov_b64 v[72:73], 0
  v_mov_b64 v[74:75], 0
  v_mov_b64 v[76:77], 0
  v_mov_b64 v[78:79], 0
  v_mov_b64 v[80:81], 0
  v_mov_b64 v[82:83], 0
  v_mov_b64 v[84:85], 0
  v_mov_b64 v[86:87], 0
  v_mov_b64 v[32:33], 0
  v_mov_b64 v[34:35], 0
  buffer_load_dwordx4 v[36:39], v1, s[4:7], s42 offen sc1
  buffer_load_dwordx4 v[128:131], v11, s[4:7], s44 offen offset:3072
  buffer_load_dwordx4 v[144:147], v11, s[4:7], s44 offen offset:3136
  s_add_u32 s44, s44, 0x40000
  s_min_u32 s44, s44, 0xfc0000
  s_add_u32 s45, s45, 0x10000
  s_waitcnt vmcnt(9)
FL_kv_chk:
  v_readfirstlane_b32 s90, v243
  s_cmp_lt_u32 s90, 32
  s_cbranch_scc1 FL_kv_f
  s_waitcnt vmcnt(2)
FL_g_chk:
  v_max3_u32 v31, v36, v37, v38
  v_max_u32 v31, v31, v39
  v_cmp_eq_u32 vcc, -1, v31
  v_mfma_f32_16x16x32_bf16 v[40:43], v[24:27], v[36:39], 0
  s_cbranch_vccnz FL_g_f
  s_nop 6
  v_add_f32_dpp v45, v40, v40 row_ror:8 row_mask:0xf bank_mask:0xf
  v_add_f32_dpp v46, v41, v41 row_ror:8 row_mask:0xf bank_mask:0xf
  v_cvt_pk_bf16_f32 v44, v45, v46
  v_min_u32 v44, s54, v44
FL_pubmem:
  buffer_store_dword v44, v2, s[4:7], s41 offen
  v_mov_b32 v148, v180
  v_mov_b32 v150, v181
  v_mov_b32 v152, v182
  v_mov_b32 v154, v183
  v_mov_b32 v149, v184
  v_mov_b32 v151, v185
  v_mov_b32 v153, v186
  v_mov_b32 v155, v187
  v_mov_b32 v156, v188
  v_mov_b32 v158, v189
  v_mov_b32 v160, v190
  v_mov_b32 v162, v191
  v_mov_b32 v157, v192
  v_mov_b32 v159, v193
  v_mov_b32 v161, v194
  v_mov_b32 v163, v195
  v_mov_b32 v164, v196
  v_mov_b32 v166, v197
  v_mov_b32 v168, v198
  v_mov_b32 v170, v199
  v_mov_b32 v165, v200
  v_mov_b32 v167, v201
  v_mov_b32 v169, v202
  v_mov_b32 v171, v203
  buffer_load_dwordx4 v[48:51], v3, s[4:7], s41 offen offset:0 sc1
  v_mov_b32 v172, v204
  v_mov_b32 v174, v205
  buffer_load_dwordx4 v[52:55], v3, s[4:7], s41 offen offset:1024 sc1
  v_mov_b32 v176, v206
  v_mov_b32 v178, v207
  buffer_load_dwordx4 v[56:59], v3, s[4:7], s41 offen offset:2048 sc1
  v_mov_b32 v173, v208
  v_mov_b32 v175, v209
  buffer_load_dwordx4 v[60:63], v3, s[4:7], s41 offen offset:3072 sc1
  v_mov_b32 v177, v210
  v_mov_b32 v179, v211
  s_waitcnt vmcnt(3)
  v_max3_u32 v31, v48, v49, v50
  v_max_u32 v31, v31, v51
  v_cmp_eq_u32 vcc, -1, v31
  s_cbranch_vccnz FL_m_f0
  v_smfmac_f32_16x16x64_bf16 v[64:67], v[48:51], a[0:7], v23
  s_waitcnt vmcnt(2)
  v_max3_u32 v31, v52, v53, v54
  v_max_u32 v31, v31, v55
  v_cmp_eq_u32 vcc, -1, v31
  v_smfmac_f32_16x16x64_bf16 v[68:71], v[48:51], a[8:15], v23
  v_smfmac_f32_16x16x64_bf16 v[72:75], v[48:51], a[16:23], v23
  v_smfmac_f32_16x16x64_bf16 v[76:79], v[48:51], a[24:31], v23
  s_cbranch_vccnz FL_m_f1
  v_smfmac_f32_16x16x64_bf16 v[64:67], v[52:55], a[48:55], v23
  s_waitcnt vmcnt(1)
  v_max3_u32 v31, v56, v57, v58
  v_max_u32 v31, v31, v59
  v_cmp_eq_u32 vcc, -1, v31
  v_smfmac_f32_16x16x64_bf16 v[68:71], v[52:55], a[56:63], v23
  v_smfmac_f32_16x16x64_bf16 v[72:75], v[52:55], a[64:71], v23
  v_smfmac_f32_16x16x64_bf16 v[76:79], v[52:55], a[72:79], v23
  s_cbranch_vccnz FL_m_f2
  v_smfmac_f32_16x16x64_bf16 v[64:67], v[56:59], a[96:103], v23
  s_waitcnt vmcnt(0)
  v_max3_u32 v31, v60, v61, v62
  v_max_u32 v31, v31, v63
  v_cmp_eq_u32 vcc, -1, v31
  v_smfmac_f32_16x16x64_bf16 v[68:71], v[56:59], a[104:111], v23
  v_smfmac_f32_16x16x64_bf16 v[72:75], v[56:59], a[112:119], v23
  v_smfmac_f32_16x16x64_bf16 v[76:79], v[56:59], a[120:127], v23
  s_cbranch_vccnz FL_m_f3
  v_smfmac_f32_16x16x64_bf16 v[64:67], v[60:63], a[144:151], v23
  v_smfmac_f32_16x16x64_bf16 v[68:71], v[60:63], a[152:159], v23
  v_smfmac_f32_16x16x64_bf16 v[72:75], v[60:63], a[160:167], v23
  v_smfmac_f32_16x16x64_bf16 v[76:79], v[60:63], a[168:175], v23
FL_m_done:
  s_nop 4
  v_pk_add_f32 v[88:89], v[64:65], v[66:67]
  v_pk_add_f32 v[90:91], v[68:69], v[70:71]
  ds_write_b128 v4, v[88:91] offset:0
  v_pk_add_f32 v[92:93], v[72:73], v[74:75]
  v_pk_add_f32 v[94:95], v[76:77], v[78:79]
  ds_write_b128 v4, v[92:95] offset:1088
  v_smfmac_f32_16x16x64_bf16 v[80:83], v[48:51], a[32:39], v23
  buffer_load_dwordx4 v[180:183], v12, s[4:7], s44 offen offset:0
  v_mov_b32 v36, 0
  v_smfmac_f32_16x16x64_bf16 v[84:87], v[48:51], a[40:47], v23
  buffer_load_dwordx4 v[184:187], v12, s[4:7], s44 offen offset:128
  v_mov_b32 v37, 0
  v_smfmac_f32_16x16x64_bf16 v[80:83], v[52:55], a[80:87], v23
  buffer_load_dwordx4 v[188:191], v12, s[4:7], s44 offen offset:1024
  v_mov_b32 v38, 0
  v_smfmac_f32_16x16x64_bf16 v[84:87], v[52:55], a[88:95], v23
  buffer_load_dwordx4 v[192:195], v12, s[4:7], s44 offen offset:1152
  v_mov_b32 v39, 0
  v_smfmac_f32_16x16x64_bf16 v[80:83], v[56:59], a[128:135], v23
  v_mov_b32 v40, 0
  s_waitcnt lgkmcnt(0)
  s_barrier
  ds_read2_b32 v[100:101], v6 offset0:0 offset1:2
  ds_read2_b32 v[102:103], v240 offset0:0 offset1:2
  ds_read2_b32 v[104:105], v241 offset0:0 offset1:2
  ds_read2_b32 v[106:107], v242 offset0:0 offset1:2
  v_smfmac_f32_16x16x64_bf16 v[84:87], v[56:59], a[136:143], v23
  v_mov_b32 v41, 0
  v_smfmac_f32_16x16x64_bf16 v[80:83], v[60:63], a[176:183], v23
  v_mov_b32 v42, 0
  v_smfmac_f32_16x16x64_bf16 v[84:87], v[60:63], a[184:191], v23
  v_mov_b32 v43, 0
  v_mov_b32 v44, 0
  v_mov_b32 v45, 0
  v_mov_b32 v46, 0
  v_mov_b32 v47, 0
  s_waitcnt lgkmcnt(2)
  v_pk_add_f32 v[100:101], v[100:101], v[102:103]
  s_waitcnt lgkmcnt(0)
  v_pk_add_f32 v[104:105], v[104:105], v[106:107]
  v_pk_add_f32 v[100:101], v[100:101], v[104:105]
  v_cvt_pk_bf16_f32 v112, v100, v101
  v_min_u32 v112, s54, v112
  buffer_store_dword v112, v7, s[4:7], s41 offen
  v_pk_add_f32 v[96:97], v[80:81], v[82:83]
  v_pk_add_f32 v[98:99], v[84:85], v[86:87]
  ds_write_b128 v4, v[96:99] offset:2176
  v_mov_b64 v[212:213], 0
  v_mov_b64 v[214:215], 0
  v_mov_b64 v[216:217], 0
  v_mov_b64 v[218:219], 0
  v_mov_b64 v[220:221], 0
  v_mov_b64 v[222:223], 0
  v_mov_b64 v[224:225], 0
  v_mov_b64 v[226:227], 0
  v_mov_b64 v[228:229], 0
  v_mov_b64 v[230:231], 0
  s_waitcnt lgkmcnt(0)
  s_barrier
  ds_read_b64 v[88:89], v5 offset:0
  ds_read_b64 v[90:91], v5 offset:3264
  ds_read_b64 v[92:93], v5 offset:6528
  ds_read_b64 v[94:95], v5 offset:9792
  s_mov_b32 s42, s41
  s_add_u32 s90, s40, 1
  s_and_b32 s90, s90, 3
  s_lshl_b32 s90, s90, 19
  s_add_u32 s91, s90, 0x3800000
  s_add_u32 s55, s55, 0x40000
  s_min_u32 s55, s55, 0xfc0000
  s_nop 0
  s_waitcnt lgkmcnt(2)
  v_pk_add_f32 v[88:89], v[88:89], v[90:91]
  s_waitcnt lgkmcnt(0)
  v_pk_add_f32 v[92:93], v[92:93], v[94:95]
  v_pk_add_f32 v[88:89], v[88:89], v[92:93]
  v_cvt_pk_bf16_f32 v113, v88, v89
  v_min_u32 v113, s54, v113
  buffer_store_dword v113, v8, s[4:7], s41 offen
  buffer_load_dwordx4 v[64:67], v9, s[4:7], s41 offen offset:0 sc1
  s_nop 1
  buffer_load_dwordx4 v[68:71], v9, s[4:7], s41 offen offset:1024 sc1
  s_nop 1
  buffer_load_dwordx4 v[72:75], v9, s[4:7], s41 offen offset:2048 sc1
  s_nop 1
  buffer_load_dwordx4 v[76:79], v9, s[4:7], s41 offen offset:3072 sc1
  s_nop 1
  s_cmp_eq_u32 s40, 63
  s_cbranch_scc1 FL_last
  s_waitcnt vmcnt(3)
  v_max3_u32 v31, v64, v65, v66
  v_max_u32 v31, v31, v67
  v_cmp_eq_u32 vcc, -1, v31
  s_cbranch_vccnz FL_x_f0
  v_mfma_f32_16x16x32_bf16 v[44:47], v[64:67], v[64:67], v[44:47]
  s_waitcnt vmcnt(2)
  v_max3_u32 v31, v68, v69, v70
  v_max_u32 v31, v31, v71
  v_cmp_eq_u32 vcc, -1, v31
  v_mfma_f32_16x16x32_bf16 v[36:39], v[116:119], v[64:67], v[36:39]
  v_mfma_f32_16x16x32_bf16 v[40:43], v[132:135], v[64:67], v[40:43]
  s_cbranch_vccnz FL_x_f1
  v_mfma_f32_16x16x32_bf16 v[44:47], v[68:71], v[68:71], v[44:47]
  s_waitcnt vmcnt(1)
  v_max3_u32 v31, v72, v73, v74
  v_max_u32 v31, v31, v75
  v_cmp_eq_u32 vcc, -1, v31
  v_mfma_f32_16x16x32_bf16 v[36:39], v[120:123], v[68:71], v[36:39]
  v_mfma_f32_16x16x32_bf16 v[40:43], v[136:139], v[68:71], v[40:43]
  s_cbranch_vccnz FL_x_f2
  v_mfma_f32_16x16x32_bf16 v[44:47], v[72:75], v[72:75], v[44:47]
  s_waitcnt vmcnt(0)
  v_max3_u32 v31, v76, v77, v78
  v_max_u32 v31, v31, v79
  v_cmp_eq_u32 vcc, -1, v31
  v_mfma_f32_16x16x32_bf16 v[36:39], v[124:127], v[72:75], v[36:39]
  v_mfma_f32_16x16x32_bf16 v[40:43], v[140:143], v[72:75], v[40:43]
  s_cbranch_vccnz FL_x_f3
  v_mfma_f32_16x16x32_bf16 v[44:47], v[76:79], v[76:79], v[44:47]
  v_mfma_f32_16x16x32_bf16 v[36:39], v[128:131], v[76:79], v[36:39]
  v_mfma_f32_16x16x32_bf16 v[40:43], v[144:147], v[76:79], v[40:43]
FL_x_done:
  buffer_load_dwordx4 v[88:91], v10, s[4:7], s41 offen offset:0 sc1
  buffer_load_dwordx4 v[92:95], v10, s[4:7], s41 offen offset:1024 sc1
  s_mov_b64 vcc, s[48:49]
  s_nop 2
  v_max_f32 v30, v46, v47
  s_nop 0
  v_cndmask_b32_dpp v96, v40, v36, vcc quad_perm:[0,1,0,1] row_mask:0xf bank_mask:0xf
  v_cndmask_b32_dpp v97, v41, v37, vcc quad_perm:[0,1,0,1] row_mask:0xf bank_mask:0xf
  v_cndmask_b32_dpp v98, v42, v38, vcc quad_perm:[0,1,0,1] row_mask:0xf bank_mask:0xf
  v_cndmask_b32_dpp v99, v43, v39, vcc quad_perm:[0,1,0,1] row_mask:0xf bank_mask:0xf
  v_max3_f32 v29, v96, v97, v98
  s_nop 0
  v_max_f32_dpp v28, v30, v99 quad_perm:[0,1,0,1] row_mask:0xf bank_mask:0xf
  v_max_f32 v29, v29, v28
  s_nop 1
  v_max_f32_dpp v28, v29, v29 quad_perm:[2,3,0,1] row_mask:0xf bank_mask:0xf
  v_mov_b32 v29, v28
  s_nop 1
  v_permlane32_swap_b32 v28, v29
  v_max_f32 v28, v28, v29
  v_mov_b32 v29, v28
  s_nop 1
  v_permlane16_swap_b32 v28, v29
  v_max_f32 v28, v28, v29
  v_mul_f32 v28, s47, v28
  v_fma_f32 v96, v96, s47, -v28
  v_fma_f32 v97, v97, s47, -v28
  v_fma_f32 v98, v98, s47, -v28
  v_fma_f32 v99, v99, s47, -v28
  v_fma_f32 v46, v46, s47, -v28
  v_fma_f32 v47, v47, s47, -v28
  v_exp_f32 v96, v96
  v_exp_f32 v97, v97
  v_exp_f32 v98, v98
  v_exp_f32 v99, v99
  v_cvt_pk_bf16_f32 v236, v96, v97
  v_cvt_pk_bf16_f32 v237, v98, v99
  v_exp_f32 v46, v46
  v_mov_b32_dpp v100, v236 quad_perm:[0,1,0,1] row_mask:0xf bank_mask:0xf
  v_mov_b32_dpp v102, v236 quad_perm:[2,3,2,3] row_mask:0xf bank_mask:0xf
  v_mov_b32_dpp v101, v237 quad_perm:[0,1,0,1] row_mask:0xf bank_mask:0xf
  v_mov_b32_dpp v103, v237 quad_perm:[2,3,2,3] row_mask:0xf bank_mask:0xf
  v_exp_f32 v47, v47
  s_nop 0
  v_smfmac_f32_16x16x64_bf16 v[228:231], v[100:103], v[248:255], v23
  v_cvt_pk_bf16_f32 v238, v46, v47
  buffer_load_dwordx4 v[116:119], v11, s[4:7], s44 offen offset:0
  v_smfmac_f32_16x16x64_bf16 v[212:215], v[100:103], v[148:155], v23
  buffer_load_dwordx4 v[132:135], v11, s[4:7], s44 offen offset:64
  v_mov_b32_dpp v232, v238 quad_perm:[0,1,0,1] row_mask:0xf bank_mask:0xf
  v_smfmac_f32_16x16x64_bf16 v[216:219], v[100:103], v[156:163], v23
  buffer_load_dwordx4 v[120:123], v11, s[4:7], s44 offen offset:1024
  v_mov_b32_dpp v235, v238 quad_perm:[0,1,0,1] row_mask:0xf bank_mask:0xf
  v_smfmac_f32_16x16x64_bf16 v[220:223], v[100:103], v[164:171], v23
  buffer_load_dwordx4 v[136:139], v11, s[4:7], s44 offen offset:1088
  s_waitcnt vmcnt(4)
  v_max3_u32 v31, v88, v89, v90
  v_max3_u32 v31, v31, v91, v92
  v_smfmac_f32_16x16x32_bf16 v[228:231], v[232:233], v[248:251], v23
  v_max3_u32 v31, v31, v93, v94
  v_max_u32 v31, v31, v95
  v_cmp_eq_u32 vcc, -1, v31
  v_smfmac_f32_16x16x64_bf16 v[224:227], v[100:103], v[172:179], v23
  s_cbranch_vccnz FL_v_f
FL_v_ok:
  v_smfmac_f32_16x16x32_bf16 v[212:215], v[232:233], v[88:91], v23
  buffer_load_dwordx4 v[124:127], v11, s[4:7], s44 offen offset:2048
  buffer_load_dwordx4 v[140:143], v11, s[4:7], s44 offen offset:2112
  v_smfmac_f32_16x16x32_bf16 v[216:219], v[234:235], v[88:91], v23
  buffer_store_dword v22, v18, s[4:7], s43 offen
  v_rcp_f32 v28, v228
  v_smfmac_f32_16x16x32_bf16 v[220:223], v[232:233], v[92:95], v23
  buffer_store_dword v22, v2, s[4:7], s43 offen
  v_rcp_f32 v29, v229
  v_smfmac_f32_16x16x32_bf16 v[224:227], v[234:235], v[92:95], v23
  buffer_store_dword v22, v7, s[4:7], s43 offen
  buffer_store_dword v22, v8, s[4:7], s43 offen
  v_pk_mul_f32 v[212:213], v[212:213], v[28:29]
  v_pk_mul_f32 v[214:215], v[214:215], v[28:29]
  v_cvt_pk_bf16_f32 v104, v212, v214
  v_cvt_pk_bf16_f32 v108, v213, v215
  v_pk_mul_f32 v[216:217], v[216:217], v[28:29]
  v_pk_mul_f32 v[218:219], v[218:219], v[28:29]
  v_cvt_pk_bf16_f32 v105, v216, v218
  v_cvt_pk_bf16_f32 v109, v217, v219
  v_pk_mul_f32 v[220:221], v[220:221], v[28:29]
  v_pk_mul_f32 v[222:223], v[222:223], v[28:29]
  v_cvt_pk_bf16_f32 v106, v220, v222
  v_cvt_pk_bf16_f32 v110, v221, v223
  v_pk_mul_f32 v[224:225], v[224:225], v[28:29]
  v_pk_mul_f32 v[226:227], v[226:227], v[28:29]
  v_cvt_pk_bf16_f32 v107, v224, v226
  v_cvt_pk_bf16_f32 v111, v225, v227
  ds_write_b128 v14, v[104:107]
  ds_write_b128 v15, v[108:111]
  s_add_u32 s92, s40, 3
  s_min_u32 s92, s92, 63
  s_lshr_b32 s92, s92, 3
  s_lshl_b32 s92, s92, 9
  s_max_u32 s93, s40, 1
  s_sub_u32 s93, s93, 1
  v_mov_b32 v246, s93
  s_waitcnt lgkmcnt(0)
  s_barrier
  ds_read_b128 v[48:51], v16 offset:0
  ds_read_b128 v[52:55], v16 offset:1024
  ds_read_b128 v[56:59], v16 offset:2048
  ds_read_b128 v[60:63], v16 offset:3072
  ds_read_b128 v[64:67], v16 offset:4096
  buffer_load_dword v0, v21, s[4:7], s55 offen
  buffer_store_dword v22, v17, s[4:7], s43 offen sc1
  s_waitcnt lgkmcnt(4)
  v_smfmac_f32_16x16x64_bf16 v[32:35], v[48:51], a[192:199], v23
  ds_read_b128 v[68:71], v16 offset:5120
  buffer_store_dword v112, v19, s[4:7], s45 offen sc1
  s_waitcnt lgkmcnt(4)
  v_smfmac_f32_16x16x64_bf16 v[32:35], v[52:55], a[200:207], v23
  ds_read_b128 v[72:75], v16 offset:6144
  buffer_store_dword v113, v20, s[4:7], s45 offen sc1
  s_waitcnt lgkmcnt(4)
  v_smfmac_f32_16x16x64_bf16 v[32:35], v[56:59], a[208:215], v23
  ds_read_b128 v[76:79], v16 offset:7168
  buffer_store_dword v246, v245, s[4:7], 0 offen sc1
  s_waitcnt lgkmcnt(4)
  v_smfmac_f32_16x16x64_bf16 v[32:35], v[60:63], a[216:223], v23
  buffer_load_dword v243, v244, s[4:7], s92 offen sc1
  s_waitcnt lgkmcnt(3)
  v_smfmac_f32_16x16x64_bf16 v[32:35], v[64:67], a[224:231], v23
  s_add_u32 s40, s40, 1
  s_waitcnt lgkmcnt(2)
  v_smfmac_f32_16x16x64_bf16 v[32:35], v[68:71], a[232:239], v23
  s_mov_b32 s41, s91
  s_waitcnt lgkmcnt(1)
  v_smfmac_f32_16x16x64_bf16 v[32:35], v[72:75], a[240:247], v23
  s_xor_b32 s43, s91, 0x100000
  s_waitcnt lgkmcnt(0)
  v_smfmac_f32_16x16x64_bf16 v[32:35], v[76:79], a[248:255], v23
  s_nop 7
  v_pk_add_f32 v[28:29], v[32:33], v[34:35]
  v_cvt_pk_bf16_f32 v28, v28, v29
  v_min_u32 v28, s54, v28
  buffer_store_dword v28, v17, s[4:7], s42 offen sc1
  buffer_store_dword v28, v18, s[4:7], s42 offen
  s_branch FL_step
FL_last:
  buffer_store_dword v112, v19, s[4:7], s45 offen sc1
  buffer_store_dword v113, v20, s[4:7], s45 offen sc1
  s_waitcnt vmcnt(0)
  s_barrier
  s_mov_b32 s90, 0x3d00080
  s_cmp_lg_u32 s32, 0
  s_cbranch_scc1 FL_sig_8
  v_mov_b32 v254, 1
  v_mov_b32 v255, 0
  s_mov_b64 exec, 1
  buffer_atomic_add v254, v255, s[4:7], s90 offen offset:0 sc1
  s_mov_b64 exec, -1
FL_sig_8:
  s_waitcnt vmcnt(0)
  s_branch L_join
FL_kv_f:
  s_sleep 8
  buffer_load_dword v243, v244, s[4:7], s92 offen sc1
  s_add_u32 s46, s46, 1
  s_cmp_ge_u32 s46, 131072
  s_cbranch_scc1 FL_rec_abort
  s_waitcnt vmcnt(0)
  s_branch FL_kv_chk
FL_g_f:
  s_mov_b64 exec, vcc
  buffer_load_dwordx4 v[36:39], v1, s[4:7], s42 offen sc1
  s_mov_b64 exec, -1
  s_add_u32 s46, s46, 1
  s_cmp_ge_u32 s46, 131072
  s_cbranch_scc1 FL_rec_abort
  s_waitcnt vmcnt(0)
  s_branch FL_g_chk
FL_m_f0:
  s_mov_b64 exec, vcc
  buffer_load_dwordx4 v[48:51], v3, s[4:7], s41 offen offset:0 sc1
  s_mov_b64 exec, -1
  s_waitcnt vmcnt(1)
  s_branch FL_m_0123_c1
FL_m_f1:
  s_mov_b64 exec, vcc
  buffer_load_dwordx4 v[52:55], v3, s[4:7], s41 offen offset:1024 sc1
  s_mov_b64 exec, -1
  s_waitcnt vmcnt(1)
  s_branch FL_m_123_c2
FL_m_f2:
  s_mov_b64 exec, vcc
  buffer_load_dwordx4 v[56:59], v3, s[4:7], s41 offen offset:2048 sc1
  s_mov_b64 exec, -1
  s_waitcnt vmcnt(1)
  s_branch FL_m_23_c3
FL_m_f3:
  s_mov_b64 exec, vcc
  buffer_load_dwordx4 v[60:63], v3, s[4:7], s41 offen offset:3072 sc1
  s_mov_b64 exec, -1
  s_nop 7
  s_branch FL_m_3_c3
FL_m_0_c0:
  v_max3_u32 v31, v48, v49, v50
  v_max_u32 v31, v31, v51
  v_cmp_eq_u32 vcc, -1, v31
  s_cbranch_vccz FL_m_0_ok0
FL_m_0_x0:
  s_mov_b64 exec, vcc
  buffer_load_dwordx4 v[48:51], v3, s[4:7], s41 offen offset:0 sc1
  s_mov_b64 exec, -1
  s_add_u32 s46, s46, 1
  s_cmp_ge_u32 s46, 131072
  s_cbranch_scc1 FL_rec_abort
  s_waitcnt vmcnt(2)
  s_branch FL_m_0_c0
FL_m_0_ok0:
  v_smfmac_f32_16x16x64_bf16 v[64:67], v[48:51], a[0:7], v23
  v_smfmac_f32_16x16x64_bf16 v[68:71], v[48:51], a[8:15], v23
  v_smfmac_f32_16x16x64_bf16 v[72:75], v[48:51], a[16:23], v23
  v_smfmac_f32_16x16x64_bf16 v[76:79], v[48:51], a[24:31], v23
  s_branch FL_m_done
FL_m_1_c1:
  v_max3_u32 v31, v52, v53, v54
  v_max_u32 v31, v31, v55
  v_cmp_eq_u32 vcc, -1, v31
  s_cbranch_vccz FL_m_1_ok1
FL_m_1_x1:
  s_mov_b64 exec, vcc
  buffer_load_dwordx4 v[52:55], v3, s[4:7], s41 offen offset:1024 sc1
  s_mov_b64 exec, -1
  s_add_u32 s46, s46, 1
  s_cmp_ge_u32 s46, 131072
  s_cbranch_scc1 FL_rec_abort
  s_waitcnt vmcnt(2)
  s_branch FL_m_1_c1
FL_m_1_ok1:
  v_smfmac_f32_16x16x64_bf16 v[64:67], v[52:55], a[48:55], v23
  v_smfmac_f32_16x16x64_bf16 v[68:71], v[52:55], a[56:63], v23
  v_smfmac_f32_16x16x64_bf16 v[72:75], v[52:55], a[64:71], v23
  v_smfmac_f32_16x16x64_bf16 v[76:79], v[52:55], a[72:79], v23
  s_branch FL_m_done
FL_m_2_c2:
  v_max3_u32 v31, v56, v57, v58
  v_max_u32 v31, v31, v59
  v_cmp_eq_u32 vcc, -1, v31
  s_cbranch_vccz FL_m_2_ok2
FL_m_2_x2:
  s_mov_b64 exec, vcc
  buffer_load_dwordx4 v[56:59], v3, s[4:7], s41 offen offset:2048 sc1
  s_mov_b64 exec, -1
  s_add_u32 s46, s46, 1
  s_cmp_ge_u32 s46, 131072
  s_cbranch_scc1 FL_rec_abort
  s_waitcnt vmcnt(2)
  s_branch FL_m_2_c2
FL_m_2_ok2:
  v_smfmac_f32_16x16x64_bf16 v[64:67], v[56:59], a[96:103], v23
  v_smfmac_f32_16x16x64_bf16 v[68:71], v[56:59], a[104:111], v23
  v_smfmac_f32_16x16x64_bf16 v[72:75], v[56:59], a[112:119], v23
  v_smfmac_f32_16x16x64_bf16 v[76:79], v[56:59], a[120:127], v23
  s_branch FL_m_done
FL_m_3_c3:
  v_max3_u32 v31, v60, v61, v62
  v_max_u32 v31, v31, v63
  v_cmp_eq_u32 vcc, -1, v31
  s_cbranch_vccz FL_m_3_ok3
FL_m_3_x3:
  s_mov_b64 exec, vcc
  buffer_load_dwordx4 v[60:63], v3, s[4:7], s41 offen offset:3072 sc1
  s_mov_b64 exec, -1
  s_add_u32 s46, s46, 1
  s_cmp_ge_u32 s46, 131072
  s_cbranch_scc1 FL_rec_abort
  s_waitcnt vmcnt(2)
  s_branch FL_m_3_c3
FL_m_3_ok3:
  v_smfmac_f32_16x16x64_bf16 v[64:67], v[60:63], a[144:151], v23
  v_smfmac_f32_16x16x64_bf16 v[68:71], v[60:63], a[152:159], v23
  v_smfmac_f32_16x16x64_bf16 v[72:75], v[60:63], a[160:167], v23
  v_smfmac_f32_16x16x64_bf16 v[76:79], v[60:63], a[168:175], v23
  s_branch FL_m_done
FL_m_01_c0:
  v_max3_u32 v31, v48, v49, v50
  v_max_u32 v31, v31, v51
  v_cmp_eq_u32 vcc, -1, v31
  s_cbranch_vccz FL_m_01_ok0
FL_m_01_x0:
  s_mov_b64 exec, vcc
  buffer_load_dwordx4 v[48:51], v3, s[4:7], s41 offen offset:0 sc1
  s_mov_b64 exec, -1
FL_m_01_c1:
  v_max3_u32 v31, v52, v53, v54
  v_max_u32 v31, v31, v55
  v_cmp_eq_u32 vcc, -1, v31
  s_cbranch_vccz FL_m_01_ok1
FL_m_01_x1:
  s_mov_b64 exec, vcc
  buffer_load_dwordx4 v[52:55], v3, s[4:7], s41 offen offset:1024 sc1
  s_mov_b64 exec, -1
  s_add_u32 s46, s46, 1
  s_cmp_ge_u32 s46, 131072
  s_cbranch_scc1 FL_rec_abort
  s_waitcnt vmcnt(4)
  s_branch FL_m_01_c0
FL_m_01_ok0:
  v_smfmac_f32_16x16x64_bf16 v[64:67], v[48:51], a[0:7], v23
  v_max3_u32 v31, v52, v53, v54
  v_max_u32 v31, v31, v55
  v_cmp_eq_u32 vcc, -1, v31
  v_smfmac_f32_16x16x64_bf16 v[68:71], v[48:51], a[8:15], v23
  v_smfmac_f32_16x16x64_bf16 v[72:75], v[48:51], a[16:23], v23
  v_smfmac_f32_16x16x64_bf16 v[76:79], v[48:51], a[24:31], v23
  s_cbranch_vccz FL_m_1_ok1
  s_branch FL_m_1_x1
FL_m_01_ok1:
  v_smfmac_f32_16x16x64_bf16 v[64:67], v[52:55], a[48:55], v23
  v_max3_u32 v31, v48, v49, v50
  v_max_u32 v31, v31, v51
  v_cmp_eq_u32 vcc, -1, v31
  v_smfmac_f32_16x16x64_bf16 v[68:71], v[52:55], a[56:63], v23
  v_smfmac_f32_16x16x64_bf16 v[72:75], v[52:55], a[64:71], v23
  v_smfmac_f32_16x16x64_bf16 v[76:79], v[52:55], a[72:79], v23
  s_cbranch_vccz FL_m_0_ok0
  s_branch FL_m_0_x0
FL_m_02_c0:
  v_max3_u32 v31, v48, v49, v50
  v_max_u32 v31, v31, v51
  v_cmp_eq_u32 vcc, -1, v31
  s_cbranch_vccz FL_m_02_ok0
FL_m_02_x0:
  s_mov_b64 exec, vcc
  buffer_load_dwordx4 v[48:51], v3, s[4:7], s41 offen offset:0 sc1
  s_mov_b64 exec, -1
FL_m_02_c2:
  v_max3_u32 v31, v56, v57, v58
  v_max_u32 v31, v31, v59
  v_cmp_eq_u32 vcc, -1, v31
  s_cbranch_vccz FL_m_02_ok2
FL_m_02_x2:
  s_mov_b64 exec, vcc
  buffer_load_dwordx4 v[56:59], v3, s[4:7], s41 offen offset:2048 sc1
  s_mov_b64 exec, -1
  s_add_u32 s46, s46, 1
  s_cmp_ge_u32 s46, 131072
  s_cbranch_scc1 FL_rec_abort
  s_waitcnt vmcnt(4)
  s_branch FL_m_02_c0
FL_m_02_ok0:
  v_smfmac_f32_16x16x64_bf16 v[64:67], v[48:51], a[0:7], v23
  v_max3_u32 v31, v56, v57, v58
  v_max_u32 v31, v31, v59
  v_cmp_eq_u32 vcc, -1, v31
  v_smfmac_f32_16x16x64_bf16 v[68:71], v[48:51], a[8:15], v23
  v_smfmac_f32_16x16x64_bf16 v[72:75], v[48:51], a[16:23], v23
  v_smfmac_f32_16x16x64_bf16 v[76:79], v[48:51], a[24:31], v23
  s_cbranch_vccz FL_m_2_ok2
  s_branch FL_m_2_x2
FL_m_02_ok2:
  v_smfmac_f32_16x16x64_bf16 v[64:67], v[56:59], a[96:103], v23
  v_max3_u32 v31, v48, v49, v50
  v_max_u32 v31, v31, v51
  v_cmp_eq_u32 vcc, -1, v31
  v_smfmac_f32_16x16x64_bf16 v[68:71], v[56:59], a[104:111], v23
  v_smfmac_f32_16x16x64_bf16 v[72:75], v[56:59], a[112:119], v23
  v_smfmac_f32_16x16x64_bf16 v[76:79], v[56:59], a[120:127], v23
  s_cbranch_vccz FL_m_0_ok0
  s_branch FL_m_0_x0
FL_m_03_c0:
  v_max3_u32 v31, v48, v49, v50
  v_max_u32 v31, v31, v51
  v_cmp_eq_u32 vcc, -1, v31
  s_cbranch_vccz FL_m_03_ok0
FL_m_03_x0:
  s_mov_b64 exec, vcc
  buffer_load_dwordx4 v[48:51], v3, s[4:7], s41 offen offset:0 sc1
  s_mov_b64 exec, -1
FL_m_03_c3:
  v_max3_u32 v31, v60, v61, v62
  v_max_u32 v31, v31, v63
  v_cmp_eq_u32 vcc, -1, v31
  s_cbranch_vccz FL_m_03_ok3
FL_m_03_x3:
  s_mov_b64 exec, vcc
  buffer_load_dwordx4 v[60:63], v3, s[4:7], s41 offen offset:3072 sc1
  s_mov_b64 exec, -1
  s_add_u32 s46, s46, 1
  s_cmp_ge_u32 s46, 131072
  s_cbranch_scc1 FL_rec_abort
  s_waitcnt vmcnt(4)
  s_branch FL_m_03_c0
FL_m_03_ok0:
  v_smfmac_f32_16x16x64_bf16 v[64:67], v[48:51], a[0:7], v23
  v_max3_u32 v31, v60, v61, v62
  v_max_u32 v31, v31, v63
  v_cmp_eq_u32 vcc, -1, v31
  v_smfmac_f32_16x16x64_bf16 v[68:71], v[48:51], a[8:15], v23
  v_smfmac_f32_16x16x64_bf16 v[72:75], v[48:51], a[16:23], v23
  v_smfmac_f32_16x16x64_bf16 v[76:79], v[48:51], a[24:31], v23
  s_cbranch_vccz FL_m_3_ok3
  s_branch FL_m_3_x3
FL_m_03_ok3:
  v_smfmac_f32_16x16x64_bf16 v[64:67], v[60:63], a[144:151], v23
  v_max3_u32 v31, v48, v49, v50
  v_max_u32 v31, v31, v51
  v_cmp_eq_u32 vcc, -1, v31
  v_smfmac_f32_16x16x64_bf16 v[68:71], v[60:63], a[152:159], v23
  v_smfmac_f32_16x16x64_bf16 v[72:75], v[60:63], a[160:167], v23
  v_smfmac_f32_16x16x64_bf16 v[76:79], v[60:63], a[168:175], v23
  s_cbranch_vccz FL_m_0_ok0
  s_branch FL_m_0_x0
FL_m_12_c1:
  v_max3_u32 v31, v52, v53, v54
  v_max_u32 v31, v31, v55
  v_cmp_eq_u32 vcc, -1, v31
  s_cbranch_vccz FL_m_12_ok1
FL_m_12_x1:
  s_mov_b64 exec, vcc
  buffer_load_dwordx4 v[52:55], v3, s[4:7], s41 offen offset:1024 sc1
  s_mov_b64 exec, -1
FL_m_12_c2:
  v_max3_u32 v31, v56, v57, v58
  v_max_u32 v31, v31, v59
  v_cmp_eq_u32 vcc, -1, v31
  s_cbranch_vccz FL_m_12_ok2
FL_m_12_x2:
  s_mov_b64 exec, vcc
  buffer_load_dwordx4 v[56:59], v3, s[4:7], s41 offen offset:2048 sc1
  s_mov_b64 exec, -1
  s_add_u32 s46, s46, 1
  s_cmp_ge_u32 s46, 131072
  s_cbranch_scc1 FL_rec_abort
  s_waitcnt vmcnt(4)
  s_branch FL_m_12_c1
FL_m_12_ok1:
  v_smfmac_f32_16x16x64_bf16 v[64:67], v[52:55], a[48:55], v23
  v_max3_u32 v31, v56, v57, v58
  v_max_u32 v31, v31, v59
  v_cmp_eq_u32 vcc, -1, v31
  v_smfmac_f32_16x16x64_bf16 v[68:71], v[52:55], a[56:63], v23
  v_smfmac_f32_16x16x64_bf16 v[72:75], v[52:55], a[64:71], v23
  v_smfmac_f32_16x16x64_bf16 v[76:79], v[52:55], a[72:79], v23
  s_cbranch_vccz FL_m_2_ok2
  s_branch FL_m_2_x2
FL_m_12_ok2:
  v_smfmac_f32_16x16x64_bf16 v[64:67], v[56:59], a[96:103], v23
  v_max3_u32 v31, v52, v53, v54
  v_max_u32 v31, v31, v55
  v_cmp_eq_u32 vcc, -1, v31
  v_smfmac_f32_16x16x64_bf16 v[68:71], v[56:59], a[104:111], v23
  v_smfmac_f32_16x16x64_bf16 v[72:75], v[56:59], a[112:119], v23
  v_smfmac_f32_16x16x64_bf16 v[76:79], v[56:59], a[120:127], v23
  s_cbranch_vccz FL_m_1_ok1
  s_branch FL_m_1_x1
FL_m_13_c1:
  v_max3_u32 v31, v52, v53, v54
  v_max_u32 v31, v31, v55
  v_cmp_eq_u32 vcc, -1, v31
  s_cbranch_vccz FL_m_13_ok1
FL_m_13_x1:
  s_mov_b64 exec, vcc
  buffer_load_dwordx4 v[52:55], v3, s[4:7], s41 offen offset:1024 sc1
  s_mov_b64 exec, -1
FL_m_13_c3:
  v_max3_u32 v31, v60, v61, v62
  v_max_u32 v31, v31, v63
  v_cmp_eq_u32 vcc, -1, v31
  s_cbranch_vccz FL_m_13_ok3
FL_m_13_x3:
  s_mov_b64 exec, vcc
  buffer_load_dwordx4 v[60:63], v3, s[4:7], s41 offen offset:3072 sc1
  s_mov_b64 exec, -1
  s_add_u32 s46, s46, 1
  s_cmp_ge_u32 s46, 131072
  s_cbranch_scc1 FL_rec_abort
  s_waitcnt vmcnt(4)
  s_branch FL_m_13_c1
FL_m_13_ok1:
  v_smfmac_f32_16x16x64_bf16 v[64:67], v[52:55], a[48:55], v23
  v_max3_u32 v31, v60, v61, v62
  v_max_u32 v31, v31, v63
  v_cmp_eq_u32 vcc, -1, v31
  v_smfmac_f32_16x16x64_bf16 v[68:71], v[52:55], a[56:63], v23
  v_smfmac_f32_16x16x64_bf16 v[72:75], v[52:55], a[64:71], v23
  v_smfmac_f32_16x16x64_bf16 v[76:79], v[52:55], a[72:79], v23
  s_cbranch_vccz FL_m_3_ok3
  s_branch FL_m_3_x3
FL_m_13_ok3:
  v_smfmac_f32_16x16x64_bf16 v[64:67], v[60:63], a[144:151], v23
  v_max3_u32 v31, v52, v53, v54
  v_max_u32 v31, v31, v55
  v_cmp_eq_u32 vcc, -1, v31
  v_smfmac_f32_16x16x64_bf16 v[68:71], v[60:63], a[152:159], v23
  v_smfmac_f32_16x16x64_bf16 v[72:75], v[60:63], a[160:167], v23
  v_smfmac_f32_16x16x64_bf16 v[76:79], v[60:63], a[168:175], v23
  s_cbranch_vccz FL_m_1_ok1
  s_branch FL_m_1_x1
FL_m_23_c2:
  v_max3_u32 v31, v56, v57, v58
  v_max_u32 v31, v31, v59
  v_cmp_eq_u32 vcc, -1, v31
  s_cbranch_vccz FL_m_23_ok2
FL_m_23_x2:
  s_mov_b64 exec, vcc
  buffer_load_dwordx4 v[56:59], v3, s[4:7], s41 offen offset:2048 sc1
  s_mov_b64 exec, -1
FL_m_23_c3:
  v_max3_u32 v31, v60, v61, v62
  v_max_u32 v31, v31, v63
  v_cmp_eq_u32 vcc, -1, v31
  s_cbranch_vccz FL_m_23_ok3
FL_m_23_x3:
  s_mov_b64 exec, vcc
  buffer_load_dwordx4 v[60:63], v3, s[4:7], s41 offen offset:3072 sc1
  s_mov_b64 exec, -1
  s_add_u32 s46, s46, 1
  s_cmp_ge_u32 s46, 131072
  s_cbranch_scc1 FL_rec_abort
  s_waitcnt vmcnt(4)
  s_branch FL_m_23_c2
FL_m_23_ok2:
  v_smfmac_f32_16x16x64_bf16 v[64:67], v[56:59], a[96:103], v23
  v_max3_u32 v31, v60, v61, v62
  v_max_u32 v31, v31, v63
  v_cmp_eq_u32 vcc, -1, v31
  v_smfmac_f32_16x16x64_bf16 v[68:71], v[56:59], a[104:111], v23
  v_smfmac_f32_16x16x64_bf16 v[72:75], v[56:59], a[112:119], v23
  v_smfmac_f32_16x16x64_bf16 v[76:79], v[56:59], a[120:127], v23
  s_cbranch_vccz FL_m_3_ok3
  s_branch FL_m_3_x3
FL_m_23_ok3:
  v_smfmac_f32_16x16x64_bf16 v[64:67], v[60:63], a[144:151], v23
  v_max3_u32 v31, v56, v57, v58
  v_max_u32 v31, v31, v59
  v_cmp_eq_u32 vcc, -1, v31
  v_smfmac_f32_16x16x64_bf16 v[68:71], v[60:63], a[152:159], v23
  v_smfmac_f32_16x16x64_bf16 v[72:75], v[60:63], a[160:167], v23
  v_smfmac_f32_16x16x64_bf16 v[76:79], v[60:63], a[168:175], v23
  s_cbranch_vccz FL_m_2_ok2
  s_branch FL_m_2_x2
FL_m_012_c0:
  v_max3_u32 v31, v48, v49, v50
  v_max_u32 v31, v31, v51
  v_cmp_eq_u32 vcc, -1, v31
  s_cbranch_vccz FL_m_012_ok0
FL_m_012_x0:
  s_mov_b64 exec, vcc
  buffer_load_dwordx4 v[48:51], v3, s[4:7], s41 offen offset:0 sc1
  s_mov_b64 exec, -1
FL_m_012_c1:
  v_max3_u32 v31, v52, v53, v54
  v_max_u32 v31, v31, v55
  v_cmp_eq_u32 vcc, -1, v31
  s_cbranch_vccz FL_m_012_ok1
FL_m_012_x1:
  s_mov_b64 exec, vcc
  buffer_load_dwordx4 v[52:55], v3, s[4:7], s41 offen offset:1024 sc1
  s_mov_b64 exec, -1
FL_m_012_c2:
  v_max3_u32 v31, v56, v57, v58
  v_max_u32 v31, v31, v59
  v_cmp_eq_u32 vcc, -1, v31
  s_cbranch_vccz FL_m_012_ok2
FL_m_012_x2:
  s_mov_b64 exec, vcc
  buffer_load_dwordx4 v[56:59], v3, s[4:7], s41 offen offset:2048 sc1
  s_mov_b64 exec, -1
  s_add_u32 s46, s46, 1
  s_cmp_ge_u32 s46, 131072
  s_cbranch_scc1 FL_rec_abort
  s_waitcnt vmcnt(4)
  s_branch FL_m_012_c0
FL_m_012_ok0:
  v_smfmac_f32_16x16x64_bf16 v[64:67], v[48:51], a[0:7], v23
  v_max3_u32 v31, v52, v53, v54
  v_max_u32 v31, v31, v55
  v_cmp_eq_u32 vcc, -1, v31
  v_smfmac_f32_16x16x64_bf16 v[68:71], v[48:51], a[8:15], v23
  v_smfmac_f32_16x16x64_bf16 v[72:75], v[48:51], a[16:23], v23
  v_smfmac_f32_16x16x64_bf16 v[76:79], v[48:51], a[24:31], v23
  s_cbranch_vccz FL_m_12_ok1
  s_branch FL_m_12_x1
FL_m_012_ok1:
  v_smfmac_f32_16x16x64_bf16 v[64:67], v[52:55], a[48:55], v23
  v_max3_u32 v31, v56, v57, v58
  v_max_u32 v31, v31, v59
  v_cmp_eq_u32 vcc, -1, v31
  v_smfmac_f32_16x16x64_bf16 v[68:71], v[52:55], a[56:63], v23
  v_smfmac_f32_16x16x64_bf16 v[72:75], v[52:55], a[64:71], v23
  v_smfmac_f32_16x16x64_bf16 v[76:79], v[52:55], a[72:79], v23
  s_cbranch_vccz FL_m_02_ok2
  s_branch FL_m_02_x2
FL_m_012_ok2:
  v_smfmac_f32_16x16x64_bf16 v[64:67], v[56:59], a[96:103], v23
  v_max3_u32 v31, v48, v49, v50
  v_max_u32 v31, v31, v51
  v_cmp_eq_u32 vcc, -1, v31
  v_smfmac_f32_16x16x64_bf16 v[68:71], v[56:59], a[104:111], v23
  v_smfmac_f32_16x16x64_bf16 v[72:75], v[56:59], a[112:119], v23
  v_smfmac_f32_16x16x64_bf16 v[76:79], v[56:59], a[120:127], v23
  s_cbranch_vccz FL_m_01_ok0
  s_branch FL_m_01_x0
FL_m_013_c0:
  v_max3_u32 v31, v48, v49, v50
  v_max_u32 v31, v31, v51
  v_cmp_eq_u32 vcc, -1, v31
  s_cbranch_vccz FL_m_013_ok0
FL_m_013_x0:
  s_mov_b64 exec, vcc
  buffer_load_dwordx4 v[48:51], v3, s[4:7], s41 offen offset:0 sc1
  s_mov_b64 exec, -1
FL_m_013_c1:
  v_max3_u32 v31, v52, v53, v54
  v_max_u32 v31, v31, v55
  v_cmp_eq_u32 vcc, -1, v31
  s_cbranch_vccz FL_m_013_ok1
FL_m_013_x1:
  s_mov_b64 exec, vcc
  buffer_load_dwordx4 v[52:55], v3, s[4:7], s41 offen offset:1024 sc1
  s_mov_b64 exec, -1
FL_m_013_c3:
  v_max3_u32 v31, v60, v61, v62
  v_max_u32 v31, v31, v63
  v_cmp_eq_u32 vcc, -1, v31
  s_cbranch_vccz FL_m_013_ok3
FL_m_013_x3:
  s_mov_b64 exec, vcc
  buffer_load_dwordx4 v[60:63], v3, s[4:7], s41 offen offset:3072 sc1
  s_mov_b64 exec, -1
  s_add_u32 s46, s46, 1
  s_cmp_ge_u32 s46, 131072
  s_cbranch_scc1 FL_rec_abort
  s_waitcnt vmcnt(4)
  s_branch FL_m_013_c0
FL_m_013_ok0:
  v_smfmac_f32_16x16x64_bf16 v[64:67], v[48:51], a[0:7], v23
  v_max3_u32 v31, v52, v53, v54
  v_max_u32 v31, v31, v55
  v_cmp_eq_u32 vcc, -1, v31
  v_smfmac_f32_16x16x64_bf16 v[68:71], v[48:51], a[8:15], v23
  v_smfmac_f32_16x16x64_bf16 v[72:75], v[48:51], a[16:23], v23
  v_smfmac_f32_16x16x64_bf16 v[76:79], v[48:51], a[24:31], v23
  s_cbranch_vccz FL_m_13_ok1
  s_branch FL_m_13_x1
FL_m_013_ok1:
  v_smfmac_f32_16x16x64_bf16 v[64:67], v[52:55], a[48:55], v23
  v_max3_u32 v31, v60, v61, v62
  v_max_u32 v31, v31, v63
  v_cmp_eq_u32 vcc, -1, v31
  v_smfmac_f32_16x16x64_bf16 v[68:71], v[52:55], a[56:63], v23
  v_smfmac_f32_16x16x64_bf16 v[72:75], v[52:55], a[64:71], v23
  v_smfmac_f32_16x16x64_bf16 v[76:79], v[52:55], a[72:79], v23
  s_cbranch_vccz FL_m_03_ok3
  s_branch FL_m_03_x3
FL_m_013_ok3:
  v_smfmac_f32_16x16x64_bf16 v[64:67], v[60:63], a[144:151], v23
  v_max3_u32 v31, v48, v49, v50
  v_max_u32 v31, v31, v51
  v_cmp_eq_u32 vcc, -1, v31
  v_smfmac_f32_16x16x64_bf16 v[68:71], v[60:63], a[152:159], v23
  v_smfmac_f32_16x16x64_bf16 v[72:75], v[60:63], a[160:167], v23
  v_smfmac_f32_16x16x64_bf16 v[76:79], v[60:63], a[168:175], v23
  s_cbranch_vccz FL_m_01_ok0
  s_branch FL_m_01_x0
FL_m_023_c0:
  v_max3_u32 v31, v48, v49, v50
  v_max_u32 v31, v31, v51
  v_cmp_eq_u32 vcc, -1, v31
  s_cbranch_vccz FL_m_023_ok0
FL_m_023_x0:
  s_mov_b64 exec, vcc
  buffer_load_dwordx4 v[48:51], v3, s[4:7], s41 offen offset:0 sc1
  s_mov_b64 exec, -1
FL_m_023_c2:
  v_max3_u32 v31, v56, v57, v58
  v_max_u32 v31, v31, v59
  v_cmp_eq_u32 vcc, -1, v31
  s_cbranch_vccz FL_m_023_ok2
FL_m_023_x2:
  s_mov_b64 exec, vcc
  buffer_load_dwordx4 v[56:59], v3, s[4:7], s41 offen offset:2048 sc1
  s_mov_b64 exec, -1
FL_m_023_c3:
  v_max3_u32 v31, v60, v61, v62
  v_max_u32 v31, v31, v63
  v_cmp_eq_u32 vcc, -1, v31
  s_cbranch_vccz FL_m_023_ok3
FL_m_023_x3:
  s_mov_b64 exec, vcc
  buffer_load_dwordx4 v[60:63], v3, s[4:7], s41 offen offset:3072 sc1
  s_mov_b64 exec, -1
  s_add_u32 s46, s46, 1
  s_cmp_ge_u32 s46, 131072
  s_cbranch_scc1 FL_rec_abort
  s_waitcnt vmcnt(4)
  s_branch FL_m_023_c0
FL_m_023_ok0:
  v_smfmac_f32_16x16x64_bf16 v[64:67], v[48:51], a[0:7], v23
  v_max3_u32 v31, v56, v57, v58
  v_max_u32 v31, v31, v59
  v_cmp_eq_u32 vcc, -1, v31
  v_smfmac_f32_16x16x64_bf16 v[68:71], v[48:51], a[8:15], v23
  v_smfmac_f32_16x16x64_bf16 v[72:75], v[48:51], a[16:23], v23
  v_smfmac_f32_16x16x64_bf16 v[76:79], v[48:51], a[24:31], v23
  s_cbranch_vccz FL_m_23_ok2
  s_branch FL_m_23_x2
FL_m_023_ok2:
  v_smfmac_f32_16x16x64_bf16 v[64:67], v[56:59], a[96:103], v23
  v_max3_u32 v31, v60, v61, v62
  v_max_u32 v31, v31, v63
  v_cmp_eq_u32 vcc, -1, v31
  v_smfmac_f32_16x16x64_bf16 v[68:71], v[56:59], a[104:111], v23
  v_smfmac_f32_16x16x64_bf16 v[72:75], v[56:59], a[112:119], v23
  v_smfmac_f32_16x16x64_bf16 v[76:79], v[56:59], a[120:127], v23
  s_cbranch_vccz FL_m_03_ok3
  s_branch FL_m_03_x3
FL_m_023_ok3:
  v_smfmac_f32_16x16x64_bf16 v[64:67], v[60:63], a[144:151], v23
  v_max3_u32 v31, v48, v49, v50
  v_max_u32 v31, v31, v51
  v_cmp_eq_u32 vcc, -1, v31
  v_smfmac_f32_16x16x64_bf16 v[68:71], v[60:63], a[152:159], v23
  v_smfmac_f32_16x16x64_bf16 v[72:75], v[60:63], a[160:167], v23
  v_smfmac_f32_16x16x64_bf16 v[76:79], v[60:63], a[168:175], v23
  s_cbranch_vccz FL_m_02_ok0
  s_branch FL_m_02_x0
FL_m_123_c1:
  v_max3_u32 v31, v52, v53, v54
  v_max_u32 v31, v31, v55
  v_cmp_eq_u32 vcc, -1, v31
  s_cbranch_vccz FL_m_123_ok1
FL_m_123_x1:
  s_mov_b64 exec, vcc
  buffer_load_dwordx4 v[52:55], v3, s[4:7], s41 offen offset:1024 sc1
  s_mov_b64 exec, -1
FL_m_123_c2:
  v_max3_u32 v31, v56, v57, v58
  v_max_u32 v31, v31, v59
  v_cmp_eq_u32 vcc, -1, v31
  s_cbranch_vccz FL_m_123_ok2
FL_m_123_x2:
  s_mov_b64 exec, vcc
  buffer_load_dwordx4 v[56:59], v3, s[4:7], s41 offen offset:2048 sc1
  s_mov_b64 exec, -1
FL_m_123_c3:
  v_max3_u32 v31, v60, v61, v62
  v_max_u32 v31, v31, v63
  v_cmp_eq_u32 vcc, -1, v31
  s_cbranch_vccz FL_m_123_ok3
FL_m_123_x3:
  s_mov_b64 exec, vcc
  buffer_load_dwordx4 v[60:63], v3, s[4:7], s41 offen offset:3072 sc1
  s_mov_b64 exec, -1
  s_add_u32 s46, s46, 1
  s_cmp_ge_u32 s46, 131072
  s_cbranch_scc1 FL_rec_abort
  s_waitcnt vmcnt(4)
  s_branch FL_m_123_c1
FL_m_123_ok1:
  v_smfmac_f32_16x16x64_bf16 v[64:67], v[52:55], a[48:55], v23
  v_max3_u32 v31, v56, v57, v58
  v_max_u32 v31, v31, v59
  v_cmp_eq_u32 vcc, -1, v31
  v_smfmac_f32_16x16x64_bf16 v[68:71], v[52:55], a[56:63], v23
  v_smfmac_f32_16x16x64_bf16 v[72:75], v[52:55], a[64:71], v23
  v_smfmac_f32_16x16x64_bf16 v[76:79], v[52:55], a[72:79], v23
  s_cbranch_vccz FL_m_23_ok2
  s_branch FL_m_23_x2
FL_m_123_ok2:
  v_smfmac_f32_16x16x64_bf16 v[64:67], v[56:59], a[96:103], v23
  v_max3_u32 v31, v60, v61, v62
  v_max_u32 v31, v31, v63
  v_cmp_eq_u32 vcc, -1, v31
  v_smfmac_f32_16x16x64_bf16 v[68:71], v[56:59], a[104:111], v23
  v_smfmac_f32_16x16x64_bf16 v[72:75], v[56:59], a[112:119], v23
  v_smfmac_f32_16x16x64_bf16 v[76:79], v[56:59], a[120:127], v23
  s_cbranch_vccz FL_m_13_ok3
  s_branch FL_m_13_x3
FL_m_123_ok3:
  v_smfmac_f32_16x16x64_bf16 v[64:67], v[60:63], a[144:151], v23
  v_max3_u32 v31, v52, v53, v54
  v_max_u32 v31, v31, v55
  v_cmp_eq_u32 vcc, -1, v31
  v_smfmac_f32_16x16x64_bf16 v[68:71], v[60:63], a[152:159], v23
  v_smfmac_f32_16x16x64_bf16 v[72:75], v[60:63], a[160:167], v23
  v_smfmac_f32_16x16x64_bf16 v[76:79], v[60:63], a[168:175], v23
  s_cbranch_vccz FL_m_12_ok1
  s_branch FL_m_12_x1
FL_m_0123_c0:
  v_max3_u32 v31, v48, v49, v50
  v_max_u32 v31, v31, v51
  v_cmp_eq_u32 vcc, -1, v31
  s_cbranch_vccz FL_m_0123_ok0
FL_m_0123_x0:
  s_mov_b64 exec, vcc
  buffer_load_dwordx4 v[48:51], v3, s[4:7], s41 offen offset:0 sc1
  s_mov_b64 exec, -1
FL_m_0123_c1:
  v_max3_u32 v31, v52, v53, v54
  v_max_u32 v31, v31, v55
  v_cmp_eq_u32 vcc, -1, v31
  s_cbranch_vccz FL_m_0123_ok1
FL_m_0123_x1:
  s_mov_b64 exec, vcc
  buffer_load_dwordx4 v[52:55], v3, s[4:7], s41 offen offset:1024 sc1
  s_mov_b64 exec, -1
FL_m_0123_c2:
  v_max3_u32 v31, v56, v57, v58
  v_max_u32 v31, v31, v59
  v_cmp_eq_u32 vcc, -1, v31
  s_cbranch_vccz FL_m_0123_ok2
FL_m_0123_x2:
  s_mov_b64 exec, vcc
  buffer_load_dwordx4 v[56:59], v3, s[4:7], s41 offen offset:2048 sc1
  s_mov_b64 exec, -1
FL_m_0123_c3:
  v_max3_u32 v31, v60, v61, v62
  v_max_u32 v31, v31, v63
  v_cmp_eq_u32 vcc, -1, v31
  s_cbranch_vccz FL_m_0123_ok3
FL_m_0123_x3:
  s_mov_b64 exec, vcc
  buffer_load_dwordx4 v[60:63], v3, s[4:7], s41 offen offset:3072 sc1
  s_mov_b64 exec, -1
  s_add_u32 s46, s46, 1
  s_cmp_ge_u32 s46, 131072
  s_cbranch_scc1 FL_rec_abort
  s_waitcnt vmcnt(4)
  s_branch FL_m_0123_c0
FL_m_0123_ok0:
  v_smfmac_f32_16x16x64_bf16 v[64:67], v[48:51], a[0:7], v23
  v_max3_u32 v31, v52, v53, v54
  v_max_u32 v31, v31, v55
  v_cmp_eq_u32 vcc, -1, v31
  v_smfmac_f32_16x16x64_bf16 v[68:71], v[48:51], a[8:15], v23
  v_smfmac_f32_16x16x64_bf16 v[72:75], v[48:51], a[16:23], v23
  v_smfmac_f32_16x16x64_bf16 v[76:79], v[48:51], a[24:31], v23
  s_cbranch_vccz FL_m_123_ok1
  s_branch FL_m_123_x1
FL_m_0123_ok1:
  v_smfmac_f32_16x16x64_bf16 v[64:67], v[52:55], a[48:55], v23
  v_max3_u32 v31, v56, v57, v58
  v_max_u32 v31, v31, v59
  v_cmp_eq_u32 vcc, -1, v31
  v_smfmac_f32_16x16x64_bf16 v[68:71], v[52:55], a[56:63], v23
  v_smfmac_f32_16x16x64_bf16 v[72:75], v[52:55], a[64:71], v23
  v_smfmac_f32_16x16x64_bf16 v[76:79], v[52:55], a[72:79], v23
  s_cbranch_vccz FL_m_023_ok2
  s_branch FL_m_023_x2
FL_m_0123_ok2:
  v_smfmac_f32_16x16x64_bf16 v[64:67], v[56:59], a[96:103], v23
  v_max3_u32 v31, v60, v61, v62
  v_max_u32 v31, v31, v63
  v_cmp_eq_u32 vcc, -1, v31
  v_smfmac_f32_16x16x64_bf16 v[68:71], v[56:59], a[104:111], v23
  v_smfmac_f32_16x16x64_bf16 v[72:75], v[56:59], a[112:119], v23
  v_smfmac_f32_16x16x64_bf16 v[76:79], v[56:59], a[120:127], v23
  s_cbranch_vccz FL_m_013_ok3
  s_branch FL_m_013_x3
FL_m_0123_ok3:
  v_smfmac_f32_16x16x64_bf16 v[64:67], v[60:63], a[144:151], v23
  v_max3_u32 v31, v48, v49, v50
  v_max_u32 v31, v31, v51
  v_cmp_eq_u32 vcc, -1, v31
  v_smfmac_f32_16x16x64_bf16 v[68:71], v[60:63], a[152:159], v23
  v_smfmac_f32_16x16x64_bf16 v[72:75], v[60:63], a[160:167], v23
  v_smfmac_f32_16x16x64_bf16 v[76:79], v[60:63], a[168:175], v23
  s_cbranch_vccz FL_m_012_ok0
  s_branch FL_m_012_x0
FL_x_f0:
  s_mov_b64 exec, vcc
  buffer_load_dwordx4 v[64:67], v9, s[4:7], s41 offen offset:0 sc1
  s_mov_b64 exec, -1
  s_waitcnt vmcnt(1)
  s_branch FL_x_0123_c1
FL_x_f1:
  s_mov_b64 exec, vcc
  buffer_load_dwordx4 v[68:71], v9, s[4:7], s41 offen offset:1024 sc1
  s_mov_b64 exec, -1
  s_waitcnt vmcnt(1)
  s_branch FL_x_123_c2
FL_x_f2:
  s_mov_b64 exec, vcc
  buffer_load_dwordx4 v[72:75], v9, s[4:7], s41 offen offset:2048 sc1
  s_mov_b64 exec, -1
  s_waitcnt vmcnt(1)
  s_branch FL_x_23_c3
FL_x_f3:
  s_mov_b64 exec, vcc
  buffer_load_dwordx4 v[76:79], v9, s[4:7], s41 offen offset:3072 sc1
  s_mov_b64 exec, -1
  s_nop 7
  s_branch FL_x_3_c3
FL_x_0_c0:
  v_max3_u32 v31, v64, v65, v66
  v_max_u32 v31, v31, v67
  v_cmp_eq_u32 vcc, -1, v31
  s_cbranch_vccz FL_x_0_ok0
FL_x_0_x0:
  s_mov_b64 exec, vcc
  buffer_load_dwordx4 v[64:67], v9, s[4:7], s41 offen offset:0 sc1
  s_mov_b64 exec, -1
  s_add_u32 s46, s46, 1
  s_cmp_ge_u32 s46, 131072
  s_cbranch_scc1 FL_rec_abort
  s_waitcnt vmcnt(2)
  s_branch FL_x_0_c0
FL_x_0_ok0:
  v_mfma_f32_16x16x32_bf16 v[44:47], v[64:67], v[64:67], v[44:47]
  v_mfma_f32_16x16x32_bf16 v[36:39], v[116:119], v[64:67], v[36:39]
  v_mfma_f32_16x16x32_bf16 v[40:43], v[132:135], v[64:67], v[40:43]
  s_branch FL_x_done
FL_x_1_c1:
  v_max3_u32 v31, v68, v69, v70
  v_max_u32 v31, v31, v71
  v_cmp_eq_u32 vcc, -1, v31
  s_cbranch_vccz FL_x_1_ok1
FL_x_1_x1:
  s_mov_b64 exec, vcc
  buffer_load_dwordx4 v[68:71], v9, s[4:7], s41 offen offset:1024 sc1
  s_mov_b64 exec, -1
  s_add_u32 s46, s46, 1
  s_cmp_ge_u32 s46, 131072
  s_cbranch_scc1 FL_rec_abort
  s_waitcnt vmcnt(2)
  s_branch FL_x_1_c1
FL_x_1_ok1:
  v_mfma_f32_16x16x32_bf16 v[44:47], v[68:71], v[68:71], v[44:47]
  v_mfma_f32_16x16x32_bf16 v[36:39], v[120:123], v[68:71], v[36:39]
  v_mfma_f32_16x16x32_bf16 v[40:43], v[136:139], v[68:71], v[40:43]
  s_branch FL_x_done
FL_x_2_c2:
  v_max3_u32 v31, v72, v73, v74
  v_max_u32 v31, v31, v75
  v_cmp_eq_u32 vcc, -1, v31
  s_cbranch_vccz FL_x_2_ok2
FL_x_2_x2:
  s_mov_b64 exec, vcc
  buffer_load_dwordx4 v[72:75], v9, s[4:7], s41 offen offset:2048 sc1
  s_mov_b64 exec, -1
  s_add_u32 s46, s46, 1
  s_cmp_ge_u32 s46, 131072
  s_cbranch_scc1 FL_rec_abort
  s_waitcnt vmcnt(2)
  s_branch FL_x_2_c2
FL_x_2_ok2:
  v_mfma_f32_16x16x32_bf16 v[44:47], v[72:75], v[72:75], v[44:47]
  v_mfma_f32_16x16x32_bf16 v[36:39], v[124:127], v[72:75], v[36:39]
  v_mfma_f32_16x16x32_bf16 v[40:43], v[140:143], v[72:75], v[40:43]
  s_branch FL_x_done
FL_x_3_c3:
  v_max3_u32 v31, v76, v77, v78
  v_max_u32 v31, v31, v79
  v_cmp_eq_u32 vcc, -1, v31
  s_cbranch_vccz FL_x_3_ok3
FL_x_3_x3:
  s_mov_b64 exec, vcc
  buffer_load_dwordx4 v[76:79], v9, s[4:7], s41 offen offset:3072 sc1
  s_mov_b64 exec, -1
  s_add_u32 s46, s46, 1
  s_cmp_ge_u32 s46, 131072
  s_cbranch_scc1 FL_rec_abort
  s_waitcnt vmcnt(2)
  s_branch FL_x_3_c3
FL_x_3_ok3:
  v_mfma_f32_16x16x32_bf16 v[44:47], v[76:79], v[76:79], v[44:47]
  v_mfma_f32_16x16x32_bf16 v[36:39], v[128:131], v[76:79], v[36:39]
  v_mfma_f32_16x16x32_bf16 v[40:43], v[144:147], v[76:79], v[40:43]
  s_branch FL_x_done
FL_x_01_c0:
  v_max3_u32 v31, v64, v65, v66
  v_max_u32 v31, v31, v67
  v_cmp_eq_u32 vcc, -1, v31
  s_cbranch_vccz FL_x_01_ok0
FL_x_01_x0:
  s_mov_b64 exec, vcc
  buffer_load_dwordx4 v[64:67], v9, s[4:7], s41 offen offset:0 sc1
  s_mov_b64 exec, -1
FL_x_01_c1:
  v_max3_u32 v31, v68, v69, v70
  v_max_u32 v31, v31, v71
  v_cmp_eq_u32 vcc, -1, v31
  s_cbranch_vccz FL_x_01_ok1
FL_x_01_x1:
  s_mov_b64 exec, vcc
  buffer_load_dwordx4 v[68:71], v9, s[4:7], s41 offen offset:1024 sc1
  s_mov_b64 exec, -1
  s_add_u32 s46, s46, 1
  s_cmp_ge_u32 s46, 131072
  s_cbranch_scc1 FL_rec_abort
  s_waitcnt vmcnt(4)
  s_branch FL_x_01_c0
FL_x_01_ok0:
  v_mfma_f32_16x16x32_bf16 v[44:47], v[64:67], v[64:67], v[44:47]
  v_max3_u32 v31, v68, v69, v70
  v_max_u32 v31, v31, v71
  v_cmp_eq_u32 vcc, -1, v31
  v_mfma_f32_16x16x32_bf16 v[36:39], v[116:119], v[64:67], v[36:39]
  v_mfma_f32_16x16x32_bf16 v[40:43], v[132:135], v[64:67], v[40:43]
  s_cbranch_vccz FL_x_1_ok1
  s_branch FL_x_1_x1
FL_x_01_ok1:
  v_mfma_f32_16x16x32_bf16 v[44:47], v[68:71], v[68:71], v[44:47]
  v_max3_u32 v31, v64, v65, v66
  v_max_u32 v31, v31, v67
  v_cmp_eq_u32 vcc, -1, v31
  v_mfma_f32_16x16x32_bf16 v[36:39], v[120:123], v[68:71], v[36:39]
  v_mfma_f32_16x16x32_bf16 v[40:43], v[136:139], v[68:71], v[40:43]
  s_cbranch_vccz FL_x_0_ok0
  s_branch FL_x_0_x0
FL_x_02_c0:
  v_max3_u32 v31, v64, v65, v66
  v_max_u32 v31, v31, v67
  v_cmp_eq_u32 vcc, -1, v31
  s_cbranch_vccz FL_x_02_ok0
FL_x_02_x0:
  s_mov_b64 exec, vcc
  buffer_load_dwordx4 v[64:67], v9, s[4:7], s41 offen offset:0 sc1
  s_mov_b64 exec, -1
FL_x_02_c2:
  v_max3_u32 v31, v72, v73, v74
  v_max_u32 v31, v31, v75
  v_cmp_eq_u32 vcc, -1, v31
  s_cbranch_vccz FL_x_02_ok2
FL_x_02_x2:
  s_mov_b64 exec, vcc
  buffer_load_dwordx4 v[72:75], v9, s[4:7], s41 offen offset:2048 sc1
  s_mov_b64 exec, -1
  s_add_u32 s46, s46, 1
  s_cmp_ge_u32 s46, 131072
  s_cbranch_scc1 FL_rec_abort
  s_waitcnt vmcnt(4)
  s_branch FL_x_02_c0
FL_x_02_ok0:
  v_mfma_f32_16x16x32_bf16 v[44:47], v[64:67], v[64:67], v[44:47]
  v_max3_u32 v31, v72, v73, v74
  v_max_u32 v31, v31, v75
  v_cmp_eq_u32 vcc, -1, v31
  v_mfma_f32_16x16x32_bf16 v[36:39], v[116:119], v[64:67], v[36:39]
  v_mfma_f32_16x16x32_bf16 v[40:43], v[132:135], v[64:67], v[40:43]
  s_cbranch_vccz FL_x_2_ok2
  s_branch FL_x_2_x2
FL_x_02_ok2:
  v_mfma_f32_16x16x32_bf16 v[44:47], v[72:75], v[72:75], v[44:47]
  v_max3_u32 v31, v64, v65, v66
  v_max_u32 v31, v31, v67
  v_cmp_eq_u32 vcc, -1, v31
  v_mfma_f32_16x16x32_bf16 v[36:39], v[124:127], v[72:75], v[36:39]
  v_mfma_f32_16x16x32_bf16 v[40:43], v[140:143], v[72:75], v[40:43]
  s_cbranch_vccz FL_x_0_ok0
  s_branch FL_x_0_x0
FL_x_03_c0:
  v_max3_u32 v31, v64, v65, v66
  v_max_u32 v31, v31, v67
  v_cmp_eq_u32 vcc, -1, v31
  s_cbranch_vccz FL_x_03_ok0
FL_x_03_x0:
  s_mov_b64 exec, vcc
  buffer_load_dwordx4 v[64:67], v9, s[4:7], s41 offen offset:0 sc1
  s_mov_b64 exec, -1
FL_x_03_c3:
  v_max3_u32 v31, v76, v77, v78
  v_max_u32 v31, v31, v79
  v_cmp_eq_u32 vcc, -1, v31
  s_cbranch_vccz FL_x_03_ok3
FL_x_03_x3:
  s_mov_b64 exec, vcc
  buffer_load_dwordx4 v[76:79], v9, s[4:7], s41 offen offset:3072 sc1
  s_mov_b64 exec, -1
  s_add_u32 s46, s46, 1
  s_cmp_ge_u32 s46, 131072
  s_cbranch_scc1 FL_rec_abort
  s_waitcnt vmcnt(4)
  s_branch FL_x_03_c0
FL_x_03_ok0:
  v_mfma_f32_16x16x32_bf16 v[44:47], v[64:67], v[64:67], v[44:47]
  v_max3_u32 v31, v76, v77, v78
  v_max_u32 v31, v31, v79
  v_cmp_eq_u32 vcc, -1, v31
  v_mfma_f32_16x16x32_bf16 v[36:39], v[116:119], v[64:67], v[36:39]
  v_mfma_f32_16x16x32_bf16 v[40:43], v[132:135], v[64:67], v[40:43]
  s_cbranch_vccz FL_x_3_ok3
  s_branch FL_x_3_x3
FL_x_03_ok3:
  v_mfma_f32_16x16x32_bf16 v[44:47], v[76:79], v[76:79], v[44:47]
  v_max3_u32 v31, v64, v65, v66
  v_max_u32 v31, v31, v67
  v_cmp_eq_u32 vcc, -1, v31
  v_mfma_f32_16x16x32_bf16 v[36:39], v[128:131], v[76:79], v[36:39]
  v_mfma_f32_16x16x32_bf16 v[40:43], v[144:147], v[76:79], v[40:43]
  s_cbranch_vccz FL_x_0_ok0
  s_branch FL_x_0_x0
FL_x_12_c1:
  v_max3_u32 v31, v68, v69, v70
  v_max_u32 v31, v31, v71
  v_cmp_eq_u32 vcc, -1, v31
  s_cbranch_vccz FL_x_12_ok1
FL_x_12_x1:
  s_mov_b64 exec, vcc
  buffer_load_dwordx4 v[68:71], v9, s[4:7], s41 offen offset:1024 sc1
  s_mov_b64 exec, -1
FL_x_12_c2:
  v_max3_u32 v31, v72, v73, v74
  v_max_u32 v31, v31, v75
  v_cmp_eq_u32 vcc, -1, v31
  s_cbranch_vccz FL_x_12_ok2
FL_x_12_x2:
  s_mov_b64 exec, vcc
  buffer_load_dwordx4 v[72:75], v9, s[4:7], s41 offen offset:2048 sc1
  s_mov_b64 exec, -1
  s_add_u32 s46, s46, 1
  s_cmp_ge_u32 s46, 131072
  s_cbranch_scc1 FL_rec_abort
  s_waitcnt vmcnt(4)
  s_branch FL_x_12_c1
FL_x_12_ok1:
  v_mfma_f32_16x16x32_bf16 v[44:47], v[68:71], v[68:71], v[44:47]
  v_max3_u32 v31, v72, v73, v74
  v_max_u32 v31, v31, v75
  v_cmp_eq_u32 vcc, -1, v31
  v_mfma_f32_16x16x32_bf16 v[36:39], v[120:123], v[68:71], v[36:39]
  v_mfma_f32_16x16x32_bf16 v[40:43], v[136:139], v[68:71], v[40:43]
  s_cbranch_vccz FL_x_2_ok2
  s_branch FL_x_2_x2
FL_x_12_ok2:
  v_mfma_f32_16x16x32_bf16 v[44:47], v[72:75], v[72:75], v[44:47]
  v_max3_u32 v31, v68, v69, v70
  v_max_u32 v31, v31, v71
  v_cmp_eq_u32 vcc, -1, v31
  v_mfma_f32_16x16x32_bf16 v[36:39], v[124:127], v[72:75], v[36:39]
  v_mfma_f32_16x16x32_bf16 v[40:43], v[140:143], v[72:75], v[40:43]
  s_cbranch_vccz FL_x_1_ok1
  s_branch FL_x_1_x1
FL_x_13_c1:
  v_max3_u32 v31, v68, v69, v70
  v_max_u32 v31, v31, v71
  v_cmp_eq_u32 vcc, -1, v31
  s_cbranch_vccz FL_x_13_ok1
FL_x_13_x1:
  s_mov_b64 exec, vcc
  buffer_load_dwordx4 v[68:71], v9, s[4:7], s41 offen offset:1024 sc1
  s_mov_b64 exec, -1
FL_x_13_c3:
  v_max3_u32 v31, v76, v77, v78
  v_max_u32 v31, v31, v79
  v_cmp_eq_u32 vcc, -1, v31
  s_cbranch_vccz FL_x_13_ok3
FL_x_13_x3:
  s_mov_b64 exec, vcc
  buffer_load_dwordx4 v[76:79], v9, s[4:7], s41 offen offset:3072 sc1
  s_mov_b64 exec, -1
  s_add_u32 s46, s46, 1
  s_cmp_ge_u32 s46, 131072
  s_cbranch_scc1 FL_rec_abort
  s_waitcnt vmcnt(4)
  s_branch FL_x_13_c1
FL_x_13_ok1:
  v_mfma_f32_16x16x32_bf16 v[44:47], v[68:71], v[68:71], v[44:47]
  v_max3_u32 v31, v76, v77, v78
  v_max_u32 v31, v31, v79
  v_cmp_eq_u32 vcc, -1, v31
  v_mfma_f32_16x16x32_bf16 v[36:39], v[120:123], v[68:71], v[36:39]
  v_mfma_f32_16x16x32_bf16 v[40:43], v[136:139], v[68:71], v[40:43]
  s_cbranch_vccz FL_x_3_ok3
  s_branch FL_x_3_x3
FL_x_13_ok3:
  v_mfma_f32_16x16x32_bf16 v[44:47], v[76:79], v[76:79], v[44:47]
  v_max3_u32 v31, v68, v69, v70
  v_max_u32 v31, v31, v71
  v_cmp_eq_u32 vcc, -1, v31
  v_mfma_f32_16x16x32_bf16 v[36:39], v[128:131], v[76:79], v[36:39]
  v_mfma_f32_16x16x32_bf16 v[40:43], v[144:147], v[76:79], v[40:43]
  s_cbranch_vccz FL_x_1_ok1
  s_branch FL_x_1_x1
FL_x_23_c2:
  v_max3_u32 v31, v72, v73, v74
  v_max_u32 v31, v31, v75
  v_cmp_eq_u32 vcc, -1, v31
  s_cbranch_vccz FL_x_23_ok2
FL_x_23_x2:
  s_mov_b64 exec, vcc
  buffer_load_dwordx4 v[72:75], v9, s[4:7], s41 offen offset:2048 sc1
  s_mov_b64 exec, -1
FL_x_23_c3:
  v_max3_u32 v31, v76, v77, v78
  v_max_u32 v31, v31, v79
  v_cmp_eq_u32 vcc, -1, v31
  s_cbranch_vccz FL_x_23_ok3
FL_x_23_x3:
  s_mov_b64 exec, vcc
  buffer_load_dwordx4 v[76:79], v9, s[4:7], s41 offen offset:3072 sc1
  s_mov_b64 exec, -1
  s_add_u32 s46, s46, 1
  s_cmp_ge_u32 s46, 131072
  s_cbranch_scc1 FL_rec_abort
  s_waitcnt vmcnt(4)
  s_branch FL_x_23_c2
FL_x_23_ok2:
  v_mfma_f32_16x16x32_bf16 v[44:47], v[72:75], v[72:75], v[44:47]
  v_max3_u32 v31, v76, v77, v78
  v_max_u32 v31, v31, v79
  v_cmp_eq_u32 vcc, -1, v31
  v_mfma_f32_16x16x32_bf16 v[36:39], v[124:127], v[72:75], v[36:39]
  v_mfma_f32_16x16x32_bf16 v[40:43], v[140:143], v[72:75], v[40:43]
  s_cbranch_vccz FL_x_3_ok3
  s_branch FL_x_3_x3
FL_x_23_ok3:
  v_mfma_f32_16x16x32_bf16 v[44:47], v[76:79], v[76:79], v[44:47]
  v_max3_u32 v31, v72, v73, v74
  v_max_u32 v31, v31, v75
  v_cmp_eq_u32 vcc, -1, v31
  v_mfma_f32_16x16x32_bf16 v[36:39], v[128:131], v[76:79], v[36:39]
  v_mfma_f32_16x16x32_bf16 v[40:43], v[144:147], v[76:79], v[40:43]
  s_cbranch_vccz FL_x_2_ok2
  s_branch FL_x_2_x2
FL_x_012_c0:
  v_max3_u32 v31, v64, v65, v66
  v_max_u32 v31, v31, v67
  v_cmp_eq_u32 vcc, -1, v31
  s_cbranch_vccz FL_x_012_ok0
FL_x_012_x0:
  s_mov_b64 exec, vcc
  buffer_load_dwordx4 v[64:67], v9, s[4:7], s41 offen offset:0 sc1
  s_mov_b64 exec, -1
FL_x_012_c1:
  v_max3_u32 v31, v68, v69, v70
  v_max_u32 v31, v31, v71
  v_cmp_eq_u32 vcc, -1, v31
  s_cbranch_vccz FL_x_012_ok1
FL_x_012_x1:
  s_mov_b64 exec, vcc
  buffer_load_dwordx4 v[68:71], v9, s[4:7], s41 offen offset:1024 sc1
  s_mov_b64 exec, -1
FL_x_012_c2:
  v_max3_u32 v31, v72, v73, v74
  v_max_u32 v31, v31, v75
  v_cmp_eq_u32 vcc, -1, v31
  s_cbranch_vccz FL_x_012_ok2
FL_x_012_x2:
  s_mov_b64 exec, vcc
  buffer_load_dwordx4 v[72:75], v9, s[4:7], s41 offen offset:2048 sc1
  s_mov_b64 exec, -1
  s_add_u32 s46, s46, 1
  s_cmp_ge_u32 s46, 131072
  s_cbranch_scc1 FL_rec_abort
  s_waitcnt vmcnt(4)
  s_branch FL_x_012_c0
FL_x_012_ok0:
  v_mfma_f32_16x16x32_bf16 v[44:47], v[64:67], v[64:67], v[44:47]
  v_max3_u32 v31, v68, v69, v70
  v_max_u32 v31, v31, v71
  v_cmp_eq_u32 vcc, -1, v31
  v_mfma_f32_16x16x32_bf16 v[36:39], v[116:119], v[64:67], v[36:39]
  v_mfma_f32_16x16x32_bf16 v[40:43], v[132:135], v[64:67], v[40:43]
  s_cbranch_vccz FL_x_12_ok1
  s_branch FL_x_12_x1
FL_x_012_ok1:
  v_mfma_f32_16x16x32_bf16 v[44:47], v[68:71], v[68:71], v[44:47]
  v_max3_u32 v31, v72, v73, v74
  v_max_u32 v31, v31, v75
  v_cmp_eq_u32 vcc, -1, v31
  v_mfma_f32_16x16x32_bf16 v[36:39], v[120:123], v[68:71], v[36:39]
  v_mfma_f32_16x16x32_bf16 v[40:43], v[136:139], v[68:71], v[40:43]
  s_cbranch_vccz FL_x_02_ok2
  s_branch FL_x_02_x2
FL_x_012_ok2:
  v_mfma_f32_16x16x32_bf16 v[44:47], v[72:75], v[72:75], v[44:47]
  v_max3_u32 v31, v64, v65, v66
  v_max_u32 v31, v31, v67
  v_cmp_eq_u32 vcc, -1, v31
  v_mfma_f32_16x16x32_bf16 v[36:39], v[124:127], v[72:75], v[36:39]
  v_mfma_f32_16x16x32_bf16 v[40:43], v[140:143], v[72:75], v[40:43]
  s_cbranch_vccz FL_x_01_ok0
  s_branch FL_x_01_x0
FL_x_013_c0:
  v_max3_u32 v31, v64, v65, v66
  v_max_u32 v31, v31, v67
  v_cmp_eq_u32 vcc, -1, v31
  s_cbranch_vccz FL_x_013_ok0
FL_x_013_x0:
  s_mov_b64 exec, vcc
  buffer_load_dwordx4 v[64:67], v9, s[4:7], s41 offen offset:0 sc1
  s_mov_b64 exec, -1
FL_x_013_c1:
  v_max3_u32 v31, v68, v69, v70
  v_max_u32 v31, v31, v71
  v_cmp_eq_u32 vcc, -1, v31
  s_cbranch_vccz FL_x_013_ok1
FL_x_013_x1:
  s_mov_b64 exec, vcc
  buffer_load_dwordx4 v[68:71], v9, s[4:7], s41 offen offset:1024 sc1
  s_mov_b64 exec, -1
FL_x_013_c3:
  v_max3_u32 v31, v76, v77, v78
  v_max_u32 v31, v31, v79
  v_cmp_eq_u32 vcc, -1, v31
  s_cbranch_vccz FL_x_013_ok3
FL_x_013_x3:
  s_mov_b64 exec, vcc
  buffer_load_dwordx4 v[76:79], v9, s[4:7], s41 offen offset:3072 sc1
  s_mov_b64 exec, -1
  s_add_u32 s46, s46, 1
  s_cmp_ge_u32 s46, 131072
  s_cbranch_scc1 FL_rec_abort
  s_waitcnt vmcnt(4)
  s_branch FL_x_013_c0
FL_x_013_ok0:
  v_mfma_f32_16x16x32_bf16 v[44:47], v[64:67], v[64:67], v[44:47]
  v_max3_u32 v31, v68, v69, v70
  v_max_u32 v31, v31, v71
  v_cmp_eq_u32 vcc, -1, v31
  v_mfma_f32_16x16x32_bf16 v[36:39], v[116:119], v[64:67], v[36:39]
  v_mfma_f32_16x16x32_bf16 v[40:43], v[132:135], v[64:67], v[40:43]
  s_cbranch_vccz FL_x_13_ok1
  s_branch FL_x_13_x1
FL_x_013_ok1:
  v_mfma_f32_16x16x32_bf16 v[44:47], v[68:71], v[68:71], v[44:47]
  v_max3_u32 v31, v76, v77, v78
  v_max_u32 v31, v31, v79
  v_cmp_eq_u32 vcc, -1, v31
  v_mfma_f32_16x16x32_bf16 v[36:39], v[120:123], v[68:71], v[36:39]
  v_mfma_f32_16x16x32_bf16 v[40:43], v[136:139], v[68:71], v[40:43]
  s_cbranch_vccz FL_x_03_ok3
  s_branch FL_x_03_x3
FL_x_013_ok3:
  v_mfma_f32_16x16x32_bf16 v[44:47], v[76:79], v[76:79], v[44:47]
  v_max3_u32 v31, v64, v65, v66
  v_max_u32 v31, v31, v67
  v_cmp_eq_u32 vcc, -1, v31
  v_mfma_f32_16x16x32_bf16 v[36:39], v[128:131], v[76:79], v[36:39]
  v_mfma_f32_16x16x32_bf16 v[40:43], v[144:147], v[76:79], v[40:43]
  s_cbranch_vccz FL_x_01_ok0
  s_branch FL_x_01_x0
FL_x_023_c0:
  v_max3_u32 v31, v64, v65, v66
  v_max_u32 v31, v31, v67
  v_cmp_eq_u32 vcc, -1, v31
  s_cbranch_vccz FL_x_023_ok0
FL_x_023_x0:
  s_mov_b64 exec, vcc
  buffer_load_dwordx4 v[64:67], v9, s[4:7], s41 offen offset:0 sc1
  s_mov_b64 exec, -1
FL_x_023_c2:
  v_max3_u32 v31, v72, v73, v74
  v_max_u32 v31, v31, v75
  v_cmp_eq_u32 vcc, -1, v31
  s_cbranch_vccz FL_x_023_ok2
FL_x_023_x2:
  s_mov_b64 exec, vcc
  buffer_load_dwordx4 v[72:75], v9, s[4:7], s41 offen offset:2048 sc1
  s_mov_b64 exec, -1
FL_x_023_c3:
  v_max3_u32 v31, v76, v77, v78
  v_max_u32 v31, v31, v79
  v_cmp_eq_u32 vcc, -1, v31
  s_cbranch_vccz FL_x_023_ok3
FL_x_023_x3:
  s_mov_b64 exec, vcc
  buffer_load_dwordx4 v[76:79], v9, s[4:7], s41 offen offset:3072 sc1
  s_mov_b64 exec, -1
  s_add_u32 s46, s46, 1
  s_cmp_ge_u32 s46, 131072
  s_cbranch_scc1 FL_rec_abort
  s_waitcnt vmcnt(4)
  s_branch FL_x_023_c0
FL_x_023_ok0:
  v_mfma_f32_16x16x32_bf16 v[44:47], v[64:67], v[64:67], v[44:47]
  v_max3_u32 v31, v72, v73, v74
  v_max_u32 v31, v31, v75
  v_cmp_eq_u32 vcc, -1, v31
  v_mfma_f32_16x16x32_bf16 v[36:39], v[116:119], v[64:67], v[36:39]
  v_mfma_f32_16x16x32_bf16 v[40:43], v[132:135], v[64:67], v[40:43]
  s_cbranch_vccz FL_x_23_ok2
  s_branch FL_x_23_x2
FL_x_023_ok2:
  v_mfma_f32_16x16x32_bf16 v[44:47], v[72:75], v[72:75], v[44:47]
  v_max3_u32 v31, v76, v77, v78
  v_max_u32 v31, v31, v79
  v_cmp_eq_u32 vcc, -1, v31
  v_mfma_f32_16x16x32_bf16 v[36:39], v[124:127], v[72:75], v[36:39]
  v_mfma_f32_16x16x32_bf16 v[40:43], v[140:143], v[72:75], v[40:43]
  s_cbranch_vccz FL_x_03_ok3
  s_branch FL_x_03_x3
FL_x_023_ok3:
  v_mfma_f32_16x16x32_bf16 v[44:47], v[76:79], v[76:79], v[44:47]
  v_max3_u32 v31, v64, v65, v66
  v_max_u32 v31, v31, v67
  v_cmp_eq_u32 vcc, -1, v31
  v_mfma_f32_16x16x32_bf16 v[36:39], v[128:131], v[76:79], v[36:39]
  v_mfma_f32_16x16x32_bf16 v[40:43], v[144:147], v[76:79], v[40:43]
  s_cbranch_vccz FL_x_02_ok0
  s_branch FL_x_02_x0
FL_x_123_c1:
  v_max3_u32 v31, v68, v69, v70
  v_max_u32 v31, v31, v71
  v_cmp_eq_u32 vcc, -1, v31
  s_cbranch_vccz FL_x_123_ok1
FL_x_123_x1:
  s_mov_b64 exec, vcc
  buffer_load_dwordx4 v[68:71], v9, s[4:7], s41 offen offset:1024 sc1
  s_mov_b64 exec, -1
FL_x_123_c2:
  v_max3_u32 v31, v72, v73, v74
  v_max_u32 v31, v31, v75
  v_cmp_eq_u32 vcc, -1, v31
  s_cbranch_vccz FL_x_123_ok2
FL_x_123_x2:
  s_mov_b64 exec, vcc
  buffer_load_dwordx4 v[72:75], v9, s[4:7], s41 offen offset:2048 sc1
  s_mov_b64 exec, -1
FL_x_123_c3:
  v_max3_u32 v31, v76, v77, v78
  v_max_u32 v31, v31, v79
  v_cmp_eq_u32 vcc, -1, v31
  s_cbranch_vccz FL_x_123_ok3
FL_x_123_x3:
  s_mov_b64 exec, vcc
  buffer_load_dwordx4 v[76:79], v9, s[4:7], s41 offen offset:3072 sc1
  s_mov_b64 exec, -1
  s_add_u32 s46, s46, 1
  s_cmp_ge_u32 s46, 131072
  s_cbranch_scc1 FL_rec_abort
  s_waitcnt vmcnt(4)
  s_branch FL_x_123_c1
FL_x_123_ok1:
  v_mfma_f32_16x16x32_bf16 v[44:47], v[68:71], v[68:71], v[44:47]
  v_max3_u32 v31, v72, v73, v74
  v_max_u32 v31, v31, v75
  v_cmp_eq_u32 vcc, -1, v31
  v_mfma_f32_16x16x32_bf16 v[36:39], v[120:123], v[68:71], v[36:39]
  v_mfma_f32_16x16x32_bf16 v[40:43], v[136:139], v[68:71], v[40:43]
  s_cbranch_vccz FL_x_23_ok2
  s_branch FL_x_23_x2
FL_x_123_ok2:
  v_mfma_f32_16x16x32_bf16 v[44:47], v[72:75], v[72:75], v[44:47]
  v_max3_u32 v31, v76, v77, v78
  v_max_u32 v31, v31, v79
  v_cmp_eq_u32 vcc, -1, v31
  v_mfma_f32_16x16x32_bf16 v[36:39], v[124:127], v[72:75], v[36:39]
  v_mfma_f32_16x16x32_bf16 v[40:43], v[140:143], v[72:75], v[40:43]
  s_cbranch_vccz FL_x_13_ok3
  s_branch FL_x_13_x3
FL_x_123_ok3:
  v_mfma_f32_16x16x32_bf16 v[44:47], v[76:79], v[76:79], v[44:47]
  v_max3_u32 v31, v68, v69, v70
  v_max_u32 v31, v31, v71
  v_cmp_eq_u32 vcc, -1, v31
  v_mfma_f32_16x16x32_bf16 v[36:39], v[128:131], v[76:79], v[36:39]
  v_mfma_f32_16x16x32_bf16 v[40:43], v[144:147], v[76:79], v[40:43]
  s_cbranch_vccz FL_x_12_ok1
  s_branch FL_x_12_x1
FL_x_0123_c0:
  v_max3_u32 v31, v64, v65, v66
  v_max_u32 v31, v31, v67
  v_cmp_eq_u32 vcc, -1, v31
  s_cbranch_vccz FL_x_0123_ok0
FL_x_0123_x0:
  s_mov_b64 exec, vcc
  buffer_load_dwordx4 v[64:67], v9, s[4:7], s41 offen offset:0 sc1
  s_mov_b64 exec, -1
FL_x_0123_c1:
  v_max3_u32 v31, v68, v69, v70
  v_max_u32 v31, v31, v71
  v_cmp_eq_u32 vcc, -1, v31
  s_cbranch_vccz FL_x_0123_ok1
FL_x_0123_x1:
  s_mov_b64 exec, vcc
  buffer_load_dwordx4 v[68:71], v9, s[4:7], s41 offen offset:1024 sc1
  s_mov_b64 exec, -1
FL_x_0123_c2:
  v_max3_u32 v31, v72, v73, v74
  v_max_u32 v31, v31, v75
  v_cmp_eq_u32 vcc, -1, v31
  s_cbranch_vccz FL_x_0123_ok2
FL_x_0123_x2:
  s_mov_b64 exec, vcc
  buffer_load_dwordx4 v[72:75], v9, s[4:7], s41 offen offset:2048 sc1
  s_mov_b64 exec, -1
FL_x_0123_c3:
  v_max3_u32 v31, v76, v77, v78
  v_max_u32 v31, v31, v79
  v_cmp_eq_u32 vcc, -1, v31
  s_cbranch_vccz FL_x_0123_ok3
FL_x_0123_x3:
  s_mov_b64 exec, vcc
  buffer_load_dwordx4 v[76:79], v9, s[4:7], s41 offen offset:3072 sc1
  s_mov_b64 exec, -1
  s_add_u32 s46, s46, 1
  s_cmp_ge_u32 s46, 131072
  s_cbranch_scc1 FL_rec_abort
  s_waitcnt vmcnt(4)
  s_branch FL_x_0123_c0
FL_x_0123_ok0:
  v_mfma_f32_16x16x32_bf16 v[44:47], v[64:67], v[64:67], v[44:47]
  v_max3_u32 v31, v68, v69, v70
  v_max_u32 v31, v31, v71
  v_cmp_eq_u32 vcc, -1, v31
  v_mfma_f32_16x16x32_bf16 v[36:39], v[116:119], v[64:67], v[36:39]
  v_mfma_f32_16x16x32_bf16 v[40:43], v[132:135], v[64:67], v[40:43]
  s_cbranch_vccz FL_x_123_ok1
  s_branch FL_x_123_x1
FL_x_0123_ok1:
  v_mfma_f32_16x16x32_bf16 v[44:47], v[68:71], v[68:71], v[44:47]
  v_max3_u32 v31, v72, v73, v74
  v_max_u32 v31, v31, v75
  v_cmp_eq_u32 vcc, -1, v31
  v_mfma_f32_16x16x32_bf16 v[36:39], v[120:123], v[68:71], v[36:39]
  v_mfma_f32_16x16x32_bf16 v[40:43], v[136:139], v[68:71], v[40:43]
  s_cbranch_vccz FL_x_023_ok2
  s_branch FL_x_023_x2
FL_x_0123_ok2:
  v_mfma_f32_16x16x32_bf16 v[44:47], v[72:75], v[72:75], v[44:47]
  v_max3_u32 v31, v76, v77, v78
  v_max_u32 v31, v31, v79
  v_cmp_eq_u32 vcc, -1, v31
  v_mfma_f32_16x16x32_bf16 v[36:39], v[124:127], v[72:75], v[36:39]
  v_mfma_f32_16x16x32_bf16 v[40:43], v[140:143], v[72:75], v[40:43]
  s_cbranch_vccz FL_x_013_ok3
  s_branch FL_x_013_x3
FL_x_0123_ok3:
  v_mfma_f32_16x16x32_bf16 v[44:47], v[76:79], v[76:79], v[44:47]
  v_max3_u32 v31, v64, v65, v66
  v_max_u32 v31, v31, v67
  v_cmp_eq_u32 vcc, -1, v31
  v_mfma_f32_16x16x32_bf16 v[36:39], v[128:131], v[76:79], v[36:39]
  v_mfma_f32_16x16x32_bf16 v[40:43], v[144:147], v[76:79], v[40:43]
  s_cbranch_vccz FL_x_012_ok0
  s_branch FL_x_012_x0
FL_v_f:
  buffer_load_dwordx4 v[88:91], v10, s[4:7], s41 offen offset:0 sc1
  buffer_load_dwordx4 v[92:95], v10, s[4:7], s41 offen offset:1024 sc1
  s_add_u32 s46, s46, 1
  s_cmp_ge_u32 s46, 131072
  s_cbranch_scc1 FL_rec_abort
  s_waitcnt vmcnt(0)
  v_max3_u32 v31, v88, v89, v90
  v_max3_u32 v31, v31, v91, v92
  v_max3_u32 v31, v31, v93, v94
  v_max_u32 v31, v31, v95
  v_cmp_eq_u32 vcc, -1, v31
  s_cbranch_vccnz FL_v_f
  s_branch FL_v_ok
FL_rec_abort:
  s_waitcnt vmcnt(0)
  s_endpgm
L_recslow:
  s_load_dwordx4 s[80:83], s[0:1], 8
  s_load_dwordx4 s[84:87], s[0:1], 24
  s_load_dwordx2 s[88:89], s[0:1], 40
  v_lshrrev_b32 v31, 6, v0
  s_nop 0
  v_readfirstlane_b32 s32, v31
  v_and_b32 v0, 63, v0
  s_lshr_b32 s35, s34, 4
  s_lshl_b32 s90, s33, 1
  s_add_u32 s35, s35, s90
  s_and_b32 s36, s34, 15
  s_lshr_b32 s37, s36, 2
  s_lshl_b32 s90, s35, 2
  s_add_u32 s37, s37, s90
  s_and_b32 s38, s36, 3
  s_waitcnt lgkmcnt(0)
  s_mov_b32 s24, s80
  s_and_b32 s25, s81, 0xffff
  s_mov_b32 s26, 0x4000
  s_mov_b32 s27, 0x20000
  s_mov_b32 s8, s82
  s_and_b32 s9, s83, 0xffff
  s_mov_b32 s10, 0x800000
  s_mov_b32 s11, 0x20000
  s_mov_b32 s12, s84
  s_and_b32 s13, s85, 0xffff
  s_mov_b32 s14, 0x800000
  s_mov_b32 s15, 0x20000
  s_mov_b32 s16, s86
  s_and_b32 s17, s87, 0xffff
  s_mov_b32 s18, 0x800000
  s_mov_b32 s19, 0x20000
  s_mov_b32 s20, s88
  s_and_b32 s21, s89, 0xffff
  s_mov_b32 s22, 0x800000
  s_mov_b32 s23, 0x20000
  s_lshl_b32 s90, s32, 21
  s_lshl_b32 s91, s37, 8
  s_add_u32 s90, s90, s91
  s_lshr_b32 s91, s38, 1
  s_lshl_b32 s91, s91, 7
  s_add_u32 s90, s90, s91
  v_mov_b32 v1, 0x0
  v_bfe_u32 v31, v0, 3, 3
  v_lshl_add_u32 v1, v31, 13, v1
  v_bfe_u32 v31, v0, 0, 3
  v_lshl_add_u32 v1, v31, 4, v1
  v_add_u32 v1, s90, v1
  s_lshl_b32 s90, s35, 2
  s_add_u32 s90, s90, s32
  s_lshl_b32 s90, s90, 18
  s_lshl_b32 s91, s36, 7
  s_add_u32 s90, s90, s91
  v_mov_b32 v2, 0x0
  v_bfe_u32 v31, v0, 3, 3
  v_lshl_add_u32 v2, v31, 11, v2
  v_bfe_u32 v31, v0, 0, 3
  v_lshl_add_u32 v2, v31, 4, v2
  v_add_u32 v2, s90, v2
  s_lshl_b32 s96, s32, 15
  s_and_b32 s91, s38, 1
  s_lshl_b32 s91, s91, 6
  s_add_u32 s91, s91, s96
  v_mov_b32 v3, 0x0
  v_bfe_u32 v31, v0, 5, 1
  v_lshl_add_u32 v3, v31, 11, v3
  v_bfe_u32 v31, v0, 4, 1
  v_lshl_add_u32 v3, v31, 10, v3
  v_bfe_u32 v31, v0, 2, 2
  v_lshl_add_u32 v3, v31, 7, v3
  v_bfe_u32 v31, v0, 0, 2
  v_lshl_add_u32 v3, v31, 3, v3
  v_add_u32 v3, s91, v3
  s_lshl_b32 s91, s32, 5
  v_mov_b32 v4, 0x0
  v_bfe_u32 v31, v0, 4, 1
  v_lshl_add_u32 v4, v31, 13, v4
  v_bfe_u32 v31, v0, 5, 1
  v_lshl_add_u32 v4, v31, 8, v4
  v_bfe_u32 v31, v0, 2, 1
  v_lshl_add_u32 v4, v31, 10, v4
  v_bfe_u32 v31, v0, 3, 1
  v_lshl_add_u32 v4, v31, 7, v4
  v_bfe_u32 v31, v0, 0, 2
  v_lshl_add_u32 v4, v31, 3, v4
  v_add_u32 v4, s91, v4
  v_add_u32 v5, 0x10000, v4
  s_lshl_b32 s97, s34, 2
  s_add_u32 s97, s97, s32
  s_lshl_b32 s98, s97, 14
  s_lshl_b32 s91, s33, 21
  s_add_u32 s98, s98, s91
  s_lshl_b32 s97, s97, 16
  s_lshl_b32 s91, s33, 11
  s_add_u32 s97, s97, s91
  v_mov_b32 v16, 0x0
  v_bfe_u32 v31, v0, 0, 4
  v_lshl_add_u32 v16, v31, 7, v16
  v_bfe_u32 v31, v0, 4, 2
  v_lshl_add_u32 v16, v31, 13, v16
  v_add_u32 v17, 0x8000, v16
  v_lshlrev_b32 v18, 7, v0
  v_add_u32 v19, 0x2000, v18
  s_lshl_b32 s58, s33, 5
  s_add_u32 s58, s58, s34
  s_lshl_b32 s59, s32, 19
  s_add_u32 s59, s59, 0x3800000
  s_lshl_b32 s90, s58, 11
  s_add_u32 s90, s90, s59
  s_mul_i32 s91, s58, 3072
  s_add_u32 s91, s91, s59
  s_add_u32 s91, s91, 0x200000
  v_lshlrev_b32 v6, 4, v0
  v_mov_b32 v8, -1
  v_mov_b32 v12, 0
  v_mov_b32 v9, -1
  v_mov_b32 v13, 0
  v_mov_b32 v10, -1
  v_mov_b32 v14, 0
  v_mov_b32 v11, -1
  v_mov_b32 v15, 0
  buffer_store_dwordx4 v[8:11], v6, s[4:7], s90 offen offset:0 sc1
  buffer_store_dwordx4 v[8:11], v6, s[4:7], s90 offen offset:1024 sc1
  buffer_store_dwordx4 v[8:11], v6, s[4:7], s91 offen offset:0 sc1
  buffer_store_dwordx4 v[8:11], v6, s[4:7], s91 offen offset:1024 sc1
  buffer_store_dwordx4 v[8:11], v6, s[4:7], s91 offen offset:2048 sc1
  s_lshl_b32 s58, s58, 2
  s_add_u32 s58, s58, s32
  s_cmp_ge_u32 s58, 24
  s_cbranch_scc1 SL_nz_1
  s_lshl_b32 s90, s58, 10
  s_add_u32 s90, s90, 0x3d00000
  buffer_store_dwordx4 v[12:15], v6, s[4:7], s90 offen sc1
SL_nz_1:
  s_add_u32 m0, s96, 0
  s_mov_b32 s90, 0x0
  buffer_load_dwordx4 v1, s[12:15], s90 offen  lds
  s_add_u32 m0, s96, 1024
  s_mov_b32 s90, 0x10000
  buffer_load_dwordx4 v1, s[12:15], s90 offen  lds
  s_add_u32 m0, s96, 2048
  s_mov_b32 s90, 0x20000
  buffer_load_dwordx4 v1, s[12:15], s90 offen  lds
  s_add_u32 m0, s96, 3072
  s_mov_b32 s90, 0x30000
  buffer_load_dwordx4 v1, s[12:15], s90 offen  lds
  s_add_u32 m0, s96, 4096
  s_mov_b32 s90, 0x0
  buffer_load_dwordx4 v1, s[16:19], s90 offen  lds
  s_add_u32 m0, s96, 5120
  s_mov_b32 s90, 0x10000
  buffer_load_dwordx4 v1, s[16:19], s90 offen  lds
  s_add_u32 m0, s96, 6144
  s_mov_b32 s90, 0x20000
  buffer_load_dwordx4 v1, s[16:19], s90 offen  lds
  s_add_u32 m0, s96, 7168
  s_mov_b32 s90, 0x30000
  buffer_load_dwordx4 v1, s[16:19], s90 offen  lds
  s_add_u32 m0, s96, 8192
  s_mov_b32 s90, 0x40000
  buffer_load_dwordx4 v1, s[12:15], s90 offen  lds
  s_add_u32 m0, s96, 9216
  s_mov_b32 s90, 0x50000
  buffer_load_dwordx4 v1, s[12:15], s90 offen  lds
  s_add_u32 m0, s96, 10240
  s_mov_b32 s90, 0x60000
  buffer_load_dwordx4 v1, s[12:15], s90 offen  lds
  s_add_u32 m0, s96, 11264
  s_mov_b32 s90, 0x70000
  buffer_load_dwordx4 v1, s[12:15], s90 offen  lds
  s_add_u32 m0, s96, 12288
  s_mov_b32 s90, 0x40000
  buffer_load_dwordx4 v1, s[16:19], s90 offen  lds
  s_add_u32 m0, s96, 13312
  s_mov_b32 s90, 0x50000
  buffer_load_dwordx4 v1, s[16:19], s90 offen  lds
  s_add_u32 m0, s96, 14336
  s_mov_b32 s90, 0x60000
  buffer_load_dwordx4 v1, s[16:19], s90 offen  lds
  s_add_u32 m0, s96, 15360
  s_mov_b32 s90, 0x70000
  buffer_load_dwordx4 v1, s[16:19], s90 offen  lds
  s_add_u32 m0, s96, 16384
  s_mov_b32 s90, 0x80000
  buffer_load_dwordx4 v1, s[12:15], s90 offen  lds
  s_add_u32 m0, s96, 17408
  s_mov_b32 s90, 0x90000
  buffer_load_dwordx4 v1, s[12:15], s90 offen  lds
  s_add_u32 m0, s96, 18432
  s_mov_b32 s90, 0xa0000
  buffer_load_dwordx4 v1, s[12:15], s90 offen  lds
  s_add_u32 m0, s96, 19456
  s_mov_b32 s90, 0xb0000
  buffer_load_dwordx4 v1, s[12:15], s90 offen  lds
  s_add_u32 m0, s96, 20480
  s_mov_b32 s90, 0x80000
  buffer_load_dwordx4 v1, s[16:19], s90 offen  lds
  s_add_u32 m0, s96, 21504
  s_mov_b32 s90, 0x90000
  buffer_load_dwordx4 v1, s[16:19], s90 offen  lds
  s_add_u32 m0, s96, 22528
  s_mov_b32 s90, 0xa0000
  buffer_load_dwordx4 v1, s[16:19], s90 offen  lds
  s_add_u32 m0, s96, 23552
  s_mov_b32 s90, 0xb0000
  buffer_load_dwordx4 v1, s[16:19], s90 offen  lds
  s_add_u32 m0, s96, 24576
  s_mov_b32 s90, 0xc0000
  buffer_load_dwordx4 v1, s[12:15], s90 offen  lds
  s_add_u32 m0, s96, 25600
  s_mov_b32 s90, 0xd0000
  buffer_load_dwordx4 v1, s[12:15], s90 offen  lds
  s_add_u32 m0, s96, 26624
  s_mov_b32 s90, 0xe0000
  buffer_load_dwordx4 v1, s[12:15], s90 offen  lds
  s_add_u32 m0, s96, 27648
  s_mov_b32 s90, 0xf0000
  buffer_load_dwordx4 v1, s[12:15], s90 offen  lds
  s_add_u32 m0, s96, 28672
  s_mov_b32 s90, 0xc0000
  buffer_load_dwordx4 v1, s[16:19], s90 offen  lds
  s_add_u32 m0, s96, 29696
  s_mov_b32 s90, 0xd0000
  buffer_load_dwordx4 v1, s[16:19], s90 offen  lds
  s_add_u32 m0, s96, 30720
  s_mov_b32 s90, 0xe0000
  buffer_load_dwordx4 v1, s[16:19], s90 offen  lds
  s_add_u32 m0, s96, 31744
  s_mov_b32 s90, 0xf0000
  buffer_load_dwordx4 v1, s[16:19], s90 offen  lds
  s_waitcnt vmcnt(32)
  s_barrier
  s_cmp_lg_u32 s32, 0
  s_cbranch_scc1 SL_sig_2
  v_mov_b32 v254, 1
  v_mov_b32 v255, 0
  s_mov_b64 exec, 1
  buffer_atomic_add v254, v255, s[28:31], s100 offen offset:132 sc1
  s_mov_b64 exec, -1
SL_sig_2:
  s_waitcnt vmcnt(28)
  ds_read_b64_tr_b16 a[16:17], v3 offset:0
  ds_read_b64_tr_b16 a[18:19], v3 offset:512
  ds_read_b64_tr_b16 a[24:25], v3 offset:32
  ds_read_b64_tr_b16 a[26:27], v3 offset:544
  s_waitcnt lgkmcnt(0)
  s_add_u32 m0, s96, 0
  s_mov_b32 s90, 0x100000
  buffer_load_dwordx4 v1, s[12:15], s90 offen  lds
  s_add_u32 m0, s96, 1024
  s_mov_b32 s90, 0x110000
  buffer_load_dwordx4 v1, s[12:15], s90 offen  lds
  s_add_u32 m0, s96, 2048
  s_mov_b32 s90, 0x120000
  buffer_load_dwordx4 v1, s[12:15], s90 offen  lds
  s_add_u32 m0, s96, 3072
  s_mov_b32 s90, 0x130000
  buffer_load_dwordx4 v1, s[12:15], s90 offen  lds
  s_waitcnt vmcnt(28)
  ds_read_b64_tr_b16 a[32:33], v3 offset:4096
  ds_read_b64_tr_b16 a[34:35], v3 offset:4608
  ds_read_b64_tr_b16 a[40:41], v3 offset:4128
  ds_read_b64_tr_b16 a[42:43], v3 offset:4640
  s_waitcnt lgkmcnt(0)
  s_add_u32 m0, s96, 4096
  s_mov_b32 s90, 0x100000
  buffer_load_dwordx4 v1, s[16:19], s90 offen  lds
  s_add_u32 m0, s96, 5120
  s_mov_b32 s90, 0x110000
  buffer_load_dwordx4 v1, s[16:19], s90 offen  lds
  s_add_u32 m0, s96, 6144
  s_mov_b32 s90, 0x120000
  buffer_load_dwordx4 v1, s[16:19], s90 offen  lds
  s_add_u32 m0, s96, 7168
  s_mov_b32 s90, 0x130000
  buffer_load_dwordx4 v1, s[16:19], s90 offen  lds
  s_waitcnt vmcnt(28)
  ds_read_b64_tr_b16 a[20:21], v3 offset:8192
  ds_read_b64_tr_b16 a[22:23], v3 offset:8704
  ds_read_b64_tr_b16 a[28:29], v3 offset:8224
  ds_read_b64_tr_b16 a[30:31], v3 offset:8736
  s_waitcnt lgkmcnt(0)
  s_add_u32 m0, s96, 8192
  s_mov_b32 s90, 0x140000
  buffer_load_dwordx4 v1, s[12:15], s90 offen  lds
  s_add_u32 m0, s96, 9216
  s_mov_b32 s90, 0x150000
  buffer_load_dwordx4 v1, s[12:15], s90 offen  lds
  s_add_u32 m0, s96, 10240
  s_mov_b32 s90, 0x160000
  buffer_load_dwordx4 v1, s[12:15], s90 offen  lds
  s_add_u32 m0, s96, 11264
  s_mov_b32 s90, 0x170000
  buffer_load_dwordx4 v1, s[12:15], s90 offen  lds
  s_waitcnt vmcnt(28)
  ds_read_b64_tr_b16 a[36:37], v3 offset:12288
  ds_read_b64_tr_b16 a[38:39], v3 offset:12800
  ds_read_b64_tr_b16 a[44:45], v3 offset:12320
  ds_read_b64_tr_b16 a[46:47], v3 offset:12832
  s_waitcnt lgkmcnt(0)
  s_add_u32 m0, s96, 12288
  s_mov_b32 s90, 0x140000
  buffer_load_dwordx4 v1, s[16:19], s90 offen  lds
  s_add_u32 m0, s96, 13312
  s_mov_b32 s90, 0x150000
  buffer_load_dwordx4 v1, s[16:19], s90 offen  lds
  s_add_u32 m0, s96, 14336
  s_mov_b32 s90, 0x160000
  buffer_load_dwordx4 v1, s[16:19], s90 offen  lds
  s_add_u32 m0, s96, 15360
  s_mov_b32 s90, 0x170000
  buffer_load_dwordx4 v1, s[16:19], s90 offen  lds
  s_waitcnt vmcnt(28)
  ds_read_b64_tr_b16 a[64:65], v3 offset:16384
  ds_read_b64_tr_b16 a[66:67], v3 offset:16896
  ds_read_b64_tr_b16 a[72:73], v3 offset:16416
  ds_read_b64_tr_b16 a[74:75], v3 offset:16928
  s_waitcnt lgkmcnt(0)
  s_add_u32 m0, s96, 16384
  s_mov_b32 s90, 0x180000
  buffer_load_dwordx4 v1, s[12:15], s90 offen  lds
  s_add_u32 m0, s96, 17408
  s_mov_b32 s90, 0x190000
  buffer_load_dwordx4 v1, s[12:15], s90 offen  lds
  s_add_u32 m0, s96, 18432
  s_mov_b32 s90, 0x1a0000
  buffer_load_dwordx4 v1, s[12:15], s90 offen  lds
  s_add_u32 m0, s96, 19456
  s_mov_b32 s90, 0x1b0000
  buffer_load_dwordx4 v1, s[12:15], s90 offen  lds
  s_waitcnt vmcnt(28)
  ds_read_b64_tr_b16 a[80:81], v3 offset:20480
  ds_read_b64_tr_b16 a[82:83], v3 offset:20992
  ds_read_b64_tr_b16 a[88:89], v3 offset:20512
  ds_read_b64_tr_b16 a[90:91], v3 offset:21024
  s_waitcnt lgkmcnt(0)
  s_add_u32 m0, s96, 20480
  s_mov_b32 s90, 0x180000
  buffer_load_dwordx4 v1, s[16:19], s90 offen  lds
  s_add_u32 m0, s96, 21504
  s_mov_b32 s90, 0x190000
  buffer_load_dwordx4 v1, s[16:19], s90 offen  lds
  s_add_u32 m0, s96, 22528
  s_mov_b32 s90, 0x1a0000
  buffer_load_dwordx4 v1, s[16:19], s90 offen  lds
  s_add_u32 m0, s96, 23552
  s_mov_b32 s90, 0x1b0000
  buffer_load_dwordx4 v1, s[16:19], s90 offen  lds
  s_waitcnt vmcnt(28)
  ds_read_b64_tr_b16 a[68:69], v3 offset:24576
  ds_read_b64_tr_b16 a[70:71], v3 offset:25088
  ds_read_b64_tr_b16 a[76:77], v3 offset:24608
  ds_read_b64_tr_b16 a[78:79], v3 offset:25120
  s_waitcnt lgkmcnt(0)
  s_add_u32 m0, s96, 24576
  s_mov_b32 s90, 0x1c0000
  buffer_load_dwordx4 v1, s[12:15], s90 offen  lds
  s_add_u32 m0, s96, 25600
  s_mov_b32 s90, 0x1d0000
  buffer_load_dwordx4 v1, s[12:15], s90 offen  lds
  s_add_u32 m0, s96, 26624
  s_mov_b32 s90, 0x1e0000
  buffer_load_dwordx4 v1, s[12:15], s90 offen  lds
  s_add_u32 m0, s96, 27648
  s_mov_b32 s90, 0x1f0000
  buffer_load_dwordx4 v1, s[12:15], s90 offen  lds
  s_waitcnt vmcnt(28)
  ds_read_b64_tr_b16 a[84:85], v3 offset:28672
  ds_read_b64_tr_b16 a[86:87], v3 offset:29184
  ds_read_b64_tr_b16 a[92:93], v3 offset:28704
  ds_read_b64_tr_b16 a[94:95], v3 offset:29216
  s_waitcnt lgkmcnt(0)
  s_add_u32 m0, s96, 28672
  s_mov_b32 s90, 0x1c0000
  buffer_load_dwordx4 v1, s[16:19], s90 offen  lds
  s_add_u32 m0, s96, 29696
  s_mov_b32 s90, 0x1d0000
  buffer_load_dwordx4 v1, s[16:19], s90 offen  lds
  s_add_u32 m0, s96, 30720
  s_mov_b32 s90, 0x1e0000
  buffer_load_dwordx4 v1, s[16:19], s90 offen  lds
  s_add_u32 m0, s96, 31744
  s_mov_b32 s90, 0x1f0000
  buffer_load_dwordx4 v1, s[16:19], s90 offen  lds
  s_waitcnt vmcnt(28)
  ds_read_b64_tr_b16 a[112:113], v3 offset:0
  ds_read_b64_tr_b16 a[114:115], v3 offset:512
  ds_read_b64_tr_b16 a[120:121], v3 offset:32
  ds_read_b64_tr_b16 a[122:123], v3 offset:544
  s_waitcnt lgkmcnt(0)
  s_add_u32 m0, s96, 0
  s_mov_b32 s90, 0x0
  buffer_load_dwordx4 v1, s[8:11], s90 offen  lds
  s_add_u32 m0, s96, 1024
  s_mov_b32 s90, 0x10000
  buffer_load_dwordx4 v1, s[8:11], s90 offen  lds
  s_add_u32 m0, s96, 2048
  s_mov_b32 s90, 0x20000
  buffer_load_dwordx4 v1, s[8:11], s90 offen  lds
  s_add_u32 m0, s96, 3072
  s_mov_b32 s90, 0x30000
  buffer_load_dwordx4 v1, s[8:11], s90 offen  lds
  s_waitcnt vmcnt(28)
  ds_read_b64_tr_b16 a[128:129], v3 offset:4096
  ds_read_b64_tr_b16 a[130:131], v3 offset:4608
  ds_read_b64_tr_b16 a[136:137], v3 offset:4128
  ds_read_b64_tr_b16 a[138:139], v3 offset:4640
  s_waitcnt lgkmcnt(0)
  s_add_u32 m0, s96, 4096
  s_mov_b32 s90, 0x40000
  buffer_load_dwordx4 v1, s[8:11], s90 offen  lds
  s_add_u32 m0, s96, 5120
  s_mov_b32 s90, 0x50000
  buffer_load_dwordx4 v1, s[8:11], s90 offen  lds
  s_add_u32 m0, s96, 6144
  s_mov_b32 s90, 0x60000
  buffer_load_dwordx4 v1, s[8:11], s90 offen  lds
  s_add_u32 m0, s96, 7168
  s_mov_b32 s90, 0x70000
  buffer_load_dwordx4 v1, s[8:11], s90 offen  lds
  s_waitcnt vmcnt(28)
  ds_read_b64_tr_b16 a[116:117], v3 offset:8192
  ds_read_b64_tr_b16 a[118:119], v3 offset:8704
  ds_read_b64_tr_b16 a[124:125], v3 offset:8224
  ds_read_b64_tr_b16 a[126:127], v3 offset:8736
  s_waitcnt lgkmcnt(0)
  s_add_u32 m0, s96, 8192
  s_mov_b32 s90, 0x80000
  buffer_load_dwordx4 v1, s[8:11], s90 offen  lds
  s_add_u32 m0, s96, 9216
  s_mov_b32 s90, 0x90000
  buffer_load_dwordx4 v1, s[8:11], s90 offen  lds
  s_add_u32 m0, s96, 10240
  s_mov_b32 s90, 0xa0000
  buffer_load_dwordx4 v1, s[8:11], s90 offen  lds
  s_add_u32 m0, s96, 11264
  s_mov_b32 s90, 0xb0000
  buffer_load_dwordx4 v1, s[8:11], s90 offen  lds
  s_waitcnt vmcnt(28)
  ds_read_b64_tr_b16 a[132:133], v3 offset:12288
  ds_read_b64_tr_b16 a[134:135], v3 offset:12800
  ds_read_b64_tr_b16 a[140:141], v3 offset:12320
  ds_read_b64_tr_b16 a[142:143], v3 offset:12832
  s_waitcnt lgkmcnt(0)
  s_add_u32 m0, s96, 12288
  s_mov_b32 s90, 0xc0000
  buffer_load_dwordx4 v1, s[8:11], s90 offen  lds
  s_add_u32 m0, s96, 13312
  s_mov_b32 s90, 0xd0000
  buffer_load_dwordx4 v1, s[8:11], s90 offen  lds
  s_add_u32 m0, s96, 14336
  s_mov_b32 s90, 0xe0000
  buffer_load_dwordx4 v1, s[8:11], s90 offen  lds
  s_add_u32 m0, s96, 15360
  s_mov_b32 s90, 0xf0000
  buffer_load_dwordx4 v1, s[8:11], s90 offen  lds
  s_waitcnt vmcnt(28)
  ds_read_b64_tr_b16 a[160:161], v3 offset:16384
  ds_read_b64_tr_b16 a[162:163], v3 offset:16896
  ds_read_b64_tr_b16 a[168:169], v3 offset:16416
  ds_read_b64_tr_b16 a[170:171], v3 offset:16928
  s_waitcnt lgkmcnt(0)
  s_add_u32 m0, s96, 16384
  s_mov_b32 s90, 0x100000
  buffer_load_dwordx4 v1, s[8:11], s90 offen  lds
  s_add_u32 m0, s96, 17408
  s_mov_b32 s90, 0x110000
  buffer_load_dwordx4 v1, s[8:11], s90 offen  lds
  s_add_u32 m0, s96, 18432
  s_mov_b32 s90, 0x120000
  buffer_load_dwordx4 v1, s[8:11], s90 offen  lds
  s_add_u32 m0, s96, 19456
  s_mov_b32 s90, 0x130000
  buffer_load_dwordx4 v1, s[8:11], s90 offen  lds
  s_waitcnt vmcnt(28)
  ds_read_b64_tr_b16 a[176:177], v3 offset:20480
  ds_read_b64_tr_b16 a[178:179], v3 offset:20992
  ds_read_b64_tr_b16 a[184:185], v3 offset:20512
  ds_read_b64_tr_b16 a[186:187], v3 offset:21024
  s_waitcnt lgkmcnt(0)
  s_add_u32 m0, s96, 20480
  s_mov_b32 s90, 0x140000
  buffer_load_dwordx4 v1, s[8:11], s90 offen  lds
  s_add_u32 m0, s96, 21504
  s_mov_b32 s90, 0x150000
  buffer_load_dwordx4 v1, s[8:11], s90 offen  lds
  s_add_u32 m0, s96, 22528
  s_mov_b32 s90, 0x160000
  buffer_load_dwordx4 v1, s[8:11], s90 offen  lds
  s_add_u32 m0, s96, 23552
  s_mov_b32 s90, 0x170000
  buffer_load_dwordx4 v1, s[8:11], s90 offen  lds
  s_waitcnt vmcnt(28)
  ds_read_b64_tr_b16 a[164:165], v3 offset:24576
  ds_read_b64_tr_b16 a[166:167], v3 offset:25088
  ds_read_b64_tr_b16 a[172:173], v3 offset:24608
  ds_read_b64_tr_b16 a[174:175], v3 offset:25120
  s_waitcnt lgkmcnt(0)
  s_add_u32 m0, s96, 24576
  s_mov_b32 s90, 0x180000
  buffer_load_dwordx4 v1, s[8:11], s90 offen  lds
  s_add_u32 m0, s96, 25600
  s_mov_b32 s90, 0x190000
  buffer_load_dwordx4 v1, s[8:11], s90 offen  lds
  s_add_u32 m0, s96, 26624
  s_mov_b32 s90, 0x1a0000
  buffer_load_dwordx4 v1, s[8:11], s90 offen  lds
  s_add_u32 m0, s96, 27648
  s_mov_b32 s90, 0x1b0000
  buffer_load_dwordx4 v1, s[8:11], s90 offen  lds
  s_waitcnt vmcnt(28)
  ds_read_b64_tr_b16 a[180:181], v3 offset:28672
  ds_read_b64_tr_b16 a[182:183], v3 offset:29184
  ds_read_b64_tr_b16 a[188:189], v3 offset:28704
  ds_read_b64_tr_b16 a[190:191], v3 offset:29216
  s_waitcnt lgkmcnt(0)
  s_add_u32 m0, s96, 28672
  s_mov_b32 s90, 0x1c0000
  buffer_load_dwordx4 v1, s[8:11], s90 offen  lds
  s_add_u32 m0, s96, 29696
  s_mov_b32 s90, 0x1d0000
  buffer_load_dwordx4 v1, s[8:11], s90 offen  lds
  s_add_u32 m0, s96, 30720
  s_mov_b32 s90, 0x1e0000
  buffer_load_dwordx4 v1, s[8:11], s90 offen  lds
  s_add_u32 m0, s96, 31744
  s_mov_b32 s90, 0x1f0000
  buffer_load_dwordx4 v1, s[8:11], s90 offen  lds
  s_waitcnt vmcnt(28)
  ds_read_b64_tr_b16 a[0:1], v3 offset:0
  ds_read_b64_tr_b16 a[2:3], v3 offset:512
  ds_read_b64_tr_b16 a[8:9], v3 offset:32
  ds_read_b64_tr_b16 a[10:11], v3 offset:544
  s_waitcnt lgkmcnt(0)
  s_add_u32 m0, s96, 0
  s_mov_b32 s90, 0x0
  buffer_load_dwordx4 v2, s[20:23], s90 offen  lds
  s_add_u32 m0, s96, 1024
  s_mov_b32 s90, 0x4000
  buffer_load_dwordx4 v2, s[20:23], s90 offen  lds
  s_add_u32 m0, s96, 2048
  s_mov_b32 s90, 0x8000
  buffer_load_dwordx4 v2, s[20:23], s90 offen  lds
  s_add_u32 m0, s96, 3072
  s_mov_b32 s90, 0xc000
  buffer_load_dwordx4 v2, s[20:23], s90 offen  lds
  s_waitcnt vmcnt(28)
  ds_read_b64_tr_b16 a[4:5], v3 offset:4096
  ds_read_b64_tr_b16 a[6:7], v3 offset:4608
  ds_read_b64_tr_b16 a[12:13], v3 offset:4128
  ds_read_b64_tr_b16 a[14:15], v3 offset:4640
  s_waitcnt lgkmcnt(0)
  s_add_u32 m0, s96, 4096
  s_mov_b32 s90, 0x10000
  buffer_load_dwordx4 v2, s[20:23], s90 offen  lds
  s_add_u32 m0, s96, 5120
  s_mov_b32 s90, 0x14000
  buffer_load_dwordx4 v2, s[20:23], s90 offen  lds
  s_add_u32 m0, s96, 6144
  s_mov_b32 s90, 0x18000
  buffer_load_dwordx4 v2, s[20:23], s90 offen  lds
  s_add_u32 m0, s96, 7168
  s_mov_b32 s90, 0x1c000
  buffer_load_dwordx4 v2, s[20:23], s90 offen  lds
  s_waitcnt vmcnt(28)
  ds_read_b64_tr_b16 a[48:49], v3 offset:8192
  ds_read_b64_tr_b16 a[50:51], v3 offset:8704
  ds_read_b64_tr_b16 a[56:57], v3 offset:8224
  ds_read_b64_tr_b16 a[58:59], v3 offset:8736
  s_waitcnt lgkmcnt(0)
  s_add_u32 m0, s96, 8192
  s_mov_b32 s90, 0x20000
  buffer_load_dwordx4 v2, s[20:23], s90 offen  lds
  s_add_u32 m0, s96, 9216
  s_mov_b32 s90, 0x24000
  buffer_load_dwordx4 v2, s[20:23], s90 offen  lds
  s_add_u32 m0, s96, 10240
  s_mov_b32 s90, 0x28000
  buffer_load_dwordx4 v2, s[20:23], s90 offen  lds
  s_add_u32 m0, s96, 11264
  s_mov_b32 s90, 0x2c000
  buffer_load_dwordx4 v2, s[20:23], s90 offen  lds
  s_waitcnt vmcnt(28)
  ds_read_b64_tr_b16 a[52:53], v3 offset:12288
  ds_read_b64_tr_b16 a[54:55], v3 offset:12800
  ds_read_b64_tr_b16 a[60:61], v3 offset:12320
  ds_read_b64_tr_b16 a[62:63], v3 offset:12832
  s_waitcnt lgkmcnt(0)
  s_add_u32 m0, s96, 12288
  s_mov_b32 s90, 0x30000
  buffer_load_dwordx4 v2, s[20:23], s90 offen  lds
  s_add_u32 m0, s96, 13312
  s_mov_b32 s90, 0x34000
  buffer_load_dwordx4 v2, s[20:23], s90 offen  lds
  s_add_u32 m0, s96, 14336
  s_mov_b32 s90, 0x38000
  buffer_load_dwordx4 v2, s[20:23], s90 offen  lds
  s_add_u32 m0, s96, 15360
  s_mov_b32 s90, 0x3c000
  buffer_load_dwordx4 v2, s[20:23], s90 offen  lds
  s_waitcnt vmcnt(28)
  ds_read_b64_tr_b16 a[96:97], v3 offset:16384
  ds_read_b64_tr_b16 a[98:99], v3 offset:16896
  ds_read_b64_tr_b16 a[104:105], v3 offset:16416
  ds_read_b64_tr_b16 a[106:107], v3 offset:16928
  s_waitcnt vmcnt(24)
  ds_read_b64_tr_b16 a[100:101], v3 offset:20480
  ds_read_b64_tr_b16 a[102:103], v3 offset:20992
  ds_read_b64_tr_b16 a[108:109], v3 offset:20512
  ds_read_b64_tr_b16 a[110:111], v3 offset:21024
  s_waitcnt vmcnt(20)
  ds_read_b64_tr_b16 a[144:145], v3 offset:24576
  ds_read_b64_tr_b16 a[146:147], v3 offset:25088
  ds_read_b64_tr_b16 a[152:153], v3 offset:24608
  ds_read_b64_tr_b16 a[154:155], v3 offset:25120
  s_waitcnt vmcnt(16)
  ds_read_b64_tr_b16 a[148:149], v3 offset:28672
  ds_read_b64_tr_b16 a[150:151], v3 offset:29184
  ds_read_b64_tr_b16 a[156:157], v3 offset:28704
  ds_read_b64_tr_b16 a[158:159], v3 offset:29216
  s_waitcnt vmcnt(0)
  s_barrier
  ds_read_b64_tr_b16 a[192:193], v4 offset:0
  ds_read_b64_tr_b16 a[194:195], v4 offset:2048
  ds_read_b64_tr_b16 a[196:197], v4 offset:512
  ds_read_b64_tr_b16 a[198:199], v4 offset:2560
  ds_read_b64_tr_b16 a[200:201], v4 offset:4096
  ds_read_b64_tr_b16 a[202:203], v4 offset:6144
  ds_read_b64_tr_b16 a[204:205], v4 offset:4608
  ds_read_b64_tr_b16 a[206:207], v4 offset:6656
  s_waitcnt lgkmcnt(0)
  ds_read_b64_tr_b16 a[208:209], v4 offset:32768
  ds_read_b64_tr_b16 a[210:211], v4 offset:34816
  ds_read_b64_tr_b16 a[212:213], v4 offset:33280
  ds_read_b64_tr_b16 a[214:215], v4 offset:35328
  ds_read_b64_tr_b16 a[216:217], v4 offset:36864
  ds_read_b64_tr_b16 a[218:219], v4 offset:38912
  ds_read_b64_tr_b16 a[220:221], v4 offset:37376
  ds_read_b64_tr_b16 a[222:223], v4 offset:39424
  s_waitcnt lgkmcnt(0)
  ds_read_b64_tr_b16 a[224:225], v5 offset:0
  ds_read_b64_tr_b16 a[226:227], v5 offset:2048
  ds_read_b64_tr_b16 a[228:229], v5 offset:512
  ds_read_b64_tr_b16 a[230:231], v5 offset:2560
  ds_read_b64_tr_b16 a[232:233], v5 offset:4096
  ds_read_b64_tr_b16 a[234:235], v5 offset:6144
  ds_read_b64_tr_b16 a[236:237], v5 offset:4608
  ds_read_b64_tr_b16 a[238:239], v5 offset:6656
  s_waitcnt lgkmcnt(0)
  ds_read_b64_tr_b16 a[240:241], v5 offset:32768
  ds_read_b64_tr_b16 a[242:243], v5 offset:34816
  ds_read_b64_tr_b16 a[244:245], v5 offset:33280
  ds_read_b64_tr_b16 a[246:247], v5 offset:35328
  ds_read_b64_tr_b16 a[248:249], v5 offset:36864
  ds_read_b64_tr_b16 a[250:251], v5 offset:38912
  ds_read_b64_tr_b16 a[252:253], v5 offset:37376
  ds_read_b64_tr_b16 a[254:255], v5 offset:39424
  s_waitcnt lgkmcnt(0)
  s_barrier
  s_mov_b32 s46, 0
  s_cmp_lg_u32 s32, 0
  s_cbranch_scc1 SL_vd_4
  v_mbcnt_lo_u32_b32 v250, -1, 0
  v_mbcnt_hi_u32_b32 v250, -1, v250
  v_lshlrev_b32 v250, 2, v250
  s_cmp_lg_u32 s100, 0
  s_cbranch_scc1 SL_vw_3
  v_readfirstlane_b32 s90, v247
  s_and_b32 s90, s90, s101
  s_cbranch_scc0 SL_vw_3
  v_mov_b32 v251, 1
  s_mov_b64 exec, 1
  buffer_store_dword v251, v250, s[28:31], 0 offen offset:32 sc1
  s_mov_b64 exec, -1
SL_vw_3:
  buffer_load_dword v251, v250, s[28:31], 0 offen sc1
  s_waitcnt vmcnt(0)
  v_cmp_eq_u32 vcc, -1, v251
  v_readlane_b32 s91, v251, 8
  v_readlane_b32 s92, v251, 32
  v_readlane_b32 s93, v251, 33
  v_readlane_b32 s90, v251, 34
  s_cmp_lg_u32 s100, 0
  s_cselect_b32 s93, s90, s93
  s_cselect_b32 s91, 0, s91
  s_cselect_b32 s92, 1, s92
  s_cselect_b32 s90, 0xff, vcc_lo
  s_cmp_lg_u32 s91, 0
  s_cselect_b32 s92, 3, s92
  s_cbranch_scc1 SL_vk_5
  s_add_u32 s3, s3, 1
  s_cmp_ge_u32 s3, 131072
  s_cselect_b32 s92, 4, s92
  s_cbranch_scc1 SL_vk_5
  s_sleep 8
  s_and_b32 s90, s90, 0xff
  s_cmp_lg_u32 s90, 0xff
  s_cbranch_scc1 SL_vw_3
  s_cmp_lt_u32 s93, 128
  s_cbranch_scc1 SL_vw_3
SL_vk_5:
  v_mov_b32 v251, s92
  v_mov_b32 v250, 131072
  ds_write_b32 v250, v251
  s_waitcnt lgkmcnt(0)
SL_vd_4:
  s_barrier
  v_mov_b32 v250, 131072
  ds_read_b32 v251, v250
  s_waitcnt lgkmcnt(0)
  v_readfirstlane_b32 s92, v251
  s_barrier
  s_cmp_eq_u32 s92, 3
  s_cbranch_scc1 L_fallback
  s_cmp_eq_u32 s92, 4
  s_cbranch_scc1 L_exit
  s_mov_b32 s39, 0
  s_lshl_b32 s90, s34, 2
  s_add_u32 s90, s90, s32
  s_lshr_b32 s91, s90, 3
  s_lshl_b32 s91, s91, 14
  s_and_b32 s92, s90, 7
  s_lshl_b32 s92, s92, 10
  s_add_u32 s91, s91, s92
  s_add_u32 s91, s91, s39
  v_mov_b32 v1, 0x0
  v_bfe_u32 v31, v0, 0, 6
  v_lshl_add_u32 v1, v31, 4, v1
  v_add_u32 v1, s91, v1
  v_lshrrev_b32 v30, 4, v0
  v_cmp_eq_u32 vcc, s33, v30
  v_xor_b32 v29, 0x2000, v1
  s_nop 0
  v_cndmask_b32 v1, v1, v29, vcc
  s_lshl_b32 s91, s33, 14
  s_lshl_b32 s92, s90, 7
  s_add_u32 s91, s91, s92
  v_mov_b32 v2, 0x200000
  v_bfe_u32 v31, v0, 0, 2
  v_lshl_add_u32 v2, v31, 2, v2
  v_bfe_u32 v31, v0, 2, 1
  v_lshl_add_u32 v2, v31, 6, v2
  v_bfe_u32 v31, v0, 4, 1
  v_lshl_add_u32 v2, v31, 4, v2
  v_bfe_u32 v31, v0, 5, 1
  v_lshl_add_u32 v2, v31, 5, v2
  v_bfe_u32 v31, v0, 3, 1
  v_lshl_add_u32 v2, v31, 31, v2
  v_add_u32 v2, s91, v2
  s_lshr_b32 s92, s90, 1
  s_lshl_b32 s92, s92, 5
  s_and_b32 s91, s90, 1
  s_lshl_b32 s91, s91, 13
  s_add_u32 s92, s92, s91
  v_mov_b32 v30, 0x0
  v_bfe_u32 v31, v0, 2, 1
  v_lshl_add_u32 v30, v31, 12, v30
  v_bfe_u32 v31, v0, 4, 1
  v_lshl_add_u32 v30, v31, 11, v30
  v_bfe_u32 v31, v0, 0, 2
  v_lshl_add_u32 v30, v31, 3, v30
  v_bfe_u32 v31, v0, 5, 1
  v_lshl_add_u32 v30, v31, 2, v30
  v_add_u32 v30, s92, v30
  buffer_load_dword v44, v30, s[24:27], 0 offen
  s_lshl_b32 s91, s33, 14
  s_lshl_b32 s92, s32, 12
  s_add_u32 s91, s91, s92
  v_mov_b32 v3, 0x200000
  v_bfe_u32 v31, v0, 0, 6
  v_lshl_add_u32 v3, v31, 4, v3
  v_add_u32 v3, s91, v3
  s_mul_i32 s91, s32, 3264
  v_mov_b32 v4, 0x0
  v_bfe_u32 v31, v0, 0, 6
  v_lshl_add_u32 v4, v31, 4, v4
  v_add_u32 v4, s91, v4
  s_lshl_b32 s91, s32, 6
  v_mov_b32 v6, 0x0
  v_bfe_u32 v31, v0, 0, 2
  v_lshl_add_u32 v6, v31, 4, v6
  v_bfe_u32 v31, v0, 2, 1
  v_lshl_add_u32 v6, v31, 2, v6
  v_bfe_u32 v31, v0, 3, 1
  s_mov_b32 s99, 1088
  v_mad_u32_u24 v6, v31, s99, v6
  v_bfe_u32 v31, v0, 4, 2
  v_lshl_add_u32 v6, v31, 8, v6
  v_add_u32 v6, s91, v6
  v_add_u32 v240, 3264, v6
  v_add_u32 v241, 6528, v6
  v_add_u32 v242, 9792, v6
  s_lshl_b32 s93, s37, 13
  s_lshl_b32 s91, s38, 10
  s_add_u32 s91, s91, s93
  s_lshl_b32 s92, s32, 8
  s_add_u32 s91, s91, s92
  v_mov_b32 v7, 0x210000
  v_bfe_u32 v31, v0, 0, 6
  v_lshl_add_u32 v7, v31, 2, v7
  v_add_u32 v7, s91, v7
  s_lshl_b32 s91, s37, 11
  s_lshl_b32 s92, s38, 9
  s_add_u32 s96, s91, s92
  s_lshl_b32 s92, s32, 7
  s_add_u32 s91, s96, s92
  v_mov_b32 v19, 0x83000000
  v_bfe_u32 v31, v0, 0, 3
  v_lshl_add_u32 v19, v31, 2, v19
  v_bfe_u32 v31, v0, 4, 2
  v_lshl_add_u32 v19, v31, 5, v19
  v_bfe_u32 v31, v0, 3, 1
  v_lshl_add_u32 v19, v31, 31, v19
  v_add_u32 v19, s91, v19
  s_lshl_b32 s91, s32, 8
  v_mov_b32 v5, 0x880
  v_bfe_u32 v31, v0, 0, 1
  v_lshl_add_u32 v5, v31, 7, v5
  v_bfe_u32 v31, v0, 1, 1
  v_lshl_add_u32 v5, v31, 3, v5
  v_bfe_u32 v31, v0, 2, 3
  v_lshl_add_u32 v5, v31, 4, v5
  v_add_u32 v5, s91, v5
  s_lshr_b32 s92, s38, 1
  s_lshl_b32 s92, s92, 10
  s_add_u32 s91, s91, s92
  s_add_u32 s91, s91, s93
  s_and_b32 s92, s38, 1
  s_lshl_b32 s92, s92, 7
  s_add_u32 s91, s91, s92
  v_mov_b32 v8, 0x211000
  v_bfe_u32 v31, v0, 0, 5
  v_lshl_add_u32 v8, v31, 2, v8
  v_bfe_u32 v31, v0, 5, 1
  v_lshl_add_u32 v8, v31, 31, v8
  v_add_u32 v8, s91, v8
  s_sub_u32 s91, s91, s93
  s_lshl_b32 s92, s37, 11
  s_add_u32 s91, s91, s92
  v_mov_b32 v20, 0x3400000
  v_bfe_u32 v31, v0, 0, 5
  v_lshl_add_u32 v20, v31, 2, v20
  v_bfe_u32 v31, v0, 5, 1
  v_lshl_add_u32 v20, v31, 31, v20
  v_add_u32 v20, s91, v20
  s_lshl_b32 s97, s35, 2
  s_add_u32 s97, s97, s32
  s_lshl_b32 s97, s97, 13
  v_mov_b32 v9, 0x210000
  v_bfe_u32 v31, v0, 0, 6
  v_lshl_add_u32 v9, v31, 4, v9
  v_add_u32 v9, s97, v9
  v_add_u32 v10, 4096, v9
  v_mov_b32 v11, 0x1000000
  v_bfe_u32 v31, v0, 0, 2
  v_lshl_add_u32 v11, v31, 4, v11
  v_bfe_u32 v31, v0, 2, 1
  v_lshl_add_u32 v11, v31, 7, v11
  v_bfe_u32 v31, v0, 3, 1
  v_lshl_add_u32 v11, v31, 12, v11
  v_bfe_u32 v31, v0, 4, 2
  v_lshl_add_u32 v11, v31, 8, v11
  v_add_u32 v11, s97, v11
  v_mov_b32 v12, 0x2000000
  v_bfe_u32 v31, v0, 0, 3
  v_lshl_add_u32 v12, v31, 4, v12
  v_bfe_u32 v31, v0, 3, 1
  v_lshl_add_u32 v12, v31, 11, v12
  v_bfe_u32 v31, v0, 4, 2
  v_lshl_add_u32 v12, v31, 8, v12
  v_add_u32 v12, s97, v12
  v_add_u32 v13, 4096, v12
  s_lshl_b32 s91, s36, 9
  s_add_u32 s91, s91, s97
  s_add_u32 s12, s91, 0x1000000
  v_mov_b32 v21, 0x1000000
  v_bfe_u32 v31, v0, 0, 2
  v_lshl_add_u32 v21, v31, 7, v21
  v_bfe_u32 v31, v0, 2, 1
  v_lshl_add_u32 v21, v31, 24, v21
  v_add_u32 v21, s91, v21
  v_cmp_gt_u32 vcc, 8, v0
  v_mov_b32 v30, 0x80000000
  s_nop 0
  v_cndmask_b32 v21, v30, v21, vcc
  s_lshl_b32 s91, s32, 11
  v_mov_b32 v30, 0x0
  v_bfe_u32 v31, v0, 2, 1
  v_lshl_add_u32 v30, v31, 6, v30
  v_bfe_u32 v31, v0, 0, 1
  v_lshl_add_u32 v30, v31, 5, v30
  v_bfe_u32 v31, v0, 1, 1
  v_lshl_add_u32 v30, v31, 4, v30
  v_mov_b32 v29, 0x0
  v_bfe_u32 v31, v0, 4, 2
  v_lshl_add_u32 v29, v31, 5, v29
  v_xor_b32 v30, v30, v29
  v_mov_b32 v14, 0x3400
  v_bfe_u32 v31, v0, 0, 4
  v_lshl_add_u32 v14, v31, 7, v14
  v_add_u32 v14, s91, v14
  v_add_u32 v14, v14, v30
  v_xor_b32 v15, 16, v14
  v_mov_b32 v30, 0x0
  v_bfe_u32 v31, v0, 5, 1
  v_lshl_add_u32 v30, v31, 6, v30
  v_bfe_u32 v31, v0, 1, 1
  v_lshl_add_u32 v30, v31, 5, v30
  v_bfe_u32 v31, v0, 4, 1
  v_lshl_add_u32 v30, v31, 4, v30
  v_mov_b32 v29, 0x0
  v_bfe_u32 v31, v0, 2, 2
  v_lshl_add_u32 v29, v31, 5, v29
  v_bfe_u32 v31, v0, 0, 1
  v_lshl_add_u32 v29, v31, 4, v29
  v_xor_b32 v30, v30, v29
  v_mov_b32 v16, 0x3400
  v_bfe_u32 v31, v0, 4, 2
  v_lshl_add_u32 v16, v31, 8, v16
  v_bfe_u32 v31, v0, 1, 1
  v_lshl_add_u32 v16, v31, 7, v16
  v_add_u32 v16, v16, v30
  s_lshl_b32 s98, s36, 14
  s_lshl_b32 s92, s35, 7
  s_add_u32 s98, s98, s92
  s_add_u32 s98, s98, s39
  s_lshl_b32 s92, s32, 11
  s_add_u32 s91, s98, s92
  v_mov_b32 v17, 0x0
  v_bfe_u32 v31, v0, 0, 5
  v_lshl_add_u32 v17, v31, 2, v17
  v_bfe_u32 v31, v0, 5, 1
  v_lshl_add_u32 v17, v31, 10, v17
  v_add_u32 v17, s91, v17
  v_xor_b32 v18, 0x2000, v17
  s_mov_b32 s48, 0x33333333
  s_mov_b32 s49, 0x33333333
  s_mov_b32 s50, 0xffff0000
  s_mov_b32 s51, 0xffff0000
  s_mov_b32 s52, 0x0000ffff
  s_mov_b32 s53, 0x0000ffff
  s_mov_b32 s54, 0xfffffffe
  s_mov_b32 s47, 0x3e0293ee
  v_mov_b32 v30, 0x4444
  v_mov_b32 v31, 0xeeee
  v_cndmask_b32 v23, v31, v30, s[48:49]
  v_mov_b32 v22, -1
  v_mov_b32 v248, 0x3f803f80
  v_mov_b32 v249, 0x3f803f80
  v_mov_b32 v250, 0x3f803f80
  v_mov_b32 v251, 0x3f803f80
  v_mov_b32 v252, 0x3f803f80
  v_mov_b32 v253, 0x3f803f80
  v_mov_b32 v254, 0x3f803f80
  v_mov_b32 v255, 0x3f803f80
  v_mov_b32 v232, 0
  v_mov_b32 v233, 0
  v_mov_b32 v234, 0
  v_mov_b32 v235, 0
  v_mov_b32 v112, 0
  v_mov_b32 v113, 0
  s_mov_b32 s56, 0xf0f0f0f0
  s_mov_b32 s57, 0xf0f0f0f0
  v_mov_b32 v30, 0x3f80
  v_mov_b32 v31, 1.0
  v_cndmask_b32 v30, v30, v31, s[56:57]
  s_mov_b32 s56, 0x110011
  s_mov_b32 s57, 0x110011
  v_cndmask_b32 v24, 0, v30, s[56:57]
  s_mov_b32 s56, 0x220022
  s_mov_b32 s57, 0x220022
  v_cndmask_b32 v25, 0, v30, s[56:57]
  s_mov_b32 s56, 0x11001100
  s_mov_b32 s57, 0x11001100
  v_cndmask_b32 v26, 0, v30, s[56:57]
  s_mov_b32 s56, 0x22002200
  s_mov_b32 s57, 0x22002200
  v_cndmask_b32 v27, 0, v30, s[56:57]
  s_mov_b32 s40, 0
  s_mov_b32 s41, 0x3800000
  s_mov_b32 s43, 0x3900000
  s_mov_b32 s44, 0
  s_mov_b32 s55, 0x40000
  s_mov_b32 s45, 0
  s_cmp_lg_u32 s32, 0
  s_cbranch_scc1 SL_kv0d
  s_lshl_b32 s90, s33, 7
  s_add_u32 s90, s90, 0x3d01000
  v_mov_b32 v30, s90
SL_kv0:
  buffer_load_dword v31, v30, s[4:7], 0 offen sc1
  s_waitcnt vmcnt(0)
  v_readfirstlane_b32 s90, v31
  s_add_u32 s46, s46, 1
  s_cmp_ge_u32 s46, 131072
  s_cbranch_scc1 SL_rec_abort
  s_sleep 2
  s_cmp_lt_u32 s90, 32
  s_cbranch_scc1 SL_kv0
SL_kv0d:
  s_barrier
  buffer_load_dwordx4 v[180:183], v12, s[4:7], s44 offen offset:0
  buffer_load_dwordx4 v[184:187], v12, s[4:7], s44 offen offset:128
  buffer_load_dwordx4 v[188:191], v12, s[4:7], s44 offen offset:1024
  buffer_load_dwordx4 v[192:195], v12, s[4:7], s44 offen offset:1152
  buffer_load_dwordx4 v[196:199], v13, s[4:7], s44 offen offset:0
  buffer_load_dwordx4 v[200:203], v13, s[4:7], s44 offen offset:128
  buffer_load_dwordx4 v[204:207], v13, s[4:7], s44 offen offset:1024
  buffer_load_dwordx4 v[208:211], v13, s[4:7], s44 offen offset:1152
  buffer_load_dwordx4 v[116:119], v11, s[4:7], s44 offen offset:0
  buffer_load_dwordx4 v[132:135], v11, s[4:7], s44 offen offset:64
  buffer_load_dwordx4 v[120:123], v11, s[4:7], s44 offen offset:1024
  buffer_load_dwordx4 v[136:139], v11, s[4:7], s44 offen offset:1088
  buffer_load_dwordx4 v[124:127], v11, s[4:7], s44 offen offset:2048
  buffer_load_dwordx4 v[140:143], v11, s[4:7], s44 offen offset:2112
  buffer_load_dwordx4 v[128:131], v11, s[4:7], s44 offen offset:3072
  buffer_load_dwordx4 v[144:147], v11, s[4:7], s44 offen offset:3136
  s_add_u32 s44, s44, 0x40000
  v_mov_b64 v[64:65], 0
  v_mov_b64 v[66:67], 0
  v_mov_b64 v[68:69], 0
  v_mov_b64 v[70:71], 0
  v_mov_b64 v[72:73], 0
  v_mov_b64 v[74:75], 0
  v_mov_b64 v[76:77], 0
  v_mov_b64 v[78:79], 0
  v_mov_b64 v[80:81], 0
  v_mov_b64 v[82:83], 0
  v_mov_b64 v[84:85], 0
  v_mov_b64 v[86:87], 0
  v_mov_b64 v[32:33], 0
  v_mov_b64 v[34:35], 0
  v_mov_b64 v[212:213], 0
  v_mov_b64 v[214:215], 0
  v_mov_b64 v[216:217], 0
  v_mov_b64 v[218:219], 0
  v_mov_b64 v[220:221], 0
  v_mov_b64 v[222:223], 0
  v_mov_b64 v[224:225], 0
  v_mov_b64 v[226:227], 0
  v_mov_b64 v[228:229], 0
  v_mov_b64 v[230:231], 0
  s_waitcnt vmcnt(0)
  v_min_u32 v44, s54, v44
  s_lshl_b32 s90, s33, 7
  s_add_u32 s90, s90, 0x3d01000
  v_mov_b32 v244, s90
  s_lshl_b32 s90, s33, 5
  s_add_u32 s90, s90, s34
  s_lshl_b32 s90, s90, 2
  s_add_u32 s90, s90, s32
  v_mbcnt_lo_u32_b32 v30, -1, 0
  v_mbcnt_hi_u32_b32 v30, -1, v30
  v_add_u32 v30, s90, v30
  v_cmp_eq_u32 vcc, 0, v30
  v_mov_b32 v30, 0x80000000
  v_mov_b32 v31, 0x3d00000
  v_cndmask_b32 v245, v30, v31, vcc
  s_branch SL_pubmem
SL_step:
  buffer_load_dwordx4 v[196:199], v13, s[4:7], s44 offen offset:0
  buffer_load_dwordx4 v[200:203], v13, s[4:7], s44 offen offset:128
  buffer_load_dwordx4 v[204:207], v13, s[4:7], s44 offen offset:1024
  buffer_load_dwordx4 v[208:211], v13, s[4:7], s44 offen offset:1152
  v_mov_b64 v[64:65], 0
  v_mov_b64 v[66:67], 0
  v_mov_b64 v[68:69], 0
  v_mov_b64 v[70:71], 0
  v_mov_b64 v[72:73], 0
  v_mov_b64 v[74:75], 0
  v_mov_b64 v[76:77], 0
  v_mov_b64 v[78:79], 0
  v_mov_b64 v[80:81], 0
  v_mov_b64 v[82:83], 0
  v_mov_b64 v[84:85], 0
  v_mov_b64 v[86:87], 0
  v_mov_b64 v[32:33], 0
  v_mov_b64 v[34:35], 0
  buffer_load_dwordx4 v[36:39], v1, s[4:7], s42 offen sc1
  buffer_load_dwordx4 v[128:131], v11, s[4:7], s44 offen offset:3072
  buffer_load_dwordx4 v[144:147], v11, s[4:7], s44 offen offset:3136
  s_add_u32 s44, s44, 0x40000
  s_min_u32 s44, s44, 0xfc0000
  s_add_u32 s45, s45, 0x10000
  s_waitcnt vmcnt(9)
SL_kv_chk:
  v_readfirstlane_b32 s90, v243
  s_cmp_lt_u32 s90, 32
  s_cbranch_scc1 SL_kv_f
  s_waitcnt vmcnt(2)
SL_g_chk:
  v_max3_u32 v31, v36, v37, v38
  v_max_u32 v31, v31, v39
  v_cmp_eq_u32 vcc, -1, v31
  v_mfma_f32_16x16x32_bf16 v[40:43], v[24:27], v[36:39], 0
  s_cbranch_vccnz SL_g_f
  s_nop 6
  v_add_f32_dpp v45, v40, v40 row_ror:8 row_mask:0xf bank_mask:0xf
  v_add_f32_dpp v46, v41, v41 row_ror:8 row_mask:0xf bank_mask:0xf
  v_cvt_pk_bf16_f32 v44, v45, v46
  v_min_u32 v44, s54, v44
SL_pubmem:
  buffer_store_dword v44, v2, s[4:7], s41 offen sc1
  v_mov_b32 v148, v180
  v_mov_b32 v150, v181
  v_mov_b32 v152, v182
  v_mov_b32 v154, v183
  v_mov_b32 v149, v184
  v_mov_b32 v151, v185
  v_mov_b32 v153, v186
  v_mov_b32 v155, v187
  v_mov_b32 v156, v188
  v_mov_b32 v158, v189
  v_mov_b32 v160, v190
  v_mov_b32 v162, v191
  v_mov_b32 v157, v192
  v_mov_b32 v159, v193
  v_mov_b32 v161, v194
  v_mov_b32 v163, v195
  v_mov_b32 v164, v196
  v_mov_b32 v166, v197
  v_mov_b32 v168, v198
  v_mov_b32 v170, v199
  v_mov_b32 v165, v200
  v_mov_b32 v167, v201
  v_mov_b32 v169, v202
  v_mov_b32 v171, v203
  buffer_load_dwordx4 v[48:51], v3, s[4:7], s41 offen offset:0 sc1
  v_mov_b32 v172, v204
  v_mov_b32 v174, v205
  buffer_load_dwordx4 v[52:55], v3, s[4:7], s41 offen offset:1024 sc1
  v_mov_b32 v176, v206
  v_mov_b32 v178, v207
  buffer_load_dwordx4 v[56:59], v3, s[4:7], s41 offen offset:2048 sc1
  v_mov_b32 v173, v208
  v_mov_b32 v175, v209
  buffer_load_dwordx4 v[60:63], v3, s[4:7], s41 offen offset:3072 sc1
  v_mov_b32 v177, v210
  v_mov_b32 v179, v211
  s_waitcnt vmcnt(3)
  v_max3_u32 v31, v48, v49, v50
  v_max_u32 v31, v31, v51
  v_cmp_eq_u32 vcc, -1, v31
  s_cbranch_vccnz SL_m_f0
  v_smfmac_f32_16x16x64_bf16 v[64:67], v[48:51], a[0:7], v23
  s_waitcnt vmcnt(2)
  v_max3_u32 v31, v52, v53, v54
  v_max_u32 v31, v31, v55
  v_cmp_eq_u32 vcc, -1, v31
  v_smfmac_f32_16x16x64_bf16 v[68:71], v[48:51], a[8:15], v23
  v_smfmac_f32_16x16x64_bf16 v[72:75], v[48:51], a[16:23], v23
  v_smfmac_f32_16x16x64_bf16 v[76:79], v[48:51], a[24:31], v23
  s_cbranch_vccnz SL_m_f1
  v_smfmac_f32_16x16x64_bf16 v[64:67], v[52:55], a[48:55], v23
  s_waitcnt vmcnt(1)
  v_max3_u32 v31, v56, v57, v58
  v_max_u32 v31, v31, v59
  v_cmp_eq_u32 vcc, -1, v31
  v_smfmac_f32_16x16x64_bf16 v[68:71], v[52:55], a[56:63], v23
  v_smfmac_f32_16x16x64_bf16 v[72:75], v[52:55], a[64:71], v23
  v_smfmac_f32_16x16x64_bf16 v[76:79], v[52:55], a[72:79], v23
  s_cbranch_vccnz SL_m_f2
  v_smfmac_f32_16x16x64_bf16 v[64:67], v[56:59], a[96:103], v23
  s_waitcnt vmcnt(0)
  v_max3_u32 v31, v60, v61, v62
  v_max_u32 v31, v31, v63
  v_cmp_eq_u32 vcc, -1, v31
  v_smfmac_f32_16x16x64_bf16 v[68:71], v[56:59], a[104:111], v23
  v_smfmac_f32_16x16x64_bf16 v[72:75], v[56:59], a[112:119], v23
  v_smfmac_f32_16x16x64_bf16 v[76:79], v[56:59], a[120:127], v23
  s_cbranch_vccnz SL_m_f3
  v_smfmac_f32_16x16x64_bf16 v[64:67], v[60:63], a[144:151], v23
  v_smfmac_f32_16x16x64_bf16 v[68:71], v[60:63], a[152:159], v23
  v_smfmac_f32_16x16x64_bf16 v[72:75], v[60:63], a[160:167], v23
  v_smfmac_f32_16x16x64_bf16 v[76:79], v[60:63], a[168:175], v23
SL_m_done:
  s_nop 4
  v_pk_add_f32 v[88:89], v[64:65], v[66:67]
  v_pk_add_f32 v[90:91], v[68:69], v[70:71]
  ds_write_b128 v4, v[88:91] offset:0
  v_pk_add_f32 v[92:93], v[72:73], v[74:75]
  v_pk_add_f32 v[94:95], v[76:77], v[78:79]
  ds_write_b128 v4, v[92:95] offset:1088
  v_smfmac_f32_16x16x64_bf16 v[80:83], v[48:51], a[32:39], v23
  buffer_load_dwordx4 v[180:183], v12, s[4:7], s44 offen offset:0
  v_mov_b32 v36, 0
  v_smfmac_f32_16x16x64_bf16 v[84:87], v[48:51], a[40:47], v23
  buffer_load_dwordx4 v[184:187], v12, s[4:7], s44 offen offset:128
  v_mov_b32 v37, 0
  v_smfmac_f32_16x16x64_bf16 v[80:83], v[52:55], a[80:87], v23
  buffer_load_dwordx4 v[188:191], v12, s[4:7], s44 offen offset:1024
  v_mov_b32 v38, 0
  v_smfmac_f32_16x16x64_bf16 v[84:87], v[52:55], a[88:95], v23
  buffer_load_dwordx4 v[192:195], v12, s[4:7], s44 offen offset:1152
  v_mov_b32 v39, 0
  v_smfmac_f32_16x16x64_bf16 v[80:83], v[56:59], a[128:135], v23
  v_mov_b32 v40, 0
  s_waitcnt lgkmcnt(0)
  s_barrier
  ds_read2_b32 v[100:101], v6 offset0:0 offset1:2
  ds_read2_b32 v[102:103], v240 offset0:0 offset1:2
  ds_read2_b32 v[104:105], v241 offset0:0 offset1:2
  ds_read2_b32 v[106:107], v242 offset0:0 offset1:2
  v_smfmac_f32_16x16x64_bf16 v[84:87], v[56:59], a[136:143], v23
  v_mov_b32 v41, 0
  v_smfmac_f32_16x16x64_bf16 v[80:83], v[60:63], a[176:183], v23
  v_mov_b32 v42, 0
  v_smfmac_f32_16x16x64_bf16 v[84:87], v[60:63], a[184:191], v23
  v_mov_b32 v43, 0
  v_mov_b32 v44, 0
  v_mov_b32 v45, 0
  v_mov_b32 v46, 0
  v_mov_b32 v47, 0
  s_waitcnt lgkmcnt(2)
  v_pk_add_f32 v[100:101], v[100:101], v[102:103]
  s_waitcnt lgkmcnt(0)
  v_pk_add_f32 v[104:105], v[104:105], v[106:107]
  v_pk_add_f32 v[100:101], v[100:101], v[104:105]
  v_cvt_pk_bf16_f32 v112, v100, v101
  v_min_u32 v112, s54, v112
  buffer_store_dword v112, v7, s[4:7], s41 offen sc1
  v_pk_add_f32 v[96:97], v[80:81], v[82:83]
  v_pk_add_f32 v[98:99], v[84:85], v[86:87]
  ds_write_b128 v4, v[96:99] offset:2176
  v_mov_b64 v[212:213], 0
  v_mov_b64 v[214:215], 0
  v_mov_b64 v[216:217], 0
  v_mov_b64 v[218:219], 0
  v_mov_b64 v[220:221], 0
  v_mov_b64 v[222:223], 0
  v_mov_b64 v[224:225], 0
  v_mov_b64 v[226:227], 0
  v_mov_b64 v[228:229], 0
  v_mov_b64 v[230:231], 0
  s_waitcnt lgkmcnt(0)
  s_barrier
  ds_read_b64 v[88:89], v5 offset:0
  ds_read_b64 v[90:91], v5 offset:3264
  ds_read_b64 v[92:93], v5 offset:6528
  ds_read_b64 v[94:95], v5 offset:9792
  s_mov_b32 s42, s41
  s_add_u32 s90, s40, 1
  s_and_b32 s90, s90, 3
  s_lshl_b32 s90, s90, 19
  s_add_u32 s91, s90, 0x3800000
  s_add_u32 s55, s55, 0x40000
  s_min_u32 s55, s55, 0xfc0000
  s_nop 0
  s_waitcnt lgkmcnt(2)
  v_pk_add_f32 v[88:89], v[88:89], v[90:91]
  s_waitcnt lgkmcnt(0)
  v_pk_add_f32 v[92:93], v[92:93], v[94:95]
  v_pk_add_f32 v[88:89], v[88:89], v[92:93]
  v_cvt_pk_bf16_f32 v113, v88, v89
  v_min_u32 v113, s54, v113
  buffer_store_dword v113, v8, s[4:7], s41 offen sc1
  buffer_load_dwordx4 v[64:67], v9, s[4:7], s41 offen offset:0 sc1
  s_nop 1
  buffer_load_dwordx4 v[68:71], v9, s[4:7], s41 offen offset:1024 sc1
  s_nop 1
  buffer_load_dwordx4 v[72:75], v9, s[4:7], s41 offen offset:2048 sc1
  s_nop 1
  buffer_load_dwordx4 v[76:79], v9, s[4:7], s41 offen offset:3072 sc1
  s_nop 1
  s_cmp_eq_u32 s40, 63
  s_cbranch_scc1 SL_last
  s_waitcnt vmcnt(3)
  v_max3_u32 v31, v64, v65, v66
  v_max_u32 v31, v31, v67
  v_cmp_eq_u32 vcc, -1, v31
  s_cbranch_vccnz SL_x_f0
  v_mfma_f32_16x16x32_bf16 v[44:47], v[64:67], v[64:67], v[44:47]
  s_waitcnt vmcnt(2)
  v_max3_u32 v31, v68, v69, v70
  v_max_u32 v31, v31, v71
  v_cmp_eq_u32 vcc, -1, v31
  v_mfma_f32_16x16x32_bf16 v[36:39], v[116:119], v[64:67], v[36:39]
  v_mfma_f32_16x16x32_bf16 v[40:43], v[132:135], v[64:67], v[40:43]
  s_cbranch_vccnz SL_x_f1
  v_mfma_f32_16x16x32_bf16 v[44:47], v[68:71], v[68:71], v[44:47]
  s_waitcnt vmcnt(1)
  v_max3_u32 v31, v72, v73, v74
  v_max_u32 v31, v31, v75
  v_cmp_eq_u32 vcc, -1, v31
  v_mfma_f32_16x16x32_bf16 v[36:39], v[120:123], v[68:71], v[36:39]
  v_mfma_f32_16x16x32_bf16 v[40:43], v[136:139], v[68:71], v[40:43]
  s_cbranch_vccnz SL_x_f2
  v_mfma_f32_16x16x32_bf16 v[44:47], v[72:75], v[72:75], v[44:47]
  s_waitcnt vmcnt(0)
  v_max3_u32 v31, v76, v77, v78
  v_max_u32 v31, v31, v79
  v_cmp_eq_u32 vcc, -1, v31
  v_mfma_f32_16x16x32_bf16 v[36:39], v[124:127], v[72:75], v[36:39]
  v_mfma_f32_16x16x32_bf16 v[40:43], v[140:143], v[72:75], v[40:43]
  s_cbranch_vccnz SL_x_f3
  v_mfma_f32_16x16x32_bf16 v[44:47], v[76:79], v[76:79], v[44:47]
  v_mfma_f32_16x16x32_bf16 v[36:39], v[128:131], v[76:79], v[36:39]
  v_mfma_f32_16x16x32_bf16 v[40:43], v[144:147], v[76:79], v[40:43]
SL_x_done:
  buffer_load_dwordx4 v[88:91], v10, s[4:7], s41 offen offset:0 sc1
  buffer_load_dwordx4 v[92:95], v10, s[4:7], s41 offen offset:1024 sc1
  s_mov_b64 vcc, s[48:49]
  s_nop 2
  v_max_f32 v30, v46, v47
  s_nop 0
  v_cndmask_b32_dpp v96, v40, v36, vcc quad_perm:[0,1,0,1] row_mask:0xf bank_mask:0xf
  v_cndmask_b32_dpp v97, v41, v37, vcc quad_perm:[0,1,0,1] row_mask:0xf bank_mask:0xf
  v_cndmask_b32_dpp v98, v42, v38, vcc quad_perm:[0,1,0,1] row_mask:0xf bank_mask:0xf
  v_cndmask_b32_dpp v99, v43, v39, vcc quad_perm:[0,1,0,1] row_mask:0xf bank_mask:0xf
  v_max3_f32 v29, v96, v97, v98
  s_nop 0
  v_max_f32_dpp v28, v30, v99 quad_perm:[0,1,0,1] row_mask:0xf bank_mask:0xf
  v_max_f32 v29, v29, v28
  s_nop 1
  v_max_f32_dpp v28, v29, v29 quad_perm:[2,3,0,1] row_mask:0xf bank_mask:0xf
  v_mov_b32 v29, v28
  s_nop 1
  v_permlane32_swap_b32 v28, v29
  v_max_f32 v28, v28, v29
  v_mov_b32 v29, v28
  s_nop 1
  v_permlane16_swap_b32 v28, v29
  v_max_f32 v28, v28, v29
  v_mul_f32 v28, s47, v28
  v_fma_f32 v96, v96, s47, -v28
  v_fma_f32 v97, v97, s47, -v28
  v_fma_f32 v98, v98, s47, -v28
  v_fma_f32 v99, v99, s47, -v28
  v_fma_f32 v46, v46, s47, -v28
  v_fma_f32 v47, v47, s47, -v28
  v_exp_f32 v96, v96
  v_exp_f32 v97, v97
  v_exp_f32 v98, v98
  v_exp_f32 v99, v99
  v_cvt_pk_bf16_f32 v236, v96, v97
  v_cvt_pk_bf16_f32 v237, v98, v99
  v_exp_f32 v46, v46
  v_mov_b32_dpp v100, v236 quad_perm:[0,1,0,1] row_mask:0xf bank_mask:0xf
  v_mov_b32_dpp v102, v236 quad_perm:[2,3,2,3] row_mask:0xf bank_mask:0xf
  v_mov_b32_dpp v101, v237 quad_perm:[0,1,0,1] row_mask:0xf bank_mask:0xf
  v_mov_b32_dpp v103, v237 quad_perm:[2,3,2,3] row_mask:0xf bank_mask:0xf
  v_exp_f32 v47, v47
  s_nop 0
  v_smfmac_f32_16x16x64_bf16 v[228:231], v[100:103], v[248:255], v23
  v_cvt_pk_bf16_f32 v238, v46, v47
  buffer_load_dwordx4 v[116:119], v11, s[4:7], s44 offen offset:0
  v_smfmac_f32_16x16x64_bf16 v[212:215], v[100:103], v[148:155], v23
  buffer_load_dwordx4 v[132:135], v11, s[4:7], s44 offen offset:64
  v_mov_b32_dpp v232, v238 quad_perm:[0,1,0,1] row_mask:0xf bank_mask:0xf
  v_smfmac_f32_16x16x64_bf16 v[216:219], v[100:103], v[156:163], v23
  buffer_load_dwordx4 v[120:123], v11, s[4:7], s44 offen offset:1024
  v_mov_b32_dpp v235, v238 quad_perm:[0,1,0,1] row_mask:0xf bank_mask:0xf
  v_smfmac_f32_16x16x64_bf16 v[220:223], v[100:103], v[164:171], v23
  buffer_load_dwordx4 v[136:139], v11, s[4:7], s44 offen offset:1088
  s_waitcnt vmcnt(4)
  v_max3_u32 v31, v88, v89, v90
  v_max3_u32 v31, v31, v91, v92
  v_smfmac_f32_16x16x32_bf16 v[228:231], v[232:233], v[248:251], v23
  v_max3_u32 v31, v31, v93, v94
  v_max_u32 v31, v31, v95
  v_cmp_eq_u32 vcc, -1, v31
  v_smfmac_f32_16x16x64_bf16 v[224:227], v[100:103], v[172:179], v23
  s_cbranch_vccnz SL_v_f
SL_v_ok:
  v_smfmac_f32_16x16x32_bf16 v[212:215], v[232:233], v[88:91], v23
  buffer_load_dwordx4 v[124:127], v11, s[4:7], s44 offen offset:2048
  buffer_load_dwordx4 v[140:143], v11, s[4:7], s44 offen offset:2112
  v_smfmac_f32_16x16x32_bf16 v[216:219], v[234:235], v[88:91], v23
  buffer_store_dword v22, v18, s[4:7], s43 offen sc1
  v_rcp_f32 v28, v228
  v_smfmac_f32_16x16x32_bf16 v[220:223], v[232:233], v[92:95], v23
  buffer_store_dword v22, v2, s[4:7], s43 offen sc1
  v_rcp_f32 v29, v229
  v_smfmac_f32_16x16x32_bf16 v[224:227], v[234:235], v[92:95], v23
  buffer_store_dword v22, v7, s[4:7], s43 offen sc1
  buffer_store_dword v22, v8, s[4:7], s43 offen sc1
  v_pk_mul_f32 v[212:213], v[212:213], v[28:29]
  v_pk_mul_f32 v[214:215], v[214:215], v[28:29]
  v_cvt_pk_bf16_f32 v104, v212, v214
  v_cvt_pk_bf16_f32 v108, v213, v215
  v_pk_mul_f32 v[216:217], v[216:217], v[28:29]
  v_pk_mul_f32 v[218:219], v[218:219], v[28:29]
  v_cvt_pk_bf16_f32 v105, v216, v218
  v_cvt_pk_bf16_f32 v109, v217, v219
  v_pk_mul_f32 v[220:221], v[220:221], v[28:29]
  v_pk_mul_f32 v[222:223], v[222:223], v[28:29]
  v_cvt_pk_bf16_f32 v106, v220, v222
  v_cvt_pk_bf16_f32 v110, v221, v223
  v_pk_mul_f32 v[224:225], v[224:225], v[28:29]
  v_pk_mul_f32 v[226:227], v[226:227], v[28:29]
  v_cvt_pk_bf16_f32 v107, v224, v226
  v_cvt_pk_bf16_f32 v111, v225, v227
  ds_write_b128 v14, v[104:107]
  ds_write_b128 v15, v[108:111]
  s_add_u32 s92, s40, 3
  s_min_u32 s92, s92, 63
  s_lshr_b32 s92, s92, 3
  s_lshl_b32 s92, s92, 9
  s_max_u32 s93, s40, 1
  s_sub_u32 s93, s93, 1
  v_mov_b32 v246, s93
  s_waitcnt lgkmcnt(0)
  s_barrier
  ds_read_b128 v[48:51], v16 offset:0
  ds_read_b128 v[52:55], v16 offset:1024
  ds_read_b128 v[56:59], v16 offset:2048
  ds_read_b128 v[60:63], v16 offset:3072
  ds_read_b128 v[64:67], v16 offset:4096
  buffer_load_dword v0, v21, s[4:7], s55 offen
  buffer_store_dword v22, v17, s[4:7], s43 offen sc1
  s_waitcnt lgkmcnt(4)
  v_smfmac_f32_16x16x64_bf16 v[32:35], v[48:51], a[192:199], v23
  ds_read_b128 v[68:71], v16 offset:5120
  buffer_store_dword v112, v19, s[4:7], s45 offen sc1
  s_waitcnt lgkmcnt(4)
  v_smfmac_f32_16x16x64_bf16 v[32:35], v[52:55], a[200:207], v23
  ds_read_b128 v[72:75], v16 offset:6144
  buffer_store_dword v113, v20, s[4:7], s45 offen sc1
  s_waitcnt lgkmcnt(4)
  v_smfmac_f32_16x16x64_bf16 v[32:35], v[56:59], a[208:215], v23
  ds_read_b128 v[76:79], v16 offset:7168
  buffer_store_dword v246, v245, s[4:7], 0 offen sc1
  s_waitcnt lgkmcnt(4)
  v_smfmac_f32_16x16x64_bf16 v[32:35], v[60:63], a[216:223], v23
  buffer_load_dword v243, v244, s[4:7], s92 offen sc1
  s_waitcnt lgkmcnt(3)
  v_smfmac_f32_16x16x64_bf16 v[32:35], v[64:67], a[224:231], v23
  s_add_u32 s40, s40, 1
  s_waitcnt lgkmcnt(2)
  v_smfmac_f32_16x16x64_bf16 v[32:35], v[68:71], a[232:239], v23
  s_mov_b32 s41, s91
  s_waitcnt lgkmcnt(1)
  v_smfmac_f32_16x16x64_bf16 v[32:35], v[72:75], a[240:247], v23
  s_xor_b32 s43, s91, 0x100000
  s_waitcnt lgkmcnt(0)
  v_smfmac_f32_16x16x64_bf16 v[32:35], v[76:79], a[248:255], v23
  s_nop 7
  v_pk_add_f32 v[28:29], v[32:33], v[34:35]
  v_cvt_pk_bf16_f32 v28, v28, v29
  v_min_u32 v28, s54, v28
  buffer_store_dword v28, v17, s[4:7], s42 offen sc1
  buffer_store_dword v28, v18, s[4:7], s42 offen sc1
  s_branch SL_step
SL_last:
  buffer_store_dword v112, v19, s[4:7], s45 offen sc1
  buffer_store_dword v113, v20, s[4:7], s45 offen sc1
  s_waitcnt vmcnt(0)
  s_barrier
  s_mov_b32 s90, 0x3d00080
  s_cmp_lg_u32 s32, 0
  s_cbranch_scc1 SL_sig_6
  v_mov_b32 v254, 1
  v_mov_b32 v255, 0
  s_mov_b64 exec, 1
  buffer_atomic_add v254, v255, s[4:7], s90 offen offset:0 sc1
  s_mov_b64 exec, -1
SL_sig_6:
  s_waitcnt vmcnt(0)
  s_branch L_join
SL_kv_f:
  s_sleep 8
  buffer_load_dword v243, v244, s[4:7], s92 offen sc1
  s_add_u32 s46, s46, 1
  s_cmp_ge_u32 s46, 131072
  s_cbranch_scc1 SL_rec_abort
  s_waitcnt vmcnt(0)
  s_branch SL_kv_chk
SL_g_f:
  s_mov_b64 exec, vcc
  buffer_load_dwordx4 v[36:39], v1, s[4:7], s42 offen sc1
  s_mov_b64 exec, -1
  s_add_u32 s46, s46, 1
  s_cmp_ge_u32 s46, 131072
  s_cbranch_scc1 SL_rec_abort
  s_waitcnt vmcnt(0)
  s_branch SL_g_chk
SL_m_f0:
  s_mov_b64 exec, vcc
  buffer_load_dwordx4 v[48:51], v3, s[4:7], s41 offen offset:0 sc1
  s_mov_b64 exec, -1
  s_waitcnt vmcnt(1)
  s_branch SL_m_0123_c1
SL_m_f1:
  s_mov_b64 exec, vcc
  buffer_load_dwordx4 v[52:55], v3, s[4:7], s41 offen offset:1024 sc1
  s_mov_b64 exec, -1
  s_waitcnt vmcnt(1)
  s_branch SL_m_123_c2
SL_m_f2:
  s_mov_b64 exec, vcc
  buffer_load_dwordx4 v[56:59], v3, s[4:7], s41 offen offset:2048 sc1
  s_mov_b64 exec, -1
  s_waitcnt vmcnt(1)
  s_branch SL_m_23_c3
SL_m_f3:
  s_mov_b64 exec, vcc
  buffer_load_dwordx4 v[60:63], v3, s[4:7], s41 offen offset:3072 sc1
  s_mov_b64 exec, -1
  s_nop 7
  s_branch SL_m_3_c3
SL_m_0_c0:
  v_max3_u32 v31, v48, v49, v50
  v_max_u32 v31, v31, v51
  v_cmp_eq_u32 vcc, -1, v31
  s_cbranch_vccz SL_m_0_ok0
SL_m_0_x0:
  s_mov_b64 exec, vcc
  buffer_load_dwordx4 v[48:51], v3, s[4:7], s41 offen offset:0 sc1
  s_mov_b64 exec, -1
  s_add_u32 s46, s46, 1
  s_cmp_ge_u32 s46, 131072
  s_cbranch_scc1 SL_rec_abort
  s_waitcnt vmcnt(2)
  s_branch SL_m_0_c0
SL_m_0_ok0:
  v_smfmac_f32_16x16x64_bf16 v[64:67], v[48:51], a[0:7], v23
  v_smfmac_f32_16x16x64_bf16 v[68:71], v[48:51], a[8:15], v23
  v_smfmac_f32_16x16x64_bf16 v[72:75], v[48:51], a[16:23], v23
  v_smfmac_f32_16x16x64_bf16 v[76:79], v[48:51], a[24:31], v23
  s_branch SL_m_done
SL_m_1_c1:
  v_max3_u32 v31, v52, v53, v54
  v_max_u32 v31, v31, v55
  v_cmp_eq_u32 vcc, -1, v31
  s_cbranch_vccz SL_m_1_ok1
SL_m_1_x1:
  s_mov_b64 exec, vcc
  buffer_load_dwordx4 v[52:55], v3, s[4:7], s41 offen offset:1024 sc1
  s_mov_b64 exec, -1
  s_add_u32 s46, s46, 1
  s_cmp_ge_u32 s46, 131072
  s_cbranch_scc1 SL_rec_abort
  s_waitcnt vmcnt(2)
  s_branch SL_m_1_c1
SL_m_1_ok1:
  v_smfmac_f32_16x16x64_bf16 v[64:67], v[52:55], a[48:55], v23
  v_smfmac_f32_16x16x64_bf16 v[68:71], v[52:55], a[56:63], v23
  v_smfmac_f32_16x16x64_bf16 v[72:75], v[52:55], a[64:71], v23
  v_smfmac_f32_16x16x64_bf16 v[76:79], v[52:55], a[72:79], v23
  s_branch SL_m_done
SL_m_2_c2:
  v_max3_u32 v31, v56, v57, v58
  v_max_u32 v31, v31, v59
  v_cmp_eq_u32 vcc, -1, v31
  s_cbranch_vccz SL_m_2_ok2
SL_m_2_x2:
  s_mov_b64 exec, vcc
  buffer_load_dwordx4 v[56:59], v3, s[4:7], s41 offen offset:2048 sc1
  s_mov_b64 exec, -1
  s_add_u32 s46, s46, 1
  s_cmp_ge_u32 s46, 131072
  s_cbranch_scc1 SL_rec_abort
  s_waitcnt vmcnt(2)
  s_branch SL_m_2_c2
SL_m_2_ok2:
  v_smfmac_f32_16x16x64_bf16 v[64:67], v[56:59], a[96:103], v23
  v_smfmac_f32_16x16x64_bf16 v[68:71], v[56:59], a[104:111], v23
  v_smfmac_f32_16x16x64_bf16 v[72:75], v[56:59], a[112:119], v23
  v_smfmac_f32_16x16x64_bf16 v[76:79], v[56:59], a[120:127], v23
  s_branch SL_m_done
SL_m_3_c3:
  v_max3_u32 v31, v60, v61, v62
  v_max_u32 v31, v31, v63
  v_cmp_eq_u32 vcc, -1, v31
  s_cbranch_vccz SL_m_3_ok3
SL_m_3_x3:
  s_mov_b64 exec, vcc
  buffer_load_dwordx4 v[60:63], v3, s[4:7], s41 offen offset:3072 sc1
  s_mov_b64 exec, -1
  s_add_u32 s46, s46, 1
  s_cmp_ge_u32 s46, 131072
  s_cbranch_scc1 SL_rec_abort
  s_waitcnt vmcnt(2)
  s_branch SL_m_3_c3
SL_m_3_ok3:
  v_smfmac_f32_16x16x64_bf16 v[64:67], v[60:63], a[144:151], v23
  v_smfmac_f32_16x16x64_bf16 v[68:71], v[60:63], a[152:159], v23
  v_smfmac_f32_16x16x64_bf16 v[72:75], v[60:63], a[160:167], v23
  v_smfmac_f32_16x16x64_bf16 v[76:79], v[60:63], a[168:175], v23
  s_branch SL_m_done
SL_m_01_c0:
  v_max3_u32 v31, v48, v49, v50
  v_max_u32 v31, v31, v51
  v_cmp_eq_u32 vcc, -1, v31
  s_cbranch_vccz SL_m_01_ok0
SL_m_01_x0:
  s_mov_b64 exec, vcc
  buffer_load_dwordx4 v[48:51], v3, s[4:7], s41 offen offset:0 sc1
  s_mov_b64 exec, -1
SL_m_01_c1:
  v_max3_u32 v31, v52, v53, v54
  v_max_u32 v31, v31, v55
  v_cmp_eq_u32 vcc, -1, v31
  s_cbranch_vccz SL_m_01_ok1
SL_m_01_x1:
  s_mov_b64 exec, vcc
  buffer_load_dwordx4 v[52:55], v3, s[4:7], s41 offen offset:1024 sc1
  s_mov_b64 exec, -1
  s_add_u32 s46, s46, 1
  s_cmp_ge_u32 s46, 131072
  s_cbranch_scc1 SL_rec_abort
  s_waitcnt vmcnt(4)
  s_branch SL_m_01_c0
SL_m_01_ok0:
  v_smfmac_f32_16x16x64_bf16 v[64:67], v[48:51], a[0:7], v23
  v_max3_u32 v31, v52, v53, v54
  v_max_u32 v31, v31, v55
  v_cmp_eq_u32 vcc, -1, v31
  v_smfmac_f32_16x16x64_bf16 v[68:71], v[48:51], a[8:15], v23
  v_smfmac_f32_16x16x64_bf16 v[72:75], v[48:51], a[16:23], v23
  v_smfmac_f32_16x16x64_bf16 v[76:79], v[48:51], a[24:31], v23
  s_cbranch_vccz SL_m_1_ok1
  s_branch SL_m_1_x1
SL_m_01_ok1:
  v_smfmac_f32_16x16x64_bf16 v[64:67], v[52:55], a[48:55], v23
  v_max3_u32 v31, v48, v49, v50
  v_max_u32 v31, v31, v51
  v_cmp_eq_u32 vcc, -1, v31
  v_smfmac_f32_16x16x64_bf16 v[68:71], v[52:55], a[56:63], v23
  v_smfmac_f32_16x16x64_bf16 v[72:75], v[52:55], a[64:71], v23
  v_smfmac_f32_16x16x64_bf16 v[76:79], v[52:55], a[72:79], v23
  s_cbranch_vccz SL_m_0_ok0
  s_branch SL_m_0_x0
SL_m_02_c0:
  v_max3_u32 v31, v48, v49, v50
  v_max_u32 v31, v31, v51
  v_cmp_eq_u32 vcc, -1, v31
  s_cbranch_vccz SL_m_02_ok0
SL_m_02_x0:
  s_mov_b64 exec, vcc
  buffer_load_dwordx4 v[48:51], v3, s[4:7], s41 offen offset:0 sc1
  s_mov_b64 exec, -1
SL_m_02_c2:
  v_max3_u32 v31, v56, v57, v58
  v_max_u32 v31, v31, v59
  v_cmp_eq_u32 vcc, -1, v31
  s_cbranch_vccz SL_m_02_ok2
SL_m_02_x2:
  s_mov_b64 exec, vcc
  buffer_load_dwordx4 v[56:59], v3, s[4:7], s41 offen offset:2048 sc1
  s_mov_b64 exec, -1
  s_add_u32 s46, s46, 1
  s_cmp_ge_u32 s46, 131072
  s_cbranch_scc1 SL_rec_abort
  s_waitcnt vmcnt(4)
  s_branch SL_m_02_c0
SL_m_02_ok0:
  v_smfmac_f32_16x16x64_bf16 v[64:67], v[48:51], a[0:7], v23
  v_max3_u32 v31, v56, v57, v58
  v_max_u32 v31, v31, v59
  v_cmp_eq_u32 vcc, -1, v31
  v_smfmac_f32_16x16x64_bf16 v[68:71], v[48:51], a[8:15], v23
  v_smfmac_f32_16x16x64_bf16 v[72:75], v[48:51], a[16:23], v23
  v_smfmac_f32_16x16x64_bf16 v[76:79], v[48:51], a[24:31], v23
  s_cbranch_vccz SL_m_2_ok2
  s_branch SL_m_2_x2
SL_m_02_ok2:
  v_smfmac_f32_16x16x64_bf16 v[64:67], v[56:59], a[96:103], v23
  v_max3_u32 v31, v48, v49, v50
  v_max_u32 v31, v31, v51
  v_cmp_eq_u32 vcc, -1, v31
  v_smfmac_f32_16x16x64_bf16 v[68:71], v[56:59], a[104:111], v23
  v_smfmac_f32_16x16x64_bf16 v[72:75], v[56:59], a[112:119], v23
  v_smfmac_f32_16x16x64_bf16 v[76:79], v[56:59], a[120:127], v23
  s_cbranch_vccz SL_m_0_ok0
  s_branch SL_m_0_x0
SL_m_03_c0:
  v_max3_u32 v31, v48, v49, v50
  v_max_u32 v31, v31, v51
  v_cmp_eq_u32 vcc, -1, v31
  s_cbranch_vccz SL_m_03_ok0
SL_m_03_x0:
  s_mov_b64 exec, vcc
  buffer_load_dwordx4 v[48:51], v3, s[4:7], s41 offen offset:0 sc1
  s_mov_b64 exec, -1
SL_m_03_c3:
  v_max3_u32 v31, v60, v61, v62
  v_max_u32 v31, v31, v63
  v_cmp_eq_u32 vcc, -1, v31
  s_cbranch_vccz SL_m_03_ok3
SL_m_03_x3:
  s_mov_b64 exec, vcc
  buffer_load_dwordx4 v[60:63], v3, s[4:7], s41 offen offset:3072 sc1
  s_mov_b64 exec, -1
  s_add_u32 s46, s46, 1
  s_cmp_ge_u32 s46, 131072
  s_cbranch_scc1 SL_rec_abort
  s_waitcnt vmcnt(4)
  s_branch SL_m_03_c0
SL_m_03_ok0:
  v_smfmac_f32_16x16x64_bf16 v[64:67], v[48:51], a[0:7], v23
  v_max3_u32 v31, v60, v61, v62
  v_max_u32 v31, v31, v63
  v_cmp_eq_u32 vcc, -1, v31
  v_smfmac_f32_16x16x64_bf16 v[68:71], v[48:51], a[8:15], v23
  v_smfmac_f32_16x16x64_bf16 v[72:75], v[48:51], a[16:23], v23
  v_smfmac_f32_16x16x64_bf16 v[76:79], v[48:51], a[24:31], v23
  s_cbranch_vccz SL_m_3_ok3
  s_branch SL_m_3_x3
SL_m_03_ok3:
  v_smfmac_f32_16x16x64_bf16 v[64:67], v[60:63], a[144:151], v23
  v_max3_u32 v31, v48, v49, v50
  v_max_u32 v31, v31, v51
  v_cmp_eq_u32 vcc, -1, v31
  v_smfmac_f32_16x16x64_bf16 v[68:71], v[60:63], a[152:159], v23
  v_smfmac_f32_16x16x64_bf16 v[72:75], v[60:63], a[160:167], v23
  v_smfmac_f32_16x16x64_bf16 v[76:79], v[60:63], a[168:175], v23
  s_cbranch_vccz SL_m_0_ok0
  s_branch SL_m_0_x0
SL_m_12_c1:
  v_max3_u32 v31, v52, v53, v54
  v_max_u32 v31, v31, v55
  v_cmp_eq_u32 vcc, -1, v31
  s_cbranch_vccz SL_m_12_ok1
SL_m_12_x1:
  s_mov_b64 exec, vcc
  buffer_load_dwordx4 v[52:55], v3, s[4:7], s41 offen offset:1024 sc1
  s_mov_b64 exec, -1
SL_m_12_c2:
  v_max3_u32 v31, v56, v57, v58
  v_max_u32 v31, v31, v59
  v_cmp_eq_u32 vcc, -1, v31
  s_cbranch_vccz SL_m_12_ok2
SL_m_12_x2:
  s_mov_b64 exec, vcc
  buffer_load_dwordx4 v[56:59], v3, s[4:7], s41 offen offset:2048 sc1
  s_mov_b64 exec, -1
  s_add_u32 s46, s46, 1
  s_cmp_ge_u32 s46, 131072
  s_cbranch_scc1 SL_rec_abort
  s_waitcnt vmcnt(4)
  s_branch SL_m_12_c1
SL_m_12_ok1:
  v_smfmac_f32_16x16x64_bf16 v[64:67], v[52:55], a[48:55], v23
  v_max3_u32 v31, v56, v57, v58
  v_max_u32 v31, v31, v59
  v_cmp_eq_u32 vcc, -1, v31
  v_smfmac_f32_16x16x64_bf16 v[68:71], v[52:55], a[56:63], v23
  v_smfmac_f32_16x16x64_bf16 v[72:75], v[52:55], a[64:71], v23
  v_smfmac_f32_16x16x64_bf16 v[76:79], v[52:55], a[72:79], v23
  s_cbranch_vccz SL_m_2_ok2
  s_branch SL_m_2_x2
SL_m_12_ok2:
  v_smfmac_f32_16x16x64_bf16 v[64:67], v[56:59], a[96:103], v23
  v_max3_u32 v31, v52, v53, v54
  v_max_u32 v31, v31, v55
  v_cmp_eq_u32 vcc, -1, v31
  v_smfmac_f32_16x16x64_bf16 v[68:71], v[56:59], a[104:111], v23
  v_smfmac_f32_16x16x64_bf16 v[72:75], v[56:59], a[112:119], v23
  v_smfmac_f32_16x16x64_bf16 v[76:79], v[56:59], a[120:127], v23
  s_cbranch_vccz SL_m_1_ok1
  s_branch SL_m_1_x1
SL_m_13_c1:
  v_max3_u32 v31, v52, v53, v54
  v_max_u32 v31, v31, v55
  v_cmp_eq_u32 vcc, -1, v31
  s_cbranch_vccz SL_m_13_ok1
SL_m_13_x1:
  s_mov_b64 exec, vcc
  buffer_load_dwordx4 v[52:55], v3, s[4:7], s41 offen offset:1024 sc1
  s_mov_b64 exec, -1
SL_m_13_c3:
  v_max3_u32 v31, v60, v61, v62
  v_max_u32 v31, v31, v63
  v_cmp_eq_u32 vcc, -1, v31
  s_cbranch_vccz SL_m_13_ok3
SL_m_13_x3:
  s_mov_b64 exec, vcc
  buffer_load_dwordx4 v[60:63], v3, s[4:7], s41 offen offset:3072 sc1
  s_mov_b64 exec, -1
  s_add_u32 s46, s46, 1
  s_cmp_ge_u32 s46, 131072
  s_cbranch_scc1 SL_rec_abort
  s_waitcnt vmcnt(4)
  s_branch SL_m_13_c1
SL_m_13_ok1:
  v_smfmac_f32_16x16x64_bf16 v[64:67], v[52:55], a[48:55], v23
  v_max3_u32 v31, v60, v61, v62
  v_max_u32 v31, v31, v63
  v_cmp_eq_u32 vcc, -1, v31
  v_smfmac_f32_16x16x64_bf16 v[68:71], v[52:55], a[56:63], v23
  v_smfmac_f32_16x16x64_bf16 v[72:75], v[52:55], a[64:71], v23
  v_smfmac_f32_16x16x64_bf16 v[76:79], v[52:55], a[72:79], v23
  s_cbranch_vccz SL_m_3_ok3
  s_branch SL_m_3_x3
SL_m_13_ok3:
  v_smfmac_f32_16x16x64_bf16 v[64:67], v[60:63], a[144:151], v23
  v_max3_u32 v31, v52, v53, v54
  v_max_u32 v31, v31, v55
  v_cmp_eq_u32 vcc, -1, v31
  v_smfmac_f32_16x16x64_bf16 v[68:71], v[60:63], a[152:159], v23
  v_smfmac_f32_16x16x64_bf16 v[72:75], v[60:63], a[160:167], v23
  v_smfmac_f32_16x16x64_bf16 v[76:79], v[60:63], a[168:175], v23
  s_cbranch_vccz SL_m_1_ok1
  s_branch SL_m_1_x1
SL_m_23_c2:
  v_max3_u32 v31, v56, v57, v58
  v_max_u32 v31, v31, v59
  v_cmp_eq_u32 vcc, -1, v31
  s_cbranch_vccz SL_m_23_ok2
SL_m_23_x2:
  s_mov_b64 exec, vcc
  buffer_load_dwordx4 v[56:59], v3, s[4:7], s41 offen offset:2048 sc1
  s_mov_b64 exec, -1
SL_m_23_c3:
  v_max3_u32 v31, v60, v61, v62
  v_max_u32 v31, v31, v63
  v_cmp_eq_u32 vcc, -1, v31
  s_cbranch_vccz SL_m_23_ok3
SL_m_23_x3:
  s_mov_b64 exec, vcc
  buffer_load_dwordx4 v[60:63], v3, s[4:7], s41 offen offset:3072 sc1
  s_mov_b64 exec, -1
  s_add_u32 s46, s46, 1
  s_cmp_ge_u32 s46, 131072
  s_cbranch_scc1 SL_rec_abort
  s_waitcnt vmcnt(4)
  s_branch SL_m_23_c2
SL_m_23_ok2:
  v_smfmac_f32_16x16x64_bf16 v[64:67], v[56:59], a[96:103], v23
  v_max3_u32 v31, v60, v61, v62
  v_max_u32 v31, v31, v63
  v_cmp_eq_u32 vcc, -1, v31
  v_smfmac_f32_16x16x64_bf16 v[68:71], v[56:59], a[104:111], v23
  v_smfmac_f32_16x16x64_bf16 v[72:75], v[56:59], a[112:119], v23
  v_smfmac_f32_16x16x64_bf16 v[76:79], v[56:59], a[120:127], v23
  s_cbranch_vccz SL_m_3_ok3
  s_branch SL_m_3_x3
SL_m_23_ok3:
  v_smfmac_f32_16x16x64_bf16 v[64:67], v[60:63], a[144:151], v23
  v_max3_u32 v31, v56, v57, v58
  v_max_u32 v31, v31, v59
  v_cmp_eq_u32 vcc, -1, v31
  v_smfmac_f32_16x16x64_bf16 v[68:71], v[60:63], a[152:159], v23
  v_smfmac_f32_16x16x64_bf16 v[72:75], v[60:63], a[160:167], v23
  v_smfmac_f32_16x16x64_bf16 v[76:79], v[60:63], a[168:175], v23
  s_cbranch_vccz SL_m_2_ok2
  s_branch SL_m_2_x2
SL_m_012_c0:
  v_max3_u32 v31, v48, v49, v50
  v_max_u32 v31, v31, v51
  v_cmp_eq_u32 vcc, -1, v31
  s_cbranch_vccz SL_m_012_ok0
SL_m_012_x0:
  s_mov_b64 exec, vcc
  buffer_load_dwordx4 v[48:51], v3, s[4:7], s41 offen offset:0 sc1
  s_mov_b64 exec, -1
SL_m_012_c1:
  v_max3_u32 v31, v52, v53, v54
  v_max_u32 v31, v31, v55
  v_cmp_eq_u32 vcc, -1, v31
  s_cbranch_vccz SL_m_012_ok1
SL_m_012_x1:
  s_mov_b64 exec, vcc
  buffer_load_dwordx4 v[52:55], v3, s[4:7], s41 offen offset:1024 sc1
  s_mov_b64 exec, -1
SL_m_012_c2:
  v_max3_u32 v31, v56, v57, v58
  v_max_u32 v31, v31, v59
  v_cmp_eq_u32 vcc, -1, v31
  s_cbranch_vccz SL_m_012_ok2
SL_m_012_x2:
  s_mov_b64 exec, vcc
  buffer_load_dwordx4 v[56:59], v3, s[4:7], s41 offen offset:2048 sc1
  s_mov_b64 exec, -1
  s_add_u32 s46, s46, 1
  s_cmp_ge_u32 s46, 131072
  s_cbranch_scc1 SL_rec_abort
  s_waitcnt vmcnt(4)
  s_branch SL_m_012_c0
SL_m_012_ok0:
  v_smfmac_f32_16x16x64_bf16 v[64:67], v[48:51], a[0:7], v23
  v_max3_u32 v31, v52, v53, v54
  v_max_u32 v31, v31, v55
  v_cmp_eq_u32 vcc, -1, v31
  v_smfmac_f32_16x16x64_bf16 v[68:71], v[48:51], a[8:15], v23
  v_smfmac_f32_16x16x64_bf16 v[72:75], v[48:51], a[16:23], v23
  v_smfmac_f32_16x16x64_bf16 v[76:79], v[48:51], a[24:31], v23
  s_cbranch_vccz SL_m_12_ok1
  s_branch SL_m_12_x1
SL_m_012_ok1:
  v_smfmac_f32_16x16x64_bf16 v[64:67], v[52:55], a[48:55], v23
  v_max3_u32 v31, v56, v57, v58
  v_max_u32 v31, v31, v59
  v_cmp_eq_u32 vcc, -1, v31
  v_smfmac_f32_16x16x64_bf16 v[68:71], v[52:55], a[56:63], v23
  v_smfmac_f32_16x16x64_bf16 v[72:75], v[52:55], a[64:71], v23
  v_smfmac_f32_16x16x64_bf16 v[76:79], v[52:55], a[72:79], v23
  s_cbranch_vccz SL_m_02_ok2
  s_branch SL_m_02_x2
SL_m_012_ok2:
  v_smfmac_f32_16x16x64_bf16 v[64:67], v[56:59], a[96:103], v23
  v_max3_u32 v31, v48, v49, v50
  v_max_u32 v31, v31, v51
  v_cmp_eq_u32 vcc, -1, v31
  v_smfmac_f32_16x16x64_bf16 v[68:71], v[56:59], a[104:111], v23
  v_smfmac_f32_16x16x64_bf16 v[72:75], v[56:59], a[112:119], v23
  v_smfmac_f32_16x16x64_bf16 v[76:79], v[56:59], a[120:127], v23
  s_cbranch_vccz SL_m_01_ok0
  s_branch SL_m_01_x0
SL_m_013_c0:
  v_max3_u32 v31, v48, v49, v50
  v_max_u32 v31, v31, v51
  v_cmp_eq_u32 vcc, -1, v31
  s_cbranch_vccz SL_m_013_ok0
SL_m_013_x0:
  s_mov_b64 exec, vcc
  buffer_load_dwordx4 v[48:51], v3, s[4:7], s41 offen offset:0 sc1
  s_mov_b64 exec, -1
SL_m_013_c1:
  v_max3_u32 v31, v52, v53, v54
  v_max_u32 v31, v31, v55
  v_cmp_eq_u32 vcc, -1, v31
  s_cbranch_vccz SL_m_013_ok1
SL_m_013_x1:
  s_mov_b64 exec, vcc
  buffer_load_dwordx4 v[52:55], v3, s[4:7], s41 offen offset:1024 sc1
  s_mov_b64 exec, -1
SL_m_013_c3:
  v_max3_u32 v31, v60, v61, v62
  v_max_u32 v31, v31, v63
  v_cmp_eq_u32 vcc, -1, v31
  s_cbranch_vccz SL_m_013_ok3
SL_m_013_x3:
  s_mov_b64 exec, vcc
  buffer_load_dwordx4 v[60:63], v3, s[4:7], s41 offen offset:3072 sc1
  s_mov_b64 exec, -1
  s_add_u32 s46, s46, 1
  s_cmp_ge_u32 s46, 131072
  s_cbranch_scc1 SL_rec_abort
  s_waitcnt vmcnt(4)
  s_branch SL_m_013_c0
SL_m_013_ok0:
  v_smfmac_f32_16x16x64_bf16 v[64:67], v[48:51], a[0:7], v23
  v_max3_u32 v31, v52, v53, v54
  v_max_u32 v31, v31, v55
  v_cmp_eq_u32 vcc, -1, v31
  v_smfmac_f32_16x16x64_bf16 v[68:71], v[48:51], a[8:15], v23
  v_smfmac_f32_16x16x64_bf16 v[72:75], v[48:51], a[16:23], v23
  v_smfmac_f32_16x16x64_bf16 v[76:79], v[48:51], a[24:31], v23
  s_cbranch_vccz SL_m_13_ok1
  s_branch SL_m_13_x1
SL_m_013_ok1:
  v_smfmac_f32_16x16x64_bf16 v[64:67], v[52:55], a[48:55], v23
  v_max3_u32 v31, v60, v61, v62
  v_max_u32 v31, v31, v63
  v_cmp_eq_u32 vcc, -1, v31
  v_smfmac_f32_16x16x64_bf16 v[68:71], v[52:55], a[56:63], v23
  v_smfmac_f32_16x16x64_bf16 v[72:75], v[52:55], a[64:71], v23
  v_smfmac_f32_16x16x64_bf16 v[76:79], v[52:55], a[72:79], v23
  s_cbranch_vccz SL_m_03_ok3
  s_branch SL_m_03_x3
SL_m_013_ok3:
  v_smfmac_f32_16x16x64_bf16 v[64:67], v[60:63], a[144:151], v23
  v_max3_u32 v31, v48, v49, v50
  v_max_u32 v31, v31, v51
  v_cmp_eq_u32 vcc, -1, v31
  v_smfmac_f32_16x16x64_bf16 v[68:71], v[60:63], a[152:159], v23
  v_smfmac_f32_16x16x64_bf16 v[72:75], v[60:63], a[160:167], v23
  v_smfmac_f32_16x16x64_bf16 v[76:79], v[60:63], a[168:175], v23
  s_cbranch_vccz SL_m_01_ok0
  s_branch SL_m_01_x0
SL_m_023_c0:
  v_max3_u32 v31, v48, v49, v50
  v_max_u32 v31, v31, v51
  v_cmp_eq_u32 vcc, -1, v31
  s_cbranch_vccz SL_m_023_ok0
SL_m_023_x0:
  s_mov_b64 exec, vcc
  buffer_load_dwordx4 v[48:51], v3, s[4:7], s41 offen offset:0 sc1
  s_mov_b64 exec, -1
SL_m_023_c2:
  v_max3_u32 v31, v56, v57, v58
  v_max_u32 v31, v31, v59
  v_cmp_eq_u32 vcc, -1, v31
  s_cbranch_vccz SL_m_023_ok2
SL_m_023_x2:
  s_mov_b64 exec, vcc
  buffer_load_dwordx4 v[56:59], v3, s[4:7], s41 offen offset:2048 sc1
  s_mov_b64 exec, -1
SL_m_023_c3:
  v_max3_u32 v31, v60, v61, v62
  v_max_u32 v31, v31, v63
  v_cmp_eq_u32 vcc, -1, v31
  s_cbranch_vccz SL_m_023_ok3
SL_m_023_x3:
  s_mov_b64 exec, vcc
  buffer_load_dwordx4 v[60:63], v3, s[4:7], s41 offen offset:3072 sc1
  s_mov_b64 exec, -1
  s_add_u32 s46, s46, 1
  s_cmp_ge_u32 s46, 131072
  s_cbranch_scc1 SL_rec_abort
  s_waitcnt vmcnt(4)
  s_branch SL_m_023_c0
SL_m_023_ok0:
  v_smfmac_f32_16x16x64_bf16 v[64:67], v[48:51], a[0:7], v23
  v_max3_u32 v31, v56, v57, v58
  v_max_u32 v31, v31, v59
  v_cmp_eq_u32 vcc, -1, v31
  v_smfmac_f32_16x16x64_bf16 v[68:71], v[48:51], a[8:15], v23
  v_smfmac_f32_16x16x64_bf16 v[72:75], v[48:51], a[16:23], v23
  v_smfmac_f32_16x16x64_bf16 v[76:79], v[48:51], a[24:31], v23
  s_cbranch_vccz SL_m_23_ok2
  s_branch SL_m_23_x2
SL_m_023_ok2:
  v_smfmac_f32_16x16x64_bf16 v[64:67], v[56:59], a[96:103], v23
  v_max3_u32 v31, v60, v61, v62
  v_max_u32 v31, v31, v63
  v_cmp_eq_u32 vcc, -1, v31
  v_smfmac_f32_16x16x64_bf16 v[68:71], v[56:59], a[104:111], v23
  v_smfmac_f32_16x16x64_bf16 v[72:75], v[56:59], a[112:119], v23
  v_smfmac_f32_16x16x64_bf16 v[76:79], v[56:59], a[120:127], v23
  s_cbranch_vccz SL_m_03_ok3
  s_branch SL_m_03_x3
SL_m_023_ok3:
  v_smfmac_f32_16x16x64_bf16 v[64:67], v[60:63], a[144:151], v23
  v_max3_u32 v31, v48, v49, v50
  v_max_u32 v31, v31, v51
  v_cmp_eq_u32 vcc, -1, v31
  v_smfmac_f32_16x16x64_bf16 v[68:71], v[60:63], a[152:159], v23
  v_smfmac_f32_16x16x64_bf16 v[72:75], v[60:63], a[160:167], v23
  v_smfmac_f32_16x16x64_bf16 v[76:79], v[60:63], a[168:175], v23
  s_cbranch_vccz SL_m_02_ok0
  s_branch SL_m_02_x0
SL_m_123_c1:
  v_max3_u32 v31, v52, v53, v54
  v_max_u32 v31, v31, v55
  v_cmp_eq_u32 vcc, -1, v31
  s_cbranch_vccz SL_m_123_ok1
SL_m_123_x1:
  s_mov_b64 exec, vcc
  buffer_load_dwordx4 v[52:55], v3, s[4:7], s41 offen offset:1024 sc1
  s_mov_b64 exec, -1
SL_m_123_c2:
  v_max3_u32 v31, v56, v57, v58
  v_max_u32 v31, v31, v59
  v_cmp_eq_u32 vcc, -1, v31
  s_cbranch_vccz SL_m_123_ok2
SL_m_123_x2:
  s_mov_b64 exec, vcc
  buffer_load_dwordx4 v[56:59], v3, s[4:7], s41 offen offset:2048 sc1
  s_mov_b64 exec, -1
SL_m_123_c3:
  v_max3_u32 v31, v60, v61, v62
  v_max_u32 v31, v31, v63
  v_cmp_eq_u32 vcc, -1, v31
  s_cbranch_vccz SL_m_123_ok3
SL_m_123_x3:
  s_mov_b64 exec, vcc
  buffer_load_dwordx4 v[60:63], v3, s[4:7], s41 offen offset:3072 sc1
  s_mov_b64 exec, -1
  s_add_u32 s46, s46, 1
  s_cmp_ge_u32 s46, 131072
  s_cbranch_scc1 SL_rec_abort
  s_waitcnt vmcnt(4)
  s_branch SL_m_123_c1
SL_m_123_ok1:
  v_smfmac_f32_16x16x64_bf16 v[64:67], v[52:55], a[48:55], v23
  v_max3_u32 v31, v56, v57, v58
  v_max_u32 v31, v31, v59
  v_cmp_eq_u32 vcc, -1, v31
  v_smfmac_f32_16x16x64_bf16 v[68:71], v[52:55], a[56:63], v23
  v_smfmac_f32_16x16x64_bf16 v[72:75], v[52:55], a[64:71], v23
  v_smfmac_f32_16x16x64_bf16 v[76:79], v[52:55], a[72:79], v23
  s_cbranch_vccz SL_m_23_ok2
  s_branch SL_m_23_x2
SL_m_123_ok2:
  v_smfmac_f32_16x16x64_bf16 v[64:67], v[56:59], a[96:103], v23
  v_max3_u32 v31, v60, v61, v62
  v_max_u32 v31, v31, v63
  v_cmp_eq_u32 vcc, -1, v31
  v_smfmac_f32_16x16x64_bf16 v[68:71], v[56:59], a[104:111], v23
  v_smfmac_f32_16x16x64_bf16 v[72:75], v[56:59], a[112:119], v23
  v_smfmac_f32_16x16x64_bf16 v[76:79], v[56:59], a[120:127], v23
  s_cbranch_vccz SL_m_13_ok3
  s_branch SL_m_13_x3
SL_m_123_ok3:
  v_smfmac_f32_16x16x64_bf16 v[64:67], v[60:63], a[144:151], v23
  v_max3_u32 v31, v52, v53, v54
  v_max_u32 v31, v31, v55
  v_cmp_eq_u32 vcc, -1, v31
  v_smfmac_f32_16x16x64_bf16 v[68:71], v[60:63], a[152:159], v23
  v_smfmac_f32_16x16x64_bf16 v[72:75], v[60:63], a[160:167], v23
  v_smfmac_f32_16x16x64_bf16 v[76:79], v[60:63], a[168:175], v23
  s_cbranch_vccz SL_m_12_ok1
  s_branch SL_m_12_x1
SL_m_0123_c0:
  v_max3_u32 v31, v48, v49, v50
  v_max_u32 v31, v31, v51
  v_cmp_eq_u32 vcc, -1, v31
  s_cbranch_vccz SL_m_0123_ok0
SL_m_0123_x0:
  s_mov_b64 exec, vcc
  buffer_load_dwordx4 v[48:51], v3, s[4:7], s41 offen offset:0 sc1
  s_mov_b64 exec, -1
SL_m_0123_c1:
  v_max3_u32 v31, v52, v53, v54
  v_max_u32 v31, v31, v55
  v_cmp_eq_u32 vcc, -1, v31
  s_cbranch_vccz SL_m_0123_ok1
SL_m_0123_x1:
  s_mov_b64 exec, vcc
  buffer_load_dwordx4 v[52:55], v3, s[4:7], s41 offen offset:1024 sc1
  s_mov_b64 exec, -1
SL_m_0123_c2:
  v_max3_u32 v31, v56, v57, v58
  v_max_u32 v31, v31, v59
  v_cmp_eq_u32 vcc, -1, v31
  s_cbranch_vccz SL_m_0123_ok2
SL_m_0123_x2:
  s_mov_b64 exec, vcc
  buffer_load_dwordx4 v[56:59], v3, s[4:7], s41 offen offset:2048 sc1
  s_mov_b64 exec, -1
SL_m_0123_c3:
  v_max3_u32 v31, v60, v61, v62
  v_max_u32 v31, v31, v63
  v_cmp_eq_u32 vcc, -1, v31
  s_cbranch_vccz SL_m_0123_ok3
SL_m_0123_x3:
  s_mov_b64 exec, vcc
  buffer_load_dwordx4 v[60:63], v3, s[4:7], s41 offen offset:3072 sc1
  s_mov_b64 exec, -1
  s_add_u32 s46, s46, 1
  s_cmp_ge_u32 s46, 131072
  s_cbranch_scc1 SL_rec_abort
  s_waitcnt vmcnt(4)
  s_branch SL_m_0123_c0
SL_m_0123_ok0:
  v_smfmac_f32_16x16x64_bf16 v[64:67], v[48:51], a[0:7], v23
  v_max3_u32 v31, v52, v53, v54
  v_max_u32 v31, v31, v55
  v_cmp_eq_u32 vcc, -1, v31
  v_smfmac_f32_16x16x64_bf16 v[68:71], v[48:51], a[8:15], v23
  v_smfmac_f32_16x16x64_bf16 v[72:75], v[48:51], a[16:23], v23
  v_smfmac_f32_16x16x64_bf16 v[76:79], v[48:51], a[24:31], v23
  s_cbranch_vccz SL_m_123_ok1
  s_branch SL_m_123_x1
SL_m_0123_ok1:
  v_smfmac_f32_16x16x64_bf16 v[64:67], v[52:55], a[48:55], v23
  v_max3_u32 v31, v56, v57, v58
  v_max_u32 v31, v31, v59
  v_cmp_eq_u32 vcc, -1, v31
  v_smfmac_f32_16x16x64_bf16 v[68:71], v[52:55], a[56:63], v23
  v_smfmac_f32_16x16x64_bf16 v[72:75], v[52:55], a[64:71], v23
  v_smfmac_f32_16x16x64_bf16 v[76:79], v[52:55], a[72:79], v23
  s_cbranch_vccz SL_m_023_ok2
  s_branch SL_m_023_x2
SL_m_0123_ok2:
  v_smfmac_f32_16x16x64_bf16 v[64:67], v[56:59], a[96:103], v23
  v_max3_u32 v31, v60, v61, v62
  v_max_u32 v31, v31, v63
  v_cmp_eq_u32 vcc, -1, v31
  v_smfmac_f32_16x16x64_bf16 v[68:71], v[56:59], a[104:111], v23
  v_smfmac_f32_16x16x64_bf16 v[72:75], v[56:59], a[112:119], v23
  v_smfmac_f32_16x16x64_bf16 v[76:79], v[56:59], a[120:127], v23
  s_cbranch_vccz SL_m_013_ok3
  s_branch SL_m_013_x3
SL_m_0123_ok3:
  v_smfmac_f32_16x16x64_bf16 v[64:67], v[60:63], a[144:151], v23
  v_max3_u32 v31, v48, v49, v50
  v_max_u32 v31, v31, v51
  v_cmp_eq_u32 vcc, -1, v31
  v_smfmac_f32_16x16x64_bf16 v[68:71], v[60:63], a[152:159], v23
  v_smfmac_f32_16x16x64_bf16 v[72:75], v[60:63], a[160:167], v23
  v_smfmac_f32_16x16x64_bf16 v[76:79], v[60:63], a[168:175], v23
  s_cbranch_vccz SL_m_012_ok0
  s_branch SL_m_012_x0
SL_x_f0:
  s_mov_b64 exec, vcc
  buffer_load_dwordx4 v[64:67], v9, s[4:7], s41 offen offset:0 sc1
  s_mov_b64 exec, -1
  s_waitcnt vmcnt(1)
  s_branch SL_x_0123_c1
SL_x_f1:
  s_mov_b64 exec, vcc
  buffer_load_dwordx4 v[68:71], v9, s[4:7], s41 offen offset:1024 sc1
  s_mov_b64 exec, -1
  s_waitcnt vmcnt(1)
  s_branch SL_x_123_c2
SL_x_f2:
  s_mov_b64 exec, vcc
  buffer_load_dwordx4 v[72:75], v9, s[4:7], s41 offen offset:2048 sc1
  s_mov_b64 exec, -1
  s_waitcnt vmcnt(1)
  s_branch SL_x_23_c3
SL_x_f3:
  s_mov_b64 exec, vcc
  buffer_load_dwordx4 v[76:79], v9, s[4:7], s41 offen offset:3072 sc1
  s_mov_b64 exec, -1
  s_nop 7
  s_branch SL_x_3_c3
SL_x_0_c0:
  v_max3_u32 v31, v64, v65, v66
  v_max_u32 v31, v31, v67
  v_cmp_eq_u32 vcc, -1, v31
  s_cbranch_vccz SL_x_0_ok0
SL_x_0_x0:
  s_mov_b64 exec, vcc
  buffer_load_dwordx4 v[64:67], v9, s[4:7], s41 offen offset:0 sc1
  s_mov_b64 exec, -1
  s_add_u32 s46, s46, 1
  s_cmp_ge_u32 s46, 131072
  s_cbranch_scc1 SL_rec_abort
  s_waitcnt vmcnt(2)
  s_branch SL_x_0_c0
SL_x_0_ok0:
  v_mfma_f32_16x16x32_bf16 v[44:47], v[64:67], v[64:67], v[44:47]
  v_mfma_f32_16x16x32_bf16 v[36:39], v[116:119], v[64:67], v[36:39]
  v_mfma_f32_16x16x32_bf16 v[40:43], v[132:135], v[64:67], v[40:43]
  s_branch SL_x_done
SL_x_1_c1:
  v_max3_u32 v31, v68, v69, v70
  v_max_u32 v31, v31, v71
  v_cmp_eq_u32 vcc, -1, v31
  s_cbranch_vccz SL_x_1_ok1
SL_x_1_x1:
  s_mov_b64 exec, vcc
  buffer_load_dwordx4 v[68:71], v9, s[4:7], s41 offen offset:1024 sc1
  s_mov_b64 exec, -1
  s_add_u32 s46, s46, 1
  s_cmp_ge_u32 s46, 131072
  s_cbranch_scc1 SL_rec_abort
  s_waitcnt vmcnt(2)
  s_branch SL_x_1_c1
SL_x_1_ok1:
  v_mfma_f32_16x16x32_bf16 v[44:47], v[68:71], v[68:71], v[44:47]
  v_mfma_f32_16x16x32_bf16 v[36:39], v[120:123], v[68:71], v[36:39]
  v_mfma_f32_16x16x32_bf16 v[40:43], v[136:139], v[68:71], v[40:43]
  s_branch SL_x_done
SL_x_2_c2:
  v_max3_u32 v31, v72, v73, v74
  v_max_u32 v31, v31, v75
  v_cmp_eq_u32 vcc, -1, v31
  s_cbranch_vccz SL_x_2_ok2
SL_x_2_x2:
  s_mov_b64 exec, vcc
  buffer_load_dwordx4 v[72:75], v9, s[4:7], s41 offen offset:2048 sc1
  s_mov_b64 exec, -1
  s_add_u32 s46, s46, 1
  s_cmp_ge_u32 s46, 131072
  s_cbranch_scc1 SL_rec_abort
  s_waitcnt vmcnt(2)
  s_branch SL_x_2_c2
SL_x_2_ok2:
  v_mfma_f32_16x16x32_bf16 v[44:47], v[72:75], v[72:75], v[44:47]
  v_mfma_f32_16x16x32_bf16 v[36:39], v[124:127], v[72:75], v[36:39]
  v_mfma_f32_16x16x32_bf16 v[40:43], v[140:143], v[72:75], v[40:43]
  s_branch SL_x_done
SL_x_3_c3:
  v_max3_u32 v31, v76, v77, v78
  v_max_u32 v31, v31, v79
  v_cmp_eq_u32 vcc, -1, v31
  s_cbranch_vccz SL_x_3_ok3
SL_x_3_x3:
  s_mov_b64 exec, vcc
  buffer_load_dwordx4 v[76:79], v9, s[4:7], s41 offen offset:3072 sc1
  s_mov_b64 exec, -1
  s_add_u32 s46, s46, 1
  s_cmp_ge_u32 s46, 131072
  s_cbranch_scc1 SL_rec_abort
  s_waitcnt vmcnt(2)
  s_branch SL_x_3_c3
SL_x_3_ok3:
  v_mfma_f32_16x16x32_bf16 v[44:47], v[76:79], v[76:79], v[44:47]
  v_mfma_f32_16x16x32_bf16 v[36:39], v[128:131], v[76:79], v[36:39]
  v_mfma_f32_16x16x32_bf16 v[40:43], v[144:147], v[76:79], v[40:43]
  s_branch SL_x_done
SL_x_01_c0:
  v_max3_u32 v31, v64, v65, v66
  v_max_u32 v31, v31, v67
  v_cmp_eq_u32 vcc, -1, v31
  s_cbranch_vccz SL_x_01_ok0
SL_x_01_x0:
  s_mov_b64 exec, vcc
  buffer_load_dwordx4 v[64:67], v9, s[4:7], s41 offen offset:0 sc1
  s_mov_b64 exec, -1
SL_x_01_c1:
  v_max3_u32 v31, v68, v69, v70
  v_max_u32 v31, v31, v71
  v_cmp_eq_u32 vcc, -1, v31
  s_cbranch_vccz SL_x_01_ok1
SL_x_01_x1:
  s_mov_b64 exec, vcc
  buffer_load_dwordx4 v[68:71], v9, s[4:7], s41 offen offset:1024 sc1
  s_mov_b64 exec, -1
  s_add_u32 s46, s46, 1
  s_cmp_ge_u32 s46, 131072
  s_cbranch_scc1 SL_rec_abort
  s_waitcnt vmcnt(4)
  s_branch SL_x_01_c0
SL_x_01_ok0:
  v_mfma_f32_16x16x32_bf16 v[44:47], v[64:67], v[64:67], v[44:47]
  v_max3_u32 v31, v68, v69, v70
  v_max_u32 v31, v31, v71
  v_cmp_eq_u32 vcc, -1, v31
  v_mfma_f32_16x16x32_bf16 v[36:39], v[116:119], v[64:67], v[36:39]
  v_mfma_f32_16x16x32_bf16 v[40:43], v[132:135], v[64:67], v[40:43]
  s_cbranch_vccz SL_x_1_ok1
  s_branch SL_x_1_x1
SL_x_01_ok1:
  v_mfma_f32_16x16x32_bf16 v[44:47], v[68:71], v[68:71], v[44:47]
  v_max3_u32 v31, v64, v65, v66
  v_max_u32 v31, v31, v67
  v_cmp_eq_u32 vcc, -1, v31
  v_mfma_f32_16x16x32_bf16 v[36:39], v[120:123], v[68:71], v[36:39]
  v_mfma_f32_16x16x32_bf16 v[40:43], v[136:139], v[68:71], v[40:43]
  s_cbranch_vccz SL_x_0_ok0
  s_branch SL_x_0_x0
SL_x_02_c0:
  v_max3_u32 v31, v64, v65, v66
  v_max_u32 v31, v31, v67
  v_cmp_eq_u32 vcc, -1, v31
  s_cbranch_vccz SL_x_02_ok0
SL_x_02_x0:
  s_mov_b64 exec, vcc
  buffer_load_dwordx4 v[64:67], v9, s[4:7], s41 offen offset:0 sc1
  s_mov_b64 exec, -1
SL_x_02_c2:
  v_max3_u32 v31, v72, v73, v74
  v_max_u32 v31, v31, v75
  v_cmp_eq_u32 vcc, -1, v31
  s_cbranch_vccz SL_x_02_ok2
SL_x_02_x2:
  s_mov_b64 exec, vcc
  buffer_load_dwordx4 v[72:75], v9, s[4:7], s41 offen offset:2048 sc1
  s_mov_b64 exec, -1
  s_add_u32 s46, s46, 1
  s_cmp_ge_u32 s46, 131072
  s_cbranch_scc1 SL_rec_abort
  s_waitcnt vmcnt(4)
  s_branch SL_x_02_c0
SL_x_02_ok0:
  v_mfma_f32_16x16x32_bf16 v[44:47], v[64:67], v[64:67], v[44:47]
  v_max3_u32 v31, v72, v73, v74
  v_max_u32 v31, v31, v75
  v_cmp_eq_u32 vcc, -1, v31
  v_mfma_f32_16x16x32_bf16 v[36:39], v[116:119], v[64:67], v[36:39]
  v_mfma_f32_16x16x32_bf16 v[40:43], v[132:135], v[64:67], v[40:43]
  s_cbranch_vccz SL_x_2_ok2
  s_branch SL_x_2_x2
SL_x_02_ok2:
  v_mfma_f32_16x16x32_bf16 v[44:47], v[72:75], v[72:75], v[44:47]
  v_max3_u32 v31, v64, v65, v66
  v_max_u32 v31, v31, v67
  v_cmp_eq_u32 vcc, -1, v31
  v_mfma_f32_16x16x32_bf16 v[36:39], v[124:127], v[72:75], v[36:39]
  v_mfma_f32_16x16x32_bf16 v[40:43], v[140:143], v[72:75], v[40:43]
  s_cbranch_vccz SL_x_0_ok0
  s_branch SL_x_0_x0
SL_x_03_c0:
  v_max3_u32 v31, v64, v65, v66
  v_max_u32 v31, v31, v67
  v_cmp_eq_u32 vcc, -1, v31
  s_cbranch_vccz SL_x_03_ok0
SL_x_03_x0:
  s_mov_b64 exec, vcc
  buffer_load_dwordx4 v[64:67], v9, s[4:7], s41 offen offset:0 sc1
  s_mov_b64 exec, -1
SL_x_03_c3:
  v_max3_u32 v31, v76, v77, v78
  v_max_u32 v31, v31, v79
  v_cmp_eq_u32 vcc, -1, v31
  s_cbranch_vccz SL_x_03_ok3
SL_x_03_x3:
  s_mov_b64 exec, vcc
  buffer_load_dwordx4 v[76:79], v9, s[4:7], s41 offen offset:3072 sc1
  s_mov_b64 exec, -1
  s_add_u32 s46, s46, 1
  s_cmp_ge_u32 s46, 131072
  s_cbranch_scc1 SL_rec_abort
  s_waitcnt vmcnt(4)
  s_branch SL_x_03_c0
SL_x_03_ok0:
  v_mfma_f32_16x16x32_bf16 v[44:47], v[64:67], v[64:67], v[44:47]
  v_max3_u32 v31, v76, v77, v78
  v_max_u32 v31, v31, v79
  v_cmp_eq_u32 vcc, -1, v31
  v_mfma_f32_16x16x32_bf16 v[36:39], v[116:119], v[64:67], v[36:39]
  v_mfma_f32_16x16x32_bf16 v[40:43], v[132:135], v[64:67], v[40:43]
  s_cbranch_vccz SL_x_3_ok3
  s_branch SL_x_3_x3
SL_x_03_ok3:
  v_mfma_f32_16x16x32_bf16 v[44:47], v[76:79], v[76:79], v[44:47]
  v_max3_u32 v31, v64, v65, v66
  v_max_u32 v31, v31, v67
  v_cmp_eq_u32 vcc, -1, v31
  v_mfma_f32_16x16x32_bf16 v[36:39], v[128:131], v[76:79], v[36:39]
  v_mfma_f32_16x16x32_bf16 v[40:43], v[144:147], v[76:79], v[40:43]
  s_cbranch_vccz SL_x_0_ok0
  s_branch SL_x_0_x0
SL_x_12_c1:
  v_max3_u32 v31, v68, v69, v70
  v_max_u32 v31, v31, v71
  v_cmp_eq_u32 vcc, -1, v31
  s_cbranch_vccz SL_x_12_ok1
SL_x_12_x1:
  s_mov_b64 exec, vcc
  buffer_load_dwordx4 v[68:71], v9, s[4:7], s41 offen offset:1024 sc1
  s_mov_b64 exec, -1
SL_x_12_c2:
  v_max3_u32 v31, v72, v73, v74
  v_max_u32 v31, v31, v75
  v_cmp_eq_u32 vcc, -1, v31
  s_cbranch_vccz SL_x_12_ok2
SL_x_12_x2:
  s_mov_b64 exec, vcc
  buffer_load_dwordx4 v[72:75], v9, s[4:7], s41 offen offset:2048 sc1
  s_mov_b64 exec, -1
  s_add_u32 s46, s46, 1
  s_cmp_ge_u32 s46, 131072
  s_cbranch_scc1 SL_rec_abort
  s_waitcnt vmcnt(4)
  s_branch SL_x_12_c1
SL_x_12_ok1:
  v_mfma_f32_16x16x32_bf16 v[44:47], v[68:71], v[68:71], v[44:47]
  v_max3_u32 v31, v72, v73, v74
  v_max_u32 v31, v31, v75
  v_cmp_eq_u32 vcc, -1, v31
  v_mfma_f32_16x16x32_bf16 v[36:39], v[120:123], v[68:71], v[36:39]
  v_mfma_f32_16x16x32_bf16 v[40:43], v[136:139], v[68:71], v[40:43]
  s_cbranch_vccz SL_x_2_ok2
  s_branch SL_x_2_x2
SL_x_12_ok2:
  v_mfma_f32_16x16x32_bf16 v[44:47], v[72:75], v[72:75], v[44:47]
  v_max3_u32 v31, v68, v69, v70
  v_max_u32 v31, v31, v71
  v_cmp_eq_u32 vcc, -1, v31
  v_mfma_f32_16x16x32_bf16 v[36:39], v[124:127], v[72:75], v[36:39]
  v_mfma_f32_16x16x32_bf16 v[40:43], v[140:143], v[72:75], v[40:43]
  s_cbranch_vccz SL_x_1_ok1
  s_branch SL_x_1_x1
SL_x_13_c1:
  v_max3_u32 v31, v68, v69, v70
  v_max_u32 v31, v31, v71
  v_cmp_eq_u32 vcc, -1, v31
  s_cbranch_vccz SL_x_13_ok1
SL_x_13_x1:
  s_mov_b64 exec, vcc
  buffer_load_dwordx4 v[68:71], v9, s[4:7], s41 offen offset:1024 sc1
  s_mov_b64 exec, -1
SL_x_13_c3:
  v_max3_u32 v31, v76, v77, v78
  v_max_u32 v31, v31, v79
  v_cmp_eq_u32 vcc, -1, v31
  s_cbranch_vccz SL_x_13_ok3
SL_x_13_x3:
  s_mov_b64 exec, vcc
  buffer_load_dwordx4 v[76:79], v9, s[4:7], s41 offen offset:3072 sc1
  s_mov_b64 exec, -1
  s_add_u32 s46, s46, 1
  s_cmp_ge_u32 s46, 131072
  s_cbranch_scc1 SL_rec_abort
  s_waitcnt vmcnt(4)
  s_branch SL_x_13_c1
SL_x_13_ok1:
  v_mfma_f32_16x16x32_bf16 v[44:47], v[68:71], v[68:71], v[44:47]
  v_max3_u32 v31, v76, v77, v78
  v_max_u32 v31, v31, v79
  v_cmp_eq_u32 vcc, -1, v31
  v_mfma_f32_16x16x32_bf16 v[36:39], v[120:123], v[68:71], v[36:39]
  v_mfma_f32_16x16x32_bf16 v[40:43], v[136:139], v[68:71], v[40:43]
  s_cbranch_vccz SL_x_3_ok3
  s_branch SL_x_3_x3
SL_x_13_ok3:
  v_mfma_f32_16x16x32_bf16 v[44:47], v[76:79], v[76:79], v[44:47]
  v_max3_u32 v31, v68, v69, v70
  v_max_u32 v31, v31, v71
  v_cmp_eq_u32 vcc, -1, v31
  v_mfma_f32_16x16x32_bf16 v[36:39], v[128:131], v[76:79], v[36:39]
  v_mfma_f32_16x16x32_bf16 v[40:43], v[144:147], v[76:79], v[40:43]
  s_cbranch_vccz SL_x_1_ok1
  s_branch SL_x_1_x1
SL_x_23_c2:
  v_max3_u32 v31, v72, v73, v74
  v_max_u32 v31, v31, v75
  v_cmp_eq_u32 vcc, -1, v31
  s_cbranch_vccz SL_x_23_ok2
SL_x_23_x2:
  s_mov_b64 exec, vcc
  buffer_load_dwordx4 v[72:75], v9, s[4:7], s41 offen offset:2048 sc1
  s_mov_b64 exec, -1
SL_x_23_c3:
  v_max3_u32 v31, v76, v77, v78
  v_max_u32 v31, v31, v79
  v_cmp_eq_u32 vcc, -1, v31
  s_cbranch_vccz SL_x_23_ok3
SL_x_23_x3:
  s_mov_b64 exec, vcc
  buffer_load_dwordx4 v[76:79], v9, s[4:7], s41 offen offset:3072 sc1
  s_mov_b64 exec, -1
  s_add_u32 s46, s46, 1
  s_cmp_ge_u32 s46, 131072
  s_cbranch_scc1 SL_rec_abort
  s_waitcnt vmcnt(4)
  s_branch SL_x_23_c2
SL_x_23_ok2:
  v_mfma_f32_16x16x32_bf16 v[44:47], v[72:75], v[72:75], v[44:47]
  v_max3_u32 v31, v76, v77, v78
  v_max_u32 v31, v31, v79
  v_cmp_eq_u32 vcc, -1, v31
  v_mfma_f32_16x16x32_bf16 v[36:39], v[124:127], v[72:75], v[36:39]
  v_mfma_f32_16x16x32_bf16 v[40:43], v[140:143], v[72:75], v[40:43]
  s_cbranch_vccz SL_x_3_ok3
  s_branch SL_x_3_x3
SL_x_23_ok3:
  v_mfma_f32_16x16x32_bf16 v[44:47], v[76:79], v[76:79], v[44:47]
  v_max3_u32 v31, v72, v73, v74
  v_max_u32 v31, v31, v75
  v_cmp_eq_u32 vcc, -1, v31
  v_mfma_f32_16x16x32_bf16 v[36:39], v[128:131], v[76:79], v[36:39]
  v_mfma_f32_16x16x32_bf16 v[40:43], v[144:147], v[76:79], v[40:43]
  s_cbranch_vccz SL_x_2_ok2
  s_branch SL_x_2_x2
SL_x_012_c0:
  v_max3_u32 v31, v64, v65, v66
  v_max_u32 v31, v31, v67
  v_cmp_eq_u32 vcc, -1, v31
  s_cbranch_vccz SL_x_012_ok0
SL_x_012_x0:
  s_mov_b64 exec, vcc
  buffer_load_dwordx4 v[64:67], v9, s[4:7], s41 offen offset:0 sc1
  s_mov_b64 exec, -1
SL_x_012_c1:
  v_max3_u32 v31, v68, v69, v70
  v_max_u32 v31, v31, v71
  v_cmp_eq_u32 vcc, -1, v31
  s_cbranch_vccz SL_x_012_ok1
SL_x_012_x1:
  s_mov_b64 exec, vcc
  buffer_load_dwordx4 v[68:71], v9, s[4:7], s41 offen offset:1024 sc1
  s_mov_b64 exec, -1
SL_x_012_c2:
  v_max3_u32 v31, v72, v73, v74
  v_max_u32 v31, v31, v75
  v_cmp_eq_u32 vcc, -1, v31
  s_cbranch_vccz SL_x_012_ok2
SL_x_012_x2:
  s_mov_b64 exec, vcc
  buffer_load_dwordx4 v[72:75], v9, s[4:7], s41 offen offset:2048 sc1
  s_mov_b64 exec, -1
  s_add_u32 s46, s46, 1
  s_cmp_ge_u32 s46, 131072
  s_cbranch_scc1 SL_rec_abort
  s_waitcnt vmcnt(4)
  s_branch SL_x_012_c0
SL_x_012_ok0:
  v_mfma_f32_16x16x32_bf16 v[44:47], v[64:67], v[64:67], v[44:47]
  v_max3_u32 v31, v68, v69, v70
  v_max_u32 v31, v31, v71
  v_cmp_eq_u32 vcc, -1, v31
  v_mfma_f32_16x16x32_bf16 v[36:39], v[116:119], v[64:67], v[36:39]
  v_mfma_f32_16x16x32_bf16 v[40:43], v[132:135], v[64:67], v[40:43]
  s_cbranch_vccz SL_x_12_ok1
  s_branch SL_x_12_x1
SL_x_012_ok1:
  v_mfma_f32_16x16x32_bf16 v[44:47], v[68:71], v[68:71], v[44:47]
  v_max3_u32 v31, v72, v73, v74
  v_max_u32 v31, v31, v75
  v_cmp_eq_u32 vcc, -1, v31
  v_mfma_f32_16x16x32_bf16 v[36:39], v[120:123], v[68:71], v[36:39]
  v_mfma_f32_16x16x32_bf16 v[40:43], v[136:139], v[68:71], v[40:43]
  s_cbranch_vccz SL_x_02_ok2
  s_branch SL_x_02_x2
SL_x_012_ok2:
  v_mfma_f32_16x16x32_bf16 v[44:47], v[72:75], v[72:75], v[44:47]
  v_max3_u32 v31, v64, v65, v66
  v_max_u32 v31, v31, v67
  v_cmp_eq_u32 vcc, -1, v31
  v_mfma_f32_16x16x32_bf16 v[36:39], v[124:127], v[72:75], v[36:39]
  v_mfma_f32_16x16x32_bf16 v[40:43], v[140:143], v[72:75], v[40:43]
  s_cbranch_vccz SL_x_01_ok0
  s_branch SL_x_01_x0
SL_x_013_c0:
  v_max3_u32 v31, v64, v65, v66
  v_max_u32 v31, v31, v67
  v_cmp_eq_u32 vcc, -1, v31
  s_cbranch_vccz SL_x_013_ok0
SL_x_013_x0:
  s_mov_b64 exec, vcc
  buffer_load_dwordx4 v[64:67], v9, s[4:7], s41 offen offset:0 sc1
  s_mov_b64 exec, -1
SL_x_013_c1:
  v_max3_u32 v31, v68, v69, v70
  v_max_u32 v31, v31, v71
  v_cmp_eq_u32 vcc, -1, v31
  s_cbranch_vccz SL_x_013_ok1
SL_x_013_x1:
  s_mov_b64 exec, vcc
  buffer_load_dwordx4 v[68:71], v9, s[4:7], s41 offen offset:1024 sc1
  s_mov_b64 exec, -1
SL_x_013_c3:
  v_max3_u32 v31, v76, v77, v78
  v_max_u32 v31, v31, v79
  v_cmp_eq_u32 vcc, -1, v31
  s_cbranch_vccz SL_x_013_ok3
SL_x_013_x3:
  s_mov_b64 exec, vcc
  buffer_load_dwordx4 v[76:79], v9, s[4:7], s41 offen offset:3072 sc1
  s_mov_b64 exec, -1
  s_add_u32 s46, s46, 1
  s_cmp_ge_u32 s46, 131072
  s_cbranch_scc1 SL_rec_abort
  s_waitcnt vmcnt(4)
  s_branch SL_x_013_c0
SL_x_013_ok0:
  v_mfma_f32_16x16x32_bf16 v[44:47], v[64:67], v[64:67], v[44:47]
  v_max3_u32 v31, v68, v69, v70
  v_max_u32 v31, v31, v71
  v_cmp_eq_u32 vcc, -1, v31
  v_mfma_f32_16x16x32_bf16 v[36:39], v[116:119], v[64:67], v[36:39]
  v_mfma_f32_16x16x32_bf16 v[40:43], v[132:135], v[64:67], v[40:43]
  s_cbranch_vccz SL_x_13_ok1
  s_branch SL_x_13_x1
SL_x_013_ok1:
  v_mfma_f32_16x16x32_bf16 v[44:47], v[68:71], v[68:71], v[44:47]
  v_max3_u32 v31, v76, v77, v78
  v_max_u32 v31, v31, v79
  v_cmp_eq_u32 vcc, -1, v31
  v_mfma_f32_16x16x32_bf16 v[36:39], v[120:123], v[68:71], v[36:39]
  v_mfma_f32_16x16x32_bf16 v[40:43], v[136:139], v[68:71], v[40:43]
  s_cbranch_vccz SL_x_03_ok3
  s_branch SL_x_03_x3
SL_x_013_ok3:
  v_mfma_f32_16x16x32_bf16 v[44:47], v[76:79], v[76:79], v[44:47]
  v_max3_u32 v31, v64, v65, v66
  v_max_u32 v31, v31, v67
  v_cmp_eq_u32 vcc, -1, v31
  v_mfma_f32_16x16x32_bf16 v[36:39], v[128:131], v[76:79], v[36:39]
  v_mfma_f32_16x16x32_bf16 v[40:43], v[144:147], v[76:79], v[40:43]
  s_cbranch_vccz SL_x_01_ok0
  s_branch SL_x_01_x0
SL_x_023_c0:
  v_max3_u32 v31, v64, v65, v66
  v_max_u32 v31, v31, v67
  v_cmp_eq_u32 vcc, -1, v31
  s_cbranch_vccz SL_x_023_ok0
SL_x_023_x0:
  s_mov_b64 exec, vcc
  buffer_load_dwordx4 v[64:67], v9, s[4:7], s41 offen offset:0 sc1
  s_mov_b64 exec, -1
SL_x_023_c2:
  v_max3_u32 v31, v72, v73, v74
  v_max_u32 v31, v31, v75
  v_cmp_eq_u32 vcc, -1, v31
  s_cbranch_vccz SL_x_023_ok2
SL_x_023_x2:
  s_mov_b64 exec, vcc
  buffer_load_dwordx4 v[72:75], v9, s[4:7], s41 offen offset:2048 sc1
  s_mov_b64 exec, -1
SL_x_023_c3:
  v_max3_u32 v31, v76, v77, v78
  v_max_u32 v31, v31, v79
  v_cmp_eq_u32 vcc, -1, v31
  s_cbranch_vccz SL_x_023_ok3
SL_x_023_x3:
  s_mov_b64 exec, vcc
  buffer_load_dwordx4 v[76:79], v9, s[4:7], s41 offen offset:3072 sc1
  s_mov_b64 exec, -1
  s_add_u32 s46, s46, 1
  s_cmp_ge_u32 s46, 131072
  s_cbranch_scc1 SL_rec_abort
  s_waitcnt vmcnt(4)
  s_branch SL_x_023_c0
SL_x_023_ok0:
  v_mfma_f32_16x16x32_bf16 v[44:47], v[64:67], v[64:67], v[44:47]
  v_max3_u32 v31, v72, v73, v74
  v_max_u32 v31, v31, v75
  v_cmp_eq_u32 vcc, -1, v31
  v_mfma_f32_16x16x32_bf16 v[36:39], v[116:119], v[64:67], v[36:39]
  v_mfma_f32_16x16x32_bf16 v[40:43], v[132:135], v[64:67], v[40:43]
  s_cbranch_vccz SL_x_23_ok2
  s_branch SL_x_23_x2
SL_x_023_ok2:
  v_mfma_f32_16x16x32_bf16 v[44:47], v[72:75], v[72:75], v[44:47]
  v_max3_u32 v31, v76, v77, v78
  v_max_u32 v31, v31, v79
  v_cmp_eq_u32 vcc, -1, v31
  v_mfma_f32_16x16x32_bf16 v[36:39], v[124:127], v[72:75], v[36:39]
  v_mfma_f32_16x16x32_bf16 v[40:43], v[140:143], v[72:75], v[40:43]
  s_cbranch_vccz SL_x_03_ok3
  s_branch SL_x_03_x3
SL_x_023_ok3:
  v_mfma_f32_16x16x32_bf16 v[44:47], v[76:79], v[76:79], v[44:47]
  v_max3_u32 v31, v64, v65, v66
  v_max_u32 v31, v31, v67
  v_cmp_eq_u32 vcc, -1, v31
  v_mfma_f32_16x16x32_bf16 v[36:39], v[128:131], v[76:79], v[36:39]
  v_mfma_f32_16x16x32_bf16 v[40:43], v[144:147], v[76:79], v[40:43]
  s_cbranch_vccz SL_x_02_ok0
  s_branch SL_x_02_x0
SL_x_123_c1:
  v_max3_u32 v31, v68, v69, v70
  v_max_u32 v31, v31, v71
  v_cmp_eq_u32 vcc, -1, v31
  s_cbranch_vccz SL_x_123_ok1
SL_x_123_x1:
  s_mov_b64 exec, vcc
  buffer_load_dwordx4 v[68:71], v9, s[4:7], s41 offen offset:1024 sc1
  s_mov_b64 exec, -1
SL_x_123_c2:
  v_max3_u32 v31, v72, v73, v74
  v_max_u32 v31, v31, v75
  v_cmp_eq_u32 vcc, -1, v31
  s_cbranch_vccz SL_x_123_ok2
SL_x_123_x2:
  s_mov_b64 exec, vcc
  buffer_load_dwordx4 v[72:75], v9, s[4:7], s41 offen offset:2048 sc1
  s_mov_b64 exec, -1
SL_x_123_c3:
  v_max3_u32 v31, v76, v77, v78
  v_max_u32 v31, v31, v79
  v_cmp_eq_u32 vcc, -1, v31
  s_cbranch_vccz SL_x_123_ok3
SL_x_123_x3:
  s_mov_b64 exec, vcc
  buffer_load_dwordx4 v[76:79], v9, s[4:7], s41 offen offset:3072 sc1
  s_mov_b64 exec, -1
  s_add_u32 s46, s46, 1
  s_cmp_ge_u32 s46, 131072
  s_cbranch_scc1 SL_rec_abort
  s_waitcnt vmcnt(4)
  s_branch SL_x_123_c1
SL_x_123_ok1:
  v_mfma_f32_16x16x32_bf16 v[44:47], v[68:71], v[68:71], v[44:47]
  v_max3_u32 v31, v72, v73, v74
  v_max_u32 v31, v31, v75
  v_cmp_eq_u32 vcc, -1, v31
  v_mfma_f32_16x16x32_bf16 v[36:39], v[120:123], v[68:71], v[36:39]
  v_mfma_f32_16x16x32_bf16 v[40:43], v[136:139], v[68:71], v[40:43]
  s_cbranch_vccz SL_x_23_ok2
  s_branch SL_x_23_x2
SL_x_123_ok2:
  v_mfma_f32_16x16x32_bf16 v[44:47], v[72:75], v[72:75], v[44:47]
  v_max3_u32 v31, v76, v77, v78
  v_max_u32 v31, v31, v79
  v_cmp_eq_u32 vcc, -1, v31
  v_mfma_f32_16x16x32_bf16 v[36:39], v[124:127], v[72:75], v[36:39]
  v_mfma_f32_16x16x32_bf16 v[40:43], v[140:143], v[72:75], v[40:43]
  s_cbranch_vccz SL_x_13_ok3
  s_branch SL_x_13_x3
SL_x_123_ok3:
  v_mfma_f32_16x16x32_bf16 v[44:47], v[76:79], v[76:79], v[44:47]
  v_max3_u32 v31, v68, v69, v70
  v_max_u32 v31, v31, v71
  v_cmp_eq_u32 vcc, -1, v31
  v_mfma_f32_16x16x32_bf16 v[36:39], v[128:131], v[76:79], v[36:39]
  v_mfma_f32_16x16x32_bf16 v[40:43], v[144:147], v[76:79], v[40:43]
  s_cbranch_vccz SL_x_12_ok1
  s_branch SL_x_12_x1
SL_x_0123_c0:
  v_max3_u32 v31, v64, v65, v66
  v_max_u32 v31, v31, v67
  v_cmp_eq_u32 vcc, -1, v31
  s_cbranch_vccz SL_x_0123_ok0
SL_x_0123_x0:
  s_mov_b64 exec, vcc
  buffer_load_dwordx4 v[64:67], v9, s[4:7], s41 offen offset:0 sc1
  s_mov_b64 exec, -1
SL_x_0123_c1:
  v_max3_u32 v31, v68, v69, v70
  v_max_u32 v31, v31, v71
  v_cmp_eq_u32 vcc, -1, v31
  s_cbranch_vccz SL_x_0123_ok1
SL_x_0123_x1:
  s_mov_b64 exec, vcc
  buffer_load_dwordx4 v[68:71], v9, s[4:7], s41 offen offset:1024 sc1
  s_mov_b64 exec, -1
SL_x_0123_c2:
  v_max3_u32 v31, v72, v73, v74
  v_max_u32 v31, v31, v75
  v_cmp_eq_u32 vcc, -1, v31
  s_cbranch_vccz SL_x_0123_ok2
SL_x_0123_x2:
  s_mov_b64 exec, vcc
  buffer_load_dwordx4 v[72:75], v9, s[4:7], s41 offen offset:2048 sc1
  s_mov_b64 exec, -1
SL_x_0123_c3:
  v_max3_u32 v31, v76, v77, v78
  v_max_u32 v31, v31, v79
  v_cmp_eq_u32 vcc, -1, v31
  s_cbranch_vccz SL_x_0123_ok3
SL_x_0123_x3:
  s_mov_b64 exec, vcc
  buffer_load_dwordx4 v[76:79], v9, s[4:7], s41 offen offset:3072 sc1
  s_mov_b64 exec, -1
  s_add_u32 s46, s46, 1
  s_cmp_ge_u32 s46, 131072
  s_cbranch_scc1 SL_rec_abort
  s_waitcnt vmcnt(4)
  s_branch SL_x_0123_c0
SL_x_0123_ok0:
  v_mfma_f32_16x16x32_bf16 v[44:47], v[64:67], v[64:67], v[44:47]
  v_max3_u32 v31, v68, v69, v70
  v_max_u32 v31, v31, v71
  v_cmp_eq_u32 vcc, -1, v31
  v_mfma_f32_16x16x32_bf16 v[36:39], v[116:119], v[64:67], v[36:39]
  v_mfma_f32_16x16x32_bf16 v[40:43], v[132:135], v[64:67], v[40:43]
  s_cbranch_vccz SL_x_123_ok1
  s_branch SL_x_123_x1
SL_x_0123_ok1:
  v_mfma_f32_16x16x32_bf16 v[44:47], v[68:71], v[68:71], v[44:47]
  v_max3_u32 v31, v72, v73, v74
  v_max_u32 v31, v31, v75
  v_cmp_eq_u32 vcc, -1, v31
  v_mfma_f32_16x16x32_bf16 v[36:39], v[120:123], v[68:71], v[36:39]
  v_mfma_f32_16x16x32_bf16 v[40:43], v[136:139], v[68:71], v[40:43]
  s_cbranch_vccz SL_x_023_ok2
  s_branch SL_x_023_x2
SL_x_0123_ok2:
  v_mfma_f32_16x16x32_bf16 v[44:47], v[72:75], v[72:75], v[44:47]
  v_max3_u32 v31, v76, v77, v78
  v_max_u32 v31, v31, v79
  v_cmp_eq_u32 vcc, -1, v31
  v_mfma_f32_16x16x32_bf16 v[36:39], v[124:127], v[72:75], v[36:39]
  v_mfma_f32_16x16x32_bf16 v[40:43], v[140:143], v[72:75], v[40:43]
  s_cbranch_vccz SL_x_013_ok3
  s_branch SL_x_013_x3
SL_x_0123_ok3:
  v_mfma_f32_16x16x32_bf16 v[44:47], v[76:79], v[76:79], v[44:47]
  v_max3_u32 v31, v64, v65, v66
  v_max_u32 v31, v31, v67
  v_cmp_eq_u32 vcc, -1, v31
  v_mfma_f32_16x16x32_bf16 v[36:39], v[128:131], v[76:79], v[36:39]
  v_mfma_f32_16x16x32_bf16 v[40:43], v[144:147], v[76:79], v[40:43]
  s_cbranch_vccz SL_x_012_ok0
  s_branch SL_x_012_x0
SL_v_f:
  buffer_load_dwordx4 v[88:91], v10, s[4:7], s41 offen offset:0 sc1
  buffer_load_dwordx4 v[92:95], v10, s[4:7], s41 offen offset:1024 sc1
  s_add_u32 s46, s46, 1
  s_cmp_ge_u32 s46, 131072
  s_cbranch_scc1 SL_rec_abort
  s_waitcnt vmcnt(0)
  v_max3_u32 v31, v88, v89, v90
  v_max3_u32 v31, v31, v91, v92
  v_max3_u32 v31, v31, v93, v94
  v_max_u32 v31, v31, v95
  v_cmp_eq_u32 vcc, -1, v31
  s_cbranch_vccnz SL_v_f
  s_branch SL_v_ok
SL_rec_abort:
  s_waitcnt vmcnt(0)
  s_endpgm
L_join:
  s_load_dwordx16 s[64:79], s[0:1], 0
  v_mbcnt_lo_u32_b32 v0, -1, 0
  v_mbcnt_hi_u32_b32 v0, -1, v0
  s_lshl_b32 s90, s32, 6
  v_add_u32 v0, s90, v0
  s_lshl_b32 s40, s33, 5
  s_add_u32 s40, s40, 128
  s_mov_b32 s39, 1
  s_barrier
  s_branch L_worker1
L_worker:
  s_mov_b32 s39, 0
L_worker1:
  s_load_dwordx4 s[80:83], s[0:1], 64
  s_load_dwordx2 s[84:85], s[0:1], 80
  s_sub_u32 s33, s40, 128
  s_lshr_b32 s33, s33, 5
  s_and_b32 s34, s40, 31
  s_getpc_b64 s[86:87]
L_pc:
  s_add_u32 s86, s86, L_table-L_pc
  s_addc_u32 s87, s87, 0
  s_waitcnt lgkmcnt(0)
  s_mov_b32 s16, s84
  s_and_b32 s17, s85, 0xffff
  s_mov_b32 s18, 0x800000
  s_mov_b32 s19, 0x20000
  s_mov_b32 s8, s64
  s_and_b32 s9, s65, 0xffff
  s_mov_b32 s10, 0x400000
  s_mov_b32 s11, 0x20000
  s_mov_b32 s12, s70
  s_and_b32 s13, s71, 0xffff
  s_mov_b32 s14, 0x800000
  s_mov_b32 s15, 0x20000
  v_mov_b32 v1, 0
  v_mov_b32 v2, 0
  v_mov_b32 v3, 0
  v_mov_b32 v4, 0
  v_mov_b32 v5, 0
  v_mov_b32 v6, 0
  v_mov_b32 v7, 0
  v_mov_b32 v8, 0
  v_mov_b32 v9, 0
  v_mov_b32 v10, 0
  v_mov_b32 v11, 0
  v_mov_b32 v12, 0
  v_mov_b32 v13, 0
  v_mov_b32 v14, 0
  v_mov_b32 v15, 0
  v_mov_b32 v16, 0
  v_mov_b32 v17, 0
  s_mov_b32 s59, 0
  s_cmp_eq_u32 s39, 0
  s_cbranch_scc1 L_have
L_next:
  s_cmp_lg_u32 s32, 0
  s_cbranch_scc1 L_rq_1
  s_cmp_eq_u32 s39, 0
  s_cbranch_scc1 L_rq_1
  s_lshl_b32 s99, s33, 7
  s_add_u32 s99, s99, 0x3d00200
  v_mov_b32 v244, 1
  v_mov_b32 v245, 0
  s_mov_b64 exec, 1
  buffer_atomic_add v244, v245, s[4:7], s99 offen sc0 sc1
  s_mov_b64 exec, -1
L_rq_1:
  s_waitcnt vmcnt(0)
L_got:
  s_cmp_lg_u32 s32, 0
  s_cbranch_scc1 L_nx1
  v_mov_b32 v245, 131072
  s_mov_b64 exec, 1
  ds_write_b32 v245, v244
  s_mov_b64 exec, -1
  s_waitcnt lgkmcnt(0)
L_nx1:
  s_barrier
  v_mov_b32 v245, 131072
  ds_read_b32 v246, v245
  s_waitcnt lgkmcnt(0)
  v_readfirstlane_b32 s34, v246
  s_add_u32 s34, s34, 32
L_have:
  s_mov_b32 s98, 1
  s_min_u32 s90, s34, 366
  s_lshl_b32 s90, s90, 2
  s_load_dword s91, s[86:87], s90
  s_waitcnt lgkmcnt(0)
  s_and_b32 s35, s91, 255
  s_lshr_b32 s36, s91, 8
  s_and_b32 s36, s36, 255
  s_lshr_b32 s37, s91, 16
  s_cmp_eq_u32 s35, 0
  s_cbranch_scc1 L_aqkv
  s_cmp_eq_u32 s35, 1
  s_cbranch_scc1 L_aqkv
  s_cmp_eq_u32 s35, 2
  s_cbranch_scc1 L_aqkv
  s_cmp_eq_u32 s35, 3
  s_cbranch_scc1 L_bqkv
  s_cmp_eq_u32 s35, 9
  s_cbranch_scc1 L_small
  s_cmp_eq_u32 s35, 10
  s_cbranch_scc1 L_small
  s_mov_b32 s58, 0
L_epi:
  s_cmp_eq_u32 s59, 0
  s_cbranch_scc1 L_epid
  s_cmp_lg_u32 s59, 1
  s_cbranch_scc1 L_e0
  s_lshr_b32 s90, s27, 1
  s_and_b32 s91, s27, 1
  v_mov_b32 v178, 0x0
  v_bfe_u32 v177, v1, 0, 6
  v_lshl_add_u32 v178, v177, 4, v178
  v_add_u32 v176, 4096, v178
  s_mul_i32 s92, s90, 4
  s_mul_i32 s92, s92, s61
  s_add_u32 s92, s92, s60
  s_mul_i32 s93, s91, 8192
  s_add_u32 s92, s92, s93
  v_accvgpr_read_b32 v184, a0
  v_accvgpr_read_b32 v185, a4
  v_accvgpr_read_b32 v186, a1
  v_accvgpr_read_b32 v187, a5
  v_accvgpr_read_b32 v188, a2
  v_accvgpr_read_b32 v189, a6
  v_accvgpr_read_b32 v190, a3
  v_accvgpr_read_b32 v191, a7
  v_cvt_pk_bf16_f32 v180, v184, v185
  v_cvt_pk_bf16_f32 v181, v186, v187
  v_cvt_pk_bf16_f32 v182, v188, v189
  v_cvt_pk_bf16_f32 v183, v190, v191
  buffer_store_dwordx4 v[180:183], v178, s[4:7], s92 offen offset:0 sc1
  v_accvgpr_read_b32 v196, a8
  v_accvgpr_read_b32 v197, a12
  v_accvgpr_read_b32 v198, a9
  v_accvgpr_read_b32 v199, a13
  v_accvgpr_read_b32 v200, a10
  v_accvgpr_read_b32 v201, a14
  v_accvgpr_read_b32 v202, a11
  v_accvgpr_read_b32 v203, a15
  v_cvt_pk_bf16_f32 v192, v196, v197
  v_cvt_pk_bf16_f32 v193, v198, v199
  v_cvt_pk_bf16_f32 v194, v200, v201
  v_cvt_pk_bf16_f32 v195, v202, v203
  buffer_store_dwordx4 v[192:195], v178, s[4:7], s92 offen offset:1024 sc1
  v_accvgpr_read_b32 v208, a16
  v_accvgpr_read_b32 v209, a20
  v_accvgpr_read_b32 v210, a17
  v_accvgpr_read_b32 v211, a21
  v_accvgpr_read_b32 v212, a18
  v_accvgpr_read_b32 v213, a22
  v_accvgpr_read_b32 v214, a19
  v_accvgpr_read_b32 v215, a23
  v_cvt_pk_bf16_f32 v204, v208, v209
  v_cvt_pk_bf16_f32 v205, v210, v211
  v_cvt_pk_bf16_f32 v206, v212, v213
  v_cvt_pk_bf16_f32 v207, v214, v215
  buffer_store_dwordx4 v[204:207], v178, s[4:7], s92 offen offset:2048 sc1
  v_accvgpr_read_b32 v220, a24
  v_accvgpr_read_b32 v221, a28
  v_accvgpr_read_b32 v222, a25
  v_accvgpr_read_b32 v223, a29
  v_accvgpr_read_b32 v224, a26
  v_accvgpr_read_b32 v225, a30
  v_accvgpr_read_b32 v226, a27
  v_accvgpr_read_b32 v227, a31
  v_cvt_pk_bf16_f32 v216, v220, v221
  v_cvt_pk_bf16_f32 v217, v222, v223
  v_cvt_pk_bf16_f32 v218, v224, v225
  v_cvt_pk_bf16_f32 v219, v226, v227
  buffer_store_dwordx4 v[216:219], v178, s[4:7], s92 offen offset:3072 sc1
  v_accvgpr_read_b32 v184, a32
  v_accvgpr_read_b32 v185, a36
  v_accvgpr_read_b32 v186, a33
  v_accvgpr_read_b32 v187, a37
  v_accvgpr_read_b32 v188, a34
  v_accvgpr_read_b32 v189, a38
  v_accvgpr_read_b32 v190, a35
  v_accvgpr_read_b32 v191, a39
  v_cvt_pk_bf16_f32 v180, v184, v185
  v_cvt_pk_bf16_f32 v181, v186, v187
  v_cvt_pk_bf16_f32 v182, v188, v189
  v_cvt_pk_bf16_f32 v183, v190, v191
  buffer_store_dwordx4 v[180:183], v176, s[4:7], s92 offen offset:0 sc1
  v_accvgpr_read_b32 v196, a40
  v_accvgpr_read_b32 v197, a44
  v_accvgpr_read_b32 v198, a41
  v_accvgpr_read_b32 v199, a45
  v_accvgpr_read_b32 v200, a42
  v_accvgpr_read_b32 v201, a46
  v_accvgpr_read_b32 v202, a43
  v_accvgpr_read_b32 v203, a47
  v_cvt_pk_bf16_f32 v192, v196, v197
  v_cvt_pk_bf16_f32 v193, v198, v199
  v_cvt_pk_bf16_f32 v194, v200, v201
  v_cvt_pk_bf16_f32 v195, v202, v203
  buffer_store_dwordx4 v[192:195], v176, s[4:7], s92 offen offset:1024 sc1
  v_accvgpr_read_b32 v208, a48
  v_accvgpr_read_b32 v209, a52
  v_accvgpr_read_b32 v210, a49
  v_accvgpr_read_b32 v211, a53
  v_accvgpr_read_b32 v212, a50
  v_accvgpr_read_b32 v213, a54
  v_accvgpr_read_b32 v214, a51
  v_accvgpr_read_b32 v215, a55
  v_cvt_pk_bf16_f32 v204, v208, v209
  v_cvt_pk_bf16_f32 v205, v210, v211
  v_cvt_pk_bf16_f32 v206, v212, v213
  v_cvt_pk_bf16_f32 v207, v214, v215
  buffer_store_dwordx4 v[204:207], v176, s[4:7], s92 offen offset:2048 sc1
  v_accvgpr_read_b32 v220, a56
  v_accvgpr_read_b32 v221, a60
  v_accvgpr_read_b32 v222, a57
  v_accvgpr_read_b32 v223, a61
  v_accvgpr_read_b32 v224, a58
  v_accvgpr_read_b32 v225, a62
  v_accvgpr_read_b32 v226, a59
  v_accvgpr_read_b32 v227, a63
  v_cvt_pk_bf16_f32 v216, v220, v221
  v_cvt_pk_bf16_f32 v217, v222, v223
  v_cvt_pk_bf16_f32 v218, v224, v225
  v_cvt_pk_bf16_f32 v219, v226, v227
  buffer_store_dwordx4 v[216:219], v176, s[4:7], s92 offen offset:3072 sc1
  s_add_u32 s92, s92, s61
  v_accvgpr_read_b32 v184, a64
  v_accvgpr_read_b32 v185, a68
  v_accvgpr_read_b32 v186, a65
  v_accvgpr_read_b32 v187, a69
  v_accvgpr_read_b32 v188, a66
  v_accvgpr_read_b32 v189, a70
  v_accvgpr_read_b32 v190, a67
  v_accvgpr_read_b32 v191, a71
  v_cvt_pk_bf16_f32 v180, v184, v185
  v_cvt_pk_bf16_f32 v181, v186, v187
  v_cvt_pk_bf16_f32 v182, v188, v189
  v_cvt_pk_bf16_f32 v183, v190, v191
  buffer_store_dwordx4 v[180:183], v178, s[4:7], s92 offen offset:0 sc1
  v_accvgpr_read_b32 v196, a72
  v_accvgpr_read_b32 v197, a76
  v_accvgpr_read_b32 v198, a73
  v_accvgpr_read_b32 v199, a77
  v_accvgpr_read_b32 v200, a74
  v_accvgpr_read_b32 v201, a78
  v_accvgpr_read_b32 v202, a75
  v_accvgpr_read_b32 v203, a79
  v_cvt_pk_bf16_f32 v192, v196, v197
  v_cvt_pk_bf16_f32 v193, v198, v199
  v_cvt_pk_bf16_f32 v194, v200, v201
  v_cvt_pk_bf16_f32 v195, v202, v203
  buffer_store_dwordx4 v[192:195], v178, s[4:7], s92 offen offset:1024 sc1
  v_accvgpr_read_b32 v208, a80
  v_accvgpr_read_b32 v209, a84
  v_accvgpr_read_b32 v210, a81
  v_accvgpr_read_b32 v211, a85
  v_accvgpr_read_b32 v212, a82
  v_accvgpr_read_b32 v213, a86
  v_accvgpr_read_b32 v214, a83
  v_accvgpr_read_b32 v215, a87
  v_cvt_pk_bf16_f32 v204, v208, v209
  v_cvt_pk_bf16_f32 v205, v210, v211
  v_cvt_pk_bf16_f32 v206, v212, v213
  v_cvt_pk_bf16_f32 v207, v214, v215
  buffer_store_dwordx4 v[204:207], v178, s[4:7], s92 offen offset:2048 sc1
  v_accvgpr_read_b32 v220, a88
  v_accvgpr_read_b32 v221, a92
  v_accvgpr_read_b32 v222, a89
  v_accvgpr_read_b32 v223, a93
  v_accvgpr_read_b32 v224, a90
  v_accvgpr_read_b32 v225, a94
  v_accvgpr_read_b32 v226, a91
  v_accvgpr_read_b32 v227, a95
  v_cvt_pk_bf16_f32 v216, v220, v221
  v_cvt_pk_bf16_f32 v217, v222, v223
  v_cvt_pk_bf16_f32 v218, v224, v225
  v_cvt_pk_bf16_f32 v219, v226, v227
  buffer_store_dwordx4 v[216:219], v178, s[4:7], s92 offen offset:3072 sc1
  v_accvgpr_read_b32 v184, a96
  v_accvgpr_read_b32 v185, a100
  v_accvgpr_read_b32 v186, a97
  v_accvgpr_read_b32 v187, a101
  v_accvgpr_read_b32 v188, a98
  v_accvgpr_read_b32 v189, a102
  v_accvgpr_read_b32 v190, a99
  v_accvgpr_read_b32 v191, a103
  v_cvt_pk_bf16_f32 v180, v184, v185
  v_cvt_pk_bf16_f32 v181, v186, v187
  v_cvt_pk_bf16_f32 v182, v188, v189
  v_cvt_pk_bf16_f32 v183, v190, v191
  buffer_store_dwordx4 v[180:183], v176, s[4:7], s92 offen offset:0 sc1
  v_accvgpr_read_b32 v196, a104
  v_accvgpr_read_b32 v197, a108
  v_accvgpr_read_b32 v198, a105
  v_accvgpr_read_b32 v199, a109
  v_accvgpr_read_b32 v200, a106
  v_accvgpr_read_b32 v201, a110
  v_accvgpr_read_b32 v202, a107
  v_accvgpr_read_b32 v203, a111
  v_cvt_pk_bf16_f32 v192, v196, v197
  v_cvt_pk_bf16_f32 v193, v198, v199
  v_cvt_pk_bf16_f32 v194, v200, v201
  v_cvt_pk_bf16_f32 v195, v202, v203
  buffer_store_dwordx4 v[192:195], v176, s[4:7], s92 offen offset:1024 sc1
  v_accvgpr_read_b32 v208, a112
  v_accvgpr_read_b32 v209, a116
  v_accvgpr_read_b32 v210, a113
  v_accvgpr_read_b32 v211, a117
  v_accvgpr_read_b32 v212, a114
  v_accvgpr_read_b32 v213, a118
  v_accvgpr_read_b32 v214, a115
  v_accvgpr_read_b32 v215, a119
  v_cvt_pk_bf16_f32 v204, v208, v209
  v_cvt_pk_bf16_f32 v205, v210, v211
  v_cvt_pk_bf16_f32 v206, v212, v213
  v_cvt_pk_bf16_f32 v207, v214, v215
  buffer_store_dwordx4 v[204:207], v176, s[4:7], s92 offen offset:2048 sc1
  v_accvgpr_read_b32 v220, a120
  v_accvgpr_read_b32 v221, a124
  v_accvgpr_read_b32 v222, a121
  v_accvgpr_read_b32 v223, a125
  v_accvgpr_read_b32 v224, a122
  v_accvgpr_read_b32 v225, a126
  v_accvgpr_read_b32 v226, a123
  v_accvgpr_read_b32 v227, a127
  v_cvt_pk_bf16_f32 v216, v220, v221
  v_cvt_pk_bf16_f32 v217, v222, v223
  v_cvt_pk_bf16_f32 v218, v224, v225
  v_cvt_pk_bf16_f32 v219, v226, v227
  buffer_store_dwordx4 v[216:219], v176, s[4:7], s92 offen offset:3072 sc1
  s_add_u32 s92, s92, s61
  v_accvgpr_read_b32 v184, a128
  v_accvgpr_read_b32 v185, a132
  v_accvgpr_read_b32 v186, a129
  v_accvgpr_read_b32 v187, a133
  v_accvgpr_read_b32 v188, a130
  v_accvgpr_read_b32 v189, a134
  v_accvgpr_read_b32 v190, a131
  v_accvgpr_read_b32 v191, a135
  v_cvt_pk_bf16_f32 v180, v184, v185
  v_cvt_pk_bf16_f32 v181, v186, v187
  v_cvt_pk_bf16_f32 v182, v188, v189
  v_cvt_pk_bf16_f32 v183, v190, v191
  buffer_store_dwordx4 v[180:183], v178, s[4:7], s92 offen offset:0 sc1
  v_accvgpr_read_b32 v196, a136
  v_accvgpr_read_b32 v197, a140
  v_accvgpr_read_b32 v198, a137
  v_accvgpr_read_b32 v199, a141
  v_accvgpr_read_b32 v200, a138
  v_accvgpr_read_b32 v201, a142
  v_accvgpr_read_b32 v202, a139
  v_accvgpr_read_b32 v203, a143
  v_cvt_pk_bf16_f32 v192, v196, v197
  v_cvt_pk_bf16_f32 v193, v198, v199
  v_cvt_pk_bf16_f32 v194, v200, v201
  v_cvt_pk_bf16_f32 v195, v202, v203
  buffer_store_dwordx4 v[192:195], v178, s[4:7], s92 offen offset:1024 sc1
  v_accvgpr_read_b32 v208, a144
  v_accvgpr_read_b32 v209, a148
  v_accvgpr_read_b32 v210, a145
  v_accvgpr_read_b32 v211, a149
  v_accvgpr_read_b32 v212, a146
  v_accvgpr_read_b32 v213, a150
  v_accvgpr_read_b32 v214, a147
  v_accvgpr_read_b32 v215, a151
  v_cvt_pk_bf16_f32 v204, v208, v209
  v_cvt_pk_bf16_f32 v205, v210, v211
  v_cvt_pk_bf16_f32 v206, v212, v213
  v_cvt_pk_bf16_f32 v207, v214, v215
  buffer_store_dwordx4 v[204:207], v178, s[4:7], s92 offen offset:2048 sc1
  v_accvgpr_read_b32 v220, a152
  v_accvgpr_read_b32 v221, a156
  v_accvgpr_read_b32 v222, a153
  v_accvgpr_read_b32 v223, a157
  v_accvgpr_read_b32 v224, a154
  v_accvgpr_read_b32 v225, a158
  v_accvgpr_read_b32 v226, a155
  v_accvgpr_read_b32 v227, a159
  v_cvt_pk_bf16_f32 v216, v220, v221
  v_cvt_pk_bf16_f32 v217, v222, v223
  v_cvt_pk_bf16_f32 v218, v224, v225
  v_cvt_pk_bf16_f32 v219, v226, v227
  buffer_store_dwordx4 v[216:219], v178, s[4:7], s92 offen offset:3072 sc1
  v_accvgpr_read_b32 v184, a160
  v_accvgpr_read_b32 v185, a164
  v_accvgpr_read_b32 v186, a161
  v_accvgpr_read_b32 v187, a165
  v_accvgpr_read_b32 v188, a162
  v_accvgpr_read_b32 v189, a166
  v_accvgpr_read_b32 v190, a163
  v_accvgpr_read_b32 v191, a167
  v_cvt_pk_bf16_f32 v180, v184, v185
  v_cvt_pk_bf16_f32 v181, v186, v187
  v_cvt_pk_bf16_f32 v182, v188, v189
  v_cvt_pk_bf16_f32 v183, v190, v191
  buffer_store_dwordx4 v[180:183], v176, s[4:7], s92 offen offset:0 sc1
  v_accvgpr_read_b32 v196, a168
  v_accvgpr_read_b32 v197, a172
  v_accvgpr_read_b32 v198, a169
  v_accvgpr_read_b32 v199, a173
  v_accvgpr_read_b32 v200, a170
  v_accvgpr_read_b32 v201, a174
  v_accvgpr_read_b32 v202, a171
  v_accvgpr_read_b32 v203, a175
  v_cvt_pk_bf16_f32 v192, v196, v197
  v_cvt_pk_bf16_f32 v193, v198, v199
  v_cvt_pk_bf16_f32 v194, v200, v201
  v_cvt_pk_bf16_f32 v195, v202, v203
  buffer_store_dwordx4 v[192:195], v176, s[4:7], s92 offen offset:1024 sc1
  v_accvgpr_read_b32 v208, a176
  v_accvgpr_read_b32 v209, a180
  v_accvgpr_read_b32 v210, a177
  v_accvgpr_read_b32 v211, a181
  v_accvgpr_read_b32 v212, a178
  v_accvgpr_read_b32 v213, a182
  v_accvgpr_read_b32 v214, a179
  v_accvgpr_read_b32 v215, a183
  v_cvt_pk_bf16_f32 v204, v208, v209
  v_cvt_pk_bf16_f32 v205, v210, v211
  v_cvt_pk_bf16_f32 v206, v212, v213
  v_cvt_pk_bf16_f32 v207, v214, v215
  buffer_store_dwordx4 v[204:207], v176, s[4:7], s92 offen offset:2048 sc1
  v_accvgpr_read_b32 v220, a184
  v_accvgpr_read_b32 v221, a188
  v_accvgpr_read_b32 v222, a185
  v_accvgpr_read_b32 v223, a189
  v_accvgpr_read_b32 v224, a186
  v_accvgpr_read_b32 v225, a190
  v_accvgpr_read_b32 v226, a187
  v_accvgpr_read_b32 v227, a191
  v_cvt_pk_bf16_f32 v216, v220, v221
  v_cvt_pk_bf16_f32 v217, v222, v223
  v_cvt_pk_bf16_f32 v218, v224, v225
  v_cvt_pk_bf16_f32 v219, v226, v227
  buffer_store_dwordx4 v[216:219], v176, s[4:7], s92 offen offset:3072 sc1
  s_add_u32 s92, s92, s61
  v_accvgpr_read_b32 v184, a192
  v_accvgpr_read_b32 v185, a196
  v_accvgpr_read_b32 v186, a193
  v_accvgpr_read_b32 v187, a197
  v_accvgpr_read_b32 v188, a194
  v_accvgpr_read_b32 v189, a198
  v_accvgpr_read_b32 v190, a195
  v_accvgpr_read_b32 v191, a199
  v_cvt_pk_bf16_f32 v180, v184, v185
  v_cvt_pk_bf16_f32 v181, v186, v187
  v_cvt_pk_bf16_f32 v182, v188, v189
  v_cvt_pk_bf16_f32 v183, v190, v191
  buffer_store_dwordx4 v[180:183], v178, s[4:7], s92 offen offset:0 sc1
  v_accvgpr_read_b32 v196, a200
  v_accvgpr_read_b32 v197, a204
  v_accvgpr_read_b32 v198, a201
  v_accvgpr_read_b32 v199, a205
  v_accvgpr_read_b32 v200, a202
  v_accvgpr_read_b32 v201, a206
  v_accvgpr_read_b32 v202, a203
  v_accvgpr_read_b32 v203, a207
  v_cvt_pk_bf16_f32 v192, v196, v197
  v_cvt_pk_bf16_f32 v193, v198, v199
  v_cvt_pk_bf16_f32 v194, v200, v201
  v_cvt_pk_bf16_f32 v195, v202, v203
  buffer_store_dwordx4 v[192:195], v178, s[4:7], s92 offen offset:1024 sc1
  v_accvgpr_read_b32 v208, a208
  v_accvgpr_read_b32 v209, a212
  v_accvgpr_read_b32 v210, a209
  v_accvgpr_read_b32 v211, a213
  v_accvgpr_read_b32 v212, a210
  v_accvgpr_read_b32 v213, a214
  v_accvgpr_read_b32 v214, a211
  v_accvgpr_read_b32 v215, a215
  v_cvt_pk_bf16_f32 v204, v208, v209
  v_cvt_pk_bf16_f32 v205, v210, v211
  v_cvt_pk_bf16_f32 v206, v212, v213
  v_cvt_pk_bf16_f32 v207, v214, v215
  buffer_store_dwordx4 v[204:207], v178, s[4:7], s92 offen offset:2048 sc1
  v_accvgpr_read_b32 v220, a216
  v_accvgpr_read_b32 v221, a220
  v_accvgpr_read_b32 v222, a217
  v_accvgpr_read_b32 v223, a221
  v_accvgpr_read_b32 v224, a218
  v_accvgpr_read_b32 v225, a222
  v_accvgpr_read_b32 v226, a219
  v_accvgpr_read_b32 v227, a223
  v_cvt_pk_bf16_f32 v216, v220, v221
  v_cvt_pk_bf16_f32 v217, v222, v223
  v_cvt_pk_bf16_f32 v218, v224, v225
  v_cvt_pk_bf16_f32 v219, v226, v227
  buffer_store_dwordx4 v[216:219], v178, s[4:7], s92 offen offset:3072 sc1
  v_accvgpr_read_b32 v184, a224
  v_accvgpr_read_b32 v185, a228
  v_accvgpr_read_b32 v186, a225
  v_accvgpr_read_b32 v187, a229
  v_accvgpr_read_b32 v188, a226
  v_accvgpr_read_b32 v189, a230
  v_accvgpr_read_b32 v190, a227
  v_accvgpr_read_b32 v191, a231
  v_cvt_pk_bf16_f32 v180, v184, v185
  v_cvt_pk_bf16_f32 v181, v186, v187
  v_cvt_pk_bf16_f32 v182, v188, v189
  v_cvt_pk_bf16_f32 v183, v190, v191
  buffer_store_dwordx4 v[180:183], v176, s[4:7], s92 offen offset:0 sc1
  v_accvgpr_read_b32 v196, a232
  v_accvgpr_read_b32 v197, a236
  v_accvgpr_read_b32 v198, a233
  v_accvgpr_read_b32 v199, a237
  v_accvgpr_read_b32 v200, a234
  v_accvgpr_read_b32 v201, a238
  v_accvgpr_read_b32 v202, a235
  v_accvgpr_read_b32 v203, a239
  v_cvt_pk_bf16_f32 v192, v196, v197
  v_cvt_pk_bf16_f32 v193, v198, v199
  v_cvt_pk_bf16_f32 v194, v200, v201
  v_cvt_pk_bf16_f32 v195, v202, v203
  buffer_store_dwordx4 v[192:195], v176, s[4:7], s92 offen offset:1024 sc1
  v_accvgpr_read_b32 v208, a240
  v_accvgpr_read_b32 v209, a244
  v_accvgpr_read_b32 v210, a241
  v_accvgpr_read_b32 v211, a245
  v_accvgpr_read_b32 v212, a242
  v_accvgpr_read_b32 v213, a246
  v_accvgpr_read_b32 v214, a243
  v_accvgpr_read_b32 v215, a247
  v_cvt_pk_bf16_f32 v204, v208, v209
  v_cvt_pk_bf16_f32 v205, v210, v211
  v_cvt_pk_bf16_f32 v206, v212, v213
  v_cvt_pk_bf16_f32 v207, v214, v215
  buffer_store_dwordx4 v[204:207], v176, s[4:7], s92 offen offset:2048 sc1
  v_accvgpr_read_b32 v220, a248
  v_accvgpr_read_b32 v221, a252
  v_accvgpr_read_b32 v222, a249
  v_accvgpr_read_b32 v223, a253
  v_accvgpr_read_b32 v224, a250
  v_accvgpr_read_b32 v225, a254
  v_accvgpr_read_b32 v226, a251
  v_accvgpr_read_b32 v227, a255
  v_cvt_pk_bf16_f32 v216, v220, v221
  v_cvt_pk_bf16_f32 v217, v222, v223
  v_cvt_pk_bf16_f32 v218, v224, v225
  v_cvt_pk_bf16_f32 v219, v226, v227
  buffer_store_dwordx4 v[216:219], v176, s[4:7], s92 offen offset:3072 sc1
  s_add_u32 s92, s92, s61
  s_branch L_esig
L_e0:
  s_cmp_lg_u32 s59, 2
  s_cbranch_scc1 L_e1
  s_lshr_b32 s90, s27, 1
  s_and_b32 s91, s27, 1
  v_mov_b32 v178, 0x0
  v_bfe_u32 v177, v1, 0, 6
  v_lshl_add_u32 v178, v177, 4, v178
  v_add_u32 v176, 4096, v178
  s_mul_i32 s92, s90, 4
  s_mul_i32 s92, s92, s61
  s_add_u32 s92, s92, s60
  s_mul_i32 s93, s91, 8192
  s_add_u32 s92, s92, s93
  v_accvgpr_read_b32 v184, a0
  v_accvgpr_read_b32 v185, a1
  v_accvgpr_read_b32 v186, a2
  v_accvgpr_read_b32 v187, a3
  v_accvgpr_read_b32 v188, a32
  v_accvgpr_read_b32 v189, a33
  v_accvgpr_read_b32 v190, a34
  v_accvgpr_read_b32 v191, a35
  v_cvt_pk_bf16_f32 v180, v184, v185
  v_cvt_pk_bf16_f32 v181, v186, v187
  v_cvt_pk_bf16_f32 v182, v188, v189
  v_cvt_pk_bf16_f32 v183, v190, v191
  buffer_store_dwordx4 v[180:183], v178, s[4:7], s92 offen offset:0 sc1
  v_accvgpr_read_b32 v196, a4
  v_accvgpr_read_b32 v197, a5
  v_accvgpr_read_b32 v198, a6
  v_accvgpr_read_b32 v199, a7
  v_accvgpr_read_b32 v200, a36
  v_accvgpr_read_b32 v201, a37
  v_accvgpr_read_b32 v202, a38
  v_accvgpr_read_b32 v203, a39
  v_cvt_pk_bf16_f32 v192, v196, v197
  v_cvt_pk_bf16_f32 v193, v198, v199
  v_cvt_pk_bf16_f32 v194, v200, v201
  v_cvt_pk_bf16_f32 v195, v202, v203
  buffer_store_dwordx4 v[192:195], v178, s[4:7], s92 offen offset:1024 sc1
  v_accvgpr_read_b32 v208, a8
  v_accvgpr_read_b32 v209, a9
  v_accvgpr_read_b32 v210, a10
  v_accvgpr_read_b32 v211, a11
  v_accvgpr_read_b32 v212, a40
  v_accvgpr_read_b32 v213, a41
  v_accvgpr_read_b32 v214, a42
  v_accvgpr_read_b32 v215, a43
  v_cvt_pk_bf16_f32 v204, v208, v209
  v_cvt_pk_bf16_f32 v205, v210, v211
  v_cvt_pk_bf16_f32 v206, v212, v213
  v_cvt_pk_bf16_f32 v207, v214, v215
  buffer_store_dwordx4 v[204:207], v178, s[4:7], s92 offen offset:2048 sc1
  v_accvgpr_read_b32 v220, a12
  v_accvgpr_read_b32 v221, a13
  v_accvgpr_read_b32 v222, a14
  v_accvgpr_read_b32 v223, a15
  v_accvgpr_read_b32 v224, a44
  v_accvgpr_read_b32 v225, a45
  v_accvgpr_read_b32 v226, a46
  v_accvgpr_read_b32 v227, a47
  v_cvt_pk_bf16_f32 v216, v220, v221
  v_cvt_pk_bf16_f32 v217, v222, v223
  v_cvt_pk_bf16_f32 v218, v224, v225
  v_cvt_pk_bf16_f32 v219, v226, v227
  buffer_store_dwordx4 v[216:219], v178, s[4:7], s92 offen offset:3072 sc1
  v_accvgpr_read_b32 v184, a16
  v_accvgpr_read_b32 v185, a17
  v_accvgpr_read_b32 v186, a18
  v_accvgpr_read_b32 v187, a19
  v_accvgpr_read_b32 v188, a48
  v_accvgpr_read_b32 v189, a49
  v_accvgpr_read_b32 v190, a50
  v_accvgpr_read_b32 v191, a51
  v_cvt_pk_bf16_f32 v180, v184, v185
  v_cvt_pk_bf16_f32 v181, v186, v187
  v_cvt_pk_bf16_f32 v182, v188, v189
  v_cvt_pk_bf16_f32 v183, v190, v191
  buffer_store_dwordx4 v[180:183], v176, s[4:7], s92 offen offset:0 sc1
  v_accvgpr_read_b32 v196, a20
  v_accvgpr_read_b32 v197, a21
  v_accvgpr_read_b32 v198, a22
  v_accvgpr_read_b32 v199, a23
  v_accvgpr_read_b32 v200, a52
  v_accvgpr_read_b32 v201, a53
  v_accvgpr_read_b32 v202, a54
  v_accvgpr_read_b32 v203, a55
  v_cvt_pk_bf16_f32 v192, v196, v197
  v_cvt_pk_bf16_f32 v193, v198, v199
  v_cvt_pk_bf16_f32 v194, v200, v201
  v_cvt_pk_bf16_f32 v195, v202, v203
  buffer_store_dwordx4 v[192:195], v176, s[4:7], s92 offen offset:1024 sc1
  v_accvgpr_read_b32 v208, a24
  v_accvgpr_read_b32 v209, a25
  v_accvgpr_read_b32 v210, a26
  v_accvgpr_read_b32 v211, a27
  v_accvgpr_read_b32 v212, a56
  v_accvgpr_read_b32 v213, a57
  v_accvgpr_read_b32 v214, a58
  v_accvgpr_read_b32 v215, a59
  v_cvt_pk_bf16_f32 v204, v208, v209
  v_cvt_pk_bf16_f32 v205, v210, v211
  v_cvt_pk_bf16_f32 v206, v212, v213
  v_cvt_pk_bf16_f32 v207, v214, v215
  buffer_store_dwordx4 v[204:207], v176, s[4:7], s92 offen offset:2048 sc1
  v_accvgpr_read_b32 v220, a28
  v_accvgpr_read_b32 v221, a29
  v_accvgpr_read_b32 v222, a30
  v_accvgpr_read_b32 v223, a31
  v_accvgpr_read_b32 v224, a60
  v_accvgpr_read_b32 v225, a61
  v_accvgpr_read_b32 v226, a62
  v_accvgpr_read_b32 v227, a63
  v_cvt_pk_bf16_f32 v216, v220, v221
  v_cvt_pk_bf16_f32 v217, v222, v223
  v_cvt_pk_bf16_f32 v218, v224, v225
  v_cvt_pk_bf16_f32 v219, v226, v227
  buffer_store_dwordx4 v[216:219], v176, s[4:7], s92 offen offset:3072 sc1
  s_add_u32 s92, s92, s61
  v_accvgpr_read_b32 v184, a64
  v_accvgpr_read_b32 v185, a65
  v_accvgpr_read_b32 v186, a66
  v_accvgpr_read_b32 v187, a67
  v_accvgpr_read_b32 v188, a96
  v_accvgpr_read_b32 v189, a97
  v_accvgpr_read_b32 v190, a98
  v_accvgpr_read_b32 v191, a99
  v_cvt_pk_bf16_f32 v180, v184, v185
  v_cvt_pk_bf16_f32 v181, v186, v187
  v_cvt_pk_bf16_f32 v182, v188, v189
  v_cvt_pk_bf16_f32 v183, v190, v191
  buffer_store_dwordx4 v[180:183], v178, s[4:7], s92 offen offset:0 sc1
  v_accvgpr_read_b32 v196, a68
  v_accvgpr_read_b32 v197, a69
  v_accvgpr_read_b32 v198, a70
  v_accvgpr_read_b32 v199, a71
  v_accvgpr_read_b32 v200, a100
  v_accvgpr_read_b32 v201, a101
  v_accvgpr_read_b32 v202, a102
  v_accvgpr_read_b32 v203, a103
  v_cvt_pk_bf16_f32 v192, v196, v197
  v_cvt_pk_bf16_f32 v193, v198, v199
  v_cvt_pk_bf16_f32 v194, v200, v201
  v_cvt_pk_bf16_f32 v195, v202, v203
  buffer_store_dwordx4 v[192:195], v178, s[4:7], s92 offen offset:1024 sc1
  v_accvgpr_read_b32 v208, a72
  v_accvgpr_read_b32 v209, a73
  v_accvgpr_read_b32 v210, a74
  v_accvgpr_read_b32 v211, a75
  v_accvgpr_read_b32 v212, a104
  v_accvgpr_read_b32 v213, a105
  v_accvgpr_read_b32 v214, a106
  v_accvgpr_read_b32 v215, a107
  v_cvt_pk_bf16_f32 v204, v208, v209
  v_cvt_pk_bf16_f32 v205, v210, v211
  v_cvt_pk_bf16_f32 v206, v212, v213
  v_cvt_pk_bf16_f32 v207, v214, v215
  buffer_store_dwordx4 v[204:207], v178, s[4:7], s92 offen offset:2048 sc1
  v_accvgpr_read_b32 v220, a76
  v_accvgpr_read_b32 v221, a77
  v_accvgpr_read_b32 v222, a78
  v_accvgpr_read_b32 v223, a79
  v_accvgpr_read_b32 v224, a108
  v_accvgpr_read_b32 v225, a109
  v_accvgpr_read_b32 v226, a110
  v_accvgpr_read_b32 v227, a111
  v_cvt_pk_bf16_f32 v216, v220, v221
  v_cvt_pk_bf16_f32 v217, v222, v223
  v_cvt_pk_bf16_f32 v218, v224, v225
  v_cvt_pk_bf16_f32 v219, v226, v227
  buffer_store_dwordx4 v[216:219], v178, s[4:7], s92 offen offset:3072 sc1
  v_accvgpr_read_b32 v184, a80
  v_accvgpr_read_b32 v185, a81
  v_accvgpr_read_b32 v186, a82
  v_accvgpr_read_b32 v187, a83
  v_accvgpr_read_b32 v188, a112
  v_accvgpr_read_b32 v189, a113
  v_accvgpr_read_b32 v190, a114
  v_accvgpr_read_b32 v191, a115
  v_cvt_pk_bf16_f32 v180, v184, v185
  v_cvt_pk_bf16_f32 v181, v186, v187
  v_cvt_pk_bf16_f32 v182, v188, v189
  v_cvt_pk_bf16_f32 v183, v190, v191
  buffer_store_dwordx4 v[180:183], v176, s[4:7], s92 offen offset:0 sc1
  v_accvgpr_read_b32 v196, a84
  v_accvgpr_read_b32 v197, a85
  v_accvgpr_read_b32 v198, a86
  v_accvgpr_read_b32 v199, a87
  v_accvgpr_read_b32 v200, a116
  v_accvgpr_read_b32 v201, a117
  v_accvgpr_read_b32 v202, a118
  v_accvgpr_read_b32 v203, a119
  v_cvt_pk_bf16_f32 v192, v196, v197
  v_cvt_pk_bf16_f32 v193, v198, v199
  v_cvt_pk_bf16_f32 v194, v200, v201
  v_cvt_pk_bf16_f32 v195, v202, v203
  buffer_store_dwordx4 v[192:195], v176, s[4:7], s92 offen offset:1024 sc1
  v_accvgpr_read_b32 v208, a88
  v_accvgpr_read_b32 v209, a89
  v_accvgpr_read_b32 v210, a90
  v_accvgpr_read_b32 v211, a91
  v_accvgpr_read_b32 v212, a120
  v_accvgpr_read_b32 v213, a121
  v_accvgpr_read_b32 v214, a122
  v_accvgpr_read_b32 v215, a123
  v_cvt_pk_bf16_f32 v204, v208, v209
  v_cvt_pk_bf16_f32 v205, v210, v211
  v_cvt_pk_bf16_f32 v206, v212, v213
  v_cvt_pk_bf16_f32 v207, v214, v215
  buffer_store_dwordx4 v[204:207], v176, s[4:7], s92 offen offset:2048 sc1
  v_accvgpr_read_b32 v220, a92
  v_accvgpr_read_b32 v221, a93
  v_accvgpr_read_b32 v222, a94
  v_accvgpr_read_b32 v223, a95
  v_accvgpr_read_b32 v224, a124
  v_accvgpr_read_b32 v225, a125
  v_accvgpr_read_b32 v226, a126
  v_accvgpr_read_b32 v227, a127
  v_cvt_pk_bf16_f32 v216, v220, v221
  v_cvt_pk_bf16_f32 v217, v222, v223
  v_cvt_pk_bf16_f32 v218, v224, v225
  v_cvt_pk_bf16_f32 v219, v226, v227
  buffer_store_dwordx4 v[216:219], v176, s[4:7], s92 offen offset:3072 sc1
  s_add_u32 s92, s92, s61
  v_accvgpr_read_b32 v184, a128
  v_accvgpr_read_b32 v185, a129
  v_accvgpr_read_b32 v186, a130
  v_accvgpr_read_b32 v187, a131
  v_accvgpr_read_b32 v188, a160
  v_accvgpr_read_b32 v189, a161
  v_accvgpr_read_b32 v190, a162
  v_accvgpr_read_b32 v191, a163
  v_cvt_pk_bf16_f32 v180, v184, v185
  v_cvt_pk_bf16_f32 v181, v186, v187
  v_cvt_pk_bf16_f32 v182, v188, v189
  v_cvt_pk_bf16_f32 v183, v190, v191
  buffer_store_dwordx4 v[180:183], v178, s[4:7], s92 offen offset:0 sc1
  v_accvgpr_read_b32 v196, a132
  v_accvgpr_read_b32 v197, a133
  v_accvgpr_read_b32 v198, a134
  v_accvgpr_read_b32 v199, a135
  v_accvgpr_read_b32 v200, a164
  v_accvgpr_read_b32 v201, a165
  v_accvgpr_read_b32 v202, a166
  v_accvgpr_read_b32 v203, a167
  v_cvt_pk_bf16_f32 v192, v196, v197
  v_cvt_pk_bf16_f32 v193, v198, v199
  v_cvt_pk_bf16_f32 v194, v200, v201
  v_cvt_pk_bf16_f32 v195, v202, v203
  buffer_store_dwordx4 v[192:195], v178, s[4:7], s92 offen offset:1024 sc1
  v_accvgpr_read_b32 v208, a136
  v_accvgpr_read_b32 v209, a137
  v_accvgpr_read_b32 v210, a138
  v_accvgpr_read_b32 v211, a139
  v_accvgpr_read_b32 v212, a168
  v_accvgpr_read_b32 v213, a169
  v_accvgpr_read_b32 v214, a170
  v_accvgpr_read_b32 v215, a171
  v_cvt_pk_bf16_f32 v204, v208, v209
  v_cvt_pk_bf16_f32 v205, v210, v211
  v_cvt_pk_bf16_f32 v206, v212, v213
  v_cvt_pk_bf16_f32 v207, v214, v215
  buffer_store_dwordx4 v[204:207], v178, s[4:7], s92 offen offset:2048 sc1
  v_accvgpr_read_b32 v220, a140
  v_accvgpr_read_b32 v221, a141
  v_accvgpr_read_b32 v222, a142
  v_accvgpr_read_b32 v223, a143
  v_accvgpr_read_b32 v224, a172
  v_accvgpr_read_b32 v225, a173
  v_accvgpr_read_b32 v226, a174
  v_accvgpr_read_b32 v227, a175
  v_cvt_pk_bf16_f32 v216, v220, v221
  v_cvt_pk_bf16_f32 v217, v222, v223
  v_cvt_pk_bf16_f32 v218, v224, v225
  v_cvt_pk_bf16_f32 v219, v226, v227
  buffer_store_dwordx4 v[216:219], v178, s[4:7], s92 offen offset:3072 sc1
  v_accvgpr_read_b32 v184, a144
  v_accvgpr_read_b32 v185, a145
  v_accvgpr_read_b32 v186, a146
  v_accvgpr_read_b32 v187, a147
  v_accvgpr_read_b32 v188, a176
  v_accvgpr_read_b32 v189, a177
  v_accvgpr_read_b32 v190, a178
  v_accvgpr_read_b32 v191, a179
  v_cvt_pk_bf16_f32 v180, v184, v185
  v_cvt_pk_bf16_f32 v181, v186, v187
  v_cvt_pk_bf16_f32 v182, v188, v189
  v_cvt_pk_bf16_f32 v183, v190, v191
  buffer_store_dwordx4 v[180:183], v176, s[4:7], s92 offen offset:0 sc1
  v_accvgpr_read_b32 v196, a148
  v_accvgpr_read_b32 v197, a149
  v_accvgpr_read_b32 v198, a150
  v_accvgpr_read_b32 v199, a151
  v_accvgpr_read_b32 v200, a180
  v_accvgpr_read_b32 v201, a181
  v_accvgpr_read_b32 v202, a182
  v_accvgpr_read_b32 v203, a183
  v_cvt_pk_bf16_f32 v192, v196, v197
  v_cvt_pk_bf16_f32 v193, v198, v199
  v_cvt_pk_bf16_f32 v194, v200, v201
  v_cvt_pk_bf16_f32 v195, v202, v203
  buffer_store_dwordx4 v[192:195], v176, s[4:7], s92 offen offset:1024 sc1
  v_accvgpr_read_b32 v208, a152
  v_accvgpr_read_b32 v209, a153
  v_accvgpr_read_b32 v210, a154
  v_accvgpr_read_b32 v211, a155
  v_accvgpr_read_b32 v212, a184
  v_accvgpr_read_b32 v213, a185
  v_accvgpr_read_b32 v214, a186
  v_accvgpr_read_b32 v215, a187
  v_cvt_pk_bf16_f32 v204, v208, v209
  v_cvt_pk_bf16_f32 v205, v210, v211
  v_cvt_pk_bf16_f32 v206, v212, v213
  v_cvt_pk_bf16_f32 v207, v214, v215
  buffer_store_dwordx4 v[204:207], v176, s[4:7], s92 offen offset:2048 sc1
  v_accvgpr_read_b32 v220, a156
  v_accvgpr_read_b32 v221, a157
  v_accvgpr_read_b32 v222, a158
  v_accvgpr_read_b32 v223, a159
  v_accvgpr_read_b32 v224, a188
  v_accvgpr_read_b32 v225, a189
  v_accvgpr_read_b32 v226, a190
  v_accvgpr_read_b32 v227, a191
  v_cvt_pk_bf16_f32 v216, v220, v221
  v_cvt_pk_bf16_f32 v217, v222, v223
  v_cvt_pk_bf16_f32 v218, v224, v225
  v_cvt_pk_bf16_f32 v219, v226, v227
  buffer_store_dwordx4 v[216:219], v176, s[4:7], s92 offen offset:3072 sc1
  s_add_u32 s92, s92, s61
  v_accvgpr_read_b32 v184, a192
  v_accvgpr_read_b32 v185, a193
  v_accvgpr_read_b32 v186, a194
  v_accvgpr_read_b32 v187, a195
  v_accvgpr_read_b32 v188, a224
  v_accvgpr_read_b32 v189, a225
  v_accvgpr_read_b32 v190, a226
  v_accvgpr_read_b32 v191, a227
  v_cvt_pk_bf16_f32 v180, v184, v185
  v_cvt_pk_bf16_f32 v181, v186, v187
  v_cvt_pk_bf16_f32 v182, v188, v189
  v_cvt_pk_bf16_f32 v183, v190, v191
  buffer_store_dwordx4 v[180:183], v178, s[4:7], s92 offen offset:0 sc1
  v_accvgpr_read_b32 v196, a196
  v_accvgpr_read_b32 v197, a197
  v_accvgpr_read_b32 v198, a198
  v_accvgpr_read_b32 v199, a199
  v_accvgpr_read_b32 v200, a228
  v_accvgpr_read_b32 v201, a229
  v_accvgpr_read_b32 v202, a230
  v_accvgpr_read_b32 v203, a231
  v_cvt_pk_bf16_f32 v192, v196, v197
  v_cvt_pk_bf16_f32 v193, v198, v199
  v_cvt_pk_bf16_f32 v194, v200, v201
  v_cvt_pk_bf16_f32 v195, v202, v203
  buffer_store_dwordx4 v[192:195], v178, s[4:7], s92 offen offset:1024 sc1
  v_accvgpr_read_b32 v208, a200
  v_accvgpr_read_b32 v209, a201
  v_accvgpr_read_b32 v210, a202
  v_accvgpr_read_b32 v211, a203
  v_accvgpr_read_b32 v212, a232
  v_accvgpr_read_b32 v213, a233
  v_accvgpr_read_b32 v214, a234
  v_accvgpr_read_b32 v215, a235
  v_cvt_pk_bf16_f32 v204, v208, v209
  v_cvt_pk_bf16_f32 v205, v210, v211
  v_cvt_pk_bf16_f32 v206, v212, v213
  v_cvt_pk_bf16_f32 v207, v214, v215
  buffer_store_dwordx4 v[204:207], v178, s[4:7], s92 offen offset:2048 sc1
  v_accvgpr_read_b32 v220, a204
  v_accvgpr_read_b32 v221, a205
  v_accvgpr_read_b32 v222, a206
  v_accvgpr_read_b32 v223, a207
  v_accvgpr_read_b32 v224, a236
  v_accvgpr_read_b32 v225, a237
  v_accvgpr_read_b32 v226, a238
  v_accvgpr_read_b32 v227, a239
  v_cvt_pk_bf16_f32 v216, v220, v221
  v_cvt_pk_bf16_f32 v217, v222, v223
  v_cvt_pk_bf16_f32 v218, v224, v225
  v_cvt_pk_bf16_f32 v219, v226, v227
  buffer_store_dwordx4 v[216:219], v178, s[4:7], s92 offen offset:3072 sc1
  v_accvgpr_read_b32 v184, a208
  v_accvgpr_read_b32 v185, a209
  v_accvgpr_read_b32 v186, a210
  v_accvgpr_read_b32 v187, a211
  v_accvgpr_read_b32 v188, a240
  v_accvgpr_read_b32 v189, a241
  v_accvgpr_read_b32 v190, a242
  v_accvgpr_read_b32 v191, a243
  v_cvt_pk_bf16_f32 v180, v184, v185
  v_cvt_pk_bf16_f32 v181, v186, v187
  v_cvt_pk_bf16_f32 v182, v188, v189
  v_cvt_pk_bf16_f32 v183, v190, v191
  buffer_store_dwordx4 v[180:183], v176, s[4:7], s92 offen offset:0 sc1
  v_accvgpr_read_b32 v196, a212
  v_accvgpr_read_b32 v197, a213
  v_accvgpr_read_b32 v198, a214
  v_accvgpr_read_b32 v199, a215
  v_accvgpr_read_b32 v200, a244
  v_accvgpr_read_b32 v201, a245
  v_accvgpr_read_b32 v202, a246
  v_accvgpr_read_b32 v203, a247
  v_cvt_pk_bf16_f32 v192, v196, v197
  v_cvt_pk_bf16_f32 v193, v198, v199
  v_cvt_pk_bf16_f32 v194, v200, v201
  v_cvt_pk_bf16_f32 v195, v202, v203
  buffer_store_dwordx4 v[192:195], v176, s[4:7], s92 offen offset:1024 sc1
  v_accvgpr_read_b32 v208, a216
  v_accvgpr_read_b32 v209, a217
  v_accvgpr_read_b32 v210, a218
  v_accvgpr_read_b32 v211, a219
  v_accvgpr_read_b32 v212, a248
  v_accvgpr_read_b32 v213, a249
  v_accvgpr_read_b32 v214, a250
  v_accvgpr_read_b32 v215, a251
  v_cvt_pk_bf16_f32 v204, v208, v209
  v_cvt_pk_bf16_f32 v205, v210, v211
  v_cvt_pk_bf16_f32 v206, v212, v213
  v_cvt_pk_bf16_f32 v207, v214, v215
  buffer_store_dwordx4 v[204:207], v176, s[4:7], s92 offen offset:2048 sc1
  v_accvgpr_read_b32 v220, a220
  v_accvgpr_read_b32 v221, a221
  v_accvgpr_read_b32 v222, a222
  v_accvgpr_read_b32 v223, a223
  v_accvgpr_read_b32 v224, a252
  v_accvgpr_read_b32 v225, a253
  v_accvgpr_read_b32 v226, a254
  v_accvgpr_read_b32 v227, a255
  v_cvt_pk_bf16_f32 v216, v220, v221
  v_cvt_pk_bf16_f32 v217, v222, v223
  v_cvt_pk_bf16_f32 v218, v224, v225
  v_cvt_pk_bf16_f32 v219, v226, v227
  buffer_store_dwordx4 v[216:219], v176, s[4:7], s92 offen offset:3072 sc1
  s_add_u32 s92, s92, s61
  s_branch L_esig
L_e1:
  s_cmp_lg_u32 s59, 3
  s_cbranch_scc1 L_e2
  s_lshr_b32 s90, s27, 1
  s_and_b32 s91, s27, 1
  v_mov_b32 v178, 0x0
  v_bfe_u32 v177, v1, 0, 6
  v_lshl_add_u32 v178, v177, 4, v178
  v_add_u32 v176, 4096, v178
  s_mul_i32 s92, s90, 2
  s_mul_i32 s92, s92, s61
  s_add_u32 s92, s92, s60
  s_mul_i32 s93, s91, 2048
  s_add_u32 s92, s92, s93
  v_accvgpr_read_b32 v184, a0
  v_accvgpr_read_b32 v185, a4
  v_accvgpr_read_b32 v186, a1
  v_accvgpr_read_b32 v187, a5
  v_accvgpr_read_b32 v188, a2
  v_accvgpr_read_b32 v189, a6
  v_accvgpr_read_b32 v190, a3
  v_accvgpr_read_b32 v191, a7
  v_cvt_pk_bf16_f32 v180, v184, v185
  v_cvt_pk_bf16_f32 v181, v186, v187
  v_cvt_pk_bf16_f32 v182, v188, v189
  v_cvt_pk_bf16_f32 v183, v190, v191
  buffer_store_dwordx4 v[180:183], v178, s[4:7], s92 offen offset:0 sc1
  v_accvgpr_read_b32 v196, a8
  v_accvgpr_read_b32 v197, a12
  v_accvgpr_read_b32 v198, a9
  v_accvgpr_read_b32 v199, a13
  v_accvgpr_read_b32 v200, a10
  v_accvgpr_read_b32 v201, a14
  v_accvgpr_read_b32 v202, a11
  v_accvgpr_read_b32 v203, a15
  v_cvt_pk_bf16_f32 v192, v196, v197
  v_cvt_pk_bf16_f32 v193, v198, v199
  v_cvt_pk_bf16_f32 v194, v200, v201
  v_cvt_pk_bf16_f32 v195, v202, v203
  buffer_store_dwordx4 v[192:195], v178, s[4:7], s92 offen offset:1024 sc1
  v_accvgpr_read_b32 v208, a16
  v_accvgpr_read_b32 v209, a20
  v_accvgpr_read_b32 v210, a17
  v_accvgpr_read_b32 v211, a21
  v_accvgpr_read_b32 v212, a18
  v_accvgpr_read_b32 v213, a22
  v_accvgpr_read_b32 v214, a19
  v_accvgpr_read_b32 v215, a23
  v_cvt_pk_bf16_f32 v204, v208, v209
  v_cvt_pk_bf16_f32 v205, v210, v211
  v_cvt_pk_bf16_f32 v206, v212, v213
  v_cvt_pk_bf16_f32 v207, v214, v215
  buffer_store_dwordx4 v[204:207], v176, s[4:7], s92 offen offset:0 sc1
  v_accvgpr_read_b32 v220, a24
  v_accvgpr_read_b32 v221, a28
  v_accvgpr_read_b32 v222, a25
  v_accvgpr_read_b32 v223, a29
  v_accvgpr_read_b32 v224, a26
  v_accvgpr_read_b32 v225, a30
  v_accvgpr_read_b32 v226, a27
  v_accvgpr_read_b32 v227, a31
  v_cvt_pk_bf16_f32 v216, v220, v221
  v_cvt_pk_bf16_f32 v217, v222, v223
  v_cvt_pk_bf16_f32 v218, v224, v225
  v_cvt_pk_bf16_f32 v219, v226, v227
  buffer_store_dwordx4 v[216:219], v176, s[4:7], s92 offen offset:1024 sc1
  s_add_u32 s92, s92, s61
  v_accvgpr_read_b32 v184, a32
  v_accvgpr_read_b32 v185, a36
  v_accvgpr_read_b32 v186, a33
  v_accvgpr_read_b32 v187, a37
  v_accvgpr_read_b32 v188, a34
  v_accvgpr_read_b32 v189, a38
  v_accvgpr_read_b32 v190, a35
  v_accvgpr_read_b32 v191, a39
  v_cvt_pk_bf16_f32 v180, v184, v185
  v_cvt_pk_bf16_f32 v181, v186, v187
  v_cvt_pk_bf16_f32 v182, v188, v189
  v_cvt_pk_bf16_f32 v183, v190, v191
  buffer_store_dwordx4 v[180:183], v178, s[4:7], s92 offen offset:0 sc1
  v_accvgpr_read_b32 v196, a40
  v_accvgpr_read_b32 v197, a44
  v_accvgpr_read_b32 v198, a41
  v_accvgpr_read_b32 v199, a45
  v_accvgpr_read_b32 v200, a42
  v_accvgpr_read_b32 v201, a46
  v_accvgpr_read_b32 v202, a43
  v_accvgpr_read_b32 v203, a47
  v_cvt_pk_bf16_f32 v192, v196, v197
  v_cvt_pk_bf16_f32 v193, v198, v199
  v_cvt_pk_bf16_f32 v194, v200, v201
  v_cvt_pk_bf16_f32 v195, v202, v203
  buffer_store_dwordx4 v[192:195], v178, s[4:7], s92 offen offset:1024 sc1
  v_accvgpr_read_b32 v208, a48
  v_accvgpr_read_b32 v209, a52
  v_accvgpr_read_b32 v210, a49
  v_accvgpr_read_b32 v211, a53
  v_accvgpr_read_b32 v212, a50
  v_accvgpr_read_b32 v213, a54
  v_accvgpr_read_b32 v214, a51
  v_accvgpr_read_b32 v215, a55
  v_cvt_pk_bf16_f32 v204, v208, v209
  v_cvt_pk_bf16_f32 v205, v210, v211
  v_cvt_pk_bf16_f32 v206, v212, v213
  v_cvt_pk_bf16_f32 v207, v214, v215
  buffer_store_dwordx4 v[204:207], v176, s[4:7], s92 offen offset:0 sc1
  v_accvgpr_read_b32 v220, a56
  v_accvgpr_read_b32 v221, a60
  v_accvgpr_read_b32 v222, a57
  v_accvgpr_read_b32 v223, a61
  v_accvgpr_read_b32 v224, a58
  v_accvgpr_read_b32 v225, a62
  v_accvgpr_read_b32 v226, a59
  v_accvgpr_read_b32 v227, a63
  v_cvt_pk_bf16_f32 v216, v220, v221
  v_cvt_pk_bf16_f32 v217, v222, v223
  v_cvt_pk_bf16_f32 v218, v224, v225
  v_cvt_pk_bf16_f32 v219, v226, v227
  buffer_store_dwordx4 v[216:219], v176, s[4:7], s92 offen offset:1024 sc1
  s_add_u32 s92, s92, s61
  s_branch L_esig
L_e2:
  s_cmp_lg_u32 s59, 4
  s_cbranch_scc1 L_e3
  s_lshr_b32 s90, s27, 1
  s_and_b32 s91, s27, 1
  v_mov_b32 v178, 0x0
  v_bfe_u32 v177, v1, 0, 6
  v_lshl_add_u32 v178, v177, 4, v178
  v_add_u32 v176, 4096, v178
  s_mul_i32 s92, s90, 2
  s_mul_i32 s92, s92, s61
  s_add_u32 s92, s92, s60
  s_mul_i32 s93, s91, 4096
  s_add_u32 s92, s92, s93
  v_accvgpr_read_b32 v184, a0
  v_accvgpr_read_b32 v185, a1
  v_accvgpr_read_b32 v186, a2
  v_accvgpr_read_b32 v187, a3
  v_accvgpr_read_b32 v188, a16
  v_accvgpr_read_b32 v189, a17
  v_accvgpr_read_b32 v190, a18
  v_accvgpr_read_b32 v191, a19
  v_cvt_pk_bf16_f32 v180, v184, v185
  v_cvt_pk_bf16_f32 v181, v186, v187
  v_cvt_pk_bf16_f32 v182, v188, v189
  v_cvt_pk_bf16_f32 v183, v190, v191
  buffer_store_dwordx4 v[180:183], v178, s[4:7], s92 offen offset:0 sc1
  v_accvgpr_read_b32 v196, a4
  v_accvgpr_read_b32 v197, a5
  v_accvgpr_read_b32 v198, a6
  v_accvgpr_read_b32 v199, a7
  v_accvgpr_read_b32 v200, a20
  v_accvgpr_read_b32 v201, a21
  v_accvgpr_read_b32 v202, a22
  v_accvgpr_read_b32 v203, a23
  v_cvt_pk_bf16_f32 v192, v196, v197
  v_cvt_pk_bf16_f32 v193, v198, v199
  v_cvt_pk_bf16_f32 v194, v200, v201
  v_cvt_pk_bf16_f32 v195, v202, v203
  buffer_store_dwordx4 v[192:195], v178, s[4:7], s92 offen offset:1024 sc1
  v_accvgpr_read_b32 v208, a8
  v_accvgpr_read_b32 v209, a9
  v_accvgpr_read_b32 v210, a10
  v_accvgpr_read_b32 v211, a11
  v_accvgpr_read_b32 v212, a24
  v_accvgpr_read_b32 v213, a25
  v_accvgpr_read_b32 v214, a26
  v_accvgpr_read_b32 v215, a27
  v_cvt_pk_bf16_f32 v204, v208, v209
  v_cvt_pk_bf16_f32 v205, v210, v211
  v_cvt_pk_bf16_f32 v206, v212, v213
  v_cvt_pk_bf16_f32 v207, v214, v215
  buffer_store_dwordx4 v[204:207], v178, s[4:7], s92 offen offset:2048 sc1
  v_accvgpr_read_b32 v220, a12
  v_accvgpr_read_b32 v221, a13
  v_accvgpr_read_b32 v222, a14
  v_accvgpr_read_b32 v223, a15
  v_accvgpr_read_b32 v224, a28
  v_accvgpr_read_b32 v225, a29
  v_accvgpr_read_b32 v226, a30
  v_accvgpr_read_b32 v227, a31
  v_cvt_pk_bf16_f32 v216, v220, v221
  v_cvt_pk_bf16_f32 v217, v222, v223
  v_cvt_pk_bf16_f32 v218, v224, v225
  v_cvt_pk_bf16_f32 v219, v226, v227
  buffer_store_dwordx4 v[216:219], v178, s[4:7], s92 offen offset:3072 sc1
  s_add_u32 s92, s92, s61
  v_accvgpr_read_b32 v184, a32
  v_accvgpr_read_b32 v185, a33
  v_accvgpr_read_b32 v186, a34
  v_accvgpr_read_b32 v187, a35
  v_accvgpr_read_b32 v188, a48
  v_accvgpr_read_b32 v189, a49
  v_accvgpr_read_b32 v190, a50
  v_accvgpr_read_b32 v191, a51
  v_cvt_pk_bf16_f32 v180, v184, v185
  v_cvt_pk_bf16_f32 v181, v186, v187
  v_cvt_pk_bf16_f32 v182, v188, v189
  v_cvt_pk_bf16_f32 v183, v190, v191
  buffer_store_dwordx4 v[180:183], v178, s[4:7], s92 offen offset:0 sc1
  v_accvgpr_read_b32 v196, a36
  v_accvgpr_read_b32 v197, a37
  v_accvgpr_read_b32 v198, a38
  v_accvgpr_read_b32 v199, a39
  v_accvgpr_read_b32 v200, a52
  v_accvgpr_read_b32 v201, a53
  v_accvgpr_read_b32 v202, a54
  v_accvgpr_read_b32 v203, a55
  v_cvt_pk_bf16_f32 v192, v196, v197
  v_cvt_pk_bf16_f32 v193, v198, v199
  v_cvt_pk_bf16_f32 v194, v200, v201
  v_cvt_pk_bf16_f32 v195, v202, v203
  buffer_store_dwordx4 v[192:195], v178, s[4:7], s92 offen offset:1024 sc1
  v_accvgpr_read_b32 v208, a40
  v_accvgpr_read_b32 v209, a41
  v_accvgpr_read_b32 v210, a42
  v_accvgpr_read_b32 v211, a43
  v_accvgpr_read_b32 v212, a56
  v_accvgpr_read_b32 v213, a57
  v_accvgpr_read_b32 v214, a58
  v_accvgpr_read_b32 v215, a59
  v_cvt_pk_bf16_f32 v204, v208, v209
  v_cvt_pk_bf16_f32 v205, v210, v211
  v_cvt_pk_bf16_f32 v206, v212, v213
  v_cvt_pk_bf16_f32 v207, v214, v215
  buffer_store_dwordx4 v[204:207], v178, s[4:7], s92 offen offset:2048 sc1
  v_accvgpr_read_b32 v220, a44
  v_accvgpr_read_b32 v221, a45
  v_accvgpr_read_b32 v222, a46
  v_accvgpr_read_b32 v223, a47
  v_accvgpr_read_b32 v224, a60
  v_accvgpr_read_b32 v225, a61
  v_accvgpr_read_b32 v226, a62
  v_accvgpr_read_b32 v227, a63
  v_cvt_pk_bf16_f32 v216, v220, v221
  v_cvt_pk_bf16_f32 v217, v222, v223
  v_cvt_pk_bf16_f32 v218, v224, v225
  v_cvt_pk_bf16_f32 v219, v226, v227
  buffer_store_dwordx4 v[216:219], v178, s[4:7], s92 offen offset:3072 sc1
  s_add_u32 s92, s92, s61
  s_branch L_esig
L_e3:
  s_cmp_lg_u32 s59, 5
  s_cbranch_scc1 L_e4
  s_lshr_b32 s90, s27, 1
  s_and_b32 s91, s27, 1
  v_and_b32 v176, 15, v1
  v_mul_lo_u32 v176, v176, s61
  v_lshrrev_b32 v177, 4, v1
  v_lshl_add_u32 v178, v177, 4, v176
  s_mul_i32 s92, s90, 64
  s_mul_i32 s92, s92, s61
  s_add_u32 s92, s92, s60
  s_mul_i32 s93, s91, 128
  s_add_u32 s92, s92, s93
  s_lshl_b32 s94, s61, 4
  v_accvgpr_read_b32 v184, a0
  v_accvgpr_read_b32 v185, a1
  v_accvgpr_read_b32 v186, a2
  v_accvgpr_read_b32 v187, a3
  v_accvgpr_read_b32 v188, a4
  v_accvgpr_read_b32 v189, a5
  v_accvgpr_read_b32 v190, a6
  v_accvgpr_read_b32 v191, a7
  v_cvt_pk_bf16_f32 v180, v184, v185
  v_cvt_pk_bf16_f32 v181, v186, v187
  v_cvt_pk_bf16_f32 v182, v188, v189
  v_cvt_pk_bf16_f32 v183, v190, v191
  buffer_store_dwordx4 v[180:183], v178, s[16:19], s92 offen offset:0
  v_accvgpr_read_b32 v196, a8
  v_accvgpr_read_b32 v197, a9
  v_accvgpr_read_b32 v198, a10
  v_accvgpr_read_b32 v199, a11
  v_accvgpr_read_b32 v200, a12
  v_accvgpr_read_b32 v201, a13
  v_accvgpr_read_b32 v202, a14
  v_accvgpr_read_b32 v203, a15
  v_cvt_pk_bf16_f32 v192, v196, v197
  v_cvt_pk_bf16_f32 v193, v198, v199
  v_cvt_pk_bf16_f32 v194, v200, v201
  v_cvt_pk_bf16_f32 v195, v202, v203
  buffer_store_dwordx4 v[192:195], v178, s[16:19], s92 offen offset:64
  s_add_u32 s92, s92, s94
  v_accvgpr_read_b32 v208, a16
  v_accvgpr_read_b32 v209, a17
  v_accvgpr_read_b32 v210, a18
  v_accvgpr_read_b32 v211, a19
  v_accvgpr_read_b32 v212, a20
  v_accvgpr_read_b32 v213, a21
  v_accvgpr_read_b32 v214, a22
  v_accvgpr_read_b32 v215, a23
  v_cvt_pk_bf16_f32 v204, v208, v209
  v_cvt_pk_bf16_f32 v205, v210, v211
  v_cvt_pk_bf16_f32 v206, v212, v213
  v_cvt_pk_bf16_f32 v207, v214, v215
  buffer_store_dwordx4 v[204:207], v178, s[16:19], s92 offen offset:0
  v_accvgpr_read_b32 v220, a24
  v_accvgpr_read_b32 v221, a25
  v_accvgpr_read_b32 v222, a26
  v_accvgpr_read_b32 v223, a27
  v_accvgpr_read_b32 v224, a28
  v_accvgpr_read_b32 v225, a29
  v_accvgpr_read_b32 v226, a30
  v_accvgpr_read_b32 v227, a31
  v_cvt_pk_bf16_f32 v216, v220, v221
  v_cvt_pk_bf16_f32 v217, v222, v223
  v_cvt_pk_bf16_f32 v218, v224, v225
  v_cvt_pk_bf16_f32 v219, v226, v227
  buffer_store_dwordx4 v[216:219], v178, s[16:19], s92 offen offset:64
  s_add_u32 s92, s92, s94
  v_accvgpr_read_b32 v184, a32
  v_accvgpr_read_b32 v185, a33
  v_accvgpr_read_b32 v186, a34
  v_accvgpr_read_b32 v187, a35
  v_accvgpr_read_b32 v188, a36
  v_accvgpr_read_b32 v189, a37
  v_accvgpr_read_b32 v190, a38
  v_accvgpr_read_b32 v191, a39
  v_cvt_pk_bf16_f32 v180, v184, v185
  v_cvt_pk_bf16_f32 v181, v186, v187
  v_cvt_pk_bf16_f32 v182, v188, v189
  v_cvt_pk_bf16_f32 v183, v190, v191
  buffer_store_dwordx4 v[180:183], v178, s[16:19], s92 offen offset:0
  v_accvgpr_read_b32 v196, a40
  v_accvgpr_read_b32 v197, a41
  v_accvgpr_read_b32 v198, a42
  v_accvgpr_read_b32 v199, a43
  v_accvgpr_read_b32 v200, a44
  v_accvgpr_read_b32 v201, a45
  v_accvgpr_read_b32 v202, a46
  v_accvgpr_read_b32 v203, a47
  v_cvt_pk_bf16_f32 v192, v196, v197
  v_cvt_pk_bf16_f32 v193, v198, v199
  v_cvt_pk_bf16_f32 v194, v200, v201
  v_cvt_pk_bf16_f32 v195, v202, v203
  buffer_store_dwordx4 v[192:195], v178, s[16:19], s92 offen offset:64
  s_add_u32 s92, s92, s94
  v_accvgpr_read_b32 v208, a48
  v_accvgpr_read_b32 v209, a49
  v_accvgpr_read_b32 v210, a50
  v_accvgpr_read_b32 v211, a51
  v_accvgpr_read_b32 v212, a52
  v_accvgpr_read_b32 v213, a53
  v_accvgpr_read_b32 v214, a54
  v_accvgpr_read_b32 v215, a55
  v_cvt_pk_bf16_f32 v204, v208, v209
  v_cvt_pk_bf16_f32 v205, v210, v211
  v_cvt_pk_bf16_f32 v206, v212, v213
  v_cvt_pk_bf16_f32 v207, v214, v215
  buffer_store_dwordx4 v[204:207], v178, s[16:19], s92 offen offset:0
  v_accvgpr_read_b32 v220, a56
  v_accvgpr_read_b32 v221, a57
  v_accvgpr_read_b32 v222, a58
  v_accvgpr_read_b32 v223, a59
  v_accvgpr_read_b32 v224, a60
  v_accvgpr_read_b32 v225, a61
  v_accvgpr_read_b32 v226, a62
  v_accvgpr_read_b32 v227, a63
  v_cvt_pk_bf16_f32 v216, v220, v221
  v_cvt_pk_bf16_f32 v217, v222, v223
  v_cvt_pk_bf16_f32 v218, v224, v225
  v_cvt_pk_bf16_f32 v219, v226, v227
  buffer_store_dwordx4 v[216:219], v178, s[16:19], s92 offen offset:64
  s_add_u32 s92, s92, s94
  s_branch L_epid
L_e4:
L_esig:
  s_waitcnt vmcnt(0)
  s_cmp_lg_u32 s39, 0
  s_cbranch_scc1 L_vok
  s_cmp_lg_u32 s32, 0
  s_cbranch_scc1 L_vd_3
  v_mbcnt_lo_u32_b32 v250, -1, 0
  v_mbcnt_hi_u32_b32 v250, -1, v250
  v_lshlrev_b32 v250, 2, v250
  s_cmp_lg_u32 s100, 0
  s_cbranch_scc1 L_vw_2
  v_readfirstlane_b32 s90, v247
  s_and_b32 s90, s90, s101
  s_cbranch_scc0 L_vw_2
  v_mov_b32 v251, 1
  s_mov_b64 exec, 1
  buffer_store_dword v251, v250, s[28:31], 0 offen offset:32 sc1
  s_mov_b64 exec, -1
L_vw_2:
  buffer_load_dword v251, v250, s[28:31], 0 offen sc1
  s_waitcnt vmcnt(0)
  v_cmp_eq_u32 vcc, -1, v251
  v_readlane_b32 s91, v251, 8
  v_readlane_b32 s92, v251, 32
  v_readlane_b32 s93, v251, 33
  v_readlane_b32 s90, v251, 34
  s_cmp_lg_u32 s100, 0
  s_cselect_b32 s93, s90, s93
  s_cselect_b32 s91, 0, s91
  s_cselect_b32 s92, 1, s92
  s_cselect_b32 s90, 0xff, vcc_lo
  s_cmp_lg_u32 s91, 0
  s_cselect_b32 s92, 3, s92
  s_cbranch_scc1 L_vk_4
  s_add_u32 s3, s3, 1
  s_cmp_ge_u32 s3, 131072
  s_cselect_b32 s92, 4, s92
  s_cbranch_scc1 L_vk_4
  s_sleep 8
  s_and_b32 s90, s90, 0xff
  s_cmp_lg_u32 s90, 0xff
  s_cbranch_scc1 L_vw_2
  s_cmp_lt_u32 s93, 128
  s_cbranch_scc1 L_vw_2
L_vk_4:
  v_mov_b32 v251, s92
  v_mov_b32 v250, 131072
  ds_write_b32 v250, v251
  s_waitcnt lgkmcnt(0)
L_vd_3:
  s_barrier
  v_mov_b32 v250, 131072
  ds_read_b32 v251, v250
  s_waitcnt lgkmcnt(0)
  v_readfirstlane_b32 s92, v251
  s_barrier
  s_cmp_eq_u32 s92, 3
  s_cbranch_scc1 L_fallback
  s_cmp_eq_u32 s92, 4
  s_cbranch_scc1 L_exit
  s_mov_b32 s39, 1
L_vok:
  s_barrier
  s_cmp_lg_u32 s32, 0
  s_cbranch_scc1 L_sig_5
  v_mov_b32 v254, s63
  v_mov_b32 v255, 0
  s_mov_b64 exec, 1
  buffer_atomic_add v254, v255, s[4:7], s62 offen offset:0 sc1
  s_mov_b64 exec, -1
L_sig_5:
L_epid:
  s_mov_b32 s59, 0
  s_cmp_eq_u32 s58, 1
  s_cbranch_scc1 L_r1
  s_cmp_eq_u32 s58, 2
  s_cbranch_scc1 L_r2
  s_cmp_eq_u32 s58, 3
  s_cbranch_scc1 L_next
  s_cmp_eq_u32 s35, 4
  s_cbranch_scc1 L_atb
  s_cmp_eq_u32 s35, 5
  s_cbranch_scc1 L_bo
  s_cmp_eq_u32 s35, 6
  s_cbranch_scc1 L_ata
  s_cmp_eq_u32 s35, 11
  s_cbranch_scc1 L_ata4
  s_cmp_eq_u32 s35, 7
  s_cbranch_scc1 L_ao
  s_cmp_eq_u32 s35, 8
  s_cbranch_scc1 L_aos
  s_cmp_eq_u32 s35, 12
  s_cbranch_scc1 L_swp
  s_branch L_exit
L_aqkv:
  s_mov_b32 s8, s64
  s_and_b32 s9, s65, 0xffff
  s_mov_b32 s10, 0x400000
  s_mov_b32 s11, 0x20000
  s_cmp_eq_u32 s35, 0
  s_cselect_b64 s[88:89], s[68:69], s[70:71]
  s_cmp_eq_u32 s35, 2
  s_cselect_b64 s[88:89], s[72:73], s[88:89]
  s_mov_b32 s12, s88
  s_and_b32 s13, s89, 0xffff
  s_mov_b32 s14, 0x800000
  s_mov_b32 s15, 0x20000
  s_lshl_b32 s91, s33, 2
  s_add_u32 s91, s91, s37
  s_mov_b32 s24, 8192
  s_mov_b32 s26, 262144
  s_lshl_b32 s20, s36, 19
  s_lshl_b32 s21, s91, 9
  s_lshl_b32 s22, s35, 24
  s_lshl_b32 s90, s36, 21
  s_add_u32 s22, s22, s90
  s_lshl_b32 s90, s91, 14
  s_add_u32 s22, s22, s90
  s_cmp_eq_u32 s35, 0
  s_mov_b32 s38, 4096
  s_cselect_b32 s38, 8192, s38
  s_cselect_b32 s98, 1, 4
  s_mov_b32 s48, s35
  s_branch L_g1
L_bqkv:
  s_mov_b32 s8, s78
  s_and_b32 s9, s79, 0xffff
  s_mov_b32 s10, 0x400000
  s_mov_b32 s11, 0x20000
  s_mov_b32 s12, s80
  s_and_b32 s13, s81, 0xffff
  s_mov_b32 s14, 0x600000
  s_mov_b32 s15, 0x20000
  s_lshl_b32 s91, s37, 2
  s_add_u32 s91, s91, s33
  s_mov_b32 s24, 6144
  s_mov_b32 s26, 65536
  s_lshl_b32 s20, s36, 19
  s_lshl_b32 s21, s91, 9
  s_lshl_b32 s22, s37, 22
  s_lshl_b32 s90, s36, 19
  s_add_u32 s22, s22, s90
  s_lshl_b32 s90, s33, 14
  s_add_u32 s22, s22, s90
  s_add_u32 s22, s22, 0x4000000
  s_mov_b32 s38, 12288
  s_mov_b32 s48, s37
L_g1:
  s_lshl_b32 s90, s36, 9
  s_add_u32 s38, s38, s90
  s_lshl_b32 s90, s33, 7
  s_add_u32 s38, s38, s90
  s_mov_b32 s23, 2048
  s_mov_b32 s25, 8
  v_and_b32 v1, 63, v0
  v_lshrrev_b32 v38, 6, v0
  s_nop 0
  v_readfirstlane_b32 s27, v38
  s_mul_i32 s90, s27, 64
  v_lshrrev_b32 v38, 3, v1
  v_add_u32 v38, s90, v38
  v_mul_lo_u32 v38, v38, s23
  v_lshrrev_b32 v39, 4, v1
  v_xor_b32 v39, v39, v1
  v_and_b32 v39, 7, v39
  v_lshl_add_u32 v2, v39, 4, v38
  s_mul_i32 s91, s23, 8
  v_add_u32 v3, s91, v2
  v_xor_b32 v3, 64, v3
  v_add_u32 v4, s91, v3
  v_xor_b32 v4, 64, v4
  v_add_u32 v5, s91, v4
  v_xor_b32 v5, 64, v5
  v_add_u32 v6, s91, v5
  v_xor_b32 v6, 64, v6
  v_add_u32 v7, s91, v6
  v_xor_b32 v7, 64, v7
  v_add_u32 v8, s91, v7
  v_xor_b32 v8, 64, v8
  v_add_u32 v9, s91, v8
  v_xor_b32 v9, 64, v9
  s_mul_i32 s90, s27, 16
  v_lshrrev_b32 v38, 5, v1
  v_add_u32 v38, 0, v38
  v_add_u32 v38, s90, v38
  v_and_b32 v39, 3, v38
  v_lshlrev_b32 v39, 1, v39
  v_and_b32 v40, 8, v38
  v_or_b32 v39, v39, v40
  v_xor_b32 v39, v39, v1
  v_and_b32 v39, 31, v39
  v_mul_lo_u32 v38, v38, s24
  v_lshl_add_u32 v10, v39, 4, v38
  v_lshrrev_b32 v38, 5, v1
  v_add_u32 v38, 2, v38
  v_add_u32 v38, s90, v38
  v_and_b32 v39, 3, v38
  v_lshlrev_b32 v39, 1, v39
  v_and_b32 v40, 8, v38
  v_or_b32 v39, v39, v40
  v_xor_b32 v39, v39, v1
  v_and_b32 v39, 31, v39
  v_mul_lo_u32 v38, v38, s24
  v_lshl_add_u32 v11, v39, 4, v38
  v_lshrrev_b32 v38, 5, v1
  v_add_u32 v38, 4, v38
  v_add_u32 v38, s90, v38
  v_and_b32 v39, 3, v38
  v_lshlrev_b32 v39, 1, v39
  v_and_b32 v40, 8, v38
  v_or_b32 v39, v39, v40
  v_xor_b32 v39, v39, v1
  v_and_b32 v39, 31, v39
  v_mul_lo_u32 v38, v38, s24
  v_lshl_add_u32 v12, v39, 4, v38
  v_lshrrev_b32 v38, 5, v1
  v_add_u32 v38, 6, v38
  v_add_u32 v38, s90, v38
  v_and_b32 v39, 3, v38
  v_lshlrev_b32 v39, 1, v39
  v_and_b32 v40, 8, v38
  v_or_b32 v39, v39, v40
  v_xor_b32 v39, v39, v1
  v_and_b32 v39, 31, v39
  v_mul_lo_u32 v38, v38, s24
  v_lshl_add_u32 v13, v39, 4, v38
  v_lshrrev_b32 v38, 5, v1
  v_add_u32 v38, 8, v38
  v_add_u32 v38, s90, v38
  v_and_b32 v39, 3, v38
  v_lshlrev_b32 v39, 1, v39
  v_and_b32 v40, 8, v38
  v_or_b32 v39, v39, v40
  v_xor_b32 v39, v39, v1
  v_and_b32 v39, 31, v39
  v_mul_lo_u32 v38, v38, s24
  v_lshl_add_u32 v14, v39, 4, v38
  v_lshrrev_b32 v38, 5, v1
  v_add_u32 v38, 10, v38
  v_add_u32 v38, s90, v38
  v_and_b32 v39, 3, v38
  v_lshlrev_b32 v39, 1, v39
  v_and_b32 v40, 8, v38
  v_or_b32 v39, v39, v40
  v_xor_b32 v39, v39, v1
  v_and_b32 v39, 31, v39
  v_mul_lo_u32 v38, v38, s24
  v_lshl_add_u32 v15, v39, 4, v38
  v_lshrrev_b32 v38, 5, v1
  v_add_u32 v38, 12, v38
  v_add_u32 v38, s90, v38
  v_and_b32 v39, 3, v38
  v_lshlrev_b32 v39, 1, v39
  v_and_b32 v40, 8, v38
  v_or_b32 v39, v39, v40
  v_xor_b32 v39, v39, v1
  v_and_b32 v39, 31, v39
  v_mul_lo_u32 v38, v38, s24
  v_lshl_add_u32 v16, v39, 4, v38
  v_lshrrev_b32 v38, 5, v1
  v_add_u32 v38, 14, v38
  v_add_u32 v38, s90, v38
  v_and_b32 v39, 3, v38
  v_lshlrev_b32 v39, 1, v39
  v_and_b32 v40, 8, v38
  v_or_b32 v39, v39, v40
  v_xor_b32 v39, v39, v1
  v_and_b32 v39, 31, v39
  v_mul_lo_u32 v38, v38, s24
  v_lshl_add_u32 v17, v39, 4, v38
  s_mul_i32 s51, s24, 64
  s_mul_i32 s52, s27, 8192
  s_mul_i32 s53, s27, 8192
  s_add_u32 s53, s53, 32768
  s_add_u32 m0, s52, 0
  s_nop 0
  buffer_load_dwordx4 v2, s[8:11], s20 offen  lds
  s_add_u32 m0, s53, 0
  s_nop 0
  buffer_load_dwordx4 v10, s[12:15], s21 offen  lds
  s_add_u32 m0, s52, 1024
  s_nop 0
  buffer_load_dwordx4 v3, s[8:11], s20 offen  lds
  s_add_u32 m0, s53, 1024
  s_nop 0
  buffer_load_dwordx4 v11, s[12:15], s21 offen  lds
  s_add_u32 m0, s52, 2048
  s_nop 0
  buffer_load_dwordx4 v4, s[8:11], s20 offen  lds
  s_add_u32 m0, s53, 2048
  s_nop 0
  buffer_load_dwordx4 v12, s[12:15], s21 offen  lds
  s_add_u32 m0, s52, 3072
  s_nop 0
  buffer_load_dwordx4 v5, s[8:11], s20 offen  lds
  s_add_u32 m0, s53, 3072
  s_nop 0
  buffer_load_dwordx4 v13, s[12:15], s21 offen  lds
  s_add_u32 m0, s52, 4096
  s_nop 0
  buffer_load_dwordx4 v6, s[8:11], s20 offen  lds
  s_add_u32 m0, s53, 4096
  s_nop 0
  buffer_load_dwordx4 v14, s[12:15], s21 offen  lds
  s_add_u32 m0, s52, 5120
  s_nop 0
  buffer_load_dwordx4 v7, s[8:11], s20 offen  lds
  s_add_u32 m0, s53, 5120
  s_nop 0
  buffer_load_dwordx4 v15, s[12:15], s21 offen  lds
  s_add_u32 m0, s52, 6144
  s_nop 0
  buffer_load_dwordx4 v8, s[8:11], s20 offen  lds
  s_add_u32 m0, s53, 6144
  s_nop 0
  buffer_load_dwordx4 v16, s[12:15], s21 offen  lds
  s_add_u32 m0, s52, 7168
  s_nop 0
  buffer_load_dwordx4 v9, s[8:11], s20 offen  lds
  s_add_u32 m0, s53, 7168
  s_nop 0
  buffer_load_dwordx4 v17, s[12:15], s21 offen  lds
  s_add_u32 s20, s20, 128
  s_add_u32 s21, s21, s51
  s_add_u32 m0, s52, 65536
  s_nop 0
  buffer_load_dwordx4 v2, s[8:11], s20 offen  lds
  s_add_u32 m0, s53, 65536
  s_nop 0
  buffer_load_dwordx4 v10, s[12:15], s21 offen  lds
  s_add_u32 m0, s52, 66560
  s_nop 0
  buffer_load_dwordx4 v3, s[8:11], s20 offen  lds
  s_add_u32 m0, s53, 66560
  s_nop 0
  buffer_load_dwordx4 v11, s[12:15], s21 offen  lds
  s_add_u32 m0, s52, 67584
  s_nop 0
  buffer_load_dwordx4 v4, s[8:11], s20 offen  lds
  s_add_u32 m0, s53, 67584
  s_nop 0
  buffer_load_dwordx4 v12, s[12:15], s21 offen  lds
  s_add_u32 m0, s52, 68608
  s_nop 0
  buffer_load_dwordx4 v5, s[8:11], s20 offen  lds
  s_add_u32 m0, s53, 68608
  s_nop 0
  buffer_load_dwordx4 v13, s[12:15], s21 offen  lds
  s_add_u32 m0, s52, 69632
  s_nop 0
  buffer_load_dwordx4 v6, s[8:11], s20 offen  lds
  s_add_u32 m0, s53, 69632
  s_nop 0
  buffer_load_dwordx4 v14, s[12:15], s21 offen  lds
  s_add_u32 m0, s52, 70656
  s_nop 0
  buffer_load_dwordx4 v7, s[8:11], s20 offen  lds
  s_add_u32 m0, s53, 70656
  s_nop 0
  buffer_load_dwordx4 v15, s[12:15], s21 offen  lds
  s_add_u32 m0, s52, 71680
  s_nop 0
  buffer_load_dwordx4 v8, s[8:11], s20 offen  lds
  s_add_u32 m0, s53, 71680
  s_nop 0
  buffer_load_dwordx4 v16, s[12:15], s21 offen  lds
  s_add_u32 m0, s52, 72704
  s_nop 0
  buffer_load_dwordx4 v9, s[8:11], s20 offen  lds
  s_add_u32 m0, s53, 72704
  s_nop 0
  buffer_load_dwordx4 v17, s[12:15], s21 offen  lds
  s_add_u32 s20, s20, 128
  s_add_u32 s21, s21, s51
  s_lshr_b32 s90, s27, 1
  s_and_b32 s91, s27, 1
  s_mul_i32 s92, s90, 16384
  v_mov_b32 v38, 0x0
  v_bfe_u32 v39, v1, 0, 4
  v_lshl_add_u32 v38, v39, 7, v38
  v_add_u32 v38, s92, v38
  v_lshrrev_b32 v39, 1, v1
  v_and_b32 v39, 7, v39
  v_lshrrev_b32 v40, 4, v1
  v_xor_b32 v39, v39, v40
  v_lshl_add_u32 v18, v39, 4, v38
  v_xor_b32 v19, 64, v18
  v_add_u32 v20, 65536, v18
  v_add_u32 v21, 65536, v19
  v_mov_b32 v38, 0x0
  v_bfe_u32 v39, v1, 2, 2
  v_lshl_add_u32 v38, v39, 9, v38
  v_bfe_u32 v39, v1, 4, 2
  v_lshl_add_u32 v38, v39, 12, v38
  v_bfe_u32 v39, v1, 0, 2
  v_lshl_add_u32 v38, v39, 3, v38
  v_bfe_u32 v40, v1, 2, 3
  s_mul_i32 s92, s91, 8
  s_add_u32 s93, s92, 0
  v_xor_b32 v39, s93, v40
  v_lshl_add_u32 v22, v39, 5, v38
  v_add_u32 v30, 65536, v22
  s_add_u32 s93, s92, 1
  v_xor_b32 v39, s93, v40
  v_lshl_add_u32 v23, v39, 5, v38
  v_add_u32 v31, 65536, v23
  s_add_u32 s93, s92, 2
  v_xor_b32 v39, s93, v40
  v_lshl_add_u32 v24, v39, 5, v38
  v_add_u32 v32, 65536, v24
  s_add_u32 s93, s92, 3
  v_xor_b32 v39, s93, v40
  v_lshl_add_u32 v25, v39, 5, v38
  v_add_u32 v33, 65536, v25
  s_add_u32 s93, s92, 4
  v_xor_b32 v39, s93, v40
  v_lshl_add_u32 v26, v39, 5, v38
  v_add_u32 v34, 65536, v26
  s_add_u32 s93, s92, 5
  v_xor_b32 v39, s93, v40
  v_lshl_add_u32 v27, v39, 5, v38
  v_add_u32 v35, 65536, v27
  s_add_u32 s93, s92, 6
  v_xor_b32 v39, s93, v40
  v_lshl_add_u32 v28, v39, 5, v38
  v_add_u32 v36, 65536, v28
  s_add_u32 s93, s92, 7
  v_xor_b32 v39, s93, v40
  v_lshl_add_u32 v29, v39, 5, v38
  v_add_u32 v37, 65536, v29
  s_mov_b32 s58, 1
  s_branch L_epi
L_r1:
  s_cmp_eq_u32 s48, 2
  s_cbranch_scc1 L_g2
  s_waitcnt vmcnt(16)
  s_barrier
  ds_read_b128 v[44:47], v18 offset:0
  ds_read_b64_tr_b16 v[108:109], v22 offset:32768
  ds_read_b64_tr_b16 v[110:111], v22 offset:34816
  ds_read_b128 v[48:51], v18 offset:2048
  ds_read_b64_tr_b16 v[112:113], v23 offset:32768
  ds_read_b64_tr_b16 v[114:115], v23 offset:34816
  ds_read_b128 v[52:55], v18 offset:4096
  ds_read_b64_tr_b16 v[116:117], v24 offset:32768
  ds_read_b64_tr_b16 v[118:119], v24 offset:34816
  ds_read_b128 v[56:59], v18 offset:6144
  ds_read_b64_tr_b16 v[120:121], v25 offset:32768
  ds_read_b64_tr_b16 v[122:123], v25 offset:34816
  ds_read_b128 v[60:63], v18 offset:8192
  ds_read_b64_tr_b16 v[124:125], v26 offset:32768
  ds_read_b64_tr_b16 v[126:127], v26 offset:34816
  ds_read_b128 v[64:67], v18 offset:10240
  ds_read_b64_tr_b16 v[128:129], v27 offset:32768
  ds_read_b64_tr_b16 v[130:131], v27 offset:34816
  ds_read_b128 v[68:71], v18 offset:12288
  ds_read_b64_tr_b16 v[132:133], v28 offset:32768
  ds_read_b64_tr_b16 v[134:135], v28 offset:34816
  ds_read_b128 v[72:75], v18 offset:14336
  ds_read_b64_tr_b16 v[136:137], v29 offset:32768
  ds_read_b64_tr_b16 v[138:139], v29 offset:34816
  s_sub_u32 s25, s25, 1
  s_waitcnt lgkmcnt(0)
  v_mfma_f32_16x16x32_bf16 a[0:3], v[108:111], v[44:47], 0
  ds_read_b128 v[76:79], v19 offset:0
  v_mfma_f32_16x16x32_bf16 a[4:7], v[112:115], v[44:47], 0
  v_mfma_f32_16x16x32_bf16 a[8:11], v[116:119], v[44:47], 0
  ds_read_b64_tr_b16 v[140:141], v22 offset:49152
  v_mfma_f32_16x16x32_bf16 a[12:15], v[120:123], v[44:47], 0
  v_mfma_f32_16x16x32_bf16 a[16:19], v[124:127], v[44:47], 0
  ds_read_b64_tr_b16 v[142:143], v22 offset:51200
  v_mfma_f32_16x16x32_bf16 a[20:23], v[128:131], v[44:47], 0
  v_mfma_f32_16x16x32_bf16 a[24:27], v[132:135], v[44:47], 0
  ds_read_b128 v[80:83], v19 offset:2048
  v_mfma_f32_16x16x32_bf16 a[28:31], v[136:139], v[44:47], 0
  v_mfma_f32_16x16x32_bf16 a[32:35], v[108:111], v[48:51], 0
  ds_read_b64_tr_b16 v[144:145], v23 offset:49152
  v_mfma_f32_16x16x32_bf16 a[36:39], v[112:115], v[48:51], 0
  v_mfma_f32_16x16x32_bf16 a[40:43], v[116:119], v[48:51], 0
  ds_read_b64_tr_b16 v[146:147], v23 offset:51200
  v_mfma_f32_16x16x32_bf16 a[44:47], v[120:123], v[48:51], 0
  v_mfma_f32_16x16x32_bf16 a[48:51], v[124:127], v[48:51], 0
  ds_read_b128 v[84:87], v19 offset:4096
  v_mfma_f32_16x16x32_bf16 a[52:55], v[128:131], v[48:51], 0
  v_mfma_f32_16x16x32_bf16 a[56:59], v[132:135], v[48:51], 0
  ds_read_b64_tr_b16 v[148:149], v24 offset:49152
  v_mfma_f32_16x16x32_bf16 a[60:63], v[136:139], v[48:51], 0
  v_mfma_f32_16x16x32_bf16 a[64:67], v[108:111], v[52:55], 0
  ds_read_b64_tr_b16 v[150:151], v24 offset:51200
  v_mfma_f32_16x16x32_bf16 a[68:71], v[112:115], v[52:55], 0
  v_mfma_f32_16x16x32_bf16 a[72:75], v[116:119], v[52:55], 0
  ds_read_b128 v[88:91], v19 offset:6144
  v_mfma_f32_16x16x32_bf16 a[76:79], v[120:123], v[52:55], 0
  v_mfma_f32_16x16x32_bf16 a[80:83], v[124:127], v[52:55], 0
  ds_read_b64_tr_b16 v[152:153], v25 offset:49152
  v_mfma_f32_16x16x32_bf16 a[84:87], v[128:131], v[52:55], 0
  v_mfma_f32_16x16x32_bf16 a[88:91], v[132:135], v[52:55], 0
  ds_read_b64_tr_b16 v[154:155], v25 offset:51200
  v_mfma_f32_16x16x32_bf16 a[92:95], v[136:139], v[52:55], 0
  v_mfma_f32_16x16x32_bf16 a[96:99], v[108:111], v[56:59], 0
  ds_read_b128 v[92:95], v19 offset:8192
  v_mfma_f32_16x16x32_bf16 a[100:103], v[112:115], v[56:59], 0
  v_mfma_f32_16x16x32_bf16 a[104:107], v[116:119], v[56:59], 0
  ds_read_b64_tr_b16 v[156:157], v26 offset:49152
  v_mfma_f32_16x16x32_bf16 a[108:111], v[120:123], v[56:59], 0
  v_mfma_f32_16x16x32_bf16 a[112:115], v[124:127], v[56:59], 0
  ds_read_b64_tr_b16 v[158:159], v26 offset:51200
  v_mfma_f32_16x16x32_bf16 a[116:119], v[128:131], v[56:59], 0
  v_mfma_f32_16x16x32_bf16 a[120:123], v[132:135], v[56:59], 0
  ds_read_b128 v[96:99], v19 offset:10240
  v_mfma_f32_16x16x32_bf16 a[124:127], v[136:139], v[56:59], 0
  v_mfma_f32_16x16x32_bf16 a[128:131], v[108:111], v[60:63], 0
  ds_read_b64_tr_b16 v[160:161], v27 offset:49152
  v_mfma_f32_16x16x32_bf16 a[132:135], v[112:115], v[60:63], 0
  v_mfma_f32_16x16x32_bf16 a[136:139], v[116:119], v[60:63], 0
  ds_read_b64_tr_b16 v[162:163], v27 offset:51200
  v_mfma_f32_16x16x32_bf16 a[140:143], v[120:123], v[60:63], 0
  v_mfma_f32_16x16x32_bf16 a[144:147], v[124:127], v[60:63], 0
  ds_read_b128 v[100:103], v19 offset:12288
  v_mfma_f32_16x16x32_bf16 a[148:151], v[128:131], v[60:63], 0
  v_mfma_f32_16x16x32_bf16 a[152:155], v[132:135], v[60:63], 0
  ds_read_b64_tr_b16 v[164:165], v28 offset:49152
  v_mfma_f32_16x16x32_bf16 a[156:159], v[136:139], v[60:63], 0
  v_mfma_f32_16x16x32_bf16 a[160:163], v[108:111], v[64:67], 0
  ds_read_b64_tr_b16 v[166:167], v28 offset:51200
  v_mfma_f32_16x16x32_bf16 a[164:167], v[112:115], v[64:67], 0
  v_mfma_f32_16x16x32_bf16 a[168:171], v[116:119], v[64:67], 0
  ds_read_b128 v[104:107], v19 offset:14336
  v_mfma_f32_16x16x32_bf16 a[172:175], v[120:123], v[64:67], 0
  v_mfma_f32_16x16x32_bf16 a[176:179], v[124:127], v[64:67], 0
  ds_read_b64_tr_b16 v[168:169], v29 offset:49152
  v_mfma_f32_16x16x32_bf16 a[180:183], v[128:131], v[64:67], 0
  v_mfma_f32_16x16x32_bf16 a[184:187], v[132:135], v[64:67], 0
  ds_read_b64_tr_b16 v[170:171], v29 offset:51200
  v_mfma_f32_16x16x32_bf16 a[188:191], v[136:139], v[64:67], 0
  v_mfma_f32_16x16x32_bf16 a[192:195], v[108:111], v[68:71], 0
  v_mfma_f32_16x16x32_bf16 a[196:199], v[112:115], v[68:71], 0
  v_mfma_f32_16x16x32_bf16 a[200:203], v[116:119], v[68:71], 0
  v_mfma_f32_16x16x32_bf16 a[204:207], v[120:123], v[68:71], 0
  v_mfma_f32_16x16x32_bf16 a[208:211], v[124:127], v[68:71], 0
  v_mfma_f32_16x16x32_bf16 a[212:215], v[128:131], v[68:71], 0
  v_mfma_f32_16x16x32_bf16 a[216:219], v[132:135], v[68:71], 0
  v_mfma_f32_16x16x32_bf16 a[220:223], v[136:139], v[68:71], 0
  v_mfma_f32_16x16x32_bf16 a[224:227], v[108:111], v[72:75], 0
  v_mfma_f32_16x16x32_bf16 a[228:231], v[112:115], v[72:75], 0
  v_mfma_f32_16x16x32_bf16 a[232:235], v[116:119], v[72:75], 0
  v_mfma_f32_16x16x32_bf16 a[236:239], v[120:123], v[72:75], 0
  v_mfma_f32_16x16x32_bf16 a[240:243], v[124:127], v[72:75], 0
  v_mfma_f32_16x16x32_bf16 a[244:247], v[128:131], v[72:75], 0
  v_mfma_f32_16x16x32_bf16 a[248:251], v[132:135], v[72:75], 0
  v_mfma_f32_16x16x32_bf16 a[252:255], v[136:139], v[72:75], 0
  s_waitcnt lgkmcnt(0)
  v_mfma_f32_16x16x32_bf16 a[0:3], v[140:143], v[76:79], a[0:3]
  s_waitcnt vmcnt(0)
  s_barrier
  s_add_u32 m0, s52, 0
  v_mfma_f32_16x16x32_bf16 a[4:7], v[144:147], v[76:79], a[4:7]
  buffer_load_dwordx4 v2, s[8:11], s20 offen  lds
  ds_read_b128 v[44:47], v20 offset:0
  v_mfma_f32_16x16x32_bf16 a[8:11], v[148:151], v[76:79], a[8:11]
  v_mfma_f32_16x16x32_bf16 a[12:15], v[152:155], v[76:79], a[12:15]
  ds_read_b64_tr_b16 v[108:109], v30 offset:32768
  s_add_u32 m0, s53, 0
  v_mfma_f32_16x16x32_bf16 a[16:19], v[156:159], v[76:79], a[16:19]
  buffer_load_dwordx4 v10, s[12:15], s21 offen  lds
  v_mfma_f32_16x16x32_bf16 a[20:23], v[160:163], v[76:79], a[20:23]
  ds_read_b64_tr_b16 v[110:111], v30 offset:34816
  v_mfma_f32_16x16x32_bf16 a[24:27], v[164:167], v[76:79], a[24:27]
  v_mfma_f32_16x16x32_bf16 a[28:31], v[168:171], v[76:79], a[28:31]
  ds_read_b128 v[48:51], v20 offset:2048
  s_add_u32 m0, s52, 1024
  v_mfma_f32_16x16x32_bf16 a[32:35], v[140:143], v[80:83], a[32:35]
  buffer_load_dwordx4 v3, s[8:11], s20 offen  lds
  v_mfma_f32_16x16x32_bf16 a[36:39], v[144:147], v[80:83], a[36:39]
  ds_read_b64_tr_b16 v[112:113], v31 offset:32768
  v_mfma_f32_16x16x32_bf16 a[40:43], v[148:151], v[80:83], a[40:43]
  v_mfma_f32_16x16x32_bf16 a[44:47], v[152:155], v[80:83], a[44:47]
  ds_read_b64_tr_b16 v[114:115], v31 offset:34816
  s_add_u32 m0, s53, 1024
  v_mfma_f32_16x16x32_bf16 a[48:51], v[156:159], v[80:83], a[48:51]
  buffer_load_dwordx4 v11, s[12:15], s21 offen  lds
  v_mfma_f32_16x16x32_bf16 a[52:55], v[160:163], v[80:83], a[52:55]
  ds_read_b128 v[52:55], v20 offset:4096
  v_mfma_f32_16x16x32_bf16 a[56:59], v[164:167], v[80:83], a[56:59]
  s_add_u32 m0, s52, 2048
  v_mfma_f32_16x16x32_bf16 a[60:63], v[168:171], v[80:83], a[60:63]
  buffer_load_dwordx4 v4, s[8:11], s20 offen  lds
  ds_read_b64_tr_b16 v[116:117], v32 offset:32768
  v_mfma_f32_16x16x32_bf16 a[64:67], v[140:143], v[84:87], a[64:67]
  v_mfma_f32_16x16x32_bf16 a[68:71], v[144:147], v[84:87], a[68:71]
  ds_read_b64_tr_b16 v[118:119], v32 offset:34816
  v_mfma_f32_16x16x32_bf16 a[72:75], v[148:151], v[84:87], a[72:75]
  s_add_u32 m0, s53, 2048
  v_mfma_f32_16x16x32_bf16 a[76:79], v[152:155], v[84:87], a[76:79]
  buffer_load_dwordx4 v12, s[12:15], s21 offen  lds
  ds_read_b128 v[56:59], v20 offset:6144
  v_mfma_f32_16x16x32_bf16 a[80:83], v[156:159], v[84:87], a[80:83]
  v_mfma_f32_16x16x32_bf16 a[84:87], v[160:163], v[84:87], a[84:87]
  ds_read_b64_tr_b16 v[120:121], v33 offset:32768
  v_mfma_f32_16x16x32_bf16 a[88:91], v[164:167], v[84:87], a[88:91]
  s_add_u32 m0, s52, 3072
  v_mfma_f32_16x16x32_bf16 a[92:95], v[168:171], v[84:87], a[92:95]
  buffer_load_dwordx4 v5, s[8:11], s20 offen  lds
  ds_read_b64_tr_b16 v[122:123], v33 offset:34816
  v_mfma_f32_16x16x32_bf16 a[96:99], v[140:143], v[88:91], a[96:99]
  v_mfma_f32_16x16x32_bf16 a[100:103], v[144:147], v[88:91], a[100:103]
  ds_read_b128 v[60:63], v20 offset:8192
  s_add_u32 m0, s53, 3072
  v_mfma_f32_16x16x32_bf16 a[104:107], v[148:151], v[88:91], a[104:107]
  buffer_load_dwordx4 v13, s[12:15], s21 offen  lds
  v_mfma_f32_16x16x32_bf16 a[108:111], v[152:155], v[88:91], a[108:111]
  ds_read_b64_tr_b16 v[124:125], v34 offset:32768
  v_mfma_f32_16x16x32_bf16 a[112:115], v[156:159], v[88:91], a[112:115]
  v_mfma_f32_16x16x32_bf16 a[116:119], v[160:163], v[88:91], a[116:119]
  ds_read_b64_tr_b16 v[126:127], v34 offset:34816
  s_add_u32 m0, s52, 4096
  v_mfma_f32_16x16x32_bf16 a[120:123], v[164:167], v[88:91], a[120:123]
  buffer_load_dwordx4 v6, s[8:11], s20 offen  lds
  v_mfma_f32_16x16x32_bf16 a[124:127], v[168:171], v[88:91], a[124:127]
  ds_read_b128 v[64:67], v20 offset:10240
  v_mfma_f32_16x16x32_bf16 a[128:131], v[140:143], v[92:95], a[128:131]
  v_mfma_f32_16x16x32_bf16 a[132:135], v[144:147], v[92:95], a[132:135]
  ds_read_b64_tr_b16 v[128:129], v35 offset:32768
  s_add_u32 m0, s53, 4096
  v_mfma_f32_16x16x32_bf16 a[136:139], v[148:151], v[92:95], a[136:139]
  buffer_load_dwordx4 v14, s[12:15], s21 offen  lds
  v_mfma_f32_16x16x32_bf16 a[140:143], v[152:155], v[92:95], a[140:143]
  ds_read_b64_tr_b16 v[130:131], v35 offset:34816
  v_mfma_f32_16x16x32_bf16 a[144:147], v[156:159], v[92:95], a[144:147]
  v_mfma_f32_16x16x32_bf16 a[148:151], v[160:163], v[92:95], a[148:151]
  ds_read_b128 v[68:71], v20 offset:12288
  s_add_u32 m0, s52, 5120
  v_mfma_f32_16x16x32_bf16 a[152:155], v[164:167], v[92:95], a[152:155]
  buffer_load_dwordx4 v7, s[8:11], s20 offen  lds
  v_mfma_f32_16x16x32_bf16 a[156:159], v[168:171], v[92:95], a[156:159]
  ds_read_b64_tr_b16 v[132:133], v36 offset:32768
  v_mfma_f32_16x16x32_bf16 a[160:163], v[140:143], v[96:99], a[160:163]
  s_add_u32 m0, s53, 5120
  v_mfma_f32_16x16x32_bf16 a[164:167], v[144:147], v[96:99], a[164:167]
  buffer_load_dwordx4 v15, s[12:15], s21 offen  lds
  ds_read_b64_tr_b16 v[134:135], v36 offset:34816
  v_mfma_f32_16x16x32_bf16 a[168:171], v[148:151], v[96:99], a[168:171]
  v_mfma_f32_16x16x32_bf16 a[172:175], v[152:155], v[96:99], a[172:175]
  ds_read_b128 v[72:75], v20 offset:14336
  v_mfma_f32_16x16x32_bf16 a[176:179], v[156:159], v[96:99], a[176:179]
  s_add_u32 m0, s52, 6144
  v_mfma_f32_16x16x32_bf16 a[180:183], v[160:163], v[96:99], a[180:183]
  buffer_load_dwordx4 v8, s[8:11], s20 offen  lds
  ds_read_b64_tr_b16 v[136:137], v37 offset:32768
  v_mfma_f32_16x16x32_bf16 a[184:187], v[164:167], v[96:99], a[184:187]
  v_mfma_f32_16x16x32_bf16 a[188:191], v[168:171], v[96:99], a[188:191]
  ds_read_b64_tr_b16 v[138:139], v37 offset:34816
  v_mfma_f32_16x16x32_bf16 a[192:195], v[140:143], v[100:103], a[192:195]
  s_add_u32 m0, s53, 6144
  v_mfma_f32_16x16x32_bf16 a[196:199], v[144:147], v[100:103], a[196:199]
  buffer_load_dwordx4 v16, s[12:15], s21 offen  lds
  v_mfma_f32_16x16x32_bf16 a[200:203], v[148:151], v[100:103], a[200:203]
  v_mfma_f32_16x16x32_bf16 a[204:207], v[152:155], v[100:103], a[204:207]
  s_add_u32 m0, s52, 7168
  v_mfma_f32_16x16x32_bf16 a[208:211], v[156:159], v[100:103], a[208:211]
  buffer_load_dwordx4 v9, s[8:11], s20 offen  lds
  v_mfma_f32_16x16x32_bf16 a[212:215], v[160:163], v[100:103], a[212:215]
  v_mfma_f32_16x16x32_bf16 a[216:219], v[164:167], v[100:103], a[216:219]
  v_mfma_f32_16x16x32_bf16 a[220:223], v[168:171], v[100:103], a[220:223]
  s_add_u32 m0, s53, 7168
  v_mfma_f32_16x16x32_bf16 a[224:227], v[140:143], v[104:107], a[224:227]
  buffer_load_dwordx4 v17, s[12:15], s21 offen  lds
  v_mfma_f32_16x16x32_bf16 a[228:231], v[144:147], v[104:107], a[228:231]
  v_mfma_f32_16x16x32_bf16 a[232:235], v[148:151], v[104:107], a[232:235]
  v_mfma_f32_16x16x32_bf16 a[236:239], v[152:155], v[104:107], a[236:239]
  s_add_u32 s20, s20, 128
  v_mfma_f32_16x16x32_bf16 a[240:243], v[156:159], v[104:107], a[240:243]
  s_add_u32 s21, s21, s51
  v_mfma_f32_16x16x32_bf16 a[244:247], v[160:163], v[104:107], a[244:247]
  v_mfma_f32_16x16x32_bf16 a[248:251], v[164:167], v[104:107], a[248:251]
  v_mfma_f32_16x16x32_bf16 a[252:255], v[168:171], v[104:107], a[252:255]
  s_waitcnt lgkmcnt(0)
  v_mfma_f32_16x16x32_bf16 a[0:3], v[108:111], v[44:47], a[0:3]
  ds_read_b128 v[76:79], v21 offset:0
  v_mfma_f32_16x16x32_bf16 a[4:7], v[112:115], v[44:47], a[4:7]
  v_mfma_f32_16x16x32_bf16 a[8:11], v[116:119], v[44:47], a[8:11]
  ds_read_b64_tr_b16 v[140:141], v30 offset:49152
  v_mfma_f32_16x16x32_bf16 a[12:15], v[120:123], v[44:47], a[12:15]
  v_mfma_f32_16x16x32_bf16 a[16:19], v[124:127], v[44:47], a[16:19]
  ds_read_b64_tr_b16 v[142:143], v30 offset:51200
  v_mfma_f32_16x16x32_bf16 a[20:23], v[128:131], v[44:47], a[20:23]
  v_mfma_f32_16x16x32_bf16 a[24:27], v[132:135], v[44:47], a[24:27]
  ds_read_b128 v[80:83], v21 offset:2048
  v_mfma_f32_16x16x32_bf16 a[28:31], v[136:139], v[44:47], a[28:31]
  v_mfma_f32_16x16x32_bf16 a[32:35], v[108:111], v[48:51], a[32:35]
  ds_read_b64_tr_b16 v[144:145], v31 offset:49152
  v_mfma_f32_16x16x32_bf16 a[36:39], v[112:115], v[48:51], a[36:39]
  v_mfma_f32_16x16x32_bf16 a[40:43], v[116:119], v[48:51], a[40:43]
  ds_read_b64_tr_b16 v[146:147], v31 offset:51200
  v_mfma_f32_16x16x32_bf16 a[44:47], v[120:123], v[48:51], a[44:47]
  v_mfma_f32_16x16x32_bf16 a[48:51], v[124:127], v[48:51], a[48:51]
  ds_read_b128 v[84:87], v21 offset:4096
  v_mfma_f32_16x16x32_bf16 a[52:55], v[128:131], v[48:51], a[52:55]
  v_mfma_f32_16x16x32_bf16 a[56:59], v[132:135], v[48:51], a[56:59]
  ds_read_b64_tr_b16 v[148:149], v32 offset:49152
  v_mfma_f32_16x16x32_bf16 a[60:63], v[136:139], v[48:51], a[60:63]
  v_mfma_f32_16x16x32_bf16 a[64:67], v[108:111], v[52:55], a[64:67]
  ds_read_b64_tr_b16 v[150:151], v32 offset:51200
  v_mfma_f32_16x16x32_bf16 a[68:71], v[112:115], v[52:55], a[68:71]
  v_mfma_f32_16x16x32_bf16 a[72:75], v[116:119], v[52:55], a[72:75]
  ds_read_b128 v[88:91], v21 offset:6144
  v_mfma_f32_16x16x32_bf16 a[76:79], v[120:123], v[52:55], a[76:79]
  v_mfma_f32_16x16x32_bf16 a[80:83], v[124:127], v[52:55], a[80:83]
  ds_read_b64_tr_b16 v[152:153], v33 offset:49152
  v_mfma_f32_16x16x32_bf16 a[84:87], v[128:131], v[52:55], a[84:87]
  v_mfma_f32_16x16x32_bf16 a[88:91], v[132:135], v[52:55], a[88:91]
  ds_read_b64_tr_b16 v[154:155], v33 offset:51200
  v_mfma_f32_16x16x32_bf16 a[92:95], v[136:139], v[52:55], a[92:95]
  v_mfma_f32_16x16x32_bf16 a[96:99], v[108:111], v[56:59], a[96:99]
  ds_read_b128 v[92:95], v21 offset:8192
  v_mfma_f32_16x16x32_bf16 a[100:103], v[112:115], v[56:59], a[100:103]
  v_mfma_f32_16x16x32_bf16 a[104:107], v[116:119], v[56:59], a[104:107]
  ds_read_b64_tr_b16 v[156:157], v34 offset:49152
  v_mfma_f32_16x16x32_bf16 a[108:111], v[120:123], v[56:59], a[108:111]
  v_mfma_f32_16x16x32_bf16 a[112:115], v[124:127], v[56:59], a[112:115]
  ds_read_b64_tr_b16 v[158:159], v34 offset:51200
  v_mfma_f32_16x16x32_bf16 a[116:119], v[128:131], v[56:59], a[116:119]
  v_mfma_f32_16x16x32_bf16 a[120:123], v[132:135], v[56:59], a[120:123]
  ds_read_b128 v[96:99], v21 offset:10240
  v_mfma_f32_16x16x32_bf16 a[124:127], v[136:139], v[56:59], a[124:127]
  v_mfma_f32_16x16x32_bf16 a[128:131], v[108:111], v[60:63], a[128:131]
  ds_read_b64_tr_b16 v[160:161], v35 offset:49152
  v_mfma_f32_16x16x32_bf16 a[132:135], v[112:115], v[60:63], a[132:135]
  v_mfma_f32_16x16x32_bf16 a[136:139], v[116:119], v[60:63], a[136:139]
  ds_read_b64_tr_b16 v[162:163], v35 offset:51200
  v_mfma_f32_16x16x32_bf16 a[140:143], v[120:123], v[60:63], a[140:143]
  v_mfma_f32_16x16x32_bf16 a[144:147], v[124:127], v[60:63], a[144:147]
  ds_read_b128 v[100:103], v21 offset:12288
  v_mfma_f32_16x16x32_bf16 a[148:151], v[128:131], v[60:63], a[148:151]
  v_mfma_f32_16x16x32_bf16 a[152:155], v[132:135], v[60:63], a[152:155]
  ds_read_b64_tr_b16 v[164:165], v36 offset:49152
  v_mfma_f32_16x16x32_bf16 a[156:159], v[136:139], v[60:63], a[156:159]
  v_mfma_f32_16x16x32_bf16 a[160:163], v[108:111], v[64:67], a[160:163]
  ds_read_b64_tr_b16 v[166:167], v36 offset:51200
  v_mfma_f32_16x16x32_bf16 a[164:167], v[112:115], v[64:67], a[164:167]
  v_mfma_f32_16x16x32_bf16 a[168:171], v[116:119], v[64:67], a[168:171]
  ds_read_b128 v[104:107], v21 offset:14336
  v_mfma_f32_16x16x32_bf16 a[172:175], v[120:123], v[64:67], a[172:175]
  v_mfma_f32_16x16x32_bf16 a[176:179], v[124:127], v[64:67], a[176:179]
  ds_read_b64_tr_b16 v[168:169], v37 offset:49152
  v_mfma_f32_16x16x32_bf16 a[180:183], v[128:131], v[64:67], a[180:183]
  v_mfma_f32_16x16x32_bf16 a[184:187], v[132:135], v[64:67], a[184:187]
  ds_read_b64_tr_b16 v[170:171], v37 offset:51200
  v_mfma_f32_16x16x32_bf16 a[188:191], v[136:139], v[64:67], a[188:191]
  v_mfma_f32_16x16x32_bf16 a[192:195], v[108:111], v[68:71], a[192:195]
  v_mfma_f32_16x16x32_bf16 a[196:199], v[112:115], v[68:71], a[196:199]
  v_mfma_f32_16x16x32_bf16 a[200:203], v[116:119], v[68:71], a[200:203]
  v_mfma_f32_16x16x32_bf16 a[204:207], v[120:123], v[68:71], a[204:207]
  v_mfma_f32_16x16x32_bf16 a[208:211], v[124:127], v[68:71], a[208:211]
  v_mfma_f32_16x16x32_bf16 a[212:215], v[128:131], v[68:71], a[212:215]
  v_mfma_f32_16x16x32_bf16 a[216:219], v[132:135], v[68:71], a[216:219]
  v_mfma_f32_16x16x32_bf16 a[220:223], v[136:139], v[68:71], a[220:223]
  v_mfma_f32_16x16x32_bf16 a[224:227], v[108:111], v[72:75], a[224:227]
  v_mfma_f32_16x16x32_bf16 a[228:231], v[112:115], v[72:75], a[228:231]
  v_mfma_f32_16x16x32_bf16 a[232:235], v[116:119], v[72:75], a[232:235]
  v_mfma_f32_16x16x32_bf16 a[236:239], v[120:123], v[72:75], a[236:239]
  v_mfma_f32_16x16x32_bf16 a[240:243], v[124:127], v[72:75], a[240:243]
  v_mfma_f32_16x16x32_bf16 a[244:247], v[128:131], v[72:75], a[244:247]
  v_mfma_f32_16x16x32_bf16 a[248:251], v[132:135], v[72:75], a[248:251]
  v_mfma_f32_16x16x32_bf16 a[252:255], v[136:139], v[72:75], a[252:255]
  s_waitcnt lgkmcnt(0)
  v_mfma_f32_16x16x32_bf16 a[0:3], v[140:143], v[76:79], a[0:3]
  s_waitcnt vmcnt(0)
  s_barrier
  s_add_u32 m0, s52, 65536
  v_mfma_f32_16x16x32_bf16 a[4:7], v[144:147], v[76:79], a[4:7]
  buffer_load_dwordx4 v2, s[8:11], s20 offen  lds
  ds_read_b128 v[44:47], v18 offset:0
  v_mfma_f32_16x16x32_bf16 a[8:11], v[148:151], v[76:79], a[8:11]
  v_mfma_f32_16x16x32_bf16 a[12:15], v[152:155], v[76:79], a[12:15]
  ds_read_b64_tr_b16 v[108:109], v22 offset:32768
  s_add_u32 m0, s53, 65536
  v_mfma_f32_16x16x32_bf16 a[16:19], v[156:159], v[76:79], a[16:19]
  buffer_load_dwordx4 v10, s[12:15], s21 offen  lds
  v_mfma_f32_16x16x32_bf16 a[20:23], v[160:163], v[76:79], a[20:23]
  ds_read_b64_tr_b16 v[110:111], v22 offset:34816
  v_mfma_f32_16x16x32_bf16 a[24:27], v[164:167], v[76:79], a[24:27]
  v_mfma_f32_16x16x32_bf16 a[28:31], v[168:171], v[76:79], a[28:31]
  ds_read_b128 v[48:51], v18 offset:2048
  s_add_u32 m0, s52, 66560
  v_mfma_f32_16x16x32_bf16 a[32:35], v[140:143], v[80:83], a[32:35]
  buffer_load_dwordx4 v3, s[8:11], s20 offen  lds
  v_mfma_f32_16x16x32_bf16 a[36:39], v[144:147], v[80:83], a[36:39]
  ds_read_b64_tr_b16 v[112:113], v23 offset:32768
  v_mfma_f32_16x16x32_bf16 a[40:43], v[148:151], v[80:83], a[40:43]
  v_mfma_f32_16x16x32_bf16 a[44:47], v[152:155], v[80:83], a[44:47]
  ds_read_b64_tr_b16 v[114:115], v23 offset:34816
  s_add_u32 m0, s53, 66560
  v_mfma_f32_16x16x32_bf16 a[48:51], v[156:159], v[80:83], a[48:51]
  buffer_load_dwordx4 v11, s[12:15], s21 offen  lds
  v_mfma_f32_16x16x32_bf16 a[52:55], v[160:163], v[80:83], a[52:55]
  ds_read_b128 v[52:55], v18 offset:4096
  v_mfma_f32_16x16x32_bf16 a[56:59], v[164:167], v[80:83], a[56:59]
  s_add_u32 m0, s52, 67584
  v_mfma_f32_16x16x32_bf16 a[60:63], v[168:171], v[80:83], a[60:63]
  buffer_load_dwordx4 v4, s[8:11], s20 offen  lds
  ds_read_b64_tr_b16 v[116:117], v24 offset:32768
  v_mfma_f32_16x16x32_bf16 a[64:67], v[140:143], v[84:87], a[64:67]
  v_mfma_f32_16x16x32_bf16 a[68:71], v[144:147], v[84:87], a[68:71]
  ds_read_b64_tr_b16 v[118:119], v24 offset:34816
  v_mfma_f32_16x16x32_bf16 a[72:75], v[148:151], v[84:87], a[72:75]
  s_add_u32 m0, s53, 67584
  v_mfma_f32_16x16x32_bf16 a[76:79], v[152:155], v[84:87], a[76:79]
  buffer_load_dwordx4 v12, s[12:15], s21 offen  lds
  ds_read_b128 v[56:59], v18 offset:6144
  v_mfma_f32_16x16x32_bf16 a[80:83], v[156:159], v[84:87], a[80:83]
  v_mfma_f32_16x16x32_bf16 a[84:87], v[160:163], v[84:87], a[84:87]
  ds_read_b64_tr_b16 v[120:121], v25 offset:32768
  v_mfma_f32_16x16x32_bf16 a[88:91], v[164:167], v[84:87], a[88:91]
  s_add_u32 m0, s52, 68608
  v_mfma_f32_16x16x32_bf16 a[92:95], v[168:171], v[84:87], a[92:95]
  buffer_load_dwordx4 v5, s[8:11], s20 offen  lds
  ds_read_b64_tr_b16 v[122:123], v25 offset:34816
  v_mfma_f32_16x16x32_bf16 a[96:99], v[140:143], v[88:91], a[96:99]
  v_mfma_f32_16x16x32_bf16 a[100:103], v[144:147], v[88:91], a[100:103]
  ds_read_b128 v[60:63], v18 offset:8192
  s_add_u32 m0, s53, 68608
  v_mfma_f32_16x16x32_bf16 a[104:107], v[148:151], v[88:91], a[104:107]
  buffer_load_dwordx4 v13, s[12:15], s21 offen  lds
  v_mfma_f32_16x16x32_bf16 a[108:111], v[152:155], v[88:91], a[108:111]
  ds_read_b64_tr_b16 v[124:125], v26 offset:32768
  v_mfma_f32_16x16x32_bf16 a[112:115], v[156:159], v[88:91], a[112:115]
  v_mfma_f32_16x16x32_bf16 a[116:119], v[160:163], v[88:91], a[116:119]
  ds_read_b64_tr_b16 v[126:127], v26 offset:34816
  s_add_u32 m0, s52, 69632
  v_mfma_f32_16x16x32_bf16 a[120:123], v[164:167], v[88:91], a[120:123]
  buffer_load_dwordx4 v6, s[8:11], s20 offen  lds
  v_mfma_f32_16x16x32_bf16 a[124:127], v[168:171], v[88:91], a[124:127]
  ds_read_b128 v[64:67], v18 offset:10240
  v_mfma_f32_16x16x32_bf16 a[128:131], v[140:143], v[92:95], a[128:131]
  v_mfma_f32_16x16x32_bf16 a[132:135], v[144:147], v[92:95], a[132:135]
  ds_read_b64_tr_b16 v[128:129], v27 offset:32768
  s_add_u32 m0, s53, 69632
  v_mfma_f32_16x16x32_bf16 a[136:139], v[148:151], v[92:95], a[136:139]
  buffer_load_dwordx4 v14, s[12:15], s21 offen  lds
  v_mfma_f32_16x16x32_bf16 a[140:143], v[152:155], v[92:95], a[140:143]
  ds_read_b64_tr_b16 v[130:131], v27 offset:34816
  v_mfma_f32_16x16x32_bf16 a[144:147], v[156:159], v[92:95], a[144:147]
  v_mfma_f32_16x16x32_bf16 a[148:151], v[160:163], v[92:95], a[148:151]
  ds_read_b128 v[68:71], v18 offset:12288
  s_add_u32 m0, s52, 70656
  v_mfma_f32_16x16x32_bf16 a[152:155], v[164:167], v[92:95], a[152:155]
  buffer_load_dwordx4 v7, s[8:11], s20 offen  lds
  v_mfma_f32_16x16x32_bf16 a[156:159], v[168:171], v[92:95], a[156:159]
  ds_read_b64_tr_b16 v[132:133], v28 offset:32768
  v_mfma_f32_16x16x32_bf16 a[160:163], v[140:143], v[96:99], a[160:163]
  s_add_u32 m0, s53, 70656
  v_mfma_f32_16x16x32_bf16 a[164:167], v[144:147], v[96:99], a[164:167]
  buffer_load_dwordx4 v15, s[12:15], s21 offen  lds
  ds_read_b64_tr_b16 v[134:135], v28 offset:34816
  v_mfma_f32_16x16x32_bf16 a[168:171], v[148:151], v[96:99], a[168:171]
  v_mfma_f32_16x16x32_bf16 a[172:175], v[152:155], v[96:99], a[172:175]
  ds_read_b128 v[72:75], v18 offset:14336
  v_mfma_f32_16x16x32_bf16 a[176:179], v[156:159], v[96:99], a[176:179]
  s_add_u32 m0, s52, 71680
  v_mfma_f32_16x16x32_bf16 a[180:183], v[160:163], v[96:99], a[180:183]
  buffer_load_dwordx4 v8, s[8:11], s20 offen  lds
  ds_read_b64_tr_b16 v[136:137], v29 offset:32768
  v_mfma_f32_16x16x32_bf16 a[184:187], v[164:167], v[96:99], a[184:187]
  v_mfma_f32_16x16x32_bf16 a[188:191], v[168:171], v[96:99], a[188:191]
  ds_read_b64_tr_b16 v[138:139], v29 offset:34816
  v_mfma_f32_16x16x32_bf16 a[192:195], v[140:143], v[100:103], a[192:195]
  s_add_u32 m0, s53, 71680
  v_mfma_f32_16x16x32_bf16 a[196:199], v[144:147], v[100:103], a[196:199]
  buffer_load_dwordx4 v16, s[12:15], s21 offen  lds
  v_mfma_f32_16x16x32_bf16 a[200:203], v[148:151], v[100:103], a[200:203]
  v_mfma_f32_16x16x32_bf16 a[204:207], v[152:155], v[100:103], a[204:207]
  s_add_u32 m0, s52, 72704
  v_mfma_f32_16x16x32_bf16 a[208:211], v[156:159], v[100:103], a[208:211]
  buffer_load_dwordx4 v9, s[8:11], s20 offen  lds
  v_mfma_f32_16x16x32_bf16 a[212:215], v[160:163], v[100:103], a[212:215]
  v_mfma_f32_16x16x32_bf16 a[216:219], v[164:167], v[100:103], a[216:219]
  v_mfma_f32_16x16x32_bf16 a[220:223], v[168:171], v[100:103], a[220:223]
  s_add_u32 m0, s53, 72704
  v_mfma_f32_16x16x32_bf16 a[224:227], v[140:143], v[104:107], a[224:227]
  buffer_load_dwordx4 v17, s[12:15], s21 offen  lds
  v_mfma_f32_16x16x32_bf16 a[228:231], v[144:147], v[104:107], a[228:231]
  v_mfma_f32_16x16x32_bf16 a[232:235], v[148:151], v[104:107], a[232:235]
  v_mfma_f32_16x16x32_bf16 a[236:239], v[152:155], v[104:107], a[236:239]
  s_add_u32 s20, s20, 128
  v_mfma_f32_16x16x32_bf16 a[240:243], v[156:159], v[104:107], a[240:243]
  s_add_u32 s21, s21, s51
  v_mfma_f32_16x16x32_bf16 a[244:247], v[160:163], v[104:107], a[244:247]
  v_mfma_f32_16x16x32_bf16 a[248:251], v[164:167], v[104:107], a[248:251]
  v_mfma_f32_16x16x32_bf16 a[252:255], v[168:171], v[104:107], a[252:255]
L_g1_loop:
  s_sub_u32 s25, s25, 1
  s_cmp_eq_u32 s25, 0
  s_cbranch_scc1 L_g1_fin
  s_waitcnt lgkmcnt(0)
  v_mfma_f32_16x16x32_bf16 a[0:3], v[108:111], v[44:47], a[0:3]
  ds_read_b128 v[76:79], v19 offset:0
  v_mfma_f32_16x16x32_bf16 a[4:7], v[112:115], v[44:47], a[4:7]
  v_mfma_f32_16x16x32_bf16 a[8:11], v[116:119], v[44:47], a[8:11]
  ds_read_b64_tr_b16 v[140:141], v22 offset:49152
  v_mfma_f32_16x16x32_bf16 a[12:15], v[120:123], v[44:47], a[12:15]
  v_mfma_f32_16x16x32_bf16 a[16:19], v[124:127], v[44:47], a[16:19]
  ds_read_b64_tr_b16 v[142:143], v22 offset:51200
  v_mfma_f32_16x16x32_bf16 a[20:23], v[128:131], v[44:47], a[20:23]
  v_mfma_f32_16x16x32_bf16 a[24:27], v[132:135], v[44:47], a[24:27]
  ds_read_b128 v[80:83], v19 offset:2048
  v_mfma_f32_16x16x32_bf16 a[28:31], v[136:139], v[44:47], a[28:31]
  v_mfma_f32_16x16x32_bf16 a[32:35], v[108:111], v[48:51], a[32:35]
  ds_read_b64_tr_b16 v[144:145], v23 offset:49152
  v_mfma_f32_16x16x32_bf16 a[36:39], v[112:115], v[48:51], a[36:39]
  v_mfma_f32_16x16x32_bf16 a[40:43], v[116:119], v[48:51], a[40:43]
  ds_read_b64_tr_b16 v[146:147], v23 offset:51200
  v_mfma_f32_16x16x32_bf16 a[44:47], v[120:123], v[48:51], a[44:47]
  v_mfma_f32_16x16x32_bf16 a[48:51], v[124:127], v[48:51], a[48:51]
  ds_read_b128 v[84:87], v19 offset:4096
  v_mfma_f32_16x16x32_bf16 a[52:55], v[128:131], v[48:51], a[52:55]
  v_mfma_f32_16x16x32_bf16 a[56:59], v[132:135], v[48:51], a[56:59]
  ds_read_b64_tr_b16 v[148:149], v24 offset:49152
  v_mfma_f32_16x16x32_bf16 a[60:63], v[136:139], v[48:51], a[60:63]
  v_mfma_f32_16x16x32_bf16 a[64:67], v[108:111], v[52:55], a[64:67]
  ds_read_b64_tr_b16 v[150:151], v24 offset:51200
  v_mfma_f32_16x16x32_bf16 a[68:71], v[112:115], v[52:55], a[68:71]
  v_mfma_f32_16x16x32_bf16 a[72:75], v[116:119], v[52:55], a[72:75]
  ds_read_b128 v[88:91], v19 offset:6144
  v_mfma_f32_16x16x32_bf16 a[76:79], v[120:123], v[52:55], a[76:79]
  v_mfma_f32_16x16x32_bf16 a[80:83], v[124:127], v[52:55], a[80:83]
  ds_read_b64_tr_b16 v[152:153], v25 offset:49152
  v_mfma_f32_16x16x32_bf16 a[84:87], v[128:131], v[52:55], a[84:87]
  v_mfma_f32_16x16x32_bf16 a[88:91], v[132:135], v[52:55], a[88:91]
  ds_read_b64_tr_b16 v[154:155], v25 offset:51200
  v_mfma_f32_16x16x32_bf16 a[92:95], v[136:139], v[52:55], a[92:95]
  v_mfma_f32_16x16x32_bf16 a[96:99], v[108:111], v[56:59], a[96:99]
  ds_read_b128 v[92:95], v19 offset:8192
  v_mfma_f32_16x16x32_bf16 a[100:103], v[112:115], v[56:59], a[100:103]
  v_mfma_f32_16x16x32_bf16 a[104:107], v[116:119], v[56:59], a[104:107]
  ds_read_b64_tr_b16 v[156:157], v26 offset:49152
  v_mfma_f32_16x16x32_bf16 a[108:111], v[120:123], v[56:59], a[108:111]
  v_mfma_f32_16x16x32_bf16 a[112:115], v[124:127], v[56:59], a[112:115]
  ds_read_b64_tr_b16 v[158:159], v26 offset:51200
  v_mfma_f32_16x16x32_bf16 a[116:119], v[128:131], v[56:59], a[116:119]
  v_mfma_f32_16x16x32_bf16 a[120:123], v[132:135], v[56:59], a[120:123]
  ds_read_b128 v[96:99], v19 offset:10240
  v_mfma_f32_16x16x32_bf16 a[124:127], v[136:139], v[56:59], a[124:127]
  v_mfma_f32_16x16x32_bf16 a[128:131], v[108:111], v[60:63], a[128:131]
  ds_read_b64_tr_b16 v[160:161], v27 offset:49152
  v_mfma_f32_16x16x32_bf16 a[132:135], v[112:115], v[60:63], a[132:135]
  v_mfma_f32_16x16x32_bf16 a[136:139], v[116:119], v[60:63], a[136:139]
  ds_read_b64_tr_b16 v[162:163], v27 offset:51200
  v_mfma_f32_16x16x32_bf16 a[140:143], v[120:123], v[60:63], a[140:143]
  v_mfma_f32_16x16x32_bf16 a[144:147], v[124:127], v[60:63], a[144:147]
  ds_read_b128 v[100:103], v19 offset:12288
  v_mfma_f32_16x16x32_bf16 a[148:151], v[128:131], v[60:63], a[148:151]
  v_mfma_f32_16x16x32_bf16 a[152:155], v[132:135], v[60:63], a[152:155]
  ds_read_b64_tr_b16 v[164:165], v28 offset:49152
  v_mfma_f32_16x16x32_bf16 a[156:159], v[136:139], v[60:63], a[156:159]
  v_mfma_f32_16x16x32_bf16 a[160:163], v[108:111], v[64:67], a[160:163]
  ds_read_b64_tr_b16 v[166:167], v28 offset:51200
  v_mfma_f32_16x16x32_bf16 a[164:167], v[112:115], v[64:67], a[164:167]
  v_mfma_f32_16x16x32_bf16 a[168:171], v[116:119], v[64:67], a[168:171]
  ds_read_b128 v[104:107], v19 offset:14336
  v_mfma_f32_16x16x32_bf16 a[172:175], v[120:123], v[64:67], a[172:175]
  v_mfma_f32_16x16x32_bf16 a[176:179], v[124:127], v[64:67], a[176:179]
  ds_read_b64_tr_b16 v[168:169], v29 offset:49152
  v_mfma_f32_16x16x32_bf16 a[180:183], v[128:131], v[64:67], a[180:183]
  v_mfma_f32_16x16x32_bf16 a[184:187], v[132:135], v[64:67], a[184:187]
  ds_read_b64_tr_b16 v[170:171], v29 offset:51200
  v_mfma_f32_16x16x32_bf16 a[188:191], v[136:139], v[64:67], a[188:191]
  v_mfma_f32_16x16x32_bf16 a[192:195], v[108:111], v[68:71], a[192:195]
  v_mfma_f32_16x16x32_bf16 a[196:199], v[112:115], v[68:71], a[196:199]
  v_mfma_f32_16x16x32_bf16 a[200:203], v[116:119], v[68:71], a[200:203]
  v_mfma_f32_16x16x32_bf16 a[204:207], v[120:123], v[68:71], a[204:207]
  v_mfma_f32_16x16x32_bf16 a[208:211], v[124:127], v[68:71], a[208:211]
  v_mfma_f32_16x16x32_bf16 a[212:215], v[128:131], v[68:71], a[212:215]
  v_mfma_f32_16x16x32_bf16 a[216:219], v[132:135], v[68:71], a[216:219]
  v_mfma_f32_16x16x32_bf16 a[220:223], v[136:139], v[68:71], a[220:223]
  v_mfma_f32_16x16x32_bf16 a[224:227], v[108:111], v[72:75], a[224:227]
  v_mfma_f32_16x16x32_bf16 a[228:231], v[112:115], v[72:75], a[228:231]
  v_mfma_f32_16x16x32_bf16 a[232:235], v[116:119], v[72:75], a[232:235]
  v_mfma_f32_16x16x32_bf16 a[236:239], v[120:123], v[72:75], a[236:239]
  v_mfma_f32_16x16x32_bf16 a[240:243], v[124:127], v[72:75], a[240:243]
  v_mfma_f32_16x16x32_bf16 a[244:247], v[128:131], v[72:75], a[244:247]
  v_mfma_f32_16x16x32_bf16 a[248:251], v[132:135], v[72:75], a[248:251]
  v_mfma_f32_16x16x32_bf16 a[252:255], v[136:139], v[72:75], a[252:255]
  s_waitcnt lgkmcnt(0)
  v_mfma_f32_16x16x32_bf16 a[0:3], v[140:143], v[76:79], a[0:3]
  s_waitcnt vmcnt(0)
  s_barrier
  s_add_u32 m0, s52, 0
  v_mfma_f32_16x16x32_bf16 a[4:7], v[144:147], v[76:79], a[4:7]
  buffer_load_dwordx4 v2, s[8:11], s20 offen  lds
  ds_read_b128 v[44:47], v20 offset:0
  v_mfma_f32_16x16x32_bf16 a[8:11], v[148:151], v[76:79], a[8:11]
  v_mfma_f32_16x16x32_bf16 a[12:15], v[152:155], v[76:79], a[12:15]
  ds_read_b64_tr_b16 v[108:109], v30 offset:32768
  s_add_u32 m0, s53, 0
  v_mfma_f32_16x16x32_bf16 a[16:19], v[156:159], v[76:79], a[16:19]
  buffer_load_dwordx4 v10, s[12:15], s21 offen  lds
  v_mfma_f32_16x16x32_bf16 a[20:23], v[160:163], v[76:79], a[20:23]
  ds_read_b64_tr_b16 v[110:111], v30 offset:34816
  v_mfma_f32_16x16x32_bf16 a[24:27], v[164:167], v[76:79], a[24:27]
  v_mfma_f32_16x16x32_bf16 a[28:31], v[168:171], v[76:79], a[28:31]
  ds_read_b128 v[48:51], v20 offset:2048
  s_add_u32 m0, s52, 1024
  v_mfma_f32_16x16x32_bf16 a[32:35], v[140:143], v[80:83], a[32:35]
  buffer_load_dwordx4 v3, s[8:11], s20 offen  lds
  v_mfma_f32_16x16x32_bf16 a[36:39], v[144:147], v[80:83], a[36:39]
  ds_read_b64_tr_b16 v[112:113], v31 offset:32768
  v_mfma_f32_16x16x32_bf16 a[40:43], v[148:151], v[80:83], a[40:43]
  v_mfma_f32_16x16x32_bf16 a[44:47], v[152:155], v[80:83], a[44:47]
  ds_read_b64_tr_b16 v[114:115], v31 offset:34816
  s_add_u32 m0, s53, 1024
  v_mfma_f32_16x16x32_bf16 a[48:51], v[156:159], v[80:83], a[48:51]
  buffer_load_dwordx4 v11, s[12:15], s21 offen  lds
  v_mfma_f32_16x16x32_bf16 a[52:55], v[160:163], v[80:83], a[52:55]
  ds_read_b128 v[52:55], v20 offset:4096
  v_mfma_f32_16x16x32_bf16 a[56:59], v[164:167], v[80:83], a[56:59]
  s_add_u32 m0, s52, 2048
  v_mfma_f32_16x16x32_bf16 a[60:63], v[168:171], v[80:83], a[60:63]
  buffer_load_dwordx4 v4, s[8:11], s20 offen  lds
  ds_read_b64_tr_b16 v[116:117], v32 offset:32768
  v_mfma_f32_16x16x32_bf16 a[64:67], v[140:143], v[84:87], a[64:67]
  v_mfma_f32_16x16x32_bf16 a[68:71], v[144:147], v[84:87], a[68:71]
  ds_read_b64_tr_b16 v[118:119], v32 offset:34816
  v_mfma_f32_16x16x32_bf16 a[72:75], v[148:151], v[84:87], a[72:75]
  s_add_u32 m0, s53, 2048
  v_mfma_f32_16x16x32_bf16 a[76:79], v[152:155], v[84:87], a[76:79]
  buffer_load_dwordx4 v12, s[12:15], s21 offen  lds
  ds_read_b128 v[56:59], v20 offset:6144
  v_mfma_f32_16x16x32_bf16 a[80:83], v[156:159], v[84:87], a[80:83]
  v_mfma_f32_16x16x32_bf16 a[84:87], v[160:163], v[84:87], a[84:87]
  ds_read_b64_tr_b16 v[120:121], v33 offset:32768
  v_mfma_f32_16x16x32_bf16 a[88:91], v[164:167], v[84:87], a[88:91]
  s_add_u32 m0, s52, 3072
  v_mfma_f32_16x16x32_bf16 a[92:95], v[168:171], v[84:87], a[92:95]
  buffer_load_dwordx4 v5, s[8:11], s20 offen  lds
  ds_read_b64_tr_b16 v[122:123], v33 offset:34816
  v_mfma_f32_16x16x32_bf16 a[96:99], v[140:143], v[88:91], a[96:99]
  v_mfma_f32_16x16x32_bf16 a[100:103], v[144:147], v[88:91], a[100:103]
  ds_read_b128 v[60:63], v20 offset:8192
  s_add_u32 m0, s53, 3072
  v_mfma_f32_16x16x32_bf16 a[104:107], v[148:151], v[88:91], a[104:107]
  buffer_load_dwordx4 v13, s[12:15], s21 offen  lds
  v_mfma_f32_16x16x32_bf16 a[108:111], v[152:155], v[88:91], a[108:111]
  ds_read_b64_tr_b16 v[124:125], v34 offset:32768
  v_mfma_f32_16x16x32_bf16 a[112:115], v[156:159], v[88:91], a[112:115]
  v_mfma_f32_16x16x32_bf16 a[116:119], v[160:163], v[88:91], a[116:119]
  ds_read_b64_tr_b16 v[126:127], v34 offset:34816
  s_add_u32 m0, s52, 4096
  v_mfma_f32_16x16x32_bf16 a[120:123], v[164:167], v[88:91], a[120:123]
  buffer_load_dwordx4 v6, s[8:11], s20 offen  lds
  v_mfma_f32_16x16x32_bf16 a[124:127], v[168:171], v[88:91], a[124:127]
  ds_read_b128 v[64:67], v20 offset:10240
  v_mfma_f32_16x16x32_bf16 a[128:131], v[140:143], v[92:95], a[128:131]
  v_mfma_f32_16x16x32_bf16 a[132:135], v[144:147], v[92:95], a[132:135]
  ds_read_b64_tr_b16 v[128:129], v35 offset:32768
  s_add_u32 m0, s53, 4096
  v_mfma_f32_16x16x32_bf16 a[136:139], v[148:151], v[92:95], a[136:139]
  buffer_load_dwordx4 v14, s[12:15], s21 offen  lds
  v_mfma_f32_16x16x32_bf16 a[140:143], v[152:155], v[92:95], a[140:143]
  ds_read_b64_tr_b16 v[130:131], v35 offset:34816
  v_mfma_f32_16x16x32_bf16 a[144:147], v[156:159], v[92:95], a[144:147]
  v_mfma_f32_16x16x32_bf16 a[148:151], v[160:163], v[92:95], a[148:151]
  ds_read_b128 v[68:71], v20 offset:12288
  s_add_u32 m0, s52, 5120
  v_mfma_f32_16x16x32_bf16 a[152:155], v[164:167], v[92:95], a[152:155]
  buffer_load_dwordx4 v7, s[8:11], s20 offen  lds
  v_mfma_f32_16x16x32_bf16 a[156:159], v[168:171], v[92:95], a[156:159]
  ds_read_b64_tr_b16 v[132:133], v36 offset:32768
  v_mfma_f32_16x16x32_bf16 a[160:163], v[140:143], v[96:99], a[160:163]
  s_add_u32 m0, s53, 5120
  v_mfma_f32_16x16x32_bf16 a[164:167], v[144:147], v[96:99], a[164:167]
  buffer_load_dwordx4 v15, s[12:15], s21 offen  lds
  ds_read_b64_tr_b16 v[134:135], v36 offset:34816
  v_mfma_f32_16x16x32_bf16 a[168:171], v[148:151], v[96:99], a[168:171]
  v_mfma_f32_16x16x32_bf16 a[172:175], v[152:155], v[96:99], a[172:175]
  ds_read_b128 v[72:75], v20 offset:14336
  v_mfma_f32_16x16x32_bf16 a[176:179], v[156:159], v[96:99], a[176:179]
  s_add_u32 m0, s52, 6144
  v_mfma_f32_16x16x32_bf16 a[180:183], v[160:163], v[96:99], a[180:183]
  buffer_load_dwordx4 v8, s[8:11], s20 offen  lds
  ds_read_b64_tr_b16 v[136:137], v37 offset:32768
  v_mfma_f32_16x16x32_bf16 a[184:187], v[164:167], v[96:99], a[184:187]
  v_mfma_f32_16x16x32_bf16 a[188:191], v[168:171], v[96:99], a[188:191]
  ds_read_b64_tr_b16 v[138:139], v37 offset:34816
  v_mfma_f32_16x16x32_bf16 a[192:195], v[140:143], v[100:103], a[192:195]
  s_add_u32 m0, s53, 6144
  v_mfma_f32_16x16x32_bf16 a[196:199], v[144:147], v[100:103], a[196:199]
  buffer_load_dwordx4 v16, s[12:15], s21 offen  lds
  v_mfma_f32_16x16x32_bf16 a[200:203], v[148:151], v[100:103], a[200:203]
  v_mfma_f32_16x16x32_bf16 a[204:207], v[152:155], v[100:103], a[204:207]
  s_add_u32 m0, s52, 7168
  v_mfma_f32_16x16x32_bf16 a[208:211], v[156:159], v[100:103], a[208:211]
  buffer_load_dwordx4 v9, s[8:11], s20 offen  lds
  v_mfma_f32_16x16x32_bf16 a[212:215], v[160:163], v[100:103], a[212:215]
  v_mfma_f32_16x16x32_bf16 a[216:219], v[164:167], v[100:103], a[216:219]
  v_mfma_f32_16x16x32_bf16 a[220:223], v[168:171], v[100:103], a[220:223]
  s_add_u32 m0, s53, 7168
  v_mfma_f32_16x16x32_bf16 a[224:227], v[140:143], v[104:107], a[224:227]
  buffer_load_dwordx4 v17, s[12:15], s21 offen  lds
  v_mfma_f32_16x16x32_bf16 a[228:231], v[144:147], v[104:107], a[228:231]
  v_mfma_f32_16x16x32_bf16 a[232:235], v[148:151], v[104:107], a[232:235]
  v_mfma_f32_16x16x32_bf16 a[236:239], v[152:155], v[104:107], a[236:239]
  s_add_u32 s20, s20, 128
  v_mfma_f32_16x16x32_bf16 a[240:243], v[156:159], v[104:107], a[240:243]
  s_add_u32 s21, s21, s51
  v_mfma_f32_16x16x32_bf16 a[244:247], v[160:163], v[104:107], a[244:247]
  v_mfma_f32_16x16x32_bf16 a[248:251], v[164:167], v[104:107], a[248:251]
  v_mfma_f32_16x16x32_bf16 a[252:255], v[168:171], v[104:107], a[252:255]
  s_waitcnt lgkmcnt(0)
  v_mfma_f32_16x16x32_bf16 a[0:3], v[108:111], v[44:47], a[0:3]
  ds_read_b128 v[76:79], v21 offset:0
  v_mfma_f32_16x16x32_bf16 a[4:7], v[112:115], v[44:47], a[4:7]
  v_mfma_f32_16x16x32_bf16 a[8:11], v[116:119], v[44:47], a[8:11]
  ds_read_b64_tr_b16 v[140:141], v30 offset:49152
  v_mfma_f32_16x16x32_bf16 a[12:15], v[120:123], v[44:47], a[12:15]
  v_mfma_f32_16x16x32_bf16 a[16:19], v[124:127], v[44:47], a[16:19]
  ds_read_b64_tr_b16 v[142:143], v30 offset:51200
  v_mfma_f32_16x16x32_bf16 a[20:23], v[128:131], v[44:47], a[20:23]
  v_mfma_f32_16x16x32_bf16 a[24:27], v[132:135], v[44:47], a[24:27]
  ds_read_b128 v[80:83], v21 offset:2048
  v_mfma_f32_16x16x32_bf16 a[28:31], v[136:139], v[44:47], a[28:31]
  v_mfma_f32_16x16x32_bf16 a[32:35], v[108:111], v[48:51], a[32:35]
  ds_read_b64_tr_b16 v[144:145], v31 offset:49152
  v_mfma_f32_16x16x32_bf16 a[36:39], v[112:115], v[48:51], a[36:39]
  v_mfma_f32_16x16x32_bf16 a[40:43], v[116:119], v[48:51], a[40:43]
  ds_read_b64_tr_b16 v[146:147], v31 offset:51200
  v_mfma_f32_16x16x32_bf16 a[44:47], v[120:123], v[48:51], a[44:47]
  v_mfma_f32_16x16x32_bf16 a[48:51], v[124:127], v[48:51], a[48:51]
  ds_read_b128 v[84:87], v21 offset:4096
  v_mfma_f32_16x16x32_bf16 a[52:55], v[128:131], v[48:51], a[52:55]
  v_mfma_f32_16x16x32_bf16 a[56:59], v[132:135], v[48:51], a[56:59]
  ds_read_b64_tr_b16 v[148:149], v32 offset:49152
  v_mfma_f32_16x16x32_bf16 a[60:63], v[136:139], v[48:51], a[60:63]
  v_mfma_f32_16x16x32_bf16 a[64:67], v[108:111], v[52:55], a[64:67]
  ds_read_b64_tr_b16 v[150:151], v32 offset:51200
  v_mfma_f32_16x16x32_bf16 a[68:71], v[112:115], v[52:55], a[68:71]
  v_mfma_f32_16x16x32_bf16 a[72:75], v[116:119], v[52:55], a[72:75]
  ds_read_b128 v[88:91], v21 offset:6144
  v_mfma_f32_16x16x32_bf16 a[76:79], v[120:123], v[52:55], a[76:79]
  v_mfma_f32_16x16x32_bf16 a[80:83], v[124:127], v[52:55], a[80:83]
  ds_read_b64_tr_b16 v[152:153], v33 offset:49152
  v_mfma_f32_16x16x32_bf16 a[84:87], v[128:131], v[52:55], a[84:87]
  v_mfma_f32_16x16x32_bf16 a[88:91], v[132:135], v[52:55], a[88:91]
  ds_read_b64_tr_b16 v[154:155], v33 offset:51200
  v_mfma_f32_16x16x32_bf16 a[92:95], v[136:139], v[52:55], a[92:95]
  v_mfma_f32_16x16x32_bf16 a[96:99], v[108:111], v[56:59], a[96:99]
  ds_read_b128 v[92:95], v21 offset:8192
  v_mfma_f32_16x16x32_bf16 a[100:103], v[112:115], v[56:59], a[100:103]
  v_mfma_f32_16x16x32_bf16 a[104:107], v[116:119], v[56:59], a[104:107]
  ds_read_b64_tr_b16 v[156:157], v34 offset:49152
  v_mfma_f32_16x16x32_bf16 a[108:111], v[120:123], v[56:59], a[108:111]
  v_mfma_f32_16x16x32_bf16 a[112:115], v[124:127], v[56:59], a[112:115]
  ds_read_b64_tr_b16 v[158:159], v34 offset:51200
  v_mfma_f32_16x16x32_bf16 a[116:119], v[128:131], v[56:59], a[116:119]
  v_mfma_f32_16x16x32_bf16 a[120:123], v[132:135], v[56:59], a[120:123]
  ds_read_b128 v[96:99], v21 offset:10240
  v_mfma_f32_16x16x32_bf16 a[124:127], v[136:139], v[56:59], a[124:127]
  v_mfma_f32_16x16x32_bf16 a[128:131], v[108:111], v[60:63], a[128:131]
  ds_read_b64_tr_b16 v[160:161], v35 offset:49152
  v_mfma_f32_16x16x32_bf16 a[132:135], v[112:115], v[60:63], a[132:135]
  v_mfma_f32_16x16x32_bf16 a[136:139], v[116:119], v[60:63], a[136:139]
  ds_read_b64_tr_b16 v[162:163], v35 offset:51200
  v_mfma_f32_16x16x32_bf16 a[140:143], v[120:123], v[60:63], a[140:143]
  v_mfma_f32_16x16x32_bf16 a[144:147], v[124:127], v[60:63], a[144:147]
  ds_read_b128 v[100:103], v21 offset:12288
  v_mfma_f32_16x16x32_bf16 a[148:151], v[128:131], v[60:63], a[148:151]
  v_mfma_f32_16x16x32_bf16 a[152:155], v[132:135], v[60:63], a[152:155]
  ds_read_b64_tr_b16 v[164:165], v36 offset:49152
  v_mfma_f32_16x16x32_bf16 a[156:159], v[136:139], v[60:63], a[156:159]
  v_mfma_f32_16x16x32_bf16 a[160:163], v[108:111], v[64:67], a[160:163]
  ds_read_b64_tr_b16 v[166:167], v36 offset:51200
  v_mfma_f32_16x16x32_bf16 a[164:167], v[112:115], v[64:67], a[164:167]
  v_mfma_f32_16x16x32_bf16 a[168:171], v[116:119], v[64:67], a[168:171]
  ds_read_b128 v[104:107], v21 offset:14336
  v_mfma_f32_16x16x32_bf16 a[172:175], v[120:123], v[64:67], a[172:175]
  v_mfma_f32_16x16x32_bf16 a[176:179], v[124:127], v[64:67], a[176:179]
  ds_read_b64_tr_b16 v[168:169], v37 offset:49152
  v_mfma_f32_16x16x32_bf16 a[180:183], v[128:131], v[64:67], a[180:183]
  v_mfma_f32_16x16x32_bf16 a[184:187], v[132:135], v[64:67], a[184:187]
  ds_read_b64_tr_b16 v[170:171], v37 offset:51200
  v_mfma_f32_16x16x32_bf16 a[188:191], v[136:139], v[64:67], a[188:191]
  v_mfma_f32_16x16x32_bf16 a[192:195], v[108:111], v[68:71], a[192:195]
  v_mfma_f32_16x16x32_bf16 a[196:199], v[112:115], v[68:71], a[196:199]
  v_mfma_f32_16x16x32_bf16 a[200:203], v[116:119], v[68:71], a[200:203]
  v_mfma_f32_16x16x32_bf16 a[204:207], v[120:123], v[68:71], a[204:207]
  v_mfma_f32_16x16x32_bf16 a[208:211], v[124:127], v[68:71], a[208:211]
  v_mfma_f32_16x16x32_bf16 a[212:215], v[128:131], v[68:71], a[212:215]
  v_mfma_f32_16x16x32_bf16 a[216:219], v[132:135], v[68:71], a[216:219]
  v_mfma_f32_16x16x32_bf16 a[220:223], v[136:139], v[68:71], a[220:223]
  v_mfma_f32_16x16x32_bf16 a[224:227], v[108:111], v[72:75], a[224:227]
  v_mfma_f32_16x16x32_bf16 a[228:231], v[112:115], v[72:75], a[228:231]
  v_mfma_f32_16x16x32_bf16 a[232:235], v[116:119], v[72:75], a[232:235]
  v_mfma_f32_16x16x32_bf16 a[236:239], v[120:123], v[72:75], a[236:239]
  v_mfma_f32_16x16x32_bf16 a[240:243], v[124:127], v[72:75], a[240:243]
  v_mfma_f32_16x16x32_bf16 a[244:247], v[128:131], v[72:75], a[244:247]
  v_mfma_f32_16x16x32_bf16 a[248:251], v[132:135], v[72:75], a[248:251]
  v_mfma_f32_16x16x32_bf16 a[252:255], v[136:139], v[72:75], a[252:255]
  s_waitcnt lgkmcnt(0)
  v_mfma_f32_16x16x32_bf16 a[0:3], v[140:143], v[76:79], a[0:3]
  s_waitcnt vmcnt(0)
  s_barrier
  s_add_u32 m0, s52, 65536
  v_mfma_f32_16x16x32_bf16 a[4:7], v[144:147], v[76:79], a[4:7]
  buffer_load_dwordx4 v2, s[8:11], s20 offen  lds
  ds_read_b128 v[44:47], v18 offset:0
  v_mfma_f32_16x16x32_bf16 a[8:11], v[148:151], v[76:79], a[8:11]
  v_mfma_f32_16x16x32_bf16 a[12:15], v[152:155], v[76:79], a[12:15]
  ds_read_b64_tr_b16 v[108:109], v22 offset:32768
  s_add_u32 m0, s53, 65536
  v_mfma_f32_16x16x32_bf16 a[16:19], v[156:159], v[76:79], a[16:19]
  buffer_load_dwordx4 v10, s[12:15], s21 offen  lds
  v_mfma_f32_16x16x32_bf16 a[20:23], v[160:163], v[76:79], a[20:23]
  ds_read_b64_tr_b16 v[110:111], v22 offset:34816
  v_mfma_f32_16x16x32_bf16 a[24:27], v[164:167], v[76:79], a[24:27]
  v_mfma_f32_16x16x32_bf16 a[28:31], v[168:171], v[76:79], a[28:31]
  ds_read_b128 v[48:51], v18 offset:2048
  s_add_u32 m0, s52, 66560
  v_mfma_f32_16x16x32_bf16 a[32:35], v[140:143], v[80:83], a[32:35]
  buffer_load_dwordx4 v3, s[8:11], s20 offen  lds
  v_mfma_f32_16x16x32_bf16 a[36:39], v[144:147], v[80:83], a[36:39]
  ds_read_b64_tr_b16 v[112:113], v23 offset:32768
  v_mfma_f32_16x16x32_bf16 a[40:43], v[148:151], v[80:83], a[40:43]
  v_mfma_f32_16x16x32_bf16 a[44:47], v[152:155], v[80:83], a[44:47]
  ds_read_b64_tr_b16 v[114:115], v23 offset:34816
  s_add_u32 m0, s53, 66560
  v_mfma_f32_16x16x32_bf16 a[48:51], v[156:159], v[80:83], a[48:51]
  buffer_load_dwordx4 v11, s[12:15], s21 offen  lds
  v_mfma_f32_16x16x32_bf16 a[52:55], v[160:163], v[80:83], a[52:55]
  ds_read_b128 v[52:55], v18 offset:4096
  v_mfma_f32_16x16x32_bf16 a[56:59], v[164:167], v[80:83], a[56:59]
  s_add_u32 m0, s52, 67584
  v_mfma_f32_16x16x32_bf16 a[60:63], v[168:171], v[80:83], a[60:63]
  buffer_load_dwordx4 v4, s[8:11], s20 offen  lds
  ds_read_b64_tr_b16 v[116:117], v24 offset:32768
  v_mfma_f32_16x16x32_bf16 a[64:67], v[140:143], v[84:87], a[64:67]
  v_mfma_f32_16x16x32_bf16 a[68:71], v[144:147], v[84:87], a[68:71]
  ds_read_b64_tr_b16 v[118:119], v24 offset:34816
  v_mfma_f32_16x16x32_bf16 a[72:75], v[148:151], v[84:87], a[72:75]
  s_add_u32 m0, s53, 67584
  v_mfma_f32_16x16x32_bf16 a[76:79], v[152:155], v[84:87], a[76:79]
  buffer_load_dwordx4 v12, s[12:15], s21 offen  lds
  ds_read_b128 v[56:59], v18 offset:6144
  v_mfma_f32_16x16x32_bf16 a[80:83], v[156:159], v[84:87], a[80:83]
  v_mfma_f32_16x16x32_bf16 a[84:87], v[160:163], v[84:87], a[84:87]
  ds_read_b64_tr_b16 v[120:121], v25 offset:32768
  v_mfma_f32_16x16x32_bf16 a[88:91], v[164:167], v[84:87], a[88:91]
  s_add_u32 m0, s52, 68608
  v_mfma_f32_16x16x32_bf16 a[92:95], v[168:171], v[84:87], a[92:95]
  buffer_load_dwordx4 v5, s[8:11], s20 offen  lds
  ds_read_b64_tr_b16 v[122:123], v25 offset:34816
  v_mfma_f32_16x16x32_bf16 a[96:99], v[140:143], v[88:91], a[96:99]
  v_mfma_f32_16x16x32_bf16 a[100:103], v[144:147], v[88:91], a[100:103]
  ds_read_b128 v[60:63], v18 offset:8192
  s_add_u32 m0, s53, 68608
  v_mfma_f32_16x16x32_bf16 a[104:107], v[148:151], v[88:91], a[104:107]
  buffer_load_dwordx4 v13, s[12:15], s21 offen  lds
  v_mfma_f32_16x16x32_bf16 a[108:111], v[152:155], v[88:91], a[108:111]
  ds_read_b64_tr_b16 v[124:125], v26 offset:32768
  v_mfma_f32_16x16x32_bf16 a[112:115], v[156:159], v[88:91], a[112:115]
  v_mfma_f32_16x16x32_bf16 a[116:119], v[160:163], v[88:91], a[116:119]
  ds_read_b64_tr_b16 v[126:127], v26 offset:34816
  s_add_u32 m0, s52, 69632
  v_mfma_f32_16x16x32_bf16 a[120:123], v[164:167], v[88:91], a[120:123]
  buffer_load_dwordx4 v6, s[8:11], s20 offen  lds
  v_mfma_f32_16x16x32_bf16 a[124:127], v[168:171], v[88:91], a[124:127]
  ds_read_b128 v[64:67], v18 offset:10240
  v_mfma_f32_16x16x32_bf16 a[128:131], v[140:143], v[92:95], a[128:131]
  v_mfma_f32_16x16x32_bf16 a[132:135], v[144:147], v[92:95], a[132:135]
  ds_read_b64_tr_b16 v[128:129], v27 offset:32768
  s_add_u32 m0, s53, 69632
  v_mfma_f32_16x16x32_bf16 a[136:139], v[148:151], v[92:95], a[136:139]
  buffer_load_dwordx4 v14, s[12:15], s21 offen  lds
  v_mfma_f32_16x16x32_bf16 a[140:143], v[152:155], v[92:95], a[140:143]
  ds_read_b64_tr_b16 v[130:131], v27 offset:34816
  v_mfma_f32_16x16x32_bf16 a[144:147], v[156:159], v[92:95], a[144:147]
  v_mfma_f32_16x16x32_bf16 a[148:151], v[160:163], v[92:95], a[148:151]
  ds_read_b128 v[68:71], v18 offset:12288
  s_add_u32 m0, s52, 70656
  v_mfma_f32_16x16x32_bf16 a[152:155], v[164:167], v[92:95], a[152:155]
  buffer_load_dwordx4 v7, s[8:11], s20 offen  lds
  v_mfma_f32_16x16x32_bf16 a[156:159], v[168:171], v[92:95], a[156:159]
  ds_read_b64_tr_b16 v[132:133], v28 offset:32768
  v_mfma_f32_16x16x32_bf16 a[160:163], v[140:143], v[96:99], a[160:163]
  s_add_u32 m0, s53, 70656
  v_mfma_f32_16x16x32_bf16 a[164:167], v[144:147], v[96:99], a[164:167]
  buffer_load_dwordx4 v15, s[12:15], s21 offen  lds
  ds_read_b64_tr_b16 v[134:135], v28 offset:34816
  v_mfma_f32_16x16x32_bf16 a[168:171], v[148:151], v[96:99], a[168:171]
  v_mfma_f32_16x16x32_bf16 a[172:175], v[152:155], v[96:99], a[172:175]
  ds_read_b128 v[72:75], v18 offset:14336
  v_mfma_f32_16x16x32_bf16 a[176:179], v[156:159], v[96:99], a[176:179]
  s_add_u32 m0, s52, 71680
  v_mfma_f32_16x16x32_bf16 a[180:183], v[160:163], v[96:99], a[180:183]
  buffer_load_dwordx4 v8, s[8:11], s20 offen  lds
  ds_read_b64_tr_b16 v[136:137], v29 offset:32768
  v_mfma_f32_16x16x32_bf16 a[184:187], v[164:167], v[96:99], a[184:187]
  v_mfma_f32_16x16x32_bf16 a[188:191], v[168:171], v[96:99], a[188:191]
  ds_read_b64_tr_b16 v[138:139], v29 offset:34816
  v_mfma_f32_16x16x32_bf16 a[192:195], v[140:143], v[100:103], a[192:195]
  s_add_u32 m0, s53, 71680
  v_mfma_f32_16x16x32_bf16 a[196:199], v[144:147], v[100:103], a[196:199]
  buffer_load_dwordx4 v16, s[12:15], s21 offen  lds
  v_mfma_f32_16x16x32_bf16 a[200:203], v[148:151], v[100:103], a[200:203]
  v_mfma_f32_16x16x32_bf16 a[204:207], v[152:155], v[100:103], a[204:207]
  s_add_u32 m0, s52, 72704
  v_mfma_f32_16x16x32_bf16 a[208:211], v[156:159], v[100:103], a[208:211]
  buffer_load_dwordx4 v9, s[8:11], s20 offen  lds
  v_mfma_f32_16x16x32_bf16 a[212:215], v[160:163], v[100:103], a[212:215]
  v_mfma_f32_16x16x32_bf16 a[216:219], v[164:167], v[100:103], a[216:219]
  v_mfma_f32_16x16x32_bf16 a[220:223], v[168:171], v[100:103], a[220:223]
  s_add_u32 m0, s53, 72704
  v_mfma_f32_16x16x32_bf16 a[224:227], v[140:143], v[104:107], a[224:227]
  buffer_load_dwordx4 v17, s[12:15], s21 offen  lds
  v_mfma_f32_16x16x32_bf16 a[228:231], v[144:147], v[104:107], a[228:231]
  v_mfma_f32_16x16x32_bf16 a[232:235], v[148:151], v[104:107], a[232:235]
  v_mfma_f32_16x16x32_bf16 a[236:239], v[152:155], v[104:107], a[236:239]
  s_add_u32 s20, s20, 128
  v_mfma_f32_16x16x32_bf16 a[240:243], v[156:159], v[104:107], a[240:243]
  s_add_u32 s21, s21, s51
  v_mfma_f32_16x16x32_bf16 a[244:247], v[160:163], v[104:107], a[244:247]
  v_mfma_f32_16x16x32_bf16 a[248:251], v[164:167], v[104:107], a[248:251]
  v_mfma_f32_16x16x32_bf16 a[252:255], v[168:171], v[104:107], a[252:255]
  s_branch L_g1_loop
L_g1_fin:
  s_cmp_lg_u32 s32, 0
  s_cbranch_scc1 L_rq_6
  s_cmp_eq_u32 s39, 0
  s_cbranch_scc1 L_rq_6
  s_lshl_b32 s99, s33, 7
  s_add_u32 s99, s99, 0x3d00200
  v_mov_b32 v244, 1
  v_mov_b32 v245, 0
  s_mov_b64 exec, 1
  buffer_atomic_add v244, v245, s[4:7], s99 offen sc0 sc1
  s_mov_b64 exec, -1
L_rq_6:
  s_waitcnt lgkmcnt(0)
  v_mfma_f32_16x16x32_bf16 a[0:3], v[108:111], v[44:47], a[0:3]
  ds_read_b128 v[76:79], v19 offset:0
  v_mfma_f32_16x16x32_bf16 a[4:7], v[112:115], v[44:47], a[4:7]
  v_mfma_f32_16x16x32_bf16 a[8:11], v[116:119], v[44:47], a[8:11]
  ds_read_b64_tr_b16 v[140:141], v22 offset:49152
  v_mfma_f32_16x16x32_bf16 a[12:15], v[120:123], v[44:47], a[12:15]
  v_mfma_f32_16x16x32_bf16 a[16:19], v[124:127], v[44:47], a[16:19]
  ds_read_b64_tr_b16 v[142:143], v22 offset:51200
  v_mfma_f32_16x16x32_bf16 a[20:23], v[128:131], v[44:47], a[20:23]
  v_mfma_f32_16x16x32_bf16 a[24:27], v[132:135], v[44:47], a[24:27]
  ds_read_b128 v[80:83], v19 offset:2048
  v_mfma_f32_16x16x32_bf16 a[28:31], v[136:139], v[44:47], a[28:31]
  v_mfma_f32_16x16x32_bf16 a[32:35], v[108:111], v[48:51], a[32:35]
  ds_read_b64_tr_b16 v[144:145], v23 offset:49152
  v_mfma_f32_16x16x32_bf16 a[36:39], v[112:115], v[48:51], a[36:39]
  v_mfma_f32_16x16x32_bf16 a[40:43], v[116:119], v[48:51], a[40:43]
  ds_read_b64_tr_b16 v[146:147], v23 offset:51200
  v_mfma_f32_16x16x32_bf16 a[44:47], v[120:123], v[48:51], a[44:47]
  v_mfma_f32_16x16x32_bf16 a[48:51], v[124:127], v[48:51], a[48:51]
  ds_read_b128 v[84:87], v19 offset:4096
  v_mfma_f32_16x16x32_bf16 a[52:55], v[128:131], v[48:51], a[52:55]
  v_mfma_f32_16x16x32_bf16 a[56:59], v[132:135], v[48:51], a[56:59]
  ds_read_b64_tr_b16 v[148:149], v24 offset:49152
  v_mfma_f32_16x16x32_bf16 a[60:63], v[136:139], v[48:51], a[60:63]
  v_mfma_f32_16x16x32_bf16 a[64:67], v[108:111], v[52:55], a[64:67]
  ds_read_b64_tr_b16 v[150:151], v24 offset:51200
  v_mfma_f32_16x16x32_bf16 a[68:71], v[112:115], v[52:55], a[68:71]
  v_mfma_f32_16x16x32_bf16 a[72:75], v[116:119], v[52:55], a[72:75]
  ds_read_b128 v[88:91], v19 offset:6144
  v_mfma_f32_16x16x32_bf16 a[76:79], v[120:123], v[52:55], a[76:79]
  v_mfma_f32_16x16x32_bf16 a[80:83], v[124:127], v[52:55], a[80:83]
  ds_read_b64_tr_b16 v[152:153], v25 offset:49152
  v_mfma_f32_16x16x32_bf16 a[84:87], v[128:131], v[52:55], a[84:87]
  v_mfma_f32_16x16x32_bf16 a[88:91], v[132:135], v[52:55], a[88:91]
  ds_read_b64_tr_b16 v[154:155], v25 offset:51200
  v_mfma_f32_16x16x32_bf16 a[92:95], v[136:139], v[52:55], a[92:95]
  v_mfma_f32_16x16x32_bf16 a[96:99], v[108:111], v[56:59], a[96:99]
  ds_read_b128 v[92:95], v19 offset:8192
  v_mfma_f32_16x16x32_bf16 a[100:103], v[112:115], v[56:59], a[100:103]
  v_mfma_f32_16x16x32_bf16 a[104:107], v[116:119], v[56:59], a[104:107]
  ds_read_b64_tr_b16 v[156:157], v26 offset:49152
  v_mfma_f32_16x16x32_bf16 a[108:111], v[120:123], v[56:59], a[108:111]
  v_mfma_f32_16x16x32_bf16 a[112:115], v[124:127], v[56:59], a[112:115]
  ds_read_b64_tr_b16 v[158:159], v26 offset:51200
  v_mfma_f32_16x16x32_bf16 a[116:119], v[128:131], v[56:59], a[116:119]
  v_mfma_f32_16x16x32_bf16 a[120:123], v[132:135], v[56:59], a[120:123]
  ds_read_b128 v[96:99], v19 offset:10240
  v_mfma_f32_16x16x32_bf16 a[124:127], v[136:139], v[56:59], a[124:127]
  v_mfma_f32_16x16x32_bf16 a[128:131], v[108:111], v[60:63], a[128:131]
  ds_read_b64_tr_b16 v[160:161], v27 offset:49152
  v_mfma_f32_16x16x32_bf16 a[132:135], v[112:115], v[60:63], a[132:135]
  v_mfma_f32_16x16x32_bf16 a[136:139], v[116:119], v[60:63], a[136:139]
  ds_read_b64_tr_b16 v[162:163], v27 offset:51200
  v_mfma_f32_16x16x32_bf16 a[140:143], v[120:123], v[60:63], a[140:143]
  v_mfma_f32_16x16x32_bf16 a[144:147], v[124:127], v[60:63], a[144:147]
  ds_read_b128 v[100:103], v19 offset:12288
  v_mfma_f32_16x16x32_bf16 a[148:151], v[128:131], v[60:63], a[148:151]
  v_mfma_f32_16x16x32_bf16 a[152:155], v[132:135], v[60:63], a[152:155]
  ds_read_b64_tr_b16 v[164:165], v28 offset:49152
  v_mfma_f32_16x16x32_bf16 a[156:159], v[136:139], v[60:63], a[156:159]
  v_mfma_f32_16x16x32_bf16 a[160:163], v[108:111], v[64:67], a[160:163]
  ds_read_b64_tr_b16 v[166:167], v28 offset:51200
  v_mfma_f32_16x16x32_bf16 a[164:167], v[112:115], v[64:67], a[164:167]
  v_mfma_f32_16x16x32_bf16 a[168:171], v[116:119], v[64:67], a[168:171]
  ds_read_b128 v[104:107], v19 offset:14336
  v_mfma_f32_16x16x32_bf16 a[172:175], v[120:123], v[64:67], a[172:175]
  v_mfma_f32_16x16x32_bf16 a[176:179], v[124:127], v[64:67], a[176:179]
  ds_read_b64_tr_b16 v[168:169], v29 offset:49152
  v_mfma_f32_16x16x32_bf16 a[180:183], v[128:131], v[64:67], a[180:183]
  v_mfma_f32_16x16x32_bf16 a[184:187], v[132:135], v[64:67], a[184:187]
  ds_read_b64_tr_b16 v[170:171], v29 offset:51200
  v_mfma_f32_16x16x32_bf16 a[188:191], v[136:139], v[64:67], a[188:191]
  v_mfma_f32_16x16x32_bf16 a[192:195], v[108:111], v[68:71], a[192:195]
  v_mfma_f32_16x16x32_bf16 a[196:199], v[112:115], v[68:71], a[196:199]
  v_mfma_f32_16x16x32_bf16 a[200:203], v[116:119], v[68:71], a[200:203]
  v_mfma_f32_16x16x32_bf16 a[204:207], v[120:123], v[68:71], a[204:207]
  v_mfma_f32_16x16x32_bf16 a[208:211], v[124:127], v[68:71], a[208:211]
  v_mfma_f32_16x16x32_bf16 a[212:215], v[128:131], v[68:71], a[212:215]
  v_mfma_f32_16x16x32_bf16 a[216:219], v[132:135], v[68:71], a[216:219]
  v_mfma_f32_16x16x32_bf16 a[220:223], v[136:139], v[68:71], a[220:223]
  v_mfma_f32_16x16x32_bf16 a[224:227], v[108:111], v[72:75], a[224:227]
  v_mfma_f32_16x16x32_bf16 a[228:231], v[112:115], v[72:75], a[228:231]
  v_mfma_f32_16x16x32_bf16 a[232:235], v[116:119], v[72:75], a[232:235]
  v_mfma_f32_16x16x32_bf16 a[236:239], v[120:123], v[72:75], a[236:239]
  v_mfma_f32_16x16x32_bf16 a[240:243], v[124:127], v[72:75], a[240:243]
  v_mfma_f32_16x16x32_bf16 a[244:247], v[128:131], v[72:75], a[244:247]
  v_mfma_f32_16x16x32_bf16 a[248:251], v[132:135], v[72:75], a[248:251]
  v_mfma_f32_16x16x32_bf16 a[252:255], v[136:139], v[72:75], a[252:255]
  s_waitcnt lgkmcnt(0)
  v_mfma_f32_16x16x32_bf16 a[0:3], v[140:143], v[76:79], a[0:3]
  s_waitcnt vmcnt(0)
  s_barrier
  v_mfma_f32_16x16x32_bf16 a[4:7], v[144:147], v[76:79], a[4:7]
  ds_read_b128 v[44:47], v20 offset:0
  v_mfma_f32_16x16x32_bf16 a[8:11], v[148:151], v[76:79], a[8:11]
  v_mfma_f32_16x16x32_bf16 a[12:15], v[152:155], v[76:79], a[12:15]
  ds_read_b64_tr_b16 v[108:109], v30 offset:32768
  v_mfma_f32_16x16x32_bf16 a[16:19], v[156:159], v[76:79], a[16:19]
  v_mfma_f32_16x16x32_bf16 a[20:23], v[160:163], v[76:79], a[20:23]
  ds_read_b64_tr_b16 v[110:111], v30 offset:34816
  v_mfma_f32_16x16x32_bf16 a[24:27], v[164:167], v[76:79], a[24:27]
  v_mfma_f32_16x16x32_bf16 a[28:31], v[168:171], v[76:79], a[28:31]
  ds_read_b128 v[48:51], v20 offset:2048
  v_mfma_f32_16x16x32_bf16 a[32:35], v[140:143], v[80:83], a[32:35]
  v_mfma_f32_16x16x32_bf16 a[36:39], v[144:147], v[80:83], a[36:39]
  ds_read_b64_tr_b16 v[112:113], v31 offset:32768
  v_mfma_f32_16x16x32_bf16 a[40:43], v[148:151], v[80:83], a[40:43]
  v_mfma_f32_16x16x32_bf16 a[44:47], v[152:155], v[80:83], a[44:47]
  ds_read_b64_tr_b16 v[114:115], v31 offset:34816
  v_mfma_f32_16x16x32_bf16 a[48:51], v[156:159], v[80:83], a[48:51]
  v_mfma_f32_16x16x32_bf16 a[52:55], v[160:163], v[80:83], a[52:55]
  ds_read_b128 v[52:55], v20 offset:4096
  v_mfma_f32_16x16x32_bf16 a[56:59], v[164:167], v[80:83], a[56:59]
  v_mfma_f32_16x16x32_bf16 a[60:63], v[168:171], v[80:83], a[60:63]
  ds_read_b64_tr_b16 v[116:117], v32 offset:32768
  v_mfma_f32_16x16x32_bf16 a[64:67], v[140:143], v[84:87], a[64:67]
  v_mfma_f32_16x16x32_bf16 a[68:71], v[144:147], v[84:87], a[68:71]
  ds_read_b64_tr_b16 v[118:119], v32 offset:34816
  v_mfma_f32_16x16x32_bf16 a[72:75], v[148:151], v[84:87], a[72:75]
  v_mfma_f32_16x16x32_bf16 a[76:79], v[152:155], v[84:87], a[76:79]
  ds_read_b128 v[56:59], v20 offset:6144
  v_mfma_f32_16x16x32_bf16 a[80:83], v[156:159], v[84:87], a[80:83]
  v_mfma_f32_16x16x32_bf16 a[84:87], v[160:163], v[84:87], a[84:87]
  ds_read_b64_tr_b16 v[120:121], v33 offset:32768
  v_mfma_f32_16x16x32_bf16 a[88:91], v[164:167], v[84:87], a[88:91]
  v_mfma_f32_16x16x32_bf16 a[92:95], v[168:171], v[84:87], a[92:95]
  ds_read_b64_tr_b16 v[122:123], v33 offset:34816
  v_mfma_f32_16x16x32_bf16 a[96:99], v[140:143], v[88:91], a[96:99]
  v_mfma_f32_16x16x32_bf16 a[100:103], v[144:147], v[88:91], a[100:103]
  ds_read_b128 v[60:63], v20 offset:8192
  v_mfma_f32_16x16x32_bf16 a[104:107], v[148:151], v[88:91], a[104:107]
  v_mfma_f32_16x16x32_bf16 a[108:111], v[152:155], v[88:91], a[108:111]
  ds_read_b64_tr_b16 v[124:125], v34 offset:32768
  v_mfma_f32_16x16x32_bf16 a[112:115], v[156:159], v[88:91], a[112:115]
  v_mfma_f32_16x16x32_bf16 a[116:119], v[160:163], v[88:91], a[116:119]
  ds_read_b64_tr_b16 v[126:127], v34 offset:34816
  v_mfma_f32_16x16x32_bf16 a[120:123], v[164:167], v[88:91], a[120:123]
  v_mfma_f32_16x16x32_bf16 a[124:127], v[168:171], v[88:91], a[124:127]
  ds_read_b128 v[64:67], v20 offset:10240
  v_mfma_f32_16x16x32_bf16 a[128:131], v[140:143], v[92:95], a[128:131]
  v_mfma_f32_16x16x32_bf16 a[132:135], v[144:147], v[92:95], a[132:135]
  ds_read_b64_tr_b16 v[128:129], v35 offset:32768
  v_mfma_f32_16x16x32_bf16 a[136:139], v[148:151], v[92:95], a[136:139]
  v_mfma_f32_16x16x32_bf16 a[140:143], v[152:155], v[92:95], a[140:143]
  ds_read_b64_tr_b16 v[130:131], v35 offset:34816
  v_mfma_f32_16x16x32_bf16 a[144:147], v[156:159], v[92:95], a[144:147]
  v_mfma_f32_16x16x32_bf16 a[148:151], v[160:163], v[92:95], a[148:151]
  ds_read_b128 v[68:71], v20 offset:12288
  v_mfma_f32_16x16x32_bf16 a[152:155], v[164:167], v[92:95], a[152:155]
  v_mfma_f32_16x16x32_bf16 a[156:159], v[168:171], v[92:95], a[156:159]
  ds_read_b64_tr_b16 v[132:133], v36 offset:32768
  v_mfma_f32_16x16x32_bf16 a[160:163], v[140:143], v[96:99], a[160:163]
  v_mfma_f32_16x16x32_bf16 a[164:167], v[144:147], v[96:99], a[164:167]
  ds_read_b64_tr_b16 v[134:135], v36 offset:34816
  v_mfma_f32_16x16x32_bf16 a[168:171], v[148:151], v[96:99], a[168:171]
  v_mfma_f32_16x16x32_bf16 a[172:175], v[152:155], v[96:99], a[172:175]
  ds_read_b128 v[72:75], v20 offset:14336
  v_mfma_f32_16x16x32_bf16 a[176:179], v[156:159], v[96:99], a[176:179]
  v_mfma_f32_16x16x32_bf16 a[180:183], v[160:163], v[96:99], a[180:183]
  ds_read_b64_tr_b16 v[136:137], v37 offset:32768
  v_mfma_f32_16x16x32_bf16 a[184:187], v[164:167], v[96:99], a[184:187]
  v_mfma_f32_16x16x32_bf16 a[188:191], v[168:171], v[96:99], a[188:191]
  ds_read_b64_tr_b16 v[138:139], v37 offset:34816
  v_mfma_f32_16x16x32_bf16 a[192:195], v[140:143], v[100:103], a[192:195]
  v_mfma_f32_16x16x32_bf16 a[196:199], v[144:147], v[100:103], a[196:199]
  v_mfma_f32_16x16x32_bf16 a[200:203], v[148:151], v[100:103], a[200:203]
  v_mfma_f32_16x16x32_bf16 a[204:207], v[152:155], v[100:103], a[204:207]
  v_mfma_f32_16x16x32_bf16 a[208:211], v[156:159], v[100:103], a[208:211]
  v_mfma_f32_16x16x32_bf16 a[212:215], v[160:163], v[100:103], a[212:215]
  v_mfma_f32_16x16x32_bf16 a[216:219], v[164:167], v[100:103], a[216:219]
  v_mfma_f32_16x16x32_bf16 a[220:223], v[168:171], v[100:103], a[220:223]
  v_mfma_f32_16x16x32_bf16 a[224:227], v[140:143], v[104:107], a[224:227]
  v_mfma_f32_16x16x32_bf16 a[228:231], v[144:147], v[104:107], a[228:231]
  v_mfma_f32_16x16x32_bf16 a[232:235], v[148:151], v[104:107], a[232:235]
  v_mfma_f32_16x16x32_bf16 a[236:239], v[152:155], v[104:107], a[236:239]
  v_mfma_f32_16x16x32_bf16 a[240:243], v[156:159], v[104:107], a[240:243]
  v_mfma_f32_16x16x32_bf16 a[244:247], v[160:163], v[104:107], a[244:247]
  v_mfma_f32_16x16x32_bf16 a[248:251], v[164:167], v[104:107], a[248:251]
  v_mfma_f32_16x16x32_bf16 a[252:255], v[168:171], v[104:107], a[252:255]
  s_waitcnt lgkmcnt(0)
  v_mfma_f32_16x16x32_bf16 a[0:3], v[108:111], v[44:47], a[0:3]
  ds_read_b128 v[76:79], v21 offset:0
  v_mfma_f32_16x16x32_bf16 a[4:7], v[112:115], v[44:47], a[4:7]
  v_mfma_f32_16x16x32_bf16 a[8:11], v[116:119], v[44:47], a[8:11]
  ds_read_b64_tr_b16 v[140:141], v30 offset:49152
  v_mfma_f32_16x16x32_bf16 a[12:15], v[120:123], v[44:47], a[12:15]
  v_mfma_f32_16x16x32_bf16 a[16:19], v[124:127], v[44:47], a[16:19]
  ds_read_b64_tr_b16 v[142:143], v30 offset:51200
  v_mfma_f32_16x16x32_bf16 a[20:23], v[128:131], v[44:47], a[20:23]
  v_mfma_f32_16x16x32_bf16 a[24:27], v[132:135], v[44:47], a[24:27]
  ds_read_b128 v[80:83], v21 offset:2048
  v_mfma_f32_16x16x32_bf16 a[28:31], v[136:139], v[44:47], a[28:31]
  v_mfma_f32_16x16x32_bf16 a[32:35], v[108:111], v[48:51], a[32:35]
  ds_read_b64_tr_b16 v[144:145], v31 offset:49152
  v_mfma_f32_16x16x32_bf16 a[36:39], v[112:115], v[48:51], a[36:39]
  v_mfma_f32_16x16x32_bf16 a[40:43], v[116:119], v[48:51], a[40:43]
  ds_read_b64_tr_b16 v[146:147], v31 offset:51200
  v_mfma_f32_16x16x32_bf16 a[44:47], v[120:123], v[48:51], a[44:47]
  v_mfma_f32_16x16x32_bf16 a[48:51], v[124:127], v[48:51], a[48:51]
  ds_read_b128 v[84:87], v21 offset:4096
  v_mfma_f32_16x16x32_bf16 a[52:55], v[128:131], v[48:51], a[52:55]
  v_mfma_f32_16x16x32_bf16 a[56:59], v[132:135], v[48:51], a[56:59]
  ds_read_b64_tr_b16 v[148:149], v32 offset:49152
  v_mfma_f32_16x16x32_bf16 a[60:63], v[136:139], v[48:51], a[60:63]
  v_mfma_f32_16x16x32_bf16 a[64:67], v[108:111], v[52:55], a[64:67]
  ds_read_b64_tr_b16 v[150:151], v32 offset:51200
  v_mfma_f32_16x16x32_bf16 a[68:71], v[112:115], v[52:55], a[68:71]
  v_mfma_f32_16x16x32_bf16 a[72:75], v[116:119], v[52:55], a[72:75]
  ds_read_b128 v[88:91], v21 offset:6144
  v_mfma_f32_16x16x32_bf16 a[76:79], v[120:123], v[52:55], a[76:79]
  v_mfma_f32_16x16x32_bf16 a[80:83], v[124:127], v[52:55], a[80:83]
  ds_read_b64_tr_b16 v[152:153], v33 offset:49152
  v_mfma_f32_16x16x32_bf16 a[84:87], v[128:131], v[52:55], a[84:87]
  v_mfma_f32_16x16x32_bf16 a[88:91], v[132:135], v[52:55], a[88:91]
  ds_read_b64_tr_b16 v[154:155], v33 offset:51200
  v_mfma_f32_16x16x32_bf16 a[92:95], v[136:139], v[52:55], a[92:95]
  v_mfma_f32_16x16x32_bf16 a[96:99], v[108:111], v[56:59], a[96:99]
  ds_read_b128 v[92:95], v21 offset:8192
  v_mfma_f32_16x16x32_bf16 a[100:103], v[112:115], v[56:59], a[100:103]
  v_mfma_f32_16x16x32_bf16 a[104:107], v[116:119], v[56:59], a[104:107]
  ds_read_b64_tr_b16 v[156:157], v34 offset:49152
  v_mfma_f32_16x16x32_bf16 a[108:111], v[120:123], v[56:59], a[108:111]
  v_mfma_f32_16x16x32_bf16 a[112:115], v[124:127], v[56:59], a[112:115]
  ds_read_b64_tr_b16 v[158:159], v34 offset:51200
  v_mfma_f32_16x16x32_bf16 a[116:119], v[128:131], v[56:59], a[116:119]
  v_mfma_f32_16x16x32_bf16 a[120:123], v[132:135], v[56:59], a[120:123]
  ds_read_b128 v[96:99], v21 offset:10240
  v_mfma_f32_16x16x32_bf16 a[124:127], v[136:139], v[56:59], a[124:127]
  v_mfma_f32_16x16x32_bf16 a[128:131], v[108:111], v[60:63], a[128:131]
  ds_read_b64_tr_b16 v[160:161], v35 offset:49152
  v_mfma_f32_16x16x32_bf16 a[132:135], v[112:115], v[60:63], a[132:135]
  v_mfma_f32_16x16x32_bf16 a[136:139], v[116:119], v[60:63], a[136:139]
  ds_read_b64_tr_b16 v[162:163], v35 offset:51200
  v_mfma_f32_16x16x32_bf16 a[140:143], v[120:123], v[60:63], a[140:143]
  v_mfma_f32_16x16x32_bf16 a[144:147], v[124:127], v[60:63], a[144:147]
  ds_read_b128 v[100:103], v21 offset:12288
  v_mfma_f32_16x16x32_bf16 a[148:151], v[128:131], v[60:63], a[148:151]
  v_mfma_f32_16x16x32_bf16 a[152:155], v[132:135], v[60:63], a[152:155]
  ds_read_b64_tr_b16 v[164:165], v36 offset:49152
  v_mfma_f32_16x16x32_bf16 a[156:159], v[136:139], v[60:63], a[156:159]
  v_mfma_f32_16x16x32_bf16 a[160:163], v[108:111], v[64:67], a[160:163]
  ds_read_b64_tr_b16 v[166:167], v36 offset:51200
  v_mfma_f32_16x16x32_bf16 a[164:167], v[112:115], v[64:67], a[164:167]
  v_mfma_f32_16x16x32_bf16 a[168:171], v[116:119], v[64:67], a[168:171]
  ds_read_b128 v[104:107], v21 offset:14336
  v_mfma_f32_16x16x32_bf16 a[172:175], v[120:123], v[64:67], a[172:175]
  v_mfma_f32_16x16x32_bf16 a[176:179], v[124:127], v[64:67], a[176:179]
  ds_read_b64_tr_b16 v[168:169], v37 offset:49152
  v_mfma_f32_16x16x32_bf16 a[180:183], v[128:131], v[64:67], a[180:183]
  v_mfma_f32_16x16x32_bf16 a[184:187], v[132:135], v[64:67], a[184:187]
  ds_read_b64_tr_b16 v[170:171], v37 offset:51200
  v_mfma_f32_16x16x32_bf16 a[188:191], v[136:139], v[64:67], a[188:191]
  v_mfma_f32_16x16x32_bf16 a[192:195], v[108:111], v[68:71], a[192:195]
  v_mfma_f32_16x16x32_bf16 a[196:199], v[112:115], v[68:71], a[196:199]
  v_mfma_f32_16x16x32_bf16 a[200:203], v[116:119], v[68:71], a[200:203]
  v_mfma_f32_16x16x32_bf16 a[204:207], v[120:123], v[68:71], a[204:207]
  v_mfma_f32_16x16x32_bf16 a[208:211], v[124:127], v[68:71], a[208:211]
  v_mfma_f32_16x16x32_bf16 a[212:215], v[128:131], v[68:71], a[212:215]
  v_mfma_f32_16x16x32_bf16 a[216:219], v[132:135], v[68:71], a[216:219]
  v_mfma_f32_16x16x32_bf16 a[220:223], v[136:139], v[68:71], a[220:223]
  v_mfma_f32_16x16x32_bf16 a[224:227], v[108:111], v[72:75], a[224:227]
  v_mfma_f32_16x16x32_bf16 a[228:231], v[112:115], v[72:75], a[228:231]
  v_mfma_f32_16x16x32_bf16 a[232:235], v[116:119], v[72:75], a[232:235]
  v_mfma_f32_16x16x32_bf16 a[236:239], v[120:123], v[72:75], a[236:239]
  v_mfma_f32_16x16x32_bf16 a[240:243], v[124:127], v[72:75], a[240:243]
  v_mfma_f32_16x16x32_bf16 a[244:247], v[128:131], v[72:75], a[244:247]
  v_mfma_f32_16x16x32_bf16 a[248:251], v[132:135], v[72:75], a[248:251]
  v_mfma_f32_16x16x32_bf16 a[252:255], v[136:139], v[72:75], a[252:255]
  s_waitcnt lgkmcnt(0)
  v_mfma_f32_16x16x32_bf16 a[0:3], v[140:143], v[76:79], a[0:3]
  v_mfma_f32_16x16x32_bf16 a[4:7], v[144:147], v[76:79], a[4:7]
  v_mfma_f32_16x16x32_bf16 a[8:11], v[148:151], v[76:79], a[8:11]
  v_mfma_f32_16x16x32_bf16 a[12:15], v[152:155], v[76:79], a[12:15]
  v_mfma_f32_16x16x32_bf16 a[16:19], v[156:159], v[76:79], a[16:19]
  v_mfma_f32_16x16x32_bf16 a[20:23], v[160:163], v[76:79], a[20:23]
  v_mfma_f32_16x16x32_bf16 a[24:27], v[164:167], v[76:79], a[24:27]
  v_mfma_f32_16x16x32_bf16 a[28:31], v[168:171], v[76:79], a[28:31]
  v_mfma_f32_16x16x32_bf16 a[32:35], v[140:143], v[80:83], a[32:35]
  v_mfma_f32_16x16x32_bf16 a[36:39], v[144:147], v[80:83], a[36:39]
  v_mfma_f32_16x16x32_bf16 a[40:43], v[148:151], v[80:83], a[40:43]
  v_mfma_f32_16x16x32_bf16 a[44:47], v[152:155], v[80:83], a[44:47]
  v_mfma_f32_16x16x32_bf16 a[48:51], v[156:159], v[80:83], a[48:51]
  v_mfma_f32_16x16x32_bf16 a[52:55], v[160:163], v[80:83], a[52:55]
  v_mfma_f32_16x16x32_bf16 a[56:59], v[164:167], v[80:83], a[56:59]
  v_mfma_f32_16x16x32_bf16 a[60:63], v[168:171], v[80:83], a[60:63]
  v_mfma_f32_16x16x32_bf16 a[64:67], v[140:143], v[84:87], a[64:67]
  v_mfma_f32_16x16x32_bf16 a[68:71], v[144:147], v[84:87], a[68:71]
  v_mfma_f32_16x16x32_bf16 a[72:75], v[148:151], v[84:87], a[72:75]
  v_mfma_f32_16x16x32_bf16 a[76:79], v[152:155], v[84:87], a[76:79]
  v_mfma_f32_16x16x32_bf16 a[80:83], v[156:159], v[84:87], a[80:83]
  v_mfma_f32_16x16x32_bf16 a[84:87], v[160:163], v[84:87], a[84:87]
  v_mfma_f32_16x16x32_bf16 a[88:91], v[164:167], v[84:87], a[88:91]
  v_mfma_f32_16x16x32_bf16 a[92:95], v[168:171], v[84:87], a[92:95]
  v_mfma_f32_16x16x32_bf16 a[96:99], v[140:143], v[88:91], a[96:99]
  v_mfma_f32_16x16x32_bf16 a[100:103], v[144:147], v[88:91], a[100:103]
  v_mfma_f32_16x16x32_bf16 a[104:107], v[148:151], v[88:91], a[104:107]
  v_mfma_f32_16x16x32_bf16 a[108:111], v[152:155], v[88:91], a[108:111]
  v_mfma_f32_16x16x32_bf16 a[112:115], v[156:159], v[88:91], a[112:115]
  v_mfma_f32_16x16x32_bf16 a[116:119], v[160:163], v[88:91], a[116:119]
  v_mfma_f32_16x16x32_bf16 a[120:123], v[164:167], v[88:91], a[120:123]
  v_mfma_f32_16x16x32_bf16 a[124:127], v[168:171], v[88:91], a[124:127]
  v_mfma_f32_16x16x32_bf16 a[128:131], v[140:143], v[92:95], a[128:131]
  v_mfma_f32_16x16x32_bf16 a[132:135], v[144:147], v[92:95], a[132:135]
  v_mfma_f32_16x16x32_bf16 a[136:139], v[148:151], v[92:95], a[136:139]
  v_mfma_f32_16x16x32_bf16 a[140:143], v[152:155], v[92:95], a[140:143]
  v_mfma_f32_16x16x32_bf16 a[144:147], v[156:159], v[92:95], a[144:147]
  v_mfma_f32_16x16x32_bf16 a[148:151], v[160:163], v[92:95], a[148:151]
  v_mfma_f32_16x16x32_bf16 a[152:155], v[164:167], v[92:95], a[152:155]
  v_mfma_f32_16x16x32_bf16 a[156:159], v[168:171], v[92:95], a[156:159]
  v_mfma_f32_16x16x32_bf16 a[160:163], v[140:143], v[96:99], a[160:163]
  v_mfma_f32_16x16x32_bf16 a[164:167], v[144:147], v[96:99], a[164:167]
  v_mfma_f32_16x16x32_bf16 a[168:171], v[148:151], v[96:99], a[168:171]
  v_mfma_f32_16x16x32_bf16 a[172:175], v[152:155], v[96:99], a[172:175]
  v_mfma_f32_16x16x32_bf16 a[176:179], v[156:159], v[96:99], a[176:179]
  v_mfma_f32_16x16x32_bf16 a[180:183], v[160:163], v[96:99], a[180:183]
  v_mfma_f32_16x16x32_bf16 a[184:187], v[164:167], v[96:99], a[184:187]
  v_mfma_f32_16x16x32_bf16 a[188:191], v[168:171], v[96:99], a[188:191]
  v_mfma_f32_16x16x32_bf16 a[192:195], v[140:143], v[100:103], a[192:195]
  v_mfma_f32_16x16x32_bf16 a[196:199], v[144:147], v[100:103], a[196:199]
  v_mfma_f32_16x16x32_bf16 a[200:203], v[148:151], v[100:103], a[200:203]
  v_mfma_f32_16x16x32_bf16 a[204:207], v[152:155], v[100:103], a[204:207]
  v_mfma_f32_16x16x32_bf16 a[208:211], v[156:159], v[100:103], a[208:211]
  v_mfma_f32_16x16x32_bf16 a[212:215], v[160:163], v[100:103], a[212:215]
  v_mfma_f32_16x16x32_bf16 a[216:219], v[164:167], v[100:103], a[216:219]
  v_mfma_f32_16x16x32_bf16 a[220:223], v[168:171], v[100:103], a[220:223]
  v_mfma_f32_16x16x32_bf16 a[224:227], v[140:143], v[104:107], a[224:227]
  v_mfma_f32_16x16x32_bf16 a[228:231], v[144:147], v[104:107], a[228:231]
  v_mfma_f32_16x16x32_bf16 a[232:235], v[148:151], v[104:107], a[232:235]
  v_mfma_f32_16x16x32_bf16 a[236:239], v[152:155], v[104:107], a[236:239]
  v_mfma_f32_16x16x32_bf16 a[240:243], v[156:159], v[104:107], a[240:243]
  v_mfma_f32_16x16x32_bf16 a[244:247], v[160:163], v[104:107], a[244:247]
  v_mfma_f32_16x16x32_bf16 a[248:251], v[164:167], v[104:107], a[248:251]
  v_mfma_f32_16x16x32_bf16 a[252:255], v[168:171], v[104:107], a[252:255]
  s_mov_b32 s59, 1
  s_mov_b32 s60, s22
  s_mov_b32 s61, s26
  s_add_u32 s62, s38, 0x3d00000
  s_mov_b32 s63, s98
  s_cmp_lg_u32 s39, 0
  s_cbranch_scc1 L_got
  s_mov_b32 s58, 3
  s_branch L_epi
L_g2:
  s_waitcnt vmcnt(16)
  s_barrier
  ds_read_b128 v[44:47], v18 offset:0
  ds_read_b64_tr_b16 v[108:109], v22 offset:32768
  ds_read_b64_tr_b16 v[110:111], v22 offset:34816
  ds_read_b128 v[48:51], v18 offset:2048
  ds_read_b64_tr_b16 v[112:113], v23 offset:32768
  ds_read_b64_tr_b16 v[114:115], v23 offset:34816
  ds_read_b128 v[52:55], v18 offset:4096
  ds_read_b64_tr_b16 v[116:117], v24 offset:32768
  ds_read_b64_tr_b16 v[118:119], v24 offset:34816
  ds_read_b128 v[56:59], v18 offset:6144
  ds_read_b64_tr_b16 v[120:121], v25 offset:32768
  ds_read_b64_tr_b16 v[122:123], v25 offset:34816
  ds_read_b128 v[60:63], v18 offset:8192
  ds_read_b64_tr_b16 v[124:125], v26 offset:32768
  ds_read_b64_tr_b16 v[126:127], v26 offset:34816
  ds_read_b128 v[64:67], v18 offset:10240
  ds_read_b64_tr_b16 v[128:129], v27 offset:32768
  ds_read_b64_tr_b16 v[130:131], v27 offset:34816
  ds_read_b128 v[68:71], v18 offset:12288
  ds_read_b64_tr_b16 v[132:133], v28 offset:32768
  ds_read_b64_tr_b16 v[134:135], v28 offset:34816
  ds_read_b128 v[72:75], v18 offset:14336
  ds_read_b64_tr_b16 v[136:137], v29 offset:32768
  ds_read_b64_tr_b16 v[138:139], v29 offset:34816
  s_sub_u32 s25, s25, 1
  s_waitcnt lgkmcnt(0)
  v_mfma_f32_16x16x32_bf16 a[0:3], v[44:47], v[108:111], 0
  ds_read_b128 v[76:79], v19 offset:0
  v_mfma_f32_16x16x32_bf16 a[4:7], v[44:47], v[112:115], 0
  v_mfma_f32_16x16x32_bf16 a[8:11], v[44:47], v[116:119], 0
  ds_read_b64_tr_b16 v[140:141], v22 offset:49152
  v_mfma_f32_16x16x32_bf16 a[12:15], v[44:47], v[120:123], 0
  v_mfma_f32_16x16x32_bf16 a[16:19], v[44:47], v[124:127], 0
  ds_read_b64_tr_b16 v[142:143], v22 offset:51200
  v_mfma_f32_16x16x32_bf16 a[20:23], v[44:47], v[128:131], 0
  v_mfma_f32_16x16x32_bf16 a[24:27], v[44:47], v[132:135], 0
  ds_read_b128 v[80:83], v19 offset:2048
  v_mfma_f32_16x16x32_bf16 a[28:31], v[44:47], v[136:139], 0
  v_mfma_f32_16x16x32_bf16 a[32:35], v[48:51], v[108:111], 0
  ds_read_b64_tr_b16 v[144:145], v23 offset:49152
  v_mfma_f32_16x16x32_bf16 a[36:39], v[48:51], v[112:115], 0
  v_mfma_f32_16x16x32_bf16 a[40:43], v[48:51], v[116:119], 0
  ds_read_b64_tr_b16 v[146:147], v23 offset:51200
  v_mfma_f32_16x16x32_bf16 a[44:47], v[48:51], v[120:123], 0
  v_mfma_f32_16x16x32_bf16 a[48:51], v[48:51], v[124:127], 0
  ds_read_b128 v[84:87], v19 offset:4096
  v_mfma_f32_16x16x32_bf16 a[52:55], v[48:51], v[128:131], 0
  v_mfma_f32_16x16x32_bf16 a[56:59], v[48:51], v[132:135], 0
  ds_read_b64_tr_b16 v[148:149], v24 offset:49152
  v_mfma_f32_16x16x32_bf16 a[60:63], v[48:51], v[136:139], 0
  v_mfma_f32_16x16x32_bf16 a[64:67], v[52:55], v[108:111], 0
  ds_read_b64_tr_b16 v[150:151], v24 offset:51200
  v_mfma_f32_16x16x32_bf16 a[68:71], v[52:55], v[112:115], 0
  v_mfma_f32_16x16x32_bf16 a[72:75], v[52:55], v[116:119], 0
  ds_read_b128 v[88:91], v19 offset:6144
  v_mfma_f32_16x16x32_bf16 a[76:79], v[52:55], v[120:123], 0
  v_mfma_f32_16x16x32_bf16 a[80:83], v[52:55], v[124:127], 0
  ds_read_b64_tr_b16 v[152:153], v25 offset:49152
  v_mfma_f32_16x16x32_bf16 a[84:87], v[52:55], v[128:131], 0
  v_mfma_f32_16x16x32_bf16 a[88:91], v[52:55], v[132:135], 0
  ds_read_b64_tr_b16 v[154:155], v25 offset:51200
  v_mfma_f32_16x16x32_bf16 a[92:95], v[52:55], v[136:139], 0
  v_mfma_f32_16x16x32_bf16 a[96:99], v[56:59], v[108:111], 0
  ds_read_b128 v[92:95], v19 offset:8192
  v_mfma_f32_16x16x32_bf16 a[100:103], v[56:59], v[112:115], 0
  v_mfma_f32_16x16x32_bf16 a[104:107], v[56:59], v[116:119], 0
  ds_read_b64_tr_b16 v[156:157], v26 offset:49152
  v_mfma_f32_16x16x32_bf16 a[108:111], v[56:59], v[120:123], 0
  v_mfma_f32_16x16x32_bf16 a[112:115], v[56:59], v[124:127], 0
  ds_read_b64_tr_b16 v[158:159], v26 offset:51200
  v_mfma_f32_16x16x32_bf16 a[116:119], v[56:59], v[128:131], 0
  v_mfma_f32_16x16x32_bf16 a[120:123], v[56:59], v[132:135], 0
  ds_read_b128 v[96:99], v19 offset:10240
  v_mfma_f32_16x16x32_bf16 a[124:127], v[56:59], v[136:139], 0
  v_mfma_f32_16x16x32_bf16 a[128:131], v[60:63], v[108:111], 0
  ds_read_b64_tr_b16 v[160:161], v27 offset:49152
  v_mfma_f32_16x16x32_bf16 a[132:135], v[60:63], v[112:115], 0
  v_mfma_f32_16x16x32_bf16 a[136:139], v[60:63], v[116:119], 0
  ds_read_b64_tr_b16 v[162:163], v27 offset:51200
  v_mfma_f32_16x16x32_bf16 a[140:143], v[60:63], v[120:123], 0
  v_mfma_f32_16x16x32_bf16 a[144:147], v[60:63], v[124:127], 0
  ds_read_b128 v[100:103], v19 offset:12288
  v_mfma_f32_16x16x32_bf16 a[148:151], v[60:63], v[128:131], 0
  v_mfma_f32_16x16x32_bf16 a[152:155], v[60:63], v[132:135], 0
  ds_read_b64_tr_b16 v[164:165], v28 offset:49152
  v_mfma_f32_16x16x32_bf16 a[156:159], v[60:63], v[136:139], 0
  v_mfma_f32_16x16x32_bf16 a[160:163], v[64:67], v[108:111], 0
  ds_read_b64_tr_b16 v[166:167], v28 offset:51200
  v_mfma_f32_16x16x32_bf16 a[164:167], v[64:67], v[112:115], 0
  v_mfma_f32_16x16x32_bf16 a[168:171], v[64:67], v[116:119], 0
  ds_read_b128 v[104:107], v19 offset:14336
  v_mfma_f32_16x16x32_bf16 a[172:175], v[64:67], v[120:123], 0
  v_mfma_f32_16x16x32_bf16 a[176:179], v[64:67], v[124:127], 0
  ds_read_b64_tr_b16 v[168:169], v29 offset:49152
  v_mfma_f32_16x16x32_bf16 a[180:183], v[64:67], v[128:131], 0
  v_mfma_f32_16x16x32_bf16 a[184:187], v[64:67], v[132:135], 0
  ds_read_b64_tr_b16 v[170:171], v29 offset:51200
  v_mfma_f32_16x16x32_bf16 a[188:191], v[64:67], v[136:139], 0
  v_mfma_f32_16x16x32_bf16 a[192:195], v[68:71], v[108:111], 0
  v_mfma_f32_16x16x32_bf16 a[196:199], v[68:71], v[112:115], 0
  v_mfma_f32_16x16x32_bf16 a[200:203], v[68:71], v[116:119], 0
  v_mfma_f32_16x16x32_bf16 a[204:207], v[68:71], v[120:123], 0
  v_mfma_f32_16x16x32_bf16 a[208:211], v[68:71], v[124:127], 0
  v_mfma_f32_16x16x32_bf16 a[212:215], v[68:71], v[128:131], 0
  v_mfma_f32_16x16x32_bf16 a[216:219], v[68:71], v[132:135], 0
  v_mfma_f32_16x16x32_bf16 a[220:223], v[68:71], v[136:139], 0
  v_mfma_f32_16x16x32_bf16 a[224:227], v[72:75], v[108:111], 0
  v_mfma_f32_16x16x32_bf16 a[228:231], v[72:75], v[112:115], 0
  v_mfma_f32_16x16x32_bf16 a[232:235], v[72:75], v[116:119], 0
  v_mfma_f32_16x16x32_bf16 a[236:239], v[72:75], v[120:123], 0
  v_mfma_f32_16x16x32_bf16 a[240:243], v[72:75], v[124:127], 0
  v_mfma_f32_16x16x32_bf16 a[244:247], v[72:75], v[128:131], 0
  v_mfma_f32_16x16x32_bf16 a[248:251], v[72:75], v[132:135], 0
  v_mfma_f32_16x16x32_bf16 a[252:255], v[72:75], v[136:139], 0
  s_waitcnt lgkmcnt(0)
  v_mfma_f32_16x16x32_bf16 a[0:3], v[76:79], v[140:143], a[0:3]
  s_waitcnt vmcnt(0)
  s_barrier
  s_add_u32 m0, s52, 0
  v_mfma_f32_16x16x32_bf16 a[4:7], v[76:79], v[144:147], a[4:7]
  buffer_load_dwordx4 v2, s[8:11], s20 offen  lds
  ds_read_b128 v[44:47], v20 offset:0
  v_mfma_f32_16x16x32_bf16 a[8:11], v[76:79], v[148:151], a[8:11]
  v_mfma_f32_16x16x32_bf16 a[12:15], v[76:79], v[152:155], a[12:15]
  ds_read_b64_tr_b16 v[108:109], v30 offset:32768
  s_add_u32 m0, s53, 0
  v_mfma_f32_16x16x32_bf16 a[16:19], v[76:79], v[156:159], a[16:19]
  buffer_load_dwordx4 v10, s[12:15], s21 offen  lds
  v_mfma_f32_16x16x32_bf16 a[20:23], v[76:79], v[160:163], a[20:23]
  ds_read_b64_tr_b16 v[110:111], v30 offset:34816
  v_mfma_f32_16x16x32_bf16 a[24:27], v[76:79], v[164:167], a[24:27]
  v_mfma_f32_16x16x32_bf16 a[28:31], v[76:79], v[168:171], a[28:31]
  ds_read_b128 v[48:51], v20 offset:2048
  s_add_u32 m0, s52, 1024
  v_mfma_f32_16x16x32_bf16 a[32:35], v[80:83], v[140:143], a[32:35]
  buffer_load_dwordx4 v3, s[8:11], s20 offen  lds
  v_mfma_f32_16x16x32_bf16 a[36:39], v[80:83], v[144:147], a[36:39]
  ds_read_b64_tr_b16 v[112:113], v31 offset:32768
  v_mfma_f32_16x16x32_bf16 a[40:43], v[80:83], v[148:151], a[40:43]
  v_mfma_f32_16x16x32_bf16 a[44:47], v[80:83], v[152:155], a[44:47]
  ds_read_b64_tr_b16 v[114:115], v31 offset:34816
  s_add_u32 m0, s53, 1024
  v_mfma_f32_16x16x32_bf16 a[48:51], v[80:83], v[156:159], a[48:51]
  buffer_load_dwordx4 v11, s[12:15], s21 offen  lds
  v_mfma_f32_16x16x32_bf16 a[52:55], v[80:83], v[160:163], a[52:55]
  ds_read_b128 v[52:55], v20 offset:4096
  v_mfma_f32_16x16x32_bf16 a[56:59], v[80:83], v[164:167], a[56:59]
  s_add_u32 m0, s52, 2048
  v_mfma_f32_16x16x32_bf16 a[60:63], v[80:83], v[168:171], a[60:63]
  buffer_load_dwordx4 v4, s[8:11], s20 offen  lds
  ds_read_b64_tr_b16 v[116:117], v32 offset:32768
  v_mfma_f32_16x16x32_bf16 a[64:67], v[84:87], v[140:143], a[64:67]
  v_mfma_f32_16x16x32_bf16 a[68:71], v[84:87], v[144:147], a[68:71]
  ds_read_b64_tr_b16 v[118:119], v32 offset:34816
  v_mfma_f32_16x16x32_bf16 a[72:75], v[84:87], v[148:151], a[72:75]
  s_add_u32 m0, s53, 2048
  v_mfma_f32_16x16x32_bf16 a[76:79], v[84:87], v[152:155], a[76:79]
  buffer_load_dwordx4 v12, s[12:15], s21 offen  lds
  ds_read_b128 v[56:59], v20 offset:6144
  v_mfma_f32_16x16x32_bf16 a[80:83], v[84:87], v[156:159], a[80:83]
  v_mfma_f32_16x16x32_bf16 a[84:87], v[84:87], v[160:163], a[84:87]
  ds_read_b64_tr_b16 v[120:121], v33 offset:32768
  v_mfma_f32_16x16x32_bf16 a[88:91], v[84:87], v[164:167], a[88:91]
  s_add_u32 m0, s52, 3072
  v_mfma_f32_16x16x32_bf16 a[92:95], v[84:87], v[168:171], a[92:95]
  buffer_load_dwordx4 v5, s[8:11], s20 offen  lds
  ds_read_b64_tr_b16 v[122:123], v33 offset:34816
  v_mfma_f32_16x16x32_bf16 a[96:99], v[88:91], v[140:143], a[96:99]
  v_mfma_f32_16x16x32_bf16 a[100:103], v[88:91], v[144:147], a[100:103]
  ds_read_b128 v[60:63], v20 offset:8192
  s_add_u32 m0, s53, 3072
  v_mfma_f32_16x16x32_bf16 a[104:107], v[88:91], v[148:151], a[104:107]
  buffer_load_dwordx4 v13, s[12:15], s21 offen  lds
  v_mfma_f32_16x16x32_bf16 a[108:111], v[88:91], v[152:155], a[108:111]
  ds_read_b64_tr_b16 v[124:125], v34 offset:32768
  v_mfma_f32_16x16x32_bf16 a[112:115], v[88:91], v[156:159], a[112:115]
  v_mfma_f32_16x16x32_bf16 a[116:119], v[88:91], v[160:163], a[116:119]
  ds_read_b64_tr_b16 v[126:127], v34 offset:34816
  s_add_u32 m0, s52, 4096
  v_mfma_f32_16x16x32_bf16 a[120:123], v[88:91], v[164:167], a[120:123]
  buffer_load_dwordx4 v6, s[8:11], s20 offen  lds
  v_mfma_f32_16x16x32_bf16 a[124:127], v[88:91], v[168:171], a[124:127]
  ds_read_b128 v[64:67], v20 offset:10240
  v_mfma_f32_16x16x32_bf16 a[128:131], v[92:95], v[140:143], a[128:131]
  v_mfma_f32_16x16x32_bf16 a[132:135], v[92:95], v[144:147], a[132:135]
  ds_read_b64_tr_b16 v[128:129], v35 offset:32768
  s_add_u32 m0, s53, 4096
  v_mfma_f32_16x16x32_bf16 a[136:139], v[92:95], v[148:151], a[136:139]
  buffer_load_dwordx4 v14, s[12:15], s21 offen  lds
  v_mfma_f32_16x16x32_bf16 a[140:143], v[92:95], v[152:155], a[140:143]
  ds_read_b64_tr_b16 v[130:131], v35 offset:34816
  v_mfma_f32_16x16x32_bf16 a[144:147], v[92:95], v[156:159], a[144:147]
  v_mfma_f32_16x16x32_bf16 a[148:151], v[92:95], v[160:163], a[148:151]
  ds_read_b128 v[68:71], v20 offset:12288
  s_add_u32 m0, s52, 5120
  v_mfma_f32_16x16x32_bf16 a[152:155], v[92:95], v[164:167], a[152:155]
  buffer_load_dwordx4 v7, s[8:11], s20 offen  lds
  v_mfma_f32_16x16x32_bf16 a[156:159], v[92:95], v[168:171], a[156:159]
  ds_read_b64_tr_b16 v[132:133], v36 offset:32768
  v_mfma_f32_16x16x32_bf16 a[160:163], v[96:99], v[140:143], a[160:163]
  s_add_u32 m0, s53, 5120
  v_mfma_f32_16x16x32_bf16 a[164:167], v[96:99], v[144:147], a[164:167]
  buffer_load_dwordx4 v15, s[12:15], s21 offen  lds
  ds_read_b64_tr_b16 v[134:135], v36 offset:34816
  v_mfma_f32_16x16x32_bf16 a[168:171], v[96:99], v[148:151], a[168:171]
  v_mfma_f32_16x16x32_bf16 a[172:175], v[96:99], v[152:155], a[172:175]
  ds_read_b128 v[72:75], v20 offset:14336
  v_mfma_f32_16x16x32_bf16 a[176:179], v[96:99], v[156:159], a[176:179]
  s_add_u32 m0, s52, 6144
  v_mfma_f32_16x16x32_bf16 a[180:183], v[96:99], v[160:163], a[180:183]
  buffer_load_dwordx4 v8, s[8:11], s20 offen  lds
  ds_read_b64_tr_b16 v[136:137], v37 offset:32768
  v_mfma_f32_16x16x32_bf16 a[184:187], v[96:99], v[164:167], a[184:187]
  v_mfma_f32_16x16x32_bf16 a[188:191], v[96:99], v[168:171], a[188:191]
  ds_read_b64_tr_b16 v[138:139], v37 offset:34816
  v_mfma_f32_16x16x32_bf16 a[192:195], v[100:103], v[140:143], a[192:195]
  s_add_u32 m0, s53, 6144
  v_mfma_f32_16x16x32_bf16 a[196:199], v[100:103], v[144:147], a[196:199]
  buffer_load_dwordx4 v16, s[12:15], s21 offen  lds
  v_mfma_f32_16x16x32_bf16 a[200:203], v[100:103], v[148:151], a[200:203]
  v_mfma_f32_16x16x32_bf16 a[204:207], v[100:103], v[152:155], a[204:207]
  s_add_u32 m0, s52, 7168
  v_mfma_f32_16x16x32_bf16 a[208:211], v[100:103], v[156:159], a[208:211]
  buffer_load_dwordx4 v9, s[8:11], s20 offen  lds
  v_mfma_f32_16x16x32_bf16 a[212:215], v[100:103], v[160:163], a[212:215]
  v_mfma_f32_16x16x32_bf16 a[216:219], v[100:103], v[164:167], a[216:219]
  v_mfma_f32_16x16x32_bf16 a[220:223], v[100:103], v[168:171], a[220:223]
  s_add_u32 m0, s53, 7168
  v_mfma_f32_16x16x32_bf16 a[224:227], v[104:107], v[140:143], a[224:227]
  buffer_load_dwordx4 v17, s[12:15], s21 offen  lds
  v_mfma_f32_16x16x32_bf16 a[228:231], v[104:107], v[144:147], a[228:231]
  v_mfma_f32_16x16x32_bf16 a[232:235], v[104:107], v[148:151], a[232:235]
  v_mfma_f32_16x16x32_bf16 a[236:239], v[104:107], v[152:155], a[236:239]
  s_add_u32 s20, s20, 128
  v_mfma_f32_16x16x32_bf16 a[240:243], v[104:107], v[156:159], a[240:243]
  s_add_u32 s21, s21, s51
  v_mfma_f32_16x16x32_bf16 a[244:247], v[104:107], v[160:163], a[244:247]
  v_mfma_f32_16x16x32_bf16 a[248:251], v[104:107], v[164:167], a[248:251]
  v_mfma_f32_16x16x32_bf16 a[252:255], v[104:107], v[168:171], a[252:255]
  s_waitcnt lgkmcnt(0)
  v_mfma_f32_16x16x32_bf16 a[0:3], v[44:47], v[108:111], a[0:3]
  ds_read_b128 v[76:79], v21 offset:0
  v_mfma_f32_16x16x32_bf16 a[4:7], v[44:47], v[112:115], a[4:7]
  v_mfma_f32_16x16x32_bf16 a[8:11], v[44:47], v[116:119], a[8:11]
  ds_read_b64_tr_b16 v[140:141], v30 offset:49152
  v_mfma_f32_16x16x32_bf16 a[12:15], v[44:47], v[120:123], a[12:15]
  v_mfma_f32_16x16x32_bf16 a[16:19], v[44:47], v[124:127], a[16:19]
  ds_read_b64_tr_b16 v[142:143], v30 offset:51200
  v_mfma_f32_16x16x32_bf16 a[20:23], v[44:47], v[128:131], a[20:23]
  v_mfma_f32_16x16x32_bf16 a[24:27], v[44:47], v[132:135], a[24:27]
  ds_read_b128 v[80:83], v21 offset:2048
  v_mfma_f32_16x16x32_bf16 a[28:31], v[44:47], v[136:139], a[28:31]
  v_mfma_f32_16x16x32_bf16 a[32:35], v[48:51], v[108:111], a[32:35]
  ds_read_b64_tr_b16 v[144:145], v31 offset:49152
  v_mfma_f32_16x16x32_bf16 a[36:39], v[48:51], v[112:115], a[36:39]
  v_mfma_f32_16x16x32_bf16 a[40:43], v[48:51], v[116:119], a[40:43]
  ds_read_b64_tr_b16 v[146:147], v31 offset:51200
  v_mfma_f32_16x16x32_bf16 a[44:47], v[48:51], v[120:123], a[44:47]
  v_mfma_f32_16x16x32_bf16 a[48:51], v[48:51], v[124:127], a[48:51]
  ds_read_b128 v[84:87], v21 offset:4096
  v_mfma_f32_16x16x32_bf16 a[52:55], v[48:51], v[128:131], a[52:55]
  v_mfma_f32_16x16x32_bf16 a[56:59], v[48:51], v[132:135], a[56:59]
  ds_read_b64_tr_b16 v[148:149], v32 offset:49152
  v_mfma_f32_16x16x32_bf16 a[60:63], v[48:51], v[136:139], a[60:63]
  v_mfma_f32_16x16x32_bf16 a[64:67], v[52:55], v[108:111], a[64:67]
  ds_read_b64_tr_b16 v[150:151], v32 offset:51200
  v_mfma_f32_16x16x32_bf16 a[68:71], v[52:55], v[112:115], a[68:71]
  v_mfma_f32_16x16x32_bf16 a[72:75], v[52:55], v[116:119], a[72:75]
  ds_read_b128 v[88:91], v21 offset:6144
  v_mfma_f32_16x16x32_bf16 a[76:79], v[52:55], v[120:123], a[76:79]
  v_mfma_f32_16x16x32_bf16 a[80:83], v[52:55], v[124:127], a[80:83]
  ds_read_b64_tr_b16 v[152:153], v33 offset:49152
  v_mfma_f32_16x16x32_bf16 a[84:87], v[52:55], v[128:131], a[84:87]
  v_mfma_f32_16x16x32_bf16 a[88:91], v[52:55], v[132:135], a[88:91]
  ds_read_b64_tr_b16 v[154:155], v33 offset:51200
  v_mfma_f32_16x16x32_bf16 a[92:95], v[52:55], v[136:139], a[92:95]
  v_mfma_f32_16x16x32_bf16 a[96:99], v[56:59], v[108:111], a[96:99]
  ds_read_b128 v[92:95], v21 offset:8192
  v_mfma_f32_16x16x32_bf16 a[100:103], v[56:59], v[112:115], a[100:103]
  v_mfma_f32_16x16x32_bf16 a[104:107], v[56:59], v[116:119], a[104:107]
  ds_read_b64_tr_b16 v[156:157], v34 offset:49152
  v_mfma_f32_16x16x32_bf16 a[108:111], v[56:59], v[120:123], a[108:111]
  v_mfma_f32_16x16x32_bf16 a[112:115], v[56:59], v[124:127], a[112:115]
  ds_read_b64_tr_b16 v[158:159], v34 offset:51200
  v_mfma_f32_16x16x32_bf16 a[116:119], v[56:59], v[128:131], a[116:119]
  v_mfma_f32_16x16x32_bf16 a[120:123], v[56:59], v[132:135], a[120:123]
  ds_read_b128 v[96:99], v21 offset:10240
  v_mfma_f32_16x16x32_bf16 a[124:127], v[56:59], v[136:139], a[124:127]
  v_mfma_f32_16x16x32_bf16 a[128:131], v[60:63], v[108:111], a[128:131]
  ds_read_b64_tr_b16 v[160:161], v35 offset:49152
  v_mfma_f32_16x16x32_bf16 a[132:135], v[60:63], v[112:115], a[132:135]
  v_mfma_f32_16x16x32_bf16 a[136:139], v[60:63], v[116:119], a[136:139]
  ds_read_b64_tr_b16 v[162:163], v35 offset:51200
  v_mfma_f32_16x16x32_bf16 a[140:143], v[60:63], v[120:123], a[140:143]
  v_mfma_f32_16x16x32_bf16 a[144:147], v[60:63], v[124:127], a[144:147]
  ds_read_b128 v[100:103], v21 offset:12288
  v_mfma_f32_16x16x32_bf16 a[148:151], v[60:63], v[128:131], a[148:151]
  v_mfma_f32_16x16x32_bf16 a[152:155], v[60:63], v[132:135], a[152:155]
  ds_read_b64_tr_b16 v[164:165], v36 offset:49152
  v_mfma_f32_16x16x32_bf16 a[156:159], v[60:63], v[136:139], a[156:159]
  v_mfma_f32_16x16x32_bf16 a[160:163], v[64:67], v[108:111], a[160:163]
  ds_read_b64_tr_b16 v[166:167], v36 offset:51200
  v_mfma_f32_16x16x32_bf16 a[164:167], v[64:67], v[112:115], a[164:167]
  v_mfma_f32_16x16x32_bf16 a[168:171], v[64:67], v[116:119], a[168:171]
  ds_read_b128 v[104:107], v21 offset:14336
  v_mfma_f32_16x16x32_bf16 a[172:175], v[64:67], v[120:123], a[172:175]
  v_mfma_f32_16x16x32_bf16 a[176:179], v[64:67], v[124:127], a[176:179]
  ds_read_b64_tr_b16 v[168:169], v37 offset:49152
  v_mfma_f32_16x16x32_bf16 a[180:183], v[64:67], v[128:131], a[180:183]
  v_mfma_f32_16x16x32_bf16 a[184:187], v[64:67], v[132:135], a[184:187]
  ds_read_b64_tr_b16 v[170:171], v37 offset:51200
  v_mfma_f32_16x16x32_bf16 a[188:191], v[64:67], v[136:139], a[188:191]
  v_mfma_f32_16x16x32_bf16 a[192:195], v[68:71], v[108:111], a[192:195]
  v_mfma_f32_16x16x32_bf16 a[196:199], v[68:71], v[112:115], a[196:199]
  v_mfma_f32_16x16x32_bf16 a[200:203], v[68:71], v[116:119], a[200:203]
  v_mfma_f32_16x16x32_bf16 a[204:207], v[68:71], v[120:123], a[204:207]
  v_mfma_f32_16x16x32_bf16 a[208:211], v[68:71], v[124:127], a[208:211]
  v_mfma_f32_16x16x32_bf16 a[212:215], v[68:71], v[128:131], a[212:215]
  v_mfma_f32_16x16x32_bf16 a[216:219], v[68:71], v[132:135], a[216:219]
  v_mfma_f32_16x16x32_bf16 a[220:223], v[68:71], v[136:139], a[220:223]
  v_mfma_f32_16x16x32_bf16 a[224:227], v[72:75], v[108:111], a[224:227]
  v_mfma_f32_16x16x32_bf16 a[228:231], v[72:75], v[112:115], a[228:231]
  v_mfma_f32_16x16x32_bf16 a[232:235], v[72:75], v[116:119], a[232:235]
  v_mfma_f32_16x16x32_bf16 a[236:239], v[72:75], v[120:123], a[236:239]
  v_mfma_f32_16x16x32_bf16 a[240:243], v[72:75], v[124:127], a[240:243]
  v_mfma_f32_16x16x32_bf16 a[244:247], v[72:75], v[128:131], a[244:247]
  v_mfma_f32_16x16x32_bf16 a[248:251], v[72:75], v[132:135], a[248:251]
  v_mfma_f32_16x16x32_bf16 a[252:255], v[72:75], v[136:139], a[252:255]
  s_waitcnt lgkmcnt(0)
  v_mfma_f32_16x16x32_bf16 a[0:3], v[76:79], v[140:143], a[0:3]
  s_waitcnt vmcnt(0)
  s_barrier
  s_add_u32 m0, s52, 65536
  v_mfma_f32_16x16x32_bf16 a[4:7], v[76:79], v[144:147], a[4:7]
  buffer_load_dwordx4 v2, s[8:11], s20 offen  lds
  ds_read_b128 v[44:47], v18 offset:0
  v_mfma_f32_16x16x32_bf16 a[8:11], v[76:79], v[148:151], a[8:11]
  v_mfma_f32_16x16x32_bf16 a[12:15], v[76:79], v[152:155], a[12:15]
  ds_read_b64_tr_b16 v[108:109], v22 offset:32768
  s_add_u32 m0, s53, 65536
  v_mfma_f32_16x16x32_bf16 a[16:19], v[76:79], v[156:159], a[16:19]
  buffer_load_dwordx4 v10, s[12:15], s21 offen  lds
  v_mfma_f32_16x16x32_bf16 a[20:23], v[76:79], v[160:163], a[20:23]
  ds_read_b64_tr_b16 v[110:111], v22 offset:34816
  v_mfma_f32_16x16x32_bf16 a[24:27], v[76:79], v[164:167], a[24:27]
  v_mfma_f32_16x16x32_bf16 a[28:31], v[76:79], v[168:171], a[28:31]
  ds_read_b128 v[48:51], v18 offset:2048
  s_add_u32 m0, s52, 66560
  v_mfma_f32_16x16x32_bf16 a[32:35], v[80:83], v[140:143], a[32:35]
  buffer_load_dwordx4 v3, s[8:11], s20 offen  lds
  v_mfma_f32_16x16x32_bf16 a[36:39], v[80:83], v[144:147], a[36:39]
  ds_read_b64_tr_b16 v[112:113], v23 offset:32768
  v_mfma_f32_16x16x32_bf16 a[40:43], v[80:83], v[148:151], a[40:43]
  v_mfma_f32_16x16x32_bf16 a[44:47], v[80:83], v[152:155], a[44:47]
  ds_read_b64_tr_b16 v[114:115], v23 offset:34816
  s_add_u32 m0, s53, 66560
  v_mfma_f32_16x16x32_bf16 a[48:51], v[80:83], v[156:159], a[48:51]
  buffer_load_dwordx4 v11, s[12:15], s21 offen  lds
  v_mfma_f32_16x16x32_bf16 a[52:55], v[80:83], v[160:163], a[52:55]
  ds_read_b128 v[52:55], v18 offset:4096
  v_mfma_f32_16x16x32_bf16 a[56:59], v[80:83], v[164:167], a[56:59]
  s_add_u32 m0, s52, 67584
  v_mfma_f32_16x16x32_bf16 a[60:63], v[80:83], v[168:171], a[60:63]
  buffer_load_dwordx4 v4, s[8:11], s20 offen  lds
  ds_read_b64_tr_b16 v[116:117], v24 offset:32768
  v_mfma_f32_16x16x32_bf16 a[64:67], v[84:87], v[140:143], a[64:67]
  v_mfma_f32_16x16x32_bf16 a[68:71], v[84:87], v[144:147], a[68:71]
  ds_read_b64_tr_b16 v[118:119], v24 offset:34816
  v_mfma_f32_16x16x32_bf16 a[72:75], v[84:87], v[148:151], a[72:75]
  s_add_u32 m0, s53, 67584
  v_mfma_f32_16x16x32_bf16 a[76:79], v[84:87], v[152:155], a[76:79]
  buffer_load_dwordx4 v12, s[12:15], s21 offen  lds
  ds_read_b128 v[56:59], v18 offset:6144
  v_mfma_f32_16x16x32_bf16 a[80:83], v[84:87], v[156:159], a[80:83]
  v_mfma_f32_16x16x32_bf16 a[84:87], v[84:87], v[160:163], a[84:87]
  ds_read_b64_tr_b16 v[120:121], v25 offset:32768
  v_mfma_f32_16x16x32_bf16 a[88:91], v[84:87], v[164:167], a[88:91]
  s_add_u32 m0, s52, 68608
  v_mfma_f32_16x16x32_bf16 a[92:95], v[84:87], v[168:171], a[92:95]
  buffer_load_dwordx4 v5, s[8:11], s20 offen  lds
  ds_read_b64_tr_b16 v[122:123], v25 offset:34816
  v_mfma_f32_16x16x32_bf16 a[96:99], v[88:91], v[140:143], a[96:99]
  v_mfma_f32_16x16x32_bf16 a[100:103], v[88:91], v[144:147], a[100:103]
  ds_read_b128 v[60:63], v18 offset:8192
  s_add_u32 m0, s53, 68608
  v_mfma_f32_16x16x32_bf16 a[104:107], v[88:91], v[148:151], a[104:107]
  buffer_load_dwordx4 v13, s[12:15], s21 offen  lds
  v_mfma_f32_16x16x32_bf16 a[108:111], v[88:91], v[152:155], a[108:111]
  ds_read_b64_tr_b16 v[124:125], v26 offset:32768
  v_mfma_f32_16x16x32_bf16 a[112:115], v[88:91], v[156:159], a[112:115]
  v_mfma_f32_16x16x32_bf16 a[116:119], v[88:91], v[160:163], a[116:119]
  ds_read_b64_tr_b16 v[126:127], v26 offset:34816
  s_add_u32 m0, s52, 69632
  v_mfma_f32_16x16x32_bf16 a[120:123], v[88:91], v[164:167], a[120:123]
  buffer_load_dwordx4 v6, s[8:11], s20 offen  lds
  v_mfma_f32_16x16x32_bf16 a[124:127], v[88:91], v[168:171], a[124:127]
  ds_read_b128 v[64:67], v18 offset:10240
  v_mfma_f32_16x16x32_bf16 a[128:131], v[92:95], v[140:143], a[128:131]
  v_mfma_f32_16x16x32_bf16 a[132:135], v[92:95], v[144:147], a[132:135]
  ds_read_b64_tr_b16 v[128:129], v27 offset:32768
  s_add_u32 m0, s53, 69632
  v_mfma_f32_16x16x32_bf16 a[136:139], v[92:95], v[148:151], a[136:139]
  buffer_load_dwordx4 v14, s[12:15], s21 offen  lds
  v_mfma_f32_16x16x32_bf16 a[140:143], v[92:95], v[152:155], a[140:143]
  ds_read_b64_tr_b16 v[130:131], v27 offset:34816
  v_mfma_f32_16x16x32_bf16 a[144:147], v[92:95], v[156:159], a[144:147]
  v_mfma_f32_16x16x32_bf16 a[148:151], v[92:95], v[160:163], a[148:151]
  ds_read_b128 v[68:71], v18 offset:12288
  s_add_u32 m0, s52, 70656
  v_mfma_f32_16x16x32_bf16 a[152:155], v[92:95], v[164:167], a[152:155]
  buffer_load_dwordx4 v7, s[8:11], s20 offen  lds
  v_mfma_f32_16x16x32_bf16 a[156:159], v[92:95], v[168:171], a[156:159]
  ds_read_b64_tr_b16 v[132:133], v28 offset:32768
  v_mfma_f32_16x16x32_bf16 a[160:163], v[96:99], v[140:143], a[160:163]
  s_add_u32 m0, s53, 70656
  v_mfma_f32_16x16x32_bf16 a[164:167], v[96:99], v[144:147], a[164:167]
  buffer_load_dwordx4 v15, s[12:15], s21 offen  lds
  ds_read_b64_tr_b16 v[134:135], v28 offset:34816
  v_mfma_f32_16x16x32_bf16 a[168:171], v[96:99], v[148:151], a[168:171]
  v_mfma_f32_16x16x32_bf16 a[172:175], v[96:99], v[152:155], a[172:175]
  ds_read_b128 v[72:75], v18 offset:14336
  v_mfma_f32_16x16x32_bf16 a[176:179], v[96:99], v[156:159], a[176:179]
  s_add_u32 m0, s52, 71680
  v_mfma_f32_16x16x32_bf16 a[180:183], v[96:99], v[160:163], a[180:183]
  buffer_load_dwordx4 v8, s[8:11], s20 offen  lds
  ds_read_b64_tr_b16 v[136:137], v29 offset:32768
  v_mfma_f32_16x16x32_bf16 a[184:187], v[96:99], v[164:167], a[184:187]
  v_mfma_f32_16x16x32_bf16 a[188:191], v[96:99], v[168:171], a[188:191]
  ds_read_b64_tr_b16 v[138:139], v29 offset:34816
  v_mfma_f32_16x16x32_bf16 a[192:195], v[100:103], v[140:143], a[192:195]
  s_add_u32 m0, s53, 71680
  v_mfma_f32_16x16x32_bf16 a[196:199], v[100:103], v[144:147], a[196:199]
  buffer_load_dwordx4 v16, s[12:15], s21 offen  lds
  v_mfma_f32_16x16x32_bf16 a[200:203], v[100:103], v[148:151], a[200:203]
  v_mfma_f32_16x16x32_bf16 a[204:207], v[100:103], v[152:155], a[204:207]
  s_add_u32 m0, s52, 72704
  v_mfma_f32_16x16x32_bf16 a[208:211], v[100:103], v[156:159], a[208:211]
  buffer_load_dwordx4 v9, s[8:11], s20 offen  lds
  v_mfma_f32_16x16x32_bf16 a[212:215], v[100:103], v[160:163], a[212:215]
  v_mfma_f32_16x16x32_bf16 a[216:219], v[100:103], v[164:167], a[216:219]
  v_mfma_f32_16x16x32_bf16 a[220:223], v[100:103], v[168:171], a[220:223]
  s_add_u32 m0, s53, 72704
  v_mfma_f32_16x16x32_bf16 a[224:227], v[104:107], v[140:143], a[224:227]
  buffer_load_dwordx4 v17, s[12:15], s21 offen  lds
  v_mfma_f32_16x16x32_bf16 a[228:231], v[104:107], v[144:147], a[228:231]
  v_mfma_f32_16x16x32_bf16 a[232:235], v[104:107], v[148:151], a[232:235]
  v_mfma_f32_16x16x32_bf16 a[236:239], v[104:107], v[152:155], a[236:239]
  s_add_u32 s20, s20, 128
  v_mfma_f32_16x16x32_bf16 a[240:243], v[104:107], v[156:159], a[240:243]
  s_add_u32 s21, s21, s51
  v_mfma_f32_16x16x32_bf16 a[244:247], v[104:107], v[160:163], a[244:247]
  v_mfma_f32_16x16x32_bf16 a[248:251], v[104:107], v[164:167], a[248:251]
  v_mfma_f32_16x16x32_bf16 a[252:255], v[104:107], v[168:171], a[252:255]
L_g2_loop:
  s_sub_u32 s25, s25, 1
  s_cmp_eq_u32 s25, 0
  s_cbranch_scc1 L_g2_fin
  s_waitcnt lgkmcnt(0)
  v_mfma_f32_16x16x32_bf16 a[0:3], v[44:47], v[108:111], a[0:3]
  ds_read_b128 v[76:79], v19 offset:0
  v_mfma_f32_16x16x32_bf16 a[4:7], v[44:47], v[112:115], a[4:7]
  v_mfma_f32_16x16x32_bf16 a[8:11], v[44:47], v[116:119], a[8:11]
  ds_read_b64_tr_b16 v[140:141], v22 offset:49152
  v_mfma_f32_16x16x32_bf16 a[12:15], v[44:47], v[120:123], a[12:15]
  v_mfma_f32_16x16x32_bf16 a[16:19], v[44:47], v[124:127], a[16:19]
  ds_read_b64_tr_b16 v[142:143], v22 offset:51200
  v_mfma_f32_16x16x32_bf16 a[20:23], v[44:47], v[128:131], a[20:23]
  v_mfma_f32_16x16x32_bf16 a[24:27], v[44:47], v[132:135], a[24:27]
  ds_read_b128 v[80:83], v19 offset:2048
  v_mfma_f32_16x16x32_bf16 a[28:31], v[44:47], v[136:139], a[28:31]
  v_mfma_f32_16x16x32_bf16 a[32:35], v[48:51], v[108:111], a[32:35]
  ds_read_b64_tr_b16 v[144:145], v23 offset:49152
  v_mfma_f32_16x16x32_bf16 a[36:39], v[48:51], v[112:115], a[36:39]
  v_mfma_f32_16x16x32_bf16 a[40:43], v[48:51], v[116:119], a[40:43]
  ds_read_b64_tr_b16 v[146:147], v23 offset:51200
  v_mfma_f32_16x16x32_bf16 a[44:47], v[48:51], v[120:123], a[44:47]
  v_mfma_f32_16x16x32_bf16 a[48:51], v[48:51], v[124:127], a[48:51]
  ds_read_b128 v[84:87], v19 offset:4096
  v_mfma_f32_16x16x32_bf16 a[52:55], v[48:51], v[128:131], a[52:55]
  v_mfma_f32_16x16x32_bf16 a[56:59], v[48:51], v[132:135], a[56:59]
  ds_read_b64_tr_b16 v[148:149], v24 offset:49152
  v_mfma_f32_16x16x32_bf16 a[60:63], v[48:51], v[136:139], a[60:63]
  v_mfma_f32_16x16x32_bf16 a[64:67], v[52:55], v[108:111], a[64:67]
  ds_read_b64_tr_b16 v[150:151], v24 offset:51200
  v_mfma_f32_16x16x32_bf16 a[68:71], v[52:55], v[112:115], a[68:71]
  v_mfma_f32_16x16x32_bf16 a[72:75], v[52:55], v[116:119], a[72:75]
  ds_read_b128 v[88:91], v19 offset:6144
  v_mfma_f32_16x16x32_bf16 a[76:79], v[52:55], v[120:123], a[76:79]
  v_mfma_f32_16x16x32_bf16 a[80:83], v[52:55], v[124:127], a[80:83]
  ds_read_b64_tr_b16 v[152:153], v25 offset:49152
  v_mfma_f32_16x16x32_bf16 a[84:87], v[52:55], v[128:131], a[84:87]
  v_mfma_f32_16x16x32_bf16 a[88:91], v[52:55], v[132:135], a[88:91]
  ds_read_b64_tr_b16 v[154:155], v25 offset:51200
  v_mfma_f32_16x16x32_bf16 a[92:95], v[52:55], v[136:139], a[92:95]
  v_mfma_f32_16x16x32_bf16 a[96:99], v[56:59], v[108:111], a[96:99]
  ds_read_b128 v[92:95], v19 offset:8192
  v_mfma_f32_16x16x32_bf16 a[100:103], v[56:59], v[112:115], a[100:103]
  v_mfma_f32_16x16x32_bf16 a[104:107], v[56:59], v[116:119], a[104:107]
  ds_read_b64_tr_b16 v[156:157], v26 offset:49152
  v_mfma_f32_16x16x32_bf16 a[108:111], v[56:59], v[120:123], a[108:111]
  v_mfma_f32_16x16x32_bf16 a[112:115], v[56:59], v[124:127], a[112:115]
  ds_read_b64_tr_b16 v[158:159], v26 offset:51200
  v_mfma_f32_16x16x32_bf16 a[116:119], v[56:59], v[128:131], a[116:119]
  v_mfma_f32_16x16x32_bf16 a[120:123], v[56:59], v[132:135], a[120:123]
  ds_read_b128 v[96:99], v19 offset:10240
  v_mfma_f32_16x16x32_bf16 a[124:127], v[56:59], v[136:139], a[124:127]
  v_mfma_f32_16x16x32_bf16 a[128:131], v[60:63], v[108:111], a[128:131]
  ds_read_b64_tr_b16 v[160:161], v27 offset:49152
  v_mfma_f32_16x16x32_bf16 a[132:135], v[60:63], v[112:115], a[132:135]
  v_mfma_f32_16x16x32_bf16 a[136:139], v[60:63], v[116:119], a[136:139]
  ds_read_b64_tr_b16 v[162:163], v27 offset:51200
  v_mfma_f32_16x16x32_bf16 a[140:143], v[60:63], v[120:123], a[140:143]
  v_mfma_f32_16x16x32_bf16 a[144:147], v[60:63], v[124:127], a[144:147]
  ds_read_b128 v[100:103], v19 offset:12288
  v_mfma_f32_16x16x32_bf16 a[148:151], v[60:63], v[128:131], a[148:151]
  v_mfma_f32_16x16x32_bf16 a[152:155], v[60:63], v[132:135], a[152:155]
  ds_read_b64_tr_b16 v[164:165], v28 offset:49152
  v_mfma_f32_16x16x32_bf16 a[156:159], v[60:63], v[136:139], a[156:159]
  v_mfma_f32_16x16x32_bf16 a[160:163], v[64:67], v[108:111], a[160:163]
  ds_read_b64_tr_b16 v[166:167], v28 offset:51200
  v_mfma_f32_16x16x32_bf16 a[164:167], v[64:67], v[112:115], a[164:167]
  v_mfma_f32_16x16x32_bf16 a[168:171], v[64:67], v[116:119], a[168:171]
  ds_read_b128 v[104:107], v19 offset:14336
  v_mfma_f32_16x16x32_bf16 a[172:175], v[64:67], v[120:123], a[172:175]
  v_mfma_f32_16x16x32_bf16 a[176:179], v[64:67], v[124:127], a[176:179]
  ds_read_b64_tr_b16 v[168:169], v29 offset:49152
  v_mfma_f32_16x16x32_bf16 a[180:183], v[64:67], v[128:131], a[180:183]
  v_mfma_f32_16x16x32_bf16 a[184:187], v[64:67], v[132:135], a[184:187]
  ds_read_b64_tr_b16 v[170:171], v29 offset:51200
  v_mfma_f32_16x16x32_bf16 a[188:191], v[64:67], v[136:139], a[188:191]
  v_mfma_f32_16x16x32_bf16 a[192:195], v[68:71], v[108:111], a[192:195]
  v_mfma_f32_16x16x32_bf16 a[196:199], v[68:71], v[112:115], a[196:199]
  v_mfma_f32_16x16x32_bf16 a[200:203], v[68:71], v[116:119], a[200:203]
  v_mfma_f32_16x16x32_bf16 a[204:207], v[68:71], v[120:123], a[204:207]
  v_mfma_f32_16x16x32_bf16 a[208:211], v[68:71], v[124:127], a[208:211]
  v_mfma_f32_16x16x32_bf16 a[212:215], v[68:71], v[128:131], a[212:215]
  v_mfma_f32_16x16x32_bf16 a[216:219], v[68:71], v[132:135], a[216:219]
  v_mfma_f32_16x16x32_bf16 a[220:223], v[68:71], v[136:139], a[220:223]
  v_mfma_f32_16x16x32_bf16 a[224:227], v[72:75], v[108:111], a[224:227]
  v_mfma_f32_16x16x32_bf16 a[228:231], v[72:75], v[112:115], a[228:231]
  v_mfma_f32_16x16x32_bf16 a[232:235], v[72:75], v[116:119], a[232:235]
  v_mfma_f32_16x16x32_bf16 a[236:239], v[72:75], v[120:123], a[236:239]
  v_mfma_f32_16x16x32_bf16 a[240:243], v[72:75], v[124:127], a[240:243]
  v_mfma_f32_16x16x32_bf16 a[244:247], v[72:75], v[128:131], a[244:247]
  v_mfma_f32_16x16x32_bf16 a[248:251], v[72:75], v[132:135], a[248:251]
  v_mfma_f32_16x16x32_bf16 a[252:255], v[72:75], v[136:139], a[252:255]
  s_waitcnt lgkmcnt(0)
  v_mfma_f32_16x16x32_bf16 a[0:3], v[76:79], v[140:143], a[0:3]
  s_waitcnt vmcnt(0)
  s_barrier
  s_add_u32 m0, s52, 0
  v_mfma_f32_16x16x32_bf16 a[4:7], v[76:79], v[144:147], a[4:7]
  buffer_load_dwordx4 v2, s[8:11], s20 offen  lds
  ds_read_b128 v[44:47], v20 offset:0
  v_mfma_f32_16x16x32_bf16 a[8:11], v[76:79], v[148:151], a[8:11]
  v_mfma_f32_16x16x32_bf16 a[12:15], v[76:79], v[152:155], a[12:15]
  ds_read_b64_tr_b16 v[108:109], v30 offset:32768
  s_add_u32 m0, s53, 0
  v_mfma_f32_16x16x32_bf16 a[16:19], v[76:79], v[156:159], a[16:19]
  buffer_load_dwordx4 v10, s[12:15], s21 offen  lds
  v_mfma_f32_16x16x32_bf16 a[20:23], v[76:79], v[160:163], a[20:23]
  ds_read_b64_tr_b16 v[110:111], v30 offset:34816
  v_mfma_f32_16x16x32_bf16 a[24:27], v[76:79], v[164:167], a[24:27]
  v_mfma_f32_16x16x32_bf16 a[28:31], v[76:79], v[168:171], a[28:31]
  ds_read_b128 v[48:51], v20 offset:2048
  s_add_u32 m0, s52, 1024
  v_mfma_f32_16x16x32_bf16 a[32:35], v[80:83], v[140:143], a[32:35]
  buffer_load_dwordx4 v3, s[8:11], s20 offen  lds
  v_mfma_f32_16x16x32_bf16 a[36:39], v[80:83], v[144:147], a[36:39]
  ds_read_b64_tr_b16 v[112:113], v31 offset:32768
  v_mfma_f32_16x16x32_bf16 a[40:43], v[80:83], v[148:151], a[40:43]
  v_mfma_f32_16x16x32_bf16 a[44:47], v[80:83], v[152:155], a[44:47]
  ds_read_b64_tr_b16 v[114:115], v31 offset:34816
  s_add_u32 m0, s53, 1024
  v_mfma_f32_16x16x32_bf16 a[48:51], v[80:83], v[156:159], a[48:51]
  buffer_load_dwordx4 v11, s[12:15], s21 offen  lds
  v_mfma_f32_16x16x32_bf16 a[52:55], v[80:83], v[160:163], a[52:55]
  ds_read_b128 v[52:55], v20 offset:4096
  v_mfma_f32_16x16x32_bf16 a[56:59], v[80:83], v[164:167], a[56:59]
  s_add_u32 m0, s52, 2048
  v_mfma_f32_16x16x32_bf16 a[60:63], v[80:83], v[168:171], a[60:63]
  buffer_load_dwordx4 v4, s[8:11], s20 offen  lds
  ds_read_b64_tr_b16 v[116:117], v32 offset:32768
  v_mfma_f32_16x16x32_bf16 a[64:67], v[84:87], v[140:143], a[64:67]
  v_mfma_f32_16x16x32_bf16 a[68:71], v[84:87], v[144:147], a[68:71]
  ds_read_b64_tr_b16 v[118:119], v32 offset:34816
  v_mfma_f32_16x16x32_bf16 a[72:75], v[84:87], v[148:151], a[72:75]
  s_add_u32 m0, s53, 2048
  v_mfma_f32_16x16x32_bf16 a[76:79], v[84:87], v[152:155], a[76:79]
  buffer_load_dwordx4 v12, s[12:15], s21 offen  lds
  ds_read_b128 v[56:59], v20 offset:6144
  v_mfma_f32_16x16x32_bf16 a[80:83], v[84:87], v[156:159], a[80:83]
  v_mfma_f32_16x16x32_bf16 a[84:87], v[84:87], v[160:163], a[84:87]
  ds_read_b64_tr_b16 v[120:121], v33 offset:32768
  v_mfma_f32_16x16x32_bf16 a[88:91], v[84:87], v[164:167], a[88:91]
  s_add_u32 m0, s52, 3072
  v_mfma_f32_16x16x32_bf16 a[92:95], v[84:87], v[168:171], a[92:95]
  buffer_load_dwordx4 v5, s[8:11], s20 offen  lds
  ds_read_b64_tr_b16 v[122:123], v33 offset:34816
  v_mfma_f32_16x16x32_bf16 a[96:99], v[88:91], v[140:143], a[96:99]
  v_mfma_f32_16x16x32_bf16 a[100:103], v[88:91], v[144:147], a[100:103]
  ds_read_b128 v[60:63], v20 offset:8192
  s_add_u32 m0, s53, 3072
  v_mfma_f32_16x16x32_bf16 a[104:107], v[88:91], v[148:151], a[104:107]
  buffer_load_dwordx4 v13, s[12:15], s21 offen  lds
  v_mfma_f32_16x16x32_bf16 a[108:111], v[88:91], v[152:155], a[108:111]
  ds_read_b64_tr_b16 v[124:125], v34 offset:32768
  v_mfma_f32_16x16x32_bf16 a[112:115], v[88:91], v[156:159], a[112:115]
  v_mfma_f32_16x16x32_bf16 a[116:119], v[88:91], v[160:163], a[116:119]
  ds_read_b64_tr_b16 v[126:127], v34 offset:34816
  s_add_u32 m0, s52, 4096
  v_mfma_f32_16x16x32_bf16 a[120:123], v[88:91], v[164:167], a[120:123]
  buffer_load_dwordx4 v6, s[8:11], s20 offen  lds
  v_mfma_f32_16x16x32_bf16 a[124:127], v[88:91], v[168:171], a[124:127]
  ds_read_b128 v[64:67], v20 offset:10240
  v_mfma_f32_16x16x32_bf16 a[128:131], v[92:95], v[140:143], a[128:131]
  v_mfma_f32_16x16x32_bf16 a[132:135], v[92:95], v[144:147], a[132:135]
  ds_read_b64_tr_b16 v[128:129], v35 offset:32768
  s_add_u32 m0, s53, 4096
  v_mfma_f32_16x16x32_bf16 a[136:139], v[92:95], v[148:151], a[136:139]
  buffer_load_dwordx4 v14, s[12:15], s21 offen  lds
  v_mfma_f32_16x16x32_bf16 a[140:143], v[92:95], v[152:155], a[140:143]
  ds_read_b64_tr_b16 v[130:131], v35 offset:34816
  v_mfma_f32_16x16x32_bf16 a[144:147], v[92:95], v[156:159], a[144:147]
  v_mfma_f32_16x16x32_bf16 a[148:151], v[92:95], v[160:163], a[148:151]
  ds_read_b128 v[68:71], v20 offset:12288
  s_add_u32 m0, s52, 5120
  v_mfma_f32_16x16x32_bf16 a[152:155], v[92:95], v[164:167], a[152:155]
  buffer_load_dwordx4 v7, s[8:11], s20 offen  lds
  v_mfma_f32_16x16x32_bf16 a[156:159], v[92:95], v[168:171], a[156:159]
  ds_read_b64_tr_b16 v[132:133], v36 offset:32768
  v_mfma_f32_16x16x32_bf16 a[160:163], v[96:99], v[140:143], a[160:163]
  s_add_u32 m0, s53, 5120
  v_mfma_f32_16x16x32_bf16 a[164:167], v[96:99], v[144:147], a[164:167]
  buffer_load_dwordx4 v15, s[12:15], s21 offen  lds
  ds_read_b64_tr_b16 v[134:135], v36 offset:34816
  v_mfma_f32_16x16x32_bf16 a[168:171], v[96:99], v[148:151], a[168:171]
  v_mfma_f32_16x16x32_bf16 a[172:175], v[96:99], v[152:155], a[172:175]
  ds_read_b128 v[72:75], v20 offset:14336
  v_mfma_f32_16x16x32_bf16 a[176:179], v[96:99], v[156:159], a[176:179]
  s_add_u32 m0, s52, 6144
  v_mfma_f32_16x16x32_bf16 a[180:183], v[96:99], v[160:163], a[180:183]
  buffer_load_dwordx4 v8, s[8:11], s20 offen  lds
  ds_read_b64_tr_b16 v[136:137], v37 offset:32768
  v_mfma_f32_16x16x32_bf16 a[184:187], v[96:99], v[164:167], a[184:187]
  v_mfma_f32_16x16x32_bf16 a[188:191], v[96:99], v[168:171], a[188:191]
  ds_read_b64_tr_b16 v[138:139], v37 offset:34816
  v_mfma_f32_16x16x32_bf16 a[192:195], v[100:103], v[140:143], a[192:195]
  s_add_u32 m0, s53, 6144
  v_mfma_f32_16x16x32_bf16 a[196:199], v[100:103], v[144:147], a[196:199]
  buffer_load_dwordx4 v16, s[12:15], s21 offen  lds
  v_mfma_f32_16x16x32_bf16 a[200:203], v[100:103], v[148:151], a[200:203]
  v_mfma_f32_16x16x32_bf16 a[204:207], v[100:103], v[152:155], a[204:207]
  s_add_u32 m0, s52, 7168
  v_mfma_f32_16x16x32_bf16 a[208:211], v[100:103], v[156:159], a[208:211]
  buffer_load_dwordx4 v9, s[8:11], s20 offen  lds
  v_mfma_f32_16x16x32_bf16 a[212:215], v[100:103], v[160:163], a[212:215]
  v_mfma_f32_16x16x32_bf16 a[216:219], v[100:103], v[164:167], a[216:219]
  v_mfma_f32_16x16x32_bf16 a[220:223], v[100:103], v[168:171], a[220:223]
  s_add_u32 m0, s53, 7168
  v_mfma_f32_16x16x32_bf16 a[224:227], v[104:107], v[140:143], a[224:227]
  buffer_load_dwordx4 v17, s[12:15], s21 offen  lds
  v_mfma_f32_16x16x32_bf16 a[228:231], v[104:107], v[144:147], a[228:231]
  v_mfma_f32_16x16x32_bf16 a[232:235], v[104:107], v[148:151], a[232:235]
  v_mfma_f32_16x16x32_bf16 a[236:239], v[104:107], v[152:155], a[236:239]
  s_add_u32 s20, s20, 128
  v_mfma_f32_16x16x32_bf16 a[240:243], v[104:107], v[156:159], a[240:243]
  s_add_u32 s21, s21, s51
  v_mfma_f32_16x16x32_bf16 a[244:247], v[104:107], v[160:163], a[244:247]
  v_mfma_f32_16x16x32_bf16 a[248:251], v[104:107], v[164:167], a[248:251]
  v_mfma_f32_16x16x32_bf16 a[252:255], v[104:107], v[168:171], a[252:255]
  s_waitcnt lgkmcnt(0)
  v_mfma_f32_16x16x32_bf16 a[0:3], v[44:47], v[108:111], a[0:3]
  ds_read_b128 v[76:79], v21 offset:0
  v_mfma_f32_16x16x32_bf16 a[4:7], v[44:47], v[112:115], a[4:7]
  v_mfma_f32_16x16x32_bf16 a[8:11], v[44:47], v[116:119], a[8:11]
  ds_read_b64_tr_b16 v[140:141], v30 offset:49152
  v_mfma_f32_16x16x32_bf16 a[12:15], v[44:47], v[120:123], a[12:15]
  v_mfma_f32_16x16x32_bf16 a[16:19], v[44:47], v[124:127], a[16:19]
  ds_read_b64_tr_b16 v[142:143], v30 offset:51200
  v_mfma_f32_16x16x32_bf16 a[20:23], v[44:47], v[128:131], a[20:23]
  v_mfma_f32_16x16x32_bf16 a[24:27], v[44:47], v[132:135], a[24:27]
  ds_read_b128 v[80:83], v21 offset:2048
  v_mfma_f32_16x16x32_bf16 a[28:31], v[44:47], v[136:139], a[28:31]
  v_mfma_f32_16x16x32_bf16 a[32:35], v[48:51], v[108:111], a[32:35]
  ds_read_b64_tr_b16 v[144:145], v31 offset:49152
  v_mfma_f32_16x16x32_bf16 a[36:39], v[48:51], v[112:115], a[36:39]
  v_mfma_f32_16x16x32_bf16 a[40:43], v[48:51], v[116:119], a[40:43]
  ds_read_b64_tr_b16 v[146:147], v31 offset:51200
  v_mfma_f32_16x16x32_bf16 a[44:47], v[48:51], v[120:123], a[44:47]
  v_mfma_f32_16x16x32_bf16 a[48:51], v[48:51], v[124:127], a[48:51]
  ds_read_b128 v[84:87], v21 offset:4096
  v_mfma_f32_16x16x32_bf16 a[52:55], v[48:51], v[128:131], a[52:55]
  v_mfma_f32_16x16x32_bf16 a[56:59], v[48:51], v[132:135], a[56:59]
  ds_read_b64_tr_b16 v[148:149], v32 offset:49152
  v_mfma_f32_16x16x32_bf16 a[60:63], v[48:51], v[136:139], a[60:63]
  v_mfma_f32_16x16x32_bf16 a[64:67], v[52:55], v[108:111], a[64:67]
  ds_read_b64_tr_b16 v[150:151], v32 offset:51200
  v_mfma_f32_16x16x32_bf16 a[68:71], v[52:55], v[112:115], a[68:71]
  v_mfma_f32_16x16x32_bf16 a[72:75], v[52:55], v[116:119], a[72:75]
  ds_read_b128 v[88:91], v21 offset:6144
  v_mfma_f32_16x16x32_bf16 a[76:79], v[52:55], v[120:123], a[76:79]
  v_mfma_f32_16x16x32_bf16 a[80:83], v[52:55], v[124:127], a[80:83]
  ds_read_b64_tr_b16 v[152:153], v33 offset:49152
  v_mfma_f32_16x16x32_bf16 a[84:87], v[52:55], v[128:131], a[84:87]
  v_mfma_f32_16x16x32_bf16 a[88:91], v[52:55], v[132:135], a[88:91]
  ds_read_b64_tr_b16 v[154:155], v33 offset:51200
  v_mfma_f32_16x16x32_bf16 a[92:95], v[52:55], v[136:139], a[92:95]
  v_mfma_f32_16x16x32_bf16 a[96:99], v[56:59], v[108:111], a[96:99]
  ds_read_b128 v[92:95], v21 offset:8192
  v_mfma_f32_16x16x32_bf16 a[100:103], v[56:59], v[112:115], a[100:103]
  v_mfma_f32_16x16x32_bf16 a[104:107], v[56:59], v[116:119], a[104:107]
  ds_read_b64_tr_b16 v[156:157], v34 offset:49152
  v_mfma_f32_16x16x32_bf16 a[108:111], v[56:59], v[120:123], a[108:111]
  v_mfma_f32_16x16x32_bf16 a[112:115], v[56:59], v[124:127], a[112:115]
  ds_read_b64_tr_b16 v[158:159], v34 offset:51200
  v_mfma_f32_16x16x32_bf16 a[116:119], v[56:59], v[128:131], a[116:119]
  v_mfma_f32_16x16x32_bf16 a[120:123], v[56:59], v[132:135], a[120:123]
  ds_read_b128 v[96:99], v21 offset:10240
  v_mfma_f32_16x16x32_bf16 a[124:127], v[56:59], v[136:139], a[124:127]
  v_mfma_f32_16x16x32_bf16 a[128:131], v[60:63], v[108:111], a[128:131]
  ds_read_b64_tr_b16 v[160:161], v35 offset:49152
  v_mfma_f32_16x16x32_bf16 a[132:135], v[60:63], v[112:115], a[132:135]
  v_mfma_f32_16x16x32_bf16 a[136:139], v[60:63], v[116:119], a[136:139]
  ds_read_b64_tr_b16 v[162:163], v35 offset:51200
  v_mfma_f32_16x16x32_bf16 a[140:143], v[60:63], v[120:123], a[140:143]
  v_mfma_f32_16x16x32_bf16 a[144:147], v[60:63], v[124:127], a[144:147]
  ds_read_b128 v[100:103], v21 offset:12288
  v_mfma_f32_16x16x32_bf16 a[148:151], v[60:63], v[128:131], a[148:151]
  v_mfma_f32_16x16x32_bf16 a[152:155], v[60:63], v[132:135], a[152:155]
  ds_read_b64_tr_b16 v[164:165], v36 offset:49152
  v_mfma_f32_16x16x32_bf16 a[156:159], v[60:63], v[136:139], a[156:159]
  v_mfma_f32_16x16x32_bf16 a[160:163], v[64:67], v[108:111], a[160:163]
  ds_read_b64_tr_b16 v[166:167], v36 offset:51200
  v_mfma_f32_16x16x32_bf16 a[164:167], v[64:67], v[112:115], a[164:167]
  v_mfma_f32_16x16x32_bf16 a[168:171], v[64:67], v[116:119], a[168:171]
  ds_read_b128 v[104:107], v21 offset:14336
  v_mfma_f32_16x16x32_bf16 a[172:175], v[64:67], v[120:123], a[172:175]
  v_mfma_f32_16x16x32_bf16 a[176:179], v[64:67], v[124:127], a[176:179]
  ds_read_b64_tr_b16 v[168:169], v37 offset:49152
  v_mfma_f32_16x16x32_bf16 a[180:183], v[64:67], v[128:131], a[180:183]
  v_mfma_f32_16x16x32_bf16 a[184:187], v[64:67], v[132:135], a[184:187]
  ds_read_b64_tr_b16 v[170:171], v37 offset:51200
  v_mfma_f32_16x16x32_bf16 a[188:191], v[64:67], v[136:139], a[188:191]
  v_mfma_f32_16x16x32_bf16 a[192:195], v[68:71], v[108:111], a[192:195]
  v_mfma_f32_16x16x32_bf16 a[196:199], v[68:71], v[112:115], a[196:199]
  v_mfma_f32_16x16x32_bf16 a[200:203], v[68:71], v[116:119], a[200:203]
  v_mfma_f32_16x16x32_bf16 a[204:207], v[68:71], v[120:123], a[204:207]
  v_mfma_f32_16x16x32_bf16 a[208:211], v[68:71], v[124:127], a[208:211]
  v_mfma_f32_16x16x32_bf16 a[212:215], v[68:71], v[128:131], a[212:215]
  v_mfma_f32_16x16x32_bf16 a[216:219], v[68:71], v[132:135], a[216:219]
  v_mfma_f32_16x16x32_bf16 a[220:223], v[68:71], v[136:139], a[220:223]
  v_mfma_f32_16x16x32_bf16 a[224:227], v[72:75], v[108:111], a[224:227]
  v_mfma_f32_16x16x32_bf16 a[228:231], v[72:75], v[112:115], a[228:231]
  v_mfma_f32_16x16x32_bf16 a[232:235], v[72:75], v[116:119], a[232:235]
  v_mfma_f32_16x16x32_bf16 a[236:239], v[72:75], v[120:123], a[236:239]
  v_mfma_f32_16x16x32_bf16 a[240:243], v[72:75], v[124:127], a[240:243]
  v_mfma_f32_16x16x32_bf16 a[244:247], v[72:75], v[128:131], a[244:247]
  v_mfma_f32_16x16x32_bf16 a[248:251], v[72:75], v[132:135], a[248:251]
  v_mfma_f32_16x16x32_bf16 a[252:255], v[72:75], v[136:139], a[252:255]
  s_waitcnt lgkmcnt(0)
  v_mfma_f32_16x16x32_bf16 a[0:3], v[76:79], v[140:143], a[0:3]
  s_waitcnt vmcnt(0)
  s_barrier
  s_add_u32 m0, s52, 65536
  v_mfma_f32_16x16x32_bf16 a[4:7], v[76:79], v[144:147], a[4:7]
  buffer_load_dwordx4 v2, s[8:11], s20 offen  lds
  ds_read_b128 v[44:47], v18 offset:0
  v_mfma_f32_16x16x32_bf16 a[8:11], v[76:79], v[148:151], a[8:11]
  v_mfma_f32_16x16x32_bf16 a[12:15], v[76:79], v[152:155], a[12:15]
  ds_read_b64_tr_b16 v[108:109], v22 offset:32768
  s_add_u32 m0, s53, 65536
  v_mfma_f32_16x16x32_bf16 a[16:19], v[76:79], v[156:159], a[16:19]
  buffer_load_dwordx4 v10, s[12:15], s21 offen  lds
  v_mfma_f32_16x16x32_bf16 a[20:23], v[76:79], v[160:163], a[20:23]
  ds_read_b64_tr_b16 v[110:111], v22 offset:34816
  v_mfma_f32_16x16x32_bf16 a[24:27], v[76:79], v[164:167], a[24:27]
  v_mfma_f32_16x16x32_bf16 a[28:31], v[76:79], v[168:171], a[28:31]
  ds_read_b128 v[48:51], v18 offset:2048
  s_add_u32 m0, s52, 66560
  v_mfma_f32_16x16x32_bf16 a[32:35], v[80:83], v[140:143], a[32:35]
  buffer_load_dwordx4 v3, s[8:11], s20 offen  lds
  v_mfma_f32_16x16x32_bf16 a[36:39], v[80:83], v[144:147], a[36:39]
  ds_read_b64_tr_b16 v[112:113], v23 offset:32768
  v_mfma_f32_16x16x32_bf16 a[40:43], v[80:83], v[148:151], a[40:43]
  v_mfma_f32_16x16x32_bf16 a[44:47], v[80:83], v[152:155], a[44:47]
  ds_read_b64_tr_b16 v[114:115], v23 offset:34816
  s_add_u32 m0, s53, 66560
  v_mfma_f32_16x16x32_bf16 a[48:51], v[80:83], v[156:159], a[48:51]
  buffer_load_dwordx4 v11, s[12:15], s21 offen  lds
  v_mfma_f32_16x16x32_bf16 a[52:55], v[80:83], v[160:163], a[52:55]
  ds_read_b128 v[52:55], v18 offset:4096
  v_mfma_f32_16x16x32_bf16 a[56:59], v[80:83], v[164:167], a[56:59]
  s_add_u32 m0, s52, 67584
  v_mfma_f32_16x16x32_bf16 a[60:63], v[80:83], v[168:171], a[60:63]
  buffer_load_dwordx4 v4, s[8:11], s20 offen  lds
  ds_read_b64_tr_b16 v[116:117], v24 offset:32768
  v_mfma_f32_16x16x32_bf16 a[64:67], v[84:87], v[140:143], a[64:67]
  v_mfma_f32_16x16x32_bf16 a[68:71], v[84:87], v[144:147], a[68:71]
  ds_read_b64_tr_b16 v[118:119], v24 offset:34816
  v_mfma_f32_16x16x32_bf16 a[72:75], v[84:87], v[148:151], a[72:75]
  s_add_u32 m0, s53, 67584
  v_mfma_f32_16x16x32_bf16 a[76:79], v[84:87], v[152:155], a[76:79]
  buffer_load_dwordx4 v12, s[12:15], s21 offen  lds
  ds_read_b128 v[56:59], v18 offset:6144
  v_mfma_f32_16x16x32_bf16 a[80:83], v[84:87], v[156:159], a[80:83]
  v_mfma_f32_16x16x32_bf16 a[84:87], v[84:87], v[160:163], a[84:87]
  ds_read_b64_tr_b16 v[120:121], v25 offset:32768
  v_mfma_f32_16x16x32_bf16 a[88:91], v[84:87], v[164:167], a[88:91]
  s_add_u32 m0, s52, 68608
  v_mfma_f32_16x16x32_bf16 a[92:95], v[84:87], v[168:171], a[92:95]
  buffer_load_dwordx4 v5, s[8:11], s20 offen  lds
  ds_read_b64_tr_b16 v[122:123], v25 offset:34816
  v_mfma_f32_16x16x32_bf16 a[96:99], v[88:91], v[140:143], a[96:99]
  v_mfma_f32_16x16x32_bf16 a[100:103], v[88:91], v[144:147], a[100:103]
  ds_read_b128 v[60:63], v18 offset:8192
  s_add_u32 m0, s53, 68608
  v_mfma_f32_16x16x32_bf16 a[104:107], v[88:91], v[148:151], a[104:107]
  buffer_load_dwordx4 v13, s[12:15], s21 offen  lds
  v_mfma_f32_16x16x32_bf16 a[108:111], v[88:91], v[152:155], a[108:111]
  ds_read_b64_tr_b16 v[124:125], v26 offset:32768
  v_mfma_f32_16x16x32_bf16 a[112:115], v[88:91], v[156:159], a[112:115]
  v_mfma_f32_16x16x32_bf16 a[116:119], v[88:91], v[160:163], a[116:119]
  ds_read_b64_tr_b16 v[126:127], v26 offset:34816
  s_add_u32 m0, s52, 69632
  v_mfma_f32_16x16x32_bf16 a[120:123], v[88:91], v[164:167], a[120:123]
  buffer_load_dwordx4 v6, s[8:11], s20 offen  lds
  v_mfma_f32_16x16x32_bf16 a[124:127], v[88:91], v[168:171], a[124:127]
  ds_read_b128 v[64:67], v18 offset:10240
  v_mfma_f32_16x16x32_bf16 a[128:131], v[92:95], v[140:143], a[128:131]
  v_mfma_f32_16x16x32_bf16 a[132:135], v[92:95], v[144:147], a[132:135]
  ds_read_b64_tr_b16 v[128:129], v27 offset:32768
  s_add_u32 m0, s53, 69632
  v_mfma_f32_16x16x32_bf16 a[136:139], v[92:95], v[148:151], a[136:139]
  buffer_load_dwordx4 v14, s[12:15], s21 offen  lds
  v_mfma_f32_16x16x32_bf16 a[140:143], v[92:95], v[152:155], a[140:143]
  ds_read_b64_tr_b16 v[130:131], v27 offset:34816
  v_mfma_f32_16x16x32_bf16 a[144:147], v[92:95], v[156:159], a[144:147]
  v_mfma_f32_16x16x32_bf16 a[148:151], v[92:95], v[160:163], a[148:151]
  ds_read_b128 v[68:71], v18 offset:12288
  s_add_u32 m0, s52, 70656
  v_mfma_f32_16x16x32_bf16 a[152:155], v[92:95], v[164:167], a[152:155]
  buffer_load_dwordx4 v7, s[8:11], s20 offen  lds
  v_mfma_f32_16x16x32_bf16 a[156:159], v[92:95], v[168:171], a[156:159]
  ds_read_b64_tr_b16 v[132:133], v28 offset:32768
  v_mfma_f32_16x16x32_bf16 a[160:163], v[96:99], v[140:143], a[160:163]
  s_add_u32 m0, s53, 70656
  v_mfma_f32_16x16x32_bf16 a[164:167], v[96:99], v[144:147], a[164:167]
  buffer_load_dwordx4 v15, s[12:15], s21 offen  lds
  ds_read_b64_tr_b16 v[134:135], v28 offset:34816
  v_mfma_f32_16x16x32_bf16 a[168:171], v[96:99], v[148:151], a[168:171]
  v_mfma_f32_16x16x32_bf16 a[172:175], v[96:99], v[152:155], a[172:175]
  ds_read_b128 v[72:75], v18 offset:14336
  v_mfma_f32_16x16x32_bf16 a[176:179], v[96:99], v[156:159], a[176:179]
  s_add_u32 m0, s52, 71680
  v_mfma_f32_16x16x32_bf16 a[180:183], v[96:99], v[160:163], a[180:183]
  buffer_load_dwordx4 v8, s[8:11], s20 offen  lds
  ds_read_b64_tr_b16 v[136:137], v29 offset:32768
  v_mfma_f32_16x16x32_bf16 a[184:187], v[96:99], v[164:167], a[184:187]
  v_mfma_f32_16x16x32_bf16 a[188:191], v[96:99], v[168:171], a[188:191]
  ds_read_b64_tr_b16 v[138:139], v29 offset:34816
  v_mfma_f32_16x16x32_bf16 a[192:195], v[100:103], v[140:143], a[192:195]
  s_add_u32 m0, s53, 71680
  v_mfma_f32_16x16x32_bf16 a[196:199], v[100:103], v[144:147], a[196:199]
  buffer_load_dwordx4 v16, s[12:15], s21 offen  lds
  v_mfma_f32_16x16x32_bf16 a[200:203], v[100:103], v[148:151], a[200:203]
  v_mfma_f32_16x16x32_bf16 a[204:207], v[100:103], v[152:155], a[204:207]
  s_add_u32 m0, s52, 72704
  v_mfma_f32_16x16x32_bf16 a[208:211], v[100:103], v[156:159], a[208:211]
  buffer_load_dwordx4 v9, s[8:11], s20 offen  lds
  v_mfma_f32_16x16x32_bf16 a[212:215], v[100:103], v[160:163], a[212:215]
  v_mfma_f32_16x16x32_bf16 a[216:219], v[100:103], v[164:167], a[216:219]
  v_mfma_f32_16x16x32_bf16 a[220:223], v[100:103], v[168:171], a[220:223]
  s_add_u32 m0, s53, 72704
  v_mfma_f32_16x16x32_bf16 a[224:227], v[104:107], v[140:143], a[224:227]
  buffer_load_dwordx4 v17, s[12:15], s21 offen  lds
  v_mfma_f32_16x16x32_bf16 a[228:231], v[104:107], v[144:147], a[228:231]
  v_mfma_f32_16x16x32_bf16 a[232:235], v[104:107], v[148:151], a[232:235]
  v_mfma_f32_16x16x32_bf16 a[236:239], v[104:107], v[152:155], a[236:239]
  s_add_u32 s20, s20, 128
  v_mfma_f32_16x16x32_bf16 a[240:243], v[104:107], v[156:159], a[240:243]
  s_add_u32 s21, s21, s51
  v_mfma_f32_16x16x32_bf16 a[244:247], v[104:107], v[160:163], a[244:247]
  v_mfma_f32_16x16x32_bf16 a[248:251], v[104:107], v[164:167], a[248:251]
  v_mfma_f32_16x16x32_bf16 a[252:255], v[104:107], v[168:171], a[252:255]
  s_branch L_g2_loop
L_g2_fin:
  s_cmp_lg_u32 s32, 0
  s_cbranch_scc1 L_rq_7
  s_cmp_eq_u32 s39, 0
  s_cbranch_scc1 L_rq_7
  s_lshl_b32 s99, s33, 7
  s_add_u32 s99, s99, 0x3d00200
  v_mov_b32 v244, 1
  v_mov_b32 v245, 0
  s_mov_b64 exec, 1
  buffer_atomic_add v244, v245, s[4:7], s99 offen sc0 sc1
  s_mov_b64 exec, -1
L_rq_7:
  s_waitcnt lgkmcnt(0)
  v_mfma_f32_16x16x32_bf16 a[0:3], v[44:47], v[108:111], a[0:3]
  ds_read_b128 v[76:79], v19 offset:0
  v_mfma_f32_16x16x32_bf16 a[4:7], v[44:47], v[112:115], a[4:7]
  v_mfma_f32_16x16x32_bf16 a[8:11], v[44:47], v[116:119], a[8:11]
  ds_read_b64_tr_b16 v[140:141], v22 offset:49152
  v_mfma_f32_16x16x32_bf16 a[12:15], v[44:47], v[120:123], a[12:15]
  v_mfma_f32_16x16x32_bf16 a[16:19], v[44:47], v[124:127], a[16:19]
  ds_read_b64_tr_b16 v[142:143], v22 offset:51200
  v_mfma_f32_16x16x32_bf16 a[20:23], v[44:47], v[128:131], a[20:23]
  v_mfma_f32_16x16x32_bf16 a[24:27], v[44:47], v[132:135], a[24:27]
  ds_read_b128 v[80:83], v19 offset:2048
  v_mfma_f32_16x16x32_bf16 a[28:31], v[44:47], v[136:139], a[28:31]
  v_mfma_f32_16x16x32_bf16 a[32:35], v[48:51], v[108:111], a[32:35]
  ds_read_b64_tr_b16 v[144:145], v23 offset:49152
  v_mfma_f32_16x16x32_bf16 a[36:39], v[48:51], v[112:115], a[36:39]
  v_mfma_f32_16x16x32_bf16 a[40:43], v[48:51], v[116:119], a[40:43]
  ds_read_b64_tr_b16 v[146:147], v23 offset:51200
  v_mfma_f32_16x16x32_bf16 a[44:47], v[48:51], v[120:123], a[44:47]
  v_mfma_f32_16x16x32_bf16 a[48:51], v[48:51], v[124:127], a[48:51]
  ds_read_b128 v[84:87], v19 offset:4096
  v_mfma_f32_16x16x32_bf16 a[52:55], v[48:51], v[128:131], a[52:55]
  v_mfma_f32_16x16x32_bf16 a[56:59], v[48:51], v[132:135], a[56:59]
  ds_read_b64_tr_b16 v[148:149], v24 offset:49152
  v_mfma_f32_16x16x32_bf16 a[60:63], v[48:51], v[136:139], a[60:63]
  v_mfma_f32_16x16x32_bf16 a[64:67], v[52:55], v[108:111], a[64:67]
  ds_read_b64_tr_b16 v[150:151], v24 offset:51200
  v_mfma_f32_16x16x32_bf16 a[68:71], v[52:55], v[112:115], a[68:71]
  v_mfma_f32_16x16x32_bf16 a[72:75], v[52:55], v[116:119], a[72:75]
  ds_read_b128 v[88:91], v19 offset:6144
  v_mfma_f32_16x16x32_bf16 a[76:79], v[52:55], v[120:123], a[76:79]
  v_mfma_f32_16x16x32_bf16 a[80:83], v[52:55], v[124:127], a[80:83]
  ds_read_b64_tr_b16 v[152:153], v25 offset:49152
  v_mfma_f32_16x16x32_bf16 a[84:87], v[52:55], v[128:131], a[84:87]
  v_mfma_f32_16x16x32_bf16 a[88:91], v[52:55], v[132:135], a[88:91]
  ds_read_b64_tr_b16 v[154:155], v25 offset:51200
  v_mfma_f32_16x16x32_bf16 a[92:95], v[52:55], v[136:139], a[92:95]
  v_mfma_f32_16x16x32_bf16 a[96:99], v[56:59], v[108:111], a[96:99]
  ds_read_b128 v[92:95], v19 offset:8192
  v_mfma_f32_16x16x32_bf16 a[100:103], v[56:59], v[112:115], a[100:103]
  v_mfma_f32_16x16x32_bf16 a[104:107], v[56:59], v[116:119], a[104:107]
  ds_read_b64_tr_b16 v[156:157], v26 offset:49152
  v_mfma_f32_16x16x32_bf16 a[108:111], v[56:59], v[120:123], a[108:111]
  v_mfma_f32_16x16x32_bf16 a[112:115], v[56:59], v[124:127], a[112:115]
  ds_read_b64_tr_b16 v[158:159], v26 offset:51200
  v_mfma_f32_16x16x32_bf16 a[116:119], v[56:59], v[128:131], a[116:119]
  v_mfma_f32_16x16x32_bf16 a[120:123], v[56:59], v[132:135], a[120:123]
  ds_read_b128 v[96:99], v19 offset:10240
  v_mfma_f32_16x16x32_bf16 a[124:127], v[56:59], v[136:139], a[124:127]
  v_mfma_f32_16x16x32_bf16 a[128:131], v[60:63], v[108:111], a[128:131]
  ds_read_b64_tr_b16 v[160:161], v27 offset:49152
  v_mfma_f32_16x16x32_bf16 a[132:135], v[60:63], v[112:115], a[132:135]
  v_mfma_f32_16x16x32_bf16 a[136:139], v[60:63], v[116:119], a[136:139]
  ds_read_b64_tr_b16 v[162:163], v27 offset:51200
  v_mfma_f32_16x16x32_bf16 a[140:143], v[60:63], v[120:123], a[140:143]
  v_mfma_f32_16x16x32_bf16 a[144:147], v[60:63], v[124:127], a[144:147]
  ds_read_b128 v[100:103], v19 offset:12288
  v_mfma_f32_16x16x32_bf16 a[148:151], v[60:63], v[128:131], a[148:151]
  v_mfma_f32_16x16x32_bf16 a[152:155], v[60:63], v[132:135], a[152:155]
  ds_read_b64_tr_b16 v[164:165], v28 offset:49152
  v_mfma_f32_16x16x32_bf16 a[156:159], v[60:63], v[136:139], a[156:159]
  v_mfma_f32_16x16x32_bf16 a[160:163], v[64:67], v[108:111], a[160:163]
  ds_read_b64_tr_b16 v[166:167], v28 offset:51200
  v_mfma_f32_16x16x32_bf16 a[164:167], v[64:67], v[112:115], a[164:167]
  v_mfma_f32_16x16x32_bf16 a[168:171], v[64:67], v[116:119], a[168:171]
  ds_read_b128 v[104:107], v19 offset:14336
  v_mfma_f32_16x16x32_bf16 a[172:175], v[64:67], v[120:123], a[172:175]
  v_mfma_f32_16x16x32_bf16 a[176:179], v[64:67], v[124:127], a[176:179]
  ds_read_b64_tr_b16 v[168:169], v29 offset:49152
  v_mfma_f32_16x16x32_bf16 a[180:183], v[64:67], v[128:131], a[180:183]
  v_mfma_f32_16x16x32_bf16 a[184:187], v[64:67], v[132:135], a[184:187]
  ds_read_b64_tr_b16 v[170:171], v29 offset:51200
  v_mfma_f32_16x16x32_bf16 a[188:191], v[64:67], v[136:139], a[188:191]
  v_mfma_f32_16x16x32_bf16 a[192:195], v[68:71], v[108:111], a[192:195]
  v_mfma_f32_16x16x32_bf16 a[196:199], v[68:71], v[112:115], a[196:199]
  v_mfma_f32_16x16x32_bf16 a[200:203], v[68:71], v[116:119], a[200:203]
  v_mfma_f32_16x16x32_bf16 a[204:207], v[68:71], v[120:123], a[204:207]
  v_mfma_f32_16x16x32_bf16 a[208:211], v[68:71], v[124:127], a[208:211]
  v_mfma_f32_16x16x32_bf16 a[212:215], v[68:71], v[128:131], a[212:215]
  v_mfma_f32_16x16x32_bf16 a[216:219], v[68:71], v[132:135], a[216:219]
  v_mfma_f32_16x16x32_bf16 a[220:223], v[68:71], v[136:139], a[220:223]
  v_mfma_f32_16x16x32_bf16 a[224:227], v[72:75], v[108:111], a[224:227]
  v_mfma_f32_16x16x32_bf16 a[228:231], v[72:75], v[112:115], a[228:231]
  v_mfma_f32_16x16x32_bf16 a[232:235], v[72:75], v[116:119], a[232:235]
  v_mfma_f32_16x16x32_bf16 a[236:239], v[72:75], v[120:123], a[236:239]
  v_mfma_f32_16x16x32_bf16 a[240:243], v[72:75], v[124:127], a[240:243]
  v_mfma_f32_16x16x32_bf16 a[244:247], v[72:75], v[128:131], a[244:247]
  v_mfma_f32_16x16x32_bf16 a[248:251], v[72:75], v[132:135], a[248:251]
  v_mfma_f32_16x16x32_bf16 a[252:255], v[72:75], v[136:139], a[252:255]
  s_waitcnt lgkmcnt(0)
  v_mfma_f32_16x16x32_bf16 a[0:3], v[76:79], v[140:143], a[0:3]
  s_waitcnt vmcnt(0)
  s_barrier
  v_mfma_f32_16x16x32_bf16 a[4:7], v[76:79], v[144:147], a[4:7]
  ds_read_b128 v[44:47], v20 offset:0
  v_mfma_f32_16x16x32_bf16 a[8:11], v[76:79], v[148:151], a[8:11]
  v_mfma_f32_16x16x32_bf16 a[12:15], v[76:79], v[152:155], a[12:15]
  ds_read_b64_tr_b16 v[108:109], v30 offset:32768
  v_mfma_f32_16x16x32_bf16 a[16:19], v[76:79], v[156:159], a[16:19]
  v_mfma_f32_16x16x32_bf16 a[20:23], v[76:79], v[160:163], a[20:23]
  ds_read_b64_tr_b16 v[110:111], v30 offset:34816
  v_mfma_f32_16x16x32_bf16 a[24:27], v[76:79], v[164:167], a[24:27]
  v_mfma_f32_16x16x32_bf16 a[28:31], v[76:79], v[168:171], a[28:31]
  ds_read_b128 v[48:51], v20 offset:2048
  v_mfma_f32_16x16x32_bf16 a[32:35], v[80:83], v[140:143], a[32:35]
  v_mfma_f32_16x16x32_bf16 a[36:39], v[80:83], v[144:147], a[36:39]
  ds_read_b64_tr_b16 v[112:113], v31 offset:32768
  v_mfma_f32_16x16x32_bf16 a[40:43], v[80:83], v[148:151], a[40:43]
  v_mfma_f32_16x16x32_bf16 a[44:47], v[80:83], v[152:155], a[44:47]
  ds_read_b64_tr_b16 v[114:115], v31 offset:34816
  v_mfma_f32_16x16x32_bf16 a[48:51], v[80:83], v[156:159], a[48:51]
  v_mfma_f32_16x16x32_bf16 a[52:55], v[80:83], v[160:163], a[52:55]
  ds_read_b128 v[52:55], v20 offset:4096
  v_mfma_f32_16x16x32_bf16 a[56:59], v[80:83], v[164:167], a[56:59]
  v_mfma_f32_16x16x32_bf16 a[60:63], v[80:83], v[168:171], a[60:63]
  ds_read_b64_tr_b16 v[116:117], v32 offset:32768
  v_mfma_f32_16x16x32_bf16 a[64:67], v[84:87], v[140:143], a[64:67]
  v_mfma_f32_16x16x32_bf16 a[68:71], v[84:87], v[144:147], a[68:71]
  ds_read_b64_tr_b16 v[118:119], v32 offset:34816
  v_mfma_f32_16x16x32_bf16 a[72:75], v[84:87], v[148:151], a[72:75]
  v_mfma_f32_16x16x32_bf16 a[76:79], v[84:87], v[152:155], a[76:79]
  ds_read_b128 v[56:59], v20 offset:6144
  v_mfma_f32_16x16x32_bf16 a[80:83], v[84:87], v[156:159], a[80:83]
  v_mfma_f32_16x16x32_bf16 a[84:87], v[84:87], v[160:163], a[84:87]
  ds_read_b64_tr_b16 v[120:121], v33 offset:32768
  v_mfma_f32_16x16x32_bf16 a[88:91], v[84:87], v[164:167], a[88:91]
  v_mfma_f32_16x16x32_bf16 a[92:95], v[84:87], v[168:171], a[92:95]
  ds_read_b64_tr_b16 v[122:123], v33 offset:34816
  v_mfma_f32_16x16x32_bf16 a[96:99], v[88:91], v[140:143], a[96:99]
  v_mfma_f32_16x16x32_bf16 a[100:103], v[88:91], v[144:147], a[100:103]
  ds_read_b128 v[60:63], v20 offset:8192
  v_mfma_f32_16x16x32_bf16 a[104:107], v[88:91], v[148:151], a[104:107]
  v_mfma_f32_16x16x32_bf16 a[108:111], v[88:91], v[152:155], a[108:111]
  ds_read_b64_tr_b16 v[124:125], v34 offset:32768
  v_mfma_f32_16x16x32_bf16 a[112:115], v[88:91], v[156:159], a[112:115]
  v_mfma_f32_16x16x32_bf16 a[116:119], v[88:91], v[160:163], a[116:119]
  ds_read_b64_tr_b16 v[126:127], v34 offset:34816
  v_mfma_f32_16x16x32_bf16 a[120:123], v[88:91], v[164:167], a[120:123]
  v_mfma_f32_16x16x32_bf16 a[124:127], v[88:91], v[168:171], a[124:127]
  ds_read_b128 v[64:67], v20 offset:10240
  v_mfma_f32_16x16x32_bf16 a[128:131], v[92:95], v[140:143], a[128:131]
  v_mfma_f32_16x16x32_bf16 a[132:135], v[92:95], v[144:147], a[132:135]
  ds_read_b64_tr_b16 v[128:129], v35 offset:32768
  v_mfma_f32_16x16x32_bf16 a[136:139], v[92:95], v[148:151], a[136:139]
  v_mfma_f32_16x16x32_bf16 a[140:143], v[92:95], v[152:155], a[140:143]
  ds_read_b64_tr_b16 v[130:131], v35 offset:34816
  v_mfma_f32_16x16x32_bf16 a[144:147], v[92:95], v[156:159], a[144:147]
  v_mfma_f32_16x16x32_bf16 a[148:151], v[92:95], v[160:163], a[148:151]
  ds_read_b128 v[68:71], v20 offset:12288
  v_mfma_f32_16x16x32_bf16 a[152:155], v[92:95], v[164:167], a[152:155]
  v_mfma_f32_16x16x32_bf16 a[156:159], v[92:95], v[168:171], a[156:159]
  ds_read_b64_tr_b16 v[132:133], v36 offset:32768
  v_mfma_f32_16x16x32_bf16 a[160:163], v[96:99], v[140:143], a[160:163]
  v_mfma_f32_16x16x32_bf16 a[164:167], v[96:99], v[144:147], a[164:167]
  ds_read_b64_tr_b16 v[134:135], v36 offset:34816
  v_mfma_f32_16x16x32_bf16 a[168:171], v[96:99], v[148:151], a[168:171]
  v_mfma_f32_16x16x32_bf16 a[172:175], v[96:99], v[152:155], a[172:175]
  ds_read_b128 v[72:75], v20 offset:14336
  v_mfma_f32_16x16x32_bf16 a[176:179], v[96:99], v[156:159], a[176:179]
  v_mfma_f32_16x16x32_bf16 a[180:183], v[96:99], v[160:163], a[180:183]
  ds_read_b64_tr_b16 v[136:137], v37 offset:32768
  v_mfma_f32_16x16x32_bf16 a[184:187], v[96:99], v[164:167], a[184:187]
  v_mfma_f32_16x16x32_bf16 a[188:191], v[96:99], v[168:171], a[188:191]
  ds_read_b64_tr_b16 v[138:139], v37 offset:34816
  v_mfma_f32_16x16x32_bf16 a[192:195], v[100:103], v[140:143], a[192:195]
  v_mfma_f32_16x16x32_bf16 a[196:199], v[100:103], v[144:147], a[196:199]
  v_mfma_f32_16x16x32_bf16 a[200:203], v[100:103], v[148:151], a[200:203]
  v_mfma_f32_16x16x32_bf16 a[204:207], v[100:103], v[152:155], a[204:207]
  v_mfma_f32_16x16x32_bf16 a[208:211], v[100:103], v[156:159], a[208:211]
  v_mfma_f32_16x16x32_bf16 a[212:215], v[100:103], v[160:163], a[212:215]
  v_mfma_f32_16x16x32_bf16 a[216:219], v[100:103], v[164:167], a[216:219]
  v_mfma_f32_16x16x32_bf16 a[220:223], v[100:103], v[168:171], a[220:223]
  v_mfma_f32_16x16x32_bf16 a[224:227], v[104:107], v[140:143], a[224:227]
  v_mfma_f32_16x16x32_bf16 a[228:231], v[104:107], v[144:147], a[228:231]
  v_mfma_f32_16x16x32_bf16 a[232:235], v[104:107], v[148:151], a[232:235]
  v_mfma_f32_16x16x32_bf16 a[236:239], v[104:107], v[152:155], a[236:239]
  v_mfma_f32_16x16x32_bf16 a[240:243], v[104:107], v[156:159], a[240:243]
  v_mfma_f32_16x16x32_bf16 a[244:247], v[104:107], v[160:163], a[244:247]
  v_mfma_f32_16x16x32_bf16 a[248:251], v[104:107], v[164:167], a[248:251]
  v_mfma_f32_16x16x32_bf16 a[252:255], v[104:107], v[168:171], a[252:255]
  s_waitcnt lgkmcnt(0)
  v_mfma_f32_16x16x32_bf16 a[0:3], v[44:47], v[108:111], a[0:3]
  ds_read_b128 v[76:79], v21 offset:0
  v_mfma_f32_16x16x32_bf16 a[4:7], v[44:47], v[112:115], a[4:7]
  v_mfma_f32_16x16x32_bf16 a[8:11], v[44:47], v[116:119], a[8:11]
  ds_read_b64_tr_b16 v[140:141], v30 offset:49152
  v_mfma_f32_16x16x32_bf16 a[12:15], v[44:47], v[120:123], a[12:15]
  v_mfma_f32_16x16x32_bf16 a[16:19], v[44:47], v[124:127], a[16:19]
  ds_read_b64_tr_b16 v[142:143], v30 offset:51200
  v_mfma_f32_16x16x32_bf16 a[20:23], v[44:47], v[128:131], a[20:23]
  v_mfma_f32_16x16x32_bf16 a[24:27], v[44:47], v[132:135], a[24:27]
  ds_read_b128 v[80:83], v21 offset:2048
  v_mfma_f32_16x16x32_bf16 a[28:31], v[44:47], v[136:139], a[28:31]
  v_mfma_f32_16x16x32_bf16 a[32:35], v[48:51], v[108:111], a[32:35]
  ds_read_b64_tr_b16 v[144:145], v31 offset:49152
  v_mfma_f32_16x16x32_bf16 a[36:39], v[48:51], v[112:115], a[36:39]
  v_mfma_f32_16x16x32_bf16 a[40:43], v[48:51], v[116:119], a[40:43]
  ds_read_b64_tr_b16 v[146:147], v31 offset:51200
  v_mfma_f32_16x16x32_bf16 a[44:47], v[48:51], v[120:123], a[44:47]
  v_mfma_f32_16x16x32_bf16 a[48:51], v[48:51], v[124:127], a[48:51]
  ds_read_b128 v[84:87], v21 offset:4096
  v_mfma_f32_16x16x32_bf16 a[52:55], v[48:51], v[128:131], a[52:55]
  v_mfma_f32_16x16x32_bf16 a[56:59], v[48:51], v[132:135], a[56:59]
  ds_read_b64_tr_b16 v[148:149], v32 offset:49152
  v_mfma_f32_16x16x32_bf16 a[60:63], v[48:51], v[136:139], a[60:63]
  v_mfma_f32_16x16x32_bf16 a[64:67], v[52:55], v[108:111], a[64:67]
  ds_read_b64_tr_b16 v[150:151], v32 offset:51200
  v_mfma_f32_16x16x32_bf16 a[68:71], v[52:55], v[112:115], a[68:71]
  v_mfma_f32_16x16x32_bf16 a[72:75], v[52:55], v[116:119], a[72:75]
  ds_read_b128 v[88:91], v21 offset:6144
  v_mfma_f32_16x16x32_bf16 a[76:79], v[52:55], v[120:123], a[76:79]
  v_mfma_f32_16x16x32_bf16 a[80:83], v[52:55], v[124:127], a[80:83]
  ds_read_b64_tr_b16 v[152:153], v33 offset:49152
  v_mfma_f32_16x16x32_bf16 a[84:87], v[52:55], v[128:131], a[84:87]
  v_mfma_f32_16x16x32_bf16 a[88:91], v[52:55], v[132:135], a[88:91]
  ds_read_b64_tr_b16 v[154:155], v33 offset:51200
  v_mfma_f32_16x16x32_bf16 a[92:95], v[52:55], v[136:139], a[92:95]
  v_mfma_f32_16x16x32_bf16 a[96:99], v[56:59], v[108:111], a[96:99]
  ds_read_b128 v[92:95], v21 offset:8192
  v_mfma_f32_16x16x32_bf16 a[100:103], v[56:59], v[112:115], a[100:103]
  v_mfma_f32_16x16x32_bf16 a[104:107], v[56:59], v[116:119], a[104:107]
  ds_read_b64_tr_b16 v[156:157], v34 offset:49152
  v_mfma_f32_16x16x32_bf16 a[108:111], v[56:59], v[120:123], a[108:111]
  v_mfma_f32_16x16x32_bf16 a[112:115], v[56:59], v[124:127], a[112:115]
  ds_read_b64_tr_b16 v[158:159], v34 offset:51200
  v_mfma_f32_16x16x32_bf16 a[116:119], v[56:59], v[128:131], a[116:119]
  v_mfma_f32_16x16x32_bf16 a[120:123], v[56:59], v[132:135], a[120:123]
  ds_read_b128 v[96:99], v21 offset:10240
  v_mfma_f32_16x16x32_bf16 a[124:127], v[56:59], v[136:139], a[124:127]
  v_mfma_f32_16x16x32_bf16 a[128:131], v[60:63], v[108:111], a[128:131]
  ds_read_b64_tr_b16 v[160:161], v35 offset:49152
  v_mfma_f32_16x16x32_bf16 a[132:135], v[60:63], v[112:115], a[132:135]
  v_mfma_f32_16x16x32_bf16 a[136:139], v[60:63], v[116:119], a[136:139]
  ds_read_b64_tr_b16 v[162:163], v35 offset:51200
  v_mfma_f32_16x16x32_bf16 a[140:143], v[60:63], v[120:123], a[140:143]
  v_mfma_f32_16x16x32_bf16 a[144:147], v[60:63], v[124:127], a[144:147]
  ds_read_b128 v[100:103], v21 offset:12288
  v_mfma_f32_16x16x32_bf16 a[148:151], v[60:63], v[128:131], a[148:151]
  v_mfma_f32_16x16x32_bf16 a[152:155], v[60:63], v[132:135], a[152:155]
  ds_read_b64_tr_b16 v[164:165], v36 offset:49152
  v_mfma_f32_16x16x32_bf16 a[156:159], v[60:63], v[136:139], a[156:159]
  v_mfma_f32_16x16x32_bf16 a[160:163], v[64:67], v[108:111], a[160:163]
  ds_read_b64_tr_b16 v[166:167], v36 offset:51200
  v_mfma_f32_16x16x32_bf16 a[164:167], v[64:67], v[112:115], a[164:167]
  v_mfma_f32_16x16x32_bf16 a[168:171], v[64:67], v[116:119], a[168:171]
  ds_read_b128 v[104:107], v21 offset:14336
  v_mfma_f32_16x16x32_bf16 a[172:175], v[64:67], v[120:123], a[172:175]
  v_mfma_f32_16x16x32_bf16 a[176:179], v[64:67], v[124:127], a[176:179]
  ds_read_b64_tr_b16 v[168:169], v37 offset:49152
  v_mfma_f32_16x16x32_bf16 a[180:183], v[64:67], v[128:131], a[180:183]
  v_mfma_f32_16x16x32_bf16 a[184:187], v[64:67], v[132:135], a[184:187]
  ds_read_b64_tr_b16 v[170:171], v37 offset:51200
  v_mfma_f32_16x16x32_bf16 a[188:191], v[64:67], v[136:139], a[188:191]
  v_mfma_f32_16x16x32_bf16 a[192:195], v[68:71], v[108:111], a[192:195]
  v_mfma_f32_16x16x32_bf16 a[196:199], v[68:71], v[112:115], a[196:199]
  v_mfma_f32_16x16x32_bf16 a[200:203], v[68:71], v[116:119], a[200:203]
  v_mfma_f32_16x16x32_bf16 a[204:207], v[68:71], v[120:123], a[204:207]
  v_mfma_f32_16x16x32_bf16 a[208:211], v[68:71], v[124:127], a[208:211]
  v_mfma_f32_16x16x32_bf16 a[212:215], v[68:71], v[128:131], a[212:215]
  v_mfma_f32_16x16x32_bf16 a[216:219], v[68:71], v[132:135], a[216:219]
  v_mfma_f32_16x16x32_bf16 a[220:223], v[68:71], v[136:139], a[220:223]
  v_mfma_f32_16x16x32_bf16 a[224:227], v[72:75], v[108:111], a[224:227]
  v_mfma_f32_16x16x32_bf16 a[228:231], v[72:75], v[112:115], a[228:231]
  v_mfma_f32_16x16x32_bf16 a[232:235], v[72:75], v[116:119], a[232:235]
  v_mfma_f32_16x16x32_bf16 a[236:239], v[72:75], v[120:123], a[236:239]
  v_mfma_f32_16x16x32_bf16 a[240:243], v[72:75], v[124:127], a[240:243]
  v_mfma_f32_16x16x32_bf16 a[244:247], v[72:75], v[128:131], a[244:247]
  v_mfma_f32_16x16x32_bf16 a[248:251], v[72:75], v[132:135], a[248:251]
  v_mfma_f32_16x16x32_bf16 a[252:255], v[72:75], v[136:139], a[252:255]
  s_waitcnt lgkmcnt(0)
  v_mfma_f32_16x16x32_bf16 a[0:3], v[76:79], v[140:143], a[0:3]
  v_mfma_f32_16x16x32_bf16 a[4:7], v[76:79], v[144:147], a[4:7]
  v_mfma_f32_16x16x32_bf16 a[8:11], v[76:79], v[148:151], a[8:11]
  v_mfma_f32_16x16x32_bf16 a[12:15], v[76:79], v[152:155], a[12:15]
  v_mfma_f32_16x16x32_bf16 a[16:19], v[76:79], v[156:159], a[16:19]
  v_mfma_f32_16x16x32_bf16 a[20:23], v[76:79], v[160:163], a[20:23]
  v_mfma_f32_16x16x32_bf16 a[24:27], v[76:79], v[164:167], a[24:27]
  v_mfma_f32_16x16x32_bf16 a[28:31], v[76:79], v[168:171], a[28:31]
  v_mfma_f32_16x16x32_bf16 a[32:35], v[80:83], v[140:143], a[32:35]
  v_mfma_f32_16x16x32_bf16 a[36:39], v[80:83], v[144:147], a[36:39]
  v_mfma_f32_16x16x32_bf16 a[40:43], v[80:83], v[148:151], a[40:43]
  v_mfma_f32_16x16x32_bf16 a[44:47], v[80:83], v[152:155], a[44:47]
  v_mfma_f32_16x16x32_bf16 a[48:51], v[80:83], v[156:159], a[48:51]
  v_mfma_f32_16x16x32_bf16 a[52:55], v[80:83], v[160:163], a[52:55]
  v_mfma_f32_16x16x32_bf16 a[56:59], v[80:83], v[164:167], a[56:59]
  v_mfma_f32_16x16x32_bf16 a[60:63], v[80:83], v[168:171], a[60:63]
  v_mfma_f32_16x16x32_bf16 a[64:67], v[84:87], v[140:143], a[64:67]
  v_mfma_f32_16x16x32_bf16 a[68:71], v[84:87], v[144:147], a[68:71]
  v_mfma_f32_16x16x32_bf16 a[72:75], v[84:87], v[148:151], a[72:75]
  v_mfma_f32_16x16x32_bf16 a[76:79], v[84:87], v[152:155], a[76:79]
  v_mfma_f32_16x16x32_bf16 a[80:83], v[84:87], v[156:159], a[80:83]
  v_mfma_f32_16x16x32_bf16 a[84:87], v[84:87], v[160:163], a[84:87]
  v_mfma_f32_16x16x32_bf16 a[88:91], v[84:87], v[164:167], a[88:91]
  v_mfma_f32_16x16x32_bf16 a[92:95], v[84:87], v[168:171], a[92:95]
  v_mfma_f32_16x16x32_bf16 a[96:99], v[88:91], v[140:143], a[96:99]
  v_mfma_f32_16x16x32_bf16 a[100:103], v[88:91], v[144:147], a[100:103]
  v_mfma_f32_16x16x32_bf16 a[104:107], v[88:91], v[148:151], a[104:107]
  v_mfma_f32_16x16x32_bf16 a[108:111], v[88:91], v[152:155], a[108:111]
  v_mfma_f32_16x16x32_bf16 a[112:115], v[88:91], v[156:159], a[112:115]
  v_mfma_f32_16x16x32_bf16 a[116:119], v[88:91], v[160:163], a[116:119]
  v_mfma_f32_16x16x32_bf16 a[120:123], v[88:91], v[164:167], a[120:123]
  v_mfma_f32_16x16x32_bf16 a[124:127], v[88:91], v[168:171], a[124:127]
  v_mfma_f32_16x16x32_bf16 a[128:131], v[92:95], v[140:143], a[128:131]
  v_mfma_f32_16x16x32_bf16 a[132:135], v[92:95], v[144:147], a[132:135]
  v_mfma_f32_16x16x32_bf16 a[136:139], v[92:95], v[148:151], a[136:139]
  v_mfma_f32_16x16x32_bf16 a[140:143], v[92:95], v[152:155], a[140:143]
  v_mfma_f32_16x16x32_bf16 a[144:147], v[92:95], v[156:159], a[144:147]
  v_mfma_f32_16x16x32_bf16 a[148:151], v[92:95], v[160:163], a[148:151]
  v_mfma_f32_16x16x32_bf16 a[152:155], v[92:95], v[164:167], a[152:155]
  v_mfma_f32_16x16x32_bf16 a[156:159], v[92:95], v[168:171], a[156:159]
  v_mfma_f32_16x16x32_bf16 a[160:163], v[96:99], v[140:143], a[160:163]
  v_mfma_f32_16x16x32_bf16 a[164:167], v[96:99], v[144:147], a[164:167]
  v_mfma_f32_16x16x32_bf16 a[168:171], v[96:99], v[148:151], a[168:171]
  v_mfma_f32_16x16x32_bf16 a[172:175], v[96:99], v[152:155], a[172:175]
  v_mfma_f32_16x16x32_bf16 a[176:179], v[96:99], v[156:159], a[176:179]
  v_mfma_f32_16x16x32_bf16 a[180:183], v[96:99], v[160:163], a[180:183]
  v_mfma_f32_16x16x32_bf16 a[184:187], v[96:99], v[164:167], a[184:187]
  v_mfma_f32_16x16x32_bf16 a[188:191], v[96:99], v[168:171], a[188:191]
  v_mfma_f32_16x16x32_bf16 a[192:195], v[100:103], v[140:143], a[192:195]
  v_mfma_f32_16x16x32_bf16 a[196:199], v[100:103], v[144:147], a[196:199]
  v_mfma_f32_16x16x32_bf16 a[200:203], v[100:103], v[148:151], a[200:203]
  v_mfma_f32_16x16x32_bf16 a[204:207], v[100:103], v[152:155], a[204:207]
  v_mfma_f32_16x16x32_bf16 a[208:211], v[100:103], v[156:159], a[208:211]
  v_mfma_f32_16x16x32_bf16 a[212:215], v[100:103], v[160:163], a[212:215]
  v_mfma_f32_16x16x32_bf16 a[216:219], v[100:103], v[164:167], a[216:219]
  v_mfma_f32_16x16x32_bf16 a[220:223], v[100:103], v[168:171], a[220:223]
  v_mfma_f32_16x16x32_bf16 a[224:227], v[104:107], v[140:143], a[224:227]
  v_mfma_f32_16x16x32_bf16 a[228:231], v[104:107], v[144:147], a[228:231]
  v_mfma_f32_16x16x32_bf16 a[232:235], v[104:107], v[148:151], a[232:235]
  v_mfma_f32_16x16x32_bf16 a[236:239], v[104:107], v[152:155], a[236:239]
  v_mfma_f32_16x16x32_bf16 a[240:243], v[104:107], v[156:159], a[240:243]
  v_mfma_f32_16x16x32_bf16 a[244:247], v[104:107], v[160:163], a[244:247]
  v_mfma_f32_16x16x32_bf16 a[248:251], v[104:107], v[164:167], a[248:251]
  v_mfma_f32_16x16x32_bf16 a[252:255], v[104:107], v[168:171], a[252:255]
  s_mov_b32 s59, 2
  s_mov_b32 s60, s22
  s_mov_b32 s61, s26
  s_add_u32 s62, s38, 0x3d00000
  s_mov_b32 s63, s98
  s_cmp_lg_u32 s39, 0
  s_cbranch_scc1 L_got
  s_mov_b32 s58, 3
  s_branch L_epi
L_small:
  s_mov_b32 s8, s64
  s_and_b32 s9, s65, 0xffff
  s_mov_b32 s10, 0x400000
  s_mov_b32 s11, 0x20000
  s_cmp_eq_u32 s35, 9
  s_cselect_b64 s[88:89], s[70:71], s[72:73]
  s_mov_b32 s12, s88
  s_and_b32 s13, s89, 0xffff
  s_mov_b32 s14, 0x800000
  s_mov_b32 s15, 0x20000
  s_lshl_b32 s91, s33, 3
  s_add_u32 s91, s91, s37
  s_mov_b32 s24, 8192
  s_mov_b32 s26, 262144
  s_mov_b32 s23, 2048
  s_mov_b32 s25, 4
  s_lshl_b32 s20, s36, 18
  s_lshl_b32 s21, s91, 8
  s_sub_u32 s22, s35, 8
  s_lshl_b32 s22, s22, 24
  s_lshl_b32 s90, s36, 20
  s_add_u32 s22, s22, s90
  s_lshl_b32 s90, s91, 13
  s_add_u32 s22, s22, s90
  s_lshr_b32 s38, s36, 1
  s_lshl_b32 s38, s38, 9
  s_add_u32 s38, s38, 4096
  s_lshl_b32 s90, s33, 7
  s_add_u32 s38, s38, s90
  v_and_b32 v1, 63, v0
  v_lshrrev_b32 v22, 6, v0
  s_nop 0
  v_readfirstlane_b32 s27, v22
  s_mul_i32 s90, s27, 32
  v_lshrrev_b32 v22, 3, v1
  v_add_u32 v22, s90, v22
  v_mul_lo_u32 v22, v22, s23
  v_lshrrev_b32 v23, 4, v1
  v_xor_b32 v23, v23, v1
  v_and_b32 v23, 7, v23
  v_lshl_add_u32 v2, v23, 4, v22
  s_mul_i32 s91, s23, 8
  v_add_u32 v3, s91, v2
  v_xor_b32 v3, 64, v3
  v_add_u32 v4, s91, v3
  v_xor_b32 v4, 64, v4
  v_add_u32 v5, s91, v4
  v_xor_b32 v5, 64, v5
  s_mul_i32 s90, s27, 16
  v_lshrrev_b32 v22, 4, v1
  v_add_u32 v22, 0, v22
  v_add_u32 v22, s90, v22
  v_and_b32 v23, 3, v22
  v_lshlrev_b32 v23, 1, v23
  v_and_b32 v24, 8, v22
  v_or_b32 v23, v23, v24
  v_xor_b32 v23, v23, v1
  v_and_b32 v23, 15, v23
  v_mul_lo_u32 v22, v22, s24
  v_lshl_add_u32 v6, v23, 4, v22
  v_lshrrev_b32 v22, 4, v1
  v_add_u32 v22, 4, v22
  v_add_u32 v22, s90, v22
  v_and_b32 v23, 3, v22
  v_lshlrev_b32 v23, 1, v23
  v_and_b32 v24, 8, v22
  v_or_b32 v23, v23, v24
  v_xor_b32 v23, v23, v1
  v_and_b32 v23, 15, v23
  v_mul_lo_u32 v22, v22, s24
  v_lshl_add_u32 v7, v23, 4, v22
  v_lshrrev_b32 v22, 4, v1
  v_add_u32 v22, 8, v22
  v_add_u32 v22, s90, v22
  v_and_b32 v23, 3, v22
  v_lshlrev_b32 v23, 1, v23
  v_and_b32 v24, 8, v22
  v_or_b32 v23, v23, v24
  v_xor_b32 v23, v23, v1
  v_and_b32 v23, 15, v23
  v_mul_lo_u32 v22, v22, s24
  v_lshl_add_u32 v8, v23, 4, v22
  v_lshrrev_b32 v22, 4, v1
  v_add_u32 v22, 12, v22
  v_add_u32 v22, s90, v22
  v_and_b32 v23, 3, v22
  v_lshlrev_b32 v23, 1, v23
  v_and_b32 v24, 8, v22
  v_or_b32 v23, v23, v24
  v_xor_b32 v23, v23, v1
  v_and_b32 v23, 15, v23
  v_mul_lo_u32 v22, v22, s24
  v_lshl_add_u32 v9, v23, 4, v22
  s_mul_i32 s51, s24, 64
  s_mul_i32 s52, s27, 4096
  s_mul_i32 s53, s27, 4096
  s_add_u32 s53, s53, 16384
  s_add_u32 m0, s52, 0
  s_nop 0
  buffer_load_dwordx4 v2, s[8:11], s20 offen  lds
  s_add_u32 m0, s53, 0
  s_nop 0
  buffer_load_dwordx4 v6, s[12:15], s21 offen  lds
  s_add_u32 m0, s52, 1024
  s_nop 0
  buffer_load_dwordx4 v3, s[8:11], s20 offen  lds
  s_add_u32 m0, s53, 1024
  s_nop 0
  buffer_load_dwordx4 v7, s[12:15], s21 offen  lds
  s_add_u32 m0, s52, 2048
  s_nop 0
  buffer_load_dwordx4 v4, s[8:11], s20 offen  lds
  s_add_u32 m0, s53, 2048
  s_nop 0
  buffer_load_dwordx4 v8, s[12:15], s21 offen  lds
  s_add_u32 m0, s52, 3072
  s_nop 0
  buffer_load_dwordx4 v5, s[8:11], s20 offen  lds
  s_add_u32 m0, s53, 3072
  s_nop 0
  buffer_load_dwordx4 v9, s[12:15], s21 offen  lds
  s_add_u32 s20, s20, 128
  s_add_u32 s21, s21, s51
  s_add_u32 m0, s52, 32768
  s_nop 0
  buffer_load_dwordx4 v2, s[8:11], s20 offen  lds
  s_add_u32 m0, s53, 32768
  s_nop 0
  buffer_load_dwordx4 v6, s[12:15], s21 offen  lds
  s_add_u32 m0, s52, 33792
  s_nop 0
  buffer_load_dwordx4 v3, s[8:11], s20 offen  lds
  s_add_u32 m0, s53, 33792
  s_nop 0
  buffer_load_dwordx4 v7, s[12:15], s21 offen  lds
  s_add_u32 m0, s52, 34816
  s_nop 0
  buffer_load_dwordx4 v4, s[8:11], s20 offen  lds
  s_add_u32 m0, s53, 34816
  s_nop 0
  buffer_load_dwordx4 v8, s[12:15], s21 offen  lds
  s_add_u32 m0, s52, 35840
  s_nop 0
  buffer_load_dwordx4 v5, s[8:11], s20 offen  lds
  s_add_u32 m0, s53, 35840
  s_nop 0
  buffer_load_dwordx4 v9, s[12:15], s21 offen  lds
  s_add_u32 s20, s20, 128
  s_add_u32 s21, s21, s51
  s_add_u32 m0, s52, 65536
  s_nop 0
  buffer_load_dwordx4 v2, s[8:11], s20 offen  lds
  s_add_u32 m0, s53, 65536
  s_nop 0
  buffer_load_dwordx4 v6, s[12:15], s21 offen  lds
  s_add_u32 m0, s52, 66560
  s_nop 0
  buffer_load_dwordx4 v3, s[8:11], s20 offen  lds
  s_add_u32 m0, s53, 66560
  s_nop 0
  buffer_load_dwordx4 v7, s[12:15], s21 offen  lds
  s_add_u32 m0, s52, 67584
  s_nop 0
  buffer_load_dwordx4 v4, s[8:11], s20 offen  lds
  s_add_u32 m0, s53, 67584
  s_nop 0
  buffer_load_dwordx4 v8, s[12:15], s21 offen  lds
  s_add_u32 m0, s52, 68608
  s_nop 0
  buffer_load_dwordx4 v5, s[8:11], s20 offen  lds
  s_add_u32 m0, s53, 68608
  s_nop 0
  buffer_load_dwordx4 v9, s[12:15], s21 offen  lds
  s_add_u32 s20, s20, 128
  s_add_u32 s21, s21, s51
  s_add_u32 m0, s52, 98304
  s_nop 0
  buffer_load_dwordx4 v2, s[8:11], s20 offen  lds
  s_add_u32 m0, s53, 98304
  s_nop 0
  buffer_load_dwordx4 v6, s[12:15], s21 offen  lds
  s_add_u32 m0, s52, 99328
  s_nop 0
  buffer_load_dwordx4 v3, s[8:11], s20 offen  lds
  s_add_u32 m0, s53, 99328
  s_nop 0
  buffer_load_dwordx4 v7, s[12:15], s21 offen  lds
  s_add_u32 m0, s52, 100352
  s_nop 0
  buffer_load_dwordx4 v4, s[8:11], s20 offen  lds
  s_add_u32 m0, s53, 100352
  s_nop 0
  buffer_load_dwordx4 v8, s[12:15], s21 offen  lds
  s_add_u32 m0, s52, 101376
  s_nop 0
  buffer_load_dwordx4 v5, s[8:11], s20 offen  lds
  s_add_u32 m0, s53, 101376
  s_nop 0
  buffer_load_dwordx4 v9, s[12:15], s21 offen  lds
  s_add_u32 s20, s20, 128
  s_add_u32 s21, s21, s51
  s_lshr_b32 s90, s27, 1
  s_and_b32 s91, s27, 1
  s_mul_i32 s92, s90, 8192
  v_mov_b32 v22, 0x0
  v_bfe_u32 v23, v1, 0, 4
  v_lshl_add_u32 v22, v23, 7, v22
  v_add_u32 v22, s92, v22
  v_lshrrev_b32 v23, 1, v1
  v_and_b32 v23, 7, v23
  v_lshrrev_b32 v24, 4, v1
  v_xor_b32 v23, v23, v24
  v_lshl_add_u32 v10, v23, 4, v22
  v_xor_b32 v11, 64, v10
  v_add_u32 v12, 65536, v10
  v_add_u32 v13, 65536, v11
  v_mov_b32 v22, 0x0
  v_bfe_u32 v23, v1, 2, 2
  v_lshl_add_u32 v22, v23, 8, v22
  v_bfe_u32 v23, v1, 4, 2
  v_lshl_add_u32 v22, v23, 11, v22
  v_bfe_u32 v23, v1, 0, 2
  v_lshl_add_u32 v22, v23, 3, v22
  v_bfe_u32 v24, v1, 2, 3
  s_mul_i32 s92, s91, 4
  s_add_u32 s93, s92, 0
  v_xor_b32 v23, s93, v24
  v_lshl_add_u32 v14, v23, 5, v22
  v_add_u32 v18, 65536, v14
  s_add_u32 s93, s92, 1
  v_xor_b32 v23, s93, v24
  v_lshl_add_u32 v15, v23, 5, v22
  v_add_u32 v19, 65536, v15
  s_add_u32 s93, s92, 2
  v_xor_b32 v23, s93, v24
  v_lshl_add_u32 v16, v23, 5, v22
  v_add_u32 v20, 65536, v16
  s_add_u32 s93, s92, 3
  v_xor_b32 v23, s93, v24
  v_lshl_add_u32 v17, v23, 5, v22
  v_add_u32 v21, 65536, v17
  s_mov_b32 s58, 2
  s_branch L_epi
L_r2:
  v_lshlrev_b32 v174, 7, v1
  s_sub_u32 s42, s34, 32
  s_lshl_b32 s40, s42, 2
  s_add_u32 s40, s40, s33
  s_lshl_b32 s40, s40, 2
  s_add_u32 s40, s40, s32
  s_lshl_b32 s40, s40, 13
  s_cmp_ge_u32 s42, 32
  s_cselect_b32 s40, 0x40000000, s40
  s_add_u32 s41, s40, 4194304
  s_mov_b32 s44, s64
  s_and_b32 s45, s65, 0xffff
  s_mov_b32 s46, 0x400000
  s_mov_b32 s47, 0x20000
  buffer_load_dword v175, v174, s[44:47], s40 offen
  s_cmp_eq_u32 s35, 10
  s_cbranch_scc1 L_g5
  s_waitcnt vmcnt(25)
  s_barrier
  ds_read_b128 v[28:31], v10 offset:0
  ds_read_b64_tr_b16 v[60:61], v14 offset:16384
  ds_read_b64_tr_b16 v[62:63], v14 offset:17408
  ds_read_b128 v[32:35], v10 offset:2048
  ds_read_b64_tr_b16 v[64:65], v15 offset:16384
  ds_read_b64_tr_b16 v[66:67], v15 offset:17408
  ds_read_b128 v[36:39], v10 offset:4096
  ds_read_b64_tr_b16 v[68:69], v16 offset:16384
  ds_read_b64_tr_b16 v[70:71], v16 offset:17408
  ds_read_b128 v[40:43], v10 offset:6144
  ds_read_b64_tr_b16 v[72:73], v17 offset:16384
  ds_read_b64_tr_b16 v[74:75], v17 offset:17408
  s_sub_u32 s25, s25, 1
  s_waitcnt lgkmcnt(0)
  v_mfma_f32_16x16x32_bf16 a[0:3], v[60:63], v[28:31], 0
  ds_read_b128 v[44:47], v11 offset:0
  v_mfma_f32_16x16x32_bf16 a[4:7], v[64:67], v[28:31], 0
  ds_read_b64_tr_b16 v[76:77], v14 offset:24576
  v_mfma_f32_16x16x32_bf16 a[8:11], v[68:71], v[28:31], 0
  ds_read_b64_tr_b16 v[78:79], v14 offset:25600
  v_mfma_f32_16x16x32_bf16 a[12:15], v[72:75], v[28:31], 0
  ds_read_b128 v[48:51], v11 offset:2048
  v_mfma_f32_16x16x32_bf16 a[16:19], v[60:63], v[32:35], 0
  ds_read_b64_tr_b16 v[80:81], v15 offset:24576
  v_mfma_f32_16x16x32_bf16 a[20:23], v[64:67], v[32:35], 0
  ds_read_b64_tr_b16 v[82:83], v15 offset:25600
  v_mfma_f32_16x16x32_bf16 a[24:27], v[68:71], v[32:35], 0
  ds_read_b128 v[52:55], v11 offset:4096
  v_mfma_f32_16x16x32_bf16 a[28:31], v[72:75], v[32:35], 0
  ds_read_b64_tr_b16 v[84:85], v16 offset:24576
  v_mfma_f32_16x16x32_bf16 a[32:35], v[60:63], v[36:39], 0
  ds_read_b64_tr_b16 v[86:87], v16 offset:25600
  v_mfma_f32_16x16x32_bf16 a[36:39], v[64:67], v[36:39], 0
  ds_read_b128 v[56:59], v11 offset:6144
  v_mfma_f32_16x16x32_bf16 a[40:43], v[68:71], v[36:39], 0
  ds_read_b64_tr_b16 v[88:89], v17 offset:24576
  v_mfma_f32_16x16x32_bf16 a[44:47], v[72:75], v[36:39], 0
  ds_read_b64_tr_b16 v[90:91], v17 offset:25600
  v_mfma_f32_16x16x32_bf16 a[48:51], v[60:63], v[40:43], 0
  v_mfma_f32_16x16x32_bf16 a[52:55], v[64:67], v[40:43], 0
  v_mfma_f32_16x16x32_bf16 a[56:59], v[68:71], v[40:43], 0
  v_mfma_f32_16x16x32_bf16 a[60:63], v[72:75], v[40:43], 0
  s_waitcnt lgkmcnt(0)
  v_mfma_f32_16x16x32_bf16 a[0:3], v[76:79], v[44:47], a[0:3]
  s_waitcnt vmcnt(17)
  s_barrier
  s_add_u32 m0, s52, 0
  v_mfma_f32_16x16x32_bf16 a[4:7], v[80:83], v[44:47], a[4:7]
  buffer_load_dwordx4 v2, s[8:11], s20 offen  lds
  ds_read_b128 v[28:31], v10 offset:32768
  v_mfma_f32_16x16x32_bf16 a[8:11], v[84:87], v[44:47], a[8:11]
  ds_read_b64_tr_b16 v[60:61], v14 offset:49152
  v_mfma_f32_16x16x32_bf16 a[12:15], v[88:91], v[44:47], a[12:15]
  ds_read_b64_tr_b16 v[62:63], v14 offset:50176
  s_add_u32 m0, s53, 0
  v_mfma_f32_16x16x32_bf16 a[16:19], v[76:79], v[48:51], a[16:19]
  buffer_load_dwordx4 v6, s[12:15], s21 offen  lds
  ds_read_b128 v[32:35], v10 offset:34816
  v_mfma_f32_16x16x32_bf16 a[20:23], v[80:83], v[48:51], a[20:23]
  ds_read_b64_tr_b16 v[64:65], v15 offset:49152
  v_mfma_f32_16x16x32_bf16 a[24:27], v[84:87], v[48:51], a[24:27]
  ds_read_b64_tr_b16 v[66:67], v15 offset:50176
  s_add_u32 m0, s52, 1024
  v_mfma_f32_16x16x32_bf16 a[28:31], v[88:91], v[48:51], a[28:31]
  buffer_load_dwordx4 v3, s[8:11], s20 offen  lds
  ds_read_b128 v[36:39], v10 offset:36864
  v_mfma_f32_16x16x32_bf16 a[32:35], v[76:79], v[52:55], a[32:35]
  ds_read_b64_tr_b16 v[68:69], v16 offset:49152
  v_mfma_f32_16x16x32_bf16 a[36:39], v[80:83], v[52:55], a[36:39]
  ds_read_b64_tr_b16 v[70:71], v16 offset:50176
  s_add_u32 m0, s53, 1024
  v_mfma_f32_16x16x32_bf16 a[40:43], v[84:87], v[52:55], a[40:43]
  buffer_load_dwordx4 v7, s[12:15], s21 offen  lds
  ds_read_b128 v[40:43], v10 offset:38912
  v_mfma_f32_16x16x32_bf16 a[44:47], v[88:91], v[52:55], a[44:47]
  ds_read_b64_tr_b16 v[72:73], v17 offset:49152
  v_mfma_f32_16x16x32_bf16 a[48:51], v[76:79], v[56:59], a[48:51]
  ds_read_b64_tr_b16 v[74:75], v17 offset:50176
  s_add_u32 m0, s52, 2048
  v_mfma_f32_16x16x32_bf16 a[52:55], v[80:83], v[56:59], a[52:55]
  buffer_load_dwordx4 v4, s[8:11], s20 offen  lds
  v_mfma_f32_16x16x32_bf16 a[56:59], v[84:87], v[56:59], a[56:59]
  v_mfma_f32_16x16x32_bf16 a[60:63], v[88:91], v[56:59], a[60:63]
  s_waitcnt lgkmcnt(0)
  s_add_u32 m0, s53, 2048
  v_mfma_f32_16x16x32_bf16 a[0:3], v[60:63], v[28:31], a[0:3]
  buffer_load_dwordx4 v8, s[12:15], s21 offen  lds
  ds_read_b128 v[44:47], v11 offset:32768
  v_mfma_f32_16x16x32_bf16 a[4:7], v[64:67], v[28:31], a[4:7]
  ds_read_b64_tr_b16 v[76:77], v14 offset:57344
  v_mfma_f32_16x16x32_bf16 a[8:11], v[68:71], v[28:31], a[8:11]
  ds_read_b64_tr_b16 v[78:79], v14 offset:58368
  v_mfma_f32_16x16x32_bf16 a[12:15], v[72:75], v[28:31], a[12:15]
  ds_read_b128 v[48:51], v11 offset:34816
  s_add_u32 m0, s52, 3072
  v_mfma_f32_16x16x32_bf16 a[16:19], v[60:63], v[32:35], a[16:19]
  buffer_load_dwordx4 v5, s[8:11], s20 offen  lds
  ds_read_b64_tr_b16 v[80:81], v15 offset:57344
  v_mfma_f32_16x16x32_bf16 a[20:23], v[64:67], v[32:35], a[20:23]
  ds_read_b64_tr_b16 v[82:83], v15 offset:58368
  v_mfma_f32_16x16x32_bf16 a[24:27], v[68:71], v[32:35], a[24:27]
  ds_read_b128 v[52:55], v11 offset:36864
  v_mfma_f32_16x16x32_bf16 a[28:31], v[72:75], v[32:35], a[28:31]
  ds_read_b64_tr_b16 v[84:85], v16 offset:57344
  s_add_u32 m0, s53, 3072
  v_mfma_f32_16x16x32_bf16 a[32:35], v[60:63], v[36:39], a[32:35]
  buffer_load_dwordx4 v9, s[12:15], s21 offen  lds
  ds_read_b64_tr_b16 v[86:87], v16 offset:58368
  v_mfma_f32_16x16x32_bf16 a[36:39], v[64:67], v[36:39], a[36:39]
  ds_read_b128 v[56:59], v11 offset:38912
  v_mfma_f32_16x16x32_bf16 a[40:43], v[68:71], v[36:39], a[40:43]
  ds_read_b64_tr_b16 v[88:89], v17 offset:57344
  v_mfma_f32_16x16x32_bf16 a[44:47], v[72:75], v[36:39], a[44:47]
  ds_read_b64_tr_b16 v[90:91], v17 offset:58368
  s_add_u32 s20, s20, 128
  v_mfma_f32_16x16x32_bf16 a[48:51], v[60:63], v[40:43], a[48:51]
  s_add_u32 s21, s21, s51
  v_mfma_f32_16x16x32_bf16 a[52:55], v[64:67], v[40:43], a[52:55]
  v_mfma_f32_16x16x32_bf16 a[56:59], v[68:71], v[40:43], a[56:59]
  v_mfma_f32_16x16x32_bf16 a[60:63], v[72:75], v[40:43], a[60:63]
  s_waitcnt lgkmcnt(0)
  v_mfma_f32_16x16x32_bf16 a[0:3], v[76:79], v[44:47], a[0:3]
  s_waitcnt vmcnt(17)
  s_barrier
  s_add_u32 m0, s52, 32768
  v_mfma_f32_16x16x32_bf16 a[4:7], v[80:83], v[44:47], a[4:7]
  buffer_load_dwordx4 v2, s[8:11], s20 offen  lds
  ds_read_b128 v[28:31], v12 offset:0
  v_mfma_f32_16x16x32_bf16 a[8:11], v[84:87], v[44:47], a[8:11]
  ds_read_b64_tr_b16 v[60:61], v18 offset:16384
  v_mfma_f32_16x16x32_bf16 a[12:15], v[88:91], v[44:47], a[12:15]
  ds_read_b64_tr_b16 v[62:63], v18 offset:17408
  s_add_u32 m0, s53, 32768
  v_mfma_f32_16x16x32_bf16 a[16:19], v[76:79], v[48:51], a[16:19]
  buffer_load_dwordx4 v6, s[12:15], s21 offen  lds
  ds_read_b128 v[32:35], v12 offset:2048
  v_mfma_f32_16x16x32_bf16 a[20:23], v[80:83], v[48:51], a[20:23]
  ds_read_b64_tr_b16 v[64:65], v19 offset:16384
  v_mfma_f32_16x16x32_bf16 a[24:27], v[84:87], v[48:51], a[24:27]
  ds_read_b64_tr_b16 v[66:67], v19 offset:17408
  s_add_u32 m0, s52, 33792
  v_mfma_f32_16x16x32_bf16 a[28:31], v[88:91], v[48:51], a[28:31]
  buffer_load_dwordx4 v3, s[8:11], s20 offen  lds
  ds_read_b128 v[36:39], v12 offset:4096
  v_mfma_f32_16x16x32_bf16 a[32:35], v[76:79], v[52:55], a[32:35]
  ds_read_b64_tr_b16 v[68:69], v20 offset:16384
  v_mfma_f32_16x16x32_bf16 a[36:39], v[80:83], v[52:55], a[36:39]
  ds_read_b64_tr_b16 v[70:71], v20 offset:17408
  s_add_u32 m0, s53, 33792
  v_mfma_f32_16x16x32_bf16 a[40:43], v[84:87], v[52:55], a[40:43]
  buffer_load_dwordx4 v7, s[12:15], s21 offen  lds
  ds_read_b128 v[40:43], v12 offset:6144
  v_mfma_f32_16x16x32_bf16 a[44:47], v[88:91], v[52:55], a[44:47]
  ds_read_b64_tr_b16 v[72:73], v21 offset:16384
  v_mfma_f32_16x16x32_bf16 a[48:51], v[76:79], v[56:59], a[48:51]
  ds_read_b64_tr_b16 v[74:75], v21 offset:17408
  s_add_u32 m0, s52, 34816
  v_mfma_f32_16x16x32_bf16 a[52:55], v[80:83], v[56:59], a[52:55]
  buffer_load_dwordx4 v4, s[8:11], s20 offen  lds
  v_mfma_f32_16x16x32_bf16 a[56:59], v[84:87], v[56:59], a[56:59]
  v_mfma_f32_16x16x32_bf16 a[60:63], v[88:91], v[56:59], a[60:63]
  s_waitcnt lgkmcnt(0)
  s_add_u32 m0, s53, 34816
  v_mfma_f32_16x16x32_bf16 a[0:3], v[60:63], v[28:31], a[0:3]
  buffer_load_dwordx4 v8, s[12:15], s21 offen  lds
  ds_read_b128 v[44:47], v13 offset:0
  v_mfma_f32_16x16x32_bf16 a[4:7], v[64:67], v[28:31], a[4:7]
  ds_read_b64_tr_b16 v[76:77], v18 offset:24576
  v_mfma_f32_16x16x32_bf16 a[8:11], v[68:71], v[28:31], a[8:11]
  ds_read_b64_tr_b16 v[78:79], v18 offset:25600
  v_mfma_f32_16x16x32_bf16 a[12:15], v[72:75], v[28:31], a[12:15]
  ds_read_b128 v[48:51], v13 offset:2048
  s_add_u32 m0, s52, 35840
  v_mfma_f32_16x16x32_bf16 a[16:19], v[60:63], v[32:35], a[16:19]
  buffer_load_dwordx4 v5, s[8:11], s20 offen  lds
  ds_read_b64_tr_b16 v[80:81], v19 offset:24576
  v_mfma_f32_16x16x32_bf16 a[20:23], v[64:67], v[32:35], a[20:23]
  ds_read_b64_tr_b16 v[82:83], v19 offset:25600
  v_mfma_f32_16x16x32_bf16 a[24:27], v[68:71], v[32:35], a[24:27]
  ds_read_b128 v[52:55], v13 offset:4096
  v_mfma_f32_16x16x32_bf16 a[28:31], v[72:75], v[32:35], a[28:31]
  ds_read_b64_tr_b16 v[84:85], v20 offset:24576
  s_add_u32 m0, s53, 35840
  v_mfma_f32_16x16x32_bf16 a[32:35], v[60:63], v[36:39], a[32:35]
  buffer_load_dwordx4 v9, s[12:15], s21 offen  lds
  ds_read_b64_tr_b16 v[86:87], v20 offset:25600
  v_mfma_f32_16x16x32_bf16 a[36:39], v[64:67], v[36:39], a[36:39]
  ds_read_b128 v[56:59], v13 offset:6144
  v_mfma_f32_16x16x32_bf16 a[40:43], v[68:71], v[36:39], a[40:43]
  ds_read_b64_tr_b16 v[88:89], v21 offset:24576
  v_mfma_f32_16x16x32_bf16 a[44:47], v[72:75], v[36:39], a[44:47]
  ds_read_b64_tr_b16 v[90:91], v21 offset:25600
  s_add_u32 s20, s20, 128
  v_mfma_f32_16x16x32_bf16 a[48:51], v[60:63], v[40:43], a[48:51]
  s_add_u32 s21, s21, s51
  v_mfma_f32_16x16x32_bf16 a[52:55], v[64:67], v[40:43], a[52:55]
  v_mfma_f32_16x16x32_bf16 a[56:59], v[68:71], v[40:43], a[56:59]
  v_mfma_f32_16x16x32_bf16 a[60:63], v[72:75], v[40:43], a[60:63]
  s_waitcnt lgkmcnt(0)
  v_mfma_f32_16x16x32_bf16 a[0:3], v[76:79], v[44:47], a[0:3]
  s_waitcnt vmcnt(17)
  s_barrier
  s_add_u32 m0, s52, 65536
  v_mfma_f32_16x16x32_bf16 a[4:7], v[80:83], v[44:47], a[4:7]
  buffer_load_dwordx4 v2, s[8:11], s20 offen  lds
  ds_read_b128 v[28:31], v12 offset:32768
  v_mfma_f32_16x16x32_bf16 a[8:11], v[84:87], v[44:47], a[8:11]
  ds_read_b64_tr_b16 v[60:61], v18 offset:49152
  v_mfma_f32_16x16x32_bf16 a[12:15], v[88:91], v[44:47], a[12:15]
  ds_read_b64_tr_b16 v[62:63], v18 offset:50176
  s_add_u32 m0, s53, 65536
  v_mfma_f32_16x16x32_bf16 a[16:19], v[76:79], v[48:51], a[16:19]
  buffer_load_dwordx4 v6, s[12:15], s21 offen  lds
  ds_read_b128 v[32:35], v12 offset:34816
  v_mfma_f32_16x16x32_bf16 a[20:23], v[80:83], v[48:51], a[20:23]
  ds_read_b64_tr_b16 v[64:65], v19 offset:49152
  v_mfma_f32_16x16x32_bf16 a[24:27], v[84:87], v[48:51], a[24:27]
  ds_read_b64_tr_b16 v[66:67], v19 offset:50176
  s_add_u32 m0, s52, 66560
  v_mfma_f32_16x16x32_bf16 a[28:31], v[88:91], v[48:51], a[28:31]
  buffer_load_dwordx4 v3, s[8:11], s20 offen  lds
  ds_read_b128 v[36:39], v12 offset:36864
  v_mfma_f32_16x16x32_bf16 a[32:35], v[76:79], v[52:55], a[32:35]
  ds_read_b64_tr_b16 v[68:69], v20 offset:49152
  v_mfma_f32_16x16x32_bf16 a[36:39], v[80:83], v[52:55], a[36:39]
  ds_read_b64_tr_b16 v[70:71], v20 offset:50176
  s_add_u32 m0, s53, 66560
  v_mfma_f32_16x16x32_bf16 a[40:43], v[84:87], v[52:55], a[40:43]
  buffer_load_dwordx4 v7, s[12:15], s21 offen  lds
  ds_read_b128 v[40:43], v12 offset:38912
  v_mfma_f32_16x16x32_bf16 a[44:47], v[88:91], v[52:55], a[44:47]
  ds_read_b64_tr_b16 v[72:73], v21 offset:49152
  v_mfma_f32_16x16x32_bf16 a[48:51], v[76:79], v[56:59], a[48:51]
  ds_read_b64_tr_b16 v[74:75], v21 offset:50176
  s_add_u32 m0, s52, 67584
  v_mfma_f32_16x16x32_bf16 a[52:55], v[80:83], v[56:59], a[52:55]
  buffer_load_dwordx4 v4, s[8:11], s20 offen  lds
  v_mfma_f32_16x16x32_bf16 a[56:59], v[84:87], v[56:59], a[56:59]
  v_mfma_f32_16x16x32_bf16 a[60:63], v[88:91], v[56:59], a[60:63]
  s_waitcnt lgkmcnt(0)
  s_add_u32 m0, s53, 67584
  v_mfma_f32_16x16x32_bf16 a[0:3], v[60:63], v[28:31], a[0:3]
  buffer_load_dwordx4 v8, s[12:15], s21 offen  lds
  ds_read_b128 v[44:47], v13 offset:32768
  v_mfma_f32_16x16x32_bf16 a[4:7], v[64:67], v[28:31], a[4:7]
  ds_read_b64_tr_b16 v[76:77], v18 offset:57344
  v_mfma_f32_16x16x32_bf16 a[8:11], v[68:71], v[28:31], a[8:11]
  ds_read_b64_tr_b16 v[78:79], v18 offset:58368
  v_mfma_f32_16x16x32_bf16 a[12:15], v[72:75], v[28:31], a[12:15]
  ds_read_b128 v[48:51], v13 offset:34816
  s_add_u32 m0, s52, 68608
  v_mfma_f32_16x16x32_bf16 a[16:19], v[60:63], v[32:35], a[16:19]
  buffer_load_dwordx4 v5, s[8:11], s20 offen  lds
  ds_read_b64_tr_b16 v[80:81], v19 offset:57344
  v_mfma_f32_16x16x32_bf16 a[20:23], v[64:67], v[32:35], a[20:23]
  ds_read_b64_tr_b16 v[82:83], v19 offset:58368
  v_mfma_f32_16x16x32_bf16 a[24:27], v[68:71], v[32:35], a[24:27]
  ds_read_b128 v[52:55], v13 offset:36864
  v_mfma_f32_16x16x32_bf16 a[28:31], v[72:75], v[32:35], a[28:31]
  ds_read_b64_tr_b16 v[84:85], v20 offset:57344
  s_add_u32 m0, s53, 68608
  v_mfma_f32_16x16x32_bf16 a[32:35], v[60:63], v[36:39], a[32:35]
  buffer_load_dwordx4 v9, s[12:15], s21 offen  lds
  ds_read_b64_tr_b16 v[86:87], v20 offset:58368
  v_mfma_f32_16x16x32_bf16 a[36:39], v[64:67], v[36:39], a[36:39]
  ds_read_b128 v[56:59], v13 offset:38912
  v_mfma_f32_16x16x32_bf16 a[40:43], v[68:71], v[36:39], a[40:43]
  ds_read_b64_tr_b16 v[88:89], v21 offset:57344
  v_mfma_f32_16x16x32_bf16 a[44:47], v[72:75], v[36:39], a[44:47]
  ds_read_b64_tr_b16 v[90:91], v21 offset:58368
  s_add_u32 s20, s20, 128
  v_mfma_f32_16x16x32_bf16 a[48:51], v[60:63], v[40:43], a[48:51]
  s_add_u32 s21, s21, s51
  v_mfma_f32_16x16x32_bf16 a[52:55], v[64:67], v[40:43], a[52:55]
  v_mfma_f32_16x16x32_bf16 a[56:59], v[68:71], v[40:43], a[56:59]
  v_mfma_f32_16x16x32_bf16 a[60:63], v[72:75], v[40:43], a[60:63]
  s_waitcnt lgkmcnt(0)
  v_mfma_f32_16x16x32_bf16 a[0:3], v[76:79], v[44:47], a[0:3]
  s_waitcnt vmcnt(16)
  s_barrier
  s_add_u32 m0, s52, 98304
  v_mfma_f32_16x16x32_bf16 a[4:7], v[80:83], v[44:47], a[4:7]
  buffer_load_dwordx4 v2, s[8:11], s20 offen  lds
  ds_read_b128 v[28:31], v10 offset:0
  v_mfma_f32_16x16x32_bf16 a[8:11], v[84:87], v[44:47], a[8:11]
  ds_read_b64_tr_b16 v[60:61], v14 offset:16384
  v_mfma_f32_16x16x32_bf16 a[12:15], v[88:91], v[44:47], a[12:15]
  ds_read_b64_tr_b16 v[62:63], v14 offset:17408
  s_add_u32 m0, s53, 98304
  v_mfma_f32_16x16x32_bf16 a[16:19], v[76:79], v[48:51], a[16:19]
  buffer_load_dwordx4 v6, s[12:15], s21 offen  lds
  ds_read_b128 v[32:35], v10 offset:2048
  v_mfma_f32_16x16x32_bf16 a[20:23], v[80:83], v[48:51], a[20:23]
  ds_read_b64_tr_b16 v[64:65], v15 offset:16384
  v_mfma_f32_16x16x32_bf16 a[24:27], v[84:87], v[48:51], a[24:27]
  ds_read_b64_tr_b16 v[66:67], v15 offset:17408
  s_add_u32 m0, s52, 99328
  v_mfma_f32_16x16x32_bf16 a[28:31], v[88:91], v[48:51], a[28:31]
  buffer_load_dwordx4 v3, s[8:11], s20 offen  lds
  ds_read_b128 v[36:39], v10 offset:4096
  v_mfma_f32_16x16x32_bf16 a[32:35], v[76:79], v[52:55], a[32:35]
  ds_read_b64_tr_b16 v[68:69], v16 offset:16384
  v_mfma_f32_16x16x32_bf16 a[36:39], v[80:83], v[52:55], a[36:39]
  ds_read_b64_tr_b16 v[70:71], v16 offset:17408
  s_add_u32 m0, s53, 99328
  v_mfma_f32_16x16x32_bf16 a[40:43], v[84:87], v[52:55], a[40:43]
  buffer_load_dwordx4 v7, s[12:15], s21 offen  lds
  ds_read_b128 v[40:43], v10 offset:6144
  v_mfma_f32_16x16x32_bf16 a[44:47], v[88:91], v[52:55], a[44:47]
  ds_read_b64_tr_b16 v[72:73], v17 offset:16384
  v_mfma_f32_16x16x32_bf16 a[48:51], v[76:79], v[56:59], a[48:51]
  ds_read_b64_tr_b16 v[74:75], v17 offset:17408
  s_add_u32 m0, s52, 100352
  v_mfma_f32_16x16x32_bf16 a[52:55], v[80:83], v[56:59], a[52:55]
  buffer_load_dwordx4 v4, s[8:11], s20 offen  lds
  v_mfma_f32_16x16x32_bf16 a[56:59], v[84:87], v[56:59], a[56:59]
  v_mfma_f32_16x16x32_bf16 a[60:63], v[88:91], v[56:59], a[60:63]
L_g4_loop:
  s_sub_u32 s25, s25, 1
  s_cmp_eq_u32 s25, 0
  s_cbranch_scc1 L_g4_fin
  s_waitcnt lgkmcnt(0)
  s_add_u32 m0, s53, 100352
  v_mfma_f32_16x16x32_bf16 a[0:3], v[60:63], v[28:31], a[0:3]
  buffer_load_dwordx4 v8, s[12:15], s21 offen  lds
  ds_read_b128 v[44:47], v11 offset:0
  v_mfma_f32_16x16x32_bf16 a[4:7], v[64:67], v[28:31], a[4:7]
  ds_read_b64_tr_b16 v[76:77], v14 offset:24576
  v_mfma_f32_16x16x32_bf16 a[8:11], v[68:71], v[28:31], a[8:11]
  ds_read_b64_tr_b16 v[78:79], v14 offset:25600
  v_mfma_f32_16x16x32_bf16 a[12:15], v[72:75], v[28:31], a[12:15]
  ds_read_b128 v[48:51], v11 offset:2048
  s_add_u32 m0, s52, 101376
  v_mfma_f32_16x16x32_bf16 a[16:19], v[60:63], v[32:35], a[16:19]
  buffer_load_dwordx4 v5, s[8:11], s20 offen  lds
  ds_read_b64_tr_b16 v[80:81], v15 offset:24576
  v_mfma_f32_16x16x32_bf16 a[20:23], v[64:67], v[32:35], a[20:23]
  ds_read_b64_tr_b16 v[82:83], v15 offset:25600
  v_mfma_f32_16x16x32_bf16 a[24:27], v[68:71], v[32:35], a[24:27]
  ds_read_b128 v[52:55], v11 offset:4096
  v_mfma_f32_16x16x32_bf16 a[28:31], v[72:75], v[32:35], a[28:31]
  ds_read_b64_tr_b16 v[84:85], v16 offset:24576
  s_add_u32 m0, s53, 101376
  v_mfma_f32_16x16x32_bf16 a[32:35], v[60:63], v[36:39], a[32:35]
  buffer_load_dwordx4 v9, s[12:15], s21 offen  lds
  ds_read_b64_tr_b16 v[86:87], v16 offset:25600
  v_mfma_f32_16x16x32_bf16 a[36:39], v[64:67], v[36:39], a[36:39]
  ds_read_b128 v[56:59], v11 offset:6144
  v_mfma_f32_16x16x32_bf16 a[40:43], v[68:71], v[36:39], a[40:43]
  ds_read_b64_tr_b16 v[88:89], v17 offset:24576
  v_mfma_f32_16x16x32_bf16 a[44:47], v[72:75], v[36:39], a[44:47]
  ds_read_b64_tr_b16 v[90:91], v17 offset:25600
  s_add_u32 s20, s20, 128
  v_mfma_f32_16x16x32_bf16 a[48:51], v[60:63], v[40:43], a[48:51]
  s_add_u32 s21, s21, s51
  v_mfma_f32_16x16x32_bf16 a[52:55], v[64:67], v[40:43], a[52:55]
  v_mfma_f32_16x16x32_bf16 a[56:59], v[68:71], v[40:43], a[56:59]
  v_mfma_f32_16x16x32_bf16 a[60:63], v[72:75], v[40:43], a[60:63]
  s_waitcnt lgkmcnt(0)
  v_mfma_f32_16x16x32_bf16 a[0:3], v[76:79], v[44:47], a[0:3]
  s_waitcnt vmcnt(16)
  s_barrier
  s_add_u32 m0, s52, 0
  v_mfma_f32_16x16x32_bf16 a[4:7], v[80:83], v[44:47], a[4:7]
  buffer_load_dwordx4 v2, s[8:11], s20 offen  lds
  ds_read_b128 v[28:31], v10 offset:32768
  v_mfma_f32_16x16x32_bf16 a[8:11], v[84:87], v[44:47], a[8:11]
  ds_read_b64_tr_b16 v[60:61], v14 offset:49152
  v_mfma_f32_16x16x32_bf16 a[12:15], v[88:91], v[44:47], a[12:15]
  ds_read_b64_tr_b16 v[62:63], v14 offset:50176
  s_add_u32 m0, s53, 0
  v_mfma_f32_16x16x32_bf16 a[16:19], v[76:79], v[48:51], a[16:19]
  buffer_load_dwordx4 v6, s[12:15], s21 offen  lds
  ds_read_b128 v[32:35], v10 offset:34816
  v_mfma_f32_16x16x32_bf16 a[20:23], v[80:83], v[48:51], a[20:23]
  ds_read_b64_tr_b16 v[64:65], v15 offset:49152
  v_mfma_f32_16x16x32_bf16 a[24:27], v[84:87], v[48:51], a[24:27]
  ds_read_b64_tr_b16 v[66:67], v15 offset:50176
  s_add_u32 m0, s52, 1024
  v_mfma_f32_16x16x32_bf16 a[28:31], v[88:91], v[48:51], a[28:31]
  buffer_load_dwordx4 v3, s[8:11], s20 offen  lds
  ds_read_b128 v[36:39], v10 offset:36864
  v_mfma_f32_16x16x32_bf16 a[32:35], v[76:79], v[52:55], a[32:35]
  ds_read_b64_tr_b16 v[68:69], v16 offset:49152
  v_mfma_f32_16x16x32_bf16 a[36:39], v[80:83], v[52:55], a[36:39]
  ds_read_b64_tr_b16 v[70:71], v16 offset:50176
  s_add_u32 m0, s53, 1024
  v_mfma_f32_16x16x32_bf16 a[40:43], v[84:87], v[52:55], a[40:43]
  buffer_load_dwordx4 v7, s[12:15], s21 offen  lds
  ds_read_b128 v[40:43], v10 offset:38912
  v_mfma_f32_16x16x32_bf16 a[44:47], v[88:91], v[52:55], a[44:47]
  ds_read_b64_tr_b16 v[72:73], v17 offset:49152
  v_mfma_f32_16x16x32_bf16 a[48:51], v[76:79], v[56:59], a[48:51]
  ds_read_b64_tr_b16 v[74:75], v17 offset:50176
  s_add_u32 m0, s52, 2048
  v_mfma_f32_16x16x32_bf16 a[52:55], v[80:83], v[56:59], a[52:55]
  buffer_load_dwordx4 v4, s[8:11], s20 offen  lds
  v_mfma_f32_16x16x32_bf16 a[56:59], v[84:87], v[56:59], a[56:59]
  v_mfma_f32_16x16x32_bf16 a[60:63], v[88:91], v[56:59], a[60:63]
  s_waitcnt lgkmcnt(0)
  s_add_u32 m0, s53, 2048
  v_mfma_f32_16x16x32_bf16 a[0:3], v[60:63], v[28:31], a[0:3]
  buffer_load_dwordx4 v8, s[12:15], s21 offen  lds
  ds_read_b128 v[44:47], v11 offset:32768
  v_mfma_f32_16x16x32_bf16 a[4:7], v[64:67], v[28:31], a[4:7]
  ds_read_b64_tr_b16 v[76:77], v14 offset:57344
  v_mfma_f32_16x16x32_bf16 a[8:11], v[68:71], v[28:31], a[8:11]
  ds_read_b64_tr_b16 v[78:79], v14 offset:58368
  v_mfma_f32_16x16x32_bf16 a[12:15], v[72:75], v[28:31], a[12:15]
  ds_read_b128 v[48:51], v11 offset:34816
  s_add_u32 m0, s52, 3072
  v_mfma_f32_16x16x32_bf16 a[16:19], v[60:63], v[32:35], a[16:19]
  buffer_load_dwordx4 v5, s[8:11], s20 offen  lds
  ds_read_b64_tr_b16 v[80:81], v15 offset:57344
  v_mfma_f32_16x16x32_bf16 a[20:23], v[64:67], v[32:35], a[20:23]
  ds_read_b64_tr_b16 v[82:83], v15 offset:58368
  v_mfma_f32_16x16x32_bf16 a[24:27], v[68:71], v[32:35], a[24:27]
  ds_read_b128 v[52:55], v11 offset:36864
  v_mfma_f32_16x16x32_bf16 a[28:31], v[72:75], v[32:35], a[28:31]
  ds_read_b64_tr_b16 v[84:85], v16 offset:57344
  s_add_u32 m0, s53, 3072
  v_mfma_f32_16x16x32_bf16 a[32:35], v[60:63], v[36:39], a[32:35]
  buffer_load_dwordx4 v9, s[12:15], s21 offen  lds
  ds_read_b64_tr_b16 v[86:87], v16 offset:58368
  v_mfma_f32_16x16x32_bf16 a[36:39], v[64:67], v[36:39], a[36:39]
  ds_read_b128 v[56:59], v11 offset:38912
  v_mfma_f32_16x16x32_bf16 a[40:43], v[68:71], v[36:39], a[40:43]
  ds_read_b64_tr_b16 v[88:89], v17 offset:57344
  v_mfma_f32_16x16x32_bf16 a[44:47], v[72:75], v[36:39], a[44:47]
  ds_read_b64_tr_b16 v[90:91], v17 offset:58368
  s_add_u32 s20, s20, 128
  v_mfma_f32_16x16x32_bf16 a[48:51], v[60:63], v[40:43], a[48:51]
  s_add_u32 s21, s21, s51
  v_mfma_f32_16x16x32_bf16 a[52:55], v[64:67], v[40:43], a[52:55]
  v_mfma_f32_16x16x32_bf16 a[56:59], v[68:71], v[40:43], a[56:59]
  v_mfma_f32_16x16x32_bf16 a[60:63], v[72:75], v[40:43], a[60:63]
  s_waitcnt lgkmcnt(0)
  v_mfma_f32_16x16x32_bf16 a[0:3], v[76:79], v[44:47], a[0:3]
  s_waitcnt vmcnt(16)
  s_barrier
  s_add_u32 m0, s52, 32768
  v_mfma_f32_16x16x32_bf16 a[4:7], v[80:83], v[44:47], a[4:7]
  buffer_load_dwordx4 v2, s[8:11], s20 offen  lds
  ds_read_b128 v[28:31], v12 offset:0
  v_mfma_f32_16x16x32_bf16 a[8:11], v[84:87], v[44:47], a[8:11]
  ds_read_b64_tr_b16 v[60:61], v18 offset:16384
  v_mfma_f32_16x16x32_bf16 a[12:15], v[88:91], v[44:47], a[12:15]
  ds_read_b64_tr_b16 v[62:63], v18 offset:17408
  s_add_u32 m0, s53, 32768
  v_mfma_f32_16x16x32_bf16 a[16:19], v[76:79], v[48:51], a[16:19]
  buffer_load_dwordx4 v6, s[12:15], s21 offen  lds
  ds_read_b128 v[32:35], v12 offset:2048
  v_mfma_f32_16x16x32_bf16 a[20:23], v[80:83], v[48:51], a[20:23]
  ds_read_b64_tr_b16 v[64:65], v19 offset:16384
  v_mfma_f32_16x16x32_bf16 a[24:27], v[84:87], v[48:51], a[24:27]
  ds_read_b64_tr_b16 v[66:67], v19 offset:17408
  s_add_u32 m0, s52, 33792
  v_mfma_f32_16x16x32_bf16 a[28:31], v[88:91], v[48:51], a[28:31]
  buffer_load_dwordx4 v3, s[8:11], s20 offen  lds
  ds_read_b128 v[36:39], v12 offset:4096
  v_mfma_f32_16x16x32_bf16 a[32:35], v[76:79], v[52:55], a[32:35]
  ds_read_b64_tr_b16 v[68:69], v20 offset:16384
  v_mfma_f32_16x16x32_bf16 a[36:39], v[80:83], v[52:55], a[36:39]
  ds_read_b64_tr_b16 v[70:71], v20 offset:17408
  s_add_u32 m0, s53, 33792
  v_mfma_f32_16x16x32_bf16 a[40:43], v[84:87], v[52:55], a[40:43]
  buffer_load_dwordx4 v7, s[12:15], s21 offen  lds
  ds_read_b128 v[40:43], v12 offset:6144
  v_mfma_f32_16x16x32_bf16 a[44:47], v[88:91], v[52:55], a[44:47]
  ds_read_b64_tr_b16 v[72:73], v21 offset:16384
  v_mfma_f32_16x16x32_bf16 a[48:51], v[76:79], v[56:59], a[48:51]
  ds_read_b64_tr_b16 v[74:75], v21 offset:17408
  s_add_u32 m0, s52, 34816
  v_mfma_f32_16x16x32_bf16 a[52:55], v[80:83], v[56:59], a[52:55]
  buffer_load_dwordx4 v4, s[8:11], s20 offen  lds
  v_mfma_f32_16x16x32_bf16 a[56:59], v[84:87], v[56:59], a[56:59]
  v_mfma_f32_16x16x32_bf16 a[60:63], v[88:91], v[56:59], a[60:63]
  s_waitcnt lgkmcnt(0)
  s_add_u32 m0, s53, 34816
  v_mfma_f32_16x16x32_bf16 a[0:3], v[60:63], v[28:31], a[0:3]
  buffer_load_dwordx4 v8, s[12:15], s21 offen  lds
  ds_read_b128 v[44:47], v13 offset:0
  v_mfma_f32_16x16x32_bf16 a[4:7], v[64:67], v[28:31], a[4:7]
  ds_read_b64_tr_b16 v[76:77], v18 offset:24576
  v_mfma_f32_16x16x32_bf16 a[8:11], v[68:71], v[28:31], a[8:11]
  ds_read_b64_tr_b16 v[78:79], v18 offset:25600
  v_mfma_f32_16x16x32_bf16 a[12:15], v[72:75], v[28:31], a[12:15]
  ds_read_b128 v[48:51], v13 offset:2048
  s_add_u32 m0, s52, 35840
  v_mfma_f32_16x16x32_bf16 a[16:19], v[60:63], v[32:35], a[16:19]
  buffer_load_dwordx4 v5, s[8:11], s20 offen  lds
  ds_read_b64_tr_b16 v[80:81], v19 offset:24576
  v_mfma_f32_16x16x32_bf16 a[20:23], v[64:67], v[32:35], a[20:23]
  ds_read_b64_tr_b16 v[82:83], v19 offset:25600
  v_mfma_f32_16x16x32_bf16 a[24:27], v[68:71], v[32:35], a[24:27]
  ds_read_b128 v[52:55], v13 offset:4096
  v_mfma_f32_16x16x32_bf16 a[28:31], v[72:75], v[32:35], a[28:31]
  ds_read_b64_tr_b16 v[84:85], v20 offset:24576
  s_add_u32 m0, s53, 35840
  v_mfma_f32_16x16x32_bf16 a[32:35], v[60:63], v[36:39], a[32:35]
  buffer_load_dwordx4 v9, s[12:15], s21 offen  lds
  ds_read_b64_tr_b16 v[86:87], v20 offset:25600
  v_mfma_f32_16x16x32_bf16 a[36:39], v[64:67], v[36:39], a[36:39]
  ds_read_b128 v[56:59], v13 offset:6144
  v_mfma_f32_16x16x32_bf16 a[40:43], v[68:71], v[36:39], a[40:43]
  ds_read_b64_tr_b16 v[88:89], v21 offset:24576
  v_mfma_f32_16x16x32_bf16 a[44:47], v[72:75], v[36:39], a[44:47]
  ds_read_b64_tr_b16 v[90:91], v21 offset:25600
  s_add_u32 s20, s20, 128
  v_mfma_f32_16x16x32_bf16 a[48:51], v[60:63], v[40:43], a[48:51]
  s_add_u32 s21, s21, s51
  v_mfma_f32_16x16x32_bf16 a[52:55], v[64:67], v[40:43], a[52:55]
  v_mfma_f32_16x16x32_bf16 a[56:59], v[68:71], v[40:43], a[56:59]
  v_mfma_f32_16x16x32_bf16 a[60:63], v[72:75], v[40:43], a[60:63]
  s_waitcnt lgkmcnt(0)
  v_mfma_f32_16x16x32_bf16 a[0:3], v[76:79], v[44:47], a[0:3]
  s_waitcnt vmcnt(16)
  s_barrier
  s_add_u32 m0, s52, 65536
  v_mfma_f32_16x16x32_bf16 a[4:7], v[80:83], v[44:47], a[4:7]
  buffer_load_dwordx4 v2, s[8:11], s20 offen  lds
  ds_read_b128 v[28:31], v12 offset:32768
  v_mfma_f32_16x16x32_bf16 a[8:11], v[84:87], v[44:47], a[8:11]
  ds_read_b64_tr_b16 v[60:61], v18 offset:49152
  v_mfma_f32_16x16x32_bf16 a[12:15], v[88:91], v[44:47], a[12:15]
  ds_read_b64_tr_b16 v[62:63], v18 offset:50176
  s_add_u32 m0, s53, 65536
  v_mfma_f32_16x16x32_bf16 a[16:19], v[76:79], v[48:51], a[16:19]
  buffer_load_dwordx4 v6, s[12:15], s21 offen  lds
  ds_read_b128 v[32:35], v12 offset:34816
  v_mfma_f32_16x16x32_bf16 a[20:23], v[80:83], v[48:51], a[20:23]
  ds_read_b64_tr_b16 v[64:65], v19 offset:49152
  v_mfma_f32_16x16x32_bf16 a[24:27], v[84:87], v[48:51], a[24:27]
  ds_read_b64_tr_b16 v[66:67], v19 offset:50176
  s_add_u32 m0, s52, 66560
  v_mfma_f32_16x16x32_bf16 a[28:31], v[88:91], v[48:51], a[28:31]
  buffer_load_dwordx4 v3, s[8:11], s20 offen  lds
  ds_read_b128 v[36:39], v12 offset:36864
  v_mfma_f32_16x16x32_bf16 a[32:35], v[76:79], v[52:55], a[32:35]
  ds_read_b64_tr_b16 v[68:69], v20 offset:49152
  v_mfma_f32_16x16x32_bf16 a[36:39], v[80:83], v[52:55], a[36:39]
  ds_read_b64_tr_b16 v[70:71], v20 offset:50176
  s_add_u32 m0, s53, 66560
  v_mfma_f32_16x16x32_bf16 a[40:43], v[84:87], v[52:55], a[40:43]
  buffer_load_dwordx4 v7, s[12:15], s21 offen  lds
  ds_read_b128 v[40:43], v12 offset:38912
  v_mfma_f32_16x16x32_bf16 a[44:47], v[88:91], v[52:55], a[44:47]
  ds_read_b64_tr_b16 v[72:73], v21 offset:49152
  v_mfma_f32_16x16x32_bf16 a[48:51], v[76:79], v[56:59], a[48:51]
  ds_read_b64_tr_b16 v[74:75], v21 offset:50176
  s_add_u32 m0, s52, 67584
  v_mfma_f32_16x16x32_bf16 a[52:55], v[80:83], v[56:59], a[52:55]
  buffer_load_dwordx4 v4, s[8:11], s20 offen  lds
  v_mfma_f32_16x16x32_bf16 a[56:59], v[84:87], v[56:59], a[56:59]
  v_mfma_f32_16x16x32_bf16 a[60:63], v[88:91], v[56:59], a[60:63]
  s_waitcnt lgkmcnt(0)
  s_add_u32 m0, s53, 67584
  v_mfma_f32_16x16x32_bf16 a[0:3], v[60:63], v[28:31], a[0:3]
  buffer_load_dwordx4 v8, s[12:15], s21 offen  lds
  ds_read_b128 v[44:47], v13 offset:32768
  v_mfma_f32_16x16x32_bf16 a[4:7], v[64:67], v[28:31], a[4:7]
  ds_read_b64_tr_b16 v[76:77], v18 offset:57344
  v_mfma_f32_16x16x32_bf16 a[8:11], v[68:71], v[28:31], a[8:11]
  ds_read_b64_tr_b16 v[78:79], v18 offset:58368
  v_mfma_f32_16x16x32_bf16 a[12:15], v[72:75], v[28:31], a[12:15]
  ds_read_b128 v[48:51], v13 offset:34816
  s_add_u32 m0, s52, 68608
  v_mfma_f32_16x16x32_bf16 a[16:19], v[60:63], v[32:35], a[16:19]
  buffer_load_dwordx4 v5, s[8:11], s20 offen  lds
  ds_read_b64_tr_b16 v[80:81], v19 offset:57344
  v_mfma_f32_16x16x32_bf16 a[20:23], v[64:67], v[32:35], a[20:23]
  ds_read_b64_tr_b16 v[82:83], v19 offset:58368
  v_mfma_f32_16x16x32_bf16 a[24:27], v[68:71], v[32:35], a[24:27]
  ds_read_b128 v[52:55], v13 offset:36864
  v_mfma_f32_16x16x32_bf16 a[28:31], v[72:75], v[32:35], a[28:31]
  ds_read_b64_tr_b16 v[84:85], v20 offset:57344
  s_add_u32 m0, s53, 68608
  v_mfma_f32_16x16x32_bf16 a[32:35], v[60:63], v[36:39], a[32:35]
  buffer_load_dwordx4 v9, s[12:15], s21 offen  lds
  ds_read_b64_tr_b16 v[86:87], v20 offset:58368
  v_mfma_f32_16x16x32_bf16 a[36:39], v[64:67], v[36:39], a[36:39]
  ds_read_b128 v[56:59], v13 offset:38912
  v_mfma_f32_16x16x32_bf16 a[40:43], v[68:71], v[36:39], a[40:43]
  ds_read_b64_tr_b16 v[88:89], v21 offset:57344
  v_mfma_f32_16x16x32_bf16 a[44:47], v[72:75], v[36:39], a[44:47]
  ds_read_b64_tr_b16 v[90:91], v21 offset:58368
  s_add_u32 s20, s20, 128
  v_mfma_f32_16x16x32_bf16 a[48:51], v[60:63], v[40:43], a[48:51]
  s_add_u32 s21, s21, s51
  v_mfma_f32_16x16x32_bf16 a[52:55], v[64:67], v[40:43], a[52:55]
  v_mfma_f32_16x16x32_bf16 a[56:59], v[68:71], v[40:43], a[56:59]
  v_mfma_f32_16x16x32_bf16 a[60:63], v[72:75], v[40:43], a[60:63]
  s_waitcnt lgkmcnt(0)
  v_mfma_f32_16x16x32_bf16 a[0:3], v[76:79], v[44:47], a[0:3]
  s_waitcnt vmcnt(16)
  s_barrier
  s_add_u32 m0, s52, 98304
  v_mfma_f32_16x16x32_bf16 a[4:7], v[80:83], v[44:47], a[4:7]
  buffer_load_dwordx4 v2, s[8:11], s20 offen  lds
  ds_read_b128 v[28:31], v10 offset:0
  v_mfma_f32_16x16x32_bf16 a[8:11], v[84:87], v[44:47], a[8:11]
  ds_read_b64_tr_b16 v[60:61], v14 offset:16384
  v_mfma_f32_16x16x32_bf16 a[12:15], v[88:91], v[44:47], a[12:15]
  ds_read_b64_tr_b16 v[62:63], v14 offset:17408
  s_add_u32 m0, s53, 98304
  v_mfma_f32_16x16x32_bf16 a[16:19], v[76:79], v[48:51], a[16:19]
  buffer_load_dwordx4 v6, s[12:15], s21 offen  lds
  ds_read_b128 v[32:35], v10 offset:2048
  v_mfma_f32_16x16x32_bf16 a[20:23], v[80:83], v[48:51], a[20:23]
  ds_read_b64_tr_b16 v[64:65], v15 offset:16384
  v_mfma_f32_16x16x32_bf16 a[24:27], v[84:87], v[48:51], a[24:27]
  ds_read_b64_tr_b16 v[66:67], v15 offset:17408
  s_add_u32 m0, s52, 99328
  v_mfma_f32_16x16x32_bf16 a[28:31], v[88:91], v[48:51], a[28:31]
  buffer_load_dwordx4 v3, s[8:11], s20 offen  lds
  ds_read_b128 v[36:39], v10 offset:4096
  v_mfma_f32_16x16x32_bf16 a[32:35], v[76:79], v[52:55], a[32:35]
  ds_read_b64_tr_b16 v[68:69], v16 offset:16384
  v_mfma_f32_16x16x32_bf16 a[36:39], v[80:83], v[52:55], a[36:39]
  ds_read_b64_tr_b16 v[70:71], v16 offset:17408
  s_add_u32 m0, s53, 99328
  v_mfma_f32_16x16x32_bf16 a[40:43], v[84:87], v[52:55], a[40:43]
  buffer_load_dwordx4 v7, s[12:15], s21 offen  lds
  ds_read_b128 v[40:43], v10 offset:6144
  v_mfma_f32_16x16x32_bf16 a[44:47], v[88:91], v[52:55], a[44:47]
  ds_read_b64_tr_b16 v[72:73], v17 offset:16384
  v_mfma_f32_16x16x32_bf16 a[48:51], v[76:79], v[56:59], a[48:51]
  ds_read_b64_tr_b16 v[74:75], v17 offset:17408
  s_add_u32 m0, s52, 100352
  v_mfma_f32_16x16x32_bf16 a[52:55], v[80:83], v[56:59], a[52:55]
  buffer_load_dwordx4 v4, s[8:11], s20 offen  lds
  v_mfma_f32_16x16x32_bf16 a[56:59], v[84:87], v[56:59], a[56:59]
  v_mfma_f32_16x16x32_bf16 a[60:63], v[88:91], v[56:59], a[60:63]
  s_branch L_g4_loop
L_g4_fin:
  s_cmp_lg_u32 s32, 0
  s_cbranch_scc1 L_rq_8
  s_cmp_eq_u32 s39, 0
  s_cbranch_scc1 L_rq_8
  s_lshl_b32 s99, s33, 7
  s_add_u32 s99, s99, 0x3d00200
  v_mov_b32 v244, 1
  v_mov_b32 v245, 0
  s_mov_b64 exec, 1
  buffer_atomic_add v244, v245, s[4:7], s99 offen sc0 sc1
  s_mov_b64 exec, -1
L_rq_8:
  s_waitcnt lgkmcnt(0)
  s_add_u32 m0, s53, 100352
  v_mfma_f32_16x16x32_bf16 a[0:3], v[60:63], v[28:31], a[0:3]
  buffer_load_dwordx4 v8, s[12:15], s21 offen  lds
  ds_read_b128 v[44:47], v11 offset:0
  v_mfma_f32_16x16x32_bf16 a[4:7], v[64:67], v[28:31], a[4:7]
  ds_read_b64_tr_b16 v[76:77], v14 offset:24576
  v_mfma_f32_16x16x32_bf16 a[8:11], v[68:71], v[28:31], a[8:11]
  ds_read_b64_tr_b16 v[78:79], v14 offset:25600
  v_mfma_f32_16x16x32_bf16 a[12:15], v[72:75], v[28:31], a[12:15]
  ds_read_b128 v[48:51], v11 offset:2048
  s_add_u32 m0, s52, 101376
  v_mfma_f32_16x16x32_bf16 a[16:19], v[60:63], v[32:35], a[16:19]
  buffer_load_dwordx4 v5, s[8:11], s20 offen  lds
  ds_read_b64_tr_b16 v[80:81], v15 offset:24576
  v_mfma_f32_16x16x32_bf16 a[20:23], v[64:67], v[32:35], a[20:23]
  ds_read_b64_tr_b16 v[82:83], v15 offset:25600
  v_mfma_f32_16x16x32_bf16 a[24:27], v[68:71], v[32:35], a[24:27]
  ds_read_b128 v[52:55], v11 offset:4096
  v_mfma_f32_16x16x32_bf16 a[28:31], v[72:75], v[32:35], a[28:31]
  ds_read_b64_tr_b16 v[84:85], v16 offset:24576
  s_add_u32 m0, s53, 101376
  v_mfma_f32_16x16x32_bf16 a[32:35], v[60:63], v[36:39], a[32:35]
  buffer_load_dwordx4 v9, s[12:15], s21 offen  lds
  ds_read_b64_tr_b16 v[86:87], v16 offset:25600
  v_mfma_f32_16x16x32_bf16 a[36:39], v[64:67], v[36:39], a[36:39]
  ds_read_b128 v[56:59], v11 offset:6144
  v_mfma_f32_16x16x32_bf16 a[40:43], v[68:71], v[36:39], a[40:43]
  ds_read_b64_tr_b16 v[88:89], v17 offset:24576
  v_mfma_f32_16x16x32_bf16 a[44:47], v[72:75], v[36:39], a[44:47]
  ds_read_b64_tr_b16 v[90:91], v17 offset:25600
  s_add_u32 s20, s20, 128
  v_mfma_f32_16x16x32_bf16 a[48:51], v[60:63], v[40:43], a[48:51]
  s_add_u32 s21, s21, s51
  v_mfma_f32_16x16x32_bf16 a[52:55], v[64:67], v[40:43], a[52:55]
  v_mfma_f32_16x16x32_bf16 a[56:59], v[68:71], v[40:43], a[56:59]
  v_mfma_f32_16x16x32_bf16 a[60:63], v[72:75], v[40:43], a[60:63]
  s_waitcnt lgkmcnt(0)
  v_mfma_f32_16x16x32_bf16 a[0:3], v[76:79], v[44:47], a[0:3]
  s_waitcnt vmcnt(16)
  s_barrier
  v_mfma_f32_16x16x32_bf16 a[4:7], v[80:83], v[44:47], a[4:7]
  ds_read_b128 v[28:31], v10 offset:32768
  v_mfma_f32_16x16x32_bf16 a[8:11], v[84:87], v[44:47], a[8:11]
  ds_read_b64_tr_b16 v[60:61], v14 offset:49152
  v_mfma_f32_16x16x32_bf16 a[12:15], v[88:91], v[44:47], a[12:15]
  ds_read_b64_tr_b16 v[62:63], v14 offset:50176
  v_mfma_f32_16x16x32_bf16 a[16:19], v[76:79], v[48:51], a[16:19]
  ds_read_b128 v[32:35], v10 offset:34816
  v_mfma_f32_16x16x32_bf16 a[20:23], v[80:83], v[48:51], a[20:23]
  ds_read_b64_tr_b16 v[64:65], v15 offset:49152
  v_mfma_f32_16x16x32_bf16 a[24:27], v[84:87], v[48:51], a[24:27]
  ds_read_b64_tr_b16 v[66:67], v15 offset:50176
  v_mfma_f32_16x16x32_bf16 a[28:31], v[88:91], v[48:51], a[28:31]
  ds_read_b128 v[36:39], v10 offset:36864
  v_mfma_f32_16x16x32_bf16 a[32:35], v[76:79], v[52:55], a[32:35]
  ds_read_b64_tr_b16 v[68:69], v16 offset:49152
  v_mfma_f32_16x16x32_bf16 a[36:39], v[80:83], v[52:55], a[36:39]
  ds_read_b64_tr_b16 v[70:71], v16 offset:50176
  v_mfma_f32_16x16x32_bf16 a[40:43], v[84:87], v[52:55], a[40:43]
  ds_read_b128 v[40:43], v10 offset:38912
  v_mfma_f32_16x16x32_bf16 a[44:47], v[88:91], v[52:55], a[44:47]
  ds_read_b64_tr_b16 v[72:73], v17 offset:49152
  v_mfma_f32_16x16x32_bf16 a[48:51], v[76:79], v[56:59], a[48:51]
  ds_read_b64_tr_b16 v[74:75], v17 offset:50176
  v_mfma_f32_16x16x32_bf16 a[52:55], v[80:83], v[56:59], a[52:55]
  v_mfma_f32_16x16x32_bf16 a[56:59], v[84:87], v[56:59], a[56:59]
  v_mfma_f32_16x16x32_bf16 a[60:63], v[88:91], v[56:59], a[60:63]
  s_waitcnt lgkmcnt(0)
  v_mfma_f32_16x16x32_bf16 a[0:3], v[60:63], v[28:31], a[0:3]
  ds_read_b128 v[44:47], v11 offset:32768
  v_mfma_f32_16x16x32_bf16 a[4:7], v[64:67], v[28:31], a[4:7]
  ds_read_b64_tr_b16 v[76:77], v14 offset:57344
  v_mfma_f32_16x16x32_bf16 a[8:11], v[68:71], v[28:31], a[8:11]
  ds_read_b64_tr_b16 v[78:79], v14 offset:58368
  v_mfma_f32_16x16x32_bf16 a[12:15], v[72:75], v[28:31], a[12:15]
  ds_read_b128 v[48:51], v11 offset:34816
  v_mfma_f32_16x16x32_bf16 a[16:19], v[60:63], v[32:35], a[16:19]
  ds_read_b64_tr_b16 v[80:81], v15 offset:57344
  v_mfma_f32_16x16x32_bf16 a[20:23], v[64:67], v[32:35], a[20:23]
  ds_read_b64_tr_b16 v[82:83], v15 offset:58368
  v_mfma_f32_16x16x32_bf16 a[24:27], v[68:71], v[32:35], a[24:27]
  ds_read_b128 v[52:55], v11 offset:36864
  v_mfma_f32_16x16x32_bf16 a[28:31], v[72:75], v[32:35], a[28:31]
  ds_read_b64_tr_b16 v[84:85], v16 offset:57344
  v_mfma_f32_16x16x32_bf16 a[32:35], v[60:63], v[36:39], a[32:35]
  ds_read_b64_tr_b16 v[86:87], v16 offset:58368
  v_mfma_f32_16x16x32_bf16 a[36:39], v[64:67], v[36:39], a[36:39]
  ds_read_b128 v[56:59], v11 offset:38912
  v_mfma_f32_16x16x32_bf16 a[40:43], v[68:71], v[36:39], a[40:43]
  ds_read_b64_tr_b16 v[88:89], v17 offset:57344
  v_mfma_f32_16x16x32_bf16 a[44:47], v[72:75], v[36:39], a[44:47]
  ds_read_b64_tr_b16 v[90:91], v17 offset:58368
  v_mfma_f32_16x16x32_bf16 a[48:51], v[60:63], v[40:43], a[48:51]
  v_mfma_f32_16x16x32_bf16 a[52:55], v[64:67], v[40:43], a[52:55]
  v_mfma_f32_16x16x32_bf16 a[56:59], v[68:71], v[40:43], a[56:59]
  v_mfma_f32_16x16x32_bf16 a[60:63], v[72:75], v[40:43], a[60:63]
  s_waitcnt lgkmcnt(0)
  v_mfma_f32_16x16x32_bf16 a[0:3], v[76:79], v[44:47], a[0:3]
  s_waitcnt vmcnt(8)
  s_barrier
  v_mfma_f32_16x16x32_bf16 a[4:7], v[80:83], v[44:47], a[4:7]
  ds_read_b128 v[28:31], v12 offset:0
  v_mfma_f32_16x16x32_bf16 a[8:11], v[84:87], v[44:47], a[8:11]
  ds_read_b64_tr_b16 v[60:61], v18 offset:16384
  v_mfma_f32_16x16x32_bf16 a[12:15], v[88:91], v[44:47], a[12:15]
  ds_read_b64_tr_b16 v[62:63], v18 offset:17408
  v_mfma_f32_16x16x32_bf16 a[16:19], v[76:79], v[48:51], a[16:19]
  ds_read_b128 v[32:35], v12 offset:2048
  v_mfma_f32_16x16x32_bf16 a[20:23], v[80:83], v[48:51], a[20:23]
  ds_read_b64_tr_b16 v[64:65], v19 offset:16384
  v_mfma_f32_16x16x32_bf16 a[24:27], v[84:87], v[48:51], a[24:27]
  ds_read_b64_tr_b16 v[66:67], v19 offset:17408
  v_mfma_f32_16x16x32_bf16 a[28:31], v[88:91], v[48:51], a[28:31]
  ds_read_b128 v[36:39], v12 offset:4096
  v_mfma_f32_16x16x32_bf16 a[32:35], v[76:79], v[52:55], a[32:35]
  ds_read_b64_tr_b16 v[68:69], v20 offset:16384
  v_mfma_f32_16x16x32_bf16 a[36:39], v[80:83], v[52:55], a[36:39]
  ds_read_b64_tr_b16 v[70:71], v20 offset:17408
  v_mfma_f32_16x16x32_bf16 a[40:43], v[84:87], v[52:55], a[40:43]
  ds_read_b128 v[40:43], v12 offset:6144
  v_mfma_f32_16x16x32_bf16 a[44:47], v[88:91], v[52:55], a[44:47]
  ds_read_b64_tr_b16 v[72:73], v21 offset:16384
  v_mfma_f32_16x16x32_bf16 a[48:51], v[76:79], v[56:59], a[48:51]
  ds_read_b64_tr_b16 v[74:75], v21 offset:17408
  v_mfma_f32_16x16x32_bf16 a[52:55], v[80:83], v[56:59], a[52:55]
  v_mfma_f32_16x16x32_bf16 a[56:59], v[84:87], v[56:59], a[56:59]
  v_mfma_f32_16x16x32_bf16 a[60:63], v[88:91], v[56:59], a[60:63]
  s_waitcnt lgkmcnt(0)
  v_mfma_f32_16x16x32_bf16 a[0:3], v[60:63], v[28:31], a[0:3]
  ds_read_b128 v[44:47], v13 offset:0
  v_mfma_f32_16x16x32_bf16 a[4:7], v[64:67], v[28:31], a[4:7]
  ds_read_b64_tr_b16 v[76:77], v18 offset:24576
  v_mfma_f32_16x16x32_bf16 a[8:11], v[68:71], v[28:31], a[8:11]
  ds_read_b64_tr_b16 v[78:79], v18 offset:25600
  v_mfma_f32_16x16x32_bf16 a[12:15], v[72:75], v[28:31], a[12:15]
  ds_read_b128 v[48:51], v13 offset:2048
  v_mfma_f32_16x16x32_bf16 a[16:19], v[60:63], v[32:35], a[16:19]
  ds_read_b64_tr_b16 v[80:81], v19 offset:24576
  v_mfma_f32_16x16x32_bf16 a[20:23], v[64:67], v[32:35], a[20:23]
  ds_read_b64_tr_b16 v[82:83], v19 offset:25600
  v_mfma_f32_16x16x32_bf16 a[24:27], v[68:71], v[32:35], a[24:27]
  ds_read_b128 v[52:55], v13 offset:4096
  v_mfma_f32_16x16x32_bf16 a[28:31], v[72:75], v[32:35], a[28:31]
  ds_read_b64_tr_b16 v[84:85], v20 offset:24576
  v_mfma_f32_16x16x32_bf16 a[32:35], v[60:63], v[36:39], a[32:35]
  ds_read_b64_tr_b16 v[86:87], v20 offset:25600
  v_mfma_f32_16x16x32_bf16 a[36:39], v[64:67], v[36:39], a[36:39]
  ds_read_b128 v[56:59], v13 offset:6144
  v_mfma_f32_16x16x32_bf16 a[40:43], v[68:71], v[36:39], a[40:43]
  ds_read_b64_tr_b16 v[88:89], v21 offset:24576
  v_mfma_f32_16x16x32_bf16 a[44:47], v[72:75], v[36:39], a[44:47]
  ds_read_b64_tr_b16 v[90:91], v21 offset:25600
  v_mfma_f32_16x16x32_bf16 a[48:51], v[60:63], v[40:43], a[48:51]
  v_mfma_f32_16x16x32_bf16 a[52:55], v[64:67], v[40:43], a[52:55]
  v_mfma_f32_16x16x32_bf16 a[56:59], v[68:71], v[40:43], a[56:59]
  v_mfma_f32_16x16x32_bf16 a[60:63], v[72:75], v[40:43], a[60:63]
  s_waitcnt lgkmcnt(0)
  v_mfma_f32_16x16x32_bf16 a[0:3], v[76:79], v[44:47], a[0:3]
  s_waitcnt vmcnt(0)
  s_barrier
  v_mfma_f32_16x16x32_bf16 a[4:7], v[80:83], v[44:47], a[4:7]
  ds_read_b128 v[28:31], v12 offset:32768
  v_mfma_f32_16x16x32_bf16 a[8:11], v[84:87], v[44:47], a[8:11]
  ds_read_b64_tr_b16 v[60:61], v18 offset:49152
  v_mfma_f32_16x16x32_bf16 a[12:15], v[88:91], v[44:47], a[12:15]
  ds_read_b64_tr_b16 v[62:63], v18 offset:50176
  v_mfma_f32_16x16x32_bf16 a[16:19], v[76:79], v[48:51], a[16:19]
  ds_read_b128 v[32:35], v12 offset:34816
  v_mfma_f32_16x16x32_bf16 a[20:23], v[80:83], v[48:51], a[20:23]
  ds_read_b64_tr_b16 v[64:65], v19 offset:49152
  v_mfma_f32_16x16x32_bf16 a[24:27], v[84:87], v[48:51], a[24:27]
  ds_read_b64_tr_b16 v[66:67], v19 offset:50176
  v_mfma_f32_16x16x32_bf16 a[28:31], v[88:91], v[48:51], a[28:31]
  ds_read_b128 v[36:39], v12 offset:36864
  v_mfma_f32_16x16x32_bf16 a[32:35], v[76:79], v[52:55], a[32:35]
  ds_read_b64_tr_b16 v[68:69], v20 offset:49152
  v_mfma_f32_16x16x32_bf16 a[36:39], v[80:83], v[52:55], a[36:39]
  ds_read_b64_tr_b16 v[70:71], v20 offset:50176
  v_mfma_f32_16x16x32_bf16 a[40:43], v[84:87], v[52:55], a[40:43]
  ds_read_b128 v[40:43], v12 offset:38912
  v_mfma_f32_16x16x32_bf16 a[44:47], v[88:91], v[52:55], a[44:47]
  ds_read_b64_tr_b16 v[72:73], v21 offset:49152
  v_mfma_f32_16x16x32_bf16 a[48:51], v[76:79], v[56:59], a[48:51]
  ds_read_b64_tr_b16 v[74:75], v21 offset:50176
  v_mfma_f32_16x16x32_bf16 a[52:55], v[80:83], v[56:59], a[52:55]
  v_mfma_f32_16x16x32_bf16 a[56:59], v[84:87], v[56:59], a[56:59]
  v_mfma_f32_16x16x32_bf16 a[60:63], v[88:91], v[56:59], a[60:63]
  s_waitcnt lgkmcnt(0)
  v_mfma_f32_16x16x32_bf16 a[0:3], v[60:63], v[28:31], a[0:3]
  ds_read_b128 v[44:47], v13 offset:32768
  v_mfma_f32_16x16x32_bf16 a[4:7], v[64:67], v[28:31], a[4:7]
  ds_read_b64_tr_b16 v[76:77], v18 offset:57344
  v_mfma_f32_16x16x32_bf16 a[8:11], v[68:71], v[28:31], a[8:11]
  ds_read_b64_tr_b16 v[78:79], v18 offset:58368
  v_mfma_f32_16x16x32_bf16 a[12:15], v[72:75], v[28:31], a[12:15]
  ds_read_b128 v[48:51], v13 offset:34816
  v_mfma_f32_16x16x32_bf16 a[16:19], v[60:63], v[32:35], a[16:19]
  ds_read_b64_tr_b16 v[80:81], v19 offset:57344
  v_mfma_f32_16x16x32_bf16 a[20:23], v[64:67], v[32:35], a[20:23]
  ds_read_b64_tr_b16 v[82:83], v19 offset:58368
  v_mfma_f32_16x16x32_bf16 a[24:27], v[68:71], v[32:35], a[24:27]
  ds_read_b128 v[52:55], v13 offset:36864
  v_mfma_f32_16x16x32_bf16 a[28:31], v[72:75], v[32:35], a[28:31]
  ds_read_b64_tr_b16 v[84:85], v20 offset:57344
  v_mfma_f32_16x16x32_bf16 a[32:35], v[60:63], v[36:39], a[32:35]
  ds_read_b64_tr_b16 v[86:87], v20 offset:58368
  v_mfma_f32_16x16x32_bf16 a[36:39], v[64:67], v[36:39], a[36:39]
  ds_read_b128 v[56:59], v13 offset:38912
  v_mfma_f32_16x16x32_bf16 a[40:43], v[68:71], v[36:39], a[40:43]
  ds_read_b64_tr_b16 v[88:89], v21 offset:57344
  v_mfma_f32_16x16x32_bf16 a[44:47], v[72:75], v[36:39], a[44:47]
  ds_read_b64_tr_b16 v[90:91], v21 offset:58368
  v_mfma_f32_16x16x32_bf16 a[48:51], v[60:63], v[40:43], a[48:51]
  v_mfma_f32_16x16x32_bf16 a[52:55], v[64:67], v[40:43], a[52:55]
  v_mfma_f32_16x16x32_bf16 a[56:59], v[68:71], v[40:43], a[56:59]
  v_mfma_f32_16x16x32_bf16 a[60:63], v[72:75], v[40:43], a[60:63]
  s_waitcnt lgkmcnt(0)
  v_mfma_f32_16x16x32_bf16 a[0:3], v[76:79], v[44:47], a[0:3]
  v_mfma_f32_16x16x32_bf16 a[4:7], v[80:83], v[44:47], a[4:7]
  v_mfma_f32_16x16x32_bf16 a[8:11], v[84:87], v[44:47], a[8:11]
  v_mfma_f32_16x16x32_bf16 a[12:15], v[88:91], v[44:47], a[12:15]
  v_mfma_f32_16x16x32_bf16 a[16:19], v[76:79], v[48:51], a[16:19]
  v_mfma_f32_16x16x32_bf16 a[20:23], v[80:83], v[48:51], a[20:23]
  v_mfma_f32_16x16x32_bf16 a[24:27], v[84:87], v[48:51], a[24:27]
  v_mfma_f32_16x16x32_bf16 a[28:31], v[88:91], v[48:51], a[28:31]
  v_mfma_f32_16x16x32_bf16 a[32:35], v[76:79], v[52:55], a[32:35]
  v_mfma_f32_16x16x32_bf16 a[36:39], v[80:83], v[52:55], a[36:39]
  v_mfma_f32_16x16x32_bf16 a[40:43], v[84:87], v[52:55], a[40:43]
  v_mfma_f32_16x16x32_bf16 a[44:47], v[88:91], v[52:55], a[44:47]
  v_mfma_f32_16x16x32_bf16 a[48:51], v[76:79], v[56:59], a[48:51]
  v_mfma_f32_16x16x32_bf16 a[52:55], v[80:83], v[56:59], a[52:55]
  v_mfma_f32_16x16x32_bf16 a[56:59], v[84:87], v[56:59], a[56:59]
  v_mfma_f32_16x16x32_bf16 a[60:63], v[88:91], v[56:59], a[60:63]
  s_mov_b32 s59, 3
  s_mov_b32 s60, s22
  s_mov_b32 s61, s26
  s_add_u32 s62, s38, 0x3d00000
  s_mov_b32 s63, s98
  s_cmp_lg_u32 s39, 0
  s_cbranch_scc1 L_got
  s_mov_b32 s58, 3
  s_branch L_epi
L_g5:
  s_waitcnt vmcnt(25)
  s_barrier
  ds_read_b128 v[28:31], v10 offset:0
  ds_read_b64_tr_b16 v[60:61], v14 offset:16384
  ds_read_b64_tr_b16 v[62:63], v14 offset:17408
  ds_read_b128 v[32:35], v10 offset:2048
  ds_read_b64_tr_b16 v[64:65], v15 offset:16384
  ds_read_b64_tr_b16 v[66:67], v15 offset:17408
  ds_read_b128 v[36:39], v10 offset:4096
  ds_read_b64_tr_b16 v[68:69], v16 offset:16384
  ds_read_b64_tr_b16 v[70:71], v16 offset:17408
  ds_read_b128 v[40:43], v10 offset:6144
  ds_read_b64_tr_b16 v[72:73], v17 offset:16384
  ds_read_b64_tr_b16 v[74:75], v17 offset:17408
  s_sub_u32 s25, s25, 1
  s_waitcnt lgkmcnt(0)
  v_mfma_f32_16x16x32_bf16 a[0:3], v[28:31], v[60:63], 0
  ds_read_b128 v[44:47], v11 offset:0
  v_mfma_f32_16x16x32_bf16 a[4:7], v[28:31], v[64:67], 0
  ds_read_b64_tr_b16 v[76:77], v14 offset:24576
  v_mfma_f32_16x16x32_bf16 a[8:11], v[28:31], v[68:71], 0
  ds_read_b64_tr_b16 v[78:79], v14 offset:25600
  v_mfma_f32_16x16x32_bf16 a[12:15], v[28:31], v[72:75], 0
  ds_read_b128 v[48:51], v11 offset:2048
  v_mfma_f32_16x16x32_bf16 a[16:19], v[32:35], v[60:63], 0
  ds_read_b64_tr_b16 v[80:81], v15 offset:24576
  v_mfma_f32_16x16x32_bf16 a[20:23], v[32:35], v[64:67], 0
  ds_read_b64_tr_b16 v[82:83], v15 offset:25600
  v_mfma_f32_16x16x32_bf16 a[24:27], v[32:35], v[68:71], 0
  ds_read_b128 v[52:55], v11 offset:4096
  v_mfma_f32_16x16x32_bf16 a[28:31], v[32:35], v[72:75], 0
  ds_read_b64_tr_b16 v[84:85], v16 offset:24576
  v_mfma_f32_16x16x32_bf16 a[32:35], v[36:39], v[60:63], 0
  ds_read_b64_tr_b16 v[86:87], v16 offset:25600
  v_mfma_f32_16x16x32_bf16 a[36:39], v[36:39], v[64:67], 0
  ds_read_b128 v[56:59], v11 offset:6144
  v_mfma_f32_16x16x32_bf16 a[40:43], v[36:39], v[68:71], 0
  ds_read_b64_tr_b16 v[88:89], v17 offset:24576
  v_mfma_f32_16x16x32_bf16 a[44:47], v[36:39], v[72:75], 0
  ds_read_b64_tr_b16 v[90:91], v17 offset:25600
  v_mfma_f32_16x16x32_bf16 a[48:51], v[40:43], v[60:63], 0
  v_mfma_f32_16x16x32_bf16 a[52:55], v[40:43], v[64:67], 0
  v_mfma_f32_16x16x32_bf16 a[56:59], v[40:43], v[68:71], 0
  v_mfma_f32_16x16x32_bf16 a[60:63], v[40:43], v[72:75], 0
  s_waitcnt lgkmcnt(0)
  v_mfma_f32_16x16x32_bf16 a[0:3], v[44:47], v[76:79], a[0:3]
  s_waitcnt vmcnt(17)
  s_barrier
  s_add_u32 m0, s52, 0
  v_mfma_f32_16x16x32_bf16 a[4:7], v[44:47], v[80:83], a[4:7]
  buffer_load_dwordx4 v2, s[8:11], s20 offen  lds
  ds_read_b128 v[28:31], v10 offset:32768
  v_mfma_f32_16x16x32_bf16 a[8:11], v[44:47], v[84:87], a[8:11]
  ds_read_b64_tr_b16 v[60:61], v14 offset:49152
  v_mfma_f32_16x16x32_bf16 a[12:15], v[44:47], v[88:91], a[12:15]
  ds_read_b64_tr_b16 v[62:63], v14 offset:50176
  s_add_u32 m0, s53, 0
  v_mfma_f32_16x16x32_bf16 a[16:19], v[48:51], v[76:79], a[16:19]
  buffer_load_dwordx4 v6, s[12:15], s21 offen  lds
  ds_read_b128 v[32:35], v10 offset:34816
  v_mfma_f32_16x16x32_bf16 a[20:23], v[48:51], v[80:83], a[20:23]
  ds_read_b64_tr_b16 v[64:65], v15 offset:49152
  v_mfma_f32_16x16x32_bf16 a[24:27], v[48:51], v[84:87], a[24:27]
  ds_read_b64_tr_b16 v[66:67], v15 offset:50176
  s_add_u32 m0, s52, 1024
  v_mfma_f32_16x16x32_bf16 a[28:31], v[48:51], v[88:91], a[28:31]
  buffer_load_dwordx4 v3, s[8:11], s20 offen  lds
  ds_read_b128 v[36:39], v10 offset:36864
  v_mfma_f32_16x16x32_bf16 a[32:35], v[52:55], v[76:79], a[32:35]
  ds_read_b64_tr_b16 v[68:69], v16 offset:49152
  v_mfma_f32_16x16x32_bf16 a[36:39], v[52:55], v[80:83], a[36:39]
  ds_read_b64_tr_b16 v[70:71], v16 offset:50176
  s_add_u32 m0, s53, 1024
  v_mfma_f32_16x16x32_bf16 a[40:43], v[52:55], v[84:87], a[40:43]
  buffer_load_dwordx4 v7, s[12:15], s21 offen  lds
  ds_read_b128 v[40:43], v10 offset:38912
  v_mfma_f32_16x16x32_bf16 a[44:47], v[52:55], v[88:91], a[44:47]
  ds_read_b64_tr_b16 v[72:73], v17 offset:49152
  v_mfma_f32_16x16x32_bf16 a[48:51], v[56:59], v[76:79], a[48:51]
  ds_read_b64_tr_b16 v[74:75], v17 offset:50176
  s_add_u32 m0, s52, 2048
  v_mfma_f32_16x16x32_bf16 a[52:55], v[56:59], v[80:83], a[52:55]
  buffer_load_dwordx4 v4, s[8:11], s20 offen  lds
  v_mfma_f32_16x16x32_bf16 a[56:59], v[56:59], v[84:87], a[56:59]
  v_mfma_f32_16x16x32_bf16 a[60:63], v[56:59], v[88:91], a[60:63]
  s_waitcnt lgkmcnt(0)
  s_add_u32 m0, s53, 2048
  v_mfma_f32_16x16x32_bf16 a[0:3], v[28:31], v[60:63], a[0:3]
  buffer_load_dwordx4 v8, s[12:15], s21 offen  lds
  ds_read_b128 v[44:47], v11 offset:32768
  v_mfma_f32_16x16x32_bf16 a[4:7], v[28:31], v[64:67], a[4:7]
  ds_read_b64_tr_b16 v[76:77], v14 offset:57344
  v_mfma_f32_16x16x32_bf16 a[8:11], v[28:31], v[68:71], a[8:11]
  ds_read_b64_tr_b16 v[78:79], v14 offset:58368
  v_mfma_f32_16x16x32_bf16 a[12:15], v[28:31], v[72:75], a[12:15]
  ds_read_b128 v[48:51], v11 offset:34816
  s_add_u32 m0, s52, 3072
  v_mfma_f32_16x16x32_bf16 a[16:19], v[32:35], v[60:63], a[16:19]
  buffer_load_dwordx4 v5, s[8:11], s20 offen  lds
  ds_read_b64_tr_b16 v[80:81], v15 offset:57344
  v_mfma_f32_16x16x32_bf16 a[20:23], v[32:35], v[64:67], a[20:23]
  ds_read_b64_tr_b16 v[82:83], v15 offset:58368
  v_mfma_f32_16x16x32_bf16 a[24:27], v[32:35], v[68:71], a[24:27]
  ds_read_b128 v[52:55], v11 offset:36864
  v_mfma_f32_16x16x32_bf16 a[28:31], v[32:35], v[72:75], a[28:31]
  ds_read_b64_tr_b16 v[84:85], v16 offset:57344
  s_add_u32 m0, s53, 3072
  v_mfma_f32_16x16x32_bf16 a[32:35], v[36:39], v[60:63], a[32:35]
  buffer_load_dwordx4 v9, s[12:15], s21 offen  lds
  ds_read_b64_tr_b16 v[86:87], v16 offset:58368
  v_mfma_f32_16x16x32_bf16 a[36:39], v[36:39], v[64:67], a[36:39]
  ds_read_b128 v[56:59], v11 offset:38912
  v_mfma_f32_16x16x32_bf16 a[40:43], v[36:39], v[68:71], a[40:43]
  ds_read_b64_tr_b16 v[88:89], v17 offset:57344
  v_mfma_f32_16x16x32_bf16 a[44:47], v[36:39], v[72:75], a[44:47]
  ds_read_b64_tr_b16 v[90:91], v17 offset:58368
  s_add_u32 s20, s20, 128
  v_mfma_f32_16x16x32_bf16 a[48:51], v[40:43], v[60:63], a[48:51]
  s_add_u32 s21, s21, s51
  v_mfma_f32_16x16x32_bf16 a[52:55], v[40:43], v[64:67], a[52:55]
  v_mfma_f32_16x16x32_bf16 a[56:59], v[40:43], v[68:71], a[56:59]
  v_mfma_f32_16x16x32_bf16 a[60:63], v[40:43], v[72:75], a[60:63]
  s_waitcnt lgkmcnt(0)
  v_mfma_f32_16x16x32_bf16 a[0:3], v[44:47], v[76:79], a[0:3]
  s_waitcnt vmcnt(17)
  s_barrier
  s_add_u32 m0, s52, 32768
  v_mfma_f32_16x16x32_bf16 a[4:7], v[44:47], v[80:83], a[4:7]
  buffer_load_dwordx4 v2, s[8:11], s20 offen  lds
  ds_read_b128 v[28:31], v12 offset:0
  v_mfma_f32_16x16x32_bf16 a[8:11], v[44:47], v[84:87], a[8:11]
  ds_read_b64_tr_b16 v[60:61], v18 offset:16384
  v_mfma_f32_16x16x32_bf16 a[12:15], v[44:47], v[88:91], a[12:15]
  ds_read_b64_tr_b16 v[62:63], v18 offset:17408
  s_add_u32 m0, s53, 32768
  v_mfma_f32_16x16x32_bf16 a[16:19], v[48:51], v[76:79], a[16:19]
  buffer_load_dwordx4 v6, s[12:15], s21 offen  lds
  ds_read_b128 v[32:35], v12 offset:2048
  v_mfma_f32_16x16x32_bf16 a[20:23], v[48:51], v[80:83], a[20:23]
  ds_read_b64_tr_b16 v[64:65], v19 offset:16384
  v_mfma_f32_16x16x32_bf16 a[24:27], v[48:51], v[84:87], a[24:27]
  ds_read_b64_tr_b16 v[66:67], v19 offset:17408
  s_add_u32 m0, s52, 33792
  v_mfma_f32_16x16x32_bf16 a[28:31], v[48:51], v[88:91], a[28:31]
  buffer_load_dwordx4 v3, s[8:11], s20 offen  lds
  ds_read_b128 v[36:39], v12 offset:4096
  v_mfma_f32_16x16x32_bf16 a[32:35], v[52:55], v[76:79], a[32:35]
  ds_read_b64_tr_b16 v[68:69], v20 offset:16384
  v_mfma_f32_16x16x32_bf16 a[36:39], v[52:55], v[80:83], a[36:39]
  ds_read_b64_tr_b16 v[70:71], v20 offset:17408
  s_add_u32 m0, s53, 33792
  v_mfma_f32_16x16x32_bf16 a[40:43], v[52:55], v[84:87], a[40:43]
  buffer_load_dwordx4 v7, s[12:15], s21 offen  lds
  ds_read_b128 v[40:43], v12 offset:6144
  v_mfma_f32_16x16x32_bf16 a[44:47], v[52:55], v[88:91], a[44:47]
  ds_read_b64_tr_b16 v[72:73], v21 offset:16384
  v_mfma_f32_16x16x32_bf16 a[48:51], v[56:59], v[76:79], a[48:51]
  ds_read_b64_tr_b16 v[74:75], v21 offset:17408
  s_add_u32 m0, s52, 34816
  v_mfma_f32_16x16x32_bf16 a[52:55], v[56:59], v[80:83], a[52:55]
  buffer_load_dwordx4 v4, s[8:11], s20 offen  lds
  v_mfma_f32_16x16x32_bf16 a[56:59], v[56:59], v[84:87], a[56:59]
  v_mfma_f32_16x16x32_bf16 a[60:63], v[56:59], v[88:91], a[60:63]
  s_waitcnt lgkmcnt(0)
  s_add_u32 m0, s53, 34816
  v_mfma_f32_16x16x32_bf16 a[0:3], v[28:31], v[60:63], a[0:3]
  buffer_load_dwordx4 v8, s[12:15], s21 offen  lds
  ds_read_b128 v[44:47], v13 offset:0
  v_mfma_f32_16x16x32_bf16 a[4:7], v[28:31], v[64:67], a[4:7]
  ds_read_b64_tr_b16 v[76:77], v18 offset:24576
  v_mfma_f32_16x16x32_bf16 a[8:11], v[28:31], v[68:71], a[8:11]
  ds_read_b64_tr_b16 v[78:79], v18 offset:25600
  v_mfma_f32_16x16x32_bf16 a[12:15], v[28:31], v[72:75], a[12:15]
  ds_read_b128 v[48:51], v13 offset:2048
  s_add_u32 m0, s52, 35840
  v_mfma_f32_16x16x32_bf16 a[16:19], v[32:35], v[60:63], a[16:19]
  buffer_load_dwordx4 v5, s[8:11], s20 offen  lds
  ds_read_b64_tr_b16 v[80:81], v19 offset:24576
  v_mfma_f32_16x16x32_bf16 a[20:23], v[32:35], v[64:67], a[20:23]
  ds_read_b64_tr_b16 v[82:83], v19 offset:25600
  v_mfma_f32_16x16x32_bf16 a[24:27], v[32:35], v[68:71], a[24:27]
  ds_read_b128 v[52:55], v13 offset:4096
  v_mfma_f32_16x16x32_bf16 a[28:31], v[32:35], v[72:75], a[28:31]
  ds_read_b64_tr_b16 v[84:85], v20 offset:24576
  s_add_u32 m0, s53, 35840
  v_mfma_f32_16x16x32_bf16 a[32:35], v[36:39], v[60:63], a[32:35]
  buffer_load_dwordx4 v9, s[12:15], s21 offen  lds
  ds_read_b64_tr_b16 v[86:87], v20 offset:25600
  v_mfma_f32_16x16x32_bf16 a[36:39], v[36:39], v[64:67], a[36:39]
  ds_read_b128 v[56:59], v13 offset:6144
  v_mfma_f32_16x16x32_bf16 a[40:43], v[36:39], v[68:71], a[40:43]
  ds_read_b64_tr_b16 v[88:89], v21 offset:24576
  v_mfma_f32_16x16x32_bf16 a[44:47], v[36:39], v[72:75], a[44:47]
  ds_read_b64_tr_b16 v[90:91], v21 offset:25600
  s_add_u32 s20, s20, 128
  v_mfma_f32_16x16x32_bf16 a[48:51], v[40:43], v[60:63], a[48:51]
  s_add_u32 s21, s21, s51
  v_mfma_f32_16x16x32_bf16 a[52:55], v[40:43], v[64:67], a[52:55]
  v_mfma_f32_16x16x32_bf16 a[56:59], v[40:43], v[68:71], a[56:59]
  v_mfma_f32_16x16x32_bf16 a[60:63], v[40:43], v[72:75], a[60:63]
  s_waitcnt lgkmcnt(0)
  v_mfma_f32_16x16x32_bf16 a[0:3], v[44:47], v[76:79], a[0:3]
  s_waitcnt vmcnt(17)
  s_barrier
  s_add_u32 m0, s52, 65536
  v_mfma_f32_16x16x32_bf16 a[4:7], v[44:47], v[80:83], a[4:7]
  buffer_load_dwordx4 v2, s[8:11], s20 offen  lds
  ds_read_b128 v[28:31], v12 offset:32768
  v_mfma_f32_16x16x32_bf16 a[8:11], v[44:47], v[84:87], a[8:11]
  ds_read_b64_tr_b16 v[60:61], v18 offset:49152
  v_mfma_f32_16x16x32_bf16 a[12:15], v[44:47], v[88:91], a[12:15]
  ds_read_b64_tr_b16 v[62:63], v18 offset:50176
  s_add_u32 m0, s53, 65536
  v_mfma_f32_16x16x32_bf16 a[16:19], v[48:51], v[76:79], a[16:19]
  buffer_load_dwordx4 v6, s[12:15], s21 offen  lds
  ds_read_b128 v[32:35], v12 offset:34816
  v_mfma_f32_16x16x32_bf16 a[20:23], v[48:51], v[80:83], a[20:23]
  ds_read_b64_tr_b16 v[64:65], v19 offset:49152
  v_mfma_f32_16x16x32_bf16 a[24:27], v[48:51], v[84:87], a[24:27]
  ds_read_b64_tr_b16 v[66:67], v19 offset:50176
  s_add_u32 m0, s52, 66560
  v_mfma_f32_16x16x32_bf16 a[28:31], v[48:51], v[88:91], a[28:31]
  buffer_load_dwordx4 v3, s[8:11], s20 offen  lds
  ds_read_b128 v[36:39], v12 offset:36864
  v_mfma_f32_16x16x32_bf16 a[32:35], v[52:55], v[76:79], a[32:35]
  ds_read_b64_tr_b16 v[68:69], v20 offset:49152
  v_mfma_f32_16x16x32_bf16 a[36:39], v[52:55], v[80:83], a[36:39]
  ds_read_b64_tr_b16 v[70:71], v20 offset:50176
  s_add_u32 m0, s53, 66560
  v_mfma_f32_16x16x32_bf16 a[40:43], v[52:55], v[84:87], a[40:43]
  buffer_load_dwordx4 v7, s[12:15], s21 offen  lds
  ds_read_b128 v[40:43], v12 offset:38912
  v_mfma_f32_16x16x32_bf16 a[44:47], v[52:55], v[88:91], a[44:47]
  ds_read_b64_tr_b16 v[72:73], v21 offset:49152
  v_mfma_f32_16x16x32_bf16 a[48:51], v[56:59], v[76:79], a[48:51]
  ds_read_b64_tr_b16 v[74:75], v21 offset:50176
  s_add_u32 m0, s52, 67584
  v_mfma_f32_16x16x32_bf16 a[52:55], v[56:59], v[80:83], a[52:55]
  buffer_load_dwordx4 v4, s[8:11], s20 offen  lds
  v_mfma_f32_16x16x32_bf16 a[56:59], v[56:59], v[84:87], a[56:59]
  v_mfma_f32_16x16x32_bf16 a[60:63], v[56:59], v[88:91], a[60:63]
  s_waitcnt lgkmcnt(0)
  s_add_u32 m0, s53, 67584
  v_mfma_f32_16x16x32_bf16 a[0:3], v[28:31], v[60:63], a[0:3]
  buffer_load_dwordx4 v8, s[12:15], s21 offen  lds
  ds_read_b128 v[44:47], v13 offset:32768
  v_mfma_f32_16x16x32_bf16 a[4:7], v[28:31], v[64:67], a[4:7]
  ds_read_b64_tr_b16 v[76:77], v18 offset:57344
  v_mfma_f32_16x16x32_bf16 a[8:11], v[28:31], v[68:71], a[8:11]
  ds_read_b64_tr_b16 v[78:79], v18 offset:58368
  v_mfma_f32_16x16x32_bf16 a[12:15], v[28:31], v[72:75], a[12:15]
  ds_read_b128 v[48:51], v13 offset:34816
  s_add_u32 m0, s52, 68608
  v_mfma_f32_16x16x32_bf16 a[16:19], v[32:35], v[60:63], a[16:19]
  buffer_load_dwordx4 v5, s[8:11], s20 offen  lds
  ds_read_b64_tr_b16 v[80:81], v19 offset:57344
  v_mfma_f32_16x16x32_bf16 a[20:23], v[32:35], v[64:67], a[20:23]
  ds_read_b64_tr_b16 v[82:83], v19 offset:58368
  v_mfma_f32_16x16x32_bf16 a[24:27], v[32:35], v[68:71], a[24:27]
  ds_read_b128 v[52:55], v13 offset:36864
  v_mfma_f32_16x16x32_bf16 a[28:31], v[32:35], v[72:75], a[28:31]
  ds_read_b64_tr_b16 v[84:85], v20 offset:57344
  s_add_u32 m0, s53, 68608
  v_mfma_f32_16x16x32_bf16 a[32:35], v[36:39], v[60:63], a[32:35]
  buffer_load_dwordx4 v9, s[12:15], s21 offen  lds
  ds_read_b64_tr_b16 v[86:87], v20 offset:58368
  v_mfma_f32_16x16x32_bf16 a[36:39], v[36:39], v[64:67], a[36:39]
  ds_read_b128 v[56:59], v13 offset:38912
  v_mfma_f32_16x16x32_bf16 a[40:43], v[36:39], v[68:71], a[40:43]
  ds_read_b64_tr_b16 v[88:89], v21 offset:57344
  v_mfma_f32_16x16x32_bf16 a[44:47], v[36:39], v[72:75], a[44:47]
  ds_read_b64_tr_b16 v[90:91], v21 offset:58368
  s_add_u32 s20, s20, 128
  v_mfma_f32_16x16x32_bf16 a[48:51], v[40:43], v[60:63], a[48:51]
  s_add_u32 s21, s21, s51
  v_mfma_f32_16x16x32_bf16 a[52:55], v[40:43], v[64:67], a[52:55]
  v_mfma_f32_16x16x32_bf16 a[56:59], v[40:43], v[68:71], a[56:59]
  v_mfma_f32_16x16x32_bf16 a[60:63], v[40:43], v[72:75], a[60:63]
  s_waitcnt lgkmcnt(0)
  v_mfma_f32_16x16x32_bf16 a[0:3], v[44:47], v[76:79], a[0:3]
  s_waitcnt vmcnt(16)
  s_barrier
  s_add_u32 m0, s52, 98304
  v_mfma_f32_16x16x32_bf16 a[4:7], v[44:47], v[80:83], a[4:7]
  buffer_load_dwordx4 v2, s[8:11], s20 offen  lds
  ds_read_b128 v[28:31], v10 offset:0
  v_mfma_f32_16x16x32_bf16 a[8:11], v[44:47], v[84:87], a[8:11]
  ds_read_b64_tr_b16 v[60:61], v14 offset:16384
  v_mfma_f32_16x16x32_bf16 a[12:15], v[44:47], v[88:91], a[12:15]
  ds_read_b64_tr_b16 v[62:63], v14 offset:17408
  s_add_u32 m0, s53, 98304
  v_mfma_f32_16x16x32_bf16 a[16:19], v[48:51], v[76:79], a[16:19]
  buffer_load_dwordx4 v6, s[12:15], s21 offen  lds
  ds_read_b128 v[32:35], v10 offset:2048
  v_mfma_f32_16x16x32_bf16 a[20:23], v[48:51], v[80:83], a[20:23]
  ds_read_b64_tr_b16 v[64:65], v15 offset:16384
  v_mfma_f32_16x16x32_bf16 a[24:27], v[48:51], v[84:87], a[24:27]
  ds_read_b64_tr_b16 v[66:67], v15 offset:17408
  s_add_u32 m0, s52, 99328
  v_mfma_f32_16x16x32_bf16 a[28:31], v[48:51], v[88:91], a[28:31]
  buffer_load_dwordx4 v3, s[8:11], s20 offen  lds
  ds_read_b128 v[36:39], v10 offset:4096
  v_mfma_f32_16x16x32_bf16 a[32:35], v[52:55], v[76:79], a[32:35]
  ds_read_b64_tr_b16 v[68:69], v16 offset:16384
  v_mfma_f32_16x16x32_bf16 a[36:39], v[52:55], v[80:83], a[36:39]
  ds_read_b64_tr_b16 v[70:71], v16 offset:17408
  s_add_u32 m0, s53, 99328
  v_mfma_f32_16x16x32_bf16 a[40:43], v[52:55], v[84:87], a[40:43]
  buffer_load_dwordx4 v7, s[12:15], s21 offen  lds
  ds_read_b128 v[40:43], v10 offset:6144
  v_mfma_f32_16x16x32_bf16 a[44:47], v[52:55], v[88:91], a[44:47]
  ds_read_b64_tr_b16 v[72:73], v17 offset:16384
  v_mfma_f32_16x16x32_bf16 a[48:51], v[56:59], v[76:79], a[48:51]
  ds_read_b64_tr_b16 v[74:75], v17 offset:17408
  s_add_u32 m0, s52, 100352
  v_mfma_f32_16x16x32_bf16 a[52:55], v[56:59], v[80:83], a[52:55]
  buffer_load_dwordx4 v4, s[8:11], s20 offen  lds
  v_mfma_f32_16x16x32_bf16 a[56:59], v[56:59], v[84:87], a[56:59]
  v_mfma_f32_16x16x32_bf16 a[60:63], v[56:59], v[88:91], a[60:63]
L_g5_loop:
  s_sub_u32 s25, s25, 1
  s_cmp_eq_u32 s25, 0
  s_cbranch_scc1 L_g5_fin
  s_waitcnt lgkmcnt(0)
  s_add_u32 m0, s53, 100352
  v_mfma_f32_16x16x32_bf16 a[0:3], v[28:31], v[60:63], a[0:3]
  buffer_load_dwordx4 v8, s[12:15], s21 offen  lds
  ds_read_b128 v[44:47], v11 offset:0
  v_mfma_f32_16x16x32_bf16 a[4:7], v[28:31], v[64:67], a[4:7]
  ds_read_b64_tr_b16 v[76:77], v14 offset:24576
  v_mfma_f32_16x16x32_bf16 a[8:11], v[28:31], v[68:71], a[8:11]
  ds_read_b64_tr_b16 v[78:79], v14 offset:25600
  v_mfma_f32_16x16x32_bf16 a[12:15], v[28:31], v[72:75], a[12:15]
  ds_read_b128 v[48:51], v11 offset:2048
  s_add_u32 m0, s52, 101376
  v_mfma_f32_16x16x32_bf16 a[16:19], v[32:35], v[60:63], a[16:19]
  buffer_load_dwordx4 v5, s[8:11], s20 offen  lds
  ds_read_b64_tr_b16 v[80:81], v15 offset:24576
  v_mfma_f32_16x16x32_bf16 a[20:23], v[32:35], v[64:67], a[20:23]
  ds_read_b64_tr_b16 v[82:83], v15 offset:25600
  v_mfma_f32_16x16x32_bf16 a[24:27], v[32:35], v[68:71], a[24:27]
  ds_read_b128 v[52:55], v11 offset:4096
  v_mfma_f32_16x16x32_bf16 a[28:31], v[32:35], v[72:75], a[28:31]
  ds_read_b64_tr_b16 v[84:85], v16 offset:24576
  s_add_u32 m0, s53, 101376
  v_mfma_f32_16x16x32_bf16 a[32:35], v[36:39], v[60:63], a[32:35]
  buffer_load_dwordx4 v9, s[12:15], s21 offen  lds
  ds_read_b64_tr_b16 v[86:87], v16 offset:25600
  v_mfma_f32_16x16x32_bf16 a[36:39], v[36:39], v[64:67], a[36:39]
  ds_read_b128 v[56:59], v11 offset:6144
  v_mfma_f32_16x16x32_bf16 a[40:43], v[36:39], v[68:71], a[40:43]
  ds_read_b64_tr_b16 v[88:89], v17 offset:24576
  v_mfma_f32_16x16x32_bf16 a[44:47], v[36:39], v[72:75], a[44:47]
  ds_read_b64_tr_b16 v[90:91], v17 offset:25600
  s_add_u32 s20, s20, 128
  v_mfma_f32_16x16x32_bf16 a[48:51], v[40:43], v[60:63], a[48:51]
  s_add_u32 s21, s21, s51
  v_mfma_f32_16x16x32_bf16 a[52:55], v[40:43], v[64:67], a[52:55]
  v_mfma_f32_16x16x32_bf16 a[56:59], v[40:43], v[68:71], a[56:59]
  v_mfma_f32_16x16x32_bf16 a[60:63], v[40:43], v[72:75], a[60:63]
  s_waitcnt lgkmcnt(0)
  v_mfma_f32_16x16x32_bf16 a[0:3], v[44:47], v[76:79], a[0:3]
  s_waitcnt vmcnt(16)
  s_barrier
  s_add_u32 m0, s52, 0
  v_mfma_f32_16x16x32_bf16 a[4:7], v[44:47], v[80:83], a[4:7]
  buffer_load_dwordx4 v2, s[8:11], s20 offen  lds
  ds_read_b128 v[28:31], v10 offset:32768
  v_mfma_f32_16x16x32_bf16 a[8:11], v[44:47], v[84:87], a[8:11]
  ds_read_b64_tr_b16 v[60:61], v14 offset:49152
  v_mfma_f32_16x16x32_bf16 a[12:15], v[44:47], v[88:91], a[12:15]
  ds_read_b64_tr_b16 v[62:63], v14 offset:50176
  s_add_u32 m0, s53, 0
  v_mfma_f32_16x16x32_bf16 a[16:19], v[48:51], v[76:79], a[16:19]
  buffer_load_dwordx4 v6, s[12:15], s21 offen  lds
  ds_read_b128 v[32:35], v10 offset:34816
  v_mfma_f32_16x16x32_bf16 a[20:23], v[48:51], v[80:83], a[20:23]
  ds_read_b64_tr_b16 v[64:65], v15 offset:49152
  v_mfma_f32_16x16x32_bf16 a[24:27], v[48:51], v[84:87], a[24:27]
  ds_read_b64_tr_b16 v[66:67], v15 offset:50176
  s_add_u32 m0, s52, 1024
  v_mfma_f32_16x16x32_bf16 a[28:31], v[48:51], v[88:91], a[28:31]
  buffer_load_dwordx4 v3, s[8:11], s20 offen  lds
  ds_read_b128 v[36:39], v10 offset:36864
  v_mfma_f32_16x16x32_bf16 a[32:35], v[52:55], v[76:79], a[32:35]
  ds_read_b64_tr_b16 v[68:69], v16 offset:49152
  v_mfma_f32_16x16x32_bf16 a[36:39], v[52:55], v[80:83], a[36:39]
  ds_read_b64_tr_b16 v[70:71], v16 offset:50176
  s_add_u32 m0, s53, 1024
  v_mfma_f32_16x16x32_bf16 a[40:43], v[52:55], v[84:87], a[40:43]
  buffer_load_dwordx4 v7, s[12:15], s21 offen  lds
  ds_read_b128 v[40:43], v10 offset:38912
  v_mfma_f32_16x16x32_bf16 a[44:47], v[52:55], v[88:91], a[44:47]
  ds_read_b64_tr_b16 v[72:73], v17 offset:49152
  v_mfma_f32_16x16x32_bf16 a[48:51], v[56:59], v[76:79], a[48:51]
  ds_read_b64_tr_b16 v[74:75], v17 offset:50176
  s_add_u32 m0, s52, 2048
  v_mfma_f32_16x16x32_bf16 a[52:55], v[56:59], v[80:83], a[52:55]
  buffer_load_dwordx4 v4, s[8:11], s20 offen  lds
  v_mfma_f32_16x16x32_bf16 a[56:59], v[56:59], v[84:87], a[56:59]
  v_mfma_f32_16x16x32_bf16 a[60:63], v[56:59], v[88:91], a[60:63]
  s_waitcnt lgkmcnt(0)
  s_add_u32 m0, s53, 2048
  v_mfma_f32_16x16x32_bf16 a[0:3], v[28:31], v[60:63], a[0:3]
  buffer_load_dwordx4 v8, s[12:15], s21 offen  lds
  ds_read_b128 v[44:47], v11 offset:32768
  v_mfma_f32_16x16x32_bf16 a[4:7], v[28:31], v[64:67], a[4:7]
  ds_read_b64_tr_b16 v[76:77], v14 offset:57344
  v_mfma_f32_16x16x32_bf16 a[8:11], v[28:31], v[68:71], a[8:11]
  ds_read_b64_tr_b16 v[78:79], v14 offset:58368
  v_mfma_f32_16x16x32_bf16 a[12:15], v[28:31], v[72:75], a[12:15]
  ds_read_b128 v[48:51], v11 offset:34816
  s_add_u32 m0, s52, 3072
  v_mfma_f32_16x16x32_bf16 a[16:19], v[32:35], v[60:63], a[16:19]
  buffer_load_dwordx4 v5, s[8:11], s20 offen  lds
  ds_read_b64_tr_b16 v[80:81], v15 offset:57344
  v_mfma_f32_16x16x32_bf16 a[20:23], v[32:35], v[64:67], a[20:23]
  ds_read_b64_tr_b16 v[82:83], v15 offset:58368
  v_mfma_f32_16x16x32_bf16 a[24:27], v[32:35], v[68:71], a[24:27]
  ds_read_b128 v[52:55], v11 offset:36864
  v_mfma_f32_16x16x32_bf16 a[28:31], v[32:35], v[72:75], a[28:31]
  ds_read_b64_tr_b16 v[84:85], v16 offset:57344
  s_add_u32 m0, s53, 3072
  v_mfma_f32_16x16x32_bf16 a[32:35], v[36:39], v[60:63], a[32:35]
  buffer_load_dwordx4 v9, s[12:15], s21 offen  lds
  ds_read_b64_tr_b16 v[86:87], v16 offset:58368
  v_mfma_f32_16x16x32_bf16 a[36:39], v[36:39], v[64:67], a[36:39]
  ds_read_b128 v[56:59], v11 offset:38912
  v_mfma_f32_16x16x32_bf16 a[40:43], v[36:39], v[68:71], a[40:43]
  ds_read_b64_tr_b16 v[88:89], v17 offset:57344
  v_mfma_f32_16x16x32_bf16 a[44:47], v[36:39], v[72:75], a[44:47]
  ds_read_b64_tr_b16 v[90:91], v17 offset:58368
  s_add_u32 s20, s20, 128
  v_mfma_f32_16x16x32_bf16 a[48:51], v[40:43], v[60:63], a[48:51]
  s_add_u32 s21, s21, s51
  v_mfma_f32_16x16x32_bf16 a[52:55], v[40:43], v[64:67], a[52:55]
  v_mfma_f32_16x16x32_bf16 a[56:59], v[40:43], v[68:71], a[56:59]
  v_mfma_f32_16x16x32_bf16 a[60:63], v[40:43], v[72:75], a[60:63]
  s_waitcnt lgkmcnt(0)
  v_mfma_f32_16x16x32_bf16 a[0:3], v[44:47], v[76:79], a[0:3]
  s_waitcnt vmcnt(16)
  s_barrier
  s_add_u32 m0, s52, 32768
  v_mfma_f32_16x16x32_bf16 a[4:7], v[44:47], v[80:83], a[4:7]
  buffer_load_dwordx4 v2, s[8:11], s20 offen  lds
  ds_read_b128 v[28:31], v12 offset:0
  v_mfma_f32_16x16x32_bf16 a[8:11], v[44:47], v[84:87], a[8:11]
  ds_read_b64_tr_b16 v[60:61], v18 offset:16384
  v_mfma_f32_16x16x32_bf16 a[12:15], v[44:47], v[88:91], a[12:15]
  ds_read_b64_tr_b16 v[62:63], v18 offset:17408
  s_add_u32 m0, s53, 32768
  v_mfma_f32_16x16x32_bf16 a[16:19], v[48:51], v[76:79], a[16:19]
  buffer_load_dwordx4 v6, s[12:15], s21 offen  lds
  ds_read_b128 v[32:35], v12 offset:2048
  v_mfma_f32_16x16x32_bf16 a[20:23], v[48:51], v[80:83], a[20:23]
  ds_read_b64_tr_b16 v[64:65], v19 offset:16384
  v_mfma_f32_16x16x32_bf16 a[24:27], v[48:51], v[84:87], a[24:27]
  ds_read_b64_tr_b16 v[66:67], v19 offset:17408
  s_add_u32 m0, s52, 33792
  v_mfma_f32_16x16x32_bf16 a[28:31], v[48:51], v[88:91], a[28:31]
  buffer_load_dwordx4 v3, s[8:11], s20 offen  lds
  ds_read_b128 v[36:39], v12 offset:4096
  v_mfma_f32_16x16x32_bf16 a[32:35], v[52:55], v[76:79], a[32:35]
  ds_read_b64_tr_b16 v[68:69], v20 offset:16384
  v_mfma_f32_16x16x32_bf16 a[36:39], v[52:55], v[80:83], a[36:39]
  ds_read_b64_tr_b16 v[70:71], v20 offset:17408
  s_add_u32 m0, s53, 33792
  v_mfma_f32_16x16x32_bf16 a[40:43], v[52:55], v[84:87], a[40:43]
  buffer_load_dwordx4 v7, s[12:15], s21 offen  lds
  ds_read_b128 v[40:43], v12 offset:6144
  v_mfma_f32_16x16x32_bf16 a[44:47], v[52:55], v[88:91], a[44:47]
  ds_read_b64_tr_b16 v[72:73], v21 offset:16384
  v_mfma_f32_16x16x32_bf16 a[48:51], v[56:59], v[76:79], a[48:51]
  ds_read_b64_tr_b16 v[74:75], v21 offset:17408
  s_add_u32 m0, s52, 34816
  v_mfma_f32_16x16x32_bf16 a[52:55], v[56:59], v[80:83], a[52:55]
  buffer_load_dwordx4 v4, s[8:11], s20 offen  lds
  v_mfma_f32_16x16x32_bf16 a[56:59], v[56:59], v[84:87], a[56:59]
  v_mfma_f32_16x16x32_bf16 a[60:63], v[56:59], v[88:91], a[60:63]
  s_waitcnt lgkmcnt(0)
  s_add_u32 m0, s53, 34816
  v_mfma_f32_16x16x32_bf16 a[0:3], v[28:31], v[60:63], a[0:3]
  buffer_load_dwordx4 v8, s[12:15], s21 offen  lds
  ds_read_b128 v[44:47], v13 offset:0
  v_mfma_f32_16x16x32_bf16 a[4:7], v[28:31], v[64:67], a[4:7]
  ds_read_b64_tr_b16 v[76:77], v18 offset:24576
  v_mfma_f32_16x16x32_bf16 a[8:11], v[28:31], v[68:71], a[8:11]
  ds_read_b64_tr_b16 v[78:79], v18 offset:25600
  v_mfma_f32_16x16x32_bf16 a[12:15], v[28:31], v[72:75], a[12:15]
  ds_read_b128 v[48:51], v13 offset:2048
  s_add_u32 m0, s52, 35840
  v_mfma_f32_16x16x32_bf16 a[16:19], v[32:35], v[60:63], a[16:19]
  buffer_load_dwordx4 v5, s[8:11], s20 offen  lds
  ds_read_b64_tr_b16 v[80:81], v19 offset:24576
  v_mfma_f32_16x16x32_bf16 a[20:23], v[32:35], v[64:67], a[20:23]
  ds_read_b64_tr_b16 v[82:83], v19 offset:25600
  v_mfma_f32_16x16x32_bf16 a[24:27], v[32:35], v[68:71], a[24:27]
  ds_read_b128 v[52:55], v13 offset:4096
  v_mfma_f32_16x16x32_bf16 a[28:31], v[32:35], v[72:75], a[28:31]
  ds_read_b64_tr_b16 v[84:85], v20 offset:24576
  s_add_u32 m0, s53, 35840
  v_mfma_f32_16x16x32_bf16 a[32:35], v[36:39], v[60:63], a[32:35]
  buffer_load_dwordx4 v9, s[12:15], s21 offen  lds
  ds_read_b64_tr_b16 v[86:87], v20 offset:25600
  v_mfma_f32_16x16x32_bf16 a[36:39], v[36:39], v[64:67], a[36:39]
  ds_read_b128 v[56:59], v13 offset:6144
  v_mfma_f32_16x16x32_bf16 a[40:43], v[36:39], v[68:71], a[40:43]
  ds_read_b64_tr_b16 v[88:89], v21 offset:24576
  v_mfma_f32_16x16x32_bf16 a[44:47], v[36:39], v[72:75], a[44:47]
  ds_read_b64_tr_b16 v[90:91], v21 offset:25600
  s_add_u32 s20, s20, 128
  v_mfma_f32_16x16x32_bf16 a[48:51], v[40:43], v[60:63], a[48:51]
  s_add_u32 s21, s21, s51
  v_mfma_f32_16x16x32_bf16 a[52:55], v[40:43], v[64:67], a[52:55]
  v_mfma_f32_16x16x32_bf16 a[56:59], v[40:43], v[68:71], a[56:59]
  v_mfma_f32_16x16x32_bf16 a[60:63], v[40:43], v[72:75], a[60:63]
  s_waitcnt lgkmcnt(0)
  v_mfma_f32_16x16x32_bf16 a[0:3], v[44:47], v[76:79], a[0:3]
  s_waitcnt vmcnt(16)
  s_barrier
  s_add_u32 m0, s52, 65536
  v_mfma_f32_16x16x32_bf16 a[4:7], v[44:47], v[80:83], a[4:7]
  buffer_load_dwordx4 v2, s[8:11], s20 offen  lds
  ds_read_b128 v[28:31], v12 offset:32768
  v_mfma_f32_16x16x32_bf16 a[8:11], v[44:47], v[84:87], a[8:11]
  ds_read_b64_tr_b16 v[60:61], v18 offset:49152
  v_mfma_f32_16x16x32_bf16 a[12:15], v[44:47], v[88:91], a[12:15]
  ds_read_b64_tr_b16 v[62:63], v18 offset:50176
  s_add_u32 m0, s53, 65536
  v_mfma_f32_16x16x32_bf16 a[16:19], v[48:51], v[76:79], a[16:19]
  buffer_load_dwordx4 v6, s[12:15], s21 offen  lds
  ds_read_b128 v[32:35], v12 offset:34816
  v_mfma_f32_16x16x32_bf16 a[20:23], v[48:51], v[80:83], a[20:23]
  ds_read_b64_tr_b16 v[64:65], v19 offset:49152
  v_mfma_f32_16x16x32_bf16 a[24:27], v[48:51], v[84:87], a[24:27]
  ds_read_b64_tr_b16 v[66:67], v19 offset:50176
  s_add_u32 m0, s52, 66560
  v_mfma_f32_16x16x32_bf16 a[28:31], v[48:51], v[88:91], a[28:31]
  buffer_load_dwordx4 v3, s[8:11], s20 offen  lds
  ds_read_b128 v[36:39], v12 offset:36864
  v_mfma_f32_16x16x32_bf16 a[32:35], v[52:55], v[76:79], a[32:35]
  ds_read_b64_tr_b16 v[68:69], v20 offset:49152
  v_mfma_f32_16x16x32_bf16 a[36:39], v[52:55], v[80:83], a[36:39]
  ds_read_b64_tr_b16 v[70:71], v20 offset:50176
  s_add_u32 m0, s53, 66560
  v_mfma_f32_16x16x32_bf16 a[40:43], v[52:55], v[84:87], a[40:43]
  buffer_load_dwordx4 v7, s[12:15], s21 offen  lds
  ds_read_b128 v[40:43], v12 offset:38912
  v_mfma_f32_16x16x32_bf16 a[44:47], v[52:55], v[88:91], a[44:47]
  ds_read_b64_tr_b16 v[72:73], v21 offset:49152
  v_mfma_f32_16x16x32_bf16 a[48:51], v[56:59], v[76:79], a[48:51]
  ds_read_b64_tr_b16 v[74:75], v21 offset:50176
  s_add_u32 m0, s52, 67584
  v_mfma_f32_16x16x32_bf16 a[52:55], v[56:59], v[80:83], a[52:55]
  buffer_load_dwordx4 v4, s[8:11], s20 offen  lds
  v_mfma_f32_16x16x32_bf16 a[56:59], v[56:59], v[84:87], a[56:59]
  v_mfma_f32_16x16x32_bf16 a[60:63], v[56:59], v[88:91], a[60:63]
  s_waitcnt lgkmcnt(0)
  s_add_u32 m0, s53, 67584
  v_mfma_f32_16x16x32_bf16 a[0:3], v[28:31], v[60:63], a[0:3]
  buffer_load_dwordx4 v8, s[12:15], s21 offen  lds
  ds_read_b128 v[44:47], v13 offset:32768
  v_mfma_f32_16x16x32_bf16 a[4:7], v[28:31], v[64:67], a[4:7]
  ds_read_b64_tr_b16 v[76:77], v18 offset:57344
  v_mfma_f32_16x16x32_bf16 a[8:11], v[28:31], v[68:71], a[8:11]
  ds_read_b64_tr_b16 v[78:79], v18 offset:58368
  v_mfma_f32_16x16x32_bf16 a[12:15], v[28:31], v[72:75], a[12:15]
  ds_read_b128 v[48:51], v13 offset:34816
  s_add_u32 m0, s52, 68608
  v_mfma_f32_16x16x32_bf16 a[16:19], v[32:35], v[60:63], a[16:19]
  buffer_load_dwordx4 v5, s[8:11], s20 offen  lds
  ds_read_b64_tr_b16 v[80:81], v19 offset:57344
  v_mfma_f32_16x16x32_bf16 a[20:23], v[32:35], v[64:67], a[20:23]
  ds_read_b64_tr_b16 v[82:83], v19 offset:58368
  v_mfma_f32_16x16x32_bf16 a[24:27], v[32:35], v[68:71], a[24:27]
  ds_read_b128 v[52:55], v13 offset:36864
  v_mfma_f32_16x16x32_bf16 a[28:31], v[32:35], v[72:75], a[28:31]
  ds_read_b64_tr_b16 v[84:85], v20 offset:57344
  s_add_u32 m0, s53, 68608
  v_mfma_f32_16x16x32_bf16 a[32:35], v[36:39], v[60:63], a[32:35]
  buffer_load_dwordx4 v9, s[12:15], s21 offen  lds
  ds_read_b64_tr_b16 v[86:87], v20 offset:58368
  v_mfma_f32_16x16x32_bf16 a[36:39], v[36:39], v[64:67], a[36:39]
  ds_read_b128 v[56:59], v13 offset:38912
  v_mfma_f32_16x16x32_bf16 a[40:43], v[36:39], v[68:71], a[40:43]
  ds_read_b64_tr_b16 v[88:89], v21 offset:57344
  v_mfma_f32_16x16x32_bf16 a[44:47], v[36:39], v[72:75], a[44:47]
  ds_read_b64_tr_b16 v[90:91], v21 offset:58368
  s_add_u32 s20, s20, 128
  v_mfma_f32_16x16x32_bf16 a[48:51], v[40:43], v[60:63], a[48:51]
  s_add_u32 s21, s21, s51
  v_mfma_f32_16x16x32_bf16 a[52:55], v[40:43], v[64:67], a[52:55]
  v_mfma_f32_16x16x32_bf16 a[56:59], v[40:43], v[68:71], a[56:59]
  v_mfma_f32_16x16x32_bf16 a[60:63], v[40:43], v[72:75], a[60:63]
  s_waitcnt lgkmcnt(0)
  v_mfma_f32_16x16x32_bf16 a[0:3], v[44:47], v[76:79], a[0:3]
  s_waitcnt vmcnt(16)
  s_barrier
  s_add_u32 m0, s52, 98304
  v_mfma_f32_16x16x32_bf16 a[4:7], v[44:47], v[80:83], a[4:7]
  buffer_load_dwordx4 v2, s[8:11], s20 offen  lds
  ds_read_b128 v[28:31], v10 offset:0
  v_mfma_f32_16x16x32_bf16 a[8:11], v[44:47], v[84:87], a[8:11]
  ds_read_b64_tr_b16 v[60:61], v14 offset:16384
  v_mfma_f32_16x16x32_bf16 a[12:15], v[44:47], v[88:91], a[12:15]
  ds_read_b64_tr_b16 v[62:63], v14 offset:17408
  s_add_u32 m0, s53, 98304
  v_mfma_f32_16x16x32_bf16 a[16:19], v[48:51], v[76:79], a[16:19]
  buffer_load_dwordx4 v6, s[12:15], s21 offen  lds
  ds_read_b128 v[32:35], v10 offset:2048
  v_mfma_f32_16x16x32_bf16 a[20:23], v[48:51], v[80:83], a[20:23]
  ds_read_b64_tr_b16 v[64:65], v15 offset:16384
  v_mfma_f32_16x16x32_bf16 a[24:27], v[48:51], v[84:87], a[24:27]
  ds_read_b64_tr_b16 v[66:67], v15 offset:17408
  s_add_u32 m0, s52, 99328
  v_mfma_f32_16x16x32_bf16 a[28:31], v[48:51], v[88:91], a[28:31]
  buffer_load_dwordx4 v3, s[8:11], s20 offen  lds
  ds_read_b128 v[36:39], v10 offset:4096
  v_mfma_f32_16x16x32_bf16 a[32:35], v[52:55], v[76:79], a[32:35]
  ds_read_b64_tr_b16 v[68:69], v16 offset:16384
  v_mfma_f32_16x16x32_bf16 a[36:39], v[52:55], v[80:83], a[36:39]
  ds_read_b64_tr_b16 v[70:71], v16 offset:17408
  s_add_u32 m0, s53, 99328
  v_mfma_f32_16x16x32_bf16 a[40:43], v[52:55], v[84:87], a[40:43]
  buffer_load_dwordx4 v7, s[12:15], s21 offen  lds
  ds_read_b128 v[40:43], v10 offset:6144
  v_mfma_f32_16x16x32_bf16 a[44:47], v[52:55], v[88:91], a[44:47]
  ds_read_b64_tr_b16 v[72:73], v17 offset:16384
  v_mfma_f32_16x16x32_bf16 a[48:51], v[56:59], v[76:79], a[48:51]
  ds_read_b64_tr_b16 v[74:75], v17 offset:17408
  s_add_u32 m0, s52, 100352
  v_mfma_f32_16x16x32_bf16 a[52:55], v[56:59], v[80:83], a[52:55]
  buffer_load_dwordx4 v4, s[8:11], s20 offen  lds
  v_mfma_f32_16x16x32_bf16 a[56:59], v[56:59], v[84:87], a[56:59]
  v_mfma_f32_16x16x32_bf16 a[60:63], v[56:59], v[88:91], a[60:63]
  s_branch L_g5_loop
L_g5_fin:
  s_cmp_lg_u32 s32, 0
  s_cbranch_scc1 L_rq_9
  s_cmp_eq_u32 s39, 0
  s_cbranch_scc1 L_rq_9
  s_lshl_b32 s99, s33, 7
  s_add_u32 s99, s99, 0x3d00200
  v_mov_b32 v244, 1
  v_mov_b32 v245, 0
  s_mov_b64 exec, 1
  buffer_atomic_add v244, v245, s[4:7], s99 offen sc0 sc1
  s_mov_b64 exec, -1
L_rq_9:
  s_waitcnt lgkmcnt(0)
  s_add_u32 m0, s53, 100352
  v_mfma_f32_16x16x32_bf16 a[0:3], v[28:31], v[60:63], a[0:3]
  buffer_load_dwordx4 v8, s[12:15], s21 offen  lds
  ds_read_b128 v[44:47], v11 offset:0
  v_mfma_f32_16x16x32_bf16 a[4:7], v[28:31], v[64:67], a[4:7]
  ds_read_b64_tr_b16 v[76:77], v14 offset:24576
  v_mfma_f32_16x16x32_bf16 a[8:11], v[28:31], v[68:71], a[8:11]
  ds_read_b64_tr_b16 v[78:79], v14 offset:25600
  v_mfma_f32_16x16x32_bf16 a[12:15], v[28:31], v[72:75], a[12:15]
  ds_read_b128 v[48:51], v11 offset:2048
  s_add_u32 m0, s52, 101376
  v_mfma_f32_16x16x32_bf16 a[16:19], v[32:35], v[60:63], a[16:19]
  buffer_load_dwordx4 v5, s[8:11], s20 offen  lds
  ds_read_b64_tr_b16 v[80:81], v15 offset:24576
  v_mfma_f32_16x16x32_bf16 a[20:23], v[32:35], v[64:67], a[20:23]
  ds_read_b64_tr_b16 v[82:83], v15 offset:25600
  v_mfma_f32_16x16x32_bf16 a[24:27], v[32:35], v[68:71], a[24:27]
  ds_read_b128 v[52:55], v11 offset:4096
  v_mfma_f32_16x16x32_bf16 a[28:31], v[32:35], v[72:75], a[28:31]
  ds_read_b64_tr_b16 v[84:85], v16 offset:24576
  s_add_u32 m0, s53, 101376
  v_mfma_f32_16x16x32_bf16 a[32:35], v[36:39], v[60:63], a[32:35]
  buffer_load_dwordx4 v9, s[12:15], s21 offen  lds
  ds_read_b64_tr_b16 v[86:87], v16 offset:25600
  v_mfma_f32_16x16x32_bf16 a[36:39], v[36:39], v[64:67], a[36:39]
  ds_read_b128 v[56:59], v11 offset:6144
  v_mfma_f32_16x16x32_bf16 a[40:43], v[36:39], v[68:71], a[40:43]
  ds_read_b64_tr_b16 v[88:89], v17 offset:24576
  v_mfma_f32_16x16x32_bf16 a[44:47], v[36:39], v[72:75], a[44:47]
  ds_read_b64_tr_b16 v[90:91], v17 offset:25600
  s_add_u32 s20, s20, 128
  v_mfma_f32_16x16x32_bf16 a[48:51], v[40:43], v[60:63], a[48:51]
  s_add_u32 s21, s21, s51
  v_mfma_f32_16x16x32_bf16 a[52:55], v[40:43], v[64:67], a[52:55]
  v_mfma_f32_16x16x32_bf16 a[56:59], v[40:43], v[68:71], a[56:59]
  v_mfma_f32_16x16x32_bf16 a[60:63], v[40:43], v[72:75], a[60:63]
  s_waitcnt lgkmcnt(0)
  v_mfma_f32_16x16x32_bf16 a[0:3], v[44:47], v[76:79], a[0:3]
  s_waitcnt vmcnt(16)
  s_barrier
  v_mfma_f32_16x16x32_bf16 a[4:7], v[44:47], v[80:83], a[4:7]
  ds_read_b128 v[28:31], v10 offset:32768
  v_mfma_f32_16x16x32_bf16 a[8:11], v[44:47], v[84:87], a[8:11]
  ds_read_b64_tr_b16 v[60:61], v14 offset:49152
  v_mfma_f32_16x16x32_bf16 a[12:15], v[44:47], v[88:91], a[12:15]
  ds_read_b64_tr_b16 v[62:63], v14 offset:50176
  v_mfma_f32_16x16x32_bf16 a[16:19], v[48:51], v[76:79], a[16:19]
  ds_read_b128 v[32:35], v10 offset:34816
  v_mfma_f32_16x16x32_bf16 a[20:23], v[48:51], v[80:83], a[20:23]
  ds_read_b64_tr_b16 v[64:65], v15 offset:49152
  v_mfma_f32_16x16x32_bf16 a[24:27], v[48:51], v[84:87], a[24:27]
  ds_read_b64_tr_b16 v[66:67], v15 offset:50176
  v_mfma_f32_16x16x32_bf16 a[28:31], v[48:51], v[88:91], a[28:31]
  ds_read_b128 v[36:39], v10 offset:36864
  v_mfma_f32_16x16x32_bf16 a[32:35], v[52:55], v[76:79], a[32:35]
  ds_read_b64_tr_b16 v[68:69], v16 offset:49152
  v_mfma_f32_16x16x32_bf16 a[36:39], v[52:55], v[80:83], a[36:39]
  ds_read_b64_tr_b16 v[70:71], v16 offset:50176
  v_mfma_f32_16x16x32_bf16 a[40:43], v[52:55], v[84:87], a[40:43]
  ds_read_b128 v[40:43], v10 offset:38912
  v_mfma_f32_16x16x32_bf16 a[44:47], v[52:55], v[88:91], a[44:47]
  ds_read_b64_tr_b16 v[72:73], v17 offset:49152
  v_mfma_f32_16x16x32_bf16 a[48:51], v[56:59], v[76:79], a[48:51]
  ds_read_b64_tr_b16 v[74:75], v17 offset:50176
  v_mfma_f32_16x16x32_bf16 a[52:55], v[56:59], v[80:83], a[52:55]
  v_mfma_f32_16x16x32_bf16 a[56:59], v[56:59], v[84:87], a[56:59]
  v_mfma_f32_16x16x32_bf16 a[60:63], v[56:59], v[88:91], a[60:63]
  s_waitcnt lgkmcnt(0)
  v_mfma_f32_16x16x32_bf16 a[0:3], v[28:31], v[60:63], a[0:3]
  ds_read_b128 v[44:47], v11 offset:32768
  v_mfma_f32_16x16x32_bf16 a[4:7], v[28:31], v[64:67], a[4:7]
  ds_read_b64_tr_b16 v[76:77], v14 offset:57344
  v_mfma_f32_16x16x32_bf16 a[8:11], v[28:31], v[68:71], a[8:11]
  ds_read_b64_tr_b16 v[78:79], v14 offset:58368
  v_mfma_f32_16x16x32_bf16 a[12:15], v[28:31], v[72:75], a[12:15]
  ds_read_b128 v[48:51], v11 offset:34816
  v_mfma_f32_16x16x32_bf16 a[16:19], v[32:35], v[60:63], a[16:19]
  ds_read_b64_tr_b16 v[80:81], v15 offset:57344
  v_mfma_f32_16x16x32_bf16 a[20:23], v[32:35], v[64:67], a[20:23]
  ds_read_b64_tr_b16 v[82:83], v15 offset:58368
  v_mfma_f32_16x16x32_bf16 a[24:27], v[32:35], v[68:71], a[24:27]
  ds_read_b128 v[52:55], v11 offset:36864
  v_mfma_f32_16x16x32_bf16 a[28:31], v[32:35], v[72:75], a[28:31]
  ds_read_b64_tr_b16 v[84:85], v16 offset:57344
  v_mfma_f32_16x16x32_bf16 a[32:35], v[36:39], v[60:63], a[32:35]
  ds_read_b64_tr_b16 v[86:87], v16 offset:58368
  v_mfma_f32_16x16x32_bf16 a[36:39], v[36:39], v[64:67], a[36:39]
  ds_read_b128 v[56:59], v11 offset:38912
  v_mfma_f32_16x16x32_bf16 a[40:43], v[36:39], v[68:71], a[40:43]
  ds_read_b64_tr_b16 v[88:89], v17 offset:57344
  v_mfma_f32_16x16x32_bf16 a[44:47], v[36:39], v[72:75], a[44:47]
  ds_read_b64_tr_b16 v[90:91], v17 offset:58368
  v_mfma_f32_16x16x32_bf16 a[48:51], v[40:43], v[60:63], a[48:51]
  v_mfma_f32_16x16x32_bf16 a[52:55], v[40:43], v[64:67], a[52:55]
  v_mfma_f32_16x16x32_bf16 a[56:59], v[40:43], v[68:71], a[56:59]
  v_mfma_f32_16x16x32_bf16 a[60:63], v[40:43], v[72:75], a[60:63]
  s_waitcnt lgkmcnt(0)
  v_mfma_f32_16x16x32_bf16 a[0:3], v[44:47], v[76:79], a[0:3]
  s_waitcnt vmcnt(8)
  s_barrier
  v_mfma_f32_16x16x32_bf16 a[4:7], v[44:47], v[80:83], a[4:7]
  ds_read_b128 v[28:31], v12 offset:0
  v_mfma_f32_16x16x32_bf16 a[8:11], v[44:47], v[84:87], a[8:11]
  ds_read_b64_tr_b16 v[60:61], v18 offset:16384
  v_mfma_f32_16x16x32_bf16 a[12:15], v[44:47], v[88:91], a[12:15]
  ds_read_b64_tr_b16 v[62:63], v18 offset:17408
  v_mfma_f32_16x16x32_bf16 a[16:19], v[48:51], v[76:79], a[16:19]
  ds_read_b128 v[32:35], v12 offset:2048
  v_mfma_f32_16x16x32_bf16 a[20:23], v[48:51], v[80:83], a[20:23]
  ds_read_b64_tr_b16 v[64:65], v19 offset:16384
  v_mfma_f32_16x16x32_bf16 a[24:27], v[48:51], v[84:87], a[24:27]
  ds_read_b64_tr_b16 v[66:67], v19 offset:17408
  v_mfma_f32_16x16x32_bf16 a[28:31], v[48:51], v[88:91], a[28:31]
  ds_read_b128 v[36:39], v12 offset:4096
  v_mfma_f32_16x16x32_bf16 a[32:35], v[52:55], v[76:79], a[32:35]
  ds_read_b64_tr_b16 v[68:69], v20 offset:16384
  v_mfma_f32_16x16x32_bf16 a[36:39], v[52:55], v[80:83], a[36:39]
  ds_read_b64_tr_b16 v[70:71], v20 offset:17408
  v_mfma_f32_16x16x32_bf16 a[40:43], v[52:55], v[84:87], a[40:43]
  ds_read_b128 v[40:43], v12 offset:6144
  v_mfma_f32_16x16x32_bf16 a[44:47], v[52:55], v[88:91], a[44:47]
  ds_read_b64_tr_b16 v[72:73], v21 offset:16384
  v_mfma_f32_16x16x32_bf16 a[48:51], v[56:59], v[76:79], a[48:51]
  ds_read_b64_tr_b16 v[74:75], v21 offset:17408
  v_mfma_f32_16x16x32_bf16 a[52:55], v[56:59], v[80:83], a[52:55]
  v_mfma_f32_16x16x32_bf16 a[56:59], v[56:59], v[84:87], a[56:59]
  v_mfma_f32_16x16x32_bf16 a[60:63], v[56:59], v[88:91], a[60:63]
  s_waitcnt lgkmcnt(0)
  v_mfma_f32_16x16x32_bf16 a[0:3], v[28:31], v[60:63], a[0:3]
  ds_read_b128 v[44:47], v13 offset:0
  v_mfma_f32_16x16x32_bf16 a[4:7], v[28:31], v[64:67], a[4:7]
  ds_read_b64_tr_b16 v[76:77], v18 offset:24576
  v_mfma_f32_16x16x32_bf16 a[8:11], v[28:31], v[68:71], a[8:11]
  ds_read_b64_tr_b16 v[78:79], v18 offset:25600
  v_mfma_f32_16x16x32_bf16 a[12:15], v[28:31], v[72:75], a[12:15]
  ds_read_b128 v[48:51], v13 offset:2048
  v_mfma_f32_16x16x32_bf16 a[16:19], v[32:35], v[60:63], a[16:19]
  ds_read_b64_tr_b16 v[80:81], v19 offset:24576
  v_mfma_f32_16x16x32_bf16 a[20:23], v[32:35], v[64:67], a[20:23]
  ds_read_b64_tr_b16 v[82:83], v19 offset:25600
  v_mfma_f32_16x16x32_bf16 a[24:27], v[32:35], v[68:71], a[24:27]
  ds_read_b128 v[52:55], v13 offset:4096
  v_mfma_f32_16x16x32_bf16 a[28:31], v[32:35], v[72:75], a[28:31]
  ds_read_b64_tr_b16 v[84:85], v20 offset:24576
  v_mfma_f32_16x16x32_bf16 a[32:35], v[36:39], v[60:63], a[32:35]
  ds_read_b64_tr_b16 v[86:87], v20 offset:25600
  v_mfma_f32_16x16x32_bf16 a[36:39], v[36:39], v[64:67], a[36:39]
  ds_read_b128 v[56:59], v13 offset:6144
  v_mfma_f32_16x16x32_bf16 a[40:43], v[36:39], v[68:71], a[40:43]
  ds_read_b64_tr_b16 v[88:89], v21 offset:24576
  v_mfma_f32_16x16x32_bf16 a[44:47], v[36:39], v[72:75], a[44:47]
  ds_read_b64_tr_b16 v[90:91], v21 offset:25600
  v_mfma_f32_16x16x32_bf16 a[48:51], v[40:43], v[60:63], a[48:51]
  v_mfma_f32_16x16x32_bf16 a[52:55], v[40:43], v[64:67], a[52:55]
  v_mfma_f32_16x16x32_bf16 a[56:59], v[40:43], v[68:71], a[56:59]
  v_mfma_f32_16x16x32_bf16 a[60:63], v[40:43], v[72:75], a[60:63]
  s_waitcnt lgkmcnt(0)
  v_mfma_f32_16x16x32_bf16 a[0:3], v[44:47], v[76:79], a[0:3]
  s_waitcnt vmcnt(0)
  s_barrier
  v_mfma_f32_16x16x32_bf16 a[4:7], v[44:47], v[80:83], a[4:7]
  ds_read_b128 v[28:31], v12 offset:32768
  v_mfma_f32_16x16x32_bf16 a[8:11], v[44:47], v[84:87], a[8:11]
  ds_read_b64_tr_b16 v[60:61], v18 offset:49152
  v_mfma_f32_16x16x32_bf16 a[12:15], v[44:47], v[88:91], a[12:15]
  ds_read_b64_tr_b16 v[62:63], v18 offset:50176
  v_mfma_f32_16x16x32_bf16 a[16:19], v[48:51], v[76:79], a[16:19]
  ds_read_b128 v[32:35], v12 offset:34816
  v_mfma_f32_16x16x32_bf16 a[20:23], v[48:51], v[80:83], a[20:23]
  ds_read_b64_tr_b16 v[64:65], v19 offset:49152
  v_mfma_f32_16x16x32_bf16 a[24:27], v[48:51], v[84:87], a[24:27]
  ds_read_b64_tr_b16 v[66:67], v19 offset:50176
  v_mfma_f32_16x16x32_bf16 a[28:31], v[48:51], v[88:91], a[28:31]
  ds_read_b128 v[36:39], v12 offset:36864
  v_mfma_f32_16x16x32_bf16 a[32:35], v[52:55], v[76:79], a[32:35]
  ds_read_b64_tr_b16 v[68:69], v20 offset:49152
  v_mfma_f32_16x16x32_bf16 a[36:39], v[52:55], v[80:83], a[36:39]
  ds_read_b64_tr_b16 v[70:71], v20 offset:50176
  v_mfma_f32_16x16x32_bf16 a[40:43], v[52:55], v[84:87], a[40:43]
  ds_read_b128 v[40:43], v12 offset:38912
  v_mfma_f32_16x16x32_bf16 a[44:47], v[52:55], v[88:91], a[44:47]
  ds_read_b64_tr_b16 v[72:73], v21 offset:49152
  v_mfma_f32_16x16x32_bf16 a[48:51], v[56:59], v[76:79], a[48:51]
  ds_read_b64_tr_b16 v[74:75], v21 offset:50176
  v_mfma_f32_16x16x32_bf16 a[52:55], v[56:59], v[80:83], a[52:55]
  v_mfma_f32_16x16x32_bf16 a[56:59], v[56:59], v[84:87], a[56:59]
  v_mfma_f32_16x16x32_bf16 a[60:63], v[56:59], v[88:91], a[60:63]
  s_waitcnt lgkmcnt(0)
  v_mfma_f32_16x16x32_bf16 a[0:3], v[28:31], v[60:63], a[0:3]
  ds_read_b128 v[44:47], v13 offset:32768
  v_mfma_f32_16x16x32_bf16 a[4:7], v[28:31], v[64:67], a[4:7]
  ds_read_b64_tr_b16 v[76:77], v18 offset:57344
  v_mfma_f32_16x16x32_bf16 a[8:11], v[28:31], v[68:71], a[8:11]
  ds_read_b64_tr_b16 v[78:79], v18 offset:58368
  v_mfma_f32_16x16x32_bf16 a[12:15], v[28:31], v[72:75], a[12:15]
  ds_read_b128 v[48:51], v13 offset:34816
  v_mfma_f32_16x16x32_bf16 a[16:19], v[32:35], v[60:63], a[16:19]
  ds_read_b64_tr_b16 v[80:81], v19 offset:57344
  v_mfma_f32_16x16x32_bf16 a[20:23], v[32:35], v[64:67], a[20:23]
  ds_read_b64_tr_b16 v[82:83], v19 offset:58368
  v_mfma_f32_16x16x32_bf16 a[24:27], v[32:35], v[68:71], a[24:27]
  ds_read_b128 v[52:55], v13 offset:36864
  v_mfma_f32_16x16x32_bf16 a[28:31], v[32:35], v[72:75], a[28:31]
  ds_read_b64_tr_b16 v[84:85], v20 offset:57344
  v_mfma_f32_16x16x32_bf16 a[32:35], v[36:39], v[60:63], a[32:35]
  ds_read_b64_tr_b16 v[86:87], v20 offset:58368
  v_mfma_f32_16x16x32_bf16 a[36:39], v[36:39], v[64:67], a[36:39]
  ds_read_b128 v[56:59], v13 offset:38912
  v_mfma_f32_16x16x32_bf16 a[40:43], v[36:39], v[68:71], a[40:43]
  ds_read_b64_tr_b16 v[88:89], v21 offset:57344
  v_mfma_f32_16x16x32_bf16 a[44:47], v[36:39], v[72:75], a[44:47]
  ds_read_b64_tr_b16 v[90:91], v21 offset:58368
  v_mfma_f32_16x16x32_bf16 a[48:51], v[40:43], v[60:63], a[48:51]
  v_mfma_f32_16x16x32_bf16 a[52:55], v[40:43], v[64:67], a[52:55]
  v_mfma_f32_16x16x32_bf16 a[56:59], v[40:43], v[68:71], a[56:59]
  v_mfma_f32_16x16x32_bf16 a[60:63], v[40:43], v[72:75], a[60:63]
  s_waitcnt lgkmcnt(0)
  v_mfma_f32_16x16x32_bf16 a[0:3], v[44:47], v[76:79], a[0:3]
  v_mfma_f32_16x16x32_bf16 a[4:7], v[44:47], v[80:83], a[4:7]
  v_mfma_f32_16x16x32_bf16 a[8:11], v[44:47], v[84:87], a[8:11]
  v_mfma_f32_16x16x32_bf16 a[12:15], v[44:47], v[88:91], a[12:15]
  v_mfma_f32_16x16x32_bf16 a[16:19], v[48:51], v[76:79], a[16:19]
  v_mfma_f32_16x16x32_bf16 a[20:23], v[48:51], v[80:83], a[20:23]
  v_mfma_f32_16x16x32_bf16 a[24:27], v[48:51], v[84:87], a[24:27]
  v_mfma_f32_16x16x32_bf16 a[28:31], v[48:51], v[88:91], a[28:31]
  v_mfma_f32_16x16x32_bf16 a[32:35], v[52:55], v[76:79], a[32:35]
  v_mfma_f32_16x16x32_bf16 a[36:39], v[52:55], v[80:83], a[36:39]
  v_mfma_f32_16x16x32_bf16 a[40:43], v[52:55], v[84:87], a[40:43]
  v_mfma_f32_16x16x32_bf16 a[44:47], v[52:55], v[88:91], a[44:47]
  v_mfma_f32_16x16x32_bf16 a[48:51], v[56:59], v[76:79], a[48:51]
  v_mfma_f32_16x16x32_bf16 a[52:55], v[56:59], v[80:83], a[52:55]
  v_mfma_f32_16x16x32_bf16 a[56:59], v[56:59], v[84:87], a[56:59]
  v_mfma_f32_16x16x32_bf16 a[60:63], v[56:59], v[88:91], a[60:63]
  s_mov_b32 s59, 4
  s_mov_b32 s60, s22
  s_mov_b32 s61, s26
  s_add_u32 s62, s38, 0x3d00000
  s_mov_b32 s63, s98
  s_cmp_lg_u32 s39, 0
  s_cbranch_scc1 L_got
  s_mov_b32 s58, 3
  s_branch L_epi
L_swp:
  s_barrier
  v_and_b32 v1, 63, v0
  v_lshlrev_b32 v2, 7, v1
  s_lshl_b32 s40, s36, 2
  s_add_u32 s40, s40, s33
  s_lshl_b32 s40, s40, 2
  s_add_u32 s40, s40, s32
  s_lshl_b32 s40, s40, 13
  s_mov_b32 s44, s78
  s_and_b32 s45, s79, 0xffff
  s_mov_b32 s46, 0x400000
  s_mov_b32 s47, 0x20000
  s_mov_b32 s41, s40
  buffer_load_dword v4, v2, s[44:47], s41 offen
  s_add_u32 s41, s41, 524288
  buffer_load_dword v5, v2, s[44:47], s41 offen
  s_add_u32 s41, s41, 524288
  buffer_load_dword v6, v2, s[44:47], s41 offen
  s_add_u32 s41, s41, 524288
  buffer_load_dword v7, v2, s[44:47], s41 offen
  s_add_u32 s41, s41, 524288
  buffer_load_dword v8, v2, s[44:47], s41 offen
  s_add_u32 s41, s41, 524288
  buffer_load_dword v9, v2, s[44:47], s41 offen
  s_add_u32 s41, s41, 524288
  buffer_load_dword v10, v2, s[44:47], s41 offen
  s_add_u32 s41, s41, 524288
  buffer_load_dword v11, v2, s[44:47], s41 offen
  s_add_u32 s41, s41, 524288
  s_mov_b32 s44, s80
  s_and_b32 s45, s81, 0xffff
  s_mov_b32 s46, 0x600000
  s_mov_b32 s47, 0x20000
  s_mov_b32 s41, s40
  buffer_load_dword v4, v2, s[44:47], s41 offen
  s_add_u32 s41, s41, 524288
  buffer_load_dword v5, v2, s[44:47], s41 offen
  s_add_u32 s41, s41, 524288
  buffer_load_dword v6, v2, s[44:47], s41 offen
  s_add_u32 s41, s41, 524288
  buffer_load_dword v7, v2, s[44:47], s41 offen
  s_add_u32 s41, s41, 524288
  buffer_load_dword v8, v2, s[44:47], s41 offen
  s_add_u32 s41, s41, 524288
  buffer_load_dword v9, v2, s[44:47], s41 offen
  s_add_u32 s41, s41, 524288
  buffer_load_dword v10, v2, s[44:47], s41 offen
  s_add_u32 s41, s41, 524288
  buffer_load_dword v11, v2, s[44:47], s41 offen
  s_add_u32 s41, s41, 524288
  buffer_load_dword v12, v2, s[44:47], s41 offen
  s_add_u32 s41, s41, 524288
  buffer_load_dword v13, v2, s[44:47], s41 offen
  s_add_u32 s41, s41, 524288
  buffer_load_dword v14, v2, s[44:47], s41 offen
  s_add_u32 s41, s41, 524288
  buffer_load_dword v15, v2, s[44:47], s41 offen
  s_add_u32 s41, s41, 524288
  s_mov_b32 s44, s82
  s_and_b32 s45, s83, 0xffff
  s_mov_b32 s46, 0x200000
  s_mov_b32 s47, 0x20000
  s_mov_b32 s41, s40
  buffer_load_dword v4, v2, s[44:47], s41 offen
  s_add_u32 s41, s41, 524288
  buffer_load_dword v5, v2, s[44:47], s41 offen
  s_add_u32 s41, s41, 524288
  buffer_load_dword v6, v2, s[44:47], s41 offen
  s_add_u32 s41, s41, 524288
  buffer_load_dword v7, v2, s[44:47], s41 offen
  s_add_u32 s41, s41, 524288
  s_branch L_next
L_atb:
  s_lshl_b32 s90, s33, 7
  s_lshl_b32 s40, s36, 9
  s_add_u32 s40, s40, s90
  s_max_u32 s41, s36, 1
  s_sub_u32 s41, s41, 1
  s_lshl_b32 s41, s41, 9
  s_add_u32 s41, s41, s90
  s_cmp_lg_u32 s32, 0
  s_cbranch_scc1 L_dd_11
  v_mov_b32 v228, 0x3d00000
  v_mov_b32 v231, 0x3d03000
L_dw_10:
  buffer_load_dword v234, v231, s[4:7], s40 offen offset:0 sc1
  buffer_load_dword v235, v231, s[4:7], s41 offen offset:0 sc1
  s_waitcnt vmcnt(0)
  s_mov_b32 s44, 1
  v_readfirstlane_b32 s45, v234
  s_cmp_ge_u32 s45, 3
  s_cselect_b32 s44, s44, 0
  v_readfirstlane_b32 s45, v235
  s_cmp_ge_u32 s45, 3
  s_cselect_b32 s44, s44, 0
  s_cmp_eq_u32 s44, 1
  s_cbranch_scc1 L_dd_11
  s_sleep 6
  s_add_u32 s3, s3, 1
  s_cmp_lt_u32 s3, 131072
  s_cbranch_scc1 L_dw_10
L_dd_11:
  s_barrier
  s_lshl_b32 s38, s36, 7
  s_add_u32 s38, s38, 1024
  s_lshl_b32 s46, s36, 3
  s_lshl_b32 s90, s37, 1
  s_add_u32 s99, s46, s90
  s_lshr_b32 s90, s32, 1
  s_add_u32 s99, s99, s90
  s_lshl_b32 s99, s99, 3
  s_lshl_b32 s90, s33, 1
  s_add_u32 s99, s99, s90
  s_and_b32 s90, s32, 1
  s_add_u32 s20, s99, s90
  v_and_b32 v1, 63, v0
  s_lshl_b32 s90, s20, 13
  s_sub_u32 s91, s90, 65536
  s_cmp_lt_u32 s20, 8
  s_cselect_b32 s91, s90, s91
  v_mov_b32 v2, 0x0
  v_bfe_u32 v7, v1, 0, 6
  v_lshl_add_u32 v2, v7, 4, v2
  v_add_u32 v3, 4096, v2
  s_add_u32 s92, s90, 67108864
  s_add_u32 s93, s90, 71303168
  s_add_u32 s94, s91, 71303168
  s_add_u32 s95, s90, 75497472
  s_add_u32 s96, s91, 75497472
  s_add_u32 s97, s90, 100663296
  buffer_load_dwordx4 v[8:11], v2, s[4:7], s92 offen offset:0 sc1
  buffer_load_dwordx4 v[12:15], v2, s[4:7], s92 offen offset:1024 sc1
  buffer_load_dwordx4 v[16:19], v2, s[4:7], s92 offen offset:2048 sc1
  buffer_load_dwordx4 v[20:23], v2, s[4:7], s92 offen offset:3072 sc1
  buffer_load_dwordx4 v[24:27], v3, s[4:7], s92 offen offset:0 sc1
  buffer_load_dwordx4 v[28:31], v3, s[4:7], s92 offen offset:1024 sc1
  buffer_load_dwordx4 v[32:35], v3, s[4:7], s92 offen offset:2048 sc1
  buffer_load_dwordx4 v[36:39], v3, s[4:7], s92 offen offset:3072 sc1
  buffer_load_dwordx4 v[40:43], v3, s[4:7], s94 offen offset:0 sc1
  buffer_load_dwordx4 v[44:47], v3, s[4:7], s94 offen offset:1024 sc1
  buffer_load_dwordx4 v[48:51], v3, s[4:7], s94 offen offset:2048 sc1
  buffer_load_dwordx4 v[52:55], v3, s[4:7], s94 offen offset:3072 sc1
  buffer_load_dwordx4 v[56:59], v2, s[4:7], s93 offen offset:0 sc1
  buffer_load_dwordx4 v[60:63], v2, s[4:7], s93 offen offset:1024 sc1
  buffer_load_dwordx4 v[64:67], v2, s[4:7], s93 offen offset:2048 sc1
  buffer_load_dwordx4 v[68:71], v2, s[4:7], s93 offen offset:3072 sc1
  buffer_load_dwordx4 v[72:75], v3, s[4:7], s93 offen offset:0 sc1
  buffer_load_dwordx4 v[76:79], v3, s[4:7], s93 offen offset:1024 sc1
  buffer_load_dwordx4 v[80:83], v3, s[4:7], s93 offen offset:2048 sc1
  buffer_load_dwordx4 v[84:87], v3, s[4:7], s93 offen offset:3072 sc1
  buffer_load_dwordx2 v[88:89], v2, s[4:7], s96 offen offset:8 sc1
  buffer_load_dwordx2 v[94:95], v2, s[4:7], s96 offen offset:1032 sc1
  buffer_load_dwordx2 v[100:101], v2, s[4:7], s96 offen offset:2056 sc1
  buffer_load_dwordx2 v[106:107], v2, s[4:7], s96 offen offset:3080 sc1
  buffer_load_dwordx2 v[112:113], v3, s[4:7], s96 offen offset:8 sc1
  buffer_load_dwordx2 v[118:119], v3, s[4:7], s96 offen offset:1032 sc1
  buffer_load_dwordx2 v[124:125], v3, s[4:7], s96 offen offset:2056 sc1
  buffer_load_dwordx2 v[130:131], v3, s[4:7], s96 offen offset:3080 sc1
  buffer_load_dwordx4 v[90:93], v2, s[4:7], s95 offen offset:0 sc1
  buffer_load_dwordx4 v[96:99], v2, s[4:7], s95 offen offset:1024 sc1
  buffer_load_dwordx4 v[102:105], v2, s[4:7], s95 offen offset:2048 sc1
  buffer_load_dwordx4 v[108:111], v2, s[4:7], s95 offen offset:3072 sc1
  buffer_load_dwordx4 v[114:117], v3, s[4:7], s95 offen offset:0 sc1
  buffer_load_dwordx4 v[120:123], v3, s[4:7], s95 offen offset:1024 sc1
  buffer_load_dwordx4 v[126:129], v3, s[4:7], s95 offen offset:2048 sc1
  buffer_load_dwordx4 v[132:135], v3, s[4:7], s95 offen offset:3072 sc1
  s_mov_b32 s40, 0x50000
  s_mov_b32 s41, 0x5550055
  s_mov_b32 s42, 0xa0000
  s_mov_b32 s43, 0xaaa00aa
  s_mov_b32 s44, 0x150001
  s_mov_b32 s45, 0x15550155
  s_mov_b32 s46, 0x2a0002
  s_mov_b32 s47, 0x2aaa02aa
  s_mov_b32 s48, 0x55505555
  s_mov_b32 s49, 0x50005500
  s_mov_b32 s50, 0xaaa0aaaa
  s_mov_b32 s51, 0xa000aa00
  s_mov_b32 s52, 0x55405554
  s_mov_b32 s53, 0x40005400
  s_mov_b32 s54, 0xaa80aaa8
  s_mov_b32 s55, 0x8000a800
  s_cmp_lt_u32 s20, 8
  s_cselect_b64 s[56:57], 0, s[40:41]
  s_cselect_b64 s[58:59], 0, s[42:43]
  s_cselect_b64 s[60:61], 0, s[44:45]
  s_cselect_b64 s[62:63], 0, s[46:47]
  s_mov_b32 s21, 0x3e8293ee
  v_mov_b32 v6, 0xcfa8965f
  s_waitcnt vmcnt(16)
  v_mfma_f32_16x16x32_bf16 v[136:139], v[40:43], v[8:11], 0
  v_mfma_f32_16x16x32_bf16 v[140:143], v[56:59], v[8:11], 0
  v_mfma_f32_16x16x32_bf16 v[144:147], v[44:47], v[12:15], 0
  v_mfma_f32_16x16x32_bf16 v[148:151], v[60:63], v[12:15], 0
  v_mfma_f32_16x16x32_bf16 v[152:155], v[48:51], v[16:19], 0
  v_mfma_f32_16x16x32_bf16 v[156:159], v[64:67], v[16:19], 0
  v_mfma_f32_16x16x32_bf16 v[160:163], v[52:55], v[20:23], 0
  v_mfma_f32_16x16x32_bf16 v[164:167], v[68:71], v[20:23], 0
  v_mfma_f32_16x16x32_bf16 v[168:171], v[56:59], v[24:27], 0
  v_mfma_f32_16x16x32_bf16 v[172:175], v[72:75], v[24:27], 0
  v_mfma_f32_16x16x32_bf16 v[176:179], v[60:63], v[28:31], 0
  v_mfma_f32_16x16x32_bf16 v[180:183], v[76:79], v[28:31], 0
  v_mfma_f32_16x16x32_bf16 v[184:187], v[64:67], v[32:35], 0
  v_mfma_f32_16x16x32_bf16 v[188:191], v[80:83], v[32:35], 0
  v_mfma_f32_16x16x32_bf16 v[192:195], v[68:71], v[36:39], 0
  v_mfma_f32_16x16x32_bf16 v[196:199], v[84:87], v[36:39], 0
  v_cndmask_b32 v136, v6, v136, s[56:57]
  v_cndmask_b32 v137, v6, v137, s[58:59]
  v_cndmask_b32 v138, v6, v138, s[60:61]
  v_cndmask_b32 v139, v6, v139, s[62:63]
  v_cndmask_b32 v140, v6, v140, s[48:49]
  v_cndmask_b32 v141, v6, v141, s[50:51]
  v_cndmask_b32 v142, v6, v142, s[52:53]
  v_cndmask_b32 v143, v6, v143, s[54:55]
  v_max3_f32 v4, v136, v137, v138
  v_max3_f32 v4, v4, v139, v140
  v_max3_f32 v4, v4, v141, v142
  v_max_f32 v4, v4, v143
  v_mov_b32 v5, v4
  s_nop 1
  v_permlane32_swap_b32 v4, v5
  v_max_f32 v4, v4, v5
  v_mov_b32 v5, v4
  s_nop 1
  v_permlane16_swap_b32 v4, v5
  v_max_f32 v4, v4, v5
  v_mul_f32 v4, s21, v4
  v_fma_f32 v136, v136, s21, -v4
  v_fma_f32 v137, v137, s21, -v4
  v_fma_f32 v138, v138, s21, -v4
  v_fma_f32 v139, v139, s21, -v4
  v_fma_f32 v140, v140, s21, -v4
  v_fma_f32 v141, v141, s21, -v4
  v_fma_f32 v142, v142, s21, -v4
  v_fma_f32 v143, v143, s21, -v4
  v_exp_f32 v136, v136
  v_exp_f32 v137, v137
  v_exp_f32 v138, v138
  v_exp_f32 v139, v139
  v_exp_f32 v140, v140
  v_exp_f32 v141, v141
  v_exp_f32 v142, v142
  v_exp_f32 v143, v143
  v_add_f32 v4, v136, v137
  v_add_f32 v4, v4, v138
  v_add_f32 v4, v4, v139
  v_add_f32 v4, v4, v140
  v_add_f32 v4, v4, v141
  v_add_f32 v4, v4, v142
  v_add_f32 v4, v4, v143
  v_mov_b32 v5, v4
  s_nop 1
  v_permlane32_swap_b32 v4, v5
  v_add_f32 v4, v4, v5
  v_mov_b32 v5, v4
  s_nop 1
  v_permlane16_swap_b32 v4, v5
  v_add_f32 v4, v4, v5
  v_rcp_f32 v4, v4
  s_nop 0
  v_mul_f32 v136, v136, v4
  v_mul_f32 v137, v137, v4
  v_mul_f32 v138, v138, v4
  v_mul_f32 v139, v139, v4
  v_mul_f32 v140, v140, v4
  v_mul_f32 v141, v141, v4
  v_mul_f32 v142, v142, v4
  v_mul_f32 v143, v143, v4
  v_cvt_pk_bf16_f32 v8, v136, v137
  v_cvt_pk_bf16_f32 v9, v138, v139
  v_cvt_pk_bf16_f32 v10, v140, v141
  v_cvt_pk_bf16_f32 v11, v142, v143
  v_cndmask_b32 v144, v6, v144, s[56:57]
  v_cndmask_b32 v145, v6, v145, s[58:59]
  v_cndmask_b32 v146, v6, v146, s[60:61]
  v_cndmask_b32 v147, v6, v147, s[62:63]
  v_cndmask_b32 v148, v6, v148, s[48:49]
  v_cndmask_b32 v149, v6, v149, s[50:51]
  v_cndmask_b32 v150, v6, v150, s[52:53]
  v_cndmask_b32 v151, v6, v151, s[54:55]
  v_max3_f32 v4, v144, v145, v146
  v_max3_f32 v4, v4, v147, v148
  v_max3_f32 v4, v4, v149, v150
  v_max_f32 v4, v4, v151
  v_mov_b32 v5, v4
  s_nop 1
  v_permlane32_swap_b32 v4, v5
  v_max_f32 v4, v4, v5
  v_mov_b32 v5, v4
  s_nop 1
  v_permlane16_swap_b32 v4, v5
  v_max_f32 v4, v4, v5
  v_mul_f32 v4, s21, v4
  v_fma_f32 v144, v144, s21, -v4
  v_fma_f32 v145, v145, s21, -v4
  v_fma_f32 v146, v146, s21, -v4
  v_fma_f32 v147, v147, s21, -v4
  v_fma_f32 v148, v148, s21, -v4
  v_fma_f32 v149, v149, s21, -v4
  v_fma_f32 v150, v150, s21, -v4
  v_fma_f32 v151, v151, s21, -v4
  v_exp_f32 v144, v144
  v_exp_f32 v145, v145
  v_exp_f32 v146, v146
  v_exp_f32 v147, v147
  v_exp_f32 v148, v148
  v_exp_f32 v149, v149
  v_exp_f32 v150, v150
  v_exp_f32 v151, v151
  v_add_f32 v4, v144, v145
  v_add_f32 v4, v4, v146
  v_add_f32 v4, v4, v147
  v_add_f32 v4, v4, v148
  v_add_f32 v4, v4, v149
  v_add_f32 v4, v4, v150
  v_add_f32 v4, v4, v151
  v_mov_b32 v5, v4
  s_nop 1
  v_permlane32_swap_b32 v4, v5
  v_add_f32 v4, v4, v5
  v_mov_b32 v5, v4
  s_nop 1
  v_permlane16_swap_b32 v4, v5
  v_add_f32 v4, v4, v5
  v_rcp_f32 v4, v4
  s_nop 0
  v_mul_f32 v144, v144, v4
  v_mul_f32 v145, v145, v4
  v_mul_f32 v146, v146, v4
  v_mul_f32 v147, v147, v4
  v_mul_f32 v148, v148, v4
  v_mul_f32 v149, v149, v4
  v_mul_f32 v150, v150, v4
  v_mul_f32 v151, v151, v4
  v_cvt_pk_bf16_f32 v12, v144, v145
  v_cvt_pk_bf16_f32 v13, v146, v147
  v_cvt_pk_bf16_f32 v14, v148, v149
  v_cvt_pk_bf16_f32 v15, v150, v151
  v_cndmask_b32 v152, v6, v152, s[56:57]
  v_cndmask_b32 v153, v6, v153, s[58:59]
  v_cndmask_b32 v154, v6, v154, s[60:61]
  v_cndmask_b32 v155, v6, v155, s[62:63]
  v_cndmask_b32 v156, v6, v156, s[48:49]
  v_cndmask_b32 v157, v6, v157, s[50:51]
  v_cndmask_b32 v158, v6, v158, s[52:53]
  v_cndmask_b32 v159, v6, v159, s[54:55]
  v_max3_f32 v4, v152, v153, v154
  v_max3_f32 v4, v4, v155, v156
  v_max3_f32 v4, v4, v157, v158
  v_max_f32 v4, v4, v159
  v_mov_b32 v5, v4
  s_nop 1
  v_permlane32_swap_b32 v4, v5
  v_max_f32 v4, v4, v5
  v_mov_b32 v5, v4
  s_nop 1
  v_permlane16_swap_b32 v4, v5
  v_max_f32 v4, v4, v5
  v_mul_f32 v4, s21, v4
  v_fma_f32 v152, v152, s21, -v4
  v_fma_f32 v153, v153, s21, -v4
  v_fma_f32 v154, v154, s21, -v4
  v_fma_f32 v155, v155, s21, -v4
  v_fma_f32 v156, v156, s21, -v4
  v_fma_f32 v157, v157, s21, -v4
  v_fma_f32 v158, v158, s21, -v4
  v_fma_f32 v159, v159, s21, -v4
  v_exp_f32 v152, v152
  v_exp_f32 v153, v153
  v_exp_f32 v154, v154
  v_exp_f32 v155, v155
  v_exp_f32 v156, v156
  v_exp_f32 v157, v157
  v_exp_f32 v158, v158
  v_exp_f32 v159, v159
  v_add_f32 v4, v152, v153
  v_add_f32 v4, v4, v154
  v_add_f32 v4, v4, v155
  v_add_f32 v4, v4, v156
  v_add_f32 v4, v4, v157
  v_add_f32 v4, v4, v158
  v_add_f32 v4, v4, v159
  v_mov_b32 v5, v4
  s_nop 1
  v_permlane32_swap_b32 v4, v5
  v_add_f32 v4, v4, v5
  v_mov_b32 v5, v4
  s_nop 1
  v_permlane16_swap_b32 v4, v5
  v_add_f32 v4, v4, v5
  v_rcp_f32 v4, v4
  s_nop 0
  v_mul_f32 v152, v152, v4
  v_mul_f32 v153, v153, v4
  v_mul_f32 v154, v154, v4
  v_mul_f32 v155, v155, v4
  v_mul_f32 v156, v156, v4
  v_mul_f32 v157, v157, v4
  v_mul_f32 v158, v158, v4
  v_mul_f32 v159, v159, v4
  v_cvt_pk_bf16_f32 v16, v152, v153
  v_cvt_pk_bf16_f32 v17, v154, v155
  v_cvt_pk_bf16_f32 v18, v156, v157
  v_cvt_pk_bf16_f32 v19, v158, v159
  v_cndmask_b32 v160, v6, v160, s[56:57]
  v_cndmask_b32 v161, v6, v161, s[58:59]
  v_cndmask_b32 v162, v6, v162, s[60:61]
  v_cndmask_b32 v163, v6, v163, s[62:63]
  v_cndmask_b32 v164, v6, v164, s[48:49]
  v_cndmask_b32 v165, v6, v165, s[50:51]
  v_cndmask_b32 v166, v6, v166, s[52:53]
  v_cndmask_b32 v167, v6, v167, s[54:55]
  v_max3_f32 v4, v160, v161, v162
  v_max3_f32 v4, v4, v163, v164
  v_max3_f32 v4, v4, v165, v166
  v_max_f32 v4, v4, v167
  v_mov_b32 v5, v4
  s_nop 1
  v_permlane32_swap_b32 v4, v5
  v_max_f32 v4, v4, v5
  v_mov_b32 v5, v4
  s_nop 1
  v_permlane16_swap_b32 v4, v5
  v_max_f32 v4, v4, v5
  v_mul_f32 v4, s21, v4
  v_fma_f32 v160, v160, s21, -v4
  v_fma_f32 v161, v161, s21, -v4
  v_fma_f32 v162, v162, s21, -v4
  v_fma_f32 v163, v163, s21, -v4
  v_fma_f32 v164, v164, s21, -v4
  v_fma_f32 v165, v165, s21, -v4
  v_fma_f32 v166, v166, s21, -v4
  v_fma_f32 v167, v167, s21, -v4
  v_exp_f32 v160, v160
  v_exp_f32 v161, v161
  v_exp_f32 v162, v162
  v_exp_f32 v163, v163
  v_exp_f32 v164, v164
  v_exp_f32 v165, v165
  v_exp_f32 v166, v166
  v_exp_f32 v167, v167
  v_add_f32 v4, v160, v161
  v_add_f32 v4, v4, v162
  v_add_f32 v4, v4, v163
  v_add_f32 v4, v4, v164
  v_add_f32 v4, v4, v165
  v_add_f32 v4, v4, v166
  v_add_f32 v4, v4, v167
  v_mov_b32 v5, v4
  s_nop 1
  v_permlane32_swap_b32 v4, v5
  v_add_f32 v4, v4, v5
  v_mov_b32 v5, v4
  s_nop 1
  v_permlane16_swap_b32 v4, v5
  v_add_f32 v4, v4, v5
  v_rcp_f32 v4, v4
  s_nop 0
  v_mul_f32 v160, v160, v4
  v_mul_f32 v161, v161, v4
  v_mul_f32 v162, v162, v4
  v_mul_f32 v163, v163, v4
  v_mul_f32 v164, v164, v4
  v_mul_f32 v165, v165, v4
  v_mul_f32 v166, v166, v4
  v_mul_f32 v167, v167, v4
  v_cvt_pk_bf16_f32 v20, v160, v161
  v_cvt_pk_bf16_f32 v21, v162, v163
  v_cvt_pk_bf16_f32 v22, v164, v165
  v_cvt_pk_bf16_f32 v23, v166, v167
  v_cndmask_b32 v168, v6, v168, s[40:41]
  v_cndmask_b32 v169, v6, v169, s[42:43]
  v_cndmask_b32 v170, v6, v170, s[44:45]
  v_cndmask_b32 v171, v6, v171, s[46:47]
  v_cndmask_b32 v172, v6, v172, s[48:49]
  v_cndmask_b32 v173, v6, v173, s[50:51]
  v_cndmask_b32 v174, v6, v174, s[52:53]
  v_cndmask_b32 v175, v6, v175, s[54:55]
  v_max3_f32 v4, v168, v169, v170
  v_max3_f32 v4, v4, v171, v172
  v_max3_f32 v4, v4, v173, v174
  v_max_f32 v4, v4, v175
  v_mov_b32 v5, v4
  s_nop 1
  v_permlane32_swap_b32 v4, v5
  v_max_f32 v4, v4, v5
  v_mov_b32 v5, v4
  s_nop 1
  v_permlane16_swap_b32 v4, v5
  v_max_f32 v4, v4, v5
  v_mul_f32 v4, s21, v4
  v_fma_f32 v168, v168, s21, -v4
  v_fma_f32 v169, v169, s21, -v4
  v_fma_f32 v170, v170, s21, -v4
  v_fma_f32 v171, v171, s21, -v4
  v_fma_f32 v172, v172, s21, -v4
  v_fma_f32 v173, v173, s21, -v4
  v_fma_f32 v174, v174, s21, -v4
  v_fma_f32 v175, v175, s21, -v4
  v_exp_f32 v168, v168
  v_exp_f32 v169, v169
  v_exp_f32 v170, v170
  v_exp_f32 v171, v171
  v_exp_f32 v172, v172
  v_exp_f32 v173, v173
  v_exp_f32 v174, v174
  v_exp_f32 v175, v175
  v_add_f32 v4, v168, v169
  v_add_f32 v4, v4, v170
  v_add_f32 v4, v4, v171
  v_add_f32 v4, v4, v172
  v_add_f32 v4, v4, v173
  v_add_f32 v4, v4, v174
  v_add_f32 v4, v4, v175
  v_mov_b32 v5, v4
  s_nop 1
  v_permlane32_swap_b32 v4, v5
  v_add_f32 v4, v4, v5
  v_mov_b32 v5, v4
  s_nop 1
  v_permlane16_swap_b32 v4, v5
  v_add_f32 v4, v4, v5
  v_rcp_f32 v4, v4
  s_nop 0
  v_mul_f32 v168, v168, v4
  v_mul_f32 v169, v169, v4
  v_mul_f32 v170, v170, v4
  v_mul_f32 v171, v171, v4
  v_mul_f32 v172, v172, v4
  v_mul_f32 v173, v173, v4
  v_mul_f32 v174, v174, v4
  v_mul_f32 v175, v175, v4
  v_cvt_pk_bf16_f32 v24, v168, v169
  v_cvt_pk_bf16_f32 v25, v170, v171
  v_cvt_pk_bf16_f32 v26, v172, v173
  v_cvt_pk_bf16_f32 v27, v174, v175
  v_cndmask_b32 v176, v6, v176, s[40:41]
  v_cndmask_b32 v177, v6, v177, s[42:43]
  v_cndmask_b32 v178, v6, v178, s[44:45]
  v_cndmask_b32 v179, v6, v179, s[46:47]
  v_cndmask_b32 v180, v6, v180, s[48:49]
  v_cndmask_b32 v181, v6, v181, s[50:51]
  v_cndmask_b32 v182, v6, v182, s[52:53]
  v_cndmask_b32 v183, v6, v183, s[54:55]
  v_max3_f32 v4, v176, v177, v178
  v_max3_f32 v4, v4, v179, v180
  v_max3_f32 v4, v4, v181, v182
  v_max_f32 v4, v4, v183
  v_mov_b32 v5, v4
  s_nop 1
  v_permlane32_swap_b32 v4, v5
  v_max_f32 v4, v4, v5
  v_mov_b32 v5, v4
  s_nop 1
  v_permlane16_swap_b32 v4, v5
  v_max_f32 v4, v4, v5
  v_mul_f32 v4, s21, v4
  v_fma_f32 v176, v176, s21, -v4
  v_fma_f32 v177, v177, s21, -v4
  v_fma_f32 v178, v178, s21, -v4
  v_fma_f32 v179, v179, s21, -v4
  v_fma_f32 v180, v180, s21, -v4
  v_fma_f32 v181, v181, s21, -v4
  v_fma_f32 v182, v182, s21, -v4
  v_fma_f32 v183, v183, s21, -v4
  v_exp_f32 v176, v176
  v_exp_f32 v177, v177
  v_exp_f32 v178, v178
  v_exp_f32 v179, v179
  v_exp_f32 v180, v180
  v_exp_f32 v181, v181
  v_exp_f32 v182, v182
  v_exp_f32 v183, v183
  v_add_f32 v4, v176, v177
  v_add_f32 v4, v4, v178
  v_add_f32 v4, v4, v179
  v_add_f32 v4, v4, v180
  v_add_f32 v4, v4, v181
  v_add_f32 v4, v4, v182
  v_add_f32 v4, v4, v183
  v_mov_b32 v5, v4
  s_nop 1
  v_permlane32_swap_b32 v4, v5
  v_add_f32 v4, v4, v5
  v_mov_b32 v5, v4
  s_nop 1
  v_permlane16_swap_b32 v4, v5
  v_add_f32 v4, v4, v5
  v_rcp_f32 v4, v4
  s_nop 0
  v_mul_f32 v176, v176, v4
  v_mul_f32 v177, v177, v4
  v_mul_f32 v178, v178, v4
  v_mul_f32 v179, v179, v4
  v_mul_f32 v180, v180, v4
  v_mul_f32 v181, v181, v4
  v_mul_f32 v182, v182, v4
  v_mul_f32 v183, v183, v4
  v_cvt_pk_bf16_f32 v28, v176, v177
  v_cvt_pk_bf16_f32 v29, v178, v179
  v_cvt_pk_bf16_f32 v30, v180, v181
  v_cvt_pk_bf16_f32 v31, v182, v183
  v_cndmask_b32 v184, v6, v184, s[40:41]
  v_cndmask_b32 v185, v6, v185, s[42:43]
  v_cndmask_b32 v186, v6, v186, s[44:45]
  v_cndmask_b32 v187, v6, v187, s[46:47]
  v_cndmask_b32 v188, v6, v188, s[48:49]
  v_cndmask_b32 v189, v6, v189, s[50:51]
  v_cndmask_b32 v190, v6, v190, s[52:53]
  v_cndmask_b32 v191, v6, v191, s[54:55]
  v_max3_f32 v4, v184, v185, v186
  v_max3_f32 v4, v4, v187, v188
  v_max3_f32 v4, v4, v189, v190
  v_max_f32 v4, v4, v191
  v_mov_b32 v5, v4
  s_nop 1
  v_permlane32_swap_b32 v4, v5
  v_max_f32 v4, v4, v5
  v_mov_b32 v5, v4
  s_nop 1
  v_permlane16_swap_b32 v4, v5
  v_max_f32 v4, v4, v5
  v_mul_f32 v4, s21, v4
  v_fma_f32 v184, v184, s21, -v4
  v_fma_f32 v185, v185, s21, -v4
  v_fma_f32 v186, v186, s21, -v4
  v_fma_f32 v187, v187, s21, -v4
  v_fma_f32 v188, v188, s21, -v4
  v_fma_f32 v189, v189, s21, -v4
  v_fma_f32 v190, v190, s21, -v4
  v_fma_f32 v191, v191, s21, -v4
  v_exp_f32 v184, v184
  v_exp_f32 v185, v185
  v_exp_f32 v186, v186
  v_exp_f32 v187, v187
  v_exp_f32 v188, v188
  v_exp_f32 v189, v189
  v_exp_f32 v190, v190
  v_exp_f32 v191, v191
  v_add_f32 v4, v184, v185
  v_add_f32 v4, v4, v186
  v_add_f32 v4, v4, v187
  v_add_f32 v4, v4, v188
  v_add_f32 v4, v4, v189
  v_add_f32 v4, v4, v190
  v_add_f32 v4, v4, v191
  v_mov_b32 v5, v4
  s_nop 1
  v_permlane32_swap_b32 v4, v5
  v_add_f32 v4, v4, v5
  v_mov_b32 v5, v4
  s_nop 1
  v_permlane16_swap_b32 v4, v5
  v_add_f32 v4, v4, v5
  v_rcp_f32 v4, v4
  s_nop 0
  v_mul_f32 v184, v184, v4
  v_mul_f32 v185, v185, v4
  v_mul_f32 v186, v186, v4
  v_mul_f32 v187, v187, v4
  v_mul_f32 v188, v188, v4
  v_mul_f32 v189, v189, v4
  v_mul_f32 v190, v190, v4
  v_mul_f32 v191, v191, v4
  v_cvt_pk_bf16_f32 v32, v184, v185
  v_cvt_pk_bf16_f32 v33, v186, v187
  v_cvt_pk_bf16_f32 v34, v188, v189
  v_cvt_pk_bf16_f32 v35, v190, v191
  v_cndmask_b32 v192, v6, v192, s[40:41]
  v_cndmask_b32 v193, v6, v193, s[42:43]
  v_cndmask_b32 v194, v6, v194, s[44:45]
  v_cndmask_b32 v195, v6, v195, s[46:47]
  v_cndmask_b32 v196, v6, v196, s[48:49]
  v_cndmask_b32 v197, v6, v197, s[50:51]
  v_cndmask_b32 v198, v6, v198, s[52:53]
  v_cndmask_b32 v199, v6, v199, s[54:55]
  v_max3_f32 v4, v192, v193, v194
  v_max3_f32 v4, v4, v195, v196
  v_max3_f32 v4, v4, v197, v198
  v_max_f32 v4, v4, v199
  v_mov_b32 v5, v4
  s_nop 1
  v_permlane32_swap_b32 v4, v5
  v_max_f32 v4, v4, v5
  v_mov_b32 v5, v4
  s_nop 1
  v_permlane16_swap_b32 v4, v5
  v_max_f32 v4, v4, v5
  v_mul_f32 v4, s21, v4
  v_fma_f32 v192, v192, s21, -v4
  v_fma_f32 v193, v193, s21, -v4
  v_fma_f32 v194, v194, s21, -v4
  v_fma_f32 v195, v195, s21, -v4
  v_fma_f32 v196, v196, s21, -v4
  v_fma_f32 v197, v197, s21, -v4
  v_fma_f32 v198, v198, s21, -v4
  v_fma_f32 v199, v199, s21, -v4
  v_exp_f32 v192, v192
  v_exp_f32 v193, v193
  v_exp_f32 v194, v194
  v_exp_f32 v195, v195
  v_exp_f32 v196, v196
  v_exp_f32 v197, v197
  v_exp_f32 v198, v198
  v_exp_f32 v199, v199
  v_add_f32 v4, v192, v193
  v_add_f32 v4, v4, v194
  v_add_f32 v4, v4, v195
  v_add_f32 v4, v4, v196
  v_add_f32 v4, v4, v197
  v_add_f32 v4, v4, v198
  v_add_f32 v4, v4, v199
  v_mov_b32 v5, v4
  s_nop 1
  v_permlane32_swap_b32 v4, v5
  v_add_f32 v4, v4, v5
  v_mov_b32 v5, v4
  s_nop 1
  v_permlane16_swap_b32 v4, v5
  v_add_f32 v4, v4, v5
  v_rcp_f32 v4, v4
  s_nop 0
  v_mul_f32 v192, v192, v4
  v_mul_f32 v193, v193, v4
  v_mul_f32 v194, v194, v4
  v_mul_f32 v195, v195, v4
  v_mul_f32 v196, v196, v4
  v_mul_f32 v197, v197, v4
  v_mul_f32 v198, v198, v4
  v_mul_f32 v199, v199, v4
  v_cvt_pk_bf16_f32 v36, v192, v193
  v_cvt_pk_bf16_f32 v37, v194, v195
  v_cvt_pk_bf16_f32 v38, v196, v197
  v_cvt_pk_bf16_f32 v39, v198, v199
  s_waitcnt vmcnt(0)
  s_cmp_lg_u32 s32, 0
  s_cbranch_scc1 L_rq_12
  s_cmp_eq_u32 s39, 0
  s_cbranch_scc1 L_rq_12
  s_lshl_b32 s99, s33, 7
  s_add_u32 s99, s99, 0x3d00200
  v_mov_b32 v244, 1
  v_mov_b32 v245, 0
  s_mov_b64 exec, 1
  buffer_atomic_add v244, v245, s[4:7], s99 offen sc0 sc1
  s_mov_b64 exec, -1
L_rq_12:
  v_mfma_f32_16x16x32_bf16 v[136:139], v[88:91], v[8:11], 0
  v_mfma_f32_16x16x32_bf16 v[140:143], v[94:97], v[8:11], 0
  v_mfma_f32_16x16x32_bf16 v[144:147], v[100:103], v[12:15], 0
  v_mfma_f32_16x16x32_bf16 v[148:151], v[106:109], v[12:15], 0
  v_mfma_f32_16x16x32_bf16 v[152:155], v[112:115], v[16:19], 0
  v_mfma_f32_16x16x32_bf16 v[156:159], v[118:121], v[16:19], 0
  v_mfma_f32_16x16x32_bf16 v[160:163], v[124:127], v[20:23], 0
  v_mfma_f32_16x16x32_bf16 v[164:167], v[130:133], v[20:23], 0
  v_mfma_f32_16x16x32_bf16 v[168:171], v[90:93], v[24:27], 0
  v_mfma_f32_16x16x32_bf16 v[172:175], v[96:99], v[24:27], 0
  v_mfma_f32_16x16x32_bf16 v[176:179], v[102:105], v[28:31], 0
  v_mfma_f32_16x16x32_bf16 v[180:183], v[108:111], v[28:31], 0
  v_mfma_f32_16x16x32_bf16 v[184:187], v[114:117], v[32:35], 0
  v_mfma_f32_16x16x32_bf16 v[188:191], v[120:123], v[32:35], 0
  v_mfma_f32_16x16x32_bf16 v[192:195], v[126:129], v[36:39], 0
  v_mfma_f32_16x16x32_bf16 v[196:199], v[132:135], v[36:39], 0
  v_cvt_pk_bf16_f32 v40, v136, v137
  v_cvt_pk_bf16_f32 v41, v138, v139
  v_cvt_pk_bf16_f32 v42, v140, v141
  v_cvt_pk_bf16_f32 v43, v142, v143
  buffer_store_dwordx4 v[40:43], v2, s[4:7], s97 offen offset:0 sc1
  v_cvt_pk_bf16_f32 v44, v144, v145
  v_cvt_pk_bf16_f32 v45, v146, v147
  v_cvt_pk_bf16_f32 v46, v148, v149
  v_cvt_pk_bf16_f32 v47, v150, v151
  buffer_store_dwordx4 v[44:47], v2, s[4:7], s97 offen offset:1024 sc1
  v_cvt_pk_bf16_f32 v48, v152, v153
  v_cvt_pk_bf16_f32 v49, v154, v155
  v_cvt_pk_bf16_f32 v50, v156, v157
  v_cvt_pk_bf16_f32 v51, v158, v159
  buffer_store_dwordx4 v[48:51], v2, s[4:7], s97 offen offset:2048 sc1
  v_cvt_pk_bf16_f32 v52, v160, v161
  v_cvt_pk_bf16_f32 v53, v162, v163
  v_cvt_pk_bf16_f32 v54, v164, v165
  v_cvt_pk_bf16_f32 v55, v166, v167
  buffer_store_dwordx4 v[52:55], v2, s[4:7], s97 offen offset:3072 sc1
  v_cvt_pk_bf16_f32 v56, v168, v169
  v_cvt_pk_bf16_f32 v57, v170, v171
  v_cvt_pk_bf16_f32 v58, v172, v173
  v_cvt_pk_bf16_f32 v59, v174, v175
  buffer_store_dwordx4 v[56:59], v3, s[4:7], s97 offen offset:0 sc1
  v_cvt_pk_bf16_f32 v60, v176, v177
  v_cvt_pk_bf16_f32 v61, v178, v179
  v_cvt_pk_bf16_f32 v62, v180, v181
  v_cvt_pk_bf16_f32 v63, v182, v183
  buffer_store_dwordx4 v[60:63], v3, s[4:7], s97 offen offset:1024 sc1
  v_cvt_pk_bf16_f32 v64, v184, v185
  v_cvt_pk_bf16_f32 v65, v186, v187
  v_cvt_pk_bf16_f32 v66, v188, v189
  v_cvt_pk_bf16_f32 v67, v190, v191
  buffer_store_dwordx4 v[64:67], v3, s[4:7], s97 offen offset:2048 sc1
  v_cvt_pk_bf16_f32 v68, v192, v193
  v_cvt_pk_bf16_f32 v69, v194, v195
  v_cvt_pk_bf16_f32 v70, v196, v197
  v_cvt_pk_bf16_f32 v71, v198, v199
  buffer_store_dwordx4 v[68:71], v3, s[4:7], s97 offen offset:3072 sc1
  s_branch L_done
L_ata:
  s_lshr_b32 s40, s36, 3
  s_lshl_b32 s40, s40, 9
  s_lshl_b32 s90, s33, 7
  s_add_u32 s40, s40, s90
  s_add_u32 s41, s36, 1
  s_cmp_lg_u32 s32, 0
  s_cbranch_scc1 L_dd_14
  v_mov_b32 v228, 0x3d00000
  v_mov_b32 v229, 0x3d01000
  v_mov_b32 v230, 0x3d02000
L_dw_13:
  buffer_load_dword v234, v230, s[4:7], s40 offen offset:0 sc1
  buffer_load_dword v235, v229, s[4:7], s40 offen offset:0 sc1
  s_waitcnt vmcnt(0)
  s_mov_b32 s44, 1
  v_readfirstlane_b32 s45, v234
  s_cmp_ge_u32 s45, 4
  s_cselect_b32 s44, s44, 0
  v_readfirstlane_b32 s45, v235
  s_cmp_ge_u32 s45, 32
  s_cselect_b32 s44, s44, 0
  s_cmp_eq_u32 s44, 1
  s_cbranch_scc1 L_dd_14
  s_sleep 6
  s_add_u32 s3, s3, 1
  s_cmp_lt_u32 s3, 131072
  s_cbranch_scc1 L_dw_13
L_dd_14:
  s_barrier
  s_mov_b32 s98, 1
  s_lshr_b32 s38, s36, 2
  s_lshl_b32 s38, s38, 7
  s_add_u32 s38, s38, 2048
  s_lshr_b32 s90, s36, 2
  s_sub_u32 s90, s90, 12
  s_lshl_b32 s90, s90, 2
  s_add_u32 s90, s90, s33
  s_lshl_b32 s90, s90, 1
  s_add_u32 s90, s90, s37
  s_lshl_b32 s90, s90, 7
  s_add_u32 s90, s90, 20480
  s_cmp_ge_u32 s36, 52
  s_cselect_b32 s38, s90, s38
  s_lshl_b32 s20, s36, 5
  s_lshl_b32 s90, s33, 3
  s_add_u32 s20, s20, s90
  s_lshl_b32 s90, s37, 2
  s_add_u32 s20, s20, s90
  s_add_u32 s20, s20, s32
  v_and_b32 v1, 63, v0
  s_lshl_b32 s90, s20, 13
  s_lshl_b32 s91, s20, 11
  v_mov_b32 v2, 0x0
  v_bfe_u32 v7, v1, 0, 6
  v_lshl_add_u32 v2, v7, 4, v2
  v_add_u32 v3, 4096, v2
  v_mov_b32 v4, 0x3000000
  v_bfe_u32 v7, v1, 0, 1
  v_lshl_add_u32 v4, v7, 4, v4
  v_bfe_u32 v7, v1, 2, 2
  v_lshl_add_u32 v4, v7, 5, v4
  v_bfe_u32 v7, v1, 4, 2
  v_lshl_add_u32 v4, v7, 7, v4
  v_add_u32 v5, 0x3400000, v2
  v_mov_b32 v8, 0x0
  v_bfe_u32 v7, v1, 0, 3
  v_lshl_add_u32 v8, v7, 4, v8
  v_bfe_u32 v7, v1, 3, 1
  v_lshl_add_u32 v8, v7, 11, v8
  v_bfe_u32 v7, v1, 4, 2
  v_lshl_add_u32 v8, v7, 8, v8
  v_add_u32 v9, 4096, v8
  v_mov_b32 v10, 0x0
  v_bfe_u32 v7, v1, 0, 4
  v_lshl_add_u32 v10, v7, 4, v10
  v_bfe_u32 v7, v1, 4, 1
  v_lshl_add_u32 v10, v7, 8, v10
  v_bfe_u32 v7, v1, 5, 1
  v_lshl_add_u32 v10, v7, 10, v10
  v_add_u32 v11, 4096, v10
  s_add_u32 s92, s90, 16777216
  s_add_u32 s93, s90, 33554432
  s_add_u32 s94, s90, 0
  s_add_u32 s95, s90, 83886080
  buffer_load_dwordx4 v[16:19], v2, s[4:7], s94 offen offset:0 sc1
  buffer_load_dwordx4 v[20:23], v2, s[4:7], s94 offen offset:1024 sc1
  buffer_load_dwordx4 v[24:27], v2, s[4:7], s94 offen offset:2048 sc1
  buffer_load_dwordx4 v[28:31], v2, s[4:7], s94 offen offset:3072 sc1
  buffer_load_dwordx4 v[32:35], v3, s[4:7], s94 offen offset:0 sc1
  buffer_load_dwordx4 v[36:39], v3, s[4:7], s94 offen offset:1024 sc1
  buffer_load_dwordx4 v[40:43], v3, s[4:7], s94 offen offset:2048 sc1
  buffer_load_dwordx4 v[44:47], v3, s[4:7], s94 offen offset:3072 sc1
  buffer_load_dwordx4 v[48:51], v2, s[4:7], s92 offen offset:0 sc1
  buffer_load_dwordx4 v[52:55], v2, s[4:7], s92 offen offset:1024 sc1
  buffer_load_dwordx4 v[56:59], v2, s[4:7], s92 offen offset:2048 sc1
  buffer_load_dwordx4 v[60:63], v2, s[4:7], s92 offen offset:3072 sc1
  buffer_load_dwordx4 v[64:67], v3, s[4:7], s92 offen offset:0 sc1
  buffer_load_dwordx4 v[68:71], v3, s[4:7], s92 offen offset:1024 sc1
  buffer_load_dwordx4 v[72:75], v3, s[4:7], s92 offen offset:2048 sc1
  buffer_load_dwordx4 v[76:79], v3, s[4:7], s92 offen offset:3072 sc1
  buffer_load_dwordx4 v[80:83], v8, s[4:7], s93 offen offset:0 sc1
  buffer_load_dwordx4 v[84:87], v8, s[4:7], s93 offen offset:128 sc1
  buffer_load_dwordx4 v[88:91], v8, s[4:7], s93 offen offset:1024 sc1
  buffer_load_dwordx4 v[92:95], v8, s[4:7], s93 offen offset:1152 sc1
  buffer_load_dwordx4 v[96:99], v9, s[4:7], s93 offen offset:0 sc1
  buffer_load_dwordx4 v[100:103], v9, s[4:7], s93 offen offset:128 sc1
  buffer_load_dwordx4 v[104:107], v9, s[4:7], s93 offen offset:1024 sc1
  buffer_load_dwordx4 v[108:111], v9, s[4:7], s93 offen offset:1152 sc1
  s_cmp_lg_u32 s32, 0
  s_cbranch_scc1 L_dd_16
  v_mov_b32 v228, 0x3d00000
L_dw_15:
  buffer_load_dword v238, v228, s[4:7], 0 offen offset:0 sc1
  buffer_load_dword v239, v228, s[4:7], 0 offen offset:128 sc1
  s_waitcnt vmcnt(0)
  s_mov_b32 s44, 1
  v_readfirstlane_b32 s45, v238
  v_readfirstlane_b32 s47, v239
  s_cmp_ge_u32 s47, 128
  s_cselect_b32 s45, 64, s45
  s_cmp_ge_u32 s45, s41
  s_cselect_b32 s44, s44, 0
  s_cmp_eq_u32 s44, 1
  s_cbranch_scc1 L_dd_16
  s_sleep 3
  s_add_u32 s3, s3, 1
  s_cmp_lt_u32 s3, 131072
  s_cbranch_scc1 L_dw_15
L_dd_16:
  s_barrier
  buffer_load_dwordx4 v[112:115], v4, s[4:7], s91 offen offset:0 sc1
  buffer_load_dwordx4 v[116:119], v4, s[4:7], s91 offen offset:512 sc1
  buffer_load_dwordx4 v[120:123], v4, s[4:7], s91 offen offset:1024 sc1
  buffer_load_dwordx4 v[124:127], v4, s[4:7], s91 offen offset:1536 sc1
  buffer_load_dwordx4 v[128:131], v5, s[4:7], s91 offen offset:0 sc1
  buffer_load_dwordx4 v[132:135], v5, s[4:7], s91 offen offset:1024 sc1
  s_add_u32 s92, s92, 262144
  s_add_u32 s93, s93, 262144
  s_add_u32 s94, s94, 262144
  s_add_u32 s91, s91, 65536
  s_mov_b32 s40, 0xfff0ffff
  s_mov_b32 s41, 0xf000ff00
  s_mov_b32 s42, 0xffe0fffe
  s_mov_b32 s43, 0xe000fe00
  s_mov_b32 s44, 0xffc0fffc
  s_mov_b32 s45, 0xc000fc00
  s_mov_b32 s46, 0xff80fff8
  s_mov_b32 s47, 0x8000f800
  s_mov_b32 s50, 0x3e0293ee
  v_mov_b32 v6, 0xd028965f
  s_waitcnt vmcnt(0)
  s_cmp_lg_u32 s32, 0
  s_cbranch_scc1 L_rq_17
  s_cmp_eq_u32 s39, 0
  s_cbranch_scc1 L_rq_17
  s_lshl_b32 s99, s33, 7
  s_add_u32 s99, s99, 0x3d00200
  v_mov_b32 v244, 1
  v_mov_b32 v245, 0
  s_mov_b64 exec, 1
  buffer_atomic_add v244, v245, s[4:7], s99 offen sc0 sc1
  s_mov_b64 exec, -1
L_rq_17:
  v_mfma_f32_16x16x32_bf16 v[136:139], v[112:115], v[16:19], 0
  v_mfma_f32_16x16x32_bf16 v[140:143], v[48:51], v[16:19], 0
  v_mfma_f32_16x16x32_bf16 v[144:147], v[112:115], v[32:35], 0
  v_mfma_f32_16x16x32_bf16 v[148:151], v[48:51], v[32:35], 0
  v_mfma_f32_16x16x32_bf16 v[152:155], v[64:67], v[32:35], 0
  v_mfma_f32_16x16x32_bf16 v[136:139], v[116:119], v[20:23], v[136:139]
  v_mfma_f32_16x16x32_bf16 v[140:143], v[52:55], v[20:23], v[140:143]
  v_mfma_f32_16x16x32_bf16 v[144:147], v[116:119], v[36:39], v[144:147]
  v_mfma_f32_16x16x32_bf16 v[148:151], v[52:55], v[36:39], v[148:151]
  v_mfma_f32_16x16x32_bf16 v[152:155], v[68:71], v[36:39], v[152:155]
  v_mfma_f32_16x16x32_bf16 v[136:139], v[120:123], v[24:27], v[136:139]
  v_mfma_f32_16x16x32_bf16 v[140:143], v[56:59], v[24:27], v[140:143]
  v_mfma_f32_16x16x32_bf16 v[144:147], v[120:123], v[40:43], v[144:147]
  v_mfma_f32_16x16x32_bf16 v[148:151], v[56:59], v[40:43], v[148:151]
  v_mfma_f32_16x16x32_bf16 v[152:155], v[72:75], v[40:43], v[152:155]
  v_mfma_f32_16x16x32_bf16 v[136:139], v[124:127], v[28:31], v[136:139]
  v_mfma_f32_16x16x32_bf16 v[140:143], v[60:63], v[28:31], v[140:143]
  v_mfma_f32_16x16x32_bf16 v[144:147], v[124:127], v[44:47], v[144:147]
  v_mfma_f32_16x16x32_bf16 v[148:151], v[60:63], v[44:47], v[148:151]
  v_mfma_f32_16x16x32_bf16 v[152:155], v[76:79], v[44:47], v[152:155]
  s_nop 4
  v_cndmask_b32 v140, v6, v140, s[40:41]
  v_cndmask_b32 v141, v6, v141, s[42:43]
  v_cndmask_b32 v142, v6, v142, s[44:45]
  v_cndmask_b32 v143, v6, v143, s[46:47]
  v_max3_f32 v12, v136, v137, v140
  v_max3_f32 v12, v12, v141, v142
  v_max_f32 v12, v12, v143
  v_mov_b32 v13, v12
  s_nop 1
  v_permlane32_swap_b32 v12, v13
  v_max_f32 v12, v12, v13
  v_mov_b32 v13, v12
  s_nop 1
  v_permlane16_swap_b32 v12, v13
  v_max_f32 v12, v12, v13
  v_mul_f32 v12, s50, v12
  v_fma_f32 v136, v136, s50, -v12
  v_fma_f32 v137, v137, s50, -v12
  v_fma_f32 v140, v140, s50, -v12
  v_fma_f32 v141, v141, s50, -v12
  v_fma_f32 v142, v142, s50, -v12
  v_fma_f32 v143, v143, s50, -v12
  v_exp_f32 v136, v136
  v_exp_f32 v137, v137
  v_exp_f32 v140, v140
  v_exp_f32 v141, v141
  v_exp_f32 v142, v142
  v_exp_f32 v143, v143
  v_add_f32 v12, v136, v137
  v_add_f32 v12, v12, v140
  v_add_f32 v12, v12, v141
  v_add_f32 v12, v12, v142
  v_add_f32 v12, v12, v143
  v_mov_b32 v13, v12
  s_nop 1
  v_permlane32_swap_b32 v12, v13
  v_add_f32 v12, v12, v13
  v_mov_b32 v13, v12
  s_nop 1
  v_permlane16_swap_b32 v12, v13
  v_add_f32 v12, v12, v13
  v_rcp_f32 v12, v12
  s_nop 0
  v_mul_f32 v136, v136, v12
  v_mul_f32 v137, v137, v12
  v_mul_f32 v140, v140, v12
  v_mul_f32 v141, v141, v12
  v_mul_f32 v142, v142, v12
  v_mul_f32 v143, v143, v12
  v_cvt_pk_bf16_f32 v160, v136, v137
  v_mov_b32 v161, 0
  v_mov_b32 v162, 0
  v_mov_b32 v163, v160
  v_cvt_pk_bf16_f32 v156, v140, v141
  v_cvt_pk_bf16_f32 v157, v142, v143
  v_mov_b32 v158, 0
  v_mov_b32 v159, 0
  v_cndmask_b32 v152, v6, v152, s[40:41]
  v_cndmask_b32 v153, v6, v153, s[42:43]
  v_cndmask_b32 v154, v6, v154, s[44:45]
  v_cndmask_b32 v155, v6, v155, s[46:47]
  v_max3_f32 v12, v144, v145, v148
  v_max3_f32 v12, v12, v149, v150
  v_max3_f32 v12, v12, v151, v152
  v_max3_f32 v12, v12, v153, v154
  v_max_f32 v12, v12, v155
  v_mov_b32 v13, v12
  s_nop 1
  v_permlane32_swap_b32 v12, v13
  v_max_f32 v12, v12, v13
  v_mov_b32 v13, v12
  s_nop 1
  v_permlane16_swap_b32 v12, v13
  v_max_f32 v12, v12, v13
  v_mul_f32 v12, s50, v12
  v_fma_f32 v144, v144, s50, -v12
  v_fma_f32 v145, v145, s50, -v12
  v_fma_f32 v148, v148, s50, -v12
  v_fma_f32 v149, v149, s50, -v12
  v_fma_f32 v150, v150, s50, -v12
  v_fma_f32 v151, v151, s50, -v12
  v_fma_f32 v152, v152, s50, -v12
  v_fma_f32 v153, v153, s50, -v12
  v_fma_f32 v154, v154, s50, -v12
  v_fma_f32 v155, v155, s50, -v12
  v_exp_f32 v144, v144
  v_exp_f32 v145, v145
  v_exp_f32 v148, v148
  v_exp_f32 v149, v149
  v_exp_f32 v150, v150
  v_exp_f32 v151, v151
  v_exp_f32 v152, v152
  v_exp_f32 v153, v153
  v_exp_f32 v154, v154
  v_exp_f32 v155, v155
  v_add_f32 v12, v144, v145
  v_add_f32 v12, v12, v148
  v_add_f32 v12, v12, v149
  v_add_f32 v12, v12, v150
  v_add_f32 v12, v12, v151
  v_add_f32 v12, v12, v152
  v_add_f32 v12, v12, v153
  v_add_f32 v12, v12, v154
  v_add_f32 v12, v12, v155
  v_mov_b32 v13, v12
  s_nop 1
  v_permlane32_swap_b32 v12, v13
  v_add_f32 v12, v12, v13
  v_mov_b32 v13, v12
  s_nop 1
  v_permlane16_swap_b32 v12, v13
  v_add_f32 v12, v12, v13
  v_rcp_f32 v12, v12
  s_nop 0
  v_mul_f32 v144, v144, v12
  v_mul_f32 v145, v145, v12
  v_mul_f32 v148, v148, v12
  v_mul_f32 v149, v149, v12
  v_mul_f32 v150, v150, v12
  v_mul_f32 v151, v151, v12
  v_mul_f32 v152, v152, v12
  v_mul_f32 v153, v153, v12
  v_mul_f32 v154, v154, v12
  v_mul_f32 v155, v155, v12
  v_cvt_pk_bf16_f32 v168, v144, v145
  v_mov_b32 v169, 0
  v_mov_b32 v170, 0
  v_mov_b32 v171, v168
  v_cvt_pk_bf16_f32 v164, v148, v149
  v_cvt_pk_bf16_f32 v165, v150, v151
  v_cvt_pk_bf16_f32 v166, v152, v153
  v_cvt_pk_bf16_f32 v167, v154, v155
  v_mfma_f32_16x16x32_bf16 v[176:179], v[80:83], v[156:159], 0
  v_mfma_f32_16x16x32_bf16 v[180:183], v[84:87], v[156:159], 0
  v_mfma_f32_16x16x32_bf16 v[184:187], v[88:91], v[156:159], 0
  v_mfma_f32_16x16x32_bf16 v[188:191], v[92:95], v[156:159], 0
  v_mfma_f32_16x16x32_bf16 v[192:195], v[96:99], v[156:159], 0
  v_mfma_f32_16x16x32_bf16 v[196:199], v[100:103], v[156:159], 0
  v_mfma_f32_16x16x32_bf16 v[200:203], v[104:107], v[156:159], 0
  v_mfma_f32_16x16x32_bf16 v[204:207], v[108:111], v[156:159], 0
  v_mfma_f32_16x16x16_bf16 v[176:179], v[128:129], v[160:161], v[176:179]
  v_mfma_f32_16x16x16_bf16 v[180:183], v[128:129], v[162:163], v[180:183]
  v_mfma_f32_16x16x16_bf16 v[184:187], v[130:131], v[160:161], v[184:187]
  v_mfma_f32_16x16x16_bf16 v[188:191], v[130:131], v[162:163], v[188:191]
  v_mfma_f32_16x16x16_bf16 v[192:195], v[132:133], v[160:161], v[192:195]
  v_mfma_f32_16x16x16_bf16 v[196:199], v[132:133], v[162:163], v[196:199]
  v_mfma_f32_16x16x16_bf16 v[200:203], v[134:135], v[160:161], v[200:203]
  v_mfma_f32_16x16x16_bf16 v[204:207], v[134:135], v[162:163], v[204:207]
  v_mfma_f32_16x16x32_bf16 v[208:211], v[80:83], v[164:167], 0
  v_mfma_f32_16x16x32_bf16 v[212:215], v[84:87], v[164:167], 0
  v_mfma_f32_16x16x32_bf16 v[216:219], v[88:91], v[164:167], 0
  v_mfma_f32_16x16x32_bf16 v[220:223], v[92:95], v[164:167], 0
  v_mfma_f32_16x16x32_bf16 v[224:227], v[96:99], v[164:167], 0
  v_mfma_f32_16x16x32_bf16 v[228:231], v[100:103], v[164:167], 0
  v_mfma_f32_16x16x32_bf16 v[232:235], v[104:107], v[164:167], 0
  v_mfma_f32_16x16x32_bf16 v[236:239], v[108:111], v[164:167], 0
  v_mfma_f32_16x16x16_bf16 v[208:211], v[128:129], v[168:169], v[208:211]
  v_mfma_f32_16x16x16_bf16 v[212:215], v[128:129], v[170:171], v[212:215]
  v_mfma_f32_16x16x16_bf16 v[216:219], v[130:131], v[168:169], v[216:219]
  v_mfma_f32_16x16x16_bf16 v[220:223], v[130:131], v[170:171], v[220:223]
  v_mfma_f32_16x16x16_bf16 v[224:227], v[132:133], v[168:169], v[224:227]
  v_mfma_f32_16x16x16_bf16 v[228:231], v[132:133], v[170:171], v[228:231]
  v_mfma_f32_16x16x16_bf16 v[232:235], v[134:135], v[168:169], v[232:235]
  v_mfma_f32_16x16x16_bf16 v[236:239], v[134:135], v[170:171], v[236:239]
  v_cvt_pk_bf16_f32 v136, v176, v177
  v_cvt_pk_bf16_f32 v137, v178, v179
  v_cvt_pk_bf16_f32 v138, v184, v185
  v_cvt_pk_bf16_f32 v139, v186, v187
  buffer_store_dwordx4 v[136:139], v10, s[4:7], s95 offen offset:0 sc1
  v_cvt_pk_bf16_f32 v140, v180, v181
  v_cvt_pk_bf16_f32 v141, v182, v183
  v_cvt_pk_bf16_f32 v142, v188, v189
  v_cvt_pk_bf16_f32 v143, v190, v191
  buffer_store_dwordx4 v[140:143], v10, s[4:7], s95 offen offset:512 sc1
  v_cvt_pk_bf16_f32 v144, v192, v193
  v_cvt_pk_bf16_f32 v145, v194, v195
  v_cvt_pk_bf16_f32 v146, v200, v201
  v_cvt_pk_bf16_f32 v147, v202, v203
  buffer_store_dwordx4 v[144:147], v10, s[4:7], s95 offen offset:2048 sc1
  v_cvt_pk_bf16_f32 v148, v196, v197
  v_cvt_pk_bf16_f32 v149, v198, v199
  v_cvt_pk_bf16_f32 v150, v204, v205
  v_cvt_pk_bf16_f32 v151, v206, v207
  buffer_store_dwordx4 v[148:151], v10, s[4:7], s95 offen offset:2560 sc1
  v_cvt_pk_bf16_f32 v136, v208, v209
  v_cvt_pk_bf16_f32 v137, v210, v211
  v_cvt_pk_bf16_f32 v138, v216, v217
  v_cvt_pk_bf16_f32 v139, v218, v219
  buffer_store_dwordx4 v[136:139], v11, s[4:7], s95 offen offset:0 sc1
  v_cvt_pk_bf16_f32 v140, v212, v213
  v_cvt_pk_bf16_f32 v141, v214, v215
  v_cvt_pk_bf16_f32 v142, v220, v221
  v_cvt_pk_bf16_f32 v143, v222, v223
  buffer_store_dwordx4 v[140:143], v11, s[4:7], s95 offen offset:512 sc1
  v_cvt_pk_bf16_f32 v144, v224, v225
  v_cvt_pk_bf16_f32 v145, v226, v227
  v_cvt_pk_bf16_f32 v146, v232, v233
  v_cvt_pk_bf16_f32 v147, v234, v235
  buffer_store_dwordx4 v[144:147], v11, s[4:7], s95 offen offset:2048 sc1
  v_cvt_pk_bf16_f32 v148, v228, v229
  v_cvt_pk_bf16_f32 v149, v230, v231
  v_cvt_pk_bf16_f32 v150, v236, v237
  v_cvt_pk_bf16_f32 v151, v238, v239
  buffer_store_dwordx4 v[148:151], v11, s[4:7], s95 offen offset:2560 sc1
  s_add_u32 s95, s95, 262144
  s_branch L_done
L_ata4:
  s_lshr_b32 s40, s36, 3
  s_lshl_b32 s40, s40, 9
  s_lshl_b32 s90, s33, 7
  s_add_u32 s40, s40, s90
  s_add_u32 s41, s36, 4
  s_cmp_lg_u32 s32, 0
  s_cbranch_scc1 L_dd_19
  v_mov_b32 v228, 0x3d00000
  v_mov_b32 v229, 0x3d01000
  v_mov_b32 v230, 0x3d02000
L_dw_18:
  buffer_load_dword v234, v230, s[4:7], s40 offen offset:0 sc1
  buffer_load_dword v235, v229, s[4:7], s40 offen offset:0 sc1
  buffer_load_dword v238, v228, s[4:7], 0 offen offset:0 sc1
  buffer_load_dword v239, v228, s[4:7], 0 offen offset:128 sc1
  s_waitcnt vmcnt(0)
  s_mov_b32 s44, 1
  v_readfirstlane_b32 s45, v234
  s_cmp_ge_u32 s45, 4
  s_cselect_b32 s44, s44, 0
  v_readfirstlane_b32 s45, v235
  s_cmp_ge_u32 s45, 32
  s_cselect_b32 s44, s44, 0
  v_readfirstlane_b32 s45, v238
  v_readfirstlane_b32 s47, v239
  s_cmp_ge_u32 s47, 128
  s_cselect_b32 s45, 64, s45
  s_cmp_ge_u32 s45, s41
  s_cselect_b32 s44, s44, 0
  s_cmp_eq_u32 s44, 1
  s_cbranch_scc1 L_dd_19
  s_sleep 6
  s_add_u32 s3, s3, 1
  s_cmp_lt_u32 s3, 131072
  s_cbranch_scc1 L_dw_18
L_dd_19:
  s_barrier
  s_mov_b32 s98, 4
  s_lshr_b32 s38, s36, 2
  s_lshl_b32 s38, s38, 7
  s_add_u32 s38, s38, 2048
  s_lshl_b32 s20, s36, 5
  s_lshl_b32 s90, s33, 3
  s_add_u32 s20, s20, s90
  s_lshl_b32 s90, s37, 2
  s_add_u32 s20, s20, s90
  s_add_u32 s20, s20, s32
  v_and_b32 v1, 63, v0
  s_lshl_b32 s90, s20, 13
  s_lshl_b32 s91, s20, 11
  v_mov_b32 v2, 0x0
  v_bfe_u32 v7, v1, 0, 6
  v_lshl_add_u32 v2, v7, 4, v2
  v_add_u32 v3, 4096, v2
  v_mov_b32 v4, 0x3000000
  v_bfe_u32 v7, v1, 0, 1
  v_lshl_add_u32 v4, v7, 4, v4
  v_bfe_u32 v7, v1, 2, 2
  v_lshl_add_u32 v4, v7, 5, v4
  v_bfe_u32 v7, v1, 4, 2
  v_lshl_add_u32 v4, v7, 7, v4
  v_add_u32 v5, 0x3400000, v2
  v_mov_b32 v8, 0x0
  v_bfe_u32 v7, v1, 0, 3
  v_lshl_add_u32 v8, v7, 4, v8
  v_bfe_u32 v7, v1, 3, 1
  v_lshl_add_u32 v8, v7, 11, v8
  v_bfe_u32 v7, v1, 4, 2
  v_lshl_add_u32 v8, v7, 8, v8
  v_add_u32 v9, 4096, v8
  v_mov_b32 v10, 0x0
  v_bfe_u32 v7, v1, 0, 4
  v_lshl_add_u32 v10, v7, 4, v10
  v_bfe_u32 v7, v1, 4, 1
  v_lshl_add_u32 v10, v7, 8, v10
  v_bfe_u32 v7, v1, 5, 1
  v_lshl_add_u32 v10, v7, 10, v10
  v_add_u32 v11, 4096, v10
  s_add_u32 s92, s90, 16777216
  s_add_u32 s93, s90, 33554432
  s_add_u32 s94, s90, 0
  s_add_u32 s95, s90, 83886080
  buffer_load_dwordx4 v[16:19], v2, s[4:7], s94 offen offset:0 sc1
  buffer_load_dwordx4 v[20:23], v2, s[4:7], s94 offen offset:1024 sc1
  buffer_load_dwordx4 v[24:27], v2, s[4:7], s94 offen offset:2048 sc1
  buffer_load_dwordx4 v[28:31], v2, s[4:7], s94 offen offset:3072 sc1
  buffer_load_dwordx4 v[32:35], v3, s[4:7], s94 offen offset:0 sc1
  buffer_load_dwordx4 v[36:39], v3, s[4:7], s94 offen offset:1024 sc1
  buffer_load_dwordx4 v[40:43], v3, s[4:7], s94 offen offset:2048 sc1
  buffer_load_dwordx4 v[44:47], v3, s[4:7], s94 offen offset:3072 sc1
  buffer_load_dwordx4 v[48:51], v2, s[4:7], s92 offen offset:0 sc1
  buffer_load_dwordx4 v[52:55], v2, s[4:7], s92 offen offset:1024 sc1
  buffer_load_dwordx4 v[56:59], v2, s[4:7], s92 offen offset:2048 sc1
  buffer_load_dwordx4 v[60:63], v2, s[4:7], s92 offen offset:3072 sc1
  buffer_load_dwordx4 v[64:67], v3, s[4:7], s92 offen offset:0 sc1
  buffer_load_dwordx4 v[68:71], v3, s[4:7], s92 offen offset:1024 sc1
  buffer_load_dwordx4 v[72:75], v3, s[4:7], s92 offen offset:2048 sc1
  buffer_load_dwordx4 v[76:79], v3, s[4:7], s92 offen offset:3072 sc1
  buffer_load_dwordx4 v[80:83], v8, s[4:7], s93 offen offset:0 sc1
  buffer_load_dwordx4 v[84:87], v8, s[4:7], s93 offen offset:128 sc1
  buffer_load_dwordx4 v[88:91], v8, s[4:7], s93 offen offset:1024 sc1
  buffer_load_dwordx4 v[92:95], v8, s[4:7], s93 offen offset:1152 sc1
  buffer_load_dwordx4 v[96:99], v9, s[4:7], s93 offen offset:0 sc1
  buffer_load_dwordx4 v[100:103], v9, s[4:7], s93 offen offset:128 sc1
  buffer_load_dwordx4 v[104:107], v9, s[4:7], s93 offen offset:1024 sc1
  buffer_load_dwordx4 v[108:111], v9, s[4:7], s93 offen offset:1152 sc1
  buffer_load_dwordx4 v[112:115], v4, s[4:7], s91 offen offset:0 sc1
  buffer_load_dwordx4 v[116:119], v4, s[4:7], s91 offen offset:512 sc1
  buffer_load_dwordx4 v[120:123], v4, s[4:7], s91 offen offset:1024 sc1
  buffer_load_dwordx4 v[124:127], v4, s[4:7], s91 offen offset:1536 sc1
  buffer_load_dwordx4 v[128:131], v5, s[4:7], s91 offen offset:0 sc1
  buffer_load_dwordx4 v[132:135], v5, s[4:7], s91 offen offset:1024 sc1
  s_add_u32 s92, s92, 262144
  s_add_u32 s93, s93, 262144
  s_add_u32 s94, s94, 262144
  s_add_u32 s91, s91, 65536
  buffer_load_dwordx4 a[0:3], v2, s[4:7], s94 offen offset:0 sc1
  buffer_load_dwordx4 a[4:7], v2, s[4:7], s94 offen offset:1024 sc1
  buffer_load_dwordx4 a[8:11], v2, s[4:7], s94 offen offset:2048 sc1
  buffer_load_dwordx4 a[12:15], v2, s[4:7], s94 offen offset:3072 sc1
  buffer_load_dwordx4 a[16:19], v3, s[4:7], s94 offen offset:0 sc1
  buffer_load_dwordx4 a[20:23], v3, s[4:7], s94 offen offset:1024 sc1
  buffer_load_dwordx4 a[24:27], v3, s[4:7], s94 offen offset:2048 sc1
  buffer_load_dwordx4 a[28:31], v3, s[4:7], s94 offen offset:3072 sc1
  buffer_load_dwordx4 a[32:35], v2, s[4:7], s92 offen offset:0 sc1
  buffer_load_dwordx4 a[36:39], v2, s[4:7], s92 offen offset:1024 sc1
  buffer_load_dwordx4 a[40:43], v2, s[4:7], s92 offen offset:2048 sc1
  buffer_load_dwordx4 a[44:47], v2, s[4:7], s92 offen offset:3072 sc1
  buffer_load_dwordx4 a[48:51], v3, s[4:7], s92 offen offset:0 sc1
  buffer_load_dwordx4 a[52:55], v3, s[4:7], s92 offen offset:1024 sc1
  buffer_load_dwordx4 a[56:59], v3, s[4:7], s92 offen offset:2048 sc1
  buffer_load_dwordx4 a[60:63], v3, s[4:7], s92 offen offset:3072 sc1
  buffer_load_dwordx4 a[64:67], v8, s[4:7], s93 offen offset:0 sc1
  buffer_load_dwordx4 a[68:71], v8, s[4:7], s93 offen offset:128 sc1
  buffer_load_dwordx4 a[72:75], v8, s[4:7], s93 offen offset:1024 sc1
  buffer_load_dwordx4 a[76:79], v8, s[4:7], s93 offen offset:1152 sc1
  buffer_load_dwordx4 a[80:83], v9, s[4:7], s93 offen offset:0 sc1
  buffer_load_dwordx4 a[84:87], v9, s[4:7], s93 offen offset:128 sc1
  buffer_load_dwordx4 a[88:91], v9, s[4:7], s93 offen offset:1024 sc1
  buffer_load_dwordx4 a[92:95], v9, s[4:7], s93 offen offset:1152 sc1
  buffer_load_dwordx4 a[96:99], v4, s[4:7], s91 offen offset:0 sc1
  buffer_load_dwordx4 a[100:103], v4, s[4:7], s91 offen offset:512 sc1
  buffer_load_dwordx4 a[104:107], v4, s[4:7], s91 offen offset:1024 sc1
  buffer_load_dwordx4 a[108:111], v4, s[4:7], s91 offen offset:1536 sc1
  buffer_load_dwordx4 a[112:115], v5, s[4:7], s91 offen offset:0 sc1
  buffer_load_dwordx4 a[116:119], v5, s[4:7], s91 offen offset:1024 sc1
  s_add_u32 s92, s92, 262144
  s_add_u32 s93, s93, 262144
  s_add_u32 s94, s94, 262144
  s_add_u32 s91, s91, 65536
  s_mov_b32 s40, 0xfff0ffff
  s_mov_b32 s41, 0xf000ff00
  s_mov_b32 s42, 0xffe0fffe
  s_mov_b32 s43, 0xe000fe00
  s_mov_b32 s44, 0xffc0fffc
  s_mov_b32 s45, 0xc000fc00
  s_mov_b32 s46, 0xff80fff8
  s_mov_b32 s47, 0x8000f800
  s_mov_b32 s50, 0x3e0293ee
  v_mov_b32 v6, 0xd028965f
  s_waitcnt vmcnt(30)
  v_mfma_f32_16x16x32_bf16 v[136:139], v[112:115], v[16:19], 0
  v_mfma_f32_16x16x32_bf16 v[140:143], v[48:51], v[16:19], 0
  v_mfma_f32_16x16x32_bf16 v[144:147], v[112:115], v[32:35], 0
  v_mfma_f32_16x16x32_bf16 v[148:151], v[48:51], v[32:35], 0
  v_mfma_f32_16x16x32_bf16 v[152:155], v[64:67], v[32:35], 0
  v_mfma_f32_16x16x32_bf16 v[136:139], v[116:119], v[20:23], v[136:139]
  v_mfma_f32_16x16x32_bf16 v[140:143], v[52:55], v[20:23], v[140:143]
  v_mfma_f32_16x16x32_bf16 v[144:147], v[116:119], v[36:39], v[144:147]
  v_mfma_f32_16x16x32_bf16 v[148:151], v[52:55], v[36:39], v[148:151]
  v_mfma_f32_16x16x32_bf16 v[152:155], v[68:71], v[36:39], v[152:155]
  v_mfma_f32_16x16x32_bf16 v[136:139], v[120:123], v[24:27], v[136:139]
  v_mfma_f32_16x16x32_bf16 v[140:143], v[56:59], v[24:27], v[140:143]
  v_mfma_f32_16x16x32_bf16 v[144:147], v[120:123], v[40:43], v[144:147]
  v_mfma_f32_16x16x32_bf16 v[148:151], v[56:59], v[40:43], v[148:151]
  v_mfma_f32_16x16x32_bf16 v[152:155], v[72:75], v[40:43], v[152:155]
  v_mfma_f32_16x16x32_bf16 v[136:139], v[124:127], v[28:31], v[136:139]
  v_mfma_f32_16x16x32_bf16 v[140:143], v[60:63], v[28:31], v[140:143]
  v_mfma_f32_16x16x32_bf16 v[144:147], v[124:127], v[44:47], v[144:147]
  v_mfma_f32_16x16x32_bf16 v[148:151], v[60:63], v[44:47], v[148:151]
  v_mfma_f32_16x16x32_bf16 v[152:155], v[76:79], v[44:47], v[152:155]
  s_nop 4
  v_cndmask_b32 v140, v6, v140, s[40:41]
  v_cndmask_b32 v141, v6, v141, s[42:43]
  v_cndmask_b32 v142, v6, v142, s[44:45]
  v_cndmask_b32 v143, v6, v143, s[46:47]
  v_max3_f32 v12, v136, v137, v140
  v_max3_f32 v12, v12, v141, v142
  v_max_f32 v12, v12, v143
  v_mov_b32 v13, v12
  s_nop 1
  v_permlane32_swap_b32 v12, v13
  v_max_f32 v12, v12, v13
  v_mov_b32 v13, v12
  s_nop 1
  v_permlane16_swap_b32 v12, v13
  v_max_f32 v12, v12, v13
  v_mul_f32 v12, s50, v12
  v_fma_f32 v136, v136, s50, -v12
  v_fma_f32 v137, v137, s50, -v12
  v_fma_f32 v140, v140, s50, -v12
  v_fma_f32 v141, v141, s50, -v12
  v_fma_f32 v142, v142, s50, -v12
  v_fma_f32 v143, v143, s50, -v12
  v_exp_f32 v136, v136
  v_exp_f32 v137, v137
  v_exp_f32 v140, v140
  v_exp_f32 v141, v141
  v_exp_f32 v142, v142
  v_exp_f32 v143, v143
  v_add_f32 v12, v136, v137
  v_add_f32 v12, v12, v140
  v_add_f32 v12, v12, v141
  v_add_f32 v12, v12, v142
  v_add_f32 v12, v12, v143
  v_mov_b32 v13, v12
  s_nop 1
  v_permlane32_swap_b32 v12, v13
  v_add_f32 v12, v12, v13
  v_mov_b32 v13, v12
  s_nop 1
  v_permlane16_swap_b32 v12, v13
  v_add_f32 v12, v12, v13
  v_rcp_f32 v12, v12
  s_nop 0
  v_mul_f32 v136, v136, v12
  v_mul_f32 v137, v137, v12
  v_mul_f32 v140, v140, v12
  v_mul_f32 v141, v141, v12
  v_mul_f32 v142, v142, v12
  v_mul_f32 v143, v143, v12
  v_cvt_pk_bf16_f32 v160, v136, v137
  v_mov_b32 v161, 0
  v_mov_b32 v162, 0
  v_mov_b32 v163, v160
  v_cvt_pk_bf16_f32 v156, v140, v141
  v_cvt_pk_bf16_f32 v157, v142, v143
  v_mov_b32 v158, 0
  v_mov_b32 v159, 0
  v_cndmask_b32 v152, v6, v152, s[40:41]
  v_cndmask_b32 v153, v6, v153, s[42:43]
  v_cndmask_b32 v154, v6, v154, s[44:45]
  v_cndmask_b32 v155, v6, v155, s[46:47]
  v_max3_f32 v12, v144, v145, v148
  v_max3_f32 v12, v12, v149, v150
  v_max3_f32 v12, v12, v151, v152
  v_max3_f32 v12, v12, v153, v154
  v_max_f32 v12, v12, v155
  v_mov_b32 v13, v12
  s_nop 1
  v_permlane32_swap_b32 v12, v13
  v_max_f32 v12, v12, v13
  v_mov_b32 v13, v12
  s_nop 1
  v_permlane16_swap_b32 v12, v13
  v_max_f32 v12, v12, v13
  v_mul_f32 v12, s50, v12
  v_fma_f32 v144, v144, s50, -v12
  v_fma_f32 v145, v145, s50, -v12
  v_fma_f32 v148, v148, s50, -v12
  v_fma_f32 v149, v149, s50, -v12
  v_fma_f32 v150, v150, s50, -v12
  v_fma_f32 v151, v151, s50, -v12
  v_fma_f32 v152, v152, s50, -v12
  v_fma_f32 v153, v153, s50, -v12
  v_fma_f32 v154, v154, s50, -v12
  v_fma_f32 v155, v155, s50, -v12
  v_exp_f32 v144, v144
  v_exp_f32 v145, v145
  v_exp_f32 v148, v148
  v_exp_f32 v149, v149
  v_exp_f32 v150, v150
  v_exp_f32 v151, v151
  v_exp_f32 v152, v152
  v_exp_f32 v153, v153
  v_exp_f32 v154, v154
  v_exp_f32 v155, v155
  v_add_f32 v12, v144, v145
  v_add_f32 v12, v12, v148
  v_add_f32 v12, v12, v149
  v_add_f32 v12, v12, v150
  v_add_f32 v12, v12, v151
  v_add_f32 v12, v12, v152
  v_add_f32 v12, v12, v153
  v_add_f32 v12, v12, v154
  v_add_f32 v12, v12, v155
  v_mov_b32 v13, v12
  s_nop 1
  v_permlane32_swap_b32 v12, v13
  v_add_f32 v12, v12, v13
  v_mov_b32 v13, v12
  s_nop 1
  v_permlane16_swap_b32 v12, v13
  v_add_f32 v12, v12, v13
  v_rcp_f32 v12, v12
  s_nop 0
  v_mul_f32 v144, v144, v12
  v_mul_f32 v145, v145, v12
  v_mul_f32 v148, v148, v12
  v_mul_f32 v149, v149, v12
  v_mul_f32 v150, v150, v12
  v_mul_f32 v151, v151, v12
  v_mul_f32 v152, v152, v12
  v_mul_f32 v153, v153, v12
  v_mul_f32 v154, v154, v12
  v_mul_f32 v155, v155, v12
  v_cvt_pk_bf16_f32 v168, v144, v145
  v_mov_b32 v169, 0
  v_mov_b32 v170, 0
  v_mov_b32 v171, v168
  v_cvt_pk_bf16_f32 v164, v148, v149
  v_cvt_pk_bf16_f32 v165, v150, v151
  v_cvt_pk_bf16_f32 v166, v152, v153
  v_cvt_pk_bf16_f32 v167, v154, v155
  v_mfma_f32_16x16x32_bf16 v[176:179], v[80:83], v[156:159], 0
  v_mfma_f32_16x16x32_bf16 v[180:183], v[84:87], v[156:159], 0
  v_mfma_f32_16x16x32_bf16 v[184:187], v[88:91], v[156:159], 0
  v_mfma_f32_16x16x32_bf16 v[188:191], v[92:95], v[156:159], 0
  v_mfma_f32_16x16x32_bf16 v[192:195], v[96:99], v[156:159], 0
  v_mfma_f32_16x16x32_bf16 v[196:199], v[100:103], v[156:159], 0
  v_mfma_f32_16x16x32_bf16 v[200:203], v[104:107], v[156:159], 0
  v_mfma_f32_16x16x32_bf16 v[204:207], v[108:111], v[156:159], 0
  v_mfma_f32_16x16x16_bf16 v[176:179], v[128:129], v[160:161], v[176:179]
  v_mfma_f32_16x16x16_bf16 v[180:183], v[128:129], v[162:163], v[180:183]
  v_mfma_f32_16x16x16_bf16 v[184:187], v[130:131], v[160:161], v[184:187]
  v_mfma_f32_16x16x16_bf16 v[188:191], v[130:131], v[162:163], v[188:191]
  v_mfma_f32_16x16x16_bf16 v[192:195], v[132:133], v[160:161], v[192:195]
  v_mfma_f32_16x16x16_bf16 v[196:199], v[132:133], v[162:163], v[196:199]
  v_mfma_f32_16x16x16_bf16 v[200:203], v[134:135], v[160:161], v[200:203]
  v_mfma_f32_16x16x16_bf16 v[204:207], v[134:135], v[162:163], v[204:207]
  v_mfma_f32_16x16x32_bf16 v[208:211], v[80:83], v[164:167], 0
  v_mfma_f32_16x16x32_bf16 v[212:215], v[84:87], v[164:167], 0
  v_mfma_f32_16x16x32_bf16 v[216:219], v[88:91], v[164:167], 0
  v_mfma_f32_16x16x32_bf16 v[220:223], v[92:95], v[164:167], 0
  v_mfma_f32_16x16x32_bf16 v[224:227], v[96:99], v[164:167], 0
  v_mfma_f32_16x16x32_bf16 v[228:231], v[100:103], v[164:167], 0
  v_mfma_f32_16x16x32_bf16 v[232:235], v[104:107], v[164:167], 0
  v_mfma_f32_16x16x32_bf16 v[236:239], v[108:111], v[164:167], 0
  v_mfma_f32_16x16x16_bf16 v[208:211], v[128:129], v[168:169], v[208:211]
  v_mfma_f32_16x16x16_bf16 v[212:215], v[128:129], v[170:171], v[212:215]
  v_mfma_f32_16x16x16_bf16 v[216:219], v[130:131], v[168:169], v[216:219]
  v_mfma_f32_16x16x16_bf16 v[220:223], v[130:131], v[170:171], v[220:223]
  v_mfma_f32_16x16x16_bf16 v[224:227], v[132:133], v[168:169], v[224:227]
  v_mfma_f32_16x16x16_bf16 v[228:231], v[132:133], v[170:171], v[228:231]
  v_mfma_f32_16x16x16_bf16 v[232:235], v[134:135], v[168:169], v[232:235]
  v_mfma_f32_16x16x16_bf16 v[236:239], v[134:135], v[170:171], v[236:239]
  buffer_load_dwordx4 v[16:19], v2, s[4:7], s94 offen offset:0 sc1
  buffer_load_dwordx4 v[20:23], v2, s[4:7], s94 offen offset:1024 sc1
  buffer_load_dwordx4 v[24:27], v2, s[4:7], s94 offen offset:2048 sc1
  buffer_load_dwordx4 v[28:31], v2, s[4:7], s94 offen offset:3072 sc1
  buffer_load_dwordx4 v[32:35], v3, s[4:7], s94 offen offset:0 sc1
  buffer_load_dwordx4 v[36:39], v3, s[4:7], s94 offen offset:1024 sc1
  buffer_load_dwordx4 v[40:43], v3, s[4:7], s94 offen offset:2048 sc1
  buffer_load_dwordx4 v[44:47], v3, s[4:7], s94 offen offset:3072 sc1
  buffer_load_dwordx4 v[48:51], v2, s[4:7], s92 offen offset:0 sc1
  buffer_load_dwordx4 v[52:55], v2, s[4:7], s92 offen offset:1024 sc1
  buffer_load_dwordx4 v[56:59], v2, s[4:7], s92 offen offset:2048 sc1
  buffer_load_dwordx4 v[60:63], v2, s[4:7], s92 offen offset:3072 sc1
  buffer_load_dwordx4 v[64:67], v3, s[4:7], s92 offen offset:0 sc1
  buffer_load_dwordx4 v[68:71], v3, s[4:7], s92 offen offset:1024 sc1
  buffer_load_dwordx4 v[72:75], v3, s[4:7], s92 offen offset:2048 sc1
  buffer_load_dwordx4 v[76:79], v3, s[4:7], s92 offen offset:3072 sc1
  buffer_load_dwordx4 v[80:83], v8, s[4:7], s93 offen offset:0 sc1
  buffer_load_dwordx4 v[84:87], v8, s[4:7], s93 offen offset:128 sc1
  buffer_load_dwordx4 v[88:91], v8, s[4:7], s93 offen offset:1024 sc1
  buffer_load_dwordx4 v[92:95], v8, s[4:7], s93 offen offset:1152 sc1
  buffer_load_dwordx4 v[96:99], v9, s[4:7], s93 offen offset:0 sc1
  buffer_load_dwordx4 v[100:103], v9, s[4:7], s93 offen offset:128 sc1
  buffer_load_dwordx4 v[104:107], v9, s[4:7], s93 offen offset:1024 sc1
  buffer_load_dwordx4 v[108:111], v9, s[4:7], s93 offen offset:1152 sc1
  buffer_load_dwordx4 v[112:115], v4, s[4:7], s91 offen offset:0 sc1
  buffer_load_dwordx4 v[116:119], v4, s[4:7], s91 offen offset:512 sc1
  buffer_load_dwordx4 v[120:123], v4, s[4:7], s91 offen offset:1024 sc1
  buffer_load_dwordx4 v[124:127], v4, s[4:7], s91 offen offset:1536 sc1
  buffer_load_dwordx4 v[128:131], v5, s[4:7], s91 offen offset:0 sc1
  buffer_load_dwordx4 v[132:135], v5, s[4:7], s91 offen offset:1024 sc1
  s_add_u32 s92, s92, 262144
  s_add_u32 s93, s93, 262144
  s_add_u32 s94, s94, 262144
  s_add_u32 s91, s91, 65536
  v_cvt_pk_bf16_f32 v136, v176, v177
  v_cvt_pk_bf16_f32 v137, v178, v179
  v_cvt_pk_bf16_f32 v138, v184, v185
  v_cvt_pk_bf16_f32 v139, v186, v187
  buffer_store_dwordx4 v[136:139], v10, s[4:7], s95 offen offset:0 sc1
  v_cvt_pk_bf16_f32 v140, v180, v181
  v_cvt_pk_bf16_f32 v141, v182, v183
  v_cvt_pk_bf16_f32 v142, v188, v189
  v_cvt_pk_bf16_f32 v143, v190, v191
  buffer_store_dwordx4 v[140:143], v10, s[4:7], s95 offen offset:512 sc1
  v_cvt_pk_bf16_f32 v144, v192, v193
  v_cvt_pk_bf16_f32 v145, v194, v195
  v_cvt_pk_bf16_f32 v146, v200, v201
  v_cvt_pk_bf16_f32 v147, v202, v203
  buffer_store_dwordx4 v[144:147], v10, s[4:7], s95 offen offset:2048 sc1
  v_cvt_pk_bf16_f32 v148, v196, v197
  v_cvt_pk_bf16_f32 v149, v198, v199
  v_cvt_pk_bf16_f32 v150, v204, v205
  v_cvt_pk_bf16_f32 v151, v206, v207
  buffer_store_dwordx4 v[148:151], v10, s[4:7], s95 offen offset:2560 sc1
  v_cvt_pk_bf16_f32 v136, v208, v209
  v_cvt_pk_bf16_f32 v137, v210, v211
  v_cvt_pk_bf16_f32 v138, v216, v217
  v_cvt_pk_bf16_f32 v139, v218, v219
  buffer_store_dwordx4 v[136:139], v11, s[4:7], s95 offen offset:0 sc1
  v_cvt_pk_bf16_f32 v140, v212, v213
  v_cvt_pk_bf16_f32 v141, v214, v215
  v_cvt_pk_bf16_f32 v142, v220, v221
  v_cvt_pk_bf16_f32 v143, v222, v223
  buffer_store_dwordx4 v[140:143], v11, s[4:7], s95 offen offset:512 sc1
  v_cvt_pk_bf16_f32 v144, v224, v225
  v_cvt_pk_bf16_f32 v145, v226, v227
  v_cvt_pk_bf16_f32 v146, v232, v233
  v_cvt_pk_bf16_f32 v147, v234, v235
  buffer_store_dwordx4 v[144:147], v11, s[4:7], s95 offen offset:2048 sc1
  v_cvt_pk_bf16_f32 v148, v228, v229
  v_cvt_pk_bf16_f32 v149, v230, v231
  v_cvt_pk_bf16_f32 v150, v236, v237
  v_cvt_pk_bf16_f32 v151, v238, v239
  buffer_store_dwordx4 v[148:151], v11, s[4:7], s95 offen offset:2560 sc1
  s_add_u32 s95, s95, 262144
  s_waitcnt vmcnt(38)
  v_mfma_f32_16x16x32_bf16 v[136:139], a[96:99], a[0:3], 0
  v_mfma_f32_16x16x32_bf16 v[140:143], a[32:35], a[0:3], 0
  v_mfma_f32_16x16x32_bf16 v[144:147], a[96:99], a[16:19], 0
  v_mfma_f32_16x16x32_bf16 v[148:151], a[32:35], a[16:19], 0
  v_mfma_f32_16x16x32_bf16 v[152:155], a[48:51], a[16:19], 0
  v_mfma_f32_16x16x32_bf16 v[136:139], a[100:103], a[4:7], v[136:139]
  v_mfma_f32_16x16x32_bf16 v[140:143], a[36:39], a[4:7], v[140:143]
  v_mfma_f32_16x16x32_bf16 v[144:147], a[100:103], a[20:23], v[144:147]
  v_mfma_f32_16x16x32_bf16 v[148:151], a[36:39], a[20:23], v[148:151]
  v_mfma_f32_16x16x32_bf16 v[152:155], a[52:55], a[20:23], v[152:155]
  v_mfma_f32_16x16x32_bf16 v[136:139], a[104:107], a[8:11], v[136:139]
  v_mfma_f32_16x16x32_bf16 v[140:143], a[40:43], a[8:11], v[140:143]
  v_mfma_f32_16x16x32_bf16 v[144:147], a[104:107], a[24:27], v[144:147]
  v_mfma_f32_16x16x32_bf16 v[148:151], a[40:43], a[24:27], v[148:151]
  v_mfma_f32_16x16x32_bf16 v[152:155], a[56:59], a[24:27], v[152:155]
  v_mfma_f32_16x16x32_bf16 v[136:139], a[108:111], a[12:15], v[136:139]
  v_mfma_f32_16x16x32_bf16 v[140:143], a[44:47], a[12:15], v[140:143]
  v_mfma_f32_16x16x32_bf16 v[144:147], a[108:111], a[28:31], v[144:147]
  v_mfma_f32_16x16x32_bf16 v[148:151], a[44:47], a[28:31], v[148:151]
  v_mfma_f32_16x16x32_bf16 v[152:155], a[60:63], a[28:31], v[152:155]
  s_nop 4
  v_cndmask_b32 v140, v6, v140, s[40:41]
  v_cndmask_b32 v141, v6, v141, s[42:43]
  v_cndmask_b32 v142, v6, v142, s[44:45]
  v_cndmask_b32 v143, v6, v143, s[46:47]
  v_max3_f32 v12, v136, v137, v140
  v_max3_f32 v12, v12, v141, v142
  v_max_f32 v12, v12, v143
  v_mov_b32 v13, v12
  s_nop 1
  v_permlane32_swap_b32 v12, v13
  v_max_f32 v12, v12, v13
  v_mov_b32 v13, v12
  s_nop 1
  v_permlane16_swap_b32 v12, v13
  v_max_f32 v12, v12, v13
  v_mul_f32 v12, s50, v12
  v_fma_f32 v136, v136, s50, -v12
  v_fma_f32 v137, v137, s50, -v12
  v_fma_f32 v140, v140, s50, -v12
  v_fma_f32 v141, v141, s50, -v12
  v_fma_f32 v142, v142, s50, -v12
  v_fma_f32 v143, v143, s50, -v12
  v_exp_f32 v136, v136
  v_exp_f32 v137, v137
  v_exp_f32 v140, v140
  v_exp_f32 v141, v141
  v_exp_f32 v142, v142
  v_exp_f32 v143, v143
  v_add_f32 v12, v136, v137
  v_add_f32 v12, v12, v140
  v_add_f32 v12, v12, v141
  v_add_f32 v12, v12, v142
  v_add_f32 v12, v12, v143
  v_mov_b32 v13, v12
  s_nop 1
  v_permlane32_swap_b32 v12, v13
  v_add_f32 v12, v12, v13
  v_mov_b32 v13, v12
  s_nop 1
  v_permlane16_swap_b32 v12, v13
  v_add_f32 v12, v12, v13
  v_rcp_f32 v12, v12
  s_nop 0
  v_mul_f32 v136, v136, v12
  v_mul_f32 v137, v137, v12
  v_mul_f32 v140, v140, v12
  v_mul_f32 v141, v141, v12
  v_mul_f32 v142, v142, v12
  v_mul_f32 v143, v143, v12
  v_cvt_pk_bf16_f32 v160, v136, v137
  v_mov_b32 v161, 0
  v_mov_b32 v162, 0
  v_mov_b32 v163, v160
  v_cvt_pk_bf16_f32 v156, v140, v141
  v_cvt_pk_bf16_f32 v157, v142, v143
  v_mov_b32 v158, 0
  v_mov_b32 v159, 0
  v_cndmask_b32 v152, v6, v152, s[40:41]
  v_cndmask_b32 v153, v6, v153, s[42:43]
  v_cndmask_b32 v154, v6, v154, s[44:45]
  v_cndmask_b32 v155, v6, v155, s[46:47]
  v_max3_f32 v12, v144, v145, v148
  v_max3_f32 v12, v12, v149, v150
  v_max3_f32 v12, v12, v151, v152
  v_max3_f32 v12, v12, v153, v154
  v_max_f32 v12, v12, v155
  v_mov_b32 v13, v12
  s_nop 1
  v_permlane32_swap_b32 v12, v13
  v_max_f32 v12, v12, v13
  v_mov_b32 v13, v12
  s_nop 1
  v_permlane16_swap_b32 v12, v13
  v_max_f32 v12, v12, v13
  v_mul_f32 v12, s50, v12
  v_fma_f32 v144, v144, s50, -v12
  v_fma_f32 v145, v145, s50, -v12
  v_fma_f32 v148, v148, s50, -v12
  v_fma_f32 v149, v149, s50, -v12
  v_fma_f32 v150, v150, s50, -v12
  v_fma_f32 v151, v151, s50, -v12
  v_fma_f32 v152, v152, s50, -v12
  v_fma_f32 v153, v153, s50, -v12
  v_fma_f32 v154, v154, s50, -v12
  v_fma_f32 v155, v155, s50, -v12
  v_exp_f32 v144, v144
  v_exp_f32 v145, v145
  v_exp_f32 v148, v148
  v_exp_f32 v149, v149
  v_exp_f32 v150, v150
  v_exp_f32 v151, v151
  v_exp_f32 v152, v152
  v_exp_f32 v153, v153
  v_exp_f32 v154, v154
  v_exp_f32 v155, v155
  v_add_f32 v12, v144, v145
  v_add_f32 v12, v12, v148
  v_add_f32 v12, v12, v149
  v_add_f32 v12, v12, v150
  v_add_f32 v12, v12, v151
  v_add_f32 v12, v12, v152
  v_add_f32 v12, v12, v153
  v_add_f32 v12, v12, v154
  v_add_f32 v12, v12, v155
  v_mov_b32 v13, v12
  s_nop 1
  v_permlane32_swap_b32 v12, v13
  v_add_f32 v12, v12, v13
  v_mov_b32 v13, v12
  s_nop 1
  v_permlane16_swap_b32 v12, v13
  v_add_f32 v12, v12, v13
  v_rcp_f32 v12, v12
  s_nop 0
  v_mul_f32 v144, v144, v12
  v_mul_f32 v145, v145, v12
  v_mul_f32 v148, v148, v12
  v_mul_f32 v149, v149, v12
  v_mul_f32 v150, v150, v12
  v_mul_f32 v151, v151, v12
  v_mul_f32 v152, v152, v12
  v_mul_f32 v153, v153, v12
  v_mul_f32 v154, v154, v12
  v_mul_f32 v155, v155, v12
  v_cvt_pk_bf16_f32 v168, v144, v145
  v_mov_b32 v169, 0
  v_mov_b32 v170, 0
  v_mov_b32 v171, v168
  v_cvt_pk_bf16_f32 v164, v148, v149
  v_cvt_pk_bf16_f32 v165, v150, v151
  v_cvt_pk_bf16_f32 v166, v152, v153
  v_cvt_pk_bf16_f32 v167, v154, v155
  v_mfma_f32_16x16x32_bf16 v[176:179], a[64:67], v[156:159], 0
  v_mfma_f32_16x16x32_bf16 v[180:183], a[68:71], v[156:159], 0
  v_mfma_f32_16x16x32_bf16 v[184:187], a[72:75], v[156:159], 0
  v_mfma_f32_16x16x32_bf16 v[188:191], a[76:79], v[156:159], 0
  v_mfma_f32_16x16x32_bf16 v[192:195], a[80:83], v[156:159], 0
  v_mfma_f32_16x16x32_bf16 v[196:199], a[84:87], v[156:159], 0
  v_mfma_f32_16x16x32_bf16 v[200:203], a[88:91], v[156:159], 0
  v_mfma_f32_16x16x32_bf16 v[204:207], a[92:95], v[156:159], 0
  v_mfma_f32_16x16x16_bf16 v[176:179], a[112:113], v[160:161], v[176:179]
  v_mfma_f32_16x16x16_bf16 v[180:183], a[112:113], v[162:163], v[180:183]
  v_mfma_f32_16x16x16_bf16 v[184:187], a[114:115], v[160:161], v[184:187]
  v_mfma_f32_16x16x16_bf16 v[188:191], a[114:115], v[162:163], v[188:191]
  v_mfma_f32_16x16x16_bf16 v[192:195], a[116:117], v[160:161], v[192:195]
  v_mfma_f32_16x16x16_bf16 v[196:199], a[116:117], v[162:163], v[196:199]
  v_mfma_f32_16x16x16_bf16 v[200:203], a[118:119], v[160:161], v[200:203]
  v_mfma_f32_16x16x16_bf16 v[204:207], a[118:119], v[162:163], v[204:207]
  v_mfma_f32_16x16x32_bf16 v[208:211], a[64:67], v[164:167], 0
  v_mfma_f32_16x16x32_bf16 v[212:215], a[68:71], v[164:167], 0
  v_mfma_f32_16x16x32_bf16 v[216:219], a[72:75], v[164:167], 0
  v_mfma_f32_16x16x32_bf16 v[220:223], a[76:79], v[164:167], 0
  v_mfma_f32_16x16x32_bf16 v[224:227], a[80:83], v[164:167], 0
  v_mfma_f32_16x16x32_bf16 v[228:231], a[84:87], v[164:167], 0
  v_mfma_f32_16x16x32_bf16 v[232:235], a[88:91], v[164:167], 0
  v_mfma_f32_16x16x32_bf16 v[236:239], a[92:95], v[164:167], 0
  v_mfma_f32_16x16x16_bf16 v[208:211], a[112:113], v[168:169], v[208:211]
  v_mfma_f32_16x16x16_bf16 v[212:215], a[112:113], v[170:171], v[212:215]
  v_mfma_f32_16x16x16_bf16 v[216:219], a[114:115], v[168:169], v[216:219]
  v_mfma_f32_16x16x16_bf16 v[220:223], a[114:115], v[170:171], v[220:223]
  v_mfma_f32_16x16x16_bf16 v[224:227], a[116:117], v[168:169], v[224:227]
  v_mfma_f32_16x16x16_bf16 v[228:231], a[116:117], v[170:171], v[228:231]
  v_mfma_f32_16x16x16_bf16 v[232:235], a[118:119], v[168:169], v[232:235]
  v_mfma_f32_16x16x16_bf16 v[236:239], a[118:119], v[170:171], v[236:239]
  buffer_load_dwordx4 a[0:3], v2, s[4:7], s94 offen offset:0 sc1
  buffer_load_dwordx4 a[4:7], v2, s[4:7], s94 offen offset:1024 sc1
  buffer_load_dwordx4 a[8:11], v2, s[4:7], s94 offen offset:2048 sc1
  buffer_load_dwordx4 a[12:15], v2, s[4:7], s94 offen offset:3072 sc1
  buffer_load_dwordx4 a[16:19], v3, s[4:7], s94 offen offset:0 sc1
  buffer_load_dwordx4 a[20:23], v3, s[4:7], s94 offen offset:1024 sc1
  buffer_load_dwordx4 a[24:27], v3, s[4:7], s94 offen offset:2048 sc1
  buffer_load_dwordx4 a[28:31], v3, s[4:7], s94 offen offset:3072 sc1
  buffer_load_dwordx4 a[32:35], v2, s[4:7], s92 offen offset:0 sc1
  buffer_load_dwordx4 a[36:39], v2, s[4:7], s92 offen offset:1024 sc1
  buffer_load_dwordx4 a[40:43], v2, s[4:7], s92 offen offset:2048 sc1
  buffer_load_dwordx4 a[44:47], v2, s[4:7], s92 offen offset:3072 sc1
  buffer_load_dwordx4 a[48:51], v3, s[4:7], s92 offen offset:0 sc1
  buffer_load_dwordx4 a[52:55], v3, s[4:7], s92 offen offset:1024 sc1
  buffer_load_dwordx4 a[56:59], v3, s[4:7], s92 offen offset:2048 sc1
  buffer_load_dwordx4 a[60:63], v3, s[4:7], s92 offen offset:3072 sc1
  buffer_load_dwordx4 a[64:67], v8, s[4:7], s93 offen offset:0 sc1
  buffer_load_dwordx4 a[68:71], v8, s[4:7], s93 offen offset:128 sc1
  buffer_load_dwordx4 a[72:75], v8, s[4:7], s93 offen offset:1024 sc1
  buffer_load_dwordx4 a[76:79], v8, s[4:7], s93 offen offset:1152 sc1
  buffer_load_dwordx4 a[80:83], v9, s[4:7], s93 offen offset:0 sc1
  buffer_load_dwordx4 a[84:87], v9, s[4:7], s93 offen offset:128 sc1
  buffer_load_dwordx4 a[88:91], v9, s[4:7], s93 offen offset:1024 sc1
  buffer_load_dwordx4 a[92:95], v9, s[4:7], s93 offen offset:1152 sc1
  buffer_load_dwordx4 a[96:99], v4, s[4:7], s91 offen offset:0 sc1
  buffer_load_dwordx4 a[100:103], v4, s[4:7], s91 offen offset:512 sc1
  buffer_load_dwordx4 a[104:107], v4, s[4:7], s91 offen offset:1024 sc1
  buffer_load_dwordx4 a[108:111], v4, s[4:7], s91 offen offset:1536 sc1
  buffer_load_dwordx4 a[112:115], v5, s[4:7], s91 offen offset:0 sc1
  buffer_load_dwordx4 a[116:119], v5, s[4:7], s91 offen offset:1024 sc1
  s_add_u32 s92, s92, 262144
  s_add_u32 s93, s93, 262144
  s_add_u32 s94, s94, 262144
  s_add_u32 s91, s91, 65536
  v_cvt_pk_bf16_f32 v136, v176, v177
  v_cvt_pk_bf16_f32 v137, v178, v179
  v_cvt_pk_bf16_f32 v138, v184, v185
  v_cvt_pk_bf16_f32 v139, v186, v187
  buffer_store_dwordx4 v[136:139], v10, s[4:7], s95 offen offset:0 sc1
  v_cvt_pk_bf16_f32 v140, v180, v181
  v_cvt_pk_bf16_f32 v141, v182, v183
  v_cvt_pk_bf16_f32 v142, v188, v189
  v_cvt_pk_bf16_f32 v143, v190, v191
  buffer_store_dwordx4 v[140:143], v10, s[4:7], s95 offen offset:512 sc1
  v_cvt_pk_bf16_f32 v144, v192, v193
  v_cvt_pk_bf16_f32 v145, v194, v195
  v_cvt_pk_bf16_f32 v146, v200, v201
  v_cvt_pk_bf16_f32 v147, v202, v203
  buffer_store_dwordx4 v[144:147], v10, s[4:7], s95 offen offset:2048 sc1
  v_cvt_pk_bf16_f32 v148, v196, v197
  v_cvt_pk_bf16_f32 v149, v198, v199
  v_cvt_pk_bf16_f32 v150, v204, v205
  v_cvt_pk_bf16_f32 v151, v206, v207
  buffer_store_dwordx4 v[148:151], v10, s[4:7], s95 offen offset:2560 sc1
  v_cvt_pk_bf16_f32 v136, v208, v209
  v_cvt_pk_bf16_f32 v137, v210, v211
  v_cvt_pk_bf16_f32 v138, v216, v217
  v_cvt_pk_bf16_f32 v139, v218, v219
  buffer_store_dwordx4 v[136:139], v11, s[4:7], s95 offen offset:0 sc1
  v_cvt_pk_bf16_f32 v140, v212, v213
  v_cvt_pk_bf16_f32 v141, v214, v215
  v_cvt_pk_bf16_f32 v142, v220, v221
  v_cvt_pk_bf16_f32 v143, v222, v223
  buffer_store_dwordx4 v[140:143], v11, s[4:7], s95 offen offset:512 sc1
  v_cvt_pk_bf16_f32 v144, v224, v225
  v_cvt_pk_bf16_f32 v145, v226, v227
  v_cvt_pk_bf16_f32 v146, v232, v233
  v_cvt_pk_bf16_f32 v147, v234, v235
  buffer_store_dwordx4 v[144:147], v11, s[4:7], s95 offen offset:2048 sc1
  v_cvt_pk_bf16_f32 v148, v228, v229
  v_cvt_pk_bf16_f32 v149, v230, v231
  v_cvt_pk_bf16_f32 v150, v236, v237
  v_cvt_pk_bf16_f32 v151, v238, v239
  buffer_store_dwordx4 v[148:151], v11, s[4:7], s95 offen offset:2560 sc1
  s_add_u32 s95, s95, 262144
  s_waitcnt vmcnt(46)
  v_mfma_f32_16x16x32_bf16 v[136:139], v[112:115], v[16:19], 0
  v_mfma_f32_16x16x32_bf16 v[140:143], v[48:51], v[16:19], 0
  v_mfma_f32_16x16x32_bf16 v[144:147], v[112:115], v[32:35], 0
  v_mfma_f32_16x16x32_bf16 v[148:151], v[48:51], v[32:35], 0
  v_mfma_f32_16x16x32_bf16 v[152:155], v[64:67], v[32:35], 0
  v_mfma_f32_16x16x32_bf16 v[136:139], v[116:119], v[20:23], v[136:139]
  v_mfma_f32_16x16x32_bf16 v[140:143], v[52:55], v[20:23], v[140:143]
  v_mfma_f32_16x16x32_bf16 v[144:147], v[116:119], v[36:39], v[144:147]
  v_mfma_f32_16x16x32_bf16 v[148:151], v[52:55], v[36:39], v[148:151]
  v_mfma_f32_16x16x32_bf16 v[152:155], v[68:71], v[36:39], v[152:155]
  v_mfma_f32_16x16x32_bf16 v[136:139], v[120:123], v[24:27], v[136:139]
  v_mfma_f32_16x16x32_bf16 v[140:143], v[56:59], v[24:27], v[140:143]
  v_mfma_f32_16x16x32_bf16 v[144:147], v[120:123], v[40:43], v[144:147]
  v_mfma_f32_16x16x32_bf16 v[148:151], v[56:59], v[40:43], v[148:151]
  v_mfma_f32_16x16x32_bf16 v[152:155], v[72:75], v[40:43], v[152:155]
  v_mfma_f32_16x16x32_bf16 v[136:139], v[124:127], v[28:31], v[136:139]
  v_mfma_f32_16x16x32_bf16 v[140:143], v[60:63], v[28:31], v[140:143]
  v_mfma_f32_16x16x32_bf16 v[144:147], v[124:127], v[44:47], v[144:147]
  v_mfma_f32_16x16x32_bf16 v[148:151], v[60:63], v[44:47], v[148:151]
  v_mfma_f32_16x16x32_bf16 v[152:155], v[76:79], v[44:47], v[152:155]
  s_nop 4
  v_cndmask_b32 v140, v6, v140, s[40:41]
  v_cndmask_b32 v141, v6, v141, s[42:43]
  v_cndmask_b32 v142, v6, v142, s[44:45]
  v_cndmask_b32 v143, v6, v143, s[46:47]
  v_max3_f32 v12, v136, v137, v140
  v_max3_f32 v12, v12, v141, v142
  v_max_f32 v12, v12, v143
  v_mov_b32 v13, v12
  s_nop 1
  v_permlane32_swap_b32 v12, v13
  v_max_f32 v12, v12, v13
  v_mov_b32 v13, v12
  s_nop 1
  v_permlane16_swap_b32 v12, v13
  v_max_f32 v12, v12, v13
  v_mul_f32 v12, s50, v12
  v_fma_f32 v136, v136, s50, -v12
  v_fma_f32 v137, v137, s50, -v12
  v_fma_f32 v140, v140, s50, -v12
  v_fma_f32 v141, v141, s50, -v12
  v_fma_f32 v142, v142, s50, -v12
  v_fma_f32 v143, v143, s50, -v12
  v_exp_f32 v136, v136
  v_exp_f32 v137, v137
  v_exp_f32 v140, v140
  v_exp_f32 v141, v141
  v_exp_f32 v142, v142
  v_exp_f32 v143, v143
  v_add_f32 v12, v136, v137
  v_add_f32 v12, v12, v140
  v_add_f32 v12, v12, v141
  v_add_f32 v12, v12, v142
  v_add_f32 v12, v12, v143
  v_mov_b32 v13, v12
  s_nop 1
  v_permlane32_swap_b32 v12, v13
  v_add_f32 v12, v12, v13
  v_mov_b32 v13, v12
  s_nop 1
  v_permlane16_swap_b32 v12, v13
  v_add_f32 v12, v12, v13
  v_rcp_f32 v12, v12
  s_nop 0
  v_mul_f32 v136, v136, v12
  v_mul_f32 v137, v137, v12
  v_mul_f32 v140, v140, v12
  v_mul_f32 v141, v141, v12
  v_mul_f32 v142, v142, v12
  v_mul_f32 v143, v143, v12
  v_cvt_pk_bf16_f32 v160, v136, v137
  v_mov_b32 v161, 0
  v_mov_b32 v162, 0
  v_mov_b32 v163, v160
  v_cvt_pk_bf16_f32 v156, v140, v141
  v_cvt_pk_bf16_f32 v157, v142, v143
  v_mov_b32 v158, 0
  v_mov_b32 v159, 0
  v_cndmask_b32 v152, v6, v152, s[40:41]
  v_cndmask_b32 v153, v6, v153, s[42:43]
  v_cndmask_b32 v154, v6, v154, s[44:45]
  v_cndmask_b32 v155, v6, v155, s[46:47]
  v_max3_f32 v12, v144, v145, v148
  v_max3_f32 v12, v12, v149, v150
  v_max3_f32 v12, v12, v151, v152
  v_max3_f32 v12, v12, v153, v154
  v_max_f32 v12, v12, v155
  v_mov_b32 v13, v12
  s_nop 1
  v_permlane32_swap_b32 v12, v13
  v_max_f32 v12, v12, v13
  v_mov_b32 v13, v12
  s_nop 1
  v_permlane16_swap_b32 v12, v13
  v_max_f32 v12, v12, v13
  v_mul_f32 v12, s50, v12
  v_fma_f32 v144, v144, s50, -v12
  v_fma_f32 v145, v145, s50, -v12
  v_fma_f32 v148, v148, s50, -v12
  v_fma_f32 v149, v149, s50, -v12
  v_fma_f32 v150, v150, s50, -v12
  v_fma_f32 v151, v151, s50, -v12
  v_fma_f32 v152, v152, s50, -v12
  v_fma_f32 v153, v153, s50, -v12
  v_fma_f32 v154, v154, s50, -v12
  v_fma_f32 v155, v155, s50, -v12
  v_exp_f32 v144, v144
  v_exp_f32 v145, v145
  v_exp_f32 v148, v148
  v_exp_f32 v149, v149
  v_exp_f32 v150, v150
  v_exp_f32 v151, v151
  v_exp_f32 v152, v152
  v_exp_f32 v153, v153
  v_exp_f32 v154, v154
  v_exp_f32 v155, v155
  v_add_f32 v12, v144, v145
  v_add_f32 v12, v12, v148
  v_add_f32 v12, v12, v149
  v_add_f32 v12, v12, v150
  v_add_f32 v12, v12, v151
  v_add_f32 v12, v12, v152
  v_add_f32 v12, v12, v153
  v_add_f32 v12, v12, v154
  v_add_f32 v12, v12, v155
  v_mov_b32 v13, v12
  s_nop 1
  v_permlane32_swap_b32 v12, v13
  v_add_f32 v12, v12, v13
  v_mov_b32 v13, v12
  s_nop 1
  v_permlane16_swap_b32 v12, v13
  v_add_f32 v12, v12, v13
  v_rcp_f32 v12, v12
  s_nop 0
  v_mul_f32 v144, v144, v12
  v_mul_f32 v145, v145, v12
  v_mul_f32 v148, v148, v12
  v_mul_f32 v149, v149, v12
  v_mul_f32 v150, v150, v12
  v_mul_f32 v151, v151, v12
  v_mul_f32 v152, v152, v12
  v_mul_f32 v153, v153, v12
  v_mul_f32 v154, v154, v12
  v_mul_f32 v155, v155, v12
  v_cvt_pk_bf16_f32 v168, v144, v145
  v_mov_b32 v169, 0
  v_mov_b32 v170, 0
  v_mov_b32 v171, v168
  v_cvt_pk_bf16_f32 v164, v148, v149
  v_cvt_pk_bf16_f32 v165, v150, v151
  v_cvt_pk_bf16_f32 v166, v152, v153
  v_cvt_pk_bf16_f32 v167, v154, v155
  v_mfma_f32_16x16x32_bf16 v[176:179], v[80:83], v[156:159], 0
  v_mfma_f32_16x16x32_bf16 v[180:183], v[84:87], v[156:159], 0
  v_mfma_f32_16x16x32_bf16 v[184:187], v[88:91], v[156:159], 0
  v_mfma_f32_16x16x32_bf16 v[188:191], v[92:95], v[156:159], 0
  v_mfma_f32_16x16x32_bf16 v[192:195], v[96:99], v[156:159], 0
  v_mfma_f32_16x16x32_bf16 v[196:199], v[100:103], v[156:159], 0
  v_mfma_f32_16x16x32_bf16 v[200:203], v[104:107], v[156:159], 0
  v_mfma_f32_16x16x32_bf16 v[204:207], v[108:111], v[156:159], 0
  v_mfma_f32_16x16x16_bf16 v[176:179], v[128:129], v[160:161], v[176:179]
  v_mfma_f32_16x16x16_bf16 v[180:183], v[128:129], v[162:163], v[180:183]
  v_mfma_f32_16x16x16_bf16 v[184:187], v[130:131], v[160:161], v[184:187]
  v_mfma_f32_16x16x16_bf16 v[188:191], v[130:131], v[162:163], v[188:191]
  v_mfma_f32_16x16x16_bf16 v[192:195], v[132:133], v[160:161], v[192:195]
  v_mfma_f32_16x16x16_bf16 v[196:199], v[132:133], v[162:163], v[196:199]
  v_mfma_f32_16x16x16_bf16 v[200:203], v[134:135], v[160:161], v[200:203]
  v_mfma_f32_16x16x16_bf16 v[204:207], v[134:135], v[162:163], v[204:207]
  v_mfma_f32_16x16x32_bf16 v[208:211], v[80:83], v[164:167], 0
  v_mfma_f32_16x16x32_bf16 v[212:215], v[84:87], v[164:167], 0
  v_mfma_f32_16x16x32_bf16 v[216:219], v[88:91], v[164:167], 0
  v_mfma_f32_16x16x32_bf16 v[220:223], v[92:95], v[164:167], 0
  v_mfma_f32_16x16x32_bf16 v[224:227], v[96:99], v[164:167], 0
  v_mfma_f32_16x16x32_bf16 v[228:231], v[100:103], v[164:167], 0
  v_mfma_f32_16x16x32_bf16 v[232:235], v[104:107], v[164:167], 0
  v_mfma_f32_16x16x32_bf16 v[236:239], v[108:111], v[164:167], 0
  v_mfma_f32_16x16x16_bf16 v[208:211], v[128:129], v[168:169], v[208:211]
  v_mfma_f32_16x16x16_bf16 v[212:215], v[128:129], v[170:171], v[212:215]
  v_mfma_f32_16x16x16_bf16 v[216:219], v[130:131], v[168:169], v[216:219]
  v_mfma_f32_16x16x16_bf16 v[220:223], v[130:131], v[170:171], v[220:223]
  v_mfma_f32_16x16x16_bf16 v[224:227], v[132:133], v[168:169], v[224:227]
  v_mfma_f32_16x16x16_bf16 v[228:231], v[132:133], v[170:171], v[228:231]
  v_mfma_f32_16x16x16_bf16 v[232:235], v[134:135], v[168:169], v[232:235]
  v_mfma_f32_16x16x16_bf16 v[236:239], v[134:135], v[170:171], v[236:239]
  v_cvt_pk_bf16_f32 v136, v176, v177
  v_cvt_pk_bf16_f32 v137, v178, v179
  v_cvt_pk_bf16_f32 v138, v184, v185
  v_cvt_pk_bf16_f32 v139, v186, v187
  buffer_store_dwordx4 v[136:139], v10, s[4:7], s95 offen offset:0 sc1
  v_cvt_pk_bf16_f32 v140, v180, v181
  v_cvt_pk_bf16_f32 v141, v182, v183
  v_cvt_pk_bf16_f32 v142, v188, v189
  v_cvt_pk_bf16_f32 v143, v190, v191
  buffer_store_dwordx4 v[140:143], v10, s[4:7], s95 offen offset:512 sc1
  v_cvt_pk_bf16_f32 v144, v192, v193
  v_cvt_pk_bf16_f32 v145, v194, v195
  v_cvt_pk_bf16_f32 v146, v200, v201
  v_cvt_pk_bf16_f32 v147, v202, v203
  buffer_store_dwordx4 v[144:147], v10, s[4:7], s95 offen offset:2048 sc1
  v_cvt_pk_bf16_f32 v148, v196, v197
  v_cvt_pk_bf16_f32 v149, v198, v199
  v_cvt_pk_bf16_f32 v150, v204, v205
  v_cvt_pk_bf16_f32 v151, v206, v207
  buffer_store_dwordx4 v[148:151], v10, s[4:7], s95 offen offset:2560 sc1
  v_cvt_pk_bf16_f32 v136, v208, v209
  v_cvt_pk_bf16_f32 v137, v210, v211
  v_cvt_pk_bf16_f32 v138, v216, v217
  v_cvt_pk_bf16_f32 v139, v218, v219
  buffer_store_dwordx4 v[136:139], v11, s[4:7], s95 offen offset:0 sc1
  v_cvt_pk_bf16_f32 v140, v212, v213
  v_cvt_pk_bf16_f32 v141, v214, v215
  v_cvt_pk_bf16_f32 v142, v220, v221
  v_cvt_pk_bf16_f32 v143, v222, v223
  buffer_store_dwordx4 v[140:143], v11, s[4:7], s95 offen offset:512 sc1
  v_cvt_pk_bf16_f32 v144, v224, v225
  v_cvt_pk_bf16_f32 v145, v226, v227
  v_cvt_pk_bf16_f32 v146, v232, v233
  v_cvt_pk_bf16_f32 v147, v234, v235
  buffer_store_dwordx4 v[144:147], v11, s[4:7], s95 offen offset:2048 sc1
  v_cvt_pk_bf16_f32 v148, v228, v229
  v_cvt_pk_bf16_f32 v149, v230, v231
  v_cvt_pk_bf16_f32 v150, v236, v237
  v_cvt_pk_bf16_f32 v151, v238, v239
  buffer_store_dwordx4 v[148:151], v11, s[4:7], s95 offen offset:2560 sc1
  s_add_u32 s95, s95, 262144
  s_waitcnt vmcnt(16)
  s_cmp_lg_u32 s32, 0
  s_cbranch_scc1 L_rq_20
  s_cmp_eq_u32 s39, 0
  s_cbranch_scc1 L_rq_20
  s_lshl_b32 s99, s33, 7
  s_add_u32 s99, s99, 0x3d00200
  v_mov_b32 v244, 1
  v_mov_b32 v245, 0
  s_mov_b64 exec, 1
  buffer_atomic_add v244, v245, s[4:7], s99 offen sc0 sc1
  s_mov_b64 exec, -1
L_rq_20:
  v_mfma_f32_16x16x32_bf16 v[136:139], a[96:99], a[0:3], 0
  v_mfma_f32_16x16x32_bf16 v[140:143], a[32:35], a[0:3], 0
  v_mfma_f32_16x16x32_bf16 v[144:147], a[96:99], a[16:19], 0
  v_mfma_f32_16x16x32_bf16 v[148:151], a[32:35], a[16:19], 0
  v_mfma_f32_16x16x32_bf16 v[152:155], a[48:51], a[16:19], 0
  v_mfma_f32_16x16x32_bf16 v[136:139], a[100:103], a[4:7], v[136:139]
  v_mfma_f32_16x16x32_bf16 v[140:143], a[36:39], a[4:7], v[140:143]
  v_mfma_f32_16x16x32_bf16 v[144:147], a[100:103], a[20:23], v[144:147]
  v_mfma_f32_16x16x32_bf16 v[148:151], a[36:39], a[20:23], v[148:151]
  v_mfma_f32_16x16x32_bf16 v[152:155], a[52:55], a[20:23], v[152:155]
  v_mfma_f32_16x16x32_bf16 v[136:139], a[104:107], a[8:11], v[136:139]
  v_mfma_f32_16x16x32_bf16 v[140:143], a[40:43], a[8:11], v[140:143]
  v_mfma_f32_16x16x32_bf16 v[144:147], a[104:107], a[24:27], v[144:147]
  v_mfma_f32_16x16x32_bf16 v[148:151], a[40:43], a[24:27], v[148:151]
  v_mfma_f32_16x16x32_bf16 v[152:155], a[56:59], a[24:27], v[152:155]
  v_mfma_f32_16x16x32_bf16 v[136:139], a[108:111], a[12:15], v[136:139]
  v_mfma_f32_16x16x32_bf16 v[140:143], a[44:47], a[12:15], v[140:143]
  v_mfma_f32_16x16x32_bf16 v[144:147], a[108:111], a[28:31], v[144:147]
  v_mfma_f32_16x16x32_bf16 v[148:151], a[44:47], a[28:31], v[148:151]
  v_mfma_f32_16x16x32_bf16 v[152:155], a[60:63], a[28:31], v[152:155]
  s_nop 4
  v_cndmask_b32 v140, v6, v140, s[40:41]
  v_cndmask_b32 v141, v6, v141, s[42:43]
  v_cndmask_b32 v142, v6, v142, s[44:45]
  v_cndmask_b32 v143, v6, v143, s[46:47]
  v_max3_f32 v12, v136, v137, v140
  v_max3_f32 v12, v12, v141, v142
  v_max_f32 v12, v12, v143
  v_mov_b32 v13, v12
  s_nop 1
  v_permlane32_swap_b32 v12, v13
  v_max_f32 v12, v12, v13
  v_mov_b32 v13, v12
  s_nop 1
  v_permlane16_swap_b32 v12, v13
  v_max_f32 v12, v12, v13
  v_mul_f32 v12, s50, v12
  v_fma_f32 v136, v136, s50, -v12
  v_fma_f32 v137, v137, s50, -v12
  v_fma_f32 v140, v140, s50, -v12
  v_fma_f32 v141, v141, s50, -v12
  v_fma_f32 v142, v142, s50, -v12
  v_fma_f32 v143, v143, s50, -v12
  v_exp_f32 v136, v136
  v_exp_f32 v137, v137
  v_exp_f32 v140, v140
  v_exp_f32 v141, v141
  v_exp_f32 v142, v142
  v_exp_f32 v143, v143
  v_add_f32 v12, v136, v137
  v_add_f32 v12, v12, v140
  v_add_f32 v12, v12, v141
  v_add_f32 v12, v12, v142
  v_add_f32 v12, v12, v143
  v_mov_b32 v13, v12
  s_nop 1
  v_permlane32_swap_b32 v12, v13
  v_add_f32 v12, v12, v13
  v_mov_b32 v13, v12
  s_nop 1
  v_permlane16_swap_b32 v12, v13
  v_add_f32 v12, v12, v13
  v_rcp_f32 v12, v12
  s_nop 0
  v_mul_f32 v136, v136, v12
  v_mul_f32 v137, v137, v12
  v_mul_f32 v140, v140, v12
  v_mul_f32 v141, v141, v12
  v_mul_f32 v142, v142, v12
  v_mul_f32 v143, v143, v12
  v_cvt_pk_bf16_f32 v160, v136, v137
  v_mov_b32 v161, 0
  v_mov_b32 v162, 0
  v_mov_b32 v163, v160
  v_cvt_pk_bf16_f32 v156, v140, v141
  v_cvt_pk_bf16_f32 v157, v142, v143
  v_mov_b32 v158, 0
  v_mov_b32 v159, 0
  v_cndmask_b32 v152, v6, v152, s[40:41]
  v_cndmask_b32 v153, v6, v153, s[42:43]
  v_cndmask_b32 v154, v6, v154, s[44:45]
  v_cndmask_b32 v155, v6, v155, s[46:47]
  v_max3_f32 v12, v144, v145, v148
  v_max3_f32 v12, v12, v149, v150
  v_max3_f32 v12, v12, v151, v152
  v_max3_f32 v12, v12, v153, v154
  v_max_f32 v12, v12, v155
  v_mov_b32 v13, v12
  s_nop 1
  v_permlane32_swap_b32 v12, v13
  v_max_f32 v12, v12, v13
  v_mov_b32 v13, v12
  s_nop 1
  v_permlane16_swap_b32 v12, v13
  v_max_f32 v12, v12, v13
  v_mul_f32 v12, s50, v12
  v_fma_f32 v144, v144, s50, -v12
  v_fma_f32 v145, v145, s50, -v12
  v_fma_f32 v148, v148, s50, -v12
  v_fma_f32 v149, v149, s50, -v12
  v_fma_f32 v150, v150, s50, -v12
  v_fma_f32 v151, v151, s50, -v12
  v_fma_f32 v152, v152, s50, -v12
  v_fma_f32 v153, v153, s50, -v12
  v_fma_f32 v154, v154, s50, -v12
  v_fma_f32 v155, v155, s50, -v12
  v_exp_f32 v144, v144
  v_exp_f32 v145, v145
  v_exp_f32 v148, v148
  v_exp_f32 v149, v149
  v_exp_f32 v150, v150
  v_exp_f32 v151, v151
  v_exp_f32 v152, v152
  v_exp_f32 v153, v153
  v_exp_f32 v154, v154
  v_exp_f32 v155, v155
  v_add_f32 v12, v144, v145
  v_add_f32 v12, v12, v148
  v_add_f32 v12, v12, v149
  v_add_f32 v12, v12, v150
  v_add_f32 v12, v12, v151
  v_add_f32 v12, v12, v152
  v_add_f32 v12, v12, v153
  v_add_f32 v12, v12, v154
  v_add_f32 v12, v12, v155
  v_mov_b32 v13, v12
  s_nop 1
  v_permlane32_swap_b32 v12, v13
  v_add_f32 v12, v12, v13
  v_mov_b32 v13, v12
  s_nop 1
  v_permlane16_swap_b32 v12, v13
  v_add_f32 v12, v12, v13
  v_rcp_f32 v12, v12
  s_nop 0
  v_mul_f32 v144, v144, v12
  v_mul_f32 v145, v145, v12
  v_mul_f32 v148, v148, v12
  v_mul_f32 v149, v149, v12
  v_mul_f32 v150, v150, v12
  v_mul_f32 v151, v151, v12
  v_mul_f32 v152, v152, v12
  v_mul_f32 v153, v153, v12
  v_mul_f32 v154, v154, v12
  v_mul_f32 v155, v155, v12
  v_cvt_pk_bf16_f32 v168, v144, v145
  v_mov_b32 v169, 0
  v_mov_b32 v170, 0
  v_mov_b32 v171, v168
  v_cvt_pk_bf16_f32 v164, v148, v149
  v_cvt_pk_bf16_f32 v165, v150, v151
  v_cvt_pk_bf16_f32 v166, v152, v153
  v_cvt_pk_bf16_f32 v167, v154, v155
  v_mfma_f32_16x16x32_bf16 v[176:179], a[64:67], v[156:159], 0
  v_mfma_f32_16x16x32_bf16 v[180:183], a[68:71], v[156:159], 0
  v_mfma_f32_16x16x32_bf16 v[184:187], a[72:75], v[156:159], 0
  v_mfma_f32_16x16x32_bf16 v[188:191], a[76:79], v[156:159], 0
  v_mfma_f32_16x16x32_bf16 v[192:195], a[80:83], v[156:159], 0
  v_mfma_f32_16x16x32_bf16 v[196:199], a[84:87], v[156:159], 0
  v_mfma_f32_16x16x32_bf16 v[200:203], a[88:91], v[156:159], 0
  v_mfma_f32_16x16x32_bf16 v[204:207], a[92:95], v[156:159], 0
  v_mfma_f32_16x16x16_bf16 v[176:179], a[112:113], v[160:161], v[176:179]
  v_mfma_f32_16x16x16_bf16 v[180:183], a[112:113], v[162:163], v[180:183]
  v_mfma_f32_16x16x16_bf16 v[184:187], a[114:115], v[160:161], v[184:187]
  v_mfma_f32_16x16x16_bf16 v[188:191], a[114:115], v[162:163], v[188:191]
  v_mfma_f32_16x16x16_bf16 v[192:195], a[116:117], v[160:161], v[192:195]
  v_mfma_f32_16x16x16_bf16 v[196:199], a[116:117], v[162:163], v[196:199]
  v_mfma_f32_16x16x16_bf16 v[200:203], a[118:119], v[160:161], v[200:203]
  v_mfma_f32_16x16x16_bf16 v[204:207], a[118:119], v[162:163], v[204:207]
  v_mfma_f32_16x16x32_bf16 v[208:211], a[64:67], v[164:167], 0
  v_mfma_f32_16x16x32_bf16 v[212:215], a[68:71], v[164:167], 0
  v_mfma_f32_16x16x32_bf16 v[216:219], a[72:75], v[164:167], 0
  v_mfma_f32_16x16x32_bf16 v[220:223], a[76:79], v[164:167], 0
  v_mfma_f32_16x16x32_bf16 v[224:227], a[80:83], v[164:167], 0
  v_mfma_f32_16x16x32_bf16 v[228:231], a[84:87], v[164:167], 0
  v_mfma_f32_16x16x32_bf16 v[232:235], a[88:91], v[164:167], 0
  v_mfma_f32_16x16x32_bf16 v[236:239], a[92:95], v[164:167], 0
  v_mfma_f32_16x16x16_bf16 v[208:211], a[112:113], v[168:169], v[208:211]
  v_mfma_f32_16x16x16_bf16 v[212:215], a[112:113], v[170:171], v[212:215]
  v_mfma_f32_16x16x16_bf16 v[216:219], a[114:115], v[168:169], v[216:219]
  v_mfma_f32_16x16x16_bf16 v[220:223], a[114:115], v[170:171], v[220:223]
  v_mfma_f32_16x16x16_bf16 v[224:227], a[116:117], v[168:169], v[224:227]
  v_mfma_f32_16x16x16_bf16 v[228:231], a[116:117], v[170:171], v[228:231]
  v_mfma_f32_16x16x16_bf16 v[232:235], a[118:119], v[168:169], v[232:235]
  v_mfma_f32_16x16x16_bf16 v[236:239], a[118:119], v[170:171], v[236:239]
  v_cvt_pk_bf16_f32 v136, v176, v177
  v_cvt_pk_bf16_f32 v137, v178, v179
  v_cvt_pk_bf16_f32 v138, v184, v185
  v_cvt_pk_bf16_f32 v139, v186, v187
  buffer_store_dwordx4 v[136:139], v10, s[4:7], s95 offen offset:0 sc1
  v_cvt_pk_bf16_f32 v140, v180, v181
  v_cvt_pk_bf16_f32 v141, v182, v183
  v_cvt_pk_bf16_f32 v142, v188, v189
  v_cvt_pk_bf16_f32 v143, v190, v191
  buffer_store_dwordx4 v[140:143], v10, s[4:7], s95 offen offset:512 sc1
  v_cvt_pk_bf16_f32 v144, v192, v193
  v_cvt_pk_bf16_f32 v145, v194, v195
  v_cvt_pk_bf16_f32 v146, v200, v201
  v_cvt_pk_bf16_f32 v147, v202, v203
  buffer_store_dwordx4 v[144:147], v10, s[4:7], s95 offen offset:2048 sc1
  v_cvt_pk_bf16_f32 v148, v196, v197
  v_cvt_pk_bf16_f32 v149, v198, v199
  v_cvt_pk_bf16_f32 v150, v204, v205
  v_cvt_pk_bf16_f32 v151, v206, v207
  buffer_store_dwordx4 v[148:151], v10, s[4:7], s95 offen offset:2560 sc1
  v_cvt_pk_bf16_f32 v136, v208, v209
  v_cvt_pk_bf16_f32 v137, v210, v211
  v_cvt_pk_bf16_f32 v138, v216, v217
  v_cvt_pk_bf16_f32 v139, v218, v219
  buffer_store_dwordx4 v[136:139], v11, s[4:7], s95 offen offset:0 sc1
  v_cvt_pk_bf16_f32 v140, v212, v213
  v_cvt_pk_bf16_f32 v141, v214, v215
  v_cvt_pk_bf16_f32 v142, v220, v221
  v_cvt_pk_bf16_f32 v143, v222, v223
  buffer_store_dwordx4 v[140:143], v11, s[4:7], s95 offen offset:512 sc1
  v_cvt_pk_bf16_f32 v144, v224, v225
  v_cvt_pk_bf16_f32 v145, v226, v227
  v_cvt_pk_bf16_f32 v146, v232, v233
  v_cvt_pk_bf16_f32 v147, v234, v235
  buffer_store_dwordx4 v[144:147], v11, s[4:7], s95 offen offset:2048 sc1
  v_cvt_pk_bf16_f32 v148, v228, v229
  v_cvt_pk_bf16_f32 v149, v230, v231
  v_cvt_pk_bf16_f32 v150, v236, v237
  v_cvt_pk_bf16_f32 v151, v238, v239
  buffer_store_dwordx4 v[148:151], v11, s[4:7], s95 offen offset:2560 sc1
  s_add_u32 s95, s95, 262144
  s_branch L_done
L_bo:
  s_lshr_b32 s40, s36, 1
  s_lshl_b32 s40, s40, 7
  s_add_u32 s40, s40, 1024
  s_mov_b32 s41, 16
  s_mov_b32 s12, s82
  s_and_b32 s13, s83, 0xffff
  s_mov_b32 s14, 0x200000
  s_mov_b32 s15, 0x20000
  s_mov_b32 s23, 65536
  s_mov_b32 s25, 4
  s_lshl_b32 s20, s36, 18
  s_add_u32 s20, s20, 0x6000000
  s_mov_b32 s22, 2048
  s_branch L_g3
L_aos:
  s_mov_b32 s12, s74
  s_and_b32 s13, s75, 0xffff
  s_mov_b32 s14, 0x800000
  s_mov_b32 s15, 0x20000
  s_and_b32 s48, s37, 7
  s_lshr_b32 s37, s37, 3
  s_sub_u32 s40, s36, 12
  s_lshl_b32 s40, s40, 3
  s_add_u32 s40, s40, s48
  s_lshl_b32 s40, s40, 7
  s_add_u32 s40, s40, 20480
  s_mov_b32 s41, 4
  s_mov_b32 s23, 262144
  s_mov_b32 s25, 2
  s_lshl_b32 s20, s36, 20
  s_add_u32 s20, s20, 0x5000000
  s_lshl_b32 s90, s48, 15
  s_add_u32 s20, s20, s90
  s_mov_b32 s22, 0
  s_lshl_b32 s49, s48, 20
  s_branch L_g3b
L_ao:
  s_lshl_b32 s40, s36, 7
  s_add_u32 s40, s40, 2048
  s_mov_b32 s41, 32
  s_mov_b32 s12, s74
  s_and_b32 s13, s75, 0xffff
  s_mov_b32 s14, 0x800000
  s_mov_b32 s15, 0x20000
  s_mov_b32 s23, 262144
  s_mov_b32 s25, 16
  s_lshl_b32 s20, s36, 20
  s_add_u32 s20, s20, 0x5000000
  s_mov_b32 s22, 0
L_g3:
  s_mov_b32 s49, 0
L_g3b:
  s_mov_b32 s8, s4
  s_and_b32 s9, s5, 0xffff
  s_mov_b32 s10, 0x10000000
  s_mov_b32 s11, 0x20000
  s_lshl_b32 s91, s33, 1
  s_add_u32 s91, s91, s37
  s_mov_b32 s24, 2048
  s_mov_b32 s26, 4096
  s_lshl_b32 s21, s91, 8
  s_add_u32 s22, s22, s21
  s_lshl_b32 s90, s36, 19
  s_add_u32 s22, s22, s90
  s_add_u32 s21, s21, s49
  s_mov_b32 s50, s91
  v_and_b32 v1, 63, v0
  v_lshrrev_b32 v16, 6, v0
  s_nop 0
  v_readfirstlane_b32 s27, v16
  s_mul_i32 s90, s27, 1
  s_mul_i32 s90, s90, s23
  v_mov_b32 v2, 0x0
  v_bfe_u32 v17, v1, 0, 6
  v_lshl_add_u32 v2, v17, 4, v2
  v_add_u32 v2, s90, v2
  v_mov_b32 v3, 0x400
  v_bfe_u32 v17, v1, 0, 6
  v_lshl_add_u32 v3, v17, 4, v3
  v_add_u32 v3, s90, v3
  v_mov_b32 v4, 0x1000
  v_bfe_u32 v17, v1, 0, 6
  v_lshl_add_u32 v4, v17, 4, v4
  v_add_u32 v4, s90, v4
  v_mov_b32 v5, 0x1400
  v_bfe_u32 v17, v1, 0, 6
  v_lshl_add_u32 v5, v17, 4, v5
  v_add_u32 v5, s90, v5
  s_mul_i32 s90, s27, 16
  v_lshrrev_b32 v16, 4, v1
  v_add_u32 v16, 0, v16
  v_add_u32 v16, s90, v16
  v_and_b32 v17, 7, v16
  v_lshlrev_b32 v17, 1, v17
  v_xor_b32 v17, v17, v1
  v_and_b32 v17, 15, v17
  v_mul_lo_u32 v16, v16, s24
  v_lshl_add_u32 v6, v17, 4, v16
  v_lshrrev_b32 v16, 4, v1
  v_add_u32 v16, 4, v16
  v_add_u32 v16, s90, v16
  v_and_b32 v17, 7, v16
  v_lshlrev_b32 v17, 1, v17
  v_xor_b32 v17, v17, v1
  v_and_b32 v17, 15, v17
  v_mul_lo_u32 v16, v16, s24
  v_lshl_add_u32 v7, v17, 4, v16
  v_lshrrev_b32 v16, 4, v1
  v_add_u32 v16, 8, v16
  v_add_u32 v16, s90, v16
  v_and_b32 v17, 7, v16
  v_lshlrev_b32 v17, 1, v17
  v_xor_b32 v17, v17, v1
  v_and_b32 v17, 15, v17
  v_mul_lo_u32 v16, v16, s24
  v_lshl_add_u32 v8, v17, 4, v16
  v_lshrrev_b32 v16, 4, v1
  v_add_u32 v16, 12, v16
  v_add_u32 v16, s90, v16
  v_and_b32 v17, 7, v16
  v_lshlrev_b32 v17, 1, v17
  v_xor_b32 v17, v17, v1
  v_and_b32 v17, 15, v17
  v_mul_lo_u32 v16, v16, s24
  v_lshl_add_u32 v9, v17, 4, v16
  s_mul_i32 s51, s24, 64
  s_mul_i32 s52, s27, 4096
  s_mul_i32 s53, s27, 4096
  s_add_u32 s53, s53, 16384
  s_add_u32 m0, s53, 0
  s_nop 0
  buffer_load_dwordx4 v6, s[12:15], s21 offen  lds
  s_add_u32 m0, s53, 1024
  s_nop 0
  buffer_load_dwordx4 v7, s[12:15], s21 offen  lds
  s_add_u32 m0, s53, 2048
  s_nop 0
  buffer_load_dwordx4 v8, s[12:15], s21 offen  lds
  s_add_u32 m0, s53, 3072
  s_nop 0
  buffer_load_dwordx4 v9, s[12:15], s21 offen  lds
  s_add_u32 s21, s21, s51
  s_add_u32 m0, s53, 32768
  s_nop 0
  buffer_load_dwordx4 v6, s[12:15], s21 offen  lds
  s_add_u32 m0, s53, 33792
  s_nop 0
  buffer_load_dwordx4 v7, s[12:15], s21 offen  lds
  s_add_u32 m0, s53, 34816
  s_nop 0
  buffer_load_dwordx4 v8, s[12:15], s21 offen  lds
  s_add_u32 m0, s53, 35840
  s_nop 0
  buffer_load_dwordx4 v9, s[12:15], s21 offen  lds
  s_add_u32 s21, s21, s51
  s_add_u32 m0, s53, 65536
  s_nop 0
  buffer_load_dwordx4 v6, s[12:15], s21 offen  lds
  s_add_u32 m0, s53, 66560
  s_nop 0
  buffer_load_dwordx4 v7, s[12:15], s21 offen  lds
  s_add_u32 m0, s53, 67584
  s_nop 0
  buffer_load_dwordx4 v8, s[12:15], s21 offen  lds
  s_add_u32 m0, s53, 68608
  s_nop 0
  buffer_load_dwordx4 v9, s[12:15], s21 offen  lds
  s_add_u32 s21, s21, s51
  s_add_u32 m0, s53, 98304
  s_nop 0
  buffer_load_dwordx4 v6, s[12:15], s21 offen  lds
  s_add_u32 m0, s53, 99328
  s_nop 0
  buffer_load_dwordx4 v7, s[12:15], s21 offen  lds
  s_add_u32 m0, s53, 100352
  s_nop 0
  buffer_load_dwordx4 v8, s[12:15], s21 offen  lds
  s_add_u32 m0, s53, 101376
  s_nop 0
  buffer_load_dwordx4 v9, s[12:15], s21 offen  lds
  s_add_u32 s21, s21, s51
  s_cmp_lg_u32 s32, 0
  s_cbranch_scc1 L_dd_22
  v_mov_b32 v228, 0x3d00000
L_dw_21:
  buffer_load_dword v234, v228, s[4:7], s40 offen offset:0 sc1
  s_waitcnt vmcnt(0)
  s_mov_b32 s44, 1
  v_readfirstlane_b32 s45, v234
  s_cmp_ge_u32 s45, s41
  s_cselect_b32 s44, s44, 0
  s_cmp_eq_u32 s44, 1
  s_cbranch_scc1 L_dd_22
  s_sleep 3
  s_add_u32 s3, s3, 1
  s_cmp_lt_u32 s3, 131072
  s_cbranch_scc1 L_dw_21
L_dd_22:
  s_barrier
  s_add_u32 m0, s52, 0
  s_nop 0
  buffer_load_dwordx4 v2, s[8:11], s20 offen sc1 lds
  s_add_u32 m0, s52, 1024
  s_nop 0
  buffer_load_dwordx4 v3, s[8:11], s20 offen sc1 lds
  s_add_u32 m0, s52, 2048
  s_nop 0
  buffer_load_dwordx4 v4, s[8:11], s20 offen sc1 lds
  s_add_u32 m0, s52, 3072
  s_nop 0
  buffer_load_dwordx4 v5, s[8:11], s20 offen sc1 lds
  s_add_u32 s20, s20, 2048
  s_add_u32 m0, s52, 32768
  s_nop 0
  buffer_load_dwordx4 v2, s[8:11], s20 offen sc1 lds
  s_add_u32 m0, s52, 33792
  s_nop 0
  buffer_load_dwordx4 v3, s[8:11], s20 offen sc1 lds
  s_add_u32 m0, s52, 34816
  s_nop 0
  buffer_load_dwordx4 v4, s[8:11], s20 offen sc1 lds
  s_add_u32 m0, s52, 35840
  s_nop 0
  buffer_load_dwordx4 v5, s[8:11], s20 offen sc1 lds
  s_add_u32 s20, s20, 6144
  s_add_u32 m0, s52, 65536
  s_nop 0
  buffer_load_dwordx4 v2, s[8:11], s20 offen sc1 lds
  s_add_u32 m0, s52, 66560
  s_nop 0
  buffer_load_dwordx4 v3, s[8:11], s20 offen sc1 lds
  s_add_u32 m0, s52, 67584
  s_nop 0
  buffer_load_dwordx4 v4, s[8:11], s20 offen sc1 lds
  s_add_u32 m0, s52, 68608
  s_nop 0
  buffer_load_dwordx4 v5, s[8:11], s20 offen sc1 lds
  s_add_u32 s20, s20, 2048
  s_add_u32 m0, s52, 98304
  s_nop 0
  buffer_load_dwordx4 v2, s[8:11], s20 offen sc1 lds
  s_add_u32 m0, s52, 99328
  s_nop 0
  buffer_load_dwordx4 v3, s[8:11], s20 offen sc1 lds
  s_add_u32 m0, s52, 100352
  s_nop 0
  buffer_load_dwordx4 v4, s[8:11], s20 offen sc1 lds
  s_add_u32 m0, s52, 101376
  s_nop 0
  buffer_load_dwordx4 v5, s[8:11], s20 offen sc1 lds
  s_add_u32 s20, s20, 6144
  s_lshr_b32 s90, s27, 1
  s_and_b32 s91, s27, 1
  s_mul_i32 s92, s90, 8192
  v_mov_b32 v10, 0x0
  v_bfe_u32 v17, v1, 0, 6
  v_lshl_add_u32 v10, v17, 4, v10
  v_add_u32 v10, s92, v10
  v_add_u32 v11, 65536, v10
  v_mov_b32 v16, 0x0
  v_bfe_u32 v17, v1, 2, 2
  v_lshl_add_u32 v16, v17, 8, v16
  v_bfe_u32 v17, v1, 4, 2
  v_lshl_add_u32 v16, v17, 10, v16
  v_bfe_u32 v17, v1, 0, 1
  v_lshl_add_u32 v16, v17, 4, v16
  v_bfe_u32 v18, v1, 2, 3
  v_bfe_u32 v17, v1, 1, 1
  v_xor_b32 v18, v18, v17
  s_mul_i32 s92, s91, 4
  s_add_u32 s93, s92, 0
  v_xor_b32 v17, s93, v18
  v_lshl_add_u32 v12, v17, 5, v16
  v_add_u32 v14, 65536, v12
  s_add_u32 s93, s92, 2
  v_xor_b32 v17, s93, v18
  v_lshl_add_u32 v13, v17, 5, v16
  v_add_u32 v15, 65536, v13
  s_waitcnt vmcnt(12)
  s_barrier
  ds_read_b128 v[20:23], v10 offset:0
  ds_read_b64_tr_b16 v[52:53], v12 offset:16384
  ds_read_b64_tr_b16 v[54:55], v12 offset:20480
  ds_read_b128 v[24:27], v10 offset:2048
  ds_read_b64_tr_b16 v[56:57], v12 offset:16392
  ds_read_b64_tr_b16 v[58:59], v12 offset:20488
  ds_read_b128 v[28:31], v10 offset:4096
  ds_read_b64_tr_b16 v[60:61], v13 offset:16384
  ds_read_b64_tr_b16 v[62:63], v13 offset:20480
  ds_read_b128 v[32:35], v10 offset:6144
  ds_read_b64_tr_b16 v[64:65], v13 offset:16392
  ds_read_b64_tr_b16 v[66:67], v13 offset:20488
  s_sub_u32 s25, s25, 1
  s_waitcnt lgkmcnt(0)
  v_mfma_f32_16x16x32_bf16 a[0:3], v[52:55], v[20:23], 0
  ds_read_b128 v[36:39], v10 offset:1024
  v_mfma_f32_16x16x32_bf16 a[4:7], v[56:59], v[20:23], 0
  ds_read_b64_tr_b16 v[68:69], v12 offset:24576
  v_mfma_f32_16x16x32_bf16 a[8:11], v[60:63], v[20:23], 0
  ds_read_b64_tr_b16 v[70:71], v12 offset:28672
  v_mfma_f32_16x16x32_bf16 a[12:15], v[64:67], v[20:23], 0
  ds_read_b128 v[40:43], v10 offset:3072
  v_mfma_f32_16x16x32_bf16 a[16:19], v[52:55], v[24:27], 0
  ds_read_b64_tr_b16 v[72:73], v12 offset:24584
  v_mfma_f32_16x16x32_bf16 a[20:23], v[56:59], v[24:27], 0
  ds_read_b64_tr_b16 v[74:75], v12 offset:28680
  v_mfma_f32_16x16x32_bf16 a[24:27], v[60:63], v[24:27], 0
  ds_read_b128 v[44:47], v10 offset:5120
  v_mfma_f32_16x16x32_bf16 a[28:31], v[64:67], v[24:27], 0
  ds_read_b64_tr_b16 v[76:77], v13 offset:24576
  v_mfma_f32_16x16x32_bf16 a[32:35], v[52:55], v[28:31], 0
  ds_read_b64_tr_b16 v[78:79], v13 offset:28672
  v_mfma_f32_16x16x32_bf16 a[36:39], v[56:59], v[28:31], 0
  ds_read_b128 v[48:51], v10 offset:7168
  v_mfma_f32_16x16x32_bf16 a[40:43], v[60:63], v[28:31], 0
  ds_read_b64_tr_b16 v[80:81], v13 offset:24584
  v_mfma_f32_16x16x32_bf16 a[44:47], v[64:67], v[28:31], 0
  ds_read_b64_tr_b16 v[82:83], v13 offset:28680
  v_mfma_f32_16x16x32_bf16 a[48:51], v[52:55], v[32:35], 0
  v_mfma_f32_16x16x32_bf16 a[52:55], v[56:59], v[32:35], 0
  v_mfma_f32_16x16x32_bf16 a[56:59], v[60:63], v[32:35], 0
  v_mfma_f32_16x16x32_bf16 a[60:63], v[64:67], v[32:35], 0
  s_waitcnt lgkmcnt(0)
  v_mfma_f32_16x16x32_bf16 a[0:3], v[68:71], v[36:39], a[0:3]
  s_waitcnt vmcnt(8)
  s_barrier
  s_add_u32 m0, s52, 0
  v_mfma_f32_16x16x32_bf16 a[4:7], v[72:75], v[36:39], a[4:7]
  buffer_load_dwordx4 v2, s[8:11], s20 offen sc1 lds
  ds_read_b128 v[20:23], v10 offset:32768
  v_mfma_f32_16x16x32_bf16 a[8:11], v[76:79], v[36:39], a[8:11]
  ds_read_b64_tr_b16 v[52:53], v12 offset:49152
  v_mfma_f32_16x16x32_bf16 a[12:15], v[80:83], v[36:39], a[12:15]
  ds_read_b64_tr_b16 v[54:55], v12 offset:53248
  s_add_u32 m0, s53, 0
  v_mfma_f32_16x16x32_bf16 a[16:19], v[68:71], v[40:43], a[16:19]
  buffer_load_dwordx4 v6, s[12:15], s21 offen  lds
  ds_read_b128 v[24:27], v10 offset:34816
  v_mfma_f32_16x16x32_bf16 a[20:23], v[72:75], v[40:43], a[20:23]
  ds_read_b64_tr_b16 v[56:57], v12 offset:49160
  v_mfma_f32_16x16x32_bf16 a[24:27], v[76:79], v[40:43], a[24:27]
  ds_read_b64_tr_b16 v[58:59], v12 offset:53256
  s_add_u32 m0, s52, 1024
  v_mfma_f32_16x16x32_bf16 a[28:31], v[80:83], v[40:43], a[28:31]
  buffer_load_dwordx4 v3, s[8:11], s20 offen sc1 lds
  ds_read_b128 v[28:31], v10 offset:36864
  v_mfma_f32_16x16x32_bf16 a[32:35], v[68:71], v[44:47], a[32:35]
  ds_read_b64_tr_b16 v[60:61], v13 offset:49152
  v_mfma_f32_16x16x32_bf16 a[36:39], v[72:75], v[44:47], a[36:39]
  ds_read_b64_tr_b16 v[62:63], v13 offset:53248
  s_add_u32 m0, s53, 1024
  v_mfma_f32_16x16x32_bf16 a[40:43], v[76:79], v[44:47], a[40:43]
  buffer_load_dwordx4 v7, s[12:15], s21 offen  lds
  ds_read_b128 v[32:35], v10 offset:38912
  v_mfma_f32_16x16x32_bf16 a[44:47], v[80:83], v[44:47], a[44:47]
  ds_read_b64_tr_b16 v[64:65], v13 offset:49160
  v_mfma_f32_16x16x32_bf16 a[48:51], v[68:71], v[48:51], a[48:51]
  ds_read_b64_tr_b16 v[66:67], v13 offset:53256
  s_add_u32 m0, s52, 2048
  v_mfma_f32_16x16x32_bf16 a[52:55], v[72:75], v[48:51], a[52:55]
  buffer_load_dwordx4 v4, s[8:11], s20 offen sc1 lds
  v_mfma_f32_16x16x32_bf16 a[56:59], v[76:79], v[48:51], a[56:59]
  v_mfma_f32_16x16x32_bf16 a[60:63], v[80:83], v[48:51], a[60:63]
  s_waitcnt lgkmcnt(0)
  s_add_u32 m0, s53, 2048
  v_mfma_f32_16x16x32_bf16 a[0:3], v[52:55], v[20:23], a[0:3]
  buffer_load_dwordx4 v8, s[12:15], s21 offen  lds
  ds_read_b128 v[36:39], v10 offset:33792
  v_mfma_f32_16x16x32_bf16 a[4:7], v[56:59], v[20:23], a[4:7]
  ds_read_b64_tr_b16 v[68:69], v12 offset:57344
  v_mfma_f32_16x16x32_bf16 a[8:11], v[60:63], v[20:23], a[8:11]
  ds_read_b64_tr_b16 v[70:71], v12 offset:61440
  v_mfma_f32_16x16x32_bf16 a[12:15], v[64:67], v[20:23], a[12:15]
  ds_read_b128 v[40:43], v10 offset:35840
  s_add_u32 m0, s52, 3072
  v_mfma_f32_16x16x32_bf16 a[16:19], v[52:55], v[24:27], a[16:19]
  buffer_load_dwordx4 v5, s[8:11], s20 offen sc1 lds
  ds_read_b64_tr_b16 v[72:73], v12 offset:57352
  v_mfma_f32_16x16x32_bf16 a[20:23], v[56:59], v[24:27], a[20:23]
  ds_read_b64_tr_b16 v[74:75], v12 offset:61448
  v_mfma_f32_16x16x32_bf16 a[24:27], v[60:63], v[24:27], a[24:27]
  ds_read_b128 v[44:47], v10 offset:37888
  v_mfma_f32_16x16x32_bf16 a[28:31], v[64:67], v[24:27], a[28:31]
  ds_read_b64_tr_b16 v[76:77], v13 offset:57344
  s_add_u32 m0, s53, 3072
  v_mfma_f32_16x16x32_bf16 a[32:35], v[52:55], v[28:31], a[32:35]
  buffer_load_dwordx4 v9, s[12:15], s21 offen  lds
  ds_read_b64_tr_b16 v[78:79], v13 offset:61440
  v_mfma_f32_16x16x32_bf16 a[36:39], v[56:59], v[28:31], a[36:39]
  ds_read_b128 v[48:51], v10 offset:39936
  v_mfma_f32_16x16x32_bf16 a[40:43], v[60:63], v[28:31], a[40:43]
  ds_read_b64_tr_b16 v[80:81], v13 offset:57352
  v_mfma_f32_16x16x32_bf16 a[44:47], v[64:67], v[28:31], a[44:47]
  ds_read_b64_tr_b16 v[82:83], v13 offset:61448
  s_add_u32 s20, s20, 2048
  v_mfma_f32_16x16x32_bf16 a[48:51], v[52:55], v[32:35], a[48:51]
  s_add_u32 s21, s21, s51
  v_mfma_f32_16x16x32_bf16 a[52:55], v[56:59], v[32:35], a[52:55]
  v_mfma_f32_16x16x32_bf16 a[56:59], v[60:63], v[32:35], a[56:59]
  v_mfma_f32_16x16x32_bf16 a[60:63], v[64:67], v[32:35], a[60:63]
  s_waitcnt lgkmcnt(0)
  v_mfma_f32_16x16x32_bf16 a[0:3], v[68:71], v[36:39], a[0:3]
  s_waitcnt vmcnt(12)
  s_barrier
  s_add_u32 m0, s52, 32768
  v_mfma_f32_16x16x32_bf16 a[4:7], v[72:75], v[36:39], a[4:7]
  buffer_load_dwordx4 v2, s[8:11], s20 offen sc1 lds
  ds_read_b128 v[20:23], v11 offset:0
  v_mfma_f32_16x16x32_bf16 a[8:11], v[76:79], v[36:39], a[8:11]
  ds_read_b64_tr_b16 v[52:53], v14 offset:16384
  v_mfma_f32_16x16x32_bf16 a[12:15], v[80:83], v[36:39], a[12:15]
  ds_read_b64_tr_b16 v[54:55], v14 offset:20480
  s_add_u32 m0, s53, 32768
  v_mfma_f32_16x16x32_bf16 a[16:19], v[68:71], v[40:43], a[16:19]
  buffer_load_dwordx4 v6, s[12:15], s21 offen  lds
  ds_read_b128 v[24:27], v11 offset:2048
  v_mfma_f32_16x16x32_bf16 a[20:23], v[72:75], v[40:43], a[20:23]
  ds_read_b64_tr_b16 v[56:57], v14 offset:16392
  v_mfma_f32_16x16x32_bf16 a[24:27], v[76:79], v[40:43], a[24:27]
  ds_read_b64_tr_b16 v[58:59], v14 offset:20488
  s_add_u32 m0, s52, 33792
  v_mfma_f32_16x16x32_bf16 a[28:31], v[80:83], v[40:43], a[28:31]
  buffer_load_dwordx4 v3, s[8:11], s20 offen sc1 lds
  ds_read_b128 v[28:31], v11 offset:4096
  v_mfma_f32_16x16x32_bf16 a[32:35], v[68:71], v[44:47], a[32:35]
  ds_read_b64_tr_b16 v[60:61], v15 offset:16384
  v_mfma_f32_16x16x32_bf16 a[36:39], v[72:75], v[44:47], a[36:39]
  ds_read_b64_tr_b16 v[62:63], v15 offset:20480
  s_add_u32 m0, s53, 33792
  v_mfma_f32_16x16x32_bf16 a[40:43], v[76:79], v[44:47], a[40:43]
  buffer_load_dwordx4 v7, s[12:15], s21 offen  lds
  ds_read_b128 v[32:35], v11 offset:6144
  v_mfma_f32_16x16x32_bf16 a[44:47], v[80:83], v[44:47], a[44:47]
  ds_read_b64_tr_b16 v[64:65], v15 offset:16392
  v_mfma_f32_16x16x32_bf16 a[48:51], v[68:71], v[48:51], a[48:51]
  ds_read_b64_tr_b16 v[66:67], v15 offset:20488
  s_add_u32 m0, s52, 34816
  v_mfma_f32_16x16x32_bf16 a[52:55], v[72:75], v[48:51], a[52:55]
  buffer_load_dwordx4 v4, s[8:11], s20 offen sc1 lds
  v_mfma_f32_16x16x32_bf16 a[56:59], v[76:79], v[48:51], a[56:59]
  v_mfma_f32_16x16x32_bf16 a[60:63], v[80:83], v[48:51], a[60:63]
  s_waitcnt lgkmcnt(0)
  s_add_u32 m0, s53, 34816
  v_mfma_f32_16x16x32_bf16 a[0:3], v[52:55], v[20:23], a[0:3]
  buffer_load_dwordx4 v8, s[12:15], s21 offen  lds
  ds_read_b128 v[36:39], v11 offset:1024
  v_mfma_f32_16x16x32_bf16 a[4:7], v[56:59], v[20:23], a[4:7]
  ds_read_b64_tr_b16 v[68:69], v14 offset:24576
  v_mfma_f32_16x16x32_bf16 a[8:11], v[60:63], v[20:23], a[8:11]
  ds_read_b64_tr_b16 v[70:71], v14 offset:28672
  v_mfma_f32_16x16x32_bf16 a[12:15], v[64:67], v[20:23], a[12:15]
  ds_read_b128 v[40:43], v11 offset:3072
  s_add_u32 m0, s52, 35840
  v_mfma_f32_16x16x32_bf16 a[16:19], v[52:55], v[24:27], a[16:19]
  buffer_load_dwordx4 v5, s[8:11], s20 offen sc1 lds
  ds_read_b64_tr_b16 v[72:73], v14 offset:24584
  v_mfma_f32_16x16x32_bf16 a[20:23], v[56:59], v[24:27], a[20:23]
  ds_read_b64_tr_b16 v[74:75], v14 offset:28680
  v_mfma_f32_16x16x32_bf16 a[24:27], v[60:63], v[24:27], a[24:27]
  ds_read_b128 v[44:47], v11 offset:5120
  v_mfma_f32_16x16x32_bf16 a[28:31], v[64:67], v[24:27], a[28:31]
  ds_read_b64_tr_b16 v[76:77], v15 offset:24576
  s_add_u32 m0, s53, 35840
  v_mfma_f32_16x16x32_bf16 a[32:35], v[52:55], v[28:31], a[32:35]
  buffer_load_dwordx4 v9, s[12:15], s21 offen  lds
  ds_read_b64_tr_b16 v[78:79], v15 offset:28672
  v_mfma_f32_16x16x32_bf16 a[36:39], v[56:59], v[28:31], a[36:39]
  ds_read_b128 v[48:51], v11 offset:7168
  v_mfma_f32_16x16x32_bf16 a[40:43], v[60:63], v[28:31], a[40:43]
  ds_read_b64_tr_b16 v[80:81], v15 offset:24584
  v_mfma_f32_16x16x32_bf16 a[44:47], v[64:67], v[28:31], a[44:47]
  ds_read_b64_tr_b16 v[82:83], v15 offset:28680
  s_add_u32 s20, s20, 6144
  v_mfma_f32_16x16x32_bf16 a[48:51], v[52:55], v[32:35], a[48:51]
  s_add_u32 s21, s21, s51
  v_mfma_f32_16x16x32_bf16 a[52:55], v[56:59], v[32:35], a[52:55]
  v_mfma_f32_16x16x32_bf16 a[56:59], v[60:63], v[32:35], a[56:59]
  v_mfma_f32_16x16x32_bf16 a[60:63], v[64:67], v[32:35], a[60:63]
  s_waitcnt lgkmcnt(0)
  v_mfma_f32_16x16x32_bf16 a[0:3], v[68:71], v[36:39], a[0:3]
  s_waitcnt vmcnt(16)
  s_barrier
  s_add_u32 m0, s52, 65536
  v_mfma_f32_16x16x32_bf16 a[4:7], v[72:75], v[36:39], a[4:7]
  buffer_load_dwordx4 v2, s[8:11], s20 offen sc1 lds
  ds_read_b128 v[20:23], v11 offset:32768
  v_mfma_f32_16x16x32_bf16 a[8:11], v[76:79], v[36:39], a[8:11]
  ds_read_b64_tr_b16 v[52:53], v14 offset:49152
  v_mfma_f32_16x16x32_bf16 a[12:15], v[80:83], v[36:39], a[12:15]
  ds_read_b64_tr_b16 v[54:55], v14 offset:53248
  s_add_u32 m0, s53, 65536
  v_mfma_f32_16x16x32_bf16 a[16:19], v[68:71], v[40:43], a[16:19]
  buffer_load_dwordx4 v6, s[12:15], s21 offen  lds
  ds_read_b128 v[24:27], v11 offset:34816
  v_mfma_f32_16x16x32_bf16 a[20:23], v[72:75], v[40:43], a[20:23]
  ds_read_b64_tr_b16 v[56:57], v14 offset:49160
  v_mfma_f32_16x16x32_bf16 a[24:27], v[76:79], v[40:43], a[24:27]
  ds_read_b64_tr_b16 v[58:59], v14 offset:53256
  s_add_u32 m0, s52, 66560
  v_mfma_f32_16x16x32_bf16 a[28:31], v[80:83], v[40:43], a[28:31]
  buffer_load_dwordx4 v3, s[8:11], s20 offen sc1 lds
  ds_read_b128 v[28:31], v11 offset:36864
  v_mfma_f32_16x16x32_bf16 a[32:35], v[68:71], v[44:47], a[32:35]
  ds_read_b64_tr_b16 v[60:61], v15 offset:49152
  v_mfma_f32_16x16x32_bf16 a[36:39], v[72:75], v[44:47], a[36:39]
  ds_read_b64_tr_b16 v[62:63], v15 offset:53248
  s_add_u32 m0, s53, 66560
  v_mfma_f32_16x16x32_bf16 a[40:43], v[76:79], v[44:47], a[40:43]
  buffer_load_dwordx4 v7, s[12:15], s21 offen  lds
  ds_read_b128 v[32:35], v11 offset:38912
  v_mfma_f32_16x16x32_bf16 a[44:47], v[80:83], v[44:47], a[44:47]
  ds_read_b64_tr_b16 v[64:65], v15 offset:49160
  v_mfma_f32_16x16x32_bf16 a[48:51], v[68:71], v[48:51], a[48:51]
  ds_read_b64_tr_b16 v[66:67], v15 offset:53256
  s_add_u32 m0, s52, 67584
  v_mfma_f32_16x16x32_bf16 a[52:55], v[72:75], v[48:51], a[52:55]
  buffer_load_dwordx4 v4, s[8:11], s20 offen sc1 lds
  v_mfma_f32_16x16x32_bf16 a[56:59], v[76:79], v[48:51], a[56:59]
  v_mfma_f32_16x16x32_bf16 a[60:63], v[80:83], v[48:51], a[60:63]
  s_waitcnt lgkmcnt(0)
  s_add_u32 m0, s53, 67584
  v_mfma_f32_16x16x32_bf16 a[0:3], v[52:55], v[20:23], a[0:3]
  buffer_load_dwordx4 v8, s[12:15], s21 offen  lds
  ds_read_b128 v[36:39], v11 offset:33792
  v_mfma_f32_16x16x32_bf16 a[4:7], v[56:59], v[20:23], a[4:7]
  ds_read_b64_tr_b16 v[68:69], v14 offset:57344
  v_mfma_f32_16x16x32_bf16 a[8:11], v[60:63], v[20:23], a[8:11]
  ds_read_b64_tr_b16 v[70:71], v14 offset:61440
  v_mfma_f32_16x16x32_bf16 a[12:15], v[64:67], v[20:23], a[12:15]
  ds_read_b128 v[40:43], v11 offset:35840
  s_add_u32 m0, s52, 68608
  v_mfma_f32_16x16x32_bf16 a[16:19], v[52:55], v[24:27], a[16:19]
  buffer_load_dwordx4 v5, s[8:11], s20 offen sc1 lds
  ds_read_b64_tr_b16 v[72:73], v14 offset:57352
  v_mfma_f32_16x16x32_bf16 a[20:23], v[56:59], v[24:27], a[20:23]
  ds_read_b64_tr_b16 v[74:75], v14 offset:61448
  v_mfma_f32_16x16x32_bf16 a[24:27], v[60:63], v[24:27], a[24:27]
  ds_read_b128 v[44:47], v11 offset:37888
  v_mfma_f32_16x16x32_bf16 a[28:31], v[64:67], v[24:27], a[28:31]
  ds_read_b64_tr_b16 v[76:77], v15 offset:57344
  s_add_u32 m0, s53, 68608
  v_mfma_f32_16x16x32_bf16 a[32:35], v[52:55], v[28:31], a[32:35]
  buffer_load_dwordx4 v9, s[12:15], s21 offen  lds
  ds_read_b64_tr_b16 v[78:79], v15 offset:61440
  v_mfma_f32_16x16x32_bf16 a[36:39], v[56:59], v[28:31], a[36:39]
  ds_read_b128 v[48:51], v11 offset:39936
  v_mfma_f32_16x16x32_bf16 a[40:43], v[60:63], v[28:31], a[40:43]
  ds_read_b64_tr_b16 v[80:81], v15 offset:57352
  v_mfma_f32_16x16x32_bf16 a[44:47], v[64:67], v[28:31], a[44:47]
  ds_read_b64_tr_b16 v[82:83], v15 offset:61448
  s_add_u32 s20, s20, 2048
  v_mfma_f32_16x16x32_bf16 a[48:51], v[52:55], v[32:35], a[48:51]
  s_add_u32 s21, s21, s51
  v_mfma_f32_16x16x32_bf16 a[52:55], v[56:59], v[32:35], a[52:55]
  v_mfma_f32_16x16x32_bf16 a[56:59], v[60:63], v[32:35], a[56:59]
  v_mfma_f32_16x16x32_bf16 a[60:63], v[64:67], v[32:35], a[60:63]
  s_waitcnt lgkmcnt(0)
  v_mfma_f32_16x16x32_bf16 a[0:3], v[68:71], v[36:39], a[0:3]
  s_waitcnt vmcnt(16)
  s_barrier
  s_add_u32 m0, s52, 98304
  v_mfma_f32_16x16x32_bf16 a[4:7], v[72:75], v[36:39], a[4:7]
  buffer_load_dwordx4 v2, s[8:11], s20 offen sc1 lds
  ds_read_b128 v[20:23], v10 offset:0
  v_mfma_f32_16x16x32_bf16 a[8:11], v[76:79], v[36:39], a[8:11]
  ds_read_b64_tr_b16 v[52:53], v12 offset:16384
  v_mfma_f32_16x16x32_bf16 a[12:15], v[80:83], v[36:39], a[12:15]
  ds_read_b64_tr_b16 v[54:55], v12 offset:20480
  s_add_u32 m0, s53, 98304
  v_mfma_f32_16x16x32_bf16 a[16:19], v[68:71], v[40:43], a[16:19]
  buffer_load_dwordx4 v6, s[12:15], s21 offen  lds
  ds_read_b128 v[24:27], v10 offset:2048
  v_mfma_f32_16x16x32_bf16 a[20:23], v[72:75], v[40:43], a[20:23]
  ds_read_b64_tr_b16 v[56:57], v12 offset:16392
  v_mfma_f32_16x16x32_bf16 a[24:27], v[76:79], v[40:43], a[24:27]
  ds_read_b64_tr_b16 v[58:59], v12 offset:20488
  s_add_u32 m0, s52, 99328
  v_mfma_f32_16x16x32_bf16 a[28:31], v[80:83], v[40:43], a[28:31]
  buffer_load_dwordx4 v3, s[8:11], s20 offen sc1 lds
  ds_read_b128 v[28:31], v10 offset:4096
  v_mfma_f32_16x16x32_bf16 a[32:35], v[68:71], v[44:47], a[32:35]
  ds_read_b64_tr_b16 v[60:61], v13 offset:16384
  v_mfma_f32_16x16x32_bf16 a[36:39], v[72:75], v[44:47], a[36:39]
  ds_read_b64_tr_b16 v[62:63], v13 offset:20480
  s_add_u32 m0, s53, 99328
  v_mfma_f32_16x16x32_bf16 a[40:43], v[76:79], v[44:47], a[40:43]
  buffer_load_dwordx4 v7, s[12:15], s21 offen  lds
  ds_read_b128 v[32:35], v10 offset:6144
  v_mfma_f32_16x16x32_bf16 a[44:47], v[80:83], v[44:47], a[44:47]
  ds_read_b64_tr_b16 v[64:65], v13 offset:16392
  v_mfma_f32_16x16x32_bf16 a[48:51], v[68:71], v[48:51], a[48:51]
  ds_read_b64_tr_b16 v[66:67], v13 offset:20488
  s_add_u32 m0, s52, 100352
  v_mfma_f32_16x16x32_bf16 a[52:55], v[72:75], v[48:51], a[52:55]
  buffer_load_dwordx4 v4, s[8:11], s20 offen sc1 lds
  v_mfma_f32_16x16x32_bf16 a[56:59], v[76:79], v[48:51], a[56:59]
  v_mfma_f32_16x16x32_bf16 a[60:63], v[80:83], v[48:51], a[60:63]
L_g3_loop:
  s_sub_u32 s25, s25, 1
  s_cmp_eq_u32 s25, 0
  s_cbranch_scc1 L_g3_fin
  s_waitcnt lgkmcnt(0)
  s_add_u32 m0, s53, 100352
  v_mfma_f32_16x16x32_bf16 a[0:3], v[52:55], v[20:23], a[0:3]
  buffer_load_dwordx4 v8, s[12:15], s21 offen  lds
  ds_read_b128 v[36:39], v10 offset:1024
  v_mfma_f32_16x16x32_bf16 a[4:7], v[56:59], v[20:23], a[4:7]
  ds_read_b64_tr_b16 v[68:69], v12 offset:24576
  v_mfma_f32_16x16x32_bf16 a[8:11], v[60:63], v[20:23], a[8:11]
  ds_read_b64_tr_b16 v[70:71], v12 offset:28672
  v_mfma_f32_16x16x32_bf16 a[12:15], v[64:67], v[20:23], a[12:15]
  ds_read_b128 v[40:43], v10 offset:3072
  s_add_u32 m0, s52, 101376
  v_mfma_f32_16x16x32_bf16 a[16:19], v[52:55], v[24:27], a[16:19]
  buffer_load_dwordx4 v5, s[8:11], s20 offen sc1 lds
  ds_read_b64_tr_b16 v[72:73], v12 offset:24584
  v_mfma_f32_16x16x32_bf16 a[20:23], v[56:59], v[24:27], a[20:23]
  ds_read_b64_tr_b16 v[74:75], v12 offset:28680
  v_mfma_f32_16x16x32_bf16 a[24:27], v[60:63], v[24:27], a[24:27]
  ds_read_b128 v[44:47], v10 offset:5120
  v_mfma_f32_16x16x32_bf16 a[28:31], v[64:67], v[24:27], a[28:31]
  ds_read_b64_tr_b16 v[76:77], v13 offset:24576
  s_add_u32 m0, s53, 101376
  v_mfma_f32_16x16x32_bf16 a[32:35], v[52:55], v[28:31], a[32:35]
  buffer_load_dwordx4 v9, s[12:15], s21 offen  lds
  ds_read_b64_tr_b16 v[78:79], v13 offset:28672
  v_mfma_f32_16x16x32_bf16 a[36:39], v[56:59], v[28:31], a[36:39]
  ds_read_b128 v[48:51], v10 offset:7168
  v_mfma_f32_16x16x32_bf16 a[40:43], v[60:63], v[28:31], a[40:43]
  ds_read_b64_tr_b16 v[80:81], v13 offset:24584
  v_mfma_f32_16x16x32_bf16 a[44:47], v[64:67], v[28:31], a[44:47]
  ds_read_b64_tr_b16 v[82:83], v13 offset:28680
  s_add_u32 s20, s20, 6144
  v_mfma_f32_16x16x32_bf16 a[48:51], v[52:55], v[32:35], a[48:51]
  s_add_u32 s21, s21, s51
  v_mfma_f32_16x16x32_bf16 a[52:55], v[56:59], v[32:35], a[52:55]
  v_mfma_f32_16x16x32_bf16 a[56:59], v[60:63], v[32:35], a[56:59]
  v_mfma_f32_16x16x32_bf16 a[60:63], v[64:67], v[32:35], a[60:63]
  s_waitcnt lgkmcnt(0)
  v_mfma_f32_16x16x32_bf16 a[0:3], v[68:71], v[36:39], a[0:3]
  s_waitcnt vmcnt(16)
  s_barrier
  s_add_u32 m0, s52, 0
  v_mfma_f32_16x16x32_bf16 a[4:7], v[72:75], v[36:39], a[4:7]
  buffer_load_dwordx4 v2, s[8:11], s20 offen sc1 lds
  ds_read_b128 v[20:23], v10 offset:32768
  v_mfma_f32_16x16x32_bf16 a[8:11], v[76:79], v[36:39], a[8:11]
  ds_read_b64_tr_b16 v[52:53], v12 offset:49152
  v_mfma_f32_16x16x32_bf16 a[12:15], v[80:83], v[36:39], a[12:15]
  ds_read_b64_tr_b16 v[54:55], v12 offset:53248
  s_add_u32 m0, s53, 0
  v_mfma_f32_16x16x32_bf16 a[16:19], v[68:71], v[40:43], a[16:19]
  buffer_load_dwordx4 v6, s[12:15], s21 offen  lds
  ds_read_b128 v[24:27], v10 offset:34816
  v_mfma_f32_16x16x32_bf16 a[20:23], v[72:75], v[40:43], a[20:23]
  ds_read_b64_tr_b16 v[56:57], v12 offset:49160
  v_mfma_f32_16x16x32_bf16 a[24:27], v[76:79], v[40:43], a[24:27]
  ds_read_b64_tr_b16 v[58:59], v12 offset:53256
  s_add_u32 m0, s52, 1024
  v_mfma_f32_16x16x32_bf16 a[28:31], v[80:83], v[40:43], a[28:31]
  buffer_load_dwordx4 v3, s[8:11], s20 offen sc1 lds
  ds_read_b128 v[28:31], v10 offset:36864
  v_mfma_f32_16x16x32_bf16 a[32:35], v[68:71], v[44:47], a[32:35]
  ds_read_b64_tr_b16 v[60:61], v13 offset:49152
  v_mfma_f32_16x16x32_bf16 a[36:39], v[72:75], v[44:47], a[36:39]
  ds_read_b64_tr_b16 v[62:63], v13 offset:53248
  s_add_u32 m0, s53, 1024
  v_mfma_f32_16x16x32_bf16 a[40:43], v[76:79], v[44:47], a[40:43]
  buffer_load_dwordx4 v7, s[12:15], s21 offen  lds
  ds_read_b128 v[32:35], v10 offset:38912
  v_mfma_f32_16x16x32_bf16 a[44:47], v[80:83], v[44:47], a[44:47]
  ds_read_b64_tr_b16 v[64:65], v13 offset:49160
  v_mfma_f32_16x16x32_bf16 a[48:51], v[68:71], v[48:51], a[48:51]
  ds_read_b64_tr_b16 v[66:67], v13 offset:53256
  s_add_u32 m0, s52, 2048
  v_mfma_f32_16x16x32_bf16 a[52:55], v[72:75], v[48:51], a[52:55]
  buffer_load_dwordx4 v4, s[8:11], s20 offen sc1 lds
  v_mfma_f32_16x16x32_bf16 a[56:59], v[76:79], v[48:51], a[56:59]
  v_mfma_f32_16x16x32_bf16 a[60:63], v[80:83], v[48:51], a[60:63]
  s_waitcnt lgkmcnt(0)
  s_add_u32 m0, s53, 2048
  v_mfma_f32_16x16x32_bf16 a[0:3], v[52:55], v[20:23], a[0:3]
  buffer_load_dwordx4 v8, s[12:15], s21 offen  lds
  ds_read_b128 v[36:39], v10 offset:33792
  v_mfma_f32_16x16x32_bf16 a[4:7], v[56:59], v[20:23], a[4:7]
  ds_read_b64_tr_b16 v[68:69], v12 offset:57344
  v_mfma_f32_16x16x32_bf16 a[8:11], v[60:63], v[20:23], a[8:11]
  ds_read_b64_tr_b16 v[70:71], v12 offset:61440
  v_mfma_f32_16x16x32_bf16 a[12:15], v[64:67], v[20:23], a[12:15]
  ds_read_b128 v[40:43], v10 offset:35840
  s_add_u32 m0, s52, 3072
  v_mfma_f32_16x16x32_bf16 a[16:19], v[52:55], v[24:27], a[16:19]
  buffer_load_dwordx4 v5, s[8:11], s20 offen sc1 lds
  ds_read_b64_tr_b16 v[72:73], v12 offset:57352
  v_mfma_f32_16x16x32_bf16 a[20:23], v[56:59], v[24:27], a[20:23]
  ds_read_b64_tr_b16 v[74:75], v12 offset:61448
  v_mfma_f32_16x16x32_bf16 a[24:27], v[60:63], v[24:27], a[24:27]
  ds_read_b128 v[44:47], v10 offset:37888
  v_mfma_f32_16x16x32_bf16 a[28:31], v[64:67], v[24:27], a[28:31]
  ds_read_b64_tr_b16 v[76:77], v13 offset:57344
  s_add_u32 m0, s53, 3072
  v_mfma_f32_16x16x32_bf16 a[32:35], v[52:55], v[28:31], a[32:35]
  buffer_load_dwordx4 v9, s[12:15], s21 offen  lds
  ds_read_b64_tr_b16 v[78:79], v13 offset:61440
  v_mfma_f32_16x16x32_bf16 a[36:39], v[56:59], v[28:31], a[36:39]
  ds_read_b128 v[48:51], v10 offset:39936
  v_mfma_f32_16x16x32_bf16 a[40:43], v[60:63], v[28:31], a[40:43]
  ds_read_b64_tr_b16 v[80:81], v13 offset:57352
  v_mfma_f32_16x16x32_bf16 a[44:47], v[64:67], v[28:31], a[44:47]
  ds_read_b64_tr_b16 v[82:83], v13 offset:61448
  s_add_u32 s20, s20, 2048
  v_mfma_f32_16x16x32_bf16 a[48:51], v[52:55], v[32:35], a[48:51]
  s_add_u32 s21, s21, s51
  v_mfma_f32_16x16x32_bf16 a[52:55], v[56:59], v[32:35], a[52:55]
  v_mfma_f32_16x16x32_bf16 a[56:59], v[60:63], v[32:35], a[56:59]
  v_mfma_f32_16x16x32_bf16 a[60:63], v[64:67], v[32:35], a[60:63]
  s_waitcnt lgkmcnt(0)
  v_mfma_f32_16x16x32_bf16 a[0:3], v[68:71], v[36:39], a[0:3]
  s_waitcnt vmcnt(16)
  s_barrier
  s_add_u32 m0, s52, 32768
  v_mfma_f32_16x16x32_bf16 a[4:7], v[72:75], v[36:39], a[4:7]
  buffer_load_dwordx4 v2, s[8:11], s20 offen sc1 lds
  ds_read_b128 v[20:23], v11 offset:0
  v_mfma_f32_16x16x32_bf16 a[8:11], v[76:79], v[36:39], a[8:11]
  ds_read_b64_tr_b16 v[52:53], v14 offset:16384
  v_mfma_f32_16x16x32_bf16 a[12:15], v[80:83], v[36:39], a[12:15]
  ds_read_b64_tr_b16 v[54:55], v14 offset:20480
  s_add_u32 m0, s53, 32768
  v_mfma_f32_16x16x32_bf16 a[16:19], v[68:71], v[40:43], a[16:19]
  buffer_load_dwordx4 v6, s[12:15], s21 offen  lds
  ds_read_b128 v[24:27], v11 offset:2048
  v_mfma_f32_16x16x32_bf16 a[20:23], v[72:75], v[40:43], a[20:23]
  ds_read_b64_tr_b16 v[56:57], v14 offset:16392
  v_mfma_f32_16x16x32_bf16 a[24:27], v[76:79], v[40:43], a[24:27]
  ds_read_b64_tr_b16 v[58:59], v14 offset:20488
  s_add_u32 m0, s52, 33792
  v_mfma_f32_16x16x32_bf16 a[28:31], v[80:83], v[40:43], a[28:31]
  buffer_load_dwordx4 v3, s[8:11], s20 offen sc1 lds
  ds_read_b128 v[28:31], v11 offset:4096
  v_mfma_f32_16x16x32_bf16 a[32:35], v[68:71], v[44:47], a[32:35]
  ds_read_b64_tr_b16 v[60:61], v15 offset:16384
  v_mfma_f32_16x16x32_bf16 a[36:39], v[72:75], v[44:47], a[36:39]
  ds_read_b64_tr_b16 v[62:63], v15 offset:20480
  s_add_u32 m0, s53, 33792
  v_mfma_f32_16x16x32_bf16 a[40:43], v[76:79], v[44:47], a[40:43]
  buffer_load_dwordx4 v7, s[12:15], s21 offen  lds
  ds_read_b128 v[32:35], v11 offset:6144
  v_mfma_f32_16x16x32_bf16 a[44:47], v[80:83], v[44:47], a[44:47]
  ds_read_b64_tr_b16 v[64:65], v15 offset:16392
  v_mfma_f32_16x16x32_bf16 a[48:51], v[68:71], v[48:51], a[48:51]
  ds_read_b64_tr_b16 v[66:67], v15 offset:20488
  s_add_u32 m0, s52, 34816
  v_mfma_f32_16x16x32_bf16 a[52:55], v[72:75], v[48:51], a[52:55]
  buffer_load_dwordx4 v4, s[8:11], s20 offen sc1 lds
  v_mfma_f32_16x16x32_bf16 a[56:59], v[76:79], v[48:51], a[56:59]
  v_mfma_f32_16x16x32_bf16 a[60:63], v[80:83], v[48:51], a[60:63]
  s_waitcnt lgkmcnt(0)
  s_add_u32 m0, s53, 34816
  v_mfma_f32_16x16x32_bf16 a[0:3], v[52:55], v[20:23], a[0:3]
  buffer_load_dwordx4 v8, s[12:15], s21 offen  lds
  ds_read_b128 v[36:39], v11 offset:1024
  v_mfma_f32_16x16x32_bf16 a[4:7], v[56:59], v[20:23], a[4:7]
  ds_read_b64_tr_b16 v[68:69], v14 offset:24576
  v_mfma_f32_16x16x32_bf16 a[8:11], v[60:63], v[20:23], a[8:11]
  ds_read_b64_tr_b16 v[70:71], v14 offset:28672
  v_mfma_f32_16x16x32_bf16 a[12:15], v[64:67], v[20:23], a[12:15]
  ds_read_b128 v[40:43], v11 offset:3072
  s_add_u32 m0, s52, 35840
  v_mfma_f32_16x16x32_bf16 a[16:19], v[52:55], v[24:27], a[16:19]
  buffer_load_dwordx4 v5, s[8:11], s20 offen sc1 lds
  ds_read_b64_tr_b16 v[72:73], v14 offset:24584
  v_mfma_f32_16x16x32_bf16 a[20:23], v[56:59], v[24:27], a[20:23]
  ds_read_b64_tr_b16 v[74:75], v14 offset:28680
  v_mfma_f32_16x16x32_bf16 a[24:27], v[60:63], v[24:27], a[24:27]
  ds_read_b128 v[44:47], v11 offset:5120
  v_mfma_f32_16x16x32_bf16 a[28:31], v[64:67], v[24:27], a[28:31]
  ds_read_b64_tr_b16 v[76:77], v15 offset:24576
  s_add_u32 m0, s53, 35840
  v_mfma_f32_16x16x32_bf16 a[32:35], v[52:55], v[28:31], a[32:35]
  buffer_load_dwordx4 v9, s[12:15], s21 offen  lds
  ds_read_b64_tr_b16 v[78:79], v15 offset:28672
  v_mfma_f32_16x16x32_bf16 a[36:39], v[56:59], v[28:31], a[36:39]
  ds_read_b128 v[48:51], v11 offset:7168
  v_mfma_f32_16x16x32_bf16 a[40:43], v[60:63], v[28:31], a[40:43]
  ds_read_b64_tr_b16 v[80:81], v15 offset:24584
  v_mfma_f32_16x16x32_bf16 a[44:47], v[64:67], v[28:31], a[44:47]
  ds_read_b64_tr_b16 v[82:83], v15 offset:28680
  s_add_u32 s20, s20, 6144
  v_mfma_f32_16x16x32_bf16 a[48:51], v[52:55], v[32:35], a[48:51]
  s_add_u32 s21, s21, s51
  v_mfma_f32_16x16x32_bf16 a[52:55], v[56:59], v[32:35], a[52:55]
  v_mfma_f32_16x16x32_bf16 a[56:59], v[60:63], v[32:35], a[56:59]
  v_mfma_f32_16x16x32_bf16 a[60:63], v[64:67], v[32:35], a[60:63]
  s_waitcnt lgkmcnt(0)
  v_mfma_f32_16x16x32_bf16 a[0:3], v[68:71], v[36:39], a[0:3]
  s_waitcnt vmcnt(16)
  s_barrier
  s_add_u32 m0, s52, 65536
  v_mfma_f32_16x16x32_bf16 a[4:7], v[72:75], v[36:39], a[4:7]
  buffer_load_dwordx4 v2, s[8:11], s20 offen sc1 lds
  ds_read_b128 v[20:23], v11 offset:32768
  v_mfma_f32_16x16x32_bf16 a[8:11], v[76:79], v[36:39], a[8:11]
  ds_read_b64_tr_b16 v[52:53], v14 offset:49152
  v_mfma_f32_16x16x32_bf16 a[12:15], v[80:83], v[36:39], a[12:15]
  ds_read_b64_tr_b16 v[54:55], v14 offset:53248
  s_add_u32 m0, s53, 65536
  v_mfma_f32_16x16x32_bf16 a[16:19], v[68:71], v[40:43], a[16:19]
  buffer_load_dwordx4 v6, s[12:15], s21 offen  lds
  ds_read_b128 v[24:27], v11 offset:34816
  v_mfma_f32_16x16x32_bf16 a[20:23], v[72:75], v[40:43], a[20:23]
  ds_read_b64_tr_b16 v[56:57], v14 offset:49160
  v_mfma_f32_16x16x32_bf16 a[24:27], v[76:79], v[40:43], a[24:27]
  ds_read_b64_tr_b16 v[58:59], v14 offset:53256
  s_add_u32 m0, s52, 66560
  v_mfma_f32_16x16x32_bf16 a[28:31], v[80:83], v[40:43], a[28:31]
  buffer_load_dwordx4 v3, s[8:11], s20 offen sc1 lds
  ds_read_b128 v[28:31], v11 offset:36864
  v_mfma_f32_16x16x32_bf16 a[32:35], v[68:71], v[44:47], a[32:35]
  ds_read_b64_tr_b16 v[60:61], v15 offset:49152
  v_mfma_f32_16x16x32_bf16 a[36:39], v[72:75], v[44:47], a[36:39]
  ds_read_b64_tr_b16 v[62:63], v15 offset:53248
  s_add_u32 m0, s53, 66560
  v_mfma_f32_16x16x32_bf16 a[40:43], v[76:79], v[44:47], a[40:43]
  buffer_load_dwordx4 v7, s[12:15], s21 offen  lds
  ds_read_b128 v[32:35], v11 offset:38912
  v_mfma_f32_16x16x32_bf16 a[44:47], v[80:83], v[44:47], a[44:47]
  ds_read_b64_tr_b16 v[64:65], v15 offset:49160
  v_mfma_f32_16x16x32_bf16 a[48:51], v[68:71], v[48:51], a[48:51]
  ds_read_b64_tr_b16 v[66:67], v15 offset:53256
  s_add_u32 m0, s52, 67584
  v_mfma_f32_16x16x32_bf16 a[52:55], v[72:75], v[48:51], a[52:55]
  buffer_load_dwordx4 v4, s[8:11], s20 offen sc1 lds
  v_mfma_f32_16x16x32_bf16 a[56:59], v[76:79], v[48:51], a[56:59]
  v_mfma_f32_16x16x32_bf16 a[60:63], v[80:83], v[48:51], a[60:63]
  s_waitcnt lgkmcnt(0)
  s_add_u32 m0, s53, 67584
  v_mfma_f32_16x16x32_bf16 a[0:3], v[52:55], v[20:23], a[0:3]
  buffer_load_dwordx4 v8, s[12:15], s21 offen  lds
  ds_read_b128 v[36:39], v11 offset:33792
  v_mfma_f32_16x16x32_bf16 a[4:7], v[56:59], v[20:23], a[4:7]
  ds_read_b64_tr_b16 v[68:69], v14 offset:57344
  v_mfma_f32_16x16x32_bf16 a[8:11], v[60:63], v[20:23], a[8:11]
  ds_read_b64_tr_b16 v[70:71], v14 offset:61440
  v_mfma_f32_16x16x32_bf16 a[12:15], v[64:67], v[20:23], a[12:15]
  ds_read_b128 v[40:43], v11 offset:35840
  s_add_u32 m0, s52, 68608
  v_mfma_f32_16x16x32_bf16 a[16:19], v[52:55], v[24:27], a[16:19]
  buffer_load_dwordx4 v5, s[8:11], s20 offen sc1 lds
  ds_read_b64_tr_b16 v[72:73], v14 offset:57352
  v_mfma_f32_16x16x32_bf16 a[20:23], v[56:59], v[24:27], a[20:23]
  ds_read_b64_tr_b16 v[74:75], v14 offset:61448
  v_mfma_f32_16x16x32_bf16 a[24:27], v[60:63], v[24:27], a[24:27]
  ds_read_b128 v[44:47], v11 offset:37888
  v_mfma_f32_16x16x32_bf16 a[28:31], v[64:67], v[24:27], a[28:31]
  ds_read_b64_tr_b16 v[76:77], v15 offset:57344
  s_add_u32 m0, s53, 68608
  v_mfma_f32_16x16x32_bf16 a[32:35], v[52:55], v[28:31], a[32:35]
  buffer_load_dwordx4 v9, s[12:15], s21 offen  lds
  ds_read_b64_tr_b16 v[78:79], v15 offset:61440
  v_mfma_f32_16x16x32_bf16 a[36:39], v[56:59], v[28:31], a[36:39]
  ds_read_b128 v[48:51], v11 offset:39936
  v_mfma_f32_16x16x32_bf16 a[40:43], v[60:63], v[28:31], a[40:43]
  ds_read_b64_tr_b16 v[80:81], v15 offset:57352
  v_mfma_f32_16x16x32_bf16 a[44:47], v[64:67], v[28:31], a[44:47]
  ds_read_b64_tr_b16 v[82:83], v15 offset:61448
  s_add_u32 s20, s20, 2048
  v_mfma_f32_16x16x32_bf16 a[48:51], v[52:55], v[32:35], a[48:51]
  s_add_u32 s21, s21, s51
  v_mfma_f32_16x16x32_bf16 a[52:55], v[56:59], v[32:35], a[52:55]
  v_mfma_f32_16x16x32_bf16 a[56:59], v[60:63], v[32:35], a[56:59]
  v_mfma_f32_16x16x32_bf16 a[60:63], v[64:67], v[32:35], a[60:63]
  s_waitcnt lgkmcnt(0)
  v_mfma_f32_16x16x32_bf16 a[0:3], v[68:71], v[36:39], a[0:3]
  s_waitcnt vmcnt(16)
  s_barrier
  s_add_u32 m0, s52, 98304
  v_mfma_f32_16x16x32_bf16 a[4:7], v[72:75], v[36:39], a[4:7]
  buffer_load_dwordx4 v2, s[8:11], s20 offen sc1 lds
  ds_read_b128 v[20:23], v10 offset:0
  v_mfma_f32_16x16x32_bf16 a[8:11], v[76:79], v[36:39], a[8:11]
  ds_read_b64_tr_b16 v[52:53], v12 offset:16384
  v_mfma_f32_16x16x32_bf16 a[12:15], v[80:83], v[36:39], a[12:15]
  ds_read_b64_tr_b16 v[54:55], v12 offset:20480
  s_add_u32 m0, s53, 98304
  v_mfma_f32_16x16x32_bf16 a[16:19], v[68:71], v[40:43], a[16:19]
  buffer_load_dwordx4 v6, s[12:15], s21 offen  lds
  ds_read_b128 v[24:27], v10 offset:2048
  v_mfma_f32_16x16x32_bf16 a[20:23], v[72:75], v[40:43], a[20:23]
  ds_read_b64_tr_b16 v[56:57], v12 offset:16392
  v_mfma_f32_16x16x32_bf16 a[24:27], v[76:79], v[40:43], a[24:27]
  ds_read_b64_tr_b16 v[58:59], v12 offset:20488
  s_add_u32 m0, s52, 99328
  v_mfma_f32_16x16x32_bf16 a[28:31], v[80:83], v[40:43], a[28:31]
  buffer_load_dwordx4 v3, s[8:11], s20 offen sc1 lds
  ds_read_b128 v[28:31], v10 offset:4096
  v_mfma_f32_16x16x32_bf16 a[32:35], v[68:71], v[44:47], a[32:35]
  ds_read_b64_tr_b16 v[60:61], v13 offset:16384
  v_mfma_f32_16x16x32_bf16 a[36:39], v[72:75], v[44:47], a[36:39]
  ds_read_b64_tr_b16 v[62:63], v13 offset:20480
  s_add_u32 m0, s53, 99328
  v_mfma_f32_16x16x32_bf16 a[40:43], v[76:79], v[44:47], a[40:43]
  buffer_load_dwordx4 v7, s[12:15], s21 offen  lds
  ds_read_b128 v[32:35], v10 offset:6144
  v_mfma_f32_16x16x32_bf16 a[44:47], v[80:83], v[44:47], a[44:47]
  ds_read_b64_tr_b16 v[64:65], v13 offset:16392
  v_mfma_f32_16x16x32_bf16 a[48:51], v[68:71], v[48:51], a[48:51]
  ds_read_b64_tr_b16 v[66:67], v13 offset:20488
  s_add_u32 m0, s52, 100352
  v_mfma_f32_16x16x32_bf16 a[52:55], v[72:75], v[48:51], a[52:55]
  buffer_load_dwordx4 v4, s[8:11], s20 offen sc1 lds
  v_mfma_f32_16x16x32_bf16 a[56:59], v[76:79], v[48:51], a[56:59]
  v_mfma_f32_16x16x32_bf16 a[60:63], v[80:83], v[48:51], a[60:63]
  s_branch L_g3_loop
L_g3_fin:
  s_cmp_eq_u32 s35, 8
  s_cbranch_scc1 L_r3_23
  s_cmp_lg_u32 s32, 0
  s_cbranch_scc1 L_rq_24
  s_cmp_eq_u32 s39, 0
  s_cbranch_scc1 L_rq_24
  s_lshl_b32 s99, s33, 7
  s_add_u32 s99, s99, 0x3d00200
  v_mov_b32 v244, 1
  v_mov_b32 v245, 0
  s_mov_b64 exec, 1
  buffer_atomic_add v244, v245, s[4:7], s99 offen sc0 sc1
  s_mov_b64 exec, -1
L_rq_24:
L_r3_23:
  s_waitcnt lgkmcnt(0)
  s_add_u32 m0, s53, 100352
  v_mfma_f32_16x16x32_bf16 a[0:3], v[52:55], v[20:23], a[0:3]
  buffer_load_dwordx4 v8, s[12:15], s21 offen  lds
  ds_read_b128 v[36:39], v10 offset:1024
  v_mfma_f32_16x16x32_bf16 a[4:7], v[56:59], v[20:23], a[4:7]
  ds_read_b64_tr_b16 v[68:69], v12 offset:24576
  v_mfma_f32_16x16x32_bf16 a[8:11], v[60:63], v[20:23], a[8:11]
  ds_read_b64_tr_b16 v[70:71], v12 offset:28672
  v_mfma_f32_16x16x32_bf16 a[12:15], v[64:67], v[20:23], a[12:15]
  ds_read_b128 v[40:43], v10 offset:3072
  s_add_u32 m0, s52, 101376
  v_mfma_f32_16x16x32_bf16 a[16:19], v[52:55], v[24:27], a[16:19]
  buffer_load_dwordx4 v5, s[8:11], s20 offen sc1 lds
  ds_read_b64_tr_b16 v[72:73], v12 offset:24584
  v_mfma_f32_16x16x32_bf16 a[20:23], v[56:59], v[24:27], a[20:23]
  ds_read_b64_tr_b16 v[74:75], v12 offset:28680
  v_mfma_f32_16x16x32_bf16 a[24:27], v[60:63], v[24:27], a[24:27]
  ds_read_b128 v[44:47], v10 offset:5120
  v_mfma_f32_16x16x32_bf16 a[28:31], v[64:67], v[24:27], a[28:31]
  ds_read_b64_tr_b16 v[76:77], v13 offset:24576
  s_add_u32 m0, s53, 101376
  v_mfma_f32_16x16x32_bf16 a[32:35], v[52:55], v[28:31], a[32:35]
  buffer_load_dwordx4 v9, s[12:15], s21 offen  lds
  ds_read_b64_tr_b16 v[78:79], v13 offset:28672
  v_mfma_f32_16x16x32_bf16 a[36:39], v[56:59], v[28:31], a[36:39]
  ds_read_b128 v[48:51], v10 offset:7168
  v_mfma_f32_16x16x32_bf16 a[40:43], v[60:63], v[28:31], a[40:43]
  ds_read_b64_tr_b16 v[80:81], v13 offset:24584
  v_mfma_f32_16x16x32_bf16 a[44:47], v[64:67], v[28:31], a[44:47]
  ds_read_b64_tr_b16 v[82:83], v13 offset:28680
  s_add_u32 s20, s20, 6144
  v_mfma_f32_16x16x32_bf16 a[48:51], v[52:55], v[32:35], a[48:51]
  s_add_u32 s21, s21, s51
  v_mfma_f32_16x16x32_bf16 a[52:55], v[56:59], v[32:35], a[52:55]
  v_mfma_f32_16x16x32_bf16 a[56:59], v[60:63], v[32:35], a[56:59]
  v_mfma_f32_16x16x32_bf16 a[60:63], v[64:67], v[32:35], a[60:63]
  s_waitcnt lgkmcnt(0)
  v_mfma_f32_16x16x32_bf16 a[0:3], v[68:71], v[36:39], a[0:3]
  s_waitcnt vmcnt(16)
  s_barrier
  v_mfma_f32_16x16x32_bf16 a[4:7], v[72:75], v[36:39], a[4:7]
  ds_read_b128 v[20:23], v10 offset:32768
  v_mfma_f32_16x16x32_bf16 a[8:11], v[76:79], v[36:39], a[8:11]
  ds_read_b64_tr_b16 v[52:53], v12 offset:49152
  v_mfma_f32_16x16x32_bf16 a[12:15], v[80:83], v[36:39], a[12:15]
  ds_read_b64_tr_b16 v[54:55], v12 offset:53248
  v_mfma_f32_16x16x32_bf16 a[16:19], v[68:71], v[40:43], a[16:19]
  ds_read_b128 v[24:27], v10 offset:34816
  v_mfma_f32_16x16x32_bf16 a[20:23], v[72:75], v[40:43], a[20:23]
  ds_read_b64_tr_b16 v[56:57], v12 offset:49160
  v_mfma_f32_16x16x32_bf16 a[24:27], v[76:79], v[40:43], a[24:27]
  ds_read_b64_tr_b16 v[58:59], v12 offset:53256
  v_mfma_f32_16x16x32_bf16 a[28:31], v[80:83], v[40:43], a[28:31]
  ds_read_b128 v[28:31], v10 offset:36864
  v_mfma_f32_16x16x32_bf16 a[32:35], v[68:71], v[44:47], a[32:35]
  ds_read_b64_tr_b16 v[60:61], v13 offset:49152
  v_mfma_f32_16x16x32_bf16 a[36:39], v[72:75], v[44:47], a[36:39]
  ds_read_b64_tr_b16 v[62:63], v13 offset:53248
  v_mfma_f32_16x16x32_bf16 a[40:43], v[76:79], v[44:47], a[40:43]
  ds_read_b128 v[32:35], v10 offset:38912
  v_mfma_f32_16x16x32_bf16 a[44:47], v[80:83], v[44:47], a[44:47]
  ds_read_b64_tr_b16 v[64:65], v13 offset:49160
  v_mfma_f32_16x16x32_bf16 a[48:51], v[68:71], v[48:51], a[48:51]
  ds_read_b64_tr_b16 v[66:67], v13 offset:53256
  v_mfma_f32_16x16x32_bf16 a[52:55], v[72:75], v[48:51], a[52:55]
  v_mfma_f32_16x16x32_bf16 a[56:59], v[76:79], v[48:51], a[56:59]
  v_mfma_f32_16x16x32_bf16 a[60:63], v[80:83], v[48:51], a[60:63]
  s_waitcnt lgkmcnt(0)
  v_mfma_f32_16x16x32_bf16 a[0:3], v[52:55], v[20:23], a[0:3]
  ds_read_b128 v[36:39], v10 offset:33792
  v_mfma_f32_16x16x32_bf16 a[4:7], v[56:59], v[20:23], a[4:7]
  ds_read_b64_tr_b16 v[68:69], v12 offset:57344
  v_mfma_f32_16x16x32_bf16 a[8:11], v[60:63], v[20:23], a[8:11]
  ds_read_b64_tr_b16 v[70:71], v12 offset:61440
  v_mfma_f32_16x16x32_bf16 a[12:15], v[64:67], v[20:23], a[12:15]
  ds_read_b128 v[40:43], v10 offset:35840
  v_mfma_f32_16x16x32_bf16 a[16:19], v[52:55], v[24:27], a[16:19]
  ds_read_b64_tr_b16 v[72:73], v12 offset:57352
  v_mfma_f32_16x16x32_bf16 a[20:23], v[56:59], v[24:27], a[20:23]
  ds_read_b64_tr_b16 v[74:75], v12 offset:61448
  v_mfma_f32_16x16x32_bf16 a[24:27], v[60:63], v[24:27], a[24:27]
  ds_read_b128 v[44:47], v10 offset:37888
  v_mfma_f32_16x16x32_bf16 a[28:31], v[64:67], v[24:27], a[28:31]
  ds_read_b64_tr_b16 v[76:77], v13 offset:57344
  v_mfma_f32_16x16x32_bf16 a[32:35], v[52:55], v[28:31], a[32:35]
  ds_read_b64_tr_b16 v[78:79], v13 offset:61440
  v_mfma_f32_16x16x32_bf16 a[36:39], v[56:59], v[28:31], a[36:39]
  ds_read_b128 v[48:51], v10 offset:39936
  v_mfma_f32_16x16x32_bf16 a[40:43], v[60:63], v[28:31], a[40:43]
  ds_read_b64_tr_b16 v[80:81], v13 offset:57352
  v_mfma_f32_16x16x32_bf16 a[44:47], v[64:67], v[28:31], a[44:47]
  ds_read_b64_tr_b16 v[82:83], v13 offset:61448
  v_mfma_f32_16x16x32_bf16 a[48:51], v[52:55], v[32:35], a[48:51]
  v_mfma_f32_16x16x32_bf16 a[52:55], v[56:59], v[32:35], a[52:55]
  v_mfma_f32_16x16x32_bf16 a[56:59], v[60:63], v[32:35], a[56:59]
  v_mfma_f32_16x16x32_bf16 a[60:63], v[64:67], v[32:35], a[60:63]
  s_waitcnt lgkmcnt(0)
  v_mfma_f32_16x16x32_bf16 a[0:3], v[68:71], v[36:39], a[0:3]
  s_waitcnt vmcnt(8)
  s_barrier
  v_mfma_f32_16x16x32_bf16 a[4:7], v[72:75], v[36:39], a[4:7]
  ds_read_b128 v[20:23], v11 offset:0
  v_mfma_f32_16x16x32_bf16 a[8:11], v[76:79], v[36:39], a[8:11]
  ds_read_b64_tr_b16 v[52:53], v14 offset:16384
  v_mfma_f32_16x16x32_bf16 a[12:15], v[80:83], v[36:39], a[12:15]
  ds_read_b64_tr_b16 v[54:55], v14 offset:20480
  v_mfma_f32_16x16x32_bf16 a[16:19], v[68:71], v[40:43], a[16:19]
  ds_read_b128 v[24:27], v11 offset:2048
  v_mfma_f32_16x16x32_bf16 a[20:23], v[72:75], v[40:43], a[20:23]
  ds_read_b64_tr_b16 v[56:57], v14 offset:16392
  v_mfma_f32_16x16x32_bf16 a[24:27], v[76:79], v[40:43], a[24:27]
  ds_read_b64_tr_b16 v[58:59], v14 offset:20488
  v_mfma_f32_16x16x32_bf16 a[28:31], v[80:83], v[40:43], a[28:31]
  ds_read_b128 v[28:31], v11 offset:4096
  v_mfma_f32_16x16x32_bf16 a[32:35], v[68:71], v[44:47], a[32:35]
  ds_read_b64_tr_b16 v[60:61], v15 offset:16384
  v_mfma_f32_16x16x32_bf16 a[36:39], v[72:75], v[44:47], a[36:39]
  ds_read_b64_tr_b16 v[62:63], v15 offset:20480
  v_mfma_f32_16x16x32_bf16 a[40:43], v[76:79], v[44:47], a[40:43]
  ds_read_b128 v[32:35], v11 offset:6144
  v_mfma_f32_16x16x32_bf16 a[44:47], v[80:83], v[44:47], a[44:47]
  ds_read_b64_tr_b16 v[64:65], v15 offset:16392
  v_mfma_f32_16x16x32_bf16 a[48:51], v[68:71], v[48:51], a[48:51]
  ds_read_b64_tr_b16 v[66:67], v15 offset:20488
  v_mfma_f32_16x16x32_bf16 a[52:55], v[72:75], v[48:51], a[52:55]
  v_mfma_f32_16x16x32_bf16 a[56:59], v[76:79], v[48:51], a[56:59]
  v_mfma_f32_16x16x32_bf16 a[60:63], v[80:83], v[48:51], a[60:63]
  s_waitcnt lgkmcnt(0)
  v_mfma_f32_16x16x32_bf16 a[0:3], v[52:55], v[20:23], a[0:3]
  ds_read_b128 v[36:39], v11 offset:1024
  v_mfma_f32_16x16x32_bf16 a[4:7], v[56:59], v[20:23], a[4:7]
  ds_read_b64_tr_b16 v[68:69], v14 offset:24576
  v_mfma_f32_16x16x32_bf16 a[8:11], v[60:63], v[20:23], a[8:11]
  ds_read_b64_tr_b16 v[70:71], v14 offset:28672
  v_mfma_f32_16x16x32_bf16 a[12:15], v[64:67], v[20:23], a[12:15]
  ds_read_b128 v[40:43], v11 offset:3072
  v_mfma_f32_16x16x32_bf16 a[16:19], v[52:55], v[24:27], a[16:19]
  ds_read_b64_tr_b16 v[72:73], v14 offset:24584
  v_mfma_f32_16x16x32_bf16 a[20:23], v[56:59], v[24:27], a[20:23]
  ds_read_b64_tr_b16 v[74:75], v14 offset:28680
  v_mfma_f32_16x16x32_bf16 a[24:27], v[60:63], v[24:27], a[24:27]
  ds_read_b128 v[44:47], v11 offset:5120
  v_mfma_f32_16x16x32_bf16 a[28:31], v[64:67], v[24:27], a[28:31]
  ds_read_b64_tr_b16 v[76:77], v15 offset:24576
  v_mfma_f32_16x16x32_bf16 a[32:35], v[52:55], v[28:31], a[32:35]
  ds_read_b64_tr_b16 v[78:79], v15 offset:28672
  v_mfma_f32_16x16x32_bf16 a[36:39], v[56:59], v[28:31], a[36:39]
  ds_read_b128 v[48:51], v11 offset:7168
  v_mfma_f32_16x16x32_bf16 a[40:43], v[60:63], v[28:31], a[40:43]
  ds_read_b64_tr_b16 v[80:81], v15 offset:24584
  v_mfma_f32_16x16x32_bf16 a[44:47], v[64:67], v[28:31], a[44:47]
  ds_read_b64_tr_b16 v[82:83], v15 offset:28680
  v_mfma_f32_16x16x32_bf16 a[48:51], v[52:55], v[32:35], a[48:51]
  v_mfma_f32_16x16x32_bf16 a[52:55], v[56:59], v[32:35], a[52:55]
  v_mfma_f32_16x16x32_bf16 a[56:59], v[60:63], v[32:35], a[56:59]
  v_mfma_f32_16x16x32_bf16 a[60:63], v[64:67], v[32:35], a[60:63]
  s_waitcnt lgkmcnt(0)
  v_mfma_f32_16x16x32_bf16 a[0:3], v[68:71], v[36:39], a[0:3]
  s_waitcnt vmcnt(0)
  s_barrier
  v_mfma_f32_16x16x32_bf16 a[4:7], v[72:75], v[36:39], a[4:7]
  ds_read_b128 v[20:23], v11 offset:32768
  v_mfma_f32_16x16x32_bf16 a[8:11], v[76:79], v[36:39], a[8:11]
  ds_read_b64_tr_b16 v[52:53], v14 offset:49152
  v_mfma_f32_16x16x32_bf16 a[12:15], v[80:83], v[36:39], a[12:15]
  ds_read_b64_tr_b16 v[54:55], v14 offset:53248
  v_mfma_f32_16x16x32_bf16 a[16:19], v[68:71], v[40:43], a[16:19]
  ds_read_b128 v[24:27], v11 offset:34816
  v_mfma_f32_16x16x32_bf16 a[20:23], v[72:75], v[40:43], a[20:23]
  ds_read_b64_tr_b16 v[56:57], v14 offset:49160
  v_mfma_f32_16x16x32_bf16 a[24:27], v[76:79], v[40:43], a[24:27]
  ds_read_b64_tr_b16 v[58:59], v14 offset:53256
  v_mfma_f32_16x16x32_bf16 a[28:31], v[80:83], v[40:43], a[28:31]
  ds_read_b128 v[28:31], v11 offset:36864
  v_mfma_f32_16x16x32_bf16 a[32:35], v[68:71], v[44:47], a[32:35]
  ds_read_b64_tr_b16 v[60:61], v15 offset:49152
  v_mfma_f32_16x16x32_bf16 a[36:39], v[72:75], v[44:47], a[36:39]
  ds_read_b64_tr_b16 v[62:63], v15 offset:53248
  v_mfma_f32_16x16x32_bf16 a[40:43], v[76:79], v[44:47], a[40:43]
  ds_read_b128 v[32:35], v11 offset:38912
  v_mfma_f32_16x16x32_bf16 a[44:47], v[80:83], v[44:47], a[44:47]
  ds_read_b64_tr_b16 v[64:65], v15 offset:49160
  v_mfma_f32_16x16x32_bf16 a[48:51], v[68:71], v[48:51], a[48:51]
  ds_read_b64_tr_b16 v[66:67], v15 offset:53256
  v_mfma_f32_16x16x32_bf16 a[52:55], v[72:75], v[48:51], a[52:55]
  v_mfma_f32_16x16x32_bf16 a[56:59], v[76:79], v[48:51], a[56:59]
  v_mfma_f32_16x16x32_bf16 a[60:63], v[80:83], v[48:51], a[60:63]
  s_waitcnt lgkmcnt(0)
  v_mfma_f32_16x16x32_bf16 a[0:3], v[52:55], v[20:23], a[0:3]
  ds_read_b128 v[36:39], v11 offset:33792
  v_mfma_f32_16x16x32_bf16 a[4:7], v[56:59], v[20:23], a[4:7]
  ds_read_b64_tr_b16 v[68:69], v14 offset:57344
  v_mfma_f32_16x16x32_bf16 a[8:11], v[60:63], v[20:23], a[8:11]
  ds_read_b64_tr_b16 v[70:71], v14 offset:61440
  v_mfma_f32_16x16x32_bf16 a[12:15], v[64:67], v[20:23], a[12:15]
  ds_read_b128 v[40:43], v11 offset:35840
  v_mfma_f32_16x16x32_bf16 a[16:19], v[52:55], v[24:27], a[16:19]
  ds_read_b64_tr_b16 v[72:73], v14 offset:57352
  v_mfma_f32_16x16x32_bf16 a[20:23], v[56:59], v[24:27], a[20:23]
  ds_read_b64_tr_b16 v[74:75], v14 offset:61448
  v_mfma_f32_16x16x32_bf16 a[24:27], v[60:63], v[24:27], a[24:27]
  ds_read_b128 v[44:47], v11 offset:37888
  v_mfma_f32_16x16x32_bf16 a[28:31], v[64:67], v[24:27], a[28:31]
  ds_read_b64_tr_b16 v[76:77], v15 offset:57344
  v_mfma_f32_16x16x32_bf16 a[32:35], v[52:55], v[28:31], a[32:35]
  ds_read_b64_tr_b16 v[78:79], v15 offset:61440
  v_mfma_f32_16x16x32_bf16 a[36:39], v[56:59], v[28:31], a[36:39]
  ds_read_b128 v[48:51], v11 offset:39936
  v_mfma_f32_16x16x32_bf16 a[40:43], v[60:63], v[28:31], a[40:43]
  ds_read_b64_tr_b16 v[80:81], v15 offset:57352
  v_mfma_f32_16x16x32_bf16 a[44:47], v[64:67], v[28:31], a[44:47]
  ds_read_b64_tr_b16 v[82:83], v15 offset:61448
  v_mfma_f32_16x16x32_bf16 a[48:51], v[52:55], v[32:35], a[48:51]
  v_mfma_f32_16x16x32_bf16 a[52:55], v[56:59], v[32:35], a[52:55]
  v_mfma_f32_16x16x32_bf16 a[56:59], v[60:63], v[32:35], a[56:59]
  v_mfma_f32_16x16x32_bf16 a[60:63], v[64:67], v[32:35], a[60:63]
  s_waitcnt lgkmcnt(0)
  v_mfma_f32_16x16x32_bf16 a[0:3], v[68:71], v[36:39], a[0:3]
  v_mfma_f32_16x16x32_bf16 a[4:7], v[72:75], v[36:39], a[4:7]
  v_mfma_f32_16x16x32_bf16 a[8:11], v[76:79], v[36:39], a[8:11]
  v_mfma_f32_16x16x32_bf16 a[12:15], v[80:83], v[36:39], a[12:15]
  v_mfma_f32_16x16x32_bf16 a[16:19], v[68:71], v[40:43], a[16:19]
  v_mfma_f32_16x16x32_bf16 a[20:23], v[72:75], v[40:43], a[20:23]
  v_mfma_f32_16x16x32_bf16 a[24:27], v[76:79], v[40:43], a[24:27]
  v_mfma_f32_16x16x32_bf16 a[28:31], v[80:83], v[40:43], a[28:31]
  v_mfma_f32_16x16x32_bf16 a[32:35], v[68:71], v[44:47], a[32:35]
  v_mfma_f32_16x16x32_bf16 a[36:39], v[72:75], v[44:47], a[36:39]
  v_mfma_f32_16x16x32_bf16 a[40:43], v[76:79], v[44:47], a[40:43]
  v_mfma_f32_16x16x32_bf16 a[44:47], v[80:83], v[44:47], a[44:47]
  v_mfma_f32_16x16x32_bf16 a[48:51], v[68:71], v[48:51], a[48:51]
  v_mfma_f32_16x16x32_bf16 a[52:55], v[72:75], v[48:51], a[52:55]
  v_mfma_f32_16x16x32_bf16 a[56:59], v[76:79], v[48:51], a[56:59]
  v_mfma_f32_16x16x32_bf16 a[60:63], v[80:83], v[48:51], a[60:63]
  s_cmp_eq_u32 s35, 8
  s_cbranch_scc1 L_part
  s_mov_b32 s59, 5
  s_mov_b32 s60, s22
  s_mov_b32 s61, s26
  s_add_u32 s62, s38, 0x3d00000
  s_mov_b32 s63, s98
  s_cmp_lg_u32 s39, 0
  s_cbranch_scc1 L_got
  s_mov_b32 s58, 3
  s_branch L_epi
L_part:
  s_sub_u32 s40, s36, 13
  s_lshl_b32 s40, s40, 3
  s_add_u32 s40, s40, s50
  s_lshl_b32 s41, s40, 19
  s_add_u32 s41, s41, 0x6400000
  s_lshl_b32 s90, s32, 14
  s_add_u32 s41, s41, s90
  s_lshl_b32 s90, s48, 16
  s_add_u32 s42, s41, s90
  v_lshlrev_b32 v2, 4, v1
  buffer_store_dwordx4 a[0:3], v2, s[4:7], s42 offen offset:0 sc1
  buffer_store_dwordx4 a[4:7], v2, s[4:7], s42 offen offset:1024 sc1
  buffer_store_dwordx4 a[8:11], v2, s[4:7], s42 offen offset:2048 sc1
  buffer_store_dwordx4 a[12:15], v2, s[4:7], s42 offen offset:3072 sc1
  s_add_u32 s42, s42, 4096
  buffer_store_dwordx4 a[16:19], v2, s[4:7], s42 offen offset:0 sc1
  buffer_store_dwordx4 a[20:23], v2, s[4:7], s42 offen offset:1024 sc1
  buffer_store_dwordx4 a[24:27], v2, s[4:7], s42 offen offset:2048 sc1
  buffer_store_dwordx4 a[28:31], v2, s[4:7], s42 offen offset:3072 sc1
  s_add_u32 s42, s42, 4096
  buffer_store_dwordx4 a[32:35], v2, s[4:7], s42 offen offset:0 sc1
  buffer_store_dwordx4 a[36:39], v2, s[4:7], s42 offen offset:1024 sc1
  buffer_store_dwordx4 a[40:43], v2, s[4:7], s42 offen offset:2048 sc1
  buffer_store_dwordx4 a[44:47], v2, s[4:7], s42 offen offset:3072 sc1
  s_add_u32 s42, s42, 4096
  buffer_store_dwordx4 a[48:51], v2, s[4:7], s42 offen offset:0 sc1
  buffer_store_dwordx4 a[52:55], v2, s[4:7], s42 offen offset:1024 sc1
  buffer_store_dwordx4 a[56:59], v2, s[4:7], s42 offen offset:2048 sc1
  buffer_store_dwordx4 a[60:63], v2, s[4:7], s42 offen offset:3072 sc1
  s_lshl_b32 s40, s40, 7
  s_add_u32 s43, s40, 0x3d04000
  s_waitcnt vmcnt(0)
  s_barrier
  s_cmp_lg_u32 s32, 0
  s_cbranch_scc1 L_sig_25
  v_mov_b32 v254, 1
  v_mov_b32 v255, 0
  s_mov_b64 exec, 1
  buffer_atomic_add v254, v255, s[4:7], s43 offen offset:0 sc1
  s_mov_b64 exec, -1
L_sig_25:
  s_cmp_lg_u32 s32, 0
  s_cbranch_scc1 L_dd_27
  v_mov_b32 v228, 0x3d00000
  v_mov_b32 v232, 0x3d04000
L_dw_26:
  buffer_load_dword v234, v232, s[4:7], s40 offen offset:0 sc1
  s_waitcnt vmcnt(0)
  s_mov_b32 s44, 1
  v_readfirstlane_b32 s45, v234
  s_cmp_ge_u32 s45, 8
  s_cselect_b32 s44, s44, 0
  s_cmp_eq_u32 s44, 1
  s_cbranch_scc1 L_dd_27
  s_sleep 1
  s_add_u32 s3, s3, 1
  s_cmp_lt_u32 s3, 131072
  s_cbranch_scc1 L_dw_26
L_dd_27:
  s_barrier
  s_cmp_lg_u32 s32, 0
  s_cbranch_scc1 L_rq_28
  s_cmp_eq_u32 s39, 0
  s_cbranch_scc1 L_rq_28
  s_lshl_b32 s99, s33, 7
  s_add_u32 s99, s99, 0x3d00200
  v_mov_b32 v244, 1
  v_mov_b32 v245, 0
  s_mov_b64 exec, 1
  buffer_atomic_add v244, v245, s[4:7], s99 offen sc0 sc1
  s_mov_b64 exec, -1
L_rq_28:
  s_lshl_b32 s90, s48, 11
  s_add_u32 s41, s41, s90
  buffer_load_dwordx4 v[16:19], v2, s[4:7], s41 offen offset:0 sc1
  buffer_load_dwordx4 v[20:23], v2, s[4:7], s41 offen offset:1024 sc1
  s_add_u32 s41, s41, 0x10000
  buffer_load_dwordx4 v[24:27], v2, s[4:7], s41 offen offset:0 sc1
  buffer_load_dwordx4 v[28:31], v2, s[4:7], s41 offen offset:1024 sc1
  s_add_u32 s41, s41, 0x10000
  buffer_load_dwordx4 v[32:35], v2, s[4:7], s41 offen offset:0 sc1
  buffer_load_dwordx4 v[36:39], v2, s[4:7], s41 offen offset:1024 sc1
  s_add_u32 s41, s41, 0x10000
  buffer_load_dwordx4 v[40:43], v2, s[4:7], s41 offen offset:0 sc1
  buffer_load_dwordx4 v[44:47], v2, s[4:7], s41 offen offset:1024 sc1
  s_add_u32 s41, s41, 0x10000
  buffer_load_dwordx4 v[48:51], v2, s[4:7], s41 offen offset:0 sc1
  buffer_load_dwordx4 v[52:55], v2, s[4:7], s41 offen offset:1024 sc1
  s_add_u32 s41, s41, 0x10000
  buffer_load_dwordx4 v[56:59], v2, s[4:7], s41 offen offset:0 sc1
  buffer_load_dwordx4 v[60:63], v2, s[4:7], s41 offen offset:1024 sc1
  s_add_u32 s41, s41, 0x10000
  buffer_load_dwordx4 v[64:67], v2, s[4:7], s41 offen offset:0 sc1
  buffer_load_dwordx4 v[68:71], v2, s[4:7], s41 offen offset:1024 sc1
  s_add_u32 s41, s41, 0x10000
  buffer_load_dwordx4 v[72:75], v2, s[4:7], s41 offen offset:0 sc1
  buffer_load_dwordx4 v[76:79], v2, s[4:7], s41 offen offset:1024 sc1
  s_add_u32 s41, s41, 0x10000
  v_mov_b32 v3, 0x0
  v_bfe_u32 v4, v1, 0, 4
  v_lshl_add_u32 v3, v4, 12, v3
  v_bfe_u32 v4, v1, 4, 2
  v_lshl_add_u32 v3, v4, 4, v3
  s_lshr_b32 s90, s32, 1
  s_lshl_b32 s90, s90, 18
  s_add_u32 s22, s22, s90
  s_and_b32 s90, s32, 1
  s_lshl_b32 s90, s90, 7
  s_add_u32 s22, s22, s90
  s_lshr_b32 s90, s48, 1
  s_lshl_b32 s90, s90, 16
  s_add_u32 s22, s22, s90
  s_and_b32 s90, s48, 1
  s_lshl_b32 s90, s90, 6
  s_add_u32 s22, s22, s90
  s_waitcnt vmcnt(12)
  v_pk_add_f32 v[16:17], v[16:17], v[24:25]
  v_pk_add_f32 v[18:19], v[18:19], v[26:27]
  v_pk_add_f32 v[20:21], v[20:21], v[28:29]
  v_pk_add_f32 v[22:23], v[22:23], v[30:31]
  s_waitcnt vmcnt(10)
  v_pk_add_f32 v[16:17], v[16:17], v[32:33]
  v_pk_add_f32 v[18:19], v[18:19], v[34:35]
  v_pk_add_f32 v[20:21], v[20:21], v[36:37]
  v_pk_add_f32 v[22:23], v[22:23], v[38:39]
  s_waitcnt vmcnt(8)
  v_pk_add_f32 v[16:17], v[16:17], v[40:41]
  v_pk_add_f32 v[18:19], v[18:19], v[42:43]
  v_pk_add_f32 v[20:21], v[20:21], v[44:45]
  v_pk_add_f32 v[22:23], v[22:23], v[46:47]
  s_waitcnt vmcnt(6)
  v_pk_add_f32 v[16:17], v[16:17], v[48:49]
  v_pk_add_f32 v[18:19], v[18:19], v[50:51]
  v_pk_add_f32 v[20:21], v[20:21], v[52:53]
  v_pk_add_f32 v[22:23], v[22:23], v[54:55]
  s_waitcnt vmcnt(4)
  v_pk_add_f32 v[16:17], v[16:17], v[56:57]
  v_pk_add_f32 v[18:19], v[18:19], v[58:59]
  v_pk_add_f32 v[20:21], v[20:21], v[60:61]
  v_pk_add_f32 v[22:23], v[22:23], v[62:63]
  s_waitcnt vmcnt(2)
  v_pk_add_f32 v[16:17], v[16:17], v[64:65]
  v_pk_add_f32 v[18:19], v[18:19], v[66:67]
  v_pk_add_f32 v[20:21], v[20:21], v[68:69]
  v_pk_add_f32 v[22:23], v[22:23], v[70:71]
  s_waitcnt vmcnt(0)
  v_pk_add_f32 v[16:17], v[16:17], v[72:73]
  v_pk_add_f32 v[18:19], v[18:19], v[74:75]
  v_pk_add_f32 v[20:21], v[20:21], v[76:77]
  v_pk_add_f32 v[22:23], v[22:23], v[78:79]
  v_cvt_pk_bf16_f32 v8, v16, v17
  v_cvt_pk_bf16_f32 v9, v18, v19
  v_cvt_pk_bf16_f32 v10, v20, v21
  v_cvt_pk_bf16_f32 v11, v22, v23
  buffer_store_dwordx4 v[8:11], v3, s[16:19], s22 offen
  s_branch L_got
L_done:
  s_waitcnt vmcnt(0)
  s_barrier
  s_add_u32 s38, s38, 0x3d00000
  s_cmp_lg_u32 s32, 0
  s_cbranch_scc1 L_sig_29
  v_mov_b32 v254, s98
  v_mov_b32 v255, 0
  s_mov_b64 exec, 1
  buffer_atomic_add v254, v255, s[4:7], s38 offen offset:0 sc1
  s_mov_b64 exec, -1
L_sig_29:
  s_mov_b32 s59, 0
  s_branch L_got
L_exit:
  s_endpgm
.p2align 2
L_table:
.long 0x9
.long 0xa
.long 0x10009
.long 0x1000a
.long 0x20009
.long 0x2000a
.long 0x30009
.long 0x3000a
.long 0x40009
.long 0x4000a
.long 0x50009
.long 0x5000a
.long 0x60009
.long 0x6000a
.long 0x70009
.long 0x7000a
.long 0x109
.long 0x10a
.long 0x10109
.long 0x1010a
.long 0x20109
.long 0x2010a
.long 0x30109
.long 0x3010a
.long 0x40109
.long 0x4010a
.long 0x50109
.long 0x5010a
.long 0x60109
.long 0x6010a
.long 0x70109
.long 0x7010a
.long 0x209
.long 0x20a
.long 0x10209
.long 0x1020a
.long 0x20209
.long 0x2020a
.long 0x30209
.long 0x3020a
.long 0x40209
.long 0x4020a
.long 0x50209
.long 0x5020a
.long 0x60209
.long 0x6020a
.long 0x70209
.long 0x7020a
.long 0x309
.long 0x30a
.long 0x10309
.long 0x1030a
.long 0x20309
.long 0x2030a
.long 0x30309
.long 0x3030a
.long 0x40309
.long 0x4030a
.long 0x50309
.long 0x5030a
.long 0x60309
.long 0x6030a
.long 0x70309
.long 0x7030a
.long 0xc
.long 0x10c
.long 0x20c
.long 0x30c
.long 0x201
.long 0x202
.long 0x10201
.long 0x10202
.long 0x20201
.long 0x20202
.long 0x30201
.long 0x30202
.long 0x301
.long 0x302
.long 0x10301
.long 0x10302
.long 0x20301
.long 0x20302
.long 0x30301
.long 0x30302
.long 0x0
.long 0x10000
.long 0x20000
.long 0x30000
.long 0x100
.long 0x10100
.long 0x20100
.long 0x30100
.long 0x401
.long 0x402
.long 0x10401
.long 0x10402
.long 0x20401
.long 0x20402
.long 0x30401
.long 0x30402
.long 0x501
.long 0x502
.long 0x10501
.long 0x10502
.long 0x20501
.long 0x20502
.long 0x30501
.long 0x30502
.long 0x200
.long 0x10200
.long 0x20200
.long 0x30200
.long 0x300
.long 0x10300
.long 0x20300
.long 0x30300
.long 0x601
.long 0x602
.long 0x10601
.long 0x10602
.long 0x20601
.long 0x20602
.long 0x30601
.long 0x30602
.long 0x701
.long 0x702
.long 0x10701
.long 0x10702
.long 0xb
.long 0x1000b
.long 0x40b
.long 0x1040b
.long 0x80b
.long 0x1080b
.long 0xc0b
.long 0x10c0b
.long 0x400
.long 0x10400
.long 0x20400
.long 0x30400
.long 0x20701
.long 0x20702
.long 0x30701
.long 0x30702
.long 0x500
.long 0x10500
.long 0x20500
.long 0x30500
.long 0x600
.long 0x10600
.long 0x20600
.long 0x30600
.long 0x700
.long 0x10700
.long 0x20700
.long 0x30700
.long 0x100b
.long 0x1100b
.long 0x140b
.long 0x1140b
.long 0x3
.long 0x10003
.long 0x20003
.long 0x103
.long 0x7
.long 0x10007
.long 0x107
.long 0x10107
.long 0x180b
.long 0x1180b
.long 0x207
.long 0x10207
.long 0x1c0b
.long 0x11c0b
.long 0x307
.long 0x10307
.long 0x407
.long 0x10407
.long 0x507
.long 0x10507
.long 0x10103
.long 0x20103
.long 0x203
.long 0x10203
.long 0x20203
.long 0x303
.long 0x10303
.long 0x20303
.long 0x403
.long 0x10403
.long 0x20403
.long 0x503
.long 0x10503
.long 0x20503
.long 0x607
.long 0x10607
.long 0x603
.long 0x10603
.long 0x200b
.long 0x1200b
.long 0x240b
.long 0x1240b
.long 0x707
.long 0x10707
.long 0x20603
.long 0x703
.long 0x10703
.long 0x20703
.long 0x807
.long 0x10807
.long 0x4
.long 0x10004
.long 0x20004
.long 0x30004
.long 0x280b
.long 0x1280b
.long 0x104
.long 0x10104
.long 0x20104
.long 0x30104
.long 0x204
.long 0x10204
.long 0x20204
.long 0x30204
.long 0x907
.long 0x10907
.long 0x304
.long 0x10304
.long 0x5
.long 0x10005
.long 0x105
.long 0x10105
.long 0x20304
.long 0x30304
.long 0x404
.long 0x10404
.long 0x20404
.long 0x30404
.long 0x504
.long 0x10504
.long 0x20504
.long 0x30504
.long 0x205
.long 0x10205
.long 0x305
.long 0x10305
.long 0x405
.long 0x10405
.long 0x2c0b
.long 0x12c0b
.long 0x3006
.long 0x13006
.long 0x3106
.long 0x13106
.long 0x3206
.long 0x13206
.long 0x3306
.long 0x13306
.long 0x505
.long 0x10505
.long 0x3406
.long 0x13406
.long 0xa07
.long 0x10a07
.long 0x3506
.long 0x13506
.long 0x605
.long 0x10605
.long 0x3606
.long 0x13606
.long 0x705
.long 0x10705
.long 0x805
.long 0x10805
.long 0x3706
.long 0x13706
.long 0x905
.long 0x10905
.long 0xa05
.long 0x10a05
.long 0xb05
.long 0x10b05
.long 0xb07
.long 0x10b07
.long 0x3806
.long 0x13806
.long 0x604
.long 0x10604
.long 0x3906
.long 0x13906
.long 0xc07
.long 0x10c07
.long 0x3a06
.long 0x13a06
.long 0x20604
.long 0x30604
.long 0x704
.long 0x10704
.long 0x20704
.long 0x30704
.long 0x3b06
.long 0x13b06
.long 0xd08
.long 0x10d08
.long 0x20d08
.long 0x30d08
.long 0x40d08
.long 0x50d08
.long 0x60d08
.long 0x70d08
.long 0x3c06
.long 0x13c06
.long 0x80d08
.long 0x90d08
.long 0xa0d08
.long 0xb0d08
.long 0xc0d08
.long 0xd0d08
.long 0x3d06
.long 0x13d06
.long 0x3e06
.long 0x13e06
.long 0x3f06
.long 0x13f06
.long 0xe0d08
.long 0xf0d08
.long 0xe08
.long 0x10e08
.long 0x20e08
.long 0x30e08
.long 0x40e08
.long 0x50e08
.long 0x60e08
.long 0x70e08
.long 0x80e08
.long 0x90e08
.long 0xa0e08
.long 0xb0e08
.long 0xc0e08
.long 0xd0e08
.long 0xe0e08
.long 0xf0e08
.long 0xf08
.long 0x10f08
.long 0x20f08
.long 0x30f08
.long 0x40f08
.long 0x50f08
.long 0x60f08
.long 0x70f08
.long 0x80f08
.long 0x90f08
.long 0xa0f08
.long 0xb0f08
.long 0xc0f08
.long 0xd0f08
.long 0xe0f08
.long 0xf0f08
.long 0xc05
.long 0x10c05
.long 0xd05
.long 0x10d05
.long 0xe05
.long 0x10e05
.long 0xf05
.long 0x10f05
.long 0xf
.long 0x0
.long 0x0
.long 0x0
.section .rodata,"a"
.p2align 6
.amdhsa_kernel concat_heads__memory_aug_recurrent_mem_tr__sliding_local_dilated__prompt_kernel
  .amdhsa_next_free_vgpr 512
  .amdhsa_next_free_sgpr 102
  .amdhsa_accum_offset 256
  .amdhsa_group_segment_fixed_size 0
  .amdhsa_kernarg_size 104
  .amdhsa_user_sgpr_count 2
  .amdhsa_user_sgpr_kernarg_segment_ptr 1
  .amdhsa_system_sgpr_workgroup_id_x 1
  .amdhsa_float_denorm_mode_32 3
  .amdhsa_float_denorm_mode_16_64 3
.end_amdhsa_kernel
```

```asm
; @launch grid=(256,1,1) block=(256,1,1) lds=131136
.amdgcn_target "amdgcn-amd-amdhsa--gfx950"
.text
.globl concat_heads__memory_aug_recurrent_mem_tr__sliding_local_dilated__prompt_kernel
.p2align 8
.type concat_heads__memory_aug_recurrent_mem_tr__sliding_local_dilated__prompt_kernel,@function
concat_heads__memory_aug_recurrent_mem_tr__sliding_local_dilated__prompt_kernel:
  s_cmp_ge_u32 s2, 256
  s_cbranch_scc1 L_exit
  s_load_dwordx4 s[92:95], s[0:1], 88
  s_load_dwordx16 s[64:79], s[0:1], 0
  s_getreg_b32 s39, hwreg(HW_REG_XCC_ID, 0, 3)
  v_lshrrev_b32 v2, 6, v0
  s_nop 0
  v_readfirstlane_b32 s32, v2
  s_mov_b32 s3, 0
  s_getpc_b64 s[86:87]
L_pc0:
  s_lshr_b32 s90, s2, 3
  s_lshl_b32 s90, s90, 2
  s_add_u32 s90, s90, s32
  s_and_b32 s90, s90, 31
  s_lshl_b32 s90, s90, 12
  v_and_b32 v1, 63, v0
  v_lshlrev_b32 v1, 6, v1
  v_add_u32 v1, s90, v1
  v_min_u32 v1, L_table-L_pc0, v1
  global_load_dword v199, v1, s[86:87]
  s_waitcnt lgkmcnt(0)
  s_mov_b32 s4, s94
  s_and_b32 s5, s95, 0xffff
  s_mov_b32 s6, 0x10000000
  s_mov_b32 s7, 0x20000
  s_mov_b32 s28, s92
  s_and_b32 s29, s93, 0xffff
  s_mov_b32 s30, 0x100
  s_mov_b32 s31, 0x20000
  s_mov_b32 s100, 0
  s_lshr_b32 s41, s2, 3
  s_lshl_b32 s101, 1, s41
  s_cmp_lg_u32 s32, 0
  s_cbranch_scc1 L_sweep
  s_lshl_b32 s90, s39, 2
  v_mov_b32 v247, s101
  v_mov_b32 v2, 0
  s_mov_b64 exec, 1
  buffer_atomic_or v247, v2, s[28:31], s90 offen offset:0 sc0 sc1
  s_mov_b64 exec, -1
L_sweep:
  s_lshl_b32 s40, s39, 5
  s_add_u32 s40, s40, s41
  s_mov_b32 s43, 1
  s_branch L_role
L_fallback:
  s_load_dwordx4 s[92:95], s[0:1], 88
  s_load_dwordx16 s[64:79], s[0:1], 0
  s_getreg_b32 s39, hwreg(HW_REG_XCC_ID, 0, 3)
  s_mov_b32 s100, 4
  v_mbcnt_lo_u32_b32 v0, -1, 0
  v_mbcnt_hi_u32_b32 v0, -1, v0
  s_lshl_b32 s90, s32, 6
  v_add_u32 v0, s90, v0
  s_waitcnt vmcnt(0) lgkmcnt(0)
  s_barrier
  s_cmp_lg_u32 s32, 0
  s_cbranch_scc1 L_tkd
  s_lshl_b32 s90, s39, 2
  v_mov_b32 v1, 1
  v_mov_b32 v2, 0
  v_lshlrev_b32 v3, 2, v0
  s_mov_b64 exec, 1
  buffer_atomic_add v1, v2, s[28:31], s90 offen offset:192 sc0 sc1
  s_mov_b64 exec, 0xff
L_tkw:
  buffer_load_dword v4, v3, s[28:31], 0 offen offset:192 sc1
  s_waitcnt vmcnt(0)
  v_readfirstlane_b32 s40, v1
  s_mov_b32 s41, 0
  s_mov_b32 s42, 0
  s_mov_b32 s43, 1
  v_readlane_b32 s44, v4, 0
  s_add_u32 s41, s41, s44
  s_cmp_gt_u32 s39, 0
  s_cselect_b32 s45, s44, 0
  s_add_u32 s42, s42, s45
  s_cmp_eq_u32 s44, 32
  s_cselect_b32 s43, s43, 0
  v_readlane_b32 s44, v4, 1
  s_add_u32 s41, s41, s44
  s_cmp_gt_u32 s39, 1
  s_cselect_b32 s45, s44, 0
  s_add_u32 s42, s42, s45
  s_cmp_eq_u32 s44, 32
  s_cselect_b32 s43, s43, 0
  v_readlane_b32 s44, v4, 2
  s_add_u32 s41, s41, s44
  s_cmp_gt_u32 s39, 2
  s_cselect_b32 s45, s44, 0
  s_add_u32 s42, s42, s45
  s_cmp_eq_u32 s44, 32
  s_cselect_b32 s43, s43, 0
  v_readlane_b32 s44, v4, 3
  s_add_u32 s41, s41, s44
  s_cmp_gt_u32 s39, 3
  s_cselect_b32 s45, s44, 0
  s_add_u32 s42, s42, s45
  s_cmp_eq_u32 s44, 32
  s_cselect_b32 s43, s43, 0
  v_readlane_b32 s44, v4, 4
  s_add_u32 s41, s41, s44
  s_cmp_gt_u32 s39, 4
  s_cselect_b32 s45, s44, 0
  s_add_u32 s42, s42, s45
  v_readlane_b32 s44, v4, 5
  s_add_u32 s41, s41, s44
  s_cmp_gt_u32 s39, 5
  s_cselect_b32 s45, s44, 0
  s_add_u32 s42, s42, s45
  v_readlane_b32 s44, v4, 6
  s_add_u32 s41, s41, s44
  s_cmp_gt_u32 s39, 6
  s_cselect_b32 s45, s44, 0
  s_add_u32 s42, s42, s45
  v_readlane_b32 s44, v4, 7
  s_add_u32 s41, s41, s44
  s_cmp_gt_u32 s39, 7
  s_cselect_b32 s45, s44, 0
  s_add_u32 s42, s42, s45
  s_add_u32 s3, s3, 1
  s_cmp_ge_u32 s3, 131072
  s_cbranch_scc1 L_tkbad
  s_sleep 4
  s_cmp_lt_u32 s41, 256
  s_cbranch_scc1 L_tkw
  s_add_u32 s40, s40, s42
  s_lshl_b32 s43, s43, 16
  s_or_b32 s40, s40, s43
  s_branch L_tkok
L_tkbad:
  s_mov_b32 s40, 0xffff
L_tkok:
  s_mov_b64 exec, -1
  v_mov_b32 v1, s40
  v_mov_b32 v2, 131072
  ds_write_b32 v2, v1
  s_waitcnt lgkmcnt(0)
L_tkd:
  s_barrier
  v_mov_b32 v2, 131072
  ds_read_b32 v1, v2
  s_waitcnt lgkmcnt(0)
  v_readfirstlane_b32 s40, v1
  s_barrier
  s_lshr_b32 s43, s40, 16
  s_and_b32 s40, s40, 0xffff
  s_cmp_ge_u32 s40, 256
  s_cbranch_scc1 L_exit
L_role:
  s_cmp_ge_u32 s40, 128
  s_cbranch_scc1 L_worker
  s_lshr_b32 s33, s40, 5
  s_and_b32 s34, s40, 31
  s_cmp_eq_u32 s43, 0
  s_cbranch_scc1 L_recslow
  s_load_dwordx4 s[80:83], s[0:1], 8
  s_load_dwordx4 s[84:87], s[0:1], 24
  s_load_dwordx2 s[88:89], s[0:1], 40
  v_lshrrev_b32 v31, 6, v0
  s_nop 0
  v_readfirstlane_b32 s32, v31
  v_and_b32 v0, 63, v0
  s_lshr_b32 s35, s34, 4
  s_lshl_b32 s90, s33, 1
  s_add_u32 s35, s35, s90
  s_and_b32 s36, s34, 15
  s_lshr_b32 s37, s36, 2
  s_lshl_b32 s90, s35, 2
  s_add_u32 s37, s37, s90
  s_and_b32 s38, s36, 3
  s_waitcnt lgkmcnt(0)
  s_mov_b32 s24, s80
  s_and_b32 s25, s81, 0xffff
  s_mov_b32 s26, 0x4000
  s_mov_b32 s27, 0x20000
  s_mov_b32 s8, s82
  s_and_b32 s9, s83, 0xffff
  s_mov_b32 s10, 0x800000
  s_mov_b32 s11, 0x20000
  s_mov_b32 s12, s84
  s_and_b32 s13, s85, 0xffff
  s_mov_b32 s14, 0x800000
  s_mov_b32 s15, 0x20000
  s_mov_b32 s16, s86
  s_and_b32 s17, s87, 0xffff
  s_mov_b32 s18, 0x800000
  s_mov_b32 s19, 0x20000
  s_mov_b32 s20, s88
  s_and_b32 s21, s89, 0xffff
  s_mov_b32 s22, 0x800000
  s_mov_b32 s23, 0x20000
  s_lshl_b32 s90, s32, 21
  s_lshl_b32 s91, s37, 8
  s_add_u32 s90, s90, s91
  s_lshr_b32 s91, s38, 1
  s_lshl_b32 s91, s91, 7
  s_add_u32 s90, s90, s91
  v_mov_b32 v180, 0x0
  v_bfe_u32 v31, v0, 3, 3
  v_lshl_add_u32 v180, v31, 13, v180
  v_bfe_u32 v31, v0, 0, 3
  v_lshl_add_u32 v180, v31, 4, v180
  v_add_u32 v180, s90, v180
  v_xor_b32 v185, 128, v180
  s_lshl_b32 s90, s35, 2
  s_add_u32 s90, s90, s32
  s_lshl_b32 s90, s90, 18
  s_lshl_b32 s91, s36, 7
  s_add_u32 s90, s90, s91
  v_mov_b32 v181, 0x0
  v_bfe_u32 v31, v0, 3, 3
  v_lshl_add_u32 v181, v31, 11, v181
  v_bfe_u32 v31, v0, 0, 3
  v_lshl_add_u32 v181, v31, 4, v181
  v_add_u32 v181, s90, v181
  s_lshl_b32 s96, s32, 15
  s_and_b32 s91, s38, 1
  s_lshl_b32 s91, s91, 6
  s_add_u32 s91, s91, s96
  v_mov_b32 v182, 0x0
  v_bfe_u32 v31, v0, 5, 1
  v_lshl_add_u32 v182, v31, 11, v182
  v_bfe_u32 v31, v0, 4, 1
  v_lshl_add_u32 v182, v31, 10, v182
  v_bfe_u32 v31, v0, 2, 2
  v_lshl_add_u32 v182, v31, 7, v182
  v_bfe_u32 v31, v0, 0, 2
  v_lshl_add_u32 v182, v31, 3, v182
  v_add_u32 v182, s91, v182
  s_lshl_b32 s91, s32, 5
  v_mov_b32 v183, 0x0
  v_bfe_u32 v31, v0, 4, 1
  v_lshl_add_u32 v183, v31, 13, v183
  v_bfe_u32 v31, v0, 5, 1
  v_lshl_add_u32 v183, v31, 8, v183
  v_bfe_u32 v31, v0, 2, 1
  v_lshl_add_u32 v183, v31, 10, v183
  v_bfe_u32 v31, v0, 3, 1
  v_lshl_add_u32 v183, v31, 7, v183
  v_bfe_u32 v31, v0, 0, 2
  v_lshl_add_u32 v183, v31, 3, v183
  v_add_u32 v183, s91, v183
  v_add_u32 v184, 0x10000, v183
  s_lshl_b32 s97, s34, 2
  s_add_u32 s97, s97, s32
  s_lshl_b32 s98, s97, 14
  s_lshl_b32 s91, s33, 21
  s_add_u32 s98, s98, s91
  s_lshl_b32 s97, s97, 16
  s_lshl_b32 s91, s33, 11
  s_add_u32 s97, s97, s91
  v_mov_b32 v16, 0x0
  v_bfe_u32 v31, v0, 0, 4
  v_lshl_add_u32 v16, v31, 7, v16
  v_bfe_u32 v31, v0, 4, 2
  v_lshl_add_u32 v16, v31, 13, v16
  v_add_u32 v17, 0x8000, v16
  v_lshlrev_b32 v18, 7, v0
  v_add_u32 v19, 0x2000, v18
  s_lshl_b32 s58, s33, 5
  s_add_u32 s58, s58, s34
  s_lshl_b32 s59, s32, 19
  s_add_u32 s59, s59, 0x3800000
  s_lshl_b32 s90, s58, 11
  s_add_u32 s90, s90, s59
  s_mul_i32 s91, s58, 3072
  s_add_u32 s91, s91, s59
  s_add_u32 s91, s91, 0x200000
  v_lshlrev_b32 v6, 4, v0
  v_mov_b32 v8, -1
  v_mov_b32 v12, 0
  v_mov_b32 v9, -1
  v_mov_b32 v13, 0
  v_mov_b32 v10, -1
  v_mov_b32 v14, 0
  v_mov_b32 v11, -1
  v_mov_b32 v15, 0
  buffer_store_dwordx4 v[8:11], v6, s[4:7], s90 offen offset:0 sc1
  buffer_store_dwordx4 v[8:11], v6, s[4:7], s90 offen offset:1024 sc1
  buffer_store_dwordx4 v[8:11], v6, s[4:7], s91 offen offset:0 sc1
  buffer_store_dwordx4 v[8:11], v6, s[4:7], s91 offen offset:1024 sc1
  buffer_store_dwordx4 v[8:11], v6, s[4:7], s91 offen offset:2048 sc1
  s_lshl_b32 s58, s58, 2
  s_add_u32 s58, s58, s32
  s_cmp_ge_u32 s58, 36
  s_cbranch_scc1 FL_nz_1
  s_lshl_b32 s90, s58, 10
  s_add_u32 s90, s90, 0x3d00000
  buffer_store_dwordx4 v[12:15], v6, s[4:7], s90 offen sc1
FL_nz_1:
  s_cmp_lg_u32 s58, 3
  s_cbranch_scc1 FL_np_2
  v_mov_b32 v6, 0x3840000
  v_bfe_u32 v31, v0, 0, 1
  v_lshl_add_u32 v6, v31, 13, v6
  v_bfe_u32 v31, v0, 1, 1
  s_mov_b32 s99, 4352
  v_mad_u32_u24 v6, v31, s99, v6
  v_bfe_u32 v31, v0, 2, 2
  s_mov_b32 s99, 82432
  v_mad_u32_u24 v6, v31, s99, v6
  v_mov_b32 v7, -1
  s_mov_b64 exec, 0xffff
  buffer_store_dword v7, v6, s[4:7], 0 offen sc1
  s_mov_b64 exec, -1
  s_waitcnt vmcnt(0)
FL_np_2:
  s_add_u32 m0, s96, 0
  s_mov_b32 s90, 0x0
  buffer_load_dwordx4 v180, s[12:15], s90 offen  lds
  s_add_u32 m0, s96, 1024
  s_mov_b32 s90, 0x10000
  buffer_load_dwordx4 v180, s[12:15], s90 offen  lds
  s_add_u32 m0, s96, 2048
  s_mov_b32 s90, 0x20000
  buffer_load_dwordx4 v180, s[12:15], s90 offen  lds
  s_add_u32 m0, s96, 3072
  s_mov_b32 s90, 0x30000
  buffer_load_dwordx4 v180, s[12:15], s90 offen  lds
  s_add_u32 m0, s96, 4096
  s_mov_b32 s90, 0x0
  buffer_load_dwordx4 v185, s[16:19], s90 offen  lds
  s_add_u32 m0, s96, 5120
  s_mov_b32 s90, 0x10000
  buffer_load_dwordx4 v185, s[16:19], s90 offen  lds
  s_add_u32 m0, s96, 6144
  s_mov_b32 s90, 0x20000
  buffer_load_dwordx4 v185, s[16:19], s90 offen  lds
  s_add_u32 m0, s96, 7168
  s_mov_b32 s90, 0x30000
  buffer_load_dwordx4 v185, s[16:19], s90 offen  lds
  s_add_u32 m0, s96, 8192
  s_mov_b32 s90, 0x40000
  buffer_load_dwordx4 v180, s[12:15], s90 offen  lds
  s_add_u32 m0, s96, 9216
  s_mov_b32 s90, 0x50000
  buffer_load_dwordx4 v180, s[12:15], s90 offen  lds
  s_add_u32 m0, s96, 10240
  s_mov_b32 s90, 0x60000
  buffer_load_dwordx4 v180, s[12:15], s90 offen  lds
  s_add_u32 m0, s96, 11264
  s_mov_b32 s90, 0x70000
  buffer_load_dwordx4 v180, s[12:15], s90 offen  lds
  s_add_u32 m0, s96, 12288
  s_mov_b32 s90, 0x40000
  buffer_load_dwordx4 v185, s[16:19], s90 offen  lds
  s_add_u32 m0, s96, 13312
  s_mov_b32 s90, 0x50000
  buffer_load_dwordx4 v185, s[16:19], s90 offen  lds
  s_add_u32 m0, s96, 14336
  s_mov_b32 s90, 0x60000
  buffer_load_dwordx4 v185, s[16:19], s90 offen  lds
  s_add_u32 m0, s96, 15360
  s_mov_b32 s90, 0x70000
  buffer_load_dwordx4 v185, s[16:19], s90 offen  lds
  s_add_u32 m0, s96, 16384
  s_mov_b32 s90, 0x80000
  buffer_load_dwordx4 v180, s[12:15], s90 offen  lds
  s_add_u32 m0, s96, 17408
  s_mov_b32 s90, 0x90000
  buffer_load_dwordx4 v180, s[12:15], s90 offen  lds
  s_add_u32 m0, s96, 18432
  s_mov_b32 s90, 0xa0000
  buffer_load_dwordx4 v180, s[12:15], s90 offen  lds
  s_add_u32 m0, s96, 19456
  s_mov_b32 s90, 0xb0000
  buffer_load_dwordx4 v180, s[12:15], s90 offen  lds
  s_add_u32 m0, s96, 20480
  s_mov_b32 s90, 0x80000
  buffer_load_dwordx4 v185, s[16:19], s90 offen  lds
  s_add_u32 m0, s96, 21504
  s_mov_b32 s90, 0x90000
  buffer_load_dwordx4 v185, s[16:19], s90 offen  lds
  s_add_u32 m0, s96, 22528
  s_mov_b32 s90, 0xa0000
  buffer_load_dwordx4 v185, s[16:19], s90 offen  lds
  s_add_u32 m0, s96, 23552
  s_mov_b32 s90, 0xb0000
  buffer_load_dwordx4 v185, s[16:19], s90 offen  lds
  s_add_u32 m0, s96, 24576
  s_mov_b32 s90, 0xc0000
  buffer_load_dwordx4 v180, s[12:15], s90 offen  lds
  s_add_u32 m0, s96, 25600
  s_mov_b32 s90, 0xd0000
  buffer_load_dwordx4 v180, s[12:15], s90 offen  lds
  s_add_u32 m0, s96, 26624
  s_mov_b32 s90, 0xe0000
  buffer_load_dwordx4 v180, s[12:15], s90 offen  lds
  s_add_u32 m0, s96, 27648
  s_mov_b32 s90, 0xf0000
  buffer_load_dwordx4 v180, s[12:15], s90 offen  lds
  s_add_u32 m0, s96, 28672
  s_mov_b32 s90, 0xc0000
  buffer_load_dwordx4 v185, s[16:19], s90 offen  lds
  s_add_u32 m0, s96, 29696
  s_mov_b32 s90, 0xd0000
  buffer_load_dwordx4 v185, s[16:19], s90 offen  lds
  s_add_u32 m0, s96, 30720
  s_mov_b32 s90, 0xe0000
  buffer_load_dwordx4 v185, s[16:19], s90 offen  lds
  s_add_u32 m0, s96, 31744
  s_mov_b32 s90, 0xf0000
  buffer_load_dwordx4 v185, s[16:19], s90 offen  lds
  s_cmp_lg_u32 s58, 3
  s_cbranch_scc1 FL_np_3
  s_add_u32 s92, s94, 0x3840000
  s_addc_u32 s93, s95, 0
  s_mov_b32 s62, -1
  s_mov_b32 s63, -1
  s_memtime s[56:57]
  s_waitcnt lgkmcnt(0)
  s_load_dword s60, s[92:93], 0x0
  s_waitcnt lgkmcnt(0)
  s_memtime s[58:59]
  s_waitcnt lgkmcnt(0)
  s_sub_u32 s58, s58, s56
  s_min_u32 s62, s62, s58
  s_memtime s[56:57]
  s_waitcnt lgkmcnt(0)
  s_load_dword s60, s[92:93], 0x2000
  s_waitcnt lgkmcnt(0)
  s_memtime s[58:59]
  s_waitcnt lgkmcnt(0)
  s_sub_u32 s58, s58, s56
  s_min_u32 s63, s63, s58
  s_memtime s[56:57]
  s_waitcnt lgkmcnt(0)
  s_load_dword s60, s[92:93], 0x1100
  s_waitcnt lgkmcnt(0)
  s_memtime s[58:59]
  s_waitcnt lgkmcnt(0)
  s_sub_u32 s58, s58, s56
  s_min_u32 s62, s62, s58
  s_memtime s[56:57]
  s_waitcnt lgkmcnt(0)
  s_load_dword s60, s[92:93], 0x3100
  s_waitcnt lgkmcnt(0)
  s_memtime s[58:59]
  s_waitcnt lgkmcnt(0)
  s_sub_u32 s58, s58, s56
  s_min_u32 s63, s63, s58
  s_memtime s[56:57]
  s_waitcnt lgkmcnt(0)
  s_load_dword s60, s[92:93], 0x14200
  s_waitcnt lgkmcnt(0)
  s_memtime s[58:59]
  s_waitcnt lgkmcnt(0)
  s_sub_u32 s58, s58, s56
  s_min_u32 s62, s62, s58
  s_memtime s[56:57]
  s_waitcnt lgkmcnt(0)
  s_load_dword s60, s[92:93], 0x16200
  s_waitcnt lgkmcnt(0)
  s_memtime s[58:59]
  s_waitcnt lgkmcnt(0)
  s_sub_u32 s58, s58, s56
  s_min_u32 s63, s63, s58
  s_memtime s[56:57]
  s_waitcnt lgkmcnt(0)
  s_load_dword s60, s[92:93], 0x15300
  s_waitcnt lgkmcnt(0)
  s_memtime s[58:59]
  s_waitcnt lgkmcnt(0)
  s_sub_u32 s58, s58, s56
  s_min_u32 s62, s62, s58
  s_memtime s[56:57]
  s_waitcnt lgkmcnt(0)
  s_load_dword s60, s[92:93], 0x17300
  s_waitcnt lgkmcnt(0)
  s_memtime s[58:59]
  s_waitcnt lgkmcnt(0)
  s_sub_u32 s58, s58, s56
  s_min_u32 s63, s63, s58
  s_cmp_lt_u32 s63, s62
  s_cselect_b32 s60, 2, 1
  v_mov_b32 v6, s60
  v_mov_b32 v7, s62
  v_mov_b32 v8, s63
  v_mov_b32 v9, 0
  s_mov_b64 exec, 1
  buffer_store_dword v6, v9, s[28:31], 0 offen offset:128 sc1
  s_mov_b64 exec, -1
FL_np_3:
  s_lshl_b32 s90, s34, 2
  s_add_u32 s90, s90, s32
  s_lshr_b32 s91, s90, 3
  s_lshl_b32 s91, s91, 14
  s_and_b32 s92, s90, 7
  s_lshl_b32 s92, s92, 10
  s_add_u32 s91, s91, s92
  v_mov_b32 v1, 0x0
  v_bfe_u32 v31, v0, 0, 6
  v_lshl_add_u32 v1, v31, 4, v1
  v_add_u32 v1, s91, v1
  v_lshrrev_b32 v30, 4, v0
  v_cmp_eq_u32 vcc, s33, v30
  v_xor_b32 v29, 0x2000, v1
  s_nop 0
  v_cndmask_b32 v1, v1, v29, vcc
  s_lshl_b32 s91, s33, 14
  s_lshl_b32 s92, s90, 7
  s_add_u32 s91, s91, s92
  v_mov_b32 v2, 0x200000
  v_bfe_u32 v31, v0, 0, 2
  v_lshl_add_u32 v2, v31, 2, v2
  v_bfe_u32 v31, v0, 2, 1
  v_lshl_add_u32 v2, v31, 6, v2
  v_bfe_u32 v31, v0, 4, 1
  v_lshl_add_u32 v2, v31, 4, v2
  v_bfe_u32 v31, v0, 5, 1
  v_lshl_add_u32 v2, v31, 5, v2
  v_bfe_u32 v31, v0, 3, 1
  v_lshl_add_u32 v2, v31, 31, v2
  v_add_u32 v2, s91, v2
  s_lshr_b32 s92, s90, 1
  s_lshl_b32 s92, s92, 5
  s_and_b32 s91, s90, 1
  s_lshl_b32 s91, s91, 13
  s_add_u32 s92, s92, s91
  v_mov_b32 v30, 0x0
  v_bfe_u32 v31, v0, 2, 1
  v_lshl_add_u32 v30, v31, 12, v30
  v_bfe_u32 v31, v0, 4, 1
  v_lshl_add_u32 v30, v31, 11, v30
  v_bfe_u32 v31, v0, 0, 2
  v_lshl_add_u32 v30, v31, 3, v30
  v_bfe_u32 v31, v0, 5, 1
  v_lshl_add_u32 v30, v31, 2, v30
  v_add_u32 v30, s92, v30
  buffer_load_dword v44, v30, s[24:27], 0 offen
  s_lshl_b32 s91, s33, 14
  s_lshl_b32 s92, s32, 12
  s_add_u32 s91, s91, s92
  v_mov_b32 v3, 0x200000
  v_bfe_u32 v31, v0, 0, 6
  v_lshl_add_u32 v3, v31, 4, v3
  v_add_u32 v3, s91, v3
  s_mul_i32 s91, s32, 3264
  v_mov_b32 v4, 0x0
  v_bfe_u32 v31, v0, 0, 6
  v_lshl_add_u32 v4, v31, 4, v4
  v_add_u32 v4, s91, v4
  s_lshl_b32 s91, s32, 6
  v_mov_b32 v6, 0x0
  v_bfe_u32 v31, v0, 0, 2
  v_lshl_add_u32 v6, v31, 4, v6
  v_bfe_u32 v31, v0, 2, 1
  v_lshl_add_u32 v6, v31, 2, v6
  v_bfe_u32 v31, v0, 3, 1
  s_mov_b32 s99, 1088
  v_mad_u32_u24 v6, v31, s99, v6
  v_bfe_u32 v31, v0, 4, 2
  v_lshl_add_u32 v6, v31, 8, v6
  v_add_u32 v6, s91, v6
  v_add_u32 v240, 3264, v6
  v_add_u32 v241, 6528, v6
  v_add_u32 v242, 9792, v6
  s_lshl_b32 s93, s37, 13
  s_lshl_b32 s91, s38, 10
  s_add_u32 s91, s91, s93
  s_lshl_b32 s92, s32, 8
  s_add_u32 s91, s91, s92
  v_mov_b32 v7, 0x210000
  v_bfe_u32 v31, v0, 0, 6
  v_lshl_add_u32 v7, v31, 2, v7
  v_add_u32 v7, s91, v7
  s_lshl_b32 s91, s37, 11
  s_lshl_b32 s92, s38, 9
  s_add_u32 s59, s91, s92
  s_lshl_b32 s92, s32, 7
  s_add_u32 s91, s59, s92
  v_mov_b32 v19, 0x83000000
  v_bfe_u32 v31, v0, 0, 3
  v_lshl_add_u32 v19, v31, 2, v19
  v_bfe_u32 v31, v0, 4, 2
  v_lshl_add_u32 v19, v31, 5, v19
  v_bfe_u32 v31, v0, 3, 1
  v_lshl_add_u32 v19, v31, 31, v19
  v_add_u32 v19, s91, v19
  s_lshl_b32 s91, s32, 8
  v_mov_b32 v5, 0x880
  v_bfe_u32 v31, v0, 0, 1
  v_lshl_add_u32 v5, v31, 7, v5
  v_bfe_u32 v31, v0, 1, 1
  v_lshl_add_u32 v5, v31, 3, v5
  v_bfe_u32 v31, v0, 2, 3
  v_lshl_add_u32 v5, v31, 4, v5
  v_add_u32 v5, s91, v5
  s_lshr_b32 s92, s38, 1
  s_xor_b32 s92, s92, 1
  s_lshl_b32 s92, s92, 10
  s_add_u32 s91, s91, s92
  s_add_u32 s91, s91, s93
  s_and_b32 s92, s38, 1
  s_lshl_b32 s92, s92, 7
  s_add_u32 s91, s91, s92
  v_mov_b32 v8, 0x211000
  v_bfe_u32 v31, v0, 0, 5
  v_lshl_add_u32 v8, v31, 2, v8
  v_bfe_u32 v31, v0, 5, 1
  v_lshl_add_u32 v8, v31, 31, v8
  v_add_u32 v8, s91, v8
  s_sub_u32 s91, s91, s93
  s_lshl_b32 s92, s37, 11
  s_add_u32 s91, s91, s92
  v_mov_b32 v20, 0x3400000
  v_bfe_u32 v31, v0, 0, 5
  v_lshl_add_u32 v20, v31, 2, v20
  v_bfe_u32 v31, v0, 5, 1
  v_lshl_add_u32 v20, v31, 31, v20
  v_add_u32 v20, s91, v20
  s_lshl_b32 s97, s35, 2
  s_add_u32 s97, s97, s32
  s_lshl_b32 s97, s97, 13
  v_mov_b32 v9, 0x210000
  v_bfe_u32 v31, v0, 0, 6
  v_lshl_add_u32 v9, v31, 4, v9
  v_add_u32 v9, s97, v9
  v_add_u32 v10, 4096, v9
  v_mov_b32 v11, 0x1000000
  v_bfe_u32 v31, v0, 0, 2
  v_lshl_add_u32 v11, v31, 4, v11
  v_bfe_u32 v31, v0, 2, 1
  v_lshl_add_u32 v11, v31, 7, v11
  v_bfe_u32 v31, v0, 3, 1
  v_lshl_add_u32 v11, v31, 12, v11
  v_bfe_u32 v31, v0, 4, 2
  v_lshl_add_u32 v11, v31, 8, v11
  v_add_u32 v11, s97, v11
  v_mov_b32 v12, 0x2000000
  v_bfe_u32 v31, v0, 0, 3
  v_lshl_add_u32 v12, v31, 4, v12
  v_bfe_u32 v31, v0, 3, 1
  v_lshl_add_u32 v12, v31, 11, v12
  v_bfe_u32 v31, v0, 4, 2
  v_lshl_add_u32 v12, v31, 8, v12
  v_add_u32 v12, s97, v12
  v_add_u32 v13, 4096, v12
  s_lshl_b32 s91, s36, 9
  s_add_u32 s91, s91, s97
  s_add_u32 s63, s91, 0x1000000
  v_mov_b32 v21, 0x1000000
  v_bfe_u32 v31, v0, 0, 2
  v_lshl_add_u32 v21, v31, 7, v21
  v_bfe_u32 v31, v0, 2, 1
  v_lshl_add_u32 v21, v31, 24, v21
  v_add_u32 v21, s91, v21
  v_cmp_gt_u32 vcc, 8, v0
  v_mov_b32 v30, 0x80000000
  s_nop 0
  v_cndmask_b32 v21, v30, v21, vcc
  s_lshl_b32 s91, s32, 11
  v_mov_b32 v30, 0x0
  v_bfe_u32 v31, v0, 2, 1
  v_lshl_add_u32 v30, v31, 6, v30
  v_bfe_u32 v31, v0, 0, 1
  v_lshl_add_u32 v30, v31, 5, v30
  v_bfe_u32 v31, v0, 1, 1
  v_lshl_add_u32 v30, v31, 4, v30
  v_mov_b32 v29, 0x0
  v_bfe_u32 v31, v0, 4, 2
  v_lshl_add_u32 v29, v31, 5, v29
  v_xor_b32 v30, v30, v29
  v_mov_b32 v14, 0x3400
  v_bfe_u32 v31, v0, 0, 4
  v_lshl_add_u32 v14, v31, 7, v14
  v_add_u32 v14, s91, v14
  v_add_u32 v14, v14, v30
  v_xor_b32 v15, 16, v14
  v_mov_b32 v30, 0x0
  v_bfe_u32 v31, v0, 5, 1
  v_lshl_add_u32 v30, v31, 6, v30
  v_bfe_u32 v31, v0, 1, 1
  v_lshl_add_u32 v30, v31, 5, v30
  v_bfe_u32 v31, v0, 4, 1
  v_lshl_add_u32 v30, v31, 4, v30
  v_mov_b32 v29, 0x0
  v_bfe_u32 v31, v0, 2, 2
  v_lshl_add_u32 v29, v31, 5, v29
  v_bfe_u32 v31, v0, 0, 1
  v_lshl_add_u32 v29, v31, 4, v29
  v_xor_b32 v30, v30, v29
  v_mov_b32 v16, 0x3400
  v_bfe_u32 v31, v0, 4, 2
  v_lshl_add_u32 v16, v31, 8, v16
  v_bfe_u32 v31, v0, 1, 1
  v_lshl_add_u32 v16, v31, 7, v16
  v_add_u32 v16, v16, v30
  s_lshl_b32 s98, s36, 14
  s_lshl_b32 s92, s35, 7
  s_add_u32 s98, s98, s92
  s_lshl_b32 s92, s32, 11
  s_add_u32 s91, s98, s92
  v_mov_b32 v17, 0x0
  v_bfe_u32 v31, v0, 0, 5
  v_lshl_add_u32 v17, v31, 2, v17
  v_bfe_u32 v31, v0, 5, 1
  v_lshl_add_u32 v17, v31, 10, v17
  v_add_u32 v17, s91, v17
  v_xor_b32 v18, 0x2000, v17
  s_mov_b32 s48, 0x33333333
  s_mov_b32 s49, 0x33333333
  s_mov_b32 s50, 0xffff0000
  s_mov_b32 s51, 0xffff0000
  s_mov_b32 s52, 0x0000ffff
  s_mov_b32 s53, 0x0000ffff
  s_mov_b32 s54, 0xfffffffe
  s_mov_b32 s47, 0x3e0293ee
  v_mov_b32 v30, 0x4444
  v_mov_b32 v31, 0xeeee
  v_cndmask_b32 v23, v31, v30, s[48:49]
  v_mov_b32 v22, -1
  v_mov_b32 v232, 0
  v_mov_b32 v233, 0
  v_mov_b32 v234, 0
  v_mov_b32 v235, 0
  v_mov_b32 v112, 0
  v_mov_b32 v113, 0
  s_mov_b32 s56, 0xf0f0f0f0
  s_mov_b32 s57, 0xf0f0f0f0
  v_mov_b32 v30, 0x3f80
  v_mov_b32 v31, 1.0
  v_cndmask_b32 v30, v30, v31, s[56:57]
  s_mov_b32 s56, 0x110011
  s_mov_b32 s57, 0x110011
  v_cndmask_b32 v24, 0, v30, s[56:57]
  s_mov_b32 s56, 0x220022
  s_mov_b32 s57, 0x220022
  v_cndmask_b32 v25, 0, v30, s[56:57]
  s_mov_b32 s56, 0x11001100
  s_mov_b32 s57, 0x11001100
  v_cndmask_b32 v26, 0, v30, s[56:57]
  s_mov_b32 s56, 0x22002200
  s_mov_b32 s57, 0x22002200
  v_cndmask_b32 v27, 0, v30, s[56:57]
  s_mov_b32 s40, 0
  s_mov_b32 s41, 0x3800000
  s_mov_b32 s43, 0x3900000
  s_mov_b32 s44, 0
  s_mov_b32 s55, 0x40000
  s_mov_b32 s45, 0
  s_waitcnt vmcnt(33)
  s_barrier
  s_cmp_lg_u32 s32, 0
  s_cbranch_scc1 FL_sig_4
  v_mov_b32 v254, 1
  v_mov_b32 v255, 0
  s_mov_b64 exec, 1
  buffer_atomic_add v254, v255, s[28:31], s100 offen offset:132 sc1
  s_mov_b64 exec, -1
FL_sig_4:
  s_waitcnt vmcnt(28)
  ds_read_b64_tr_b16 a[16:17], v182 offset:0
  ds_read_b64_tr_b16 a[18:19], v182 offset:512
  ds_read_b64_tr_b16 a[24:25], v182 offset:32
  ds_read_b64_tr_b16 a[26:27], v182 offset:544
  s_waitcnt lgkmcnt(0)
  s_add_u32 m0, s96, 0
  s_mov_b32 s90, 0x100000
  buffer_load_dwordx4 v180, s[12:15], s90 offen  lds
  s_add_u32 m0, s96, 1024
  s_mov_b32 s90, 0x110000
  buffer_load_dwordx4 v180, s[12:15], s90 offen  lds
  s_add_u32 m0, s96, 2048
  s_mov_b32 s90, 0x120000
  buffer_load_dwordx4 v180, s[12:15], s90 offen  lds
  s_add_u32 m0, s96, 3072
  s_mov_b32 s90, 0x130000
  buffer_load_dwordx4 v180, s[12:15], s90 offen  lds
  s_waitcnt vmcnt(28)
  ds_read_b64_tr_b16 a[32:33], v182 offset:4096
  ds_read_b64_tr_b16 a[34:35], v182 offset:4608
  ds_read_b64_tr_b16 a[40:41], v182 offset:4128
  ds_read_b64_tr_b16 a[42:43], v182 offset:4640
  s_waitcnt lgkmcnt(0)
  s_add_u32 m0, s96, 4096
  s_mov_b32 s90, 0x100000
  buffer_load_dwordx4 v185, s[16:19], s90 offen  lds
  s_add_u32 m0, s96, 5120
  s_mov_b32 s90, 0x110000
  buffer_load_dwordx4 v185, s[16:19], s90 offen  lds
  s_add_u32 m0, s96, 6144
  s_mov_b32 s90, 0x120000
  buffer_load_dwordx4 v185, s[16:19], s90 offen  lds
  s_add_u32 m0, s96, 7168
  s_mov_b32 s90, 0x130000
  buffer_load_dwordx4 v185, s[16:19], s90 offen  lds
  s_waitcnt vmcnt(28)
  ds_read_b64_tr_b16 a[20:21], v182 offset:8192
  ds_read_b64_tr_b16 a[22:23], v182 offset:8704
  ds_read_b64_tr_b16 a[28:29], v182 offset:8224
  ds_read_b64_tr_b16 a[30:31], v182 offset:8736
  s_waitcnt lgkmcnt(0)
  s_add_u32 m0, s96, 8192
  s_mov_b32 s90, 0x140000
  buffer_load_dwordx4 v180, s[12:15], s90 offen  lds
  s_add_u32 m0, s96, 9216
  s_mov_b32 s90, 0x150000
  buffer_load_dwordx4 v180, s[12:15], s90 offen  lds
  s_add_u32 m0, s96, 10240
  s_mov_b32 s90, 0x160000
  buffer_load_dwordx4 v180, s[12:15], s90 offen  lds
  s_add_u32 m0, s96, 11264
  s_mov_b32 s90, 0x170000
  buffer_load_dwordx4 v180, s[12:15], s90 offen  lds
  s_waitcnt vmcnt(28)
  ds_read_b64_tr_b16 a[36:37], v182 offset:12288
  ds_read_b64_tr_b16 a[38:39], v182 offset:12800
  ds_read_b64_tr_b16 a[44:45], v182 offset:12320
  ds_read_b64_tr_b16 a[46:47], v182 offset:12832
  s_waitcnt lgkmcnt(0)
  s_add_u32 m0, s96, 12288
  s_mov_b32 s90, 0x140000
  buffer_load_dwordx4 v185, s[16:19], s90 offen  lds
  s_add_u32 m0, s96, 13312
  s_mov_b32 s90, 0x150000
  buffer_load_dwordx4 v185, s[16:19], s90 offen  lds
  s_add_u32 m0, s96, 14336
  s_mov_b32 s90, 0x160000
  buffer_load_dwordx4 v185, s[16:19], s90 offen  lds
  s_add_u32 m0, s96, 15360
  s_mov_b32 s90, 0x170000
  buffer_load_dwordx4 v185, s[16:19], s90 offen  lds
  s_waitcnt vmcnt(28)
  ds_read_b64_tr_b16 a[64:65], v182 offset:16384
  ds_read_b64_tr_b16 a[66:67], v182 offset:16896
  ds_read_b64_tr_b16 a[72:73], v182 offset:16416
  ds_read_b64_tr_b16 a[74:75], v182 offset:16928
  s_waitcnt lgkmcnt(0)
  s_add_u32 m0, s96, 16384
  s_mov_b32 s90, 0x180000
  buffer_load_dwordx4 v180, s[12:15], s90 offen  lds
  s_add_u32 m0, s96, 17408
  s_mov_b32 s90, 0x190000
  buffer_load_dwordx4 v180, s[12:15], s90 offen  lds
  s_add_u32 m0, s96, 18432
  s_mov_b32 s90, 0x1a0000
  buffer_load_dwordx4 v180, s[12:15], s90 offen  lds
  s_add_u32 m0, s96, 19456
  s_mov_b32 s90, 0x1b0000
  buffer_load_dwordx4 v180, s[12:15], s90 offen  lds
  s_waitcnt vmcnt(28)
  ds_read_b64_tr_b16 a[80:81], v182 offset:20480
  ds_read_b64_tr_b16 a[82:83], v182 offset:20992
  ds_read_b64_tr_b16 a[88:89], v182 offset:20512
  ds_read_b64_tr_b16 a[90:91], v182 offset:21024
  s_waitcnt lgkmcnt(0)
  s_add_u32 m0, s96, 20480
  s_mov_b32 s90, 0x180000
  buffer_load_dwordx4 v185, s[16:19], s90 offen  lds
  s_add_u32 m0, s96, 21504
  s_mov_b32 s90, 0x190000
  buffer_load_dwordx4 v185, s[16:19], s90 offen  lds
  s_add_u32 m0, s96, 22528
  s_mov_b32 s90, 0x1a0000
  buffer_load_dwordx4 v185, s[16:19], s90 offen  lds
  s_add_u32 m0, s96, 23552
  s_mov_b32 s90, 0x1b0000
  buffer_load_dwordx4 v185, s[16:19], s90 offen  lds
  s_waitcnt vmcnt(28)
  ds_read_b64_tr_b16 a[68:69], v182 offset:24576
  ds_read_b64_tr_b16 a[70:71], v182 offset:25088
  ds_read_b64_tr_b16 a[76:77], v182 offset:24608
  ds_read_b64_tr_b16 a[78:79], v182 offset:25120
  s_waitcnt lgkmcnt(0)
  s_add_u32 m0, s96, 24576
  s_mov_b32 s90, 0x1c0000
  buffer_load_dwordx4 v180, s[12:15], s90 offen  lds
  s_add_u32 m0, s96, 25600
  s_mov_b32 s90, 0x1d0000
  buffer_load_dwordx4 v180, s[12:15], s90 offen  lds
  s_add_u32 m0, s96, 26624
  s_mov_b32 s90, 0x1e0000
  buffer_load_dwordx4 v180, s[12:15], s90 offen  lds
  s_add_u32 m0, s96, 27648
  s_mov_b32 s90, 0x1f0000
  buffer_load_dwordx4 v180, s[12:15], s90 offen  lds
  s_waitcnt vmcnt(28)
  ds_read_b64_tr_b16 a[84:85], v182 offset:28672
  ds_read_b64_tr_b16 a[86:87], v182 offset:29184
  ds_read_b64_tr_b16 a[92:93], v182 offset:28704
  ds_read_b64_tr_b16 a[94:95], v182 offset:29216
  s_waitcnt lgkmcnt(0)
  s_add_u32 m0, s96, 28672
  s_mov_b32 s90, 0x1c0000
  buffer_load_dwordx4 v185, s[16:19], s90 offen  lds
  s_add_u32 m0, s96, 29696
  s_mov_b32 s90, 0x1d0000
  buffer_load_dwordx4 v185, s[16:19], s90 offen  lds
  s_add_u32 m0, s96, 30720
  s_mov_b32 s90, 0x1e0000
  buffer_load_dwordx4 v185, s[16:19], s90 offen  lds
  s_add_u32 m0, s96, 31744
  s_mov_b32 s90, 0x1f0000
  buffer_load_dwordx4 v185, s[16:19], s90 offen  lds
  s_waitcnt vmcnt(28)
  ds_read_b64_tr_b16 a[112:113], v182 offset:0
  ds_read_b64_tr_b16 a[114:115], v182 offset:512
  ds_read_b64_tr_b16 a[120:121], v182 offset:32
  ds_read_b64_tr_b16 a[122:123], v182 offset:544
  s_waitcnt lgkmcnt(0)
  s_add_u32 m0, s96, 0
  s_mov_b32 s90, 0x0
  buffer_load_dwordx4 v180, s[8:11], s90 offen  lds
  s_add_u32 m0, s96, 1024
  s_mov_b32 s90, 0x10000
  buffer_load_dwordx4 v180, s[8:11], s90 offen  lds
  s_add_u32 m0, s96, 2048
  s_mov_b32 s90, 0x20000
  buffer_load_dwordx4 v180, s[8:11], s90 offen  lds
  s_add_u32 m0, s96, 3072
  s_mov_b32 s90, 0x30000
  buffer_load_dwordx4 v180, s[8:11], s90 offen  lds
  s_waitcnt vmcnt(28)
  ds_read_b64_tr_b16 a[128:129], v182 offset:4096
  ds_read_b64_tr_b16 a[130:131], v182 offset:4608
  ds_read_b64_tr_b16 a[136:137], v182 offset:4128
  ds_read_b64_tr_b16 a[138:139], v182 offset:4640
  s_waitcnt lgkmcnt(0)
  s_add_u32 m0, s96, 4096
  s_mov_b32 s90, 0x40000
  buffer_load_dwordx4 v180, s[8:11], s90 offen  lds
  s_add_u32 m0, s96, 5120
  s_mov_b32 s90, 0x50000
  buffer_load_dwordx4 v180, s[8:11], s90 offen  lds
  s_add_u32 m0, s96, 6144
  s_mov_b32 s90, 0x60000
  buffer_load_dwordx4 v180, s[8:11], s90 offen  lds
  s_add_u32 m0, s96, 7168
  s_mov_b32 s90, 0x70000
  buffer_load_dwordx4 v180, s[8:11], s90 offen  lds
  s_waitcnt vmcnt(28)
  ds_read_b64_tr_b16 a[116:117], v182 offset:8192
  ds_read_b64_tr_b16 a[118:119], v182 offset:8704
  ds_read_b64_tr_b16 a[124:125], v182 offset:8224
  ds_read_b64_tr_b16 a[126:127], v182 offset:8736
  s_waitcnt lgkmcnt(0)
  s_add_u32 m0, s96, 8192
  s_mov_b32 s90, 0x80000
  buffer_load_dwordx4 v180, s[8:11], s90 offen  lds
  s_add_u32 m0, s96, 9216
  s_mov_b32 s90, 0x90000
  buffer_load_dwordx4 v180, s[8:11], s90 offen  lds
  s_add_u32 m0, s96, 10240
  s_mov_b32 s90, 0xa0000
  buffer_load_dwordx4 v180, s[8:11], s90 offen  lds
  s_add_u32 m0, s96, 11264
  s_mov_b32 s90, 0xb0000
  buffer_load_dwordx4 v180, s[8:11], s90 offen  lds
  s_waitcnt vmcnt(28)
  ds_read_b64_tr_b16 a[132:133], v182 offset:12288
  ds_read_b64_tr_b16 a[134:135], v182 offset:12800
  ds_read_b64_tr_b16 a[140:141], v182 offset:12320
  ds_read_b64_tr_b16 a[142:143], v182 offset:12832
  s_waitcnt lgkmcnt(0)
  s_add_u32 m0, s96, 12288
  s_mov_b32 s90, 0xc0000
  buffer_load_dwordx4 v180, s[8:11], s90 offen  lds
  s_add_u32 m0, s96, 13312
  s_mov_b32 s90, 0xd0000
  buffer_load_dwordx4 v180, s[8:11], s90 offen  lds
  s_add_u32 m0, s96, 14336
  s_mov_b32 s90, 0xe0000
  buffer_load_dwordx4 v180, s[8:11], s90 offen  lds
  s_add_u32 m0, s96, 15360
  s_mov_b32 s90, 0xf0000
  buffer_load_dwordx4 v180, s[8:11], s90 offen  lds
  s_waitcnt vmcnt(28)
  ds_read_b64_tr_b16 a[160:161], v182 offset:16384
  ds_read_b64_tr_b16 a[162:163], v182 offset:16896
  ds_read_b64_tr_b16 a[168:169], v182 offset:16416
  ds_read_b64_tr_b16 a[170:171], v182 offset:16928
  s_waitcnt lgkmcnt(0)
  s_add_u32 m0, s96, 16384
  s_mov_b32 s90, 0x100000
  buffer_load_dwordx4 v180, s[8:11], s90 offen  lds
  s_add_u32 m0, s96, 17408
  s_mov_b32 s90, 0x110000
  buffer_load_dwordx4 v180, s[8:11], s90 offen  lds
  s_add_u32 m0, s96, 18432
  s_mov_b32 s90, 0x120000
  buffer_load_dwordx4 v180, s[8:11], s90 offen  lds
  s_add_u32 m0, s96, 19456
  s_mov_b32 s90, 0x130000
  buffer_load_dwordx4 v180, s[8:11], s90 offen  lds
  s_waitcnt vmcnt(28)
  ds_read_b64_tr_b16 a[176:177], v182 offset:20480
  ds_read_b64_tr_b16 a[178:179], v182 offset:20992
  ds_read_b64_tr_b16 a[184:185], v182 offset:20512
  ds_read_b64_tr_b16 a[186:187], v182 offset:21024
  s_waitcnt lgkmcnt(0)
  s_add_u32 m0, s96, 20480
  s_mov_b32 s90, 0x140000
  buffer_load_dwordx4 v180, s[8:11], s90 offen  lds
  s_add_u32 m0, s96, 21504
  s_mov_b32 s90, 0x150000
  buffer_load_dwordx4 v180, s[8:11], s90 offen  lds
  s_add_u32 m0, s96, 22528
  s_mov_b32 s90, 0x160000
  buffer_load_dwordx4 v180, s[8:11], s90 offen  lds
  s_add_u32 m0, s96, 23552
  s_mov_b32 s90, 0x170000
  buffer_load_dwordx4 v180, s[8:11], s90 offen  lds
  s_waitcnt vmcnt(28)
  ds_read_b64_tr_b16 a[164:165], v182 offset:24576
  ds_read_b64_tr_b16 a[166:167], v182 offset:25088
  ds_read_b64_tr_b16 a[172:173], v182 offset:24608
  ds_read_b64_tr_b16 a[174:175], v182 offset:25120
  s_waitcnt lgkmcnt(0)
  s_add_u32 m0, s96, 24576
  s_mov_b32 s90, 0x180000
  buffer_load_dwordx4 v180, s[8:11], s90 offen  lds
  s_add_u32 m0, s96, 25600
  s_mov_b32 s90, 0x190000
  buffer_load_dwordx4 v180, s[8:11], s90 offen  lds
  s_add_u32 m0, s96, 26624
  s_mov_b32 s90, 0x1a0000
  buffer_load_dwordx4 v180, s[8:11], s90 offen  lds
  s_add_u32 m0, s96, 27648
  s_mov_b32 s90, 0x1b0000
  buffer_load_dwordx4 v180, s[8:11], s90 offen  lds
  s_waitcnt vmcnt(28)
  ds_read_b64_tr_b16 a[180:181], v182 offset:28672
  ds_read_b64_tr_b16 a[182:183], v182 offset:29184
  ds_read_b64_tr_b16 a[188:189], v182 offset:28704
  ds_read_b64_tr_b16 a[190:191], v182 offset:29216
  s_waitcnt lgkmcnt(0)
  s_add_u32 m0, s96, 28672
  s_mov_b32 s90, 0x1c0000
  buffer_load_dwordx4 v180, s[8:11], s90 offen  lds
  s_add_u32 m0, s96, 29696
  s_mov_b32 s90, 0x1d0000
  buffer_load_dwordx4 v180, s[8:11], s90 offen  lds
  s_add_u32 m0, s96, 30720
  s_mov_b32 s90, 0x1e0000
  buffer_load_dwordx4 v180, s[8:11], s90 offen  lds
  s_add_u32 m0, s96, 31744
  s_mov_b32 s90, 0x1f0000
  buffer_load_dwordx4 v180, s[8:11], s90 offen  lds
  s_waitcnt vmcnt(28)
  ds_read_b64_tr_b16 a[0:1], v182 offset:0
  ds_read_b64_tr_b16 a[2:3], v182 offset:512
  ds_read_b64_tr_b16 a[8:9], v182 offset:32
  ds_read_b64_tr_b16 a[10:11], v182 offset:544
  s_waitcnt lgkmcnt(0)
  s_add_u32 m0, s96, 0
  s_mov_b32 s90, 0x0
  buffer_load_dwordx4 v181, s[20:23], s90 offen  lds
  s_add_u32 m0, s96, 1024
  s_mov_b32 s90, 0x4000
  buffer_load_dwordx4 v181, s[20:23], s90 offen  lds
  s_add_u32 m0, s96, 2048
  s_mov_b32 s90, 0x8000
  buffer_load_dwordx4 v181, s[20:23], s90 offen  lds
  s_add_u32 m0, s96, 3072
  s_mov_b32 s90, 0xc000
  buffer_load_dwordx4 v181, s[20:23], s90 offen  lds
  s_waitcnt vmcnt(28)
  ds_read_b64_tr_b16 a[4:5], v182 offset:4096
  ds_read_b64_tr_b16 a[6:7], v182 offset:4608
  ds_read_b64_tr_b16 a[12:13], v182 offset:4128
  ds_read_b64_tr_b16 a[14:15], v182 offset:4640
  s_waitcnt lgkmcnt(0)
  s_add_u32 m0, s96, 4096
  s_mov_b32 s90, 0x10000
  buffer_load_dwordx4 v181, s[20:23], s90 offen  lds
  s_add_u32 m0, s96, 5120
  s_mov_b32 s90, 0x14000
  buffer_load_dwordx4 v181, s[20:23], s90 offen  lds
  s_add_u32 m0, s96, 6144
  s_mov_b32 s90, 0x18000
  buffer_load_dwordx4 v181, s[20:23], s90 offen  lds
  s_add_u32 m0, s96, 7168
  s_mov_b32 s90, 0x1c000
  buffer_load_dwordx4 v181, s[20:23], s90 offen  lds
  s_waitcnt vmcnt(28)
  ds_read_b64_tr_b16 a[48:49], v182 offset:8192
  ds_read_b64_tr_b16 a[50:51], v182 offset:8704
  ds_read_b64_tr_b16 a[56:57], v182 offset:8224
  ds_read_b64_tr_b16 a[58:59], v182 offset:8736
  s_waitcnt lgkmcnt(0)
  s_add_u32 m0, s96, 8192
  s_mov_b32 s90, 0x20000
  buffer_load_dwordx4 v181, s[20:23], s90 offen  lds
  s_add_u32 m0, s96, 9216
  s_mov_b32 s90, 0x24000
  buffer_load_dwordx4 v181, s[20:23], s90 offen  lds
  s_add_u32 m0, s96, 10240
  s_mov_b32 s90, 0x28000
  buffer_load_dwordx4 v181, s[20:23], s90 offen  lds
  s_add_u32 m0, s96, 11264
  s_mov_b32 s90, 0x2c000
  buffer_load_dwordx4 v181, s[20:23], s90 offen  lds
  s_waitcnt vmcnt(28)
  ds_read_b64_tr_b16 a[52:53], v182 offset:12288
  ds_read_b64_tr_b16 a[54:55], v182 offset:12800
  ds_read_b64_tr_b16 a[60:61], v182 offset:12320
  ds_read_b64_tr_b16 a[62:63], v182 offset:12832
  s_waitcnt lgkmcnt(0)
  s_add_u32 m0, s96, 12288
  s_mov_b32 s90, 0x30000
  buffer_load_dwordx4 v181, s[20:23], s90 offen  lds
  s_add_u32 m0, s96, 13312
  s_mov_b32 s90, 0x34000
  buffer_load_dwordx4 v181, s[20:23], s90 offen  lds
  s_add_u32 m0, s96, 14336
  s_mov_b32 s90, 0x38000
  buffer_load_dwordx4 v181, s[20:23], s90 offen  lds
  s_add_u32 m0, s96, 15360
  s_mov_b32 s90, 0x3c000
  buffer_load_dwordx4 v181, s[20:23], s90 offen  lds
  s_waitcnt vmcnt(28)
  ds_read_b64_tr_b16 a[96:97], v182 offset:16384
  ds_read_b64_tr_b16 a[98:99], v182 offset:16896
  ds_read_b64_tr_b16 a[104:105], v182 offset:16416
  ds_read_b64_tr_b16 a[106:107], v182 offset:16928
  s_waitcnt vmcnt(24)
  ds_read_b64_tr_b16 a[100:101], v182 offset:20480
  ds_read_b64_tr_b16 a[102:103], v182 offset:20992
  ds_read_b64_tr_b16 a[108:109], v182 offset:20512
  ds_read_b64_tr_b16 a[110:111], v182 offset:21024
  s_waitcnt vmcnt(20)
  ds_read_b64_tr_b16 a[144:145], v182 offset:24576
  ds_read_b64_tr_b16 a[146:147], v182 offset:25088
  ds_read_b64_tr_b16 a[152:153], v182 offset:24608
  ds_read_b64_tr_b16 a[154:155], v182 offset:25120
  s_waitcnt vmcnt(16)
  ds_read_b64_tr_b16 a[148:149], v182 offset:28672
  ds_read_b64_tr_b16 a[150:151], v182 offset:29184
  ds_read_b64_tr_b16 a[156:157], v182 offset:28704
  ds_read_b64_tr_b16 a[158:159], v182 offset:29216
  s_cmp_lg_u32 s32, 0
  s_cbranch_scc1 FL_vd_6
  v_mbcnt_lo_u32_b32 v250, -1, 0
  v_mbcnt_hi_u32_b32 v250, -1, v250
  v_lshlrev_b32 v250, 2, v250
  s_cmp_lg_u32 s100, 0
  s_cbranch_scc1 FL_vw_5
  v_readfirstlane_b32 s90, v247
  s_and_b32 s90, s90, s101
  s_cbranch_scc0 FL_vw_5
  v_mov_b32 v251, 1
  s_mov_b64 exec, 1
  buffer_store_dword v251, v250, s[28:31], 0 offen offset:32 sc1
  s_mov_b64 exec, -1
FL_vw_5:
  buffer_load_dword v251, v250, s[28:31], 0 offen sc1
  s_waitcnt vmcnt(0)
  v_cmp_eq_u32 vcc, -1, v251
  v_readlane_b32 s91, v251, 8
  v_readlane_b32 s92, v251, 32
  v_readlane_b32 s93, v251, 33
  v_readlane_b32 s90, v251, 34
  s_cmp_lg_u32 s100, 0
  s_cselect_b32 s93, s90, s93
  s_cselect_b32 s91, 0, s91
  s_cselect_b32 s92, 1, s92
  s_cselect_b32 s90, 0xff, vcc_lo
  s_cmp_lg_u32 s91, 0
  s_cselect_b32 s92, 3, s92
  s_cbranch_scc1 FL_vk_7
  s_add_u32 s3, s3, 1
  s_cmp_ge_u32 s3, 131072
  s_cselect_b32 s92, 4, s92
  s_cbranch_scc1 FL_vk_7
  s_sleep 8
  s_and_b32 s90, s90, 0xff
  s_cmp_lg_u32 s90, 0xff
  s_cbranch_scc1 FL_vw_5
  s_cmp_lt_u32 s93, 128
  s_cbranch_scc1 FL_vw_5
  s_cmp_eq_u32 s92, 0
  s_cbranch_scc1 FL_vw_5
FL_vk_7:
  v_mov_b32 v251, s92
  v_mov_b32 v250, 131072
  ds_write_b32 v250, v251
  s_waitcnt lgkmcnt(0)
FL_vd_6:
  s_barrier
  v_mov_b32 v250, 131072
  ds_read_b32 v251, v250
  s_waitcnt lgkmcnt(0)
  v_readfirstlane_b32 s92, v251
  s_barrier
  s_cmp_eq_u32 s92, 3
  s_cbranch_scc1 L_fallback
  s_cmp_eq_u32 s92, 4
  s_cbranch_scc1 L_exit
  s_sub_u32 s39, s92, 1
  s_and_b32 s39, s39, 1
  s_lshl_b32 s39, s39, 13
  s_waitcnt vmcnt(0)
  s_barrier
  ds_read_b64_tr_b16 a[192:193], v183 offset:0
  ds_read_b64_tr_b16 a[194:195], v183 offset:2048
  ds_read_b64_tr_b16 a[196:197], v183 offset:512
  ds_read_b64_tr_b16 a[198:199], v183 offset:2560
  ds_read_b64_tr_b16 a[200:201], v183 offset:4096
  ds_read_b64_tr_b16 a[202:203], v183 offset:6144
  ds_read_b64_tr_b16 a[204:205], v183 offset:4608
  ds_read_b64_tr_b16 a[206:207], v183 offset:6656
  s_waitcnt lgkmcnt(0)
  ds_read_b64_tr_b16 a[208:209], v183 offset:32768
  ds_read_b64_tr_b16 a[210:211], v183 offset:34816
  ds_read_b64_tr_b16 a[212:213], v183 offset:33280
  ds_read_b64_tr_b16 a[214:215], v183 offset:35328
  ds_read_b64_tr_b16 a[216:217], v183 offset:36864
  ds_read_b64_tr_b16 a[218:219], v183 offset:38912
  ds_read_b64_tr_b16 a[220:221], v183 offset:37376
  ds_read_b64_tr_b16 a[222:223], v183 offset:39424
  s_waitcnt lgkmcnt(0)
  ds_read_b64_tr_b16 a[224:225], v184 offset:0
  ds_read_b64_tr_b16 a[226:227], v184 offset:2048
  ds_read_b64_tr_b16 a[228:229], v184 offset:512
  ds_read_b64_tr_b16 a[230:231], v184 offset:2560
  ds_read_b64_tr_b16 a[232:233], v184 offset:4096
  ds_read_b64_tr_b16 a[234:235], v184 offset:6144
  ds_read_b64_tr_b16 a[236:237], v184 offset:4608
  ds_read_b64_tr_b16 a[238:239], v184 offset:6656
  s_waitcnt lgkmcnt(0)
  ds_read_b64_tr_b16 a[240:241], v184 offset:32768
  ds_read_b64_tr_b16 a[242:243], v184 offset:34816
  ds_read_b64_tr_b16 a[244:245], v184 offset:33280
  ds_read_b64_tr_b16 a[246:247], v184 offset:35328
  ds_read_b64_tr_b16 a[248:249], v184 offset:36864
  ds_read_b64_tr_b16 a[250:251], v184 offset:38912
  ds_read_b64_tr_b16 a[252:253], v184 offset:37376
  ds_read_b64_tr_b16 a[254:255], v184 offset:39424
  s_waitcnt lgkmcnt(0)
  s_barrier
  s_mov_b32 s46, 0
  v_xor_b32 v1, s39, v1
  v_xor_b32 v17, s39, v17
  v_xor_b32 v18, s39, v18
  s_mov_b32 s12, s63
  v_mov_b32 v248, 0x3f803f80
  v_mov_b32 v249, 0x3f803f80
  v_mov_b32 v250, 0x3f803f80
  v_mov_b32 v251, 0x3f803f80
  v_mov_b32 v252, 0x3f803f80
  v_mov_b32 v253, 0x3f803f80
  v_mov_b32 v254, 0x3f803f80
  v_mov_b32 v255, 0x3f803f80
  s_cmp_lg_u32 s32, 0
  s_cbranch_scc1 FL_kv0d
  s_lshl_b32 s90, s33, 7
  s_add_u32 s90, s90, 0x3d07000
  v_mov_b32 v30, s90
FL_kv0:
  buffer_load_dword v31, v30, s[4:7], 0 offen sc1
  s_waitcnt vmcnt(0)
  v_readfirstlane_b32 s90, v31
  s_add_u32 s46, s46, 1
  s_cmp_ge_u32 s46, 131072
  s_cbranch_scc1 FL_rec_abort
  s_sleep 2
  s_cmp_lt_u32 s90, 16
  s_cbranch_scc1 FL_kv0
FL_kv0d:
  s_barrier
  buffer_load_dwordx4 v[180:183], v12, s[4:7], s44 offen offset:0
  buffer_load_dwordx4 v[184:187], v12, s[4:7], s44 offen offset:128
  buffer_load_dwordx4 v[188:191], v12, s[4:7], s44 offen offset:1024
  buffer_load_dwordx4 v[192:195], v12, s[4:7], s44 offen offset:1152
  buffer_load_dwordx4 v[196:199], v13, s[4:7], s44 offen offset:0
  buffer_load_dwordx4 v[200:203], v13, s[4:7], s44 offen offset:128
  buffer_load_dwordx4 v[204:207], v13, s[4:7], s44 offen offset:1024
  buffer_load_dwordx4 v[208:211], v13, s[4:7], s44 offen offset:1152
  buffer_load_dwordx4 v[116:119], v11, s[4:7], s44 offen offset:0
  buffer_load_dwordx4 v[132:135], v11, s[4:7], s44 offen offset:64
  buffer_load_dwordx4 v[120:123], v11, s[4:7], s44 offen offset:1024
  buffer_load_dwordx4 v[136:139], v11, s[4:7], s44 offen offset:1088
  buffer_load_dwordx4 v[124:127], v11, s[4:7], s44 offen offset:2048
  buffer_load_dwordx4 v[140:143], v11, s[4:7], s44 offen offset:2112
  buffer_load_dwordx4 v[128:131], v11, s[4:7], s44 offen offset:3072
  buffer_load_dwordx4 v[144:147], v11, s[4:7], s44 offen offset:3136
  s_add_u32 s44, s44, 0x40000
  v_mov_b64 v[64:65], 0
  v_mov_b64 v[66:67], 0
  v_mov_b64 v[68:69], 0
  v_mov_b64 v[70:71], 0
  v_mov_b64 v[72:73], 0
  v_mov_b64 v[74:75], 0
  v_mov_b64 v[76:77], 0
  v_mov_b64 v[78:79], 0
  v_mov_b64 v[80:81], 0
  v_mov_b64 v[82:83], 0
  v_mov_b64 v[84:85], 0
  v_mov_b64 v[86:87], 0
  v_mov_b64 v[32:33], 0
  v_mov_b64 v[34:35], 0
  v_mov_b64 v[212:213], 0
  v_mov_b64 v[214:215], 0
  v_mov_b64 v[216:217], 0
  v_mov_b64 v[218:219], 0
  v_mov_b64 v[220:221], 0
  v_mov_b64 v[222:223], 0
  v_mov_b64 v[224:225], 0
  v_mov_b64 v[226:227], 0
  v_mov_b64 v[228:229], 0
  v_mov_b64 v[230:231], 0
  s_waitcnt vmcnt(0)
  v_min_u32 v44, s54, v44
  s_lshl_b32 s90, s33, 7
  s_add_u32 s90, s90, 0x3d07000
  v_mov_b32 v244, s90
  s_lshl_b32 s90, s34, 2
  s_add_u32 s90, s90, s32
  s_lshl_b32 s91, s33, 7
  s_add_u32 s91, s91, 0x3d00000
  v_mbcnt_lo_u32_b32 v30, -1, 0
  v_mbcnt_hi_u32_b32 v30, -1, v30
  v_add_u32 v30, s90, v30
  v_cmp_eq_u32 vcc, 0, v30
  v_mov_b32 v30, 0x80000000
  v_mov_b32 v31, s91
  v_cndmask_b32 v245, v30, v31, vcc
  s_mov_b64 s[8:9], s[94:95]
  s_mov_b64 s[10:11], s[94:95]
  s_branch FL_pubmem
FL_step:
  s_load_dword s16, s[8:9], 256
  s_load_dword s17, s[10:11], 256
  s_load_dword s18, s[8:9], 320
  s_load_dword s19, s[10:11], 320
  s_load_dword s20, s[8:9], 384
  s_load_dword s21, s[10:11], 384
  s_load_dword s22, s[8:9], 448
  s_load_dword s23, s[10:11], 448
  buffer_load_dwordx4 v[200:203], v13, s[4:7], s44 offen offset:128
  buffer_load_dwordx4 v[204:207], v13, s[4:7], s44 offen offset:1024
  buffer_load_dwordx4 v[208:211], v13, s[4:7], s44 offen offset:1152
  buffer_load_dwordx4 v[128:131], v11, s[4:7], s44 offen offset:3072
  buffer_load_dwordx4 v[144:147], v11, s[4:7], s44 offen offset:3136
  v_mov_b64 v[64:65], 0
  v_mov_b64 v[66:67], 0
  v_mov_b64 v[68:69], 0
  v_mov_b64 v[70:71], 0
  v_mov_b64 v[72:73], 0
  v_mov_b64 v[74:75], 0
  v_mov_b64 v[76:77], 0
  v_mov_b64 v[78:79], 0
  v_mov_b64 v[80:81], 0
  v_mov_b64 v[82:83], 0
  v_mov_b64 v[84:85], 0
  v_mov_b64 v[86:87], 0
  v_mov_b64 v[32:33], 0
  v_mov_b64 v[34:35], 0
  buffer_load_dwordx4 v[36:39], v1, s[4:7], s42 offen sc1
  buffer_store_dword v22, v18, s[4:7], s13 offen
  buffer_store_dword v22, v2, s[4:7], s13 offen
  buffer_store_dword v22, v7, s[4:7], s13 offen
  buffer_store_dword v22, v8, s[4:7], s13 offen
  s_add_u32 s44, s44, 0x40000
  s_min_u32 s44, s44, 0xfc0000
  s_add_u32 s45, s45, 0x10000
  s_waitcnt vmcnt(12)
FL_kv_chk:
  v_readfirstlane_b32 s90, v243
  s_cmp_lt_u32 s90, 16
  s_cbranch_scc1 FL_kv_f
  s_waitcnt vmcnt(4)
FL_g_chk:
  v_max3_u32 v31, v36, v37, v38
  v_max_u32 v31, v31, v39
  v_cmp_eq_u32 vcc, -1, v31
  v_mfma_f32_16x16x32_bf16 v[40:43], v[24:27], v[36:39], 0
  s_cbranch_vccnz FL_g_f
  s_nop 6
  v_add_f32_dpp v45, v40, v40 row_ror:8 row_mask:0xf bank_mask:0xf
  v_add_f32_dpp v46, v41, v41 row_ror:8 row_mask:0xf bank_mask:0xf
  v_cvt_pk_bf16_f32 v44, v45, v46
  v_min_u32 v44, s54, v44
FL_pubmem:
  buffer_store_dword v44, v2, s[4:7], s41 offen
  v_mov_b32 v148, v180
  v_mov_b32 v150, v181
  v_mov_b32 v152, v182
  v_mov_b32 v154, v183
  v_mov_b32 v149, v184
  v_mov_b32 v151, v185
  v_mov_b32 v153, v186
  v_mov_b32 v155, v187
  v_mov_b32 v156, v188
  v_mov_b32 v158, v189
  v_mov_b32 v160, v190
  v_mov_b32 v162, v191
  v_mov_b32 v157, v192
  v_mov_b32 v159, v193
  v_mov_b32 v161, v194
  v_mov_b32 v163, v195
  v_mov_b32 v164, v196
  v_mov_b32 v166, v197
  v_mov_b32 v168, v198
  v_mov_b32 v170, v199
  v_mov_b32 v165, v200
  v_mov_b32 v167, v201
  v_mov_b32 v169, v202
  v_mov_b32 v171, v203
  buffer_load_dwordx4 v[48:51], v3, s[4:7], s41 offen offset:0 sc1
  v_mov_b32 v172, v204
  v_mov_b32 v174, v205
  buffer_load_dwordx4 v[52:55], v3, s[4:7], s41 offen offset:1024 sc1
  v_mov_b32 v176, v206
  v_mov_b32 v178, v207
  buffer_load_dwordx4 v[56:59], v3, s[4:7], s41 offen offset:2048 sc1
  v_mov_b32 v173, v208
  v_mov_b32 v175, v209
  buffer_load_dwordx4 v[60:63], v3, s[4:7], s41 offen offset:3072 sc1
  v_mov_b32 v177, v210
  v_mov_b32 v179, v211
  s_waitcnt vmcnt(3)
  v_max3_u32 v31, v48, v49, v50
  v_max_u32 v31, v31, v51
  v_cmp_eq_u32 vcc, -1, v31
  s_cbranch_vccnz FL_m_f0
  v_smfmac_f32_16x16x64_bf16 v[64:67], v[48:51], a[0:7], v23
  s_waitcnt vmcnt(2)
  v_max3_u32 v31, v52, v53, v54
  v_max_u32 v31, v31, v55
  v_cmp_eq_u32 vcc, -1, v31
  v_smfmac_f32_16x16x64_bf16 v[68:71], v[48:51], a[8:15], v23
  v_smfmac_f32_16x16x64_bf16 v[72:75], v[48:51], a[16:23], v23
  v_smfmac_f32_16x16x64_bf16 v[76:79], v[48:51], a[24:31], v23
  s_cbranch_vccnz FL_m_f1
  v_smfmac_f32_16x16x64_bf16 v[64:67], v[52:55], a[48:55], v23
  s_waitcnt vmcnt(1)
  v_max3_u32 v31, v56, v57, v58
  v_max_u32 v31, v31, v59
  v_cmp_eq_u32 vcc, -1, v31
  v_smfmac_f32_16x16x64_bf16 v[68:71], v[52:55], a[56:63], v23
  v_smfmac_f32_16x16x64_bf16 v[72:75], v[52:55], a[64:71], v23
  v_smfmac_f32_16x16x64_bf16 v[76:79], v[52:55], a[72:79], v23
  s_cbranch_vccnz FL_m_f2
  v_smfmac_f32_16x16x64_bf16 v[64:67], v[56:59], a[96:103], v23
  s_waitcnt vmcnt(0)
  v_max3_u32 v31, v60, v61, v62
  v_max_u32 v31, v31, v63
  v_cmp_eq_u32 vcc, -1, v31
  v_smfmac_f32_16x16x64_bf16 v[68:71], v[56:59], a[104:111], v23
  v_smfmac_f32_16x16x64_bf16 v[72:75], v[56:59], a[112:119], v23
  v_smfmac_f32_16x16x64_bf16 v[76:79], v[56:59], a[120:127], v23
  s_cbranch_vccnz FL_m_f3
  v_smfmac_f32_16x16x64_bf16 v[64:67], v[60:63], a[144:151], v23
  v_smfmac_f32_16x16x64_bf16 v[68:71], v[60:63], a[152:159], v23
  v_smfmac_f32_16x16x64_bf16 v[72:75], v[60:63], a[160:167], v23
  v_smfmac_f32_16x16x64_bf16 v[76:79], v[60:63], a[168:175], v23
FL_m_done:
  s_nop 4
  v_pk_add_f32 v[88:89], v[64:65], v[66:67]
  v_pk_add_f32 v[90:91], v[68:69], v[70:71]
  ds_write_b128 v4, v[88:91] offset:0
  v_pk_add_f32 v[92:93], v[72:73], v[74:75]
  v_pk_add_f32 v[94:95], v[76:77], v[78:79]
  ds_write_b128 v4, v[92:95] offset:1088
  v_smfmac_f32_16x16x64_bf16 v[80:83], v[48:51], a[32:39], v23
  buffer_load_dwordx4 v[180:183], v12, s[4:7], s44 offen offset:0
  v_mov_b32 v36, 0
  v_smfmac_f32_16x16x64_bf16 v[84:87], v[48:51], a[40:47], v23
  buffer_load_dwordx4 v[184:187], v12, s[4:7], s44 offen offset:128
  v_mov_b32 v37, 0
  v_smfmac_f32_16x16x64_bf16 v[80:83], v[52:55], a[80:87], v23
  buffer_load_dwordx4 v[188:191], v12, s[4:7], s44 offen offset:1024
  v_mov_b32 v38, 0
  v_smfmac_f32_16x16x64_bf16 v[84:87], v[52:55], a[88:95], v23
  buffer_load_dwordx4 v[192:195], v12, s[4:7], s44 offen offset:1152
  v_mov_b32 v39, 0
  v_smfmac_f32_16x16x64_bf16 v[80:83], v[56:59], a[128:135], v23
  buffer_load_dwordx4 v[196:199], v13, s[4:7], s44 offen offset:0
  v_mov_b32 v40, 0
  s_waitcnt lgkmcnt(0)
  s_barrier
  ds_read2_b32 v[100:101], v6 offset0:0 offset1:2
  ds_read2_b32 v[102:103], v240 offset0:0 offset1:2
  ds_read2_b32 v[104:105], v241 offset0:0 offset1:2
  ds_read2_b32 v[106:107], v242 offset0:0 offset1:2
  v_smfmac_f32_16x16x64_bf16 v[84:87], v[56:59], a[136:143], v23
  v_mov_b32 v41, 0
  v_smfmac_f32_16x16x64_bf16 v[80:83], v[60:63], a[176:183], v23
  v_mov_b32 v42, 0
  v_smfmac_f32_16x16x64_bf16 v[84:87], v[60:63], a[184:191], v23
  v_mov_b32 v43, 0
  v_mov_b32 v44, 0
  v_mov_b32 v45, 0
  v_mov_b32 v46, 0
  v_mov_b32 v47, 0
  s_waitcnt lgkmcnt(2)
  v_pk_add_f32 v[100:101], v[100:101], v[102:103]
  s_waitcnt lgkmcnt(0)
  v_pk_add_f32 v[104:105], v[104:105], v[106:107]
  v_pk_add_f32 v[100:101], v[100:101], v[104:105]
  v_cvt_pk_bf16_f32 v112, v100, v101
  v_min_u32 v112, s54, v112
  buffer_store_dword v112, v7, s[4:7], s41 offen
  v_pk_add_f32 v[96:97], v[80:81], v[82:83]
  v_pk_add_f32 v[98:99], v[84:85], v[86:87]
  ds_write_b128 v4, v[96:99] offset:2176
  v_mov_b64 v[212:213], 0
  v_mov_b64 v[214:215], 0
  v_mov_b64 v[216:217], 0
  v_mov_b64 v[218:219], 0
  v_mov_b64 v[220:221], 0
  v_mov_b64 v[222:223], 0
  v_mov_b64 v[224:225], 0
  v_mov_b64 v[226:227], 0
  v_mov_b64 v[228:229], 0
  v_mov_b64 v[230:231], 0
  s_waitcnt lgkmcnt(0)
  s_barrier
  ds_read_b64 v[88:89], v5 offset:0
  buffer_load_dwordx4 v[64:67], v9, s[4:7], s41 offen offset:0 sc1
  s_mov_b32 s42, s41
  s_add_u32 s90, s40, 1
  ds_read_b64 v[90:91], v5 offset:3264
  buffer_load_dwordx4 v[68:71], v9, s[4:7], s41 offen offset:1024 sc1
  s_and_b32 s90, s90, 3
  s_lshl_b32 s90, s90, 19
  ds_read_b64 v[92:93], v5 offset:6528
  buffer_load_dwordx4 v[72:75], v9, s[4:7], s41 offen offset:2048 sc1
  s_add_u32 s91, s90, 0x3800000
  s_add_u32 s55, s55, 0x40000
  ds_read_b64 v[94:95], v5 offset:9792
  buffer_load_dwordx4 v[76:79], v9, s[4:7], s41 offen offset:3072 sc1
  s_min_u32 s55, s55, 0xfc0000
  s_nop 0
  s_waitcnt lgkmcnt(2)
  v_pk_add_f32 v[88:89], v[88:89], v[90:91]
  s_waitcnt lgkmcnt(0)
  v_pk_add_f32 v[92:93], v[92:93], v[94:95]
  v_pk_add_f32 v[88:89], v[88:89], v[92:93]
  v_cvt_pk_bf16_f32 v113, v88, v89
  v_min_u32 v113, s54, v113
  buffer_store_dword v113, v8, s[4:7], s41 offen
  s_add_u32 s8, s94, s55
  s_addc_u32 s9, s95, 0
  s_add_u32 s8, s8, s12
  s_addc_u32 s9, s9, 0
  s_add_u32 s10, s8, 0x1000000
  s_addc_u32 s11, s9, 0
  s_load_dword s16, s[8:9], 0
  s_load_dword s17, s[10:11], 0
  s_load_dword s18, s[8:9], 64
  s_load_dword s19, s[10:11], 64
  s_load_dword s20, s[8:9], 128
  s_load_dword s21, s[10:11], 128
  s_load_dword s22, s[8:9], 192
  s_load_dword s23, s[10:11], 192
  s_cmp_eq_u32 s40, 63
  s_cbranch_scc1 FL_last
  s_waitcnt vmcnt(4)
  v_max3_u32 v31, v64, v65, v66
  v_max_u32 v31, v31, v67
  v_cmp_eq_u32 vcc, -1, v31
  s_cbranch_vccnz FL_x_f0
  v_mfma_f32_16x16x32_bf16 v[44:47], v[64:67], v[64:67], v[44:47]
  s_waitcnt vmcnt(3)
  v_max3_u32 v31, v68, v69, v70
  v_max_u32 v31, v31, v71
  v_cmp_eq_u32 vcc, -1, v31
  v_mfma_f32_16x16x32_bf16 v[36:39], v[116:119], v[64:67], v[36:39]
  v_mfma_f32_16x16x32_bf16 v[40:43], v[132:135], v[64:67], v[40:43]
  s_cbranch_vccnz FL_x_f1
  v_mfma_f32_16x16x32_bf16 v[44:47], v[68:71], v[68:71], v[44:47]
  s_waitcnt vmcnt(2)
  v_max3_u32 v31, v72, v73, v74
  v_max_u32 v31, v31, v75
  v_cmp_eq_u32 vcc, -1, v31
  v_mfma_f32_16x16x32_bf16 v[36:39], v[120:123], v[68:71], v[36:39]
  v_mfma_f32_16x16x32_bf16 v[40:43], v[136:139], v[68:71], v[40:43]
  s_cbranch_vccnz FL_x_f2
  v_mfma_f32_16x16x32_bf16 v[44:47], v[72:75], v[72:75], v[44:47]
  s_waitcnt vmcnt(1)
  v_max3_u32 v31, v76, v77, v78
  v_max_u32 v31, v31, v79
  v_cmp_eq_u32 vcc, -1, v31
  v_mfma_f32_16x16x32_bf16 v[36:39], v[124:127], v[72:75], v[36:39]
  v_mfma_f32_16x16x32_bf16 v[40:43], v[140:143], v[72:75], v[40:43]
  s_cbranch_vccnz FL_x_f3
  v_mfma_f32_16x16x32_bf16 v[44:47], v[76:79], v[76:79], v[44:47]
  v_mfma_f32_16x16x32_bf16 v[36:39], v[128:131], v[76:79], v[36:39]
  v_mfma_f32_16x16x32_bf16 v[40:43], v[144:147], v[76:79], v[40:43]
FL_x_done:
  buffer_load_dwordx4 v[88:91], v10, s[4:7], s41 offen offset:0 sc1
  buffer_load_dwordx4 v[92:95], v10, s[4:7], s41 offen offset:1024 sc1
  s_mov_b64 vcc, s[48:49]
  s_nop 2
  v_max_f32 v30, v46, v47
  s_nop 0
  v_cndmask_b32_dpp v96, v40, v36, vcc quad_perm:[0,1,0,1] row_mask:0xf bank_mask:0xf
  v_cndmask_b32_dpp v97, v41, v37, vcc quad_perm:[0,1,0,1] row_mask:0xf bank_mask:0xf
  v_cndmask_b32_dpp v98, v42, v38, vcc quad_perm:[0,1,0,1] row_mask:0xf bank_mask:0xf
  v_cndmask_b32_dpp v99, v43, v39, vcc quad_perm:[0,1,0,1] row_mask:0xf bank_mask:0xf
  v_max3_f32 v29, v96, v97, v98
  s_nop 0
  v_max_f32_dpp v28, v30, v99 quad_perm:[0,1,0,1] row_mask:0xf bank_mask:0xf
  v_max_f32 v29, v29, v28
  s_nop 1
  v_max_f32_dpp v28, v29, v29 quad_perm:[2,3,0,1] row_mask:0xf bank_mask:0xf
  v_mov_b32 v29, v28
  s_nop 1
  v_permlane32_swap_b32 v28, v29
  v_max_f32 v28, v28, v29
  v_mov_b32 v29, v28
  s_nop 1
  v_permlane16_swap_b32 v28, v29
  v_max_f32 v28, v28, v29
  v_mul_f32 v28, s47, v28
  v_fma_f32 v96, v96, s47, -v28
  v_fma_f32 v97, v97, s47, -v28
  v_fma_f32 v98, v98, s47, -v28
  v_fma_f32 v99, v99, s47, -v28
  v_fma_f32 v46, v46, s47, -v28
  v_fma_f32 v47, v47, s47, -v28
  v_exp_f32 v96, v96
  v_exp_f32 v97, v97
  v_exp_f32 v98, v98
  v_exp_f32 v99, v99
  v_cvt_pk_bf16_f32 v236, v96, v97
  v_cvt_pk_bf16_f32 v237, v98, v99
  v_exp_f32 v46, v46
  v_mov_b32_dpp v100, v236 quad_perm:[0,1,0,1] row_mask:0xf bank_mask:0xf
  v_mov_b32_dpp v102, v236 quad_perm:[2,3,2,3] row_mask:0xf bank_mask:0xf
  v_mov_b32_dpp v101, v237 quad_perm:[0,1,0,1] row_mask:0xf bank_mask:0xf
  v_mov_b32_dpp v103, v237 quad_perm:[2,3,2,3] row_mask:0xf bank_mask:0xf
  v_exp_f32 v47, v47
  s_nop 0
  v_smfmac_f32_16x16x64_bf16 v[228:231], v[100:103], v[248:255], v23
  v_cvt_pk_bf16_f32 v238, v46, v47
  buffer_load_dwordx4 v[116:119], v11, s[4:7], s44 offen offset:0
  v_smfmac_f32_16x16x64_bf16 v[212:215], v[100:103], v[148:155], v23
  buffer_load_dwordx4 v[132:135], v11, s[4:7], s44 offen offset:64
  v_mov_b32_dpp v232, v238 quad_perm:[0,1,0,1] row_mask:0xf bank_mask:0xf
  v_smfmac_f32_16x16x64_bf16 v[216:219], v[100:103], v[156:163], v23
  buffer_load_dwordx4 v[120:123], v11, s[4:7], s44 offen offset:1024
  v_mov_b32_dpp v235, v238 quad_perm:[0,1,0,1] row_mask:0xf bank_mask:0xf
  v_smfmac_f32_16x16x64_bf16 v[220:223], v[100:103], v[164:171], v23
  buffer_load_dwordx4 v[136:139], v11, s[4:7], s44 offen offset:1088
  s_waitcnt vmcnt(4)
  v_max3_u32 v31, v88, v89, v90
  v_max3_u32 v31, v31, v91, v92
  v_smfmac_f32_16x16x32_bf16 v[228:231], v[232:233], v[248:251], v23
  v_max3_u32 v31, v31, v93, v94
  v_max_u32 v31, v31, v95
  v_cmp_eq_u32 vcc, -1, v31
  v_smfmac_f32_16x16x64_bf16 v[224:227], v[100:103], v[172:179], v23
  s_cbranch_vccnz FL_v_f
FL_v_ok:
  v_smfmac_f32_16x16x32_bf16 v[212:215], v[232:233], v[88:91], v23
  buffer_load_dwordx4 v[124:127], v11, s[4:7], s44 offen offset:2048
  buffer_load_dwordx4 v[140:143], v11, s[4:7], s44 offen offset:2112
  v_smfmac_f32_16x16x32_bf16 v[216:219], v[234:235], v[88:91], v23
  v_rcp_f32 v28, v228
  v_smfmac_f32_16x16x32_bf16 v[220:223], v[232:233], v[92:95], v23
  v_rcp_f32 v29, v229
  v_smfmac_f32_16x16x32_bf16 v[224:227], v[234:235], v[92:95], v23
  s_nop 0
  v_pk_mul_f32 v[212:213], v[212:213], v[28:29]
  v_pk_mul_f32 v[214:215], v[214:215], v[28:29]
  v_cvt_pk_bf16_f32 v104, v212, v214
  v_cvt_pk_bf16_f32 v108, v213, v215
  v_pk_mul_f32 v[216:217], v[216:217], v[28:29]
  v_pk_mul_f32 v[218:219], v[218:219], v[28:29]
  v_cvt_pk_bf16_f32 v105, v216, v218
  v_cvt_pk_bf16_f32 v109, v217, v219
  v_pk_mul_f32 v[220:221], v[220:221], v[28:29]
  v_pk_mul_f32 v[222:223], v[222:223], v[28:29]
  v_cvt_pk_bf16_f32 v106, v220, v222
  v_cvt_pk_bf16_f32 v110, v221, v223
  v_pk_mul_f32 v[224:225], v[224:225], v[28:29]
  v_pk_mul_f32 v[226:227], v[226:227], v[28:29]
  v_cvt_pk_bf16_f32 v107, v224, v226
  v_cvt_pk_bf16_f32 v111, v225, v227
  ds_write_b128 v14, v[104:107]
  ds_write_b128 v15, v[108:111]
  s_add_u32 s92, s40, 3
  s_min_u32 s92, s92, 63
  s_lshr_b32 s92, s92, 2
  s_lshl_b32 s92, s92, 9
  v_mov_b32 v246, s40
  s_waitcnt lgkmcnt(0)
  s_barrier
  ds_read_b128 v[48:51], v16 offset:0
  ds_read_b128 v[52:55], v16 offset:1024
  ds_read_b128 v[56:59], v16 offset:2048
  ds_read_b128 v[60:63], v16 offset:3072
  ds_read_b128 v[64:67], v16 offset:4096
  buffer_store_dword v22, v17, s[4:7], s43 offen sc1
  buffer_store_dword v112, v19, s[4:7], s45 offen sc1
  s_waitcnt lgkmcnt(4)
  v_smfmac_f32_16x16x64_bf16 v[32:35], v[48:51], a[192:199], v23
  ds_read_b128 v[68:71], v16 offset:5120
  buffer_store_dword v113, v20, s[4:7], s45 offen sc1
  s_waitcnt lgkmcnt(4)
  v_smfmac_f32_16x16x64_bf16 v[32:35], v[52:55], a[200:207], v23
  ds_read_b128 v[72:75], v16 offset:6144
  buffer_store_dword v246, v245, s[4:7], 0 offen sc1
  s_waitcnt lgkmcnt(4)
  v_smfmac_f32_16x16x64_bf16 v[32:35], v[56:59], a[208:215], v23
  ds_read_b128 v[76:79], v16 offset:7168
  buffer_load_dword v243, v244, s[4:7], s92 offen sc1
  s_waitcnt lgkmcnt(4)
  v_smfmac_f32_16x16x64_bf16 v[32:35], v[60:63], a[216:223], v23
  s_mov_b32 s13, s43
  s_waitcnt lgkmcnt(3)
  v_smfmac_f32_16x16x64_bf16 v[32:35], v[64:67], a[224:231], v23
  s_add_u32 s40, s40, 1
  s_waitcnt lgkmcnt(2)
  v_smfmac_f32_16x16x64_bf16 v[32:35], v[68:71], a[232:239], v23
  s_mov_b32 s41, s91
  s_waitcnt lgkmcnt(1)
  v_smfmac_f32_16x16x64_bf16 v[32:35], v[72:75], a[240:247], v23
  s_xor_b32 s43, s91, 0x100000
  s_waitcnt lgkmcnt(0)
  v_smfmac_f32_16x16x64_bf16 v[32:35], v[76:79], a[248:255], v23
  s_nop 7
  v_pk_add_f32 v[28:29], v[32:33], v[34:35]
  v_cvt_pk_bf16_f32 v28, v28, v29
  v_min_u32 v28, s54, v28
  buffer_store_dword v28, v17, s[4:7], s42 offen sc1
  buffer_store_dword v28, v18, s[4:7], s42 offen
  s_branch FL_step
FL_last:
  buffer_store_dword v112, v19, s[4:7], s45 offen sc1
  buffer_store_dword v113, v20, s[4:7], s45 offen sc1
  s_waitcnt vmcnt(0)
  s_barrier
  s_lshl_b32 s90, s35, 7
  s_add_u32 s90, s90, 0x3d01000
  s_cmp_lg_u32 s32, 0
  s_cbranch_scc1 FL_sig_8
  v_mov_b32 v254, 1
  v_mov_b32 v255, 0
  s_mov_b64 exec, 1
  buffer_atomic_add v254, v255, s[4:7], s90 offen offset:0 sc1
  s_mov_b64 exec, -1
FL_sig_8:
  s_waitcnt vmcnt(0)
  s_branch L_join
FL_kv_f:
  s_sleep 8
  buffer_load_dword v243, v244, s[4:7], s92 offen sc1
  s_add_u32 s46, s46, 1
  s_cmp_ge_u32 s46, 131072
  s_cbranch_scc1 FL_rec_abort
  s_waitcnt vmcnt(0)
  s_branch FL_kv_chk
FL_g_f:
  s_mov_b64 exec, vcc
  buffer_load_dwordx4 v[36:39], v1, s[4:7], s42 offen sc1
  s_mov_b64 exec, -1
  s_add_u32 s46, s46, 1
  s_cmp_ge_u32 s46, 131072
  s_cbranch_scc1 FL_rec_abort
  s_waitcnt vmcnt(0)
  s_branch FL_g_chk
FL_m_f0:
  s_mov_b64 exec, vcc
  buffer_load_dwordx4 v[48:51], v3, s[4:7], s41 offen offset:0 sc1
  s_mov_b64 exec, -1
  s_waitcnt vmcnt(1)
  s_branch FL_m_0123_c1
FL_m_f1:
  s_mov_b64 exec, vcc
  buffer_load_dwordx4 v[52:55], v3, s[4:7], s41 offen offset:1024 sc1
  s_mov_b64 exec, -1
  s_waitcnt vmcnt(1)
  s_branch FL_m_123_c2
FL_m_f2:
  s_mov_b64 exec, vcc
  buffer_load_dwordx4 v[56:59], v3, s[4:7], s41 offen offset:2048 sc1
  s_mov_b64 exec, -1
  s_waitcnt vmcnt(1)
  s_branch FL_m_23_c3
FL_m_f3:
  s_mov_b64 exec, vcc
  buffer_load_dwordx4 v[60:63], v3, s[4:7], s41 offen offset:3072 sc1
  s_mov_b64 exec, -1
  s_nop 7
  s_branch FL_m_3_c3
FL_m_0_c0:
  v_max3_u32 v31, v48, v49, v50
  v_max_u32 v31, v31, v51
  v_cmp_eq_u32 vcc, -1, v31
  s_cbranch_vccz FL_m_0_ok0
FL_m_0_x0:
  s_mov_b64 exec, vcc
  buffer_load_dwordx4 v[48:51], v3, s[4:7], s41 offen offset:0 sc1
  s_mov_b64 exec, -1
  s_add_u32 s46, s46, 1
  s_cmp_ge_u32 s46, 131072
  s_cbranch_scc1 FL_rec_abort
  s_waitcnt vmcnt(2)
  s_branch FL_m_0_c0
FL_m_0_ok0:
  v_smfmac_f32_16x16x64_bf16 v[64:67], v[48:51], a[0:7], v23
  v_smfmac_f32_16x16x64_bf16 v[68:71], v[48:51], a[8:15], v23
  v_smfmac_f32_16x16x64_bf16 v[72:75], v[48:51], a[16:23], v23
  v_smfmac_f32_16x16x64_bf16 v[76:79], v[48:51], a[24:31], v23
  s_branch FL_m_done
FL_m_1_c1:
  v_max3_u32 v31, v52, v53, v54
  v_max_u32 v31, v31, v55
  v_cmp_eq_u32 vcc, -1, v31
  s_cbranch_vccz FL_m_1_ok1
FL_m_1_x1:
  s_mov_b64 exec, vcc
  buffer_load_dwordx4 v[52:55], v3, s[4:7], s41 offen offset:1024 sc1
  s_mov_b64 exec, -1
  s_add_u32 s46, s46, 1
  s_cmp_ge_u32 s46, 131072
  s_cbranch_scc1 FL_rec_abort
  s_waitcnt vmcnt(2)
  s_branch FL_m_1_c1
FL_m_1_ok1:
  v_smfmac_f32_16x16x64_bf16 v[64:67], v[52:55], a[48:55], v23
  v_smfmac_f32_16x16x64_bf16 v[68:71], v[52:55], a[56:63], v23
  v_smfmac_f32_16x16x64_bf16 v[72:75], v[52:55], a[64:71], v23
  v_smfmac_f32_16x16x64_bf16 v[76:79], v[52:55], a[72:79], v23
  s_branch FL_m_done
FL_m_2_c2:
  v_max3_u32 v31, v56, v57, v58
  v_max_u32 v31, v31, v59
  v_cmp_eq_u32 vcc, -1, v31
  s_cbranch_vccz FL_m_2_ok2
FL_m_2_x2:
  s_mov_b64 exec, vcc
  buffer_load_dwordx4 v[56:59], v3, s[4:7], s41 offen offset:2048 sc1
  s_mov_b64 exec, -1
  s_add_u32 s46, s46, 1
  s_cmp_ge_u32 s46, 131072
  s_cbranch_scc1 FL_rec_abort
  s_waitcnt vmcnt(2)
  s_branch FL_m_2_c2
FL_m_2_ok2:
  v_smfmac_f32_16x16x64_bf16 v[64:67], v[56:59], a[96:103], v23
  v_smfmac_f32_16x16x64_bf16 v[68:71], v[56:59], a[104:111], v23
  v_smfmac_f32_16x16x64_bf16 v[72:75], v[56:59], a[112:119], v23
  v_smfmac_f32_16x16x64_bf16 v[76:79], v[56:59], a[120:127], v23
  s_branch FL_m_done
FL_m_3_c3:
  v_max3_u32 v31, v60, v61, v62
  v_max_u32 v31, v31, v63
  v_cmp_eq_u32 vcc, -1, v31
  s_cbranch_vccz FL_m_3_ok3
FL_m_3_x3:
  s_mov_b64 exec, vcc
  buffer_load_dwordx4 v[60:63], v3, s[4:7], s41 offen offset:3072 sc1
  s_mov_b64 exec, -1
  s_add_u32 s46, s46, 1
  s_cmp_ge_u32 s46, 131072
  s_cbranch_scc1 FL_rec_abort
  s_waitcnt vmcnt(2)
  s_branch FL_m_3_c3
FL_m_3_ok3:
  v_smfmac_f32_16x16x64_bf16 v[64:67], v[60:63], a[144:151], v23
  v_smfmac_f32_16x16x64_bf16 v[68:71], v[60:63], a[152:159], v23
  v_smfmac_f32_16x16x64_bf16 v[72:75], v[60:63], a[160:167], v23
  v_smfmac_f32_16x16x64_bf16 v[76:79], v[60:63], a[168:175], v23
  s_branch FL_m_done
FL_m_01_c0:
  v_max3_u32 v31, v48, v49, v50
  v_max_u32 v31, v31, v51
  v_cmp_eq_u32 vcc, -1, v31
  s_cbranch_vccz FL_m_01_ok0
FL_m_01_x0:
  s_mov_b64 exec, vcc
  buffer_load_dwordx4 v[48:51], v3, s[4:7], s41 offen offset:0 sc1
  s_mov_b64 exec, -1
FL_m_01_c1:
  v_max3_u32 v31, v52, v53, v54
  v_max_u32 v31, v31, v55
  v_cmp_eq_u32 vcc, -1, v31
  s_cbranch_vccz FL_m_01_ok1
FL_m_01_x1:
  s_mov_b64 exec, vcc
  buffer_load_dwordx4 v[52:55], v3, s[4:7], s41 offen offset:1024 sc1
  s_mov_b64 exec, -1
  s_add_u32 s46, s46, 1
  s_cmp_ge_u32 s46, 131072
  s_cbranch_scc1 FL_rec_abort
  s_waitcnt vmcnt(4)
  s_branch FL_m_01_c0
FL_m_01_ok0:
  v_smfmac_f32_16x16x64_bf16 v[64:67], v[48:51], a[0:7], v23
  v_max3_u32 v31, v52, v53, v54
  v_max_u32 v31, v31, v55
  v_cmp_eq_u32 vcc, -1, v31
  v_smfmac_f32_16x16x64_bf16 v[68:71], v[48:51], a[8:15], v23
  v_smfmac_f32_16x16x64_bf16 v[72:75], v[48:51], a[16:23], v23
  v_smfmac_f32_16x16x64_bf16 v[76:79], v[48:51], a[24:31], v23
  s_cbranch_vccz FL_m_1_ok1
  s_branch FL_m_1_x1
FL_m_01_ok1:
  v_smfmac_f32_16x16x64_bf16 v[64:67], v[52:55], a[48:55], v23
  v_max3_u32 v31, v48, v49, v50
  v_max_u32 v31, v31, v51
  v_cmp_eq_u32 vcc, -1, v31
  v_smfmac_f32_16x16x64_bf16 v[68:71], v[52:55], a[56:63], v23
  v_smfmac_f32_16x16x64_bf16 v[72:75], v[52:55], a[64:71], v23
  v_smfmac_f32_16x16x64_bf16 v[76:79], v[52:55], a[72:79], v23
  s_cbranch_vccz FL_m_0_ok0
  s_branch FL_m_0_x0
FL_m_02_c0:
  v_max3_u32 v31, v48, v49, v50
  v_max_u32 v31, v31, v51
  v_cmp_eq_u32 vcc, -1, v31
  s_cbranch_vccz FL_m_02_ok0
FL_m_02_x0:
  s_mov_b64 exec, vcc
  buffer_load_dwordx4 v[48:51], v3, s[4:7], s41 offen offset:0 sc1
  s_mov_b64 exec, -1
FL_m_02_c2:
  v_max3_u32 v31, v56, v57, v58
  v_max_u32 v31, v31, v59
  v_cmp_eq_u32 vcc, -1, v31
  s_cbranch_vccz FL_m_02_ok2
FL_m_02_x2:
  s_mov_b64 exec, vcc
  buffer_load_dwordx4 v[56:59], v3, s[4:7], s41 offen offset:2048 sc1
  s_mov_b64 exec, -1
  s_add_u32 s46, s46, 1
  s_cmp_ge_u32 s46, 131072
  s_cbranch_scc1 FL_rec_abort
  s_waitcnt vmcnt(4)
  s_branch FL_m_02_c0
FL_m_02_ok0:
  v_smfmac_f32_16x16x64_bf16 v[64:67], v[48:51], a[0:7], v23
  v_max3_u32 v31, v56, v57, v58
  v_max_u32 v31, v31, v59
  v_cmp_eq_u32 vcc, -1, v31
  v_smfmac_f32_16x16x64_bf16 v[68:71], v[48:51], a[8:15], v23
  v_smfmac_f32_16x16x64_bf16 v[72:75], v[48:51], a[16:23], v23
  v_smfmac_f32_16x16x64_bf16 v[76:79], v[48:51], a[24:31], v23
  s_cbranch_vccz FL_m_2_ok2
  s_branch FL_m_2_x2
FL_m_02_ok2:
  v_smfmac_f32_16x16x64_bf16 v[64:67], v[56:59], a[96:103], v23
  v_max3_u32 v31, v48, v49, v50
  v_max_u32 v31, v31, v51
  v_cmp_eq_u32 vcc, -1, v31
  v_smfmac_f32_16x16x64_bf16 v[68:71], v[56:59], a[104:111], v23
  v_smfmac_f32_16x16x64_bf16 v[72:75], v[56:59], a[112:119], v23
  v_smfmac_f32_16x16x64_bf16 v[76:79], v[56:59], a[120:127], v23
  s_cbranch_vccz FL_m_0_ok0
  s_branch FL_m_0_x0
FL_m_03_c0:
  v_max3_u32 v31, v48, v49, v50
  v_max_u32 v31, v31, v51
  v_cmp_eq_u32 vcc, -1, v31
  s_cbranch_vccz FL_m_03_ok0
FL_m_03_x0:
  s_mov_b64 exec, vcc
  buffer_load_dwordx4 v[48:51], v3, s[4:7], s41 offen offset:0 sc1
  s_mov_b64 exec, -1
FL_m_03_c3:
  v_max3_u32 v31, v60, v61, v62
  v_max_u32 v31, v31, v63
  v_cmp_eq_u32 vcc, -1, v31
  s_cbranch_vccz FL_m_03_ok3
FL_m_03_x3:
  s_mov_b64 exec, vcc
  buffer_load_dwordx4 v[60:63], v3, s[4:7], s41 offen offset:3072 sc1
  s_mov_b64 exec, -1
  s_add_u32 s46, s46, 1
  s_cmp_ge_u32 s46, 131072
  s_cbranch_scc1 FL_rec_abort
  s_waitcnt vmcnt(4)
  s_branch FL_m_03_c0
FL_m_03_ok0:
  v_smfmac_f32_16x16x64_bf16 v[64:67], v[48:51], a[0:7], v23
  v_max3_u32 v31, v60, v61, v62
  v_max_u32 v31, v31, v63
  v_cmp_eq_u32 vcc, -1, v31
  v_smfmac_f32_16x16x64_bf16 v[68:71], v[48:51], a[8:15], v23
  v_smfmac_f32_16x16x64_bf16 v[72:75], v[48:51], a[16:23], v23
  v_smfmac_f32_16x16x64_bf16 v[76:79], v[48:51], a[24:31], v23
  s_cbranch_vccz FL_m_3_ok3
  s_branch FL_m_3_x3
FL_m_03_ok3:
  v_smfmac_f32_16x16x64_bf16 v[64:67], v[60:63], a[144:151], v23
  v_max3_u32 v31, v48, v49, v50
  v_max_u32 v31, v31, v51
  v_cmp_eq_u32 vcc, -1, v31
  v_smfmac_f32_16x16x64_bf16 v[68:71], v[60:63], a[152:159], v23
  v_smfmac_f32_16x16x64_bf16 v[72:75], v[60:63], a[160:167], v23
  v_smfmac_f32_16x16x64_bf16 v[76:79], v[60:63], a[168:175], v23
  s_cbranch_vccz FL_m_0_ok0
  s_branch FL_m_0_x0
FL_m_12_c1:
  v_max3_u32 v31, v52, v53, v54
  v_max_u32 v31, v31, v55
  v_cmp_eq_u32 vcc, -1, v31
  s_cbranch_vccz FL_m_12_ok1
FL_m_12_x1:
  s_mov_b64 exec, vcc
  buffer_load_dwordx4 v[52:55], v3, s[4:7], s41 offen offset:1024 sc1
  s_mov_b64 exec, -1
FL_m_12_c2:
  v_max3_u32 v31, v56, v57, v58
  v_max_u32 v31, v31, v59
  v_cmp_eq_u32 vcc, -1, v31
  s_cbranch_vccz FL_m_12_ok2
FL_m_12_x2:
  s_mov_b64 exec, vcc
  buffer_load_dwordx4 v[56:59], v3, s[4:7], s41 offen offset:2048 sc1
  s_mov_b64 exec, -1
  s_add_u32 s46, s46, 1
  s_cmp_ge_u32 s46, 131072
  s_cbranch_scc1 FL_rec_abort
  s_waitcnt vmcnt(4)
  s_branch FL_m_12_c1
FL_m_12_ok1:
  v_smfmac_f32_16x16x64_bf16 v[64:67], v[52:55], a[48:55], v23
  v_max3_u32 v31, v56, v57, v58
  v_max_u32 v31, v31, v59
  v_cmp_eq_u32 vcc, -1, v31
  v_smfmac_f32_16x16x64_bf16 v[68:71], v[52:55], a[56:63], v23
  v_smfmac_f32_16x16x64_bf16 v[72:75], v[52:55], a[64:71], v23
  v_smfmac_f32_16x16x64_bf16 v[76:79], v[52:55], a[72:79], v23
  s_cbranch_vccz FL_m_2_ok2
  s_branch FL_m_2_x2
FL_m_12_ok2:
  v_smfmac_f32_16x16x64_bf16 v[64:67], v[56:59], a[96:103], v23
  v_max3_u32 v31, v52, v53, v54
  v_max_u32 v31, v31, v55
  v_cmp_eq_u32 vcc, -1, v31
  v_smfmac_f32_16x16x64_bf16 v[68:71], v[56:59], a[104:111], v23
  v_smfmac_f32_16x16x64_bf16 v[72:75], v[56:59], a[112:119], v23
  v_smfmac_f32_16x16x64_bf16 v[76:79], v[56:59], a[120:127], v23
  s_cbranch_vccz FL_m_1_ok1
  s_branch FL_m_1_x1
FL_m_13_c1:
  v_max3_u32 v31, v52, v53, v54
  v_max_u32 v31, v31, v55
  v_cmp_eq_u32 vcc, -1, v31
  s_cbranch_vccz FL_m_13_ok1
FL_m_13_x1:
  s_mov_b64 exec, vcc
  buffer_load_dwordx4 v[52:55], v3, s[4:7], s41 offen offset:1024 sc1
  s_mov_b64 exec, -1
FL_m_13_c3:
  v_max3_u32 v31, v60, v61, v62
  v_max_u32 v31, v31, v63
  v_cmp_eq_u32 vcc, -1, v31
  s_cbranch_vccz FL_m_13_ok3
FL_m_13_x3:
  s_mov_b64 exec, vcc
  buffer_load_dwordx4 v[60:63], v3, s[4:7], s41 offen offset:3072 sc1
  s_mov_b64 exec, -1
  s_add_u32 s46, s46, 1
  s_cmp_ge_u32 s46, 131072
  s_cbranch_scc1 FL_rec_abort
  s_waitcnt vmcnt(4)
  s_branch FL_m_13_c1
FL_m_13_ok1:
  v_smfmac_f32_16x16x64_bf16 v[64:67], v[52:55], a[48:55], v23
  v_max3_u32 v31, v60, v61, v62
  v_max_u32 v31, v31, v63
  v_cmp_eq_u32 vcc, -1, v31
  v_smfmac_f32_16x16x64_bf16 v[68:71], v[52:55], a[56:63], v23
  v_smfmac_f32_16x16x64_bf16 v[72:75], v[52:55], a[64:71], v23
  v_smfmac_f32_16x16x64_bf16 v[76:79], v[52:55], a[72:79], v23
  s_cbranch_vccz FL_m_3_ok3
  s_branch FL_m_3_x3
FL_m_13_ok3:
  v_smfmac_f32_16x16x64_bf16 v[64:67], v[60:63], a[144:151], v23
  v_max3_u32 v31, v52, v53, v54
  v_max_u32 v31, v31, v55
  v_cmp_eq_u32 vcc, -1, v31
  v_smfmac_f32_16x16x64_bf16 v[68:71], v[60:63], a[152:159], v23
  v_smfmac_f32_16x16x64_bf16 v[72:75], v[60:63], a[160:167], v23
  v_smfmac_f32_16x16x64_bf16 v[76:79], v[60:63], a[168:175], v23
  s_cbranch_vccz FL_m_1_ok1
  s_branch FL_m_1_x1
FL_m_23_c2:
  v_max3_u32 v31, v56, v57, v58
  v_max_u32 v31, v31, v59
  v_cmp_eq_u32 vcc, -1, v31
  s_cbranch_vccz FL_m_23_ok2
FL_m_23_x2:
  s_mov_b64 exec, vcc
  buffer_load_dwordx4 v[56:59], v3, s[4:7], s41 offen offset:2048 sc1
  s_mov_b64 exec, -1
FL_m_23_c3:
  v_max3_u32 v31, v60, v61, v62
  v_max_u32 v31, v31, v63
  v_cmp_eq_u32 vcc, -1, v31
  s_cbranch_vccz FL_m_23_ok3
FL_m_23_x3:
  s_mov_b64 exec, vcc
  buffer_load_dwordx4 v[60:63], v3, s[4:7], s41 offen offset:3072 sc1
  s_mov_b64 exec, -1
  s_add_u32 s46, s46, 1
  s_cmp_ge_u32 s46, 131072
  s_cbranch_scc1 FL_rec_abort
  s_waitcnt vmcnt(4)
  s_branch FL_m_23_c2
FL_m_23_ok2:
  v_smfmac_f32_16x16x64_bf16 v[64:67], v[56:59], a[96:103], v23
  v_max3_u32 v31, v60, v61, v62
  v_max_u32 v31, v31, v63
  v_cmp_eq_u32 vcc, -1, v31
  v_smfmac_f32_16x16x64_bf16 v[68:71], v[56:59], a[104:111], v23
  v_smfmac_f32_16x16x64_bf16 v[72:75], v[56:59], a[112:119], v23
  v_smfmac_f32_16x16x64_bf16 v[76:79], v[56:59], a[120:127], v23
  s_cbranch_vccz FL_m_3_ok3
  s_branch FL_m_3_x3
FL_m_23_ok3:
  v_smfmac_f32_16x16x64_bf16 v[64:67], v[60:63], a[144:151], v23
  v_max3_u32 v31, v56, v57, v58
  v_max_u32 v31, v31, v59
  v_cmp_eq_u32 vcc, -1, v31
  v_smfmac_f32_16x16x64_bf16 v[68:71], v[60:63], a[152:159], v23
  v_smfmac_f32_16x16x64_bf16 v[72:75], v[60:63], a[160:167], v23
  v_smfmac_f32_16x16x64_bf16 v[76:79], v[60:63], a[168:175], v23
  s_cbranch_vccz FL_m_2_ok2
  s_branch FL_m_2_x2
FL_m_012_c0:
  v_max3_u32 v31, v48, v49, v50
  v_max_u32 v31, v31, v51
  v_cmp_eq_u32 vcc, -1, v31
  s_cbranch_vccz FL_m_012_ok0
FL_m_012_x0:
  s_mov_b64 exec, vcc
  buffer_load_dwordx4 v[48:51], v3, s[4:7], s41 offen offset:0 sc1
  s_mov_b64 exec, -1
FL_m_012_c1:
  v_max3_u32 v31, v52, v53, v54
  v_max_u32 v31, v31, v55
  v_cmp_eq_u32 vcc, -1, v31
  s_cbranch_vccz FL_m_012_ok1
FL_m_012_x1:
  s_mov_b64 exec, vcc
  buffer_load_dwordx4 v[52:55], v3, s[4:7], s41 offen offset:1024 sc1
  s_mov_b64 exec, -1
FL_m_012_c2:
  v_max3_u32 v31, v56, v57, v58
  v_max_u32 v31, v31, v59
  v_cmp_eq_u32 vcc, -1, v31
  s_cbranch_vccz FL_m_012_ok2
FL_m_012_x2:
  s_mov_b64 exec, vcc
  buffer_load_dwordx4 v[56:59], v3, s[4:7], s41 offen offset:2048 sc1
  s_mov_b64 exec, -1
  s_add_u32 s46, s46, 1
  s_cmp_ge_u32 s46, 131072
  s_cbranch_scc1 FL_rec_abort
  s_waitcnt vmcnt(4)
  s_branch FL_m_012_c0
FL_m_012_ok0:
  v_smfmac_f32_16x16x64_bf16 v[64:67], v[48:51], a[0:7], v23
  v_max3_u32 v31, v52, v53, v54
  v_max_u32 v31, v31, v55
  v_cmp_eq_u32 vcc, -1, v31
  v_smfmac_f32_16x16x64_bf16 v[68:71], v[48:51], a[8:15], v23
  v_smfmac_f32_16x16x64_bf16 v[72:75], v[48:51], a[16:23], v23
  v_smfmac_f32_16x16x64_bf16 v[76:79], v[48:51], a[24:31], v23
  s_cbranch_vccz FL_m_12_ok1
  s_branch FL_m_12_x1
FL_m_012_ok1:
  v_smfmac_f32_16x16x64_bf16 v[64:67], v[52:55], a[48:55], v23
  v_max3_u32 v31, v56, v57, v58
  v_max_u32 v31, v31, v59
  v_cmp_eq_u32 vcc, -1, v31
  v_smfmac_f32_16x16x64_bf16 v[68:71], v[52:55], a[56:63], v23
  v_smfmac_f32_16x16x64_bf16 v[72:75], v[52:55], a[64:71], v23
  v_smfmac_f32_16x16x64_bf16 v[76:79], v[52:55], a[72:79], v23
  s_cbranch_vccz FL_m_02_ok2
  s_branch FL_m_02_x2
FL_m_012_ok2:
  v_smfmac_f32_16x16x64_bf16 v[64:67], v[56:59], a[96:103], v23
  v_max3_u32 v31, v48, v49, v50
  v_max_u32 v31, v31, v51
  v_cmp_eq_u32 vcc, -1, v31
  v_smfmac_f32_16x16x64_bf16 v[68:71], v[56:59], a[104:111], v23
  v_smfmac_f32_16x16x64_bf16 v[72:75], v[56:59], a[112:119], v23
  v_smfmac_f32_16x16x64_bf16 v[76:79], v[56:59], a[120:127], v23
  s_cbranch_vccz FL_m_01_ok0
  s_branch FL_m_01_x0
FL_m_013_c0:
  v_max3_u32 v31, v48, v49, v50
  v_max_u32 v31, v31, v51
  v_cmp_eq_u32 vcc, -1, v31
  s_cbranch_vccz FL_m_013_ok0
FL_m_013_x0:
  s_mov_b64 exec, vcc
  buffer_load_dwordx4 v[48:51], v3, s[4:7], s41 offen offset:0 sc1
  s_mov_b64 exec, -1
FL_m_013_c1:
  v_max3_u32 v31, v52, v53, v54
  v_max_u32 v31, v31, v55
  v_cmp_eq_u32 vcc, -1, v31
  s_cbranch_vccz FL_m_013_ok1
FL_m_013_x1:
  s_mov_b64 exec, vcc
  buffer_load_dwordx4 v[52:55], v3, s[4:7], s41 offen offset:1024 sc1
  s_mov_b64 exec, -1
FL_m_013_c3:
  v_max3_u32 v31, v60, v61, v62
  v_max_u32 v31, v31, v63
  v_cmp_eq_u32 vcc, -1, v31
  s_cbranch_vccz FL_m_013_ok3
FL_m_013_x3:
  s_mov_b64 exec, vcc
  buffer_load_dwordx4 v[60:63], v3, s[4:7], s41 offen offset:3072 sc1
  s_mov_b64 exec, -1
  s_add_u32 s46, s46, 1
  s_cmp_ge_u32 s46, 131072
  s_cbranch_scc1 FL_rec_abort
  s_waitcnt vmcnt(4)
  s_branch FL_m_013_c0
FL_m_013_ok0:
  v_smfmac_f32_16x16x64_bf16 v[64:67], v[48:51], a[0:7], v23
  v_max3_u32 v31, v52, v53, v54
  v_max_u32 v31, v31, v55
  v_cmp_eq_u32 vcc, -1, v31
  v_smfmac_f32_16x16x64_bf16 v[68:71], v[48:51], a[8:15], v23
  v_smfmac_f32_16x16x64_bf16 v[72:75], v[48:51], a[16:23], v23
  v_smfmac_f32_16x16x64_bf16 v[76:79], v[48:51], a[24:31], v23
  s_cbranch_vccz FL_m_13_ok1
  s_branch FL_m_13_x1
FL_m_013_ok1:
  v_smfmac_f32_16x16x64_bf16 v[64:67], v[52:55], a[48:55], v23
  v_max3_u32 v31, v60, v61, v62
  v_max_u32 v31, v31, v63
  v_cmp_eq_u32 vcc, -1, v31
  v_smfmac_f32_16x16x64_bf16 v[68:71], v[52:55], a[56:63], v23
  v_smfmac_f32_16x16x64_bf16 v[72:75], v[52:55], a[64:71], v23
  v_smfmac_f32_16x16x64_bf16 v[76:79], v[52:55], a[72:79], v23
  s_cbranch_vccz FL_m_03_ok3
  s_branch FL_m_03_x3
FL_m_013_ok3:
  v_smfmac_f32_16x16x64_bf16 v[64:67], v[60:63], a[144:151], v23
  v_max3_u32 v31, v48, v49, v50
  v_max_u32 v31, v31, v51
  v_cmp_eq_u32 vcc, -1, v31
  v_smfmac_f32_16x16x64_bf16 v[68:71], v[60:63], a[152:159], v23
  v_smfmac_f32_16x16x64_bf16 v[72:75], v[60:63], a[160:167], v23
  v_smfmac_f32_16x16x64_bf16 v[76:79], v[60:63], a[168:175], v23
  s_cbranch_vccz FL_m_01_ok0
  s_branch FL_m_01_x0
FL_m_023_c0:
  v_max3_u32 v31, v48, v49, v50
  v_max_u32 v31, v31, v51
  v_cmp_eq_u32 vcc, -1, v31
  s_cbranch_vccz FL_m_023_ok0
FL_m_023_x0:
  s_mov_b64 exec, vcc
  buffer_load_dwordx4 v[48:51], v3, s[4:7], s41 offen offset:0 sc1
  s_mov_b64 exec, -1
FL_m_023_c2:
  v_max3_u32 v31, v56, v57, v58
  v_max_u32 v31, v31, v59
  v_cmp_eq_u32 vcc, -1, v31
  s_cbranch_vccz FL_m_023_ok2
FL_m_023_x2:
  s_mov_b64 exec, vcc
  buffer_load_dwordx4 v[56:59], v3, s[4:7], s41 offen offset:2048 sc1
  s_mov_b64 exec, -1
FL_m_023_c3:
  v_max3_u32 v31, v60, v61, v62
  v_max_u32 v31, v31, v63
  v_cmp_eq_u32 vcc, -1, v31
  s_cbranch_vccz FL_m_023_ok3
FL_m_023_x3:
  s_mov_b64 exec, vcc
  buffer_load_dwordx4 v[60:63], v3, s[4:7], s41 offen offset:3072 sc1
  s_mov_b64 exec, -1
  s_add_u32 s46, s46, 1
  s_cmp_ge_u32 s46, 131072
  s_cbranch_scc1 FL_rec_abort
  s_waitcnt vmcnt(4)
  s_branch FL_m_023_c0
FL_m_023_ok0:
  v_smfmac_f32_16x16x64_bf16 v[64:67], v[48:51], a[0:7], v23
  v_max3_u32 v31, v56, v57, v58
  v_max_u32 v31, v31, v59
  v_cmp_eq_u32 vcc, -1, v31
  v_smfmac_f32_16x16x64_bf16 v[68:71], v[48:51], a[8:15], v23
  v_smfmac_f32_16x16x64_bf16 v[72:75], v[48:51], a[16:23], v23
  v_smfmac_f32_16x16x64_bf16 v[76:79], v[48:51], a[24:31], v23
  s_cbranch_vccz FL_m_23_ok2
  s_branch FL_m_23_x2
FL_m_023_ok2:
  v_smfmac_f32_16x16x64_bf16 v[64:67], v[56:59], a[96:103], v23
  v_max3_u32 v31, v60, v61, v62
  v_max_u32 v31, v31, v63
  v_cmp_eq_u32 vcc, -1, v31
  v_smfmac_f32_16x16x64_bf16 v[68:71], v[56:59], a[104:111], v23
  v_smfmac_f32_16x16x64_bf16 v[72:75], v[56:59], a[112:119], v23
  v_smfmac_f32_16x16x64_bf16 v[76:79], v[56:59], a[120:127], v23
  s_cbranch_vccz FL_m_03_ok3
  s_branch FL_m_03_x3
FL_m_023_ok3:
  v_smfmac_f32_16x16x64_bf16 v[64:67], v[60:63], a[144:151], v23
  v_max3_u32 v31, v48, v49, v50
  v_max_u32 v31, v31, v51
  v_cmp_eq_u32 vcc, -1, v31
  v_smfmac_f32_16x16x64_bf16 v[68:71], v[60:63], a[152:159], v23
  v_smfmac_f32_16x16x64_bf16 v[72:75], v[60:63], a[160:167], v23
  v_smfmac_f32_16x16x64_bf16 v[76:79], v[60:63], a[168:175], v23
  s_cbranch_vccz FL_m_02_ok0
  s_branch FL_m_02_x0
FL_m_123_c1:
  v_max3_u32 v31, v52, v53, v54
  v_max_u32 v31, v31, v55
  v_cmp_eq_u32 vcc, -1, v31
  s_cbranch_vccz FL_m_123_ok1
FL_m_123_x1:
  s_mov_b64 exec, vcc
  buffer_load_dwordx4 v[52:55], v3, s[4:7], s41 offen offset:1024 sc1
  s_mov_b64 exec, -1
FL_m_123_c2:
  v_max3_u32 v31, v56, v57, v58
  v_max_u32 v31, v31, v59
  v_cmp_eq_u32 vcc, -1, v31
  s_cbranch_vccz FL_m_123_ok2
FL_m_123_x2:
  s_mov_b64 exec, vcc
  buffer_load_dwordx4 v[56:59], v3, s[4:7], s41 offen offset:2048 sc1
  s_mov_b64 exec, -1
FL_m_123_c3:
  v_max3_u32 v31, v60, v61, v62
  v_max_u32 v31, v31, v63
  v_cmp_eq_u32 vcc, -1, v31
  s_cbranch_vccz FL_m_123_ok3
FL_m_123_x3:
  s_mov_b64 exec, vcc
  buffer_load_dwordx4 v[60:63], v3, s[4:7], s41 offen offset:3072 sc1
  s_mov_b64 exec, -1
  s_add_u32 s46, s46, 1
  s_cmp_ge_u32 s46, 131072
  s_cbranch_scc1 FL_rec_abort
  s_waitcnt vmcnt(4)
  s_branch FL_m_123_c1
FL_m_123_ok1:
  v_smfmac_f32_16x16x64_bf16 v[64:67], v[52:55], a[48:55], v23
  v_max3_u32 v31, v56, v57, v58
  v_max_u32 v31, v31, v59
  v_cmp_eq_u32 vcc, -1, v31
  v_smfmac_f32_16x16x64_bf16 v[68:71], v[52:55], a[56:63], v23
  v_smfmac_f32_16x16x64_bf16 v[72:75], v[52:55], a[64:71], v23
  v_smfmac_f32_16x16x64_bf16 v[76:79], v[52:55], a[72:79], v23
  s_cbranch_vccz FL_m_23_ok2
  s_branch FL_m_23_x2
FL_m_123_ok2:
  v_smfmac_f32_16x16x64_bf16 v[64:67], v[56:59], a[96:103], v23
  v_max3_u32 v31, v60, v61, v62
  v_max_u32 v31, v31, v63
  v_cmp_eq_u32 vcc, -1, v31
  v_smfmac_f32_16x16x64_bf16 v[68:71], v[56:59], a[104:111], v23
  v_smfmac_f32_16x16x64_bf16 v[72:75], v[56:59], a[112:119], v23
  v_smfmac_f32_16x16x64_bf16 v[76:79], v[56:59], a[120:127], v23
  s_cbranch_vccz FL_m_13_ok3
  s_branch FL_m_13_x3
FL_m_123_ok3:
  v_smfmac_f32_16x16x64_bf16 v[64:67], v[60:63], a[144:151], v23
  v_max3_u32 v31, v52, v53, v54
  v_max_u32 v31, v31, v55
  v_cmp_eq_u32 vcc, -1, v31
  v_smfmac_f32_16x16x64_bf16 v[68:71], v[60:63], a[152:159], v23
  v_smfmac_f32_16x16x64_bf16 v[72:75], v[60:63], a[160:167], v23
  v_smfmac_f32_16x16x64_bf16 v[76:79], v[60:63], a[168:175], v23
  s_cbranch_vccz FL_m_12_ok1
  s_branch FL_m_12_x1
FL_m_0123_c0:
  v_max3_u32 v31, v48, v49, v50
  v_max_u32 v31, v31, v51
  v_cmp_eq_u32 vcc, -1, v31
  s_cbranch_vccz FL_m_0123_ok0
FL_m_0123_x0:
  s_mov_b64 exec, vcc
  buffer_load_dwordx4 v[48:51], v3, s[4:7], s41 offen offset:0 sc1
  s_mov_b64 exec, -1
FL_m_0123_c1:
  v_max3_u32 v31, v52, v53, v54
  v_max_u32 v31, v31, v55
  v_cmp_eq_u32 vcc, -1, v31
  s_cbranch_vccz FL_m_0123_ok1
FL_m_0123_x1:
  s_mov_b64 exec, vcc
  buffer_load_dwordx4 v[52:55], v3, s[4:7], s41 offen offset:1024 sc1
  s_mov_b64 exec, -1
FL_m_0123_c2:
  v_max3_u32 v31, v56, v57, v58
  v_max_u32 v31, v31, v59
  v_cmp_eq_u32 vcc, -1, v31
  s_cbranch_vccz FL_m_0123_ok2
FL_m_0123_x2:
  s_mov_b64 exec, vcc
  buffer_load_dwordx4 v[56:59], v3, s[4:7], s41 offen offset:2048 sc1
  s_mov_b64 exec, -1
FL_m_0123_c3:
  v_max3_u32 v31, v60, v61, v62
  v_max_u32 v31, v31, v63
  v_cmp_eq_u32 vcc, -1, v31
  s_cbranch_vccz FL_m_0123_ok3
FL_m_0123_x3:
  s_mov_b64 exec, vcc
  buffer_load_dwordx4 v[60:63], v3, s[4:7], s41 offen offset:3072 sc1
  s_mov_b64 exec, -1
  s_add_u32 s46, s46, 1
  s_cmp_ge_u32 s46, 131072
  s_cbranch_scc1 FL_rec_abort
  s_waitcnt vmcnt(4)
  s_branch FL_m_0123_c0
FL_m_0123_ok0:
  v_smfmac_f32_16x16x64_bf16 v[64:67], v[48:51], a[0:7], v23
  v_max3_u32 v31, v52, v53, v54
  v_max_u32 v31, v31, v55
  v_cmp_eq_u32 vcc, -1, v31
  v_smfmac_f32_16x16x64_bf16 v[68:71], v[48:51], a[8:15], v23
  v_smfmac_f32_16x16x64_bf16 v[72:75], v[48:51], a[16:23], v23
  v_smfmac_f32_16x16x64_bf16 v[76:79], v[48:51], a[24:31], v23
  s_cbranch_vccz FL_m_123_ok1
  s_branch FL_m_123_x1
FL_m_0123_ok1:
  v_smfmac_f32_16x16x64_bf16 v[64:67], v[52:55], a[48:55], v23
  v_max3_u32 v31, v56, v57, v58
  v_max_u32 v31, v31, v59
  v_cmp_eq_u32 vcc, -1, v31
  v_smfmac_f32_16x16x64_bf16 v[68:71], v[52:55], a[56:63], v23
  v_smfmac_f32_16x16x64_bf16 v[72:75], v[52:55], a[64:71], v23
  v_smfmac_f32_16x16x64_bf16 v[76:79], v[52:55], a[72:79], v23
  s_cbranch_vccz FL_m_023_ok2
  s_branch FL_m_023_x2
FL_m_0123_ok2:
  v_smfmac_f32_16x16x64_bf16 v[64:67], v[56:59], a[96:103], v23
  v_max3_u32 v31, v60, v61, v62
  v_max_u32 v31, v31, v63
  v_cmp_eq_u32 vcc, -1, v31
  v_smfmac_f32_16x16x64_bf16 v[68:71], v[56:59], a[104:111], v23
  v_smfmac_f32_16x16x64_bf16 v[72:75], v[56:59], a[112:119], v23
  v_smfmac_f32_16x16x64_bf16 v[76:79], v[56:59], a[120:127], v23
  s_cbranch_vccz FL_m_013_ok3
  s_branch FL_m_013_x3
FL_m_0123_ok3:
  v_smfmac_f32_16x16x64_bf16 v[64:67], v[60:63], a[144:151], v23
  v_max3_u32 v31, v48, v49, v50
  v_max_u32 v31, v31, v51
  v_cmp_eq_u32 vcc, -1, v31
  v_smfmac_f32_16x16x64_bf16 v[68:71], v[60:63], a[152:159], v23
  v_smfmac_f32_16x16x64_bf16 v[72:75], v[60:63], a[160:167], v23
  v_smfmac_f32_16x16x64_bf16 v[76:79], v[60:63], a[168:175], v23
  s_cbranch_vccz FL_m_012_ok0
  s_branch FL_m_012_x0
FL_x_f0:
  s_mov_b64 exec, vcc
  buffer_load_dwordx4 v[64:67], v9, s[4:7], s41 offen offset:0 sc1
  s_mov_b64 exec, -1
  s_waitcnt vmcnt(2)
  s_branch FL_x_0123_c1
FL_x_f1:
  s_mov_b64 exec, vcc
  buffer_load_dwordx4 v[68:71], v9, s[4:7], s41 offen offset:1024 sc1
  s_mov_b64 exec, -1
  s_waitcnt vmcnt(2)
  s_branch FL_x_123_c2
FL_x_f2:
  s_mov_b64 exec, vcc
  buffer_load_dwordx4 v[72:75], v9, s[4:7], s41 offen offset:2048 sc1
  s_mov_b64 exec, -1
  s_waitcnt vmcnt(2)
  s_branch FL_x_23_c3
FL_x_f3:
  s_mov_b64 exec, vcc
  buffer_load_dwordx4 v[76:79], v9, s[4:7], s41 offen offset:3072 sc1
  s_mov_b64 exec, -1
  s_nop 7
  s_branch FL_x_3_c3
FL_x_0_c0:
  v_max3_u32 v31, v64, v65, v66
  v_max_u32 v31, v31, v67
  v_cmp_eq_u32 vcc, -1, v31
  s_cbranch_vccz FL_x_0_ok0
FL_x_0_x0:
  s_mov_b64 exec, vcc
  buffer_load_dwordx4 v[64:67], v9, s[4:7], s41 offen offset:0 sc1
  s_mov_b64 exec, -1
  s_add_u32 s46, s46, 1
  s_cmp_ge_u32 s46, 131072
  s_cbranch_scc1 FL_rec_abort
  s_waitcnt vmcnt(2)
  s_branch FL_x_0_c0
FL_x_0_ok0:
  v_mfma_f32_16x16x32_bf16 v[44:47], v[64:67], v[64:67], v[44:47]
  v_mfma_f32_16x16x32_bf16 v[36:39], v[116:119], v[64:67], v[36:39]
  v_mfma_f32_16x16x32_bf16 v[40:43], v[132:135], v[64:67], v[40:43]
  s_branch FL_x_done
FL_x_1_c1:
  v_max3_u32 v31, v68, v69, v70
  v_max_u32 v31, v31, v71
  v_cmp_eq_u32 vcc, -1, v31
  s_cbranch_vccz FL_x_1_ok1
FL_x_1_x1:
  s_mov_b64 exec, vcc
  buffer_load_dwordx4 v[68:71], v9, s[4:7], s41 offen offset:1024 sc1
  s_mov_b64 exec, -1
  s_add_u32 s46, s46, 1
  s_cmp_ge_u32 s46, 131072
  s_cbranch_scc1 FL_rec_abort
  s_waitcnt vmcnt(2)
  s_branch FL_x_1_c1
FL_x_1_ok1:
  v_mfma_f32_16x16x32_bf16 v[44:47], v[68:71], v[68:71], v[44:47]
  v_mfma_f32_16x16x32_bf16 v[36:39], v[120:123], v[68:71], v[36:39]
  v_mfma_f32_16x16x32_bf16 v[40:43], v[136:139], v[68:71], v[40:43]
  s_branch FL_x_done
FL_x_2_c2:
  v_max3_u32 v31, v72, v73, v74
  v_max_u32 v31, v31, v75
  v_cmp_eq_u32 vcc, -1, v31
  s_cbranch_vccz FL_x_2_ok2
FL_x_2_x2:
  s_mov_b64 exec, vcc
  buffer_load_dwordx4 v[72:75], v9, s[4:7], s41 offen offset:2048 sc1
  s_mov_b64 exec, -1
  s_add_u32 s46, s46, 1
  s_cmp_ge_u32 s46, 131072
  s_cbranch_scc1 FL_rec_abort
  s_waitcnt vmcnt(2)
  s_branch FL_x_2_c2
FL_x_2_ok2:
  v_mfma_f32_16x16x32_bf16 v[44:47], v[72:75], v[72:75], v[44:47]
  v_mfma_f32_16x16x32_bf16 v[36:39], v[124:127], v[72:75], v[36:39]
  v_mfma_f32_16x16x32_bf16 v[40:43], v[140:143], v[72:75], v[40:43]
  s_branch FL_x_done
FL_x_3_c3:
  v_max3_u32 v31, v76, v77, v78
  v_max_u32 v31, v31, v79
  v_cmp_eq_u32 vcc, -1, v31
  s_cbranch_vccz FL_x_3_ok3
FL_x_3_x3:
  s_mov_b64 exec, vcc
  buffer_load_dwordx4 v[76:79], v9, s[4:7], s41 offen offset:3072 sc1
  s_mov_b64 exec, -1
  s_add_u32 s46, s46, 1
  s_cmp_ge_u32 s46, 131072
  s_cbranch_scc1 FL_rec_abort
  s_waitcnt vmcnt(2)
  s_branch FL_x_3_c3
FL_x_3_ok3:
  v_mfma_f32_16x16x32_bf16 v[44:47], v[76:79], v[76:79], v[44:47]
  v_mfma_f32_16x16x32_bf16 v[36:39], v[128:131], v[76:79], v[36:39]
  v_mfma_f32_16x16x32_bf16 v[40:43], v[144:147], v[76:79], v[40:43]
  s_branch FL_x_done
FL_x_01_c0:
  v_max3_u32 v31, v64, v65, v66
  v_max_u32 v31, v31, v67
  v_cmp_eq_u32 vcc, -1, v31
  s_cbranch_vccz FL_x_01_ok0
FL_x_01_x0:
  s_mov_b64 exec, vcc
  buffer_load_dwordx4 v[64:67], v9, s[4:7], s41 offen offset:0 sc1
  s_mov_b64 exec, -1
FL_x_01_c1:
  v_max3_u32 v31, v68, v69, v70
  v_max_u32 v31, v31, v71
  v_cmp_eq_u32 vcc, -1, v31
  s_cbranch_vccz FL_x_01_ok1
FL_x_01_x1:
  s_mov_b64 exec, vcc
  buffer_load_dwordx4 v[68:71], v9, s[4:7], s41 offen offset:1024 sc1
  s_mov_b64 exec, -1
  s_add_u32 s46, s46, 1
  s_cmp_ge_u32 s46, 131072
  s_cbranch_scc1 FL_rec_abort
  s_waitcnt vmcnt(4)
  s_branch FL_x_01_c0
FL_x_01_ok0:
  v_mfma_f32_16x16x32_bf16 v[44:47], v[64:67], v[64:67], v[44:47]
  v_max3_u32 v31, v68, v69, v70
  v_max_u32 v31, v31, v71
  v_cmp_eq_u32 vcc, -1, v31
  v_mfma_f32_16x16x32_bf16 v[36:39], v[116:119], v[64:67], v[36:39]
  v_mfma_f32_16x16x32_bf16 v[40:43], v[132:135], v[64:67], v[40:43]
  s_cbranch_vccz FL_x_1_ok1
  s_branch FL_x_1_x1
FL_x_01_ok1:
  v_mfma_f32_16x16x32_bf16 v[44:47], v[68:71], v[68:71], v[44:47]
  v_max3_u32 v31, v64, v65, v66
  v_max_u32 v31, v31, v67
  v_cmp_eq_u32 vcc, -1, v31
  v_mfma_f32_16x16x32_bf16 v[36:39], v[120:123], v[68:71], v[36:39]
  v_mfma_f32_16x16x32_bf16 v[40:43], v[136:139], v[68:71], v[40:43]
  s_cbranch_vccz FL_x_0_ok0
  s_branch FL_x_0_x0
FL_x_02_c0:
  v_max3_u32 v31, v64, v65, v66
  v_max_u32 v31, v31, v67
  v_cmp_eq_u32 vcc, -1, v31
  s_cbranch_vccz FL_x_02_ok0
FL_x_02_x0:
  s_mov_b64 exec, vcc
  buffer_load_dwordx4 v[64:67], v9, s[4:7], s41 offen offset:0 sc1
  s_mov_b64 exec, -1
FL_x_02_c2:
  v_max3_u32 v31, v72, v73, v74
  v_max_u32 v31, v31, v75
  v_cmp_eq_u32 vcc, -1, v31
  s_cbranch_vccz FL_x_02_ok2
FL_x_02_x2:
  s_mov_b64 exec, vcc
  buffer_load_dwordx4 v[72:75], v9, s[4:7], s41 offen offset:2048 sc1
  s_mov_b64 exec, -1
  s_add_u32 s46, s46, 1
  s_cmp_ge_u32 s46, 131072
  s_cbranch_scc1 FL_rec_abort
  s_waitcnt vmcnt(4)
  s_branch FL_x_02_c0
FL_x_02_ok0:
  v_mfma_f32_16x16x32_bf16 v[44:47], v[64:67], v[64:67], v[44:47]
  v_max3_u32 v31, v72, v73, v74
  v_max_u32 v31, v31, v75
  v_cmp_eq_u32 vcc, -1, v31
  v_mfma_f32_16x16x32_bf16 v[36:39], v[116:119], v[64:67], v[36:39]
  v_mfma_f32_16x16x32_bf16 v[40:43], v[132:135], v[64:67], v[40:43]
  s_cbranch_vccz FL_x_2_ok2
  s_branch FL_x_2_x2
FL_x_02_ok2:
  v_mfma_f32_16x16x32_bf16 v[44:47], v[72:75], v[72:75], v[44:47]
  v_max3_u32 v31, v64, v65, v66
  v_max_u32 v31, v31, v67
  v_cmp_eq_u32 vcc, -1, v31
  v_mfma_f32_16x16x32_bf16 v[36:39], v[124:127], v[72:75], v[36:39]
  v_mfma_f32_16x16x32_bf16 v[40:43], v[140:143], v[72:75], v[40:43]
  s_cbranch_vccz FL_x_0_ok0
  s_branch FL_x_0_x0
FL_x_03_c0:
  v_max3_u32 v31, v64, v65, v66
  v_max_u32 v31, v31, v67
  v_cmp_eq_u32 vcc, -1, v31
  s_cbranch_vccz FL_x_03_ok0
FL_x_03_x0:
  s_mov_b64 exec, vcc
  buffer_load_dwordx4 v[64:67], v9, s[4:7], s41 offen offset:0 sc1
  s_mov_b64 exec, -1
FL_x_03_c3:
  v_max3_u32 v31, v76, v77, v78
  v_max_u32 v31, v31, v79
  v_cmp_eq_u32 vcc, -1, v31
  s_cbranch_vccz FL_x_03_ok3
FL_x_03_x3:
  s_mov_b64 exec, vcc
  buffer_load_dwordx4 v[76:79], v9, s[4:7], s41 offen offset:3072 sc1
  s_mov_b64 exec, -1
  s_add_u32 s46, s46, 1
  s_cmp_ge_u32 s46, 131072
  s_cbranch_scc1 FL_rec_abort
  s_waitcnt vmcnt(4)
  s_branch FL_x_03_c0
FL_x_03_ok0:
  v_mfma_f32_16x16x32_bf16 v[44:47], v[64:67], v[64:67], v[44:47]
  v_max3_u32 v31, v76, v77, v78
  v_max_u32 v31, v31, v79
  v_cmp_eq_u32 vcc, -1, v31
  v_mfma_f32_16x16x32_bf16 v[36:39], v[116:119], v[64:67], v[36:39]
  v_mfma_f32_16x16x32_bf16 v[40:43], v[132:135], v[64:67], v[40:43]
  s_cbranch_vccz FL_x_3_ok3
  s_branch FL_x_3_x3
FL_x_03_ok3:
  v_mfma_f32_16x16x32_bf16 v[44:47], v[76:79], v[76:79], v[44:47]
  v_max3_u32 v31, v64, v65, v66
  v_max_u32 v31, v31, v67
  v_cmp_eq_u32 vcc, -1, v31
  v_mfma_f32_16x16x32_bf16 v[36:39], v[128:131], v[76:79], v[36:39]
  v_mfma_f32_16x16x32_bf16 v[40:43], v[144:147], v[76:79], v[40:43]
  s_cbranch_vccz FL_x_0_ok0
  s_branch FL_x_0_x0
FL_x_12_c1:
  v_max3_u32 v31, v68, v69, v70
  v_max_u32 v31, v31, v71
  v_cmp_eq_u32 vcc, -1, v31
  s_cbranch_vccz FL_x_12_ok1
FL_x_12_x1:
  s_mov_b64 exec, vcc
  buffer_load_dwordx4 v[68:71], v9, s[4:7], s41 offen offset:1024 sc1
  s_mov_b64 exec, -1
FL_x_12_c2:
  v_max3_u32 v31, v72, v73, v74
  v_max_u32 v31, v31, v75
  v_cmp_eq_u32 vcc, -1, v31
  s_cbranch_vccz FL_x_12_ok2
FL_x_12_x2:
  s_mov_b64 exec, vcc
  buffer_load_dwordx4 v[72:75], v9, s[4:7], s41 offen offset:2048 sc1
  s_mov_b64 exec, -1
  s_add_u32 s46, s46, 1
  s_cmp_ge_u32 s46, 131072
  s_cbranch_scc1 FL_rec_abort
  s_waitcnt vmcnt(4)
  s_branch FL_x_12_c1
FL_x_12_ok1:
  v_mfma_f32_16x16x32_bf16 v[44:47], v[68:71], v[68:71], v[44:47]
  v_max3_u32 v31, v72, v73, v74
  v_max_u32 v31, v31, v75
  v_cmp_eq_u32 vcc, -1, v31
  v_mfma_f32_16x16x32_bf16 v[36:39], v[120:123], v[68:71], v[36:39]
  v_mfma_f32_16x16x32_bf16 v[40:43], v[136:139], v[68:71], v[40:43]
  s_cbranch_vccz FL_x_2_ok2
  s_branch FL_x_2_x2
FL_x_12_ok2:
  v_mfma_f32_16x16x32_bf16 v[44:47], v[72:75], v[72:75], v[44:47]
  v_max3_u32 v31, v68, v69, v70
  v_max_u32 v31, v31, v71
  v_cmp_eq_u32 vcc, -1, v31
  v_mfma_f32_16x16x32_bf16 v[36:39], v[124:127], v[72:75], v[36:39]
  v_mfma_f32_16x16x32_bf16 v[40:43], v[140:143], v[72:75], v[40:43]
  s_cbranch_vccz FL_x_1_ok1
  s_branch FL_x_1_x1
FL_x_13_c1:
  v_max3_u32 v31, v68, v69, v70
  v_max_u32 v31, v31, v71
  v_cmp_eq_u32 vcc, -1, v31
  s_cbranch_vccz FL_x_13_ok1
FL_x_13_x1:
  s_mov_b64 exec, vcc
  buffer_load_dwordx4 v[68:71], v9, s[4:7], s41 offen offset:1024 sc1
  s_mov_b64 exec, -1
FL_x_13_c3:
  v_max3_u32 v31, v76, v77, v78
  v_max_u32 v31, v31, v79
  v_cmp_eq_u32 vcc, -1, v31
  s_cbranch_vccz FL_x_13_ok3
FL_x_13_x3:
  s_mov_b64 exec, vcc
  buffer_load_dwordx4 v[76:79], v9, s[4:7], s41 offen offset:3072 sc1
  s_mov_b64 exec, -1
  s_add_u32 s46, s46, 1
  s_cmp_ge_u32 s46, 131072
  s_cbranch_scc1 FL_rec_abort
  s_waitcnt vmcnt(4)
  s_branch FL_x_13_c1
FL_x_13_ok1:
  v_mfma_f32_16x16x32_bf16 v[44:47], v[68:71], v[68:71], v[44:47]
  v_max3_u32 v31, v76, v77, v78
  v_max_u32 v31, v31, v79
  v_cmp_eq_u32 vcc, -1, v31
  v_mfma_f32_16x16x32_bf16 v[36:39], v[120:123], v[68:71], v[36:39]
  v_mfma_f32_16x16x32_bf16 v[40:43], v[136:139], v[68:71], v[40:43]
  s_cbranch_vccz FL_x_3_ok3
  s_branch FL_x_3_x3
FL_x_13_ok3:
  v_mfma_f32_16x16x32_bf16 v[44:47], v[76:79], v[76:79], v[44:47]
  v_max3_u32 v31, v68, v69, v70
  v_max_u32 v31, v31, v71
  v_cmp_eq_u32 vcc, -1, v31
  v_mfma_f32_16x16x32_bf16 v[36:39], v[128:131], v[76:79], v[36:39]
  v_mfma_f32_16x16x32_bf16 v[40:43], v[144:147], v[76:79], v[40:43]
  s_cbranch_vccz FL_x_1_ok1
  s_branch FL_x_1_x1
FL_x_23_c2:
  v_max3_u32 v31, v72, v73, v74
  v_max_u32 v31, v31, v75
  v_cmp_eq_u32 vcc, -1, v31
  s_cbranch_vccz FL_x_23_ok2
FL_x_23_x2:
  s_mov_b64 exec, vcc
  buffer_load_dwordx4 v[72:75], v9, s[4:7], s41 offen offset:2048 sc1
  s_mov_b64 exec, -1
FL_x_23_c3:
  v_max3_u32 v31, v76, v77, v78
  v_max_u32 v31, v31, v79
  v_cmp_eq_u32 vcc, -1, v31
  s_cbranch_vccz FL_x_23_ok3
FL_x_23_x3:
  s_mov_b64 exec, vcc
  buffer_load_dwordx4 v[76:79], v9, s[4:7], s41 offen offset:3072 sc1
  s_mov_b64 exec, -1
  s_add_u32 s46, s46, 1
  s_cmp_ge_u32 s46, 131072
  s_cbranch_scc1 FL_rec_abort
  s_waitcnt vmcnt(4)
  s_branch FL_x_23_c2
FL_x_23_ok2:
  v_mfma_f32_16x16x32_bf16 v[44:47], v[72:75], v[72:75], v[44:47]
  v_max3_u32 v31, v76, v77, v78
  v_max_u32 v31, v31, v79
  v_cmp_eq_u32 vcc, -1, v31
  v_mfma_f32_16x16x32_bf16 v[36:39], v[124:127], v[72:75], v[36:39]
  v_mfma_f32_16x16x32_bf16 v[40:43], v[140:143], v[72:75], v[40:43]
  s_cbranch_vccz FL_x_3_ok3
  s_branch FL_x_3_x3
FL_x_23_ok3:
  v_mfma_f32_16x16x32_bf16 v[44:47], v[76:79], v[76:79], v[44:47]
  v_max3_u32 v31, v72, v73, v74
  v_max_u32 v31, v31, v75
  v_cmp_eq_u32 vcc, -1, v31
  v_mfma_f32_16x16x32_bf16 v[36:39], v[128:131], v[76:79], v[36:39]
  v_mfma_f32_16x16x32_bf16 v[40:43], v[144:147], v[76:79], v[40:43]
  s_cbranch_vccz FL_x_2_ok2
  s_branch FL_x_2_x2
FL_x_012_c0:
  v_max3_u32 v31, v64, v65, v66
  v_max_u32 v31, v31, v67
  v_cmp_eq_u32 vcc, -1, v31
  s_cbranch_vccz FL_x_012_ok0
FL_x_012_x0:
  s_mov_b64 exec, vcc
  buffer_load_dwordx4 v[64:67], v9, s[4:7], s41 offen offset:0 sc1
  s_mov_b64 exec, -1
FL_x_012_c1:
  v_max3_u32 v31, v68, v69, v70
  v_max_u32 v31, v31, v71
  v_cmp_eq_u32 vcc, -1, v31
  s_cbranch_vccz FL_x_012_ok1
FL_x_012_x1:
  s_mov_b64 exec, vcc
  buffer_load_dwordx4 v[68:71], v9, s[4:7], s41 offen offset:1024 sc1
  s_mov_b64 exec, -1
FL_x_012_c2:
  v_max3_u32 v31, v72, v73, v74
  v_max_u32 v31, v31, v75
  v_cmp_eq_u32 vcc, -1, v31
  s_cbranch_vccz FL_x_012_ok2
FL_x_012_x2:
  s_mov_b64 exec, vcc
  buffer_load_dwordx4 v[72:75], v9, s[4:7], s41 offen offset:2048 sc1
  s_mov_b64 exec, -1
  s_add_u32 s46, s46, 1
  s_cmp_ge_u32 s46, 131072
  s_cbranch_scc1 FL_rec_abort
  s_waitcnt vmcnt(4)
  s_branch FL_x_012_c0
FL_x_012_ok0:
  v_mfma_f32_16x16x32_bf16 v[44:47], v[64:67], v[64:67], v[44:47]
  v_max3_u32 v31, v68, v69, v70
  v_max_u32 v31, v31, v71
  v_cmp_eq_u32 vcc, -1, v31
  v_mfma_f32_16x16x32_bf16 v[36:39], v[116:119], v[64:67], v[36:39]
  v_mfma_f32_16x16x32_bf16 v[40:43], v[132:135], v[64:67], v[40:43]
  s_cbranch_vccz FL_x_12_ok1
  s_branch FL_x_12_x1
FL_x_012_ok1:
  v_mfma_f32_16x16x32_bf16 v[44:47], v[68:71], v[68:71], v[44:47]
  v_max3_u32 v31, v72, v73, v74
  v_max_u32 v31, v31, v75
  v_cmp_eq_u32 vcc, -1, v31
  v_mfma_f32_16x16x32_bf16 v[36:39], v[120:123], v[68:71], v[36:39]
  v_mfma_f32_16x16x32_bf16 v[40:43], v[136:139], v[68:71], v[40:43]
  s_cbranch_vccz FL_x_02_ok2
  s_branch FL_x_02_x2
FL_x_012_ok2:
  v_mfma_f32_16x16x32_bf16 v[44:47], v[72:75], v[72:75], v[44:47]
  v_max3_u32 v31, v64, v65, v66
  v_max_u32 v31, v31, v67
  v_cmp_eq_u32 vcc, -1, v31
  v_mfma_f32_16x16x32_bf16 v[36:39], v[124:127], v[72:75], v[36:39]
  v_mfma_f32_16x16x32_bf16 v[40:43], v[140:143], v[72:75], v[40:43]
  s_cbranch_vccz FL_x_01_ok0
  s_branch FL_x_01_x0
FL_x_013_c0:
  v_max3_u32 v31, v64, v65, v66
  v_max_u32 v31, v31, v67
  v_cmp_eq_u32 vcc, -1, v31
  s_cbranch_vccz FL_x_013_ok0
FL_x_013_x0:
  s_mov_b64 exec, vcc
  buffer_load_dwordx4 v[64:67], v9, s[4:7], s41 offen offset:0 sc1
  s_mov_b64 exec, -1
FL_x_013_c1:
  v_max3_u32 v31, v68, v69, v70
  v_max_u32 v31, v31, v71
  v_cmp_eq_u32 vcc, -1, v31
  s_cbranch_vccz FL_x_013_ok1
FL_x_013_x1:
  s_mov_b64 exec, vcc
  buffer_load_dwordx4 v[68:71], v9, s[4:7], s41 offen offset:1024 sc1
  s_mov_b64 exec, -1
FL_x_013_c3:
  v_max3_u32 v31, v76, v77, v78
  v_max_u32 v31, v31, v79
  v_cmp_eq_u32 vcc, -1, v31
  s_cbranch_vccz FL_x_013_ok3
FL_x_013_x3:
  s_mov_b64 exec, vcc
  buffer_load_dwordx4 v[76:79], v9, s[4:7], s41 offen offset:3072 sc1
  s_mov_b64 exec, -1
  s_add_u32 s46, s46, 1
  s_cmp_ge_u32 s46, 131072
  s_cbranch_scc1 FL_rec_abort
  s_waitcnt vmcnt(4)
  s_branch FL_x_013_c0
FL_x_013_ok0:
  v_mfma_f32_16x16x32_bf16 v[44:47], v[64:67], v[64:67], v[44:47]
  v_max3_u32 v31, v68, v69, v70
  v_max_u32 v31, v31, v71
  v_cmp_eq_u32 vcc, -1, v31
  v_mfma_f32_16x16x32_bf16 v[36:39], v[116:119], v[64:67], v[36:39]
  v_mfma_f32_16x16x32_bf16 v[40:43], v[132:135], v[64:67], v[40:43]
  s_cbranch_vccz FL_x_13_ok1
  s_branch FL_x_13_x1
FL_x_013_ok1:
  v_mfma_f32_16x16x32_bf16 v[44:47], v[68:71], v[68:71], v[44:47]
  v_max3_u32 v31, v76, v77, v78
  v_max_u32 v31, v31, v79
  v_cmp_eq_u32 vcc, -1, v31
  v_mfma_f32_16x16x32_bf16 v[36:39], v[120:123], v[68:71], v[36:39]
  v_mfma_f32_16x16x32_bf16 v[40:43], v[136:139], v[68:71], v[40:43]
  s_cbranch_vccz FL_x_03_ok3
  s_branch FL_x_03_x3
FL_x_013_ok3:
  v_mfma_f32_16x16x32_bf16 v[44:47], v[76:79], v[76:79], v[44:47]
  v_max3_u32 v31, v64, v65, v66
  v_max_u32 v31, v31, v67
  v_cmp_eq_u32 vcc, -1, v31
  v_mfma_f32_16x16x32_bf16 v[36:39], v[128:131], v[76:79], v[36:39]
  v_mfma_f32_16x16x32_bf16 v[40:43], v[144:147], v[76:79], v[40:43]
  s_cbranch_vccz FL_x_01_ok0
  s_branch FL_x_01_x0
FL_x_023_c0:
  v_max3_u32 v31, v64, v65, v66
  v_max_u32 v31, v31, v67
  v_cmp_eq_u32 vcc, -1, v31
  s_cbranch_vccz FL_x_023_ok0
FL_x_023_x0:
  s_mov_b64 exec, vcc
  buffer_load_dwordx4 v[64:67], v9, s[4:7], s41 offen offset:0 sc1
  s_mov_b64 exec, -1
FL_x_023_c2:
  v_max3_u32 v31, v72, v73, v74
  v_max_u32 v31, v31, v75
  v_cmp_eq_u32 vcc, -1, v31
  s_cbranch_vccz FL_x_023_ok2
FL_x_023_x2:
  s_mov_b64 exec, vcc
  buffer_load_dwordx4 v[72:75], v9, s[4:7], s41 offen offset:2048 sc1
  s_mov_b64 exec, -1
FL_x_023_c3:
  v_max3_u32 v31, v76, v77, v78
  v_max_u32 v31, v31, v79
  v_cmp_eq_u32 vcc, -1, v31
  s_cbranch_vccz FL_x_023_ok3
FL_x_023_x3:
  s_mov_b64 exec, vcc
  buffer_load_dwordx4 v[76:79], v9, s[4:7], s41 offen offset:3072 sc1
  s_mov_b64 exec, -1
  s_add_u32 s46, s46, 1
  s_cmp_ge_u32 s46, 131072
  s_cbranch_scc1 FL_rec_abort
  s_waitcnt vmcnt(4)
  s_branch FL_x_023_c0
FL_x_023_ok0:
  v_mfma_f32_16x16x32_bf16 v[44:47], v[64:67], v[64:67], v[44:47]
  v_max3_u32 v31, v72, v73, v74
  v_max_u32 v31, v31, v75
  v_cmp_eq_u32 vcc, -1, v31
  v_mfma_f32_16x16x32_bf16 v[36:39], v[116:119], v[64:67], v[36:39]
  v_mfma_f32_16x16x32_bf16 v[40:43], v[132:135], v[64:67], v[40:43]
  s_cbranch_vccz FL_x_23_ok2
  s_branch FL_x_23_x2
FL_x_023_ok2:
  v_mfma_f32_16x16x32_bf16 v[44:47], v[72:75], v[72:75], v[44:47]
  v_max3_u32 v31, v76, v77, v78
  v_max_u32 v31, v31, v79
  v_cmp_eq_u32 vcc, -1, v31
  v_mfma_f32_16x16x32_bf16 v[36:39], v[124:127], v[72:75], v[36:39]
  v_mfma_f32_16x16x32_bf16 v[40:43], v[140:143], v[72:75], v[40:43]
  s_cbranch_vccz FL_x_03_ok3
  s_branch FL_x_03_x3
FL_x_023_ok3:
  v_mfma_f32_16x16x32_bf16 v[44:47], v[76:79], v[76:79], v[44:47]
  v_max3_u32 v31, v64, v65, v66
  v_max_u32 v31, v31, v67
  v_cmp_eq_u32 vcc, -1, v31
  v_mfma_f32_16x16x32_bf16 v[36:39], v[128:131], v[76:79], v[36:39]
  v_mfma_f32_16x16x32_bf16 v[40:43], v[144:147], v[76:79], v[40:43]
  s_cbranch_vccz FL_x_02_ok0
  s_branch FL_x_02_x0
FL_x_123_c1:
  v_max3_u32 v31, v68, v69, v70
  v_max_u32 v31, v31, v71
  v_cmp_eq_u32 vcc, -1, v31
  s_cbranch_vccz FL_x_123_ok1
FL_x_123_x1:
  s_mov_b64 exec, vcc
  buffer_load_dwordx4 v[68:71], v9, s[4:7], s41 offen offset:1024 sc1
  s_mov_b64 exec, -1
FL_x_123_c2:
  v_max3_u32 v31, v72, v73, v74
  v_max_u32 v31, v31, v75
  v_cmp_eq_u32 vcc, -1, v31
  s_cbranch_vccz FL_x_123_ok2
FL_x_123_x2:
  s_mov_b64 exec, vcc
  buffer_load_dwordx4 v[72:75], v9, s[4:7], s41 offen offset:2048 sc1
  s_mov_b64 exec, -1
FL_x_123_c3:
  v_max3_u32 v31, v76, v77, v78
  v_max_u32 v31, v31, v79
  v_cmp_eq_u32 vcc, -1, v31
  s_cbranch_vccz FL_x_123_ok3
FL_x_123_x3:
  s_mov_b64 exec, vcc
  buffer_load_dwordx4 v[76:79], v9, s[4:7], s41 offen offset:3072 sc1
  s_mov_b64 exec, -1
  s_add_u32 s46, s46, 1
  s_cmp_ge_u32 s46, 131072
  s_cbranch_scc1 FL_rec_abort
  s_waitcnt vmcnt(4)
  s_branch FL_x_123_c1
FL_x_123_ok1:
  v_mfma_f32_16x16x32_bf16 v[44:47], v[68:71], v[68:71], v[44:47]
  v_max3_u32 v31, v72, v73, v74
  v_max_u32 v31, v31, v75
  v_cmp_eq_u32 vcc, -1, v31
  v_mfma_f32_16x16x32_bf16 v[36:39], v[120:123], v[68:71], v[36:39]
  v_mfma_f32_16x16x32_bf16 v[40:43], v[136:139], v[68:71], v[40:43]
  s_cbranch_vccz FL_x_23_ok2
  s_branch FL_x_23_x2
FL_x_123_ok2:
  v_mfma_f32_16x16x32_bf16 v[44:47], v[72:75], v[72:75], v[44:47]
  v_max3_u32 v31, v76, v77, v78
  v_max_u32 v31, v31, v79
  v_cmp_eq_u32 vcc, -1, v31
  v_mfma_f32_16x16x32_bf16 v[36:39], v[124:127], v[72:75], v[36:39]
  v_mfma_f32_16x16x32_bf16 v[40:43], v[140:143], v[72:75], v[40:43]
  s_cbranch_vccz FL_x_13_ok3
  s_branch FL_x_13_x3
FL_x_123_ok3:
  v_mfma_f32_16x16x32_bf16 v[44:47], v[76:79], v[76:79], v[44:47]
  v_max3_u32 v31, v68, v69, v70
  v_max_u32 v31, v31, v71
  v_cmp_eq_u32 vcc, -1, v31
  v_mfma_f32_16x16x32_bf16 v[36:39], v[128:131], v[76:79], v[36:39]
  v_mfma_f32_16x16x32_bf16 v[40:43], v[144:147], v[76:79], v[40:43]
  s_cbranch_vccz FL_x_12_ok1
  s_branch FL_x_12_x1
FL_x_0123_c0:
  v_max3_u32 v31, v64, v65, v66
  v_max_u32 v31, v31, v67
  v_cmp_eq_u32 vcc, -1, v31
  s_cbranch_vccz FL_x_0123_ok0
FL_x_0123_x0:
  s_mov_b64 exec, vcc
  buffer_load_dwordx4 v[64:67], v9, s[4:7], s41 offen offset:0 sc1
  s_mov_b64 exec, -1
FL_x_0123_c1:
  v_max3_u32 v31, v68, v69, v70
  v_max_u32 v31, v31, v71
  v_cmp_eq_u32 vcc, -1, v31
  s_cbranch_vccz FL_x_0123_ok1
FL_x_0123_x1:
  s_mov_b64 exec, vcc
  buffer_load_dwordx4 v[68:71], v9, s[4:7], s41 offen offset:1024 sc1
  s_mov_b64 exec, -1
FL_x_0123_c2:
  v_max3_u32 v31, v72, v73, v74
  v_max_u32 v31, v31, v75
  v_cmp_eq_u32 vcc, -1, v31
  s_cbranch_vccz FL_x_0123_ok2
FL_x_0123_x2:
  s_mov_b64 exec, vcc
  buffer_load_dwordx4 v[72:75], v9, s[4:7], s41 offen offset:2048 sc1
  s_mov_b64 exec, -1
FL_x_0123_c3:
  v_max3_u32 v31, v76, v77, v78
  v_max_u32 v31, v31, v79
  v_cmp_eq_u32 vcc, -1, v31
  s_cbranch_vccz FL_x_0123_ok3
FL_x_0123_x3:
  s_mov_b64 exec, vcc
  buffer_load_dwordx4 v[76:79], v9, s[4:7], s41 offen offset:3072 sc1
  s_mov_b64 exec, -1
  s_add_u32 s46, s46, 1
  s_cmp_ge_u32 s46, 131072
  s_cbranch_scc1 FL_rec_abort
  s_waitcnt vmcnt(4)
  s_branch FL_x_0123_c0
FL_x_0123_ok0:
  v_mfma_f32_16x16x32_bf16 v[44:47], v[64:67], v[64:67], v[44:47]
  v_max3_u32 v31, v68, v69, v70
  v_max_u32 v31, v31, v71
  v_cmp_eq_u32 vcc, -1, v31
  v_mfma_f32_16x16x32_bf16 v[36:39], v[116:119], v[64:67], v[36:39]
  v_mfma_f32_16x16x32_bf16 v[40:43], v[132:135], v[64:67], v[40:43]
  s_cbranch_vccz FL_x_123_ok1
  s_branch FL_x_123_x1
FL_x_0123_ok1:
  v_mfma_f32_16x16x32_bf16 v[44:47], v[68:71], v[68:71], v[44:47]
  v_max3_u32 v31, v72, v73, v74
  v_max_u32 v31, v31, v75
  v_cmp_eq_u32 vcc, -1, v31
  v_mfma_f32_16x16x32_bf16 v[36:39], v[120:123], v[68:71], v[36:39]
  v_mfma_f32_16x16x32_bf16 v[40:43], v[136:139], v[68:71], v[40:43]
  s_cbranch_vccz FL_x_023_ok2
  s_branch FL_x_023_x2
FL_x_0123_ok2:
  v_mfma_f32_16x16x32_bf16 v[44:47], v[72:75], v[72:75], v[44:47]
  v_max3_u32 v31, v76, v77, v78
  v_max_u32 v31, v31, v79
  v_cmp_eq_u32 vcc, -1, v31
  v_mfma_f32_16x16x32_bf16 v[36:39], v[124:127], v[72:75], v[36:39]
  v_mfma_f32_16x16x32_bf16 v[40:43], v[140:143], v[72:75], v[40:43]
  s_cbranch_vccz FL_x_013_ok3
  s_branch FL_x_013_x3
FL_x_0123_ok3:
  v_mfma_f32_16x16x32_bf16 v[44:47], v[76:79], v[76:79], v[44:47]
  v_max3_u32 v31, v64, v65, v66
  v_max_u32 v31, v31, v67
  v_cmp_eq_u32 vcc, -1, v31
  v_mfma_f32_16x16x32_bf16 v[36:39], v[128:131], v[76:79], v[36:39]
  v_mfma_f32_16x16x32_bf16 v[40:43], v[144:147], v[76:79], v[40:43]
  s_cbranch_vccz FL_x_012_ok0
  s_branch FL_x_012_x0
FL_v_f:
  buffer_load_dwordx4 v[88:91], v10, s[4:7], s41 offen offset:0 sc1
  buffer_load_dwordx4 v[92:95], v10, s[4:7], s41 offen offset:1024 sc1
  s_add_u32 s46, s46, 1
  s_cmp_ge_u32 s46, 131072
  s_cbranch_scc1 FL_rec_abort
  s_waitcnt vmcnt(0)
  v_max3_u32 v31, v88, v89, v90
  v_max3_u32 v31, v31, v91, v92
  v_max3_u32 v31, v31, v93, v94
  v_max_u32 v31, v31, v95
  v_cmp_eq_u32 vcc, -1, v31
  s_cbranch_vccnz FL_v_f
  s_branch FL_v_ok
FL_rec_abort:
  s_waitcnt vmcnt(0)
  s_endpgm
L_recslow:
  s_load_dwordx4 s[80:83], s[0:1], 8
  s_load_dwordx4 s[84:87], s[0:1], 24
  s_load_dwordx2 s[88:89], s[0:1], 40
  v_lshrrev_b32 v31, 6, v0
  s_nop 0
  v_readfirstlane_b32 s32, v31
  v_and_b32 v0, 63, v0
  s_lshr_b32 s35, s34, 4
  s_lshl_b32 s90, s33, 1
  s_add_u32 s35, s35, s90
  s_and_b32 s36, s34, 15
  s_lshr_b32 s37, s36, 2
  s_lshl_b32 s90, s35, 2
  s_add_u32 s37, s37, s90
  s_and_b32 s38, s36, 3
  s_waitcnt lgkmcnt(0)
  s_mov_b32 s24, s80
  s_and_b32 s25, s81, 0xffff
  s_mov_b32 s26, 0x4000
  s_mov_b32 s27, 0x20000
  s_mov_b32 s8, s82
  s_and_b32 s9, s83, 0xffff
  s_mov_b32 s10, 0x800000
  s_mov_b32 s11, 0x20000
  s_mov_b32 s12, s84
  s_and_b32 s13, s85, 0xffff
  s_mov_b32 s14, 0x800000
  s_mov_b32 s15, 0x20000
  s_mov_b32 s16, s86
  s_and_b32 s17, s87, 0xffff
  s_mov_b32 s18, 0x800000
  s_mov_b32 s19, 0x20000
  s_mov_b32 s20, s88
  s_and_b32 s21, s89, 0xffff
  s_mov_b32 s22, 0x800000
  s_mov_b32 s23, 0x20000
  s_lshl_b32 s90, s32, 21
  s_lshl_b32 s91, s37, 8
  s_add_u32 s90, s90, s91
  s_lshr_b32 s91, s38, 1
  s_lshl_b32 s91, s91, 7
  s_add_u32 s90, s90, s91
  v_mov_b32 v180, 0x0
  v_bfe_u32 v31, v0, 3, 3
  v_lshl_add_u32 v180, v31, 13, v180
  v_bfe_u32 v31, v0, 0, 3
  v_lshl_add_u32 v180, v31, 4, v180
  v_add_u32 v180, s90, v180
  v_xor_b32 v185, 128, v180
  s_lshl_b32 s90, s35, 2
  s_add_u32 s90, s90, s32
  s_lshl_b32 s90, s90, 18
  s_lshl_b32 s91, s36, 7
  s_add_u32 s90, s90, s91
  v_mov_b32 v181, 0x0
  v_bfe_u32 v31, v0, 3, 3
  v_lshl_add_u32 v181, v31, 11, v181
  v_bfe_u32 v31, v0, 0, 3
  v_lshl_add_u32 v181, v31, 4, v181
  v_add_u32 v181, s90, v181
  s_lshl_b32 s96, s32, 15
  s_and_b32 s91, s38, 1
  s_lshl_b32 s91, s91, 6
  s_add_u32 s91, s91, s96
  v_mov_b32 v182, 0x0
  v_bfe_u32 v31, v0, 5, 1
  v_lshl_add_u32 v182, v31, 11, v182
  v_bfe_u32 v31, v0, 4, 1
  v_lshl_add_u32 v182, v31, 10, v182
  v_bfe_u32 v31, v0, 2, 2
  v_lshl_add_u32 v182, v31, 7, v182
  v_bfe_u32 v31, v0, 0, 2
  v_lshl_add_u32 v182, v31, 3, v182
  v_add_u32 v182, s91, v182
  s_lshl_b32 s91, s32, 5
  v_mov_b32 v183, 0x0
  v_bfe_u32 v31, v0, 4, 1
  v_lshl_add_u32 v183, v31, 13, v183
  v_bfe_u32 v31, v0, 5, 1
  v_lshl_add_u32 v183, v31, 8, v183
  v_bfe_u32 v31, v0, 2, 1
  v_lshl_add_u32 v183, v31, 10, v183
  v_bfe_u32 v31, v0, 3, 1
  v_lshl_add_u32 v183, v31, 7, v183
  v_bfe_u32 v31, v0, 0, 2
  v_lshl_add_u32 v183, v31, 3, v183
  v_add_u32 v183, s91, v183
  v_add_u32 v184, 0x10000, v183
  s_lshl_b32 s97, s34, 2
  s_add_u32 s97, s97, s32
  s_lshl_b32 s98, s97, 14
  s_lshl_b32 s91, s33, 21
  s_add_u32 s98, s98, s91
  s_lshl_b32 s97, s97, 16
  s_lshl_b32 s91, s33, 11
  s_add_u32 s97, s97, s91
  v_mov_b32 v16, 0x0
  v_bfe_u32 v31, v0, 0, 4
  v_lshl_add_u32 v16, v31, 7, v16
  v_bfe_u32 v31, v0, 4, 2
  v_lshl_add_u32 v16, v31, 13, v16
  v_add_u32 v17, 0x8000, v16
  v_lshlrev_b32 v18, 7, v0
  v_add_u32 v19, 0x2000, v18
  s_lshl_b32 s58, s33, 5
  s_add_u32 s58, s58, s34
  s_lshl_b32 s59, s32, 19
  s_add_u32 s59, s59, 0x3800000
  s_lshl_b32 s90, s58, 11
  s_add_u32 s90, s90, s59
  s_mul_i32 s91, s58, 3072
  s_add_u32 s91, s91, s59
  s_add_u32 s91, s91, 0x200000
  v_lshlrev_b32 v6, 4, v0
  v_mov_b32 v8, -1
  v_mov_b32 v12, 0
  v_mov_b32 v9, -1
  v_mov_b32 v13, 0
  v_mov_b32 v10, -1
  v_mov_b32 v14, 0
  v_mov_b32 v11, -1
  v_mov_b32 v15, 0
  buffer_store_dwordx4 v[8:11], v6, s[4:7], s90 offen offset:0 sc1
  buffer_store_dwordx4 v[8:11], v6, s[4:7], s90 offen offset:1024 sc1
  buffer_store_dwordx4 v[8:11], v6, s[4:7], s91 offen offset:0 sc1
  buffer_store_dwordx4 v[8:11], v6, s[4:7], s91 offen offset:1024 sc1
  buffer_store_dwordx4 v[8:11], v6, s[4:7], s91 offen offset:2048 sc1
  s_lshl_b32 s58, s58, 2
  s_add_u32 s58, s58, s32
  s_cmp_ge_u32 s58, 36
  s_cbranch_scc1 SL_nz_1
  s_lshl_b32 s90, s58, 10
  s_add_u32 s90, s90, 0x3d00000
  buffer_store_dwordx4 v[12:15], v6, s[4:7], s90 offen sc1
SL_nz_1:
  s_add_u32 m0, s96, 0
  s_mov_b32 s90, 0x0
  buffer_load_dwordx4 v180, s[12:15], s90 offen  lds
  s_add_u32 m0, s96, 1024
  s_mov_b32 s90, 0x10000
  buffer_load_dwordx4 v180, s[12:15], s90 offen  lds
  s_add_u32 m0, s96, 2048
  s_mov_b32 s90, 0x20000
  buffer_load_dwordx4 v180, s[12:15], s90 offen  lds
  s_add_u32 m0, s96, 3072
  s_mov_b32 s90, 0x30000
  buffer_load_dwordx4 v180, s[12:15], s90 offen  lds
  s_add_u32 m0, s96, 4096
  s_mov_b32 s90, 0x0
  buffer_load_dwordx4 v185, s[16:19], s90 offen  lds
  s_add_u32 m0, s96, 5120
  s_mov_b32 s90, 0x10000
  buffer_load_dwordx4 v185, s[16:19], s90 offen  lds
  s_add_u32 m0, s96, 6144
  s_mov_b32 s90, 0x20000
  buffer_load_dwordx4 v185, s[16:19], s90 offen  lds
  s_add_u32 m0, s96, 7168
  s_mov_b32 s90, 0x30000
  buffer_load_dwordx4 v185, s[16:19], s90 offen  lds
  s_add_u32 m0, s96, 8192
  s_mov_b32 s90, 0x40000
  buffer_load_dwordx4 v180, s[12:15], s90 offen  lds
  s_add_u32 m0, s96, 9216
  s_mov_b32 s90, 0x50000
  buffer_load_dwordx4 v180, s[12:15], s90 offen  lds
  s_add_u32 m0, s96, 10240
  s_mov_b32 s90, 0x60000
  buffer_load_dwordx4 v180, s[12:15], s90 offen  lds
  s_add_u32 m0, s96, 11264
  s_mov_b32 s90, 0x70000
  buffer_load_dwordx4 v180, s[12:15], s90 offen  lds
  s_add_u32 m0, s96, 12288
  s_mov_b32 s90, 0x40000
  buffer_load_dwordx4 v185, s[16:19], s90 offen  lds
  s_add_u32 m0, s96, 13312
  s_mov_b32 s90, 0x50000
  buffer_load_dwordx4 v185, s[16:19], s90 offen  lds
  s_add_u32 m0, s96, 14336
  s_mov_b32 s90, 0x60000
  buffer_load_dwordx4 v185, s[16:19], s90 offen  lds
  s_add_u32 m0, s96, 15360
  s_mov_b32 s90, 0x70000
  buffer_load_dwordx4 v185, s[16:19], s90 offen  lds
  s_add_u32 m0, s96, 16384
  s_mov_b32 s90, 0x80000
  buffer_load_dwordx4 v180, s[12:15], s90 offen  lds
  s_add_u32 m0, s96, 17408
  s_mov_b32 s90, 0x90000
  buffer_load_dwordx4 v180, s[12:15], s90 offen  lds
  s_add_u32 m0, s96, 18432
  s_mov_b32 s90, 0xa0000
  buffer_load_dwordx4 v180, s[12:15], s90 offen  lds
  s_add_u32 m0, s96, 19456
  s_mov_b32 s90, 0xb0000
  buffer_load_dwordx4 v180, s[12:15], s90 offen  lds
  s_add_u32 m0, s96, 20480
  s_mov_b32 s90, 0x80000
  buffer_load_dwordx4 v185, s[16:19], s90 offen  lds
  s_add_u32 m0, s96, 21504
  s_mov_b32 s90, 0x90000
  buffer_load_dwordx4 v185, s[16:19], s90 offen  lds
  s_add_u32 m0, s96, 22528
  s_mov_b32 s90, 0xa0000
  buffer_load_dwordx4 v185, s[16:19], s90 offen  lds
  s_add_u32 m0, s96, 23552
  s_mov_b32 s90, 0xb0000
  buffer_load_dwordx4 v185, s[16:19], s90 offen  lds
  s_add_u32 m0, s96, 24576
  s_mov_b32 s90, 0xc0000
  buffer_load_dwordx4 v180, s[12:15], s90 offen  lds
  s_add_u32 m0, s96, 25600
  s_mov_b32 s90, 0xd0000
  buffer_load_dwordx4 v180, s[12:15], s90 offen  lds
  s_add_u32 m0, s96, 26624
  s_mov_b32 s90, 0xe0000
  buffer_load_dwordx4 v180, s[12:15], s90 offen  lds
  s_add_u32 m0, s96, 27648
  s_mov_b32 s90, 0xf0000
  buffer_load_dwordx4 v180, s[12:15], s90 offen  lds
  s_add_u32 m0, s96, 28672
  s_mov_b32 s90, 0xc0000
  buffer_load_dwordx4 v185, s[16:19], s90 offen  lds
  s_add_u32 m0, s96, 29696
  s_mov_b32 s90, 0xd0000
  buffer_load_dwordx4 v185, s[16:19], s90 offen  lds
  s_add_u32 m0, s96, 30720
  s_mov_b32 s90, 0xe0000
  buffer_load_dwordx4 v185, s[16:19], s90 offen  lds
  s_add_u32 m0, s96, 31744
  s_mov_b32 s90, 0xf0000
  buffer_load_dwordx4 v185, s[16:19], s90 offen  lds
  s_lshl_b32 s90, s34, 2
  s_add_u32 s90, s90, s32
  s_lshr_b32 s91, s90, 3
  s_lshl_b32 s91, s91, 14
  s_and_b32 s92, s90, 7
  s_lshl_b32 s92, s92, 10
  s_add_u32 s91, s91, s92
  v_mov_b32 v1, 0x0
  v_bfe_u32 v31, v0, 0, 6
  v_lshl_add_u32 v1, v31, 4, v1
  v_add_u32 v1, s91, v1
  v_lshrrev_b32 v30, 4, v0
  v_cmp_eq_u32 vcc, s33, v30
  v_xor_b32 v29, 0x2000, v1
  s_nop 0
  v_cndmask_b32 v1, v1, v29, vcc
  s_lshl_b32 s91, s33, 14
  s_lshl_b32 s92, s90, 7
  s_add_u32 s91, s91, s92
  v_mov_b32 v2, 0x200000
  v_bfe_u32 v31, v0, 0, 2
  v_lshl_add_u32 v2, v31, 2, v2
  v_bfe_u32 v31, v0, 2, 1
  v_lshl_add_u32 v2, v31, 6, v2
  v_bfe_u32 v31, v0, 4, 1
  v_lshl_add_u32 v2, v31, 4, v2
  v_bfe_u32 v31, v0, 5, 1
  v_lshl_add_u32 v2, v31, 5, v2
  v_bfe_u32 v31, v0, 3, 1
  v_lshl_add_u32 v2, v31, 31, v2
  v_add_u32 v2, s91, v2
  s_lshr_b32 s92, s90, 1
  s_lshl_b32 s92, s92, 5
  s_and_b32 s91, s90, 1
  s_lshl_b32 s91, s91, 13
  s_add_u32 s92, s92, s91
  v_mov_b32 v30, 0x0
  v_bfe_u32 v31, v0, 2, 1
  v_lshl_add_u32 v30, v31, 12, v30
  v_bfe_u32 v31, v0, 4, 1
  v_lshl_add_u32 v30, v31, 11, v30
  v_bfe_u32 v31, v0, 0, 2
  v_lshl_add_u32 v30, v31, 3, v30
  v_bfe_u32 v31, v0, 5, 1
  v_lshl_add_u32 v30, v31, 2, v30
  v_add_u32 v30, s92, v30
  buffer_load_dword v44, v30, s[24:27], 0 offen
  s_lshl_b32 s91, s33, 14
  s_lshl_b32 s92, s32, 12
  s_add_u32 s91, s91, s92
  v_mov_b32 v3, 0x200000
  v_bfe_u32 v31, v0, 0, 6
  v_lshl_add_u32 v3, v31, 4, v3
  v_add_u32 v3, s91, v3
  s_mul_i32 s91, s32, 3264
  v_mov_b32 v4, 0x0
  v_bfe_u32 v31, v0, 0, 6
  v_lshl_add_u32 v4, v31, 4, v4
  v_add_u32 v4, s91, v4
  s_lshl_b32 s91, s32, 6
  v_mov_b32 v6, 0x0
  v_bfe_u32 v31, v0, 0, 2
  v_lshl_add_u32 v6, v31, 4, v6
  v_bfe_u32 v31, v0, 2, 1
  v_lshl_add_u32 v6, v31, 2, v6
  v_bfe_u32 v31, v0, 3, 1
  s_mov_b32 s99, 1088
  v_mad_u32_u24 v6, v31, s99, v6
  v_bfe_u32 v31, v0, 4, 2
  v_lshl_add_u32 v6, v31, 8, v6
  v_add_u32 v6, s91, v6
  v_add_u32 v240, 3264, v6
  v_add_u32 v241, 6528, v6
  v_add_u32 v242, 9792, v6
  s_lshl_b32 s93, s37, 13
  s_lshl_b32 s91, s38, 10
  s_add_u32 s91, s91, s93
  s_lshl_b32 s92, s32, 8
  s_add_u32 s91, s91, s92
  v_mov_b32 v7, 0x210000
  v_bfe_u32 v31, v0, 0, 6
  v_lshl_add_u32 v7, v31, 2, v7
  v_add_u32 v7, s91, v7
  s_lshl_b32 s91, s37, 11
  s_lshl_b32 s92, s38, 9
  s_add_u32 s59, s91, s92
  s_lshl_b32 s92, s32, 7
  s_add_u32 s91, s59, s92
  v_mov_b32 v19, 0x83000000
  v_bfe_u32 v31, v0, 0, 3
  v_lshl_add_u32 v19, v31, 2, v19
  v_bfe_u32 v31, v0, 4, 2
  v_lshl_add_u32 v19, v31, 5, v19
  v_bfe_u32 v31, v0, 3, 1
  v_lshl_add_u32 v19, v31, 31, v19
  v_add_u32 v19, s91, v19
  s_lshl_b32 s91, s32, 8
  v_mov_b32 v5, 0x880
  v_bfe_u32 v31, v0, 0, 1
  v_lshl_add_u32 v5, v31, 7, v5
  v_bfe_u32 v31, v0, 1, 1
  v_lshl_add_u32 v5, v31, 3, v5
  v_bfe_u32 v31, v0, 2, 3
  v_lshl_add_u32 v5, v31, 4, v5
  v_add_u32 v5, s91, v5
  s_lshr_b32 s92, s38, 1
  s_xor_b32 s92, s92, 1
  s_lshl_b32 s92, s92, 10
  s_add_u32 s91, s91, s92
  s_add_u32 s91, s91, s93
  s_and_b32 s92, s38, 1
  s_lshl_b32 s92, s92, 7
  s_add_u32 s91, s91, s92
  v_mov_b32 v8, 0x211000
  v_bfe_u32 v31, v0, 0, 5
  v_lshl_add_u32 v8, v31, 2, v8
  v_bfe_u32 v31, v0, 5, 1
  v_lshl_add_u32 v8, v31, 31, v8
  v_add_u32 v8, s91, v8
  s_sub_u32 s91, s91, s93
  s_lshl_b32 s92, s37, 11
  s_add_u32 s91, s91, s92
  v_mov_b32 v20, 0x3400000
  v_bfe_u32 v31, v0, 0, 5
  v_lshl_add_u32 v20, v31, 2, v20
  v_bfe_u32 v31, v0, 5, 1
  v_lshl_add_u32 v20, v31, 31, v20
  v_add_u32 v20, s91, v20
  s_lshl_b32 s97, s35, 2
  s_add_u32 s97, s97, s32
  s_lshl_b32 s97, s97, 13
  v_mov_b32 v9, 0x210000
  v_bfe_u32 v31, v0, 0, 6
  v_lshl_add_u32 v9, v31, 4, v9
  v_add_u32 v9, s97, v9
  v_add_u32 v10, 4096, v9
  v_mov_b32 v11, 0x1000000
  v_bfe_u32 v31, v0, 0, 2
  v_lshl_add_u32 v11, v31, 4, v11
  v_bfe_u32 v31, v0, 2, 1
  v_lshl_add_u32 v11, v31, 7, v11
  v_bfe_u32 v31, v0, 3, 1
  v_lshl_add_u32 v11, v31, 12, v11
  v_bfe_u32 v31, v0, 4, 2
  v_lshl_add_u32 v11, v31, 8, v11
  v_add_u32 v11, s97, v11
  v_mov_b32 v12, 0x2000000
  v_bfe_u32 v31, v0, 0, 3
  v_lshl_add_u32 v12, v31, 4, v12
  v_bfe_u32 v31, v0, 3, 1
  v_lshl_add_u32 v12, v31, 11, v12
  v_bfe_u32 v31, v0, 4, 2
  v_lshl_add_u32 v12, v31, 8, v12
  v_add_u32 v12, s97, v12
  v_add_u32 v13, 4096, v12
  s_lshl_b32 s91, s36, 9
  s_add_u32 s91, s91, s97
  s_add_u32 s63, s91, 0x1000000
  v_mov_b32 v21, 0x1000000
  v_bfe_u32 v31, v0, 0, 2
  v_lshl_add_u32 v21, v31, 7, v21
  v_bfe_u32 v31, v0, 2, 1
  v_lshl_add_u32 v21, v31, 24, v21
  v_add_u32 v21, s91, v21
  v_cmp_gt_u32 vcc, 8, v0
  v_mov_b32 v30, 0x80000000
  s_nop 0
  v_cndmask_b32 v21, v30, v21, vcc
  s_lshl_b32 s91, s32, 11
  v_mov_b32 v30, 0x0
  v_bfe_u32 v31, v0, 2, 1
  v_lshl_add_u32 v30, v31, 6, v30
  v_bfe_u32 v31, v0, 0, 1
  v_lshl_add_u32 v30, v31, 5, v30
  v_bfe_u32 v31, v0, 1, 1
  v_lshl_add_u32 v30, v31, 4, v30
  v_mov_b32 v29, 0x0
  v_bfe_u32 v31, v0, 4, 2
  v_lshl_add_u32 v29, v31, 5, v29
  v_xor_b32 v30, v30, v29
  v_mov_b32 v14, 0x3400
  v_bfe_u32 v31, v0, 0, 4
  v_lshl_add_u32 v14, v31, 7, v14
  v_add_u32 v14, s91, v14
  v_add_u32 v14, v14, v30
  v_xor_b32 v15, 16, v14
  v_mov_b32 v30, 0x0
  v_bfe_u32 v31, v0, 5, 1
  v_lshl_add_u32 v30, v31, 6, v30
  v_bfe_u32 v31, v0, 1, 1
  v_lshl_add_u32 v30, v31, 5, v30
  v_bfe_u32 v31, v0, 4, 1
  v_lshl_add_u32 v30, v31, 4, v30
  v_mov_b32 v29, 0x0
  v_bfe_u32 v31, v0, 2, 2
  v_lshl_add_u32 v29, v31, 5, v29
  v_bfe_u32 v31, v0, 0, 1
  v_lshl_add_u32 v29, v31, 4, v29
  v_xor_b32 v30, v30, v29
  v_mov_b32 v16, 0x3400
  v_bfe_u32 v31, v0, 4, 2
  v_lshl_add_u32 v16, v31, 8, v16
  v_bfe_u32 v31, v0, 1, 1
  v_lshl_add_u32 v16, v31, 7, v16
  v_add_u32 v16, v16, v30
  s_lshl_b32 s98, s36, 14
  s_lshl_b32 s92, s35, 7
  s_add_u32 s98, s98, s92
  s_lshl_b32 s92, s32, 11
  s_add_u32 s91, s98, s92
  v_mov_b32 v17, 0x0
  v_bfe_u32 v31, v0, 0, 5
  v_lshl_add_u32 v17, v31, 2, v17
  v_bfe_u32 v31, v0, 5, 1
  v_lshl_add_u32 v17, v31, 10, v17
  v_add_u32 v17, s91, v17
  v_xor_b32 v18, 0x2000, v17
  s_mov_b32 s48, 0x33333333
  s_mov_b32 s49, 0x33333333
  s_mov_b32 s50, 0xffff0000
  s_mov_b32 s51, 0xffff0000
  s_mov_b32 s52, 0x0000ffff
  s_mov_b32 s53, 0x0000ffff
  s_mov_b32 s54, 0xfffffffe
  s_mov_b32 s47, 0x3e0293ee
  v_mov_b32 v30, 0x4444
  v_mov_b32 v31, 0xeeee
  v_cndmask_b32 v23, v31, v30, s[48:49]
  v_mov_b32 v22, -1
  v_mov_b32 v232, 0
  v_mov_b32 v233, 0
  v_mov_b32 v234, 0
  v_mov_b32 v235, 0
  v_mov_b32 v112, 0
  v_mov_b32 v113, 0
  s_mov_b32 s56, 0xf0f0f0f0
  s_mov_b32 s57, 0xf0f0f0f0
  v_mov_b32 v30, 0x3f80
  v_mov_b32 v31, 1.0
  v_cndmask_b32 v30, v30, v31, s[56:57]
  s_mov_b32 s56, 0x110011
  s_mov_b32 s57, 0x110011
  v_cndmask_b32 v24, 0, v30, s[56:57]
  s_mov_b32 s56, 0x220022
  s_mov_b32 s57, 0x220022
  v_cndmask_b32 v25, 0, v30, s[56:57]
  s_mov_b32 s56, 0x11001100
  s_mov_b32 s57, 0x11001100
  v_cndmask_b32 v26, 0, v30, s[56:57]
  s_mov_b32 s56, 0x22002200
  s_mov_b32 s57, 0x22002200
  v_cndmask_b32 v27, 0, v30, s[56:57]
  s_mov_b32 s40, 0
  s_mov_b32 s41, 0x3800000
  s_mov_b32 s43, 0x3900000
  s_mov_b32 s44, 0
  s_mov_b32 s55, 0x40000
  s_mov_b32 s45, 0
  s_waitcnt vmcnt(33)
  s_barrier
  s_cmp_lg_u32 s32, 0
  s_cbranch_scc1 SL_sig_2
  v_mov_b32 v254, 1
  v_mov_b32 v255, 0
  s_mov_b64 exec, 1
  buffer_atomic_add v254, v255, s[28:31], s100 offen offset:132 sc1
  s_mov_b64 exec, -1
SL_sig_2:
  s_waitcnt vmcnt(28)
  ds_read_b64_tr_b16 a[16:17], v182 offset:0
  ds_read_b64_tr_b16 a[18:19], v182 offset:512
  ds_read_b64_tr_b16 a[24:25], v182 offset:32
  ds_read_b64_tr_b16 a[26:27], v182 offset:544
  s_waitcnt lgkmcnt(0)
  s_add_u32 m0, s96, 0
  s_mov_b32 s90, 0x100000
  buffer_load_dwordx4 v180, s[12:15], s90 offen  lds
  s_add_u32 m0, s96, 1024
  s_mov_b32 s90, 0x110000
  buffer_load_dwordx4 v180, s[12:15], s90 offen  lds
  s_add_u32 m0, s96, 2048
  s_mov_b32 s90, 0x120000
  buffer_load_dwordx4 v180, s[12:15], s90 offen  lds
  s_add_u32 m0, s96, 3072
  s_mov_b32 s90, 0x130000
  buffer_load_dwordx4 v180, s[12:15], s90 offen  lds
  s_waitcnt vmcnt(28)
  ds_read_b64_tr_b16 a[32:33], v182 offset:4096
  ds_read_b64_tr_b16 a[34:35], v182 offset:4608
  ds_read_b64_tr_b16 a[40:41], v182 offset:4128
  ds_read_b64_tr_b16 a[42:43], v182 offset:4640
  s_waitcnt lgkmcnt(0)
  s_add_u32 m0, s96, 4096
  s_mov_b32 s90, 0x100000
  buffer_load_dwordx4 v185, s[16:19], s90 offen  lds
  s_add_u32 m0, s96, 5120
  s_mov_b32 s90, 0x110000
  buffer_load_dwordx4 v185, s[16:19], s90 offen  lds
  s_add_u32 m0, s96, 6144
  s_mov_b32 s90, 0x120000
  buffer_load_dwordx4 v185, s[16:19], s90 offen  lds
  s_add_u32 m0, s96, 7168
  s_mov_b32 s90, 0x130000
  buffer_load_dwordx4 v185, s[16:19], s90 offen  lds
  s_waitcnt vmcnt(28)
  ds_read_b64_tr_b16 a[20:21], v182 offset:8192
  ds_read_b64_tr_b16 a[22:23], v182 offset:8704
  ds_read_b64_tr_b16 a[28:29], v182 offset:8224
  ds_read_b64_tr_b16 a[30:31], v182 offset:8736
  s_waitcnt lgkmcnt(0)
  s_add_u32 m0, s96, 8192
  s_mov_b32 s90, 0x140000
  buffer_load_dwordx4 v180, s[12:15], s90 offen  lds
  s_add_u32 m0, s96, 9216
  s_mov_b32 s90, 0x150000
  buffer_load_dwordx4 v180, s[12:15], s90 offen  lds
  s_add_u32 m0, s96, 10240
  s_mov_b32 s90, 0x160000
  buffer_load_dwordx4 v180, s[12:15], s90 offen  lds
  s_add_u32 m0, s96, 11264
  s_mov_b32 s90, 0x170000
  buffer_load_dwordx4 v180, s[12:15], s90 offen  lds
  s_waitcnt vmcnt(28)
  ds_read_b64_tr_b16 a[36:37], v182 offset:12288
  ds_read_b64_tr_b16 a[38:39], v182 offset:12800
  ds_read_b64_tr_b16 a[44:45], v182 offset:12320
  ds_read_b64_tr_b16 a[46:47], v182 offset:12832
  s_waitcnt lgkmcnt(0)
  s_add_u32 m0, s96, 12288
  s_mov_b32 s90, 0x140000
  buffer_load_dwordx4 v185, s[16:19], s90 offen  lds
  s_add_u32 m0, s96, 13312
  s_mov_b32 s90, 0x150000
  buffer_load_dwordx4 v185, s[16:19], s90 offen  lds
  s_add_u32 m0, s96, 14336
  s_mov_b32 s90, 0x160000
  buffer_load_dwordx4 v185, s[16:19], s90 offen  lds
  s_add_u32 m0, s96, 15360
  s_mov_b32 s90, 0x170000
  buffer_load_dwordx4 v185, s[16:19], s90 offen  lds
  s_waitcnt vmcnt(28)
  ds_read_b64_tr_b16 a[64:65], v182 offset:16384
  ds_read_b64_tr_b16 a[66:67], v182 offset:16896
  ds_read_b64_tr_b16 a[72:73], v182 offset:16416
  ds_read_b64_tr_b16 a[74:75], v182 offset:16928
  s_waitcnt lgkmcnt(0)
  s_add_u32 m0, s96, 16384
  s_mov_b32 s90, 0x180000
  buffer_load_dwordx4 v180, s[12:15], s90 offen  lds
  s_add_u32 m0, s96, 17408
  s_mov_b32 s90, 0x190000
  buffer_load_dwordx4 v180, s[12:15], s90 offen  lds
  s_add_u32 m0, s96, 18432
  s_mov_b32 s90, 0x1a0000
  buffer_load_dwordx4 v180, s[12:15], s90 offen  lds
  s_add_u32 m0, s96, 19456
  s_mov_b32 s90, 0x1b0000
  buffer_load_dwordx4 v180, s[12:15], s90 offen  lds
  s_waitcnt vmcnt(28)
  ds_read_b64_tr_b16 a[80:81], v182 offset:20480
  ds_read_b64_tr_b16 a[82:83], v182 offset:20992
  ds_read_b64_tr_b16 a[88:89], v182 offset:20512
  ds_read_b64_tr_b16 a[90:91], v182 offset:21024
  s_waitcnt lgkmcnt(0)
  s_add_u32 m0, s96, 20480
  s_mov_b32 s90, 0x180000
  buffer_load_dwordx4 v185, s[16:19], s90 offen  lds
  s_add_u32 m0, s96, 21504
  s_mov_b32 s90, 0x190000
  buffer_load_dwordx4 v185, s[16:19], s90 offen  lds
  s_add_u32 m0, s96, 22528
  s_mov_b32 s90, 0x1a0000
  buffer_load_dwordx4 v185, s[16:19], s90 offen  lds
  s_add_u32 m0, s96, 23552
  s_mov_b32 s90, 0x1b0000
  buffer_load_dwordx4 v185, s[16:19], s90 offen  lds
  s_waitcnt vmcnt(28)
  ds_read_b64_tr_b16 a[68:69], v182 offset:24576
  ds_read_b64_tr_b16 a[70:71], v182 offset:25088
  ds_read_b64_tr_b16 a[76:77], v182 offset:24608
  ds_read_b64_tr_b16 a[78:79], v182 offset:25120
  s_waitcnt lgkmcnt(0)
  s_add_u32 m0, s96, 24576
  s_mov_b32 s90, 0x1c0000
  buffer_load_dwordx4 v180, s[12:15], s90 offen  lds
  s_add_u32 m0, s96, 25600
  s_mov_b32 s90, 0x1d0000
  buffer_load_dwordx4 v180, s[12:15], s90 offen  lds
  s_add_u32 m0, s96, 26624
  s_mov_b32 s90, 0x1e0000
  buffer_load_dwordx4 v180, s[12:15], s90 offen  lds
  s_add_u32 m0, s96, 27648
  s_mov_b32 s90, 0x1f0000
  buffer_load_dwordx4 v180, s[12:15], s90 offen  lds
  s_waitcnt vmcnt(28)
  ds_read_b64_tr_b16 a[84:85], v182 offset:28672
  ds_read_b64_tr_b16 a[86:87], v182 offset:29184
  ds_read_b64_tr_b16 a[92:93], v182 offset:28704
  ds_read_b64_tr_b16 a[94:95], v182 offset:29216
  s_waitcnt lgkmcnt(0)
  s_add_u32 m0, s96, 28672
  s_mov_b32 s90, 0x1c0000
  buffer_load_dwordx4 v185, s[16:19], s90 offen  lds
  s_add_u32 m0, s96, 29696
  s_mov_b32 s90, 0x1d0000
  buffer_load_dwordx4 v185, s[16:19], s90 offen  lds
  s_add_u32 m0, s96, 30720
  s_mov_b32 s90, 0x1e0000
  buffer_load_dwordx4 v185, s[16:19], s90 offen  lds
  s_add_u32 m0, s96, 31744
  s_mov_b32 s90, 0x1f0000
  buffer_load_dwordx4 v185, s[16:19], s90 offen  lds
  s_waitcnt vmcnt(28)
  ds_read_b64_tr_b16 a[112:113], v182 offset:0
  ds_read_b64_tr_b16 a[114:115], v182 offset:512
  ds_read_b64_tr_b16 a[120:121], v182 offset:32
  ds_read_b64_tr_b16 a[122:123], v182 offset:544
  s_waitcnt lgkmcnt(0)
  s_add_u32 m0, s96, 0
  s_mov_b32 s90, 0x0
  buffer_load_dwordx4 v180, s[8:11], s90 offen  lds
  s_add_u32 m0, s96, 1024
  s_mov_b32 s90, 0x10000
  buffer_load_dwordx4 v180, s[8:11], s90 offen  lds
  s_add_u32 m0, s96, 2048
  s_mov_b32 s90, 0x20000
  buffer_load_dwordx4 v180, s[8:11], s90 offen  lds
  s_add_u32 m0, s96, 3072
  s_mov_b32 s90, 0x30000
  buffer_load_dwordx4 v180, s[8:11], s90 offen  lds
  s_waitcnt vmcnt(28)
  ds_read_b64_tr_b16 a[128:129], v182 offset:4096
  ds_read_b64_tr_b16 a[130:131], v182 offset:4608
  ds_read_b64_tr_b16 a[136:137], v182 offset:4128
  ds_read_b64_tr_b16 a[138:139], v182 offset:4640
  s_waitcnt lgkmcnt(0)
  s_add_u32 m0, s96, 4096
  s_mov_b32 s90, 0x40000
  buffer_load_dwordx4 v180, s[8:11], s90 offen  lds
  s_add_u32 m0, s96, 5120
  s_mov_b32 s90, 0x50000
  buffer_load_dwordx4 v180, s[8:11], s90 offen  lds
  s_add_u32 m0, s96, 6144
  s_mov_b32 s90, 0x60000
  buffer_load_dwordx4 v180, s[8:11], s90 offen  lds
  s_add_u32 m0, s96, 7168
  s_mov_b32 s90, 0x70000
  buffer_load_dwordx4 v180, s[8:11], s90 offen  lds
  s_waitcnt vmcnt(28)
  ds_read_b64_tr_b16 a[116:117], v182 offset:8192
  ds_read_b64_tr_b16 a[118:119], v182 offset:8704
  ds_read_b64_tr_b16 a[124:125], v182 offset:8224
  ds_read_b64_tr_b16 a[126:127], v182 offset:8736
  s_waitcnt lgkmcnt(0)
  s_add_u32 m0, s96, 8192
  s_mov_b32 s90, 0x80000
  buffer_load_dwordx4 v180, s[8:11], s90 offen  lds
  s_add_u32 m0, s96, 9216
  s_mov_b32 s90, 0x90000
  buffer_load_dwordx4 v180, s[8:11], s90 offen  lds
  s_add_u32 m0, s96, 10240
  s_mov_b32 s90, 0xa0000
  buffer_load_dwordx4 v180, s[8:11], s90 offen  lds
  s_add_u32 m0, s96, 11264
  s_mov_b32 s90, 0xb0000
  buffer_load_dwordx4 v180, s[8:11], s90 offen  lds
  s_waitcnt vmcnt(28)
  ds_read_b64_tr_b16 a[132:133], v182 offset:12288
  ds_read_b64_tr_b16 a[134:135], v182 offset:12800
  ds_read_b64_tr_b16 a[140:141], v182 offset:12320
  ds_read_b64_tr_b16 a[142:143], v182 offset:12832
  s_waitcnt lgkmcnt(0)
  s_add_u32 m0, s96, 12288
  s_mov_b32 s90, 0xc0000
  buffer_load_dwordx4 v180, s[8:11], s90 offen  lds
  s_add_u32 m0, s96, 13312
  s_mov_b32 s90, 0xd0000
  buffer_load_dwordx4 v180, s[8:11], s90 offen  lds
  s_add_u32 m0, s96, 14336
  s_mov_b32 s90, 0xe0000
  buffer_load_dwordx4 v180, s[8:11], s90 offen  lds
  s_add_u32 m0, s96, 15360
  s_mov_b32 s90, 0xf0000
  buffer_load_dwordx4 v180, s[8:11], s90 offen  lds
  s_waitcnt vmcnt(28)
  ds_read_b64_tr_b16 a[160:161], v182 offset:16384
  ds_read_b64_tr_b16 a[162:163], v182 offset:16896
  ds_read_b64_tr_b16 a[168:169], v182 offset:16416
  ds_read_b64_tr_b16 a[170:171], v182 offset:16928
  s_waitcnt lgkmcnt(0)
  s_add_u32 m0, s96, 16384
  s_mov_b32 s90, 0x100000
  buffer_load_dwordx4 v180, s[8:11], s90 offen  lds
  s_add_u32 m0, s96, 17408
  s_mov_b32 s90, 0x110000
  buffer_load_dwordx4 v180, s[8:11], s90 offen  lds
  s_add_u32 m0, s96, 18432
  s_mov_b32 s90, 0x120000
  buffer_load_dwordx4 v180, s[8:11], s90 offen  lds
  s_add_u32 m0, s96, 19456
  s_mov_b32 s90, 0x130000
  buffer_load_dwordx4 v180, s[8:11], s90 offen  lds
  s_waitcnt vmcnt(28)
  ds_read_b64_tr_b16 a[176:177], v182 offset:20480
  ds_read_b64_tr_b16 a[178:179], v182 offset:20992
  ds_read_b64_tr_b16 a[184:185], v182 offset:20512
  ds_read_b64_tr_b16 a[186:187], v182 offset:21024
  s_waitcnt lgkmcnt(0)
  s_add_u32 m0, s96, 20480
  s_mov_b32 s90, 0x140000
  buffer_load_dwordx4 v180, s[8:11], s90 offen  lds
  s_add_u32 m0, s96, 21504
  s_mov_b32 s90, 0x150000
  buffer_load_dwordx4 v180, s[8:11], s90 offen  lds
  s_add_u32 m0, s96, 22528
  s_mov_b32 s90, 0x160000
  buffer_load_dwordx4 v180, s[8:11], s90 offen  lds
  s_add_u32 m0, s96, 23552
  s_mov_b32 s90, 0x170000
  buffer_load_dwordx4 v180, s[8:11], s90 offen  lds
  s_waitcnt vmcnt(28)
  ds_read_b64_tr_b16 a[164:165], v182 offset:24576
  ds_read_b64_tr_b16 a[166:167], v182 offset:25088
  ds_read_b64_tr_b16 a[172:173], v182 offset:24608
  ds_read_b64_tr_b16 a[174:175], v182 offset:25120
  s_waitcnt lgkmcnt(0)
  s_add_u32 m0, s96, 24576
  s_mov_b32 s90, 0x180000
  buffer_load_dwordx4 v180, s[8:11], s90 offen  lds
  s_add_u32 m0, s96, 25600
  s_mov_b32 s90, 0x190000
  buffer_load_dwordx4 v180, s[8:11], s90 offen  lds
  s_add_u32 m0, s96, 26624
  s_mov_b32 s90, 0x1a0000
  buffer_load_dwordx4 v180, s[8:11], s90 offen  lds
  s_add_u32 m0, s96, 27648
  s_mov_b32 s90, 0x1b0000
  buffer_load_dwordx4 v180, s[8:11], s90 offen  lds
  s_waitcnt vmcnt(28)
  ds_read_b64_tr_b16 a[180:181], v182 offset:28672
  ds_read_b64_tr_b16 a[182:183], v182 offset:29184
  ds_read_b64_tr_b16 a[188:189], v182 offset:28704
  ds_read_b64_tr_b16 a[190:191], v182 offset:29216
  s_waitcnt lgkmcnt(0)
  s_add_u32 m0, s96, 28672
  s_mov_b32 s90, 0x1c0000
  buffer_load_dwordx4 v180, s[8:11], s90 offen  lds
  s_add_u32 m0, s96, 29696
  s_mov_b32 s90, 0x1d0000
  buffer_load_dwordx4 v180, s[8:11], s90 offen  lds
  s_add_u32 m0, s96, 30720
  s_mov_b32 s90, 0x1e0000
  buffer_load_dwordx4 v180, s[8:11], s90 offen  lds
  s_add_u32 m0, s96, 31744
  s_mov_b32 s90, 0x1f0000
  buffer_load_dwordx4 v180, s[8:11], s90 offen  lds
  s_waitcnt vmcnt(28)
  ds_read_b64_tr_b16 a[0:1], v182 offset:0
  ds_read_b64_tr_b16 a[2:3], v182 offset:512
  ds_read_b64_tr_b16 a[8:9], v182 offset:32
  ds_read_b64_tr_b16 a[10:11], v182 offset:544
  s_waitcnt lgkmcnt(0)
  s_add_u32 m0, s96, 0
  s_mov_b32 s90, 0x0
  buffer_load_dwordx4 v181, s[20:23], s90 offen  lds
  s_add_u32 m0, s96, 1024
  s_mov_b32 s90, 0x4000
  buffer_load_dwordx4 v181, s[20:23], s90 offen  lds
  s_add_u32 m0, s96, 2048
  s_mov_b32 s90, 0x8000
  buffer_load_dwordx4 v181, s[20:23], s90 offen  lds
  s_add_u32 m0, s96, 3072
  s_mov_b32 s90, 0xc000
  buffer_load_dwordx4 v181, s[20:23], s90 offen  lds
  s_waitcnt vmcnt(28)
  ds_read_b64_tr_b16 a[4:5], v182 offset:4096
  ds_read_b64_tr_b16 a[6:7], v182 offset:4608
  ds_read_b64_tr_b16 a[12:13], v182 offset:4128
  ds_read_b64_tr_b16 a[14:15], v182 offset:4640
  s_waitcnt lgkmcnt(0)
  s_add_u32 m0, s96, 4096
  s_mov_b32 s90, 0x10000
  buffer_load_dwordx4 v181, s[20:23], s90 offen  lds
  s_add_u32 m0, s96, 5120
  s_mov_b32 s90, 0x14000
  buffer_load_dwordx4 v181, s[20:23], s90 offen  lds
  s_add_u32 m0, s96, 6144
  s_mov_b32 s90, 0x18000
  buffer_load_dwordx4 v181, s[20:23], s90 offen  lds
  s_add_u32 m0, s96, 7168
  s_mov_b32 s90, 0x1c000
  buffer_load_dwordx4 v181, s[20:23], s90 offen  lds
  s_waitcnt vmcnt(28)
  ds_read_b64_tr_b16 a[48:49], v182 offset:8192
  ds_read_b64_tr_b16 a[50:51], v182 offset:8704
  ds_read_b64_tr_b16 a[56:57], v182 offset:8224
  ds_read_b64_tr_b16 a[58:59], v182 offset:8736
  s_waitcnt lgkmcnt(0)
  s_add_u32 m0, s96, 8192
  s_mov_b32 s90, 0x20000
  buffer_load_dwordx4 v181, s[20:23], s90 offen  lds
  s_add_u32 m0, s96, 9216
  s_mov_b32 s90, 0x24000
  buffer_load_dwordx4 v181, s[20:23], s90 offen  lds
  s_add_u32 m0, s96, 10240
  s_mov_b32 s90, 0x28000
  buffer_load_dwordx4 v181, s[20:23], s90 offen  lds
  s_add_u32 m0, s96, 11264
  s_mov_b32 s90, 0x2c000
  buffer_load_dwordx4 v181, s[20:23], s90 offen  lds
  s_waitcnt vmcnt(28)
  ds_read_b64_tr_b16 a[52:53], v182 offset:12288
  ds_read_b64_tr_b16 a[54:55], v182 offset:12800
  ds_read_b64_tr_b16 a[60:61], v182 offset:12320
  ds_read_b64_tr_b16 a[62:63], v182 offset:12832
  s_waitcnt lgkmcnt(0)
  s_add_u32 m0, s96, 12288
  s_mov_b32 s90, 0x30000
  buffer_load_dwordx4 v181, s[20:23], s90 offen  lds
  s_add_u32 m0, s96, 13312
  s_mov_b32 s90, 0x34000
  buffer_load_dwordx4 v181, s[20:23], s90 offen  lds
  s_add_u32 m0, s96, 14336
  s_mov_b32 s90, 0x38000
  buffer_load_dwordx4 v181, s[20:23], s90 offen  lds
  s_add_u32 m0, s96, 15360
  s_mov_b32 s90, 0x3c000
  buffer_load_dwordx4 v181, s[20:23], s90 offen  lds
  s_waitcnt vmcnt(28)
  ds_read_b64_tr_b16 a[96:97], v182 offset:16384
  ds_read_b64_tr_b16 a[98:99], v182 offset:16896
  ds_read_b64_tr_b16 a[104:105], v182 offset:16416
  ds_read_b64_tr_b16 a[106:107], v182 offset:16928
  s_waitcnt vmcnt(24)
  ds_read_b64_tr_b16 a[100:101], v182 offset:20480
  ds_read_b64_tr_b16 a[102:103], v182 offset:20992
  ds_read_b64_tr_b16 a[108:109], v182 offset:20512
  ds_read_b64_tr_b16 a[110:111], v182 offset:21024
  s_waitcnt vmcnt(20)
  ds_read_b64_tr_b16 a[144:145], v182 offset:24576
  ds_read_b64_tr_b16 a[146:147], v182 offset:25088
  ds_read_b64_tr_b16 a[152:153], v182 offset:24608
  ds_read_b64_tr_b16 a[154:155], v182 offset:25120
  s_waitcnt vmcnt(16)
  ds_read_b64_tr_b16 a[148:149], v182 offset:28672
  ds_read_b64_tr_b16 a[150:151], v182 offset:29184
  ds_read_b64_tr_b16 a[156:157], v182 offset:28704
  ds_read_b64_tr_b16 a[158:159], v182 offset:29216
  s_cmp_lg_u32 s32, 0
  s_cbranch_scc1 SL_vd_4
  v_mbcnt_lo_u32_b32 v250, -1, 0
  v_mbcnt_hi_u32_b32 v250, -1, v250
  v_lshlrev_b32 v250, 2, v250
  s_cmp_lg_u32 s100, 0
  s_cbranch_scc1 SL_vw_3
  v_readfirstlane_b32 s90, v247
  s_and_b32 s90, s90, s101
  s_cbranch_scc0 SL_vw_3
  v_mov_b32 v251, 1
  s_mov_b64 exec, 1
  buffer_store_dword v251, v250, s[28:31], 0 offen offset:32 sc1
  s_mov_b64 exec, -1
SL_vw_3:
  buffer_load_dword v251, v250, s[28:31], 0 offen sc1
  s_waitcnt vmcnt(0)
  v_cmp_eq_u32 vcc, -1, v251
  v_readlane_b32 s91, v251, 8
  v_readlane_b32 s92, v251, 32
  v_readlane_b32 s93, v251, 33
  v_readlane_b32 s90, v251, 34
  s_cmp_lg_u32 s100, 0
  s_cselect_b32 s93, s90, s93
  s_cselect_b32 s91, 0, s91
  s_cselect_b32 s92, 1, s92
  s_cselect_b32 s90, 0xff, vcc_lo
  s_cmp_lg_u32 s91, 0
  s_cselect_b32 s92, 3, s92
  s_cbranch_scc1 SL_vk_5
  s_add_u32 s3, s3, 1
  s_cmp_ge_u32 s3, 131072
  s_cselect_b32 s92, 4, s92
  s_cbranch_scc1 SL_vk_5
  s_sleep 8
  s_and_b32 s90, s90, 0xff
  s_cmp_lg_u32 s90, 0xff
  s_cbranch_scc1 SL_vw_3
  s_cmp_lt_u32 s93, 128
  s_cbranch_scc1 SL_vw_3
SL_vk_5:
  v_mov_b32 v251, s92
  v_mov_b32 v250, 131072
  ds_write_b32 v250, v251
  s_waitcnt lgkmcnt(0)
SL_vd_4:
  s_barrier
  v_mov_b32 v250, 131072
  ds_read_b32 v251, v250
  s_waitcnt lgkmcnt(0)
  v_readfirstlane_b32 s92, v251
  s_barrier
  s_cmp_eq_u32 s92, 3
  s_cbranch_scc1 L_fallback
  s_cmp_eq_u32 s92, 4
  s_cbranch_scc1 L_exit
  s_waitcnt vmcnt(0)
  s_barrier
  ds_read_b64_tr_b16 a[192:193], v183 offset:0
  ds_read_b64_tr_b16 a[194:195], v183 offset:2048
  ds_read_b64_tr_b16 a[196:197], v183 offset:512
  ds_read_b64_tr_b16 a[198:199], v183 offset:2560
  ds_read_b64_tr_b16 a[200:201], v183 offset:4096
  ds_read_b64_tr_b16 a[202:203], v183 offset:6144
  ds_read_b64_tr_b16 a[204:205], v183 offset:4608
  ds_read_b64_tr_b16 a[206:207], v183 offset:6656
  s_waitcnt lgkmcnt(0)
  ds_read_b64_tr_b16 a[208:209], v183 offset:32768
  ds_read_b64_tr_b16 a[210:211], v183 offset:34816
  ds_read_b64_tr_b16 a[212:213], v183 offset:33280
  ds_read_b64_tr_b16 a[214:215], v183 offset:35328
  ds_read_b64_tr_b16 a[216:217], v183 offset:36864
  ds_read_b64_tr_b16 a[218:219], v183 offset:38912
  ds_read_b64_tr_b16 a[220:221], v183 offset:37376
  ds_read_b64_tr_b16 a[222:223], v183 offset:39424
  s_waitcnt lgkmcnt(0)
  ds_read_b64_tr_b16 a[224:225], v184 offset:0
  ds_read_b64_tr_b16 a[226:227], v184 offset:2048
  ds_read_b64_tr_b16 a[228:229], v184 offset:512
  ds_read_b64_tr_b16 a[230:231], v184 offset:2560
  ds_read_b64_tr_b16 a[232:233], v184 offset:4096
  ds_read_b64_tr_b16 a[234:235], v184 offset:6144
  ds_read_b64_tr_b16 a[236:237], v184 offset:4608
  ds_read_b64_tr_b16 a[238:239], v184 offset:6656
  s_waitcnt lgkmcnt(0)
  ds_read_b64_tr_b16 a[240:241], v184 offset:32768
  ds_read_b64_tr_b16 a[242:243], v184 offset:34816
  ds_read_b64_tr_b16 a[244:245], v184 offset:33280
  ds_read_b64_tr_b16 a[246:247], v184 offset:35328
  ds_read_b64_tr_b16 a[248:249], v184 offset:36864
  ds_read_b64_tr_b16 a[250:251], v184 offset:38912
  ds_read_b64_tr_b16 a[252:253], v184 offset:37376
  ds_read_b64_tr_b16 a[254:255], v184 offset:39424
  s_waitcnt lgkmcnt(0)
  s_barrier
  s_mov_b32 s46, 0
  s_mov_b32 s39, 0
  v_xor_b32 v1, s39, v1
  v_xor_b32 v17, s39, v17
  v_xor_b32 v18, s39, v18
  s_mov_b32 s12, s63
  v_mov_b32 v248, 0x3f803f80
  v_mov_b32 v249, 0x3f803f80
  v_mov_b32 v250, 0x3f803f80
  v_mov_b32 v251, 0x3f803f80
  v_mov_b32 v252, 0x3f803f80
  v_mov_b32 v253, 0x3f803f80
  v_mov_b32 v254, 0x3f803f80
  v_mov_b32 v255, 0x3f803f80
  s_cmp_lg_u32 s32, 0
  s_cbranch_scc1 SL_kv0d
  s_lshl_b32 s90, s33, 7
  s_add_u32 s90, s90, 0x3d07000
  v_mov_b32 v30, s90
SL_kv0:
  buffer_load_dword v31, v30, s[4:7], 0 offen sc1
  s_waitcnt vmcnt(0)
  v_readfirstlane_b32 s90, v31
  s_add_u32 s46, s46, 1
  s_cmp_ge_u32 s46, 131072
  s_cbranch_scc1 SL_rec_abort
  s_sleep 2
  s_cmp_lt_u32 s90, 16
  s_cbranch_scc1 SL_kv0
SL_kv0d:
  s_barrier
  buffer_load_dwordx4 v[180:183], v12, s[4:7], s44 offen offset:0
  buffer_load_dwordx4 v[184:187], v12, s[4:7], s44 offen offset:128
  buffer_load_dwordx4 v[188:191], v12, s[4:7], s44 offen offset:1024
  buffer_load_dwordx4 v[192:195], v12, s[4:7], s44 offen offset:1152
  buffer_load_dwordx4 v[196:199], v13, s[4:7], s44 offen offset:0
  buffer_load_dwordx4 v[200:203], v13, s[4:7], s44 offen offset:128
  buffer_load_dwordx4 v[204:207], v13, s[4:7], s44 offen offset:1024
  buffer_load_dwordx4 v[208:211], v13, s[4:7], s44 offen offset:1152
  buffer_load_dwordx4 v[116:119], v11, s[4:7], s44 offen offset:0
  buffer_load_dwordx4 v[132:135], v11, s[4:7], s44 offen offset:64
  buffer_load_dwordx4 v[120:123], v11, s[4:7], s44 offen offset:1024
  buffer_load_dwordx4 v[136:139], v11, s[4:7], s44 offen offset:1088
  buffer_load_dwordx4 v[124:127], v11, s[4:7], s44 offen offset:2048
  buffer_load_dwordx4 v[140:143], v11, s[4:7], s44 offen offset:2112
  buffer_load_dwordx4 v[128:131], v11, s[4:7], s44 offen offset:3072
  buffer_load_dwordx4 v[144:147], v11, s[4:7], s44 offen offset:3136
  s_add_u32 s44, s44, 0x40000
  v_mov_b64 v[64:65], 0
  v_mov_b64 v[66:67], 0
  v_mov_b64 v[68:69], 0
  v_mov_b64 v[70:71], 0
  v_mov_b64 v[72:73], 0
  v_mov_b64 v[74:75], 0
  v_mov_b64 v[76:77], 0
  v_mov_b64 v[78:79], 0
  v_mov_b64 v[80:81], 0
  v_mov_b64 v[82:83], 0
  v_mov_b64 v[84:85], 0
  v_mov_b64 v[86:87], 0
  v_mov_b64 v[32:33], 0
  v_mov_b64 v[34:35], 0
  v_mov_b64 v[212:213], 0
  v_mov_b64 v[214:215], 0
  v_mov_b64 v[216:217], 0
  v_mov_b64 v[218:219], 0
  v_mov_b64 v[220:221], 0
  v_mov_b64 v[222:223], 0
  v_mov_b64 v[224:225], 0
  v_mov_b64 v[226:227], 0
  v_mov_b64 v[228:229], 0
  v_mov_b64 v[230:231], 0
  s_waitcnt vmcnt(0)
  v_min_u32 v44, s54, v44
  s_lshl_b32 s90, s33, 7
  s_add_u32 s90, s90, 0x3d07000
  v_mov_b32 v244, s90
  s_lshl_b32 s90, s34, 2
  s_add_u32 s90, s90, s32
  s_lshl_b32 s91, s33, 7
  s_add_u32 s91, s91, 0x3d00000
  v_mbcnt_lo_u32_b32 v30, -1, 0
  v_mbcnt_hi_u32_b32 v30, -1, v30
  v_add_u32 v30, s90, v30
  v_cmp_eq_u32 vcc, 0, v30
  v_mov_b32 v30, 0x80000000
  v_mov_b32 v31, s91
  v_cndmask_b32 v245, v30, v31, vcc
  s_mov_b64 s[8:9], s[94:95]
  s_mov_b64 s[10:11], s[94:95]
  s_branch SL_pubmem
SL_step:
  s_load_dword s16, s[8:9], 256
  s_load_dword s17, s[10:11], 256
  s_load_dword s18, s[8:9], 320
  s_load_dword s19, s[10:11], 320
  s_load_dword s20, s[8:9], 384
  s_load_dword s21, s[10:11], 384
  s_load_dword s22, s[8:9], 448
  s_load_dword s23, s[10:11], 448
  buffer_load_dwordx4 v[200:203], v13, s[4:7], s44 offen offset:128
  buffer_load_dwordx4 v[204:207], v13, s[4:7], s44 offen offset:1024
  buffer_load_dwordx4 v[208:211], v13, s[4:7], s44 offen offset:1152
  buffer_load_dwordx4 v[128:131], v11, s[4:7], s44 offen offset:3072
  buffer_load_dwordx4 v[144:147], v11, s[4:7], s44 offen offset:3136
  v_mov_b64 v[64:65], 0
  v_mov_b64 v[66:67], 0
  v_mov_b64 v[68:69], 0
  v_mov_b64 v[70:71], 0
  v_mov_b64 v[72:73], 0
  v_mov_b64 v[74:75], 0
  v_mov_b64 v[76:77], 0
  v_mov_b64 v[78:79], 0
  v_mov_b64 v[80:81], 0
  v_mov_b64 v[82:83], 0
  v_mov_b64 v[84:85], 0
  v_mov_b64 v[86:87], 0
  v_mov_b64 v[32:33], 0
  v_mov_b64 v[34:35], 0
  buffer_load_dwordx4 v[36:39], v1, s[4:7], s42 offen sc1
  buffer_store_dword v22, v18, s[4:7], s13 offen sc1
  buffer_store_dword v22, v2, s[4:7], s13 offen sc1
  buffer_store_dword v22, v7, s[4:7], s13 offen sc1
  buffer_store_dword v22, v8, s[4:7], s13 offen sc1
  s_add_u32 s44, s44, 0x40000
  s_min_u32 s44, s44, 0xfc0000
  s_add_u32 s45, s45, 0x10000
  s_waitcnt vmcnt(12)
SL_kv_chk:
  v_readfirstlane_b32 s90, v243
  s_cmp_lt_u32 s90, 16
  s_cbranch_scc1 SL_kv_f
  s_waitcnt vmcnt(4)
SL_g_chk:
  v_max3_u32 v31, v36, v37, v38
  v_max_u32 v31, v31, v39
  v_cmp_eq_u32 vcc, -1, v31
  v_mfma_f32_16x16x32_bf16 v[40:43], v[24:27], v[36:39], 0
  s_cbranch_vccnz SL_g_f
  s_nop 6
  v_add_f32_dpp v45, v40, v40 row_ror:8 row_mask:0xf bank_mask:0xf
  v_add_f32_dpp v46, v41, v41 row_ror:8 row_mask:0xf bank_mask:0xf
  v_cvt_pk_bf16_f32 v44, v45, v46
  v_min_u32 v44, s54, v44
SL_pubmem:
  buffer_store_dword v44, v2, s[4:7], s41 offen sc1
  v_mov_b32 v148, v180
  v_mov_b32 v150, v181
  v_mov_b32 v152, v182
  v_mov_b32 v154, v183
  v_mov_b32 v149, v184
  v_mov_b32 v151, v185
  v_mov_b32 v153, v186
  v_mov_b32 v155, v187
  v_mov_b32 v156, v188
  v_mov_b32 v158, v189
  v_mov_b32 v160, v190
  v_mov_b32 v162, v191
  v_mov_b32 v157, v192
  v_mov_b32 v159, v193
  v_mov_b32 v161, v194
  v_mov_b32 v163, v195
  v_mov_b32 v164, v196
  v_mov_b32 v166, v197
  v_mov_b32 v168, v198
  v_mov_b32 v170, v199
  v_mov_b32 v165, v200
  v_mov_b32 v167, v201
  v_mov_b32 v169, v202
  v_mov_b32 v171, v203
  buffer_load_dwordx4 v[48:51], v3, s[4:7], s41 offen offset:0 sc1
  v_mov_b32 v172, v204
  v_mov_b32 v174, v205
  buffer_load_dwordx4 v[52:55], v3, s[4:7], s41 offen offset:1024 sc1
  v_mov_b32 v176, v206
  v_mov_b32 v178, v207
  buffer_load_dwordx4 v[56:59], v3, s[4:7], s41 offen offset:2048 sc1
  v_mov_b32 v173, v208
  v_mov_b32 v175, v209
  buffer_load_dwordx4 v[60:63], v3, s[4:7], s41 offen offset:3072 sc1
  v_mov_b32 v177, v210
  v_mov_b32 v179, v211
  s_waitcnt vmcnt(3)
  v_max3_u32 v31, v48, v49, v50
  v_max_u32 v31, v31, v51
  v_cmp_eq_u32 vcc, -1, v31
  s_cbranch_vccnz SL_m_f0
  v_smfmac_f32_16x16x64_bf16 v[64:67], v[48:51], a[0:7], v23
  s_waitcnt vmcnt(2)
  v_max3_u32 v31, v52, v53, v54
  v_max_u32 v31, v31, v55
  v_cmp_eq_u32 vcc, -1, v31
  v_smfmac_f32_16x16x64_bf16 v[68:71], v[48:51], a[8:15], v23
  v_smfmac_f32_16x16x64_bf16 v[72:75], v[48:51], a[16:23], v23
  v_smfmac_f32_16x16x64_bf16 v[76:79], v[48:51], a[24:31], v23
  s_cbranch_vccnz SL_m_f1
  v_smfmac_f32_16x16x64_bf16 v[64:67], v[52:55], a[48:55], v23
  s_waitcnt vmcnt(1)
  v_max3_u32 v31, v56, v57, v58
  v_max_u32 v31, v31, v59
  v_cmp_eq_u32 vcc, -1, v31
  v_smfmac_f32_16x16x64_bf16 v[68:71], v[52:55], a[56:63], v23
  v_smfmac_f32_16x16x64_bf16 v[72:75], v[52:55], a[64:71], v23
  v_smfmac_f32_16x16x64_bf16 v[76:79], v[52:55], a[72:79], v23
  s_cbranch_vccnz SL_m_f2
  v_smfmac_f32_16x16x64_bf16 v[64:67], v[56:59], a[96:103], v23
  s_waitcnt vmcnt(0)
  v_max3_u32 v31, v60, v61, v62
  v_max_u32 v31, v31, v63
  v_cmp_eq_u32 vcc, -1, v31
  v_smfmac_f32_16x16x64_bf16 v[68:71], v[56:59], a[104:111], v23
  v_smfmac_f32_16x16x64_bf16 v[72:75], v[56:59], a[112:119], v23
  v_smfmac_f32_16x16x64_bf16 v[76:79], v[56:59], a[120:127], v23
  s_cbranch_vccnz SL_m_f3
  v_smfmac_f32_16x16x64_bf16 v[64:67], v[60:63], a[144:151], v23
  v_smfmac_f32_16x16x64_bf16 v[68:71], v[60:63], a[152:159], v23
  v_smfmac_f32_16x16x64_bf16 v[72:75], v[60:63], a[160:167], v23
  v_smfmac_f32_16x16x64_bf16 v[76:79], v[60:63], a[168:175], v23
SL_m_done:
  s_nop 4
  v_pk_add_f32 v[88:89], v[64:65], v[66:67]
  v_pk_add_f32 v[90:91], v[68:69], v[70:71]
  ds_write_b128 v4, v[88:91] offset:0
  v_pk_add_f32 v[92:93], v[72:73], v[74:75]
  v_pk_add_f32 v[94:95], v[76:77], v[78:79]
  ds_write_b128 v4, v[92:95] offset:1088
  v_smfmac_f32_16x16x64_bf16 v[80:83], v[48:51], a[32:39], v23
  buffer_load_dwordx4 v[180:183], v12, s[4:7], s44 offen offset:0
  v_mov_b32 v36, 0
  v_smfmac_f32_16x16x64_bf16 v[84:87], v[48:51], a[40:47], v23
  buffer_load_dwordx4 v[184:187], v12, s[4:7], s44 offen offset:128
  v_mov_b32 v37, 0
  v_smfmac_f32_16x16x64_bf16 v[80:83], v[52:55], a[80:87], v23
  buffer_load_dwordx4 v[188:191], v12, s[4:7], s44 offen offset:1024
  v_mov_b32 v38, 0
  v_smfmac_f32_16x16x64_bf16 v[84:87], v[52:55], a[88:95], v23
  buffer_load_dwordx4 v[192:195], v12, s[4:7], s44 offen offset:1152
  v_mov_b32 v39, 0
  v_smfmac_f32_16x16x64_bf16 v[80:83], v[56:59], a[128:135], v23
  buffer_load_dwordx4 v[196:199], v13, s[4:7], s44 offen offset:0
  v_mov_b32 v40, 0
  s_waitcnt lgkmcnt(0)
  s_barrier
  ds_read2_b32 v[100:101], v6 offset0:0 offset1:2
  ds_read2_b32 v[102:103], v240 offset0:0 offset1:2
  ds_read2_b32 v[104:105], v241 offset0:0 offset1:2
  ds_read2_b32 v[106:107], v242 offset0:0 offset1:2
  v_smfmac_f32_16x16x64_bf16 v[84:87], v[56:59], a[136:143], v23
  v_mov_b32 v41, 0
  v_smfmac_f32_16x16x64_bf16 v[80:83], v[60:63], a[176:183], v23
  v_mov_b32 v42, 0
  v_smfmac_f32_16x16x64_bf16 v[84:87], v[60:63], a[184:191], v23
  v_mov_b32 v43, 0
  v_mov_b32 v44, 0
  v_mov_b32 v45, 0
  v_mov_b32 v46, 0
  v_mov_b32 v47, 0
  s_waitcnt lgkmcnt(2)
  v_pk_add_f32 v[100:101], v[100:101], v[102:103]
  s_waitcnt lgkmcnt(0)
  v_pk_add_f32 v[104:105], v[104:105], v[106:107]
  v_pk_add_f32 v[100:101], v[100:101], v[104:105]
  v_cvt_pk_bf16_f32 v112, v100, v101
  v_min_u32 v112, s54, v112
  buffer_store_dword v112, v7, s[4:7], s41 offen sc1
  v_pk_add_f32 v[96:97], v[80:81], v[82:83]
  v_pk_add_f32 v[98:99], v[84:85], v[86:87]
  ds_write_b128 v4, v[96:99] offset:2176
  v_mov_b64 v[212:213], 0
  v_mov_b64 v[214:215], 0
  v_mov_b64 v[216:217], 0
  v_mov_b64 v[218:219], 0
  v_mov_b64 v[220:221], 0
  v_mov_b64 v[222:223], 0
  v_mov_b64 v[224:225], 0
  v_mov_b64 v[226:227], 0
  v_mov_b64 v[228:229], 0
  v_mov_b64 v[230:231], 0
  s_waitcnt lgkmcnt(0)
  s_barrier
  ds_read_b64 v[88:89], v5 offset:0
  buffer_load_dwordx4 v[64:67], v9, s[4:7], s41 offen offset:0 sc1
  s_mov_b32 s42, s41
  s_add_u32 s90, s40, 1
  ds_read_b64 v[90:91], v5 offset:3264
  buffer_load_dwordx4 v[68:71], v9, s[4:7], s41 offen offset:1024 sc1
  s_and_b32 s90, s90, 3
  s_lshl_b32 s90, s90, 19
  ds_read_b64 v[92:93], v5 offset:6528
  buffer_load_dwordx4 v[72:75], v9, s[4:7], s41 offen offset:2048 sc1
  s_add_u32 s91, s90, 0x3800000
  s_add_u32 s55, s55, 0x40000
  ds_read_b64 v[94:95], v5 offset:9792
  buffer_load_dwordx4 v[76:79], v9, s[4:7], s41 offen offset:3072 sc1
  s_min_u32 s55, s55, 0xfc0000
  s_nop 0
  s_waitcnt lgkmcnt(2)
  v_pk_add_f32 v[88:89], v[88:89], v[90:91]
  s_waitcnt lgkmcnt(0)
  v_pk_add_f32 v[92:93], v[92:93], v[94:95]
  v_pk_add_f32 v[88:89], v[88:89], v[92:93]
  v_cvt_pk_bf16_f32 v113, v88, v89
  v_min_u32 v113, s54, v113
  buffer_store_dword v113, v8, s[4:7], s41 offen sc1
  s_add_u32 s8, s94, s55
  s_addc_u32 s9, s95, 0
  s_add_u32 s8, s8, s12
  s_addc_u32 s9, s9, 0
  s_add_u32 s10, s8, 0x1000000
  s_addc_u32 s11, s9, 0
  s_load_dword s16, s[8:9], 0
  s_load_dword s17, s[10:11], 0
  s_load_dword s18, s[8:9], 64
  s_load_dword s19, s[10:11], 64
  s_load_dword s20, s[8:9], 128
  s_load_dword s21, s[10:11], 128
  s_load_dword s22, s[8:9], 192
  s_load_dword s23, s[10:11], 192
  s_cmp_eq_u32 s40, 63
  s_cbranch_scc1 SL_last
  s_waitcnt vmcnt(4)
  v_max3_u32 v31, v64, v65, v66
  v_max_u32 v31, v31, v67
  v_cmp_eq_u32 vcc, -1, v31
  s_cbranch_vccnz SL_x_f0
  v_mfma_f32_16x16x32_bf16 v[44:47], v[64:67], v[64:67], v[44:47]
  s_waitcnt vmcnt(3)
  v_max3_u32 v31, v68, v69, v70
  v_max_u32 v31, v31, v71
  v_cmp_eq_u32 vcc, -1, v31
  v_mfma_f32_16x16x32_bf16 v[36:39], v[116:119], v[64:67], v[36:39]
  v_mfma_f32_16x16x32_bf16 v[40:43], v[132:135], v[64:67], v[40:43]
  s_cbranch_vccnz SL_x_f1
  v_mfma_f32_16x16x32_bf16 v[44:47], v[68:71], v[68:71], v[44:47]
  s_waitcnt vmcnt(2)
  v_max3_u32 v31, v72, v73, v74
  v_max_u32 v31, v31, v75
  v_cmp_eq_u32 vcc, -1, v31
  v_mfma_f32_16x16x32_bf16 v[36:39], v[120:123], v[68:71], v[36:39]
  v_mfma_f32_16x16x32_bf16 v[40:43], v[136:139], v[68:71], v[40:43]
  s_cbranch_vccnz SL_x_f2
  v_mfma_f32_16x16x32_bf16 v[44:47], v[72:75], v[72:75], v[44:47]
  s_waitcnt vmcnt(1)
  v_max3_u32 v31, v76, v77, v78
  v_max_u32 v31, v31, v79
  v_cmp_eq_u32 vcc, -1, v31
  v_mfma_f32_16x16x32_bf16 v[36:39], v[124:127], v[72:75], v[36:39]
  v_mfma_f32_16x16x32_bf16 v[40:43], v[140:143], v[72:75], v[40:43]
  s_cbranch_vccnz SL_x_f3
  v_mfma_f32_16x16x32_bf16 v[44:47], v[76:79], v[76:79], v[44:47]
  v_mfma_f32_16x16x32_bf16 v[36:39], v[128:131], v[76:79], v[36:39]
  v_mfma_f32_16x16x32_bf16 v[40:43], v[144:147], v[76:79], v[40:43]
SL_x_done:
  buffer_load_dwordx4 v[88:91], v10, s[4:7], s41 offen offset:0 sc1
  buffer_load_dwordx4 v[92:95], v10, s[4:7], s41 offen offset:1024 sc1
  s_mov_b64 vcc, s[48:49]
  s_nop 2
  v_max_f32 v30, v46, v47
  s_nop 0
  v_cndmask_b32_dpp v96, v40, v36, vcc quad_perm:[0,1,0,1] row_mask:0xf bank_mask:0xf
  v_cndmask_b32_dpp v97, v41, v37, vcc quad_perm:[0,1,0,1] row_mask:0xf bank_mask:0xf
  v_cndmask_b32_dpp v98, v42, v38, vcc quad_perm:[0,1,0,1] row_mask:0xf bank_mask:0xf
  v_cndmask_b32_dpp v99, v43, v39, vcc quad_perm:[0,1,0,1] row_mask:0xf bank_mask:0xf
  v_max3_f32 v29, v96, v97, v98
  s_nop 0
  v_max_f32_dpp v28, v30, v99 quad_perm:[0,1,0,1] row_mask:0xf bank_mask:0xf
  v_max_f32 v29, v29, v28
  s_nop 1
  v_max_f32_dpp v28, v29, v29 quad_perm:[2,3,0,1] row_mask:0xf bank_mask:0xf
  v_mov_b32 v29, v28
  s_nop 1
  v_permlane32_swap_b32 v28, v29
  v_max_f32 v28, v28, v29
  v_mov_b32 v29, v28
  s_nop 1
  v_permlane16_swap_b32 v28, v29
  v_max_f32 v28, v28, v29
  v_mul_f32 v28, s47, v28
  v_fma_f32 v96, v96, s47, -v28
  v_fma_f32 v97, v97, s47, -v28
  v_fma_f32 v98, v98, s47, -v28
  v_fma_f32 v99, v99, s47, -v28
  v_fma_f32 v46, v46, s47, -v28
  v_fma_f32 v47, v47, s47, -v28
  v_exp_f32 v96, v96
  v_exp_f32 v97, v97
  v_exp_f32 v98, v98
  v_exp_f32 v99, v99
  v_cvt_pk_bf16_f32 v236, v96, v97
  v_cvt_pk_bf16_f32 v237, v98, v99
  v_exp_f32 v46, v46
  v_mov_b32_dpp v100, v236 quad_perm:[0,1,0,1] row_mask:0xf bank_mask:0xf
  v_mov_b32_dpp v102, v236 quad_perm:[2,3,2,3] row_mask:0xf bank_mask:0xf
  v_mov_b32_dpp v101, v237 quad_perm:[0,1,0,1] row_mask:0xf bank_mask:0xf
  v_mov_b32_dpp v103, v237 quad_perm:[2,3,2,3] row_mask:0xf bank_mask:0xf
  v_exp_f32 v47, v47
  s_nop 0
  v_smfmac_f32_16x16x64_bf16 v[228:231], v[100:103], v[248:255], v23
  v_cvt_pk_bf16_f32 v238, v46, v47
  buffer_load_dwordx4 v[116:119], v11, s[4:7], s44 offen offset:0
  v_smfmac_f32_16x16x64_bf16 v[212:215], v[100:103], v[148:155], v23
  buffer_load_dwordx4 v[132:135], v11, s[4:7], s44 offen offset:64
  v_mov_b32_dpp v232, v238 quad_perm:[0,1,0,1] row_mask:0xf bank_mask:0xf
  v_smfmac_f32_16x16x64_bf16 v[216:219], v[100:103], v[156:163], v23
  buffer_load_dwordx4 v[120:123], v11, s[4:7], s44 offen offset:1024
  v_mov_b32_dpp v235, v238 quad_perm:[0,1,0,1] row_mask:0xf bank_mask:0xf
  v_smfmac_f32_16x16x64_bf16 v[220:223], v[100:103], v[164:171], v23
  buffer_load_dwordx4 v[136:139], v11, s[4:7], s44 offen offset:1088
  s_waitcnt vmcnt(4)
  v_max3_u32 v31, v88, v89, v90
  v_max3_u32 v31, v31, v91, v92
  v_smfmac_f32_16x16x32_bf16 v[228:231], v[232:233], v[248:251], v23
  v_max3_u32 v31, v31, v93, v94
  v_max_u32 v31, v31, v95
  v_cmp_eq_u32 vcc, -1, v31
  v_smfmac_f32_16x16x64_bf16 v[224:227], v[100:103], v[172:179], v23
  s_cbranch_vccnz SL_v_f
SL_v_ok:
  v_smfmac_f32_16x16x32_bf16 v[212:215], v[232:233], v[88:91], v23
  buffer_load_dwordx4 v[124:127], v11, s[4:7], s44 offen offset:2048
  buffer_load_dwordx4 v[140:143], v11, s[4:7], s44 offen offset:2112
  v_smfmac_f32_16x16x32_bf16 v[216:219], v[234:235], v[88:91], v23
  v_rcp_f32 v28, v228
  v_smfmac_f32_16x16x32_bf16 v[220:223], v[232:233], v[92:95], v23
  v_rcp_f32 v29, v229
  v_smfmac_f32_16x16x32_bf16 v[224:227], v[234:235], v[92:95], v23
  s_nop 0
  v_pk_mul_f32 v[212:213], v[212:213], v[28:29]
  v_pk_mul_f32 v[214:215], v[214:215], v[28:29]
  v_cvt_pk_bf16_f32 v104, v212, v214
  v_cvt_pk_bf16_f32 v108, v213, v215
  v_pk_mul_f32 v[216:217], v[216:217], v[28:29]
  v_pk_mul_f32 v[218:219], v[218:219], v[28:29]
  v_cvt_pk_bf16_f32 v105, v216, v218
  v_cvt_pk_bf16_f32 v109, v217, v219
  v_pk_mul_f32 v[220:221], v[220:221], v[28:29]
  v_pk_mul_f32 v[222:223], v[222:223], v[28:29]
  v_cvt_pk_bf16_f32 v106, v220, v222
  v_cvt_pk_bf16_f32 v110, v221, v223
  v_pk_mul_f32 v[224:225], v[224:225], v[28:29]
  v_pk_mul_f32 v[226:227], v[226:227], v[28:29]
  v_cvt_pk_bf16_f32 v107, v224, v226
  v_cvt_pk_bf16_f32 v111, v225, v227
  ds_write_b128 v14, v[104:107]
  ds_write_b128 v15, v[108:111]
  s_add_u32 s92, s40, 3
  s_min_u32 s92, s92, 63
  s_lshr_b32 s92, s92, 2
  s_lshl_b32 s92, s92, 9
  v_mov_b32 v246, s40
  s_waitcnt lgkmcnt(0)
  s_barrier
  ds_read_b128 v[48:51], v16 offset:0
  ds_read_b128 v[52:55], v16 offset:1024
  ds_read_b128 v[56:59], v16 offset:2048
  ds_read_b128 v[60:63], v16 offset:3072
  ds_read_b128 v[64:67], v16 offset:4096
  buffer_store_dword v22, v17, s[4:7], s43 offen sc1
  buffer_store_dword v112, v19, s[4:7], s45 offen sc1
  s_waitcnt lgkmcnt(4)
  v_smfmac_f32_16x16x64_bf16 v[32:35], v[48:51], a[192:199], v23
  ds_read_b128 v[68:71], v16 offset:5120
  buffer_store_dword v113, v20, s[4:7], s45 offen sc1
  s_waitcnt lgkmcnt(4)
  v_smfmac_f32_16x16x64_bf16 v[32:35], v[52:55], a[200:207], v23
  ds_read_b128 v[72:75], v16 offset:6144
  buffer_store_dword v246, v245, s[4:7], 0 offen sc1
  s_waitcnt lgkmcnt(4)
  v_smfmac_f32_16x16x64_bf16 v[32:35], v[56:59], a[208:215], v23
  ds_read_b128 v[76:79], v16 offset:7168
  buffer_load_dword v243, v244, s[4:7], s92 offen sc1
  s_waitcnt lgkmcnt(4)
  v_smfmac_f32_16x16x64_bf16 v[32:35], v[60:63], a[216:223], v23
  s_mov_b32 s13, s43
  s_waitcnt lgkmcnt(3)
  v_smfmac_f32_16x16x64_bf16 v[32:35], v[64:67], a[224:231], v23
  s_add_u32 s40, s40, 1
  s_waitcnt lgkmcnt(2)
  v_smfmac_f32_16x16x64_bf16 v[32:35], v[68:71], a[232:239], v23
  s_mov_b32 s41, s91
  s_waitcnt lgkmcnt(1)
  v_smfmac_f32_16x16x64_bf16 v[32:35], v[72:75], a[240:247], v23
  s_xor_b32 s43, s91, 0x100000
  s_waitcnt lgkmcnt(0)
  v_smfmac_f32_16x16x64_bf16 v[32:35], v[76:79], a[248:255], v23
  s_nop 7
  v_pk_add_f32 v[28:29], v[32:33], v[34:35]
  v_cvt_pk_bf16_f32 v28, v28, v29
  v_min_u32 v28, s54, v28
  buffer_store_dword v28, v17, s[4:7], s42 offen sc1
  buffer_store_dword v28, v18, s[4:7], s42 offen sc1
  s_branch SL_step
SL_last:
  buffer_store_dword v112, v19, s[4:7], s45 offen sc1
  buffer_store_dword v113, v20, s[4:7], s45 offen sc1
  s_waitcnt vmcnt(0)
  s_barrier
  s_lshl_b32 s90, s35, 7
  s_add_u32 s90, s90, 0x3d01000
  s_cmp_lg_u32 s32, 0
  s_cbranch_scc1 SL_sig_6
  v_mov_b32 v254, 1
  v_mov_b32 v255, 0
  s_mov_b64 exec, 1
  buffer_atomic_add v254, v255, s[4:7], s90 offen offset:0 sc1
  s_mov_b64 exec, -1
SL_sig_6:
  s_waitcnt vmcnt(0)
  s_branch L_join
SL_kv_f:
  s_sleep 8
  buffer_load_dword v243, v244, s[4:7], s92 offen sc1
  s_add_u32 s46, s46, 1
  s_cmp_ge_u32 s46, 131072
  s_cbranch_scc1 SL_rec_abort
  s_waitcnt vmcnt(0)
  s_branch SL_kv_chk
SL_g_f:
  s_mov_b64 exec, vcc
  buffer_load_dwordx4 v[36:39], v1, s[4:7], s42 offen sc1
  s_mov_b64 exec, -1
  s_add_u32 s46, s46, 1
  s_cmp_ge_u32 s46, 131072
  s_cbranch_scc1 SL_rec_abort
  s_waitcnt vmcnt(0)
  s_branch SL_g_chk
SL_m_f0:
  s_mov_b64 exec, vcc
  buffer_load_dwordx4 v[48:51], v3, s[4:7], s41 offen offset:0 sc1
  s_mov_b64 exec, -1
  s_waitcnt vmcnt(1)
  s_branch SL_m_0123_c1
SL_m_f1:
  s_mov_b64 exec, vcc
  buffer_load_dwordx4 v[52:55], v3, s[4:7], s41 offen offset:1024 sc1
  s_mov_b64 exec, -1
  s_waitcnt vmcnt(1)
  s_branch SL_m_123_c2
SL_m_f2:
  s_mov_b64 exec, vcc
  buffer_load_dwordx4 v[56:59], v3, s[4:7], s41 offen offset:2048 sc1
  s_mov_b64 exec, -1
  s_waitcnt vmcnt(1)
  s_branch SL_m_23_c3
SL_m_f3:
  s_mov_b64 exec, vcc
  buffer_load_dwordx4 v[60:63], v3, s[4:7], s41 offen offset:3072 sc1
  s_mov_b64 exec, -1
  s_nop 7
  s_branch SL_m_3_c3
SL_m_0_c0:
  v_max3_u32 v31, v48, v49, v50
  v_max_u32 v31, v31, v51
  v_cmp_eq_u32 vcc, -1, v31
  s_cbranch_vccz SL_m_0_ok0
SL_m_0_x0:
  s_mov_b64 exec, vcc
  buffer_load_dwordx4 v[48:51], v3, s[4:7], s41 offen offset:0 sc1
  s_mov_b64 exec, -1
  s_add_u32 s46, s46, 1
  s_cmp_ge_u32 s46, 131072
  s_cbranch_scc1 SL_rec_abort
  s_waitcnt vmcnt(2)
  s_branch SL_m_0_c0
SL_m_0_ok0:
  v_smfmac_f32_16x16x64_bf16 v[64:67], v[48:51], a[0:7], v23
  v_smfmac_f32_16x16x64_bf16 v[68:71], v[48:51], a[8:15], v23
  v_smfmac_f32_16x16x64_bf16 v[72:75], v[48:51], a[16:23], v23
  v_smfmac_f32_16x16x64_bf16 v[76:79], v[48:51], a[24:31], v23
  s_branch SL_m_done
SL_m_1_c1:
  v_max3_u32 v31, v52, v53, v54
  v_max_u32 v31, v31, v55
  v_cmp_eq_u32 vcc, -1, v31
  s_cbranch_vccz SL_m_1_ok1
SL_m_1_x1:
  s_mov_b64 exec, vcc
  buffer_load_dwordx4 v[52:55], v3, s[4:7], s41 offen offset:1024 sc1
  s_mov_b64 exec, -1
  s_add_u32 s46, s46, 1
  s_cmp_ge_u32 s46, 131072
  s_cbranch_scc1 SL_rec_abort
  s_waitcnt vmcnt(2)
  s_branch SL_m_1_c1
SL_m_1_ok1:
  v_smfmac_f32_16x16x64_bf16 v[64:67], v[52:55], a[48:55], v23
  v_smfmac_f32_16x16x64_bf16 v[68:71], v[52:55], a[56:63], v23
  v_smfmac_f32_16x16x64_bf16 v[72:75], v[52:55], a[64:71], v23
  v_smfmac_f32_16x16x64_bf16 v[76:79], v[52:55], a[72:79], v23
  s_branch SL_m_done
SL_m_2_c2:
  v_max3_u32 v31, v56, v57, v58
  v_max_u32 v31, v31, v59
  v_cmp_eq_u32 vcc, -1, v31
  s_cbranch_vccz SL_m_2_ok2
SL_m_2_x2:
  s_mov_b64 exec, vcc
  buffer_load_dwordx4 v[56:59], v3, s[4:7], s41 offen offset:2048 sc1
  s_mov_b64 exec, -1
  s_add_u32 s46, s46, 1
  s_cmp_ge_u32 s46, 131072
  s_cbranch_scc1 SL_rec_abort
  s_waitcnt vmcnt(2)
  s_branch SL_m_2_c2
SL_m_2_ok2:
  v_smfmac_f32_16x16x64_bf16 v[64:67], v[56:59], a[96:103], v23
  v_smfmac_f32_16x16x64_bf16 v[68:71], v[56:59], a[104:111], v23
  v_smfmac_f32_16x16x64_bf16 v[72:75], v[56:59], a[112:119], v23
  v_smfmac_f32_16x16x64_bf16 v[76:79], v[56:59], a[120:127], v23
  s_branch SL_m_done
SL_m_3_c3:
  v_max3_u32 v31, v60, v61, v62
  v_max_u32 v31, v31, v63
  v_cmp_eq_u32 vcc, -1, v31
  s_cbranch_vccz SL_m_3_ok3
SL_m_3_x3:
  s_mov_b64 exec, vcc
  buffer_load_dwordx4 v[60:63], v3, s[4:7], s41 offen offset:3072 sc1
  s_mov_b64 exec, -1
  s_add_u32 s46, s46, 1
  s_cmp_ge_u32 s46, 131072
  s_cbranch_scc1 SL_rec_abort
  s_waitcnt vmcnt(2)
  s_branch SL_m_3_c3
SL_m_3_ok3:
  v_smfmac_f32_16x16x64_bf16 v[64:67], v[60:63], a[144:151], v23
  v_smfmac_f32_16x16x64_bf16 v[68:71], v[60:63], a[152:159], v23
  v_smfmac_f32_16x16x64_bf16 v[72:75], v[60:63], a[160:167], v23
  v_smfmac_f32_16x16x64_bf16 v[76:79], v[60:63], a[168:175], v23
  s_branch SL_m_done
SL_m_01_c0:
  v_max3_u32 v31, v48, v49, v50
  v_max_u32 v31, v31, v51
  v_cmp_eq_u32 vcc, -1, v31
  s_cbranch_vccz SL_m_01_ok0
SL_m_01_x0:
  s_mov_b64 exec, vcc
  buffer_load_dwordx4 v[48:51], v3, s[4:7], s41 offen offset:0 sc1
  s_mov_b64 exec, -1
SL_m_01_c1:
  v_max3_u32 v31, v52, v53, v54
  v_max_u32 v31, v31, v55
  v_cmp_eq_u32 vcc, -1, v31
  s_cbranch_vccz SL_m_01_ok1
SL_m_01_x1:
  s_mov_b64 exec, vcc
  buffer_load_dwordx4 v[52:55], v3, s[4:7], s41 offen offset:1024 sc1
  s_mov_b64 exec, -1
  s_add_u32 s46, s46, 1
  s_cmp_ge_u32 s46, 131072
  s_cbranch_scc1 SL_rec_abort
  s_waitcnt vmcnt(4)
  s_branch SL_m_01_c0
SL_m_01_ok0:
  v_smfmac_f32_16x16x64_bf16 v[64:67], v[48:51], a[0:7], v23
  v_max3_u32 v31, v52, v53, v54
  v_max_u32 v31, v31, v55
  v_cmp_eq_u32 vcc, -1, v31
  v_smfmac_f32_16x16x64_bf16 v[68:71], v[48:51], a[8:15], v23
  v_smfmac_f32_16x16x64_bf16 v[72:75], v[48:51], a[16:23], v23
  v_smfmac_f32_16x16x64_bf16 v[76:79], v[48:51], a[24:31], v23
  s_cbranch_vccz SL_m_1_ok1
  s_branch SL_m_1_x1
SL_m_01_ok1:
  v_smfmac_f32_16x16x64_bf16 v[64:67], v[52:55], a[48:55], v23
  v_max3_u32 v31, v48, v49, v50
  v_max_u32 v31, v31, v51
  v_cmp_eq_u32 vcc, -1, v31
  v_smfmac_f32_16x16x64_bf16 v[68:71], v[52:55], a[56:63], v23
  v_smfmac_f32_16x16x64_bf16 v[72:75], v[52:55], a[64:71], v23
  v_smfmac_f32_16x16x64_bf16 v[76:79], v[52:55], a[72:79], v23
  s_cbranch_vccz SL_m_0_ok0
  s_branch SL_m_0_x0
SL_m_02_c0:
  v_max3_u32 v31, v48, v49, v50
  v_max_u32 v31, v31, v51
  v_cmp_eq_u32 vcc, -1, v31
  s_cbranch_vccz SL_m_02_ok0
SL_m_02_x0:
  s_mov_b64 exec, vcc
  buffer_load_dwordx4 v[48:51], v3, s[4:7], s41 offen offset:0 sc1
  s_mov_b64 exec, -1
SL_m_02_c2:
  v_max3_u32 v31, v56, v57, v58
  v_max_u32 v31, v31, v59
  v_cmp_eq_u32 vcc, -1, v31
  s_cbranch_vccz SL_m_02_ok2
SL_m_02_x2:
  s_mov_b64 exec, vcc
  buffer_load_dwordx4 v[56:59], v3, s[4:7], s41 offen offset:2048 sc1
  s_mov_b64 exec, -1
  s_add_u32 s46, s46, 1
  s_cmp_ge_u32 s46, 131072
  s_cbranch_scc1 SL_rec_abort
  s_waitcnt vmcnt(4)
  s_branch SL_m_02_c0
SL_m_02_ok0:
  v_smfmac_f32_16x16x64_bf16 v[64:67], v[48:51], a[0:7], v23
  v_max3_u32 v31, v56, v57, v58
  v_max_u32 v31, v31, v59
  v_cmp_eq_u32 vcc, -1, v31
  v_smfmac_f32_16x16x64_bf16 v[68:71], v[48:51], a[8:15], v23
  v_smfmac_f32_16x16x64_bf16 v[72:75], v[48:51], a[16:23], v23
  v_smfmac_f32_16x16x64_bf16 v[76:79], v[48:51], a[24:31], v23
  s_cbranch_vccz SL_m_2_ok2
  s_branch SL_m_2_x2
SL_m_02_ok2:
  v_smfmac_f32_16x16x64_bf16 v[64:67], v[56:59], a[96:103], v23
  v_max3_u32 v31, v48, v49, v50
  v_max_u32 v31, v31, v51
  v_cmp_eq_u32 vcc, -1, v31
  v_smfmac_f32_16x16x64_bf16 v[68:71], v[56:59], a[104:111], v23
  v_smfmac_f32_16x16x64_bf16 v[72:75], v[56:59], a[112:119], v23
  v_smfmac_f32_16x16x64_bf16 v[76:79], v[56:59], a[120:127], v23
  s_cbranch_vccz SL_m_0_ok0
  s_branch SL_m_0_x0
SL_m_03_c0:
  v_max3_u32 v31, v48, v49, v50
  v_max_u32 v31, v31, v51
  v_cmp_eq_u32 vcc, -1, v31
  s_cbranch_vccz SL_m_03_ok0
SL_m_03_x0:
  s_mov_b64 exec, vcc
  buffer_load_dwordx4 v[48:51], v3, s[4:7], s41 offen offset:0 sc1
  s_mov_b64 exec, -1
SL_m_03_c3:
  v_max3_u32 v31, v60, v61, v62
  v_max_u32 v31, v31, v63
  v_cmp_eq_u32 vcc, -1, v31
  s_cbranch_vccz SL_m_03_ok3
SL_m_03_x3:
  s_mov_b64 exec, vcc
  buffer_load_dwordx4 v[60:63], v3, s[4:7], s41 offen offset:3072 sc1
  s_mov_b64 exec, -1
  s_add_u32 s46, s46, 1
  s_cmp_ge_u32 s46, 131072
  s_cbranch_scc1 SL_rec_abort
  s_waitcnt vmcnt(4)
  s_branch SL_m_03_c0
SL_m_03_ok0:
  v_smfmac_f32_16x16x64_bf16 v[64:67], v[48:51], a[0:7], v23
  v_max3_u32 v31, v60, v61, v62
  v_max_u32 v31, v31, v63
  v_cmp_eq_u32 vcc, -1, v31
  v_smfmac_f32_16x16x64_bf16 v[68:71], v[48:51], a[8:15], v23
  v_smfmac_f32_16x16x64_bf16 v[72:75], v[48:51], a[16:23], v23
  v_smfmac_f32_16x16x64_bf16 v[76:79], v[48:51], a[24:31], v23
  s_cbranch_vccz SL_m_3_ok3
  s_branch SL_m_3_x3
SL_m_03_ok3:
  v_smfmac_f32_16x16x64_bf16 v[64:67], v[60:63], a[144:151], v23
  v_max3_u32 v31, v48, v49, v50
  v_max_u32 v31, v31, v51
  v_cmp_eq_u32 vcc, -1, v31
  v_smfmac_f32_16x16x64_bf16 v[68:71], v[60:63], a[152:159], v23
  v_smfmac_f32_16x16x64_bf16 v[72:75], v[60:63], a[160:167], v23
  v_smfmac_f32_16x16x64_bf16 v[76:79], v[60:63], a[168:175], v23
  s_cbranch_vccz SL_m_0_ok0
  s_branch SL_m_0_x0
SL_m_12_c1:
  v_max3_u32 v31, v52, v53, v54
  v_max_u32 v31, v31, v55
  v_cmp_eq_u32 vcc, -1, v31
  s_cbranch_vccz SL_m_12_ok1
SL_m_12_x1:
  s_mov_b64 exec, vcc
  buffer_load_dwordx4 v[52:55], v3, s[4:7], s41 offen offset:1024 sc1
  s_mov_b64 exec, -1
SL_m_12_c2:
  v_max3_u32 v31, v56, v57, v58
  v_max_u32 v31, v31, v59
  v_cmp_eq_u32 vcc, -1, v31
  s_cbranch_vccz SL_m_12_ok2
SL_m_12_x2:
  s_mov_b64 exec, vcc
  buffer_load_dwordx4 v[56:59], v3, s[4:7], s41 offen offset:2048 sc1
  s_mov_b64 exec, -1
  s_add_u32 s46, s46, 1
  s_cmp_ge_u32 s46, 131072
  s_cbranch_scc1 SL_rec_abort
  s_waitcnt vmcnt(4)
  s_branch SL_m_12_c1
SL_m_12_ok1:
  v_smfmac_f32_16x16x64_bf16 v[64:67], v[52:55], a[48:55], v23
  v_max3_u32 v31, v56, v57, v58
  v_max_u32 v31, v31, v59
  v_cmp_eq_u32 vcc, -1, v31
  v_smfmac_f32_16x16x64_bf16 v[68:71], v[52:55], a[56:63], v23
  v_smfmac_f32_16x16x64_bf16 v[72:75], v[52:55], a[64:71], v23
  v_smfmac_f32_16x16x64_bf16 v[76:79], v[52:55], a[72:79], v23
  s_cbranch_vccz SL_m_2_ok2
  s_branch SL_m_2_x2
SL_m_12_ok2:
  v_smfmac_f32_16x16x64_bf16 v[64:67], v[56:59], a[96:103], v23
  v_max3_u32 v31, v52, v53, v54
  v_max_u32 v31, v31, v55
  v_cmp_eq_u32 vcc, -1, v31
  v_smfmac_f32_16x16x64_bf16 v[68:71], v[56:59], a[104:111], v23
  v_smfmac_f32_16x16x64_bf16 v[72:75], v[56:59], a[112:119], v23
  v_smfmac_f32_16x16x64_bf16 v[76:79], v[56:59], a[120:127], v23
  s_cbranch_vccz SL_m_1_ok1
  s_branch SL_m_1_x1
SL_m_13_c1:
  v_max3_u32 v31, v52, v53, v54
  v_max_u32 v31, v31, v55
  v_cmp_eq_u32 vcc, -1, v31
  s_cbranch_vccz SL_m_13_ok1
SL_m_13_x1:
  s_mov_b64 exec, vcc
  buffer_load_dwordx4 v[52:55], v3, s[4:7], s41 offen offset:1024 sc1
  s_mov_b64 exec, -1
SL_m_13_c3:
  v_max3_u32 v31, v60, v61, v62
  v_max_u32 v31, v31, v63
  v_cmp_eq_u32 vcc, -1, v31
  s_cbranch_vccz SL_m_13_ok3
SL_m_13_x3:
  s_mov_b64 exec, vcc
  buffer_load_dwordx4 v[60:63], v3, s[4:7], s41 offen offset:3072 sc1
  s_mov_b64 exec, -1
  s_add_u32 s46, s46, 1
  s_cmp_ge_u32 s46, 131072
  s_cbranch_scc1 SL_rec_abort
  s_waitcnt vmcnt(4)
  s_branch SL_m_13_c1
SL_m_13_ok1:
  v_smfmac_f32_16x16x64_bf16 v[64:67], v[52:55], a[48:55], v23
  v_max3_u32 v31, v60, v61, v62
  v_max_u32 v31, v31, v63
  v_cmp_eq_u32 vcc, -1, v31
  v_smfmac_f32_16x16x64_bf16 v[68:71], v[52:55], a[56:63], v23
  v_smfmac_f32_16x16x64_bf16 v[72:75], v[52:55], a[64:71], v23
  v_smfmac_f32_16x16x64_bf16 v[76:79], v[52:55], a[72:79], v23
  s_cbranch_vccz SL_m_3_ok3
  s_branch SL_m_3_x3
SL_m_13_ok3:
  v_smfmac_f32_16x16x64_bf16 v[64:67], v[60:63], a[144:151], v23
  v_max3_u32 v31, v52, v53, v54
  v_max_u32 v31, v31, v55
  v_cmp_eq_u32 vcc, -1, v31
  v_smfmac_f32_16x16x64_bf16 v[68:71], v[60:63], a[152:159], v23
  v_smfmac_f32_16x16x64_bf16 v[72:75], v[60:63], a[160:167], v23
  v_smfmac_f32_16x16x64_bf16 v[76:79], v[60:63], a[168:175], v23
  s_cbranch_vccz SL_m_1_ok1
  s_branch SL_m_1_x1
SL_m_23_c2:
  v_max3_u32 v31, v56, v57, v58
  v_max_u32 v31, v31, v59
  v_cmp_eq_u32 vcc, -1, v31
  s_cbranch_vccz SL_m_23_ok2
SL_m_23_x2:
  s_mov_b64 exec, vcc
  buffer_load_dwordx4 v[56:59], v3, s[4:7], s41 offen offset:2048 sc1
  s_mov_b64 exec, -1
SL_m_23_c3:
  v_max3_u32 v31, v60, v61, v62
  v_max_u32 v31, v31, v63
  v_cmp_eq_u32 vcc, -1, v31
  s_cbranch_vccz SL_m_23_ok3
SL_m_23_x3:
  s_mov_b64 exec, vcc
  buffer_load_dwordx4 v[60:63], v3, s[4:7], s41 offen offset:3072 sc1
  s_mov_b64 exec, -1
  s_add_u32 s46, s46, 1
  s_cmp_ge_u32 s46, 131072
  s_cbranch_scc1 SL_rec_abort
  s_waitcnt vmcnt(4)
  s_branch SL_m_23_c2
SL_m_23_ok2:
  v_smfmac_f32_16x16x64_bf16 v[64:67], v[56:59], a[96:103], v23
  v_max3_u32 v31, v60, v61, v62
  v_max_u32 v31, v31, v63
  v_cmp_eq_u32 vcc, -1, v31
  v_smfmac_f32_16x16x64_bf16 v[68:71], v[56:59], a[104:111], v23
  v_smfmac_f32_16x16x64_bf16 v[72:75], v[56:59], a[112:119], v23
  v_smfmac_f32_16x16x64_bf16 v[76:79], v[56:59], a[120:127], v23
  s_cbranch_vccz SL_m_3_ok3
  s_branch SL_m_3_x3
SL_m_23_ok3:
  v_smfmac_f32_16x16x64_bf16 v[64:67], v[60:63], a[144:151], v23
  v_max3_u32 v31, v56, v57, v58
  v_max_u32 v31, v31, v59
  v_cmp_eq_u32 vcc, -1, v31
  v_smfmac_f32_16x16x64_bf16 v[68:71], v[60:63], a[152:159], v23
  v_smfmac_f32_16x16x64_bf16 v[72:75], v[60:63], a[160:167], v23
  v_smfmac_f32_16x16x64_bf16 v[76:79], v[60:63], a[168:175], v23
  s_cbranch_vccz SL_m_2_ok2
  s_branch SL_m_2_x2
SL_m_012_c0:
  v_max3_u32 v31, v48, v49, v50
  v_max_u32 v31, v31, v51
  v_cmp_eq_u32 vcc, -1, v31
  s_cbranch_vccz SL_m_012_ok0
SL_m_012_x0:
  s_mov_b64 exec, vcc
  buffer_load_dwordx4 v[48:51], v3, s[4:7], s41 offen offset:0 sc1
  s_mov_b64 exec, -1
SL_m_012_c1:
  v_max3_u32 v31, v52, v53, v54
  v_max_u32 v31, v31, v55
  v_cmp_eq_u32 vcc, -1, v31
  s_cbranch_vccz SL_m_012_ok1
SL_m_012_x1:
  s_mov_b64 exec, vcc
  buffer_load_dwordx4 v[52:55], v3, s[4:7], s41 offen offset:1024 sc1
  s_mov_b64 exec, -1
SL_m_012_c2:
  v_max3_u32 v31, v56, v57, v58
  v_max_u32 v31, v31, v59
  v_cmp_eq_u32 vcc, -1, v31
  s_cbranch_vccz SL_m_012_ok2
SL_m_012_x2:
  s_mov_b64 exec, vcc
  buffer_load_dwordx4 v[56:59], v3, s[4:7], s41 offen offset:2048 sc1
  s_mov_b64 exec, -1
  s_add_u32 s46, s46, 1
  s_cmp_ge_u32 s46, 131072
  s_cbranch_scc1 SL_rec_abort
  s_waitcnt vmcnt(4)
  s_branch SL_m_012_c0
SL_m_012_ok0:
  v_smfmac_f32_16x16x64_bf16 v[64:67], v[48:51], a[0:7], v23
  v_max3_u32 v31, v52, v53, v54
  v_max_u32 v31, v31, v55
  v_cmp_eq_u32 vcc, -1, v31
  v_smfmac_f32_16x16x64_bf16 v[68:71], v[48:51], a[8:15], v23
  v_smfmac_f32_16x16x64_bf16 v[72:75], v[48:51], a[16:23], v23
  v_smfmac_f32_16x16x64_bf16 v[76:79], v[48:51], a[24:31], v23
  s_cbranch_vccz SL_m_12_ok1
  s_branch SL_m_12_x1
SL_m_012_ok1:
  v_smfmac_f32_16x16x64_bf16 v[64:67], v[52:55], a[48:55], v23
  v_max3_u32 v31, v56, v57, v58
  v_max_u32 v31, v31, v59
  v_cmp_eq_u32 vcc, -1, v31
  v_smfmac_f32_16x16x64_bf16 v[68:71], v[52:55], a[56:63], v23
  v_smfmac_f32_16x16x64_bf16 v[72:75], v[52:55], a[64:71], v23
  v_smfmac_f32_16x16x64_bf16 v[76:79], v[52:55], a[72:79], v23
  s_cbranch_vccz SL_m_02_ok2
  s_branch SL_m_02_x2
SL_m_012_ok2:
  v_smfmac_f32_16x16x64_bf16 v[64:67], v[56:59], a[96:103], v23
  v_max3_u32 v31, v48, v49, v50
  v_max_u32 v31, v31, v51
  v_cmp_eq_u32 vcc, -1, v31
  v_smfmac_f32_16x16x64_bf16 v[68:71], v[56:59], a[104:111], v23
  v_smfmac_f32_16x16x64_bf16 v[72:75], v[56:59], a[112:119], v23
  v_smfmac_f32_16x16x64_bf16 v[76:79], v[56:59], a[120:127], v23
  s_cbranch_vccz SL_m_01_ok0
  s_branch SL_m_01_x0
SL_m_013_c0:
  v_max3_u32 v31, v48, v49, v50
  v_max_u32 v31, v31, v51
  v_cmp_eq_u32 vcc, -1, v31
  s_cbranch_vccz SL_m_013_ok0
SL_m_013_x0:
  s_mov_b64 exec, vcc
  buffer_load_dwordx4 v[48:51], v3, s[4:7], s41 offen offset:0 sc1
  s_mov_b64 exec, -1
SL_m_013_c1:
  v_max3_u32 v31, v52, v53, v54
  v_max_u32 v31, v31, v55
  v_cmp_eq_u32 vcc, -1, v31
  s_cbranch_vccz SL_m_013_ok1
SL_m_013_x1:
  s_mov_b64 exec, vcc
  buffer_load_dwordx4 v[52:55], v3, s[4:7], s41 offen offset:1024 sc1
  s_mov_b64 exec, -1
SL_m_013_c3:
  v_max3_u32 v31, v60, v61, v62
  v_max_u32 v31, v31, v63
  v_cmp_eq_u32 vcc, -1, v31
  s_cbranch_vccz SL_m_013_ok3
SL_m_013_x3:
  s_mov_b64 exec, vcc
  buffer_load_dwordx4 v[60:63], v3, s[4:7], s41 offen offset:3072 sc1
  s_mov_b64 exec, -1
  s_add_u32 s46, s46, 1
  s_cmp_ge_u32 s46, 131072
  s_cbranch_scc1 SL_rec_abort
  s_waitcnt vmcnt(4)
  s_branch SL_m_013_c0
SL_m_013_ok0:
  v_smfmac_f32_16x16x64_bf16 v[64:67], v[48:51], a[0:7], v23
  v_max3_u32 v31, v52, v53, v54
  v_max_u32 v31, v31, v55
  v_cmp_eq_u32 vcc, -1, v31
  v_smfmac_f32_16x16x64_bf16 v[68:71], v[48:51], a[8:15], v23
  v_smfmac_f32_16x16x64_bf16 v[72:75], v[48:51], a[16:23], v23
  v_smfmac_f32_16x16x64_bf16 v[76:79], v[48:51], a[24:31], v23
  s_cbranch_vccz SL_m_13_ok1
  s_branch SL_m_13_x1
SL_m_013_ok1:
  v_smfmac_f32_16x16x64_bf16 v[64:67], v[52:55], a[48:55], v23
  v_max3_u32 v31, v60, v61, v62
  v_max_u32 v31, v31, v63
  v_cmp_eq_u32 vcc, -1, v31
  v_smfmac_f32_16x16x64_bf16 v[68:71], v[52:55], a[56:63], v23
  v_smfmac_f32_16x16x64_bf16 v[72:75], v[52:55], a[64:71], v23
  v_smfmac_f32_16x16x64_bf16 v[76:79], v[52:55], a[72:79], v23
  s_cbranch_vccz SL_m_03_ok3
  s_branch SL_m_03_x3
SL_m_013_ok3:
  v_smfmac_f32_16x16x64_bf16 v[64:67], v[60:63], a[144:151], v23
  v_max3_u32 v31, v48, v49, v50
  v_max_u32 v31, v31, v51
  v_cmp_eq_u32 vcc, -1, v31
  v_smfmac_f32_16x16x64_bf16 v[68:71], v[60:63], a[152:159], v23
  v_smfmac_f32_16x16x64_bf16 v[72:75], v[60:63], a[160:167], v23
  v_smfmac_f32_16x16x64_bf16 v[76:79], v[60:63], a[168:175], v23
  s_cbranch_vccz SL_m_01_ok0
  s_branch SL_m_01_x0
SL_m_023_c0:
  v_max3_u32 v31, v48, v49, v50
  v_max_u32 v31, v31, v51
  v_cmp_eq_u32 vcc, -1, v31
  s_cbranch_vccz SL_m_023_ok0
SL_m_023_x0:
  s_mov_b64 exec, vcc
  buffer_load_dwordx4 v[48:51], v3, s[4:7], s41 offen offset:0 sc1
  s_mov_b64 exec, -1
SL_m_023_c2:
  v_max3_u32 v31, v56, v57, v58
  v_max_u32 v31, v31, v59
  v_cmp_eq_u32 vcc, -1, v31
  s_cbranch_vccz SL_m_023_ok2
SL_m_023_x2:
  s_mov_b64 exec, vcc
  buffer_load_dwordx4 v[56:59], v3, s[4:7], s41 offen offset:2048 sc1
  s_mov_b64 exec, -1
SL_m_023_c3:
  v_max3_u32 v31, v60, v61, v62
  v_max_u32 v31, v31, v63
  v_cmp_eq_u32 vcc, -1, v31
  s_cbranch_vccz SL_m_023_ok3
SL_m_023_x3:
  s_mov_b64 exec, vcc
  buffer_load_dwordx4 v[60:63], v3, s[4:7], s41 offen offset:3072 sc1
  s_mov_b64 exec, -1
  s_add_u32 s46, s46, 1
  s_cmp_ge_u32 s46, 131072
  s_cbranch_scc1 SL_rec_abort
  s_waitcnt vmcnt(4)
  s_branch SL_m_023_c0
SL_m_023_ok0:
  v_smfmac_f32_16x16x64_bf16 v[64:67], v[48:51], a[0:7], v23
  v_max3_u32 v31, v56, v57, v58
  v_max_u32 v31, v31, v59
  v_cmp_eq_u32 vcc, -1, v31
  v_smfmac_f32_16x16x64_bf16 v[68:71], v[48:51], a[8:15], v23
  v_smfmac_f32_16x16x64_bf16 v[72:75], v[48:51], a[16:23], v23
  v_smfmac_f32_16x16x64_bf16 v[76:79], v[48:51], a[24:31], v23
  s_cbranch_vccz SL_m_23_ok2
  s_branch SL_m_23_x2
SL_m_023_ok2:
  v_smfmac_f32_16x16x64_bf16 v[64:67], v[56:59], a[96:103], v23
  v_max3_u32 v31, v60, v61, v62
  v_max_u32 v31, v31, v63
  v_cmp_eq_u32 vcc, -1, v31
  v_smfmac_f32_16x16x64_bf16 v[68:71], v[56:59], a[104:111], v23
  v_smfmac_f32_16x16x64_bf16 v[72:75], v[56:59], a[112:119], v23
  v_smfmac_f32_16x16x64_bf16 v[76:79], v[56:59], a[120:127], v23
  s_cbranch_vccz SL_m_03_ok3
  s_branch SL_m_03_x3
SL_m_023_ok3:
  v_smfmac_f32_16x16x64_bf16 v[64:67], v[60:63], a[144:151], v23
  v_max3_u32 v31, v48, v49, v50
  v_max_u32 v31, v31, v51
  v_cmp_eq_u32 vcc, -1, v31
  v_smfmac_f32_16x16x64_bf16 v[68:71], v[60:63], a[152:159], v23
  v_smfmac_f32_16x16x64_bf16 v[72:75], v[60:63], a[160:167], v23
  v_smfmac_f32_16x16x64_bf16 v[76:79], v[60:63], a[168:175], v23
  s_cbranch_vccz SL_m_02_ok0
  s_branch SL_m_02_x0
SL_m_123_c1:
  v_max3_u32 v31, v52, v53, v54
  v_max_u32 v31, v31, v55
  v_cmp_eq_u32 vcc, -1, v31
  s_cbranch_vccz SL_m_123_ok1
SL_m_123_x1:
  s_mov_b64 exec, vcc
  buffer_load_dwordx4 v[52:55], v3, s[4:7], s41 offen offset:1024 sc1
  s_mov_b64 exec, -1
SL_m_123_c2:
  v_max3_u32 v31, v56, v57, v58
  v_max_u32 v31, v31, v59
  v_cmp_eq_u32 vcc, -1, v31
  s_cbranch_vccz SL_m_123_ok2
SL_m_123_x2:
  s_mov_b64 exec, vcc
  buffer_load_dwordx4 v[56:59], v3, s[4:7], s41 offen offset:2048 sc1
  s_mov_b64 exec, -1
SL_m_123_c3:
  v_max3_u32 v31, v60, v61, v62
  v_max_u32 v31, v31, v63
  v_cmp_eq_u32 vcc, -1, v31
  s_cbranch_vccz SL_m_123_ok3
SL_m_123_x3:
  s_mov_b64 exec, vcc
  buffer_load_dwordx4 v[60:63], v3, s[4:7], s41 offen offset:3072 sc1
  s_mov_b64 exec, -1
  s_add_u32 s46, s46, 1
  s_cmp_ge_u32 s46, 131072
  s_cbranch_scc1 SL_rec_abort
  s_waitcnt vmcnt(4)
  s_branch SL_m_123_c1
SL_m_123_ok1:
  v_smfmac_f32_16x16x64_bf16 v[64:67], v[52:55], a[48:55], v23
  v_max3_u32 v31, v56, v57, v58
  v_max_u32 v31, v31, v59
  v_cmp_eq_u32 vcc, -1, v31
  v_smfmac_f32_16x16x64_bf16 v[68:71], v[52:55], a[56:63], v23
  v_smfmac_f32_16x16x64_bf16 v[72:75], v[52:55], a[64:71], v23
  v_smfmac_f32_16x16x64_bf16 v[76:79], v[52:55], a[72:79], v23
  s_cbranch_vccz SL_m_23_ok2
  s_branch SL_m_23_x2
SL_m_123_ok2:
  v_smfmac_f32_16x16x64_bf16 v[64:67], v[56:59], a[96:103], v23
  v_max3_u32 v31, v60, v61, v62
  v_max_u32 v31, v31, v63
  v_cmp_eq_u32 vcc, -1, v31
  v_smfmac_f32_16x16x64_bf16 v[68:71], v[56:59], a[104:111], v23
  v_smfmac_f32_16x16x64_bf16 v[72:75], v[56:59], a[112:119], v23
  v_smfmac_f32_16x16x64_bf16 v[76:79], v[56:59], a[120:127], v23
  s_cbranch_vccz SL_m_13_ok3
  s_branch SL_m_13_x3
SL_m_123_ok3:
  v_smfmac_f32_16x16x64_bf16 v[64:67], v[60:63], a[144:151], v23
  v_max3_u32 v31, v52, v53, v54
  v_max_u32 v31, v31, v55
  v_cmp_eq_u32 vcc, -1, v31
  v_smfmac_f32_16x16x64_bf16 v[68:71], v[60:63], a[152:159], v23
  v_smfmac_f32_16x16x64_bf16 v[72:75], v[60:63], a[160:167], v23
  v_smfmac_f32_16x16x64_bf16 v[76:79], v[60:63], a[168:175], v23
  s_cbranch_vccz SL_m_12_ok1
  s_branch SL_m_12_x1
SL_m_0123_c0:
  v_max3_u32 v31, v48, v49, v50
  v_max_u32 v31, v31, v51
  v_cmp_eq_u32 vcc, -1, v31
  s_cbranch_vccz SL_m_0123_ok0
SL_m_0123_x0:
  s_mov_b64 exec, vcc
  buffer_load_dwordx4 v[48:51], v3, s[4:7], s41 offen offset:0 sc1
  s_mov_b64 exec, -1
SL_m_0123_c1:
  v_max3_u32 v31, v52, v53, v54
  v_max_u32 v31, v31, v55
  v_cmp_eq_u32 vcc, -1, v31
  s_cbranch_vccz SL_m_0123_ok1
SL_m_0123_x1:
  s_mov_b64 exec, vcc
  buffer_load_dwordx4 v[52:55], v3, s[4:7], s41 offen offset:1024 sc1
  s_mov_b64 exec, -1
SL_m_0123_c2:
  v_max3_u32 v31, v56, v57, v58
  v_max_u32 v31, v31, v59
  v_cmp_eq_u32 vcc, -1, v31
  s_cbranch_vccz SL_m_0123_ok2
SL_m_0123_x2:
  s_mov_b64 exec, vcc
  buffer_load_dwordx4 v[56:59], v3, s[4:7], s41 offen offset:2048 sc1
  s_mov_b64 exec, -1
SL_m_0123_c3:
  v_max3_u32 v31, v60, v61, v62
  v_max_u32 v31, v31, v63
  v_cmp_eq_u32 vcc, -1, v31
  s_cbranch_vccz SL_m_0123_ok3
SL_m_0123_x3:
  s_mov_b64 exec, vcc
  buffer_load_dwordx4 v[60:63], v3, s[4:7], s41 offen offset:3072 sc1
  s_mov_b64 exec, -1
  s_add_u32 s46, s46, 1
  s_cmp_ge_u32 s46, 131072
  s_cbranch_scc1 SL_rec_abort
  s_waitcnt vmcnt(4)
  s_branch SL_m_0123_c0
SL_m_0123_ok0:
  v_smfmac_f32_16x16x64_bf16 v[64:67], v[48:51], a[0:7], v23
  v_max3_u32 v31, v52, v53, v54
  v_max_u32 v31, v31, v55
  v_cmp_eq_u32 vcc, -1, v31
  v_smfmac_f32_16x16x64_bf16 v[68:71], v[48:51], a[8:15], v23
  v_smfmac_f32_16x16x64_bf16 v[72:75], v[48:51], a[16:23], v23
  v_smfmac_f32_16x16x64_bf16 v[76:79], v[48:51], a[24:31], v23
  s_cbranch_vccz SL_m_123_ok1
  s_branch SL_m_123_x1
SL_m_0123_ok1:
  v_smfmac_f32_16x16x64_bf16 v[64:67], v[52:55], a[48:55], v23
  v_max3_u32 v31, v56, v57, v58
  v_max_u32 v31, v31, v59
  v_cmp_eq_u32 vcc, -1, v31
  v_smfmac_f32_16x16x64_bf16 v[68:71], v[52:55], a[56:63], v23
  v_smfmac_f32_16x16x64_bf16 v[72:75], v[52:55], a[64:71], v23
  v_smfmac_f32_16x16x64_bf16 v[76:79], v[52:55], a[72:79], v23
  s_cbranch_vccz SL_m_023_ok2
  s_branch SL_m_023_x2
SL_m_0123_ok2:
  v_smfmac_f32_16x16x64_bf16 v[64:67], v[56:59], a[96:103], v23
  v_max3_u32 v31, v60, v61, v62
  v_max_u32 v31, v31, v63
  v_cmp_eq_u32 vcc, -1, v31
  v_smfmac_f32_16x16x64_bf16 v[68:71], v[56:59], a[104:111], v23
  v_smfmac_f32_16x16x64_bf16 v[72:75], v[56:59], a[112:119], v23
  v_smfmac_f32_16x16x64_bf16 v[76:79], v[56:59], a[120:127], v23
  s_cbranch_vccz SL_m_013_ok3
  s_branch SL_m_013_x3
SL_m_0123_ok3:
  v_smfmac_f32_16x16x64_bf16 v[64:67], v[60:63], a[144:151], v23
  v_max3_u32 v31, v48, v49, v50
  v_max_u32 v31, v31, v51
  v_cmp_eq_u32 vcc, -1, v31
  v_smfmac_f32_16x16x64_bf16 v[68:71], v[60:63], a[152:159], v23
  v_smfmac_f32_16x16x64_bf16 v[72:75], v[60:63], a[160:167], v23
  v_smfmac_f32_16x16x64_bf16 v[76:79], v[60:63], a[168:175], v23
  s_cbranch_vccz SL_m_012_ok0
  s_branch SL_m_012_x0
SL_x_f0:
  s_mov_b64 exec, vcc
  buffer_load_dwordx4 v[64:67], v9, s[4:7], s41 offen offset:0 sc1
  s_mov_b64 exec, -1
  s_waitcnt vmcnt(2)
  s_branch SL_x_0123_c1
SL_x_f1:
  s_mov_b64 exec, vcc
  buffer_load_dwordx4 v[68:71], v9, s[4:7], s41 offen offset:1024 sc1
  s_mov_b64 exec, -1
  s_waitcnt vmcnt(2)
  s_branch SL_x_123_c2
SL_x_f2:
  s_mov_b64 exec, vcc
  buffer_load_dwordx4 v[72:75], v9, s[4:7], s41 offen offset:2048 sc1
  s_mov_b64 exec, -1
  s_waitcnt vmcnt(2)
  s_branch SL_x_23_c3
SL_x_f3:
  s_mov_b64 exec, vcc
  buffer_load_dwordx4 v[76:79], v9, s[4:7], s41 offen offset:3072 sc1
  s_mov_b64 exec, -1
  s_nop 7
  s_branch SL_x_3_c3
SL_x_0_c0:
  v_max3_u32 v31, v64, v65, v66
  v_max_u32 v31, v31, v67
  v_cmp_eq_u32 vcc, -1, v31
  s_cbranch_vccz SL_x_0_ok0
SL_x_0_x0:
  s_mov_b64 exec, vcc
  buffer_load_dwordx4 v[64:67], v9, s[4:7], s41 offen offset:0 sc1
  s_mov_b64 exec, -1
  s_add_u32 s46, s46, 1
  s_cmp_ge_u32 s46, 131072
  s_cbranch_scc1 SL_rec_abort
  s_waitcnt vmcnt(2)
  s_branch SL_x_0_c0
SL_x_0_ok0:
  v_mfma_f32_16x16x32_bf16 v[44:47], v[64:67], v[64:67], v[44:47]
  v_mfma_f32_16x16x32_bf16 v[36:39], v[116:119], v[64:67], v[36:39]
  v_mfma_f32_16x16x32_bf16 v[40:43], v[132:135], v[64:67], v[40:43]
  s_branch SL_x_done
SL_x_1_c1:
  v_max3_u32 v31, v68, v69, v70
  v_max_u32 v31, v31, v71
  v_cmp_eq_u32 vcc, -1, v31
  s_cbranch_vccz SL_x_1_ok1
SL_x_1_x1:
  s_mov_b64 exec, vcc
  buffer_load_dwordx4 v[68:71], v9, s[4:7], s41 offen offset:1024 sc1
  s_mov_b64 exec, -1
  s_add_u32 s46, s46, 1
  s_cmp_ge_u32 s46, 131072
  s_cbranch_scc1 SL_rec_abort
  s_waitcnt vmcnt(2)
  s_branch SL_x_1_c1
SL_x_1_ok1:
  v_mfma_f32_16x16x32_bf16 v[44:47], v[68:71], v[68:71], v[44:47]
  v_mfma_f32_16x16x32_bf16 v[36:39], v[120:123], v[68:71], v[36:39]
  v_mfma_f32_16x16x32_bf16 v[40:43], v[136:139], v[68:71], v[40:43]
  s_branch SL_x_done
SL_x_2_c2:
  v_max3_u32 v31, v72, v73, v74
  v_max_u32 v31, v31, v75
  v_cmp_eq_u32 vcc, -1, v31
  s_cbranch_vccz SL_x_2_ok2
SL_x_2_x2:
  s_mov_b64 exec, vcc
  buffer_load_dwordx4 v[72:75], v9, s[4:7], s41 offen offset:2048 sc1
  s_mov_b64 exec, -1
  s_add_u32 s46, s46, 1
  s_cmp_ge_u32 s46, 131072
  s_cbranch_scc1 SL_rec_abort
  s_waitcnt vmcnt(2)
  s_branch SL_x_2_c2
SL_x_2_ok2:
  v_mfma_f32_16x16x32_bf16 v[44:47], v[72:75], v[72:75], v[44:47]
  v_mfma_f32_16x16x32_bf16 v[36:39], v[124:127], v[72:75], v[36:39]
  v_mfma_f32_16x16x32_bf16 v[40:43], v[140:143], v[72:75], v[40:43]
  s_branch SL_x_done
SL_x_3_c3:
  v_max3_u32 v31, v76, v77, v78
  v_max_u32 v31, v31, v79
  v_cmp_eq_u32 vcc, -1, v31
  s_cbranch_vccz SL_x_3_ok3
SL_x_3_x3:
  s_mov_b64 exec, vcc
  buffer_load_dwordx4 v[76:79], v9, s[4:7], s41 offen offset:3072 sc1
  s_mov_b64 exec, -1
  s_add_u32 s46, s46, 1
  s_cmp_ge_u32 s46, 131072
  s_cbranch_scc1 SL_rec_abort
  s_waitcnt vmcnt(2)
  s_branch SL_x_3_c3
SL_x_3_ok3:
  v_mfma_f32_16x16x32_bf16 v[44:47], v[76:79], v[76:79], v[44:47]
  v_mfma_f32_16x16x32_bf16 v[36:39], v[128:131], v[76:79], v[36:39]
  v_mfma_f32_16x16x32_bf16 v[40:43], v[144:147], v[76:79], v[40:43]
  s_branch SL_x_done
SL_x_01_c0:
  v_max3_u32 v31, v64, v65, v66
  v_max_u32 v31, v31, v67
  v_cmp_eq_u32 vcc, -1, v31
  s_cbranch_vccz SL_x_01_ok0
SL_x_01_x0:
  s_mov_b64 exec, vcc
  buffer_load_dwordx4 v[64:67], v9, s[4:7], s41 offen offset:0 sc1
  s_mov_b64 exec, -1
SL_x_01_c1:
  v_max3_u32 v31, v68, v69, v70
  v_max_u32 v31, v31, v71
  v_cmp_eq_u32 vcc, -1, v31
  s_cbranch_vccz SL_x_01_ok1
SL_x_01_x1:
  s_mov_b64 exec, vcc
  buffer_load_dwordx4 v[68:71], v9, s[4:7], s41 offen offset:1024 sc1
  s_mov_b64 exec, -1
  s_add_u32 s46, s46, 1
  s_cmp_ge_u32 s46, 131072
  s_cbranch_scc1 SL_rec_abort
  s_waitcnt vmcnt(4)
  s_branch SL_x_01_c0
SL_x_01_ok0:
  v_mfma_f32_16x16x32_bf16 v[44:47], v[64:67], v[64:67], v[44:47]
  v_max3_u32 v31, v68, v69, v70
  v_max_u32 v31, v31, v71
  v_cmp_eq_u32 vcc, -1, v31
  v_mfma_f32_16x16x32_bf16 v[36:39], v[116:119], v[64:67], v[36:39]
  v_mfma_f32_16x16x32_bf16 v[40:43], v[132:135], v[64:67], v[40:43]
  s_cbranch_vccz SL_x_1_ok1
  s_branch SL_x_1_x1
SL_x_01_ok1:
  v_mfma_f32_16x16x32_bf16 v[44:47], v[68:71], v[68:71], v[44:47]
  v_max3_u32 v31, v64, v65, v66
  v_max_u32 v31, v31, v67
  v_cmp_eq_u32 vcc, -1, v31
  v_mfma_f32_16x16x32_bf16 v[36:39], v[120:123], v[68:71], v[36:39]
  v_mfma_f32_16x16x32_bf16 v[40:43], v[136:139], v[68:71], v[40:43]
  s_cbranch_vccz SL_x_0_ok0
  s_branch SL_x_0_x0
SL_x_02_c0:
  v_max3_u32 v31, v64, v65, v66
  v_max_u32 v31, v31, v67
  v_cmp_eq_u32 vcc, -1, v31
  s_cbranch_vccz SL_x_02_ok0
SL_x_02_x0:
  s_mov_b64 exec, vcc
  buffer_load_dwordx4 v[64:67], v9, s[4:7], s41 offen offset:0 sc1
  s_mov_b64 exec, -1
SL_x_02_c2:
  v_max3_u32 v31, v72, v73, v74
  v_max_u32 v31, v31, v75
  v_cmp_eq_u32 vcc, -1, v31
  s_cbranch_vccz SL_x_02_ok2
SL_x_02_x2:
  s_mov_b64 exec, vcc
  buffer_load_dwordx4 v[72:75], v9, s[4:7], s41 offen offset:2048 sc1
  s_mov_b64 exec, -1
  s_add_u32 s46, s46, 1
  s_cmp_ge_u32 s46, 131072
  s_cbranch_scc1 SL_rec_abort
  s_waitcnt vmcnt(4)
  s_branch SL_x_02_c0
SL_x_02_ok0:
  v_mfma_f32_16x16x32_bf16 v[44:47], v[64:67], v[64:67], v[44:47]
  v_max3_u32 v31, v72, v73, v74
  v_max_u32 v31, v31, v75
  v_cmp_eq_u32 vcc, -1, v31
  v_mfma_f32_16x16x32_bf16 v[36:39], v[116:119], v[64:67], v[36:39]
  v_mfma_f32_16x16x32_bf16 v[40:43], v[132:135], v[64:67], v[40:43]
  s_cbranch_vccz SL_x_2_ok2
  s_branch SL_x_2_x2
SL_x_02_ok2:
  v_mfma_f32_16x16x32_bf16 v[44:47], v[72:75], v[72:75], v[44:47]
  v_max3_u32 v31, v64, v65, v66
  v_max_u32 v31, v31, v67
  v_cmp_eq_u32 vcc, -1, v31
  v_mfma_f32_16x16x32_bf16 v[36:39], v[124:127], v[72:75], v[36:39]
  v_mfma_f32_16x16x32_bf16 v[40:43], v[140:143], v[72:75], v[40:43]
  s_cbranch_vccz SL_x_0_ok0
  s_branch SL_x_0_x0
SL_x_03_c0:
  v_max3_u32 v31, v64, v65, v66
  v_max_u32 v31, v31, v67
  v_cmp_eq_u32 vcc, -1, v31
  s_cbranch_vccz SL_x_03_ok0
SL_x_03_x0:
  s_mov_b64 exec, vcc
  buffer_load_dwordx4 v[64:67], v9, s[4:7], s41 offen offset:0 sc1
  s_mov_b64 exec, -1
SL_x_03_c3:
  v_max3_u32 v31, v76, v77, v78
  v_max_u32 v31, v31, v79
  v_cmp_eq_u32 vcc, -1, v31
  s_cbranch_vccz SL_x_03_ok3
SL_x_03_x3:
  s_mov_b64 exec, vcc
  buffer_load_dwordx4 v[76:79], v9, s[4:7], s41 offen offset:3072 sc1
  s_mov_b64 exec, -1
  s_add_u32 s46, s46, 1
  s_cmp_ge_u32 s46, 131072
  s_cbranch_scc1 SL_rec_abort
  s_waitcnt vmcnt(4)
  s_branch SL_x_03_c0
SL_x_03_ok0:
  v_mfma_f32_16x16x32_bf16 v[44:47], v[64:67], v[64:67], v[44:47]
  v_max3_u32 v31, v76, v77, v78
  v_max_u32 v31, v31, v79
  v_cmp_eq_u32 vcc, -1, v31
  v_mfma_f32_16x16x32_bf16 v[36:39], v[116:119], v[64:67], v[36:39]
  v_mfma_f32_16x16x32_bf16 v[40:43], v[132:135], v[64:67], v[40:43]
  s_cbranch_vccz SL_x_3_ok3
  s_branch SL_x_3_x3
SL_x_03_ok3:
  v_mfma_f32_16x16x32_bf16 v[44:47], v[76:79], v[76:79], v[44:47]
  v_max3_u32 v31, v64, v65, v66
  v_max_u32 v31, v31, v67
  v_cmp_eq_u32 vcc, -1, v31
  v_mfma_f32_16x16x32_bf16 v[36:39], v[128:131], v[76:79], v[36:39]
  v_mfma_f32_16x16x32_bf16 v[40:43], v[144:147], v[76:79], v[40:43]
  s_cbranch_vccz SL_x_0_ok0
  s_branch SL_x_0_x0
SL_x_12_c1:
  v_max3_u32 v31, v68, v69, v70
  v_max_u32 v31, v31, v71
  v_cmp_eq_u32 vcc, -1, v31
  s_cbranch_vccz SL_x_12_ok1
SL_x_12_x1:
  s_mov_b64 exec, vcc
  buffer_load_dwordx4 v[68:71], v9, s[4:7], s41 offen offset:1024 sc1
  s_mov_b64 exec, -1
SL_x_12_c2:
  v_max3_u32 v31, v72, v73, v74
  v_max_u32 v31, v31, v75
  v_cmp_eq_u32 vcc, -1, v31
  s_cbranch_vccz SL_x_12_ok2
SL_x_12_x2:
  s_mov_b64 exec, vcc
  buffer_load_dwordx4 v[72:75], v9, s[4:7], s41 offen offset:2048 sc1
  s_mov_b64 exec, -1
  s_add_u32 s46, s46, 1
  s_cmp_ge_u32 s46, 131072
  s_cbranch_scc1 SL_rec_abort
  s_waitcnt vmcnt(4)
  s_branch SL_x_12_c1
SL_x_12_ok1:
  v_mfma_f32_16x16x32_bf16 v[44:47], v[68:71], v[68:71], v[44:47]
  v_max3_u32 v31, v72, v73, v74
  v_max_u32 v31, v31, v75
  v_cmp_eq_u32 vcc, -1, v31
  v_mfma_f32_16x16x32_bf16 v[36:39], v[120:123], v[68:71], v[36:39]
  v_mfma_f32_16x16x32_bf16 v[40:43], v[136:139], v[68:71], v[40:43]
  s_cbranch_vccz SL_x_2_ok2
  s_branch SL_x_2_x2
SL_x_12_ok2:
  v_mfma_f32_16x16x32_bf16 v[44:47], v[72:75], v[72:75], v[44:47]
  v_max3_u32 v31, v68, v69, v70
  v_max_u32 v31, v31, v71
  v_cmp_eq_u32 vcc, -1, v31
  v_mfma_f32_16x16x32_bf16 v[36:39], v[124:127], v[72:75], v[36:39]
  v_mfma_f32_16x16x32_bf16 v[40:43], v[140:143], v[72:75], v[40:43]
  s_cbranch_vccz SL_x_1_ok1
  s_branch SL_x_1_x1
SL_x_13_c1:
  v_max3_u32 v31, v68, v69, v70
  v_max_u32 v31, v31, v71
  v_cmp_eq_u32 vcc, -1, v31
  s_cbranch_vccz SL_x_13_ok1
SL_x_13_x1:
  s_mov_b64 exec, vcc
  buffer_load_dwordx4 v[68:71], v9, s[4:7], s41 offen offset:1024 sc1
  s_mov_b64 exec, -1
SL_x_13_c3:
  v_max3_u32 v31, v76, v77, v78
  v_max_u32 v31, v31, v79
  v_cmp_eq_u32 vcc, -1, v31
  s_cbranch_vccz SL_x_13_ok3
SL_x_13_x3:
  s_mov_b64 exec, vcc
  buffer_load_dwordx4 v[76:79], v9, s[4:7], s41 offen offset:3072 sc1
  s_mov_b64 exec, -1
  s_add_u32 s46, s46, 1
  s_cmp_ge_u32 s46, 131072
  s_cbranch_scc1 SL_rec_abort
  s_waitcnt vmcnt(4)
  s_branch SL_x_13_c1
SL_x_13_ok1:
  v_mfma_f32_16x16x32_bf16 v[44:47], v[68:71], v[68:71], v[44:47]
  v_max3_u32 v31, v76, v77, v78
  v_max_u32 v31, v31, v79
  v_cmp_eq_u32 vcc, -1, v31
  v_mfma_f32_16x16x32_bf16 v[36:39], v[120:123], v[68:71], v[36:39]
  v_mfma_f32_16x16x32_bf16 v[40:43], v[136:139], v[68:71], v[40:43]
  s_cbranch_vccz SL_x_3_ok3
  s_branch SL_x_3_x3
SL_x_13_ok3:
  v_mfma_f32_16x16x32_bf16 v[44:47], v[76:79], v[76:79], v[44:47]
  v_max3_u32 v31, v68, v69, v70
  v_max_u32 v31, v31, v71
  v_cmp_eq_u32 vcc, -1, v31
  v_mfma_f32_16x16x32_bf16 v[36:39], v[128:131], v[76:79], v[36:39]
  v_mfma_f32_16x16x32_bf16 v[40:43], v[144:147], v[76:79], v[40:43]
  s_cbranch_vccz SL_x_1_ok1
  s_branch SL_x_1_x1
SL_x_23_c2:
  v_max3_u32 v31, v72, v73, v74
  v_max_u32 v31, v31, v75
  v_cmp_eq_u32 vcc, -1, v31
  s_cbranch_vccz SL_x_23_ok2
SL_x_23_x2:
  s_mov_b64 exec, vcc
  buffer_load_dwordx4 v[72:75], v9, s[4:7], s41 offen offset:2048 sc1
  s_mov_b64 exec, -1
SL_x_23_c3:
  v_max3_u32 v31, v76, v77, v78
  v_max_u32 v31, v31, v79
  v_cmp_eq_u32 vcc, -1, v31
  s_cbranch_vccz SL_x_23_ok3
SL_x_23_x3:
  s_mov_b64 exec, vcc
  buffer_load_dwordx4 v[76:79], v9, s[4:7], s41 offen offset:3072 sc1
  s_mov_b64 exec, -1
  s_add_u32 s46, s46, 1
  s_cmp_ge_u32 s46, 131072
  s_cbranch_scc1 SL_rec_abort
  s_waitcnt vmcnt(4)
  s_branch SL_x_23_c2
SL_x_23_ok2:
  v_mfma_f32_16x16x32_bf16 v[44:47], v[72:75], v[72:75], v[44:47]
  v_max3_u32 v31, v76, v77, v78
  v_max_u32 v31, v31, v79
  v_cmp_eq_u32 vcc, -1, v31
  v_mfma_f32_16x16x32_bf16 v[36:39], v[124:127], v[72:75], v[36:39]
  v_mfma_f32_16x16x32_bf16 v[40:43], v[140:143], v[72:75], v[40:43]
  s_cbranch_vccz SL_x_3_ok3
  s_branch SL_x_3_x3
SL_x_23_ok3:
  v_mfma_f32_16x16x32_bf16 v[44:47], v[76:79], v[76:79], v[44:47]
  v_max3_u32 v31, v72, v73, v74
  v_max_u32 v31, v31, v75
  v_cmp_eq_u32 vcc, -1, v31
  v_mfma_f32_16x16x32_bf16 v[36:39], v[128:131], v[76:79], v[36:39]
  v_mfma_f32_16x16x32_bf16 v[40:43], v[144:147], v[76:79], v[40:43]
  s_cbranch_vccz SL_x_2_ok2
  s_branch SL_x_2_x2
SL_x_012_c0:
  v_max3_u32 v31, v64, v65, v66
  v_max_u32 v31, v31, v67
  v_cmp_eq_u32 vcc, -1, v31
  s_cbranch_vccz SL_x_012_ok0
SL_x_012_x0:
  s_mov_b64 exec, vcc
  buffer_load_dwordx4 v[64:67], v9, s[4:7], s41 offen offset:0 sc1
  s_mov_b64 exec, -1
SL_x_012_c1:
  v_max3_u32 v31, v68, v69, v70
  v_max_u32 v31, v31, v71
  v_cmp_eq_u32 vcc, -1, v31
  s_cbranch_vccz SL_x_012_ok1
SL_x_012_x1:
  s_mov_b64 exec, vcc
  buffer_load_dwordx4 v[68:71], v9, s[4:7], s41 offen offset:1024 sc1
  s_mov_b64 exec, -1
SL_x_012_c2:
  v_max3_u32 v31, v72, v73, v74
  v_max_u32 v31, v31, v75
  v_cmp_eq_u32 vcc, -1, v31
  s_cbranch_vccz SL_x_012_ok2
SL_x_012_x2:
  s_mov_b64 exec, vcc
  buffer_load_dwordx4 v[72:75], v9, s[4:7], s41 offen offset:2048 sc1
  s_mov_b64 exec, -1
  s_add_u32 s46, s46, 1
  s_cmp_ge_u32 s46, 131072
  s_cbranch_scc1 SL_rec_abort
  s_waitcnt vmcnt(4)
  s_branch SL_x_012_c0
SL_x_012_ok0:
  v_mfma_f32_16x16x32_bf16 v[44:47], v[64:67], v[64:67], v[44:47]
  v_max3_u32 v31, v68, v69, v70
  v_max_u32 v31, v31, v71
  v_cmp_eq_u32 vcc, -1, v31
  v_mfma_f32_16x16x32_bf16 v[36:39], v[116:119], v[64:67], v[36:39]
  v_mfma_f32_16x16x32_bf16 v[40:43], v[132:135], v[64:67], v[40:43]
  s_cbranch_vccz SL_x_12_ok1
  s_branch SL_x_12_x1
SL_x_012_ok1:
  v_mfma_f32_16x16x32_bf16 v[44:47], v[68:71], v[68:71], v[44:47]
  v_max3_u32 v31, v72, v73, v74
  v_max_u32 v31, v31, v75
  v_cmp_eq_u32 vcc, -1, v31
  v_mfma_f32_16x16x32_bf16 v[36:39], v[120:123], v[68:71], v[36:39]
  v_mfma_f32_16x16x32_bf16 v[40:43], v[136:139], v[68:71], v[40:43]
  s_cbranch_vccz SL_x_02_ok2
  s_branch SL_x_02_x2
SL_x_012_ok2:
  v_mfma_f32_16x16x32_bf16 v[44:47], v[72:75], v[72:75], v[44:47]
  v_max3_u32 v31, v64, v65, v66
  v_max_u32 v31, v31, v67
  v_cmp_eq_u32 vcc, -1, v31
  v_mfma_f32_16x16x32_bf16 v[36:39], v[124:127], v[72:75], v[36:39]
  v_mfma_f32_16x16x32_bf16 v[40:43], v[140:143], v[72:75], v[40:43]
  s_cbranch_vccz SL_x_01_ok0
  s_branch SL_x_01_x0
SL_x_013_c0:
  v_max3_u32 v31, v64, v65, v66
  v_max_u32 v31, v31, v67
  v_cmp_eq_u32 vcc, -1, v31
  s_cbranch_vccz SL_x_013_ok0
SL_x_013_x0:
  s_mov_b64 exec, vcc
  buffer_load_dwordx4 v[64:67], v9, s[4:7], s41 offen offset:0 sc1
  s_mov_b64 exec, -1
SL_x_013_c1:
  v_max3_u32 v31, v68, v69, v70
  v_max_u32 v31, v31, v71
  v_cmp_eq_u32 vcc, -1, v31
  s_cbranch_vccz SL_x_013_ok1
SL_x_013_x1:
  s_mov_b64 exec, vcc
  buffer_load_dwordx4 v[68:71], v9, s[4:7], s41 offen offset:1024 sc1
  s_mov_b64 exec, -1
SL_x_013_c3:
  v_max3_u32 v31, v76, v77, v78
  v_max_u32 v31, v31, v79
  v_cmp_eq_u32 vcc, -1, v31
  s_cbranch_vccz SL_x_013_ok3
SL_x_013_x3:
  s_mov_b64 exec, vcc
  buffer_load_dwordx4 v[76:79], v9, s[4:7], s41 offen offset:3072 sc1
  s_mov_b64 exec, -1
  s_add_u32 s46, s46, 1
  s_cmp_ge_u32 s46, 131072
  s_cbranch_scc1 SL_rec_abort
  s_waitcnt vmcnt(4)
  s_branch SL_x_013_c0
SL_x_013_ok0:
  v_mfma_f32_16x16x32_bf16 v[44:47], v[64:67], v[64:67], v[44:47]
  v_max3_u32 v31, v68, v69, v70
  v_max_u32 v31, v31, v71
  v_cmp_eq_u32 vcc, -1, v31
  v_mfma_f32_16x16x32_bf16 v[36:39], v[116:119], v[64:67], v[36:39]
  v_mfma_f32_16x16x32_bf16 v[40:43], v[132:135], v[64:67], v[40:43]
  s_cbranch_vccz SL_x_13_ok1
  s_branch SL_x_13_x1
SL_x_013_ok1:
  v_mfma_f32_16x16x32_bf16 v[44:47], v[68:71], v[68:71], v[44:47]
  v_max3_u32 v31, v76, v77, v78
  v_max_u32 v31, v31, v79
  v_cmp_eq_u32 vcc, -1, v31
  v_mfma_f32_16x16x32_bf16 v[36:39], v[120:123], v[68:71], v[36:39]
  v_mfma_f32_16x16x32_bf16 v[40:43], v[136:139], v[68:71], v[40:43]
  s_cbranch_vccz SL_x_03_ok3
  s_branch SL_x_03_x3
SL_x_013_ok3:
  v_mfma_f32_16x16x32_bf16 v[44:47], v[76:79], v[76:79], v[44:47]
  v_max3_u32 v31, v64, v65, v66
  v_max_u32 v31, v31, v67
  v_cmp_eq_u32 vcc, -1, v31
  v_mfma_f32_16x16x32_bf16 v[36:39], v[128:131], v[76:79], v[36:39]
  v_mfma_f32_16x16x32_bf16 v[40:43], v[144:147], v[76:79], v[40:43]
  s_cbranch_vccz SL_x_01_ok0
  s_branch SL_x_01_x0
SL_x_023_c0:
  v_max3_u32 v31, v64, v65, v66
  v_max_u32 v31, v31, v67
  v_cmp_eq_u32 vcc, -1, v31
  s_cbranch_vccz SL_x_023_ok0
SL_x_023_x0:
  s_mov_b64 exec, vcc
  buffer_load_dwordx4 v[64:67], v9, s[4:7], s41 offen offset:0 sc1
  s_mov_b64 exec, -1
SL_x_023_c2:
  v_max3_u32 v31, v72, v73, v74
  v_max_u32 v31, v31, v75
  v_cmp_eq_u32 vcc, -1, v31
  s_cbranch_vccz SL_x_023_ok2
SL_x_023_x2:
  s_mov_b64 exec, vcc
  buffer_load_dwordx4 v[72:75], v9, s[4:7], s41 offen offset:2048 sc1
  s_mov_b64 exec, -1
SL_x_023_c3:
  v_max3_u32 v31, v76, v77, v78
  v_max_u32 v31, v31, v79
  v_cmp_eq_u32 vcc, -1, v31
  s_cbranch_vccz SL_x_023_ok3
SL_x_023_x3:
  s_mov_b64 exec, vcc
  buffer_load_dwordx4 v[76:79], v9, s[4:7], s41 offen offset:3072 sc1
  s_mov_b64 exec, -1
  s_add_u32 s46, s46, 1
  s_cmp_ge_u32 s46, 131072
  s_cbranch_scc1 SL_rec_abort
  s_waitcnt vmcnt(4)
  s_branch SL_x_023_c0
SL_x_023_ok0:
  v_mfma_f32_16x16x32_bf16 v[44:47], v[64:67], v[64:67], v[44:47]
  v_max3_u32 v31, v72, v73, v74
  v_max_u32 v31, v31, v75
  v_cmp_eq_u32 vcc, -1, v31
  v_mfma_f32_16x16x32_bf16 v[36:39], v[116:119], v[64:67], v[36:39]
  v_mfma_f32_16x16x32_bf16 v[40:43], v[132:135], v[64:67], v[40:43]
  s_cbranch_vccz SL_x_23_ok2
  s_branch SL_x_23_x2
SL_x_023_ok2:
  v_mfma_f32_16x16x32_bf16 v[44:47], v[72:75], v[72:75], v[44:47]
  v_max3_u32 v31, v76, v77, v78
  v_max_u32 v31, v31, v79
  v_cmp_eq_u32 vcc, -1, v31
  v_mfma_f32_16x16x32_bf16 v[36:39], v[124:127], v[72:75], v[36:39]
  v_mfma_f32_16x16x32_bf16 v[40:43], v[140:143], v[72:75], v[40:43]
  s_cbranch_vccz SL_x_03_ok3
  s_branch SL_x_03_x3
SL_x_023_ok3:
  v_mfma_f32_16x16x32_bf16 v[44:47], v[76:79], v[76:79], v[44:47]
  v_max3_u32 v31, v64, v65, v66
  v_max_u32 v31, v31, v67
  v_cmp_eq_u32 vcc, -1, v31
  v_mfma_f32_16x16x32_bf16 v[36:39], v[128:131], v[76:79], v[36:39]
  v_mfma_f32_16x16x32_bf16 v[40:43], v[144:147], v[76:79], v[40:43]
  s_cbranch_vccz SL_x_02_ok0
  s_branch SL_x_02_x0
SL_x_123_c1:
  v_max3_u32 v31, v68, v69, v70
  v_max_u32 v31, v31, v71
  v_cmp_eq_u32 vcc, -1, v31
  s_cbranch_vccz SL_x_123_ok1
SL_x_123_x1:
  s_mov_b64 exec, vcc
  buffer_load_dwordx4 v[68:71], v9, s[4:7], s41 offen offset:1024 sc1
  s_mov_b64 exec, -1
SL_x_123_c2:
  v_max3_u32 v31, v72, v73, v74
  v_max_u32 v31, v31, v75
  v_cmp_eq_u32 vcc, -1, v31
  s_cbranch_vccz SL_x_123_ok2
SL_x_123_x2:
  s_mov_b64 exec, vcc
  buffer_load_dwordx4 v[72:75], v9, s[4:7], s41 offen offset:2048 sc1
  s_mov_b64 exec, -1
SL_x_123_c3:
  v_max3_u32 v31, v76, v77, v78
  v_max_u32 v31, v31, v79
  v_cmp_eq_u32 vcc, -1, v31
  s_cbranch_vccz SL_x_123_ok3
SL_x_123_x3:
  s_mov_b64 exec, vcc
  buffer_load_dwordx4 v[76:79], v9, s[4:7], s41 offen offset:3072 sc1
  s_mov_b64 exec, -1
  s_add_u32 s46, s46, 1
  s_cmp_ge_u32 s46, 131072
  s_cbranch_scc1 SL_rec_abort
  s_waitcnt vmcnt(4)
  s_branch SL_x_123_c1
SL_x_123_ok1:
  v_mfma_f32_16x16x32_bf16 v[44:47], v[68:71], v[68:71], v[44:47]
  v_max3_u32 v31, v72, v73, v74
  v_max_u32 v31, v31, v75
  v_cmp_eq_u32 vcc, -1, v31
  v_mfma_f32_16x16x32_bf16 v[36:39], v[120:123], v[68:71], v[36:39]
  v_mfma_f32_16x16x32_bf16 v[40:43], v[136:139], v[68:71], v[40:43]
  s_cbranch_vccz SL_x_23_ok2
  s_branch SL_x_23_x2
SL_x_123_ok2:
  v_mfma_f32_16x16x32_bf16 v[44:47], v[72:75], v[72:75], v[44:47]
  v_max3_u32 v31, v76, v77, v78
  v_max_u32 v31, v31, v79
  v_cmp_eq_u32 vcc, -1, v31
  v_mfma_f32_16x16x32_bf16 v[36:39], v[124:127], v[72:75], v[36:39]
  v_mfma_f32_16x16x32_bf16 v[40:43], v[140:143], v[72:75], v[40:43]
  s_cbranch_vccz SL_x_13_ok3
  s_branch SL_x_13_x3
SL_x_123_ok3:
  v_mfma_f32_16x16x32_bf16 v[44:47], v[76:79], v[76:79], v[44:47]
  v_max3_u32 v31, v68, v69, v70
  v_max_u32 v31, v31, v71
  v_cmp_eq_u32 vcc, -1, v31
  v_mfma_f32_16x16x32_bf16 v[36:39], v[128:131], v[76:79], v[36:39]
  v_mfma_f32_16x16x32_bf16 v[40:43], v[144:147], v[76:79], v[40:43]
  s_cbranch_vccz SL_x_12_ok1
  s_branch SL_x_12_x1
SL_x_0123_c0:
  v_max3_u32 v31, v64, v65, v66
  v_max_u32 v31, v31, v67
  v_cmp_eq_u32 vcc, -1, v31
  s_cbranch_vccz SL_x_0123_ok0
SL_x_0123_x0:
  s_mov_b64 exec, vcc
  buffer_load_dwordx4 v[64:67], v9, s[4:7], s41 offen offset:0 sc1
  s_mov_b64 exec, -1
SL_x_0123_c1:
  v_max3_u32 v31, v68, v69, v70
  v_max_u32 v31, v31, v71
  v_cmp_eq_u32 vcc, -1, v31
  s_cbranch_vccz SL_x_0123_ok1
SL_x_0123_x1:
  s_mov_b64 exec, vcc
  buffer_load_dwordx4 v[68:71], v9, s[4:7], s41 offen offset:1024 sc1
  s_mov_b64 exec, -1
SL_x_0123_c2:
  v_max3_u32 v31, v72, v73, v74
  v_max_u32 v31, v31, v75
  v_cmp_eq_u32 vcc, -1, v31
  s_cbranch_vccz SL_x_0123_ok2
SL_x_0123_x2:
  s_mov_b64 exec, vcc
  buffer_load_dwordx4 v[72:75], v9, s[4:7], s41 offen offset:2048 sc1
  s_mov_b64 exec, -1
SL_x_0123_c3:
  v_max3_u32 v31, v76, v77, v78
  v_max_u32 v31, v31, v79
  v_cmp_eq_u32 vcc, -1, v31
  s_cbranch_vccz SL_x_0123_ok3
SL_x_0123_x3:
  s_mov_b64 exec, vcc
  buffer_load_dwordx4 v[76:79], v9, s[4:7], s41 offen offset:3072 sc1
  s_mov_b64 exec, -1
  s_add_u32 s46, s46, 1
  s_cmp_ge_u32 s46, 131072
  s_cbranch_scc1 SL_rec_abort
  s_waitcnt vmcnt(4)
  s_branch SL_x_0123_c0
SL_x_0123_ok0:
  v_mfma_f32_16x16x32_bf16 v[44:47], v[64:67], v[64:67], v[44:47]
  v_max3_u32 v31, v68, v69, v70
  v_max_u32 v31, v31, v71
  v_cmp_eq_u32 vcc, -1, v31
  v_mfma_f32_16x16x32_bf16 v[36:39], v[116:119], v[64:67], v[36:39]
  v_mfma_f32_16x16x32_bf16 v[40:43], v[132:135], v[64:67], v[40:43]
  s_cbranch_vccz SL_x_123_ok1
  s_branch SL_x_123_x1
SL_x_0123_ok1:
  v_mfma_f32_16x16x32_bf16 v[44:47], v[68:71], v[68:71], v[44:47]
  v_max3_u32 v31, v72, v73, v74
  v_max_u32 v31, v31, v75
  v_cmp_eq_u32 vcc, -1, v31
  v_mfma_f32_16x16x32_bf16 v[36:39], v[120:123], v[68:71], v[36:39]
  v_mfma_f32_16x16x32_bf16 v[40:43], v[136:139], v[68:71], v[40:43]
  s_cbranch_vccz SL_x_023_ok2
  s_branch SL_x_023_x2
SL_x_0123_ok2:
  v_mfma_f32_16x16x32_bf16 v[44:47], v[72:75], v[72:75], v[44:47]
  v_max3_u32 v31, v76, v77, v78
  v_max_u32 v31, v31, v79
  v_cmp_eq_u32 vcc, -1, v31
  v_mfma_f32_16x16x32_bf16 v[36:39], v[124:127], v[72:75], v[36:39]
  v_mfma_f32_16x16x32_bf16 v[40:43], v[140:143], v[72:75], v[40:43]
  s_cbranch_vccz SL_x_013_ok3
  s_branch SL_x_013_x3
SL_x_0123_ok3:
  v_mfma_f32_16x16x32_bf16 v[44:47], v[76:79], v[76:79], v[44:47]
  v_max3_u32 v31, v64, v65, v66
  v_max_u32 v31, v31, v67
  v_cmp_eq_u32 vcc, -1, v31
  v_mfma_f32_16x16x32_bf16 v[36:39], v[128:131], v[76:79], v[36:39]
  v_mfma_f32_16x16x32_bf16 v[40:43], v[144:147], v[76:79], v[40:43]
  s_cbranch_vccz SL_x_012_ok0
  s_branch SL_x_012_x0
SL_v_f:
  buffer_load_dwordx4 v[88:91], v10, s[4:7], s41 offen offset:0 sc1
  buffer_load_dwordx4 v[92:95], v10, s[4:7], s41 offen offset:1024 sc1
  s_add_u32 s46, s46, 1
  s_cmp_ge_u32 s46, 131072
  s_cbranch_scc1 SL_rec_abort
  s_waitcnt vmcnt(0)
  v_max3_u32 v31, v88, v89, v90
  v_max3_u32 v31, v31, v91, v92
  v_max3_u32 v31, v31, v93, v94
  v_max_u32 v31, v31, v95
  v_cmp_eq_u32 vcc, -1, v31
  s_cbranch_vccnz SL_v_f
  s_branch SL_v_ok
SL_rec_abort:
  s_waitcnt vmcnt(0)
  s_endpgm
L_join:
  s_load_dwordx16 s[64:79], s[0:1], 0
  v_mbcnt_lo_u32_b32 v0, -1, 0
  v_mbcnt_hi_u32_b32 v0, -1, v0
  s_lshl_b32 s90, s32, 6
  v_add_u32 v0, s90, v0
  s_lshl_b32 s40, s33, 5
  s_add_u32 s40, s40, 128
  s_mov_b32 s39, 1
  s_barrier
  s_branch L_worker1
L_worker:
  s_mov_b32 s39, 0
L_worker1:
  s_load_dwordx4 s[80:83], s[0:1], 64
  s_load_dwordx2 s[84:85], s[0:1], 80
  s_sub_u32 s33, s40, 128
  s_lshr_b32 s33, s33, 5
  s_and_b32 s34, s40, 31
  s_getpc_b64 s[86:87]
L_pc:
  s_add_u32 s86, s86, L_table-L_pc
  s_addc_u32 s87, s87, 0
  s_waitcnt lgkmcnt(0)
  s_mov_b32 s16, s84
  s_and_b32 s17, s85, 0xffff
  s_mov_b32 s18, 0x800000
  s_mov_b32 s19, 0x20000
  s_mov_b32 s8, s64
  s_and_b32 s9, s65, 0xffff
  s_mov_b32 s10, 0x400000
  s_mov_b32 s11, 0x20000
  s_mov_b32 s12, s70
  s_and_b32 s13, s71, 0xffff
  s_mov_b32 s14, 0x800000
  s_mov_b32 s15, 0x20000
  v_mov_b32 v1, 0
  v_mov_b32 v2, 0
  v_mov_b32 v3, 0
  v_mov_b32 v4, 0
  v_mov_b32 v5, 0
  v_mov_b32 v6, 0
  v_mov_b32 v7, 0
  v_mov_b32 v8, 0
  v_mov_b32 v9, 0
  v_mov_b32 v10, 0
  v_mov_b32 v11, 0
  v_mov_b32 v12, 0
  v_mov_b32 v13, 0
  v_mov_b32 v14, 0
  v_mov_b32 v15, 0
  v_mov_b32 v16, 0
  v_mov_b32 v17, 0
  v_mov_b32 v172, 0
  v_mov_b32 v173, 0
  s_mov_b32 s59, 0
  s_cmp_eq_u32 s39, 0
  s_cbranch_scc1 L_have
L_next:
  s_cmp_lg_u32 s32, 0
  s_cbranch_scc1 L_rq_1
  s_cmp_eq_u32 s39, 0
  s_cbranch_scc1 L_rq_1
  s_lshl_b32 s99, s33, 7
  s_add_u32 s99, s99, 0x3d00200
  v_mov_b32 v244, 1
  v_mov_b32 v245, 0
  s_mov_b64 exec, 1
  buffer_atomic_add v244, v245, s[4:7], s99 offen sc0 sc1
  s_mov_b64 exec, -1
L_rq_1:
  s_waitcnt vmcnt(0)
L_got:
  s_cmp_lg_u32 s32, 0
  s_cbranch_scc1 L_nx1
  v_mov_b32 v245, 131072
  s_mov_b64 exec, 1
  ds_write_b32 v245, v244
  s_mov_b64 exec, -1
  s_waitcnt lgkmcnt(0)
L_nx1:
  s_barrier
  v_mov_b32 v245, 131072
  ds_read_b32 v246, v245
  s_waitcnt lgkmcnt(0)
  v_readfirstlane_b32 s34, v246
  s_add_u32 s34, s34, 32
L_have:
  s_mov_b32 s98, 1
  s_min_u32 s90, s34, 366
  s_lshl_b32 s90, s90, 2
  s_load_dword s91, s[86:87], s90
  s_waitcnt lgkmcnt(0)
  s_and_b32 s35, s91, 255
  s_lshr_b32 s36, s91, 8
  s_and_b32 s36, s36, 255
  s_lshr_b32 s37, s91, 16
  s_cmp_eq_u32 s35, 0
  s_cbranch_scc1 L_aqkv
  s_cmp_eq_u32 s35, 1
  s_cbranch_scc1 L_aqkv
  s_cmp_eq_u32 s35, 2
  s_cbranch_scc1 L_aqkv
  s_cmp_eq_u32 s35, 3
  s_cbranch_scc1 L_bqkv
  s_cmp_eq_u32 s35, 9
  s_cbranch_scc1 L_small
  s_cmp_eq_u32 s35, 10
  s_cbranch_scc1 L_small
  s_mov_b32 s58, 0
L_epi:
  s_mov_b32 s46, 0x40000000
  s_mov_b32 s47, 0x40000000
  s_mov_b32 s49, 0
  s_cmp_eq_u32 s59, 0
  s_cbranch_scc1 L_epid
  s_cmp_lg_u32 s59, 1
  s_cbranch_scc1 L_e0
  s_lshr_b32 s90, s27, 1
  s_and_b32 s91, s27, 1
  v_mov_b32 v172, 0x0
  v_bfe_u32 v45, v1, 0, 6
  v_lshl_add_u32 v172, v45, 4, v172
  v_add_u32 v173, 4096, v172
  s_mul_i32 s92, s90, 4
  s_mul_i32 s92, s92, s61
  s_add_u32 s92, s92, s60
  s_mul_i32 s93, s91, 8192
  s_add_u32 s92, s92, s93
  v_accvgpr_read_b32 v52, a0
  v_accvgpr_read_b32 v53, a4
  v_accvgpr_read_b32 v54, a1
  v_accvgpr_read_b32 v55, a5
  v_accvgpr_read_b32 v56, a2
  v_accvgpr_read_b32 v57, a6
  v_accvgpr_read_b32 v58, a3
  v_accvgpr_read_b32 v59, a7
  v_cvt_pk_bf16_f32 v48, v52, v53
  v_cvt_pk_bf16_f32 v49, v54, v55
  v_cvt_pk_bf16_f32 v50, v56, v57
  v_cvt_pk_bf16_f32 v51, v58, v59
  buffer_store_dwordx4 v[48:51], v172, s[4:7], s92 offen offset:0 sc1
  v_accvgpr_read_b32 v64, a128
  v_accvgpr_read_b32 v65, a132
  v_accvgpr_read_b32 v66, a129
  v_accvgpr_read_b32 v67, a133
  v_accvgpr_read_b32 v68, a130
  v_accvgpr_read_b32 v69, a134
  v_accvgpr_read_b32 v70, a131
  v_accvgpr_read_b32 v71, a135
  v_cvt_pk_bf16_f32 v176, v64, v65
  v_cvt_pk_bf16_f32 v177, v66, v67
  v_cvt_pk_bf16_f32 v178, v68, v69
  v_cvt_pk_bf16_f32 v179, v70, v71
  v_accvgpr_read_b32 v76, a8
  v_accvgpr_read_b32 v77, a12
  v_accvgpr_read_b32 v78, a9
  v_accvgpr_read_b32 v79, a13
  v_accvgpr_read_b32 v80, a10
  v_accvgpr_read_b32 v81, a14
  v_accvgpr_read_b32 v82, a11
  v_accvgpr_read_b32 v83, a15
  v_cvt_pk_bf16_f32 v72, v76, v77
  v_cvt_pk_bf16_f32 v73, v78, v79
  v_cvt_pk_bf16_f32 v74, v80, v81
  v_cvt_pk_bf16_f32 v75, v82, v83
  buffer_store_dwordx4 v[72:75], v172, s[4:7], s92 offen offset:1024 sc1
  v_accvgpr_read_b32 v88, a136
  v_accvgpr_read_b32 v89, a140
  v_accvgpr_read_b32 v90, a137
  v_accvgpr_read_b32 v91, a141
  v_accvgpr_read_b32 v92, a138
  v_accvgpr_read_b32 v93, a142
  v_accvgpr_read_b32 v94, a139
  v_accvgpr_read_b32 v95, a143
  v_cvt_pk_bf16_f32 v180, v88, v89
  v_cvt_pk_bf16_f32 v181, v90, v91
  v_cvt_pk_bf16_f32 v182, v92, v93
  v_cvt_pk_bf16_f32 v183, v94, v95
  v_accvgpr_read_b32 v52, a16
  v_accvgpr_read_b32 v53, a20
  v_accvgpr_read_b32 v54, a17
  v_accvgpr_read_b32 v55, a21
  v_accvgpr_read_b32 v56, a18
  v_accvgpr_read_b32 v57, a22
  v_accvgpr_read_b32 v58, a19
  v_accvgpr_read_b32 v59, a23
  v_cvt_pk_bf16_f32 v48, v52, v53
  v_cvt_pk_bf16_f32 v49, v54, v55
  v_cvt_pk_bf16_f32 v50, v56, v57
  v_cvt_pk_bf16_f32 v51, v58, v59
  buffer_store_dwordx4 v[48:51], v172, s[4:7], s92 offen offset:2048 sc1
  v_accvgpr_read_b32 v64, a144
  v_accvgpr_read_b32 v65, a148
  v_accvgpr_read_b32 v66, a145
  v_accvgpr_read_b32 v67, a149
  v_accvgpr_read_b32 v68, a146
  v_accvgpr_read_b32 v69, a150
  v_accvgpr_read_b32 v70, a147
  v_accvgpr_read_b32 v71, a151
  v_cvt_pk_bf16_f32 v184, v64, v65
  v_cvt_pk_bf16_f32 v185, v66, v67
  v_cvt_pk_bf16_f32 v186, v68, v69
  v_cvt_pk_bf16_f32 v187, v70, v71
  v_accvgpr_read_b32 v76, a24
  v_accvgpr_read_b32 v77, a28
  v_accvgpr_read_b32 v78, a25
  v_accvgpr_read_b32 v79, a29
  v_accvgpr_read_b32 v80, a26
  v_accvgpr_read_b32 v81, a30
  v_accvgpr_read_b32 v82, a27
  v_accvgpr_read_b32 v83, a31
  v_cvt_pk_bf16_f32 v72, v76, v77
  v_cvt_pk_bf16_f32 v73, v78, v79
  v_cvt_pk_bf16_f32 v74, v80, v81
  v_cvt_pk_bf16_f32 v75, v82, v83
  buffer_store_dwordx4 v[72:75], v172, s[4:7], s92 offen offset:3072 sc1
  v_accvgpr_read_b32 v88, a152
  v_accvgpr_read_b32 v89, a156
  v_accvgpr_read_b32 v90, a153
  v_accvgpr_read_b32 v91, a157
  v_accvgpr_read_b32 v92, a154
  v_accvgpr_read_b32 v93, a158
  v_accvgpr_read_b32 v94, a155
  v_accvgpr_read_b32 v95, a159
  v_cvt_pk_bf16_f32 v188, v88, v89
  v_cvt_pk_bf16_f32 v189, v90, v91
  v_cvt_pk_bf16_f32 v190, v92, v93
  v_cvt_pk_bf16_f32 v191, v94, v95
  v_accvgpr_read_b32 v52, a32
  v_accvgpr_read_b32 v53, a36
  v_accvgpr_read_b32 v54, a33
  v_accvgpr_read_b32 v55, a37
  v_accvgpr_read_b32 v56, a34
  v_accvgpr_read_b32 v57, a38
  v_accvgpr_read_b32 v58, a35
  v_accvgpr_read_b32 v59, a39
  v_cvt_pk_bf16_f32 v48, v52, v53
  v_cvt_pk_bf16_f32 v49, v54, v55
  v_cvt_pk_bf16_f32 v50, v56, v57
  v_cvt_pk_bf16_f32 v51, v58, v59
  buffer_store_dwordx4 v[48:51], v173, s[4:7], s92 offen offset:0 sc1
  v_accvgpr_read_b32 v64, a160
  v_accvgpr_read_b32 v65, a164
  v_accvgpr_read_b32 v66, a161
  v_accvgpr_read_b32 v67, a165
  v_accvgpr_read_b32 v68, a162
  v_accvgpr_read_b32 v69, a166
  v_accvgpr_read_b32 v70, a163
  v_accvgpr_read_b32 v71, a167
  v_cvt_pk_bf16_f32 v192, v64, v65
  v_cvt_pk_bf16_f32 v193, v66, v67
  v_cvt_pk_bf16_f32 v194, v68, v69
  v_cvt_pk_bf16_f32 v195, v70, v71
  v_accvgpr_read_b32 v76, a40
  v_accvgpr_read_b32 v77, a44
  v_accvgpr_read_b32 v78, a41
  v_accvgpr_read_b32 v79, a45
  v_accvgpr_read_b32 v80, a42
  v_accvgpr_read_b32 v81, a46
  v_accvgpr_read_b32 v82, a43
  v_accvgpr_read_b32 v83, a47
  v_cvt_pk_bf16_f32 v72, v76, v77
  v_cvt_pk_bf16_f32 v73, v78, v79
  v_cvt_pk_bf16_f32 v74, v80, v81
  v_cvt_pk_bf16_f32 v75, v82, v83
  buffer_store_dwordx4 v[72:75], v173, s[4:7], s92 offen offset:1024 sc1
  v_accvgpr_read_b32 v88, a168
  v_accvgpr_read_b32 v89, a172
  v_accvgpr_read_b32 v90, a169
  v_accvgpr_read_b32 v91, a173
  v_accvgpr_read_b32 v92, a170
  v_accvgpr_read_b32 v93, a174
  v_accvgpr_read_b32 v94, a171
  v_accvgpr_read_b32 v95, a175
  v_cvt_pk_bf16_f32 v196, v88, v89
  v_cvt_pk_bf16_f32 v197, v90, v91
  v_cvt_pk_bf16_f32 v198, v92, v93
  v_cvt_pk_bf16_f32 v199, v94, v95
  v_accvgpr_read_b32 v52, a48
  v_accvgpr_read_b32 v53, a52
  v_accvgpr_read_b32 v54, a49
  v_accvgpr_read_b32 v55, a53
  v_accvgpr_read_b32 v56, a50
  v_accvgpr_read_b32 v57, a54
  v_accvgpr_read_b32 v58, a51
  v_accvgpr_read_b32 v59, a55
  v_cvt_pk_bf16_f32 v48, v52, v53
  v_cvt_pk_bf16_f32 v49, v54, v55
  v_cvt_pk_bf16_f32 v50, v56, v57
  v_cvt_pk_bf16_f32 v51, v58, v59
  buffer_store_dwordx4 v[48:51], v173, s[4:7], s92 offen offset:2048 sc1
  v_accvgpr_read_b32 v64, a176
  v_accvgpr_read_b32 v65, a180
  v_accvgpr_read_b32 v66, a177
  v_accvgpr_read_b32 v67, a181
  v_accvgpr_read_b32 v68, a178
  v_accvgpr_read_b32 v69, a182
  v_accvgpr_read_b32 v70, a179
  v_accvgpr_read_b32 v71, a183
  v_cvt_pk_bf16_f32 v200, v64, v65
  v_cvt_pk_bf16_f32 v201, v66, v67
  v_cvt_pk_bf16_f32 v202, v68, v69
  v_cvt_pk_bf16_f32 v203, v70, v71
  v_accvgpr_read_b32 v76, a56
  v_accvgpr_read_b32 v77, a60
  v_accvgpr_read_b32 v78, a57
  v_accvgpr_read_b32 v79, a61
  v_accvgpr_read_b32 v80, a58
  v_accvgpr_read_b32 v81, a62
  v_accvgpr_read_b32 v82, a59
  v_accvgpr_read_b32 v83, a63
  v_cvt_pk_bf16_f32 v72, v76, v77
  v_cvt_pk_bf16_f32 v73, v78, v79
  v_cvt_pk_bf16_f32 v74, v80, v81
  v_cvt_pk_bf16_f32 v75, v82, v83
  buffer_store_dwordx4 v[72:75], v173, s[4:7], s92 offen offset:3072 sc1
  v_accvgpr_read_b32 v88, a184
  v_accvgpr_read_b32 v89, a188
  v_accvgpr_read_b32 v90, a185
  v_accvgpr_read_b32 v91, a189
  v_accvgpr_read_b32 v92, a186
  v_accvgpr_read_b32 v93, a190
  v_accvgpr_read_b32 v94, a187
  v_accvgpr_read_b32 v95, a191
  v_cvt_pk_bf16_f32 v204, v88, v89
  v_cvt_pk_bf16_f32 v205, v90, v91
  v_cvt_pk_bf16_f32 v206, v92, v93
  v_cvt_pk_bf16_f32 v207, v94, v95
  s_add_u32 s92, s92, s61
  v_accvgpr_read_b32 v52, a64
  v_accvgpr_read_b32 v53, a68
  v_accvgpr_read_b32 v54, a65
  v_accvgpr_read_b32 v55, a69
  v_accvgpr_read_b32 v56, a66
  v_accvgpr_read_b32 v57, a70
  v_accvgpr_read_b32 v58, a67
  v_accvgpr_read_b32 v59, a71
  v_cvt_pk_bf16_f32 v48, v52, v53
  v_cvt_pk_bf16_f32 v49, v54, v55
  v_cvt_pk_bf16_f32 v50, v56, v57
  v_cvt_pk_bf16_f32 v51, v58, v59
  buffer_store_dwordx4 v[48:51], v172, s[4:7], s92 offen offset:0 sc1
  v_accvgpr_read_b32 v64, a192
  v_accvgpr_read_b32 v65, a196
  v_accvgpr_read_b32 v66, a193
  v_accvgpr_read_b32 v67, a197
  v_accvgpr_read_b32 v68, a194
  v_accvgpr_read_b32 v69, a198
  v_accvgpr_read_b32 v70, a195
  v_accvgpr_read_b32 v71, a199
  v_cvt_pk_bf16_f32 v208, v64, v65
  v_cvt_pk_bf16_f32 v209, v66, v67
  v_cvt_pk_bf16_f32 v210, v68, v69
  v_cvt_pk_bf16_f32 v211, v70, v71
  v_accvgpr_read_b32 v76, a72
  v_accvgpr_read_b32 v77, a76
  v_accvgpr_read_b32 v78, a73
  v_accvgpr_read_b32 v79, a77
  v_accvgpr_read_b32 v80, a74
  v_accvgpr_read_b32 v81, a78
  v_accvgpr_read_b32 v82, a75
  v_accvgpr_read_b32 v83, a79
  v_cvt_pk_bf16_f32 v72, v76, v77
  v_cvt_pk_bf16_f32 v73, v78, v79
  v_cvt_pk_bf16_f32 v74, v80, v81
  v_cvt_pk_bf16_f32 v75, v82, v83
  buffer_store_dwordx4 v[72:75], v172, s[4:7], s92 offen offset:1024 sc1
  v_accvgpr_read_b32 v88, a200
  v_accvgpr_read_b32 v89, a204
  v_accvgpr_read_b32 v90, a201
  v_accvgpr_read_b32 v91, a205
  v_accvgpr_read_b32 v92, a202
  v_accvgpr_read_b32 v93, a206
  v_accvgpr_read_b32 v94, a203
  v_accvgpr_read_b32 v95, a207
  v_cvt_pk_bf16_f32 v212, v88, v89
  v_cvt_pk_bf16_f32 v213, v90, v91
  v_cvt_pk_bf16_f32 v214, v92, v93
  v_cvt_pk_bf16_f32 v215, v94, v95
  v_accvgpr_read_b32 v52, a80
  v_accvgpr_read_b32 v53, a84
  v_accvgpr_read_b32 v54, a81
  v_accvgpr_read_b32 v55, a85
  v_accvgpr_read_b32 v56, a82
  v_accvgpr_read_b32 v57, a86
  v_accvgpr_read_b32 v58, a83
  v_accvgpr_read_b32 v59, a87
  v_cvt_pk_bf16_f32 v48, v52, v53
  v_cvt_pk_bf16_f32 v49, v54, v55
  v_cvt_pk_bf16_f32 v50, v56, v57
  v_cvt_pk_bf16_f32 v51, v58, v59
  buffer_store_dwordx4 v[48:51], v172, s[4:7], s92 offen offset:2048 sc1
  v_accvgpr_read_b32 v64, a208
  v_accvgpr_read_b32 v65, a212
  v_accvgpr_read_b32 v66, a209
  v_accvgpr_read_b32 v67, a213
  v_accvgpr_read_b32 v68, a210
  v_accvgpr_read_b32 v69, a214
  v_accvgpr_read_b32 v70, a211
  v_accvgpr_read_b32 v71, a215
  v_cvt_pk_bf16_f32 v216, v64, v65
  v_cvt_pk_bf16_f32 v217, v66, v67
  v_cvt_pk_bf16_f32 v218, v68, v69
  v_cvt_pk_bf16_f32 v219, v70, v71
  v_accvgpr_read_b32 v76, a88
  v_accvgpr_read_b32 v77, a92
  v_accvgpr_read_b32 v78, a89
  v_accvgpr_read_b32 v79, a93
  v_accvgpr_read_b32 v80, a90
  v_accvgpr_read_b32 v81, a94
  v_accvgpr_read_b32 v82, a91
  v_accvgpr_read_b32 v83, a95
  v_cvt_pk_bf16_f32 v72, v76, v77
  v_cvt_pk_bf16_f32 v73, v78, v79
  v_cvt_pk_bf16_f32 v74, v80, v81
  v_cvt_pk_bf16_f32 v75, v82, v83
  buffer_store_dwordx4 v[72:75], v172, s[4:7], s92 offen offset:3072 sc1
  v_accvgpr_read_b32 v88, a216
  v_accvgpr_read_b32 v89, a220
  v_accvgpr_read_b32 v90, a217
  v_accvgpr_read_b32 v91, a221
  v_accvgpr_read_b32 v92, a218
  v_accvgpr_read_b32 v93, a222
  v_accvgpr_read_b32 v94, a219
  v_accvgpr_read_b32 v95, a223
  v_cvt_pk_bf16_f32 v220, v88, v89
  v_cvt_pk_bf16_f32 v221, v90, v91
  v_cvt_pk_bf16_f32 v222, v92, v93
  v_cvt_pk_bf16_f32 v223, v94, v95
  v_accvgpr_read_b32 v52, a96
  v_accvgpr_read_b32 v53, a100
  v_accvgpr_read_b32 v54, a97
  v_accvgpr_read_b32 v55, a101
  v_accvgpr_read_b32 v56, a98
  v_accvgpr_read_b32 v57, a102
  v_accvgpr_read_b32 v58, a99
  v_accvgpr_read_b32 v59, a103
  v_cvt_pk_bf16_f32 v48, v52, v53
  v_cvt_pk_bf16_f32 v49, v54, v55
  v_cvt_pk_bf16_f32 v50, v56, v57
  v_cvt_pk_bf16_f32 v51, v58, v59
  buffer_store_dwordx4 v[48:51], v173, s[4:7], s92 offen offset:0 sc1
  v_accvgpr_read_b32 v64, a224
  v_accvgpr_read_b32 v65, a228
  v_accvgpr_read_b32 v66, a225
  v_accvgpr_read_b32 v67, a229
  v_accvgpr_read_b32 v68, a226
  v_accvgpr_read_b32 v69, a230
  v_accvgpr_read_b32 v70, a227
  v_accvgpr_read_b32 v71, a231
  v_cvt_pk_bf16_f32 v224, v64, v65
  v_cvt_pk_bf16_f32 v225, v66, v67
  v_cvt_pk_bf16_f32 v226, v68, v69
  v_cvt_pk_bf16_f32 v227, v70, v71
  v_accvgpr_read_b32 v76, a104
  v_accvgpr_read_b32 v77, a108
  v_accvgpr_read_b32 v78, a105
  v_accvgpr_read_b32 v79, a109
  v_accvgpr_read_b32 v80, a106
  v_accvgpr_read_b32 v81, a110
  v_accvgpr_read_b32 v82, a107
  v_accvgpr_read_b32 v83, a111
  v_cvt_pk_bf16_f32 v72, v76, v77
  v_cvt_pk_bf16_f32 v73, v78, v79
  v_cvt_pk_bf16_f32 v74, v80, v81
  v_cvt_pk_bf16_f32 v75, v82, v83
  buffer_store_dwordx4 v[72:75], v173, s[4:7], s92 offen offset:1024 sc1
  v_accvgpr_read_b32 v88, a232
  v_accvgpr_read_b32 v89, a236
  v_accvgpr_read_b32 v90, a233
  v_accvgpr_read_b32 v91, a237
  v_accvgpr_read_b32 v92, a234
  v_accvgpr_read_b32 v93, a238
  v_accvgpr_read_b32 v94, a235
  v_accvgpr_read_b32 v95, a239
  v_cvt_pk_bf16_f32 v228, v88, v89
  v_cvt_pk_bf16_f32 v229, v90, v91
  v_cvt_pk_bf16_f32 v230, v92, v93
  v_cvt_pk_bf16_f32 v231, v94, v95
  v_accvgpr_read_b32 v52, a112
  v_accvgpr_read_b32 v53, a116
  v_accvgpr_read_b32 v54, a113
  v_accvgpr_read_b32 v55, a117
  v_accvgpr_read_b32 v56, a114
  v_accvgpr_read_b32 v57, a118
  v_accvgpr_read_b32 v58, a115
  v_accvgpr_read_b32 v59, a119
  v_cvt_pk_bf16_f32 v48, v52, v53
  v_cvt_pk_bf16_f32 v49, v54, v55
  v_cvt_pk_bf16_f32 v50, v56, v57
  v_cvt_pk_bf16_f32 v51, v58, v59
  buffer_store_dwordx4 v[48:51], v173, s[4:7], s92 offen offset:2048 sc1
  v_accvgpr_read_b32 v64, a240
  v_accvgpr_read_b32 v65, a244
  v_accvgpr_read_b32 v66, a241
  v_accvgpr_read_b32 v67, a245
  v_accvgpr_read_b32 v68, a242
  v_accvgpr_read_b32 v69, a246
  v_accvgpr_read_b32 v70, a243
  v_accvgpr_read_b32 v71, a247
  v_cvt_pk_bf16_f32 v232, v64, v65
  v_cvt_pk_bf16_f32 v233, v66, v67
  v_cvt_pk_bf16_f32 v234, v68, v69
  v_cvt_pk_bf16_f32 v235, v70, v71
  v_accvgpr_read_b32 v76, a120
  v_accvgpr_read_b32 v77, a124
  v_accvgpr_read_b32 v78, a121
  v_accvgpr_read_b32 v79, a125
  v_accvgpr_read_b32 v80, a122
  v_accvgpr_read_b32 v81, a126
  v_accvgpr_read_b32 v82, a123
  v_accvgpr_read_b32 v83, a127
  v_cvt_pk_bf16_f32 v72, v76, v77
  v_cvt_pk_bf16_f32 v73, v78, v79
  v_cvt_pk_bf16_f32 v74, v80, v81
  v_cvt_pk_bf16_f32 v75, v82, v83
  buffer_store_dwordx4 v[72:75], v173, s[4:7], s92 offen offset:3072 sc1
  v_accvgpr_read_b32 v88, a248
  v_accvgpr_read_b32 v89, a252
  v_accvgpr_read_b32 v90, a249
  v_accvgpr_read_b32 v91, a253
  v_accvgpr_read_b32 v92, a250
  v_accvgpr_read_b32 v93, a254
  v_accvgpr_read_b32 v94, a251
  v_accvgpr_read_b32 v95, a255
  v_cvt_pk_bf16_f32 v236, v88, v89
  v_cvt_pk_bf16_f32 v237, v90, v91
  v_cvt_pk_bf16_f32 v238, v92, v93
  v_cvt_pk_bf16_f32 v239, v94, v95
  s_add_u32 s92, s92, s61
  s_mov_b32 s46, s92
  s_add_u32 s47, s92, s61
  s_branch L_edef
L_e0:
  s_cmp_lg_u32 s59, 2
  s_cbranch_scc1 L_e1
  s_lshr_b32 s90, s27, 1
  s_and_b32 s91, s27, 1
  v_mov_b32 v172, 0x0
  v_bfe_u32 v45, v1, 0, 6
  v_lshl_add_u32 v172, v45, 4, v172
  v_add_u32 v173, 4096, v172
  s_mul_i32 s92, s90, 4
  s_mul_i32 s92, s92, s61
  s_add_u32 s92, s92, s60
  s_mul_i32 s93, s91, 8192
  s_add_u32 s92, s92, s93
  v_accvgpr_read_b32 v52, a0
  v_accvgpr_read_b32 v53, a1
  v_accvgpr_read_b32 v54, a2
  v_accvgpr_read_b32 v55, a3
  v_accvgpr_read_b32 v56, a32
  v_accvgpr_read_b32 v57, a33
  v_accvgpr_read_b32 v58, a34
  v_accvgpr_read_b32 v59, a35
  v_cvt_pk_bf16_f32 v48, v52, v53
  v_cvt_pk_bf16_f32 v49, v54, v55
  v_cvt_pk_bf16_f32 v50, v56, v57
  v_cvt_pk_bf16_f32 v51, v58, v59
  buffer_store_dwordx4 v[48:51], v172, s[4:7], s92 offen offset:0 sc1
  v_accvgpr_read_b32 v64, a128
  v_accvgpr_read_b32 v65, a129
  v_accvgpr_read_b32 v66, a130
  v_accvgpr_read_b32 v67, a131
  v_accvgpr_read_b32 v68, a160
  v_accvgpr_read_b32 v69, a161
  v_accvgpr_read_b32 v70, a162
  v_accvgpr_read_b32 v71, a163
  v_cvt_pk_bf16_f32 v176, v64, v65
  v_cvt_pk_bf16_f32 v177, v66, v67
  v_cvt_pk_bf16_f32 v178, v68, v69
  v_cvt_pk_bf16_f32 v179, v70, v71
  v_accvgpr_read_b32 v76, a4
  v_accvgpr_read_b32 v77, a5
  v_accvgpr_read_b32 v78, a6
  v_accvgpr_read_b32 v79, a7
  v_accvgpr_read_b32 v80, a36
  v_accvgpr_read_b32 v81, a37
  v_accvgpr_read_b32 v82, a38
  v_accvgpr_read_b32 v83, a39
  v_cvt_pk_bf16_f32 v72, v76, v77
  v_cvt_pk_bf16_f32 v73, v78, v79
  v_cvt_pk_bf16_f32 v74, v80, v81
  v_cvt_pk_bf16_f32 v75, v82, v83
  buffer_store_dwordx4 v[72:75], v172, s[4:7], s92 offen offset:1024 sc1
  v_accvgpr_read_b32 v88, a132
  v_accvgpr_read_b32 v89, a133
  v_accvgpr_read_b32 v90, a134
  v_accvgpr_read_b32 v91, a135
  v_accvgpr_read_b32 v92, a164
  v_accvgpr_read_b32 v93, a165
  v_accvgpr_read_b32 v94, a166
  v_accvgpr_read_b32 v95, a167
  v_cvt_pk_bf16_f32 v180, v88, v89
  v_cvt_pk_bf16_f32 v181, v90, v91
  v_cvt_pk_bf16_f32 v182, v92, v93
  v_cvt_pk_bf16_f32 v183, v94, v95
  v_accvgpr_read_b32 v52, a8
  v_accvgpr_read_b32 v53, a9
  v_accvgpr_read_b32 v54, a10
  v_accvgpr_read_b32 v55, a11
  v_accvgpr_read_b32 v56, a40
  v_accvgpr_read_b32 v57, a41
  v_accvgpr_read_b32 v58, a42
  v_accvgpr_read_b32 v59, a43
  v_cvt_pk_bf16_f32 v48, v52, v53
  v_cvt_pk_bf16_f32 v49, v54, v55
  v_cvt_pk_bf16_f32 v50, v56, v57
  v_cvt_pk_bf16_f32 v51, v58, v59
  buffer_store_dwordx4 v[48:51], v172, s[4:7], s92 offen offset:2048 sc1
  v_accvgpr_read_b32 v64, a136
  v_accvgpr_read_b32 v65, a137
  v_accvgpr_read_b32 v66, a138
  v_accvgpr_read_b32 v67, a139
  v_accvgpr_read_b32 v68, a168
  v_accvgpr_read_b32 v69, a169
  v_accvgpr_read_b32 v70, a170
  v_accvgpr_read_b32 v71, a171
  v_cvt_pk_bf16_f32 v184, v64, v65
  v_cvt_pk_bf16_f32 v185, v66, v67
  v_cvt_pk_bf16_f32 v186, v68, v69
  v_cvt_pk_bf16_f32 v187, v70, v71
  v_accvgpr_read_b32 v76, a12
  v_accvgpr_read_b32 v77, a13
  v_accvgpr_read_b32 v78, a14
  v_accvgpr_read_b32 v79, a15
  v_accvgpr_read_b32 v80, a44
  v_accvgpr_read_b32 v81, a45
  v_accvgpr_read_b32 v82, a46
  v_accvgpr_read_b32 v83, a47
  v_cvt_pk_bf16_f32 v72, v76, v77
  v_cvt_pk_bf16_f32 v73, v78, v79
  v_cvt_pk_bf16_f32 v74, v80, v81
  v_cvt_pk_bf16_f32 v75, v82, v83
  buffer_store_dwordx4 v[72:75], v172, s[4:7], s92 offen offset:3072 sc1
  v_accvgpr_read_b32 v88, a140
  v_accvgpr_read_b32 v89, a141
  v_accvgpr_read_b32 v90, a142
  v_accvgpr_read_b32 v91, a143
  v_accvgpr_read_b32 v92, a172
  v_accvgpr_read_b32 v93, a173
  v_accvgpr_read_b32 v94, a174
  v_accvgpr_read_b32 v95, a175
  v_cvt_pk_bf16_f32 v188, v88, v89
  v_cvt_pk_bf16_f32 v189, v90, v91
  v_cvt_pk_bf16_f32 v190, v92, v93
  v_cvt_pk_bf16_f32 v191, v94, v95
  v_accvgpr_read_b32 v52, a16
  v_accvgpr_read_b32 v53, a17
  v_accvgpr_read_b32 v54, a18
  v_accvgpr_read_b32 v55, a19
  v_accvgpr_read_b32 v56, a48
  v_accvgpr_read_b32 v57, a49
  v_accvgpr_read_b32 v58, a50
  v_accvgpr_read_b32 v59, a51
  v_cvt_pk_bf16_f32 v48, v52, v53
  v_cvt_pk_bf16_f32 v49, v54, v55
  v_cvt_pk_bf16_f32 v50, v56, v57
  v_cvt_pk_bf16_f32 v51, v58, v59
  buffer_store_dwordx4 v[48:51], v173, s[4:7], s92 offen offset:0 sc1
  v_accvgpr_read_b32 v64, a144
  v_accvgpr_read_b32 v65, a145
  v_accvgpr_read_b32 v66, a146
  v_accvgpr_read_b32 v67, a147
  v_accvgpr_read_b32 v68, a176
  v_accvgpr_read_b32 v69, a177
  v_accvgpr_read_b32 v70, a178
  v_accvgpr_read_b32 v71, a179
  v_cvt_pk_bf16_f32 v192, v64, v65
  v_cvt_pk_bf16_f32 v193, v66, v67
  v_cvt_pk_bf16_f32 v194, v68, v69
  v_cvt_pk_bf16_f32 v195, v70, v71
  v_accvgpr_read_b32 v76, a20
  v_accvgpr_read_b32 v77, a21
  v_accvgpr_read_b32 v78, a22
  v_accvgpr_read_b32 v79, a23
  v_accvgpr_read_b32 v80, a52
  v_accvgpr_read_b32 v81, a53
  v_accvgpr_read_b32 v82, a54
  v_accvgpr_read_b32 v83, a55
  v_cvt_pk_bf16_f32 v72, v76, v77
  v_cvt_pk_bf16_f32 v73, v78, v79
  v_cvt_pk_bf16_f32 v74, v80, v81
  v_cvt_pk_bf16_f32 v75, v82, v83
  buffer_store_dwordx4 v[72:75], v173, s[4:7], s92 offen offset:1024 sc1
  v_accvgpr_read_b32 v88, a148
  v_accvgpr_read_b32 v89, a149
  v_accvgpr_read_b32 v90, a150
  v_accvgpr_read_b32 v91, a151
  v_accvgpr_read_b32 v92, a180
  v_accvgpr_read_b32 v93, a181
  v_accvgpr_read_b32 v94, a182
  v_accvgpr_read_b32 v95, a183
  v_cvt_pk_bf16_f32 v196, v88, v89
  v_cvt_pk_bf16_f32 v197, v90, v91
  v_cvt_pk_bf16_f32 v198, v92, v93
  v_cvt_pk_bf16_f32 v199, v94, v95
  v_accvgpr_read_b32 v52, a24
  v_accvgpr_read_b32 v53, a25
  v_accvgpr_read_b32 v54, a26
  v_accvgpr_read_b32 v55, a27
  v_accvgpr_read_b32 v56, a56
  v_accvgpr_read_b32 v57, a57
  v_accvgpr_read_b32 v58, a58
  v_accvgpr_read_b32 v59, a59
  v_cvt_pk_bf16_f32 v48, v52, v53
  v_cvt_pk_bf16_f32 v49, v54, v55
  v_cvt_pk_bf16_f32 v50, v56, v57
  v_cvt_pk_bf16_f32 v51, v58, v59
  buffer_store_dwordx4 v[48:51], v173, s[4:7], s92 offen offset:2048 sc1
  v_accvgpr_read_b32 v64, a152
  v_accvgpr_read_b32 v65, a153
  v_accvgpr_read_b32 v66, a154
  v_accvgpr_read_b32 v67, a155
  v_accvgpr_read_b32 v68, a184
  v_accvgpr_read_b32 v69, a185
  v_accvgpr_read_b32 v70, a186
  v_accvgpr_read_b32 v71, a187
  v_cvt_pk_bf16_f32 v200, v64, v65
  v_cvt_pk_bf16_f32 v201, v66, v67
  v_cvt_pk_bf16_f32 v202, v68, v69
  v_cvt_pk_bf16_f32 v203, v70, v71
  v_accvgpr_read_b32 v76, a28
  v_accvgpr_read_b32 v77, a29
  v_accvgpr_read_b32 v78, a30
  v_accvgpr_read_b32 v79, a31
  v_accvgpr_read_b32 v80, a60
  v_accvgpr_read_b32 v81, a61
  v_accvgpr_read_b32 v82, a62
  v_accvgpr_read_b32 v83, a63
  v_cvt_pk_bf16_f32 v72, v76, v77
  v_cvt_pk_bf16_f32 v73, v78, v79
  v_cvt_pk_bf16_f32 v74, v80, v81
  v_cvt_pk_bf16_f32 v75, v82, v83
  buffer_store_dwordx4 v[72:75], v173, s[4:7], s92 offen offset:3072 sc1
  v_accvgpr_read_b32 v88, a156
  v_accvgpr_read_b32 v89, a157
  v_accvgpr_read_b32 v90, a158
  v_accvgpr_read_b32 v91, a159
  v_accvgpr_read_b32 v92, a188
  v_accvgpr_read_b32 v93, a189
  v_accvgpr_read_b32 v94, a190
  v_accvgpr_read_b32 v95, a191
  v_cvt_pk_bf16_f32 v204, v88, v89
  v_cvt_pk_bf16_f32 v205, v90, v91
  v_cvt_pk_bf16_f32 v206, v92, v93
  v_cvt_pk_bf16_f32 v207, v94, v95
  s_add_u32 s92, s92, s61
  v_accvgpr_read_b32 v52, a64
  v_accvgpr_read_b32 v53, a65
  v_accvgpr_read_b32 v54, a66
  v_accvgpr_read_b32 v55, a67
  v_accvgpr_read_b32 v56, a96
  v_accvgpr_read_b32 v57, a97
  v_accvgpr_read_b32 v58, a98
  v_accvgpr_read_b32 v59, a99
  v_cvt_pk_bf16_f32 v48, v52, v53
  v_cvt_pk_bf16_f32 v49, v54, v55
  v_cvt_pk_bf16_f32 v50, v56, v57
  v_cvt_pk_bf16_f32 v51, v58, v59
  buffer_store_dwordx4 v[48:51], v172, s[4:7], s92 offen offset:0 sc1
  v_accvgpr_read_b32 v64, a192
  v_accvgpr_read_b32 v65, a193
  v_accvgpr_read_b32 v66, a194
  v_accvgpr_read_b32 v67, a195
  v_accvgpr_read_b32 v68, a224
  v_accvgpr_read_b32 v69, a225
  v_accvgpr_read_b32 v70, a226
  v_accvgpr_read_b32 v71, a227
  v_cvt_pk_bf16_f32 v208, v64, v65
  v_cvt_pk_bf16_f32 v209, v66, v67
  v_cvt_pk_bf16_f32 v210, v68, v69
  v_cvt_pk_bf16_f32 v211, v70, v71
  v_accvgpr_read_b32 v76, a68
  v_accvgpr_read_b32 v77, a69
  v_accvgpr_read_b32 v78, a70
  v_accvgpr_read_b32 v79, a71
  v_accvgpr_read_b32 v80, a100
  v_accvgpr_read_b32 v81, a101
  v_accvgpr_read_b32 v82, a102
  v_accvgpr_read_b32 v83, a103
  v_cvt_pk_bf16_f32 v72, v76, v77
  v_cvt_pk_bf16_f32 v73, v78, v79
  v_cvt_pk_bf16_f32 v74, v80, v81
  v_cvt_pk_bf16_f32 v75, v82, v83
  buffer_store_dwordx4 v[72:75], v172, s[4:7], s92 offen offset:1024 sc1
  v_accvgpr_read_b32 v88, a196
  v_accvgpr_read_b32 v89, a197
  v_accvgpr_read_b32 v90, a198
  v_accvgpr_read_b32 v91, a199
  v_accvgpr_read_b32 v92, a228
  v_accvgpr_read_b32 v93, a229
  v_accvgpr_read_b32 v94, a230
  v_accvgpr_read_b32 v95, a231
  v_cvt_pk_bf16_f32 v212, v88, v89
  v_cvt_pk_bf16_f32 v213, v90, v91
  v_cvt_pk_bf16_f32 v214, v92, v93
  v_cvt_pk_bf16_f32 v215, v94, v95
  v_accvgpr_read_b32 v52, a72
  v_accvgpr_read_b32 v53, a73
  v_accvgpr_read_b32 v54, a74
  v_accvgpr_read_b32 v55, a75
  v_accvgpr_read_b32 v56, a104
  v_accvgpr_read_b32 v57, a105
  v_accvgpr_read_b32 v58, a106
  v_accvgpr_read_b32 v59, a107
  v_cvt_pk_bf16_f32 v48, v52, v53
  v_cvt_pk_bf16_f32 v49, v54, v55
  v_cvt_pk_bf16_f32 v50, v56, v57
  v_cvt_pk_bf16_f32 v51, v58, v59
  buffer_store_dwordx4 v[48:51], v172, s[4:7], s92 offen offset:2048 sc1
  v_accvgpr_read_b32 v64, a200
  v_accvgpr_read_b32 v65, a201
  v_accvgpr_read_b32 v66, a202
  v_accvgpr_read_b32 v67, a203
  v_accvgpr_read_b32 v68, a232
  v_accvgpr_read_b32 v69, a233
  v_accvgpr_read_b32 v70, a234
  v_accvgpr_read_b32 v71, a235
  v_cvt_pk_bf16_f32 v216, v64, v65
  v_cvt_pk_bf16_f32 v217, v66, v67
  v_cvt_pk_bf16_f32 v218, v68, v69
  v_cvt_pk_bf16_f32 v219, v70, v71
  v_accvgpr_read_b32 v76, a76
  v_accvgpr_read_b32 v77, a77
  v_accvgpr_read_b32 v78, a78
  v_accvgpr_read_b32 v79, a79
  v_accvgpr_read_b32 v80, a108
  v_accvgpr_read_b32 v81, a109
  v_accvgpr_read_b32 v82, a110
  v_accvgpr_read_b32 v83, a111
  v_cvt_pk_bf16_f32 v72, v76, v77
  v_cvt_pk_bf16_f32 v73, v78, v79
  v_cvt_pk_bf16_f32 v74, v80, v81
  v_cvt_pk_bf16_f32 v75, v82, v83
  buffer_store_dwordx4 v[72:75], v172, s[4:7], s92 offen offset:3072 sc1
  v_accvgpr_read_b32 v88, a204
  v_accvgpr_read_b32 v89, a205
  v_accvgpr_read_b32 v90, a206
  v_accvgpr_read_b32 v91, a207
  v_accvgpr_read_b32 v92, a236
  v_accvgpr_read_b32 v93, a237
  v_accvgpr_read_b32 v94, a238
  v_accvgpr_read_b32 v95, a239
  v_cvt_pk_bf16_f32 v220, v88, v89
  v_cvt_pk_bf16_f32 v221, v90, v91
  v_cvt_pk_bf16_f32 v222, v92, v93
  v_cvt_pk_bf16_f32 v223, v94, v95
  v_accvgpr_read_b32 v52, a80
  v_accvgpr_read_b32 v53, a81
  v_accvgpr_read_b32 v54, a82
  v_accvgpr_read_b32 v55, a83
  v_accvgpr_read_b32 v56, a112
  v_accvgpr_read_b32 v57, a113
  v_accvgpr_read_b32 v58, a114
  v_accvgpr_read_b32 v59, a115
  v_cvt_pk_bf16_f32 v48, v52, v53
  v_cvt_pk_bf16_f32 v49, v54, v55
  v_cvt_pk_bf16_f32 v50, v56, v57
  v_cvt_pk_bf16_f32 v51, v58, v59
  buffer_store_dwordx4 v[48:51], v173, s[4:7], s92 offen offset:0 sc1
  v_accvgpr_read_b32 v64, a208
  v_accvgpr_read_b32 v65, a209
  v_accvgpr_read_b32 v66, a210
  v_accvgpr_read_b32 v67, a211
  v_accvgpr_read_b32 v68, a240
  v_accvgpr_read_b32 v69, a241
  v_accvgpr_read_b32 v70, a242
  v_accvgpr_read_b32 v71, a243
  v_cvt_pk_bf16_f32 v224, v64, v65
  v_cvt_pk_bf16_f32 v225, v66, v67
  v_cvt_pk_bf16_f32 v226, v68, v69
  v_cvt_pk_bf16_f32 v227, v70, v71
  v_accvgpr_read_b32 v76, a84
  v_accvgpr_read_b32 v77, a85
  v_accvgpr_read_b32 v78, a86
  v_accvgpr_read_b32 v79, a87
  v_accvgpr_read_b32 v80, a116
  v_accvgpr_read_b32 v81, a117
  v_accvgpr_read_b32 v82, a118
  v_accvgpr_read_b32 v83, a119
  v_cvt_pk_bf16_f32 v72, v76, v77
  v_cvt_pk_bf16_f32 v73, v78, v79
  v_cvt_pk_bf16_f32 v74, v80, v81
  v_cvt_pk_bf16_f32 v75, v82, v83
  buffer_store_dwordx4 v[72:75], v173, s[4:7], s92 offen offset:1024 sc1
  v_accvgpr_read_b32 v88, a212
  v_accvgpr_read_b32 v89, a213
  v_accvgpr_read_b32 v90, a214
  v_accvgpr_read_b32 v91, a215
  v_accvgpr_read_b32 v92, a244
  v_accvgpr_read_b32 v93, a245
  v_accvgpr_read_b32 v94, a246
  v_accvgpr_read_b32 v95, a247
  v_cvt_pk_bf16_f32 v228, v88, v89
  v_cvt_pk_bf16_f32 v229, v90, v91
  v_cvt_pk_bf16_f32 v230, v92, v93
  v_cvt_pk_bf16_f32 v231, v94, v95
  v_accvgpr_read_b32 v52, a88
  v_accvgpr_read_b32 v53, a89
  v_accvgpr_read_b32 v54, a90
  v_accvgpr_read_b32 v55, a91
  v_accvgpr_read_b32 v56, a120
  v_accvgpr_read_b32 v57, a121
  v_accvgpr_read_b32 v58, a122
  v_accvgpr_read_b32 v59, a123
  v_cvt_pk_bf16_f32 v48, v52, v53
  v_cvt_pk_bf16_f32 v49, v54, v55
  v_cvt_pk_bf16_f32 v50, v56, v57
  v_cvt_pk_bf16_f32 v51, v58, v59
  buffer_store_dwordx4 v[48:51], v173, s[4:7], s92 offen offset:2048 sc1
  v_accvgpr_read_b32 v64, a216
  v_accvgpr_read_b32 v65, a217
  v_accvgpr_read_b32 v66, a218
  v_accvgpr_read_b32 v67, a219
  v_accvgpr_read_b32 v68, a248
  v_accvgpr_read_b32 v69, a249
  v_accvgpr_read_b32 v70, a250
  v_accvgpr_read_b32 v71, a251
  v_cvt_pk_bf16_f32 v232, v64, v65
  v_cvt_pk_bf16_f32 v233, v66, v67
  v_cvt_pk_bf16_f32 v234, v68, v69
  v_cvt_pk_bf16_f32 v235, v70, v71
  v_accvgpr_read_b32 v76, a92
  v_accvgpr_read_b32 v77, a93
  v_accvgpr_read_b32 v78, a94
  v_accvgpr_read_b32 v79, a95
  v_accvgpr_read_b32 v80, a124
  v_accvgpr_read_b32 v81, a125
  v_accvgpr_read_b32 v82, a126
  v_accvgpr_read_b32 v83, a127
  v_cvt_pk_bf16_f32 v72, v76, v77
  v_cvt_pk_bf16_f32 v73, v78, v79
  v_cvt_pk_bf16_f32 v74, v80, v81
  v_cvt_pk_bf16_f32 v75, v82, v83
  buffer_store_dwordx4 v[72:75], v173, s[4:7], s92 offen offset:3072 sc1
  v_accvgpr_read_b32 v88, a220
  v_accvgpr_read_b32 v89, a221
  v_accvgpr_read_b32 v90, a222
  v_accvgpr_read_b32 v91, a223
  v_accvgpr_read_b32 v92, a252
  v_accvgpr_read_b32 v93, a253
  v_accvgpr_read_b32 v94, a254
  v_accvgpr_read_b32 v95, a255
  v_cvt_pk_bf16_f32 v236, v88, v89
  v_cvt_pk_bf16_f32 v237, v90, v91
  v_cvt_pk_bf16_f32 v238, v92, v93
  v_cvt_pk_bf16_f32 v239, v94, v95
  s_add_u32 s92, s92, s61
  s_mov_b32 s46, s92
  s_add_u32 s47, s92, s61
  s_branch L_edef
L_e1:
  s_cmp_lg_u32 s59, 3
  s_cbranch_scc1 L_e2
  s_lshr_b32 s90, s27, 1
  s_and_b32 s91, s27, 1
  v_mov_b32 v178, 0x0
  v_bfe_u32 v177, v1, 0, 6
  v_lshl_add_u32 v178, v177, 4, v178
  v_add_u32 v176, 4096, v178
  s_mul_i32 s92, s90, 2
  s_mul_i32 s92, s92, s61
  s_add_u32 s92, s92, s60
  s_mul_i32 s93, s91, 2048
  s_add_u32 s92, s92, s93
  v_accvgpr_read_b32 v184, a0
  v_accvgpr_read_b32 v185, a4
  v_accvgpr_read_b32 v186, a1
  v_accvgpr_read_b32 v187, a5
  v_accvgpr_read_b32 v188, a2
  v_accvgpr_read_b32 v189, a6
  v_accvgpr_read_b32 v190, a3
  v_accvgpr_read_b32 v191, a7
  v_cvt_pk_bf16_f32 v180, v184, v185
  v_cvt_pk_bf16_f32 v181, v186, v187
  v_cvt_pk_bf16_f32 v182, v188, v189
  v_cvt_pk_bf16_f32 v183, v190, v191
  buffer_store_dwordx4 v[180:183], v178, s[4:7], s92 offen offset:0 sc1
  v_accvgpr_read_b32 v196, a8
  v_accvgpr_read_b32 v197, a12
  v_accvgpr_read_b32 v198, a9
  v_accvgpr_read_b32 v199, a13
  v_accvgpr_read_b32 v200, a10
  v_accvgpr_read_b32 v201, a14
  v_accvgpr_read_b32 v202, a11
  v_accvgpr_read_b32 v203, a15
  v_cvt_pk_bf16_f32 v192, v196, v197
  v_cvt_pk_bf16_f32 v193, v198, v199
  v_cvt_pk_bf16_f32 v194, v200, v201
  v_cvt_pk_bf16_f32 v195, v202, v203
  buffer_store_dwordx4 v[192:195], v178, s[4:7], s92 offen offset:1024 sc1
  v_accvgpr_read_b32 v208, a16
  v_accvgpr_read_b32 v209, a20
  v_accvgpr_read_b32 v210, a17
  v_accvgpr_read_b32 v211, a21
  v_accvgpr_read_b32 v212, a18
  v_accvgpr_read_b32 v213, a22
  v_accvgpr_read_b32 v214, a19
  v_accvgpr_read_b32 v215, a23
  v_cvt_pk_bf16_f32 v204, v208, v209
  v_cvt_pk_bf16_f32 v205, v210, v211
  v_cvt_pk_bf16_f32 v206, v212, v213
  v_cvt_pk_bf16_f32 v207, v214, v215
  buffer_store_dwordx4 v[204:207], v176, s[4:7], s92 offen offset:0 sc1
  v_accvgpr_read_b32 v220, a24
  v_accvgpr_read_b32 v221, a28
  v_accvgpr_read_b32 v222, a25
  v_accvgpr_read_b32 v223, a29
  v_accvgpr_read_b32 v224, a26
  v_accvgpr_read_b32 v225, a30
  v_accvgpr_read_b32 v226, a27
  v_accvgpr_read_b32 v227, a31
  v_cvt_pk_bf16_f32 v216, v220, v221
  v_cvt_pk_bf16_f32 v217, v222, v223
  v_cvt_pk_bf16_f32 v218, v224, v225
  v_cvt_pk_bf16_f32 v219, v226, v227
  buffer_store_dwordx4 v[216:219], v176, s[4:7], s92 offen offset:1024 sc1
  s_add_u32 s92, s92, s61
  v_accvgpr_read_b32 v184, a32
  v_accvgpr_read_b32 v185, a36
  v_accvgpr_read_b32 v186, a33
  v_accvgpr_read_b32 v187, a37
  v_accvgpr_read_b32 v188, a34
  v_accvgpr_read_b32 v189, a38
  v_accvgpr_read_b32 v190, a35
  v_accvgpr_read_b32 v191, a39
  v_cvt_pk_bf16_f32 v180, v184, v185
  v_cvt_pk_bf16_f32 v181, v186, v187
  v_cvt_pk_bf16_f32 v182, v188, v189
  v_cvt_pk_bf16_f32 v183, v190, v191
  buffer_store_dwordx4 v[180:183], v178, s[4:7], s92 offen offset:0 sc1
  v_accvgpr_read_b32 v196, a40
  v_accvgpr_read_b32 v197, a44
  v_accvgpr_read_b32 v198, a41
  v_accvgpr_read_b32 v199, a45
  v_accvgpr_read_b32 v200, a42
  v_accvgpr_read_b32 v201, a46
  v_accvgpr_read_b32 v202, a43
  v_accvgpr_read_b32 v203, a47
  v_cvt_pk_bf16_f32 v192, v196, v197
  v_cvt_pk_bf16_f32 v193, v198, v199
  v_cvt_pk_bf16_f32 v194, v200, v201
  v_cvt_pk_bf16_f32 v195, v202, v203
  buffer_store_dwordx4 v[192:195], v178, s[4:7], s92 offen offset:1024 sc1
  v_accvgpr_read_b32 v208, a48
  v_accvgpr_read_b32 v209, a52
  v_accvgpr_read_b32 v210, a49
  v_accvgpr_read_b32 v211, a53
  v_accvgpr_read_b32 v212, a50
  v_accvgpr_read_b32 v213, a54
  v_accvgpr_read_b32 v214, a51
  v_accvgpr_read_b32 v215, a55
  v_cvt_pk_bf16_f32 v204, v208, v209
  v_cvt_pk_bf16_f32 v205, v210, v211
  v_cvt_pk_bf16_f32 v206, v212, v213
  v_cvt_pk_bf16_f32 v207, v214, v215
  buffer_store_dwordx4 v[204:207], v176, s[4:7], s92 offen offset:0 sc1
  v_accvgpr_read_b32 v220, a56
  v_accvgpr_read_b32 v221, a60
  v_accvgpr_read_b32 v222, a57
  v_accvgpr_read_b32 v223, a61
  v_accvgpr_read_b32 v224, a58
  v_accvgpr_read_b32 v225, a62
  v_accvgpr_read_b32 v226, a59
  v_accvgpr_read_b32 v227, a63
  v_cvt_pk_bf16_f32 v216, v220, v221
  v_cvt_pk_bf16_f32 v217, v222, v223
  v_cvt_pk_bf16_f32 v218, v224, v225
  v_cvt_pk_bf16_f32 v219, v226, v227
  buffer_store_dwordx4 v[216:219], v176, s[4:7], s92 offen offset:1024 sc1
  s_add_u32 s92, s92, s61
  s_branch L_esig
L_e2:
  s_cmp_lg_u32 s59, 4
  s_cbranch_scc1 L_e3
  s_lshr_b32 s90, s27, 1
  s_and_b32 s91, s27, 1
  v_mov_b32 v178, 0x0
  v_bfe_u32 v177, v1, 0, 6
  v_lshl_add_u32 v178, v177, 4, v178
  v_add_u32 v176, 4096, v178
  s_mul_i32 s92, s90, 2
  s_mul_i32 s92, s92, s61
  s_add_u32 s92, s92, s60
  s_mul_i32 s93, s91, 4096
  s_add_u32 s92, s92, s93
  v_accvgpr_read_b32 v184, a0
  v_accvgpr_read_b32 v185, a1
  v_accvgpr_read_b32 v186, a2
  v_accvgpr_read_b32 v187, a3
  v_accvgpr_read_b32 v188, a16
  v_accvgpr_read_b32 v189, a17
  v_accvgpr_read_b32 v190, a18
  v_accvgpr_read_b32 v191, a19
  v_cvt_pk_bf16_f32 v180, v184, v185
  v_cvt_pk_bf16_f32 v181, v186, v187
  v_cvt_pk_bf16_f32 v182, v188, v189
  v_cvt_pk_bf16_f32 v183, v190, v191
  buffer_store_dwordx4 v[180:183], v178, s[4:7], s92 offen offset:0 sc1
  v_accvgpr_read_b32 v196, a4
  v_accvgpr_read_b32 v197, a5
  v_accvgpr_read_b32 v198, a6
  v_accvgpr_read_b32 v199, a7
  v_accvgpr_read_b32 v200, a20
  v_accvgpr_read_b32 v201, a21
  v_accvgpr_read_b32 v202, a22
  v_accvgpr_read_b32 v203, a23
  v_cvt_pk_bf16_f32 v192, v196, v197
  v_cvt_pk_bf16_f32 v193, v198, v199
  v_cvt_pk_bf16_f32 v194, v200, v201
  v_cvt_pk_bf16_f32 v195, v202, v203
  buffer_store_dwordx4 v[192:195], v178, s[4:7], s92 offen offset:1024 sc1
  v_accvgpr_read_b32 v208, a8
  v_accvgpr_read_b32 v209, a9
  v_accvgpr_read_b32 v210, a10
  v_accvgpr_read_b32 v211, a11
  v_accvgpr_read_b32 v212, a24
  v_accvgpr_read_b32 v213, a25
  v_accvgpr_read_b32 v214, a26
  v_accvgpr_read_b32 v215, a27
  v_cvt_pk_bf16_f32 v204, v208, v209
  v_cvt_pk_bf16_f32 v205, v210, v211
  v_cvt_pk_bf16_f32 v206, v212, v213
  v_cvt_pk_bf16_f32 v207, v214, v215
  buffer_store_dwordx4 v[204:207], v178, s[4:7], s92 offen offset:2048 sc1
  v_accvgpr_read_b32 v220, a12
  v_accvgpr_read_b32 v221, a13
  v_accvgpr_read_b32 v222, a14
  v_accvgpr_read_b32 v223, a15
  v_accvgpr_read_b32 v224, a28
  v_accvgpr_read_b32 v225, a29
  v_accvgpr_read_b32 v226, a30
  v_accvgpr_read_b32 v227, a31
  v_cvt_pk_bf16_f32 v216, v220, v221
  v_cvt_pk_bf16_f32 v217, v222, v223
  v_cvt_pk_bf16_f32 v218, v224, v225
  v_cvt_pk_bf16_f32 v219, v226, v227
  buffer_store_dwordx4 v[216:219], v178, s[4:7], s92 offen offset:3072 sc1
  s_add_u32 s92, s92, s61
  v_accvgpr_read_b32 v184, a32
  v_accvgpr_read_b32 v185, a33
  v_accvgpr_read_b32 v186, a34
  v_accvgpr_read_b32 v187, a35
  v_accvgpr_read_b32 v188, a48
  v_accvgpr_read_b32 v189, a49
  v_accvgpr_read_b32 v190, a50
  v_accvgpr_read_b32 v191, a51
  v_cvt_pk_bf16_f32 v180, v184, v185
  v_cvt_pk_bf16_f32 v181, v186, v187
  v_cvt_pk_bf16_f32 v182, v188, v189
  v_cvt_pk_bf16_f32 v183, v190, v191
  buffer_store_dwordx4 v[180:183], v178, s[4:7], s92 offen offset:0 sc1
  v_accvgpr_read_b32 v196, a36
  v_accvgpr_read_b32 v197, a37
  v_accvgpr_read_b32 v198, a38
  v_accvgpr_read_b32 v199, a39
  v_accvgpr_read_b32 v200, a52
  v_accvgpr_read_b32 v201, a53
  v_accvgpr_read_b32 v202, a54
  v_accvgpr_read_b32 v203, a55
  v_cvt_pk_bf16_f32 v192, v196, v197
  v_cvt_pk_bf16_f32 v193, v198, v199
  v_cvt_pk_bf16_f32 v194, v200, v201
  v_cvt_pk_bf16_f32 v195, v202, v203
  buffer_store_dwordx4 v[192:195], v178, s[4:7], s92 offen offset:1024 sc1
  v_accvgpr_read_b32 v208, a40
  v_accvgpr_read_b32 v209, a41
  v_accvgpr_read_b32 v210, a42
  v_accvgpr_read_b32 v211, a43
  v_accvgpr_read_b32 v212, a56
  v_accvgpr_read_b32 v213, a57
  v_accvgpr_read_b32 v214, a58
  v_accvgpr_read_b32 v215, a59
  v_cvt_pk_bf16_f32 v204, v208, v209
  v_cvt_pk_bf16_f32 v205, v210, v211
  v_cvt_pk_bf16_f32 v206, v212, v213
  v_cvt_pk_bf16_f32 v207, v214, v215
  buffer_store_dwordx4 v[204:207], v178, s[4:7], s92 offen offset:2048 sc1
  v_accvgpr_read_b32 v220, a44
  v_accvgpr_read_b32 v221, a45
  v_accvgpr_read_b32 v222, a46
  v_accvgpr_read_b32 v223, a47
  v_accvgpr_read_b32 v224, a60
  v_accvgpr_read_b32 v225, a61
  v_accvgpr_read_b32 v226, a62
  v_accvgpr_read_b32 v227, a63
  v_cvt_pk_bf16_f32 v216, v220, v221
  v_cvt_pk_bf16_f32 v217, v222, v223
  v_cvt_pk_bf16_f32 v218, v224, v225
  v_cvt_pk_bf16_f32 v219, v226, v227
  buffer_store_dwordx4 v[216:219], v178, s[4:7], s92 offen offset:3072 sc1
  s_add_u32 s92, s92, s61
  s_branch L_esig
L_e3:
  s_cmp_lg_u32 s59, 5
  s_cbranch_scc1 L_e4
  s_lshr_b32 s90, s27, 1
  s_and_b32 s91, s27, 1
  v_and_b32 v176, 15, v1
  v_mul_lo_u32 v176, v176, s61
  v_lshrrev_b32 v177, 4, v1
  v_lshl_add_u32 v178, v177, 4, v176
  s_mul_i32 s92, s90, 64
  s_mul_i32 s92, s92, s61
  s_add_u32 s92, s92, s60
  s_mul_i32 s93, s91, 128
  s_add_u32 s92, s92, s93
  s_lshl_b32 s94, s61, 4
  v_accvgpr_read_b32 v184, a0
  v_accvgpr_read_b32 v185, a1
  v_accvgpr_read_b32 v186, a2
  v_accvgpr_read_b32 v187, a3
  v_accvgpr_read_b32 v188, a4
  v_accvgpr_read_b32 v189, a5
  v_accvgpr_read_b32 v190, a6
  v_accvgpr_read_b32 v191, a7
  v_cvt_pk_bf16_f32 v180, v184, v185
  v_cvt_pk_bf16_f32 v181, v186, v187
  v_cvt_pk_bf16_f32 v182, v188, v189
  v_cvt_pk_bf16_f32 v183, v190, v191
  buffer_store_dwordx4 v[180:183], v178, s[16:19], s92 offen offset:0
  v_accvgpr_read_b32 v196, a8
  v_accvgpr_read_b32 v197, a9
  v_accvgpr_read_b32 v198, a10
  v_accvgpr_read_b32 v199, a11
  v_accvgpr_read_b32 v200, a12
  v_accvgpr_read_b32 v201, a13
  v_accvgpr_read_b32 v202, a14
  v_accvgpr_read_b32 v203, a15
  v_cvt_pk_bf16_f32 v192, v196, v197
  v_cvt_pk_bf16_f32 v193, v198, v199
  v_cvt_pk_bf16_f32 v194, v200, v201
  v_cvt_pk_bf16_f32 v195, v202, v203
  buffer_store_dwordx4 v[192:195], v178, s[16:19], s92 offen offset:64
  s_add_u32 s92, s92, s94
  v_accvgpr_read_b32 v208, a16
  v_accvgpr_read_b32 v209, a17
  v_accvgpr_read_b32 v210, a18
  v_accvgpr_read_b32 v211, a19
  v_accvgpr_read_b32 v212, a20
  v_accvgpr_read_b32 v213, a21
  v_accvgpr_read_b32 v214, a22
  v_accvgpr_read_b32 v215, a23
  v_cvt_pk_bf16_f32 v204, v208, v209
  v_cvt_pk_bf16_f32 v205, v210, v211
  v_cvt_pk_bf16_f32 v206, v212, v213
  v_cvt_pk_bf16_f32 v207, v214, v215
  buffer_store_dwordx4 v[204:207], v178, s[16:19], s92 offen offset:0
  v_accvgpr_read_b32 v220, a24
  v_accvgpr_read_b32 v221, a25
  v_accvgpr_read_b32 v222, a26
  v_accvgpr_read_b32 v223, a27
  v_accvgpr_read_b32 v224, a28
  v_accvgpr_read_b32 v225, a29
  v_accvgpr_read_b32 v226, a30
  v_accvgpr_read_b32 v227, a31
  v_cvt_pk_bf16_f32 v216, v220, v221
  v_cvt_pk_bf16_f32 v217, v222, v223
  v_cvt_pk_bf16_f32 v218, v224, v225
  v_cvt_pk_bf16_f32 v219, v226, v227
  buffer_store_dwordx4 v[216:219], v178, s[16:19], s92 offen offset:64
  s_add_u32 s92, s92, s94
  v_accvgpr_read_b32 v184, a32
  v_accvgpr_read_b32 v185, a33
  v_accvgpr_read_b32 v186, a34
  v_accvgpr_read_b32 v187, a35
  v_accvgpr_read_b32 v188, a36
  v_accvgpr_read_b32 v189, a37
  v_accvgpr_read_b32 v190, a38
  v_accvgpr_read_b32 v191, a39
  v_cvt_pk_bf16_f32 v180, v184, v185
  v_cvt_pk_bf16_f32 v181, v186, v187
  v_cvt_pk_bf16_f32 v182, v188, v189
  v_cvt_pk_bf16_f32 v183, v190, v191
  buffer_store_dwordx4 v[180:183], v178, s[16:19], s92 offen offset:0
  v_accvgpr_read_b32 v196, a40
  v_accvgpr_read_b32 v197, a41
  v_accvgpr_read_b32 v198, a42
  v_accvgpr_read_b32 v199, a43
  v_accvgpr_read_b32 v200, a44
  v_accvgpr_read_b32 v201, a45
  v_accvgpr_read_b32 v202, a46
  v_accvgpr_read_b32 v203, a47
  v_cvt_pk_bf16_f32 v192, v196, v197
  v_cvt_pk_bf16_f32 v193, v198, v199
  v_cvt_pk_bf16_f32 v194, v200, v201
  v_cvt_pk_bf16_f32 v195, v202, v203
  buffer_store_dwordx4 v[192:195], v178, s[16:19], s92 offen offset:64
  s_add_u32 s92, s92, s94
  v_accvgpr_read_b32 v208, a48
  v_accvgpr_read_b32 v209, a49
  v_accvgpr_read_b32 v210, a50
  v_accvgpr_read_b32 v211, a51
  v_accvgpr_read_b32 v212, a52
  v_accvgpr_read_b32 v213, a53
  v_accvgpr_read_b32 v214, a54
  v_accvgpr_read_b32 v215, a55
  v_cvt_pk_bf16_f32 v204, v208, v209
  v_cvt_pk_bf16_f32 v205, v210, v211
  v_cvt_pk_bf16_f32 v206, v212, v213
  v_cvt_pk_bf16_f32 v207, v214, v215
  buffer_store_dwordx4 v[204:207], v178, s[16:19], s92 offen offset:0
  v_accvgpr_read_b32 v220, a56
  v_accvgpr_read_b32 v221, a57
  v_accvgpr_read_b32 v222, a58
  v_accvgpr_read_b32 v223, a59
  v_accvgpr_read_b32 v224, a60
  v_accvgpr_read_b32 v225, a61
  v_accvgpr_read_b32 v226, a62
  v_accvgpr_read_b32 v227, a63
  v_cvt_pk_bf16_f32 v216, v220, v221
  v_cvt_pk_bf16_f32 v217, v222, v223
  v_cvt_pk_bf16_f32 v218, v224, v225
  v_cvt_pk_bf16_f32 v219, v226, v227
  buffer_store_dwordx4 v[216:219], v178, s[16:19], s92 offen offset:64
  s_add_u32 s92, s92, s94
  s_branch L_epid
L_e4:
L_edef:
  s_mov_b32 s49, 1
  s_cmp_eq_u32 s58, 1
  s_cbranch_scc1 L_epid
  s_mov_b32 s49, 0
  buffer_store_dwordx4 v[176:179], v172, s[4:7], s46 offen offset:0 sc1
  buffer_store_dwordx4 v[180:183], v172, s[4:7], s46 offen offset:1024 sc1
  buffer_store_dwordx4 v[184:187], v172, s[4:7], s46 offen offset:2048 sc1
  buffer_store_dwordx4 v[188:191], v172, s[4:7], s46 offen offset:3072 sc1
  buffer_store_dwordx4 v[192:195], v173, s[4:7], s46 offen offset:0 sc1
  buffer_store_dwordx4 v[196:199], v173, s[4:7], s46 offen offset:1024 sc1
  buffer_store_dwordx4 v[200:203], v173, s[4:7], s46 offen offset:2048 sc1
  buffer_store_dwordx4 v[204:207], v173, s[4:7], s46 offen offset:3072 sc1
  buffer_store_dwordx4 v[208:211], v172, s[4:7], s47 offen offset:0 sc1
  buffer_store_dwordx4 v[212:215], v172, s[4:7], s47 offen offset:1024 sc1
  buffer_store_dwordx4 v[216:219], v172, s[4:7], s47 offen offset:2048 sc1
  buffer_store_dwordx4 v[220:223], v172, s[4:7], s47 offen offset:3072 sc1
  buffer_store_dwordx4 v[224:227], v173, s[4:7], s47 offen offset:0 sc1
  buffer_store_dwordx4 v[228:231], v173, s[4:7], s47 offen offset:1024 sc1
  buffer_store_dwordx4 v[232:235], v173, s[4:7], s47 offen offset:2048 sc1
  buffer_store_dwordx4 v[236:239], v173, s[4:7], s47 offen offset:3072 sc1
  s_mov_b32 s46, 0x40000000
  s_mov_b32 s47, 0x40000000
L_esig:
  s_waitcnt vmcnt(0)
  s_cmp_lg_u32 s39, 0
  s_cbranch_scc1 L_vok
  s_cmp_lg_u32 s32, 0
  s_cbranch_scc1 L_vd_3
  v_mbcnt_lo_u32_b32 v250, -1, 0
  v_mbcnt_hi_u32_b32 v250, -1, v250
  v_lshlrev_b32 v250, 2, v250
  s_cmp_lg_u32 s100, 0
  s_cbranch_scc1 L_vw_2
  v_readfirstlane_b32 s90, v247
  s_and_b32 s90, s90, s101
  s_cbranch_scc0 L_vw_2
  v_mov_b32 v251, 1
  s_mov_b64 exec, 1
  buffer_store_dword v251, v250, s[28:31], 0 offen offset:32 sc1
  s_mov_b64 exec, -1
L_vw_2:
  buffer_load_dword v251, v250, s[28:31], 0 offen sc1
  s_waitcnt vmcnt(0)
  v_cmp_eq_u32 vcc, -1, v251
  v_readlane_b32 s91, v251, 8
  v_readlane_b32 s92, v251, 32
  v_readlane_b32 s93, v251, 33
  v_readlane_b32 s90, v251, 34
  s_cmp_lg_u32 s100, 0
  s_cselect_b32 s93, s90, s93
  s_cselect_b32 s91, 0, s91
  s_cselect_b32 s92, 1, s92
  s_cselect_b32 s90, 0xff, vcc_lo
  s_cmp_lg_u32 s91, 0
  s_cselect_b32 s92, 3, s92
  s_cbranch_scc1 L_vk_4
  s_add_u32 s3, s3, 1
  s_cmp_ge_u32 s3, 131072
  s_cselect_b32 s92, 4, s92
  s_cbranch_scc1 L_vk_4
  s_sleep 8
  s_and_b32 s90, s90, 0xff
  s_cmp_lg_u32 s90, 0xff
  s_cbranch_scc1 L_vw_2
  s_cmp_lt_u32 s93, 128
  s_cbranch_scc1 L_vw_2
L_vk_4:
  v_mov_b32 v251, s92
  v_mov_b32 v250, 131072
  ds_write_b32 v250, v251
  s_waitcnt lgkmcnt(0)
L_vd_3:
  s_barrier
  v_mov_b32 v250, 131072
  ds_read_b32 v251, v250
  s_waitcnt lgkmcnt(0)
  v_readfirstlane_b32 s92, v251
  s_barrier
  s_cmp_eq_u32 s92, 3
  s_cbranch_scc1 L_fallback
  s_cmp_eq_u32 s92, 4
  s_cbranch_scc1 L_exit
  s_mov_b32 s39, 1
L_vok:
  s_barrier
  s_cmp_lg_u32 s32, 0
  s_cbranch_scc1 L_sig_5
  v_mov_b32 v254, s63
  v_mov_b32 v255, 0
  v_mbcnt_lo_u32_b32 v255, -1, 0
  v_lshlrev_b32 v255, 9, v255
  s_cmp_eq_u32 s63, 2
  s_cselect_b64 exec, 3, 1
  buffer_atomic_add v254, v255, s[4:7], s62 offen offset:0 sc1
  s_mov_b64 exec, -1
L_sig_5:
L_epid:
  s_mov_b32 s59, 0
  s_cmp_eq_u32 s58, 1
  s_cbranch_scc1 L_r1
  s_cmp_eq_u32 s58, 2
  s_cbranch_scc1 L_r2
  s_cmp_eq_u32 s58, 3
  s_cbranch_scc1 L_next
  s_cmp_eq_u32 s35, 4
  s_cbranch_scc1 L_atb
  s_cmp_eq_u32 s35, 5
  s_cbranch_scc1 L_bo
  s_cmp_eq_u32 s35, 6
  s_cbranch_scc1 L_ata
  s_cmp_eq_u32 s35, 11
  s_cbranch_scc1 L_ata4
  s_cmp_eq_u32 s35, 7
  s_cbranch_scc1 L_ao
  s_cmp_eq_u32 s35, 8
  s_cbranch_scc1 L_aos
  s_cmp_eq_u32 s35, 12
  s_cbranch_scc1 L_swp
  s_cmp_eq_u32 s35, 13
  s_cbranch_scc1 L_aof
  s_branch L_exit
L_aqkv:
  s_mov_b32 s8, s64
  s_and_b32 s9, s65, 0xffff
  s_mov_b32 s10, 0x400000
  s_mov_b32 s11, 0x20000
  s_cmp_eq_u32 s35, 0
  s_cselect_b64 s[88:89], s[68:69], s[70:71]
  s_cmp_eq_u32 s35, 2
  s_cselect_b64 s[88:89], s[72:73], s[88:89]
  s_mov_b32 s12, s88
  s_and_b32 s13, s89, 0xffff
  s_mov_b32 s14, 0x800000
  s_mov_b32 s15, 0x20000
  s_lshl_b32 s91, s33, 2
  s_add_u32 s91, s91, s37
  s_mov_b32 s24, 8192
  s_mov_b32 s26, 262144
  s_lshl_b32 s20, s36, 19
  s_lshl_b32 s21, s91, 9
  s_lshl_b32 s22, s35, 24
  s_lshl_b32 s90, s36, 21
  s_add_u32 s22, s22, s90
  s_lshl_b32 s90, s91, 14
  s_add_u32 s22, s22, s90
  s_lshl_b32 s38, s36, 9
  s_add_u32 s38, s38, 28672
  s_cmp_eq_u32 s35, 0
  s_cselect_b32 s38, 8192, s38
  s_cselect_b32 s98, 1, 2
  s_mov_b32 s48, s35
  s_branch L_g1
L_bqkv:
  s_mov_b32 s8, s78
  s_and_b32 s9, s79, 0xffff
  s_mov_b32 s10, 0x400000
  s_mov_b32 s11, 0x20000
  s_mov_b32 s12, s80
  s_and_b32 s13, s81, 0xffff
  s_mov_b32 s14, 0x600000
  s_mov_b32 s15, 0x20000
  s_lshl_b32 s91, s37, 2
  s_add_u32 s91, s91, s33
  s_mov_b32 s24, 6144
  s_mov_b32 s26, 65536
  s_lshl_b32 s20, s36, 19
  s_lshl_b32 s21, s91, 9
  s_lshl_b32 s22, s37, 22
  s_lshl_b32 s90, s36, 19
  s_add_u32 s22, s22, s90
  s_lshl_b32 s90, s33, 14
  s_add_u32 s22, s22, s90
  s_add_u32 s22, s22, 0x4000000
  s_mov_b32 s38, 12288
  s_mov_b32 s48, s37
L_g1:
  s_lshl_b32 s90, s36, 9
  s_add_u32 s38, s38, s90
  s_lshl_b32 s90, s33, 7
  s_add_u32 s38, s38, s90
  s_mov_b32 s23, 2048
  s_mov_b32 s25, 8
  v_and_b32 v1, 63, v0
  v_lshrrev_b32 v38, 6, v0
  s_nop 0
  v_readfirstlane_b32 s27, v38
  s_mul_i32 s90, s27, 64
  v_lshrrev_b32 v38, 3, v1
  v_add_u32 v38, s90, v38
  v_mul_lo_u32 v38, v38, s23
  v_lshrrev_b32 v39, 4, v1
  v_xor_b32 v39, v39, v1
  v_and_b32 v39, 7, v39
  v_lshl_add_u32 v2, v39, 4, v38
  s_mul_i32 s91, s23, 8
  v_add_u32 v3, s91, v2
  v_xor_b32 v3, 64, v3
  v_add_u32 v4, s91, v3
  v_xor_b32 v4, 64, v4
  v_add_u32 v5, s91, v4
  v_xor_b32 v5, 64, v5
  v_add_u32 v6, s91, v5
  v_xor_b32 v6, 64, v6
  v_add_u32 v7, s91, v6
  v_xor_b32 v7, 64, v7
  v_add_u32 v8, s91, v7
  v_xor_b32 v8, 64, v8
  v_add_u32 v9, s91, v8
  v_xor_b32 v9, 64, v9
  s_mul_i32 s90, s27, 16
  v_lshrrev_b32 v38, 5, v1
  v_add_u32 v38, 0, v38
  v_add_u32 v38, s90, v38
  v_and_b32 v39, 3, v38
  v_lshlrev_b32 v39, 1, v39
  v_and_b32 v40, 8, v38
  v_or_b32 v39, v39, v40
  v_xor_b32 v39, v39, v1
  v_and_b32 v39, 31, v39
  v_mul_lo_u32 v38, v38, s24
  v_lshl_add_u32 v10, v39, 4, v38
  v_lshrrev_b32 v38, 5, v1
  v_add_u32 v38, 2, v38
  v_add_u32 v38, s90, v38
  v_and_b32 v39, 3, v38
  v_lshlrev_b32 v39, 1, v39
  v_and_b32 v40, 8, v38
  v_or_b32 v39, v39, v40
  v_xor_b32 v39, v39, v1
  v_and_b32 v39, 31, v39
  v_mul_lo_u32 v38, v38, s24
  v_lshl_add_u32 v11, v39, 4, v38
  v_lshrrev_b32 v38, 5, v1
  v_add_u32 v38, 4, v38
  v_add_u32 v38, s90, v38
  v_and_b32 v39, 3, v38
  v_lshlrev_b32 v39, 1, v39
  v_and_b32 v40, 8, v38
  v_or_b32 v39, v39, v40
  v_xor_b32 v39, v39, v1
  v_and_b32 v39, 31, v39
  v_mul_lo_u32 v38, v38, s24
  v_lshl_add_u32 v12, v39, 4, v38
  v_lshrrev_b32 v38, 5, v1
  v_add_u32 v38, 6, v38
  v_add_u32 v38, s90, v38
  v_and_b32 v39, 3, v38
  v_lshlrev_b32 v39, 1, v39
  v_and_b32 v40, 8, v38
  v_or_b32 v39, v39, v40
  v_xor_b32 v39, v39, v1
  v_and_b32 v39, 31, v39
  v_mul_lo_u32 v38, v38, s24
  v_lshl_add_u32 v13, v39, 4, v38
  v_lshrrev_b32 v38, 5, v1
  v_add_u32 v38, 8, v38
  v_add_u32 v38, s90, v38
  v_and_b32 v39, 3, v38
  v_lshlrev_b32 v39, 1, v39
  v_and_b32 v40, 8, v38
  v_or_b32 v39, v39, v40
  v_xor_b32 v39, v39, v1
  v_and_b32 v39, 31, v39
  v_mul_lo_u32 v38, v38, s24
  v_lshl_add_u32 v14, v39, 4, v38
  v_lshrrev_b32 v38, 5, v1
  v_add_u32 v38, 10, v38
  v_add_u32 v38, s90, v38
  v_and_b32 v39, 3, v38
  v_lshlrev_b32 v39, 1, v39
  v_and_b32 v40, 8, v38
  v_or_b32 v39, v39, v40
  v_xor_b32 v39, v39, v1
  v_and_b32 v39, 31, v39
  v_mul_lo_u32 v38, v38, s24
  v_lshl_add_u32 v15, v39, 4, v38
  v_lshrrev_b32 v38, 5, v1
  v_add_u32 v38, 12, v38
  v_add_u32 v38, s90, v38
  v_and_b32 v39, 3, v38
  v_lshlrev_b32 v39, 1, v39
  v_and_b32 v40, 8, v38
  v_or_b32 v39, v39, v40
  v_xor_b32 v39, v39, v1
  v_and_b32 v39, 31, v39
  v_mul_lo_u32 v38, v38, s24
  v_lshl_add_u32 v16, v39, 4, v38
  v_lshrrev_b32 v38, 5, v1
  v_add_u32 v38, 14, v38
  v_add_u32 v38, s90, v38
  v_and_b32 v39, 3, v38
  v_lshlrev_b32 v39, 1, v39
  v_and_b32 v40, 8, v38
  v_or_b32 v39, v39, v40
  v_xor_b32 v39, v39, v1
  v_and_b32 v39, 31, v39
  v_mul_lo_u32 v38, v38, s24
  v_lshl_add_u32 v17, v39, 4, v38
  s_mul_i32 s51, s24, 64
  s_mul_i32 s52, s27, 8192
  s_mul_i32 s53, s27, 8192
  s_add_u32 s53, s53, 32768
  s_add_u32 m0, s52, 0
  s_nop 0
  buffer_load_dwordx4 v2, s[8:11], s20 offen  lds
  s_add_u32 m0, s53, 0
  s_nop 0
  buffer_load_dwordx4 v10, s[12:15], s21 offen  lds
  s_add_u32 m0, s52, 1024
  s_nop 0
  buffer_load_dwordx4 v3, s[8:11], s20 offen  lds
  s_add_u32 m0, s53, 1024
  s_nop 0
  buffer_load_dwordx4 v11, s[12:15], s21 offen  lds
  s_add_u32 m0, s52, 2048
  s_nop 0
  buffer_load_dwordx4 v4, s[8:11], s20 offen  lds
  s_add_u32 m0, s53, 2048
  s_nop 0
  buffer_load_dwordx4 v12, s[12:15], s21 offen  lds
  s_add_u32 m0, s52, 3072
  s_nop 0
  buffer_load_dwordx4 v5, s[8:11], s20 offen  lds
  s_add_u32 m0, s53, 3072
  s_nop 0
  buffer_load_dwordx4 v13, s[12:15], s21 offen  lds
  s_add_u32 m0, s52, 4096
  s_nop 0
  buffer_load_dwordx4 v6, s[8:11], s20 offen  lds
  s_add_u32 m0, s53, 4096
  s_nop 0
  buffer_load_dwordx4 v14, s[12:15], s21 offen  lds
  s_add_u32 m0, s52, 5120
  s_nop 0
  buffer_load_dwordx4 v7, s[8:11], s20 offen  lds
  s_add_u32 m0, s53, 5120
  s_nop 0
  buffer_load_dwordx4 v15, s[12:15], s21 offen  lds
  s_add_u32 m0, s52, 6144
  s_nop 0
  buffer_load_dwordx4 v8, s[8:11], s20 offen  lds
  s_add_u32 m0, s53, 6144
  s_nop 0
  buffer_load_dwordx4 v16, s[12:15], s21 offen  lds
  s_add_u32 m0, s52, 7168
  s_nop 0
  buffer_load_dwordx4 v9, s[8:11], s20 offen  lds
  s_add_u32 m0, s53, 7168
  s_nop 0
  buffer_load_dwordx4 v17, s[12:15], s21 offen  lds
  s_add_u32 s20, s20, 128
  s_add_u32 s21, s21, s51
  s_add_u32 m0, s52, 65536
  s_nop 0
  buffer_load_dwordx4 v2, s[8:11], s20 offen  lds
  s_add_u32 m0, s53, 65536
  s_nop 0
  buffer_load_dwordx4 v10, s[12:15], s21 offen  lds
  s_add_u32 m0, s52, 66560
  s_nop 0
  buffer_load_dwordx4 v3, s[8:11], s20 offen  lds
  s_add_u32 m0, s53, 66560
  s_nop 0
  buffer_load_dwordx4 v11, s[12:15], s21 offen  lds
  s_add_u32 m0, s52, 67584
  s_nop 0
  buffer_load_dwordx4 v4, s[8:11], s20 offen  lds
  s_add_u32 m0, s53, 67584
  s_nop 0
  buffer_load_dwordx4 v12, s[12:15], s21 offen  lds
  s_add_u32 m0, s52, 68608
  s_nop 0
  buffer_load_dwordx4 v5, s[8:11], s20 offen  lds
  s_add_u32 m0, s53, 68608
  s_nop 0
  buffer_load_dwordx4 v13, s[12:15], s21 offen  lds
  s_add_u32 m0, s52, 69632
  s_nop 0
  buffer_load_dwordx4 v6, s[8:11], s20 offen  lds
  s_add_u32 m0, s53, 69632
  s_nop 0
  buffer_load_dwordx4 v14, s[12:15], s21 offen  lds
  s_add_u32 m0, s52, 70656
  s_nop 0
  buffer_load_dwordx4 v7, s[8:11], s20 offen  lds
  s_add_u32 m0, s53, 70656
  s_nop 0
  buffer_load_dwordx4 v15, s[12:15], s21 offen  lds
  s_add_u32 m0, s52, 71680
  s_nop 0
  buffer_load_dwordx4 v8, s[8:11], s20 offen  lds
  s_add_u32 m0, s53, 71680
  s_nop 0
  buffer_load_dwordx4 v16, s[12:15], s21 offen  lds
  s_add_u32 m0, s52, 72704
  s_nop 0
  buffer_load_dwordx4 v9, s[8:11], s20 offen  lds
  s_add_u32 m0, s53, 72704
  s_nop 0
  buffer_load_dwordx4 v17, s[12:15], s21 offen  lds
  s_add_u32 s20, s20, 128
  s_add_u32 s21, s21, s51
  s_lshr_b32 s90, s27, 1
  s_and_b32 s91, s27, 1
  s_mul_i32 s92, s90, 16384
  v_mov_b32 v38, 0x0
  v_bfe_u32 v39, v1, 0, 4
  v_lshl_add_u32 v38, v39, 7, v38
  v_add_u32 v38, s92, v38
  v_lshrrev_b32 v39, 1, v1
  v_and_b32 v39, 7, v39
  v_lshrrev_b32 v40, 4, v1
  v_xor_b32 v39, v39, v40
  v_lshl_add_u32 v18, v39, 4, v38
  v_xor_b32 v19, 64, v18
  v_add_u32 v20, 65536, v18
  v_add_u32 v21, 65536, v19
  v_mov_b32 v38, 0x0
  v_bfe_u32 v39, v1, 2, 2
  v_lshl_add_u32 v38, v39, 9, v38
  v_bfe_u32 v39, v1, 4, 2
  v_lshl_add_u32 v38, v39, 12, v38
  v_bfe_u32 v39, v1, 0, 2
  v_lshl_add_u32 v38, v39, 3, v38
  v_bfe_u32 v40, v1, 2, 3
  s_mul_i32 s92, s91, 8
  s_add_u32 s93, s92, 0
  v_xor_b32 v39, s93, v40
  v_lshl_add_u32 v22, v39, 5, v38
  v_add_u32 v30, 65536, v22
  s_add_u32 s93, s92, 1
  v_xor_b32 v39, s93, v40
  v_lshl_add_u32 v23, v39, 5, v38
  v_add_u32 v31, 65536, v23
  s_add_u32 s93, s92, 2
  v_xor_b32 v39, s93, v40
  v_lshl_add_u32 v24, v39, 5, v38
  v_add_u32 v32, 65536, v24
  s_add_u32 s93, s92, 3
  v_xor_b32 v39, s93, v40
  v_lshl_add_u32 v25, v39, 5, v38
  v_add_u32 v33, 65536, v25
  s_add_u32 s93, s92, 4
  v_xor_b32 v39, s93, v40
  v_lshl_add_u32 v26, v39, 5, v38
  v_add_u32 v34, 65536, v26
  s_add_u32 s93, s92, 5
  v_xor_b32 v39, s93, v40
  v_lshl_add_u32 v27, v39, 5, v38
  v_add_u32 v35, 65536, v27
  s_add_u32 s93, s92, 6
  v_xor_b32 v39, s93, v40
  v_lshl_add_u32 v28, v39, 5, v38
  v_add_u32 v36, 65536, v28
  s_add_u32 s93, s92, 7
  v_xor_b32 v39, s93, v40
  v_lshl_add_u32 v29, v39, 5, v38
  v_add_u32 v37, 65536, v29
  s_mov_b32 s58, 1
  s_branch L_epi
L_r1:
  s_cmp_eq_u32 s48, 2
  s_cbranch_scc1 L_g2
  s_waitcnt vmcnt(16)
  s_barrier
  ds_read_b128 v[44:47], v18 offset:0
  ds_read_b64_tr_b16 v[108:109], v22 offset:32768
  ds_read_b64_tr_b16 v[110:111], v22 offset:34816
  ds_read_b128 v[48:51], v18 offset:2048
  ds_read_b64_tr_b16 v[112:113], v23 offset:32768
  ds_read_b64_tr_b16 v[114:115], v23 offset:34816
  ds_read_b128 v[52:55], v18 offset:4096
  ds_read_b64_tr_b16 v[116:117], v24 offset:32768
  ds_read_b64_tr_b16 v[118:119], v24 offset:34816
  ds_read_b128 v[56:59], v18 offset:6144
  ds_read_b64_tr_b16 v[120:121], v25 offset:32768
  ds_read_b64_tr_b16 v[122:123], v25 offset:34816
  ds_read_b128 v[60:63], v18 offset:8192
  ds_read_b64_tr_b16 v[124:125], v26 offset:32768
  ds_read_b64_tr_b16 v[126:127], v26 offset:34816
  ds_read_b128 v[64:67], v18 offset:10240
  ds_read_b64_tr_b16 v[128:129], v27 offset:32768
  ds_read_b64_tr_b16 v[130:131], v27 offset:34816
  ds_read_b128 v[68:71], v18 offset:12288
  ds_read_b64_tr_b16 v[132:133], v28 offset:32768
  ds_read_b64_tr_b16 v[134:135], v28 offset:34816
  ds_read_b128 v[72:75], v18 offset:14336
  ds_read_b64_tr_b16 v[136:137], v29 offset:32768
  ds_read_b64_tr_b16 v[138:139], v29 offset:34816
  s_sub_u32 s25, s25, 1
  s_waitcnt lgkmcnt(0)
  s_nop 0
  v_mfma_f32_16x16x32_bf16 a[0:3], v[108:111], v[44:47], 0
  buffer_store_dwordx4 v[176:179], v172, s[4:7], s46 offen offset:0 sc1
  ds_read_b128 v[76:79], v19 offset:0
  v_mfma_f32_16x16x32_bf16 a[4:7], v[112:115], v[44:47], 0
  v_mfma_f32_16x16x32_bf16 a[8:11], v[116:119], v[44:47], 0
  ds_read_b64_tr_b16 v[140:141], v22 offset:49152
  v_mfma_f32_16x16x32_bf16 a[12:15], v[120:123], v[44:47], 0
  s_nop 0
  v_mfma_f32_16x16x32_bf16 a[16:19], v[124:127], v[44:47], 0
  buffer_store_dwordx4 v[180:183], v172, s[4:7], s46 offen offset:1024 sc1
  ds_read_b64_tr_b16 v[142:143], v22 offset:51200
  v_mfma_f32_16x16x32_bf16 a[20:23], v[128:131], v[44:47], 0
  v_mfma_f32_16x16x32_bf16 a[24:27], v[132:135], v[44:47], 0
  ds_read_b128 v[80:83], v19 offset:2048
  v_mfma_f32_16x16x32_bf16 a[28:31], v[136:139], v[44:47], 0
  s_nop 0
  v_mfma_f32_16x16x32_bf16 a[32:35], v[108:111], v[48:51], 0
  buffer_store_dwordx4 v[184:187], v172, s[4:7], s46 offen offset:2048 sc1
  ds_read_b64_tr_b16 v[144:145], v23 offset:49152
  v_mfma_f32_16x16x32_bf16 a[36:39], v[112:115], v[48:51], 0
  v_mfma_f32_16x16x32_bf16 a[40:43], v[116:119], v[48:51], 0
  ds_read_b64_tr_b16 v[146:147], v23 offset:51200
  v_mfma_f32_16x16x32_bf16 a[44:47], v[120:123], v[48:51], 0
  s_nop 0
  v_mfma_f32_16x16x32_bf16 a[48:51], v[124:127], v[48:51], 0
  buffer_store_dwordx4 v[188:191], v172, s[4:7], s46 offen offset:3072 sc1
  ds_read_b128 v[84:87], v19 offset:4096
  v_mfma_f32_16x16x32_bf16 a[52:55], v[128:131], v[48:51], 0
  v_mfma_f32_16x16x32_bf16 a[56:59], v[132:135], v[48:51], 0
  ds_read_b64_tr_b16 v[148:149], v24 offset:49152
  v_mfma_f32_16x16x32_bf16 a[60:63], v[136:139], v[48:51], 0
  s_nop 0
  v_mfma_f32_16x16x32_bf16 a[64:67], v[108:111], v[52:55], 0
  buffer_store_dwordx4 v[192:195], v173, s[4:7], s46 offen offset:0 sc1
  ds_read_b64_tr_b16 v[150:151], v24 offset:51200
  v_mfma_f32_16x16x32_bf16 a[68:71], v[112:115], v[52:55], 0
  v_mfma_f32_16x16x32_bf16 a[72:75], v[116:119], v[52:55], 0
  ds_read_b128 v[88:91], v19 offset:6144
  v_mfma_f32_16x16x32_bf16 a[76:79], v[120:123], v[52:55], 0
  s_nop 0
  v_mfma_f32_16x16x32_bf16 a[80:83], v[124:127], v[52:55], 0
  buffer_store_dwordx4 v[196:199], v173, s[4:7], s46 offen offset:1024 sc1
  ds_read_b64_tr_b16 v[152:153], v25 offset:49152
  v_mfma_f32_16x16x32_bf16 a[84:87], v[128:131], v[52:55], 0
  v_mfma_f32_16x16x32_bf16 a[88:91], v[132:135], v[52:55], 0
  ds_read_b64_tr_b16 v[154:155], v25 offset:51200
  v_mfma_f32_16x16x32_bf16 a[92:95], v[136:139], v[52:55], 0
  s_nop 0
  v_mfma_f32_16x16x32_bf16 a[96:99], v[108:111], v[56:59], 0
  buffer_store_dwordx4 v[200:203], v173, s[4:7], s46 offen offset:2048 sc1
  ds_read_b128 v[92:95], v19 offset:8192
  v_mfma_f32_16x16x32_bf16 a[100:103], v[112:115], v[56:59], 0
  v_mfma_f32_16x16x32_bf16 a[104:107], v[116:119], v[56:59], 0
  ds_read_b64_tr_b16 v[156:157], v26 offset:49152
  v_mfma_f32_16x16x32_bf16 a[108:111], v[120:123], v[56:59], 0
  s_nop 0
  v_mfma_f32_16x16x32_bf16 a[112:115], v[124:127], v[56:59], 0
  buffer_store_dwordx4 v[204:207], v173, s[4:7], s46 offen offset:3072 sc1
  ds_read_b64_tr_b16 v[158:159], v26 offset:51200
  v_mfma_f32_16x16x32_bf16 a[116:119], v[128:131], v[56:59], 0
  v_mfma_f32_16x16x32_bf16 a[120:123], v[132:135], v[56:59], 0
  ds_read_b128 v[96:99], v19 offset:10240
  v_mfma_f32_16x16x32_bf16 a[124:127], v[136:139], v[56:59], 0
  s_nop 0
  v_mfma_f32_16x16x32_bf16 a[128:131], v[108:111], v[60:63], 0
  buffer_store_dwordx4 v[208:211], v172, s[4:7], s47 offen offset:0 sc1
  ds_read_b64_tr_b16 v[160:161], v27 offset:49152
  v_mfma_f32_16x16x32_bf16 a[132:135], v[112:115], v[60:63], 0
  v_mfma_f32_16x16x32_bf16 a[136:139], v[116:119], v[60:63], 0
  ds_read_b64_tr_b16 v[162:163], v27 offset:51200
  v_mfma_f32_16x16x32_bf16 a[140:143], v[120:123], v[60:63], 0
  s_nop 0
  v_mfma_f32_16x16x32_bf16 a[144:147], v[124:127], v[60:63], 0
  buffer_store_dwordx4 v[212:215], v172, s[4:7], s47 offen offset:1024 sc1
  ds_read_b128 v[100:103], v19 offset:12288
  v_mfma_f32_16x16x32_bf16 a[148:151], v[128:131], v[60:63], 0
  v_mfma_f32_16x16x32_bf16 a[152:155], v[132:135], v[60:63], 0
  ds_read_b64_tr_b16 v[164:165], v28 offset:49152
  v_mfma_f32_16x16x32_bf16 a[156:159], v[136:139], v[60:63], 0
  s_nop 0
  v_mfma_f32_16x16x32_bf16 a[160:163], v[108:111], v[64:67], 0
  buffer_store_dwordx4 v[216:219], v172, s[4:7], s47 offen offset:2048 sc1
  ds_read_b64_tr_b16 v[166:167], v28 offset:51200
  v_mfma_f32_16x16x32_bf16 a[164:167], v[112:115], v[64:67], 0
  v_mfma_f32_16x16x32_bf16 a[168:171], v[116:119], v[64:67], 0
  ds_read_b128 v[104:107], v19 offset:14336
  v_mfma_f32_16x16x32_bf16 a[172:175], v[120:123], v[64:67], 0
  s_nop 0
  v_mfma_f32_16x16x32_bf16 a[176:179], v[124:127], v[64:67], 0
  buffer_store_dwordx4 v[220:223], v172, s[4:7], s47 offen offset:3072 sc1
  ds_read_b64_tr_b16 v[168:169], v29 offset:49152
  v_mfma_f32_16x16x32_bf16 a[180:183], v[128:131], v[64:67], 0
  v_mfma_f32_16x16x32_bf16 a[184:187], v[132:135], v[64:67], 0
  ds_read_b64_tr_b16 v[170:171], v29 offset:51200
  v_mfma_f32_16x16x32_bf16 a[188:191], v[136:139], v[64:67], 0
  s_nop 0
  v_mfma_f32_16x16x32_bf16 a[192:195], v[108:111], v[68:71], 0
  buffer_store_dwordx4 v[224:227], v173, s[4:7], s47 offen offset:0 sc1
  v_mfma_f32_16x16x32_bf16 a[196:199], v[112:115], v[68:71], 0
  v_mfma_f32_16x16x32_bf16 a[200:203], v[116:119], v[68:71], 0
  v_mfma_f32_16x16x32_bf16 a[204:207], v[120:123], v[68:71], 0
  s_nop 0
  v_mfma_f32_16x16x32_bf16 a[208:211], v[124:127], v[68:71], 0
  buffer_store_dwordx4 v[228:231], v173, s[4:7], s47 offen offset:1024 sc1
  v_mfma_f32_16x16x32_bf16 a[212:215], v[128:131], v[68:71], 0
  v_mfma_f32_16x16x32_bf16 a[216:219], v[132:135], v[68:71], 0
  v_mfma_f32_16x16x32_bf16 a[220:223], v[136:139], v[68:71], 0
  s_nop 0
  v_mfma_f32_16x16x32_bf16 a[224:227], v[108:111], v[72:75], 0
  buffer_store_dwordx4 v[232:235], v173, s[4:7], s47 offen offset:2048 sc1
  v_mfma_f32_16x16x32_bf16 a[228:231], v[112:115], v[72:75], 0
  v_mfma_f32_16x16x32_bf16 a[232:235], v[116:119], v[72:75], 0
  v_mfma_f32_16x16x32_bf16 a[236:239], v[120:123], v[72:75], 0
  s_nop 0
  v_mfma_f32_16x16x32_bf16 a[240:243], v[124:127], v[72:75], 0
  buffer_store_dwordx4 v[236:239], v173, s[4:7], s47 offen offset:3072 sc1
  v_mfma_f32_16x16x32_bf16 a[244:247], v[128:131], v[72:75], 0
  v_mfma_f32_16x16x32_bf16 a[248:251], v[132:135], v[72:75], 0
  v_mfma_f32_16x16x32_bf16 a[252:255], v[136:139], v[72:75], 0
  s_waitcnt lgkmcnt(0)
  v_mfma_f32_16x16x32_bf16 a[0:3], v[140:143], v[76:79], a[0:3]
  s_waitcnt vmcnt(16)
  s_barrier
  s_add_u32 m0, s52, 0
  v_mfma_f32_16x16x32_bf16 a[4:7], v[144:147], v[76:79], a[4:7]
  buffer_load_dwordx4 v2, s[8:11], s20 offen  lds
  ds_read_b128 v[44:47], v20 offset:0
  v_mfma_f32_16x16x32_bf16 a[8:11], v[148:151], v[76:79], a[8:11]
  v_mfma_f32_16x16x32_bf16 a[12:15], v[152:155], v[76:79], a[12:15]
  ds_read_b64_tr_b16 v[108:109], v30 offset:32768
  s_add_u32 m0, s53, 0
  v_mfma_f32_16x16x32_bf16 a[16:19], v[156:159], v[76:79], a[16:19]
  buffer_load_dwordx4 v10, s[12:15], s21 offen  lds
  v_mfma_f32_16x16x32_bf16 a[20:23], v[160:163], v[76:79], a[20:23]
  ds_read_b64_tr_b16 v[110:111], v30 offset:34816
  v_mfma_f32_16x16x32_bf16 a[24:27], v[164:167], v[76:79], a[24:27]
  v_mfma_f32_16x16x32_bf16 a[28:31], v[168:171], v[76:79], a[28:31]
  ds_read_b128 v[48:51], v20 offset:2048
  s_add_u32 m0, s52, 1024
  v_mfma_f32_16x16x32_bf16 a[32:35], v[140:143], v[80:83], a[32:35]
  buffer_load_dwordx4 v3, s[8:11], s20 offen  lds
  v_mfma_f32_16x16x32_bf16 a[36:39], v[144:147], v[80:83], a[36:39]
  ds_read_b64_tr_b16 v[112:113], v31 offset:32768
  v_mfma_f32_16x16x32_bf16 a[40:43], v[148:151], v[80:83], a[40:43]
  v_mfma_f32_16x16x32_bf16 a[44:47], v[152:155], v[80:83], a[44:47]
  ds_read_b64_tr_b16 v[114:115], v31 offset:34816
  s_add_u32 m0, s53, 1024
  v_mfma_f32_16x16x32_bf16 a[48:51], v[156:159], v[80:83], a[48:51]
  buffer_load_dwordx4 v11, s[12:15], s21 offen  lds
  v_mfma_f32_16x16x32_bf16 a[52:55], v[160:163], v[80:83], a[52:55]
  ds_read_b128 v[52:55], v20 offset:4096
  v_mfma_f32_16x16x32_bf16 a[56:59], v[164:167], v[80:83], a[56:59]
  s_add_u32 m0, s52, 2048
  v_mfma_f32_16x16x32_bf16 a[60:63], v[168:171], v[80:83], a[60:63]
  buffer_load_dwordx4 v4, s[8:11], s20 offen  lds
  ds_read_b64_tr_b16 v[116:117], v32 offset:32768
  v_mfma_f32_16x16x32_bf16 a[64:67], v[140:143], v[84:87], a[64:67]
  v_mfma_f32_16x16x32_bf16 a[68:71], v[144:147], v[84:87], a[68:71]
  ds_read_b64_tr_b16 v[118:119], v32 offset:34816
  v_mfma_f32_16x16x32_bf16 a[72:75], v[148:151], v[84:87], a[72:75]
  s_add_u32 m0, s53, 2048
  v_mfma_f32_16x16x32_bf16 a[76:79], v[152:155], v[84:87], a[76:79]
  buffer_load_dwordx4 v12, s[12:15], s21 offen  lds
  ds_read_b128 v[56:59], v20 offset:6144
  v_mfma_f32_16x16x32_bf16 a[80:83], v[156:159], v[84:87], a[80:83]
  v_mfma_f32_16x16x32_bf16 a[84:87], v[160:163], v[84:87], a[84:87]
  ds_read_b64_tr_b16 v[120:121], v33 offset:32768
  v_mfma_f32_16x16x32_bf16 a[88:91], v[164:167], v[84:87], a[88:91]
  s_add_u32 m0, s52, 3072
  v_mfma_f32_16x16x32_bf16 a[92:95], v[168:171], v[84:87], a[92:95]
  buffer_load_dwordx4 v5, s[8:11], s20 offen  lds
  ds_read_b64_tr_b16 v[122:123], v33 offset:34816
  v_mfma_f32_16x16x32_bf16 a[96:99], v[140:143], v[88:91], a[96:99]
  v_mfma_f32_16x16x32_bf16 a[100:103], v[144:147], v[88:91], a[100:103]
  ds_read_b128 v[60:63], v20 offset:8192
  s_add_u32 m0, s53, 3072
  v_mfma_f32_16x16x32_bf16 a[104:107], v[148:151], v[88:91], a[104:107]
  buffer_load_dwordx4 v13, s[12:15], s21 offen  lds
  v_mfma_f32_16x16x32_bf16 a[108:111], v[152:155], v[88:91], a[108:111]
  ds_read_b64_tr_b16 v[124:125], v34 offset:32768
  v_mfma_f32_16x16x32_bf16 a[112:115], v[156:159], v[88:91], a[112:115]
  v_mfma_f32_16x16x32_bf16 a[116:119], v[160:163], v[88:91], a[116:119]
  ds_read_b64_tr_b16 v[126:127], v34 offset:34816
  s_add_u32 m0, s52, 4096
  v_mfma_f32_16x16x32_bf16 a[120:123], v[164:167], v[88:91], a[120:123]
  buffer_load_dwordx4 v6, s[8:11], s20 offen  lds
  v_mfma_f32_16x16x32_bf16 a[124:127], v[168:171], v[88:91], a[124:127]
  ds_read_b128 v[64:67], v20 offset:10240
  v_mfma_f32_16x16x32_bf16 a[128:131], v[140:143], v[92:95], a[128:131]
  v_mfma_f32_16x16x32_bf16 a[132:135], v[144:147], v[92:95], a[132:135]
  ds_read_b64_tr_b16 v[128:129], v35 offset:32768
  s_add_u32 m0, s53, 4096
  v_mfma_f32_16x16x32_bf16 a[136:139], v[148:151], v[92:95], a[136:139]
  buffer_load_dwordx4 v14, s[12:15], s21 offen  lds
  v_mfma_f32_16x16x32_bf16 a[140:143], v[152:155], v[92:95], a[140:143]
  ds_read_b64_tr_b16 v[130:131], v35 offset:34816
  v_mfma_f32_16x16x32_bf16 a[144:147], v[156:159], v[92:95], a[144:147]
  v_mfma_f32_16x16x32_bf16 a[148:151], v[160:163], v[92:95], a[148:151]
  ds_read_b128 v[68:71], v20 offset:12288
  s_add_u32 m0, s52, 5120
  v_mfma_f32_16x16x32_bf16 a[152:155], v[164:167], v[92:95], a[152:155]
  buffer_load_dwordx4 v7, s[8:11], s20 offen  lds
  v_mfma_f32_16x16x32_bf16 a[156:159], v[168:171], v[92:95], a[156:159]
  ds_read_b64_tr_b16 v[132:133], v36 offset:32768
  v_mfma_f32_16x16x32_bf16 a[160:163], v[140:143], v[96:99], a[160:163]
  s_add_u32 m0, s53, 5120
  v_mfma_f32_16x16x32_bf16 a[164:167], v[144:147], v[96:99], a[164:167]
  buffer_load_dwordx4 v15, s[12:15], s21 offen  lds
  ds_read_b64_tr_b16 v[134:135], v36 offset:34816
  v_mfma_f32_16x16x32_bf16 a[168:171], v[148:151], v[96:99], a[168:171]
  v_mfma_f32_16x16x32_bf16 a[172:175], v[152:155], v[96:99], a[172:175]
  ds_read_b128 v[72:75], v20 offset:14336
  v_mfma_f32_16x16x32_bf16 a[176:179], v[156:159], v[96:99], a[176:179]
  s_add_u32 m0, s52, 6144
  v_mfma_f32_16x16x32_bf16 a[180:183], v[160:163], v[96:99], a[180:183]
  buffer_load_dwordx4 v8, s[8:11], s20 offen  lds
  ds_read_b64_tr_b16 v[136:137], v37 offset:32768
  v_mfma_f32_16x16x32_bf16 a[184:187], v[164:167], v[96:99], a[184:187]
  v_mfma_f32_16x16x32_bf16 a[188:191], v[168:171], v[96:99], a[188:191]
  ds_read_b64_tr_b16 v[138:139], v37 offset:34816
  v_mfma_f32_16x16x32_bf16 a[192:195], v[140:143], v[100:103], a[192:195]
  s_add_u32 m0, s53, 6144
  v_mfma_f32_16x16x32_bf16 a[196:199], v[144:147], v[100:103], a[196:199]
  buffer_load_dwordx4 v16, s[12:15], s21 offen  lds
  v_mfma_f32_16x16x32_bf16 a[200:203], v[148:151], v[100:103], a[200:203]
  v_mfma_f32_16x16x32_bf16 a[204:207], v[152:155], v[100:103], a[204:207]
  s_add_u32 m0, s52, 7168
  v_mfma_f32_16x16x32_bf16 a[208:211], v[156:159], v[100:103], a[208:211]
  buffer_load_dwordx4 v9, s[8:11], s20 offen  lds
  v_mfma_f32_16x16x32_bf16 a[212:215], v[160:163], v[100:103], a[212:215]
  v_mfma_f32_16x16x32_bf16 a[216:219], v[164:167], v[100:103], a[216:219]
  v_mfma_f32_16x16x32_bf16 a[220:223], v[168:171], v[100:103], a[220:223]
  s_add_u32 m0, s53, 7168
  v_mfma_f32_16x16x32_bf16 a[224:227], v[140:143], v[104:107], a[224:227]
  buffer_load_dwordx4 v17, s[12:15], s21 offen  lds
  v_mfma_f32_16x16x32_bf16 a[228:231], v[144:147], v[104:107], a[228:231]
  v_mfma_f32_16x16x32_bf16 a[232:235], v[148:151], v[104:107], a[232:235]
  v_mfma_f32_16x16x32_bf16 a[236:239], v[152:155], v[104:107], a[236:239]
  s_add_u32 s20, s20, 128
  v_mfma_f32_16x16x32_bf16 a[240:243], v[156:159], v[104:107], a[240:243]
  s_add_u32 s21, s21, s51
  v_mfma_f32_16x16x32_bf16 a[244:247], v[160:163], v[104:107], a[244:247]
  v_mfma_f32_16x16x32_bf16 a[248:251], v[164:167], v[104:107], a[248:251]
  v_mfma_f32_16x16x32_bf16 a[252:255], v[168:171], v[104:107], a[252:255]
  s_waitcnt lgkmcnt(0)
  v_mfma_f32_16x16x32_bf16 a[0:3], v[108:111], v[44:47], a[0:3]
  ds_read_b128 v[76:79], v21 offset:0
  v_mfma_f32_16x16x32_bf16 a[4:7], v[112:115], v[44:47], a[4:7]
  v_mfma_f32_16x16x32_bf16 a[8:11], v[116:119], v[44:47], a[8:11]
  ds_read_b64_tr_b16 v[140:141], v30 offset:49152
  v_mfma_f32_16x16x32_bf16 a[12:15], v[120:123], v[44:47], a[12:15]
  v_mfma_f32_16x16x32_bf16 a[16:19], v[124:127], v[44:47], a[16:19]
  ds_read_b64_tr_b16 v[142:143], v30 offset:51200
  v_mfma_f32_16x16x32_bf16 a[20:23], v[128:131], v[44:47], a[20:23]
  v_mfma_f32_16x16x32_bf16 a[24:27], v[132:135], v[44:47], a[24:27]
  ds_read_b128 v[80:83], v21 offset:2048
  v_mfma_f32_16x16x32_bf16 a[28:31], v[136:139], v[44:47], a[28:31]
  v_mfma_f32_16x16x32_bf16 a[32:35], v[108:111], v[48:51], a[32:35]
  ds_read_b64_tr_b16 v[144:145], v31 offset:49152
  v_mfma_f32_16x16x32_bf16 a[36:39], v[112:115], v[48:51], a[36:39]
  v_mfma_f32_16x16x32_bf16 a[40:43], v[116:119], v[48:51], a[40:43]
  ds_read_b64_tr_b16 v[146:147], v31 offset:51200
  v_mfma_f32_16x16x32_bf16 a[44:47], v[120:123], v[48:51], a[44:47]
  v_mfma_f32_16x16x32_bf16 a[48:51], v[124:127], v[48:51], a[48:51]
  ds_read_b128 v[84:87], v21 offset:4096
  v_mfma_f32_16x16x32_bf16 a[52:55], v[128:131], v[48:51], a[52:55]
  v_mfma_f32_16x16x32_bf16 a[56:59], v[132:135], v[48:51], a[56:59]
  ds_read_b64_tr_b16 v[148:149], v32 offset:49152
  v_mfma_f32_16x16x32_bf16 a[60:63], v[136:139], v[48:51], a[60:63]
  v_mfma_f32_16x16x32_bf16 a[64:67], v[108:111], v[52:55], a[64:67]
  ds_read_b64_tr_b16 v[150:151], v32 offset:51200
  v_mfma_f32_16x16x32_bf16 a[68:71], v[112:115], v[52:55], a[68:71]
  v_mfma_f32_16x16x32_bf16 a[72:75], v[116:119], v[52:55], a[72:75]
  ds_read_b128 v[88:91], v21 offset:6144
  v_mfma_f32_16x16x32_bf16 a[76:79], v[120:123], v[52:55], a[76:79]
  v_mfma_f32_16x16x32_bf16 a[80:83], v[124:127], v[52:55], a[80:83]
  ds_read_b64_tr_b16 v[152:153], v33 offset:49152
  v_mfma_f32_16x16x32_bf16 a[84:87], v[128:131], v[52:55], a[84:87]
  v_mfma_f32_16x16x32_bf16 a[88:91], v[132:135], v[52:55], a[88:91]
  ds_read_b64_tr_b16 v[154:155], v33 offset:51200
  v_mfma_f32_16x16x32_bf16 a[92:95], v[136:139], v[52:55], a[92:95]
  v_mfma_f32_16x16x32_bf16 a[96:99], v[108:111], v[56:59], a[96:99]
  ds_read_b128 v[92:95], v21 offset:8192
  v_mfma_f32_16x16x32_bf16 a[100:103], v[112:115], v[56:59], a[100:103]
  v_mfma_f32_16x16x32_bf16 a[104:107], v[116:119], v[56:59], a[104:107]
  ds_read_b64_tr_b16 v[156:157], v34 offset:49152
  v_mfma_f32_16x16x32_bf16 a[108:111], v[120:123], v[56:59], a[108:111]
  v_mfma_f32_16x16x32_bf16 a[112:115], v[124:127], v[56:59], a[112:115]
  ds_read_b64_tr_b16 v[158:159], v34 offset:51200
  v_mfma_f32_16x16x32_bf16 a[116:119], v[128:131], v[56:59], a[116:119]
  v_mfma_f32_16x16x32_bf16 a[120:123], v[132:135], v[56:59], a[120:123]
  ds_read_b128 v[96:99], v21 offset:10240
  v_mfma_f32_16x16x32_bf16 a[124:127], v[136:139], v[56:59], a[124:127]
  v_mfma_f32_16x16x32_bf16 a[128:131], v[108:111], v[60:63], a[128:131]
  ds_read_b64_tr_b16 v[160:161], v35 offset:49152
  v_mfma_f32_16x16x32_bf16 a[132:135], v[112:115], v[60:63], a[132:135]
  v_mfma_f32_16x16x32_bf16 a[136:139], v[116:119], v[60:63], a[136:139]
  ds_read_b64_tr_b16 v[162:163], v35 offset:51200
  v_mfma_f32_16x16x32_bf16 a[140:143], v[120:123], v[60:63], a[140:143]
  v_mfma_f32_16x16x32_bf16 a[144:147], v[124:127], v[60:63], a[144:147]
  ds_read_b128 v[100:103], v21 offset:12288
  v_mfma_f32_16x16x32_bf16 a[148:151], v[128:131], v[60:63], a[148:151]
  v_mfma_f32_16x16x32_bf16 a[152:155], v[132:135], v[60:63], a[152:155]
  ds_read_b64_tr_b16 v[164:165], v36 offset:49152
  v_mfma_f32_16x16x32_bf16 a[156:159], v[136:139], v[60:63], a[156:159]
  v_mfma_f32_16x16x32_bf16 a[160:163], v[108:111], v[64:67], a[160:163]
  ds_read_b64_tr_b16 v[166:167], v36 offset:51200
  v_mfma_f32_16x16x32_bf16 a[164:167], v[112:115], v[64:67], a[164:167]
  v_mfma_f32_16x16x32_bf16 a[168:171], v[116:119], v[64:67], a[168:171]
  ds_read_b128 v[104:107], v21 offset:14336
  v_mfma_f32_16x16x32_bf16 a[172:175], v[120:123], v[64:67], a[172:175]
  v_mfma_f32_16x16x32_bf16 a[176:179], v[124:127], v[64:67], a[176:179]
  ds_read_b64_tr_b16 v[168:169], v37 offset:49152
  v_mfma_f32_16x16x32_bf16 a[180:183], v[128:131], v[64:67], a[180:183]
  v_mfma_f32_16x16x32_bf16 a[184:187], v[132:135], v[64:67], a[184:187]
  ds_read_b64_tr_b16 v[170:171], v37 offset:51200
  v_mfma_f32_16x16x32_bf16 a[188:191], v[136:139], v[64:67], a[188:191]
  v_mfma_f32_16x16x32_bf16 a[192:195], v[108:111], v[68:71], a[192:195]
  v_mfma_f32_16x16x32_bf16 a[196:199], v[112:115], v[68:71], a[196:199]
  v_mfma_f32_16x16x32_bf16 a[200:203], v[116:119], v[68:71], a[200:203]
  v_mfma_f32_16x16x32_bf16 a[204:207], v[120:123], v[68:71], a[204:207]
  v_mfma_f32_16x16x32_bf16 a[208:211], v[124:127], v[68:71], a[208:211]
  v_mfma_f32_16x16x32_bf16 a[212:215], v[128:131], v[68:71], a[212:215]
  v_mfma_f32_16x16x32_bf16 a[216:219], v[132:135], v[68:71], a[216:219]
  v_mfma_f32_16x16x32_bf16 a[220:223], v[136:139], v[68:71], a[220:223]
  v_mfma_f32_16x16x32_bf16 a[224:227], v[108:111], v[72:75], a[224:227]
  v_mfma_f32_16x16x32_bf16 a[228:231], v[112:115], v[72:75], a[228:231]
  v_mfma_f32_16x16x32_bf16 a[232:235], v[116:119], v[72:75], a[232:235]
  v_mfma_f32_16x16x32_bf16 a[236:239], v[120:123], v[72:75], a[236:239]
  v_mfma_f32_16x16x32_bf16 a[240:243], v[124:127], v[72:75], a[240:243]
  v_mfma_f32_16x16x32_bf16 a[244:247], v[128:131], v[72:75], a[244:247]
  v_mfma_f32_16x16x32_bf16 a[248:251], v[132:135], v[72:75], a[248:251]
  v_mfma_f32_16x16x32_bf16 a[252:255], v[136:139], v[72:75], a[252:255]
  s_waitcnt lgkmcnt(0)
  v_mfma_f32_16x16x32_bf16 a[0:3], v[140:143], v[76:79], a[0:3]
  s_waitcnt vmcnt(0)
  s_barrier
  s_cmp_eq_u32 s49, 0
  s_cbranch_scc1 L_hs_6
  s_cmp_lg_u32 s32, 0
  s_cbranch_scc1 L_sig_7
  v_mov_b32 v254, s63
  v_mov_b32 v255, 0
  v_mbcnt_lo_u32_b32 v255, -1, 0
  v_lshlrev_b32 v255, 9, v255
  s_cmp_eq_u32 s63, 2
  s_cselect_b64 exec, 3, 1
  buffer_atomic_add v254, v255, s[4:7], s62 offen offset:0 sc1
  s_mov_b64 exec, -1
L_sig_7:
L_hs_6:
  s_add_u32 m0, s52, 65536
  v_mfma_f32_16x16x32_bf16 a[4:7], v[144:147], v[76:79], a[4:7]
  buffer_load_dwordx4 v2, s[8:11], s20 offen  lds
  ds_read_b128 v[44:47], v18 offset:0
  v_mfma_f32_16x16x32_bf16 a[8:11], v[148:151], v[76:79], a[8:11]
  v_mfma_f32_16x16x32_bf16 a[12:15], v[152:155], v[76:79], a[12:15]
  ds_read_b64_tr_b16 v[108:109], v22 offset:32768
  s_add_u32 m0, s53, 65536
  v_mfma_f32_16x16x32_bf16 a[16:19], v[156:159], v[76:79], a[16:19]
  buffer_load_dwordx4 v10, s[12:15], s21 offen  lds
  v_mfma_f32_16x16x32_bf16 a[20:23], v[160:163], v[76:79], a[20:23]
  ds_read_b64_tr_b16 v[110:111], v22 offset:34816
  v_mfma_f32_16x16x32_bf16 a[24:27], v[164:167], v[76:79], a[24:27]
  v_mfma_f32_16x16x32_bf16 a[28:31], v[168:171], v[76:79], a[28:31]
  ds_read_b128 v[48:51], v18 offset:2048
  s_add_u32 m0, s52, 66560
  v_mfma_f32_16x16x32_bf16 a[32:35], v[140:143], v[80:83], a[32:35]
  buffer_load_dwordx4 v3, s[8:11], s20 offen  lds
  v_mfma_f32_16x16x32_bf16 a[36:39], v[144:147], v[80:83], a[36:39]
  ds_read_b64_tr_b16 v[112:113], v23 offset:32768
  v_mfma_f32_16x16x32_bf16 a[40:43], v[148:151], v[80:83], a[40:43]
  v_mfma_f32_16x16x32_bf16 a[44:47], v[152:155], v[80:83], a[44:47]
  ds_read_b64_tr_b16 v[114:115], v23 offset:34816
  s_add_u32 m0, s53, 66560
  v_mfma_f32_16x16x32_bf16 a[48:51], v[156:159], v[80:83], a[48:51]
  buffer_load_dwordx4 v11, s[12:15], s21 offen  lds
  v_mfma_f32_16x16x32_bf16 a[52:55], v[160:163], v[80:83], a[52:55]
  ds_read_b128 v[52:55], v18 offset:4096
  v_mfma_f32_16x16x32_bf16 a[56:59], v[164:167], v[80:83], a[56:59]
  s_add_u32 m0, s52, 67584
  v_mfma_f32_16x16x32_bf16 a[60:63], v[168:171], v[80:83], a[60:63]
  buffer_load_dwordx4 v4, s[8:11], s20 offen  lds
  ds_read_b64_tr_b16 v[116:117], v24 offset:32768
  v_mfma_f32_16x16x32_bf16 a[64:67], v[140:143], v[84:87], a[64:67]
  v_mfma_f32_16x16x32_bf16 a[68:71], v[144:147], v[84:87], a[68:71]
  ds_read_b64_tr_b16 v[118:119], v24 offset:34816
  v_mfma_f32_16x16x32_bf16 a[72:75], v[148:151], v[84:87], a[72:75]
  s_add_u32 m0, s53, 67584
  v_mfma_f32_16x16x32_bf16 a[76:79], v[152:155], v[84:87], a[76:79]
  buffer_load_dwordx4 v12, s[12:15], s21 offen  lds
  ds_read_b128 v[56:59], v18 offset:6144
  v_mfma_f32_16x16x32_bf16 a[80:83], v[156:159], v[84:87], a[80:83]
  v_mfma_f32_16x16x32_bf16 a[84:87], v[160:163], v[84:87], a[84:87]
  ds_read_b64_tr_b16 v[120:121], v25 offset:32768
  v_mfma_f32_16x16x32_bf16 a[88:91], v[164:167], v[84:87], a[88:91]
  s_add_u32 m0, s52, 68608
  v_mfma_f32_16x16x32_bf16 a[92:95], v[168:171], v[84:87], a[92:95]
  buffer_load_dwordx4 v5, s[8:11], s20 offen  lds
  ds_read_b64_tr_b16 v[122:123], v25 offset:34816
  v_mfma_f32_16x16x32_bf16 a[96:99], v[140:143], v[88:91], a[96:99]
  v_mfma_f32_16x16x32_bf16 a[100:103], v[144:147], v[88:91], a[100:103]
  ds_read_b128 v[60:63], v18 offset:8192
  s_add_u32 m0, s53, 68608
  v_mfma_f32_16x16x32_bf16 a[104:107], v[148:151], v[88:91], a[104:107]
  buffer_load_dwordx4 v13, s[12:15], s21 offen  lds
  v_mfma_f32_16x16x32_bf16 a[108:111], v[152:155], v[88:91], a[108:111]
  ds_read_b64_tr_b16 v[124:125], v26 offset:32768
  v_mfma_f32_16x16x32_bf16 a[112:115], v[156:159], v[88:91], a[112:115]
  v_mfma_f32_16x16x32_bf16 a[116:119], v[160:163], v[88:91], a[116:119]
  ds_read_b64_tr_b16 v[126:127], v26 offset:34816
  s_add_u32 m0, s52, 69632
  v_mfma_f32_16x16x32_bf16 a[120:123], v[164:167], v[88:91], a[120:123]
  buffer_load_dwordx4 v6, s[8:11], s20 offen  lds
  v_mfma_f32_16x16x32_bf16 a[124:127], v[168:171], v[88:91], a[124:127]
  ds_read_b128 v[64:67], v18 offset:10240
  v_mfma_f32_16x16x32_bf16 a[128:131], v[140:143], v[92:95], a[128:131]
  v_mfma_f32_16x16x32_bf16 a[132:135], v[144:147], v[92:95], a[132:135]
  ds_read_b64_tr_b16 v[128:129], v27 offset:32768
  s_add_u32 m0, s53, 69632
  v_mfma_f32_16x16x32_bf16 a[136:139], v[148:151], v[92:95], a[136:139]
  buffer_load_dwordx4 v14, s[12:15], s21 offen  lds
  v_mfma_f32_16x16x32_bf16 a[140:143], v[152:155], v[92:95], a[140:143]
  ds_read_b64_tr_b16 v[130:131], v27 offset:34816
  v_mfma_f32_16x16x32_bf16 a[144:147], v[156:159], v[92:95], a[144:147]
  v_mfma_f32_16x16x32_bf16 a[148:151], v[160:163], v[92:95], a[148:151]
  ds_read_b128 v[68:71], v18 offset:12288
  s_add_u32 m0, s52, 70656
  v_mfma_f32_16x16x32_bf16 a[152:155], v[164:167], v[92:95], a[152:155]
  buffer_load_dwordx4 v7, s[8:11], s20 offen  lds
  v_mfma_f32_16x16x32_bf16 a[156:159], v[168:171], v[92:95], a[156:159]
  ds_read_b64_tr_b16 v[132:133], v28 offset:32768
  v_mfma_f32_16x16x32_bf16 a[160:163], v[140:143], v[96:99], a[160:163]
  s_add_u32 m0, s53, 70656
  v_mfma_f32_16x16x32_bf16 a[164:167], v[144:147], v[96:99], a[164:167]
  buffer_load_dwordx4 v15, s[12:15], s21 offen  lds
  ds_read_b64_tr_b16 v[134:135], v28 offset:34816
  v_mfma_f32_16x16x32_bf16 a[168:171], v[148:151], v[96:99], a[168:171]
  v_mfma_f32_16x16x32_bf16 a[172:175], v[152:155], v[96:99], a[172:175]
  ds_read_b128 v[72:75], v18 offset:14336
  v_mfma_f32_16x16x32_bf16 a[176:179], v[156:159], v[96:99], a[176:179]
  s_add_u32 m0, s52, 71680
  v_mfma_f32_16x16x32_bf16 a[180:183], v[160:163], v[96:99], a[180:183]
  buffer_load_dwordx4 v8, s[8:11], s20 offen  lds
  ds_read_b64_tr_b16 v[136:137], v29 offset:32768
  v_mfma_f32_16x16x32_bf16 a[184:187], v[164:167], v[96:99], a[184:187]
  v_mfma_f32_16x16x32_bf16 a[188:191], v[168:171], v[96:99], a[188:191]
  ds_read_b64_tr_b16 v[138:139], v29 offset:34816
  v_mfma_f32_16x16x32_bf16 a[192:195], v[140:143], v[100:103], a[192:195]
  s_add_u32 m0, s53, 71680
  v_mfma_f32_16x16x32_bf16 a[196:199], v[144:147], v[100:103], a[196:199]
  buffer_load_dwordx4 v16, s[12:15], s21 offen  lds
  v_mfma_f32_16x16x32_bf16 a[200:203], v[148:151], v[100:103], a[200:203]
  v_mfma_f32_16x16x32_bf16 a[204:207], v[152:155], v[100:103], a[204:207]
  s_add_u32 m0, s52, 72704
  v_mfma_f32_16x16x32_bf16 a[208:211], v[156:159], v[100:103], a[208:211]
  buffer_load_dwordx4 v9, s[8:11], s20 offen  lds
  v_mfma_f32_16x16x32_bf16 a[212:215], v[160:163], v[100:103], a[212:215]
  v_mfma_f32_16x16x32_bf16 a[216:219], v[164:167], v[100:103], a[216:219]
  v_mfma_f32_16x16x32_bf16 a[220:223], v[168:171], v[100:103], a[220:223]
  s_add_u32 m0, s53, 72704
  v_mfma_f32_16x16x32_bf16 a[224:227], v[140:143], v[104:107], a[224:227]
  buffer_load_dwordx4 v17, s[12:15], s21 offen  lds
  v_mfma_f32_16x16x32_bf16 a[228:231], v[144:147], v[104:107], a[228:231]
  v_mfma_f32_16x16x32_bf16 a[232:235], v[148:151], v[104:107], a[232:235]
  v_mfma_f32_16x16x32_bf16 a[236:239], v[152:155], v[104:107], a[236:239]
  s_add_u32 s20, s20, 128
  v_mfma_f32_16x16x32_bf16 a[240:243], v[156:159], v[104:107], a[240:243]
  s_add_u32 s21, s21, s51
  v_mfma_f32_16x16x32_bf16 a[244:247], v[160:163], v[104:107], a[244:247]
  v_mfma_f32_16x16x32_bf16 a[248:251], v[164:167], v[104:107], a[248:251]
  v_mfma_f32_16x16x32_bf16 a[252:255], v[168:171], v[104:107], a[252:255]
L_g1_loop:
  s_sub_u32 s25, s25, 1
  s_cmp_eq_u32 s25, 0
  s_cbranch_scc1 L_g1_fin
  s_waitcnt lgkmcnt(0)
  v_mfma_f32_16x16x32_bf16 a[0:3], v[108:111], v[44:47], a[0:3]
  ds_read_b128 v[76:79], v19 offset:0
  v_mfma_f32_16x16x32_bf16 a[4:7], v[112:115], v[44:47], a[4:7]
  v_mfma_f32_16x16x32_bf16 a[8:11], v[116:119], v[44:47], a[8:11]
  ds_read_b64_tr_b16 v[140:141], v22 offset:49152
  v_mfma_f32_16x16x32_bf16 a[12:15], v[120:123], v[44:47], a[12:15]
  v_mfma_f32_16x16x32_bf16 a[16:19], v[124:127], v[44:47], a[16:19]
  ds_read_b64_tr_b16 v[142:143], v22 offset:51200
  v_mfma_f32_16x16x32_bf16 a[20:23], v[128:131], v[44:47], a[20:23]
  v_mfma_f32_16x16x32_bf16 a[24:27], v[132:135], v[44:47], a[24:27]
  ds_read_b128 v[80:83], v19 offset:2048
  v_mfma_f32_16x16x32_bf16 a[28:31], v[136:139], v[44:47], a[28:31]
  v_mfma_f32_16x16x32_bf16 a[32:35], v[108:111], v[48:51], a[32:35]
  ds_read_b64_tr_b16 v[144:145], v23 offset:49152
  v_mfma_f32_16x16x32_bf16 a[36:39], v[112:115], v[48:51], a[36:39]
  v_mfma_f32_16x16x32_bf16 a[40:43], v[116:119], v[48:51], a[40:43]
  ds_read_b64_tr_b16 v[146:147], v23 offset:51200
  v_mfma_f32_16x16x32_bf16 a[44:47], v[120:123], v[48:51], a[44:47]
  v_mfma_f32_16x16x32_bf16 a[48:51], v[124:127], v[48:51], a[48:51]
  ds_read_b128 v[84:87], v19 offset:4096
  v_mfma_f32_16x16x32_bf16 a[52:55], v[128:131], v[48:51], a[52:55]
  v_mfma_f32_16x16x32_bf16 a[56:59], v[132:135], v[48:51], a[56:59]
  ds_read_b64_tr_b16 v[148:149], v24 offset:49152
  v_mfma_f32_16x16x32_bf16 a[60:63], v[136:139], v[48:51], a[60:63]
  v_mfma_f32_16x16x32_bf16 a[64:67], v[108:111], v[52:55], a[64:67]
  ds_read_b64_tr_b16 v[150:151], v24 offset:51200
  v_mfma_f32_16x16x32_bf16 a[68:71], v[112:115], v[52:55], a[68:71]
  v_mfma_f32_16x16x32_bf16 a[72:75], v[116:119], v[52:55], a[72:75]
  ds_read_b128 v[88:91], v19 offset:6144
  v_mfma_f32_16x16x32_bf16 a[76:79], v[120:123], v[52:55], a[76:79]
  v_mfma_f32_16x16x32_bf16 a[80:83], v[124:127], v[52:55], a[80:83]
  ds_read_b64_tr_b16 v[152:153], v25 offset:49152
  v_mfma_f32_16x16x32_bf16 a[84:87], v[128:131], v[52:55], a[84:87]
  v_mfma_f32_16x16x32_bf16 a[88:91], v[132:135], v[52:55], a[88:91]
  ds_read_b64_tr_b16 v[154:155], v25 offset:51200
  v_mfma_f32_16x16x32_bf16 a[92:95], v[136:139], v[52:55], a[92:95]
  v_mfma_f32_16x16x32_bf16 a[96:99], v[108:111], v[56:59], a[96:99]
  ds_read_b128 v[92:95], v19 offset:8192
  v_mfma_f32_16x16x32_bf16 a[100:103], v[112:115], v[56:59], a[100:103]
  v_mfma_f32_16x16x32_bf16 a[104:107], v[116:119], v[56:59], a[104:107]
  ds_read_b64_tr_b16 v[156:157], v26 offset:49152
  v_mfma_f32_16x16x32_bf16 a[108:111], v[120:123], v[56:59], a[108:111]
  v_mfma_f32_16x16x32_bf16 a[112:115], v[124:127], v[56:59], a[112:115]
  ds_read_b64_tr_b16 v[158:159], v26 offset:51200
  v_mfma_f32_16x16x32_bf16 a[116:119], v[128:131], v[56:59], a[116:119]
  v_mfma_f32_16x16x32_bf16 a[120:123], v[132:135], v[56:59], a[120:123]
  ds_read_b128 v[96:99], v19 offset:10240
  v_mfma_f32_16x16x32_bf16 a[124:127], v[136:139], v[56:59], a[124:127]
  v_mfma_f32_16x16x32_bf16 a[128:131], v[108:111], v[60:63], a[128:131]
  ds_read_b64_tr_b16 v[160:161], v27 offset:49152
  v_mfma_f32_16x16x32_bf16 a[132:135], v[112:115], v[60:63], a[132:135]
  v_mfma_f32_16x16x32_bf16 a[136:139], v[116:119], v[60:63], a[136:139]
  ds_read_b64_tr_b16 v[162:163], v27 offset:51200
  v_mfma_f32_16x16x32_bf16 a[140:143], v[120:123], v[60:63], a[140:143]
  v_mfma_f32_16x16x32_bf16 a[144:147], v[124:127], v[60:63], a[144:147]
  ds_read_b128 v[100:103], v19 offset:12288
  v_mfma_f32_16x16x32_bf16 a[148:151], v[128:131], v[60:63], a[148:151]
  v_mfma_f32_16x16x32_bf16 a[152:155], v[132:135], v[60:63], a[152:155]
  ds_read_b64_tr_b16 v[164:165], v28 offset:49152
  v_mfma_f32_16x16x32_bf16 a[156:159], v[136:139], v[60:63], a[156:159]
  v_mfma_f32_16x16x32_bf16 a[160:163], v[108:111], v[64:67], a[160:163]
  ds_read_b64_tr_b16 v[166:167], v28 offset:51200
  v_mfma_f32_16x16x32_bf16 a[164:167], v[112:115], v[64:67], a[164:167]
  v_mfma_f32_16x16x32_bf16 a[168:171], v[116:119], v[64:67], a[168:171]
  ds_read_b128 v[104:107], v19 offset:14336
  v_mfma_f32_16x16x32_bf16 a[172:175], v[120:123], v[64:67], a[172:175]
  v_mfma_f32_16x16x32_bf16 a[176:179], v[124:127], v[64:67], a[176:179]
  ds_read_b64_tr_b16 v[168:169], v29 offset:49152
  v_mfma_f32_16x16x32_bf16 a[180:183], v[128:131], v[64:67], a[180:183]
  v_mfma_f32_16x16x32_bf16 a[184:187], v[132:135], v[64:67], a[184:187]
  ds_read_b64_tr_b16 v[170:171], v29 offset:51200
  v_mfma_f32_16x16x32_bf16 a[188:191], v[136:139], v[64:67], a[188:191]
  v_mfma_f32_16x16x32_bf16 a[192:195], v[108:111], v[68:71], a[192:195]
  v_mfma_f32_16x16x32_bf16 a[196:199], v[112:115], v[68:71], a[196:199]
  v_mfma_f32_16x16x32_bf16 a[200:203], v[116:119], v[68:71], a[200:203]
  v_mfma_f32_16x16x32_bf16 a[204:207], v[120:123], v[68:71], a[204:207]
  v_mfma_f32_16x16x32_bf16 a[208:211], v[124:127], v[68:71], a[208:211]
  v_mfma_f32_16x16x32_bf16 a[212:215], v[128:131], v[68:71], a[212:215]
  v_mfma_f32_16x16x32_bf16 a[216:219], v[132:135], v[68:71], a[216:219]
  v_mfma_f32_16x16x32_bf16 a[220:223], v[136:139], v[68:71], a[220:223]
  v_mfma_f32_16x16x32_bf16 a[224:227], v[108:111], v[72:75], a[224:227]
  v_mfma_f32_16x16x32_bf16 a[228:231], v[112:115], v[72:75], a[228:231]
  v_mfma_f32_16x16x32_bf16 a[232:235], v[116:119], v[72:75], a[232:235]
  v_mfma_f32_16x16x32_bf16 a[236:239], v[120:123], v[72:75], a[236:239]
  v_mfma_f32_16x16x32_bf16 a[240:243], v[124:127], v[72:75], a[240:243]
  v_mfma_f32_16x16x32_bf16 a[244:247], v[128:131], v[72:75], a[244:247]
  v_mfma_f32_16x16x32_bf16 a[248:251], v[132:135], v[72:75], a[248:251]
  v_mfma_f32_16x16x32_bf16 a[252:255], v[136:139], v[72:75], a[252:255]
  s_waitcnt lgkmcnt(0)
  v_mfma_f32_16x16x32_bf16 a[0:3], v[140:143], v[76:79], a[0:3]
  s_waitcnt vmcnt(0)
  s_barrier
  s_add_u32 m0, s52, 0
  v_mfma_f32_16x16x32_bf16 a[4:7], v[144:147], v[76:79], a[4:7]
  buffer_load_dwordx4 v2, s[8:11], s20 offen  lds
  ds_read_b128 v[44:47], v20 offset:0
  v_mfma_f32_16x16x32_bf16 a[8:11], v[148:151], v[76:79], a[8:11]
  v_mfma_f32_16x16x32_bf16 a[12:15], v[152:155], v[76:79], a[12:15]
  ds_read_b64_tr_b16 v[108:109], v30 offset:32768
  s_add_u32 m0, s53, 0
  v_mfma_f32_16x16x32_bf16 a[16:19], v[156:159], v[76:79], a[16:19]
  buffer_load_dwordx4 v10, s[12:15], s21 offen  lds
  v_mfma_f32_16x16x32_bf16 a[20:23], v[160:163], v[76:79], a[20:23]
  ds_read_b64_tr_b16 v[110:111], v30 offset:34816
  v_mfma_f32_16x16x32_bf16 a[24:27], v[164:167], v[76:79], a[24:27]
  v_mfma_f32_16x16x32_bf16 a[28:31], v[168:171], v[76:79], a[28:31]
  ds_read_b128 v[48:51], v20 offset:2048
  s_add_u32 m0, s52, 1024
  v_mfma_f32_16x16x32_bf16 a[32:35], v[140:143], v[80:83], a[32:35]
  buffer_load_dwordx4 v3, s[8:11], s20 offen  lds
  v_mfma_f32_16x16x32_bf16 a[36:39], v[144:147], v[80:83], a[36:39]
  ds_read_b64_tr_b16 v[112:113], v31 offset:32768
  v_mfma_f32_16x16x32_bf16 a[40:43], v[148:151], v[80:83], a[40:43]
  v_mfma_f32_16x16x32_bf16 a[44:47], v[152:155], v[80:83], a[44:47]
  ds_read_b64_tr_b16 v[114:115], v31 offset:34816
  s_add_u32 m0, s53, 1024
  v_mfma_f32_16x16x32_bf16 a[48:51], v[156:159], v[80:83], a[48:51]
  buffer_load_dwordx4 v11, s[12:15], s21 offen  lds
  v_mfma_f32_16x16x32_bf16 a[52:55], v[160:163], v[80:83], a[52:55]
  ds_read_b128 v[52:55], v20 offset:4096
  v_mfma_f32_16x16x32_bf16 a[56:59], v[164:167], v[80:83], a[56:59]
  s_add_u32 m0, s52, 2048
  v_mfma_f32_16x16x32_bf16 a[60:63], v[168:171], v[80:83], a[60:63]
  buffer_load_dwordx4 v4, s[8:11], s20 offen  lds
  ds_read_b64_tr_b16 v[116:117], v32 offset:32768
  v_mfma_f32_16x16x32_bf16 a[64:67], v[140:143], v[84:87], a[64:67]
  v_mfma_f32_16x16x32_bf16 a[68:71], v[144:147], v[84:87], a[68:71]
  ds_read_b64_tr_b16 v[118:119], v32 offset:34816
  v_mfma_f32_16x16x32_bf16 a[72:75], v[148:151], v[84:87], a[72:75]
  s_add_u32 m0, s53, 2048
  v_mfma_f32_16x16x32_bf16 a[76:79], v[152:155], v[84:87], a[76:79]
  buffer_load_dwordx4 v12, s[12:15], s21 offen  lds
  ds_read_b128 v[56:59], v20 offset:6144
  v_mfma_f32_16x16x32_bf16 a[80:83], v[156:159], v[84:87], a[80:83]
  v_mfma_f32_16x16x32_bf16 a[84:87], v[160:163], v[84:87], a[84:87]
  ds_read_b64_tr_b16 v[120:121], v33 offset:32768
  v_mfma_f32_16x16x32_bf16 a[88:91], v[164:167], v[84:87], a[88:91]
  s_add_u32 m0, s52, 3072
  v_mfma_f32_16x16x32_bf16 a[92:95], v[168:171], v[84:87], a[92:95]
  buffer_load_dwordx4 v5, s[8:11], s20 offen  lds
  ds_read_b64_tr_b16 v[122:123], v33 offset:34816
  v_mfma_f32_16x16x32_bf16 a[96:99], v[140:143], v[88:91], a[96:99]
  v_mfma_f32_16x16x32_bf16 a[100:103], v[144:147], v[88:91], a[100:103]
  ds_read_b128 v[60:63], v20 offset:8192
  s_add_u32 m0, s53, 3072
  v_mfma_f32_16x16x32_bf16 a[104:107], v[148:151], v[88:91], a[104:107]
  buffer_load_dwordx4 v13, s[12:15], s21 offen  lds
  v_mfma_f32_16x16x32_bf16 a[108:111], v[152:155], v[88:91], a[108:111]
  ds_read_b64_tr_b16 v[124:125], v34 offset:32768
  v_mfma_f32_16x16x32_bf16 a[112:115], v[156:159], v[88:91], a[112:115]
  v_mfma_f32_16x16x32_bf16 a[116:119], v[160:163], v[88:91], a[116:119]
  ds_read_b64_tr_b16 v[126:127], v34 offset:34816
  s_add_u32 m0, s52, 4096
  v_mfma_f32_16x16x32_bf16 a[120:123], v[164:167], v[88:91], a[120:123]
  buffer_load_dwordx4 v6, s[8:11], s20 offen  lds
  v_mfma_f32_16x16x32_bf16 a[124:127], v[168:171], v[88:91], a[124:127]
  ds_read_b128 v[64:67], v20 offset:10240
  v_mfma_f32_16x16x32_bf16 a[128:131], v[140:143], v[92:95], a[128:131]
  v_mfma_f32_16x16x32_bf16 a[132:135], v[144:147], v[92:95], a[132:135]
  ds_read_b64_tr_b16 v[128:129], v35 offset:32768
  s_add_u32 m0, s53, 4096
  v_mfma_f32_16x16x32_bf16 a[136:139], v[148:151], v[92:95], a[136:139]
  buffer_load_dwordx4 v14, s[12:15], s21 offen  lds
  v_mfma_f32_16x16x32_bf16 a[140:143], v[152:155], v[92:95], a[140:143]
  ds_read_b64_tr_b16 v[130:131], v35 offset:34816
  v_mfma_f32_16x16x32_bf16 a[144:147], v[156:159], v[92:95], a[144:147]
  v_mfma_f32_16x16x32_bf16 a[148:151], v[160:163], v[92:95], a[148:151]
  ds_read_b128 v[68:71], v20 offset:12288
  s_add_u32 m0, s52, 5120
  v_mfma_f32_16x16x32_bf16 a[152:155], v[164:167], v[92:95], a[152:155]
  buffer_load_dwordx4 v7, s[8:11], s20 offen  lds
  v_mfma_f32_16x16x32_bf16 a[156:159], v[168:171], v[92:95], a[156:159]
  ds_read_b64_tr_b16 v[132:133], v36 offset:32768
  v_mfma_f32_16x16x32_bf16 a[160:163], v[140:143], v[96:99], a[160:163]
  s_add_u32 m0, s53, 5120
  v_mfma_f32_16x16x32_bf16 a[164:167], v[144:147], v[96:99], a[164:167]
  buffer_load_dwordx4 v15, s[12:15], s21 offen  lds
  ds_read_b64_tr_b16 v[134:135], v36 offset:34816
  v_mfma_f32_16x16x32_bf16 a[168:171], v[148:151], v[96:99], a[168:171]
  v_mfma_f32_16x16x32_bf16 a[172:175], v[152:155], v[96:99], a[172:175]
  ds_read_b128 v[72:75], v20 offset:14336
  v_mfma_f32_16x16x32_bf16 a[176:179], v[156:159], v[96:99], a[176:179]
  s_add_u32 m0, s52, 6144
  v_mfma_f32_16x16x32_bf16 a[180:183], v[160:163], v[96:99], a[180:183]
  buffer_load_dwordx4 v8, s[8:11], s20 offen  lds
  ds_read_b64_tr_b16 v[136:137], v37 offset:32768
  v_mfma_f32_16x16x32_bf16 a[184:187], v[164:167], v[96:99], a[184:187]
  v_mfma_f32_16x16x32_bf16 a[188:191], v[168:171], v[96:99], a[188:191]
  ds_read_b64_tr_b16 v[138:139], v37 offset:34816
  v_mfma_f32_16x16x32_bf16 a[192:195], v[140:143], v[100:103], a[192:195]
  s_add_u32 m0, s53, 6144
  v_mfma_f32_16x16x32_bf16 a[196:199], v[144:147], v[100:103], a[196:199]
  buffer_load_dwordx4 v16, s[12:15], s21 offen  lds
  v_mfma_f32_16x16x32_bf16 a[200:203], v[148:151], v[100:103], a[200:203]
  v_mfma_f32_16x16x32_bf16 a[204:207], v[152:155], v[100:103], a[204:207]
  s_add_u32 m0, s52, 7168
  v_mfma_f32_16x16x32_bf16 a[208:211], v[156:159], v[100:103], a[208:211]
  buffer_load_dwordx4 v9, s[8:11], s20 offen  lds
  v_mfma_f32_16x16x32_bf16 a[212:215], v[160:163], v[100:103], a[212:215]
  v_mfma_f32_16x16x32_bf16 a[216:219], v[164:167], v[100:103], a[216:219]
  v_mfma_f32_16x16x32_bf16 a[220:223], v[168:171], v[100:103], a[220:223]
  s_add_u32 m0, s53, 7168
  v_mfma_f32_16x16x32_bf16 a[224:227], v[140:143], v[104:107], a[224:227]
  buffer_load_dwordx4 v17, s[12:15], s21 offen  lds
  v_mfma_f32_16x16x32_bf16 a[228:231], v[144:147], v[104:107], a[228:231]
  v_mfma_f32_16x16x32_bf16 a[232:235], v[148:151], v[104:107], a[232:235]
  v_mfma_f32_16x16x32_bf16 a[236:239], v[152:155], v[104:107], a[236:239]
  s_add_u32 s20, s20, 128
  v_mfma_f32_16x16x32_bf16 a[240:243], v[156:159], v[104:107], a[240:243]
  s_add_u32 s21, s21, s51
  v_mfma_f32_16x16x32_bf16 a[244:247], v[160:163], v[104:107], a[244:247]
  v_mfma_f32_16x16x32_bf16 a[248:251], v[164:167], v[104:107], a[248:251]
  v_mfma_f32_16x16x32_bf16 a[252:255], v[168:171], v[104:107], a[252:255]
  s_waitcnt lgkmcnt(0)
  v_mfma_f32_16x16x32_bf16 a[0:3], v[108:111], v[44:47], a[0:3]
  ds_read_b128 v[76:79], v21 offset:0
  v_mfma_f32_16x16x32_bf16 a[4:7], v[112:115], v[44:47], a[4:7]
  v_mfma_f32_16x16x32_bf16 a[8:11], v[116:119], v[44:47], a[8:11]
  ds_read_b64_tr_b16 v[140:141], v30 offset:49152
  v_mfma_f32_16x16x32_bf16 a[12:15], v[120:123], v[44:47], a[12:15]
  v_mfma_f32_16x16x32_bf16 a[16:19], v[124:127], v[44:47], a[16:19]
  ds_read_b64_tr_b16 v[142:143], v30 offset:51200
  v_mfma_f32_16x16x32_bf16 a[20:23], v[128:131], v[44:47], a[20:23]
  v_mfma_f32_16x16x32_bf16 a[24:27], v[132:135], v[44:47], a[24:27]
  ds_read_b128 v[80:83], v21 offset:2048
  v_mfma_f32_16x16x32_bf16 a[28:31], v[136:139], v[44:47], a[28:31]
  v_mfma_f32_16x16x32_bf16 a[32:35], v[108:111], v[48:51], a[32:35]
  ds_read_b64_tr_b16 v[144:145], v31 offset:49152
  v_mfma_f32_16x16x32_bf16 a[36:39], v[112:115], v[48:51], a[36:39]
  v_mfma_f32_16x16x32_bf16 a[40:43], v[116:119], v[48:51], a[40:43]
  ds_read_b64_tr_b16 v[146:147], v31 offset:51200
  v_mfma_f32_16x16x32_bf16 a[44:47], v[120:123], v[48:51], a[44:47]
  v_mfma_f32_16x16x32_bf16 a[48:51], v[124:127], v[48:51], a[48:51]
  ds_read_b128 v[84:87], v21 offset:4096
  v_mfma_f32_16x16x32_bf16 a[52:55], v[128:131], v[48:51], a[52:55]
  v_mfma_f32_16x16x32_bf16 a[56:59], v[132:135], v[48:51], a[56:59]
  ds_read_b64_tr_b16 v[148:149], v32 offset:49152
  v_mfma_f32_16x16x32_bf16 a[60:63], v[136:139], v[48:51], a[60:63]
  v_mfma_f32_16x16x32_bf16 a[64:67], v[108:111], v[52:55], a[64:67]
  ds_read_b64_tr_b16 v[150:151], v32 offset:51200
  v_mfma_f32_16x16x32_bf16 a[68:71], v[112:115], v[52:55], a[68:71]
  v_mfma_f32_16x16x32_bf16 a[72:75], v[116:119], v[52:55], a[72:75]
  ds_read_b128 v[88:91], v21 offset:6144
  v_mfma_f32_16x16x32_bf16 a[76:79], v[120:123], v[52:55], a[76:79]
  v_mfma_f32_16x16x32_bf16 a[80:83], v[124:127], v[52:55], a[80:83]
  ds_read_b64_tr_b16 v[152:153], v33 offset:49152
  v_mfma_f32_16x16x32_bf16 a[84:87], v[128:131], v[52:55], a[84:87]
  v_mfma_f32_16x16x32_bf16 a[88:91], v[132:135], v[52:55], a[88:91]
  ds_read_b64_tr_b16 v[154:155], v33 offset:51200
  v_mfma_f32_16x16x32_bf16 a[92:95], v[136:139], v[52:55], a[92:95]
  v_mfma_f32_16x16x32_bf16 a[96:99], v[108:111], v[56:59], a[96:99]
  ds_read_b128 v[92:95], v21 offset:8192
  v_mfma_f32_16x16x32_bf16 a[100:103], v[112:115], v[56:59], a[100:103]
  v_mfma_f32_16x16x32_bf16 a[104:107], v[116:119], v[56:59], a[104:107]
  ds_read_b64_tr_b16 v[156:157], v34 offset:49152
  v_mfma_f32_16x16x32_bf16 a[108:111], v[120:123], v[56:59], a[108:111]
  v_mfma_f32_16x16x32_bf16 a[112:115], v[124:127], v[56:59], a[112:115]
  ds_read_b64_tr_b16 v[158:159], v34 offset:51200
  v_mfma_f32_16x16x32_bf16 a[116:119], v[128:131], v[56:59], a[116:119]
  v_mfma_f32_16x16x32_bf16 a[120:123], v[132:135], v[56:59], a[120:123]
  ds_read_b128 v[96:99], v21 offset:10240
  v_mfma_f32_16x16x32_bf16 a[124:127], v[136:139], v[56:59], a[124:127]
  v_mfma_f32_16x16x32_bf16 a[128:131], v[108:111], v[60:63], a[128:131]
  ds_read_b64_tr_b16 v[160:161], v35 offset:49152
  v_mfma_f32_16x16x32_bf16 a[132:135], v[112:115], v[60:63], a[132:135]
  v_mfma_f32_16x16x32_bf16 a[136:139], v[116:119], v[60:63], a[136:139]
  ds_read_b64_tr_b16 v[162:163], v35 offset:51200
  v_mfma_f32_16x16x32_bf16 a[140:143], v[120:123], v[60:63], a[140:143]
  v_mfma_f32_16x16x32_bf16 a[144:147], v[124:127], v[60:63], a[144:147]
  ds_read_b128 v[100:103], v21 offset:12288
  v_mfma_f32_16x16x32_bf16 a[148:151], v[128:131], v[60:63], a[148:151]
  v_mfma_f32_16x16x32_bf16 a[152:155], v[132:135], v[60:63], a[152:155]
  ds_read_b64_tr_b16 v[164:165], v36 offset:49152
  v_mfma_f32_16x16x32_bf16 a[156:159], v[136:139], v[60:63], a[156:159]
  v_mfma_f32_16x16x32_bf16 a[160:163], v[108:111], v[64:67], a[160:163]
  ds_read_b64_tr_b16 v[166:167], v36 offset:51200
  v_mfma_f32_16x16x32_bf16 a[164:167], v[112:115], v[64:67], a[164:167]
  v_mfma_f32_16x16x32_bf16 a[168:171], v[116:119], v[64:67], a[168:171]
  ds_read_b128 v[104:107], v21 offset:14336
  v_mfma_f32_16x16x32_bf16 a[172:175], v[120:123], v[64:67], a[172:175]
  v_mfma_f32_16x16x32_bf16 a[176:179], v[124:127], v[64:67], a[176:179]
  ds_read_b64_tr_b16 v[168:169], v37 offset:49152
  v_mfma_f32_16x16x32_bf16 a[180:183], v[128:131], v[64:67], a[180:183]
  v_mfma_f32_16x16x32_bf16 a[184:187], v[132:135], v[64:67], a[184:187]
  ds_read_b64_tr_b16 v[170:171], v37 offset:51200
  v_mfma_f32_16x16x32_bf16 a[188:191], v[136:139], v[64:67], a[188:191]
  v_mfma_f32_16x16x32_bf16 a[192:195], v[108:111], v[68:71], a[192:195]
  v_mfma_f32_16x16x32_bf16 a[196:199], v[112:115], v[68:71], a[196:199]
  v_mfma_f32_16x16x32_bf16 a[200:203], v[116:119], v[68:71], a[200:203]
  v_mfma_f32_16x16x32_bf16 a[204:207], v[120:123], v[68:71], a[204:207]
  v_mfma_f32_16x16x32_bf16 a[208:211], v[124:127], v[68:71], a[208:211]
  v_mfma_f32_16x16x32_bf16 a[212:215], v[128:131], v[68:71], a[212:215]
  v_mfma_f32_16x16x32_bf16 a[216:219], v[132:135], v[68:71], a[216:219]
  v_mfma_f32_16x16x32_bf16 a[220:223], v[136:139], v[68:71], a[220:223]
  v_mfma_f32_16x16x32_bf16 a[224:227], v[108:111], v[72:75], a[224:227]
  v_mfma_f32_16x16x32_bf16 a[228:231], v[112:115], v[72:75], a[228:231]
  v_mfma_f32_16x16x32_bf16 a[232:235], v[116:119], v[72:75], a[232:235]
  v_mfma_f32_16x16x32_bf16 a[236:239], v[120:123], v[72:75], a[236:239]
  v_mfma_f32_16x16x32_bf16 a[240:243], v[124:127], v[72:75], a[240:243]
  v_mfma_f32_16x16x32_bf16 a[244:247], v[128:131], v[72:75], a[244:247]
  v_mfma_f32_16x16x32_bf16 a[248:251], v[132:135], v[72:75], a[248:251]
  v_mfma_f32_16x16x32_bf16 a[252:255], v[136:139], v[72:75], a[252:255]
  s_waitcnt lgkmcnt(0)
  v_mfma_f32_16x16x32_bf16 a[0:3], v[140:143], v[76:79], a[0:3]
  s_waitcnt vmcnt(0)
  s_barrier
  s_add_u32 m0, s52, 65536
  v_mfma_f32_16x16x32_bf16 a[4:7], v[144:147], v[76:79], a[4:7]
  buffer_load_dwordx4 v2, s[8:11], s20 offen  lds
  ds_read_b128 v[44:47], v18 offset:0
  v_mfma_f32_16x16x32_bf16 a[8:11], v[148:151], v[76:79], a[8:11]
  v_mfma_f32_16x16x32_bf16 a[12:15], v[152:155], v[76:79], a[12:15]
  ds_read_b64_tr_b16 v[108:109], v22 offset:32768
  s_add_u32 m0, s53, 65536
  v_mfma_f32_16x16x32_bf16 a[16:19], v[156:159], v[76:79], a[16:19]
  buffer_load_dwordx4 v10, s[12:15], s21 offen  lds
  v_mfma_f32_16x16x32_bf16 a[20:23], v[160:163], v[76:79], a[20:23]
  ds_read_b64_tr_b16 v[110:111], v22 offset:34816
  v_mfma_f32_16x16x32_bf16 a[24:27], v[164:167], v[76:79], a[24:27]
  v_mfma_f32_16x16x32_bf16 a[28:31], v[168:171], v[76:79], a[28:31]
  ds_read_b128 v[48:51], v18 offset:2048
  s_add_u32 m0, s52, 66560
  v_mfma_f32_16x16x32_bf16 a[32:35], v[140:143], v[80:83], a[32:35]
  buffer_load_dwordx4 v3, s[8:11], s20 offen  lds
  v_mfma_f32_16x16x32_bf16 a[36:39], v[144:147], v[80:83], a[36:39]
  ds_read_b64_tr_b16 v[112:113], v23 offset:32768
  v_mfma_f32_16x16x32_bf16 a[40:43], v[148:151], v[80:83], a[40:43]
  v_mfma_f32_16x16x32_bf16 a[44:47], v[152:155], v[80:83], a[44:47]
  ds_read_b64_tr_b16 v[114:115], v23 offset:34816
  s_add_u32 m0, s53, 66560
  v_mfma_f32_16x16x32_bf16 a[48:51], v[156:159], v[80:83], a[48:51]
  buffer_load_dwordx4 v11, s[12:15], s21 offen  lds
  v_mfma_f32_16x16x32_bf16 a[52:55], v[160:163], v[80:83], a[52:55]
  ds_read_b128 v[52:55], v18 offset:4096
  v_mfma_f32_16x16x32_bf16 a[56:59], v[164:167], v[80:83], a[56:59]
  s_add_u32 m0, s52, 67584
  v_mfma_f32_16x16x32_bf16 a[60:63], v[168:171], v[80:83], a[60:63]
  buffer_load_dwordx4 v4, s[8:11], s20 offen  lds
  ds_read_b64_tr_b16 v[116:117], v24 offset:32768
  v_mfma_f32_16x16x32_bf16 a[64:67], v[140:143], v[84:87], a[64:67]
  v_mfma_f32_16x16x32_bf16 a[68:71], v[144:147], v[84:87], a[68:71]
  ds_read_b64_tr_b16 v[118:119], v24 offset:34816
  v_mfma_f32_16x16x32_bf16 a[72:75], v[148:151], v[84:87], a[72:75]
  s_add_u32 m0, s53, 67584
  v_mfma_f32_16x16x32_bf16 a[76:79], v[152:155], v[84:87], a[76:79]
  buffer_load_dwordx4 v12, s[12:15], s21 offen  lds
  ds_read_b128 v[56:59], v18 offset:6144
  v_mfma_f32_16x16x32_bf16 a[80:83], v[156:159], v[84:87], a[80:83]
  v_mfma_f32_16x16x32_bf16 a[84:87], v[160:163], v[84:87], a[84:87]
  ds_read_b64_tr_b16 v[120:121], v25 offset:32768
  v_mfma_f32_16x16x32_bf16 a[88:91], v[164:167], v[84:87], a[88:91]
  s_add_u32 m0, s52, 68608
  v_mfma_f32_16x16x32_bf16 a[92:95], v[168:171], v[84:87], a[92:95]
  buffer_load_dwordx4 v5, s[8:11], s20 offen  lds
  ds_read_b64_tr_b16 v[122:123], v25 offset:34816
  v_mfma_f32_16x16x32_bf16 a[96:99], v[140:143], v[88:91], a[96:99]
  v_mfma_f32_16x16x32_bf16 a[100:103], v[144:147], v[88:91], a[100:103]
  ds_read_b128 v[60:63], v18 offset:8192
  s_add_u32 m0, s53, 68608
  v_mfma_f32_16x16x32_bf16 a[104:107], v[148:151], v[88:91], a[104:107]
  buffer_load_dwordx4 v13, s[12:15], s21 offen  lds
  v_mfma_f32_16x16x32_bf16 a[108:111], v[152:155], v[88:91], a[108:111]
  ds_read_b64_tr_b16 v[124:125], v26 offset:32768
  v_mfma_f32_16x16x32_bf16 a[112:115], v[156:159], v[88:91], a[112:115]
  v_mfma_f32_16x16x32_bf16 a[116:119], v[160:163], v[88:91], a[116:119]
  ds_read_b64_tr_b16 v[126:127], v26 offset:34816
  s_add_u32 m0, s52, 69632
  v_mfma_f32_16x16x32_bf16 a[120:123], v[164:167], v[88:91], a[120:123]
  buffer_load_dwordx4 v6, s[8:11], s20 offen  lds
  v_mfma_f32_16x16x32_bf16 a[124:127], v[168:171], v[88:91], a[124:127]
  ds_read_b128 v[64:67], v18 offset:10240
  v_mfma_f32_16x16x32_bf16 a[128:131], v[140:143], v[92:95], a[128:131]
  v_mfma_f32_16x16x32_bf16 a[132:135], v[144:147], v[92:95], a[132:135]
  ds_read_b64_tr_b16 v[128:129], v27 offset:32768
  s_add_u32 m0, s53, 69632
  v_mfma_f32_16x16x32_bf16 a[136:139], v[148:151], v[92:95], a[136:139]
  buffer_load_dwordx4 v14, s[12:15], s21 offen  lds
  v_mfma_f32_16x16x32_bf16 a[140:143], v[152:155], v[92:95], a[140:143]
  ds_read_b64_tr_b16 v[130:131], v27 offset:34816
  v_mfma_f32_16x16x32_bf16 a[144:147], v[156:159], v[92:95], a[144:147]
  v_mfma_f32_16x16x32_bf16 a[148:151], v[160:163], v[92:95], a[148:151]
  ds_read_b128 v[68:71], v18 offset:12288
  s_add_u32 m0, s52, 70656
  v_mfma_f32_16x16x32_bf16 a[152:155], v[164:167], v[92:95], a[152:155]
  buffer_load_dwordx4 v7, s[8:11], s20 offen  lds
  v_mfma_f32_16x16x32_bf16 a[156:159], v[168:171], v[92:95], a[156:159]
  ds_read_b64_tr_b16 v[132:133], v28 offset:32768
  v_mfma_f32_16x16x32_bf16 a[160:163], v[140:143], v[96:99], a[160:163]
  s_add_u32 m0, s53, 70656
  v_mfma_f32_16x16x32_bf16 a[164:167], v[144:147], v[96:99], a[164:167]
  buffer_load_dwordx4 v15, s[12:15], s21 offen  lds
  ds_read_b64_tr_b16 v[134:135], v28 offset:34816
  v_mfma_f32_16x16x32_bf16 a[168:171], v[148:151], v[96:99], a[168:171]
  v_mfma_f32_16x16x32_bf16 a[172:175], v[152:155], v[96:99], a[172:175]
  ds_read_b128 v[72:75], v18 offset:14336
  v_mfma_f32_16x16x32_bf16 a[176:179], v[156:159], v[96:99], a[176:179]
  s_add_u32 m0, s52, 71680
  v_mfma_f32_16x16x32_bf16 a[180:183], v[160:163], v[96:99], a[180:183]
  buffer_load_dwordx4 v8, s[8:11], s20 offen  lds
  ds_read_b64_tr_b16 v[136:137], v29 offset:32768
  v_mfma_f32_16x16x32_bf16 a[184:187], v[164:167], v[96:99], a[184:187]
  v_mfma_f32_16x16x32_bf16 a[188:191], v[168:171], v[96:99], a[188:191]
  ds_read_b64_tr_b16 v[138:139], v29 offset:34816
  v_mfma_f32_16x16x32_bf16 a[192:195], v[140:143], v[100:103], a[192:195]
  s_add_u32 m0, s53, 71680
  v_mfma_f32_16x16x32_bf16 a[196:199], v[144:147], v[100:103], a[196:199]
  buffer_load_dwordx4 v16, s[12:15], s21 offen  lds
  v_mfma_f32_16x16x32_bf16 a[200:203], v[148:151], v[100:103], a[200:203]
  v_mfma_f32_16x16x32_bf16 a[204:207], v[152:155], v[100:103], a[204:207]
  s_add_u32 m0, s52, 72704
  v_mfma_f32_16x16x32_bf16 a[208:211], v[156:159], v[100:103], a[208:211]
  buffer_load_dwordx4 v9, s[8:11], s20 offen  lds
  v_mfma_f32_16x16x32_bf16 a[212:215], v[160:163], v[100:103], a[212:215]
  v_mfma_f32_16x16x32_bf16 a[216:219], v[164:167], v[100:103], a[216:219]
  v_mfma_f32_16x16x32_bf16 a[220:223], v[168:171], v[100:103], a[220:223]
  s_add_u32 m0, s53, 72704
  v_mfma_f32_16x16x32_bf16 a[224:227], v[140:143], v[104:107], a[224:227]
  buffer_load_dwordx4 v17, s[12:15], s21 offen  lds
  v_mfma_f32_16x16x32_bf16 a[228:231], v[144:147], v[104:107], a[228:231]
  v_mfma_f32_16x16x32_bf16 a[232:235], v[148:151], v[104:107], a[232:235]
  v_mfma_f32_16x16x32_bf16 a[236:239], v[152:155], v[104:107], a[236:239]
  s_add_u32 s20, s20, 128
  v_mfma_f32_16x16x32_bf16 a[240:243], v[156:159], v[104:107], a[240:243]
  s_add_u32 s21, s21, s51
  v_mfma_f32_16x16x32_bf16 a[244:247], v[160:163], v[104:107], a[244:247]
  v_mfma_f32_16x16x32_bf16 a[248:251], v[164:167], v[104:107], a[248:251]
  v_mfma_f32_16x16x32_bf16 a[252:255], v[168:171], v[104:107], a[252:255]
  s_branch L_g1_loop
L_g1_fin:
  s_cmp_lg_u32 s32, 0
  s_cbranch_scc1 L_rq_8
  s_cmp_eq_u32 s39, 0
  s_cbranch_scc1 L_rq_8
  s_lshl_b32 s99, s33, 7
  s_add_u32 s99, s99, 0x3d00200
  v_mov_b32 v244, 1
  v_mov_b32 v245, 0
  s_mov_b64 exec, 1
  buffer_atomic_add v244, v245, s[4:7], s99 offen sc0 sc1
  s_mov_b64 exec, -1
L_rq_8:
  s_waitcnt lgkmcnt(0)
  v_mfma_f32_16x16x32_bf16 a[0:3], v[108:111], v[44:47], a[0:3]
  ds_read_b128 v[76:79], v19 offset:0
  v_mfma_f32_16x16x32_bf16 a[4:7], v[112:115], v[44:47], a[4:7]
  v_mfma_f32_16x16x32_bf16 a[8:11], v[116:119], v[44:47], a[8:11]
  ds_read_b64_tr_b16 v[140:141], v22 offset:49152
  v_mfma_f32_16x16x32_bf16 a[12:15], v[120:123], v[44:47], a[12:15]
  v_mfma_f32_16x16x32_bf16 a[16:19], v[124:127], v[44:47], a[16:19]
  ds_read_b64_tr_b16 v[142:143], v22 offset:51200
  v_mfma_f32_16x16x32_bf16 a[20:23], v[128:131], v[44:47], a[20:23]
  v_mfma_f32_16x16x32_bf16 a[24:27], v[132:135], v[44:47], a[24:27]
  ds_read_b128 v[80:83], v19 offset:2048
  v_mfma_f32_16x16x32_bf16 a[28:31], v[136:139], v[44:47], a[28:31]
  v_mfma_f32_16x16x32_bf16 a[32:35], v[108:111], v[48:51], a[32:35]
  ds_read_b64_tr_b16 v[144:145], v23 offset:49152
  v_mfma_f32_16x16x32_bf16 a[36:39], v[112:115], v[48:51], a[36:39]
  v_mfma_f32_16x16x32_bf16 a[40:43], v[116:119], v[48:51], a[40:43]
  ds_read_b64_tr_b16 v[146:147], v23 offset:51200
  v_mfma_f32_16x16x32_bf16 a[44:47], v[120:123], v[48:51], a[44:47]
  v_mfma_f32_16x16x32_bf16 a[48:51], v[124:127], v[48:51], a[48:51]
  ds_read_b128 v[84:87], v19 offset:4096
  v_mfma_f32_16x16x32_bf16 a[52:55], v[128:131], v[48:51], a[52:55]
  v_mfma_f32_16x16x32_bf16 a[56:59], v[132:135], v[48:51], a[56:59]
  ds_read_b64_tr_b16 v[148:149], v24 offset:49152
  v_mfma_f32_16x16x32_bf16 a[60:63], v[136:139], v[48:51], a[60:63]
  v_mfma_f32_16x16x32_bf16 a[64:67], v[108:111], v[52:55], a[64:67]
  ds_read_b64_tr_b16 v[150:151], v24 offset:51200
  v_mfma_f32_16x16x32_bf16 a[68:71], v[112:115], v[52:55], a[68:71]
  v_mfma_f32_16x16x32_bf16 a[72:75], v[116:119], v[52:55], a[72:75]
  ds_read_b128 v[88:91], v19 offset:6144
  v_mfma_f32_16x16x32_bf16 a[76:79], v[120:123], v[52:55], a[76:79]
  v_mfma_f32_16x16x32_bf16 a[80:83], v[124:127], v[52:55], a[80:83]
  ds_read_b64_tr_b16 v[152:153], v25 offset:49152
  v_mfma_f32_16x16x32_bf16 a[84:87], v[128:131], v[52:55], a[84:87]
  v_mfma_f32_16x16x32_bf16 a[88:91], v[132:135], v[52:55], a[88:91]
  ds_read_b64_tr_b16 v[154:155], v25 offset:51200
  v_mfma_f32_16x16x32_bf16 a[92:95], v[136:139], v[52:55], a[92:95]
  v_mfma_f32_16x16x32_bf16 a[96:99], v[108:111], v[56:59], a[96:99]
  ds_read_b128 v[92:95], v19 offset:8192
  v_mfma_f32_16x16x32_bf16 a[100:103], v[112:115], v[56:59], a[100:103]
  v_mfma_f32_16x16x32_bf16 a[104:107], v[116:119], v[56:59], a[104:107]
  ds_read_b64_tr_b16 v[156:157], v26 offset:49152
  v_mfma_f32_16x16x32_bf16 a[108:111], v[120:123], v[56:59], a[108:111]
  v_mfma_f32_16x16x32_bf16 a[112:115], v[124:127], v[56:59], a[112:115]
  ds_read_b64_tr_b16 v[158:159], v26 offset:51200
  v_mfma_f32_16x16x32_bf16 a[116:119], v[128:131], v[56:59], a[116:119]
  v_mfma_f32_16x16x32_bf16 a[120:123], v[132:135], v[56:59], a[120:123]
  ds_read_b128 v[96:99], v19 offset:10240
  v_mfma_f32_16x16x32_bf16 a[124:127], v[136:139], v[56:59], a[124:127]
  v_mfma_f32_16x16x32_bf16 a[128:131], v[108:111], v[60:63], a[128:131]
  ds_read_b64_tr_b16 v[160:161], v27 offset:49152
  v_mfma_f32_16x16x32_bf16 a[132:135], v[112:115], v[60:63], a[132:135]
  v_mfma_f32_16x16x32_bf16 a[136:139], v[116:119], v[60:63], a[136:139]
  ds_read_b64_tr_b16 v[162:163], v27 offset:51200
  v_mfma_f32_16x16x32_bf16 a[140:143], v[120:123], v[60:63], a[140:143]
  v_mfma_f32_16x16x32_bf16 a[144:147], v[124:127], v[60:63], a[144:147]
  ds_read_b128 v[100:103], v19 offset:12288
  v_mfma_f32_16x16x32_bf16 a[148:151], v[128:131], v[60:63], a[148:151]
  v_mfma_f32_16x16x32_bf16 a[152:155], v[132:135], v[60:63], a[152:155]
  ds_read_b64_tr_b16 v[164:165], v28 offset:49152
  v_mfma_f32_16x16x32_bf16 a[156:159], v[136:139], v[60:63], a[156:159]
  v_mfma_f32_16x16x32_bf16 a[160:163], v[108:111], v[64:67], a[160:163]
  ds_read_b64_tr_b16 v[166:167], v28 offset:51200
  v_mfma_f32_16x16x32_bf16 a[164:167], v[112:115], v[64:67], a[164:167]
  v_mfma_f32_16x16x32_bf16 a[168:171], v[116:119], v[64:67], a[168:171]
  ds_read_b128 v[104:107], v19 offset:14336
  v_mfma_f32_16x16x32_bf16 a[172:175], v[120:123], v[64:67], a[172:175]
  v_mfma_f32_16x16x32_bf16 a[176:179], v[124:127], v[64:67], a[176:179]
  ds_read_b64_tr_b16 v[168:169], v29 offset:49152
  v_mfma_f32_16x16x32_bf16 a[180:183], v[128:131], v[64:67], a[180:183]
  v_mfma_f32_16x16x32_bf16 a[184:187], v[132:135], v[64:67], a[184:187]
  ds_read_b64_tr_b16 v[170:171], v29 offset:51200
  v_mfma_f32_16x16x32_bf16 a[188:191], v[136:139], v[64:67], a[188:191]
  v_mfma_f32_16x16x32_bf16 a[192:195], v[108:111], v[68:71], a[192:195]
  v_mfma_f32_16x16x32_bf16 a[196:199], v[112:115], v[68:71], a[196:199]
  v_mfma_f32_16x16x32_bf16 a[200:203], v[116:119], v[68:71], a[200:203]
  v_mfma_f32_16x16x32_bf16 a[204:207], v[120:123], v[68:71], a[204:207]
  v_mfma_f32_16x16x32_bf16 a[208:211], v[124:127], v[68:71], a[208:211]
  v_mfma_f32_16x16x32_bf16 a[212:215], v[128:131], v[68:71], a[212:215]
  v_mfma_f32_16x16x32_bf16 a[216:219], v[132:135], v[68:71], a[216:219]
  v_mfma_f32_16x16x32_bf16 a[220:223], v[136:139], v[68:71], a[220:223]
  v_mfma_f32_16x16x32_bf16 a[224:227], v[108:111], v[72:75], a[224:227]
  v_mfma_f32_16x16x32_bf16 a[228:231], v[112:115], v[72:75], a[228:231]
  v_mfma_f32_16x16x32_bf16 a[232:235], v[116:119], v[72:75], a[232:235]
  v_mfma_f32_16x16x32_bf16 a[236:239], v[120:123], v[72:75], a[236:239]
  v_mfma_f32_16x16x32_bf16 a[240:243], v[124:127], v[72:75], a[240:243]
  v_mfma_f32_16x16x32_bf16 a[244:247], v[128:131], v[72:75], a[244:247]
  v_mfma_f32_16x16x32_bf16 a[248:251], v[132:135], v[72:75], a[248:251]
  v_mfma_f32_16x16x32_bf16 a[252:255], v[136:139], v[72:75], a[252:255]
  s_waitcnt lgkmcnt(0)
  v_mfma_f32_16x16x32_bf16 a[0:3], v[140:143], v[76:79], a[0:3]
  s_waitcnt vmcnt(0)
  s_barrier
  v_mfma_f32_16x16x32_bf16 a[4:7], v[144:147], v[76:79], a[4:7]
  ds_read_b128 v[44:47], v20 offset:0
  v_mfma_f32_16x16x32_bf16 a[8:11], v[148:151], v[76:79], a[8:11]
  v_mfma_f32_16x16x32_bf16 a[12:15], v[152:155], v[76:79], a[12:15]
  ds_read_b64_tr_b16 v[108:109], v30 offset:32768
  v_mfma_f32_16x16x32_bf16 a[16:19], v[156:159], v[76:79], a[16:19]
  v_mfma_f32_16x16x32_bf16 a[20:23], v[160:163], v[76:79], a[20:23]
  ds_read_b64_tr_b16 v[110:111], v30 offset:34816
  v_mfma_f32_16x16x32_bf16 a[24:27], v[164:167], v[76:79], a[24:27]
  v_mfma_f32_16x16x32_bf16 a[28:31], v[168:171], v[76:79], a[28:31]
  ds_read_b128 v[48:51], v20 offset:2048
  v_mfma_f32_16x16x32_bf16 a[32:35], v[140:143], v[80:83], a[32:35]
  v_mfma_f32_16x16x32_bf16 a[36:39], v[144:147], v[80:83], a[36:39]
  ds_read_b64_tr_b16 v[112:113], v31 offset:32768
  v_mfma_f32_16x16x32_bf16 a[40:43], v[148:151], v[80:83], a[40:43]
  v_mfma_f32_16x16x32_bf16 a[44:47], v[152:155], v[80:83], a[44:47]
  ds_read_b64_tr_b16 v[114:115], v31 offset:34816
  v_mfma_f32_16x16x32_bf16 a[48:51], v[156:159], v[80:83], a[48:51]
  v_mfma_f32_16x16x32_bf16 a[52:55], v[160:163], v[80:83], a[52:55]
  ds_read_b128 v[52:55], v20 offset:4096
  v_mfma_f32_16x16x32_bf16 a[56:59], v[164:167], v[80:83], a[56:59]
  v_mfma_f32_16x16x32_bf16 a[60:63], v[168:171], v[80:83], a[60:63]
  ds_read_b64_tr_b16 v[116:117], v32 offset:32768
  v_mfma_f32_16x16x32_bf16 a[64:67], v[140:143], v[84:87], a[64:67]
  v_mfma_f32_16x16x32_bf16 a[68:71], v[144:147], v[84:87], a[68:71]
  ds_read_b64_tr_b16 v[118:119], v32 offset:34816
  v_mfma_f32_16x16x32_bf16 a[72:75], v[148:151], v[84:87], a[72:75]
  v_mfma_f32_16x16x32_bf16 a[76:79], v[152:155], v[84:87], a[76:79]
  ds_read_b128 v[56:59], v20 offset:6144
  v_mfma_f32_16x16x32_bf16 a[80:83], v[156:159], v[84:87], a[80:83]
  v_mfma_f32_16x16x32_bf16 a[84:87], v[160:163], v[84:87], a[84:87]
  ds_read_b64_tr_b16 v[120:121], v33 offset:32768
  v_mfma_f32_16x16x32_bf16 a[88:91], v[164:167], v[84:87], a[88:91]
  v_mfma_f32_16x16x32_bf16 a[92:95], v[168:171], v[84:87], a[92:95]
  ds_read_b64_tr_b16 v[122:123], v33 offset:34816
  v_mfma_f32_16x16x32_bf16 a[96:99], v[140:143], v[88:91], a[96:99]
  v_mfma_f32_16x16x32_bf16 a[100:103], v[144:147], v[88:91], a[100:103]
  ds_read_b128 v[60:63], v20 offset:8192
  v_mfma_f32_16x16x32_bf16 a[104:107], v[148:151], v[88:91], a[104:107]
  v_mfma_f32_16x16x32_bf16 a[108:111], v[152:155], v[88:91], a[108:111]
  ds_read_b64_tr_b16 v[124:125], v34 offset:32768
  v_mfma_f32_16x16x32_bf16 a[112:115], v[156:159], v[88:91], a[112:115]
  v_mfma_f32_16x16x32_bf16 a[116:119], v[160:163], v[88:91], a[116:119]
  ds_read_b64_tr_b16 v[126:127], v34 offset:34816
  v_mfma_f32_16x16x32_bf16 a[120:123], v[164:167], v[88:91], a[120:123]
  v_mfma_f32_16x16x32_bf16 a[124:127], v[168:171], v[88:91], a[124:127]
  ds_read_b128 v[64:67], v20 offset:10240
  v_mfma_f32_16x16x32_bf16 a[128:131], v[140:143], v[92:95], a[128:131]
  v_mfma_f32_16x16x32_bf16 a[132:135], v[144:147], v[92:95], a[132:135]
  ds_read_b64_tr_b16 v[128:129], v35 offset:32768
  v_mfma_f32_16x16x32_bf16 a[136:139], v[148:151], v[92:95], a[136:139]
  v_mfma_f32_16x16x32_bf16 a[140:143], v[152:155], v[92:95], a[140:143]
  ds_read_b64_tr_b16 v[130:131], v35 offset:34816
  v_mfma_f32_16x16x32_bf16 a[144:147], v[156:159], v[92:95], a[144:147]
  v_mfma_f32_16x16x32_bf16 a[148:151], v[160:163], v[92:95], a[148:151]
  ds_read_b128 v[68:71], v20 offset:12288
  v_mfma_f32_16x16x32_bf16 a[152:155], v[164:167], v[92:95], a[152:155]
  v_mfma_f32_16x16x32_bf16 a[156:159], v[168:171], v[92:95], a[156:159]
  ds_read_b64_tr_b16 v[132:133], v36 offset:32768
  v_mfma_f32_16x16x32_bf16 a[160:163], v[140:143], v[96:99], a[160:163]
  v_mfma_f32_16x16x32_bf16 a[164:167], v[144:147], v[96:99], a[164:167]
  ds_read_b64_tr_b16 v[134:135], v36 offset:34816
  v_mfma_f32_16x16x32_bf16 a[168:171], v[148:151], v[96:99], a[168:171]
  v_mfma_f32_16x16x32_bf16 a[172:175], v[152:155], v[96:99], a[172:175]
  ds_read_b128 v[72:75], v20 offset:14336
  v_mfma_f32_16x16x32_bf16 a[176:179], v[156:159], v[96:99], a[176:179]
  v_mfma_f32_16x16x32_bf16 a[180:183], v[160:163], v[96:99], a[180:183]
  ds_read_b64_tr_b16 v[136:137], v37 offset:32768
  v_mfma_f32_16x16x32_bf16 a[184:187], v[164:167], v[96:99], a[184:187]
  v_mfma_f32_16x16x32_bf16 a[188:191], v[168:171], v[96:99], a[188:191]
  ds_read_b64_tr_b16 v[138:139], v37 offset:34816
  v_mfma_f32_16x16x32_bf16 a[192:195], v[140:143], v[100:103], a[192:195]
  v_mfma_f32_16x16x32_bf16 a[196:199], v[144:147], v[100:103], a[196:199]
  v_mfma_f32_16x16x32_bf16 a[200:203], v[148:151], v[100:103], a[200:203]
  v_mfma_f32_16x16x32_bf16 a[204:207], v[152:155], v[100:103], a[204:207]
  v_mfma_f32_16x16x32_bf16 a[208:211], v[156:159], v[100:103], a[208:211]
  v_mfma_f32_16x16x32_bf16 a[212:215], v[160:163], v[100:103], a[212:215]
  v_mfma_f32_16x16x32_bf16 a[216:219], v[164:167], v[100:103], a[216:219]
  v_mfma_f32_16x16x32_bf16 a[220:223], v[168:171], v[100:103], a[220:223]
  v_mfma_f32_16x16x32_bf16 a[224:227], v[140:143], v[104:107], a[224:227]
  v_mfma_f32_16x16x32_bf16 a[228:231], v[144:147], v[104:107], a[228:231]
  v_mfma_f32_16x16x32_bf16 a[232:235], v[148:151], v[104:107], a[232:235]
  v_mfma_f32_16x16x32_bf16 a[236:239], v[152:155], v[104:107], a[236:239]
  v_mfma_f32_16x16x32_bf16 a[240:243], v[156:159], v[104:107], a[240:243]
  v_mfma_f32_16x16x32_bf16 a[244:247], v[160:163], v[104:107], a[244:247]
  v_mfma_f32_16x16x32_bf16 a[248:251], v[164:167], v[104:107], a[248:251]
  v_mfma_f32_16x16x32_bf16 a[252:255], v[168:171], v[104:107], a[252:255]
  s_waitcnt lgkmcnt(0)
  v_mfma_f32_16x16x32_bf16 a[0:3], v[108:111], v[44:47], a[0:3]
  ds_read_b128 v[76:79], v21 offset:0
  v_mfma_f32_16x16x32_bf16 a[4:7], v[112:115], v[44:47], a[4:7]
  v_mfma_f32_16x16x32_bf16 a[8:11], v[116:119], v[44:47], a[8:11]
  ds_read_b64_tr_b16 v[140:141], v30 offset:49152
  v_mfma_f32_16x16x32_bf16 a[12:15], v[120:123], v[44:47], a[12:15]
  v_mfma_f32_16x16x32_bf16 a[16:19], v[124:127], v[44:47], a[16:19]
  ds_read_b64_tr_b16 v[142:143], v30 offset:51200
  v_mfma_f32_16x16x32_bf16 a[20:23], v[128:131], v[44:47], a[20:23]
  v_mfma_f32_16x16x32_bf16 a[24:27], v[132:135], v[44:47], a[24:27]
  ds_read_b128 v[80:83], v21 offset:2048
  v_mfma_f32_16x16x32_bf16 a[28:31], v[136:139], v[44:47], a[28:31]
  v_mfma_f32_16x16x32_bf16 a[32:35], v[108:111], v[48:51], a[32:35]
  ds_read_b64_tr_b16 v[144:145], v31 offset:49152
  v_mfma_f32_16x16x32_bf16 a[36:39], v[112:115], v[48:51], a[36:39]
  v_mfma_f32_16x16x32_bf16 a[40:43], v[116:119], v[48:51], a[40:43]
  ds_read_b64_tr_b16 v[146:147], v31 offset:51200
  v_mfma_f32_16x16x32_bf16 a[44:47], v[120:123], v[48:51], a[44:47]
  v_mfma_f32_16x16x32_bf16 a[48:51], v[124:127], v[48:51], a[48:51]
  ds_read_b128 v[84:87], v21 offset:4096
  v_mfma_f32_16x16x32_bf16 a[52:55], v[128:131], v[48:51], a[52:55]
  v_mfma_f32_16x16x32_bf16 a[56:59], v[132:135], v[48:51], a[56:59]
  ds_read_b64_tr_b16 v[148:149], v32 offset:49152
  v_mfma_f32_16x16x32_bf16 a[60:63], v[136:139], v[48:51], a[60:63]
  v_mfma_f32_16x16x32_bf16 a[64:67], v[108:111], v[52:55], a[64:67]
  ds_read_b64_tr_b16 v[150:151], v32 offset:51200
  v_mfma_f32_16x16x32_bf16 a[68:71], v[112:115], v[52:55], a[68:71]
  v_mfma_f32_16x16x32_bf16 a[72:75], v[116:119], v[52:55], a[72:75]
  ds_read_b128 v[88:91], v21 offset:6144
  v_mfma_f32_16x16x32_bf16 a[76:79], v[120:123], v[52:55], a[76:79]
  v_mfma_f32_16x16x32_bf16 a[80:83], v[124:127], v[52:55], a[80:83]
  ds_read_b64_tr_b16 v[152:153], v33 offset:49152
  v_mfma_f32_16x16x32_bf16 a[84:87], v[128:131], v[52:55], a[84:87]
  v_mfma_f32_16x16x32_bf16 a[88:91], v[132:135], v[52:55], a[88:91]
  ds_read_b64_tr_b16 v[154:155], v33 offset:51200
  v_mfma_f32_16x16x32_bf16 a[92:95], v[136:139], v[52:55], a[92:95]
  v_mfma_f32_16x16x32_bf16 a[96:99], v[108:111], v[56:59], a[96:99]
  ds_read_b128 v[92:95], v21 offset:8192
  v_mfma_f32_16x16x32_bf16 a[100:103], v[112:115], v[56:59], a[100:103]
  v_mfma_f32_16x16x32_bf16 a[104:107], v[116:119], v[56:59], a[104:107]
  ds_read_b64_tr_b16 v[156:157], v34 offset:49152
  v_mfma_f32_16x16x32_bf16 a[108:111], v[120:123], v[56:59], a[108:111]
  v_mfma_f32_16x16x32_bf16 a[112:115], v[124:127], v[56:59], a[112:115]
  ds_read_b64_tr_b16 v[158:159], v34 offset:51200
  v_mfma_f32_16x16x32_bf16 a[116:119], v[128:131], v[56:59], a[116:119]
  v_mfma_f32_16x16x32_bf16 a[120:123], v[132:135], v[56:59], a[120:123]
  ds_read_b128 v[96:99], v21 offset:10240
  v_mfma_f32_16x16x32_bf16 a[124:127], v[136:139], v[56:59], a[124:127]
  v_mfma_f32_16x16x32_bf16 a[128:131], v[108:111], v[60:63], a[128:131]
  ds_read_b64_tr_b16 v[160:161], v35 offset:49152
  v_mfma_f32_16x16x32_bf16 a[132:135], v[112:115], v[60:63], a[132:135]
  v_mfma_f32_16x16x32_bf16 a[136:139], v[116:119], v[60:63], a[136:139]
  ds_read_b64_tr_b16 v[162:163], v35 offset:51200
  v_mfma_f32_16x16x32_bf16 a[140:143], v[120:123], v[60:63], a[140:143]
  v_mfma_f32_16x16x32_bf16 a[144:147], v[124:127], v[60:63], a[144:147]
  ds_read_b128 v[100:103], v21 offset:12288
  v_mfma_f32_16x16x32_bf16 a[148:151], v[128:131], v[60:63], a[148:151]
  v_mfma_f32_16x16x32_bf16 a[152:155], v[132:135], v[60:63], a[152:155]
  ds_read_b64_tr_b16 v[164:165], v36 offset:49152
  v_mfma_f32_16x16x32_bf16 a[156:159], v[136:139], v[60:63], a[156:159]
  v_mfma_f32_16x16x32_bf16 a[160:163], v[108:111], v[64:67], a[160:163]
  ds_read_b64_tr_b16 v[166:167], v36 offset:51200
  v_mfma_f32_16x16x32_bf16 a[164:167], v[112:115], v[64:67], a[164:167]
  v_mfma_f32_16x16x32_bf16 a[168:171], v[116:119], v[64:67], a[168:171]
  ds_read_b128 v[104:107], v21 offset:14336
  v_mfma_f32_16x16x32_bf16 a[172:175], v[120:123], v[64:67], a[172:175]
  v_mfma_f32_16x16x32_bf16 a[176:179], v[124:127], v[64:67], a[176:179]
  ds_read_b64_tr_b16 v[168:169], v37 offset:49152
  v_mfma_f32_16x16x32_bf16 a[180:183], v[128:131], v[64:67], a[180:183]
  v_mfma_f32_16x16x32_bf16 a[184:187], v[132:135], v[64:67], a[184:187]
  ds_read_b64_tr_b16 v[170:171], v37 offset:51200
  v_mfma_f32_16x16x32_bf16 a[188:191], v[136:139], v[64:67], a[188:191]
  v_mfma_f32_16x16x32_bf16 a[192:195], v[108:111], v[68:71], a[192:195]
  v_mfma_f32_16x16x32_bf16 a[196:199], v[112:115], v[68:71], a[196:199]
  v_mfma_f32_16x16x32_bf16 a[200:203], v[116:119], v[68:71], a[200:203]
  v_mfma_f32_16x16x32_bf16 a[204:207], v[120:123], v[68:71], a[204:207]
  v_mfma_f32_16x16x32_bf16 a[208:211], v[124:127], v[68:71], a[208:211]
  v_mfma_f32_16x16x32_bf16 a[212:215], v[128:131], v[68:71], a[212:215]
  v_mfma_f32_16x16x32_bf16 a[216:219], v[132:135], v[68:71], a[216:219]
  v_mfma_f32_16x16x32_bf16 a[220:223], v[136:139], v[68:71], a[220:223]
  v_mfma_f32_16x16x32_bf16 a[224:227], v[108:111], v[72:75], a[224:227]
  v_mfma_f32_16x16x32_bf16 a[228:231], v[112:115], v[72:75], a[228:231]
  v_mfma_f32_16x16x32_bf16 a[232:235], v[116:119], v[72:75], a[232:235]
  v_mfma_f32_16x16x32_bf16 a[236:239], v[120:123], v[72:75], a[236:239]
  v_mfma_f32_16x16x32_bf16 a[240:243], v[124:127], v[72:75], a[240:243]
  v_mfma_f32_16x16x32_bf16 a[244:247], v[128:131], v[72:75], a[244:247]
  v_mfma_f32_16x16x32_bf16 a[248:251], v[132:135], v[72:75], a[248:251]
  v_mfma_f32_16x16x32_bf16 a[252:255], v[136:139], v[72:75], a[252:255]
  s_waitcnt lgkmcnt(0)
  v_mfma_f32_16x16x32_bf16 a[0:3], v[140:143], v[76:79], a[0:3]
  v_mfma_f32_16x16x32_bf16 a[4:7], v[144:147], v[76:79], a[4:7]
  v_mfma_f32_16x16x32_bf16 a[8:11], v[148:151], v[76:79], a[8:11]
  v_mfma_f32_16x16x32_bf16 a[12:15], v[152:155], v[76:79], a[12:15]
  v_mfma_f32_16x16x32_bf16 a[16:19], v[156:159], v[76:79], a[16:19]
  v_mfma_f32_16x16x32_bf16 a[20:23], v[160:163], v[76:79], a[20:23]
  v_mfma_f32_16x16x32_bf16 a[24:27], v[164:167], v[76:79], a[24:27]
  v_mfma_f32_16x16x32_bf16 a[28:31], v[168:171], v[76:79], a[28:31]
  v_mfma_f32_16x16x32_bf16 a[32:35], v[140:143], v[80:83], a[32:35]
  v_mfma_f32_16x16x32_bf16 a[36:39], v[144:147], v[80:83], a[36:39]
  v_mfma_f32_16x16x32_bf16 a[40:43], v[148:151], v[80:83], a[40:43]
  v_mfma_f32_16x16x32_bf16 a[44:47], v[152:155], v[80:83], a[44:47]
  v_mfma_f32_16x16x32_bf16 a[48:51], v[156:159], v[80:83], a[48:51]
  v_mfma_f32_16x16x32_bf16 a[52:55], v[160:163], v[80:83], a[52:55]
  v_mfma_f32_16x16x32_bf16 a[56:59], v[164:167], v[80:83], a[56:59]
  v_mfma_f32_16x16x32_bf16 a[60:63], v[168:171], v[80:83], a[60:63]
  v_mfma_f32_16x16x32_bf16 a[64:67], v[140:143], v[84:87], a[64:67]
  v_mfma_f32_16x16x32_bf16 a[68:71], v[144:147], v[84:87], a[68:71]
  v_mfma_f32_16x16x32_bf16 a[72:75], v[148:151], v[84:87], a[72:75]
  v_mfma_f32_16x16x32_bf16 a[76:79], v[152:155], v[84:87], a[76:79]
  v_mfma_f32_16x16x32_bf16 a[80:83], v[156:159], v[84:87], a[80:83]
  v_mfma_f32_16x16x32_bf16 a[84:87], v[160:163], v[84:87], a[84:87]
  v_mfma_f32_16x16x32_bf16 a[88:91], v[164:167], v[84:87], a[88:91]
  v_mfma_f32_16x16x32_bf16 a[92:95], v[168:171], v[84:87], a[92:95]
  v_mfma_f32_16x16x32_bf16 a[96:99], v[140:143], v[88:91], a[96:99]
  v_mfma_f32_16x16x32_bf16 a[100:103], v[144:147], v[88:91], a[100:103]
  v_mfma_f32_16x16x32_bf16 a[104:107], v[148:151], v[88:91], a[104:107]
  v_mfma_f32_16x16x32_bf16 a[108:111], v[152:155], v[88:91], a[108:111]
  v_mfma_f32_16x16x32_bf16 a[112:115], v[156:159], v[88:91], a[112:115]
  v_mfma_f32_16x16x32_bf16 a[116:119], v[160:163], v[88:91], a[116:119]
  v_mfma_f32_16x16x32_bf16 a[120:123], v[164:167], v[88:91], a[120:123]
  v_mfma_f32_16x16x32_bf16 a[124:127], v[168:171], v[88:91], a[124:127]
  v_mfma_f32_16x16x32_bf16 a[128:131], v[140:143], v[92:95], a[128:131]
  v_mfma_f32_16x16x32_bf16 a[132:135], v[144:147], v[92:95], a[132:135]
  v_mfma_f32_16x16x32_bf16 a[136:139], v[148:151], v[92:95], a[136:139]
  v_mfma_f32_16x16x32_bf16 a[140:143], v[152:155], v[92:95], a[140:143]
  v_mfma_f32_16x16x32_bf16 a[144:147], v[156:159], v[92:95], a[144:147]
  v_mfma_f32_16x16x32_bf16 a[148:151], v[160:163], v[92:95], a[148:151]
  v_mfma_f32_16x16x32_bf16 a[152:155], v[164:167], v[92:95], a[152:155]
  v_mfma_f32_16x16x32_bf16 a[156:159], v[168:171], v[92:95], a[156:159]
  v_mfma_f32_16x16x32_bf16 a[160:163], v[140:143], v[96:99], a[160:163]
  v_mfma_f32_16x16x32_bf16 a[164:167], v[144:147], v[96:99], a[164:167]
  v_mfma_f32_16x16x32_bf16 a[168:171], v[148:151], v[96:99], a[168:171]
  v_mfma_f32_16x16x32_bf16 a[172:175], v[152:155], v[96:99], a[172:175]
  v_mfma_f32_16x16x32_bf16 a[176:179], v[156:159], v[96:99], a[176:179]
  v_mfma_f32_16x16x32_bf16 a[180:183], v[160:163], v[96:99], a[180:183]
  v_mfma_f32_16x16x32_bf16 a[184:187], v[164:167], v[96:99], a[184:187]
  v_mfma_f32_16x16x32_bf16 a[188:191], v[168:171], v[96:99], a[188:191]
  v_mfma_f32_16x16x32_bf16 a[192:195], v[140:143], v[100:103], a[192:195]
  v_mfma_f32_16x16x32_bf16 a[196:199], v[144:147], v[100:103], a[196:199]
  v_mfma_f32_16x16x32_bf16 a[200:203], v[148:151], v[100:103], a[200:203]
  v_mfma_f32_16x16x32_bf16 a[204:207], v[152:155], v[100:103], a[204:207]
  v_mfma_f32_16x16x32_bf16 a[208:211], v[156:159], v[100:103], a[208:211]
  v_mfma_f32_16x16x32_bf16 a[212:215], v[160:163], v[100:103], a[212:215]
  v_mfma_f32_16x16x32_bf16 a[216:219], v[164:167], v[100:103], a[216:219]
  v_mfma_f32_16x16x32_bf16 a[220:223], v[168:171], v[100:103], a[220:223]
  v_mfma_f32_16x16x32_bf16 a[224:227], v[140:143], v[104:107], a[224:227]
  v_mfma_f32_16x16x32_bf16 a[228:231], v[144:147], v[104:107], a[228:231]
  v_mfma_f32_16x16x32_bf16 a[232:235], v[148:151], v[104:107], a[232:235]
  v_mfma_f32_16x16x32_bf16 a[236:239], v[152:155], v[104:107], a[236:239]
  v_mfma_f32_16x16x32_bf16 a[240:243], v[156:159], v[104:107], a[240:243]
  v_mfma_f32_16x16x32_bf16 a[244:247], v[160:163], v[104:107], a[244:247]
  v_mfma_f32_16x16x32_bf16 a[248:251], v[164:167], v[104:107], a[248:251]
  v_mfma_f32_16x16x32_bf16 a[252:255], v[168:171], v[104:107], a[252:255]
  s_mov_b32 s59, 1
  s_mov_b32 s60, s22
  s_mov_b32 s61, s26
  s_add_u32 s62, s38, 0x3d00000
  s_mov_b32 s63, s98
  s_cmp_lg_u32 s39, 0
  s_cbranch_scc1 L_got
  s_mov_b32 s58, 3
  s_branch L_epi
L_g2:
  s_waitcnt vmcnt(16)
  s_barrier
  ds_read_b128 v[44:47], v18 offset:0
  ds_read_b64_tr_b16 v[108:109], v22 offset:32768
  ds_read_b64_tr_b16 v[110:111], v22 offset:34816
  ds_read_b128 v[48:51], v18 offset:2048
  ds_read_b64_tr_b16 v[112:113], v23 offset:32768
  ds_read_b64_tr_b16 v[114:115], v23 offset:34816
  ds_read_b128 v[52:55], v18 offset:4096
  ds_read_b64_tr_b16 v[116:117], v24 offset:32768
  ds_read_b64_tr_b16 v[118:119], v24 offset:34816
  ds_read_b128 v[56:59], v18 offset:6144
  ds_read_b64_tr_b16 v[120:121], v25 offset:32768
  ds_read_b64_tr_b16 v[122:123], v25 offset:34816
  ds_read_b128 v[60:63], v18 offset:8192
  ds_read_b64_tr_b16 v[124:125], v26 offset:32768
  ds_read_b64_tr_b16 v[126:127], v26 offset:34816
  ds_read_b128 v[64:67], v18 offset:10240
  ds_read_b64_tr_b16 v[128:129], v27 offset:32768
  ds_read_b64_tr_b16 v[130:131], v27 offset:34816
  ds_read_b128 v[68:71], v18 offset:12288
  ds_read_b64_tr_b16 v[132:133], v28 offset:32768
  ds_read_b64_tr_b16 v[134:135], v28 offset:34816
  ds_read_b128 v[72:75], v18 offset:14336
  ds_read_b64_tr_b16 v[136:137], v29 offset:32768
  ds_read_b64_tr_b16 v[138:139], v29 offset:34816
  s_sub_u32 s25, s25, 1
  s_waitcnt lgkmcnt(0)
  s_nop 0
  v_mfma_f32_16x16x32_bf16 a[0:3], v[44:47], v[108:111], 0
  buffer_store_dwordx4 v[176:179], v172, s[4:7], s46 offen offset:0 sc1
  ds_read_b128 v[76:79], v19 offset:0
  v_mfma_f32_16x16x32_bf16 a[4:7], v[44:47], v[112:115], 0
  v_mfma_f32_16x16x32_bf16 a[8:11], v[44:47], v[116:119], 0
  ds_read_b64_tr_b16 v[140:141], v22 offset:49152
  v_mfma_f32_16x16x32_bf16 a[12:15], v[44:47], v[120:123], 0
  s_nop 0
  v_mfma_f32_16x16x32_bf16 a[16:19], v[44:47], v[124:127], 0
  buffer_store_dwordx4 v[180:183], v172, s[4:7], s46 offen offset:1024 sc1
  ds_read_b64_tr_b16 v[142:143], v22 offset:51200
  v_mfma_f32_16x16x32_bf16 a[20:23], v[44:47], v[128:131], 0
  v_mfma_f32_16x16x32_bf16 a[24:27], v[44:47], v[132:135], 0
  ds_read_b128 v[80:83], v19 offset:2048
  v_mfma_f32_16x16x32_bf16 a[28:31], v[44:47], v[136:139], 0
  s_nop 0
  v_mfma_f32_16x16x32_bf16 a[32:35], v[48:51], v[108:111], 0
  buffer_store_dwordx4 v[184:187], v172, s[4:7], s46 offen offset:2048 sc1
  ds_read_b64_tr_b16 v[144:145], v23 offset:49152
  v_mfma_f32_16x16x32_bf16 a[36:39], v[48:51], v[112:115], 0
  v_mfma_f32_16x16x32_bf16 a[40:43], v[48:51], v[116:119], 0
  ds_read_b64_tr_b16 v[146:147], v23 offset:51200
  v_mfma_f32_16x16x32_bf16 a[44:47], v[48:51], v[120:123], 0
  s_nop 0
  v_mfma_f32_16x16x32_bf16 a[48:51], v[48:51], v[124:127], 0
  buffer_store_dwordx4 v[188:191], v172, s[4:7], s46 offen offset:3072 sc1
  ds_read_b128 v[84:87], v19 offset:4096
  v_mfma_f32_16x16x32_bf16 a[52:55], v[48:51], v[128:131], 0
  v_mfma_f32_16x16x32_bf16 a[56:59], v[48:51], v[132:135], 0
  ds_read_b64_tr_b16 v[148:149], v24 offset:49152
  v_mfma_f32_16x16x32_bf16 a[60:63], v[48:51], v[136:139], 0
  s_nop 0
  v_mfma_f32_16x16x32_bf16 a[64:67], v[52:55], v[108:111], 0
  buffer_store_dwordx4 v[192:195], v173, s[4:7], s46 offen offset:0 sc1
  ds_read_b64_tr_b16 v[150:151], v24 offset:51200
  v_mfma_f32_16x16x32_bf16 a[68:71], v[52:55], v[112:115], 0
  v_mfma_f32_16x16x32_bf16 a[72:75], v[52:55], v[116:119], 0
  ds_read_b128 v[88:91], v19 offset:6144
  v_mfma_f32_16x16x32_bf16 a[76:79], v[52:55], v[120:123], 0
  s_nop 0
  v_mfma_f32_16x16x32_bf16 a[80:83], v[52:55], v[124:127], 0
  buffer_store_dwordx4 v[196:199], v173, s[4:7], s46 offen offset:1024 sc1
  ds_read_b64_tr_b16 v[152:153], v25 offset:49152
  v_mfma_f32_16x16x32_bf16 a[84:87], v[52:55], v[128:131], 0
  v_mfma_f32_16x16x32_bf16 a[88:91], v[52:55], v[132:135], 0
  ds_read_b64_tr_b16 v[154:155], v25 offset:51200
  v_mfma_f32_16x16x32_bf16 a[92:95], v[52:55], v[136:139], 0
  s_nop 0
  v_mfma_f32_16x16x32_bf16 a[96:99], v[56:59], v[108:111], 0
  buffer_store_dwordx4 v[200:203], v173, s[4:7], s46 offen offset:2048 sc1
  ds_read_b128 v[92:95], v19 offset:8192
  v_mfma_f32_16x16x32_bf16 a[100:103], v[56:59], v[112:115], 0
  v_mfma_f32_16x16x32_bf16 a[104:107], v[56:59], v[116:119], 0
  ds_read_b64_tr_b16 v[156:157], v26 offset:49152
  v_mfma_f32_16x16x32_bf16 a[108:111], v[56:59], v[120:123], 0
  s_nop 0
  v_mfma_f32_16x16x32_bf16 a[112:115], v[56:59], v[124:127], 0
  buffer_store_dwordx4 v[204:207], v173, s[4:7], s46 offen offset:3072 sc1
  ds_read_b64_tr_b16 v[158:159], v26 offset:51200
  v_mfma_f32_16x16x32_bf16 a[116:119], v[56:59], v[128:131], 0
  v_mfma_f32_16x16x32_bf16 a[120:123], v[56:59], v[132:135], 0
  ds_read_b128 v[96:99], v19 offset:10240
  v_mfma_f32_16x16x32_bf16 a[124:127], v[56:59], v[136:139], 0
  s_nop 0
  v_mfma_f32_16x16x32_bf16 a[128:131], v[60:63], v[108:111], 0
  buffer_store_dwordx4 v[208:211], v172, s[4:7], s47 offen offset:0 sc1
  ds_read_b64_tr_b16 v[160:161], v27 offset:49152
  v_mfma_f32_16x16x32_bf16 a[132:135], v[60:63], v[112:115], 0
  v_mfma_f32_16x16x32_bf16 a[136:139], v[60:63], v[116:119], 0
  ds_read_b64_tr_b16 v[162:163], v27 offset:51200
  v_mfma_f32_16x16x32_bf16 a[140:143], v[60:63], v[120:123], 0
  s_nop 0
  v_mfma_f32_16x16x32_bf16 a[144:147], v[60:63], v[124:127], 0
  buffer_store_dwordx4 v[212:215], v172, s[4:7], s47 offen offset:1024 sc1
  ds_read_b128 v[100:103], v19 offset:12288
  v_mfma_f32_16x16x32_bf16 a[148:151], v[60:63], v[128:131], 0
  v_mfma_f32_16x16x32_bf16 a[152:155], v[60:63], v[132:135], 0
  ds_read_b64_tr_b16 v[164:165], v28 offset:49152
  v_mfma_f32_16x16x32_bf16 a[156:159], v[60:63], v[136:139], 0
  s_nop 0
  v_mfma_f32_16x16x32_bf16 a[160:163], v[64:67], v[108:111], 0
  buffer_store_dwordx4 v[216:219], v172, s[4:7], s47 offen offset:2048 sc1
  ds_read_b64_tr_b16 v[166:167], v28 offset:51200
  v_mfma_f32_16x16x32_bf16 a[164:167], v[64:67], v[112:115], 0
  v_mfma_f32_16x16x32_bf16 a[168:171], v[64:67], v[116:119], 0
  ds_read_b128 v[104:107], v19 offset:14336
  v_mfma_f32_16x16x32_bf16 a[172:175], v[64:67], v[120:123], 0
  s_nop 0
  v_mfma_f32_16x16x32_bf16 a[176:179], v[64:67], v[124:127], 0
  buffer_store_dwordx4 v[220:223], v172, s[4:7], s47 offen offset:3072 sc1
  ds_read_b64_tr_b16 v[168:169], v29 offset:49152
  v_mfma_f32_16x16x32_bf16 a[180:183], v[64:67], v[128:131], 0
  v_mfma_f32_16x16x32_bf16 a[184:187], v[64:67], v[132:135], 0
  ds_read_b64_tr_b16 v[170:171], v29 offset:51200
  v_mfma_f32_16x16x32_bf16 a[188:191], v[64:67], v[136:139], 0
  s_nop 0
  v_mfma_f32_16x16x32_bf16 a[192:195], v[68:71], v[108:111], 0
  buffer_store_dwordx4 v[224:227], v173, s[4:7], s47 offen offset:0 sc1
  v_mfma_f32_16x16x32_bf16 a[196:199], v[68:71], v[112:115], 0
  v_mfma_f32_16x16x32_bf16 a[200:203], v[68:71], v[116:119], 0
  v_mfma_f32_16x16x32_bf16 a[204:207], v[68:71], v[120:123], 0
  s_nop 0
  v_mfma_f32_16x16x32_bf16 a[208:211], v[68:71], v[124:127], 0
  buffer_store_dwordx4 v[228:231], v173, s[4:7], s47 offen offset:1024 sc1
  v_mfma_f32_16x16x32_bf16 a[212:215], v[68:71], v[128:131], 0
  v_mfma_f32_16x16x32_bf16 a[216:219], v[68:71], v[132:135], 0
  v_mfma_f32_16x16x32_bf16 a[220:223], v[68:71], v[136:139], 0
  s_nop 0
  v_mfma_f32_16x16x32_bf16 a[224:227], v[72:75], v[108:111], 0
  buffer_store_dwordx4 v[232:235], v173, s[4:7], s47 offen offset:2048 sc1
  v_mfma_f32_16x16x32_bf16 a[228:231], v[72:75], v[112:115], 0
  v_mfma_f32_16x16x32_bf16 a[232:235], v[72:75], v[116:119], 0
  v_mfma_f32_16x16x32_bf16 a[236:239], v[72:75], v[120:123], 0
  s_nop 0
  v_mfma_f32_16x16x32_bf16 a[240:243], v[72:75], v[124:127], 0
  buffer_store_dwordx4 v[236:239], v173, s[4:7], s47 offen offset:3072 sc1
  v_mfma_f32_16x16x32_bf16 a[244:247], v[72:75], v[128:131], 0
  v_mfma_f32_16x16x32_bf16 a[248:251], v[72:75], v[132:135], 0
  v_mfma_f32_16x16x32_bf16 a[252:255], v[72:75], v[136:139], 0
  s_waitcnt lgkmcnt(0)
  v_mfma_f32_16x16x32_bf16 a[0:3], v[76:79], v[140:143], a[0:3]
  s_waitcnt vmcnt(16)
  s_barrier
  s_add_u32 m0, s52, 0
  v_mfma_f32_16x16x32_bf16 a[4:7], v[76:79], v[144:147], a[4:7]
  buffer_load_dwordx4 v2, s[8:11], s20 offen  lds
  ds_read_b128 v[44:47], v20 offset:0
  v_mfma_f32_16x16x32_bf16 a[8:11], v[76:79], v[148:151], a[8:11]
  v_mfma_f32_16x16x32_bf16 a[12:15], v[76:79], v[152:155], a[12:15]
  ds_read_b64_tr_b16 v[108:109], v30 offset:32768
  s_add_u32 m0, s53, 0
  v_mfma_f32_16x16x32_bf16 a[16:19], v[76:79], v[156:159], a[16:19]
  buffer_load_dwordx4 v10, s[12:15], s21 offen  lds
  v_mfma_f32_16x16x32_bf16 a[20:23], v[76:79], v[160:163], a[20:23]
  ds_read_b64_tr_b16 v[110:111], v30 offset:34816
  v_mfma_f32_16x16x32_bf16 a[24:27], v[76:79], v[164:167], a[24:27]
  v_mfma_f32_16x16x32_bf16 a[28:31], v[76:79], v[168:171], a[28:31]
  ds_read_b128 v[48:51], v20 offset:2048
  s_add_u32 m0, s52, 1024
  v_mfma_f32_16x16x32_bf16 a[32:35], v[80:83], v[140:143], a[32:35]
  buffer_load_dwordx4 v3, s[8:11], s20 offen  lds
  v_mfma_f32_16x16x32_bf16 a[36:39], v[80:83], v[144:147], a[36:39]
  ds_read_b64_tr_b16 v[112:113], v31 offset:32768
  v_mfma_f32_16x16x32_bf16 a[40:43], v[80:83], v[148:151], a[40:43]
  v_mfma_f32_16x16x32_bf16 a[44:47], v[80:83], v[152:155], a[44:47]
  ds_read_b64_tr_b16 v[114:115], v31 offset:34816
  s_add_u32 m0, s53, 1024
  v_mfma_f32_16x16x32_bf16 a[48:51], v[80:83], v[156:159], a[48:51]
  buffer_load_dwordx4 v11, s[12:15], s21 offen  lds
  v_mfma_f32_16x16x32_bf16 a[52:55], v[80:83], v[160:163], a[52:55]
  ds_read_b128 v[52:55], v20 offset:4096
  v_mfma_f32_16x16x32_bf16 a[56:59], v[80:83], v[164:167], a[56:59]
  s_add_u32 m0, s52, 2048
  v_mfma_f32_16x16x32_bf16 a[60:63], v[80:83], v[168:171], a[60:63]
  buffer_load_dwordx4 v4, s[8:11], s20 offen  lds
  ds_read_b64_tr_b16 v[116:117], v32 offset:32768
  v_mfma_f32_16x16x32_bf16 a[64:67], v[84:87], v[140:143], a[64:67]
  v_mfma_f32_16x16x32_bf16 a[68:71], v[84:87], v[144:147], a[68:71]
  ds_read_b64_tr_b16 v[118:119], v32 offset:34816
  v_mfma_f32_16x16x32_bf16 a[72:75], v[84:87], v[148:151], a[72:75]
  s_add_u32 m0, s53, 2048
  v_mfma_f32_16x16x32_bf16 a[76:79], v[84:87], v[152:155], a[76:79]
  buffer_load_dwordx4 v12, s[12:15], s21 offen  lds
  ds_read_b128 v[56:59], v20 offset:6144
  v_mfma_f32_16x16x32_bf16 a[80:83], v[84:87], v[156:159], a[80:83]
  v_mfma_f32_16x16x32_bf16 a[84:87], v[84:87], v[160:163], a[84:87]
  ds_read_b64_tr_b16 v[120:121], v33 offset:32768
  v_mfma_f32_16x16x32_bf16 a[88:91], v[84:87], v[164:167], a[88:91]
  s_add_u32 m0, s52, 3072
  v_mfma_f32_16x16x32_bf16 a[92:95], v[84:87], v[168:171], a[92:95]
  buffer_load_dwordx4 v5, s[8:11], s20 offen  lds
  ds_read_b64_tr_b16 v[122:123], v33 offset:34816
  v_mfma_f32_16x16x32_bf16 a[96:99], v[88:91], v[140:143], a[96:99]
  v_mfma_f32_16x16x32_bf16 a[100:103], v[88:91], v[144:147], a[100:103]
  ds_read_b128 v[60:63], v20 offset:8192
  s_add_u32 m0, s53, 3072
  v_mfma_f32_16x16x32_bf16 a[104:107], v[88:91], v[148:151], a[104:107]
  buffer_load_dwordx4 v13, s[12:15], s21 offen  lds
  v_mfma_f32_16x16x32_bf16 a[108:111], v[88:91], v[152:155], a[108:111]
  ds_read_b64_tr_b16 v[124:125], v34 offset:32768
  v_mfma_f32_16x16x32_bf16 a[112:115], v[88:91], v[156:159], a[112:115]
  v_mfma_f32_16x16x32_bf16 a[116:119], v[88:91], v[160:163], a[116:119]
  ds_read_b64_tr_b16 v[126:127], v34 offset:34816
  s_add_u32 m0, s52, 4096
  v_mfma_f32_16x16x32_bf16 a[120:123], v[88:91], v[164:167], a[120:123]
  buffer_load_dwordx4 v6, s[8:11], s20 offen  lds
  v_mfma_f32_16x16x32_bf16 a[124:127], v[88:91], v[168:171], a[124:127]
  ds_read_b128 v[64:67], v20 offset:10240
  v_mfma_f32_16x16x32_bf16 a[128:131], v[92:95], v[140:143], a[128:131]
  v_mfma_f32_16x16x32_bf16 a[132:135], v[92:95], v[144:147], a[132:135]
  ds_read_b64_tr_b16 v[128:129], v35 offset:32768
  s_add_u32 m0, s53, 4096
  v_mfma_f32_16x16x32_bf16 a[136:139], v[92:95], v[148:151], a[136:139]
  buffer_load_dwordx4 v14, s[12:15], s21 offen  lds
  v_mfma_f32_16x16x32_bf16 a[140:143], v[92:95], v[152:155], a[140:143]
  ds_read_b64_tr_b16 v[130:131], v35 offset:34816
  v_mfma_f32_16x16x32_bf16 a[144:147], v[92:95], v[156:159], a[144:147]
  v_mfma_f32_16x16x32_bf16 a[148:151], v[92:95], v[160:163], a[148:151]
  ds_read_b128 v[68:71], v20 offset:12288
  s_add_u32 m0, s52, 5120
  v_mfma_f32_16x16x32_bf16 a[152:155], v[92:95], v[164:167], a[152:155]
  buffer_load_dwordx4 v7, s[8:11], s20 offen  lds
  v_mfma_f32_16x16x32_bf16 a[156:159], v[92:95], v[168:171], a[156:159]
  ds_read_b64_tr_b16 v[132:133], v36 offset:32768
  v_mfma_f32_16x16x32_bf16 a[160:163], v[96:99], v[140:143], a[160:163]
  s_add_u32 m0, s53, 5120
  v_mfma_f32_16x16x32_bf16 a[164:167], v[96:99], v[144:147], a[164:167]
  buffer_load_dwordx4 v15, s[12:15], s21 offen  lds
  ds_read_b64_tr_b16 v[134:135], v36 offset:34816
  v_mfma_f32_16x16x32_bf16 a[168:171], v[96:99], v[148:151], a[168:171]
  v_mfma_f32_16x16x32_bf16 a[172:175], v[96:99], v[152:155], a[172:175]
  ds_read_b128 v[72:75], v20 offset:14336
  v_mfma_f32_16x16x32_bf16 a[176:179], v[96:99], v[156:159], a[176:179]
  s_add_u32 m0, s52, 6144
  v_mfma_f32_16x16x32_bf16 a[180:183], v[96:99], v[160:163], a[180:183]
  buffer_load_dwordx4 v8, s[8:11], s20 offen  lds
  ds_read_b64_tr_b16 v[136:137], v37 offset:32768
  v_mfma_f32_16x16x32_bf16 a[184:187], v[96:99], v[164:167], a[184:187]
  v_mfma_f32_16x16x32_bf16 a[188:191], v[96:99], v[168:171], a[188:191]
  ds_read_b64_tr_b16 v[138:139], v37 offset:34816
  v_mfma_f32_16x16x32_bf16 a[192:195], v[100:103], v[140:143], a[192:195]
  s_add_u32 m0, s53, 6144
  v_mfma_f32_16x16x32_bf16 a[196:199], v[100:103], v[144:147], a[196:199]
  buffer_load_dwordx4 v16, s[12:15], s21 offen  lds
  v_mfma_f32_16x16x32_bf16 a[200:203], v[100:103], v[148:151], a[200:203]
  v_mfma_f32_16x16x32_bf16 a[204:207], v[100:103], v[152:155], a[204:207]
  s_add_u32 m0, s52, 7168
  v_mfma_f32_16x16x32_bf16 a[208:211], v[100:103], v[156:159], a[208:211]
  buffer_load_dwordx4 v9, s[8:11], s20 offen  lds
  v_mfma_f32_16x16x32_bf16 a[212:215], v[100:103], v[160:163], a[212:215]
  v_mfma_f32_16x16x32_bf16 a[216:219], v[100:103], v[164:167], a[216:219]
  v_mfma_f32_16x16x32_bf16 a[220:223], v[100:103], v[168:171], a[220:223]
  s_add_u32 m0, s53, 7168
  v_mfma_f32_16x16x32_bf16 a[224:227], v[104:107], v[140:143], a[224:227]
  buffer_load_dwordx4 v17, s[12:15], s21 offen  lds
  v_mfma_f32_16x16x32_bf16 a[228:231], v[104:107], v[144:147], a[228:231]
  v_mfma_f32_16x16x32_bf16 a[232:235], v[104:107], v[148:151], a[232:235]
  v_mfma_f32_16x16x32_bf16 a[236:239], v[104:107], v[152:155], a[236:239]
  s_add_u32 s20, s20, 128
  v_mfma_f32_16x16x32_bf16 a[240:243], v[104:107], v[156:159], a[240:243]
  s_add_u32 s21, s21, s51
  v_mfma_f32_16x16x32_bf16 a[244:247], v[104:107], v[160:163], a[244:247]
  v_mfma_f32_16x16x32_bf16 a[248:251], v[104:107], v[164:167], a[248:251]
  v_mfma_f32_16x16x32_bf16 a[252:255], v[104:107], v[168:171], a[252:255]
  s_waitcnt lgkmcnt(0)
  v_mfma_f32_16x16x32_bf16 a[0:3], v[44:47], v[108:111], a[0:3]
  ds_read_b128 v[76:79], v21 offset:0
  v_mfma_f32_16x16x32_bf16 a[4:7], v[44:47], v[112:115], a[4:7]
  v_mfma_f32_16x16x32_bf16 a[8:11], v[44:47], v[116:119], a[8:11]
  ds_read_b64_tr_b16 v[140:141], v30 offset:49152
  v_mfma_f32_16x16x32_bf16 a[12:15], v[44:47], v[120:123], a[12:15]
  v_mfma_f32_16x16x32_bf16 a[16:19], v[44:47], v[124:127], a[16:19]
  ds_read_b64_tr_b16 v[142:143], v30 offset:51200
  v_mfma_f32_16x16x32_bf16 a[20:23], v[44:47], v[128:131], a[20:23]
  v_mfma_f32_16x16x32_bf16 a[24:27], v[44:47], v[132:135], a[24:27]
  ds_read_b128 v[80:83], v21 offset:2048
  v_mfma_f32_16x16x32_bf16 a[28:31], v[44:47], v[136:139], a[28:31]
  v_mfma_f32_16x16x32_bf16 a[32:35], v[48:51], v[108:111], a[32:35]
  ds_read_b64_tr_b16 v[144:145], v31 offset:49152
  v_mfma_f32_16x16x32_bf16 a[36:39], v[48:51], v[112:115], a[36:39]
  v_mfma_f32_16x16x32_bf16 a[40:43], v[48:51], v[116:119], a[40:43]
  ds_read_b64_tr_b16 v[146:147], v31 offset:51200
  v_mfma_f32_16x16x32_bf16 a[44:47], v[48:51], v[120:123], a[44:47]
  v_mfma_f32_16x16x32_bf16 a[48:51], v[48:51], v[124:127], a[48:51]
  ds_read_b128 v[84:87], v21 offset:4096
  v_mfma_f32_16x16x32_bf16 a[52:55], v[48:51], v[128:131], a[52:55]
  v_mfma_f32_16x16x32_bf16 a[56:59], v[48:51], v[132:135], a[56:59]
  ds_read_b64_tr_b16 v[148:149], v32 offset:49152
  v_mfma_f32_16x16x32_bf16 a[60:63], v[48:51], v[136:139], a[60:63]
  v_mfma_f32_16x16x32_bf16 a[64:67], v[52:55], v[108:111], a[64:67]
  ds_read_b64_tr_b16 v[150:151], v32 offset:51200
  v_mfma_f32_16x16x32_bf16 a[68:71], v[52:55], v[112:115], a[68:71]
  v_mfma_f32_16x16x32_bf16 a[72:75], v[52:55], v[116:119], a[72:75]
  ds_read_b128 v[88:91], v21 offset:6144
  v_mfma_f32_16x16x32_bf16 a[76:79], v[52:55], v[120:123], a[76:79]
  v_mfma_f32_16x16x32_bf16 a[80:83], v[52:55], v[124:127], a[80:83]
  ds_read_b64_tr_b16 v[152:153], v33 offset:49152
  v_mfma_f32_16x16x32_bf16 a[84:87], v[52:55], v[128:131], a[84:87]
  v_mfma_f32_16x16x32_bf16 a[88:91], v[52:55], v[132:135], a[88:91]
  ds_read_b64_tr_b16 v[154:155], v33 offset:51200
  v_mfma_f32_16x16x32_bf16 a[92:95], v[52:55], v[136:139], a[92:95]
  v_mfma_f32_16x16x32_bf16 a[96:99], v[56:59], v[108:111], a[96:99]
  ds_read_b128 v[92:95], v21 offset:8192
  v_mfma_f32_16x16x32_bf16 a[100:103], v[56:59], v[112:115], a[100:103]
  v_mfma_f32_16x16x32_bf16 a[104:107], v[56:59], v[116:119], a[104:107]
  ds_read_b64_tr_b16 v[156:157], v34 offset:49152
  v_mfma_f32_16x16x32_bf16 a[108:111], v[56:59], v[120:123], a[108:111]
  v_mfma_f32_16x16x32_bf16 a[112:115], v[56:59], v[124:127], a[112:115]
  ds_read_b64_tr_b16 v[158:159], v34 offset:51200
  v_mfma_f32_16x16x32_bf16 a[116:119], v[56:59], v[128:131], a[116:119]
  v_mfma_f32_16x16x32_bf16 a[120:123], v[56:59], v[132:135], a[120:123]
  ds_read_b128 v[96:99], v21 offset:10240
  v_mfma_f32_16x16x32_bf16 a[124:127], v[56:59], v[136:139], a[124:127]
  v_mfma_f32_16x16x32_bf16 a[128:131], v[60:63], v[108:111], a[128:131]
  ds_read_b64_tr_b16 v[160:161], v35 offset:49152
  v_mfma_f32_16x16x32_bf16 a[132:135], v[60:63], v[112:115], a[132:135]
  v_mfma_f32_16x16x32_bf16 a[136:139], v[60:63], v[116:119], a[136:139]
  ds_read_b64_tr_b16 v[162:163], v35 offset:51200
  v_mfma_f32_16x16x32_bf16 a[140:143], v[60:63], v[120:123], a[140:143]
  v_mfma_f32_16x16x32_bf16 a[144:147], v[60:63], v[124:127], a[144:147]
  ds_read_b128 v[100:103], v21 offset:12288
  v_mfma_f32_16x16x32_bf16 a[148:151], v[60:63], v[128:131], a[148:151]
  v_mfma_f32_16x16x32_bf16 a[152:155], v[60:63], v[132:135], a[152:155]
  ds_read_b64_tr_b16 v[164:165], v36 offset:49152
  v_mfma_f32_16x16x32_bf16 a[156:159], v[60:63], v[136:139], a[156:159]
  v_mfma_f32_16x16x32_bf16 a[160:163], v[64:67], v[108:111], a[160:163]
  ds_read_b64_tr_b16 v[166:167], v36 offset:51200
  v_mfma_f32_16x16x32_bf16 a[164:167], v[64:67], v[112:115], a[164:167]
  v_mfma_f32_16x16x32_bf16 a[168:171], v[64:67], v[116:119], a[168:171]
  ds_read_b128 v[104:107], v21 offset:14336
  v_mfma_f32_16x16x32_bf16 a[172:175], v[64:67], v[120:123], a[172:175]
  v_mfma_f32_16x16x32_bf16 a[176:179], v[64:67], v[124:127], a[176:179]
  ds_read_b64_tr_b16 v[168:169], v37 offset:49152
  v_mfma_f32_16x16x32_bf16 a[180:183], v[64:67], v[128:131], a[180:183]
  v_mfma_f32_16x16x32_bf16 a[184:187], v[64:67], v[132:135], a[184:187]
  ds_read_b64_tr_b16 v[170:171], v37 offset:51200
  v_mfma_f32_16x16x32_bf16 a[188:191], v[64:67], v[136:139], a[188:191]
  v_mfma_f32_16x16x32_bf16 a[192:195], v[68:71], v[108:111], a[192:195]
  v_mfma_f32_16x16x32_bf16 a[196:199], v[68:71], v[112:115], a[196:199]
  v_mfma_f32_16x16x32_bf16 a[200:203], v[68:71], v[116:119], a[200:203]
  v_mfma_f32_16x16x32_bf16 a[204:207], v[68:71], v[120:123], a[204:207]
  v_mfma_f32_16x16x32_bf16 a[208:211], v[68:71], v[124:127], a[208:211]
  v_mfma_f32_16x16x32_bf16 a[212:215], v[68:71], v[128:131], a[212:215]
  v_mfma_f32_16x16x32_bf16 a[216:219], v[68:71], v[132:135], a[216:219]
  v_mfma_f32_16x16x32_bf16 a[220:223], v[68:71], v[136:139], a[220:223]
  v_mfma_f32_16x16x32_bf16 a[224:227], v[72:75], v[108:111], a[224:227]
  v_mfma_f32_16x16x32_bf16 a[228:231], v[72:75], v[112:115], a[228:231]
  v_mfma_f32_16x16x32_bf16 a[232:235], v[72:75], v[116:119], a[232:235]
  v_mfma_f32_16x16x32_bf16 a[236:239], v[72:75], v[120:123], a[236:239]
  v_mfma_f32_16x16x32_bf16 a[240:243], v[72:75], v[124:127], a[240:243]
  v_mfma_f32_16x16x32_bf16 a[244:247], v[72:75], v[128:131], a[244:247]
  v_mfma_f32_16x16x32_bf16 a[248:251], v[72:75], v[132:135], a[248:251]
  v_mfma_f32_16x16x32_bf16 a[252:255], v[72:75], v[136:139], a[252:255]
  s_waitcnt lgkmcnt(0)
  v_mfma_f32_16x16x32_bf16 a[0:3], v[76:79], v[140:143], a[0:3]
  s_waitcnt vmcnt(0)
  s_barrier
  s_cmp_eq_u32 s49, 0
  s_cbranch_scc1 L_hs_9
  s_cmp_lg_u32 s32, 0
  s_cbranch_scc1 L_sig_10
  v_mov_b32 v254, s63
  v_mov_b32 v255, 0
  v_mbcnt_lo_u32_b32 v255, -1, 0
  v_lshlrev_b32 v255, 9, v255
  s_cmp_eq_u32 s63, 2
  s_cselect_b64 exec, 3, 1
  buffer_atomic_add v254, v255, s[4:7], s62 offen offset:0 sc1
  s_mov_b64 exec, -1
L_sig_10:
L_hs_9:
  s_add_u32 m0, s52, 65536
  v_mfma_f32_16x16x32_bf16 a[4:7], v[76:79], v[144:147], a[4:7]
  buffer_load_dwordx4 v2, s[8:11], s20 offen  lds
  ds_read_b128 v[44:47], v18 offset:0
  v_mfma_f32_16x16x32_bf16 a[8:11], v[76:79], v[148:151], a[8:11]
  v_mfma_f32_16x16x32_bf16 a[12:15], v[76:79], v[152:155], a[12:15]
  ds_read_b64_tr_b16 v[108:109], v22 offset:32768
  s_add_u32 m0, s53, 65536
  v_mfma_f32_16x16x32_bf16 a[16:19], v[76:79], v[156:159], a[16:19]
  buffer_load_dwordx4 v10, s[12:15], s21 offen  lds
  v_mfma_f32_16x16x32_bf16 a[20:23], v[76:79], v[160:163], a[20:23]
  ds_read_b64_tr_b16 v[110:111], v22 offset:34816
  v_mfma_f32_16x16x32_bf16 a[24:27], v[76:79], v[164:167], a[24:27]
  v_mfma_f32_16x16x32_bf16 a[28:31], v[76:79], v[168:171], a[28:31]
  ds_read_b128 v[48:51], v18 offset:2048
  s_add_u32 m0, s52, 66560
  v_mfma_f32_16x16x32_bf16 a[32:35], v[80:83], v[140:143], a[32:35]
  buffer_load_dwordx4 v3, s[8:11], s20 offen  lds
  v_mfma_f32_16x16x32_bf16 a[36:39], v[80:83], v[144:147], a[36:39]
  ds_read_b64_tr_b16 v[112:113], v23 offset:32768
  v_mfma_f32_16x16x32_bf16 a[40:43], v[80:83], v[148:151], a[40:43]
  v_mfma_f32_16x16x32_bf16 a[44:47], v[80:83], v[152:155], a[44:47]
  ds_read_b64_tr_b16 v[114:115], v23 offset:34816
  s_add_u32 m0, s53, 66560
  v_mfma_f32_16x16x32_bf16 a[48:51], v[80:83], v[156:159], a[48:51]
  buffer_load_dwordx4 v11, s[12:15], s21 offen  lds
  v_mfma_f32_16x16x32_bf16 a[52:55], v[80:83], v[160:163], a[52:55]
  ds_read_b128 v[52:55], v18 offset:4096
  v_mfma_f32_16x16x32_bf16 a[56:59], v[80:83], v[164:167], a[56:59]
  s_add_u32 m0, s52, 67584
  v_mfma_f32_16x16x32_bf16 a[60:63], v[80:83], v[168:171], a[60:63]
  buffer_load_dwordx4 v4, s[8:11], s20 offen  lds
  ds_read_b64_tr_b16 v[116:117], v24 offset:32768
  v_mfma_f32_16x16x32_bf16 a[64:67], v[84:87], v[140:143], a[64:67]
  v_mfma_f32_16x16x32_bf16 a[68:71], v[84:87], v[144:147], a[68:71]
  ds_read_b64_tr_b16 v[118:119], v24 offset:34816
  v_mfma_f32_16x16x32_bf16 a[72:75], v[84:87], v[148:151], a[72:75]
  s_add_u32 m0, s53, 67584
  v_mfma_f32_16x16x32_bf16 a[76:79], v[84:87], v[152:155], a[76:79]
  buffer_load_dwordx4 v12, s[12:15], s21 offen  lds
  ds_read_b128 v[56:59], v18 offset:6144
  v_mfma_f32_16x16x32_bf16 a[80:83], v[84:87], v[156:159], a[80:83]
  v_mfma_f32_16x16x32_bf16 a[84:87], v[84:87], v[160:163], a[84:87]
  ds_read_b64_tr_b16 v[120:121], v25 offset:32768
  v_mfma_f32_16x16x32_bf16 a[88:91], v[84:87], v[164:167], a[88:91]
  s_add_u32 m0, s52, 68608
  v_mfma_f32_16x16x32_bf16 a[92:95], v[84:87], v[168:171], a[92:95]
  buffer_load_dwordx4 v5, s[8:11], s20 offen  lds
  ds_read_b64_tr_b16 v[122:123], v25 offset:34816
  v_mfma_f32_16x16x32_bf16 a[96:99], v[88:91], v[140:143], a[96:99]
  v_mfma_f32_16x16x32_bf16 a[100:103], v[88:91], v[144:147], a[100:103]
  ds_read_b128 v[60:63], v18 offset:8192
  s_add_u32 m0, s53, 68608
  v_mfma_f32_16x16x32_bf16 a[104:107], v[88:91], v[148:151], a[104:107]
  buffer_load_dwordx4 v13, s[12:15], s21 offen  lds
  v_mfma_f32_16x16x32_bf16 a[108:111], v[88:91], v[152:155], a[108:111]
  ds_read_b64_tr_b16 v[124:125], v26 offset:32768
  v_mfma_f32_16x16x32_bf16 a[112:115], v[88:91], v[156:159], a[112:115]
  v_mfma_f32_16x16x32_bf16 a[116:119], v[88:91], v[160:163], a[116:119]
  ds_read_b64_tr_b16 v[126:127], v26 offset:34816
  s_add_u32 m0, s52, 69632
  v_mfma_f32_16x16x32_bf16 a[120:123], v[88:91], v[164:167], a[120:123]
  buffer_load_dwordx4 v6, s[8:11], s20 offen  lds
  v_mfma_f32_16x16x32_bf16 a[124:127], v[88:91], v[168:171], a[124:127]
  ds_read_b128 v[64:67], v18 offset:10240
  v_mfma_f32_16x16x32_bf16 a[128:131], v[92:95], v[140:143], a[128:131]
  v_mfma_f32_16x16x32_bf16 a[132:135], v[92:95], v[144:147], a[132:135]
  ds_read_b64_tr_b16 v[128:129], v27 offset:32768
  s_add_u32 m0, s53, 69632
  v_mfma_f32_16x16x32_bf16 a[136:139], v[92:95], v[148:151], a[136:139]
  buffer_load_dwordx4 v14, s[12:15], s21 offen  lds
  v_mfma_f32_16x16x32_bf16 a[140:143], v[92:95], v[152:155], a[140:143]
  ds_read_b64_tr_b16 v[130:131], v27 offset:34816
  v_mfma_f32_16x16x32_bf16 a[144:147], v[92:95], v[156:159], a[144:147]
  v_mfma_f32_16x16x32_bf16 a[148:151], v[92:95], v[160:163], a[148:151]
  ds_read_b128 v[68:71], v18 offset:12288
  s_add_u32 m0, s52, 70656
  v_mfma_f32_16x16x32_bf16 a[152:155], v[92:95], v[164:167], a[152:155]
  buffer_load_dwordx4 v7, s[8:11], s20 offen  lds
  v_mfma_f32_16x16x32_bf16 a[156:159], v[92:95], v[168:171], a[156:159]
  ds_read_b64_tr_b16 v[132:133], v28 offset:32768
  v_mfma_f32_16x16x32_bf16 a[160:163], v[96:99], v[140:143], a[160:163]
  s_add_u32 m0, s53, 70656
  v_mfma_f32_16x16x32_bf16 a[164:167], v[96:99], v[144:147], a[164:167]
  buffer_load_dwordx4 v15, s[12:15], s21 offen  lds
  ds_read_b64_tr_b16 v[134:135], v28 offset:34816
  v_mfma_f32_16x16x32_bf16 a[168:171], v[96:99], v[148:151], a[168:171]
  v_mfma_f32_16x16x32_bf16 a[172:175], v[96:99], v[152:155], a[172:175]
  ds_read_b128 v[72:75], v18 offset:14336
  v_mfma_f32_16x16x32_bf16 a[176:179], v[96:99], v[156:159], a[176:179]
  s_add_u32 m0, s52, 71680
  v_mfma_f32_16x16x32_bf16 a[180:183], v[96:99], v[160:163], a[180:183]
  buffer_load_dwordx4 v8, s[8:11], s20 offen  lds
  ds_read_b64_tr_b16 v[136:137], v29 offset:32768
  v_mfma_f32_16x16x32_bf16 a[184:187], v[96:99], v[164:167], a[184:187]
  v_mfma_f32_16x16x32_bf16 a[188:191], v[96:99], v[168:171], a[188:191]
  ds_read_b64_tr_b16 v[138:139], v29 offset:34816
  v_mfma_f32_16x16x32_bf16 a[192:195], v[100:103], v[140:143], a[192:195]
  s_add_u32 m0, s53, 71680
  v_mfma_f32_16x16x32_bf16 a[196:199], v[100:103], v[144:147], a[196:199]
  buffer_load_dwordx4 v16, s[12:15], s21 offen  lds
  v_mfma_f32_16x16x32_bf16 a[200:203], v[100:103], v[148:151], a[200:203]
  v_mfma_f32_16x16x32_bf16 a[204:207], v[100:103], v[152:155], a[204:207]
  s_add_u32 m0, s52, 72704
  v_mfma_f32_16x16x32_bf16 a[208:211], v[100:103], v[156:159], a[208:211]
  buffer_load_dwordx4 v9, s[8:11], s20 offen  lds
  v_mfma_f32_16x16x32_bf16 a[212:215], v[100:103], v[160:163], a[212:215]
  v_mfma_f32_16x16x32_bf16 a[216:219], v[100:103], v[164:167], a[216:219]
  v_mfma_f32_16x16x32_bf16 a[220:223], v[100:103], v[168:171], a[220:223]
  s_add_u32 m0, s53, 72704
  v_mfma_f32_16x16x32_bf16 a[224:227], v[104:107], v[140:143], a[224:227]
  buffer_load_dwordx4 v17, s[12:15], s21 offen  lds
  v_mfma_f32_16x16x32_bf16 a[228:231], v[104:107], v[144:147], a[228:231]
  v_mfma_f32_16x16x32_bf16 a[232:235], v[104:107], v[148:151], a[232:235]
  v_mfma_f32_16x16x32_bf16 a[236:239], v[104:107], v[152:155], a[236:239]
  s_add_u32 s20, s20, 128
  v_mfma_f32_16x16x32_bf16 a[240:243], v[104:107], v[156:159], a[240:243]
  s_add_u32 s21, s21, s51
  v_mfma_f32_16x16x32_bf16 a[244:247], v[104:107], v[160:163], a[244:247]
  v_mfma_f32_16x16x32_bf16 a[248:251], v[104:107], v[164:167], a[248:251]
  v_mfma_f32_16x16x32_bf16 a[252:255], v[104:107], v[168:171], a[252:255]
L_g2_loop:
  s_sub_u32 s25, s25, 1
  s_cmp_eq_u32 s25, 0
  s_cbranch_scc1 L_g2_fin
  s_waitcnt lgkmcnt(0)
  v_mfma_f32_16x16x32_bf16 a[0:3], v[44:47], v[108:111], a[0:3]
  ds_read_b128 v[76:79], v19 offset:0
  v_mfma_f32_16x16x32_bf16 a[4:7], v[44:47], v[112:115], a[4:7]
  v_mfma_f32_16x16x32_bf16 a[8:11], v[44:47], v[116:119], a[8:11]
  ds_read_b64_tr_b16 v[140:141], v22 offset:49152
  v_mfma_f32_16x16x32_bf16 a[12:15], v[44:47], v[120:123], a[12:15]
  v_mfma_f32_16x16x32_bf16 a[16:19], v[44:47], v[124:127], a[16:19]
  ds_read_b64_tr_b16 v[142:143], v22 offset:51200
  v_mfma_f32_16x16x32_bf16 a[20:23], v[44:47], v[128:131], a[20:23]
  v_mfma_f32_16x16x32_bf16 a[24:27], v[44:47], v[132:135], a[24:27]
  ds_read_b128 v[80:83], v19 offset:2048
  v_mfma_f32_16x16x32_bf16 a[28:31], v[44:47], v[136:139], a[28:31]
  v_mfma_f32_16x16x32_bf16 a[32:35], v[48:51], v[108:111], a[32:35]
  ds_read_b64_tr_b16 v[144:145], v23 offset:49152
  v_mfma_f32_16x16x32_bf16 a[36:39], v[48:51], v[112:115], a[36:39]
  v_mfma_f32_16x16x32_bf16 a[40:43], v[48:51], v[116:119], a[40:43]
  ds_read_b64_tr_b16 v[146:147], v23 offset:51200
  v_mfma_f32_16x16x32_bf16 a[44:47], v[48:51], v[120:123], a[44:47]
  v_mfma_f32_16x16x32_bf16 a[48:51], v[48:51], v[124:127], a[48:51]
  ds_read_b128 v[84:87], v19 offset:4096
  v_mfma_f32_16x16x32_bf16 a[52:55], v[48:51], v[128:131], a[52:55]
  v_mfma_f32_16x16x32_bf16 a[56:59], v[48:51], v[132:135], a[56:59]
  ds_read_b64_tr_b16 v[148:149], v24 offset:49152
  v_mfma_f32_16x16x32_bf16 a[60:63], v[48:51], v[136:139], a[60:63]
  v_mfma_f32_16x16x32_bf16 a[64:67], v[52:55], v[108:111], a[64:67]
  ds_read_b64_tr_b16 v[150:151], v24 offset:51200
  v_mfma_f32_16x16x32_bf16 a[68:71], v[52:55], v[112:115], a[68:71]
  v_mfma_f32_16x16x32_bf16 a[72:75], v[52:55], v[116:119], a[72:75]
  ds_read_b128 v[88:91], v19 offset:6144
  v_mfma_f32_16x16x32_bf16 a[76:79], v[52:55], v[120:123], a[76:79]
  v_mfma_f32_16x16x32_bf16 a[80:83], v[52:55], v[124:127], a[80:83]
  ds_read_b64_tr_b16 v[152:153], v25 offset:49152
  v_mfma_f32_16x16x32_bf16 a[84:87], v[52:55], v[128:131], a[84:87]
  v_mfma_f32_16x16x32_bf16 a[88:91], v[52:55], v[132:135], a[88:91]
  ds_read_b64_tr_b16 v[154:155], v25 offset:51200
  v_mfma_f32_16x16x32_bf16 a[92:95], v[52:55], v[136:139], a[92:95]
  v_mfma_f32_16x16x32_bf16 a[96:99], v[56:59], v[108:111], a[96:99]
  ds_read_b128 v[92:95], v19 offset:8192
  v_mfma_f32_16x16x32_bf16 a[100:103], v[56:59], v[112:115], a[100:103]
  v_mfma_f32_16x16x32_bf16 a[104:107], v[56:59], v[116:119], a[104:107]
  ds_read_b64_tr_b16 v[156:157], v26 offset:49152
  v_mfma_f32_16x16x32_bf16 a[108:111], v[56:59], v[120:123], a[108:111]
  v_mfma_f32_16x16x32_bf16 a[112:115], v[56:59], v[124:127], a[112:115]
  ds_read_b64_tr_b16 v[158:159], v26 offset:51200
  v_mfma_f32_16x16x32_bf16 a[116:119], v[56:59], v[128:131], a[116:119]
  v_mfma_f32_16x16x32_bf16 a[120:123], v[56:59], v[132:135], a[120:123]
  ds_read_b128 v[96:99], v19 offset:10240
  v_mfma_f32_16x16x32_bf16 a[124:127], v[56:59], v[136:139], a[124:127]
  v_mfma_f32_16x16x32_bf16 a[128:131], v[60:63], v[108:111], a[128:131]
  ds_read_b64_tr_b16 v[160:161], v27 offset:49152
  v_mfma_f32_16x16x32_bf16 a[132:135], v[60:63], v[112:115], a[132:135]
  v_mfma_f32_16x16x32_bf16 a[136:139], v[60:63], v[116:119], a[136:139]
  ds_read_b64_tr_b16 v[162:163], v27 offset:51200
  v_mfma_f32_16x16x32_bf16 a[140:143], v[60:63], v[120:123], a[140:143]
  v_mfma_f32_16x16x32_bf16 a[144:147], v[60:63], v[124:127], a[144:147]
  ds_read_b128 v[100:103], v19 offset:12288
  v_mfma_f32_16x16x32_bf16 a[148:151], v[60:63], v[128:131], a[148:151]
  v_mfma_f32_16x16x32_bf16 a[152:155], v[60:63], v[132:135], a[152:155]
  ds_read_b64_tr_b16 v[164:165], v28 offset:49152
  v_mfma_f32_16x16x32_bf16 a[156:159], v[60:63], v[136:139], a[156:159]
  v_mfma_f32_16x16x32_bf16 a[160:163], v[64:67], v[108:111], a[160:163]
  ds_read_b64_tr_b16 v[166:167], v28 offset:51200
  v_mfma_f32_16x16x32_bf16 a[164:167], v[64:67], v[112:115], a[164:167]
  v_mfma_f32_16x16x32_bf16 a[168:171], v[64:67], v[116:119], a[168:171]
  ds_read_b128 v[104:107], v19 offset:14336
  v_mfma_f32_16x16x32_bf16 a[172:175], v[64:67], v[120:123], a[172:175]
  v_mfma_f32_16x16x32_bf16 a[176:179], v[64:67], v[124:127], a[176:179]
  ds_read_b64_tr_b16 v[168:169], v29 offset:49152
  v_mfma_f32_16x16x32_bf16 a[180:183], v[64:67], v[128:131], a[180:183]
  v_mfma_f32_16x16x32_bf16 a[184:187], v[64:67], v[132:135], a[184:187]
  ds_read_b64_tr_b16 v[170:171], v29 offset:51200
  v_mfma_f32_16x16x32_bf16 a[188:191], v[64:67], v[136:139], a[188:191]
  v_mfma_f32_16x16x32_bf16 a[192:195], v[68:71], v[108:111], a[192:195]
  v_mfma_f32_16x16x32_bf16 a[196:199], v[68:71], v[112:115], a[196:199]
  v_mfma_f32_16x16x32_bf16 a[200:203], v[68:71], v[116:119], a[200:203]
  v_mfma_f32_16x16x32_bf16 a[204:207], v[68:71], v[120:123], a[204:207]
  v_mfma_f32_16x16x32_bf16 a[208:211], v[68:71], v[124:127], a[208:211]
  v_mfma_f32_16x16x32_bf16 a[212:215], v[68:71], v[128:131], a[212:215]
  v_mfma_f32_16x16x32_bf16 a[216:219], v[68:71], v[132:135], a[216:219]
  v_mfma_f32_16x16x32_bf16 a[220:223], v[68:71], v[136:139], a[220:223]
  v_mfma_f32_16x16x32_bf16 a[224:227], v[72:75], v[108:111], a[224:227]
  v_mfma_f32_16x16x32_bf16 a[228:231], v[72:75], v[112:115], a[228:231]
  v_mfma_f32_16x16x32_bf16 a[232:235], v[72:75], v[116:119], a[232:235]
  v_mfma_f32_16x16x32_bf16 a[236:239], v[72:75], v[120:123], a[236:239]
  v_mfma_f32_16x16x32_bf16 a[240:243], v[72:75], v[124:127], a[240:243]
  v_mfma_f32_16x16x32_bf16 a[244:247], v[72:75], v[128:131], a[244:247]
  v_mfma_f32_16x16x32_bf16 a[248:251], v[72:75], v[132:135], a[248:251]
  v_mfma_f32_16x16x32_bf16 a[252:255], v[72:75], v[136:139], a[252:255]
  s_waitcnt lgkmcnt(0)
  v_mfma_f32_16x16x32_bf16 a[0:3], v[76:79], v[140:143], a[0:3]
  s_waitcnt vmcnt(0)
  s_barrier
  s_add_u32 m0, s52, 0
  v_mfma_f32_16x16x32_bf16 a[4:7], v[76:79], v[144:147], a[4:7]
  buffer_load_dwordx4 v2, s[8:11], s20 offen  lds
  ds_read_b128 v[44:47], v20 offset:0
  v_mfma_f32_16x16x32_bf16 a[8:11], v[76:79], v[148:151], a[8:11]
  v_mfma_f32_16x16x32_bf16 a[12:15], v[76:79], v[152:155], a[12:15]
  ds_read_b64_tr_b16 v[108:109], v30 offset:32768
  s_add_u32 m0, s53, 0
  v_mfma_f32_16x16x32_bf16 a[16:19], v[76:79], v[156:159], a[16:19]
  buffer_load_dwordx4 v10, s[12:15], s21 offen  lds
  v_mfma_f32_16x16x32_bf16 a[20:23], v[76:79], v[160:163], a[20:23]
  ds_read_b64_tr_b16 v[110:111], v30 offset:34816
  v_mfma_f32_16x16x32_bf16 a[24:27], v[76:79], v[164:167], a[24:27]
  v_mfma_f32_16x16x32_bf16 a[28:31], v[76:79], v[168:171], a[28:31]
  ds_read_b128 v[48:51], v20 offset:2048
  s_add_u32 m0, s52, 1024
  v_mfma_f32_16x16x32_bf16 a[32:35], v[80:83], v[140:143], a[32:35]
  buffer_load_dwordx4 v3, s[8:11], s20 offen  lds
  v_mfma_f32_16x16x32_bf16 a[36:39], v[80:83], v[144:147], a[36:39]
  ds_read_b64_tr_b16 v[112:113], v31 offset:32768
  v_mfma_f32_16x16x32_bf16 a[40:43], v[80:83], v[148:151], a[40:43]
  v_mfma_f32_16x16x32_bf16 a[44:47], v[80:83], v[152:155], a[44:47]
  ds_read_b64_tr_b16 v[114:115], v31 offset:34816
  s_add_u32 m0, s53, 1024
  v_mfma_f32_16x16x32_bf16 a[48:51], v[80:83], v[156:159], a[48:51]
  buffer_load_dwordx4 v11, s[12:15], s21 offen  lds
  v_mfma_f32_16x16x32_bf16 a[52:55], v[80:83], v[160:163], a[52:55]
  ds_read_b128 v[52:55], v20 offset:4096
  v_mfma_f32_16x16x32_bf16 a[56:59], v[80:83], v[164:167], a[56:59]
  s_add_u32 m0, s52, 2048
  v_mfma_f32_16x16x32_bf16 a[60:63], v[80:83], v[168:171], a[60:63]
  buffer_load_dwordx4 v4, s[8:11], s20 offen  lds
  ds_read_b64_tr_b16 v[116:117], v32 offset:32768
  v_mfma_f32_16x16x32_bf16 a[64:67], v[84:87], v[140:143], a[64:67]
  v_mfma_f32_16x16x32_bf16 a[68:71], v[84:87], v[144:147], a[68:71]
  ds_read_b64_tr_b16 v[118:119], v32 offset:34816
  v_mfma_f32_16x16x32_bf16 a[72:75], v[84:87], v[148:151], a[72:75]
  s_add_u32 m0, s53, 2048
  v_mfma_f32_16x16x32_bf16 a[76:79], v[84:87], v[152:155], a[76:79]
  buffer_load_dwordx4 v12, s[12:15], s21 offen  lds
  ds_read_b128 v[56:59], v20 offset:6144
  v_mfma_f32_16x16x32_bf16 a[80:83], v[84:87], v[156:159], a[80:83]
  v_mfma_f32_16x16x32_bf16 a[84:87], v[84:87], v[160:163], a[84:87]
  ds_read_b64_tr_b16 v[120:121], v33 offset:32768
  v_mfma_f32_16x16x32_bf16 a[88:91], v[84:87], v[164:167], a[88:91]
  s_add_u32 m0, s52, 3072
  v_mfma_f32_16x16x32_bf16 a[92:95], v[84:87], v[168:171], a[92:95]
  buffer_load_dwordx4 v5, s[8:11], s20 offen  lds
  ds_read_b64_tr_b16 v[122:123], v33 offset:34816
  v_mfma_f32_16x16x32_bf16 a[96:99], v[88:91], v[140:143], a[96:99]
  v_mfma_f32_16x16x32_bf16 a[100:103], v[88:91], v[144:147], a[100:103]
  ds_read_b128 v[60:63], v20 offset:8192
  s_add_u32 m0, s53, 3072
  v_mfma_f32_16x16x32_bf16 a[104:107], v[88:91], v[148:151], a[104:107]
  buffer_load_dwordx4 v13, s[12:15], s21 offen  lds
  v_mfma_f32_16x16x32_bf16 a[108:111], v[88:91], v[152:155], a[108:111]
  ds_read_b64_tr_b16 v[124:125], v34 offset:32768
  v_mfma_f32_16x16x32_bf16 a[112:115], v[88:91], v[156:159], a[112:115]
  v_mfma_f32_16x16x32_bf16 a[116:119], v[88:91], v[160:163], a[116:119]
  ds_read_b64_tr_b16 v[126:127], v34 offset:34816
  s_add_u32 m0, s52, 4096
  v_mfma_f32_16x16x32_bf16 a[120:123], v[88:91], v[164:167], a[120:123]
  buffer_load_dwordx4 v6, s[8:11], s20 offen  lds
  v_mfma_f32_16x16x32_bf16 a[124:127], v[88:91], v[168:171], a[124:127]
  ds_read_b128 v[64:67], v20 offset:10240
  v_mfma_f32_16x16x32_bf16 a[128:131], v[92:95], v[140:143], a[128:131]
  v_mfma_f32_16x16x32_bf16 a[132:135], v[92:95], v[144:147], a[132:135]
  ds_read_b64_tr_b16 v[128:129], v35 offset:32768
  s_add_u32 m0, s53, 4096
  v_mfma_f32_16x16x32_bf16 a[136:139], v[92:95], v[148:151], a[136:139]
  buffer_load_dwordx4 v14, s[12:15], s21 offen  lds
  v_mfma_f32_16x16x32_bf16 a[140:143], v[92:95], v[152:155], a[140:143]
  ds_read_b64_tr_b16 v[130:131], v35 offset:34816
  v_mfma_f32_16x16x32_bf16 a[144:147], v[92:95], v[156:159], a[144:147]
  v_mfma_f32_16x16x32_bf16 a[148:151], v[92:95], v[160:163], a[148:151]
  ds_read_b128 v[68:71], v20 offset:12288
  s_add_u32 m0, s52, 5120
  v_mfma_f32_16x16x32_bf16 a[152:155], v[92:95], v[164:167], a[152:155]
  buffer_load_dwordx4 v7, s[8:11], s20 offen  lds
  v_mfma_f32_16x16x32_bf16 a[156:159], v[92:95], v[168:171], a[156:159]
  ds_read_b64_tr_b16 v[132:133], v36 offset:32768
  v_mfma_f32_16x16x32_bf16 a[160:163], v[96:99], v[140:143], a[160:163]
  s_add_u32 m0, s53, 5120
  v_mfma_f32_16x16x32_bf16 a[164:167], v[96:99], v[144:147], a[164:167]
  buffer_load_dwordx4 v15, s[12:15], s21 offen  lds
  ds_read_b64_tr_b16 v[134:135], v36 offset:34816
  v_mfma_f32_16x16x32_bf16 a[168:171], v[96:99], v[148:151], a[168:171]
  v_mfma_f32_16x16x32_bf16 a[172:175], v[96:99], v[152:155], a[172:175]
  ds_read_b128 v[72:75], v20 offset:14336
  v_mfma_f32_16x16x32_bf16 a[176:179], v[96:99], v[156:159], a[176:179]
  s_add_u32 m0, s52, 6144
  v_mfma_f32_16x16x32_bf16 a[180:183], v[96:99], v[160:163], a[180:183]
  buffer_load_dwordx4 v8, s[8:11], s20 offen  lds
  ds_read_b64_tr_b16 v[136:137], v37 offset:32768
  v_mfma_f32_16x16x32_bf16 a[184:187], v[96:99], v[164:167], a[184:187]
  v_mfma_f32_16x16x32_bf16 a[188:191], v[96:99], v[168:171], a[188:191]
  ds_read_b64_tr_b16 v[138:139], v37 offset:34816
  v_mfma_f32_16x16x32_bf16 a[192:195], v[100:103], v[140:143], a[192:195]
  s_add_u32 m0, s53, 6144
  v_mfma_f32_16x16x32_bf16 a[196:199], v[100:103], v[144:147], a[196:199]
  buffer_load_dwordx4 v16, s[12:15], s21 offen  lds
  v_mfma_f32_16x16x32_bf16 a[200:203], v[100:103], v[148:151], a[200:203]
  v_mfma_f32_16x16x32_bf16 a[204:207], v[100:103], v[152:155], a[204:207]
  s_add_u32 m0, s52, 7168
  v_mfma_f32_16x16x32_bf16 a[208:211], v[100:103], v[156:159], a[208:211]
  buffer_load_dwordx4 v9, s[8:11], s20 offen  lds
  v_mfma_f32_16x16x32_bf16 a[212:215], v[100:103], v[160:163], a[212:215]
  v_mfma_f32_16x16x32_bf16 a[216:219], v[100:103], v[164:167], a[216:219]
  v_mfma_f32_16x16x32_bf16 a[220:223], v[100:103], v[168:171], a[220:223]
  s_add_u32 m0, s53, 7168
  v_mfma_f32_16x16x32_bf16 a[224:227], v[104:107], v[140:143], a[224:227]
  buffer_load_dwordx4 v17, s[12:15], s21 offen  lds
  v_mfma_f32_16x16x32_bf16 a[228:231], v[104:107], v[144:147], a[228:231]
  v_mfma_f32_16x16x32_bf16 a[232:235], v[104:107], v[148:151], a[232:235]
  v_mfma_f32_16x16x32_bf16 a[236:239], v[104:107], v[152:155], a[236:239]
  s_add_u32 s20, s20, 128
  v_mfma_f32_16x16x32_bf16 a[240:243], v[104:107], v[156:159], a[240:243]
  s_add_u32 s21, s21, s51
  v_mfma_f32_16x16x32_bf16 a[244:247], v[104:107], v[160:163], a[244:247]
  v_mfma_f32_16x16x32_bf16 a[248:251], v[104:107], v[164:167], a[248:251]
  v_mfma_f32_16x16x32_bf16 a[252:255], v[104:107], v[168:171], a[252:255]
  s_waitcnt lgkmcnt(0)
  v_mfma_f32_16x16x32_bf16 a[0:3], v[44:47], v[108:111], a[0:3]
  ds_read_b128 v[76:79], v21 offset:0
  v_mfma_f32_16x16x32_bf16 a[4:7], v[44:47], v[112:115], a[4:7]
  v_mfma_f32_16x16x32_bf16 a[8:11], v[44:47], v[116:119], a[8:11]
  ds_read_b64_tr_b16 v[140:141], v30 offset:49152
  v_mfma_f32_16x16x32_bf16 a[12:15], v[44:47], v[120:123], a[12:15]
  v_mfma_f32_16x16x32_bf16 a[16:19], v[44:47], v[124:127], a[16:19]
  ds_read_b64_tr_b16 v[142:143], v30 offset:51200
  v_mfma_f32_16x16x32_bf16 a[20:23], v[44:47], v[128:131], a[20:23]
  v_mfma_f32_16x16x32_bf16 a[24:27], v[44:47], v[132:135], a[24:27]
  ds_read_b128 v[80:83], v21 offset:2048
  v_mfma_f32_16x16x32_bf16 a[28:31], v[44:47], v[136:139], a[28:31]
  v_mfma_f32_16x16x32_bf16 a[32:35], v[48:51], v[108:111], a[32:35]
  ds_read_b64_tr_b16 v[144:145], v31 offset:49152
  v_mfma_f32_16x16x32_bf16 a[36:39], v[48:51], v[112:115], a[36:39]
  v_mfma_f32_16x16x32_bf16 a[40:43], v[48:51], v[116:119], a[40:43]
  ds_read_b64_tr_b16 v[146:147], v31 offset:51200
  v_mfma_f32_16x16x32_bf16 a[44:47], v[48:51], v[120:123], a[44:47]
  v_mfma_f32_16x16x32_bf16 a[48:51], v[48:51], v[124:127], a[48:51]
  ds_read_b128 v[84:87], v21 offset:4096
  v_mfma_f32_16x16x32_bf16 a[52:55], v[48:51], v[128:131], a[52:55]
  v_mfma_f32_16x16x32_bf16 a[56:59], v[48:51], v[132:135], a[56:59]
  ds_read_b64_tr_b16 v[148:149], v32 offset:49152
  v_mfma_f32_16x16x32_bf16 a[60:63], v[48:51], v[136:139], a[60:63]
  v_mfma_f32_16x16x32_bf16 a[64:67], v[52:55], v[108:111], a[64:67]
  ds_read_b64_tr_b16 v[150:151], v32 offset:51200
  v_mfma_f32_16x16x32_bf16 a[68:71], v[52:55], v[112:115], a[68:71]
  v_mfma_f32_16x16x32_bf16 a[72:75], v[52:55], v[116:119], a[72:75]
  ds_read_b128 v[88:91], v21 offset:6144
  v_mfma_f32_16x16x32_bf16 a[76:79], v[52:55], v[120:123], a[76:79]
  v_mfma_f32_16x16x32_bf16 a[80:83], v[52:55], v[124:127], a[80:83]
  ds_read_b64_tr_b16 v[152:153], v33 offset:49152
  v_mfma_f32_16x16x32_bf16 a[84:87], v[52:55], v[128:131], a[84:87]
  v_mfma_f32_16x16x32_bf16 a[88:91], v[52:55], v[132:135], a[88:91]
  ds_read_b64_tr_b16 v[154:155], v33 offset:51200
  v_mfma_f32_16x16x32_bf16 a[92:95], v[52:55], v[136:139], a[92:95]
  v_mfma_f32_16x16x32_bf16 a[96:99], v[56:59], v[108:111], a[96:99]
  ds_read_b128 v[92:95], v21 offset:8192
  v_mfma_f32_16x16x32_bf16 a[100:103], v[56:59], v[112:115], a[100:103]
  v_mfma_f32_16x16x32_bf16 a[104:107], v[56:59], v[116:119], a[104:107]
  ds_read_b64_tr_b16 v[156:157], v34 offset:49152
  v_mfma_f32_16x16x32_bf16 a[108:111], v[56:59], v[120:123], a[108:111]
  v_mfma_f32_16x16x32_bf16 a[112:115], v[56:59], v[124:127], a[112:115]
  ds_read_b64_tr_b16 v[158:159], v34 offset:51200
  v_mfma_f32_16x16x32_bf16 a[116:119], v[56:59], v[128:131], a[116:119]
  v_mfma_f32_16x16x32_bf16 a[120:123], v[56:59], v[132:135], a[120:123]
  ds_read_b128 v[96:99], v21 offset:10240
  v_mfma_f32_16x16x32_bf16 a[124:127], v[56:59], v[136:139], a[124:127]
  v_mfma_f32_16x16x32_bf16 a[128:131], v[60:63], v[108:111], a[128:131]
  ds_read_b64_tr_b16 v[160:161], v35 offset:49152
  v_mfma_f32_16x16x32_bf16 a[132:135], v[60:63], v[112:115], a[132:135]
  v_mfma_f32_16x16x32_bf16 a[136:139], v[60:63], v[116:119], a[136:139]
  ds_read_b64_tr_b16 v[162:163], v35 offset:51200
  v_mfma_f32_16x16x32_bf16 a[140:143], v[60:63], v[120:123], a[140:143]
  v_mfma_f32_16x16x32_bf16 a[144:147], v[60:63], v[124:127], a[144:147]
  ds_read_b128 v[100:103], v21 offset:12288
  v_mfma_f32_16x16x32_bf16 a[148:151], v[60:63], v[128:131], a[148:151]
  v_mfma_f32_16x16x32_bf16 a[152:155], v[60:63], v[132:135], a[152:155]
  ds_read_b64_tr_b16 v[164:165], v36 offset:49152
  v_mfma_f32_16x16x32_bf16 a[156:159], v[60:63], v[136:139], a[156:159]
  v_mfma_f32_16x16x32_bf16 a[160:163], v[64:67], v[108:111], a[160:163]
  ds_read_b64_tr_b16 v[166:167], v36 offset:51200
  v_mfma_f32_16x16x32_bf16 a[164:167], v[64:67], v[112:115], a[164:167]
  v_mfma_f32_16x16x32_bf16 a[168:171], v[64:67], v[116:119], a[168:171]
  ds_read_b128 v[104:107], v21 offset:14336
  v_mfma_f32_16x16x32_bf16 a[172:175], v[64:67], v[120:123], a[172:175]
  v_mfma_f32_16x16x32_bf16 a[176:179], v[64:67], v[124:127], a[176:179]
  ds_read_b64_tr_b16 v[168:169], v37 offset:49152
  v_mfma_f32_16x16x32_bf16 a[180:183], v[64:67], v[128:131], a[180:183]
  v_mfma_f32_16x16x32_bf16 a[184:187], v[64:67], v[132:135], a[184:187]
  ds_read_b64_tr_b16 v[170:171], v37 offset:51200
  v_mfma_f32_16x16x32_bf16 a[188:191], v[64:67], v[136:139], a[188:191]
  v_mfma_f32_16x16x32_bf16 a[192:195], v[68:71], v[108:111], a[192:195]
  v_mfma_f32_16x16x32_bf16 a[196:199], v[68:71], v[112:115], a[196:199]
  v_mfma_f32_16x16x32_bf16 a[200:203], v[68:71], v[116:119], a[200:203]
  v_mfma_f32_16x16x32_bf16 a[204:207], v[68:71], v[120:123], a[204:207]
  v_mfma_f32_16x16x32_bf16 a[208:211], v[68:71], v[124:127], a[208:211]
  v_mfma_f32_16x16x32_bf16 a[212:215], v[68:71], v[128:131], a[212:215]
  v_mfma_f32_16x16x32_bf16 a[216:219], v[68:71], v[132:135], a[216:219]
  v_mfma_f32_16x16x32_bf16 a[220:223], v[68:71], v[136:139], a[220:223]
  v_mfma_f32_16x16x32_bf16 a[224:227], v[72:75], v[108:111], a[224:227]
  v_mfma_f32_16x16x32_bf16 a[228:231], v[72:75], v[112:115], a[228:231]
  v_mfma_f32_16x16x32_bf16 a[232:235], v[72:75], v[116:119], a[232:235]
  v_mfma_f32_16x16x32_bf16 a[236:239], v[72:75], v[120:123], a[236:239]
  v_mfma_f32_16x16x32_bf16 a[240:243], v[72:75], v[124:127], a[240:243]
  v_mfma_f32_16x16x32_bf16 a[244:247], v[72:75], v[128:131], a[244:247]
  v_mfma_f32_16x16x32_bf16 a[248:251], v[72:75], v[132:135], a[248:251]
  v_mfma_f32_16x16x32_bf16 a[252:255], v[72:75], v[136:139], a[252:255]
  s_waitcnt lgkmcnt(0)
  v_mfma_f32_16x16x32_bf16 a[0:3], v[76:79], v[140:143], a[0:3]
  s_waitcnt vmcnt(0)
  s_barrier
  s_add_u32 m0, s52, 65536
  v_mfma_f32_16x16x32_bf16 a[4:7], v[76:79], v[144:147], a[4:7]
  buffer_load_dwordx4 v2, s[8:11], s20 offen  lds
  ds_read_b128 v[44:47], v18 offset:0
  v_mfma_f32_16x16x32_bf16 a[8:11], v[76:79], v[148:151], a[8:11]
  v_mfma_f32_16x16x32_bf16 a[12:15], v[76:79], v[152:155], a[12:15]
  ds_read_b64_tr_b16 v[108:109], v22 offset:32768
  s_add_u32 m0, s53, 65536
  v_mfma_f32_16x16x32_bf16 a[16:19], v[76:79], v[156:159], a[16:19]
  buffer_load_dwordx4 v10, s[12:15], s21 offen  lds
  v_mfma_f32_16x16x32_bf16 a[20:23], v[76:79], v[160:163], a[20:23]
  ds_read_b64_tr_b16 v[110:111], v22 offset:34816
  v_mfma_f32_16x16x32_bf16 a[24:27], v[76:79], v[164:167], a[24:27]
  v_mfma_f32_16x16x32_bf16 a[28:31], v[76:79], v[168:171], a[28:31]
  ds_read_b128 v[48:51], v18 offset:2048
  s_add_u32 m0, s52, 66560
  v_mfma_f32_16x16x32_bf16 a[32:35], v[80:83], v[140:143], a[32:35]
  buffer_load_dwordx4 v3, s[8:11], s20 offen  lds
  v_mfma_f32_16x16x32_bf16 a[36:39], v[80:83], v[144:147], a[36:39]
  ds_read_b64_tr_b16 v[112:113], v23 offset:32768
  v_mfma_f32_16x16x32_bf16 a[40:43], v[80:83], v[148:151], a[40:43]
  v_mfma_f32_16x16x32_bf16 a[44:47], v[80:83], v[152:155], a[44:47]
  ds_read_b64_tr_b16 v[114:115], v23 offset:34816
  s_add_u32 m0, s53, 66560
  v_mfma_f32_16x16x32_bf16 a[48:51], v[80:83], v[156:159], a[48:51]
  buffer_load_dwordx4 v11, s[12:15], s21 offen  lds
  v_mfma_f32_16x16x32_bf16 a[52:55], v[80:83], v[160:163], a[52:55]
  ds_read_b128 v[52:55], v18 offset:4096
  v_mfma_f32_16x16x32_bf16 a[56:59], v[80:83], v[164:167], a[56:59]
  s_add_u32 m0, s52, 67584
  v_mfma_f32_16x16x32_bf16 a[60:63], v[80:83], v[168:171], a[60:63]
  buffer_load_dwordx4 v4, s[8:11], s20 offen  lds
  ds_read_b64_tr_b16 v[116:117], v24 offset:32768
  v_mfma_f32_16x16x32_bf16 a[64:67], v[84:87], v[140:143], a[64:67]
  v_mfma_f32_16x16x32_bf16 a[68:71], v[84:87], v[144:147], a[68:71]
  ds_read_b64_tr_b16 v[118:119], v24 offset:34816
  v_mfma_f32_16x16x32_bf16 a[72:75], v[84:87], v[148:151], a[72:75]
  s_add_u32 m0, s53, 67584
  v_mfma_f32_16x16x32_bf16 a[76:79], v[84:87], v[152:155], a[76:79]
  buffer_load_dwordx4 v12, s[12:15], s21 offen  lds
  ds_read_b128 v[56:59], v18 offset:6144
  v_mfma_f32_16x16x32_bf16 a[80:83], v[84:87], v[156:159], a[80:83]
  v_mfma_f32_16x16x32_bf16 a[84:87], v[84:87], v[160:163], a[84:87]
  ds_read_b64_tr_b16 v[120:121], v25 offset:32768
  v_mfma_f32_16x16x32_bf16 a[88:91], v[84:87], v[164:167], a[88:91]
  s_add_u32 m0, s52, 68608
  v_mfma_f32_16x16x32_bf16 a[92:95], v[84:87], v[168:171], a[92:95]
  buffer_load_dwordx4 v5, s[8:11], s20 offen  lds
  ds_read_b64_tr_b16 v[122:123], v25 offset:34816
  v_mfma_f32_16x16x32_bf16 a[96:99], v[88:91], v[140:143], a[96:99]
  v_mfma_f32_16x16x32_bf16 a[100:103], v[88:91], v[144:147], a[100:103]
  ds_read_b128 v[60:63], v18 offset:8192
  s_add_u32 m0, s53, 68608
  v_mfma_f32_16x16x32_bf16 a[104:107], v[88:91], v[148:151], a[104:107]
  buffer_load_dwordx4 v13, s[12:15], s21 offen  lds
  v_mfma_f32_16x16x32_bf16 a[108:111], v[88:91], v[152:155], a[108:111]
  ds_read_b64_tr_b16 v[124:125], v26 offset:32768
  v_mfma_f32_16x16x32_bf16 a[112:115], v[88:91], v[156:159], a[112:115]
  v_mfma_f32_16x16x32_bf16 a[116:119], v[88:91], v[160:163], a[116:119]
  ds_read_b64_tr_b16 v[126:127], v26 offset:34816
  s_add_u32 m0, s52, 69632
  v_mfma_f32_16x16x32_bf16 a[120:123], v[88:91], v[164:167], a[120:123]
  buffer_load_dwordx4 v6, s[8:11], s20 offen  lds
  v_mfma_f32_16x16x32_bf16 a[124:127], v[88:91], v[168:171], a[124:127]
  ds_read_b128 v[64:67], v18 offset:10240
  v_mfma_f32_16x16x32_bf16 a[128:131], v[92:95], v[140:143], a[128:131]
  v_mfma_f32_16x16x32_bf16 a[132:135], v[92:95], v[144:147], a[132:135]
  ds_read_b64_tr_b16 v[128:129], v27 offset:32768
  s_add_u32 m0, s53, 69632
  v_mfma_f32_16x16x32_bf16 a[136:139], v[92:95], v[148:151], a[136:139]
  buffer_load_dwordx4 v14, s[12:15], s21 offen  lds
  v_mfma_f32_16x16x32_bf16 a[140:143], v[92:95], v[152:155], a[140:143]
  ds_read_b64_tr_b16 v[130:131], v27 offset:34816
  v_mfma_f32_16x16x32_bf16 a[144:147], v[92:95], v[156:159], a[144:147]
  v_mfma_f32_16x16x32_bf16 a[148:151], v[92:95], v[160:163], a[148:151]
  ds_read_b128 v[68:71], v18 offset:12288
  s_add_u32 m0, s52, 70656
  v_mfma_f32_16x16x32_bf16 a[152:155], v[92:95], v[164:167], a[152:155]
  buffer_load_dwordx4 v7, s[8:11], s20 offen  lds
  v_mfma_f32_16x16x32_bf16 a[156:159], v[92:95], v[168:171], a[156:159]
  ds_read_b64_tr_b16 v[132:133], v28 offset:32768
  v_mfma_f32_16x16x32_bf16 a[160:163], v[96:99], v[140:143], a[160:163]
  s_add_u32 m0, s53, 70656
  v_mfma_f32_16x16x32_bf16 a[164:167], v[96:99], v[144:147], a[164:167]
  buffer_load_dwordx4 v15, s[12:15], s21 offen  lds
  ds_read_b64_tr_b16 v[134:135], v28 offset:34816
  v_mfma_f32_16x16x32_bf16 a[168:171], v[96:99], v[148:151], a[168:171]
  v_mfma_f32_16x16x32_bf16 a[172:175], v[96:99], v[152:155], a[172:175]
  ds_read_b128 v[72:75], v18 offset:14336
  v_mfma_f32_16x16x32_bf16 a[176:179], v[96:99], v[156:159], a[176:179]
  s_add_u32 m0, s52, 71680
  v_mfma_f32_16x16x32_bf16 a[180:183], v[96:99], v[160:163], a[180:183]
  buffer_load_dwordx4 v8, s[8:11], s20 offen  lds
  ds_read_b64_tr_b16 v[136:137], v29 offset:32768
  v_mfma_f32_16x16x32_bf16 a[184:187], v[96:99], v[164:167], a[184:187]
  v_mfma_f32_16x16x32_bf16 a[188:191], v[96:99], v[168:171], a[188:191]
  ds_read_b64_tr_b16 v[138:139], v29 offset:34816
  v_mfma_f32_16x16x32_bf16 a[192:195], v[100:103], v[140:143], a[192:195]
  s_add_u32 m0, s53, 71680
  v_mfma_f32_16x16x32_bf16 a[196:199], v[100:103], v[144:147], a[196:199]
  buffer_load_dwordx4 v16, s[12:15], s21 offen  lds
  v_mfma_f32_16x16x32_bf16 a[200:203], v[100:103], v[148:151], a[200:203]
  v_mfma_f32_16x16x32_bf16 a[204:207], v[100:103], v[152:155], a[204:207]
  s_add_u32 m0, s52, 72704
  v_mfma_f32_16x16x32_bf16 a[208:211], v[100:103], v[156:159], a[208:211]
  buffer_load_dwordx4 v9, s[8:11], s20 offen  lds
  v_mfma_f32_16x16x32_bf16 a[212:215], v[100:103], v[160:163], a[212:215]
  v_mfma_f32_16x16x32_bf16 a[216:219], v[100:103], v[164:167], a[216:219]
  v_mfma_f32_16x16x32_bf16 a[220:223], v[100:103], v[168:171], a[220:223]
  s_add_u32 m0, s53, 72704
  v_mfma_f32_16x16x32_bf16 a[224:227], v[104:107], v[140:143], a[224:227]
  buffer_load_dwordx4 v17, s[12:15], s21 offen  lds
  v_mfma_f32_16x16x32_bf16 a[228:231], v[104:107], v[144:147], a[228:231]
  v_mfma_f32_16x16x32_bf16 a[232:235], v[104:107], v[148:151], a[232:235]
  v_mfma_f32_16x16x32_bf16 a[236:239], v[104:107], v[152:155], a[236:239]
  s_add_u32 s20, s20, 128
  v_mfma_f32_16x16x32_bf16 a[240:243], v[104:107], v[156:159], a[240:243]
  s_add_u32 s21, s21, s51
  v_mfma_f32_16x16x32_bf16 a[244:247], v[104:107], v[160:163], a[244:247]
  v_mfma_f32_16x16x32_bf16 a[248:251], v[104:107], v[164:167], a[248:251]
  v_mfma_f32_16x16x32_bf16 a[252:255], v[104:107], v[168:171], a[252:255]
  s_branch L_g2_loop
L_g2_fin:
  s_cmp_lg_u32 s32, 0
  s_cbranch_scc1 L_rq_11
  s_cmp_eq_u32 s39, 0
  s_cbranch_scc1 L_rq_11
  s_lshl_b32 s99, s33, 7
  s_add_u32 s99, s99, 0x3d00200
  v_mov_b32 v244, 1
  v_mov_b32 v245, 0
  s_mov_b64 exec, 1
  buffer_atomic_add v244, v245, s[4:7], s99 offen sc0 sc1
  s_mov_b64 exec, -1
L_rq_11:
  s_waitcnt lgkmcnt(0)
  v_mfma_f32_16x16x32_bf16 a[0:3], v[44:47], v[108:111], a[0:3]
  ds_read_b128 v[76:79], v19 offset:0
  v_mfma_f32_16x16x32_bf16 a[4:7], v[44:47], v[112:115], a[4:7]
  v_mfma_f32_16x16x32_bf16 a[8:11], v[44:47], v[116:119], a[8:11]
  ds_read_b64_tr_b16 v[140:141], v22 offset:49152
  v_mfma_f32_16x16x32_bf16 a[12:15], v[44:47], v[120:123], a[12:15]
  v_mfma_f32_16x16x32_bf16 a[16:19], v[44:47], v[124:127], a[16:19]
  ds_read_b64_tr_b16 v[142:143], v22 offset:51200
  v_mfma_f32_16x16x32_bf16 a[20:23], v[44:47], v[128:131], a[20:23]
  v_mfma_f32_16x16x32_bf16 a[24:27], v[44:47], v[132:135], a[24:27]
  ds_read_b128 v[80:83], v19 offset:2048
  v_mfma_f32_16x16x32_bf16 a[28:31], v[44:47], v[136:139], a[28:31]
  v_mfma_f32_16x16x32_bf16 a[32:35], v[48:51], v[108:111], a[32:35]
  ds_read_b64_tr_b16 v[144:145], v23 offset:49152
  v_mfma_f32_16x16x32_bf16 a[36:39], v[48:51], v[112:115], a[36:39]
  v_mfma_f32_16x16x32_bf16 a[40:43], v[48:51], v[116:119], a[40:43]
  ds_read_b64_tr_b16 v[146:147], v23 offset:51200
  v_mfma_f32_16x16x32_bf16 a[44:47], v[48:51], v[120:123], a[44:47]
  v_mfma_f32_16x16x32_bf16 a[48:51], v[48:51], v[124:127], a[48:51]
  ds_read_b128 v[84:87], v19 offset:4096
  v_mfma_f32_16x16x32_bf16 a[52:55], v[48:51], v[128:131], a[52:55]
  v_mfma_f32_16x16x32_bf16 a[56:59], v[48:51], v[132:135], a[56:59]
  ds_read_b64_tr_b16 v[148:149], v24 offset:49152
  v_mfma_f32_16x16x32_bf16 a[60:63], v[48:51], v[136:139], a[60:63]
  v_mfma_f32_16x16x32_bf16 a[64:67], v[52:55], v[108:111], a[64:67]
  ds_read_b64_tr_b16 v[150:151], v24 offset:51200
  v_mfma_f32_16x16x32_bf16 a[68:71], v[52:55], v[112:115], a[68:71]
  v_mfma_f32_16x16x32_bf16 a[72:75], v[52:55], v[116:119], a[72:75]
  ds_read_b128 v[88:91], v19 offset:6144
  v_mfma_f32_16x16x32_bf16 a[76:79], v[52:55], v[120:123], a[76:79]
  v_mfma_f32_16x16x32_bf16 a[80:83], v[52:55], v[124:127], a[80:83]
  ds_read_b64_tr_b16 v[152:153], v25 offset:49152
  v_mfma_f32_16x16x32_bf16 a[84:87], v[52:55], v[128:131], a[84:87]
  v_mfma_f32_16x16x32_bf16 a[88:91], v[52:55], v[132:135], a[88:91]
  ds_read_b64_tr_b16 v[154:155], v25 offset:51200
  v_mfma_f32_16x16x32_bf16 a[92:95], v[52:55], v[136:139], a[92:95]
  v_mfma_f32_16x16x32_bf16 a[96:99], v[56:59], v[108:111], a[96:99]
  ds_read_b128 v[92:95], v19 offset:8192
  v_mfma_f32_16x16x32_bf16 a[100:103], v[56:59], v[112:115], a[100:103]
  v_mfma_f32_16x16x32_bf16 a[104:107], v[56:59], v[116:119], a[104:107]
  ds_read_b64_tr_b16 v[156:157], v26 offset:49152
  v_mfma_f32_16x16x32_bf16 a[108:111], v[56:59], v[120:123], a[108:111]
  v_mfma_f32_16x16x32_bf16 a[112:115], v[56:59], v[124:127], a[112:115]
  ds_read_b64_tr_b16 v[158:159], v26 offset:51200
  v_mfma_f32_16x16x32_bf16 a[116:119], v[56:59], v[128:131], a[116:119]
  v_mfma_f32_16x16x32_bf16 a[120:123], v[56:59], v[132:135], a[120:123]
  ds_read_b128 v[96:99], v19 offset:10240
  v_mfma_f32_16x16x32_bf16 a[124:127], v[56:59], v[136:139], a[124:127]
  v_mfma_f32_16x16x32_bf16 a[128:131], v[60:63], v[108:111], a[128:131]
  ds_read_b64_tr_b16 v[160:161], v27 offset:49152
  v_mfma_f32_16x16x32_bf16 a[132:135], v[60:63], v[112:115], a[132:135]
  v_mfma_f32_16x16x32_bf16 a[136:139], v[60:63], v[116:119], a[136:139]
  ds_read_b64_tr_b16 v[162:163], v27 offset:51200
  v_mfma_f32_16x16x32_bf16 a[140:143], v[60:63], v[120:123], a[140:143]
  v_mfma_f32_16x16x32_bf16 a[144:147], v[60:63], v[124:127], a[144:147]
  ds_read_b128 v[100:103], v19 offset:12288
  v_mfma_f32_16x16x32_bf16 a[148:151], v[60:63], v[128:131], a[148:151]
  v_mfma_f32_16x16x32_bf16 a[152:155], v[60:63], v[132:135], a[152:155]
  ds_read_b64_tr_b16 v[164:165], v28 offset:49152
  v_mfma_f32_16x16x32_bf16 a[156:159], v[60:63], v[136:139], a[156:159]
  v_mfma_f32_16x16x32_bf16 a[160:163], v[64:67], v[108:111], a[160:163]
  ds_read_b64_tr_b16 v[166:167], v28 offset:51200
  v_mfma_f32_16x16x32_bf16 a[164:167], v[64:67], v[112:115], a[164:167]
  v_mfma_f32_16x16x32_bf16 a[168:171], v[64:67], v[116:119], a[168:171]
  ds_read_b128 v[104:107], v19 offset:14336
  v_mfma_f32_16x16x32_bf16 a[172:175], v[64:67], v[120:123], a[172:175]
  v_mfma_f32_16x16x32_bf16 a[176:179], v[64:67], v[124:127], a[176:179]
  ds_read_b64_tr_b16 v[168:169], v29 offset:49152
  v_mfma_f32_16x16x32_bf16 a[180:183], v[64:67], v[128:131], a[180:183]
  v_mfma_f32_16x16x32_bf16 a[184:187], v[64:67], v[132:135], a[184:187]
  ds_read_b64_tr_b16 v[170:171], v29 offset:51200
  v_mfma_f32_16x16x32_bf16 a[188:191], v[64:67], v[136:139], a[188:191]
  v_mfma_f32_16x16x32_bf16 a[192:195], v[68:71], v[108:111], a[192:195]
  v_mfma_f32_16x16x32_bf16 a[196:199], v[68:71], v[112:115], a[196:199]
  v_mfma_f32_16x16x32_bf16 a[200:203], v[68:71], v[116:119], a[200:203]
  v_mfma_f32_16x16x32_bf16 a[204:207], v[68:71], v[120:123], a[204:207]
  v_mfma_f32_16x16x32_bf16 a[208:211], v[68:71], v[124:127], a[208:211]
  v_mfma_f32_16x16x32_bf16 a[212:215], v[68:71], v[128:131], a[212:215]
  v_mfma_f32_16x16x32_bf16 a[216:219], v[68:71], v[132:135], a[216:219]
  v_mfma_f32_16x16x32_bf16 a[220:223], v[68:71], v[136:139], a[220:223]
  v_mfma_f32_16x16x32_bf16 a[224:227], v[72:75], v[108:111], a[224:227]
  v_mfma_f32_16x16x32_bf16 a[228:231], v[72:75], v[112:115], a[228:231]
  v_mfma_f32_16x16x32_bf16 a[232:235], v[72:75], v[116:119], a[232:235]
  v_mfma_f32_16x16x32_bf16 a[236:239], v[72:75], v[120:123], a[236:239]
  v_mfma_f32_16x16x32_bf16 a[240:243], v[72:75], v[124:127], a[240:243]
  v_mfma_f32_16x16x32_bf16 a[244:247], v[72:75], v[128:131], a[244:247]
  v_mfma_f32_16x16x32_bf16 a[248:251], v[72:75], v[132:135], a[248:251]
  v_mfma_f32_16x16x32_bf16 a[252:255], v[72:75], v[136:139], a[252:255]
  s_waitcnt lgkmcnt(0)
  v_mfma_f32_16x16x32_bf16 a[0:3], v[76:79], v[140:143], a[0:3]
  s_waitcnt vmcnt(0)
  s_barrier
  v_mfma_f32_16x16x32_bf16 a[4:7], v[76:79], v[144:147], a[4:7]
  ds_read_b128 v[44:47], v20 offset:0
  v_mfma_f32_16x16x32_bf16 a[8:11], v[76:79], v[148:151], a[8:11]
  v_mfma_f32_16x16x32_bf16 a[12:15], v[76:79], v[152:155], a[12:15]
  ds_read_b64_tr_b16 v[108:109], v30 offset:32768
  v_mfma_f32_16x16x32_bf16 a[16:19], v[76:79], v[156:159], a[16:19]
  v_mfma_f32_16x16x32_bf16 a[20:23], v[76:79], v[160:163], a[20:23]
  ds_read_b64_tr_b16 v[110:111], v30 offset:34816
  v_mfma_f32_16x16x32_bf16 a[24:27], v[76:79], v[164:167], a[24:27]
  v_mfma_f32_16x16x32_bf16 a[28:31], v[76:79], v[168:171], a[28:31]
  ds_read_b128 v[48:51], v20 offset:2048
  v_mfma_f32_16x16x32_bf16 a[32:35], v[80:83], v[140:143], a[32:35]
  v_mfma_f32_16x16x32_bf16 a[36:39], v[80:83], v[144:147], a[36:39]
  ds_read_b64_tr_b16 v[112:113], v31 offset:32768
  v_mfma_f32_16x16x32_bf16 a[40:43], v[80:83], v[148:151], a[40:43]
  v_mfma_f32_16x16x32_bf16 a[44:47], v[80:83], v[152:155], a[44:47]
  ds_read_b64_tr_b16 v[114:115], v31 offset:34816
  v_mfma_f32_16x16x32_bf16 a[48:51], v[80:83], v[156:159], a[48:51]
  v_mfma_f32_16x16x32_bf16 a[52:55], v[80:83], v[160:163], a[52:55]
  ds_read_b128 v[52:55], v20 offset:4096
  v_mfma_f32_16x16x32_bf16 a[56:59], v[80:83], v[164:167], a[56:59]
  v_mfma_f32_16x16x32_bf16 a[60:63], v[80:83], v[168:171], a[60:63]
  ds_read_b64_tr_b16 v[116:117], v32 offset:32768
  v_mfma_f32_16x16x32_bf16 a[64:67], v[84:87], v[140:143], a[64:67]
  v_mfma_f32_16x16x32_bf16 a[68:71], v[84:87], v[144:147], a[68:71]
  ds_read_b64_tr_b16 v[118:119], v32 offset:34816
  v_mfma_f32_16x16x32_bf16 a[72:75], v[84:87], v[148:151], a[72:75]
  v_mfma_f32_16x16x32_bf16 a[76:79], v[84:87], v[152:155], a[76:79]
  ds_read_b128 v[56:59], v20 offset:6144
  v_mfma_f32_16x16x32_bf16 a[80:83], v[84:87], v[156:159], a[80:83]
  v_mfma_f32_16x16x32_bf16 a[84:87], v[84:87], v[160:163], a[84:87]
  ds_read_b64_tr_b16 v[120:121], v33 offset:32768
  v_mfma_f32_16x16x32_bf16 a[88:91], v[84:87], v[164:167], a[88:91]
  v_mfma_f32_16x16x32_bf16 a[92:95], v[84:87], v[168:171], a[92:95]
  ds_read_b64_tr_b16 v[122:123], v33 offset:34816
  v_mfma_f32_16x16x32_bf16 a[96:99], v[88:91], v[140:143], a[96:99]
  v_mfma_f32_16x16x32_bf16 a[100:103], v[88:91], v[144:147], a[100:103]
  ds_read_b128 v[60:63], v20 offset:8192
  v_mfma_f32_16x16x32_bf16 a[104:107], v[88:91], v[148:151], a[104:107]
  v_mfma_f32_16x16x32_bf16 a[108:111], v[88:91], v[152:155], a[108:111]
  ds_read_b64_tr_b16 v[124:125], v34 offset:32768
  v_mfma_f32_16x16x32_bf16 a[112:115], v[88:91], v[156:159], a[112:115]
  v_mfma_f32_16x16x32_bf16 a[116:119], v[88:91], v[160:163], a[116:119]
  ds_read_b64_tr_b16 v[126:127], v34 offset:34816
  v_mfma_f32_16x16x32_bf16 a[120:123], v[88:91], v[164:167], a[120:123]
  v_mfma_f32_16x16x32_bf16 a[124:127], v[88:91], v[168:171], a[124:127]
  ds_read_b128 v[64:67], v20 offset:10240
  v_mfma_f32_16x16x32_bf16 a[128:131], v[92:95], v[140:143], a[128:131]
  v_mfma_f32_16x16x32_bf16 a[132:135], v[92:95], v[144:147], a[132:135]
  ds_read_b64_tr_b16 v[128:129], v35 offset:32768
  v_mfma_f32_16x16x32_bf16 a[136:139], v[92:95], v[148:151], a[136:139]
  v_mfma_f32_16x16x32_bf16 a[140:143], v[92:95], v[152:155], a[140:143]
  ds_read_b64_tr_b16 v[130:131], v35 offset:34816
  v_mfma_f32_16x16x32_bf16 a[144:147], v[92:95], v[156:159], a[144:147]
  v_mfma_f32_16x16x32_bf16 a[148:151], v[92:95], v[160:163], a[148:151]
  ds_read_b128 v[68:71], v20 offset:12288
  v_mfma_f32_16x16x32_bf16 a[152:155], v[92:95], v[164:167], a[152:155]
  v_mfma_f32_16x16x32_bf16 a[156:159], v[92:95], v[168:171], a[156:159]
  ds_read_b64_tr_b16 v[132:133], v36 offset:32768
  v_mfma_f32_16x16x32_bf16 a[160:163], v[96:99], v[140:143], a[160:163]
  v_mfma_f32_16x16x32_bf16 a[164:167], v[96:99], v[144:147], a[164:167]
  ds_read_b64_tr_b16 v[134:135], v36 offset:34816
  v_mfma_f32_16x16x32_bf16 a[168:171], v[96:99], v[148:151], a[168:171]
  v_mfma_f32_16x16x32_bf16 a[172:175], v[96:99], v[152:155], a[172:175]
  ds_read_b128 v[72:75], v20 offset:14336
  v_mfma_f32_16x16x32_bf16 a[176:179], v[96:99], v[156:159], a[176:179]
  v_mfma_f32_16x16x32_bf16 a[180:183], v[96:99], v[160:163], a[180:183]
  ds_read_b64_tr_b16 v[136:137], v37 offset:32768
  v_mfma_f32_16x16x32_bf16 a[184:187], v[96:99], v[164:167], a[184:187]
  v_mfma_f32_16x16x32_bf16 a[188:191], v[96:99], v[168:171], a[188:191]
  ds_read_b64_tr_b16 v[138:139], v37 offset:34816
  v_mfma_f32_16x16x32_bf16 a[192:195], v[100:103], v[140:143], a[192:195]
  v_mfma_f32_16x16x32_bf16 a[196:199], v[100:103], v[144:147], a[196:199]
  v_mfma_f32_16x16x32_bf16 a[200:203], v[100:103], v[148:151], a[200:203]
  v_mfma_f32_16x16x32_bf16 a[204:207], v[100:103], v[152:155], a[204:207]
  v_mfma_f32_16x16x32_bf16 a[208:211], v[100:103], v[156:159], a[208:211]
  v_mfma_f32_16x16x32_bf16 a[212:215], v[100:103], v[160:163], a[212:215]
  v_mfma_f32_16x16x32_bf16 a[216:219], v[100:103], v[164:167], a[216:219]
  v_mfma_f32_16x16x32_bf16 a[220:223], v[100:103], v[168:171], a[220:223]
  v_mfma_f32_16x16x32_bf16 a[224:227], v[104:107], v[140:143], a[224:227]
  v_mfma_f32_16x16x32_bf16 a[228:231], v[104:107], v[144:147], a[228:231]
  v_mfma_f32_16x16x32_bf16 a[232:235], v[104:107], v[148:151], a[232:235]
  v_mfma_f32_16x16x32_bf16 a[236:239], v[104:107], v[152:155], a[236:239]
  v_mfma_f32_16x16x32_bf16 a[240:243], v[104:107], v[156:159], a[240:243]
  v_mfma_f32_16x16x32_bf16 a[244:247], v[104:107], v[160:163], a[244:247]
  v_mfma_f32_16x16x32_bf16 a[248:251], v[104:107], v[164:167], a[248:251]
  v_mfma_f32_16x16x32_bf16 a[252:255], v[104:107], v[168:171], a[252:255]
  s_waitcnt lgkmcnt(0)
  v_mfma_f32_16x16x32_bf16 a[0:3], v[44:47], v[108:111], a[0:3]
  ds_read_b128 v[76:79], v21 offset:0
  v_mfma_f32_16x16x32_bf16 a[4:7], v[44:47], v[112:115], a[4:7]
  v_mfma_f32_16x16x32_bf16 a[8:11], v[44:47], v[116:119], a[8:11]
  ds_read_b64_tr_b16 v[140:141], v30 offset:49152
  v_mfma_f32_16x16x32_bf16 a[12:15], v[44:47], v[120:123], a[12:15]
  v_mfma_f32_16x16x32_bf16 a[16:19], v[44:47], v[124:127], a[16:19]
  ds_read_b64_tr_b16 v[142:143], v30 offset:51200
  v_mfma_f32_16x16x32_bf16 a[20:23], v[44:47], v[128:131], a[20:23]
  v_mfma_f32_16x16x32_bf16 a[24:27], v[44:47], v[132:135], a[24:27]
  ds_read_b128 v[80:83], v21 offset:2048
  v_mfma_f32_16x16x32_bf16 a[28:31], v[44:47], v[136:139], a[28:31]
  v_mfma_f32_16x16x32_bf16 a[32:35], v[48:51], v[108:111], a[32:35]
  ds_read_b64_tr_b16 v[144:145], v31 offset:49152
  v_mfma_f32_16x16x32_bf16 a[36:39], v[48:51], v[112:115], a[36:39]
  v_mfma_f32_16x16x32_bf16 a[40:43], v[48:51], v[116:119], a[40:43]
  ds_read_b64_tr_b16 v[146:147], v31 offset:51200
  v_mfma_f32_16x16x32_bf16 a[44:47], v[48:51], v[120:123], a[44:47]
  v_mfma_f32_16x16x32_bf16 a[48:51], v[48:51], v[124:127], a[48:51]
  ds_read_b128 v[84:87], v21 offset:4096
  v_mfma_f32_16x16x32_bf16 a[52:55], v[48:51], v[128:131], a[52:55]
  v_mfma_f32_16x16x32_bf16 a[56:59], v[48:51], v[132:135], a[56:59]
  ds_read_b64_tr_b16 v[148:149], v32 offset:49152
  v_mfma_f32_16x16x32_bf16 a[60:63], v[48:51], v[136:139], a[60:63]
  v_mfma_f32_16x16x32_bf16 a[64:67], v[52:55], v[108:111], a[64:67]
  ds_read_b64_tr_b16 v[150:151], v32 offset:51200
  v_mfma_f32_16x16x32_bf16 a[68:71], v[52:55], v[112:115], a[68:71]
  v_mfma_f32_16x16x32_bf16 a[72:75], v[52:55], v[116:119], a[72:75]
  ds_read_b128 v[88:91], v21 offset:6144
  v_mfma_f32_16x16x32_bf16 a[76:79], v[52:55], v[120:123], a[76:79]
  v_mfma_f32_16x16x32_bf16 a[80:83], v[52:55], v[124:127], a[80:83]
  ds_read_b64_tr_b16 v[152:153], v33 offset:49152
  v_mfma_f32_16x16x32_bf16 a[84:87], v[52:55], v[128:131], a[84:87]
  v_mfma_f32_16x16x32_bf16 a[88:91], v[52:55], v[132:135], a[88:91]
  ds_read_b64_tr_b16 v[154:155], v33 offset:51200
  v_mfma_f32_16x16x32_bf16 a[92:95], v[52:55], v[136:139], a[92:95]
  v_mfma_f32_16x16x32_bf16 a[96:99], v[56:59], v[108:111], a[96:99]
  ds_read_b128 v[92:95], v21 offset:8192
  v_mfma_f32_16x16x32_bf16 a[100:103], v[56:59], v[112:115], a[100:103]
  v_mfma_f32_16x16x32_bf16 a[104:107], v[56:59], v[116:119], a[104:107]
  ds_read_b64_tr_b16 v[156:157], v34 offset:49152
  v_mfma_f32_16x16x32_bf16 a[108:111], v[56:59], v[120:123], a[108:111]
  v_mfma_f32_16x16x32_bf16 a[112:115], v[56:59], v[124:127], a[112:115]
  ds_read_b64_tr_b16 v[158:159], v34 offset:51200
  v_mfma_f32_16x16x32_bf16 a[116:119], v[56:59], v[128:131], a[116:119]
  v_mfma_f32_16x16x32_bf16 a[120:123], v[56:59], v[132:135], a[120:123]
  ds_read_b128 v[96:99], v21 offset:10240
  v_mfma_f32_16x16x32_bf16 a[124:127], v[56:59], v[136:139], a[124:127]
  v_mfma_f32_16x16x32_bf16 a[128:131], v[60:63], v[108:111], a[128:131]
  ds_read_b64_tr_b16 v[160:161], v35 offset:49152
  v_mfma_f32_16x16x32_bf16 a[132:135], v[60:63], v[112:115], a[132:135]
  v_mfma_f32_16x16x32_bf16 a[136:139], v[60:63], v[116:119], a[136:139]
  ds_read_b64_tr_b16 v[162:163], v35 offset:51200
  v_mfma_f32_16x16x32_bf16 a[140:143], v[60:63], v[120:123], a[140:143]
  v_mfma_f32_16x16x32_bf16 a[144:147], v[60:63], v[124:127], a[144:147]
  ds_read_b128 v[100:103], v21 offset:12288
  v_mfma_f32_16x16x32_bf16 a[148:151], v[60:63], v[128:131], a[148:151]
  v_mfma_f32_16x16x32_bf16 a[152:155], v[60:63], v[132:135], a[152:155]
  ds_read_b64_tr_b16 v[164:165], v36 offset:49152
  v_mfma_f32_16x16x32_bf16 a[156:159], v[60:63], v[136:139], a[156:159]
  v_mfma_f32_16x16x32_bf16 a[160:163], v[64:67], v[108:111], a[160:163]
  ds_read_b64_tr_b16 v[166:167], v36 offset:51200
  v_mfma_f32_16x16x32_bf16 a[164:167], v[64:67], v[112:115], a[164:167]
  v_mfma_f32_16x16x32_bf16 a[168:171], v[64:67], v[116:119], a[168:171]
  ds_read_b128 v[104:107], v21 offset:14336
  v_mfma_f32_16x16x32_bf16 a[172:175], v[64:67], v[120:123], a[172:175]
  v_mfma_f32_16x16x32_bf16 a[176:179], v[64:67], v[124:127], a[176:179]
  ds_read_b64_tr_b16 v[168:169], v37 offset:49152
  v_mfma_f32_16x16x32_bf16 a[180:183], v[64:67], v[128:131], a[180:183]
  v_mfma_f32_16x16x32_bf16 a[184:187], v[64:67], v[132:135], a[184:187]
  ds_read_b64_tr_b16 v[170:171], v37 offset:51200
  v_mfma_f32_16x16x32_bf16 a[188:191], v[64:67], v[136:139], a[188:191]
  v_mfma_f32_16x16x32_bf16 a[192:195], v[68:71], v[108:111], a[192:195]
  v_mfma_f32_16x16x32_bf16 a[196:199], v[68:71], v[112:115], a[196:199]
  v_mfma_f32_16x16x32_bf16 a[200:203], v[68:71], v[116:119], a[200:203]
  v_mfma_f32_16x16x32_bf16 a[204:207], v[68:71], v[120:123], a[204:207]
  v_mfma_f32_16x16x32_bf16 a[208:211], v[68:71], v[124:127], a[208:211]
  v_mfma_f32_16x16x32_bf16 a[212:215], v[68:71], v[128:131], a[212:215]
  v_mfma_f32_16x16x32_bf16 a[216:219], v[68:71], v[132:135], a[216:219]
  v_mfma_f32_16x16x32_bf16 a[220:223], v[68:71], v[136:139], a[220:223]
  v_mfma_f32_16x16x32_bf16 a[224:227], v[72:75], v[108:111], a[224:227]
  v_mfma_f32_16x16x32_bf16 a[228:231], v[72:75], v[112:115], a[228:231]
  v_mfma_f32_16x16x32_bf16 a[232:235], v[72:75], v[116:119], a[232:235]
  v_mfma_f32_16x16x32_bf16 a[236:239], v[72:75], v[120:123], a[236:239]
  v_mfma_f32_16x16x32_bf16 a[240:243], v[72:75], v[124:127], a[240:243]
  v_mfma_f32_16x16x32_bf16 a[244:247], v[72:75], v[128:131], a[244:247]
  v_mfma_f32_16x16x32_bf16 a[248:251], v[72:75], v[132:135], a[248:251]
  v_mfma_f32_16x16x32_bf16 a[252:255], v[72:75], v[136:139], a[252:255]
  s_waitcnt lgkmcnt(0)
  v_mfma_f32_16x16x32_bf16 a[0:3], v[76:79], v[140:143], a[0:3]
  v_mfma_f32_16x16x32_bf16 a[4:7], v[76:79], v[144:147], a[4:7]
  v_mfma_f32_16x16x32_bf16 a[8:11], v[76:79], v[148:151], a[8:11]
  v_mfma_f32_16x16x32_bf16 a[12:15], v[76:79], v[152:155], a[12:15]
  v_mfma_f32_16x16x32_bf16 a[16:19], v[76:79], v[156:159], a[16:19]
  v_mfma_f32_16x16x32_bf16 a[20:23], v[76:79], v[160:163], a[20:23]
  v_mfma_f32_16x16x32_bf16 a[24:27], v[76:79], v[164:167], a[24:27]
  v_mfma_f32_16x16x32_bf16 a[28:31], v[76:79], v[168:171], a[28:31]
  v_mfma_f32_16x16x32_bf16 a[32:35], v[80:83], v[140:143], a[32:35]
  v_mfma_f32_16x16x32_bf16 a[36:39], v[80:83], v[144:147], a[36:39]
  v_mfma_f32_16x16x32_bf16 a[40:43], v[80:83], v[148:151], a[40:43]
  v_mfma_f32_16x16x32_bf16 a[44:47], v[80:83], v[152:155], a[44:47]
  v_mfma_f32_16x16x32_bf16 a[48:51], v[80:83], v[156:159], a[48:51]
  v_mfma_f32_16x16x32_bf16 a[52:55], v[80:83], v[160:163], a[52:55]
  v_mfma_f32_16x16x32_bf16 a[56:59], v[80:83], v[164:167], a[56:59]
  v_mfma_f32_16x16x32_bf16 a[60:63], v[80:83], v[168:171], a[60:63]
  v_mfma_f32_16x16x32_bf16 a[64:67], v[84:87], v[140:143], a[64:67]
  v_mfma_f32_16x16x32_bf16 a[68:71], v[84:87], v[144:147], a[68:71]
  v_mfma_f32_16x16x32_bf16 a[72:75], v[84:87], v[148:151], a[72:75]
  v_mfma_f32_16x16x32_bf16 a[76:79], v[84:87], v[152:155], a[76:79]
  v_mfma_f32_16x16x32_bf16 a[80:83], v[84:87], v[156:159], a[80:83]
  v_mfma_f32_16x16x32_bf16 a[84:87], v[84:87], v[160:163], a[84:87]
  v_mfma_f32_16x16x32_bf16 a[88:91], v[84:87], v[164:167], a[88:91]
  v_mfma_f32_16x16x32_bf16 a[92:95], v[84:87], v[168:171], a[92:95]
  v_mfma_f32_16x16x32_bf16 a[96:99], v[88:91], v[140:143], a[96:99]
  v_mfma_f32_16x16x32_bf16 a[100:103], v[88:91], v[144:147], a[100:103]
  v_mfma_f32_16x16x32_bf16 a[104:107], v[88:91], v[148:151], a[104:107]
  v_mfma_f32_16x16x32_bf16 a[108:111], v[88:91], v[152:155], a[108:111]
  v_mfma_f32_16x16x32_bf16 a[112:115], v[88:91], v[156:159], a[112:115]
  v_mfma_f32_16x16x32_bf16 a[116:119], v[88:91], v[160:163], a[116:119]
  v_mfma_f32_16x16x32_bf16 a[120:123], v[88:91], v[164:167], a[120:123]
  v_mfma_f32_16x16x32_bf16 a[124:127], v[88:91], v[168:171], a[124:127]
  v_mfma_f32_16x16x32_bf16 a[128:131], v[92:95], v[140:143], a[128:131]
  v_mfma_f32_16x16x32_bf16 a[132:135], v[92:95], v[144:147], a[132:135]
  v_mfma_f32_16x16x32_bf16 a[136:139], v[92:95], v[148:151], a[136:139]
  v_mfma_f32_16x16x32_bf16 a[140:143], v[92:95], v[152:155], a[140:143]
  v_mfma_f32_16x16x32_bf16 a[144:147], v[92:95], v[156:159], a[144:147]
  v_mfma_f32_16x16x32_bf16 a[148:151], v[92:95], v[160:163], a[148:151]
  v_mfma_f32_16x16x32_bf16 a[152:155], v[92:95], v[164:167], a[152:155]
  v_mfma_f32_16x16x32_bf16 a[156:159], v[92:95], v[168:171], a[156:159]
  v_mfma_f32_16x16x32_bf16 a[160:163], v[96:99], v[140:143], a[160:163]
  v_mfma_f32_16x16x32_bf16 a[164:167], v[96:99], v[144:147], a[164:167]
  v_mfma_f32_16x16x32_bf16 a[168:171], v[96:99], v[148:151], a[168:171]
  v_mfma_f32_16x16x32_bf16 a[172:175], v[96:99], v[152:155], a[172:175]
  v_mfma_f32_16x16x32_bf16 a[176:179], v[96:99], v[156:159], a[176:179]
  v_mfma_f32_16x16x32_bf16 a[180:183], v[96:99], v[160:163], a[180:183]
  v_mfma_f32_16x16x32_bf16 a[184:187], v[96:99], v[164:167], a[184:187]
  v_mfma_f32_16x16x32_bf16 a[188:191], v[96:99], v[168:171], a[188:191]
  v_mfma_f32_16x16x32_bf16 a[192:195], v[100:103], v[140:143], a[192:195]
  v_mfma_f32_16x16x32_bf16 a[196:199], v[100:103], v[144:147], a[196:199]
  v_mfma_f32_16x16x32_bf16 a[200:203], v[100:103], v[148:151], a[200:203]
  v_mfma_f32_16x16x32_bf16 a[204:207], v[100:103], v[152:155], a[204:207]
  v_mfma_f32_16x16x32_bf16 a[208:211], v[100:103], v[156:159], a[208:211]
  v_mfma_f32_16x16x32_bf16 a[212:215], v[100:103], v[160:163], a[212:215]
  v_mfma_f32_16x16x32_bf16 a[216:219], v[100:103], v[164:167], a[216:219]
  v_mfma_f32_16x16x32_bf16 a[220:223], v[100:103], v[168:171], a[220:223]
  v_mfma_f32_16x16x32_bf16 a[224:227], v[104:107], v[140:143], a[224:227]
  v_mfma_f32_16x16x32_bf16 a[228:231], v[104:107], v[144:147], a[228:231]
  v_mfma_f32_16x16x32_bf16 a[232:235], v[104:107], v[148:151], a[232:235]
  v_mfma_f32_16x16x32_bf16 a[236:239], v[104:107], v[152:155], a[236:239]
  v_mfma_f32_16x16x32_bf16 a[240:243], v[104:107], v[156:159], a[240:243]
  v_mfma_f32_16x16x32_bf16 a[244:247], v[104:107], v[160:163], a[244:247]
  v_mfma_f32_16x16x32_bf16 a[248:251], v[104:107], v[164:167], a[248:251]
  v_mfma_f32_16x16x32_bf16 a[252:255], v[104:107], v[168:171], a[252:255]
  s_mov_b32 s59, 2
  s_mov_b32 s60, s22
  s_mov_b32 s61, s26
  s_add_u32 s62, s38, 0x3d00000
  s_mov_b32 s63, s98
  s_cmp_lg_u32 s39, 0
  s_cbranch_scc1 L_got
  s_mov_b32 s58, 3
  s_branch L_epi
L_small:
  s_mov_b32 s8, s64
  s_and_b32 s9, s65, 0xffff
  s_mov_b32 s10, 0x400000
  s_mov_b32 s11, 0x20000
  s_cmp_eq_u32 s35, 9
  s_cselect_b64 s[88:89], s[70:71], s[72:73]
  s_mov_b32 s12, s88
  s_and_b32 s13, s89, 0xffff
  s_mov_b32 s14, 0x800000
  s_mov_b32 s15, 0x20000
  s_lshl_b32 s91, s33, 3
  s_add_u32 s91, s91, s37
  s_mov_b32 s24, 8192
  s_mov_b32 s26, 262144
  s_mov_b32 s23, 2048
  s_mov_b32 s25, 4
  s_lshl_b32 s20, s36, 18
  s_lshl_b32 s21, s91, 8
  s_sub_u32 s22, s35, 8
  s_lshl_b32 s22, s22, 24
  s_lshl_b32 s90, s36, 20
  s_add_u32 s22, s22, s90
  s_lshl_b32 s90, s91, 13
  s_add_u32 s22, s22, s90
  s_lshl_b32 s38, s36, 9
  s_add_u32 s38, s38, 28672
  s_lshl_b32 s90, s33, 7
  s_add_u32 s38, s38, s90
  v_and_b32 v1, 63, v0
  v_lshrrev_b32 v22, 6, v0
  s_nop 0
  v_readfirstlane_b32 s27, v22
  s_mul_i32 s90, s27, 32
  v_lshrrev_b32 v22, 3, v1
  v_add_u32 v22, s90, v22
  v_mul_lo_u32 v22, v22, s23
  v_lshrrev_b32 v23, 4, v1
  v_xor_b32 v23, v23, v1
  v_and_b32 v23, 7, v23
  v_lshl_add_u32 v2, v23, 4, v22
  s_mul_i32 s91, s23, 8
  v_add_u32 v3, s91, v2
  v_xor_b32 v3, 64, v3
  v_add_u32 v4, s91, v3
  v_xor_b32 v4, 64, v4
  v_add_u32 v5, s91, v4
  v_xor_b32 v5, 64, v5
  s_mul_i32 s90, s27, 16
  v_lshrrev_b32 v22, 4, v1
  v_add_u32 v22, 0, v22
  v_add_u32 v22, s90, v22
  v_and_b32 v23, 3, v22
  v_lshlrev_b32 v23, 1, v23
  v_and_b32 v24, 8, v22
  v_or_b32 v23, v23, v24
  v_xor_b32 v23, v23, v1
  v_and_b32 v23, 15, v23
  v_mul_lo_u32 v22, v22, s24
  v_lshl_add_u32 v6, v23, 4, v22
  v_lshrrev_b32 v22, 4, v1
  v_add_u32 v22, 4, v22
  v_add_u32 v22, s90, v22
  v_and_b32 v23, 3, v22
  v_lshlrev_b32 v23, 1, v23
  v_and_b32 v24, 8, v22
  v_or_b32 v23, v23, v24
  v_xor_b32 v23, v23, v1
  v_and_b32 v23, 15, v23
  v_mul_lo_u32 v22, v22, s24
  v_lshl_add_u32 v7, v23, 4, v22
  v_lshrrev_b32 v22, 4, v1
  v_add_u32 v22, 8, v22
  v_add_u32 v22, s90, v22
  v_and_b32 v23, 3, v22
  v_lshlrev_b32 v23, 1, v23
  v_and_b32 v24, 8, v22
  v_or_b32 v23, v23, v24
  v_xor_b32 v23, v23, v1
  v_and_b32 v23, 15, v23
  v_mul_lo_u32 v22, v22, s24
  v_lshl_add_u32 v8, v23, 4, v22
  v_lshrrev_b32 v22, 4, v1
  v_add_u32 v22, 12, v22
  v_add_u32 v22, s90, v22
  v_and_b32 v23, 3, v22
  v_lshlrev_b32 v23, 1, v23
  v_and_b32 v24, 8, v22
  v_or_b32 v23, v23, v24
  v_xor_b32 v23, v23, v1
  v_and_b32 v23, 15, v23
  v_mul_lo_u32 v22, v22, s24
  v_lshl_add_u32 v9, v23, 4, v22
  s_mul_i32 s51, s24, 64
  s_mul_i32 s52, s27, 4096
  s_mul_i32 s53, s27, 4096
  s_add_u32 s53, s53, 16384
  s_add_u32 m0, s52, 0
  s_nop 0
  buffer_load_dwordx4 v2, s[8:11], s20 offen  lds
  s_add_u32 m0, s53, 0
  s_nop 0
  buffer_load_dwordx4 v6, s[12:15], s21 offen  lds
  s_add_u32 m0, s52, 1024
  s_nop 0
  buffer_load_dwordx4 v3, s[8:11], s20 offen  lds
  s_add_u32 m0, s53, 1024
  s_nop 0
  buffer_load_dwordx4 v7, s[12:15], s21 offen  lds
  s_add_u32 m0, s52, 2048
  s_nop 0
  buffer_load_dwordx4 v4, s[8:11], s20 offen  lds
  s_add_u32 m0, s53, 2048
  s_nop 0
  buffer_load_dwordx4 v8, s[12:15], s21 offen  lds
  s_add_u32 m0, s52, 3072
  s_nop 0
  buffer_load_dwordx4 v5, s[8:11], s20 offen  lds
  s_add_u32 m0, s53, 3072
  s_nop 0
  buffer_load_dwordx4 v9, s[12:15], s21 offen  lds
  s_add_u32 s20, s20, 128
  s_add_u32 s21, s21, s51
  s_add_u32 m0, s52, 32768
  s_nop 0
  buffer_load_dwordx4 v2, s[8:11], s20 offen  lds
  s_add_u32 m0, s53, 32768
  s_nop 0
  buffer_load_dwordx4 v6, s[12:15], s21 offen  lds
  s_add_u32 m0, s52, 33792
  s_nop 0
  buffer_load_dwordx4 v3, s[8:11], s20 offen  lds
  s_add_u32 m0, s53, 33792
  s_nop 0
  buffer_load_dwordx4 v7, s[12:15], s21 offen  lds
  s_add_u32 m0, s52, 34816
  s_nop 0
  buffer_load_dwordx4 v4, s[8:11], s20 offen  lds
  s_add_u32 m0, s53, 34816
  s_nop 0
  buffer_load_dwordx4 v8, s[12:15], s21 offen  lds
  s_add_u32 m0, s52, 35840
  s_nop 0
  buffer_load_dwordx4 v5, s[8:11], s20 offen  lds
  s_add_u32 m0, s53, 35840
  s_nop 0
  buffer_load_dwordx4 v9, s[12:15], s21 offen  lds
  s_add_u32 s20, s20, 128
  s_add_u32 s21, s21, s51
  s_add_u32 m0, s52, 65536
  s_nop 0
  buffer_load_dwordx4 v2, s[8:11], s20 offen  lds
  s_add_u32 m0, s53, 65536
  s_nop 0
  buffer_load_dwordx4 v6, s[12:15], s21 offen  lds
  s_add_u32 m0, s52, 66560
  s_nop 0
  buffer_load_dwordx4 v3, s[8:11], s20 offen  lds
  s_add_u32 m0, s53, 66560
  s_nop 0
  buffer_load_dwordx4 v7, s[12:15], s21 offen  lds
  s_add_u32 m0, s52, 67584
  s_nop 0
  buffer_load_dwordx4 v4, s[8:11], s20 offen  lds
  s_add_u32 m0, s53, 67584
  s_nop 0
  buffer_load_dwordx4 v8, s[12:15], s21 offen  lds
  s_add_u32 m0, s52, 68608
  s_nop 0
  buffer_load_dwordx4 v5, s[8:11], s20 offen  lds
  s_add_u32 m0, s53, 68608
  s_nop 0
  buffer_load_dwordx4 v9, s[12:15], s21 offen  lds
  s_add_u32 s20, s20, 128
  s_add_u32 s21, s21, s51
  s_add_u32 m0, s52, 98304
  s_nop 0
  buffer_load_dwordx4 v2, s[8:11], s20 offen  lds
  s_add_u32 m0, s53, 98304
  s_nop 0
  buffer_load_dwordx4 v6, s[12:15], s21 offen  lds
  s_add_u32 m0, s52, 99328
  s_nop 0
  buffer_load_dwordx4 v3, s[8:11], s20 offen  lds
  s_add_u32 m0, s53, 99328
  s_nop 0
  buffer_load_dwordx4 v7, s[12:15], s21 offen  lds
  s_add_u32 m0, s52, 100352
  s_nop 0
  buffer_load_dwordx4 v4, s[8:11], s20 offen  lds
  s_add_u32 m0, s53, 100352
  s_nop 0
  buffer_load_dwordx4 v8, s[12:15], s21 offen  lds
  s_add_u32 m0, s52, 101376
  s_nop 0
  buffer_load_dwordx4 v5, s[8:11], s20 offen  lds
  s_add_u32 m0, s53, 101376
  s_nop 0
  buffer_load_dwordx4 v9, s[12:15], s21 offen  lds
  s_add_u32 s20, s20, 128
  s_add_u32 s21, s21, s51
  s_lshr_b32 s90, s27, 1
  s_and_b32 s91, s27, 1
  s_mul_i32 s92, s90, 8192
  v_mov_b32 v22, 0x0
  v_bfe_u32 v23, v1, 0, 4
  v_lshl_add_u32 v22, v23, 7, v22
  v_add_u32 v22, s92, v22
  v_lshrrev_b32 v23, 1, v1
  v_and_b32 v23, 7, v23
  v_lshrrev_b32 v24, 4, v1
  v_xor_b32 v23, v23, v24
  v_lshl_add_u32 v10, v23, 4, v22
  v_xor_b32 v11, 64, v10
  v_add_u32 v12, 65536, v10
  v_add_u32 v13, 65536, v11
  v_mov_b32 v22, 0x0
  v_bfe_u32 v23, v1, 2, 2
  v_lshl_add_u32 v22, v23, 8, v22
  v_bfe_u32 v23, v1, 4, 2
  v_lshl_add_u32 v22, v23, 11, v22
  v_bfe_u32 v23, v1, 0, 2
  v_lshl_add_u32 v22, v23, 3, v22
  v_bfe_u32 v24, v1, 2, 3
  s_mul_i32 s92, s91, 4
  s_add_u32 s93, s92, 0
  v_xor_b32 v23, s93, v24
  v_lshl_add_u32 v14, v23, 5, v22
  v_add_u32 v18, 65536, v14
  s_add_u32 s93, s92, 1
  v_xor_b32 v23, s93, v24
  v_lshl_add_u32 v15, v23, 5, v22
  v_add_u32 v19, 65536, v15
  s_add_u32 s93, s92, 2
  v_xor_b32 v23, s93, v24
  v_lshl_add_u32 v16, v23, 5, v22
  v_add_u32 v20, 65536, v16
  s_add_u32 s93, s92, 3
  v_xor_b32 v23, s93, v24
  v_lshl_add_u32 v17, v23, 5, v22
  v_add_u32 v21, 65536, v17
  s_mov_b32 s58, 2
  s_branch L_epi
L_r2:
  v_lshlrev_b32 v174, 7, v1
  s_sub_u32 s42, s34, 32
  s_lshl_b32 s40, s42, 2
  s_add_u32 s40, s40, s33
  s_lshl_b32 s40, s40, 2
  s_add_u32 s40, s40, s32
  s_lshl_b32 s40, s40, 13
  s_cmp_ge_u32 s42, 16
  s_cselect_b32 s40, 0x40000000, s40
  s_add_u32 s41, s40, 2097152
  s_mov_b32 s44, s64
  s_and_b32 s45, s65, 0xffff
  s_mov_b32 s46, 0x400000
  s_mov_b32 s47, 0x20000
  buffer_load_dword v175, v174, s[44:47], s40 offen
  s_mov_b32 s44, s64
  s_and_b32 s45, s65, 0xffff
  s_mov_b32 s46, 0x400000
  s_mov_b32 s47, 0x20000
  buffer_load_dword v175, v174, s[44:47], s41 offen
  s_cmp_eq_u32 s35, 10
  s_cbranch_scc1 L_g5
  s_waitcnt vmcnt(26)
  s_barrier
  ds_read_b128 v[28:31], v10 offset:0
  ds_read_b64_tr_b16 v[60:61], v14 offset:16384
  ds_read_b64_tr_b16 v[62:63], v14 offset:17408
  ds_read_b128 v[32:35], v10 offset:2048
  ds_read_b64_tr_b16 v[64:65], v15 offset:16384
  ds_read_b64_tr_b16 v[66:67], v15 offset:17408
  ds_read_b128 v[36:39], v10 offset:4096
  ds_read_b64_tr_b16 v[68:69], v16 offset:16384
  ds_read_b64_tr_b16 v[70:71], v16 offset:17408
  ds_read_b128 v[40:43], v10 offset:6144
  ds_read_b64_tr_b16 v[72:73], v17 offset:16384
  ds_read_b64_tr_b16 v[74:75], v17 offset:17408
  s_sub_u32 s25, s25, 1
  s_waitcnt lgkmcnt(0)
  v_mfma_f32_16x16x32_bf16 a[0:3], v[60:63], v[28:31], 0
  ds_read_b128 v[44:47], v11 offset:0
  v_mfma_f32_16x16x32_bf16 a[4:7], v[64:67], v[28:31], 0
  ds_read_b64_tr_b16 v[76:77], v14 offset:24576
  v_mfma_f32_16x16x32_bf16 a[8:11], v[68:71], v[28:31], 0
  ds_read_b64_tr_b16 v[78:79], v14 offset:25600
  v_mfma_f32_16x16x32_bf16 a[12:15], v[72:75], v[28:31], 0
  ds_read_b128 v[48:51], v11 offset:2048
  v_mfma_f32_16x16x32_bf16 a[16:19], v[60:63], v[32:35], 0
  ds_read_b64_tr_b16 v[80:81], v15 offset:24576
  v_mfma_f32_16x16x32_bf16 a[20:23], v[64:67], v[32:35], 0
  ds_read_b64_tr_b16 v[82:83], v15 offset:25600
  v_mfma_f32_16x16x32_bf16 a[24:27], v[68:71], v[32:35], 0
  ds_read_b128 v[52:55], v11 offset:4096
  v_mfma_f32_16x16x32_bf16 a[28:31], v[72:75], v[32:35], 0
  ds_read_b64_tr_b16 v[84:85], v16 offset:24576
  v_mfma_f32_16x16x32_bf16 a[32:35], v[60:63], v[36:39], 0
  ds_read_b64_tr_b16 v[86:87], v16 offset:25600
  v_mfma_f32_16x16x32_bf16 a[36:39], v[64:67], v[36:39], 0
  ds_read_b128 v[56:59], v11 offset:6144
  v_mfma_f32_16x16x32_bf16 a[40:43], v[68:71], v[36:39], 0
  ds_read_b64_tr_b16 v[88:89], v17 offset:24576
  v_mfma_f32_16x16x32_bf16 a[44:47], v[72:75], v[36:39], 0
  ds_read_b64_tr_b16 v[90:91], v17 offset:25600
  v_mfma_f32_16x16x32_bf16 a[48:51], v[60:63], v[40:43], 0
  v_mfma_f32_16x16x32_bf16 a[52:55], v[64:67], v[40:43], 0
  v_mfma_f32_16x16x32_bf16 a[56:59], v[68:71], v[40:43], 0
  v_mfma_f32_16x16x32_bf16 a[60:63], v[72:75], v[40:43], 0
  s_waitcnt lgkmcnt(0)
  v_mfma_f32_16x16x32_bf16 a[0:3], v[76:79], v[44:47], a[0:3]
  s_waitcnt vmcnt(18)
  s_barrier
  s_add_u32 m0, s52, 0
  v_mfma_f32_16x16x32_bf16 a[4:7], v[80:83], v[44:47], a[4:7]
  buffer_load_dwordx4 v2, s[8:11], s20 offen  lds
  ds_read_b128 v[28:31], v10 offset:32768
  v_mfma_f32_16x16x32_bf16 a[8:11], v[84:87], v[44:47], a[8:11]
  ds_read_b64_tr_b16 v[60:61], v14 offset:49152
  v_mfma_f32_16x16x32_bf16 a[12:15], v[88:91], v[44:47], a[12:15]
  ds_read_b64_tr_b16 v[62:63], v14 offset:50176
  s_add_u32 m0, s53, 0
  v_mfma_f32_16x16x32_bf16 a[16:19], v[76:79], v[48:51], a[16:19]
  buffer_load_dwordx4 v6, s[12:15], s21 offen  lds
  ds_read_b128 v[32:35], v10 offset:34816
  v_mfma_f32_16x16x32_bf16 a[20:23], v[80:83], v[48:51], a[20:23]
  ds_read_b64_tr_b16 v[64:65], v15 offset:49152
  v_mfma_f32_16x16x32_bf16 a[24:27], v[84:87], v[48:51], a[24:27]
  ds_read_b64_tr_b16 v[66:67], v15 offset:50176
  s_add_u32 m0, s52, 1024
  v_mfma_f32_16x16x32_bf16 a[28:31], v[88:91], v[48:51], a[28:31]
  buffer_load_dwordx4 v3, s[8:11], s20 offen  lds
  ds_read_b128 v[36:39], v10 offset:36864
  v_mfma_f32_16x16x32_bf16 a[32:35], v[76:79], v[52:55], a[32:35]
  ds_read_b64_tr_b16 v[68:69], v16 offset:49152
  v_mfma_f32_16x16x32_bf16 a[36:39], v[80:83], v[52:55], a[36:39]
  ds_read_b64_tr_b16 v[70:71], v16 offset:50176
  s_add_u32 m0, s53, 1024
  v_mfma_f32_16x16x32_bf16 a[40:43], v[84:87], v[52:55], a[40:43]
  buffer_load_dwordx4 v7, s[12:15], s21 offen  lds
  ds_read_b128 v[40:43], v10 offset:38912
  v_mfma_f32_16x16x32_bf16 a[44:47], v[88:91], v[52:55], a[44:47]
  ds_read_b64_tr_b16 v[72:73], v17 offset:49152
  v_mfma_f32_16x16x32_bf16 a[48:51], v[76:79], v[56:59], a[48:51]
  ds_read_b64_tr_b16 v[74:75], v17 offset:50176
  s_add_u32 m0, s52, 2048
  v_mfma_f32_16x16x32_bf16 a[52:55], v[80:83], v[56:59], a[52:55]
  buffer_load_dwordx4 v4, s[8:11], s20 offen  lds
  v_mfma_f32_16x16x32_bf16 a[56:59], v[84:87], v[56:59], a[56:59]
  v_mfma_f32_16x16x32_bf16 a[60:63], v[88:91], v[56:59], a[60:63]
  s_waitcnt lgkmcnt(0)
  s_add_u32 m0, s53, 2048
  v_mfma_f32_16x16x32_bf16 a[0:3], v[60:63], v[28:31], a[0:3]
  buffer_load_dwordx4 v8, s[12:15], s21 offen  lds
  ds_read_b128 v[44:47], v11 offset:32768
  v_mfma_f32_16x16x32_bf16 a[4:7], v[64:67], v[28:31], a[4:7]
  ds_read_b64_tr_b16 v[76:77], v14 offset:57344
  v_mfma_f32_16x16x32_bf16 a[8:11], v[68:71], v[28:31], a[8:11]
  ds_read_b64_tr_b16 v[78:79], v14 offset:58368
  v_mfma_f32_16x16x32_bf16 a[12:15], v[72:75], v[28:31], a[12:15]
  ds_read_b128 v[48:51], v11 offset:34816
  s_add_u32 m0, s52, 3072
  v_mfma_f32_16x16x32_bf16 a[16:19], v[60:63], v[32:35], a[16:19]
  buffer_load_dwordx4 v5, s[8:11], s20 offen  lds
  ds_read_b64_tr_b16 v[80:81], v15 offset:57344
  v_mfma_f32_16x16x32_bf16 a[20:23], v[64:67], v[32:35], a[20:23]
  ds_read_b64_tr_b16 v[82:83], v15 offset:58368
  v_mfma_f32_16x16x32_bf16 a[24:27], v[68:71], v[32:35], a[24:27]
  ds_read_b128 v[52:55], v11 offset:36864
  v_mfma_f32_16x16x32_bf16 a[28:31], v[72:75], v[32:35], a[28:31]
  ds_read_b64_tr_b16 v[84:85], v16 offset:57344
  s_add_u32 m0, s53, 3072
  v_mfma_f32_16x16x32_bf16 a[32:35], v[60:63], v[36:39], a[32:35]
  buffer_load_dwordx4 v9, s[12:15], s21 offen  lds
  ds_read_b64_tr_b16 v[86:87], v16 offset:58368
  v_mfma_f32_16x16x32_bf16 a[36:39], v[64:67], v[36:39], a[36:39]
  ds_read_b128 v[56:59], v11 offset:38912
  v_mfma_f32_16x16x32_bf16 a[40:43], v[68:71], v[36:39], a[40:43]
  ds_read_b64_tr_b16 v[88:89], v17 offset:57344
  v_mfma_f32_16x16x32_bf16 a[44:47], v[72:75], v[36:39], a[44:47]
  ds_read_b64_tr_b16 v[90:91], v17 offset:58368
  s_add_u32 s20, s20, 128
  v_mfma_f32_16x16x32_bf16 a[48:51], v[60:63], v[40:43], a[48:51]
  s_add_u32 s21, s21, s51
  v_mfma_f32_16x16x32_bf16 a[52:55], v[64:67], v[40:43], a[52:55]
  v_mfma_f32_16x16x32_bf16 a[56:59], v[68:71], v[40:43], a[56:59]
  v_mfma_f32_16x16x32_bf16 a[60:63], v[72:75], v[40:43], a[60:63]
  s_waitcnt lgkmcnt(0)
  v_mfma_f32_16x16x32_bf16 a[0:3], v[76:79], v[44:47], a[0:3]
  s_waitcnt vmcnt(18)
  s_barrier
  s_add_u32 m0, s52, 32768
  v_mfma_f32_16x16x32_bf16 a[4:7], v[80:83], v[44:47], a[4:7]
  buffer_load_dwordx4 v2, s[8:11], s20 offen  lds
  ds_read_b128 v[28:31], v12 offset:0
  v_mfma_f32_16x16x32_bf16 a[8:11], v[84:87], v[44:47], a[8:11]
  ds_read_b64_tr_b16 v[60:61], v18 offset:16384
  v_mfma_f32_16x16x32_bf16 a[12:15], v[88:91], v[44:47], a[12:15]
  ds_read_b64_tr_b16 v[62:63], v18 offset:17408
  s_add_u32 m0, s53, 32768
  v_mfma_f32_16x16x32_bf16 a[16:19], v[76:79], v[48:51], a[16:19]
  buffer_load_dwordx4 v6, s[12:15], s21 offen  lds
  ds_read_b128 v[32:35], v12 offset:2048
  v_mfma_f32_16x16x32_bf16 a[20:23], v[80:83], v[48:51], a[20:23]
  ds_read_b64_tr_b16 v[64:65], v19 offset:16384
  v_mfma_f32_16x16x32_bf16 a[24:27], v[84:87], v[48:51], a[24:27]
  ds_read_b64_tr_b16 v[66:67], v19 offset:17408
  s_add_u32 m0, s52, 33792
  v_mfma_f32_16x16x32_bf16 a[28:31], v[88:91], v[48:51], a[28:31]
  buffer_load_dwordx4 v3, s[8:11], s20 offen  lds
  ds_read_b128 v[36:39], v12 offset:4096
  v_mfma_f32_16x16x32_bf16 a[32:35], v[76:79], v[52:55], a[32:35]
  ds_read_b64_tr_b16 v[68:69], v20 offset:16384
  v_mfma_f32_16x16x32_bf16 a[36:39], v[80:83], v[52:55], a[36:39]
  ds_read_b64_tr_b16 v[70:71], v20 offset:17408
  s_add_u32 m0, s53, 33792
  v_mfma_f32_16x16x32_bf16 a[40:43], v[84:87], v[52:55], a[40:43]
  buffer_load_dwordx4 v7, s[12:15], s21 offen  lds
  ds_read_b128 v[40:43], v12 offset:6144
  v_mfma_f32_16x16x32_bf16 a[44:47], v[88:91], v[52:55], a[44:47]
  ds_read_b64_tr_b16 v[72:73], v21 offset:16384
  v_mfma_f32_16x16x32_bf16 a[48:51], v[76:79], v[56:59], a[48:51]
  ds_read_b64_tr_b16 v[74:75], v21 offset:17408
  s_add_u32 m0, s52, 34816
  v_mfma_f32_16x16x32_bf16 a[52:55], v[80:83], v[56:59], a[52:55]
  buffer_load_dwordx4 v4, s[8:11], s20 offen  lds
  v_mfma_f32_16x16x32_bf16 a[56:59], v[84:87], v[56:59], a[56:59]
  v_mfma_f32_16x16x32_bf16 a[60:63], v[88:91], v[56:59], a[60:63]
  s_waitcnt lgkmcnt(0)
  s_add_u32 m0, s53, 34816
  v_mfma_f32_16x16x32_bf16 a[0:3], v[60:63], v[28:31], a[0:3]
  buffer_load_dwordx4 v8, s[12:15], s21 offen  lds
  ds_read_b128 v[44:47], v13 offset:0
  v_mfma_f32_16x16x32_bf16 a[4:7], v[64:67], v[28:31], a[4:7]
  ds_read_b64_tr_b16 v[76:77], v18 offset:24576
  v_mfma_f32_16x16x32_bf16 a[8:11], v[68:71], v[28:31], a[8:11]
  ds_read_b64_tr_b16 v[78:79], v18 offset:25600
  v_mfma_f32_16x16x32_bf16 a[12:15], v[72:75], v[28:31], a[12:15]
  ds_read_b128 v[48:51], v13 offset:2048
  s_add_u32 m0, s52, 35840
  v_mfma_f32_16x16x32_bf16 a[16:19], v[60:63], v[32:35], a[16:19]
  buffer_load_dwordx4 v5, s[8:11], s20 offen  lds
  ds_read_b64_tr_b16 v[80:81], v19 offset:24576
  v_mfma_f32_16x16x32_bf16 a[20:23], v[64:67], v[32:35], a[20:23]
  ds_read_b64_tr_b16 v[82:83], v19 offset:25600
  v_mfma_f32_16x16x32_bf16 a[24:27], v[68:71], v[32:35], a[24:27]
  ds_read_b128 v[52:55], v13 offset:4096
  v_mfma_f32_16x16x32_bf16 a[28:31], v[72:75], v[32:35], a[28:31]
  ds_read_b64_tr_b16 v[84:85], v20 offset:24576
  s_add_u32 m0, s53, 35840
  v_mfma_f32_16x16x32_bf16 a[32:35], v[60:63], v[36:39], a[32:35]
  buffer_load_dwordx4 v9, s[12:15], s21 offen  lds
  ds_read_b64_tr_b16 v[86:87], v20 offset:25600
  v_mfma_f32_16x16x32_bf16 a[36:39], v[64:67], v[36:39], a[36:39]
  ds_read_b128 v[56:59], v13 offset:6144
  v_mfma_f32_16x16x32_bf16 a[40:43], v[68:71], v[36:39], a[40:43]
  ds_read_b64_tr_b16 v[88:89], v21 offset:24576
  v_mfma_f32_16x16x32_bf16 a[44:47], v[72:75], v[36:39], a[44:47]
  ds_read_b64_tr_b16 v[90:91], v21 offset:25600
  s_add_u32 s20, s20, 128
  v_mfma_f32_16x16x32_bf16 a[48:51], v[60:63], v[40:43], a[48:51]
  s_add_u32 s21, s21, s51
  v_mfma_f32_16x16x32_bf16 a[52:55], v[64:67], v[40:43], a[52:55]
  v_mfma_f32_16x16x32_bf16 a[56:59], v[68:71], v[40:43], a[56:59]
  v_mfma_f32_16x16x32_bf16 a[60:63], v[72:75], v[40:43], a[60:63]
  s_waitcnt lgkmcnt(0)
  v_mfma_f32_16x16x32_bf16 a[0:3], v[76:79], v[44:47], a[0:3]
  s_waitcnt vmcnt(18)
  s_barrier
  s_add_u32 m0, s52, 65536
  v_mfma_f32_16x16x32_bf16 a[4:7], v[80:83], v[44:47], a[4:7]
  buffer_load_dwordx4 v2, s[8:11], s20 offen  lds
  ds_read_b128 v[28:31], v12 offset:32768
  v_mfma_f32_16x16x32_bf16 a[8:11], v[84:87], v[44:47], a[8:11]
  ds_read_b64_tr_b16 v[60:61], v18 offset:49152
  v_mfma_f32_16x16x32_bf16 a[12:15], v[88:91], v[44:47], a[12:15]
  ds_read_b64_tr_b16 v[62:63], v18 offset:50176
  s_add_u32 m0, s53, 65536
  v_mfma_f32_16x16x32_bf16 a[16:19], v[76:79], v[48:51], a[16:19]
  buffer_load_dwordx4 v6, s[12:15], s21 offen  lds
  ds_read_b128 v[32:35], v12 offset:34816
  v_mfma_f32_16x16x32_bf16 a[20:23], v[80:83], v[48:51], a[20:23]
  ds_read_b64_tr_b16 v[64:65], v19 offset:49152
  v_mfma_f32_16x16x32_bf16 a[24:27], v[84:87], v[48:51], a[24:27]
  ds_read_b64_tr_b16 v[66:67], v19 offset:50176
  s_add_u32 m0, s52, 66560
  v_mfma_f32_16x16x32_bf16 a[28:31], v[88:91], v[48:51], a[28:31]
  buffer_load_dwordx4 v3, s[8:11], s20 offen  lds
  ds_read_b128 v[36:39], v12 offset:36864
  v_mfma_f32_16x16x32_bf16 a[32:35], v[76:79], v[52:55], a[32:35]
  ds_read_b64_tr_b16 v[68:69], v20 offset:49152
  v_mfma_f32_16x16x32_bf16 a[36:39], v[80:83], v[52:55], a[36:39]
  ds_read_b64_tr_b16 v[70:71], v20 offset:50176
  s_add_u32 m0, s53, 66560
  v_mfma_f32_16x16x32_bf16 a[40:43], v[84:87], v[52:55], a[40:43]
  buffer_load_dwordx4 v7, s[12:15], s21 offen  lds
  ds_read_b128 v[40:43], v12 offset:38912
  v_mfma_f32_16x16x32_bf16 a[44:47], v[88:91], v[52:55], a[44:47]
  ds_read_b64_tr_b16 v[72:73], v21 offset:49152
  v_mfma_f32_16x16x32_bf16 a[48:51], v[76:79], v[56:59], a[48:51]
  ds_read_b64_tr_b16 v[74:75], v21 offset:50176
  s_add_u32 m0, s52, 67584
  v_mfma_f32_16x16x32_bf16 a[52:55], v[80:83], v[56:59], a[52:55]
  buffer_load_dwordx4 v4, s[8:11], s20 offen  lds
  v_mfma_f32_16x16x32_bf16 a[56:59], v[84:87], v[56:59], a[56:59]
  v_mfma_f32_16x16x32_bf16 a[60:63], v[88:91], v[56:59], a[60:63]
  s_waitcnt lgkmcnt(0)
  s_add_u32 m0, s53, 67584
  v_mfma_f32_16x16x32_bf16 a[0:3], v[60:63], v[28:31], a[0:3]
  buffer_load_dwordx4 v8, s[12:15], s21 offen  lds
  ds_read_b128 v[44:47], v13 offset:32768
  v_mfma_f32_16x16x32_bf16 a[4:7], v[64:67], v[28:31], a[4:7]
  ds_read_b64_tr_b16 v[76:77], v18 offset:57344
  v_mfma_f32_16x16x32_bf16 a[8:11], v[68:71], v[28:31], a[8:11]
  ds_read_b64_tr_b16 v[78:79], v18 offset:58368
  v_mfma_f32_16x16x32_bf16 a[12:15], v[72:75], v[28:31], a[12:15]
  ds_read_b128 v[48:51], v13 offset:34816
  s_add_u32 m0, s52, 68608
  v_mfma_f32_16x16x32_bf16 a[16:19], v[60:63], v[32:35], a[16:19]
  buffer_load_dwordx4 v5, s[8:11], s20 offen  lds
  ds_read_b64_tr_b16 v[80:81], v19 offset:57344
  v_mfma_f32_16x16x32_bf16 a[20:23], v[64:67], v[32:35], a[20:23]
  ds_read_b64_tr_b16 v[82:83], v19 offset:58368
  v_mfma_f32_16x16x32_bf16 a[24:27], v[68:71], v[32:35], a[24:27]
  ds_read_b128 v[52:55], v13 offset:36864
  v_mfma_f32_16x16x32_bf16 a[28:31], v[72:75], v[32:35], a[28:31]
  ds_read_b64_tr_b16 v[84:85], v20 offset:57344
  s_add_u32 m0, s53, 68608
  v_mfma_f32_16x16x32_bf16 a[32:35], v[60:63], v[36:39], a[32:35]
  buffer_load_dwordx4 v9, s[12:15], s21 offen  lds
  ds_read_b64_tr_b16 v[86:87], v20 offset:58368
  v_mfma_f32_16x16x32_bf16 a[36:39], v[64:67], v[36:39], a[36:39]
  ds_read_b128 v[56:59], v13 offset:38912
  v_mfma_f32_16x16x32_bf16 a[40:43], v[68:71], v[36:39], a[40:43]
  ds_read_b64_tr_b16 v[88:89], v21 offset:57344
  v_mfma_f32_16x16x32_bf16 a[44:47], v[72:75], v[36:39], a[44:47]
  ds_read_b64_tr_b16 v[90:91], v21 offset:58368
  s_add_u32 s20, s20, 128
  v_mfma_f32_16x16x32_bf16 a[48:51], v[60:63], v[40:43], a[48:51]
  s_add_u32 s21, s21, s51
  v_mfma_f32_16x16x32_bf16 a[52:55], v[64:67], v[40:43], a[52:55]
  v_mfma_f32_16x16x32_bf16 a[56:59], v[68:71], v[40:43], a[56:59]
  v_mfma_f32_16x16x32_bf16 a[60:63], v[72:75], v[40:43], a[60:63]
  s_waitcnt lgkmcnt(0)
  v_mfma_f32_16x16x32_bf16 a[0:3], v[76:79], v[44:47], a[0:3]
  s_waitcnt vmcnt(16)
  s_barrier
  s_add_u32 m0, s52, 98304
  v_mfma_f32_16x16x32_bf16 a[4:7], v[80:83], v[44:47], a[4:7]
  buffer_load_dwordx4 v2, s[8:11], s20 offen  lds
  ds_read_b128 v[28:31], v10 offset:0
  v_mfma_f32_16x16x32_bf16 a[8:11], v[84:87], v[44:47], a[8:11]
  ds_read_b64_tr_b16 v[60:61], v14 offset:16384
  v_mfma_f32_16x16x32_bf16 a[12:15], v[88:91], v[44:47], a[12:15]
  ds_read_b64_tr_b16 v[62:63], v14 offset:17408
  s_add_u32 m0, s53, 98304
  v_mfma_f32_16x16x32_bf16 a[16:19], v[76:79], v[48:51], a[16:19]
  buffer_load_dwordx4 v6, s[12:15], s21 offen  lds
  ds_read_b128 v[32:35], v10 offset:2048
  v_mfma_f32_16x16x32_bf16 a[20:23], v[80:83], v[48:51], a[20:23]
  ds_read_b64_tr_b16 v[64:65], v15 offset:16384
  v_mfma_f32_16x16x32_bf16 a[24:27], v[84:87], v[48:51], a[24:27]
  ds_read_b64_tr_b16 v[66:67], v15 offset:17408
  s_add_u32 m0, s52, 99328
  v_mfma_f32_16x16x32_bf16 a[28:31], v[88:91], v[48:51], a[28:31]
  buffer_load_dwordx4 v3, s[8:11], s20 offen  lds
  ds_read_b128 v[36:39], v10 offset:4096
  v_mfma_f32_16x16x32_bf16 a[32:35], v[76:79], v[52:55], a[32:35]
  ds_read_b64_tr_b16 v[68:69], v16 offset:16384
  v_mfma_f32_16x16x32_bf16 a[36:39], v[80:83], v[52:55], a[36:39]
  ds_read_b64_tr_b16 v[70:71], v16 offset:17408
  s_add_u32 m0, s53, 99328
  v_mfma_f32_16x16x32_bf16 a[40:43], v[84:87], v[52:55], a[40:43]
  buffer_load_dwordx4 v7, s[12:15], s21 offen  lds
  ds_read_b128 v[40:43], v10 offset:6144
  v_mfma_f32_16x16x32_bf16 a[44:47], v[88:91], v[52:55], a[44:47]
  ds_read_b64_tr_b16 v[72:73], v17 offset:16384
  v_mfma_f32_16x16x32_bf16 a[48:51], v[76:79], v[56:59], a[48:51]
  ds_read_b64_tr_b16 v[74:75], v17 offset:17408
  s_add_u32 m0, s52, 100352
  v_mfma_f32_16x16x32_bf16 a[52:55], v[80:83], v[56:59], a[52:55]
  buffer_load_dwordx4 v4, s[8:11], s20 offen  lds
  v_mfma_f32_16x16x32_bf16 a[56:59], v[84:87], v[56:59], a[56:59]
  v_mfma_f32_16x16x32_bf16 a[60:63], v[88:91], v[56:59], a[60:63]
L_g4_loop:
  s_sub_u32 s25, s25, 1
  s_cmp_eq_u32 s25, 0
  s_cbranch_scc1 L_g4_fin
  s_waitcnt lgkmcnt(0)
  s_add_u32 m0, s53, 100352
  v_mfma_f32_16x16x32_bf16 a[0:3], v[60:63], v[28:31], a[0:3]
  buffer_load_dwordx4 v8, s[12:15], s21 offen  lds
  ds_read_b128 v[44:47], v11 offset:0
  v_mfma_f32_16x16x32_bf16 a[4:7], v[64:67], v[28:31], a[4:7]
  ds_read_b64_tr_b16 v[76:77], v14 offset:24576
  v_mfma_f32_16x16x32_bf16 a[8:11], v[68:71], v[28:31], a[8:11]
  ds_read_b64_tr_b16 v[78:79], v14 offset:25600
  v_mfma_f32_16x16x32_bf16 a[12:15], v[72:75], v[28:31], a[12:15]
  ds_read_b128 v[48:51], v11 offset:2048
  s_add_u32 m0, s52, 101376
  v_mfma_f32_16x16x32_bf16 a[16:19], v[60:63], v[32:35], a[16:19]
  buffer_load_dwordx4 v5, s[8:11], s20 offen  lds
  ds_read_b64_tr_b16 v[80:81], v15 offset:24576
  v_mfma_f32_16x16x32_bf16 a[20:23], v[64:67], v[32:35], a[20:23]
  ds_read_b64_tr_b16 v[82:83], v15 offset:25600
  v_mfma_f32_16x16x32_bf16 a[24:27], v[68:71], v[32:35], a[24:27]
  ds_read_b128 v[52:55], v11 offset:4096
  v_mfma_f32_16x16x32_bf16 a[28:31], v[72:75], v[32:35], a[28:31]
  ds_read_b64_tr_b16 v[84:85], v16 offset:24576
  s_add_u32 m0, s53, 101376
  v_mfma_f32_16x16x32_bf16 a[32:35], v[60:63], v[36:39], a[32:35]
  buffer_load_dwordx4 v9, s[12:15], s21 offen  lds
  ds_read_b64_tr_b16 v[86:87], v16 offset:25600
  v_mfma_f32_16x16x32_bf16 a[36:39], v[64:67], v[36:39], a[36:39]
  ds_read_b128 v[56:59], v11 offset:6144
  v_mfma_f32_16x16x32_bf16 a[40:43], v[68:71], v[36:39], a[40:43]
  ds_read_b64_tr_b16 v[88:89], v17 offset:24576
  v_mfma_f32_16x16x32_bf16 a[44:47], v[72:75], v[36:39], a[44:47]
  ds_read_b64_tr_b16 v[90:91], v17 offset:25600
  s_add_u32 s20, s20, 128
  v_mfma_f32_16x16x32_bf16 a[48:51], v[60:63], v[40:43], a[48:51]
  s_add_u32 s21, s21, s51
  v_mfma_f32_16x16x32_bf16 a[52:55], v[64:67], v[40:43], a[52:55]
  v_mfma_f32_16x16x32_bf16 a[56:59], v[68:71], v[40:43], a[56:59]
  v_mfma_f32_16x16x32_bf16 a[60:63], v[72:75], v[40:43], a[60:63]
  s_waitcnt lgkmcnt(0)
  v_mfma_f32_16x16x32_bf16 a[0:3], v[76:79], v[44:47], a[0:3]
  s_waitcnt vmcnt(16)
  s_barrier
  s_add_u32 m0, s52, 0
  v_mfma_f32_16x16x32_bf16 a[4:7], v[80:83], v[44:47], a[4:7]
  buffer_load_dwordx4 v2, s[8:11], s20 offen  lds
  ds_read_b128 v[28:31], v10 offset:32768
  v_mfma_f32_16x16x32_bf16 a[8:11], v[84:87], v[44:47], a[8:11]
  ds_read_b64_tr_b16 v[60:61], v14 offset:49152
  v_mfma_f32_16x16x32_bf16 a[12:15], v[88:91], v[44:47], a[12:15]
  ds_read_b64_tr_b16 v[62:63], v14 offset:50176
  s_add_u32 m0, s53, 0
  v_mfma_f32_16x16x32_bf16 a[16:19], v[76:79], v[48:51], a[16:19]
  buffer_load_dwordx4 v6, s[12:15], s21 offen  lds
  ds_read_b128 v[32:35], v10 offset:34816
  v_mfma_f32_16x16x32_bf16 a[20:23], v[80:83], v[48:51], a[20:23]
  ds_read_b64_tr_b16 v[64:65], v15 offset:49152
  v_mfma_f32_16x16x32_bf16 a[24:27], v[84:87], v[48:51], a[24:27]
  ds_read_b64_tr_b16 v[66:67], v15 offset:50176
  s_add_u32 m0, s52, 1024
  v_mfma_f32_16x16x32_bf16 a[28:31], v[88:91], v[48:51], a[28:31]
  buffer_load_dwordx4 v3, s[8:11], s20 offen  lds
  ds_read_b128 v[36:39], v10 offset:36864
  v_mfma_f32_16x16x32_bf16 a[32:35], v[76:79], v[52:55], a[32:35]
  ds_read_b64_tr_b16 v[68:69], v16 offset:49152
  v_mfma_f32_16x16x32_bf16 a[36:39], v[80:83], v[52:55], a[36:39]
  ds_read_b64_tr_b16 v[70:71], v16 offset:50176
  s_add_u32 m0, s53, 1024
  v_mfma_f32_16x16x32_bf16 a[40:43], v[84:87], v[52:55], a[40:43]
  buffer_load_dwordx4 v7, s[12:15], s21 offen  lds
  ds_read_b128 v[40:43], v10 offset:38912
  v_mfma_f32_16x16x32_bf16 a[44:47], v[88:91], v[52:55], a[44:47]
  ds_read_b64_tr_b16 v[72:73], v17 offset:49152
  v_mfma_f32_16x16x32_bf16 a[48:51], v[76:79], v[56:59], a[48:51]
  ds_read_b64_tr_b16 v[74:75], v17 offset:50176
  s_add_u32 m0, s52, 2048
  v_mfma_f32_16x16x32_bf16 a[52:55], v[80:83], v[56:59], a[52:55]
  buffer_load_dwordx4 v4, s[8:11], s20 offen  lds
  v_mfma_f32_16x16x32_bf16 a[56:59], v[84:87], v[56:59], a[56:59]
  v_mfma_f32_16x16x32_bf16 a[60:63], v[88:91], v[56:59], a[60:63]
  s_waitcnt lgkmcnt(0)
  s_add_u32 m0, s53, 2048
  v_mfma_f32_16x16x32_bf16 a[0:3], v[60:63], v[28:31], a[0:3]
  buffer_load_dwordx4 v8, s[12:15], s21 offen  lds
  ds_read_b128 v[44:47], v11 offset:32768
  v_mfma_f32_16x16x32_bf16 a[4:7], v[64:67], v[28:31], a[4:7]
  ds_read_b64_tr_b16 v[76:77], v14 offset:57344
  v_mfma_f32_16x16x32_bf16 a[8:11], v[68:71], v[28:31], a[8:11]
  ds_read_b64_tr_b16 v[78:79], v14 offset:58368
  v_mfma_f32_16x16x32_bf16 a[12:15], v[72:75], v[28:31], a[12:15]
  ds_read_b128 v[48:51], v11 offset:34816
  s_add_u32 m0, s52, 3072
  v_mfma_f32_16x16x32_bf16 a[16:19], v[60:63], v[32:35], a[16:19]
  buffer_load_dwordx4 v5, s[8:11], s20 offen  lds
  ds_read_b64_tr_b16 v[80:81], v15 offset:57344
  v_mfma_f32_16x16x32_bf16 a[20:23], v[64:67], v[32:35], a[20:23]
  ds_read_b64_tr_b16 v[82:83], v15 offset:58368
  v_mfma_f32_16x16x32_bf16 a[24:27], v[68:71], v[32:35], a[24:27]
  ds_read_b128 v[52:55], v11 offset:36864
  v_mfma_f32_16x16x32_bf16 a[28:31], v[72:75], v[32:35], a[28:31]
  ds_read_b64_tr_b16 v[84:85], v16 offset:57344
  s_add_u32 m0, s53, 3072
  v_mfma_f32_16x16x32_bf16 a[32:35], v[60:63], v[36:39], a[32:35]
  buffer_load_dwordx4 v9, s[12:15], s21 offen  lds
  ds_read_b64_tr_b16 v[86:87], v16 offset:58368
  v_mfma_f32_16x16x32_bf16 a[36:39], v[64:67], v[36:39], a[36:39]
  ds_read_b128 v[56:59], v11 offset:38912
  v_mfma_f32_16x16x32_bf16 a[40:43], v[68:71], v[36:39], a[40:43]
  ds_read_b64_tr_b16 v[88:89], v17 offset:57344
  v_mfma_f32_16x16x32_bf16 a[44:47], v[72:75], v[36:39], a[44:47]
  ds_read_b64_tr_b16 v[90:91], v17 offset:58368
  s_add_u32 s20, s20, 128
  v_mfma_f32_16x16x32_bf16 a[48:51], v[60:63], v[40:43], a[48:51]
  s_add_u32 s21, s21, s51
  v_mfma_f32_16x16x32_bf16 a[52:55], v[64:67], v[40:43], a[52:55]
  v_mfma_f32_16x16x32_bf16 a[56:59], v[68:71], v[40:43], a[56:59]
  v_mfma_f32_16x16x32_bf16 a[60:63], v[72:75], v[40:43], a[60:63]
  s_waitcnt lgkmcnt(0)
  v_mfma_f32_16x16x32_bf16 a[0:3], v[76:79], v[44:47], a[0:3]
  s_waitcnt vmcnt(16)
  s_barrier
  s_add_u32 m0, s52, 32768
  v_mfma_f32_16x16x32_bf16 a[4:7], v[80:83], v[44:47], a[4:7]
  buffer_load_dwordx4 v2, s[8:11], s20 offen  lds
  ds_read_b128 v[28:31], v12 offset:0
  v_mfma_f32_16x16x32_bf16 a[8:11], v[84:87], v[44:47], a[8:11]
  ds_read_b64_tr_b16 v[60:61], v18 offset:16384
  v_mfma_f32_16x16x32_bf16 a[12:15], v[88:91], v[44:47], a[12:15]
  ds_read_b64_tr_b16 v[62:63], v18 offset:17408
  s_add_u32 m0, s53, 32768
  v_mfma_f32_16x16x32_bf16 a[16:19], v[76:79], v[48:51], a[16:19]
  buffer_load_dwordx4 v6, s[12:15], s21 offen  lds
  ds_read_b128 v[32:35], v12 offset:2048
  v_mfma_f32_16x16x32_bf16 a[20:23], v[80:83], v[48:51], a[20:23]
  ds_read_b64_tr_b16 v[64:65], v19 offset:16384
  v_mfma_f32_16x16x32_bf16 a[24:27], v[84:87], v[48:51], a[24:27]
  ds_read_b64_tr_b16 v[66:67], v19 offset:17408
  s_add_u32 m0, s52, 33792
  v_mfma_f32_16x16x32_bf16 a[28:31], v[88:91], v[48:51], a[28:31]
  buffer_load_dwordx4 v3, s[8:11], s20 offen  lds
  ds_read_b128 v[36:39], v12 offset:4096
  v_mfma_f32_16x16x32_bf16 a[32:35], v[76:79], v[52:55], a[32:35]
  ds_read_b64_tr_b16 v[68:69], v20 offset:16384
  v_mfma_f32_16x16x32_bf16 a[36:39], v[80:83], v[52:55], a[36:39]
  ds_read_b64_tr_b16 v[70:71], v20 offset:17408
  s_add_u32 m0, s53, 33792
  v_mfma_f32_16x16x32_bf16 a[40:43], v[84:87], v[52:55], a[40:43]
  buffer_load_dwordx4 v7, s[12:15], s21 offen  lds
  ds_read_b128 v[40:43], v12 offset:6144
  v_mfma_f32_16x16x32_bf16 a[44:47], v[88:91], v[52:55], a[44:47]
  ds_read_b64_tr_b16 v[72:73], v21 offset:16384
  v_mfma_f32_16x16x32_bf16 a[48:51], v[76:79], v[56:59], a[48:51]
  ds_read_b64_tr_b16 v[74:75], v21 offset:17408
  s_add_u32 m0, s52, 34816
  v_mfma_f32_16x16x32_bf16 a[52:55], v[80:83], v[56:59], a[52:55]
  buffer_load_dwordx4 v4, s[8:11], s20 offen  lds
  v_mfma_f32_16x16x32_bf16 a[56:59], v[84:87], v[56:59], a[56:59]
  v_mfma_f32_16x16x32_bf16 a[60:63], v[88:91], v[56:59], a[60:63]
  s_waitcnt lgkmcnt(0)
  s_add_u32 m0, s53, 34816
  v_mfma_f32_16x16x32_bf16 a[0:3], v[60:63], v[28:31], a[0:3]
  buffer_load_dwordx4 v8, s[12:15], s21 offen  lds
  ds_read_b128 v[44:47], v13 offset:0
  v_mfma_f32_16x16x32_bf16 a[4:7], v[64:67], v[28:31], a[4:7]
  ds_read_b64_tr_b16 v[76:77], v18 offset:24576
  v_mfma_f32_16x16x32_bf16 a[8:11], v[68:71], v[28:31], a[8:11]
  ds_read_b64_tr_b16 v[78:79], v18 offset:25600
  v_mfma_f32_16x16x32_bf16 a[12:15], v[72:75], v[28:31], a[12:15]
  ds_read_b128 v[48:51], v13 offset:2048
  s_add_u32 m0, s52, 35840
  v_mfma_f32_16x16x32_bf16 a[16:19], v[60:63], v[32:35], a[16:19]
  buffer_load_dwordx4 v5, s[8:11], s20 offen  lds
  ds_read_b64_tr_b16 v[80:81], v19 offset:24576
  v_mfma_f32_16x16x32_bf16 a[20:23], v[64:67], v[32:35], a[20:23]
  ds_read_b64_tr_b16 v[82:83], v19 offset:25600
  v_mfma_f32_16x16x32_bf16 a[24:27], v[68:71], v[32:35], a[24:27]
  ds_read_b128 v[52:55], v13 offset:4096
  v_mfma_f32_16x16x32_bf16 a[28:31], v[72:75], v[32:35], a[28:31]
  ds_read_b64_tr_b16 v[84:85], v20 offset:24576
  s_add_u32 m0, s53, 35840
  v_mfma_f32_16x16x32_bf16 a[32:35], v[60:63], v[36:39], a[32:35]
  buffer_load_dwordx4 v9, s[12:15], s21 offen  lds
  ds_read_b64_tr_b16 v[86:87], v20 offset:25600
  v_mfma_f32_16x16x32_bf16 a[36:39], v[64:67], v[36:39], a[36:39]
  ds_read_b128 v[56:59], v13 offset:6144
  v_mfma_f32_16x16x32_bf16 a[40:43], v[68:71], v[36:39], a[40:43]
  ds_read_b64_tr_b16 v[88:89], v21 offset:24576
  v_mfma_f32_16x16x32_bf16 a[44:47], v[72:75], v[36:39], a[44:47]
  ds_read_b64_tr_b16 v[90:91], v21 offset:25600
  s_add_u32 s20, s20, 128
  v_mfma_f32_16x16x32_bf16 a[48:51], v[60:63], v[40:43], a[48:51]
  s_add_u32 s21, s21, s51
  v_mfma_f32_16x16x32_bf16 a[52:55], v[64:67], v[40:43], a[52:55]
  v_mfma_f32_16x16x32_bf16 a[56:59], v[68:71], v[40:43], a[56:59]
  v_mfma_f32_16x16x32_bf16 a[60:63], v[72:75], v[40:43], a[60:63]
  s_waitcnt lgkmcnt(0)
  v_mfma_f32_16x16x32_bf16 a[0:3], v[76:79], v[44:47], a[0:3]
  s_waitcnt vmcnt(16)
  s_barrier
  s_add_u32 m0, s52, 65536
  v_mfma_f32_16x16x32_bf16 a[4:7], v[80:83], v[44:47], a[4:7]
  buffer_load_dwordx4 v2, s[8:11], s20 offen  lds
  ds_read_b128 v[28:31], v12 offset:32768
  v_mfma_f32_16x16x32_bf16 a[8:11], v[84:87], v[44:47], a[8:11]
  ds_read_b64_tr_b16 v[60:61], v18 offset:49152
  v_mfma_f32_16x16x32_bf16 a[12:15], v[88:91], v[44:47], a[12:15]
  ds_read_b64_tr_b16 v[62:63], v18 offset:50176
  s_add_u32 m0, s53, 65536
  v_mfma_f32_16x16x32_bf16 a[16:19], v[76:79], v[48:51], a[16:19]
  buffer_load_dwordx4 v6, s[12:15], s21 offen  lds
  ds_read_b128 v[32:35], v12 offset:34816
  v_mfma_f32_16x16x32_bf16 a[20:23], v[80:83], v[48:51], a[20:23]
  ds_read_b64_tr_b16 v[64:65], v19 offset:49152
  v_mfma_f32_16x16x32_bf16 a[24:27], v[84:87], v[48:51], a[24:27]
  ds_read_b64_tr_b16 v[66:67], v19 offset:50176
  s_add_u32 m0, s52, 66560
  v_mfma_f32_16x16x32_bf16 a[28:31], v[88:91], v[48:51], a[28:31]
  buffer_load_dwordx4 v3, s[8:11], s20 offen  lds
  ds_read_b128 v[36:39], v12 offset:36864
  v_mfma_f32_16x16x32_bf16 a[32:35], v[76:79], v[52:55], a[32:35]
  ds_read_b64_tr_b16 v[68:69], v20 offset:49152
  v_mfma_f32_16x16x32_bf16 a[36:39], v[80:83], v[52:55], a[36:39]
  ds_read_b64_tr_b16 v[70:71], v20 offset:50176
  s_add_u32 m0, s53, 66560
  v_mfma_f32_16x16x32_bf16 a[40:43], v[84:87], v[52:55], a[40:43]
  buffer_load_dwordx4 v7, s[12:15], s21 offen  lds
  ds_read_b128 v[40:43], v12 offset:38912
  v_mfma_f32_16x16x32_bf16 a[44:47], v[88:91], v[52:55], a[44:47]
  ds_read_b64_tr_b16 v[72:73], v21 offset:49152
  v_mfma_f32_16x16x32_bf16 a[48:51], v[76:79], v[56:59], a[48:51]
  ds_read_b64_tr_b16 v[74:75], v21 offset:50176
  s_add_u32 m0, s52, 67584
  v_mfma_f32_16x16x32_bf16 a[52:55], v[80:83], v[56:59], a[52:55]
  buffer_load_dwordx4 v4, s[8:11], s20 offen  lds
  v_mfma_f32_16x16x32_bf16 a[56:59], v[84:87], v[56:59], a[56:59]
  v_mfma_f32_16x16x32_bf16 a[60:63], v[88:91], v[56:59], a[60:63]
  s_waitcnt lgkmcnt(0)
  s_add_u32 m0, s53, 67584
  v_mfma_f32_16x16x32_bf16 a[0:3], v[60:63], v[28:31], a[0:3]
  buffer_load_dwordx4 v8, s[12:15], s21 offen  lds
  ds_read_b128 v[44:47], v13 offset:32768
  v_mfma_f32_16x16x32_bf16 a[4:7], v[64:67], v[28:31], a[4:7]
  ds_read_b64_tr_b16 v[76:77], v18 offset:57344
  v_mfma_f32_16x16x32_bf16 a[8:11], v[68:71], v[28:31], a[8:11]
  ds_read_b64_tr_b16 v[78:79], v18 offset:58368
  v_mfma_f32_16x16x32_bf16 a[12:15], v[72:75], v[28:31], a[12:15]
  ds_read_b128 v[48:51], v13 offset:34816
  s_add_u32 m0, s52, 68608
  v_mfma_f32_16x16x32_bf16 a[16:19], v[60:63], v[32:35], a[16:19]
  buffer_load_dwordx4 v5, s[8:11], s20 offen  lds
  ds_read_b64_tr_b16 v[80:81], v19 offset:57344
  v_mfma_f32_16x16x32_bf16 a[20:23], v[64:67], v[32:35], a[20:23]
  ds_read_b64_tr_b16 v[82:83], v19 offset:58368
  v_mfma_f32_16x16x32_bf16 a[24:27], v[68:71], v[32:35], a[24:27]
  ds_read_b128 v[52:55], v13 offset:36864
  v_mfma_f32_16x16x32_bf16 a[28:31], v[72:75], v[32:35], a[28:31]
  ds_read_b64_tr_b16 v[84:85], v20 offset:57344
  s_add_u32 m0, s53, 68608
  v_mfma_f32_16x16x32_bf16 a[32:35], v[60:63], v[36:39], a[32:35]
  buffer_load_dwordx4 v9, s[12:15], s21 offen  lds
  ds_read_b64_tr_b16 v[86:87], v20 offset:58368
  v_mfma_f32_16x16x32_bf16 a[36:39], v[64:67], v[36:39], a[36:39]
  ds_read_b128 v[56:59], v13 offset:38912
  v_mfma_f32_16x16x32_bf16 a[40:43], v[68:71], v[36:39], a[40:43]
  ds_read_b64_tr_b16 v[88:89], v21 offset:57344
  v_mfma_f32_16x16x32_bf16 a[44:47], v[72:75], v[36:39], a[44:47]
  ds_read_b64_tr_b16 v[90:91], v21 offset:58368
  s_add_u32 s20, s20, 128
  v_mfma_f32_16x16x32_bf16 a[48:51], v[60:63], v[40:43], a[48:51]
  s_add_u32 s21, s21, s51
  v_mfma_f32_16x16x32_bf16 a[52:55], v[64:67], v[40:43], a[52:55]
  v_mfma_f32_16x16x32_bf16 a[56:59], v[68:71], v[40:43], a[56:59]
  v_mfma_f32_16x16x32_bf16 a[60:63], v[72:75], v[40:43], a[60:63]
  s_waitcnt lgkmcnt(0)
  v_mfma_f32_16x16x32_bf16 a[0:3], v[76:79], v[44:47], a[0:3]
  s_waitcnt vmcnt(16)
  s_barrier
  s_add_u32 m0, s52, 98304
  v_mfma_f32_16x16x32_bf16 a[4:7], v[80:83], v[44:47], a[4:7]
  buffer_load_dwordx4 v2, s[8:11], s20 offen  lds
  ds_read_b128 v[28:31], v10 offset:0
  v_mfma_f32_16x16x32_bf16 a[8:11], v[84:87], v[44:47], a[8:11]
  ds_read_b64_tr_b16 v[60:61], v14 offset:16384
  v_mfma_f32_16x16x32_bf16 a[12:15], v[88:91], v[44:47], a[12:15]
  ds_read_b64_tr_b16 v[62:63], v14 offset:17408
  s_add_u32 m0, s53, 98304
  v_mfma_f32_16x16x32_bf16 a[16:19], v[76:79], v[48:51], a[16:19]
  buffer_load_dwordx4 v6, s[12:15], s21 offen  lds
  ds_read_b128 v[32:35], v10 offset:2048
  v_mfma_f32_16x16x32_bf16 a[20:23], v[80:83], v[48:51], a[20:23]
  ds_read_b64_tr_b16 v[64:65], v15 offset:16384
  v_mfma_f32_16x16x32_bf16 a[24:27], v[84:87], v[48:51], a[24:27]
  ds_read_b64_tr_b16 v[66:67], v15 offset:17408
  s_add_u32 m0, s52, 99328
  v_mfma_f32_16x16x32_bf16 a[28:31], v[88:91], v[48:51], a[28:31]
  buffer_load_dwordx4 v3, s[8:11], s20 offen  lds
  ds_read_b128 v[36:39], v10 offset:4096
  v_mfma_f32_16x16x32_bf16 a[32:35], v[76:79], v[52:55], a[32:35]
  ds_read_b64_tr_b16 v[68:69], v16 offset:16384
  v_mfma_f32_16x16x32_bf16 a[36:39], v[80:83], v[52:55], a[36:39]
  ds_read_b64_tr_b16 v[70:71], v16 offset:17408
  s_add_u32 m0, s53, 99328
  v_mfma_f32_16x16x32_bf16 a[40:43], v[84:87], v[52:55], a[40:43]
  buffer_load_dwordx4 v7, s[12:15], s21 offen  lds
  ds_read_b128 v[40:43], v10 offset:6144
  v_mfma_f32_16x16x32_bf16 a[44:47], v[88:91], v[52:55], a[44:47]
  ds_read_b64_tr_b16 v[72:73], v17 offset:16384
  v_mfma_f32_16x16x32_bf16 a[48:51], v[76:79], v[56:59], a[48:51]
  ds_read_b64_tr_b16 v[74:75], v17 offset:17408
  s_add_u32 m0, s52, 100352
  v_mfma_f32_16x16x32_bf16 a[52:55], v[80:83], v[56:59], a[52:55]
  buffer_load_dwordx4 v4, s[8:11], s20 offen  lds
  v_mfma_f32_16x16x32_bf16 a[56:59], v[84:87], v[56:59], a[56:59]
  v_mfma_f32_16x16x32_bf16 a[60:63], v[88:91], v[56:59], a[60:63]
  s_branch L_g4_loop
L_g4_fin:
  s_cmp_lg_u32 s32, 0
  s_cbranch_scc1 L_rq_12
  s_cmp_eq_u32 s39, 0
  s_cbranch_scc1 L_rq_12
  s_lshl_b32 s99, s33, 7
  s_add_u32 s99, s99, 0x3d00200
  v_mov_b32 v244, 1
  v_mov_b32 v245, 0
  s_mov_b64 exec, 1
  buffer_atomic_add v244, v245, s[4:7], s99 offen sc0 sc1
  s_mov_b64 exec, -1
L_rq_12:
  s_waitcnt lgkmcnt(0)
  s_add_u32 m0, s53, 100352
  v_mfma_f32_16x16x32_bf16 a[0:3], v[60:63], v[28:31], a[0:3]
  buffer_load_dwordx4 v8, s[12:15], s21 offen  lds
  ds_read_b128 v[44:47], v11 offset:0
  v_mfma_f32_16x16x32_bf16 a[4:7], v[64:67], v[28:31], a[4:7]
  ds_read_b64_tr_b16 v[76:77], v14 offset:24576
  v_mfma_f32_16x16x32_bf16 a[8:11], v[68:71], v[28:31], a[8:11]
  ds_read_b64_tr_b16 v[78:79], v14 offset:25600
  v_mfma_f32_16x16x32_bf16 a[12:15], v[72:75], v[28:31], a[12:15]
  ds_read_b128 v[48:51], v11 offset:2048
  s_add_u32 m0, s52, 101376
  v_mfma_f32_16x16x32_bf16 a[16:19], v[60:63], v[32:35], a[16:19]
  buffer_load_dwordx4 v5, s[8:11], s20 offen  lds
  ds_read_b64_tr_b16 v[80:81], v15 offset:24576
  v_mfma_f32_16x16x32_bf16 a[20:23], v[64:67], v[32:35], a[20:23]
  ds_read_b64_tr_b16 v[82:83], v15 offset:25600
  v_mfma_f32_16x16x32_bf16 a[24:27], v[68:71], v[32:35], a[24:27]
  ds_read_b128 v[52:55], v11 offset:4096
  v_mfma_f32_16x16x32_bf16 a[28:31], v[72:75], v[32:35], a[28:31]
  ds_read_b64_tr_b16 v[84:85], v16 offset:24576
  s_add_u32 m0, s53, 101376
  v_mfma_f32_16x16x32_bf16 a[32:35], v[60:63], v[36:39], a[32:35]
  buffer_load_dwordx4 v9, s[12:15], s21 offen  lds
  ds_read_b64_tr_b16 v[86:87], v16 offset:25600
  v_mfma_f32_16x16x32_bf16 a[36:39], v[64:67], v[36:39], a[36:39]
  ds_read_b128 v[56:59], v11 offset:6144
  v_mfma_f32_16x16x32_bf16 a[40:43], v[68:71], v[36:39], a[40:43]
  ds_read_b64_tr_b16 v[88:89], v17 offset:24576
  v_mfma_f32_16x16x32_bf16 a[44:47], v[72:75], v[36:39], a[44:47]
  ds_read_b64_tr_b16 v[90:91], v17 offset:25600
  s_add_u32 s20, s20, 128
  v_mfma_f32_16x16x32_bf16 a[48:51], v[60:63], v[40:43], a[48:51]
  s_add_u32 s21, s21, s51
  v_mfma_f32_16x16x32_bf16 a[52:55], v[64:67], v[40:43], a[52:55]
  v_mfma_f32_16x16x32_bf16 a[56:59], v[68:71], v[40:43], a[56:59]
  v_mfma_f32_16x16x32_bf16 a[60:63], v[72:75], v[40:43], a[60:63]
  s_waitcnt lgkmcnt(0)
  v_mfma_f32_16x16x32_bf16 a[0:3], v[76:79], v[44:47], a[0:3]
  s_waitcnt vmcnt(16)
  s_barrier
  v_mfma_f32_16x16x32_bf16 a[4:7], v[80:83], v[44:47], a[4:7]
  ds_read_b128 v[28:31], v10 offset:32768
  v_mfma_f32_16x16x32_bf16 a[8:11], v[84:87], v[44:47], a[8:11]
  ds_read_b64_tr_b16 v[60:61], v14 offset:49152
  v_mfma_f32_16x16x32_bf16 a[12:15], v[88:91], v[44:47], a[12:15]
  ds_read_b64_tr_b16 v[62:63], v14 offset:50176
  v_mfma_f32_16x16x32_bf16 a[16:19], v[76:79], v[48:51], a[16:19]
  ds_read_b128 v[32:35], v10 offset:34816
  v_mfma_f32_16x16x32_bf16 a[20:23], v[80:83], v[48:51], a[20:23]
  ds_read_b64_tr_b16 v[64:65], v15 offset:49152
  v_mfma_f32_16x16x32_bf16 a[24:27], v[84:87], v[48:51], a[24:27]
  ds_read_b64_tr_b16 v[66:67], v15 offset:50176
  v_mfma_f32_16x16x32_bf16 a[28:31], v[88:91], v[48:51], a[28:31]
  ds_read_b128 v[36:39], v10 offset:36864
  v_mfma_f32_16x16x32_bf16 a[32:35], v[76:79], v[52:55], a[32:35]
  ds_read_b64_tr_b16 v[68:69], v16 offset:49152
  v_mfma_f32_16x16x32_bf16 a[36:39], v[80:83], v[52:55], a[36:39]
  ds_read_b64_tr_b16 v[70:71], v16 offset:50176
  v_mfma_f32_16x16x32_bf16 a[40:43], v[84:87], v[52:55], a[40:43]
  ds_read_b128 v[40:43], v10 offset:38912
  v_mfma_f32_16x16x32_bf16 a[44:47], v[88:91], v[52:55], a[44:47]
  ds_read_b64_tr_b16 v[72:73], v17 offset:49152
  v_mfma_f32_16x16x32_bf16 a[48:51], v[76:79], v[56:59], a[48:51]
  ds_read_b64_tr_b16 v[74:75], v17 offset:50176
  v_mfma_f32_16x16x32_bf16 a[52:55], v[80:83], v[56:59], a[52:55]
  v_mfma_f32_16x16x32_bf16 a[56:59], v[84:87], v[56:59], a[56:59]
  v_mfma_f32_16x16x32_bf16 a[60:63], v[88:91], v[56:59], a[60:63]
  s_waitcnt lgkmcnt(0)
  v_mfma_f32_16x16x32_bf16 a[0:3], v[60:63], v[28:31], a[0:3]
  ds_read_b128 v[44:47], v11 offset:32768
  v_mfma_f32_16x16x32_bf16 a[4:7], v[64:67], v[28:31], a[4:7]
  ds_read_b64_tr_b16 v[76:77], v14 offset:57344
  v_mfma_f32_16x16x32_bf16 a[8:11], v[68:71], v[28:31], a[8:11]
  ds_read_b64_tr_b16 v[78:79], v14 offset:58368
  v_mfma_f32_16x16x32_bf16 a[12:15], v[72:75], v[28:31], a[12:15]
  ds_read_b128 v[48:51], v11 offset:34816
  v_mfma_f32_16x16x32_bf16 a[16:19], v[60:63], v[32:35], a[16:19]
  ds_read_b64_tr_b16 v[80:81], v15 offset:57344
  v_mfma_f32_16x16x32_bf16 a[20:23], v[64:67], v[32:35], a[20:23]
  ds_read_b64_tr_b16 v[82:83], v15 offset:58368
  v_mfma_f32_16x16x32_bf16 a[24:27], v[68:71], v[32:35], a[24:27]
  ds_read_b128 v[52:55], v11 offset:36864
  v_mfma_f32_16x16x32_bf16 a[28:31], v[72:75], v[32:35], a[28:31]
  ds_read_b64_tr_b16 v[84:85], v16 offset:57344
  v_mfma_f32_16x16x32_bf16 a[32:35], v[60:63], v[36:39], a[32:35]
  ds_read_b64_tr_b16 v[86:87], v16 offset:58368
  v_mfma_f32_16x16x32_bf16 a[36:39], v[64:67], v[36:39], a[36:39]
  ds_read_b128 v[56:59], v11 offset:38912
  v_mfma_f32_16x16x32_bf16 a[40:43], v[68:71], v[36:39], a[40:43]
  ds_read_b64_tr_b16 v[88:89], v17 offset:57344
  v_mfma_f32_16x16x32_bf16 a[44:47], v[72:75], v[36:39], a[44:47]
  ds_read_b64_tr_b16 v[90:91], v17 offset:58368
  v_mfma_f32_16x16x32_bf16 a[48:51], v[60:63], v[40:43], a[48:51]
  v_mfma_f32_16x16x32_bf16 a[52:55], v[64:67], v[40:43], a[52:55]
  v_mfma_f32_16x16x32_bf16 a[56:59], v[68:71], v[40:43], a[56:59]
  v_mfma_f32_16x16x32_bf16 a[60:63], v[72:75], v[40:43], a[60:63]
  s_waitcnt lgkmcnt(0)
  v_mfma_f32_16x16x32_bf16 a[0:3], v[76:79], v[44:47], a[0:3]
  s_waitcnt vmcnt(8)
  s_barrier
  v_mfma_f32_16x16x32_bf16 a[4:7], v[80:83], v[44:47], a[4:7]
  ds_read_b128 v[28:31], v12 offset:0
  v_mfma_f32_16x16x32_bf16 a[8:11], v[84:87], v[44:47], a[8:11]
  ds_read_b64_tr_b16 v[60:61], v18 offset:16384
  v_mfma_f32_16x16x32_bf16 a[12:15], v[88:91], v[44:47], a[12:15]
  ds_read_b64_tr_b16 v[62:63], v18 offset:17408
  v_mfma_f32_16x16x32_bf16 a[16:19], v[76:79], v[48:51], a[16:19]
  ds_read_b128 v[32:35], v12 offset:2048
  v_mfma_f32_16x16x32_bf16 a[20:23], v[80:83], v[48:51], a[20:23]
  ds_read_b64_tr_b16 v[64:65], v19 offset:16384
  v_mfma_f32_16x16x32_bf16 a[24:27], v[84:87], v[48:51], a[24:27]
  ds_read_b64_tr_b16 v[66:67], v19 offset:17408
  v_mfma_f32_16x16x32_bf16 a[28:31], v[88:91], v[48:51], a[28:31]
  ds_read_b128 v[36:39], v12 offset:4096
  v_mfma_f32_16x16x32_bf16 a[32:35], v[76:79], v[52:55], a[32:35]
  ds_read_b64_tr_b16 v[68:69], v20 offset:16384
  v_mfma_f32_16x16x32_bf16 a[36:39], v[80:83], v[52:55], a[36:39]
  ds_read_b64_tr_b16 v[70:71], v20 offset:17408
  v_mfma_f32_16x16x32_bf16 a[40:43], v[84:87], v[52:55], a[40:43]
  ds_read_b128 v[40:43], v12 offset:6144
  v_mfma_f32_16x16x32_bf16 a[44:47], v[88:91], v[52:55], a[44:47]
  ds_read_b64_tr_b16 v[72:73], v21 offset:16384
  v_mfma_f32_16x16x32_bf16 a[48:51], v[76:79], v[56:59], a[48:51]
  ds_read_b64_tr_b16 v[74:75], v21 offset:17408
  v_mfma_f32_16x16x32_bf16 a[52:55], v[80:83], v[56:59], a[52:55]
  v_mfma_f32_16x16x32_bf16 a[56:59], v[84:87], v[56:59], a[56:59]
  v_mfma_f32_16x16x32_bf16 a[60:63], v[88:91], v[56:59], a[60:63]
  s_waitcnt lgkmcnt(0)
  v_mfma_f32_16x16x32_bf16 a[0:3], v[60:63], v[28:31], a[0:3]
  ds_read_b128 v[44:47], v13 offset:0
  v_mfma_f32_16x16x32_bf16 a[4:7], v[64:67], v[28:31], a[4:7]
  ds_read_b64_tr_b16 v[76:77], v18 offset:24576
  v_mfma_f32_16x16x32_bf16 a[8:11], v[68:71], v[28:31], a[8:11]
  ds_read_b64_tr_b16 v[78:79], v18 offset:25600
  v_mfma_f32_16x16x32_bf16 a[12:15], v[72:75], v[28:31], a[12:15]
  ds_read_b128 v[48:51], v13 offset:2048
  v_mfma_f32_16x16x32_bf16 a[16:19], v[60:63], v[32:35], a[16:19]
  ds_read_b64_tr_b16 v[80:81], v19 offset:24576
  v_mfma_f32_16x16x32_bf16 a[20:23], v[64:67], v[32:35], a[20:23]
  ds_read_b64_tr_b16 v[82:83], v19 offset:25600
  v_mfma_f32_16x16x32_bf16 a[24:27], v[68:71], v[32:35], a[24:27]
  ds_read_b128 v[52:55], v13 offset:4096
  v_mfma_f32_16x16x32_bf16 a[28:31], v[72:75], v[32:35], a[28:31]
  ds_read_b64_tr_b16 v[84:85], v20 offset:24576
  v_mfma_f32_16x16x32_bf16 a[32:35], v[60:63], v[36:39], a[32:35]
  ds_read_b64_tr_b16 v[86:87], v20 offset:25600
  v_mfma_f32_16x16x32_bf16 a[36:39], v[64:67], v[36:39], a[36:39]
  ds_read_b128 v[56:59], v13 offset:6144
  v_mfma_f32_16x16x32_bf16 a[40:43], v[68:71], v[36:39], a[40:43]
  ds_read_b64_tr_b16 v[88:89], v21 offset:24576
  v_mfma_f32_16x16x32_bf16 a[44:47], v[72:75], v[36:39], a[44:47]
  ds_read_b64_tr_b16 v[90:91], v21 offset:25600
  v_mfma_f32_16x16x32_bf16 a[48:51], v[60:63], v[40:43], a[48:51]
  v_mfma_f32_16x16x32_bf16 a[52:55], v[64:67], v[40:43], a[52:55]
  v_mfma_f32_16x16x32_bf16 a[56:59], v[68:71], v[40:43], a[56:59]
  v_mfma_f32_16x16x32_bf16 a[60:63], v[72:75], v[40:43], a[60:63]
  s_waitcnt lgkmcnt(0)
  v_mfma_f32_16x16x32_bf16 a[0:3], v[76:79], v[44:47], a[0:3]
  s_waitcnt vmcnt(0)
  s_barrier
  v_mfma_f32_16x16x32_bf16 a[4:7], v[80:83], v[44:47], a[4:7]
  ds_read_b128 v[28:31], v12 offset:32768
  v_mfma_f32_16x16x32_bf16 a[8:11], v[84:87], v[44:47], a[8:11]
  ds_read_b64_tr_b16 v[60:61], v18 offset:49152
  v_mfma_f32_16x16x32_bf16 a[12:15], v[88:91], v[44:47], a[12:15]
  ds_read_b64_tr_b16 v[62:63], v18 offset:50176
  v_mfma_f32_16x16x32_bf16 a[16:19], v[76:79], v[48:51], a[16:19]
  ds_read_b128 v[32:35], v12 offset:34816
  v_mfma_f32_16x16x32_bf16 a[20:23], v[80:83], v[48:51], a[20:23]
  ds_read_b64_tr_b16 v[64:65], v19 offset:49152
  v_mfma_f32_16x16x32_bf16 a[24:27], v[84:87], v[48:51], a[24:27]
  ds_read_b64_tr_b16 v[66:67], v19 offset:50176
  v_mfma_f32_16x16x32_bf16 a[28:31], v[88:91], v[48:51], a[28:31]
  ds_read_b128 v[36:39], v12 offset:36864
  v_mfma_f32_16x16x32_bf16 a[32:35], v[76:79], v[52:55], a[32:35]
  ds_read_b64_tr_b16 v[68:69], v20 offset:49152
  v_mfma_f32_16x16x32_bf16 a[36:39], v[80:83], v[52:55], a[36:39]
  ds_read_b64_tr_b16 v[70:71], v20 offset:50176
  v_mfma_f32_16x16x32_bf16 a[40:43], v[84:87], v[52:55], a[40:43]
  ds_read_b128 v[40:43], v12 offset:38912
  v_mfma_f32_16x16x32_bf16 a[44:47], v[88:91], v[52:55], a[44:47]
  ds_read_b64_tr_b16 v[72:73], v21 offset:49152
  v_mfma_f32_16x16x32_bf16 a[48:51], v[76:79], v[56:59], a[48:51]
  ds_read_b64_tr_b16 v[74:75], v21 offset:50176
  v_mfma_f32_16x16x32_bf16 a[52:55], v[80:83], v[56:59], a[52:55]
  v_mfma_f32_16x16x32_bf16 a[56:59], v[84:87], v[56:59], a[56:59]
  v_mfma_f32_16x16x32_bf16 a[60:63], v[88:91], v[56:59], a[60:63]
  s_waitcnt lgkmcnt(0)
  v_mfma_f32_16x16x32_bf16 a[0:3], v[60:63], v[28:31], a[0:3]
  ds_read_b128 v[44:47], v13 offset:32768
  v_mfma_f32_16x16x32_bf16 a[4:7], v[64:67], v[28:31], a[4:7]
  ds_read_b64_tr_b16 v[76:77], v18 offset:57344
  v_mfma_f32_16x16x32_bf16 a[8:11], v[68:71], v[28:31], a[8:11]
  ds_read_b64_tr_b16 v[78:79], v18 offset:58368
  v_mfma_f32_16x16x32_bf16 a[12:15], v[72:75], v[28:31], a[12:15]
  ds_read_b128 v[48:51], v13 offset:34816
  v_mfma_f32_16x16x32_bf16 a[16:19], v[60:63], v[32:35], a[16:19]
  ds_read_b64_tr_b16 v[80:81], v19 offset:57344
  v_mfma_f32_16x16x32_bf16 a[20:23], v[64:67], v[32:35], a[20:23]
  ds_read_b64_tr_b16 v[82:83], v19 offset:58368
  v_mfma_f32_16x16x32_bf16 a[24:27], v[68:71], v[32:35], a[24:27]
  ds_read_b128 v[52:55], v13 offset:36864
  v_mfma_f32_16x16x32_bf16 a[28:31], v[72:75], v[32:35], a[28:31]
  ds_read_b64_tr_b16 v[84:85], v20 offset:57344
  v_mfma_f32_16x16x32_bf16 a[32:35], v[60:63], v[36:39], a[32:35]
  ds_read_b64_tr_b16 v[86:87], v20 offset:58368
  v_mfma_f32_16x16x32_bf16 a[36:39], v[64:67], v[36:39], a[36:39]
  ds_read_b128 v[56:59], v13 offset:38912
  v_mfma_f32_16x16x32_bf16 a[40:43], v[68:71], v[36:39], a[40:43]
  ds_read_b64_tr_b16 v[88:89], v21 offset:57344
  v_mfma_f32_16x16x32_bf16 a[44:47], v[72:75], v[36:39], a[44:47]
  ds_read_b64_tr_b16 v[90:91], v21 offset:58368
  v_mfma_f32_16x16x32_bf16 a[48:51], v[60:63], v[40:43], a[48:51]
  v_mfma_f32_16x16x32_bf16 a[52:55], v[64:67], v[40:43], a[52:55]
  v_mfma_f32_16x16x32_bf16 a[56:59], v[68:71], v[40:43], a[56:59]
  v_mfma_f32_16x16x32_bf16 a[60:63], v[72:75], v[40:43], a[60:63]
  s_waitcnt lgkmcnt(0)
  v_mfma_f32_16x16x32_bf16 a[0:3], v[76:79], v[44:47], a[0:3]
  v_mfma_f32_16x16x32_bf16 a[4:7], v[80:83], v[44:47], a[4:7]
  v_mfma_f32_16x16x32_bf16 a[8:11], v[84:87], v[44:47], a[8:11]
  v_mfma_f32_16x16x32_bf16 a[12:15], v[88:91], v[44:47], a[12:15]
  v_mfma_f32_16x16x32_bf16 a[16:19], v[76:79], v[48:51], a[16:19]
  v_mfma_f32_16x16x32_bf16 a[20:23], v[80:83], v[48:51], a[20:23]
  v_mfma_f32_16x16x32_bf16 a[24:27], v[84:87], v[48:51], a[24:27]
  v_mfma_f32_16x16x32_bf16 a[28:31], v[88:91], v[48:51], a[28:31]
  v_mfma_f32_16x16x32_bf16 a[32:35], v[76:79], v[52:55], a[32:35]
  v_mfma_f32_16x16x32_bf16 a[36:39], v[80:83], v[52:55], a[36:39]
  v_mfma_f32_16x16x32_bf16 a[40:43], v[84:87], v[52:55], a[40:43]
  v_mfma_f32_16x16x32_bf16 a[44:47], v[88:91], v[52:55], a[44:47]
  v_mfma_f32_16x16x32_bf16 a[48:51], v[76:79], v[56:59], a[48:51]
  v_mfma_f32_16x16x32_bf16 a[52:55], v[80:83], v[56:59], a[52:55]
  v_mfma_f32_16x16x32_bf16 a[56:59], v[84:87], v[56:59], a[56:59]
  v_mfma_f32_16x16x32_bf16 a[60:63], v[88:91], v[56:59], a[60:63]
  s_mov_b32 s59, 3
  s_mov_b32 s60, s22
  s_mov_b32 s61, s26
  s_add_u32 s62, s38, 0x3d00000
  s_mov_b32 s63, s98
  s_cmp_lg_u32 s39, 0
  s_cbranch_scc1 L_got
  s_mov_b32 s58, 3
  s_branch L_epi
L_g5:
  s_waitcnt vmcnt(26)
  s_barrier
  ds_read_b128 v[28:31], v10 offset:0
  ds_read_b64_tr_b16 v[60:61], v14 offset:16384
  ds_read_b64_tr_b16 v[62:63], v14 offset:17408
  ds_read_b128 v[32:35], v10 offset:2048
  ds_read_b64_tr_b16 v[64:65], v15 offset:16384
  ds_read_b64_tr_b16 v[66:67], v15 offset:17408
  ds_read_b128 v[36:39], v10 offset:4096
  ds_read_b64_tr_b16 v[68:69], v16 offset:16384
  ds_read_b64_tr_b16 v[70:71], v16 offset:17408
  ds_read_b128 v[40:43], v10 offset:6144
  ds_read_b64_tr_b16 v[72:73], v17 offset:16384
  ds_read_b64_tr_b16 v[74:75], v17 offset:17408
  s_sub_u32 s25, s25, 1
  s_waitcnt lgkmcnt(0)
  v_mfma_f32_16x16x32_bf16 a[0:3], v[28:31], v[60:63], 0
  ds_read_b128 v[44:47], v11 offset:0
  v_mfma_f32_16x16x32_bf16 a[4:7], v[28:31], v[64:67], 0
  ds_read_b64_tr_b16 v[76:77], v14 offset:24576
  v_mfma_f32_16x16x32_bf16 a[8:11], v[28:31], v[68:71], 0
  ds_read_b64_tr_b16 v[78:79], v14 offset:25600
  v_mfma_f32_16x16x32_bf16 a[12:15], v[28:31], v[72:75], 0
  ds_read_b128 v[48:51], v11 offset:2048
  v_mfma_f32_16x16x32_bf16 a[16:19], v[32:35], v[60:63], 0
  ds_read_b64_tr_b16 v[80:81], v15 offset:24576
  v_mfma_f32_16x16x32_bf16 a[20:23], v[32:35], v[64:67], 0
  ds_read_b64_tr_b16 v[82:83], v15 offset:25600
  v_mfma_f32_16x16x32_bf16 a[24:27], v[32:35], v[68:71], 0
  ds_read_b128 v[52:55], v11 offset:4096
  v_mfma_f32_16x16x32_bf16 a[28:31], v[32:35], v[72:75], 0
  ds_read_b64_tr_b16 v[84:85], v16 offset:24576
  v_mfma_f32_16x16x32_bf16 a[32:35], v[36:39], v[60:63], 0
  ds_read_b64_tr_b16 v[86:87], v16 offset:25600
  v_mfma_f32_16x16x32_bf16 a[36:39], v[36:39], v[64:67], 0
  ds_read_b128 v[56:59], v11 offset:6144
  v_mfma_f32_16x16x32_bf16 a[40:43], v[36:39], v[68:71], 0
  ds_read_b64_tr_b16 v[88:89], v17 offset:24576
  v_mfma_f32_16x16x32_bf16 a[44:47], v[36:39], v[72:75], 0
  ds_read_b64_tr_b16 v[90:91], v17 offset:25600
  v_mfma_f32_16x16x32_bf16 a[48:51], v[40:43], v[60:63], 0
  v_mfma_f32_16x16x32_bf16 a[52:55], v[40:43], v[64:67], 0
  v_mfma_f32_16x16x32_bf16 a[56:59], v[40:43], v[68:71], 0
  v_mfma_f32_16x16x32_bf16 a[60:63], v[40:43], v[72:75], 0
  s_waitcnt lgkmcnt(0)
  v_mfma_f32_16x16x32_bf16 a[0:3], v[44:47], v[76:79], a[0:3]
  s_waitcnt vmcnt(18)
  s_barrier
  s_add_u32 m0, s52, 0
  v_mfma_f32_16x16x32_bf16 a[4:7], v[44:47], v[80:83], a[4:7]
  buffer_load_dwordx4 v2, s[8:11], s20 offen  lds
  ds_read_b128 v[28:31], v10 offset:32768
  v_mfma_f32_16x16x32_bf16 a[8:11], v[44:47], v[84:87], a[8:11]
  ds_read_b64_tr_b16 v[60:61], v14 offset:49152
  v_mfma_f32_16x16x32_bf16 a[12:15], v[44:47], v[88:91], a[12:15]
  ds_read_b64_tr_b16 v[62:63], v14 offset:50176
  s_add_u32 m0, s53, 0
  v_mfma_f32_16x16x32_bf16 a[16:19], v[48:51], v[76:79], a[16:19]
  buffer_load_dwordx4 v6, s[12:15], s21 offen  lds
  ds_read_b128 v[32:35], v10 offset:34816
  v_mfma_f32_16x16x32_bf16 a[20:23], v[48:51], v[80:83], a[20:23]
  ds_read_b64_tr_b16 v[64:65], v15 offset:49152
  v_mfma_f32_16x16x32_bf16 a[24:27], v[48:51], v[84:87], a[24:27]
  ds_read_b64_tr_b16 v[66:67], v15 offset:50176
  s_add_u32 m0, s52, 1024
  v_mfma_f32_16x16x32_bf16 a[28:31], v[48:51], v[88:91], a[28:31]
  buffer_load_dwordx4 v3, s[8:11], s20 offen  lds
  ds_read_b128 v[36:39], v10 offset:36864
  v_mfma_f32_16x16x32_bf16 a[32:35], v[52:55], v[76:79], a[32:35]
  ds_read_b64_tr_b16 v[68:69], v16 offset:49152
  v_mfma_f32_16x16x32_bf16 a[36:39], v[52:55], v[80:83], a[36:39]
  ds_read_b64_tr_b16 v[70:71], v16 offset:50176
  s_add_u32 m0, s53, 1024
  v_mfma_f32_16x16x32_bf16 a[40:43], v[52:55], v[84:87], a[40:43]
  buffer_load_dwordx4 v7, s[12:15], s21 offen  lds
  ds_read_b128 v[40:43], v10 offset:38912
  v_mfma_f32_16x16x32_bf16 a[44:47], v[52:55], v[88:91], a[44:47]
  ds_read_b64_tr_b16 v[72:73], v17 offset:49152
  v_mfma_f32_16x16x32_bf16 a[48:51], v[56:59], v[76:79], a[48:51]
  ds_read_b64_tr_b16 v[74:75], v17 offset:50176
  s_add_u32 m0, s52, 2048
  v_mfma_f32_16x16x32_bf16 a[52:55], v[56:59], v[80:83], a[52:55]
  buffer_load_dwordx4 v4, s[8:11], s20 offen  lds
  v_mfma_f32_16x16x32_bf16 a[56:59], v[56:59], v[84:87], a[56:59]
  v_mfma_f32_16x16x32_bf16 a[60:63], v[56:59], v[88:91], a[60:63]
  s_waitcnt lgkmcnt(0)
  s_add_u32 m0, s53, 2048
  v_mfma_f32_16x16x32_bf16 a[0:3], v[28:31], v[60:63], a[0:3]
  buffer_load_dwordx4 v8, s[12:15], s21 offen  lds
  ds_read_b128 v[44:47], v11 offset:32768
  v_mfma_f32_16x16x32_bf16 a[4:7], v[28:31], v[64:67], a[4:7]
  ds_read_b64_tr_b16 v[76:77], v14 offset:57344
  v_mfma_f32_16x16x32_bf16 a[8:11], v[28:31], v[68:71], a[8:11]
  ds_read_b64_tr_b16 v[78:79], v14 offset:58368
  v_mfma_f32_16x16x32_bf16 a[12:15], v[28:31], v[72:75], a[12:15]
  ds_read_b128 v[48:51], v11 offset:34816
  s_add_u32 m0, s52, 3072
  v_mfma_f32_16x16x32_bf16 a[16:19], v[32:35], v[60:63], a[16:19]
  buffer_load_dwordx4 v5, s[8:11], s20 offen  lds
  ds_read_b64_tr_b16 v[80:81], v15 offset:57344
  v_mfma_f32_16x16x32_bf16 a[20:23], v[32:35], v[64:67], a[20:23]
  ds_read_b64_tr_b16 v[82:83], v15 offset:58368
  v_mfma_f32_16x16x32_bf16 a[24:27], v[32:35], v[68:71], a[24:27]
  ds_read_b128 v[52:55], v11 offset:36864
  v_mfma_f32_16x16x32_bf16 a[28:31], v[32:35], v[72:75], a[28:31]
  ds_read_b64_tr_b16 v[84:85], v16 offset:57344
  s_add_u32 m0, s53, 3072
  v_mfma_f32_16x16x32_bf16 a[32:35], v[36:39], v[60:63], a[32:35]
  buffer_load_dwordx4 v9, s[12:15], s21 offen  lds
  ds_read_b64_tr_b16 v[86:87], v16 offset:58368
  v_mfma_f32_16x16x32_bf16 a[36:39], v[36:39], v[64:67], a[36:39]
  ds_read_b128 v[56:59], v11 offset:38912
  v_mfma_f32_16x16x32_bf16 a[40:43], v[36:39], v[68:71], a[40:43]
  ds_read_b64_tr_b16 v[88:89], v17 offset:57344
  v_mfma_f32_16x16x32_bf16 a[44:47], v[36:39], v[72:75], a[44:47]
  ds_read_b64_tr_b16 v[90:91], v17 offset:58368
  s_add_u32 s20, s20, 128
  v_mfma_f32_16x16x32_bf16 a[48:51], v[40:43], v[60:63], a[48:51]
  s_add_u32 s21, s21, s51
  v_mfma_f32_16x16x32_bf16 a[52:55], v[40:43], v[64:67], a[52:55]
  v_mfma_f32_16x16x32_bf16 a[56:59], v[40:43], v[68:71], a[56:59]
  v_mfma_f32_16x16x32_bf16 a[60:63], v[40:43], v[72:75], a[60:63]
  s_waitcnt lgkmcnt(0)
  v_mfma_f32_16x16x32_bf16 a[0:3], v[44:47], v[76:79], a[0:3]
  s_waitcnt vmcnt(18)
  s_barrier
  s_add_u32 m0, s52, 32768
  v_mfma_f32_16x16x32_bf16 a[4:7], v[44:47], v[80:83], a[4:7]
  buffer_load_dwordx4 v2, s[8:11], s20 offen  lds
  ds_read_b128 v[28:31], v12 offset:0
  v_mfma_f32_16x16x32_bf16 a[8:11], v[44:47], v[84:87], a[8:11]
  ds_read_b64_tr_b16 v[60:61], v18 offset:16384
  v_mfma_f32_16x16x32_bf16 a[12:15], v[44:47], v[88:91], a[12:15]
  ds_read_b64_tr_b16 v[62:63], v18 offset:17408
  s_add_u32 m0, s53, 32768
  v_mfma_f32_16x16x32_bf16 a[16:19], v[48:51], v[76:79], a[16:19]
  buffer_load_dwordx4 v6, s[12:15], s21 offen  lds
  ds_read_b128 v[32:35], v12 offset:2048
  v_mfma_f32_16x16x32_bf16 a[20:23], v[48:51], v[80:83], a[20:23]
  ds_read_b64_tr_b16 v[64:65], v19 offset:16384
  v_mfma_f32_16x16x32_bf16 a[24:27], v[48:51], v[84:87], a[24:27]
  ds_read_b64_tr_b16 v[66:67], v19 offset:17408
  s_add_u32 m0, s52, 33792
  v_mfma_f32_16x16x32_bf16 a[28:31], v[48:51], v[88:91], a[28:31]
  buffer_load_dwordx4 v3, s[8:11], s20 offen  lds
  ds_read_b128 v[36:39], v12 offset:4096
  v_mfma_f32_16x16x32_bf16 a[32:35], v[52:55], v[76:79], a[32:35]
  ds_read_b64_tr_b16 v[68:69], v20 offset:16384
  v_mfma_f32_16x16x32_bf16 a[36:39], v[52:55], v[80:83], a[36:39]
  ds_read_b64_tr_b16 v[70:71], v20 offset:17408
  s_add_u32 m0, s53, 33792
  v_mfma_f32_16x16x32_bf16 a[40:43], v[52:55], v[84:87], a[40:43]
  buffer_load_dwordx4 v7, s[12:15], s21 offen  lds
  ds_read_b128 v[40:43], v12 offset:6144
  v_mfma_f32_16x16x32_bf16 a[44:47], v[52:55], v[88:91], a[44:47]
  ds_read_b64_tr_b16 v[72:73], v21 offset:16384
  v_mfma_f32_16x16x32_bf16 a[48:51], v[56:59], v[76:79], a[48:51]
  ds_read_b64_tr_b16 v[74:75], v21 offset:17408
  s_add_u32 m0, s52, 34816
  v_mfma_f32_16x16x32_bf16 a[52:55], v[56:59], v[80:83], a[52:55]
  buffer_load_dwordx4 v4, s[8:11], s20 offen  lds
  v_mfma_f32_16x16x32_bf16 a[56:59], v[56:59], v[84:87], a[56:59]
  v_mfma_f32_16x16x32_bf16 a[60:63], v[56:59], v[88:91], a[60:63]
  s_waitcnt lgkmcnt(0)
  s_add_u32 m0, s53, 34816
  v_mfma_f32_16x16x32_bf16 a[0:3], v[28:31], v[60:63], a[0:3]
  buffer_load_dwordx4 v8, s[12:15], s21 offen  lds
  ds_read_b128 v[44:47], v13 offset:0
  v_mfma_f32_16x16x32_bf16 a[4:7], v[28:31], v[64:67], a[4:7]
  ds_read_b64_tr_b16 v[76:77], v18 offset:24576
  v_mfma_f32_16x16x32_bf16 a[8:11], v[28:31], v[68:71], a[8:11]
  ds_read_b64_tr_b16 v[78:79], v18 offset:25600
  v_mfma_f32_16x16x32_bf16 a[12:15], v[28:31], v[72:75], a[12:15]
  ds_read_b128 v[48:51], v13 offset:2048
  s_add_u32 m0, s52, 35840
  v_mfma_f32_16x16x32_bf16 a[16:19], v[32:35], v[60:63], a[16:19]
  buffer_load_dwordx4 v5, s[8:11], s20 offen  lds
  ds_read_b64_tr_b16 v[80:81], v19 offset:24576
  v_mfma_f32_16x16x32_bf16 a[20:23], v[32:35], v[64:67], a[20:23]
  ds_read_b64_tr_b16 v[82:83], v19 offset:25600
  v_mfma_f32_16x16x32_bf16 a[24:27], v[32:35], v[68:71], a[24:27]
  ds_read_b128 v[52:55], v13 offset:4096
  v_mfma_f32_16x16x32_bf16 a[28:31], v[32:35], v[72:75], a[28:31]
  ds_read_b64_tr_b16 v[84:85], v20 offset:24576
  s_add_u32 m0, s53, 35840
  v_mfma_f32_16x16x32_bf16 a[32:35], v[36:39], v[60:63], a[32:35]
  buffer_load_dwordx4 v9, s[12:15], s21 offen  lds
  ds_read_b64_tr_b16 v[86:87], v20 offset:25600
  v_mfma_f32_16x16x32_bf16 a[36:39], v[36:39], v[64:67], a[36:39]
  ds_read_b128 v[56:59], v13 offset:6144
  v_mfma_f32_16x16x32_bf16 a[40:43], v[36:39], v[68:71], a[40:43]
  ds_read_b64_tr_b16 v[88:89], v21 offset:24576
  v_mfma_f32_16x16x32_bf16 a[44:47], v[36:39], v[72:75], a[44:47]
  ds_read_b64_tr_b16 v[90:91], v21 offset:25600
  s_add_u32 s20, s20, 128
  v_mfma_f32_16x16x32_bf16 a[48:51], v[40:43], v[60:63], a[48:51]
  s_add_u32 s21, s21, s51
  v_mfma_f32_16x16x32_bf16 a[52:55], v[40:43], v[64:67], a[52:55]
  v_mfma_f32_16x16x32_bf16 a[56:59], v[40:43], v[68:71], a[56:59]
  v_mfma_f32_16x16x32_bf16 a[60:63], v[40:43], v[72:75], a[60:63]
  s_waitcnt lgkmcnt(0)
  v_mfma_f32_16x16x32_bf16 a[0:3], v[44:47], v[76:79], a[0:3]
  s_waitcnt vmcnt(18)
  s_barrier
  s_add_u32 m0, s52, 65536
  v_mfma_f32_16x16x32_bf16 a[4:7], v[44:47], v[80:83], a[4:7]
  buffer_load_dwordx4 v2, s[8:11], s20 offen  lds
  ds_read_b128 v[28:31], v12 offset:32768
  v_mfma_f32_16x16x32_bf16 a[8:11], v[44:47], v[84:87], a[8:11]
  ds_read_b64_tr_b16 v[60:61], v18 offset:49152
  v_mfma_f32_16x16x32_bf16 a[12:15], v[44:47], v[88:91], a[12:15]
  ds_read_b64_tr_b16 v[62:63], v18 offset:50176
  s_add_u32 m0, s53, 65536
  v_mfma_f32_16x16x32_bf16 a[16:19], v[48:51], v[76:79], a[16:19]
  buffer_load_dwordx4 v6, s[12:15], s21 offen  lds
  ds_read_b128 v[32:35], v12 offset:34816
  v_mfma_f32_16x16x32_bf16 a[20:23], v[48:51], v[80:83], a[20:23]
  ds_read_b64_tr_b16 v[64:65], v19 offset:49152
  v_mfma_f32_16x16x32_bf16 a[24:27], v[48:51], v[84:87], a[24:27]
  ds_read_b64_tr_b16 v[66:67], v19 offset:50176
  s_add_u32 m0, s52, 66560
  v_mfma_f32_16x16x32_bf16 a[28:31], v[48:51], v[88:91], a[28:31]
  buffer_load_dwordx4 v3, s[8:11], s20 offen  lds
  ds_read_b128 v[36:39], v12 offset:36864
  v_mfma_f32_16x16x32_bf16 a[32:35], v[52:55], v[76:79], a[32:35]
  ds_read_b64_tr_b16 v[68:69], v20 offset:49152
  v_mfma_f32_16x16x32_bf16 a[36:39], v[52:55], v[80:83], a[36:39]
  ds_read_b64_tr_b16 v[70:71], v20 offset:50176
  s_add_u32 m0, s53, 66560
  v_mfma_f32_16x16x32_bf16 a[40:43], v[52:55], v[84:87], a[40:43]
  buffer_load_dwordx4 v7, s[12:15], s21 offen  lds
  ds_read_b128 v[40:43], v12 offset:38912
  v_mfma_f32_16x16x32_bf16 a[44:47], v[52:55], v[88:91], a[44:47]
  ds_read_b64_tr_b16 v[72:73], v21 offset:49152
  v_mfma_f32_16x16x32_bf16 a[48:51], v[56:59], v[76:79], a[48:51]
  ds_read_b64_tr_b16 v[74:75], v21 offset:50176
  s_add_u32 m0, s52, 67584
  v_mfma_f32_16x16x32_bf16 a[52:55], v[56:59], v[80:83], a[52:55]
  buffer_load_dwordx4 v4, s[8:11], s20 offen  lds
  v_mfma_f32_16x16x32_bf16 a[56:59], v[56:59], v[84:87], a[56:59]
  v_mfma_f32_16x16x32_bf16 a[60:63], v[56:59], v[88:91], a[60:63]
  s_waitcnt lgkmcnt(0)
  s_add_u32 m0, s53, 67584
  v_mfma_f32_16x16x32_bf16 a[0:3], v[28:31], v[60:63], a[0:3]
  buffer_load_dwordx4 v8, s[12:15], s21 offen  lds
  ds_read_b128 v[44:47], v13 offset:32768
  v_mfma_f32_16x16x32_bf16 a[4:7], v[28:31], v[64:67], a[4:7]
  ds_read_b64_tr_b16 v[76:77], v18 offset:57344
  v_mfma_f32_16x16x32_bf16 a[8:11], v[28:31], v[68:71], a[8:11]
  ds_read_b64_tr_b16 v[78:79], v18 offset:58368
  v_mfma_f32_16x16x32_bf16 a[12:15], v[28:31], v[72:75], a[12:15]
  ds_read_b128 v[48:51], v13 offset:34816
  s_add_u32 m0, s52, 68608
  v_mfma_f32_16x16x32_bf16 a[16:19], v[32:35], v[60:63], a[16:19]
  buffer_load_dwordx4 v5, s[8:11], s20 offen  lds
  ds_read_b64_tr_b16 v[80:81], v19 offset:57344
  v_mfma_f32_16x16x32_bf16 a[20:23], v[32:35], v[64:67], a[20:23]
  ds_read_b64_tr_b16 v[82:83], v19 offset:58368
  v_mfma_f32_16x16x32_bf16 a[24:27], v[32:35], v[68:71], a[24:27]
  ds_read_b128 v[52:55], v13 offset:36864
  v_mfma_f32_16x16x32_bf16 a[28:31], v[32:35], v[72:75], a[28:31]
  ds_read_b64_tr_b16 v[84:85], v20 offset:57344
  s_add_u32 m0, s53, 68608
  v_mfma_f32_16x16x32_bf16 a[32:35], v[36:39], v[60:63], a[32:35]
  buffer_load_dwordx4 v9, s[12:15], s21 offen  lds
  ds_read_b64_tr_b16 v[86:87], v20 offset:58368
  v_mfma_f32_16x16x32_bf16 a[36:39], v[36:39], v[64:67], a[36:39]
  ds_read_b128 v[56:59], v13 offset:38912
  v_mfma_f32_16x16x32_bf16 a[40:43], v[36:39], v[68:71], a[40:43]
  ds_read_b64_tr_b16 v[88:89], v21 offset:57344
  v_mfma_f32_16x16x32_bf16 a[44:47], v[36:39], v[72:75], a[44:47]
  ds_read_b64_tr_b16 v[90:91], v21 offset:58368
  s_add_u32 s20, s20, 128
  v_mfma_f32_16x16x32_bf16 a[48:51], v[40:43], v[60:63], a[48:51]
  s_add_u32 s21, s21, s51
  v_mfma_f32_16x16x32_bf16 a[52:55], v[40:43], v[64:67], a[52:55]
  v_mfma_f32_16x16x32_bf16 a[56:59], v[40:43], v[68:71], a[56:59]
  v_mfma_f32_16x16x32_bf16 a[60:63], v[40:43], v[72:75], a[60:63]
  s_waitcnt lgkmcnt(0)
  v_mfma_f32_16x16x32_bf16 a[0:3], v[44:47], v[76:79], a[0:3]
  s_waitcnt vmcnt(16)
  s_barrier
  s_add_u32 m0, s52, 98304
  v_mfma_f32_16x16x32_bf16 a[4:7], v[44:47], v[80:83], a[4:7]
  buffer_load_dwordx4 v2, s[8:11], s20 offen  lds
  ds_read_b128 v[28:31], v10 offset:0
  v_mfma_f32_16x16x32_bf16 a[8:11], v[44:47], v[84:87], a[8:11]
  ds_read_b64_tr_b16 v[60:61], v14 offset:16384
  v_mfma_f32_16x16x32_bf16 a[12:15], v[44:47], v[88:91], a[12:15]
  ds_read_b64_tr_b16 v[62:63], v14 offset:17408
  s_add_u32 m0, s53, 98304
  v_mfma_f32_16x16x32_bf16 a[16:19], v[48:51], v[76:79], a[16:19]
  buffer_load_dwordx4 v6, s[12:15], s21 offen  lds
  ds_read_b128 v[32:35], v10 offset:2048
  v_mfma_f32_16x16x32_bf16 a[20:23], v[48:51], v[80:83], a[20:23]
  ds_read_b64_tr_b16 v[64:65], v15 offset:16384
  v_mfma_f32_16x16x32_bf16 a[24:27], v[48:51], v[84:87], a[24:27]
  ds_read_b64_tr_b16 v[66:67], v15 offset:17408
  s_add_u32 m0, s52, 99328
  v_mfma_f32_16x16x32_bf16 a[28:31], v[48:51], v[88:91], a[28:31]
  buffer_load_dwordx4 v3, s[8:11], s20 offen  lds
  ds_read_b128 v[36:39], v10 offset:4096
  v_mfma_f32_16x16x32_bf16 a[32:35], v[52:55], v[76:79], a[32:35]
  ds_read_b64_tr_b16 v[68:69], v16 offset:16384
  v_mfma_f32_16x16x32_bf16 a[36:39], v[52:55], v[80:83], a[36:39]
  ds_read_b64_tr_b16 v[70:71], v16 offset:17408
  s_add_u32 m0, s53, 99328
  v_mfma_f32_16x16x32_bf16 a[40:43], v[52:55], v[84:87], a[40:43]
  buffer_load_dwordx4 v7, s[12:15], s21 offen  lds
  ds_read_b128 v[40:43], v10 offset:6144
  v_mfma_f32_16x16x32_bf16 a[44:47], v[52:55], v[88:91], a[44:47]
  ds_read_b64_tr_b16 v[72:73], v17 offset:16384
  v_mfma_f32_16x16x32_bf16 a[48:51], v[56:59], v[76:79], a[48:51]
  ds_read_b64_tr_b16 v[74:75], v17 offset:17408
  s_add_u32 m0, s52, 100352
  v_mfma_f32_16x16x32_bf16 a[52:55], v[56:59], v[80:83], a[52:55]
  buffer_load_dwordx4 v4, s[8:11], s20 offen  lds
  v_mfma_f32_16x16x32_bf16 a[56:59], v[56:59], v[84:87], a[56:59]
  v_mfma_f32_16x16x32_bf16 a[60:63], v[56:59], v[88:91], a[60:63]
L_g5_loop:
  s_sub_u32 s25, s25, 1
  s_cmp_eq_u32 s25, 0
  s_cbranch_scc1 L_g5_fin
  s_waitcnt lgkmcnt(0)
  s_add_u32 m0, s53, 100352
  v_mfma_f32_16x16x32_bf16 a[0:3], v[28:31], v[60:63], a[0:3]
  buffer_load_dwordx4 v8, s[12:15], s21 offen  lds
  ds_read_b128 v[44:47], v11 offset:0
  v_mfma_f32_16x16x32_bf16 a[4:7], v[28:31], v[64:67], a[4:7]
  ds_read_b64_tr_b16 v[76:77], v14 offset:24576
  v_mfma_f32_16x16x32_bf16 a[8:11], v[28:31], v[68:71], a[8:11]
  ds_read_b64_tr_b16 v[78:79], v14 offset:25600
  v_mfma_f32_16x16x32_bf16 a[12:15], v[28:31], v[72:75], a[12:15]
  ds_read_b128 v[48:51], v11 offset:2048
  s_add_u32 m0, s52, 101376
  v_mfma_f32_16x16x32_bf16 a[16:19], v[32:35], v[60:63], a[16:19]
  buffer_load_dwordx4 v5, s[8:11], s20 offen  lds
  ds_read_b64_tr_b16 v[80:81], v15 offset:24576
  v_mfma_f32_16x16x32_bf16 a[20:23], v[32:35], v[64:67], a[20:23]
  ds_read_b64_tr_b16 v[82:83], v15 offset:25600
  v_mfma_f32_16x16x32_bf16 a[24:27], v[32:35], v[68:71], a[24:27]
  ds_read_b128 v[52:55], v11 offset:4096
  v_mfma_f32_16x16x32_bf16 a[28:31], v[32:35], v[72:75], a[28:31]
  ds_read_b64_tr_b16 v[84:85], v16 offset:24576
  s_add_u32 m0, s53, 101376
  v_mfma_f32_16x16x32_bf16 a[32:35], v[36:39], v[60:63], a[32:35]
  buffer_load_dwordx4 v9, s[12:15], s21 offen  lds
  ds_read_b64_tr_b16 v[86:87], v16 offset:25600
  v_mfma_f32_16x16x32_bf16 a[36:39], v[36:39], v[64:67], a[36:39]
  ds_read_b128 v[56:59], v11 offset:6144
  v_mfma_f32_16x16x32_bf16 a[40:43], v[36:39], v[68:71], a[40:43]
  ds_read_b64_tr_b16 v[88:89], v17 offset:24576
  v_mfma_f32_16x16x32_bf16 a[44:47], v[36:39], v[72:75], a[44:47]
  ds_read_b64_tr_b16 v[90:91], v17 offset:25600
  s_add_u32 s20, s20, 128
  v_mfma_f32_16x16x32_bf16 a[48:51], v[40:43], v[60:63], a[48:51]
  s_add_u32 s21, s21, s51
  v_mfma_f32_16x16x32_bf16 a[52:55], v[40:43], v[64:67], a[52:55]
  v_mfma_f32_16x16x32_bf16 a[56:59], v[40:43], v[68:71], a[56:59]
  v_mfma_f32_16x16x32_bf16 a[60:63], v[40:43], v[72:75], a[60:63]
  s_waitcnt lgkmcnt(0)
  v_mfma_f32_16x16x32_bf16 a[0:3], v[44:47], v[76:79], a[0:3]
  s_waitcnt vmcnt(16)
  s_barrier
  s_add_u32 m0, s52, 0
  v_mfma_f32_16x16x32_bf16 a[4:7], v[44:47], v[80:83], a[4:7]
  buffer_load_dwordx4 v2, s[8:11], s20 offen  lds
  ds_read_b128 v[28:31], v10 offset:32768
  v_mfma_f32_16x16x32_bf16 a[8:11], v[44:47], v[84:87], a[8:11]
  ds_read_b64_tr_b16 v[60:61], v14 offset:49152
  v_mfma_f32_16x16x32_bf16 a[12:15], v[44:47], v[88:91], a[12:15]
  ds_read_b64_tr_b16 v[62:63], v14 offset:50176
  s_add_u32 m0, s53, 0
  v_mfma_f32_16x16x32_bf16 a[16:19], v[48:51], v[76:79], a[16:19]
  buffer_load_dwordx4 v6, s[12:15], s21 offen  lds
  ds_read_b128 v[32:35], v10 offset:34816
  v_mfma_f32_16x16x32_bf16 a[20:23], v[48:51], v[80:83], a[20:23]
  ds_read_b64_tr_b16 v[64:65], v15 offset:49152
  v_mfma_f32_16x16x32_bf16 a[24:27], v[48:51], v[84:87], a[24:27]
  ds_read_b64_tr_b16 v[66:67], v15 offset:50176
  s_add_u32 m0, s52, 1024
  v_mfma_f32_16x16x32_bf16 a[28:31], v[48:51], v[88:91], a[28:31]
  buffer_load_dwordx4 v3, s[8:11], s20 offen  lds
  ds_read_b128 v[36:39], v10 offset:36864
  v_mfma_f32_16x16x32_bf16 a[32:35], v[52:55], v[76:79], a[32:35]
  ds_read_b64_tr_b16 v[68:69], v16 offset:49152
  v_mfma_f32_16x16x32_bf16 a[36:39], v[52:55], v[80:83], a[36:39]
  ds_read_b64_tr_b16 v[70:71], v16 offset:50176
  s_add_u32 m0, s53, 1024
  v_mfma_f32_16x16x32_bf16 a[40:43], v[52:55], v[84:87], a[40:43]
  buffer_load_dwordx4 v7, s[12:15], s21 offen  lds
  ds_read_b128 v[40:43], v10 offset:38912
  v_mfma_f32_16x16x32_bf16 a[44:47], v[52:55], v[88:91], a[44:47]
  ds_read_b64_tr_b16 v[72:73], v17 offset:49152
  v_mfma_f32_16x16x32_bf16 a[48:51], v[56:59], v[76:79], a[48:51]
  ds_read_b64_tr_b16 v[74:75], v17 offset:50176
  s_add_u32 m0, s52, 2048
  v_mfma_f32_16x16x32_bf16 a[52:55], v[56:59], v[80:83], a[52:55]
  buffer_load_dwordx4 v4, s[8:11], s20 offen  lds
  v_mfma_f32_16x16x32_bf16 a[56:59], v[56:59], v[84:87], a[56:59]
  v_mfma_f32_16x16x32_bf16 a[60:63], v[56:59], v[88:91], a[60:63]
  s_waitcnt lgkmcnt(0)
  s_add_u32 m0, s53, 2048
  v_mfma_f32_16x16x32_bf16 a[0:3], v[28:31], v[60:63], a[0:3]
  buffer_load_dwordx4 v8, s[12:15], s21 offen  lds
  ds_read_b128 v[44:47], v11 offset:32768
  v_mfma_f32_16x16x32_bf16 a[4:7], v[28:31], v[64:67], a[4:7]
  ds_read_b64_tr_b16 v[76:77], v14 offset:57344
  v_mfma_f32_16x16x32_bf16 a[8:11], v[28:31], v[68:71], a[8:11]
  ds_read_b64_tr_b16 v[78:79], v14 offset:58368
  v_mfma_f32_16x16x32_bf16 a[12:15], v[28:31], v[72:75], a[12:15]
  ds_read_b128 v[48:51], v11 offset:34816
  s_add_u32 m0, s52, 3072
  v_mfma_f32_16x16x32_bf16 a[16:19], v[32:35], v[60:63], a[16:19]
  buffer_load_dwordx4 v5, s[8:11], s20 offen  lds
  ds_read_b64_tr_b16 v[80:81], v15 offset:57344
  v_mfma_f32_16x16x32_bf16 a[20:23], v[32:35], v[64:67], a[20:23]
  ds_read_b64_tr_b16 v[82:83], v15 offset:58368
  v_mfma_f32_16x16x32_bf16 a[24:27], v[32:35], v[68:71], a[24:27]
  ds_read_b128 v[52:55], v11 offset:36864
  v_mfma_f32_16x16x32_bf16 a[28:31], v[32:35], v[72:75], a[28:31]
  ds_read_b64_tr_b16 v[84:85], v16 offset:57344
  s_add_u32 m0, s53, 3072
  v_mfma_f32_16x16x32_bf16 a[32:35], v[36:39], v[60:63], a[32:35]
  buffer_load_dwordx4 v9, s[12:15], s21 offen  lds
  ds_read_b64_tr_b16 v[86:87], v16 offset:58368
  v_mfma_f32_16x16x32_bf16 a[36:39], v[36:39], v[64:67], a[36:39]
  ds_read_b128 v[56:59], v11 offset:38912
  v_mfma_f32_16x16x32_bf16 a[40:43], v[36:39], v[68:71], a[40:43]
  ds_read_b64_tr_b16 v[88:89], v17 offset:57344
  v_mfma_f32_16x16x32_bf16 a[44:47], v[36:39], v[72:75], a[44:47]
  ds_read_b64_tr_b16 v[90:91], v17 offset:58368
  s_add_u32 s20, s20, 128
  v_mfma_f32_16x16x32_bf16 a[48:51], v[40:43], v[60:63], a[48:51]
  s_add_u32 s21, s21, s51
  v_mfma_f32_16x16x32_bf16 a[52:55], v[40:43], v[64:67], a[52:55]
  v_mfma_f32_16x16x32_bf16 a[56:59], v[40:43], v[68:71], a[56:59]
  v_mfma_f32_16x16x32_bf16 a[60:63], v[40:43], v[72:75], a[60:63]
  s_waitcnt lgkmcnt(0)
  v_mfma_f32_16x16x32_bf16 a[0:3], v[44:47], v[76:79], a[0:3]
  s_waitcnt vmcnt(16)
  s_barrier
  s_add_u32 m0, s52, 32768
  v_mfma_f32_16x16x32_bf16 a[4:7], v[44:47], v[80:83], a[4:7]
  buffer_load_dwordx4 v2, s[8:11], s20 offen  lds
  ds_read_b128 v[28:31], v12 offset:0
  v_mfma_f32_16x16x32_bf16 a[8:11], v[44:47], v[84:87], a[8:11]
  ds_read_b64_tr_b16 v[60:61], v18 offset:16384
  v_mfma_f32_16x16x32_bf16 a[12:15], v[44:47], v[88:91], a[12:15]
  ds_read_b64_tr_b16 v[62:63], v18 offset:17408
  s_add_u32 m0, s53, 32768
  v_mfma_f32_16x16x32_bf16 a[16:19], v[48:51], v[76:79], a[16:19]
  buffer_load_dwordx4 v6, s[12:15], s21 offen  lds
  ds_read_b128 v[32:35], v12 offset:2048
  v_mfma_f32_16x16x32_bf16 a[20:23], v[48:51], v[80:83], a[20:23]
  ds_read_b64_tr_b16 v[64:65], v19 offset:16384
  v_mfma_f32_16x16x32_bf16 a[24:27], v[48:51], v[84:87], a[24:27]
  ds_read_b64_tr_b16 v[66:67], v19 offset:17408
  s_add_u32 m0, s52, 33792
  v_mfma_f32_16x16x32_bf16 a[28:31], v[48:51], v[88:91], a[28:31]
  buffer_load_dwordx4 v3, s[8:11], s20 offen  lds
  ds_read_b128 v[36:39], v12 offset:4096
  v_mfma_f32_16x16x32_bf16 a[32:35], v[52:55], v[76:79], a[32:35]
  ds_read_b64_tr_b16 v[68:69], v20 offset:16384
  v_mfma_f32_16x16x32_bf16 a[36:39], v[52:55], v[80:83], a[36:39]
  ds_read_b64_tr_b16 v[70:71], v20 offset:17408
  s_add_u32 m0, s53, 33792
  v_mfma_f32_16x16x32_bf16 a[40:43], v[52:55], v[84:87], a[40:43]
  buffer_load_dwordx4 v7, s[12:15], s21 offen  lds
  ds_read_b128 v[40:43], v12 offset:6144
  v_mfma_f32_16x16x32_bf16 a[44:47], v[52:55], v[88:91], a[44:47]
  ds_read_b64_tr_b16 v[72:73], v21 offset:16384
  v_mfma_f32_16x16x32_bf16 a[48:51], v[56:59], v[76:79], a[48:51]
  ds_read_b64_tr_b16 v[74:75], v21 offset:17408
  s_add_u32 m0, s52, 34816
  v_mfma_f32_16x16x32_bf16 a[52:55], v[56:59], v[80:83], a[52:55]
  buffer_load_dwordx4 v4, s[8:11], s20 offen  lds
  v_mfma_f32_16x16x32_bf16 a[56:59], v[56:59], v[84:87], a[56:59]
  v_mfma_f32_16x16x32_bf16 a[60:63], v[56:59], v[88:91], a[60:63]
  s_waitcnt lgkmcnt(0)
  s_add_u32 m0, s53, 34816
  v_mfma_f32_16x16x32_bf16 a[0:3], v[28:31], v[60:63], a[0:3]
  buffer_load_dwordx4 v8, s[12:15], s21 offen  lds
  ds_read_b128 v[44:47], v13 offset:0
  v_mfma_f32_16x16x32_bf16 a[4:7], v[28:31], v[64:67], a[4:7]
  ds_read_b64_tr_b16 v[76:77], v18 offset:24576
  v_mfma_f32_16x16x32_bf16 a[8:11], v[28:31], v[68:71], a[8:11]
  ds_read_b64_tr_b16 v[78:79], v18 offset:25600
  v_mfma_f32_16x16x32_bf16 a[12:15], v[28:31], v[72:75], a[12:15]
  ds_read_b128 v[48:51], v13 offset:2048
  s_add_u32 m0, s52, 35840
  v_mfma_f32_16x16x32_bf16 a[16:19], v[32:35], v[60:63], a[16:19]
  buffer_load_dwordx4 v5, s[8:11], s20 offen  lds
  ds_read_b64_tr_b16 v[80:81], v19 offset:24576
  v_mfma_f32_16x16x32_bf16 a[20:23], v[32:35], v[64:67], a[20:23]
  ds_read_b64_tr_b16 v[82:83], v19 offset:25600
  v_mfma_f32_16x16x32_bf16 a[24:27], v[32:35], v[68:71], a[24:27]
  ds_read_b128 v[52:55], v13 offset:4096
  v_mfma_f32_16x16x32_bf16 a[28:31], v[32:35], v[72:75], a[28:31]
  ds_read_b64_tr_b16 v[84:85], v20 offset:24576
  s_add_u32 m0, s53, 35840
  v_mfma_f32_16x16x32_bf16 a[32:35], v[36:39], v[60:63], a[32:35]
  buffer_load_dwordx4 v9, s[12:15], s21 offen  lds
  ds_read_b64_tr_b16 v[86:87], v20 offset:25600
  v_mfma_f32_16x16x32_bf16 a[36:39], v[36:39], v[64:67], a[36:39]
  ds_read_b128 v[56:59], v13 offset:6144
  v_mfma_f32_16x16x32_bf16 a[40:43], v[36:39], v[68:71], a[40:43]
  ds_read_b64_tr_b16 v[88:89], v21 offset:24576
  v_mfma_f32_16x16x32_bf16 a[44:47], v[36:39], v[72:75], a[44:47]
  ds_read_b64_tr_b16 v[90:91], v21 offset:25600
  s_add_u32 s20, s20, 128
  v_mfma_f32_16x16x32_bf16 a[48:51], v[40:43], v[60:63], a[48:51]
  s_add_u32 s21, s21, s51
  v_mfma_f32_16x16x32_bf16 a[52:55], v[40:43], v[64:67], a[52:55]
  v_mfma_f32_16x16x32_bf16 a[56:59], v[40:43], v[68:71], a[56:59]
  v_mfma_f32_16x16x32_bf16 a[60:63], v[40:43], v[72:75], a[60:63]
  s_waitcnt lgkmcnt(0)
  v_mfma_f32_16x16x32_bf16 a[0:3], v[44:47], v[76:79], a[0:3]
  s_waitcnt vmcnt(16)
  s_barrier
  s_add_u32 m0, s52, 65536
  v_mfma_f32_16x16x32_bf16 a[4:7], v[44:47], v[80:83], a[4:7]
  buffer_load_dwordx4 v2, s[8:11], s20 offen  lds
  ds_read_b128 v[28:31], v12 offset:32768
  v_mfma_f32_16x16x32_bf16 a[8:11], v[44:47], v[84:87], a[8:11]
  ds_read_b64_tr_b16 v[60:61], v18 offset:49152
  v_mfma_f32_16x16x32_bf16 a[12:15], v[44:47], v[88:91], a[12:15]
  ds_read_b64_tr_b16 v[62:63], v18 offset:50176
  s_add_u32 m0, s53, 65536
  v_mfma_f32_16x16x32_bf16 a[16:19], v[48:51], v[76:79], a[16:19]
  buffer_load_dwordx4 v6, s[12:15], s21 offen  lds
  ds_read_b128 v[32:35], v12 offset:34816
  v_mfma_f32_16x16x32_bf16 a[20:23], v[48:51], v[80:83], a[20:23]
  ds_read_b64_tr_b16 v[64:65], v19 offset:49152
  v_mfma_f32_16x16x32_bf16 a[24:27], v[48:51], v[84:87], a[24:27]
  ds_read_b64_tr_b16 v[66:67], v19 offset:50176
  s_add_u32 m0, s52, 66560
  v_mfma_f32_16x16x32_bf16 a[28:31], v[48:51], v[88:91], a[28:31]
  buffer_load_dwordx4 v3, s[8:11], s20 offen  lds
  ds_read_b128 v[36:39], v12 offset:36864
  v_mfma_f32_16x16x32_bf16 a[32:35], v[52:55], v[76:79], a[32:35]
  ds_read_b64_tr_b16 v[68:69], v20 offset:49152
  v_mfma_f32_16x16x32_bf16 a[36:39], v[52:55], v[80:83], a[36:39]
  ds_read_b64_tr_b16 v[70:71], v20 offset:50176
  s_add_u32 m0, s53, 66560
  v_mfma_f32_16x16x32_bf16 a[40:43], v[52:55], v[84:87], a[40:43]
  buffer_load_dwordx4 v7, s[12:15], s21 offen  lds
  ds_read_b128 v[40:43], v12 offset:38912
  v_mfma_f32_16x16x32_bf16 a[44:47], v[52:55], v[88:91], a[44:47]
  ds_read_b64_tr_b16 v[72:73], v21 offset:49152
  v_mfma_f32_16x16x32_bf16 a[48:51], v[56:59], v[76:79], a[48:51]
  ds_read_b64_tr_b16 v[74:75], v21 offset:50176
  s_add_u32 m0, s52, 67584
  v_mfma_f32_16x16x32_bf16 a[52:55], v[56:59], v[80:83], a[52:55]
  buffer_load_dwordx4 v4, s[8:11], s20 offen  lds
  v_mfma_f32_16x16x32_bf16 a[56:59], v[56:59], v[84:87], a[56:59]
  v_mfma_f32_16x16x32_bf16 a[60:63], v[56:59], v[88:91], a[60:63]
  s_waitcnt lgkmcnt(0)
  s_add_u32 m0, s53, 67584
  v_mfma_f32_16x16x32_bf16 a[0:3], v[28:31], v[60:63], a[0:3]
  buffer_load_dwordx4 v8, s[12:15], s21 offen  lds
  ds_read_b128 v[44:47], v13 offset:32768
  v_mfma_f32_16x16x32_bf16 a[4:7], v[28:31], v[64:67], a[4:7]
  ds_read_b64_tr_b16 v[76:77], v18 offset:57344
  v_mfma_f32_16x16x32_bf16 a[8:11], v[28:31], v[68:71], a[8:11]
  ds_read_b64_tr_b16 v[78:79], v18 offset:58368
  v_mfma_f32_16x16x32_bf16 a[12:15], v[28:31], v[72:75], a[12:15]
  ds_read_b128 v[48:51], v13 offset:34816
  s_add_u32 m0, s52, 68608
  v_mfma_f32_16x16x32_bf16 a[16:19], v[32:35], v[60:63], a[16:19]
  buffer_load_dwordx4 v5, s[8:11], s20 offen  lds
  ds_read_b64_tr_b16 v[80:81], v19 offset:57344
  v_mfma_f32_16x16x32_bf16 a[20:23], v[32:35], v[64:67], a[20:23]
  ds_read_b64_tr_b16 v[82:83], v19 offset:58368
  v_mfma_f32_16x16x32_bf16 a[24:27], v[32:35], v[68:71], a[24:27]
  ds_read_b128 v[52:55], v13 offset:36864
  v_mfma_f32_16x16x32_bf16 a[28:31], v[32:35], v[72:75], a[28:31]
  ds_read_b64_tr_b16 v[84:85], v20 offset:57344
  s_add_u32 m0, s53, 68608
  v_mfma_f32_16x16x32_bf16 a[32:35], v[36:39], v[60:63], a[32:35]
  buffer_load_dwordx4 v9, s[12:15], s21 offen  lds
  ds_read_b64_tr_b16 v[86:87], v20 offset:58368
  v_mfma_f32_16x16x32_bf16 a[36:39], v[36:39], v[64:67], a[36:39]
  ds_read_b128 v[56:59], v13 offset:38912
  v_mfma_f32_16x16x32_bf16 a[40:43], v[36:39], v[68:71], a[40:43]
  ds_read_b64_tr_b16 v[88:89], v21 offset:57344
  v_mfma_f32_16x16x32_bf16 a[44:47], v[36:39], v[72:75], a[44:47]
  ds_read_b64_tr_b16 v[90:91], v21 offset:58368
  s_add_u32 s20, s20, 128
  v_mfma_f32_16x16x32_bf16 a[48:51], v[40:43], v[60:63], a[48:51]
  s_add_u32 s21, s21, s51
  v_mfma_f32_16x16x32_bf16 a[52:55], v[40:43], v[64:67], a[52:55]
  v_mfma_f32_16x16x32_bf16 a[56:59], v[40:43], v[68:71], a[56:59]
  v_mfma_f32_16x16x32_bf16 a[60:63], v[40:43], v[72:75], a[60:63]
  s_waitcnt lgkmcnt(0)
  v_mfma_f32_16x16x32_bf16 a[0:3], v[44:47], v[76:79], a[0:3]
  s_waitcnt vmcnt(16)
  s_barrier
  s_add_u32 m0, s52, 98304
  v_mfma_f32_16x16x32_bf16 a[4:7], v[44:47], v[80:83], a[4:7]
  buffer_load_dwordx4 v2, s[8:11], s20 offen  lds
  ds_read_b128 v[28:31], v10 offset:0
  v_mfma_f32_16x16x32_bf16 a[8:11], v[44:47], v[84:87], a[8:11]
  ds_read_b64_tr_b16 v[60:61], v14 offset:16384
  v_mfma_f32_16x16x32_bf16 a[12:15], v[44:47], v[88:91], a[12:15]
  ds_read_b64_tr_b16 v[62:63], v14 offset:17408
  s_add_u32 m0, s53, 98304
  v_mfma_f32_16x16x32_bf16 a[16:19], v[48:51], v[76:79], a[16:19]
  buffer_load_dwordx4 v6, s[12:15], s21 offen  lds
  ds_read_b128 v[32:35], v10 offset:2048
  v_mfma_f32_16x16x32_bf16 a[20:23], v[48:51], v[80:83], a[20:23]
  ds_read_b64_tr_b16 v[64:65], v15 offset:16384
  v_mfma_f32_16x16x32_bf16 a[24:27], v[48:51], v[84:87], a[24:27]
  ds_read_b64_tr_b16 v[66:67], v15 offset:17408
  s_add_u32 m0, s52, 99328
  v_mfma_f32_16x16x32_bf16 a[28:31], v[48:51], v[88:91], a[28:31]
  buffer_load_dwordx4 v3, s[8:11], s20 offen  lds
  ds_read_b128 v[36:39], v10 offset:4096
  v_mfma_f32_16x16x32_bf16 a[32:35], v[52:55], v[76:79], a[32:35]
  ds_read_b64_tr_b16 v[68:69], v16 offset:16384
  v_mfma_f32_16x16x32_bf16 a[36:39], v[52:55], v[80:83], a[36:39]
  ds_read_b64_tr_b16 v[70:71], v16 offset:17408
  s_add_u32 m0, s53, 99328
  v_mfma_f32_16x16x32_bf16 a[40:43], v[52:55], v[84:87], a[40:43]
  buffer_load_dwordx4 v7, s[12:15], s21 offen  lds
  ds_read_b128 v[40:43], v10 offset:6144
  v_mfma_f32_16x16x32_bf16 a[44:47], v[52:55], v[88:91], a[44:47]
  ds_read_b64_tr_b16 v[72:73], v17 offset:16384
  v_mfma_f32_16x16x32_bf16 a[48:51], v[56:59], v[76:79], a[48:51]
  ds_read_b64_tr_b16 v[74:75], v17 offset:17408
  s_add_u32 m0, s52, 100352
  v_mfma_f32_16x16x32_bf16 a[52:55], v[56:59], v[80:83], a[52:55]
  buffer_load_dwordx4 v4, s[8:11], s20 offen  lds
  v_mfma_f32_16x16x32_bf16 a[56:59], v[56:59], v[84:87], a[56:59]
  v_mfma_f32_16x16x32_bf16 a[60:63], v[56:59], v[88:91], a[60:63]
  s_branch L_g5_loop
L_g5_fin:
  s_cmp_lg_u32 s32, 0
  s_cbranch_scc1 L_rq_13
  s_cmp_eq_u32 s39, 0
  s_cbranch_scc1 L_rq_13
  s_lshl_b32 s99, s33, 7
  s_add_u32 s99, s99, 0x3d00200
  v_mov_b32 v244, 1
  v_mov_b32 v245, 0
  s_mov_b64 exec, 1
  buffer_atomic_add v244, v245, s[4:7], s99 offen sc0 sc1
  s_mov_b64 exec, -1
L_rq_13:
  s_waitcnt lgkmcnt(0)
  s_add_u32 m0, s53, 100352
  v_mfma_f32_16x16x32_bf16 a[0:3], v[28:31], v[60:63], a[0:3]
  buffer_load_dwordx4 v8, s[12:15], s21 offen  lds
  ds_read_b128 v[44:47], v11 offset:0
  v_mfma_f32_16x16x32_bf16 a[4:7], v[28:31], v[64:67], a[4:7]
  ds_read_b64_tr_b16 v[76:77], v14 offset:24576
  v_mfma_f32_16x16x32_bf16 a[8:11], v[28:31], v[68:71], a[8:11]
  ds_read_b64_tr_b16 v[78:79], v14 offset:25600
  v_mfma_f32_16x16x32_bf16 a[12:15], v[28:31], v[72:75], a[12:15]
  ds_read_b128 v[48:51], v11 offset:2048
  s_add_u32 m0, s52, 101376
  v_mfma_f32_16x16x32_bf16 a[16:19], v[32:35], v[60:63], a[16:19]
  buffer_load_dwordx4 v5, s[8:11], s20 offen  lds
  ds_read_b64_tr_b16 v[80:81], v15 offset:24576
  v_mfma_f32_16x16x32_bf16 a[20:23], v[32:35], v[64:67], a[20:23]
  ds_read_b64_tr_b16 v[82:83], v15 offset:25600
  v_mfma_f32_16x16x32_bf16 a[24:27], v[32:35], v[68:71], a[24:27]
  ds_read_b128 v[52:55], v11 offset:4096
  v_mfma_f32_16x16x32_bf16 a[28:31], v[32:35], v[72:75], a[28:31]
  ds_read_b64_tr_b16 v[84:85], v16 offset:24576
  s_add_u32 m0, s53, 101376
  v_mfma_f32_16x16x32_bf16 a[32:35], v[36:39], v[60:63], a[32:35]
  buffer_load_dwordx4 v9, s[12:15], s21 offen  lds
  ds_read_b64_tr_b16 v[86:87], v16 offset:25600
  v_mfma_f32_16x16x32_bf16 a[36:39], v[36:39], v[64:67], a[36:39]
  ds_read_b128 v[56:59], v11 offset:6144
  v_mfma_f32_16x16x32_bf16 a[40:43], v[36:39], v[68:71], a[40:43]
  ds_read_b64_tr_b16 v[88:89], v17 offset:24576
  v_mfma_f32_16x16x32_bf16 a[44:47], v[36:39], v[72:75], a[44:47]
  ds_read_b64_tr_b16 v[90:91], v17 offset:25600
  s_add_u32 s20, s20, 128
  v_mfma_f32_16x16x32_bf16 a[48:51], v[40:43], v[60:63], a[48:51]
  s_add_u32 s21, s21, s51
  v_mfma_f32_16x16x32_bf16 a[52:55], v[40:43], v[64:67], a[52:55]
  v_mfma_f32_16x16x32_bf16 a[56:59], v[40:43], v[68:71], a[56:59]
  v_mfma_f32_16x16x32_bf16 a[60:63], v[40:43], v[72:75], a[60:63]
  s_waitcnt lgkmcnt(0)
  v_mfma_f32_16x16x32_bf16 a[0:3], v[44:47], v[76:79], a[0:3]
  s_waitcnt vmcnt(16)
  s_barrier
  v_mfma_f32_16x16x32_bf16 a[4:7], v[44:47], v[80:83], a[4:7]
  ds_read_b128 v[28:31], v10 offset:32768
  v_mfma_f32_16x16x32_bf16 a[8:11], v[44:47], v[84:87], a[8:11]
  ds_read_b64_tr_b16 v[60:61], v14 offset:49152
  v_mfma_f32_16x16x32_bf16 a[12:15], v[44:47], v[88:91], a[12:15]
  ds_read_b64_tr_b16 v[62:63], v14 offset:50176
  v_mfma_f32_16x16x32_bf16 a[16:19], v[48:51], v[76:79], a[16:19]
  ds_read_b128 v[32:35], v10 offset:34816
  v_mfma_f32_16x16x32_bf16 a[20:23], v[48:51], v[80:83], a[20:23]
  ds_read_b64_tr_b16 v[64:65], v15 offset:49152
  v_mfma_f32_16x16x32_bf16 a[24:27], v[48:51], v[84:87], a[24:27]
  ds_read_b64_tr_b16 v[66:67], v15 offset:50176
  v_mfma_f32_16x16x32_bf16 a[28:31], v[48:51], v[88:91], a[28:31]
  ds_read_b128 v[36:39], v10 offset:36864
  v_mfma_f32_16x16x32_bf16 a[32:35], v[52:55], v[76:79], a[32:35]
  ds_read_b64_tr_b16 v[68:69], v16 offset:49152
  v_mfma_f32_16x16x32_bf16 a[36:39], v[52:55], v[80:83], a[36:39]
  ds_read_b64_tr_b16 v[70:71], v16 offset:50176
  v_mfma_f32_16x16x32_bf16 a[40:43], v[52:55], v[84:87], a[40:43]
  ds_read_b128 v[40:43], v10 offset:38912
  v_mfma_f32_16x16x32_bf16 a[44:47], v[52:55], v[88:91], a[44:47]
  ds_read_b64_tr_b16 v[72:73], v17 offset:49152
  v_mfma_f32_16x16x32_bf16 a[48:51], v[56:59], v[76:79], a[48:51]
  ds_read_b64_tr_b16 v[74:75], v17 offset:50176
  v_mfma_f32_16x16x32_bf16 a[52:55], v[56:59], v[80:83], a[52:55]
  v_mfma_f32_16x16x32_bf16 a[56:59], v[56:59], v[84:87], a[56:59]
  v_mfma_f32_16x16x32_bf16 a[60:63], v[56:59], v[88:91], a[60:63]
  s_waitcnt lgkmcnt(0)
  v_mfma_f32_16x16x32_bf16 a[0:3], v[28:31], v[60:63], a[0:3]
  ds_read_b128 v[44:47], v11 offset:32768
  v_mfma_f32_16x16x32_bf16 a[4:7], v[28:31], v[64:67], a[4:7]
  ds_read_b64_tr_b16 v[76:77], v14 offset:57344
  v_mfma_f32_16x16x32_bf16 a[8:11], v[28:31], v[68:71], a[8:11]
  ds_read_b64_tr_b16 v[78:79], v14 offset:58368
  v_mfma_f32_16x16x32_bf16 a[12:15], v[28:31], v[72:75], a[12:15]
  ds_read_b128 v[48:51], v11 offset:34816
  v_mfma_f32_16x16x32_bf16 a[16:19], v[32:35], v[60:63], a[16:19]
  ds_read_b64_tr_b16 v[80:81], v15 offset:57344
  v_mfma_f32_16x16x32_bf16 a[20:23], v[32:35], v[64:67], a[20:23]
  ds_read_b64_tr_b16 v[82:83], v15 offset:58368
  v_mfma_f32_16x16x32_bf16 a[24:27], v[32:35], v[68:71], a[24:27]
  ds_read_b128 v[52:55], v11 offset:36864
  v_mfma_f32_16x16x32_bf16 a[28:31], v[32:35], v[72:75], a[28:31]
  ds_read_b64_tr_b16 v[84:85], v16 offset:57344
  v_mfma_f32_16x16x32_bf16 a[32:35], v[36:39], v[60:63], a[32:35]
  ds_read_b64_tr_b16 v[86:87], v16 offset:58368
  v_mfma_f32_16x16x32_bf16 a[36:39], v[36:39], v[64:67], a[36:39]
  ds_read_b128 v[56:59], v11 offset:38912
  v_mfma_f32_16x16x32_bf16 a[40:43], v[36:39], v[68:71], a[40:43]
  ds_read_b64_tr_b16 v[88:89], v17 offset:57344
  v_mfma_f32_16x16x32_bf16 a[44:47], v[36:39], v[72:75], a[44:47]
  ds_read_b64_tr_b16 v[90:91], v17 offset:58368
  v_mfma_f32_16x16x32_bf16 a[48:51], v[40:43], v[60:63], a[48:51]
  v_mfma_f32_16x16x32_bf16 a[52:55], v[40:43], v[64:67], a[52:55]
  v_mfma_f32_16x16x32_bf16 a[56:59], v[40:43], v[68:71], a[56:59]
  v_mfma_f32_16x16x32_bf16 a[60:63], v[40:43], v[72:75], a[60:63]
  s_waitcnt lgkmcnt(0)
  v_mfma_f32_16x16x32_bf16 a[0:3], v[44:47], v[76:79], a[0:3]
  s_waitcnt vmcnt(8)
  s_barrier
  v_mfma_f32_16x16x32_bf16 a[4:7], v[44:47], v[80:83], a[4:7]
  ds_read_b128 v[28:31], v12 offset:0
  v_mfma_f32_16x16x32_bf16 a[8:11], v[44:47], v[84:87], a[8:11]
  ds_read_b64_tr_b16 v[60:61], v18 offset:16384
  v_mfma_f32_16x16x32_bf16 a[12:15], v[44:47], v[88:91], a[12:15]
  ds_read_b64_tr_b16 v[62:63], v18 offset:17408
  v_mfma_f32_16x16x32_bf16 a[16:19], v[48:51], v[76:79], a[16:19]
  ds_read_b128 v[32:35], v12 offset:2048
  v_mfma_f32_16x16x32_bf16 a[20:23], v[48:51], v[80:83], a[20:23]
  ds_read_b64_tr_b16 v[64:65], v19 offset:16384
  v_mfma_f32_16x16x32_bf16 a[24:27], v[48:51], v[84:87], a[24:27]
  ds_read_b64_tr_b16 v[66:67], v19 offset:17408
  v_mfma_f32_16x16x32_bf16 a[28:31], v[48:51], v[88:91], a[28:31]
  ds_read_b128 v[36:39], v12 offset:4096
  v_mfma_f32_16x16x32_bf16 a[32:35], v[52:55], v[76:79], a[32:35]
  ds_read_b64_tr_b16 v[68:69], v20 offset:16384
  v_mfma_f32_16x16x32_bf16 a[36:39], v[52:55], v[80:83], a[36:39]
  ds_read_b64_tr_b16 v[70:71], v20 offset:17408
  v_mfma_f32_16x16x32_bf16 a[40:43], v[52:55], v[84:87], a[40:43]
  ds_read_b128 v[40:43], v12 offset:6144
  v_mfma_f32_16x16x32_bf16 a[44:47], v[52:55], v[88:91], a[44:47]
  ds_read_b64_tr_b16 v[72:73], v21 offset:16384
  v_mfma_f32_16x16x32_bf16 a[48:51], v[56:59], v[76:79], a[48:51]
  ds_read_b64_tr_b16 v[74:75], v21 offset:17408
  v_mfma_f32_16x16x32_bf16 a[52:55], v[56:59], v[80:83], a[52:55]
  v_mfma_f32_16x16x32_bf16 a[56:59], v[56:59], v[84:87], a[56:59]
  v_mfma_f32_16x16x32_bf16 a[60:63], v[56:59], v[88:91], a[60:63]
  s_waitcnt lgkmcnt(0)
  v_mfma_f32_16x16x32_bf16 a[0:3], v[28:31], v[60:63], a[0:3]
  ds_read_b128 v[44:47], v13 offset:0
  v_mfma_f32_16x16x32_bf16 a[4:7], v[28:31], v[64:67], a[4:7]
  ds_read_b64_tr_b16 v[76:77], v18 offset:24576
  v_mfma_f32_16x16x32_bf16 a[8:11], v[28:31], v[68:71], a[8:11]
  ds_read_b64_tr_b16 v[78:79], v18 offset:25600
  v_mfma_f32_16x16x32_bf16 a[12:15], v[28:31], v[72:75], a[12:15]
  ds_read_b128 v[48:51], v13 offset:2048
  v_mfma_f32_16x16x32_bf16 a[16:19], v[32:35], v[60:63], a[16:19]
  ds_read_b64_tr_b16 v[80:81], v19 offset:24576
  v_mfma_f32_16x16x32_bf16 a[20:23], v[32:35], v[64:67], a[20:23]
  ds_read_b64_tr_b16 v[82:83], v19 offset:25600
  v_mfma_f32_16x16x32_bf16 a[24:27], v[32:35], v[68:71], a[24:27]
  ds_read_b128 v[52:55], v13 offset:4096
  v_mfma_f32_16x16x32_bf16 a[28:31], v[32:35], v[72:75], a[28:31]
  ds_read_b64_tr_b16 v[84:85], v20 offset:24576
  v_mfma_f32_16x16x32_bf16 a[32:35], v[36:39], v[60:63], a[32:35]
  ds_read_b64_tr_b16 v[86:87], v20 offset:25600
  v_mfma_f32_16x16x32_bf16 a[36:39], v[36:39], v[64:67], a[36:39]
  ds_read_b128 v[56:59], v13 offset:6144
  v_mfma_f32_16x16x32_bf16 a[40:43], v[36:39], v[68:71], a[40:43]
  ds_read_b64_tr_b16 v[88:89], v21 offset:24576
  v_mfma_f32_16x16x32_bf16 a[44:47], v[36:39], v[72:75], a[44:47]
  ds_read_b64_tr_b16 v[90:91], v21 offset:25600
  v_mfma_f32_16x16x32_bf16 a[48:51], v[40:43], v[60:63], a[48:51]
  v_mfma_f32_16x16x32_bf16 a[52:55], v[40:43], v[64:67], a[52:55]
  v_mfma_f32_16x16x32_bf16 a[56:59], v[40:43], v[68:71], a[56:59]
  v_mfma_f32_16x16x32_bf16 a[60:63], v[40:43], v[72:75], a[60:63]
  s_waitcnt lgkmcnt(0)
  v_mfma_f32_16x16x32_bf16 a[0:3], v[44:47], v[76:79], a[0:3]
  s_waitcnt vmcnt(0)
  s_barrier
  v_mfma_f32_16x16x32_bf16 a[4:7], v[44:47], v[80:83], a[4:7]
  ds_read_b128 v[28:31], v12 offset:32768
  v_mfma_f32_16x16x32_bf16 a[8:11], v[44:47], v[84:87], a[8:11]
  ds_read_b64_tr_b16 v[60:61], v18 offset:49152
  v_mfma_f32_16x16x32_bf16 a[12:15], v[44:47], v[88:91], a[12:15]
  ds_read_b64_tr_b16 v[62:63], v18 offset:50176
  v_mfma_f32_16x16x32_bf16 a[16:19], v[48:51], v[76:79], a[16:19]
  ds_read_b128 v[32:35], v12 offset:34816
  v_mfma_f32_16x16x32_bf16 a[20:23], v[48:51], v[80:83], a[20:23]
  ds_read_b64_tr_b16 v[64:65], v19 offset:49152
  v_mfma_f32_16x16x32_bf16 a[24:27], v[48:51], v[84:87], a[24:27]
  ds_read_b64_tr_b16 v[66:67], v19 offset:50176
  v_mfma_f32_16x16x32_bf16 a[28:31], v[48:51], v[88:91], a[28:31]
  ds_read_b128 v[36:39], v12 offset:36864
  v_mfma_f32_16x16x32_bf16 a[32:35], v[52:55], v[76:79], a[32:35]
  ds_read_b64_tr_b16 v[68:69], v20 offset:49152
  v_mfma_f32_16x16x32_bf16 a[36:39], v[52:55], v[80:83], a[36:39]
  ds_read_b64_tr_b16 v[70:71], v20 offset:50176
  v_mfma_f32_16x16x32_bf16 a[40:43], v[52:55], v[84:87], a[40:43]
  ds_read_b128 v[40:43], v12 offset:38912
  v_mfma_f32_16x16x32_bf16 a[44:47], v[52:55], v[88:91], a[44:47]
  ds_read_b64_tr_b16 v[72:73], v21 offset:49152
  v_mfma_f32_16x16x32_bf16 a[48:51], v[56:59], v[76:79], a[48:51]
  ds_read_b64_tr_b16 v[74:75], v21 offset:50176
  v_mfma_f32_16x16x32_bf16 a[52:55], v[56:59], v[80:83], a[52:55]
  v_mfma_f32_16x16x32_bf16 a[56:59], v[56:59], v[84:87], a[56:59]
  v_mfma_f32_16x16x32_bf16 a[60:63], v[56:59], v[88:91], a[60:63]
  s_waitcnt lgkmcnt(0)
  v_mfma_f32_16x16x32_bf16 a[0:3], v[28:31], v[60:63], a[0:3]
  ds_read_b128 v[44:47], v13 offset:32768
  v_mfma_f32_16x16x32_bf16 a[4:7], v[28:31], v[64:67], a[4:7]
  ds_read_b64_tr_b16 v[76:77], v18 offset:57344
  v_mfma_f32_16x16x32_bf16 a[8:11], v[28:31], v[68:71], a[8:11]
  ds_read_b64_tr_b16 v[78:79], v18 offset:58368
  v_mfma_f32_16x16x32_bf16 a[12:15], v[28:31], v[72:75], a[12:15]
  ds_read_b128 v[48:51], v13 offset:34816
  v_mfma_f32_16x16x32_bf16 a[16:19], v[32:35], v[60:63], a[16:19]
  ds_read_b64_tr_b16 v[80:81], v19 offset:57344
  v_mfma_f32_16x16x32_bf16 a[20:23], v[32:35], v[64:67], a[20:23]
  ds_read_b64_tr_b16 v[82:83], v19 offset:58368
  v_mfma_f32_16x16x32_bf16 a[24:27], v[32:35], v[68:71], a[24:27]
  ds_read_b128 v[52:55], v13 offset:36864
  v_mfma_f32_16x16x32_bf16 a[28:31], v[32:35], v[72:75], a[28:31]
  ds_read_b64_tr_b16 v[84:85], v20 offset:57344
  v_mfma_f32_16x16x32_bf16 a[32:35], v[36:39], v[60:63], a[32:35]
  ds_read_b64_tr_b16 v[86:87], v20 offset:58368
  v_mfma_f32_16x16x32_bf16 a[36:39], v[36:39], v[64:67], a[36:39]
  ds_read_b128 v[56:59], v13 offset:38912
  v_mfma_f32_16x16x32_bf16 a[40:43], v[36:39], v[68:71], a[40:43]
  ds_read_b64_tr_b16 v[88:89], v21 offset:57344
  v_mfma_f32_16x16x32_bf16 a[44:47], v[36:39], v[72:75], a[44:47]
  ds_read_b64_tr_b16 v[90:91], v21 offset:58368
  v_mfma_f32_16x16x32_bf16 a[48:51], v[40:43], v[60:63], a[48:51]
  v_mfma_f32_16x16x32_bf16 a[52:55], v[40:43], v[64:67], a[52:55]
  v_mfma_f32_16x16x32_bf16 a[56:59], v[40:43], v[68:71], a[56:59]
  v_mfma_f32_16x16x32_bf16 a[60:63], v[40:43], v[72:75], a[60:63]
  s_waitcnt lgkmcnt(0)
  v_mfma_f32_16x16x32_bf16 a[0:3], v[44:47], v[76:79], a[0:3]
  v_mfma_f32_16x16x32_bf16 a[4:7], v[44:47], v[80:83], a[4:7]
  v_mfma_f32_16x16x32_bf16 a[8:11], v[44:47], v[84:87], a[8:11]
  v_mfma_f32_16x16x32_bf16 a[12:15], v[44:47], v[88:91], a[12:15]
  v_mfma_f32_16x16x32_bf16 a[16:19], v[48:51], v[76:79], a[16:19]
  v_mfma_f32_16x16x32_bf16 a[20:23], v[48:51], v[80:83], a[20:23]
  v_mfma_f32_16x16x32_bf16 a[24:27], v[48:51], v[84:87], a[24:27]
  v_mfma_f32_16x16x32_bf16 a[28:31], v[48:51], v[88:91], a[28:31]
  v_mfma_f32_16x16x32_bf16 a[32:35], v[52:55], v[76:79], a[32:35]
  v_mfma_f32_16x16x32_bf16 a[36:39], v[52:55], v[80:83], a[36:39]
  v_mfma_f32_16x16x32_bf16 a[40:43], v[52:55], v[84:87], a[40:43]
  v_mfma_f32_16x16x32_bf16 a[44:47], v[52:55], v[88:91], a[44:47]
  v_mfma_f32_16x16x32_bf16 a[48:51], v[56:59], v[76:79], a[48:51]
  v_mfma_f32_16x16x32_bf16 a[52:55], v[56:59], v[80:83], a[52:55]
  v_mfma_f32_16x16x32_bf16 a[56:59], v[56:59], v[84:87], a[56:59]
  v_mfma_f32_16x16x32_bf16 a[60:63], v[56:59], v[88:91], a[60:63]
  s_mov_b32 s59, 4
  s_mov_b32 s60, s22
  s_mov_b32 s61, s26
  s_add_u32 s62, s38, 0x3d00000
  s_mov_b32 s63, s98
  s_cmp_lg_u32 s39, 0
  s_cbranch_scc1 L_got
  s_mov_b32 s58, 3
  s_branch L_epi
L_swp:
  s_barrier
  v_and_b32 v1, 63, v0
  v_lshlrev_b32 v2, 7, v1
  s_lshl_b32 s40, s36, 2
  s_add_u32 s40, s40, s33
  s_lshl_b32 s40, s40, 2
  s_add_u32 s40, s40, s32
  s_lshl_b32 s40, s40, 13
  s_mov_b32 s44, s78
  s_and_b32 s45, s79, 0xffff
  s_mov_b32 s46, 0x400000
  s_mov_b32 s47, 0x20000
  s_mov_b32 s41, s40
  buffer_load_dword v4, v2, s[44:47], s41 offen
  s_add_u32 s41, s41, 524288
  buffer_load_dword v5, v2, s[44:47], s41 offen
  s_add_u32 s41, s41, 524288
  buffer_load_dword v6, v2, s[44:47], s41 offen
  s_add_u32 s41, s41, 524288
  buffer_load_dword v7, v2, s[44:47], s41 offen
  s_add_u32 s41, s41, 524288
  buffer_load_dword v8, v2, s[44:47], s41 offen
  s_add_u32 s41, s41, 524288
  buffer_load_dword v9, v2, s[44:47], s41 offen
  s_add_u32 s41, s41, 524288
  buffer_load_dword v10, v2, s[44:47], s41 offen
  s_add_u32 s41, s41, 524288
  buffer_load_dword v11, v2, s[44:47], s41 offen
  s_add_u32 s41, s41, 524288
  s_mov_b32 s44, s80
  s_and_b32 s45, s81, 0xffff
  s_mov_b32 s46, 0x600000
  s_mov_b32 s47, 0x20000
  s_mov_b32 s41, s40
  buffer_load_dword v4, v2, s[44:47], s41 offen
  s_add_u32 s41, s41, 524288
  buffer_load_dword v5, v2, s[44:47], s41 offen
  s_add_u32 s41, s41, 524288
  buffer_load_dword v6, v2, s[44:47], s41 offen
  s_add_u32 s41, s41, 524288
  buffer_load_dword v7, v2, s[44:47], s41 offen
  s_add_u32 s41, s41, 524288
  buffer_load_dword v8, v2, s[44:47], s41 offen
  s_add_u32 s41, s41, 524288
  buffer_load_dword v9, v2, s[44:47], s41 offen
  s_add_u32 s41, s41, 524288
  buffer_load_dword v10, v2, s[44:47], s41 offen
  s_add_u32 s41, s41, 524288
  buffer_load_dword v11, v2, s[44:47], s41 offen
  s_add_u32 s41, s41, 524288
  buffer_load_dword v12, v2, s[44:47], s41 offen
  s_add_u32 s41, s41, 524288
  buffer_load_dword v13, v2, s[44:47], s41 offen
  s_add_u32 s41, s41, 524288
  buffer_load_dword v14, v2, s[44:47], s41 offen
  s_add_u32 s41, s41, 524288
  buffer_load_dword v15, v2, s[44:47], s41 offen
  s_add_u32 s41, s41, 524288
  s_mov_b32 s44, s82
  s_and_b32 s45, s83, 0xffff
  s_mov_b32 s46, 0x200000
  s_mov_b32 s47, 0x20000
  s_mov_b32 s41, s40
  buffer_load_dword v4, v2, s[44:47], s41 offen
  s_add_u32 s41, s41, 524288
  buffer_load_dword v5, v2, s[44:47], s41 offen
  s_add_u32 s41, s41, 524288
  buffer_load_dword v6, v2, s[44:47], s41 offen
  s_add_u32 s41, s41, 524288
  buffer_load_dword v7, v2, s[44:47], s41 offen
  s_add_u32 s41, s41, 524288
  s_branch L_next
L_atb:
  s_lshl_b32 s90, s33, 7
  s_lshl_b32 s40, s36, 9
  s_add_u32 s40, s40, s90
  s_max_u32 s41, s36, 1
  s_sub_u32 s41, s41, 1
  s_lshl_b32 s41, s41, 9
  s_add_u32 s41, s41, s90
  s_cmp_lg_u32 s32, 0
  s_cbranch_scc1 L_dd_15
  v_mov_b32 v228, 0x3d00000
  v_mov_b32 v231, 0x3d03000
L_dw_14:
  buffer_load_dword v234, v231, s[4:7], s40 offen offset:0 sc1
  buffer_load_dword v235, v231, s[4:7], s41 offen offset:0 sc1
  s_waitcnt vmcnt(0)
  s_mov_b32 s44, 1
  v_readfirstlane_b32 s45, v234
  s_cmp_ge_u32 s45, 3
  s_cselect_b32 s44, s44, 0
  v_readfirstlane_b32 s45, v235
  s_cmp_ge_u32 s45, 3
  s_cselect_b32 s44, s44, 0
  s_cmp_eq_u32 s44, 1
  s_cbranch_scc1 L_dd_15
  s_sleep 6
  s_add_u32 s3, s3, 1
  s_cmp_lt_u32 s3, 131072
  s_cbranch_scc1 L_dw_14
L_dd_15:
  s_barrier
  s_lshl_b32 s38, s36, 7
  s_add_u32 s38, s38, 1024
  s_lshl_b32 s46, s36, 3
  s_lshl_b32 s90, s37, 1
  s_add_u32 s99, s46, s90
  s_lshr_b32 s90, s32, 1
  s_add_u32 s99, s99, s90
  s_lshl_b32 s99, s99, 3
  s_lshl_b32 s90, s33, 1
  s_add_u32 s99, s99, s90
  s_and_b32 s90, s32, 1
  s_add_u32 s20, s99, s90
  v_and_b32 v1, 63, v0
  s_lshl_b32 s90, s20, 13
  s_sub_u32 s91, s90, 65536
  s_cmp_lt_u32 s20, 8
  s_cselect_b32 s91, s90, s91
  v_mov_b32 v2, 0x0
  v_bfe_u32 v7, v1, 0, 6
  v_lshl_add_u32 v2, v7, 4, v2
  v_add_u32 v3, 4096, v2
  s_add_u32 s92, s90, 67108864
  s_add_u32 s93, s90, 71303168
  s_add_u32 s94, s91, 71303168
  s_add_u32 s95, s90, 75497472
  s_add_u32 s96, s91, 75497472
  s_add_u32 s97, s90, 100663296
  buffer_load_dwordx4 v[8:11], v2, s[4:7], s92 offen offset:0 sc1
  buffer_load_dwordx4 v[12:15], v2, s[4:7], s92 offen offset:1024 sc1
  buffer_load_dwordx4 v[16:19], v2, s[4:7], s92 offen offset:2048 sc1
  buffer_load_dwordx4 v[20:23], v2, s[4:7], s92 offen offset:3072 sc1
  buffer_load_dwordx4 v[24:27], v3, s[4:7], s92 offen offset:0 sc1
  buffer_load_dwordx4 v[28:31], v3, s[4:7], s92 offen offset:1024 sc1
  buffer_load_dwordx4 v[32:35], v3, s[4:7], s92 offen offset:2048 sc1
  buffer_load_dwordx4 v[36:39], v3, s[4:7], s92 offen offset:3072 sc1
  buffer_load_dwordx4 v[40:43], v3, s[4:7], s94 offen offset:0 sc1
  buffer_load_dwordx4 v[44:47], v3, s[4:7], s94 offen offset:1024 sc1
  buffer_load_dwordx4 v[48:51], v3, s[4:7], s94 offen offset:2048 sc1
  buffer_load_dwordx4 v[52:55], v3, s[4:7], s94 offen offset:3072 sc1
  buffer_load_dwordx4 v[56:59], v2, s[4:7], s93 offen offset:0 sc1
  buffer_load_dwordx4 v[60:63], v2, s[4:7], s93 offen offset:1024 sc1
  buffer_load_dwordx4 v[64:67], v2, s[4:7], s93 offen offset:2048 sc1
  buffer_load_dwordx4 v[68:71], v2, s[4:7], s93 offen offset:3072 sc1
  buffer_load_dwordx4 v[72:75], v3, s[4:7], s93 offen offset:0 sc1
  buffer_load_dwordx4 v[76:79], v3, s[4:7], s93 offen offset:1024 sc1
  buffer_load_dwordx4 v[80:83], v3, s[4:7], s93 offen offset:2048 sc1
  buffer_load_dwordx4 v[84:87], v3, s[4:7], s93 offen offset:3072 sc1
  buffer_load_dwordx2 v[88:89], v2, s[4:7], s96 offen offset:8 sc1
  buffer_load_dwordx2 v[94:95], v2, s[4:7], s96 offen offset:1032 sc1
  buffer_load_dwordx2 v[100:101], v2, s[4:7], s96 offen offset:2056 sc1
  buffer_load_dwordx2 v[106:107], v2, s[4:7], s96 offen offset:3080 sc1
  buffer_load_dwordx2 v[112:113], v3, s[4:7], s96 offen offset:8 sc1
  buffer_load_dwordx2 v[118:119], v3, s[4:7], s96 offen offset:1032 sc1
  buffer_load_dwordx2 v[124:125], v3, s[4:7], s96 offen offset:2056 sc1
  buffer_load_dwordx2 v[130:131], v3, s[4:7], s96 offen offset:3080 sc1
  buffer_load_dwordx4 v[90:93], v2, s[4:7], s95 offen offset:0 sc1
  buffer_load_dwordx4 v[96:99], v2, s[4:7], s95 offen offset:1024 sc1
  buffer_load_dwordx4 v[102:105], v2, s[4:7], s95 offen offset:2048 sc1
  buffer_load_dwordx4 v[108:111], v2, s[4:7], s95 offen offset:3072 sc1
  buffer_load_dwordx4 v[114:117], v3, s[4:7], s95 offen offset:0 sc1
  buffer_load_dwordx4 v[120:123], v3, s[4:7], s95 offen offset:1024 sc1
  buffer_load_dwordx4 v[126:129], v3, s[4:7], s95 offen offset:2048 sc1
  buffer_load_dwordx4 v[132:135], v3, s[4:7], s95 offen offset:3072 sc1
  s_mov_b32 s40, 0x50000
  s_mov_b32 s41, 0x5550055
  s_mov_b32 s42, 0xa0000
  s_mov_b32 s43, 0xaaa00aa
  s_mov_b32 s44, 0x150001
  s_mov_b32 s45, 0x15550155
  s_mov_b32 s46, 0x2a0002
  s_mov_b32 s47, 0x2aaa02aa
  s_mov_b32 s48, 0x55505555
  s_mov_b32 s49, 0x50005500
  s_mov_b32 s50, 0xaaa0aaaa
  s_mov_b32 s51, 0xa000aa00
  s_mov_b32 s52, 0x55405554
  s_mov_b32 s53, 0x40005400
  s_mov_b32 s54, 0xaa80aaa8
  s_mov_b32 s55, 0x8000a800
  s_cmp_lt_u32 s20, 8
  s_cselect_b64 s[56:57], 0, s[40:41]
  s_cselect_b64 s[58:59], 0, s[42:43]
  s_cselect_b64 s[60:61], 0, s[44:45]
  s_cselect_b64 s[62:63], 0, s[46:47]
  s_mov_b32 s21, 0x3e8293ee
  v_mov_b32 v6, 0xcfa8965f
  s_waitcnt vmcnt(16)
  v_mfma_f32_16x16x32_bf16 v[136:139], v[40:43], v[8:11], 0
  v_mfma_f32_16x16x32_bf16 v[140:143], v[56:59], v[8:11], 0
  v_mfma_f32_16x16x32_bf16 v[144:147], v[44:47], v[12:15], 0
  v_mfma_f32_16x16x32_bf16 v[148:151], v[60:63], v[12:15], 0
  v_mfma_f32_16x16x32_bf16 v[152:155], v[48:51], v[16:19], 0
  v_mfma_f32_16x16x32_bf16 v[156:159], v[64:67], v[16:19], 0
  v_mfma_f32_16x16x32_bf16 v[160:163], v[52:55], v[20:23], 0
  v_mfma_f32_16x16x32_bf16 v[164:167], v[68:71], v[20:23], 0
  v_mfma_f32_16x16x32_bf16 v[168:171], v[56:59], v[24:27], 0
  v_mfma_f32_16x16x32_bf16 v[172:175], v[72:75], v[24:27], 0
  v_mfma_f32_16x16x32_bf16 v[176:179], v[60:63], v[28:31], 0
  v_mfma_f32_16x16x32_bf16 v[180:183], v[76:79], v[28:31], 0
  v_mfma_f32_16x16x32_bf16 v[184:187], v[64:67], v[32:35], 0
  v_mfma_f32_16x16x32_bf16 v[188:191], v[80:83], v[32:35], 0
  v_mfma_f32_16x16x32_bf16 v[192:195], v[68:71], v[36:39], 0
  v_mfma_f32_16x16x32_bf16 v[196:199], v[84:87], v[36:39], 0
  v_cndmask_b32 v136, v6, v136, s[56:57]
  v_cndmask_b32 v137, v6, v137, s[58:59]
  v_cndmask_b32 v138, v6, v138, s[60:61]
  v_cndmask_b32 v139, v6, v139, s[62:63]
  v_cndmask_b32 v140, v6, v140, s[48:49]
  v_cndmask_b32 v141, v6, v141, s[50:51]
  v_cndmask_b32 v142, v6, v142, s[52:53]
  v_cndmask_b32 v143, v6, v143, s[54:55]
  v_max3_f32 v4, v136, v137, v138
  v_max3_f32 v4, v4, v139, v140
  v_max3_f32 v4, v4, v141, v142
  v_max_f32 v4, v4, v143
  v_mov_b32 v5, v4
  s_nop 1
  v_permlane32_swap_b32 v4, v5
  v_max_f32 v4, v4, v5
  v_mov_b32 v5, v4
  s_nop 1
  v_permlane16_swap_b32 v4, v5
  v_max_f32 v4, v4, v5
  v_mul_f32 v4, s21, v4
  v_fma_f32 v136, v136, s21, -v4
  v_fma_f32 v137, v137, s21, -v4
  v_fma_f32 v138, v138, s21, -v4
  v_fma_f32 v139, v139, s21, -v4
  v_fma_f32 v140, v140, s21, -v4
  v_fma_f32 v141, v141, s21, -v4
  v_fma_f32 v142, v142, s21, -v4
  v_fma_f32 v143, v143, s21, -v4
  v_exp_f32 v136, v136
  v_exp_f32 v137, v137
  v_exp_f32 v138, v138
  v_exp_f32 v139, v139
  v_exp_f32 v140, v140
  v_exp_f32 v141, v141
  v_exp_f32 v142, v142
  v_exp_f32 v143, v143
  v_add_f32 v4, v136, v137
  v_add_f32 v4, v4, v138
  v_add_f32 v4, v4, v139
  v_add_f32 v4, v4, v140
  v_add_f32 v4, v4, v141
  v_add_f32 v4, v4, v142
  v_add_f32 v4, v4, v143
  v_mov_b32 v5, v4
  s_nop 1
  v_permlane32_swap_b32 v4, v5
  v_add_f32 v4, v4, v5
  v_mov_b32 v5, v4
  s_nop 1
  v_permlane16_swap_b32 v4, v5
  v_add_f32 v4, v4, v5
  v_rcp_f32 v4, v4
  s_nop 0
  v_mul_f32 v136, v136, v4
  v_mul_f32 v137, v137, v4
  v_mul_f32 v138, v138, v4
  v_mul_f32 v139, v139, v4
  v_mul_f32 v140, v140, v4
  v_mul_f32 v141, v141, v4
  v_mul_f32 v142, v142, v4
  v_mul_f32 v143, v143, v4
  v_cvt_pk_bf16_f32 v8, v136, v137
  v_cvt_pk_bf16_f32 v9, v138, v139
  v_cvt_pk_bf16_f32 v10, v140, v141
  v_cvt_pk_bf16_f32 v11, v142, v143
  v_cndmask_b32 v144, v6, v144, s[56:57]
  v_cndmask_b32 v145, v6, v145, s[58:59]
  v_cndmask_b32 v146, v6, v146, s[60:61]
  v_cndmask_b32 v147, v6, v147, s[62:63]
  v_cndmask_b32 v148, v6, v148, s[48:49]
  v_cndmask_b32 v149, v6, v149, s[50:51]
  v_cndmask_b32 v150, v6, v150, s[52:53]
  v_cndmask_b32 v151, v6, v151, s[54:55]
  v_max3_f32 v4, v144, v145, v146
  v_max3_f32 v4, v4, v147, v148
  v_max3_f32 v4, v4, v149, v150
  v_max_f32 v4, v4, v151
  v_mov_b32 v5, v4
  s_nop 1
  v_permlane32_swap_b32 v4, v5
  v_max_f32 v4, v4, v5
  v_mov_b32 v5, v4
  s_nop 1
  v_permlane16_swap_b32 v4, v5
  v_max_f32 v4, v4, v5
  v_mul_f32 v4, s21, v4
  v_fma_f32 v144, v144, s21, -v4
  v_fma_f32 v145, v145, s21, -v4
  v_fma_f32 v146, v146, s21, -v4
  v_fma_f32 v147, v147, s21, -v4
  v_fma_f32 v148, v148, s21, -v4
  v_fma_f32 v149, v149, s21, -v4
  v_fma_f32 v150, v150, s21, -v4
  v_fma_f32 v151, v151, s21, -v4
  v_exp_f32 v144, v144
  v_exp_f32 v145, v145
  v_exp_f32 v146, v146
  v_exp_f32 v147, v147
  v_exp_f32 v148, v148
  v_exp_f32 v149, v149
  v_exp_f32 v150, v150
  v_exp_f32 v151, v151
  v_add_f32 v4, v144, v145
  v_add_f32 v4, v4, v146
  v_add_f32 v4, v4, v147
  v_add_f32 v4, v4, v148
  v_add_f32 v4, v4, v149
  v_add_f32 v4, v4, v150
  v_add_f32 v4, v4, v151
  v_mov_b32 v5, v4
  s_nop 1
  v_permlane32_swap_b32 v4, v5
  v_add_f32 v4, v4, v5
  v_mov_b32 v5, v4
  s_nop 1
  v_permlane16_swap_b32 v4, v5
  v_add_f32 v4, v4, v5
  v_rcp_f32 v4, v4
  s_nop 0
  v_mul_f32 v144, v144, v4
  v_mul_f32 v145, v145, v4
  v_mul_f32 v146, v146, v4
  v_mul_f32 v147, v147, v4
  v_mul_f32 v148, v148, v4
  v_mul_f32 v149, v149, v4
  v_mul_f32 v150, v150, v4
  v_mul_f32 v151, v151, v4
  v_cvt_pk_bf16_f32 v12, v144, v145
  v_cvt_pk_bf16_f32 v13, v146, v147
  v_cvt_pk_bf16_f32 v14, v148, v149
  v_cvt_pk_bf16_f32 v15, v150, v151
  v_cndmask_b32 v152, v6, v152, s[56:57]
  v_cndmask_b32 v153, v6, v153, s[58:59]
  v_cndmask_b32 v154, v6, v154, s[60:61]
  v_cndmask_b32 v155, v6, v155, s[62:63]
  v_cndmask_b32 v156, v6, v156, s[48:49]
  v_cndmask_b32 v157, v6, v157, s[50:51]
  v_cndmask_b32 v158, v6, v158, s[52:53]
  v_cndmask_b32 v159, v6, v159, s[54:55]
  v_max3_f32 v4, v152, v153, v154
  v_max3_f32 v4, v4, v155, v156
  v_max3_f32 v4, v4, v157, v158
  v_max_f32 v4, v4, v159
  v_mov_b32 v5, v4
  s_nop 1
  v_permlane32_swap_b32 v4, v5
  v_max_f32 v4, v4, v5
  v_mov_b32 v5, v4
  s_nop 1
  v_permlane16_swap_b32 v4, v5
  v_max_f32 v4, v4, v5
  v_mul_f32 v4, s21, v4
  v_fma_f32 v152, v152, s21, -v4
  v_fma_f32 v153, v153, s21, -v4
  v_fma_f32 v154, v154, s21, -v4
  v_fma_f32 v155, v155, s21, -v4
  v_fma_f32 v156, v156, s21, -v4
  v_fma_f32 v157, v157, s21, -v4
  v_fma_f32 v158, v158, s21, -v4
  v_fma_f32 v159, v159, s21, -v4
  v_exp_f32 v152, v152
  v_exp_f32 v153, v153
  v_exp_f32 v154, v154
  v_exp_f32 v155, v155
  v_exp_f32 v156, v156
  v_exp_f32 v157, v157
  v_exp_f32 v158, v158
  v_exp_f32 v159, v159
  v_add_f32 v4, v152, v153
  v_add_f32 v4, v4, v154
  v_add_f32 v4, v4, v155
  v_add_f32 v4, v4, v156
  v_add_f32 v4, v4, v157
  v_add_f32 v4, v4, v158
  v_add_f32 v4, v4, v159
  v_mov_b32 v5, v4
  s_nop 1
  v_permlane32_swap_b32 v4, v5
  v_add_f32 v4, v4, v5
  v_mov_b32 v5, v4
  s_nop 1
  v_permlane16_swap_b32 v4, v5
  v_add_f32 v4, v4, v5
  v_rcp_f32 v4, v4
  s_nop 0
  v_mul_f32 v152, v152, v4
  v_mul_f32 v153, v153, v4
  v_mul_f32 v154, v154, v4
  v_mul_f32 v155, v155, v4
  v_mul_f32 v156, v156, v4
  v_mul_f32 v157, v157, v4
  v_mul_f32 v158, v158, v4
  v_mul_f32 v159, v159, v4
  v_cvt_pk_bf16_f32 v16, v152, v153
  v_cvt_pk_bf16_f32 v17, v154, v155
  v_cvt_pk_bf16_f32 v18, v156, v157
  v_cvt_pk_bf16_f32 v19, v158, v159
  v_cndmask_b32 v160, v6, v160, s[56:57]
  v_cndmask_b32 v161, v6, v161, s[58:59]
  v_cndmask_b32 v162, v6, v162, s[60:61]
  v_cndmask_b32 v163, v6, v163, s[62:63]
  v_cndmask_b32 v164, v6, v164, s[48:49]
  v_cndmask_b32 v165, v6, v165, s[50:51]
  v_cndmask_b32 v166, v6, v166, s[52:53]
  v_cndmask_b32 v167, v6, v167, s[54:55]
  v_max3_f32 v4, v160, v161, v162
  v_max3_f32 v4, v4, v163, v164
  v_max3_f32 v4, v4, v165, v166
  v_max_f32 v4, v4, v167
  v_mov_b32 v5, v4
  s_nop 1
  v_permlane32_swap_b32 v4, v5
  v_max_f32 v4, v4, v5
  v_mov_b32 v5, v4
  s_nop 1
  v_permlane16_swap_b32 v4, v5
  v_max_f32 v4, v4, v5
  v_mul_f32 v4, s21, v4
  v_fma_f32 v160, v160, s21, -v4
  v_fma_f32 v161, v161, s21, -v4
  v_fma_f32 v162, v162, s21, -v4
  v_fma_f32 v163, v163, s21, -v4
  v_fma_f32 v164, v164, s21, -v4
  v_fma_f32 v165, v165, s21, -v4
  v_fma_f32 v166, v166, s21, -v4
  v_fma_f32 v167, v167, s21, -v4
  v_exp_f32 v160, v160
  v_exp_f32 v161, v161
  v_exp_f32 v162, v162
  v_exp_f32 v163, v163
  v_exp_f32 v164, v164
  v_exp_f32 v165, v165
  v_exp_f32 v166, v166
  v_exp_f32 v167, v167
  v_add_f32 v4, v160, v161
  v_add_f32 v4, v4, v162
  v_add_f32 v4, v4, v163
  v_add_f32 v4, v4, v164
  v_add_f32 v4, v4, v165
  v_add_f32 v4, v4, v166
  v_add_f32 v4, v4, v167
  v_mov_b32 v5, v4
  s_nop 1
  v_permlane32_swap_b32 v4, v5
  v_add_f32 v4, v4, v5
  v_mov_b32 v5, v4
  s_nop 1
  v_permlane16_swap_b32 v4, v5
  v_add_f32 v4, v4, v5
  v_rcp_f32 v4, v4
  s_nop 0
  v_mul_f32 v160, v160, v4
  v_mul_f32 v161, v161, v4
  v_mul_f32 v162, v162, v4
  v_mul_f32 v163, v163, v4
  v_mul_f32 v164, v164, v4
  v_mul_f32 v165, v165, v4
  v_mul_f32 v166, v166, v4
  v_mul_f32 v167, v167, v4
  v_cvt_pk_bf16_f32 v20, v160, v161
  v_cvt_pk_bf16_f32 v21, v162, v163
  v_cvt_pk_bf16_f32 v22, v164, v165
  v_cvt_pk_bf16_f32 v23, v166, v167
  v_cndmask_b32 v168, v6, v168, s[40:41]
  v_cndmask_b32 v169, v6, v169, s[42:43]
  v_cndmask_b32 v170, v6, v170, s[44:45]
  v_cndmask_b32 v171, v6, v171, s[46:47]
  v_cndmask_b32 v172, v6, v172, s[48:49]
  v_cndmask_b32 v173, v6, v173, s[50:51]
  v_cndmask_b32 v174, v6, v174, s[52:53]
  v_cndmask_b32 v175, v6, v175, s[54:55]
  v_max3_f32 v4, v168, v169, v170
  v_max3_f32 v4, v4, v171, v172
  v_max3_f32 v4, v4, v173, v174
  v_max_f32 v4, v4, v175
  v_mov_b32 v5, v4
  s_nop 1
  v_permlane32_swap_b32 v4, v5
  v_max_f32 v4, v4, v5
  v_mov_b32 v5, v4
  s_nop 1
  v_permlane16_swap_b32 v4, v5
  v_max_f32 v4, v4, v5
  v_mul_f32 v4, s21, v4
  v_fma_f32 v168, v168, s21, -v4
  v_fma_f32 v169, v169, s21, -v4
  v_fma_f32 v170, v170, s21, -v4
  v_fma_f32 v171, v171, s21, -v4
  v_fma_f32 v172, v172, s21, -v4
  v_fma_f32 v173, v173, s21, -v4
  v_fma_f32 v174, v174, s21, -v4
  v_fma_f32 v175, v175, s21, -v4
  v_exp_f32 v168, v168
  v_exp_f32 v169, v169
  v_exp_f32 v170, v170
  v_exp_f32 v171, v171
  v_exp_f32 v172, v172
  v_exp_f32 v173, v173
  v_exp_f32 v174, v174
  v_exp_f32 v175, v175
  v_add_f32 v4, v168, v169
  v_add_f32 v4, v4, v170
  v_add_f32 v4, v4, v171
  v_add_f32 v4, v4, v172
  v_add_f32 v4, v4, v173
  v_add_f32 v4, v4, v174
  v_add_f32 v4, v4, v175
  v_mov_b32 v5, v4
  s_nop 1
  v_permlane32_swap_b32 v4, v5
  v_add_f32 v4, v4, v5
  v_mov_b32 v5, v4
  s_nop 1
  v_permlane16_swap_b32 v4, v5
  v_add_f32 v4, v4, v5
  v_rcp_f32 v4, v4
  s_nop 0
  v_mul_f32 v168, v168, v4
  v_mul_f32 v169, v169, v4
  v_mul_f32 v170, v170, v4
  v_mul_f32 v171, v171, v4
  v_mul_f32 v172, v172, v4
  v_mul_f32 v173, v173, v4
  v_mul_f32 v174, v174, v4
  v_mul_f32 v175, v175, v4
  v_cvt_pk_bf16_f32 v24, v168, v169
  v_cvt_pk_bf16_f32 v25, v170, v171
  v_cvt_pk_bf16_f32 v26, v172, v173
  v_cvt_pk_bf16_f32 v27, v174, v175
  v_cndmask_b32 v176, v6, v176, s[40:41]
  v_cndmask_b32 v177, v6, v177, s[42:43]
  v_cndmask_b32 v178, v6, v178, s[44:45]
  v_cndmask_b32 v179, v6, v179, s[46:47]
  v_cndmask_b32 v180, v6, v180, s[48:49]
  v_cndmask_b32 v181, v6, v181, s[50:51]
  v_cndmask_b32 v182, v6, v182, s[52:53]
  v_cndmask_b32 v183, v6, v183, s[54:55]
  v_max3_f32 v4, v176, v177, v178
  v_max3_f32 v4, v4, v179, v180
  v_max3_f32 v4, v4, v181, v182
  v_max_f32 v4, v4, v183
  v_mov_b32 v5, v4
  s_nop 1
  v_permlane32_swap_b32 v4, v5
  v_max_f32 v4, v4, v5
  v_mov_b32 v5, v4
  s_nop 1
  v_permlane16_swap_b32 v4, v5
  v_max_f32 v4, v4, v5
  v_mul_f32 v4, s21, v4
  v_fma_f32 v176, v176, s21, -v4
  v_fma_f32 v177, v177, s21, -v4
  v_fma_f32 v178, v178, s21, -v4
  v_fma_f32 v179, v179, s21, -v4
  v_fma_f32 v180, v180, s21, -v4
  v_fma_f32 v181, v181, s21, -v4
  v_fma_f32 v182, v182, s21, -v4
  v_fma_f32 v183, v183, s21, -v4
  v_exp_f32 v176, v176
  v_exp_f32 v177, v177
  v_exp_f32 v178, v178
  v_exp_f32 v179, v179
  v_exp_f32 v180, v180
  v_exp_f32 v181, v181
  v_exp_f32 v182, v182
  v_exp_f32 v183, v183
  v_add_f32 v4, v176, v177
  v_add_f32 v4, v4, v178
  v_add_f32 v4, v4, v179
  v_add_f32 v4, v4, v180
  v_add_f32 v4, v4, v181
  v_add_f32 v4, v4, v182
  v_add_f32 v4, v4, v183
  v_mov_b32 v5, v4
  s_nop 1
  v_permlane32_swap_b32 v4, v5
  v_add_f32 v4, v4, v5
  v_mov_b32 v5, v4
  s_nop 1
  v_permlane16_swap_b32 v4, v5
  v_add_f32 v4, v4, v5
  v_rcp_f32 v4, v4
  s_nop 0
  v_mul_f32 v176, v176, v4
  v_mul_f32 v177, v177, v4
  v_mul_f32 v178, v178, v4
  v_mul_f32 v179, v179, v4
  v_mul_f32 v180, v180, v4
  v_mul_f32 v181, v181, v4
  v_mul_f32 v182, v182, v4
  v_mul_f32 v183, v183, v4
  v_cvt_pk_bf16_f32 v28, v176, v177
  v_cvt_pk_bf16_f32 v29, v178, v179
  v_cvt_pk_bf16_f32 v30, v180, v181
  v_cvt_pk_bf16_f32 v31, v182, v183
  v_cndmask_b32 v184, v6, v184, s[40:41]
  v_cndmask_b32 v185, v6, v185, s[42:43]
  v_cndmask_b32 v186, v6, v186, s[44:45]
  v_cndmask_b32 v187, v6, v187, s[46:47]
  v_cndmask_b32 v188, v6, v188, s[48:49]
  v_cndmask_b32 v189, v6, v189, s[50:51]
  v_cndmask_b32 v190, v6, v190, s[52:53]
  v_cndmask_b32 v191, v6, v191, s[54:55]
  v_max3_f32 v4, v184, v185, v186
  v_max3_f32 v4, v4, v187, v188
  v_max3_f32 v4, v4, v189, v190
  v_max_f32 v4, v4, v191
  v_mov_b32 v5, v4
  s_nop 1
  v_permlane32_swap_b32 v4, v5
  v_max_f32 v4, v4, v5
  v_mov_b32 v5, v4
  s_nop 1
  v_permlane16_swap_b32 v4, v5
  v_max_f32 v4, v4, v5
  v_mul_f32 v4, s21, v4
  v_fma_f32 v184, v184, s21, -v4
  v_fma_f32 v185, v185, s21, -v4
  v_fma_f32 v186, v186, s21, -v4
  v_fma_f32 v187, v187, s21, -v4
  v_fma_f32 v188, v188, s21, -v4
  v_fma_f32 v189, v189, s21, -v4
  v_fma_f32 v190, v190, s21, -v4
  v_fma_f32 v191, v191, s21, -v4
  v_exp_f32 v184, v184
  v_exp_f32 v185, v185
  v_exp_f32 v186, v186
  v_exp_f32 v187, v187
  v_exp_f32 v188, v188
  v_exp_f32 v189, v189
  v_exp_f32 v190, v190
  v_exp_f32 v191, v191
  v_add_f32 v4, v184, v185
  v_add_f32 v4, v4, v186
  v_add_f32 v4, v4, v187
  v_add_f32 v4, v4, v188
  v_add_f32 v4, v4, v189
  v_add_f32 v4, v4, v190
  v_add_f32 v4, v4, v191
  v_mov_b32 v5, v4
  s_nop 1
  v_permlane32_swap_b32 v4, v5
  v_add_f32 v4, v4, v5
  v_mov_b32 v5, v4
  s_nop 1
  v_permlane16_swap_b32 v4, v5
  v_add_f32 v4, v4, v5
  v_rcp_f32 v4, v4
  s_nop 0
  v_mul_f32 v184, v184, v4
  v_mul_f32 v185, v185, v4
  v_mul_f32 v186, v186, v4
  v_mul_f32 v187, v187, v4
  v_mul_f32 v188, v188, v4
  v_mul_f32 v189, v189, v4
  v_mul_f32 v190, v190, v4
  v_mul_f32 v191, v191, v4
  v_cvt_pk_bf16_f32 v32, v184, v185
  v_cvt_pk_bf16_f32 v33, v186, v187
  v_cvt_pk_bf16_f32 v34, v188, v189
  v_cvt_pk_bf16_f32 v35, v190, v191
  v_cndmask_b32 v192, v6, v192, s[40:41]
  v_cndmask_b32 v193, v6, v193, s[42:43]
  v_cndmask_b32 v194, v6, v194, s[44:45]
  v_cndmask_b32 v195, v6, v195, s[46:47]
  v_cndmask_b32 v196, v6, v196, s[48:49]
  v_cndmask_b32 v197, v6, v197, s[50:51]
  v_cndmask_b32 v198, v6, v198, s[52:53]
  v_cndmask_b32 v199, v6, v199, s[54:55]
  v_max3_f32 v4, v192, v193, v194
  v_max3_f32 v4, v4, v195, v196
  v_max3_f32 v4, v4, v197, v198
  v_max_f32 v4, v4, v199
  v_mov_b32 v5, v4
  s_nop 1
  v_permlane32_swap_b32 v4, v5
  v_max_f32 v4, v4, v5
  v_mov_b32 v5, v4
  s_nop 1
  v_permlane16_swap_b32 v4, v5
  v_max_f32 v4, v4, v5
  v_mul_f32 v4, s21, v4
  v_fma_f32 v192, v192, s21, -v4
  v_fma_f32 v193, v193, s21, -v4
  v_fma_f32 v194, v194, s21, -v4
  v_fma_f32 v195, v195, s21, -v4
  v_fma_f32 v196, v196, s21, -v4
  v_fma_f32 v197, v197, s21, -v4
  v_fma_f32 v198, v198, s21, -v4
  v_fma_f32 v199, v199, s21, -v4
  v_exp_f32 v192, v192
  v_exp_f32 v193, v193
  v_exp_f32 v194, v194
  v_exp_f32 v195, v195
  v_exp_f32 v196, v196
  v_exp_f32 v197, v197
  v_exp_f32 v198, v198
  v_exp_f32 v199, v199
  v_add_f32 v4, v192, v193
  v_add_f32 v4, v4, v194
  v_add_f32 v4, v4, v195
  v_add_f32 v4, v4, v196
  v_add_f32 v4, v4, v197
  v_add_f32 v4, v4, v198
  v_add_f32 v4, v4, v199
  v_mov_b32 v5, v4
  s_nop 1
  v_permlane32_swap_b32 v4, v5
  v_add_f32 v4, v4, v5
  v_mov_b32 v5, v4
  s_nop 1
  v_permlane16_swap_b32 v4, v5
  v_add_f32 v4, v4, v5
  v_rcp_f32 v4, v4
  s_nop 0
  v_mul_f32 v192, v192, v4
  v_mul_f32 v193, v193, v4
  v_mul_f32 v194, v194, v4
  v_mul_f32 v195, v195, v4
  v_mul_f32 v196, v196, v4
  v_mul_f32 v197, v197, v4
  v_mul_f32 v198, v198, v4
  v_mul_f32 v199, v199, v4
  v_cvt_pk_bf16_f32 v36, v192, v193
  v_cvt_pk_bf16_f32 v37, v194, v195
  v_cvt_pk_bf16_f32 v38, v196, v197
  v_cvt_pk_bf16_f32 v39, v198, v199
  s_waitcnt vmcnt(0)
  s_cmp_lg_u32 s32, 0
  s_cbranch_scc1 L_rq_16
  s_cmp_eq_u32 s39, 0
  s_cbranch_scc1 L_rq_16
  s_lshl_b32 s99, s33, 7
  s_add_u32 s99, s99, 0x3d00200
  v_mov_b32 v244, 1
  v_mov_b32 v245, 0
  s_mov_b64 exec, 1
  buffer_atomic_add v244, v245, s[4:7], s99 offen sc0 sc1
  s_mov_b64 exec, -1
L_rq_16:
  v_mfma_f32_16x16x32_bf16 v[136:139], v[88:91], v[8:11], 0
  v_mfma_f32_16x16x32_bf16 v[140:143], v[94:97], v[8:11], 0
  v_mfma_f32_16x16x32_bf16 v[144:147], v[100:103], v[12:15], 0
  v_mfma_f32_16x16x32_bf16 v[148:151], v[106:109], v[12:15], 0
  v_mfma_f32_16x16x32_bf16 v[152:155], v[112:115], v[16:19], 0
  v_mfma_f32_16x16x32_bf16 v[156:159], v[118:121], v[16:19], 0
  v_mfma_f32_16x16x32_bf16 v[160:163], v[124:127], v[20:23], 0
  v_mfma_f32_16x16x32_bf16 v[164:167], v[130:133], v[20:23], 0
  v_mfma_f32_16x16x32_bf16 v[168:171], v[90:93], v[24:27], 0
  v_mfma_f32_16x16x32_bf16 v[172:175], v[96:99], v[24:27], 0
  v_mfma_f32_16x16x32_bf16 v[176:179], v[102:105], v[28:31], 0
  v_mfma_f32_16x16x32_bf16 v[180:183], v[108:111], v[28:31], 0
  v_mfma_f32_16x16x32_bf16 v[184:187], v[114:117], v[32:35], 0
  v_mfma_f32_16x16x32_bf16 v[188:191], v[120:123], v[32:35], 0
  v_mfma_f32_16x16x32_bf16 v[192:195], v[126:129], v[36:39], 0
  v_mfma_f32_16x16x32_bf16 v[196:199], v[132:135], v[36:39], 0
  v_cvt_pk_bf16_f32 v40, v136, v137
  v_cvt_pk_bf16_f32 v41, v138, v139
  v_cvt_pk_bf16_f32 v42, v140, v141
  v_cvt_pk_bf16_f32 v43, v142, v143
  buffer_store_dwordx4 v[40:43], v2, s[4:7], s97 offen offset:0 sc1
  v_cvt_pk_bf16_f32 v44, v144, v145
  v_cvt_pk_bf16_f32 v45, v146, v147
  v_cvt_pk_bf16_f32 v46, v148, v149
  v_cvt_pk_bf16_f32 v47, v150, v151
  buffer_store_dwordx4 v[44:47], v2, s[4:7], s97 offen offset:1024 sc1
  v_cvt_pk_bf16_f32 v48, v152, v153
  v_cvt_pk_bf16_f32 v49, v154, v155
  v_cvt_pk_bf16_f32 v50, v156, v157
  v_cvt_pk_bf16_f32 v51, v158, v159
  buffer_store_dwordx4 v[48:51], v2, s[4:7], s97 offen offset:2048 sc1
  v_cvt_pk_bf16_f32 v52, v160, v161
  v_cvt_pk_bf16_f32 v53, v162, v163
  v_cvt_pk_bf16_f32 v54, v164, v165
  v_cvt_pk_bf16_f32 v55, v166, v167
  buffer_store_dwordx4 v[52:55], v2, s[4:7], s97 offen offset:3072 sc1
  v_cvt_pk_bf16_f32 v56, v168, v169
  v_cvt_pk_bf16_f32 v57, v170, v171
  v_cvt_pk_bf16_f32 v58, v172, v173
  v_cvt_pk_bf16_f32 v59, v174, v175
  buffer_store_dwordx4 v[56:59], v3, s[4:7], s97 offen offset:0 sc1
  v_cvt_pk_bf16_f32 v60, v176, v177
  v_cvt_pk_bf16_f32 v61, v178, v179
  v_cvt_pk_bf16_f32 v62, v180, v181
  v_cvt_pk_bf16_f32 v63, v182, v183
  buffer_store_dwordx4 v[60:63], v3, s[4:7], s97 offen offset:1024 sc1
  v_cvt_pk_bf16_f32 v64, v184, v185
  v_cvt_pk_bf16_f32 v65, v186, v187
  v_cvt_pk_bf16_f32 v66, v188, v189
  v_cvt_pk_bf16_f32 v67, v190, v191
  buffer_store_dwordx4 v[64:67], v3, s[4:7], s97 offen offset:2048 sc1
  v_cvt_pk_bf16_f32 v68, v192, v193
  v_cvt_pk_bf16_f32 v69, v194, v195
  v_cvt_pk_bf16_f32 v70, v196, v197
  v_cvt_pk_bf16_f32 v71, v198, v199
  buffer_store_dwordx4 v[68:71], v3, s[4:7], s97 offen offset:3072 sc1
  s_branch L_done
L_ata:
  s_lshr_b32 s40, s36, 3
  s_lshl_b32 s40, s40, 9
  s_lshl_b32 s90, s33, 7
  s_add_u32 s40, s40, s90
  s_add_u32 s41, s36, 1
  s_lshr_b32 s43, s36, 2
  s_lshl_b32 s43, s43, 9
  s_add_u32 s43, s43, s90
  s_add_u32 s43, s43, 28672
  s_lshl_b32 s42, s33, 1
  s_add_u32 s42, s42, s37
  s_lshl_b32 s42, s42, 7
  s_add_u32 s42, s42, 4096
  s_cmp_lg_u32 s32, 0
  s_cbranch_scc1 L_dd_18
  v_mov_b32 v228, 0x3d00000
  v_mov_b32 v230, 0x3d02000
L_dw_17:
  buffer_load_dword v234, v230, s[4:7], s40 offen offset:0 sc1
  buffer_load_dword v235, v228, s[4:7], s43 offen offset:0 sc1
  s_waitcnt vmcnt(0)
  s_mov_b32 s44, 1
  v_readfirstlane_b32 s45, v234
  s_cmp_ge_u32 s45, 4
  s_cselect_b32 s44, s44, 0
  v_readfirstlane_b32 s45, v235
  s_cmp_ge_u32 s45, 16
  s_cselect_b32 s44, s44, 0
  s_cmp_eq_u32 s44, 1
  s_cbranch_scc1 L_dd_18
  s_sleep 6
  s_add_u32 s3, s3, 1
  s_cmp_lt_u32 s3, 131072
  s_cbranch_scc1 L_dw_17
L_dd_18:
  s_barrier
  s_mov_b32 s98, 1
  s_lshr_b32 s38, s36, 2
  s_lshl_b32 s38, s38, 7
  s_add_u32 s38, s38, 2048
  s_lshr_b32 s90, s36, 1
  s_sub_u32 s90, s90, 24
  s_lshl_b32 s90, s90, 2
  s_add_u32 s90, s90, s33
  s_lshl_b32 s90, s90, 1
  s_add_u32 s90, s90, s37
  s_lshl_b32 s90, s90, 7
  s_add_u32 s90, s90, 20480
  s_cmp_ge_u32 s36, 52
  s_cselect_b32 s38, s90, s38
  s_lshl_b32 s20, s36, 5
  s_lshl_b32 s90, s33, 3
  s_add_u32 s20, s20, s90
  s_lshl_b32 s90, s37, 2
  s_add_u32 s20, s20, s90
  s_add_u32 s20, s20, s32
  v_and_b32 v1, 63, v0
  s_lshl_b32 s90, s20, 13
  s_lshl_b32 s91, s20, 11
  v_mov_b32 v2, 0x0
  v_bfe_u32 v7, v1, 0, 6
  v_lshl_add_u32 v2, v7, 4, v2
  v_add_u32 v3, 4096, v2
  v_mov_b32 v4, 0x3000000
  v_bfe_u32 v7, v1, 0, 1
  v_lshl_add_u32 v4, v7, 4, v4
  v_bfe_u32 v7, v1, 2, 2
  v_lshl_add_u32 v4, v7, 5, v4
  v_bfe_u32 v7, v1, 4, 2
  v_lshl_add_u32 v4, v7, 7, v4
  v_add_u32 v5, 0x3400000, v2
  v_mov_b32 v8, 0x0
  v_bfe_u32 v7, v1, 0, 3
  v_lshl_add_u32 v8, v7, 4, v8
  v_bfe_u32 v7, v1, 3, 1
  v_lshl_add_u32 v8, v7, 11, v8
  v_bfe_u32 v7, v1, 4, 2
  v_lshl_add_u32 v8, v7, 8, v8
  v_add_u32 v9, 4096, v8
  v_mov_b32 v10, 0x0
  v_bfe_u32 v7, v1, 0, 4
  v_lshl_add_u32 v10, v7, 4, v10
  v_bfe_u32 v7, v1, 4, 1
  v_lshl_add_u32 v10, v7, 8, v10
  v_bfe_u32 v7, v1, 5, 1
  v_lshl_add_u32 v10, v7, 10, v10
  v_add_u32 v11, 4096, v10
  s_add_u32 s92, s90, 16777216
  s_add_u32 s93, s90, 33554432
  s_add_u32 s94, s90, 0
  s_add_u32 s95, s90, 83886080
  buffer_load_dwordx4 v[16:19], v2, s[4:7], s94 offen offset:0 sc1
  buffer_load_dwordx4 v[20:23], v2, s[4:7], s94 offen offset:1024 sc1
  buffer_load_dwordx4 v[24:27], v2, s[4:7], s94 offen offset:2048 sc1
  buffer_load_dwordx4 v[28:31], v2, s[4:7], s94 offen offset:3072 sc1
  buffer_load_dwordx4 v[32:35], v3, s[4:7], s94 offen offset:0 sc1
  buffer_load_dwordx4 v[36:39], v3, s[4:7], s94 offen offset:1024 sc1
  buffer_load_dwordx4 v[40:43], v3, s[4:7], s94 offen offset:2048 sc1
  buffer_load_dwordx4 v[44:47], v3, s[4:7], s94 offen offset:3072 sc1
  buffer_load_dwordx4 v[48:51], v2, s[4:7], s92 offen offset:0 sc1
  buffer_load_dwordx4 v[52:55], v2, s[4:7], s92 offen offset:1024 sc1
  buffer_load_dwordx4 v[56:59], v2, s[4:7], s92 offen offset:2048 sc1
  buffer_load_dwordx4 v[60:63], v2, s[4:7], s92 offen offset:3072 sc1
  buffer_load_dwordx4 v[64:67], v3, s[4:7], s92 offen offset:0 sc1
  buffer_load_dwordx4 v[68:71], v3, s[4:7], s92 offen offset:1024 sc1
  buffer_load_dwordx4 v[72:75], v3, s[4:7], s92 offen offset:2048 sc1
  buffer_load_dwordx4 v[76:79], v3, s[4:7], s92 offen offset:3072 sc1
  buffer_load_dwordx4 v[80:83], v8, s[4:7], s93 offen offset:0 sc1
  buffer_load_dwordx4 v[84:87], v8, s[4:7], s93 offen offset:128 sc1
  buffer_load_dwordx4 v[88:91], v8, s[4:7], s93 offen offset:1024 sc1
  buffer_load_dwordx4 v[92:95], v8, s[4:7], s93 offen offset:1152 sc1
  buffer_load_dwordx4 v[96:99], v9, s[4:7], s93 offen offset:0 sc1
  buffer_load_dwordx4 v[100:103], v9, s[4:7], s93 offen offset:128 sc1
  buffer_load_dwordx4 v[104:107], v9, s[4:7], s93 offen offset:1024 sc1
  buffer_load_dwordx4 v[108:111], v9, s[4:7], s93 offen offset:1152 sc1
  s_cmp_lg_u32 s32, 0
  s_cbranch_scc1 L_dd_20
  v_mov_b32 v228, 0x3d00000
L_dw_19:
  s_lshl_b32 s45, s33, 7
  buffer_load_dword v238, v228, s[4:7], s45 offen offset:0 sc1
  buffer_load_dword v239, v228, s[4:7], s42 offen sc1
  s_waitcnt vmcnt(0)
  s_mov_b32 s44, 1
  v_readfirstlane_b32 s45, v238
  v_readfirstlane_b32 s47, v239
  s_cmp_ge_u32 s47, 16
  s_cselect_b32 s45, 64, s45
  s_cmp_ge_u32 s45, s41
  s_cselect_b32 s44, s44, 0
  s_cmp_eq_u32 s44, 1
  s_cbranch_scc1 L_dd_20
  s_sleep 3
  s_add_u32 s3, s3, 1
  s_cmp_lt_u32 s3, 131072
  s_cbranch_scc1 L_dw_19
L_dd_20:
  s_barrier
  buffer_load_dwordx4 v[112:115], v4, s[4:7], s91 offen offset:0 sc1
  buffer_load_dwordx4 v[116:119], v4, s[4:7], s91 offen offset:512 sc1
  buffer_load_dwordx4 v[120:123], v4, s[4:7], s91 offen offset:1024 sc1
  buffer_load_dwordx4 v[124:127], v4, s[4:7], s91 offen offset:1536 sc1
  buffer_load_dwordx4 v[128:131], v5, s[4:7], s91 offen offset:0 sc1
  buffer_load_dwordx4 v[132:135], v5, s[4:7], s91 offen offset:1024 sc1
  s_add_u32 s92, s92, 262144
  s_add_u32 s93, s93, 262144
  s_add_u32 s94, s94, 262144
  s_add_u32 s91, s91, 65536
  s_mov_b32 s40, 0xfff0ffff
  s_mov_b32 s41, 0xf000ff00
  s_mov_b32 s42, 0xffe0fffe
  s_mov_b32 s43, 0xe000fe00
  s_mov_b32 s44, 0xffc0fffc
  s_mov_b32 s45, 0xc000fc00
  s_mov_b32 s46, 0xff80fff8
  s_mov_b32 s47, 0x8000f800
  s_mov_b32 s50, 0x3e0293ee
  v_mov_b32 v6, 0xd028965f
  s_waitcnt vmcnt(0)
  s_cmp_lg_u32 s32, 0
  s_cbranch_scc1 L_rq_21
  s_cmp_eq_u32 s39, 0
  s_cbranch_scc1 L_rq_21
  s_lshl_b32 s99, s33, 7
  s_add_u32 s99, s99, 0x3d00200
  v_mov_b32 v244, 1
  v_mov_b32 v245, 0
  s_mov_b64 exec, 1
  buffer_atomic_add v244, v245, s[4:7], s99 offen sc0 sc1
  s_mov_b64 exec, -1
L_rq_21:
  v_mfma_f32_16x16x32_bf16 v[136:139], v[112:115], v[16:19], 0
  v_mfma_f32_16x16x32_bf16 v[140:143], v[48:51], v[16:19], 0
  v_mfma_f32_16x16x32_bf16 v[144:147], v[112:115], v[32:35], 0
  v_mfma_f32_16x16x32_bf16 v[148:151], v[48:51], v[32:35], 0
  v_mfma_f32_16x16x32_bf16 v[152:155], v[64:67], v[32:35], 0
  v_mfma_f32_16x16x32_bf16 v[136:139], v[116:119], v[20:23], v[136:139]
  v_mfma_f32_16x16x32_bf16 v[140:143], v[52:55], v[20:23], v[140:143]
  v_mfma_f32_16x16x32_bf16 v[144:147], v[116:119], v[36:39], v[144:147]
  v_mfma_f32_16x16x32_bf16 v[148:151], v[52:55], v[36:39], v[148:151]
  v_mfma_f32_16x16x32_bf16 v[152:155], v[68:71], v[36:39], v[152:155]
  v_mfma_f32_16x16x32_bf16 v[136:139], v[120:123], v[24:27], v[136:139]
  v_mfma_f32_16x16x32_bf16 v[140:143], v[56:59], v[24:27], v[140:143]
  v_mfma_f32_16x16x32_bf16 v[144:147], v[120:123], v[40:43], v[144:147]
  v_mfma_f32_16x16x32_bf16 v[148:151], v[56:59], v[40:43], v[148:151]
  v_mfma_f32_16x16x32_bf16 v[152:155], v[72:75], v[40:43], v[152:155]
  v_mfma_f32_16x16x32_bf16 v[136:139], v[124:127], v[28:31], v[136:139]
  v_mfma_f32_16x16x32_bf16 v[140:143], v[60:63], v[28:31], v[140:143]
  v_mfma_f32_16x16x32_bf16 v[144:147], v[124:127], v[44:47], v[144:147]
  v_mfma_f32_16x16x32_bf16 v[148:151], v[60:63], v[44:47], v[148:151]
  v_mfma_f32_16x16x32_bf16 v[152:155], v[76:79], v[44:47], v[152:155]
  s_nop 4
  v_cndmask_b32 v140, v6, v140, s[40:41]
  v_cndmask_b32 v141, v6, v141, s[42:43]
  v_cndmask_b32 v142, v6, v142, s[44:45]
  v_cndmask_b32 v143, v6, v143, s[46:47]
  v_max3_f32 v12, v136, v137, v140
  v_max3_f32 v12, v12, v141, v142
  v_max_f32 v12, v12, v143
  v_mov_b32 v13, v12
  s_nop 1
  v_permlane32_swap_b32 v12, v13
  v_max_f32 v12, v12, v13
  v_mov_b32 v13, v12
  s_nop 1
  v_permlane16_swap_b32 v12, v13
  v_max_f32 v12, v12, v13
  v_mul_f32 v12, s50, v12
  v_fma_f32 v136, v136, s50, -v12
  v_fma_f32 v137, v137, s50, -v12
  v_fma_f32 v140, v140, s50, -v12
  v_fma_f32 v141, v141, s50, -v12
  v_fma_f32 v142, v142, s50, -v12
  v_fma_f32 v143, v143, s50, -v12
  v_exp_f32 v136, v136
  v_exp_f32 v137, v137
  v_exp_f32 v140, v140
  v_exp_f32 v141, v141
  v_exp_f32 v142, v142
  v_exp_f32 v143, v143
  v_add_f32 v12, v136, v137
  v_add_f32 v12, v12, v140
  v_add_f32 v12, v12, v141
  v_add_f32 v12, v12, v142
  v_add_f32 v12, v12, v143
  v_mov_b32 v13, v12
  s_nop 1
  v_permlane32_swap_b32 v12, v13
  v_add_f32 v12, v12, v13
  v_mov_b32 v13, v12
  s_nop 1
  v_permlane16_swap_b32 v12, v13
  v_add_f32 v12, v12, v13
  v_rcp_f32 v12, v12
  s_nop 0
  v_mul_f32 v136, v136, v12
  v_mul_f32 v137, v137, v12
  v_mul_f32 v140, v140, v12
  v_mul_f32 v141, v141, v12
  v_mul_f32 v142, v142, v12
  v_mul_f32 v143, v143, v12
  v_cvt_pk_bf16_f32 v160, v136, v137
  v_mov_b32 v161, 0
  v_mov_b32 v162, 0
  v_mov_b32 v163, v160
  v_cvt_pk_bf16_f32 v156, v140, v141
  v_cvt_pk_bf16_f32 v157, v142, v143
  v_mov_b32 v158, 0
  v_mov_b32 v159, 0
  v_cndmask_b32 v152, v6, v152, s[40:41]
  v_cndmask_b32 v153, v6, v153, s[42:43]
  v_cndmask_b32 v154, v6, v154, s[44:45]
  v_cndmask_b32 v155, v6, v155, s[46:47]
  v_max3_f32 v12, v144, v145, v148
  v_max3_f32 v12, v12, v149, v150
  v_max3_f32 v12, v12, v151, v152
  v_max3_f32 v12, v12, v153, v154
  v_max_f32 v12, v12, v155
  v_mov_b32 v13, v12
  s_nop 1
  v_permlane32_swap_b32 v12, v13
  v_max_f32 v12, v12, v13
  v_mov_b32 v13, v12
  s_nop 1
  v_permlane16_swap_b32 v12, v13
  v_max_f32 v12, v12, v13
  v_mul_f32 v12, s50, v12
  v_fma_f32 v144, v144, s50, -v12
  v_fma_f32 v145, v145, s50, -v12
  v_fma_f32 v148, v148, s50, -v12
  v_fma_f32 v149, v149, s50, -v12
  v_fma_f32 v150, v150, s50, -v12
  v_fma_f32 v151, v151, s50, -v12
  v_fma_f32 v152, v152, s50, -v12
  v_fma_f32 v153, v153, s50, -v12
  v_fma_f32 v154, v154, s50, -v12
  v_fma_f32 v155, v155, s50, -v12
  v_exp_f32 v144, v144
  v_exp_f32 v145, v145
  v_exp_f32 v148, v148
  v_exp_f32 v149, v149
  v_exp_f32 v150, v150
  v_exp_f32 v151, v151
  v_exp_f32 v152, v152
  v_exp_f32 v153, v153
  v_exp_f32 v154, v154
  v_exp_f32 v155, v155
  v_add_f32 v12, v144, v145
  v_add_f32 v12, v12, v148
  v_add_f32 v12, v12, v149
  v_add_f32 v12, v12, v150
  v_add_f32 v12, v12, v151
  v_add_f32 v12, v12, v152
  v_add_f32 v12, v12, v153
  v_add_f32 v12, v12, v154
  v_add_f32 v12, v12, v155
  v_mov_b32 v13, v12
  s_nop 1
  v_permlane32_swap_b32 v12, v13
  v_add_f32 v12, v12, v13
  v_mov_b32 v13, v12
  s_nop 1
  v_permlane16_swap_b32 v12, v13
  v_add_f32 v12, v12, v13
  v_rcp_f32 v12, v12
  s_nop 0
  v_mul_f32 v144, v144, v12
  v_mul_f32 v145, v145, v12
  v_mul_f32 v148, v148, v12
  v_mul_f32 v149, v149, v12
  v_mul_f32 v150, v150, v12
  v_mul_f32 v151, v151, v12
  v_mul_f32 v152, v152, v12
  v_mul_f32 v153, v153, v12
  v_mul_f32 v154, v154, v12
  v_mul_f32 v155, v155, v12
  v_cvt_pk_bf16_f32 v168, v144, v145
  v_mov_b32 v169, 0
  v_mov_b32 v170, 0
  v_mov_b32 v171, v168
  v_cvt_pk_bf16_f32 v164, v148, v149
  v_cvt_pk_bf16_f32 v165, v150, v151
  v_cvt_pk_bf16_f32 v166, v152, v153
  v_cvt_pk_bf16_f32 v167, v154, v155
  v_mfma_f32_16x16x32_bf16 v[176:179], v[80:83], v[156:159], 0
  v_mfma_f32_16x16x32_bf16 v[180:183], v[84:87], v[156:159], 0
  v_mfma_f32_16x16x32_bf16 v[184:187], v[88:91], v[156:159], 0
  v_mfma_f32_16x16x32_bf16 v[188:191], v[92:95], v[156:159], 0
  v_mfma_f32_16x16x32_bf16 v[192:195], v[96:99], v[156:159], 0
  v_mfma_f32_16x16x32_bf16 v[196:199], v[100:103], v[156:159], 0
  v_mfma_f32_16x16x32_bf16 v[200:203], v[104:107], v[156:159], 0
  v_mfma_f32_16x16x32_bf16 v[204:207], v[108:111], v[156:159], 0
  v_mfma_f32_16x16x16_bf16 v[176:179], v[128:129], v[160:161], v[176:179]
  v_mfma_f32_16x16x16_bf16 v[180:183], v[128:129], v[162:163], v[180:183]
  v_mfma_f32_16x16x16_bf16 v[184:187], v[130:131], v[160:161], v[184:187]
  v_mfma_f32_16x16x16_bf16 v[188:191], v[130:131], v[162:163], v[188:191]
  v_mfma_f32_16x16x16_bf16 v[192:195], v[132:133], v[160:161], v[192:195]
  v_mfma_f32_16x16x16_bf16 v[196:199], v[132:133], v[162:163], v[196:199]
  v_mfma_f32_16x16x16_bf16 v[200:203], v[134:135], v[160:161], v[200:203]
  v_mfma_f32_16x16x16_bf16 v[204:207], v[134:135], v[162:163], v[204:207]
  v_mfma_f32_16x16x32_bf16 v[208:211], v[80:83], v[164:167], 0
  v_mfma_f32_16x16x32_bf16 v[212:215], v[84:87], v[164:167], 0
  v_mfma_f32_16x16x32_bf16 v[216:219], v[88:91], v[164:167], 0
  v_mfma_f32_16x16x32_bf16 v[220:223], v[92:95], v[164:167], 0
  v_mfma_f32_16x16x32_bf16 v[224:227], v[96:99], v[164:167], 0
  v_mfma_f32_16x16x32_bf16 v[228:231], v[100:103], v[164:167], 0
  v_mfma_f32_16x16x32_bf16 v[232:235], v[104:107], v[164:167], 0
  v_mfma_f32_16x16x32_bf16 v[236:239], v[108:111], v[164:167], 0
  v_mfma_f32_16x16x16_bf16 v[208:211], v[128:129], v[168:169], v[208:211]
  v_mfma_f32_16x16x16_bf16 v[212:215], v[128:129], v[170:171], v[212:215]
  v_mfma_f32_16x16x16_bf16 v[216:219], v[130:131], v[168:169], v[216:219]
  v_mfma_f32_16x16x16_bf16 v[220:223], v[130:131], v[170:171], v[220:223]
  v_mfma_f32_16x16x16_bf16 v[224:227], v[132:133], v[168:169], v[224:227]
  v_mfma_f32_16x16x16_bf16 v[228:231], v[132:133], v[170:171], v[228:231]
  v_mfma_f32_16x16x16_bf16 v[232:235], v[134:135], v[168:169], v[232:235]
  v_mfma_f32_16x16x16_bf16 v[236:239], v[134:135], v[170:171], v[236:239]
  v_cvt_pk_bf16_f32 v136, v176, v177
  v_cvt_pk_bf16_f32 v137, v178, v179
  v_cvt_pk_bf16_f32 v138, v184, v185
  v_cvt_pk_bf16_f32 v139, v186, v187
  buffer_store_dwordx4 v[136:139], v10, s[4:7], s95 offen offset:0 sc1
  v_cvt_pk_bf16_f32 v140, v180, v181
  v_cvt_pk_bf16_f32 v141, v182, v183
  v_cvt_pk_bf16_f32 v142, v188, v189
  v_cvt_pk_bf16_f32 v143, v190, v191
  buffer_store_dwordx4 v[140:143], v10, s[4:7], s95 offen offset:512 sc1
  v_cvt_pk_bf16_f32 v144, v192, v193
  v_cvt_pk_bf16_f32 v145, v194, v195
  v_cvt_pk_bf16_f32 v146, v200, v201
  v_cvt_pk_bf16_f32 v147, v202, v203
  buffer_store_dwordx4 v[144:147], v10, s[4:7], s95 offen offset:2048 sc1
  v_cvt_pk_bf16_f32 v148, v196, v197
  v_cvt_pk_bf16_f32 v149, v198, v199
  v_cvt_pk_bf16_f32 v150, v204, v205
  v_cvt_pk_bf16_f32 v151, v206, v207
  buffer_store_dwordx4 v[148:151], v10, s[4:7], s95 offen offset:2560 sc1
  v_cvt_pk_bf16_f32 v136, v208, v209
  v_cvt_pk_bf16_f32 v137, v210, v211
  v_cvt_pk_bf16_f32 v138, v216, v217
  v_cvt_pk_bf16_f32 v139, v218, v219
  buffer_store_dwordx4 v[136:139], v11, s[4:7], s95 offen offset:0 sc1
  v_cvt_pk_bf16_f32 v140, v212, v213
  v_cvt_pk_bf16_f32 v141, v214, v215
  v_cvt_pk_bf16_f32 v142, v220, v221
  v_cvt_pk_bf16_f32 v143, v222, v223
  buffer_store_dwordx4 v[140:143], v11, s[4:7], s95 offen offset:512 sc1
  v_cvt_pk_bf16_f32 v144, v224, v225
  v_cvt_pk_bf16_f32 v145, v226, v227
  v_cvt_pk_bf16_f32 v146, v232, v233
  v_cvt_pk_bf16_f32 v147, v234, v235
  buffer_store_dwordx4 v[144:147], v11, s[4:7], s95 offen offset:2048 sc1
  v_cvt_pk_bf16_f32 v148, v228, v229
  v_cvt_pk_bf16_f32 v149, v230, v231
  v_cvt_pk_bf16_f32 v150, v236, v237
  v_cvt_pk_bf16_f32 v151, v238, v239
  buffer_store_dwordx4 v[148:151], v11, s[4:7], s95 offen offset:2560 sc1
  s_add_u32 s95, s95, 262144
  s_branch L_done
L_ata4:
  s_lshr_b32 s40, s36, 3
  s_lshl_b32 s40, s40, 9
  s_lshl_b32 s90, s33, 7
  s_add_u32 s40, s40, s90
  s_add_u32 s41, s36, 4
  s_lshr_b32 s43, s36, 2
  s_lshl_b32 s43, s43, 9
  s_add_u32 s43, s43, s90
  s_add_u32 s43, s43, 28672
  s_lshl_b32 s42, s33, 1
  s_add_u32 s42, s42, s37
  s_lshl_b32 s42, s42, 7
  s_add_u32 s42, s42, 4096
  s_cmp_lg_u32 s32, 0
  s_cbranch_scc1 L_dd_23
  v_mov_b32 v228, 0x3d00000
  v_mov_b32 v230, 0x3d02000
L_dw_22:
  buffer_load_dword v234, v230, s[4:7], s40 offen offset:0 sc1
  buffer_load_dword v235, v228, s[4:7], s43 offen offset:0 sc1
  s_lshl_b32 s45, s33, 7
  buffer_load_dword v238, v228, s[4:7], s45 offen offset:0 sc1
  buffer_load_dword v239, v228, s[4:7], s42 offen sc1
  s_waitcnt vmcnt(0)
  s_mov_b32 s44, 1
  v_readfirstlane_b32 s45, v234
  s_cmp_ge_u32 s45, 4
  s_cselect_b32 s44, s44, 0
  v_readfirstlane_b32 s45, v235
  s_cmp_ge_u32 s45, 16
  s_cselect_b32 s44, s44, 0
  v_readfirstlane_b32 s45, v238
  v_readfirstlane_b32 s47, v239
  s_cmp_ge_u32 s47, 16
  s_cselect_b32 s45, 64, s45
  s_cmp_ge_u32 s45, s41
  s_cselect_b32 s44, s44, 0
  s_cmp_eq_u32 s44, 1
  s_cbranch_scc1 L_dd_23
  s_sleep 6
  s_add_u32 s3, s3, 1
  s_cmp_lt_u32 s3, 131072
  s_cbranch_scc1 L_dw_22
L_dd_23:
  s_barrier
  s_mov_b32 s98, 4
  s_lshr_b32 s38, s36, 2
  s_lshl_b32 s38, s38, 7
  s_add_u32 s38, s38, 2048
  s_lshl_b32 s20, s36, 5
  s_lshl_b32 s90, s33, 3
  s_add_u32 s20, s20, s90
  s_lshl_b32 s90, s37, 2
  s_add_u32 s20, s20, s90
  s_add_u32 s20, s20, s32
  v_and_b32 v1, 63, v0
  s_lshl_b32 s90, s20, 13
  s_lshl_b32 s91, s20, 11
  v_mov_b32 v2, 0x0
  v_bfe_u32 v7, v1, 0, 6
  v_lshl_add_u32 v2, v7, 4, v2
  v_add_u32 v3, 4096, v2
  v_mov_b32 v4, 0x3000000
  v_bfe_u32 v7, v1, 0, 1
  v_lshl_add_u32 v4, v7, 4, v4
  v_bfe_u32 v7, v1, 2, 2
  v_lshl_add_u32 v4, v7, 5, v4
  v_bfe_u32 v7, v1, 4, 2
  v_lshl_add_u32 v4, v7, 7, v4
  v_add_u32 v5, 0x3400000, v2
  v_mov_b32 v8, 0x0
  v_bfe_u32 v7, v1, 0, 3
  v_lshl_add_u32 v8, v7, 4, v8
  v_bfe_u32 v7, v1, 3, 1
  v_lshl_add_u32 v8, v7, 11, v8
  v_bfe_u32 v7, v1, 4, 2
  v_lshl_add_u32 v8, v7, 8, v8
  v_add_u32 v9, 4096, v8
  v_mov_b32 v10, 0x0
  v_bfe_u32 v7, v1, 0, 4
  v_lshl_add_u32 v10, v7, 4, v10
  v_bfe_u32 v7, v1, 4, 1
  v_lshl_add_u32 v10, v7, 8, v10
  v_bfe_u32 v7, v1, 5, 1
  v_lshl_add_u32 v10, v7, 10, v10
  v_add_u32 v11, 4096, v10
  s_add_u32 s92, s90, 16777216
  s_add_u32 s93, s90, 33554432
  s_add_u32 s94, s90, 0
  s_add_u32 s95, s90, 83886080
  buffer_load_dwordx4 v[16:19], v2, s[4:7], s94 offen offset:0 sc1
  buffer_load_dwordx4 v[20:23], v2, s[4:7], s94 offen offset:1024 sc1
  buffer_load_dwordx4 v[24:27], v2, s[4:7], s94 offen offset:2048 sc1
  buffer_load_dwordx4 v[28:31], v2, s[4:7], s94 offen offset:3072 sc1
  buffer_load_dwordx4 v[32:35], v3, s[4:7], s94 offen offset:0 sc1
  buffer_load_dwordx4 v[36:39], v3, s[4:7], s94 offen offset:1024 sc1
  buffer_load_dwordx4 v[40:43], v3, s[4:7], s94 offen offset:2048 sc1
  buffer_load_dwordx4 v[44:47], v3, s[4:7], s94 offen offset:3072 sc1
  buffer_load_dwordx4 v[48:51], v2, s[4:7], s92 offen offset:0 sc1
  buffer_load_dwordx4 v[52:55], v2, s[4:7], s92 offen offset:1024 sc1
  buffer_load_dwordx4 v[56:59], v2, s[4:7], s92 offen offset:2048 sc1
  buffer_load_dwordx4 v[60:63], v2, s[4:7], s92 offen offset:3072 sc1
  buffer_load_dwordx4 v[64:67], v3, s[4:7], s92 offen offset:0 sc1
  buffer_load_dwordx4 v[68:71], v3, s[4:7], s92 offen offset:1024 sc1
  buffer_load_dwordx4 v[72:75], v3, s[4:7], s92 offen offset:2048 sc1
  buffer_load_dwordx4 v[76:79], v3, s[4:7], s92 offen offset:3072 sc1
  buffer_load_dwordx4 v[80:83], v8, s[4:7], s93 offen offset:0 sc1
  buffer_load_dwordx4 v[84:87], v8, s[4:7], s93 offen offset:128 sc1
  buffer_load_dwordx4 v[88:91], v8, s[4:7], s93 offen offset:1024 sc1
  buffer_load_dwordx4 v[92:95], v8, s[4:7], s93 offen offset:1152 sc1
  buffer_load_dwordx4 v[96:99], v9, s[4:7], s93 offen offset:0 sc1
  buffer_load_dwordx4 v[100:103], v9, s[4:7], s93 offen offset:128 sc1
  buffer_load_dwordx4 v[104:107], v9, s[4:7], s93 offen offset:1024 sc1
  buffer_load_dwordx4 v[108:111], v9, s[4:7], s93 offen offset:1152 sc1
  buffer_load_dwordx4 v[112:115], v4, s[4:7], s91 offen offset:0 sc1
  buffer_load_dwordx4 v[116:119], v4, s[4:7], s91 offen offset:512 sc1
  buffer_load_dwordx4 v[120:123], v4, s[4:7], s91 offen offset:1024 sc1
  buffer_load_dwordx4 v[124:127], v4, s[4:7], s91 offen offset:1536 sc1
  buffer_load_dwordx4 v[128:131], v5, s[4:7], s91 offen offset:0 sc1
  buffer_load_dwordx4 v[132:135], v5, s[4:7], s91 offen offset:1024 sc1
  s_add_u32 s92, s92, 262144
  s_add_u32 s93, s93, 262144
  s_add_u32 s94, s94, 262144
  s_add_u32 s91, s91, 65536
  buffer_load_dwordx4 a[0:3], v2, s[4:7], s94 offen offset:0 sc1
  buffer_load_dwordx4 a[4:7], v2, s[4:7], s94 offen offset:1024 sc1
  buffer_load_dwordx4 a[8:11], v2, s[4:7], s94 offen offset:2048 sc1
  buffer_load_dwordx4 a[12:15], v2, s[4:7], s94 offen offset:3072 sc1
  buffer_load_dwordx4 a[16:19], v3, s[4:7], s94 offen offset:0 sc1
  buffer_load_dwordx4 a[20:23], v3, s[4:7], s94 offen offset:1024 sc1
  buffer_load_dwordx4 a[24:27], v3, s[4:7], s94 offen offset:2048 sc1
  buffer_load_dwordx4 a[28:31], v3, s[4:7], s94 offen offset:3072 sc1
  buffer_load_dwordx4 a[32:35], v2, s[4:7], s92 offen offset:0 sc1
  buffer_load_dwordx4 a[36:39], v2, s[4:7], s92 offen offset:1024 sc1
  buffer_load_dwordx4 a[40:43], v2, s[4:7], s92 offen offset:2048 sc1
  buffer_load_dwordx4 a[44:47], v2, s[4:7], s92 offen offset:3072 sc1
  buffer_load_dwordx4 a[48:51], v3, s[4:7], s92 offen offset:0 sc1
  buffer_load_dwordx4 a[52:55], v3, s[4:7], s92 offen offset:1024 sc1
  buffer_load_dwordx4 a[56:59], v3, s[4:7], s92 offen offset:2048 sc1
  buffer_load_dwordx4 a[60:63], v3, s[4:7], s92 offen offset:3072 sc1
  buffer_load_dwordx4 a[64:67], v8, s[4:7], s93 offen offset:0 sc1
  buffer_load_dwordx4 a[68:71], v8, s[4:7], s93 offen offset:128 sc1
  buffer_load_dwordx4 a[72:75], v8, s[4:7], s93 offen offset:1024 sc1
  buffer_load_dwordx4 a[76:79], v8, s[4:7], s93 offen offset:1152 sc1
  buffer_load_dwordx4 a[80:83], v9, s[4:7], s93 offen offset:0 sc1
  buffer_load_dwordx4 a[84:87], v9, s[4:7], s93 offen offset:128 sc1
  buffer_load_dwordx4 a[88:91], v9, s[4:7], s93 offen offset:1024 sc1
  buffer_load_dwordx4 a[92:95], v9, s[4:7], s93 offen offset:1152 sc1
  buffer_load_dwordx4 a[96:99], v4, s[4:7], s91 offen offset:0 sc1
  buffer_load_dwordx4 a[100:103], v4, s[4:7], s91 offen offset:512 sc1
  buffer_load_dwordx4 a[104:107], v4, s[4:7], s91 offen offset:1024 sc1
  buffer_load_dwordx4 a[108:111], v4, s[4:7], s91 offen offset:1536 sc1
  buffer_load_dwordx4 a[112:115], v5, s[4:7], s91 offen offset:0 sc1
  buffer_load_dwordx4 a[116:119], v5, s[4:7], s91 offen offset:1024 sc1
  s_add_u32 s92, s92, 262144
  s_add_u32 s93, s93, 262144
  s_add_u32 s94, s94, 262144
  s_add_u32 s91, s91, 65536
  s_mov_b32 s40, 0xfff0ffff
  s_mov_b32 s41, 0xf000ff00
  s_mov_b32 s42, 0xffe0fffe
  s_mov_b32 s43, 0xe000fe00
  s_mov_b32 s44, 0xffc0fffc
  s_mov_b32 s45, 0xc000fc00
  s_mov_b32 s46, 0xff80fff8
  s_mov_b32 s47, 0x8000f800
  s_mov_b32 s50, 0x3e0293ee
  v_mov_b32 v6, 0xd028965f
  s_waitcnt vmcnt(30)
  v_mfma_f32_16x16x32_bf16 v[136:139], v[112:115], v[16:19], 0
  v_mfma_f32_16x16x32_bf16 v[140:143], v[48:51], v[16:19], 0
  v_mfma_f32_16x16x32_bf16 v[144:147], v[112:115], v[32:35], 0
  v_mfma_f32_16x16x32_bf16 v[148:151], v[48:51], v[32:35], 0
  v_mfma_f32_16x16x32_bf16 v[152:155], v[64:67], v[32:35], 0
  v_mfma_f32_16x16x32_bf16 v[136:139], v[116:119], v[20:23], v[136:139]
  v_mfma_f32_16x16x32_bf16 v[140:143], v[52:55], v[20:23], v[140:143]
  v_mfma_f32_16x16x32_bf16 v[144:147], v[116:119], v[36:39], v[144:147]
  v_mfma_f32_16x16x32_bf16 v[148:151], v[52:55], v[36:39], v[148:151]
  v_mfma_f32_16x16x32_bf16 v[152:155], v[68:71], v[36:39], v[152:155]
  v_mfma_f32_16x16x32_bf16 v[136:139], v[120:123], v[24:27], v[136:139]
  v_mfma_f32_16x16x32_bf16 v[140:143], v[56:59], v[24:27], v[140:143]
  v_mfma_f32_16x16x32_bf16 v[144:147], v[120:123], v[40:43], v[144:147]
  v_mfma_f32_16x16x32_bf16 v[148:151], v[56:59], v[40:43], v[148:151]
  v_mfma_f32_16x16x32_bf16 v[152:155], v[72:75], v[40:43], v[152:155]
  v_mfma_f32_16x16x32_bf16 v[136:139], v[124:127], v[28:31], v[136:139]
  v_mfma_f32_16x16x32_bf16 v[140:143], v[60:63], v[28:31], v[140:143]
  v_mfma_f32_16x16x32_bf16 v[144:147], v[124:127], v[44:47], v[144:147]
  v_mfma_f32_16x16x32_bf16 v[148:151], v[60:63], v[44:47], v[148:151]
  v_mfma_f32_16x16x32_bf16 v[152:155], v[76:79], v[44:47], v[152:155]
  s_nop 4
  v_cndmask_b32 v140, v6, v140, s[40:41]
  v_cndmask_b32 v141, v6, v141, s[42:43]
  v_cndmask_b32 v142, v6, v142, s[44:45]
  v_cndmask_b32 v143, v6, v143, s[46:47]
  v_max3_f32 v12, v136, v137, v140
  v_max3_f32 v12, v12, v141, v142
  v_max_f32 v12, v12, v143
  v_mov_b32 v13, v12
  s_nop 1
  v_permlane32_swap_b32 v12, v13
  v_max_f32 v12, v12, v13
  v_mov_b32 v13, v12
  s_nop 1
  v_permlane16_swap_b32 v12, v13
  v_max_f32 v12, v12, v13
  v_mul_f32 v12, s50, v12
  v_fma_f32 v136, v136, s50, -v12
  v_fma_f32 v137, v137, s50, -v12
  v_fma_f32 v140, v140, s50, -v12
  v_fma_f32 v141, v141, s50, -v12
  v_fma_f32 v142, v142, s50, -v12
  v_fma_f32 v143, v143, s50, -v12
  v_exp_f32 v136, v136
  v_exp_f32 v137, v137
  v_exp_f32 v140, v140
  v_exp_f32 v141, v141
  v_exp_f32 v142, v142
  v_exp_f32 v143, v143
  v_add_f32 v12, v136, v137
  v_add_f32 v12, v12, v140
  v_add_f32 v12, v12, v141
  v_add_f32 v12, v12, v142
  v_add_f32 v12, v12, v143
  v_mov_b32 v13, v12
  s_nop 1
  v_permlane32_swap_b32 v12, v13
  v_add_f32 v12, v12, v13
  v_mov_b32 v13, v12
  s_nop 1
  v_permlane16_swap_b32 v12, v13
  v_add_f32 v12, v12, v13
  v_rcp_f32 v12, v12
  s_nop 0
  v_mul_f32 v136, v136, v12
  v_mul_f32 v137, v137, v12
  v_mul_f32 v140, v140, v12
  v_mul_f32 v141, v141, v12
  v_mul_f32 v142, v142, v12
  v_mul_f32 v143, v143, v12
  v_cvt_pk_bf16_f32 v160, v136, v137
  v_mov_b32 v161, 0
  v_mov_b32 v162, 0
  v_mov_b32 v163, v160
  v_cvt_pk_bf16_f32 v156, v140, v141
  v_cvt_pk_bf16_f32 v157, v142, v143
  v_mov_b32 v158, 0
  v_mov_b32 v159, 0
  v_cndmask_b32 v152, v6, v152, s[40:41]
  v_cndmask_b32 v153, v6, v153, s[42:43]
  v_cndmask_b32 v154, v6, v154, s[44:45]
  v_cndmask_b32 v155, v6, v155, s[46:47]
  v_max3_f32 v12, v144, v145, v148
  v_max3_f32 v12, v12, v149, v150
  v_max3_f32 v12, v12, v151, v152
  v_max3_f32 v12, v12, v153, v154
  v_max_f32 v12, v12, v155
  v_mov_b32 v13, v12
  s_nop 1
  v_permlane32_swap_b32 v12, v13
  v_max_f32 v12, v12, v13
  v_mov_b32 v13, v12
  s_nop 1
  v_permlane16_swap_b32 v12, v13
  v_max_f32 v12, v12, v13
  v_mul_f32 v12, s50, v12
  v_fma_f32 v144, v144, s50, -v12
  v_fma_f32 v145, v145, s50, -v12
  v_fma_f32 v148, v148, s50, -v12
  v_fma_f32 v149, v149, s50, -v12
  v_fma_f32 v150, v150, s50, -v12
  v_fma_f32 v151, v151, s50, -v12
  v_fma_f32 v152, v152, s50, -v12
  v_fma_f32 v153, v153, s50, -v12
  v_fma_f32 v154, v154, s50, -v12
  v_fma_f32 v155, v155, s50, -v12
  v_exp_f32 v144, v144
  v_exp_f32 v145, v145
  v_exp_f32 v148, v148
  v_exp_f32 v149, v149
  v_exp_f32 v150, v150
  v_exp_f32 v151, v151
  v_exp_f32 v152, v152
  v_exp_f32 v153, v153
  v_exp_f32 v154, v154
  v_exp_f32 v155, v155
  v_add_f32 v12, v144, v145
  v_add_f32 v12, v12, v148
  v_add_f32 v12, v12, v149
  v_add_f32 v12, v12, v150
  v_add_f32 v12, v12, v151
  v_add_f32 v12, v12, v152
  v_add_f32 v12, v12, v153
  v_add_f32 v12, v12, v154
  v_add_f32 v12, v12, v155
  v_mov_b32 v13, v12
  s_nop 1
  v_permlane32_swap_b32 v12, v13
  v_add_f32 v12, v12, v13
  v_mov_b32 v13, v12
  s_nop 1
  v_permlane16_swap_b32 v12, v13
  v_add_f32 v12, v12, v13
  v_rcp_f32 v12, v12
  s_nop 0
  v_mul_f32 v144, v144, v12
  v_mul_f32 v145, v145, v12
  v_mul_f32 v148, v148, v12
  v_mul_f32 v149, v149, v12
  v_mul_f32 v150, v150, v12
  v_mul_f32 v151, v151, v12
  v_mul_f32 v152, v152, v12
  v_mul_f32 v153, v153, v12
  v_mul_f32 v154, v154, v12
  v_mul_f32 v155, v155, v12
  v_cvt_pk_bf16_f32 v168, v144, v145
  v_mov_b32 v169, 0
  v_mov_b32 v170, 0
  v_mov_b32 v171, v168
  v_cvt_pk_bf16_f32 v164, v148, v149
  v_cvt_pk_bf16_f32 v165, v150, v151
  v_cvt_pk_bf16_f32 v166, v152, v153
  v_cvt_pk_bf16_f32 v167, v154, v155
  v_mfma_f32_16x16x32_bf16 v[176:179], v[80:83], v[156:159], 0
  v_mfma_f32_16x16x32_bf16 v[180:183], v[84:87], v[156:159], 0
  v_mfma_f32_16x16x32_bf16 v[184:187], v[88:91], v[156:159], 0
  v_mfma_f32_16x16x32_bf16 v[188:191], v[92:95], v[156:159], 0
  v_mfma_f32_16x16x32_bf16 v[192:195], v[96:99], v[156:159], 0
  v_mfma_f32_16x16x32_bf16 v[196:199], v[100:103], v[156:159], 0
  v_mfma_f32_16x16x32_bf16 v[200:203], v[104:107], v[156:159], 0
  v_mfma_f32_16x16x32_bf16 v[204:207], v[108:111], v[156:159], 0
  v_mfma_f32_16x16x16_bf16 v[176:179], v[128:129], v[160:161], v[176:179]
  v_mfma_f32_16x16x16_bf16 v[180:183], v[128:129], v[162:163], v[180:183]
  v_mfma_f32_16x16x16_bf16 v[184:187], v[130:131], v[160:161], v[184:187]
  v_mfma_f32_16x16x16_bf16 v[188:191], v[130:131], v[162:163], v[188:191]
  v_mfma_f32_16x16x16_bf16 v[192:195], v[132:133], v[160:161], v[192:195]
  v_mfma_f32_16x16x16_bf16 v[196:199], v[132:133], v[162:163], v[196:199]
  v_mfma_f32_16x16x16_bf16 v[200:203], v[134:135], v[160:161], v[200:203]
  v_mfma_f32_16x16x16_bf16 v[204:207], v[134:135], v[162:163], v[204:207]
  v_mfma_f32_16x16x32_bf16 v[208:211], v[80:83], v[164:167], 0
  v_mfma_f32_16x16x32_bf16 v[212:215], v[84:87], v[164:167], 0
  v_mfma_f32_16x16x32_bf16 v[216:219], v[88:91], v[164:167], 0
  v_mfma_f32_16x16x32_bf16 v[220:223], v[92:95], v[164:167], 0
  v_mfma_f32_16x16x32_bf16 v[224:227], v[96:99], v[164:167], 0
  v_mfma_f32_16x16x32_bf16 v[228:231], v[100:103], v[164:167], 0
  v_mfma_f32_16x16x32_bf16 v[232:235], v[104:107], v[164:167], 0
  v_mfma_f32_16x16x32_bf16 v[236:239], v[108:111], v[164:167], 0
  v_mfma_f32_16x16x16_bf16 v[208:211], v[128:129], v[168:169], v[208:211]
  v_mfma_f32_16x16x16_bf16 v[212:215], v[128:129], v[170:171], v[212:215]
  v_mfma_f32_16x16x16_bf16 v[216:219], v[130:131], v[168:169], v[216:219]
  v_mfma_f32_16x16x16_bf16 v[220:223], v[130:131], v[170:171], v[220:223]
  v_mfma_f32_16x16x16_bf16 v[224:227], v[132:133], v[168:169], v[224:227]
  v_mfma_f32_16x16x16_bf16 v[228:231], v[132:133], v[170:171], v[228:231]
  v_mfma_f32_16x16x16_bf16 v[232:235], v[134:135], v[168:169], v[232:235]
  v_mfma_f32_16x16x16_bf16 v[236:239], v[134:135], v[170:171], v[236:239]
  buffer_load_dwordx4 v[16:19], v2, s[4:7], s94 offen offset:0 sc1
  buffer_load_dwordx4 v[20:23], v2, s[4:7], s94 offen offset:1024 sc1
  buffer_load_dwordx4 v[24:27], v2, s[4:7], s94 offen offset:2048 sc1
  buffer_load_dwordx4 v[28:31], v2, s[4:7], s94 offen offset:3072 sc1
  buffer_load_dwordx4 v[32:35], v3, s[4:7], s94 offen offset:0 sc1
  buffer_load_dwordx4 v[36:39], v3, s[4:7], s94 offen offset:1024 sc1
  buffer_load_dwordx4 v[40:43], v3, s[4:7], s94 offen offset:2048 sc1
  buffer_load_dwordx4 v[44:47], v3, s[4:7], s94 offen offset:3072 sc1
  buffer_load_dwordx4 v[48:51], v2, s[4:7], s92 offen offset:0 sc1
  buffer_load_dwordx4 v[52:55], v2, s[4:7], s92 offen offset:1024 sc1
  buffer_load_dwordx4 v[56:59], v2, s[4:7], s92 offen offset:2048 sc1
  buffer_load_dwordx4 v[60:63], v2, s[4:7], s92 offen offset:3072 sc1
  buffer_load_dwordx4 v[64:67], v3, s[4:7], s92 offen offset:0 sc1
  buffer_load_dwordx4 v[68:71], v3, s[4:7], s92 offen offset:1024 sc1
  buffer_load_dwordx4 v[72:75], v3, s[4:7], s92 offen offset:2048 sc1
  buffer_load_dwordx4 v[76:79], v3, s[4:7], s92 offen offset:3072 sc1
  buffer_load_dwordx4 v[80:83], v8, s[4:7], s93 offen offset:0 sc1
  buffer_load_dwordx4 v[84:87], v8, s[4:7], s93 offen offset:128 sc1
  buffer_load_dwordx4 v[88:91], v8, s[4:7], s93 offen offset:1024 sc1
  buffer_load_dwordx4 v[92:95], v8, s[4:7], s93 offen offset:1152 sc1
  buffer_load_dwordx4 v[96:99], v9, s[4:7], s93 offen offset:0 sc1
  buffer_load_dwordx4 v[100:103], v9, s[4:7], s93 offen offset:128 sc1
  buffer_load_dwordx4 v[104:107], v9, s[4:7], s93 offen offset:1024 sc1
  buffer_load_dwordx4 v[108:111], v9, s[4:7], s93 offen offset:1152 sc1
  buffer_load_dwordx4 v[112:115], v4, s[4:7], s91 offen offset:0 sc1
  buffer_load_dwordx4 v[116:119], v4, s[4:7], s91 offen offset:512 sc1
  buffer_load_dwordx4 v[120:123], v4, s[4:7], s91 offen offset:1024 sc1
  buffer_load_dwordx4 v[124:127], v4, s[4:7], s91 offen offset:1536 sc1
  buffer_load_dwordx4 v[128:131], v5, s[4:7], s91 offen offset:0 sc1
  buffer_load_dwordx4 v[132:135], v5, s[4:7], s91 offen offset:1024 sc1
  s_add_u32 s92, s92, 262144
  s_add_u32 s93, s93, 262144
  s_add_u32 s94, s94, 262144
  s_add_u32 s91, s91, 65536
  v_cvt_pk_bf16_f32 v136, v176, v177
  v_cvt_pk_bf16_f32 v137, v178, v179
  v_cvt_pk_bf16_f32 v138, v184, v185
  v_cvt_pk_bf16_f32 v139, v186, v187
  buffer_store_dwordx4 v[136:139], v10, s[4:7], s95 offen offset:0 sc1
  v_cvt_pk_bf16_f32 v140, v180, v181
  v_cvt_pk_bf16_f32 v141, v182, v183
  v_cvt_pk_bf16_f32 v142, v188, v189
  v_cvt_pk_bf16_f32 v143, v190, v191
  buffer_store_dwordx4 v[140:143], v10, s[4:7], s95 offen offset:512 sc1
  v_cvt_pk_bf16_f32 v144, v192, v193
  v_cvt_pk_bf16_f32 v145, v194, v195
  v_cvt_pk_bf16_f32 v146, v200, v201
  v_cvt_pk_bf16_f32 v147, v202, v203
  buffer_store_dwordx4 v[144:147], v10, s[4:7], s95 offen offset:2048 sc1
  v_cvt_pk_bf16_f32 v148, v196, v197
  v_cvt_pk_bf16_f32 v149, v198, v199
  v_cvt_pk_bf16_f32 v150, v204, v205
  v_cvt_pk_bf16_f32 v151, v206, v207
  buffer_store_dwordx4 v[148:151], v10, s[4:7], s95 offen offset:2560 sc1
  v_cvt_pk_bf16_f32 v136, v208, v209
  v_cvt_pk_bf16_f32 v137, v210, v211
  v_cvt_pk_bf16_f32 v138, v216, v217
  v_cvt_pk_bf16_f32 v139, v218, v219
  buffer_store_dwordx4 v[136:139], v11, s[4:7], s95 offen offset:0 sc1
  v_cvt_pk_bf16_f32 v140, v212, v213
  v_cvt_pk_bf16_f32 v141, v214, v215
  v_cvt_pk_bf16_f32 v142, v220, v221
  v_cvt_pk_bf16_f32 v143, v222, v223
  buffer_store_dwordx4 v[140:143], v11, s[4:7], s95 offen offset:512 sc1
  v_cvt_pk_bf16_f32 v144, v224, v225
  v_cvt_pk_bf16_f32 v145, v226, v227
  v_cvt_pk_bf16_f32 v146, v232, v233
  v_cvt_pk_bf16_f32 v147, v234, v235
  buffer_store_dwordx4 v[144:147], v11, s[4:7], s95 offen offset:2048 sc1
  v_cvt_pk_bf16_f32 v148, v228, v229
  v_cvt_pk_bf16_f32 v149, v230, v231
  v_cvt_pk_bf16_f32 v150, v236, v237
  v_cvt_pk_bf16_f32 v151, v238, v239
  buffer_store_dwordx4 v[148:151], v11, s[4:7], s95 offen offset:2560 sc1
  s_add_u32 s95, s95, 262144
  s_waitcnt vmcnt(38)
  v_mfma_f32_16x16x32_bf16 v[136:139], a[96:99], a[0:3], 0
  v_mfma_f32_16x16x32_bf16 v[140:143], a[32:35], a[0:3], 0
  v_mfma_f32_16x16x32_bf16 v[144:147], a[96:99], a[16:19], 0
  v_mfma_f32_16x16x32_bf16 v[148:151], a[32:35], a[16:19], 0
  v_mfma_f32_16x16x32_bf16 v[152:155], a[48:51], a[16:19], 0
  v_mfma_f32_16x16x32_bf16 v[136:139], a[100:103], a[4:7], v[136:139]
  v_mfma_f32_16x16x32_bf16 v[140:143], a[36:39], a[4:7], v[140:143]
  v_mfma_f32_16x16x32_bf16 v[144:147], a[100:103], a[20:23], v[144:147]
  v_mfma_f32_16x16x32_bf16 v[148:151], a[36:39], a[20:23], v[148:151]
  v_mfma_f32_16x16x32_bf16 v[152:155], a[52:55], a[20:23], v[152:155]
  v_mfma_f32_16x16x32_bf16 v[136:139], a[104:107], a[8:11], v[136:139]
  v_mfma_f32_16x16x32_bf16 v[140:143], a[40:43], a[8:11], v[140:143]
  v_mfma_f32_16x16x32_bf16 v[144:147], a[104:107], a[24:27], v[144:147]
  v_mfma_f32_16x16x32_bf16 v[148:151], a[40:43], a[24:27], v[148:151]
  v_mfma_f32_16x16x32_bf16 v[152:155], a[56:59], a[24:27], v[152:155]
  v_mfma_f32_16x16x32_bf16 v[136:139], a[108:111], a[12:15], v[136:139]
  v_mfma_f32_16x16x32_bf16 v[140:143], a[44:47], a[12:15], v[140:143]
  v_mfma_f32_16x16x32_bf16 v[144:147], a[108:111], a[28:31], v[144:147]
  v_mfma_f32_16x16x32_bf16 v[148:151], a[44:47], a[28:31], v[148:151]
  v_mfma_f32_16x16x32_bf16 v[152:155], a[60:63], a[28:31], v[152:155]
  s_nop 4
  v_cndmask_b32 v140, v6, v140, s[40:41]
  v_cndmask_b32 v141, v6, v141, s[42:43]
  v_cndmask_b32 v142, v6, v142, s[44:45]
  v_cndmask_b32 v143, v6, v143, s[46:47]
  v_max3_f32 v12, v136, v137, v140
  v_max3_f32 v12, v12, v141, v142
  v_max_f32 v12, v12, v143
  v_mov_b32 v13, v12
  s_nop 1
  v_permlane32_swap_b32 v12, v13
  v_max_f32 v12, v12, v13
  v_mov_b32 v13, v12
  s_nop 1
  v_permlane16_swap_b32 v12, v13
  v_max_f32 v12, v12, v13
  v_mul_f32 v12, s50, v12
  v_fma_f32 v136, v136, s50, -v12
  v_fma_f32 v137, v137, s50, -v12
  v_fma_f32 v140, v140, s50, -v12
  v_fma_f32 v141, v141, s50, -v12
  v_fma_f32 v142, v142, s50, -v12
  v_fma_f32 v143, v143, s50, -v12
  v_exp_f32 v136, v136
  v_exp_f32 v137, v137
  v_exp_f32 v140, v140
  v_exp_f32 v141, v141
  v_exp_f32 v142, v142
  v_exp_f32 v143, v143
  v_add_f32 v12, v136, v137
  v_add_f32 v12, v12, v140
  v_add_f32 v12, v12, v141
  v_add_f32 v12, v12, v142
  v_add_f32 v12, v12, v143
  v_mov_b32 v13, v12
  s_nop 1
  v_permlane32_swap_b32 v12, v13
  v_add_f32 v12, v12, v13
  v_mov_b32 v13, v12
  s_nop 1
  v_permlane16_swap_b32 v12, v13
  v_add_f32 v12, v12, v13
  v_rcp_f32 v12, v12
  s_nop 0
  v_mul_f32 v136, v136, v12
  v_mul_f32 v137, v137, v12
  v_mul_f32 v140, v140, v12
  v_mul_f32 v141, v141, v12
  v_mul_f32 v142, v142, v12
  v_mul_f32 v143, v143, v12
  v_cvt_pk_bf16_f32 v160, v136, v137
  v_mov_b32 v161, 0
  v_mov_b32 v162, 0
  v_mov_b32 v163, v160
  v_cvt_pk_bf16_f32 v156, v140, v141
  v_cvt_pk_bf16_f32 v157, v142, v143
  v_mov_b32 v158, 0
  v_mov_b32 v159, 0
  v_cndmask_b32 v152, v6, v152, s[40:41]
  v_cndmask_b32 v153, v6, v153, s[42:43]
  v_cndmask_b32 v154, v6, v154, s[44:45]
  v_cndmask_b32 v155, v6, v155, s[46:47]
  v_max3_f32 v12, v144, v145, v148
  v_max3_f32 v12, v12, v149, v150
  v_max3_f32 v12, v12, v151, v152
  v_max3_f32 v12, v12, v153, v154
  v_max_f32 v12, v12, v155
  v_mov_b32 v13, v12
  s_nop 1
  v_permlane32_swap_b32 v12, v13
  v_max_f32 v12, v12, v13
  v_mov_b32 v13, v12
  s_nop 1
  v_permlane16_swap_b32 v12, v13
  v_max_f32 v12, v12, v13
  v_mul_f32 v12, s50, v12
  v_fma_f32 v144, v144, s50, -v12
  v_fma_f32 v145, v145, s50, -v12
  v_fma_f32 v148, v148, s50, -v12
  v_fma_f32 v149, v149, s50, -v12
  v_fma_f32 v150, v150, s50, -v12
  v_fma_f32 v151, v151, s50, -v12
  v_fma_f32 v152, v152, s50, -v12
  v_fma_f32 v153, v153, s50, -v12
  v_fma_f32 v154, v154, s50, -v12
  v_fma_f32 v155, v155, s50, -v12
  v_exp_f32 v144, v144
  v_exp_f32 v145, v145
  v_exp_f32 v148, v148
  v_exp_f32 v149, v149
  v_exp_f32 v150, v150
  v_exp_f32 v151, v151
  v_exp_f32 v152, v152
  v_exp_f32 v153, v153
  v_exp_f32 v154, v154
  v_exp_f32 v155, v155
  v_add_f32 v12, v144, v145
  v_add_f32 v12, v12, v148
  v_add_f32 v12, v12, v149
  v_add_f32 v12, v12, v150
  v_add_f32 v12, v12, v151
  v_add_f32 v12, v12, v152
  v_add_f32 v12, v12, v153
  v_add_f32 v12, v12, v154
  v_add_f32 v12, v12, v155
  v_mov_b32 v13, v12
  s_nop 1
  v_permlane32_swap_b32 v12, v13
  v_add_f32 v12, v12, v13
  v_mov_b32 v13, v12
  s_nop 1
  v_permlane16_swap_b32 v12, v13
  v_add_f32 v12, v12, v13
  v_rcp_f32 v12, v12
  s_nop 0
  v_mul_f32 v144, v144, v12
  v_mul_f32 v145, v145, v12
  v_mul_f32 v148, v148, v12
  v_mul_f32 v149, v149, v12
  v_mul_f32 v150, v150, v12
  v_mul_f32 v151, v151, v12
  v_mul_f32 v152, v152, v12
  v_mul_f32 v153, v153, v12
  v_mul_f32 v154, v154, v12
  v_mul_f32 v155, v155, v12
  v_cvt_pk_bf16_f32 v168, v144, v145
  v_mov_b32 v169, 0
  v_mov_b32 v170, 0
  v_mov_b32 v171, v168
  v_cvt_pk_bf16_f32 v164, v148, v149
  v_cvt_pk_bf16_f32 v165, v150, v151
  v_cvt_pk_bf16_f32 v166, v152, v153
  v_cvt_pk_bf16_f32 v167, v154, v155
  v_mfma_f32_16x16x32_bf16 v[176:179], a[64:67], v[156:159], 0
  v_mfma_f32_16x16x32_bf16 v[180:183], a[68:71], v[156:159], 0
  v_mfma_f32_16x16x32_bf16 v[184:187], a[72:75], v[156:159], 0
  v_mfma_f32_16x16x32_bf16 v[188:191], a[76:79], v[156:159], 0
  v_mfma_f32_16x16x32_bf16 v[192:195], a[80:83], v[156:159], 0
  v_mfma_f32_16x16x32_bf16 v[196:199], a[84:87], v[156:159], 0
  v_mfma_f32_16x16x32_bf16 v[200:203], a[88:91], v[156:159], 0
  v_mfma_f32_16x16x32_bf16 v[204:207], a[92:95], v[156:159], 0
  v_mfma_f32_16x16x16_bf16 v[176:179], a[112:113], v[160:161], v[176:179]
  v_mfma_f32_16x16x16_bf16 v[180:183], a[112:113], v[162:163], v[180:183]
  v_mfma_f32_16x16x16_bf16 v[184:187], a[114:115], v[160:161], v[184:187]
  v_mfma_f32_16x16x16_bf16 v[188:191], a[114:115], v[162:163], v[188:191]
  v_mfma_f32_16x16x16_bf16 v[192:195], a[116:117], v[160:161], v[192:195]
  v_mfma_f32_16x16x16_bf16 v[196:199], a[116:117], v[162:163], v[196:199]
  v_mfma_f32_16x16x16_bf16 v[200:203], a[118:119], v[160:161], v[200:203]
  v_mfma_f32_16x16x16_bf16 v[204:207], a[118:119], v[162:163], v[204:207]
  v_mfma_f32_16x16x32_bf16 v[208:211], a[64:67], v[164:167], 0
  v_mfma_f32_16x16x32_bf16 v[212:215], a[68:71], v[164:167], 0
  v_mfma_f32_16x16x32_bf16 v[216:219], a[72:75], v[164:167], 0
  v_mfma_f32_16x16x32_bf16 v[220:223], a[76:79], v[164:167], 0
  v_mfma_f32_16x16x32_bf16 v[224:227], a[80:83], v[164:167], 0
  v_mfma_f32_16x16x32_bf16 v[228:231], a[84:87], v[164:167], 0
  v_mfma_f32_16x16x32_bf16 v[232:235], a[88:91], v[164:167], 0
  v_mfma_f32_16x16x32_bf16 v[236:239], a[92:95], v[164:167], 0
  v_mfma_f32_16x16x16_bf16 v[208:211], a[112:113], v[168:169], v[208:211]
  v_mfma_f32_16x16x16_bf16 v[212:215], a[112:113], v[170:171], v[212:215]
  v_mfma_f32_16x16x16_bf16 v[216:219], a[114:115], v[168:169], v[216:219]
  v_mfma_f32_16x16x16_bf16 v[220:223], a[114:115], v[170:171], v[220:223]
  v_mfma_f32_16x16x16_bf16 v[224:227], a[116:117], v[168:169], v[224:227]
  v_mfma_f32_16x16x16_bf16 v[228:231], a[116:117], v[170:171], v[228:231]
  v_mfma_f32_16x16x16_bf16 v[232:235], a[118:119], v[168:169], v[232:235]
  v_mfma_f32_16x16x16_bf16 v[236:239], a[118:119], v[170:171], v[236:239]
  buffer_load_dwordx4 a[0:3], v2, s[4:7], s94 offen offset:0 sc1
  buffer_load_dwordx4 a[4:7], v2, s[4:7], s94 offen offset:1024 sc1
  buffer_load_dwordx4 a[8:11], v2, s[4:7], s94 offen offset:2048 sc1
  buffer_load_dwordx4 a[12:15], v2, s[4:7], s94 offen offset:3072 sc1
  buffer_load_dwordx4 a[16:19], v3, s[4:7], s94 offen offset:0 sc1
  buffer_load_dwordx4 a[20:23], v3, s[4:7], s94 offen offset:1024 sc1
  buffer_load_dwordx4 a[24:27], v3, s[4:7], s94 offen offset:2048 sc1
  buffer_load_dwordx4 a[28:31], v3, s[4:7], s94 offen offset:3072 sc1
  buffer_load_dwordx4 a[32:35], v2, s[4:7], s92 offen offset:0 sc1
  buffer_load_dwordx4 a[36:39], v2, s[4:7], s92 offen offset:1024 sc1
  buffer_load_dwordx4 a[40:43], v2, s[4:7], s92 offen offset:2048 sc1
  buffer_load_dwordx4 a[44:47], v2, s[4:7], s92 offen offset:3072 sc1
  buffer_load_dwordx4 a[48:51], v3, s[4:7], s92 offen offset:0 sc1
  buffer_load_dwordx4 a[52:55], v3, s[4:7], s92 offen offset:1024 sc1
  buffer_load_dwordx4 a[56:59], v3, s[4:7], s92 offen offset:2048 sc1
  buffer_load_dwordx4 a[60:63], v3, s[4:7], s92 offen offset:3072 sc1
  buffer_load_dwordx4 a[64:67], v8, s[4:7], s93 offen offset:0 sc1
  buffer_load_dwordx4 a[68:71], v8, s[4:7], s93 offen offset:128 sc1
  buffer_load_dwordx4 a[72:75], v8, s[4:7], s93 offen offset:1024 sc1
  buffer_load_dwordx4 a[76:79], v8, s[4:7], s93 offen offset:1152 sc1
  buffer_load_dwordx4 a[80:83], v9, s[4:7], s93 offen offset:0 sc1
  buffer_load_dwordx4 a[84:87], v9, s[4:7], s93 offen offset:128 sc1
  buffer_load_dwordx4 a[88:91], v9, s[4:7], s93 offen offset:1024 sc1
  buffer_load_dwordx4 a[92:95], v9, s[4:7], s93 offen offset:1152 sc1
  buffer_load_dwordx4 a[96:99], v4, s[4:7], s91 offen offset:0 sc1
  buffer_load_dwordx4 a[100:103], v4, s[4:7], s91 offen offset:512 sc1
  buffer_load_dwordx4 a[104:107], v4, s[4:7], s91 offen offset:1024 sc1
  buffer_load_dwordx4 a[108:111], v4, s[4:7], s91 offen offset:1536 sc1
  buffer_load_dwordx4 a[112:115], v5, s[4:7], s91 offen offset:0 sc1
  buffer_load_dwordx4 a[116:119], v5, s[4:7], s91 offen offset:1024 sc1
  s_add_u32 s92, s92, 262144
  s_add_u32 s93, s93, 262144
  s_add_u32 s94, s94, 262144
  s_add_u32 s91, s91, 65536
  v_cvt_pk_bf16_f32 v136, v176, v177
  v_cvt_pk_bf16_f32 v137, v178, v179
  v_cvt_pk_bf16_f32 v138, v184, v185
  v_cvt_pk_bf16_f32 v139, v186, v187
  buffer_store_dwordx4 v[136:139], v10, s[4:7], s95 offen offset:0 sc1
  v_cvt_pk_bf16_f32 v140, v180, v181
  v_cvt_pk_bf16_f32 v141, v182, v183
  v_cvt_pk_bf16_f32 v142, v188, v189
  v_cvt_pk_bf16_f32 v143, v190, v191
  buffer_store_dwordx4 v[140:143], v10, s[4:7], s95 offen offset:512 sc1
  v_cvt_pk_bf16_f32 v144, v192, v193
  v_cvt_pk_bf16_f32 v145, v194, v195
  v_cvt_pk_bf16_f32 v146, v200, v201
  v_cvt_pk_bf16_f32 v147, v202, v203
  buffer_store_dwordx4 v[144:147], v10, s[4:7], s95 offen offset:2048 sc1
  v_cvt_pk_bf16_f32 v148, v196, v197
  v_cvt_pk_bf16_f32 v149, v198, v199
  v_cvt_pk_bf16_f32 v150, v204, v205
  v_cvt_pk_bf16_f32 v151, v206, v207
  buffer_store_dwordx4 v[148:151], v10, s[4:7], s95 offen offset:2560 sc1
  v_cvt_pk_bf16_f32 v136, v208, v209
  v_cvt_pk_bf16_f32 v137, v210, v211
  v_cvt_pk_bf16_f32 v138, v216, v217
  v_cvt_pk_bf16_f32 v139, v218, v219
  buffer_store_dwordx4 v[136:139], v11, s[4:7], s95 offen offset:0 sc1
  v_cvt_pk_bf16_f32 v140, v212, v213
  v_cvt_pk_bf16_f32 v141, v214, v215
  v_cvt_pk_bf16_f32 v142, v220, v221
  v_cvt_pk_bf16_f32 v143, v222, v223
  buffer_store_dwordx4 v[140:143], v11, s[4:7], s95 offen offset:512 sc1
  v_cvt_pk_bf16_f32 v144, v224, v225
  v_cvt_pk_bf16_f32 v145, v226, v227
  v_cvt_pk_bf16_f32 v146, v232, v233
  v_cvt_pk_bf16_f32 v147, v234, v235
  buffer_store_dwordx4 v[144:147], v11, s[4:7], s95 offen offset:2048 sc1
  v_cvt_pk_bf16_f32 v148, v228, v229
  v_cvt_pk_bf16_f32 v149, v230, v231
  v_cvt_pk_bf16_f32 v150, v236, v237
  v_cvt_pk_bf16_f32 v151, v238, v239
  buffer_store_dwordx4 v[148:151], v11, s[4:7], s95 offen offset:2560 sc1
  s_add_u32 s95, s95, 262144
  s_waitcnt vmcnt(46)
  v_mfma_f32_16x16x32_bf16 v[136:139], v[112:115], v[16:19], 0
  v_mfma_f32_16x16x32_bf16 v[140:143], v[48:51], v[16:19], 0
  v_mfma_f32_16x16x32_bf16 v[144:147], v[112:115], v[32:35], 0
  v_mfma_f32_16x16x32_bf16 v[148:151], v[48:51], v[32:35], 0
  v_mfma_f32_16x16x32_bf16 v[152:155], v[64:67], v[32:35], 0
  v_mfma_f32_16x16x32_bf16 v[136:139], v[116:119], v[20:23], v[136:139]
  v_mfma_f32_16x16x32_bf16 v[140:143], v[52:55], v[20:23], v[140:143]
  v_mfma_f32_16x16x32_bf16 v[144:147], v[116:119], v[36:39], v[144:147]
  v_mfma_f32_16x16x32_bf16 v[148:151], v[52:55], v[36:39], v[148:151]
  v_mfma_f32_16x16x32_bf16 v[152:155], v[68:71], v[36:39], v[152:155]
  v_mfma_f32_16x16x32_bf16 v[136:139], v[120:123], v[24:27], v[136:139]
  v_mfma_f32_16x16x32_bf16 v[140:143], v[56:59], v[24:27], v[140:143]
  v_mfma_f32_16x16x32_bf16 v[144:147], v[120:123], v[40:43], v[144:147]
  v_mfma_f32_16x16x32_bf16 v[148:151], v[56:59], v[40:43], v[148:151]
  v_mfma_f32_16x16x32_bf16 v[152:155], v[72:75], v[40:43], v[152:155]
  v_mfma_f32_16x16x32_bf16 v[136:139], v[124:127], v[28:31], v[136:139]
  v_mfma_f32_16x16x32_bf16 v[140:143], v[60:63], v[28:31], v[140:143]
  v_mfma_f32_16x16x32_bf16 v[144:147], v[124:127], v[44:47], v[144:147]
  v_mfma_f32_16x16x32_bf16 v[148:151], v[60:63], v[44:47], v[148:151]
  v_mfma_f32_16x16x32_bf16 v[152:155], v[76:79], v[44:47], v[152:155]
  s_nop 4
  v_cndmask_b32 v140, v6, v140, s[40:41]
  v_cndmask_b32 v141, v6, v141, s[42:43]
  v_cndmask_b32 v142, v6, v142, s[44:45]
  v_cndmask_b32 v143, v6, v143, s[46:47]
  v_max3_f32 v12, v136, v137, v140
  v_max3_f32 v12, v12, v141, v142
  v_max_f32 v12, v12, v143
  v_mov_b32 v13, v12
  s_nop 1
  v_permlane32_swap_b32 v12, v13
  v_max_f32 v12, v12, v13
  v_mov_b32 v13, v12
  s_nop 1
  v_permlane16_swap_b32 v12, v13
  v_max_f32 v12, v12, v13
  v_mul_f32 v12, s50, v12
  v_fma_f32 v136, v136, s50, -v12
  v_fma_f32 v137, v137, s50, -v12
  v_fma_f32 v140, v140, s50, -v12
  v_fma_f32 v141, v141, s50, -v12
  v_fma_f32 v142, v142, s50, -v12
  v_fma_f32 v143, v143, s50, -v12
  v_exp_f32 v136, v136
  v_exp_f32 v137, v137
  v_exp_f32 v140, v140
  v_exp_f32 v141, v141
  v_exp_f32 v142, v142
  v_exp_f32 v143, v143
  v_add_f32 v12, v136, v137
  v_add_f32 v12, v12, v140
  v_add_f32 v12, v12, v141
  v_add_f32 v12, v12, v142
  v_add_f32 v12, v12, v143
  v_mov_b32 v13, v12
  s_nop 1
  v_permlane32_swap_b32 v12, v13
  v_add_f32 v12, v12, v13
  v_mov_b32 v13, v12
  s_nop 1
  v_permlane16_swap_b32 v12, v13
  v_add_f32 v12, v12, v13
  v_rcp_f32 v12, v12
  s_nop 0
  v_mul_f32 v136, v136, v12
  v_mul_f32 v137, v137, v12
  v_mul_f32 v140, v140, v12
  v_mul_f32 v141, v141, v12
  v_mul_f32 v142, v142, v12
  v_mul_f32 v143, v143, v12
  v_cvt_pk_bf16_f32 v160, v136, v137
  v_mov_b32 v161, 0
  v_mov_b32 v162, 0
  v_mov_b32 v163, v160
  v_cvt_pk_bf16_f32 v156, v140, v141
  v_cvt_pk_bf16_f32 v157, v142, v143
  v_mov_b32 v158, 0
  v_mov_b32 v159, 0
  v_cndmask_b32 v152, v6, v152, s[40:41]
  v_cndmask_b32 v153, v6, v153, s[42:43]
  v_cndmask_b32 v154, v6, v154, s[44:45]
  v_cndmask_b32 v155, v6, v155, s[46:47]
  v_max3_f32 v12, v144, v145, v148
  v_max3_f32 v12, v12, v149, v150
  v_max3_f32 v12, v12, v151, v152
  v_max3_f32 v12, v12, v153, v154
  v_max_f32 v12, v12, v155
  v_mov_b32 v13, v12
  s_nop 1
  v_permlane32_swap_b32 v12, v13
  v_max_f32 v12, v12, v13
  v_mov_b32 v13, v12
  s_nop 1
  v_permlane16_swap_b32 v12, v13
  v_max_f32 v12, v12, v13
  v_mul_f32 v12, s50, v12
  v_fma_f32 v144, v144, s50, -v12
  v_fma_f32 v145, v145, s50, -v12
  v_fma_f32 v148, v148, s50, -v12
  v_fma_f32 v149, v149, s50, -v12
  v_fma_f32 v150, v150, s50, -v12
  v_fma_f32 v151, v151, s50, -v12
  v_fma_f32 v152, v152, s50, -v12
  v_fma_f32 v153, v153, s50, -v12
  v_fma_f32 v154, v154, s50, -v12
  v_fma_f32 v155, v155, s50, -v12
  v_exp_f32 v144, v144
  v_exp_f32 v145, v145
  v_exp_f32 v148, v148
  v_exp_f32 v149, v149
  v_exp_f32 v150, v150
  v_exp_f32 v151, v151
  v_exp_f32 v152, v152
  v_exp_f32 v153, v153
  v_exp_f32 v154, v154
  v_exp_f32 v155, v155
  v_add_f32 v12, v144, v145
  v_add_f32 v12, v12, v148
  v_add_f32 v12, v12, v149
  v_add_f32 v12, v12, v150
  v_add_f32 v12, v12, v151
  v_add_f32 v12, v12, v152
  v_add_f32 v12, v12, v153
  v_add_f32 v12, v12, v154
  v_add_f32 v12, v12, v155
  v_mov_b32 v13, v12
  s_nop 1
  v_permlane32_swap_b32 v12, v13
  v_add_f32 v12, v12, v13
  v_mov_b32 v13, v12
  s_nop 1
  v_permlane16_swap_b32 v12, v13
  v_add_f32 v12, v12, v13
  v_rcp_f32 v12, v12
  s_nop 0
  v_mul_f32 v144, v144, v12
  v_mul_f32 v145, v145, v12
  v_mul_f32 v148, v148, v12
  v_mul_f32 v149, v149, v12
  v_mul_f32 v150, v150, v12
  v_mul_f32 v151, v151, v12
  v_mul_f32 v152, v152, v12
  v_mul_f32 v153, v153, v12
  v_mul_f32 v154, v154, v12
  v_mul_f32 v155, v155, v12
  v_cvt_pk_bf16_f32 v168, v144, v145
  v_mov_b32 v169, 0
  v_mov_b32 v170, 0
  v_mov_b32 v171, v168
  v_cvt_pk_bf16_f32 v164, v148, v149
  v_cvt_pk_bf16_f32 v165, v150, v151
  v_cvt_pk_bf16_f32 v166, v152, v153
  v_cvt_pk_bf16_f32 v167, v154, v155
  v_mfma_f32_16x16x32_bf16 v[176:179], v[80:83], v[156:159], 0
  v_mfma_f32_16x16x32_bf16 v[180:183], v[84:87], v[156:159], 0
  v_mfma_f32_16x16x32_bf16 v[184:187], v[88:91], v[156:159], 0
  v_mfma_f32_16x16x32_bf16 v[188:191], v[92:95], v[156:159], 0
  v_mfma_f32_16x16x32_bf16 v[192:195], v[96:99], v[156:159], 0
  v_mfma_f32_16x16x32_bf16 v[196:199], v[100:103], v[156:159], 0
  v_mfma_f32_16x16x32_bf16 v[200:203], v[104:107], v[156:159], 0
  v_mfma_f32_16x16x32_bf16 v[204:207], v[108:111], v[156:159], 0
  v_mfma_f32_16x16x16_bf16 v[176:179], v[128:129], v[160:161], v[176:179]
  v_mfma_f32_16x16x16_bf16 v[180:183], v[128:129], v[162:163], v[180:183]
  v_mfma_f32_16x16x16_bf16 v[184:187], v[130:131], v[160:161], v[184:187]
  v_mfma_f32_16x16x16_bf16 v[188:191], v[130:131], v[162:163], v[188:191]
  v_mfma_f32_16x16x16_bf16 v[192:195], v[132:133], v[160:161], v[192:195]
  v_mfma_f32_16x16x16_bf16 v[196:199], v[132:133], v[162:163], v[196:199]
  v_mfma_f32_16x16x16_bf16 v[200:203], v[134:135], v[160:161], v[200:203]
  v_mfma_f32_16x16x16_bf16 v[204:207], v[134:135], v[162:163], v[204:207]
  v_mfma_f32_16x16x32_bf16 v[208:211], v[80:83], v[164:167], 0
  v_mfma_f32_16x16x32_bf16 v[212:215], v[84:87], v[164:167], 0
  v_mfma_f32_16x16x32_bf16 v[216:219], v[88:91], v[164:167], 0
  v_mfma_f32_16x16x32_bf16 v[220:223], v[92:95], v[164:167], 0
  v_mfma_f32_16x16x32_bf16 v[224:227], v[96:99], v[164:167], 0
  v_mfma_f32_16x16x32_bf16 v[228:231], v[100:103], v[164:167], 0
  v_mfma_f32_16x16x32_bf16 v[232:235], v[104:107], v[164:167], 0
  v_mfma_f32_16x16x32_bf16 v[236:239], v[108:111], v[164:167], 0
  v_mfma_f32_16x16x16_bf16 v[208:211], v[128:129], v[168:169], v[208:211]
  v_mfma_f32_16x16x16_bf16 v[212:215], v[128:129], v[170:171], v[212:215]
  v_mfma_f32_16x16x16_bf16 v[216:219], v[130:131], v[168:169], v[216:219]
  v_mfma_f32_16x16x16_bf16 v[220:223], v[130:131], v[170:171], v[220:223]
  v_mfma_f32_16x16x16_bf16 v[224:227], v[132:133], v[168:169], v[224:227]
  v_mfma_f32_16x16x16_bf16 v[228:231], v[132:133], v[170:171], v[228:231]
  v_mfma_f32_16x16x16_bf16 v[232:235], v[134:135], v[168:169], v[232:235]
  v_mfma_f32_16x16x16_bf16 v[236:239], v[134:135], v[170:171], v[236:239]
  v_cvt_pk_bf16_f32 v136, v176, v177
  v_cvt_pk_bf16_f32 v137, v178, v179
  v_cvt_pk_bf16_f32 v138, v184, v185
  v_cvt_pk_bf16_f32 v139, v186, v187
  buffer_store_dwordx4 v[136:139], v10, s[4:7], s95 offen offset:0 sc1
  v_cvt_pk_bf16_f32 v140, v180, v181
  v_cvt_pk_bf16_f32 v141, v182, v183
  v_cvt_pk_bf16_f32 v142, v188, v189
  v_cvt_pk_bf16_f32 v143, v190, v191
  buffer_store_dwordx4 v[140:143], v10, s[4:7], s95 offen offset:512 sc1
  v_cvt_pk_bf16_f32 v144, v192, v193
  v_cvt_pk_bf16_f32 v145, v194, v195
  v_cvt_pk_bf16_f32 v146, v200, v201
  v_cvt_pk_bf16_f32 v147, v202, v203
  buffer_store_dwordx4 v[144:147], v10, s[4:7], s95 offen offset:2048 sc1
  v_cvt_pk_bf16_f32 v148, v196, v197
  v_cvt_pk_bf16_f32 v149, v198, v199
  v_cvt_pk_bf16_f32 v150, v204, v205
  v_cvt_pk_bf16_f32 v151, v206, v207
  buffer_store_dwordx4 v[148:151], v10, s[4:7], s95 offen offset:2560 sc1
  v_cvt_pk_bf16_f32 v136, v208, v209
  v_cvt_pk_bf16_f32 v137, v210, v211
  v_cvt_pk_bf16_f32 v138, v216, v217
  v_cvt_pk_bf16_f32 v139, v218, v219
  buffer_store_dwordx4 v[136:139], v11, s[4:7], s95 offen offset:0 sc1
  v_cvt_pk_bf16_f32 v140, v212, v213
  v_cvt_pk_bf16_f32 v141, v214, v215
  v_cvt_pk_bf16_f32 v142, v220, v221
  v_cvt_pk_bf16_f32 v143, v222, v223
  buffer_store_dwordx4 v[140:143], v11, s[4:7], s95 offen offset:512 sc1
  v_cvt_pk_bf16_f32 v144, v224, v225
  v_cvt_pk_bf16_f32 v145, v226, v227
  v_cvt_pk_bf16_f32 v146, v232, v233
  v_cvt_pk_bf16_f32 v147, v234, v235
  buffer_store_dwordx4 v[144:147], v11, s[4:7], s95 offen offset:2048 sc1
  v_cvt_pk_bf16_f32 v148, v228, v229
  v_cvt_pk_bf16_f32 v149, v230, v231
  v_cvt_pk_bf16_f32 v150, v236, v237
  v_cvt_pk_bf16_f32 v151, v238, v239
  buffer_store_dwordx4 v[148:151], v11, s[4:7], s95 offen offset:2560 sc1
  s_add_u32 s95, s95, 262144
  s_waitcnt vmcnt(16)
  s_cmp_lg_u32 s32, 0
  s_cbranch_scc1 L_rq_24
  s_cmp_eq_u32 s39, 0
  s_cbranch_scc1 L_rq_24
  s_lshl_b32 s99, s33, 7
  s_add_u32 s99, s99, 0x3d00200
  v_mov_b32 v244, 1
  v_mov_b32 v245, 0
  s_mov_b64 exec, 1
  buffer_atomic_add v244, v245, s[4:7], s99 offen sc0 sc1
  s_mov_b64 exec, -1
L_rq_24:
  v_mfma_f32_16x16x32_bf16 v[136:139], a[96:99], a[0:3], 0
  v_mfma_f32_16x16x32_bf16 v[140:143], a[32:35], a[0:3], 0
  v_mfma_f32_16x16x32_bf16 v[144:147], a[96:99], a[16:19], 0
  v_mfma_f32_16x16x32_bf16 v[148:151], a[32:35], a[16:19], 0
  v_mfma_f32_16x16x32_bf16 v[152:155], a[48:51], a[16:19], 0
  v_mfma_f32_16x16x32_bf16 v[136:139], a[100:103], a[4:7], v[136:139]
  v_mfma_f32_16x16x32_bf16 v[140:143], a[36:39], a[4:7], v[140:143]
  v_mfma_f32_16x16x32_bf16 v[144:147], a[100:103], a[20:23], v[144:147]
  v_mfma_f32_16x16x32_bf16 v[148:151], a[36:39], a[20:23], v[148:151]
  v_mfma_f32_16x16x32_bf16 v[152:155], a[52:55], a[20:23], v[152:155]
  v_mfma_f32_16x16x32_bf16 v[136:139], a[104:107], a[8:11], v[136:139]
  v_mfma_f32_16x16x32_bf16 v[140:143], a[40:43], a[8:11], v[140:143]
  v_mfma_f32_16x16x32_bf16 v[144:147], a[104:107], a[24:27], v[144:147]
  v_mfma_f32_16x16x32_bf16 v[148:151], a[40:43], a[24:27], v[148:151]
  v_mfma_f32_16x16x32_bf16 v[152:155], a[56:59], a[24:27], v[152:155]
  v_mfma_f32_16x16x32_bf16 v[136:139], a[108:111], a[12:15], v[136:139]
  v_mfma_f32_16x16x32_bf16 v[140:143], a[44:47], a[12:15], v[140:143]
  v_mfma_f32_16x16x32_bf16 v[144:147], a[108:111], a[28:31], v[144:147]
  v_mfma_f32_16x16x32_bf16 v[148:151], a[44:47], a[28:31], v[148:151]
  v_mfma_f32_16x16x32_bf16 v[152:155], a[60:63], a[28:31], v[152:155]
  s_nop 4
  v_cndmask_b32 v140, v6, v140, s[40:41]
  v_cndmask_b32 v141, v6, v141, s[42:43]
  v_cndmask_b32 v142, v6, v142, s[44:45]
  v_cndmask_b32 v143, v6, v143, s[46:47]
  v_max3_f32 v12, v136, v137, v140
  v_max3_f32 v12, v12, v141, v142
  v_max_f32 v12, v12, v143
  v_mov_b32 v13, v12
  s_nop 1
  v_permlane32_swap_b32 v12, v13
  v_max_f32 v12, v12, v13
  v_mov_b32 v13, v12
  s_nop 1
  v_permlane16_swap_b32 v12, v13
  v_max_f32 v12, v12, v13
  v_mul_f32 v12, s50, v12
  v_fma_f32 v136, v136, s50, -v12
  v_fma_f32 v137, v137, s50, -v12
  v_fma_f32 v140, v140, s50, -v12
  v_fma_f32 v141, v141, s50, -v12
  v_fma_f32 v142, v142, s50, -v12
  v_fma_f32 v143, v143, s50, -v12
  v_exp_f32 v136, v136
  v_exp_f32 v137, v137
  v_exp_f32 v140, v140
  v_exp_f32 v141, v141
  v_exp_f32 v142, v142
  v_exp_f32 v143, v143
  v_add_f32 v12, v136, v137
  v_add_f32 v12, v12, v140
  v_add_f32 v12, v12, v141
  v_add_f32 v12, v12, v142
  v_add_f32 v12, v12, v143
  v_mov_b32 v13, v12
  s_nop 1
  v_permlane32_swap_b32 v12, v13
  v_add_f32 v12, v12, v13
  v_mov_b32 v13, v12
  s_nop 1
  v_permlane16_swap_b32 v12, v13
  v_add_f32 v12, v12, v13
  v_rcp_f32 v12, v12
  s_nop 0
  v_mul_f32 v136, v136, v12
  v_mul_f32 v137, v137, v12
  v_mul_f32 v140, v140, v12
  v_mul_f32 v141, v141, v12
  v_mul_f32 v142, v142, v12
  v_mul_f32 v143, v143, v12
  v_cvt_pk_bf16_f32 v160, v136, v137
  v_mov_b32 v161, 0
  v_mov_b32 v162, 0
  v_mov_b32 v163, v160
  v_cvt_pk_bf16_f32 v156, v140, v141
  v_cvt_pk_bf16_f32 v157, v142, v143
  v_mov_b32 v158, 0
  v_mov_b32 v159, 0
  v_cndmask_b32 v152, v6, v152, s[40:41]
  v_cndmask_b32 v153, v6, v153, s[42:43]
  v_cndmask_b32 v154, v6, v154, s[44:45]
  v_cndmask_b32 v155, v6, v155, s[46:47]
  v_max3_f32 v12, v144, v145, v148
  v_max3_f32 v12, v12, v149, v150
  v_max3_f32 v12, v12, v151, v152
  v_max3_f32 v12, v12, v153, v154
  v_max_f32 v12, v12, v155
  v_mov_b32 v13, v12
  s_nop 1
  v_permlane32_swap_b32 v12, v13
  v_max_f32 v12, v12, v13
  v_mov_b32 v13, v12
  s_nop 1
  v_permlane16_swap_b32 v12, v13
  v_max_f32 v12, v12, v13
  v_mul_f32 v12, s50, v12
  v_fma_f32 v144, v144, s50, -v12
  v_fma_f32 v145, v145, s50, -v12
  v_fma_f32 v148, v148, s50, -v12
  v_fma_f32 v149, v149, s50, -v12
  v_fma_f32 v150, v150, s50, -v12
  v_fma_f32 v151, v151, s50, -v12
  v_fma_f32 v152, v152, s50, -v12
  v_fma_f32 v153, v153, s50, -v12
  v_fma_f32 v154, v154, s50, -v12
  v_fma_f32 v155, v155, s50, -v12
  v_exp_f32 v144, v144
  v_exp_f32 v145, v145
  v_exp_f32 v148, v148
  v_exp_f32 v149, v149
  v_exp_f32 v150, v150
  v_exp_f32 v151, v151
  v_exp_f32 v152, v152
  v_exp_f32 v153, v153
  v_exp_f32 v154, v154
  v_exp_f32 v155, v155
  v_add_f32 v12, v144, v145
  v_add_f32 v12, v12, v148
  v_add_f32 v12, v12, v149
  v_add_f32 v12, v12, v150
  v_add_f32 v12, v12, v151
  v_add_f32 v12, v12, v152
  v_add_f32 v12, v12, v153
  v_add_f32 v12, v12, v154
  v_add_f32 v12, v12, v155
  v_mov_b32 v13, v12
  s_nop 1
  v_permlane32_swap_b32 v12, v13
  v_add_f32 v12, v12, v13
  v_mov_b32 v13, v12
  s_nop 1
  v_permlane16_swap_b32 v12, v13
  v_add_f32 v12, v12, v13
  v_rcp_f32 v12, v12
  s_nop 0
  v_mul_f32 v144, v144, v12
  v_mul_f32 v145, v145, v12
  v_mul_f32 v148, v148, v12
  v_mul_f32 v149, v149, v12
  v_mul_f32 v150, v150, v12
  v_mul_f32 v151, v151, v12
  v_mul_f32 v152, v152, v12
  v_mul_f32 v153, v153, v12
  v_mul_f32 v154, v154, v12
  v_mul_f32 v155, v155, v12
  v_cvt_pk_bf16_f32 v168, v144, v145
  v_mov_b32 v169, 0
  v_mov_b32 v170, 0
  v_mov_b32 v171, v168
  v_cvt_pk_bf16_f32 v164, v148, v149
  v_cvt_pk_bf16_f32 v165, v150, v151
  v_cvt_pk_bf16_f32 v166, v152, v153
  v_cvt_pk_bf16_f32 v167, v154, v155
  v_mfma_f32_16x16x32_bf16 v[176:179], a[64:67], v[156:159], 0
  v_mfma_f32_16x16x32_bf16 v[180:183], a[68:71], v[156:159], 0
  v_mfma_f32_16x16x32_bf16 v[184:187], a[72:75], v[156:159], 0
  v_mfma_f32_16x16x32_bf16 v[188:191], a[76:79], v[156:159], 0
  v_mfma_f32_16x16x32_bf16 v[192:195], a[80:83], v[156:159], 0
  v_mfma_f32_16x16x32_bf16 v[196:199], a[84:87], v[156:159], 0
  v_mfma_f32_16x16x32_bf16 v[200:203], a[88:91], v[156:159], 0
  v_mfma_f32_16x16x32_bf16 v[204:207], a[92:95], v[156:159], 0
  v_mfma_f32_16x16x16_bf16 v[176:179], a[112:113], v[160:161], v[176:179]
  v_mfma_f32_16x16x16_bf16 v[180:183], a[112:113], v[162:163], v[180:183]
  v_mfma_f32_16x16x16_bf16 v[184:187], a[114:115], v[160:161], v[184:187]
  v_mfma_f32_16x16x16_bf16 v[188:191], a[114:115], v[162:163], v[188:191]
  v_mfma_f32_16x16x16_bf16 v[192:195], a[116:117], v[160:161], v[192:195]
  v_mfma_f32_16x16x16_bf16 v[196:199], a[116:117], v[162:163], v[196:199]
  v_mfma_f32_16x16x16_bf16 v[200:203], a[118:119], v[160:161], v[200:203]
  v_mfma_f32_16x16x16_bf16 v[204:207], a[118:119], v[162:163], v[204:207]
  v_mfma_f32_16x16x32_bf16 v[208:211], a[64:67], v[164:167], 0
  v_mfma_f32_16x16x32_bf16 v[212:215], a[68:71], v[164:167], 0
  v_mfma_f32_16x16x32_bf16 v[216:219], a[72:75], v[164:167], 0
  v_mfma_f32_16x16x32_bf16 v[220:223], a[76:79], v[164:167], 0
  v_mfma_f32_16x16x32_bf16 v[224:227], a[80:83], v[164:167], 0
  v_mfma_f32_16x16x32_bf16 v[228:231], a[84:87], v[164:167], 0
  v_mfma_f32_16x16x32_bf16 v[232:235], a[88:91], v[164:167], 0
  v_mfma_f32_16x16x32_bf16 v[236:239], a[92:95], v[164:167], 0
  v_mfma_f32_16x16x16_bf16 v[208:211], a[112:113], v[168:169], v[208:211]
  v_mfma_f32_16x16x16_bf16 v[212:215], a[112:113], v[170:171], v[212:215]
  v_mfma_f32_16x16x16_bf16 v[216:219], a[114:115], v[168:169], v[216:219]
  v_mfma_f32_16x16x16_bf16 v[220:223], a[114:115], v[170:171], v[220:223]
  v_mfma_f32_16x16x16_bf16 v[224:227], a[116:117], v[168:169], v[224:227]
  v_mfma_f32_16x16x16_bf16 v[228:231], a[116:117], v[170:171], v[228:231]
  v_mfma_f32_16x16x16_bf16 v[232:235], a[118:119], v[168:169], v[232:235]
  v_mfma_f32_16x16x16_bf16 v[236:239], a[118:119], v[170:171], v[236:239]
  v_cvt_pk_bf16_f32 v136, v176, v177
  v_cvt_pk_bf16_f32 v137, v178, v179
  v_cvt_pk_bf16_f32 v138, v184, v185
  v_cvt_pk_bf16_f32 v139, v186, v187
  buffer_store_dwordx4 v[136:139], v10, s[4:7], s95 offen offset:0 sc1
  v_cvt_pk_bf16_f32 v140, v180, v181
  v_cvt_pk_bf16_f32 v141, v182, v183
  v_cvt_pk_bf16_f32 v142, v188, v189
  v_cvt_pk_bf16_f32 v143, v190, v191
  buffer_store_dwordx4 v[140:143], v10, s[4:7], s95 offen offset:512 sc1
  v_cvt_pk_bf16_f32 v144, v192, v193
  v_cvt_pk_bf16_f32 v145, v194, v195
  v_cvt_pk_bf16_f32 v146, v200, v201
  v_cvt_pk_bf16_f32 v147, v202, v203
  buffer_store_dwordx4 v[144:147], v10, s[4:7], s95 offen offset:2048 sc1
  v_cvt_pk_bf16_f32 v148, v196, v197
  v_cvt_pk_bf16_f32 v149, v198, v199
  v_cvt_pk_bf16_f32 v150, v204, v205
  v_cvt_pk_bf16_f32 v151, v206, v207
  buffer_store_dwordx4 v[148:151], v10, s[4:7], s95 offen offset:2560 sc1
  v_cvt_pk_bf16_f32 v136, v208, v209
  v_cvt_pk_bf16_f32 v137, v210, v211
  v_cvt_pk_bf16_f32 v138, v216, v217
  v_cvt_pk_bf16_f32 v139, v218, v219
  buffer_store_dwordx4 v[136:139], v11, s[4:7], s95 offen offset:0 sc1
  v_cvt_pk_bf16_f32 v140, v212, v213
  v_cvt_pk_bf16_f32 v141, v214, v215
  v_cvt_pk_bf16_f32 v142, v220, v221
  v_cvt_pk_bf16_f32 v143, v222, v223
  buffer_store_dwordx4 v[140:143], v11, s[4:7], s95 offen offset:512 sc1
  v_cvt_pk_bf16_f32 v144, v224, v225
  v_cvt_pk_bf16_f32 v145, v226, v227
  v_cvt_pk_bf16_f32 v146, v232, v233
  v_cvt_pk_bf16_f32 v147, v234, v235
  buffer_store_dwordx4 v[144:147], v11, s[4:7], s95 offen offset:2048 sc1
  v_cvt_pk_bf16_f32 v148, v228, v229
  v_cvt_pk_bf16_f32 v149, v230, v231
  v_cvt_pk_bf16_f32 v150, v236, v237
  v_cvt_pk_bf16_f32 v151, v238, v239
  buffer_store_dwordx4 v[148:151], v11, s[4:7], s95 offen offset:2560 sc1
  s_add_u32 s95, s95, 262144
  s_branch L_done
L_bo:
  s_lshr_b32 s40, s36, 1
  s_lshl_b32 s40, s40, 7
  s_add_u32 s40, s40, 1024
  s_mov_b32 s41, 16
  s_mov_b32 s12, s82
  s_and_b32 s13, s83, 0xffff
  s_mov_b32 s14, 0x200000
  s_mov_b32 s15, 0x20000
  s_mov_b32 s23, 65536
  s_mov_b32 s25, 4
  s_lshl_b32 s20, s36, 18
  s_add_u32 s20, s20, 0x6000000
  s_mov_b32 s22, 2048
  s_branch L_g3
L_aos:
  s_mov_b32 s12, s74
  s_and_b32 s13, s75, 0xffff
  s_mov_b32 s14, 0x800000
  s_mov_b32 s15, 0x20000
  s_and_b32 s48, s37, 7
  s_lshr_b32 s37, s37, 3
  s_sub_u32 s40, s36, 12
  s_lshl_b32 s40, s40, 4
  s_add_u32 s40, s40, s48
  s_lshl_b32 s40, s40, 7
  s_add_u32 s40, s40, 20480
  s_mov_b32 s41, 2
  s_add_u32 s42, s40, 1024
  s_mov_b32 s23, 262144
  s_mov_b32 s25, 2
  s_lshl_b32 s20, s36, 20
  s_add_u32 s20, s20, 0x5000000
  s_lshl_b32 s90, s48, 15
  s_add_u32 s20, s20, s90
  s_mov_b32 s22, 0
  s_lshl_b32 s49, s48, 20
  s_branch L_g3b
L_ao:
  s_lshl_b32 s40, s36, 7
  s_add_u32 s40, s40, 2048
  s_mov_b32 s41, 32
  s_mov_b32 s12, s74
  s_and_b32 s13, s75, 0xffff
  s_mov_b32 s14, 0x800000
  s_mov_b32 s15, 0x20000
  s_mov_b32 s23, 262144
  s_mov_b32 s25, 16
  s_lshl_b32 s20, s36, 20
  s_add_u32 s20, s20, 0x5000000
  s_mov_b32 s22, 0
L_g3:
  s_mov_b32 s49, 0
  s_mov_b32 s42, s40
L_g3b:
  s_mov_b32 s8, s4
  s_and_b32 s9, s5, 0xffff
  s_mov_b32 s10, 0x10000000
  s_mov_b32 s11, 0x20000
  s_lshl_b32 s91, s33, 1
  s_add_u32 s91, s91, s37
  s_mov_b32 s24, 2048
  s_mov_b32 s26, 4096
  s_lshl_b32 s21, s91, 8
  s_add_u32 s22, s22, s21
  s_lshl_b32 s90, s36, 19
  s_add_u32 s22, s22, s90
  s_add_u32 s21, s21, s49
  s_mov_b32 s50, s91
  v_and_b32 v1, 63, v0
  v_lshrrev_b32 v16, 6, v0
  s_nop 0
  v_readfirstlane_b32 s27, v16
  s_mul_i32 s90, s27, 1
  s_mul_i32 s90, s90, s23
  v_mov_b32 v2, 0x0
  v_bfe_u32 v17, v1, 0, 6
  v_lshl_add_u32 v2, v17, 4, v2
  v_add_u32 v2, s90, v2
  v_mov_b32 v3, 0x400
  v_bfe_u32 v17, v1, 0, 6
  v_lshl_add_u32 v3, v17, 4, v3
  v_add_u32 v3, s90, v3
  v_mov_b32 v4, 0x1000
  v_bfe_u32 v17, v1, 0, 6
  v_lshl_add_u32 v4, v17, 4, v4
  v_add_u32 v4, s90, v4
  v_mov_b32 v5, 0x1400
  v_bfe_u32 v17, v1, 0, 6
  v_lshl_add_u32 v5, v17, 4, v5
  v_add_u32 v5, s90, v5
  s_mul_i32 s90, s27, 16
  v_lshrrev_b32 v16, 4, v1
  v_add_u32 v16, 0, v16
  v_add_u32 v16, s90, v16
  v_and_b32 v17, 7, v16
  v_lshlrev_b32 v17, 1, v17
  v_xor_b32 v17, v17, v1
  v_and_b32 v17, 15, v17
  v_mul_lo_u32 v16, v16, s24
  v_lshl_add_u32 v6, v17, 4, v16
  v_lshrrev_b32 v16, 4, v1
  v_add_u32 v16, 4, v16
  v_add_u32 v16, s90, v16
  v_and_b32 v17, 7, v16
  v_lshlrev_b32 v17, 1, v17
  v_xor_b32 v17, v17, v1
  v_and_b32 v17, 15, v17
  v_mul_lo_u32 v16, v16, s24
  v_lshl_add_u32 v7, v17, 4, v16
  v_lshrrev_b32 v16, 4, v1
  v_add_u32 v16, 8, v16
  v_add_u32 v16, s90, v16
  v_and_b32 v17, 7, v16
  v_lshlrev_b32 v17, 1, v17
  v_xor_b32 v17, v17, v1
  v_and_b32 v17, 15, v17
  v_mul_lo_u32 v16, v16, s24
  v_lshl_add_u32 v8, v17, 4, v16
  v_lshrrev_b32 v16, 4, v1
  v_add_u32 v16, 12, v16
  v_add_u32 v16, s90, v16
  v_and_b32 v17, 7, v16
  v_lshlrev_b32 v17, 1, v17
  v_xor_b32 v17, v17, v1
  v_and_b32 v17, 15, v17
  v_mul_lo_u32 v16, v16, s24
  v_lshl_add_u32 v9, v17, 4, v16
  s_mul_i32 s51, s24, 64
  s_mul_i32 s52, s27, 4096
  s_mul_i32 s53, s27, 4096
  s_add_u32 s53, s53, 16384
  s_add_u32 m0, s53, 0
  s_nop 0
  buffer_load_dwordx4 v6, s[12:15], s21 offen  lds
  s_add_u32 m0, s53, 1024
  s_nop 0
  buffer_load_dwordx4 v7, s[12:15], s21 offen  lds
  s_add_u32 m0, s53, 2048
  s_nop 0
  buffer_load_dwordx4 v8, s[12:15], s21 offen  lds
  s_add_u32 m0, s53, 3072
  s_nop 0
  buffer_load_dwordx4 v9, s[12:15], s21 offen  lds
  s_add_u32 s21, s21, s51
  s_add_u32 m0, s53, 32768
  s_nop 0
  buffer_load_dwordx4 v6, s[12:15], s21 offen  lds
  s_add_u32 m0, s53, 33792
  s_nop 0
  buffer_load_dwordx4 v7, s[12:15], s21 offen  lds
  s_add_u32 m0, s53, 34816
  s_nop 0
  buffer_load_dwordx4 v8, s[12:15], s21 offen  lds
  s_add_u32 m0, s53, 35840
  s_nop 0
  buffer_load_dwordx4 v9, s[12:15], s21 offen  lds
  s_add_u32 s21, s21, s51
  s_add_u32 m0, s53, 65536
  s_nop 0
  buffer_load_dwordx4 v6, s[12:15], s21 offen  lds
  s_add_u32 m0, s53, 66560
  s_nop 0
  buffer_load_dwordx4 v7, s[12:15], s21 offen  lds
  s_add_u32 m0, s53, 67584
  s_nop 0
  buffer_load_dwordx4 v8, s[12:15], s21 offen  lds
  s_add_u32 m0, s53, 68608
  s_nop 0
  buffer_load_dwordx4 v9, s[12:15], s21 offen  lds
  s_add_u32 s21, s21, s51
  s_add_u32 m0, s53, 98304
  s_nop 0
  buffer_load_dwordx4 v6, s[12:15], s21 offen  lds
  s_add_u32 m0, s53, 99328
  s_nop 0
  buffer_load_dwordx4 v7, s[12:15], s21 offen  lds
  s_add_u32 m0, s53, 100352
  s_nop 0
  buffer_load_dwordx4 v8, s[12:15], s21 offen  lds
  s_add_u32 m0, s53, 101376
  s_nop 0
  buffer_load_dwordx4 v9, s[12:15], s21 offen  lds
  s_add_u32 s21, s21, s51
  s_cmp_lg_u32 s32, 0
  s_cbranch_scc1 L_dd_26
  v_mov_b32 v228, 0x3d00000
L_dw_25:
  buffer_load_dword v234, v228, s[4:7], s40 offen offset:0 sc1
  buffer_load_dword v235, v228, s[4:7], s42 offen offset:0 sc1
  s_waitcnt vmcnt(0)
  s_mov_b32 s44, 1
  v_readfirstlane_b32 s45, v234
  s_cmp_ge_u32 s45, s41
  s_cselect_b32 s44, s44, 0
  v_readfirstlane_b32 s45, v235
  s_cmp_ge_u32 s45, s41
  s_cselect_b32 s44, s44, 0
  s_cmp_eq_u32 s44, 1
  s_cbranch_scc1 L_dd_26
  s_sleep 3
  s_add_u32 s3, s3, 1
  s_cmp_lt_u32 s3, 131072
  s_cbranch_scc1 L_dw_25
L_dd_26:
  s_barrier
  s_add_u32 m0, s52, 0
  s_nop 0
  buffer_load_dwordx4 v2, s[8:11], s20 offen sc1 lds
  s_add_u32 m0, s52, 1024
  s_nop 0
  buffer_load_dwordx4 v3, s[8:11], s20 offen sc1 lds
  s_add_u32 m0, s52, 2048
  s_nop 0
  buffer_load_dwordx4 v4, s[8:11], s20 offen sc1 lds
  s_add_u32 m0, s52, 3072
  s_nop 0
  buffer_load_dwordx4 v5, s[8:11], s20 offen sc1 lds
  s_add_u32 s20, s20, 2048
  s_add_u32 m0, s52, 32768
  s_nop 0
  buffer_load_dwordx4 v2, s[8:11], s20 offen sc1 lds
  s_add_u32 m0, s52, 33792
  s_nop 0
  buffer_load_dwordx4 v3, s[8:11], s20 offen sc1 lds
  s_add_u32 m0, s52, 34816
  s_nop 0
  buffer_load_dwordx4 v4, s[8:11], s20 offen sc1 lds
  s_add_u32 m0, s52, 35840
  s_nop 0
  buffer_load_dwordx4 v5, s[8:11], s20 offen sc1 lds
  s_add_u32 s20, s20, 6144
  s_add_u32 m0, s52, 65536
  s_nop 0
  buffer_load_dwordx4 v2, s[8:11], s20 offen sc1 lds
  s_add_u32 m0, s52, 66560
  s_nop 0
  buffer_load_dwordx4 v3, s[8:11], s20 offen sc1 lds
  s_add_u32 m0, s52, 67584
  s_nop 0
  buffer_load_dwordx4 v4, s[8:11], s20 offen sc1 lds
  s_add_u32 m0, s52, 68608
  s_nop 0
  buffer_load_dwordx4 v5, s[8:11], s20 offen sc1 lds
  s_add_u32 s20, s20, 2048
  s_add_u32 m0, s52, 98304
  s_nop 0
  buffer_load_dwordx4 v2, s[8:11], s20 offen sc1 lds
  s_add_u32 m0, s52, 99328
  s_nop 0
  buffer_load_dwordx4 v3, s[8:11], s20 offen sc1 lds
  s_add_u32 m0, s52, 100352
  s_nop 0
  buffer_load_dwordx4 v4, s[8:11], s20 offen sc1 lds
  s_add_u32 m0, s52, 101376
  s_nop 0
  buffer_load_dwordx4 v5, s[8:11], s20 offen sc1 lds
  s_add_u32 s20, s20, 6144
  s_lshr_b32 s90, s27, 1
  s_and_b32 s91, s27, 1
  s_mul_i32 s92, s90, 8192
  v_mov_b32 v10, 0x0
  v_bfe_u32 v17, v1, 0, 6
  v_lshl_add_u32 v10, v17, 4, v10
  v_add_u32 v10, s92, v10
  v_add_u32 v11, 65536, v10
  v_mov_b32 v16, 0x0
  v_bfe_u32 v17, v1, 2, 2
  v_lshl_add_u32 v16, v17, 8, v16
  v_bfe_u32 v17, v1, 4, 2
  v_lshl_add_u32 v16, v17, 10, v16
  v_bfe_u32 v17, v1, 0, 1
  v_lshl_add_u32 v16, v17, 4, v16
  v_bfe_u32 v18, v1, 2, 3
  v_bfe_u32 v17, v1, 1, 1
  v_xor_b32 v18, v18, v17
  s_mul_i32 s92, s91, 4
  s_add_u32 s93, s92, 0
  v_xor_b32 v17, s93, v18
  v_lshl_add_u32 v12, v17, 5, v16
  v_add_u32 v14, 65536, v12
  s_add_u32 s93, s92, 2
  v_xor_b32 v17, s93, v18
  v_lshl_add_u32 v13, v17, 5, v16
  v_add_u32 v15, 65536, v13
  s_waitcnt vmcnt(12)
  s_barrier
  ds_read_b128 v[20:23], v10 offset:0
  ds_read_b64_tr_b16 v[52:53], v12 offset:16384
  ds_read_b64_tr_b16 v[54:55], v12 offset:20480
  ds_read_b128 v[24:27], v10 offset:2048
  ds_read_b64_tr_b16 v[56:57], v12 offset:16392
  ds_read_b64_tr_b16 v[58:59], v12 offset:20488
  ds_read_b128 v[28:31], v10 offset:4096
  ds_read_b64_tr_b16 v[60:61], v13 offset:16384
  ds_read_b64_tr_b16 v[62:63], v13 offset:20480
  ds_read_b128 v[32:35], v10 offset:6144
  ds_read_b64_tr_b16 v[64:65], v13 offset:16392
  ds_read_b64_tr_b16 v[66:67], v13 offset:20488
  s_sub_u32 s25, s25, 1
  s_waitcnt lgkmcnt(0)
  v_mfma_f32_16x16x32_bf16 a[0:3], v[52:55], v[20:23], 0
  ds_read_b128 v[36:39], v10 offset:1024
  v_mfma_f32_16x16x32_bf16 a[4:7], v[56:59], v[20:23], 0
  ds_read_b64_tr_b16 v[68:69], v12 offset:24576
  v_mfma_f32_16x16x32_bf16 a[8:11], v[60:63], v[20:23], 0
  ds_read_b64_tr_b16 v[70:71], v12 offset:28672
  v_mfma_f32_16x16x32_bf16 a[12:15], v[64:67], v[20:23], 0
  ds_read_b128 v[40:43], v10 offset:3072
  v_mfma_f32_16x16x32_bf16 a[16:19], v[52:55], v[24:27], 0
  ds_read_b64_tr_b16 v[72:73], v12 offset:24584
  v_mfma_f32_16x16x32_bf16 a[20:23], v[56:59], v[24:27], 0
  ds_read_b64_tr_b16 v[74:75], v12 offset:28680
  v_mfma_f32_16x16x32_bf16 a[24:27], v[60:63], v[24:27], 0
  ds_read_b128 v[44:47], v10 offset:5120
  v_mfma_f32_16x16x32_bf16 a[28:31], v[64:67], v[24:27], 0
  ds_read_b64_tr_b16 v[76:77], v13 offset:24576
  v_mfma_f32_16x16x32_bf16 a[32:35], v[52:55], v[28:31], 0
  ds_read_b64_tr_b16 v[78:79], v13 offset:28672
  v_mfma_f32_16x16x32_bf16 a[36:39], v[56:59], v[28:31], 0
  ds_read_b128 v[48:51], v10 offset:7168
  v_mfma_f32_16x16x32_bf16 a[40:43], v[60:63], v[28:31], 0
  ds_read_b64_tr_b16 v[80:81], v13 offset:24584
  v_mfma_f32_16x16x32_bf16 a[44:47], v[64:67], v[28:31], 0
  ds_read_b64_tr_b16 v[82:83], v13 offset:28680
  v_mfma_f32_16x16x32_bf16 a[48:51], v[52:55], v[32:35], 0
  v_mfma_f32_16x16x32_bf16 a[52:55], v[56:59], v[32:35], 0
  v_mfma_f32_16x16x32_bf16 a[56:59], v[60:63], v[32:35], 0
  v_mfma_f32_16x16x32_bf16 a[60:63], v[64:67], v[32:35], 0
  s_waitcnt lgkmcnt(0)
  v_mfma_f32_16x16x32_bf16 a[0:3], v[68:71], v[36:39], a[0:3]
  s_waitcnt vmcnt(8)
  s_barrier
  s_add_u32 m0, s52, 0
  v_mfma_f32_16x16x32_bf16 a[4:7], v[72:75], v[36:39], a[4:7]
  buffer_load_dwordx4 v2, s[8:11], s20 offen sc1 lds
  ds_read_b128 v[20:23], v10 offset:32768
  v_mfma_f32_16x16x32_bf16 a[8:11], v[76:79], v[36:39], a[8:11]
  ds_read_b64_tr_b16 v[52:53], v12 offset:49152
  v_mfma_f32_16x16x32_bf16 a[12:15], v[80:83], v[36:39], a[12:15]
  ds_read_b64_tr_b16 v[54:55], v12 offset:53248
  s_add_u32 m0, s53, 0
  v_mfma_f32_16x16x32_bf16 a[16:19], v[68:71], v[40:43], a[16:19]
  buffer_load_dwordx4 v6, s[12:15], s21 offen  lds
  ds_read_b128 v[24:27], v10 offset:34816
  v_mfma_f32_16x16x32_bf16 a[20:23], v[72:75], v[40:43], a[20:23]
  ds_read_b64_tr_b16 v[56:57], v12 offset:49160
  v_mfma_f32_16x16x32_bf16 a[24:27], v[76:79], v[40:43], a[24:27]
  ds_read_b64_tr_b16 v[58:59], v12 offset:53256
  s_add_u32 m0, s52, 1024
  v_mfma_f32_16x16x32_bf16 a[28:31], v[80:83], v[40:43], a[28:31]
  buffer_load_dwordx4 v3, s[8:11], s20 offen sc1 lds
  ds_read_b128 v[28:31], v10 offset:36864
  v_mfma_f32_16x16x32_bf16 a[32:35], v[68:71], v[44:47], a[32:35]
  ds_read_b64_tr_b16 v[60:61], v13 offset:49152
  v_mfma_f32_16x16x32_bf16 a[36:39], v[72:75], v[44:47], a[36:39]
  ds_read_b64_tr_b16 v[62:63], v13 offset:53248
  s_add_u32 m0, s53, 1024
  v_mfma_f32_16x16x32_bf16 a[40:43], v[76:79], v[44:47], a[40:43]
  buffer_load_dwordx4 v7, s[12:15], s21 offen  lds
  ds_read_b128 v[32:35], v10 offset:38912
  v_mfma_f32_16x16x32_bf16 a[44:47], v[80:83], v[44:47], a[44:47]
  ds_read_b64_tr_b16 v[64:65], v13 offset:49160
  v_mfma_f32_16x16x32_bf16 a[48:51], v[68:71], v[48:51], a[48:51]
  ds_read_b64_tr_b16 v[66:67], v13 offset:53256
  s_add_u32 m0, s52, 2048
  v_mfma_f32_16x16x32_bf16 a[52:55], v[72:75], v[48:51], a[52:55]
  buffer_load_dwordx4 v4, s[8:11], s20 offen sc1 lds
  v_mfma_f32_16x16x32_bf16 a[56:59], v[76:79], v[48:51], a[56:59]
  v_mfma_f32_16x16x32_bf16 a[60:63], v[80:83], v[48:51], a[60:63]
  s_waitcnt lgkmcnt(0)
  s_add_u32 m0, s53, 2048
  v_mfma_f32_16x16x32_bf16 a[0:3], v[52:55], v[20:23], a[0:3]
  buffer_load_dwordx4 v8, s[12:15], s21 offen  lds
  ds_read_b128 v[36:39], v10 offset:33792
  v_mfma_f32_16x16x32_bf16 a[4:7], v[56:59], v[20:23], a[4:7]
  ds_read_b64_tr_b16 v[68:69], v12 offset:57344
  v_mfma_f32_16x16x32_bf16 a[8:11], v[60:63], v[20:23], a[8:11]
  ds_read_b64_tr_b16 v[70:71], v12 offset:61440
  v_mfma_f32_16x16x32_bf16 a[12:15], v[64:67], v[20:23], a[12:15]
  ds_read_b128 v[40:43], v10 offset:35840
  s_add_u32 m0, s52, 3072
  v_mfma_f32_16x16x32_bf16 a[16:19], v[52:55], v[24:27], a[16:19]
  buffer_load_dwordx4 v5, s[8:11], s20 offen sc1 lds
  ds_read_b64_tr_b16 v[72:73], v12 offset:57352
  v_mfma_f32_16x16x32_bf16 a[20:23], v[56:59], v[24:27], a[20:23]
  ds_read_b64_tr_b16 v[74:75], v12 offset:61448
  v_mfma_f32_16x16x32_bf16 a[24:27], v[60:63], v[24:27], a[24:27]
  ds_read_b128 v[44:47], v10 offset:37888
  v_mfma_f32_16x16x32_bf16 a[28:31], v[64:67], v[24:27], a[28:31]
  ds_read_b64_tr_b16 v[76:77], v13 offset:57344
  s_add_u32 m0, s53, 3072
  v_mfma_f32_16x16x32_bf16 a[32:35], v[52:55], v[28:31], a[32:35]
  buffer_load_dwordx4 v9, s[12:15], s21 offen  lds
  ds_read_b64_tr_b16 v[78:79], v13 offset:61440
  v_mfma_f32_16x16x32_bf16 a[36:39], v[56:59], v[28:31], a[36:39]
  ds_read_b128 v[48:51], v10 offset:39936
  v_mfma_f32_16x16x32_bf16 a[40:43], v[60:63], v[28:31], a[40:43]
  ds_read_b64_tr_b16 v[80:81], v13 offset:57352
  v_mfma_f32_16x16x32_bf16 a[44:47], v[64:67], v[28:31], a[44:47]
  ds_read_b64_tr_b16 v[82:83], v13 offset:61448
  s_add_u32 s20, s20, 2048
  v_mfma_f32_16x16x32_bf16 a[48:51], v[52:55], v[32:35], a[48:51]
  s_add_u32 s21, s21, s51
  v_mfma_f32_16x16x32_bf16 a[52:55], v[56:59], v[32:35], a[52:55]
  v_mfma_f32_16x16x32_bf16 a[56:59], v[60:63], v[32:35], a[56:59]
  v_mfma_f32_16x16x32_bf16 a[60:63], v[64:67], v[32:35], a[60:63]
  s_waitcnt lgkmcnt(0)
  v_mfma_f32_16x16x32_bf16 a[0:3], v[68:71], v[36:39], a[0:3]
  s_waitcnt vmcnt(12)
  s_barrier
  s_add_u32 m0, s52, 32768
  v_mfma_f32_16x16x32_bf16 a[4:7], v[72:75], v[36:39], a[4:7]
  buffer_load_dwordx4 v2, s[8:11], s20 offen sc1 lds
  ds_read_b128 v[20:23], v11 offset:0
  v_mfma_f32_16x16x32_bf16 a[8:11], v[76:79], v[36:39], a[8:11]
  ds_read_b64_tr_b16 v[52:53], v14 offset:16384
  v_mfma_f32_16x16x32_bf16 a[12:15], v[80:83], v[36:39], a[12:15]
  ds_read_b64_tr_b16 v[54:55], v14 offset:20480
  s_add_u32 m0, s53, 32768
  v_mfma_f32_16x16x32_bf16 a[16:19], v[68:71], v[40:43], a[16:19]
  buffer_load_dwordx4 v6, s[12:15], s21 offen  lds
  ds_read_b128 v[24:27], v11 offset:2048
  v_mfma_f32_16x16x32_bf16 a[20:23], v[72:75], v[40:43], a[20:23]
  ds_read_b64_tr_b16 v[56:57], v14 offset:16392
  v_mfma_f32_16x16x32_bf16 a[24:27], v[76:79], v[40:43], a[24:27]
  ds_read_b64_tr_b16 v[58:59], v14 offset:20488
  s_add_u32 m0, s52, 33792
  v_mfma_f32_16x16x32_bf16 a[28:31], v[80:83], v[40:43], a[28:31]
  buffer_load_dwordx4 v3, s[8:11], s20 offen sc1 lds
  ds_read_b128 v[28:31], v11 offset:4096
  v_mfma_f32_16x16x32_bf16 a[32:35], v[68:71], v[44:47], a[32:35]
  ds_read_b64_tr_b16 v[60:61], v15 offset:16384
  v_mfma_f32_16x16x32_bf16 a[36:39], v[72:75], v[44:47], a[36:39]
  ds_read_b64_tr_b16 v[62:63], v15 offset:20480
  s_add_u32 m0, s53, 33792
  v_mfma_f32_16x16x32_bf16 a[40:43], v[76:79], v[44:47], a[40:43]
  buffer_load_dwordx4 v7, s[12:15], s21 offen  lds
  ds_read_b128 v[32:35], v11 offset:6144
  v_mfma_f32_16x16x32_bf16 a[44:47], v[80:83], v[44:47], a[44:47]
  ds_read_b64_tr_b16 v[64:65], v15 offset:16392
  v_mfma_f32_16x16x32_bf16 a[48:51], v[68:71], v[48:51], a[48:51]
  ds_read_b64_tr_b16 v[66:67], v15 offset:20488
  s_add_u32 m0, s52, 34816
  v_mfma_f32_16x16x32_bf16 a[52:55], v[72:75], v[48:51], a[52:55]
  buffer_load_dwordx4 v4, s[8:11], s20 offen sc1 lds
  v_mfma_f32_16x16x32_bf16 a[56:59], v[76:79], v[48:51], a[56:59]
  v_mfma_f32_16x16x32_bf16 a[60:63], v[80:83], v[48:51], a[60:63]
  s_waitcnt lgkmcnt(0)
  s_add_u32 m0, s53, 34816
  v_mfma_f32_16x16x32_bf16 a[0:3], v[52:55], v[20:23], a[0:3]
  buffer_load_dwordx4 v8, s[12:15], s21 offen  lds
  ds_read_b128 v[36:39], v11 offset:1024
  v_mfma_f32_16x16x32_bf16 a[4:7], v[56:59], v[20:23], a[4:7]
  ds_read_b64_tr_b16 v[68:69], v14 offset:24576
  v_mfma_f32_16x16x32_bf16 a[8:11], v[60:63], v[20:23], a[8:11]
  ds_read_b64_tr_b16 v[70:71], v14 offset:28672
  v_mfma_f32_16x16x32_bf16 a[12:15], v[64:67], v[20:23], a[12:15]
  ds_read_b128 v[40:43], v11 offset:3072
  s_add_u32 m0, s52, 35840
  v_mfma_f32_16x16x32_bf16 a[16:19], v[52:55], v[24:27], a[16:19]
  buffer_load_dwordx4 v5, s[8:11], s20 offen sc1 lds
  ds_read_b64_tr_b16 v[72:73], v14 offset:24584
  v_mfma_f32_16x16x32_bf16 a[20:23], v[56:59], v[24:27], a[20:23]
  ds_read_b64_tr_b16 v[74:75], v14 offset:28680
  v_mfma_f32_16x16x32_bf16 a[24:27], v[60:63], v[24:27], a[24:27]
  ds_read_b128 v[44:47], v11 offset:5120
  v_mfma_f32_16x16x32_bf16 a[28:31], v[64:67], v[24:27], a[28:31]
  ds_read_b64_tr_b16 v[76:77], v15 offset:24576
  s_add_u32 m0, s53, 35840
  v_mfma_f32_16x16x32_bf16 a[32:35], v[52:55], v[28:31], a[32:35]
  buffer_load_dwordx4 v9, s[12:15], s21 offen  lds
  ds_read_b64_tr_b16 v[78:79], v15 offset:28672
  v_mfma_f32_16x16x32_bf16 a[36:39], v[56:59], v[28:31], a[36:39]
  ds_read_b128 v[48:51], v11 offset:7168
  v_mfma_f32_16x16x32_bf16 a[40:43], v[60:63], v[28:31], a[40:43]
  ds_read_b64_tr_b16 v[80:81], v15 offset:24584
  v_mfma_f32_16x16x32_bf16 a[44:47], v[64:67], v[28:31], a[44:47]
  ds_read_b64_tr_b16 v[82:83], v15 offset:28680
  s_add_u32 s20, s20, 6144
  v_mfma_f32_16x16x32_bf16 a[48:51], v[52:55], v[32:35], a[48:51]
  s_add_u32 s21, s21, s51
  v_mfma_f32_16x16x32_bf16 a[52:55], v[56:59], v[32:35], a[52:55]
  v_mfma_f32_16x16x32_bf16 a[56:59], v[60:63], v[32:35], a[56:59]
  v_mfma_f32_16x16x32_bf16 a[60:63], v[64:67], v[32:35], a[60:63]
  s_waitcnt lgkmcnt(0)
  v_mfma_f32_16x16x32_bf16 a[0:3], v[68:71], v[36:39], a[0:3]
  s_waitcnt vmcnt(16)
  s_barrier
  s_add_u32 m0, s52, 65536
  v_mfma_f32_16x16x32_bf16 a[4:7], v[72:75], v[36:39], a[4:7]
  buffer_load_dwordx4 v2, s[8:11], s20 offen sc1 lds
  ds_read_b128 v[20:23], v11 offset:32768
  v_mfma_f32_16x16x32_bf16 a[8:11], v[76:79], v[36:39], a[8:11]
  ds_read_b64_tr_b16 v[52:53], v14 offset:49152
  v_mfma_f32_16x16x32_bf16 a[12:15], v[80:83], v[36:39], a[12:15]
  ds_read_b64_tr_b16 v[54:55], v14 offset:53248
  s_add_u32 m0, s53, 65536
  v_mfma_f32_16x16x32_bf16 a[16:19], v[68:71], v[40:43], a[16:19]
  buffer_load_dwordx4 v6, s[12:15], s21 offen  lds
  ds_read_b128 v[24:27], v11 offset:34816
  v_mfma_f32_16x16x32_bf16 a[20:23], v[72:75], v[40:43], a[20:23]
  ds_read_b64_tr_b16 v[56:57], v14 offset:49160
  v_mfma_f32_16x16x32_bf16 a[24:27], v[76:79], v[40:43], a[24:27]
  ds_read_b64_tr_b16 v[58:59], v14 offset:53256
  s_add_u32 m0, s52, 66560
  v_mfma_f32_16x16x32_bf16 a[28:31], v[80:83], v[40:43], a[28:31]
  buffer_load_dwordx4 v3, s[8:11], s20 offen sc1 lds
  ds_read_b128 v[28:31], v11 offset:36864
  v_mfma_f32_16x16x32_bf16 a[32:35], v[68:71], v[44:47], a[32:35]
  ds_read_b64_tr_b16 v[60:61], v15 offset:49152
  v_mfma_f32_16x16x32_bf16 a[36:39], v[72:75], v[44:47], a[36:39]
  ds_read_b64_tr_b16 v[62:63], v15 offset:53248
  s_add_u32 m0, s53, 66560
  v_mfma_f32_16x16x32_bf16 a[40:43], v[76:79], v[44:47], a[40:43]
  buffer_load_dwordx4 v7, s[12:15], s21 offen  lds
  ds_read_b128 v[32:35], v11 offset:38912
  v_mfma_f32_16x16x32_bf16 a[44:47], v[80:83], v[44:47], a[44:47]
  ds_read_b64_tr_b16 v[64:65], v15 offset:49160
  v_mfma_f32_16x16x32_bf16 a[48:51], v[68:71], v[48:51], a[48:51]
  ds_read_b64_tr_b16 v[66:67], v15 offset:53256
  s_add_u32 m0, s52, 67584
  v_mfma_f32_16x16x32_bf16 a[52:55], v[72:75], v[48:51], a[52:55]
  buffer_load_dwordx4 v4, s[8:11], s20 offen sc1 lds
  v_mfma_f32_16x16x32_bf16 a[56:59], v[76:79], v[48:51], a[56:59]
  v_mfma_f32_16x16x32_bf16 a[60:63], v[80:83], v[48:51], a[60:63]
  s_waitcnt lgkmcnt(0)
  s_add_u32 m0, s53, 67584
  v_mfma_f32_16x16x32_bf16 a[0:3], v[52:55], v[20:23], a[0:3]
  buffer_load_dwordx4 v8, s[12:15], s21 offen  lds
  ds_read_b128 v[36:39], v11 offset:33792
  v_mfma_f32_16x16x32_bf16 a[4:7], v[56:59], v[20:23], a[4:7]
  ds_read_b64_tr_b16 v[68:69], v14 offset:57344
  v_mfma_f32_16x16x32_bf16 a[8:11], v[60:63], v[20:23], a[8:11]
  ds_read_b64_tr_b16 v[70:71], v14 offset:61440
  v_mfma_f32_16x16x32_bf16 a[12:15], v[64:67], v[20:23], a[12:15]
  ds_read_b128 v[40:43], v11 offset:35840
  s_add_u32 m0, s52, 68608
  v_mfma_f32_16x16x32_bf16 a[16:19], v[52:55], v[24:27], a[16:19]
  buffer_load_dwordx4 v5, s[8:11], s20 offen sc1 lds
  ds_read_b64_tr_b16 v[72:73], v14 offset:57352
  v_mfma_f32_16x16x32_bf16 a[20:23], v[56:59], v[24:27], a[20:23]
  ds_read_b64_tr_b16 v[74:75], v14 offset:61448
  v_mfma_f32_16x16x32_bf16 a[24:27], v[60:63], v[24:27], a[24:27]
  ds_read_b128 v[44:47], v11 offset:37888
  v_mfma_f32_16x16x32_bf16 a[28:31], v[64:67], v[24:27], a[28:31]
  ds_read_b64_tr_b16 v[76:77], v15 offset:57344
  s_add_u32 m0, s53, 68608
  v_mfma_f32_16x16x32_bf16 a[32:35], v[52:55], v[28:31], a[32:35]
  buffer_load_dwordx4 v9, s[12:15], s21 offen  lds
  ds_read_b64_tr_b16 v[78:79], v15 offset:61440
  v_mfma_f32_16x16x32_bf16 a[36:39], v[56:59], v[28:31], a[36:39]
  ds_read_b128 v[48:51], v11 offset:39936
  v_mfma_f32_16x16x32_bf16 a[40:43], v[60:63], v[28:31], a[40:43]
  ds_read_b64_tr_b16 v[80:81], v15 offset:57352
  v_mfma_f32_16x16x32_bf16 a[44:47], v[64:67], v[28:31], a[44:47]
  ds_read_b64_tr_b16 v[82:83], v15 offset:61448
  s_add_u32 s20, s20, 2048
  v_mfma_f32_16x16x32_bf16 a[48:51], v[52:55], v[32:35], a[48:51]
  s_add_u32 s21, s21, s51
  v_mfma_f32_16x16x32_bf16 a[52:55], v[56:59], v[32:35], a[52:55]
  v_mfma_f32_16x16x32_bf16 a[56:59], v[60:63], v[32:35], a[56:59]
  v_mfma_f32_16x16x32_bf16 a[60:63], v[64:67], v[32:35], a[60:63]
  s_waitcnt lgkmcnt(0)
  v_mfma_f32_16x16x32_bf16 a[0:3], v[68:71], v[36:39], a[0:3]
  s_waitcnt vmcnt(16)
  s_barrier
  s_add_u32 m0, s52, 98304
  v_mfma_f32_16x16x32_bf16 a[4:7], v[72:75], v[36:39], a[4:7]
  buffer_load_dwordx4 v2, s[8:11], s20 offen sc1 lds
  ds_read_b128 v[20:23], v10 offset:0
  v_mfma_f32_16x16x32_bf16 a[8:11], v[76:79], v[36:39], a[8:11]
  ds_read_b64_tr_b16 v[52:53], v12 offset:16384
  v_mfma_f32_16x16x32_bf16 a[12:15], v[80:83], v[36:39], a[12:15]
  ds_read_b64_tr_b16 v[54:55], v12 offset:20480
  s_add_u32 m0, s53, 98304
  v_mfma_f32_16x16x32_bf16 a[16:19], v[68:71], v[40:43], a[16:19]
  buffer_load_dwordx4 v6, s[12:15], s21 offen  lds
  ds_read_b128 v[24:27], v10 offset:2048
  v_mfma_f32_16x16x32_bf16 a[20:23], v[72:75], v[40:43], a[20:23]
  ds_read_b64_tr_b16 v[56:57], v12 offset:16392
  v_mfma_f32_16x16x32_bf16 a[24:27], v[76:79], v[40:43], a[24:27]
  ds_read_b64_tr_b16 v[58:59], v12 offset:20488
  s_add_u32 m0, s52, 99328
  v_mfma_f32_16x16x32_bf16 a[28:31], v[80:83], v[40:43], a[28:31]
  buffer_load_dwordx4 v3, s[8:11], s20 offen sc1 lds
  ds_read_b128 v[28:31], v10 offset:4096
  v_mfma_f32_16x16x32_bf16 a[32:35], v[68:71], v[44:47], a[32:35]
  ds_read_b64_tr_b16 v[60:61], v13 offset:16384
  v_mfma_f32_16x16x32_bf16 a[36:39], v[72:75], v[44:47], a[36:39]
  ds_read_b64_tr_b16 v[62:63], v13 offset:20480
  s_add_u32 m0, s53, 99328
  v_mfma_f32_16x16x32_bf16 a[40:43], v[76:79], v[44:47], a[40:43]
  buffer_load_dwordx4 v7, s[12:15], s21 offen  lds
  ds_read_b128 v[32:35], v10 offset:6144
  v_mfma_f32_16x16x32_bf16 a[44:47], v[80:83], v[44:47], a[44:47]
  ds_read_b64_tr_b16 v[64:65], v13 offset:16392
  v_mfma_f32_16x16x32_bf16 a[48:51], v[68:71], v[48:51], a[48:51]
  ds_read_b64_tr_b16 v[66:67], v13 offset:20488
  s_add_u32 m0, s52, 100352
  v_mfma_f32_16x16x32_bf16 a[52:55], v[72:75], v[48:51], a[52:55]
  buffer_load_dwordx4 v4, s[8:11], s20 offen sc1 lds
  v_mfma_f32_16x16x32_bf16 a[56:59], v[76:79], v[48:51], a[56:59]
  v_mfma_f32_16x16x32_bf16 a[60:63], v[80:83], v[48:51], a[60:63]
L_g3_loop:
  s_sub_u32 s25, s25, 1
  s_cmp_eq_u32 s25, 0
  s_cbranch_scc1 L_g3_fin
  s_waitcnt lgkmcnt(0)
  s_add_u32 m0, s53, 100352
  v_mfma_f32_16x16x32_bf16 a[0:3], v[52:55], v[20:23], a[0:3]
  buffer_load_dwordx4 v8, s[12:15], s21 offen  lds
  ds_read_b128 v[36:39], v10 offset:1024
  v_mfma_f32_16x16x32_bf16 a[4:7], v[56:59], v[20:23], a[4:7]
  ds_read_b64_tr_b16 v[68:69], v12 offset:24576
  v_mfma_f32_16x16x32_bf16 a[8:11], v[60:63], v[20:23], a[8:11]
  ds_read_b64_tr_b16 v[70:71], v12 offset:28672
  v_mfma_f32_16x16x32_bf16 a[12:15], v[64:67], v[20:23], a[12:15]
  ds_read_b128 v[40:43], v10 offset:3072
  s_add_u32 m0, s52, 101376
  v_mfma_f32_16x16x32_bf16 a[16:19], v[52:55], v[24:27], a[16:19]
  buffer_load_dwordx4 v5, s[8:11], s20 offen sc1 lds
  ds_read_b64_tr_b16 v[72:73], v12 offset:24584
  v_mfma_f32_16x16x32_bf16 a[20:23], v[56:59], v[24:27], a[20:23]
  ds_read_b64_tr_b16 v[74:75], v12 offset:28680
  v_mfma_f32_16x16x32_bf16 a[24:27], v[60:63], v[24:27], a[24:27]
  ds_read_b128 v[44:47], v10 offset:5120
  v_mfma_f32_16x16x32_bf16 a[28:31], v[64:67], v[24:27], a[28:31]
  ds_read_b64_tr_b16 v[76:77], v13 offset:24576
  s_add_u32 m0, s53, 101376
  v_mfma_f32_16x16x32_bf16 a[32:35], v[52:55], v[28:31], a[32:35]
  buffer_load_dwordx4 v9, s[12:15], s21 offen  lds
  ds_read_b64_tr_b16 v[78:79], v13 offset:28672
  v_mfma_f32_16x16x32_bf16 a[36:39], v[56:59], v[28:31], a[36:39]
  ds_read_b128 v[48:51], v10 offset:7168
  v_mfma_f32_16x16x32_bf16 a[40:43], v[60:63], v[28:31], a[40:43]
  ds_read_b64_tr_b16 v[80:81], v13 offset:24584
  v_mfma_f32_16x16x32_bf16 a[44:47], v[64:67], v[28:31], a[44:47]
  ds_read_b64_tr_b16 v[82:83], v13 offset:28680
  s_add_u32 s20, s20, 6144
  v_mfma_f32_16x16x32_bf16 a[48:51], v[52:55], v[32:35], a[48:51]
  s_add_u32 s21, s21, s51
  v_mfma_f32_16x16x32_bf16 a[52:55], v[56:59], v[32:35], a[52:55]
  v_mfma_f32_16x16x32_bf16 a[56:59], v[60:63], v[32:35], a[56:59]
  v_mfma_f32_16x16x32_bf16 a[60:63], v[64:67], v[32:35], a[60:63]
  s_waitcnt lgkmcnt(0)
  v_mfma_f32_16x16x32_bf16 a[0:3], v[68:71], v[36:39], a[0:3]
  s_waitcnt vmcnt(16)
  s_barrier
  s_add_u32 m0, s52, 0
  v_mfma_f32_16x16x32_bf16 a[4:7], v[72:75], v[36:39], a[4:7]
  buffer_load_dwordx4 v2, s[8:11], s20 offen sc1 lds
  ds_read_b128 v[20:23], v10 offset:32768
  v_mfma_f32_16x16x32_bf16 a[8:11], v[76:79], v[36:39], a[8:11]
  ds_read_b64_tr_b16 v[52:53], v12 offset:49152
  v_mfma_f32_16x16x32_bf16 a[12:15], v[80:83], v[36:39], a[12:15]
  ds_read_b64_tr_b16 v[54:55], v12 offset:53248
  s_add_u32 m0, s53, 0
  v_mfma_f32_16x16x32_bf16 a[16:19], v[68:71], v[40:43], a[16:19]
  buffer_load_dwordx4 v6, s[12:15], s21 offen  lds
  ds_read_b128 v[24:27], v10 offset:34816
  v_mfma_f32_16x16x32_bf16 a[20:23], v[72:75], v[40:43], a[20:23]
  ds_read_b64_tr_b16 v[56:57], v12 offset:49160
  v_mfma_f32_16x16x32_bf16 a[24:27], v[76:79], v[40:43], a[24:27]
  ds_read_b64_tr_b16 v[58:59], v12 offset:53256
  s_add_u32 m0, s52, 1024
  v_mfma_f32_16x16x32_bf16 a[28:31], v[80:83], v[40:43], a[28:31]
  buffer_load_dwordx4 v3, s[8:11], s20 offen sc1 lds
  ds_read_b128 v[28:31], v10 offset:36864
  v_mfma_f32_16x16x32_bf16 a[32:35], v[68:71], v[44:47], a[32:35]
  ds_read_b64_tr_b16 v[60:61], v13 offset:49152
  v_mfma_f32_16x16x32_bf16 a[36:39], v[72:75], v[44:47], a[36:39]
  ds_read_b64_tr_b16 v[62:63], v13 offset:53248
  s_add_u32 m0, s53, 1024
  v_mfma_f32_16x16x32_bf16 a[40:43], v[76:79], v[44:47], a[40:43]
  buffer_load_dwordx4 v7, s[12:15], s21 offen  lds
  ds_read_b128 v[32:35], v10 offset:38912
  v_mfma_f32_16x16x32_bf16 a[44:47], v[80:83], v[44:47], a[44:47]
  ds_read_b64_tr_b16 v[64:65], v13 offset:49160
  v_mfma_f32_16x16x32_bf16 a[48:51], v[68:71], v[48:51], a[48:51]
  ds_read_b64_tr_b16 v[66:67], v13 offset:53256
  s_add_u32 m0, s52, 2048
  v_mfma_f32_16x16x32_bf16 a[52:55], v[72:75], v[48:51], a[52:55]
  buffer_load_dwordx4 v4, s[8:11], s20 offen sc1 lds
  v_mfma_f32_16x16x32_bf16 a[56:59], v[76:79], v[48:51], a[56:59]
  v_mfma_f32_16x16x32_bf16 a[60:63], v[80:83], v[48:51], a[60:63]
  s_waitcnt lgkmcnt(0)
  s_add_u32 m0, s53, 2048
  v_mfma_f32_16x16x32_bf16 a[0:3], v[52:55], v[20:23], a[0:3]
  buffer_load_dwordx4 v8, s[12:15], s21 offen  lds
  ds_read_b128 v[36:39], v10 offset:33792
  v_mfma_f32_16x16x32_bf16 a[4:7], v[56:59], v[20:23], a[4:7]
  ds_read_b64_tr_b16 v[68:69], v12 offset:57344
  v_mfma_f32_16x16x32_bf16 a[8:11], v[60:63], v[20:23], a[8:11]
  ds_read_b64_tr_b16 v[70:71], v12 offset:61440
  v_mfma_f32_16x16x32_bf16 a[12:15], v[64:67], v[20:23], a[12:15]
  ds_read_b128 v[40:43], v10 offset:35840
  s_add_u32 m0, s52, 3072
  v_mfma_f32_16x16x32_bf16 a[16:19], v[52:55], v[24:27], a[16:19]
  buffer_load_dwordx4 v5, s[8:11], s20 offen sc1 lds
  ds_read_b64_tr_b16 v[72:73], v12 offset:57352
  v_mfma_f32_16x16x32_bf16 a[20:23], v[56:59], v[24:27], a[20:23]
  ds_read_b64_tr_b16 v[74:75], v12 offset:61448
  v_mfma_f32_16x16x32_bf16 a[24:27], v[60:63], v[24:27], a[24:27]
  ds_read_b128 v[44:47], v10 offset:37888
  v_mfma_f32_16x16x32_bf16 a[28:31], v[64:67], v[24:27], a[28:31]
  ds_read_b64_tr_b16 v[76:77], v13 offset:57344
  s_add_u32 m0, s53, 3072
  v_mfma_f32_16x16x32_bf16 a[32:35], v[52:55], v[28:31], a[32:35]
  buffer_load_dwordx4 v9, s[12:15], s21 offen  lds
  ds_read_b64_tr_b16 v[78:79], v13 offset:61440
  v_mfma_f32_16x16x32_bf16 a[36:39], v[56:59], v[28:31], a[36:39]
  ds_read_b128 v[48:51], v10 offset:39936
  v_mfma_f32_16x16x32_bf16 a[40:43], v[60:63], v[28:31], a[40:43]
  ds_read_b64_tr_b16 v[80:81], v13 offset:57352
  v_mfma_f32_16x16x32_bf16 a[44:47], v[64:67], v[28:31], a[44:47]
  ds_read_b64_tr_b16 v[82:83], v13 offset:61448
  s_add_u32 s20, s20, 2048
  v_mfma_f32_16x16x32_bf16 a[48:51], v[52:55], v[32:35], a[48:51]
  s_add_u32 s21, s21, s51
  v_mfma_f32_16x16x32_bf16 a[52:55], v[56:59], v[32:35], a[52:55]
  v_mfma_f32_16x16x32_bf16 a[56:59], v[60:63], v[32:35], a[56:59]
  v_mfma_f32_16x16x32_bf16 a[60:63], v[64:67], v[32:35], a[60:63]
  s_waitcnt lgkmcnt(0)
  v_mfma_f32_16x16x32_bf16 a[0:3], v[68:71], v[36:39], a[0:3]
  s_waitcnt vmcnt(16)
  s_barrier
  s_add_u32 m0, s52, 32768
  v_mfma_f32_16x16x32_bf16 a[4:7], v[72:75], v[36:39], a[4:7]
  buffer_load_dwordx4 v2, s[8:11], s20 offen sc1 lds
  ds_read_b128 v[20:23], v11 offset:0
  v_mfma_f32_16x16x32_bf16 a[8:11], v[76:79], v[36:39], a[8:11]
  ds_read_b64_tr_b16 v[52:53], v14 offset:16384
  v_mfma_f32_16x16x32_bf16 a[12:15], v[80:83], v[36:39], a[12:15]
  ds_read_b64_tr_b16 v[54:55], v14 offset:20480
  s_add_u32 m0, s53, 32768
  v_mfma_f32_16x16x32_bf16 a[16:19], v[68:71], v[40:43], a[16:19]
  buffer_load_dwordx4 v6, s[12:15], s21 offen  lds
  ds_read_b128 v[24:27], v11 offset:2048
  v_mfma_f32_16x16x32_bf16 a[20:23], v[72:75], v[40:43], a[20:23]
  ds_read_b64_tr_b16 v[56:57], v14 offset:16392
  v_mfma_f32_16x16x32_bf16 a[24:27], v[76:79], v[40:43], a[24:27]
  ds_read_b64_tr_b16 v[58:59], v14 offset:20488
  s_add_u32 m0, s52, 33792
  v_mfma_f32_16x16x32_bf16 a[28:31], v[80:83], v[40:43], a[28:31]
  buffer_load_dwordx4 v3, s[8:11], s20 offen sc1 lds
  ds_read_b128 v[28:31], v11 offset:4096
  v_mfma_f32_16x16x32_bf16 a[32:35], v[68:71], v[44:47], a[32:35]
  ds_read_b64_tr_b16 v[60:61], v15 offset:16384
  v_mfma_f32_16x16x32_bf16 a[36:39], v[72:75], v[44:47], a[36:39]
  ds_read_b64_tr_b16 v[62:63], v15 offset:20480
  s_add_u32 m0, s53, 33792
  v_mfma_f32_16x16x32_bf16 a[40:43], v[76:79], v[44:47], a[40:43]
  buffer_load_dwordx4 v7, s[12:15], s21 offen  lds
  ds_read_b128 v[32:35], v11 offset:6144
  v_mfma_f32_16x16x32_bf16 a[44:47], v[80:83], v[44:47], a[44:47]
  ds_read_b64_tr_b16 v[64:65], v15 offset:16392
  v_mfma_f32_16x16x32_bf16 a[48:51], v[68:71], v[48:51], a[48:51]
  ds_read_b64_tr_b16 v[66:67], v15 offset:20488
  s_add_u32 m0, s52, 34816
  v_mfma_f32_16x16x32_bf16 a[52:55], v[72:75], v[48:51], a[52:55]
  buffer_load_dwordx4 v4, s[8:11], s20 offen sc1 lds
  v_mfma_f32_16x16x32_bf16 a[56:59], v[76:79], v[48:51], a[56:59]
  v_mfma_f32_16x16x32_bf16 a[60:63], v[80:83], v[48:51], a[60:63]
  s_waitcnt lgkmcnt(0)
  s_add_u32 m0, s53, 34816
  v_mfma_f32_16x16x32_bf16 a[0:3], v[52:55], v[20:23], a[0:3]
  buffer_load_dwordx4 v8, s[12:15], s21 offen  lds
  ds_read_b128 v[36:39], v11 offset:1024
  v_mfma_f32_16x16x32_bf16 a[4:7], v[56:59], v[20:23], a[4:7]
  ds_read_b64_tr_b16 v[68:69], v14 offset:24576
  v_mfma_f32_16x16x32_bf16 a[8:11], v[60:63], v[20:23], a[8:11]
  ds_read_b64_tr_b16 v[70:71], v14 offset:28672
  v_mfma_f32_16x16x32_bf16 a[12:15], v[64:67], v[20:23], a[12:15]
  ds_read_b128 v[40:43], v11 offset:3072
  s_add_u32 m0, s52, 35840
  v_mfma_f32_16x16x32_bf16 a[16:19], v[52:55], v[24:27], a[16:19]
  buffer_load_dwordx4 v5, s[8:11], s20 offen sc1 lds
  ds_read_b64_tr_b16 v[72:73], v14 offset:24584
  v_mfma_f32_16x16x32_bf16 a[20:23], v[56:59], v[24:27], a[20:23]
  ds_read_b64_tr_b16 v[74:75], v14 offset:28680
  v_mfma_f32_16x16x32_bf16 a[24:27], v[60:63], v[24:27], a[24:27]
  ds_read_b128 v[44:47], v11 offset:5120
  v_mfma_f32_16x16x32_bf16 a[28:31], v[64:67], v[24:27], a[28:31]
  ds_read_b64_tr_b16 v[76:77], v15 offset:24576
  s_add_u32 m0, s53, 35840
  v_mfma_f32_16x16x32_bf16 a[32:35], v[52:55], v[28:31], a[32:35]
  buffer_load_dwordx4 v9, s[12:15], s21 offen  lds
  ds_read_b64_tr_b16 v[78:79], v15 offset:28672
  v_mfma_f32_16x16x32_bf16 a[36:39], v[56:59], v[28:31], a[36:39]
  ds_read_b128 v[48:51], v11 offset:7168
  v_mfma_f32_16x16x32_bf16 a[40:43], v[60:63], v[28:31], a[40:43]
  ds_read_b64_tr_b16 v[80:81], v15 offset:24584
  v_mfma_f32_16x16x32_bf16 a[44:47], v[64:67], v[28:31], a[44:47]
  ds_read_b64_tr_b16 v[82:83], v15 offset:28680
  s_add_u32 s20, s20, 6144
  v_mfma_f32_16x16x32_bf16 a[48:51], v[52:55], v[32:35], a[48:51]
  s_add_u32 s21, s21, s51
  v_mfma_f32_16x16x32_bf16 a[52:55], v[56:59], v[32:35], a[52:55]
  v_mfma_f32_16x16x32_bf16 a[56:59], v[60:63], v[32:35], a[56:59]
  v_mfma_f32_16x16x32_bf16 a[60:63], v[64:67], v[32:35], a[60:63]
  s_waitcnt lgkmcnt(0)
  v_mfma_f32_16x16x32_bf16 a[0:3], v[68:71], v[36:39], a[0:3]
  s_waitcnt vmcnt(16)
  s_barrier
  s_add_u32 m0, s52, 65536
  v_mfma_f32_16x16x32_bf16 a[4:7], v[72:75], v[36:39], a[4:7]
  buffer_load_dwordx4 v2, s[8:11], s20 offen sc1 lds
  ds_read_b128 v[20:23], v11 offset:32768
  v_mfma_f32_16x16x32_bf16 a[8:11], v[76:79], v[36:39], a[8:11]
  ds_read_b64_tr_b16 v[52:53], v14 offset:49152
  v_mfma_f32_16x16x32_bf16 a[12:15], v[80:83], v[36:39], a[12:15]
  ds_read_b64_tr_b16 v[54:55], v14 offset:53248
  s_add_u32 m0, s53, 65536
  v_mfma_f32_16x16x32_bf16 a[16:19], v[68:71], v[40:43], a[16:19]
  buffer_load_dwordx4 v6, s[12:15], s21 offen  lds
  ds_read_b128 v[24:27], v11 offset:34816
  v_mfma_f32_16x16x32_bf16 a[20:23], v[72:75], v[40:43], a[20:23]
  ds_read_b64_tr_b16 v[56:57], v14 offset:49160
  v_mfma_f32_16x16x32_bf16 a[24:27], v[76:79], v[40:43], a[24:27]
  ds_read_b64_tr_b16 v[58:59], v14 offset:53256
  s_add_u32 m0, s52, 66560
  v_mfma_f32_16x16x32_bf16 a[28:31], v[80:83], v[40:43], a[28:31]
  buffer_load_dwordx4 v3, s[8:11], s20 offen sc1 lds
  ds_read_b128 v[28:31], v11 offset:36864
  v_mfma_f32_16x16x32_bf16 a[32:35], v[68:71], v[44:47], a[32:35]
  ds_read_b64_tr_b16 v[60:61], v15 offset:49152
  v_mfma_f32_16x16x32_bf16 a[36:39], v[72:75], v[44:47], a[36:39]
  ds_read_b64_tr_b16 v[62:63], v15 offset:53248
  s_add_u32 m0, s53, 66560
  v_mfma_f32_16x16x32_bf16 a[40:43], v[76:79], v[44:47], a[40:43]
  buffer_load_dwordx4 v7, s[12:15], s21 offen  lds
  ds_read_b128 v[32:35], v11 offset:38912
  v_mfma_f32_16x16x32_bf16 a[44:47], v[80:83], v[44:47], a[44:47]
  ds_read_b64_tr_b16 v[64:65], v15 offset:49160
  v_mfma_f32_16x16x32_bf16 a[48:51], v[68:71], v[48:51], a[48:51]
  ds_read_b64_tr_b16 v[66:67], v15 offset:53256
  s_add_u32 m0, s52, 67584
  v_mfma_f32_16x16x32_bf16 a[52:55], v[72:75], v[48:51], a[52:55]
  buffer_load_dwordx4 v4, s[8:11], s20 offen sc1 lds
  v_mfma_f32_16x16x32_bf16 a[56:59], v[76:79], v[48:51], a[56:59]
  v_mfma_f32_16x16x32_bf16 a[60:63], v[80:83], v[48:51], a[60:63]
  s_waitcnt lgkmcnt(0)
  s_add_u32 m0, s53, 67584
  v_mfma_f32_16x16x32_bf16 a[0:3], v[52:55], v[20:23], a[0:3]
  buffer_load_dwordx4 v8, s[12:15], s21 offen  lds
  ds_read_b128 v[36:39], v11 offset:33792
  v_mfma_f32_16x16x32_bf16 a[4:7], v[56:59], v[20:23], a[4:7]
  ds_read_b64_tr_b16 v[68:69], v14 offset:57344
  v_mfma_f32_16x16x32_bf16 a[8:11], v[60:63], v[20:23], a[8:11]
  ds_read_b64_tr_b16 v[70:71], v14 offset:61440
  v_mfma_f32_16x16x32_bf16 a[12:15], v[64:67], v[20:23], a[12:15]
  ds_read_b128 v[40:43], v11 offset:35840
  s_add_u32 m0, s52, 68608
  v_mfma_f32_16x16x32_bf16 a[16:19], v[52:55], v[24:27], a[16:19]
  buffer_load_dwordx4 v5, s[8:11], s20 offen sc1 lds
  ds_read_b64_tr_b16 v[72:73], v14 offset:57352
  v_mfma_f32_16x16x32_bf16 a[20:23], v[56:59], v[24:27], a[20:23]
  ds_read_b64_tr_b16 v[74:75], v14 offset:61448
  v_mfma_f32_16x16x32_bf16 a[24:27], v[60:63], v[24:27], a[24:27]
  ds_read_b128 v[44:47], v11 offset:37888
  v_mfma_f32_16x16x32_bf16 a[28:31], v[64:67], v[24:27], a[28:31]
  ds_read_b64_tr_b16 v[76:77], v15 offset:57344
  s_add_u32 m0, s53, 68608
  v_mfma_f32_16x16x32_bf16 a[32:35], v[52:55], v[28:31], a[32:35]
  buffer_load_dwordx4 v9, s[12:15], s21 offen  lds
  ds_read_b64_tr_b16 v[78:79], v15 offset:61440
  v_mfma_f32_16x16x32_bf16 a[36:39], v[56:59], v[28:31], a[36:39]
  ds_read_b128 v[48:51], v11 offset:39936
  v_mfma_f32_16x16x32_bf16 a[40:43], v[60:63], v[28:31], a[40:43]
  ds_read_b64_tr_b16 v[80:81], v15 offset:57352
  v_mfma_f32_16x16x32_bf16 a[44:47], v[64:67], v[28:31], a[44:47]
  ds_read_b64_tr_b16 v[82:83], v15 offset:61448
  s_add_u32 s20, s20, 2048
  v_mfma_f32_16x16x32_bf16 a[48:51], v[52:55], v[32:35], a[48:51]
  s_add_u32 s21, s21, s51
  v_mfma_f32_16x16x32_bf16 a[52:55], v[56:59], v[32:35], a[52:55]
  v_mfma_f32_16x16x32_bf16 a[56:59], v[60:63], v[32:35], a[56:59]
  v_mfma_f32_16x16x32_bf16 a[60:63], v[64:67], v[32:35], a[60:63]
  s_waitcnt lgkmcnt(0)
  v_mfma_f32_16x16x32_bf16 a[0:3], v[68:71], v[36:39], a[0:3]
  s_waitcnt vmcnt(16)
  s_barrier
  s_add_u32 m0, s52, 98304
  v_mfma_f32_16x16x32_bf16 a[4:7], v[72:75], v[36:39], a[4:7]
  buffer_load_dwordx4 v2, s[8:11], s20 offen sc1 lds
  ds_read_b128 v[20:23], v10 offset:0
  v_mfma_f32_16x16x32_bf16 a[8:11], v[76:79], v[36:39], a[8:11]
  ds_read_b64_tr_b16 v[52:53], v12 offset:16384
  v_mfma_f32_16x16x32_bf16 a[12:15], v[80:83], v[36:39], a[12:15]
  ds_read_b64_tr_b16 v[54:55], v12 offset:20480
  s_add_u32 m0, s53, 98304
  v_mfma_f32_16x16x32_bf16 a[16:19], v[68:71], v[40:43], a[16:19]
  buffer_load_dwordx4 v6, s[12:15], s21 offen  lds
  ds_read_b128 v[24:27], v10 offset:2048
  v_mfma_f32_16x16x32_bf16 a[20:23], v[72:75], v[40:43], a[20:23]
  ds_read_b64_tr_b16 v[56:57], v12 offset:16392
  v_mfma_f32_16x16x32_bf16 a[24:27], v[76:79], v[40:43], a[24:27]
  ds_read_b64_tr_b16 v[58:59], v12 offset:20488
  s_add_u32 m0, s52, 99328
  v_mfma_f32_16x16x32_bf16 a[28:31], v[80:83], v[40:43], a[28:31]
  buffer_load_dwordx4 v3, s[8:11], s20 offen sc1 lds
  ds_read_b128 v[28:31], v10 offset:4096
  v_mfma_f32_16x16x32_bf16 a[32:35], v[68:71], v[44:47], a[32:35]
  ds_read_b64_tr_b16 v[60:61], v13 offset:16384
  v_mfma_f32_16x16x32_bf16 a[36:39], v[72:75], v[44:47], a[36:39]
  ds_read_b64_tr_b16 v[62:63], v13 offset:20480
  s_add_u32 m0, s53, 99328
  v_mfma_f32_16x16x32_bf16 a[40:43], v[76:79], v[44:47], a[40:43]
  buffer_load_dwordx4 v7, s[12:15], s21 offen  lds
  ds_read_b128 v[32:35], v10 offset:6144
  v_mfma_f32_16x16x32_bf16 a[44:47], v[80:83], v[44:47], a[44:47]
  ds_read_b64_tr_b16 v[64:65], v13 offset:16392
  v_mfma_f32_16x16x32_bf16 a[48:51], v[68:71], v[48:51], a[48:51]
  ds_read_b64_tr_b16 v[66:67], v13 offset:20488
  s_add_u32 m0, s52, 100352
  v_mfma_f32_16x16x32_bf16 a[52:55], v[72:75], v[48:51], a[52:55]
  buffer_load_dwordx4 v4, s[8:11], s20 offen sc1 lds
  v_mfma_f32_16x16x32_bf16 a[56:59], v[76:79], v[48:51], a[56:59]
  v_mfma_f32_16x16x32_bf16 a[60:63], v[80:83], v[48:51], a[60:63]
  s_branch L_g3_loop
L_g3_fin:
  s_cmp_eq_u32 s35, 8
  s_cbranch_scc1 L_r3_27
  s_cmp_lg_u32 s32, 0
  s_cbranch_scc1 L_rq_28
  s_cmp_eq_u32 s39, 0
  s_cbranch_scc1 L_rq_28
  s_lshl_b32 s99, s33, 7
  s_add_u32 s99, s99, 0x3d00200
  v_mov_b32 v244, 1
  v_mov_b32 v245, 0
  s_mov_b64 exec, 1
  buffer_atomic_add v244, v245, s[4:7], s99 offen sc0 sc1
  s_mov_b64 exec, -1
L_rq_28:
L_r3_27:
  s_waitcnt lgkmcnt(0)
  s_add_u32 m0, s53, 100352
  v_mfma_f32_16x16x32_bf16 a[0:3], v[52:55], v[20:23], a[0:3]
  buffer_load_dwordx4 v8, s[12:15], s21 offen  lds
  ds_read_b128 v[36:39], v10 offset:1024
  v_mfma_f32_16x16x32_bf16 a[4:7], v[56:59], v[20:23], a[4:7]
  ds_read_b64_tr_b16 v[68:69], v12 offset:24576
  v_mfma_f32_16x16x32_bf16 a[8:11], v[60:63], v[20:23], a[8:11]
  ds_read_b64_tr_b16 v[70:71], v12 offset:28672
  v_mfma_f32_16x16x32_bf16 a[12:15], v[64:67], v[20:23], a[12:15]
  ds_read_b128 v[40:43], v10 offset:3072
  s_add_u32 m0, s52, 101376
  v_mfma_f32_16x16x32_bf16 a[16:19], v[52:55], v[24:27], a[16:19]
  buffer_load_dwordx4 v5, s[8:11], s20 offen sc1 lds
  ds_read_b64_tr_b16 v[72:73], v12 offset:24584
  v_mfma_f32_16x16x32_bf16 a[20:23], v[56:59], v[24:27], a[20:23]
  ds_read_b64_tr_b16 v[74:75], v12 offset:28680
  v_mfma_f32_16x16x32_bf16 a[24:27], v[60:63], v[24:27], a[24:27]
  ds_read_b128 v[44:47], v10 offset:5120
  v_mfma_f32_16x16x32_bf16 a[28:31], v[64:67], v[24:27], a[28:31]
  ds_read_b64_tr_b16 v[76:77], v13 offset:24576
  s_add_u32 m0, s53, 101376
  v_mfma_f32_16x16x32_bf16 a[32:35], v[52:55], v[28:31], a[32:35]
  buffer_load_dwordx4 v9, s[12:15], s21 offen  lds
  ds_read_b64_tr_b16 v[78:79], v13 offset:28672
  v_mfma_f32_16x16x32_bf16 a[36:39], v[56:59], v[28:31], a[36:39]
  ds_read_b128 v[48:51], v10 offset:7168
  v_mfma_f32_16x16x32_bf16 a[40:43], v[60:63], v[28:31], a[40:43]
  ds_read_b64_tr_b16 v[80:81], v13 offset:24584
  v_mfma_f32_16x16x32_bf16 a[44:47], v[64:67], v[28:31], a[44:47]
  ds_read_b64_tr_b16 v[82:83], v13 offset:28680
  s_add_u32 s20, s20, 6144
  v_mfma_f32_16x16x32_bf16 a[48:51], v[52:55], v[32:35], a[48:51]
  s_add_u32 s21, s21, s51
  v_mfma_f32_16x16x32_bf16 a[52:55], v[56:59], v[32:35], a[52:55]
  v_mfma_f32_16x16x32_bf16 a[56:59], v[60:63], v[32:35], a[56:59]
  v_mfma_f32_16x16x32_bf16 a[60:63], v[64:67], v[32:35], a[60:63]
  s_waitcnt lgkmcnt(0)
  v_mfma_f32_16x16x32_bf16 a[0:3], v[68:71], v[36:39], a[0:3]
  s_waitcnt vmcnt(16)
  s_barrier
  v_mfma_f32_16x16x32_bf16 a[4:7], v[72:75], v[36:39], a[4:7]
  ds_read_b128 v[20:23], v10 offset:32768
  v_mfma_f32_16x16x32_bf16 a[8:11], v[76:79], v[36:39], a[8:11]
  ds_read_b64_tr_b16 v[52:53], v12 offset:49152
  v_mfma_f32_16x16x32_bf16 a[12:15], v[80:83], v[36:39], a[12:15]
  ds_read_b64_tr_b16 v[54:55], v12 offset:53248
  v_mfma_f32_16x16x32_bf16 a[16:19], v[68:71], v[40:43], a[16:19]
  ds_read_b128 v[24:27], v10 offset:34816
  v_mfma_f32_16x16x32_bf16 a[20:23], v[72:75], v[40:43], a[20:23]
  ds_read_b64_tr_b16 v[56:57], v12 offset:49160
  v_mfma_f32_16x16x32_bf16 a[24:27], v[76:79], v[40:43], a[24:27]
  ds_read_b64_tr_b16 v[58:59], v12 offset:53256
  v_mfma_f32_16x16x32_bf16 a[28:31], v[80:83], v[40:43], a[28:31]
  ds_read_b128 v[28:31], v10 offset:36864
  v_mfma_f32_16x16x32_bf16 a[32:35], v[68:71], v[44:47], a[32:35]
  ds_read_b64_tr_b16 v[60:61], v13 offset:49152
  v_mfma_f32_16x16x32_bf16 a[36:39], v[72:75], v[44:47], a[36:39]
  ds_read_b64_tr_b16 v[62:63], v13 offset:53248
  v_mfma_f32_16x16x32_bf16 a[40:43], v[76:79], v[44:47], a[40:43]
  ds_read_b128 v[32:35], v10 offset:38912
  v_mfma_f32_16x16x32_bf16 a[44:47], v[80:83], v[44:47], a[44:47]
  ds_read_b64_tr_b16 v[64:65], v13 offset:49160
  v_mfma_f32_16x16x32_bf16 a[48:51], v[68:71], v[48:51], a[48:51]
  ds_read_b64_tr_b16 v[66:67], v13 offset:53256
  v_mfma_f32_16x16x32_bf16 a[52:55], v[72:75], v[48:51], a[52:55]
  v_mfma_f32_16x16x32_bf16 a[56:59], v[76:79], v[48:51], a[56:59]
  v_mfma_f32_16x16x32_bf16 a[60:63], v[80:83], v[48:51], a[60:63]
  s_waitcnt lgkmcnt(0)
  v_mfma_f32_16x16x32_bf16 a[0:3], v[52:55], v[20:23], a[0:3]
  ds_read_b128 v[36:39], v10 offset:33792
  v_mfma_f32_16x16x32_bf16 a[4:7], v[56:59], v[20:23], a[4:7]
  ds_read_b64_tr_b16 v[68:69], v12 offset:57344
  v_mfma_f32_16x16x32_bf16 a[8:11], v[60:63], v[20:23], a[8:11]
  ds_read_b64_tr_b16 v[70:71], v12 offset:61440
  v_mfma_f32_16x16x32_bf16 a[12:15], v[64:67], v[20:23], a[12:15]
  ds_read_b128 v[40:43], v10 offset:35840
  v_mfma_f32_16x16x32_bf16 a[16:19], v[52:55], v[24:27], a[16:19]
  ds_read_b64_tr_b16 v[72:73], v12 offset:57352
  v_mfma_f32_16x16x32_bf16 a[20:23], v[56:59], v[24:27], a[20:23]
  ds_read_b64_tr_b16 v[74:75], v12 offset:61448
  v_mfma_f32_16x16x32_bf16 a[24:27], v[60:63], v[24:27], a[24:27]
  ds_read_b128 v[44:47], v10 offset:37888
  v_mfma_f32_16x16x32_bf16 a[28:31], v[64:67], v[24:27], a[28:31]
  ds_read_b64_tr_b16 v[76:77], v13 offset:57344
  v_mfma_f32_16x16x32_bf16 a[32:35], v[52:55], v[28:31], a[32:35]
  ds_read_b64_tr_b16 v[78:79], v13 offset:61440
  v_mfma_f32_16x16x32_bf16 a[36:39], v[56:59], v[28:31], a[36:39]
  ds_read_b128 v[48:51], v10 offset:39936
  v_mfma_f32_16x16x32_bf16 a[40:43], v[60:63], v[28:31], a[40:43]
  ds_read_b64_tr_b16 v[80:81], v13 offset:57352
  v_mfma_f32_16x16x32_bf16 a[44:47], v[64:67], v[28:31], a[44:47]
  ds_read_b64_tr_b16 v[82:83], v13 offset:61448
  v_mfma_f32_16x16x32_bf16 a[48:51], v[52:55], v[32:35], a[48:51]
  v_mfma_f32_16x16x32_bf16 a[52:55], v[56:59], v[32:35], a[52:55]
  v_mfma_f32_16x16x32_bf16 a[56:59], v[60:63], v[32:35], a[56:59]
  v_mfma_f32_16x16x32_bf16 a[60:63], v[64:67], v[32:35], a[60:63]
  s_waitcnt lgkmcnt(0)
  v_mfma_f32_16x16x32_bf16 a[0:3], v[68:71], v[36:39], a[0:3]
  s_waitcnt vmcnt(8)
  s_barrier
  v_mfma_f32_16x16x32_bf16 a[4:7], v[72:75], v[36:39], a[4:7]
  ds_read_b128 v[20:23], v11 offset:0
  v_mfma_f32_16x16x32_bf16 a[8:11], v[76:79], v[36:39], a[8:11]
  ds_read_b64_tr_b16 v[52:53], v14 offset:16384
  v_mfma_f32_16x16x32_bf16 a[12:15], v[80:83], v[36:39], a[12:15]
  ds_read_b64_tr_b16 v[54:55], v14 offset:20480
  v_mfma_f32_16x16x32_bf16 a[16:19], v[68:71], v[40:43], a[16:19]
  ds_read_b128 v[24:27], v11 offset:2048
  v_mfma_f32_16x16x32_bf16 a[20:23], v[72:75], v[40:43], a[20:23]
  ds_read_b64_tr_b16 v[56:57], v14 offset:16392
  v_mfma_f32_16x16x32_bf16 a[24:27], v[76:79], v[40:43], a[24:27]
  ds_read_b64_tr_b16 v[58:59], v14 offset:20488
  v_mfma_f32_16x16x32_bf16 a[28:31], v[80:83], v[40:43], a[28:31]
  ds_read_b128 v[28:31], v11 offset:4096
  v_mfma_f32_16x16x32_bf16 a[32:35], v[68:71], v[44:47], a[32:35]
  ds_read_b64_tr_b16 v[60:61], v15 offset:16384
  v_mfma_f32_16x16x32_bf16 a[36:39], v[72:75], v[44:47], a[36:39]
  ds_read_b64_tr_b16 v[62:63], v15 offset:20480
  v_mfma_f32_16x16x32_bf16 a[40:43], v[76:79], v[44:47], a[40:43]
  ds_read_b128 v[32:35], v11 offset:6144
  v_mfma_f32_16x16x32_bf16 a[44:47], v[80:83], v[44:47], a[44:47]
  ds_read_b64_tr_b16 v[64:65], v15 offset:16392
  v_mfma_f32_16x16x32_bf16 a[48:51], v[68:71], v[48:51], a[48:51]
  ds_read_b64_tr_b16 v[66:67], v15 offset:20488
  v_mfma_f32_16x16x32_bf16 a[52:55], v[72:75], v[48:51], a[52:55]
  v_mfma_f32_16x16x32_bf16 a[56:59], v[76:79], v[48:51], a[56:59]
  v_mfma_f32_16x16x32_bf16 a[60:63], v[80:83], v[48:51], a[60:63]
  s_waitcnt lgkmcnt(0)
  v_mfma_f32_16x16x32_bf16 a[0:3], v[52:55], v[20:23], a[0:3]
  ds_read_b128 v[36:39], v11 offset:1024
  v_mfma_f32_16x16x32_bf16 a[4:7], v[56:59], v[20:23], a[4:7]
  ds_read_b64_tr_b16 v[68:69], v14 offset:24576
  v_mfma_f32_16x16x32_bf16 a[8:11], v[60:63], v[20:23], a[8:11]
  ds_read_b64_tr_b16 v[70:71], v14 offset:28672
  v_mfma_f32_16x16x32_bf16 a[12:15], v[64:67], v[20:23], a[12:15]
  ds_read_b128 v[40:43], v11 offset:3072
  v_mfma_f32_16x16x32_bf16 a[16:19], v[52:55], v[24:27], a[16:19]
  ds_read_b64_tr_b16 v[72:73], v14 offset:24584
  v_mfma_f32_16x16x32_bf16 a[20:23], v[56:59], v[24:27], a[20:23]
  ds_read_b64_tr_b16 v[74:75], v14 offset:28680
  v_mfma_f32_16x16x32_bf16 a[24:27], v[60:63], v[24:27], a[24:27]
  ds_read_b128 v[44:47], v11 offset:5120
  v_mfma_f32_16x16x32_bf16 a[28:31], v[64:67], v[24:27], a[28:31]
  ds_read_b64_tr_b16 v[76:77], v15 offset:24576
  v_mfma_f32_16x16x32_bf16 a[32:35], v[52:55], v[28:31], a[32:35]
  ds_read_b64_tr_b16 v[78:79], v15 offset:28672
  v_mfma_f32_16x16x32_bf16 a[36:39], v[56:59], v[28:31], a[36:39]
  ds_read_b128 v[48:51], v11 offset:7168
  v_mfma_f32_16x16x32_bf16 a[40:43], v[60:63], v[28:31], a[40:43]
  ds_read_b64_tr_b16 v[80:81], v15 offset:24584
  v_mfma_f32_16x16x32_bf16 a[44:47], v[64:67], v[28:31], a[44:47]
  ds_read_b64_tr_b16 v[82:83], v15 offset:28680
  v_mfma_f32_16x16x32_bf16 a[48:51], v[52:55], v[32:35], a[48:51]
  v_mfma_f32_16x16x32_bf16 a[52:55], v[56:59], v[32:35], a[52:55]
  v_mfma_f32_16x16x32_bf16 a[56:59], v[60:63], v[32:35], a[56:59]
  v_mfma_f32_16x16x32_bf16 a[60:63], v[64:67], v[32:35], a[60:63]
  s_waitcnt lgkmcnt(0)
  v_mfma_f32_16x16x32_bf16 a[0:3], v[68:71], v[36:39], a[0:3]
  s_waitcnt vmcnt(0)
  s_barrier
  v_mfma_f32_16x16x32_bf16 a[4:7], v[72:75], v[36:39], a[4:7]
  ds_read_b128 v[20:23], v11 offset:32768
  v_mfma_f32_16x16x32_bf16 a[8:11], v[76:79], v[36:39], a[8:11]
  ds_read_b64_tr_b16 v[52:53], v14 offset:49152
  v_mfma_f32_16x16x32_bf16 a[12:15], v[80:83], v[36:39], a[12:15]
  ds_read_b64_tr_b16 v[54:55], v14 offset:53248
  v_mfma_f32_16x16x32_bf16 a[16:19], v[68:71], v[40:43], a[16:19]
  ds_read_b128 v[24:27], v11 offset:34816
  v_mfma_f32_16x16x32_bf16 a[20:23], v[72:75], v[40:43], a[20:23]
  ds_read_b64_tr_b16 v[56:57], v14 offset:49160
  v_mfma_f32_16x16x32_bf16 a[24:27], v[76:79], v[40:43], a[24:27]
  ds_read_b64_tr_b16 v[58:59], v14 offset:53256
  v_mfma_f32_16x16x32_bf16 a[28:31], v[80:83], v[40:43], a[28:31]
  ds_read_b128 v[28:31], v11 offset:36864
  v_mfma_f32_16x16x32_bf16 a[32:35], v[68:71], v[44:47], a[32:35]
  ds_read_b64_tr_b16 v[60:61], v15 offset:49152
  v_mfma_f32_16x16x32_bf16 a[36:39], v[72:75], v[44:47], a[36:39]
  ds_read_b64_tr_b16 v[62:63], v15 offset:53248
  v_mfma_f32_16x16x32_bf16 a[40:43], v[76:79], v[44:47], a[40:43]
  ds_read_b128 v[32:35], v11 offset:38912
  v_mfma_f32_16x16x32_bf16 a[44:47], v[80:83], v[44:47], a[44:47]
  ds_read_b64_tr_b16 v[64:65], v15 offset:49160
  v_mfma_f32_16x16x32_bf16 a[48:51], v[68:71], v[48:51], a[48:51]
  ds_read_b64_tr_b16 v[66:67], v15 offset:53256
  v_mfma_f32_16x16x32_bf16 a[52:55], v[72:75], v[48:51], a[52:55]
  v_mfma_f32_16x16x32_bf16 a[56:59], v[76:79], v[48:51], a[56:59]
  v_mfma_f32_16x16x32_bf16 a[60:63], v[80:83], v[48:51], a[60:63]
  s_waitcnt lgkmcnt(0)
  v_mfma_f32_16x16x32_bf16 a[0:3], v[52:55], v[20:23], a[0:3]
  ds_read_b128 v[36:39], v11 offset:33792
  v_mfma_f32_16x16x32_bf16 a[4:7], v[56:59], v[20:23], a[4:7]
  ds_read_b64_tr_b16 v[68:69], v14 offset:57344
  v_mfma_f32_16x16x32_bf16 a[8:11], v[60:63], v[20:23], a[8:11]
  ds_read_b64_tr_b16 v[70:71], v14 offset:61440
  v_mfma_f32_16x16x32_bf16 a[12:15], v[64:67], v[20:23], a[12:15]
  ds_read_b128 v[40:43], v11 offset:35840
  v_mfma_f32_16x16x32_bf16 a[16:19], v[52:55], v[24:27], a[16:19]
  ds_read_b64_tr_b16 v[72:73], v14 offset:57352
  v_mfma_f32_16x16x32_bf16 a[20:23], v[56:59], v[24:27], a[20:23]
  ds_read_b64_tr_b16 v[74:75], v14 offset:61448
  v_mfma_f32_16x16x32_bf16 a[24:27], v[60:63], v[24:27], a[24:27]
  ds_read_b128 v[44:47], v11 offset:37888
  v_mfma_f32_16x16x32_bf16 a[28:31], v[64:67], v[24:27], a[28:31]
  ds_read_b64_tr_b16 v[76:77], v15 offset:57344
  v_mfma_f32_16x16x32_bf16 a[32:35], v[52:55], v[28:31], a[32:35]
  ds_read_b64_tr_b16 v[78:79], v15 offset:61440
  v_mfma_f32_16x16x32_bf16 a[36:39], v[56:59], v[28:31], a[36:39]
  ds_read_b128 v[48:51], v11 offset:39936
  v_mfma_f32_16x16x32_bf16 a[40:43], v[60:63], v[28:31], a[40:43]
  ds_read_b64_tr_b16 v[80:81], v15 offset:57352
  v_mfma_f32_16x16x32_bf16 a[44:47], v[64:67], v[28:31], a[44:47]
  ds_read_b64_tr_b16 v[82:83], v15 offset:61448
  v_mfma_f32_16x16x32_bf16 a[48:51], v[52:55], v[32:35], a[48:51]
  v_mfma_f32_16x16x32_bf16 a[52:55], v[56:59], v[32:35], a[52:55]
  v_mfma_f32_16x16x32_bf16 a[56:59], v[60:63], v[32:35], a[56:59]
  v_mfma_f32_16x16x32_bf16 a[60:63], v[64:67], v[32:35], a[60:63]
  s_waitcnt lgkmcnt(0)
  v_mfma_f32_16x16x32_bf16 a[0:3], v[68:71], v[36:39], a[0:3]
  v_mfma_f32_16x16x32_bf16 a[4:7], v[72:75], v[36:39], a[4:7]
  v_mfma_f32_16x16x32_bf16 a[8:11], v[76:79], v[36:39], a[8:11]
  v_mfma_f32_16x16x32_bf16 a[12:15], v[80:83], v[36:39], a[12:15]
  v_mfma_f32_16x16x32_bf16 a[16:19], v[68:71], v[40:43], a[16:19]
  v_mfma_f32_16x16x32_bf16 a[20:23], v[72:75], v[40:43], a[20:23]
  v_mfma_f32_16x16x32_bf16 a[24:27], v[76:79], v[40:43], a[24:27]
  v_mfma_f32_16x16x32_bf16 a[28:31], v[80:83], v[40:43], a[28:31]
  v_mfma_f32_16x16x32_bf16 a[32:35], v[68:71], v[44:47], a[32:35]
  v_mfma_f32_16x16x32_bf16 a[36:39], v[72:75], v[44:47], a[36:39]
  v_mfma_f32_16x16x32_bf16 a[40:43], v[76:79], v[44:47], a[40:43]
  v_mfma_f32_16x16x32_bf16 a[44:47], v[80:83], v[44:47], a[44:47]
  v_mfma_f32_16x16x32_bf16 a[48:51], v[68:71], v[48:51], a[48:51]
  v_mfma_f32_16x16x32_bf16 a[52:55], v[72:75], v[48:51], a[52:55]
  v_mfma_f32_16x16x32_bf16 a[56:59], v[76:79], v[48:51], a[56:59]
  v_mfma_f32_16x16x32_bf16 a[60:63], v[80:83], v[48:51], a[60:63]
  s_cmp_eq_u32 s35, 8
  s_cbranch_scc1 L_part
  s_mov_b32 s59, 5
  s_mov_b32 s60, s22
  s_mov_b32 s61, s26
  s_add_u32 s62, s38, 0x3d00000
  s_mov_b32 s63, s98
  s_cmp_lg_u32 s39, 0
  s_cbranch_scc1 L_got
  s_mov_b32 s58, 3
  s_branch L_epi
L_part:
  s_sub_u32 s40, s36, 13
  s_lshl_b32 s40, s40, 3
  s_add_u32 s40, s40, s50
  s_lshl_b32 s41, s40, 19
  s_add_u32 s41, s41, 0x6400000
  s_lshl_b32 s90, s32, 14
  s_add_u32 s41, s41, s90
  s_lshl_b32 s90, s48, 16
  s_add_u32 s42, s41, s90
  v_lshlrev_b32 v2, 4, v1
  buffer_store_dwordx4 a[0:3], v2, s[4:7], s42 offen offset:0 sc1
  buffer_store_dwordx4 a[4:7], v2, s[4:7], s42 offen offset:1024 sc1
  buffer_store_dwordx4 a[8:11], v2, s[4:7], s42 offen offset:2048 sc1
  buffer_store_dwordx4 a[12:15], v2, s[4:7], s42 offen offset:3072 sc1
  s_add_u32 s42, s42, 4096
  buffer_store_dwordx4 a[16:19], v2, s[4:7], s42 offen offset:0 sc1
  buffer_store_dwordx4 a[20:23], v2, s[4:7], s42 offen offset:1024 sc1
  buffer_store_dwordx4 a[24:27], v2, s[4:7], s42 offen offset:2048 sc1
  buffer_store_dwordx4 a[28:31], v2, s[4:7], s42 offen offset:3072 sc1
  s_add_u32 s42, s42, 4096
  buffer_store_dwordx4 a[32:35], v2, s[4:7], s42 offen offset:0 sc1
  buffer_store_dwordx4 a[36:39], v2, s[4:7], s42 offen offset:1024 sc1
  buffer_store_dwordx4 a[40:43], v2, s[4:7], s42 offen offset:2048 sc1
  buffer_store_dwordx4 a[44:47], v2, s[4:7], s42 offen offset:3072 sc1
  s_add_u32 s42, s42, 4096
  buffer_store_dwordx4 a[48:51], v2, s[4:7], s42 offen offset:0 sc1
  buffer_store_dwordx4 a[52:55], v2, s[4:7], s42 offen offset:1024 sc1
  buffer_store_dwordx4 a[56:59], v2, s[4:7], s42 offen offset:2048 sc1
  buffer_store_dwordx4 a[60:63], v2, s[4:7], s42 offen offset:3072 sc1
  s_lshl_b32 s40, s40, 7
  s_add_u32 s43, s40, 0x3d04000
  s_waitcnt vmcnt(0)
  s_barrier
  s_cmp_lg_u32 s32, 0
  s_cbranch_scc1 L_sig_29
  v_mov_b32 v254, 1
  v_mov_b32 v255, 0
  s_mov_b64 exec, 1
  buffer_atomic_add v254, v255, s[4:7], s43 offen offset:0 sc1
  s_mov_b64 exec, -1
L_sig_29:
  s_cmp_lg_u32 s32, 0
  s_cbranch_scc1 L_dd_31
  v_mov_b32 v228, 0x3d00000
  v_mov_b32 v232, 0x3d04000
L_dw_30:
  buffer_load_dword v234, v232, s[4:7], s40 offen offset:0 sc1
  s_waitcnt vmcnt(0)
  s_mov_b32 s44, 1
  v_readfirstlane_b32 s45, v234
  s_cmp_ge_u32 s45, 8
  s_cselect_b32 s44, s44, 0
  s_cmp_eq_u32 s44, 1
  s_cbranch_scc1 L_dd_31
  s_sleep 1
  s_add_u32 s3, s3, 1
  s_cmp_lt_u32 s3, 131072
  s_cbranch_scc1 L_dw_30
L_dd_31:
  s_barrier
  s_cmp_lg_u32 s32, 0
  s_cbranch_scc1 L_rq_32
  s_cmp_eq_u32 s39, 0
  s_cbranch_scc1 L_rq_32
  s_lshl_b32 s99, s33, 7
  s_add_u32 s99, s99, 0x3d00200
  v_mov_b32 v244, 1
  v_mov_b32 v245, 0
  s_mov_b64 exec, 1
  buffer_atomic_add v244, v245, s[4:7], s99 offen sc0 sc1
  s_mov_b64 exec, -1
L_rq_32:
  s_lshl_b32 s90, s48, 11
  s_add_u32 s41, s41, s90
  buffer_load_dwordx4 v[16:19], v2, s[4:7], s41 offen offset:0 sc1
  buffer_load_dwordx4 v[20:23], v2, s[4:7], s41 offen offset:1024 sc1
  s_add_u32 s41, s41, 0x10000
  buffer_load_dwordx4 v[24:27], v2, s[4:7], s41 offen offset:0 sc1
  buffer_load_dwordx4 v[28:31], v2, s[4:7], s41 offen offset:1024 sc1
  s_add_u32 s41, s41, 0x10000
  buffer_load_dwordx4 v[32:35], v2, s[4:7], s41 offen offset:0 sc1
  buffer_load_dwordx4 v[36:39], v2, s[4:7], s41 offen offset:1024 sc1
  s_add_u32 s41, s41, 0x10000
  buffer_load_dwordx4 v[40:43], v2, s[4:7], s41 offen offset:0 sc1
  buffer_load_dwordx4 v[44:47], v2, s[4:7], s41 offen offset:1024 sc1
  s_add_u32 s41, s41, 0x10000
  buffer_load_dwordx4 v[48:51], v2, s[4:7], s41 offen offset:0 sc1
  buffer_load_dwordx4 v[52:55], v2, s[4:7], s41 offen offset:1024 sc1
  s_add_u32 s41, s41, 0x10000
  buffer_load_dwordx4 v[56:59], v2, s[4:7], s41 offen offset:0 sc1
  buffer_load_dwordx4 v[60:63], v2, s[4:7], s41 offen offset:1024 sc1
  s_add_u32 s41, s41, 0x10000
  buffer_load_dwordx4 v[64:67], v2, s[4:7], s41 offen offset:0 sc1
  buffer_load_dwordx4 v[68:71], v2, s[4:7], s41 offen offset:1024 sc1
  s_add_u32 s41, s41, 0x10000
  buffer_load_dwordx4 v[72:75], v2, s[4:7], s41 offen offset:0 sc1
  buffer_load_dwordx4 v[76:79], v2, s[4:7], s41 offen offset:1024 sc1
  s_add_u32 s41, s41, 0x10000
  v_mov_b32 v3, 0x0
  v_bfe_u32 v4, v1, 0, 4
  v_lshl_add_u32 v3, v4, 12, v3
  v_bfe_u32 v4, v1, 4, 2
  v_lshl_add_u32 v3, v4, 4, v3
  s_lshr_b32 s90, s32, 1
  s_lshl_b32 s90, s90, 18
  s_add_u32 s22, s22, s90
  s_and_b32 s90, s32, 1
  s_lshl_b32 s90, s90, 7
  s_add_u32 s22, s22, s90
  s_lshr_b32 s90, s48, 1
  s_lshl_b32 s90, s90, 16
  s_add_u32 s22, s22, s90
  s_and_b32 s90, s48, 1
  s_lshl_b32 s90, s90, 6
  s_add_u32 s22, s22, s90
  s_waitcnt vmcnt(12)
  v_pk_add_f32 v[16:17], v[16:17], v[24:25]
  v_pk_add_f32 v[18:19], v[18:19], v[26:27]
  v_pk_add_f32 v[20:21], v[20:21], v[28:29]
  v_pk_add_f32 v[22:23], v[22:23], v[30:31]
  s_waitcnt vmcnt(10)
  v_pk_add_f32 v[16:17], v[16:17], v[32:33]
  v_pk_add_f32 v[18:19], v[18:19], v[34:35]
  v_pk_add_f32 v[20:21], v[20:21], v[36:37]
  v_pk_add_f32 v[22:23], v[22:23], v[38:39]
  s_waitcnt vmcnt(8)
  v_pk_add_f32 v[16:17], v[16:17], v[40:41]
  v_pk_add_f32 v[18:19], v[18:19], v[42:43]
  v_pk_add_f32 v[20:21], v[20:21], v[44:45]
  v_pk_add_f32 v[22:23], v[22:23], v[46:47]
  s_waitcnt vmcnt(6)
  v_pk_add_f32 v[16:17], v[16:17], v[48:49]
  v_pk_add_f32 v[18:19], v[18:19], v[50:51]
  v_pk_add_f32 v[20:21], v[20:21], v[52:53]
  v_pk_add_f32 v[22:23], v[22:23], v[54:55]
  s_waitcnt vmcnt(4)
  v_pk_add_f32 v[16:17], v[16:17], v[56:57]
  v_pk_add_f32 v[18:19], v[18:19], v[58:59]
  v_pk_add_f32 v[20:21], v[20:21], v[60:61]
  v_pk_add_f32 v[22:23], v[22:23], v[62:63]
  s_waitcnt vmcnt(2)
  v_pk_add_f32 v[16:17], v[16:17], v[64:65]
  v_pk_add_f32 v[18:19], v[18:19], v[66:67]
  v_pk_add_f32 v[20:21], v[20:21], v[68:69]
  v_pk_add_f32 v[22:23], v[22:23], v[70:71]
  s_waitcnt vmcnt(0)
  v_pk_add_f32 v[16:17], v[16:17], v[72:73]
  v_pk_add_f32 v[18:19], v[18:19], v[74:75]
  v_pk_add_f32 v[20:21], v[20:21], v[76:77]
  v_pk_add_f32 v[22:23], v[22:23], v[78:79]
  v_cvt_pk_bf16_f32 v8, v16, v17
  v_cvt_pk_bf16_f32 v9, v18, v19
  v_cvt_pk_bf16_f32 v10, v20, v21
  v_cvt_pk_bf16_f32 v11, v22, v23
  buffer_store_dwordx4 v[8:11], v3, s[16:19], s22 offen
  s_branch L_got
L_aof:
  s_mov_b32 s12, s74
  s_and_b32 s13, s75, 0xffff
  s_mov_b32 s14, 0x800000
  s_mov_b32 s15, 0x20000
  s_mov_b32 s8, s4
  s_and_b32 s9, s5, 0xffff
  s_mov_b32 s10, 0x10000000
  s_mov_b32 s11, 0x20000
  s_and_b32 s48, s37, 15
  s_lshr_b32 s37, s37, 4
  s_lshl_b32 s50, s33, 1
  s_add_u32 s50, s50, s37
  s_sub_u32 s40, s36, 24
  s_lshl_b32 s40, s40, 3
  s_lshr_b32 s90, s48, 1
  s_add_u32 s40, s40, s90
  s_lshl_b32 s40, s40, 7
  s_add_u32 s40, s40, 20480
  s_mov_b32 s23, 262144
  s_mov_b32 s24, 2048
  s_lshl_b32 s20, s36, 19
  s_add_u32 s20, s20, 0x5000000
  s_lshl_b32 s90, s48, 14
  s_add_u32 s20, s20, s90
  s_lshl_b32 s21, s50, 8
  s_lshl_b32 s22, s36, 18
  s_add_u32 s22, s22, s21
  s_lshl_b32 s90, s48, 19
  s_add_u32 s21, s21, s90
  v_and_b32 v1, 63, v0
  v_lshrrev_b32 v14, 6, v0
  s_nop 0
  v_readfirstlane_b32 s27, v14
  s_lshr_b32 s90, s27, 1
  s_mul_i32 s90, s90, s23
  s_and_b32 s91, s27, 1
  s_lshl_b32 s91, s91, 12
  s_add_u32 s90, s90, s91
  v_mov_b32 v2, 0x0
  v_bfe_u32 v15, v1, 0, 6
  v_lshl_add_u32 v2, v15, 4, v2
  v_add_u32 v2, s90, v2
  v_mov_b32 v3, 0x400
  v_bfe_u32 v15, v1, 0, 6
  v_lshl_add_u32 v3, v15, 4, v3
  v_add_u32 v3, s90, v3
  s_mul_i32 s90, s27, 16
  v_lshrrev_b32 v14, 4, v1
  v_add_u32 v14, 0, v14
  v_add_u32 v14, s90, v14
  v_and_b32 v15, 7, v14
  v_lshlrev_b32 v15, 1, v15
  v_xor_b32 v15, v15, v1
  v_and_b32 v15, 15, v15
  v_mul_lo_u32 v14, v14, s24
  v_lshl_add_u32 v4, v15, 4, v14
  v_lshrrev_b32 v14, 4, v1
  v_add_u32 v14, 4, v14
  v_add_u32 v14, s90, v14
  v_and_b32 v15, 7, v14
  v_lshlrev_b32 v15, 1, v15
  v_xor_b32 v15, v15, v1
  v_and_b32 v15, 15, v15
  v_mul_lo_u32 v14, v14, s24
  v_lshl_add_u32 v5, v15, 4, v14
  v_lshrrev_b32 v14, 4, v1
  v_add_u32 v14, 8, v14
  v_add_u32 v14, s90, v14
  v_and_b32 v15, 7, v14
  v_lshlrev_b32 v15, 1, v15
  v_xor_b32 v15, v15, v1
  v_and_b32 v15, 15, v15
  v_mul_lo_u32 v14, v14, s24
  v_lshl_add_u32 v6, v15, 4, v14
  v_lshrrev_b32 v14, 4, v1
  v_add_u32 v14, 12, v14
  v_add_u32 v14, s90, v14
  v_and_b32 v15, 7, v14
  v_lshlrev_b32 v15, 1, v15
  v_xor_b32 v15, v15, v1
  v_and_b32 v15, 15, v15
  v_mul_lo_u32 v14, v14, s24
  v_lshl_add_u32 v7, v15, 4, v14
  s_mul_i32 s51, s24, 64
  s_mul_i32 s52, s27, 2048
  s_mul_i32 s53, s27, 4096
  s_add_u32 s53, s53, 8192
  s_add_u32 m0, s53, 0
  s_nop 0
  buffer_load_dwordx4 v4, s[12:15], s21 offen  lds
  s_add_u32 m0, s53, 1024
  s_nop 0
  buffer_load_dwordx4 v5, s[12:15], s21 offen  lds
  s_add_u32 m0, s53, 2048
  s_nop 0
  buffer_load_dwordx4 v6, s[12:15], s21 offen  lds
  s_add_u32 m0, s53, 3072
  s_nop 0
  buffer_load_dwordx4 v7, s[12:15], s21 offen  lds
  s_add_u32 s21, s21, s51
  s_add_u32 m0, s53, 24576
  s_nop 0
  buffer_load_dwordx4 v4, s[12:15], s21 offen  lds
  s_add_u32 m0, s53, 25600
  s_nop 0
  buffer_load_dwordx4 v5, s[12:15], s21 offen  lds
  s_add_u32 m0, s53, 26624
  s_nop 0
  buffer_load_dwordx4 v6, s[12:15], s21 offen  lds
  s_add_u32 m0, s53, 27648
  s_nop 0
  buffer_load_dwordx4 v7, s[12:15], s21 offen  lds
  s_add_u32 s21, s21, s51
  s_add_u32 m0, s53, 49152
  s_nop 0
  buffer_load_dwordx4 v4, s[12:15], s21 offen  lds
  s_add_u32 m0, s53, 50176
  s_nop 0
  buffer_load_dwordx4 v5, s[12:15], s21 offen  lds
  s_add_u32 m0, s53, 51200
  s_nop 0
  buffer_load_dwordx4 v6, s[12:15], s21 offen  lds
  s_add_u32 m0, s53, 52224
  s_nop 0
  buffer_load_dwordx4 v7, s[12:15], s21 offen  lds
  s_add_u32 s21, s21, s51
  s_add_u32 m0, s53, 73728
  s_nop 0
  buffer_load_dwordx4 v4, s[12:15], s21 offen  lds
  s_add_u32 m0, s53, 74752
  s_nop 0
  buffer_load_dwordx4 v5, s[12:15], s21 offen  lds
  s_add_u32 m0, s53, 75776
  s_nop 0
  buffer_load_dwordx4 v6, s[12:15], s21 offen  lds
  s_add_u32 m0, s53, 76800
  s_nop 0
  buffer_load_dwordx4 v7, s[12:15], s21 offen  lds
  s_add_u32 s21, s21, s51
  s_cmp_lg_u32 s32, 0
  s_cbranch_scc1 L_dd_34
  v_mov_b32 v228, 0x3d00000
L_dw_33:
  buffer_load_dword v234, v228, s[4:7], s40 offen offset:0 sc1
  s_waitcnt vmcnt(0)
  s_mov_b32 s44, 1
  v_readfirstlane_b32 s45, v234
  s_cmp_ge_u32 s45, 2
  s_cselect_b32 s44, s44, 0
  s_cmp_eq_u32 s44, 1
  s_cbranch_scc1 L_dd_34
  s_sleep 1
  s_add_u32 s3, s3, 1
  s_cmp_lt_u32 s3, 131072
  s_cbranch_scc1 L_dw_33
L_dd_34:
  s_barrier
  s_add_u32 m0, s52, 0
  s_nop 0
  buffer_load_dwordx4 v2, s[8:11], s20 offen sc1 lds
  s_add_u32 m0, s52, 1024
  s_nop 0
  buffer_load_dwordx4 v3, s[8:11], s20 offen sc1 lds
  s_add_u32 s20, s20, 2048
  s_add_u32 m0, s52, 24576
  s_nop 0
  buffer_load_dwordx4 v2, s[8:11], s20 offen sc1 lds
  s_add_u32 m0, s52, 25600
  s_nop 0
  buffer_load_dwordx4 v3, s[8:11], s20 offen sc1 lds
  s_add_u32 s20, s20, 6144
  s_add_u32 m0, s52, 49152
  s_nop 0
  buffer_load_dwordx4 v2, s[8:11], s20 offen sc1 lds
  s_add_u32 m0, s52, 50176
  s_nop 0
  buffer_load_dwordx4 v3, s[8:11], s20 offen sc1 lds
  s_add_u32 s20, s20, 2048
  s_add_u32 m0, s52, 73728
  s_nop 0
  buffer_load_dwordx4 v2, s[8:11], s20 offen sc1 lds
  s_add_u32 m0, s52, 74752
  s_nop 0
  buffer_load_dwordx4 v3, s[8:11], s20 offen sc1 lds
  s_add_u32 s20, s20, 6144
  s_lshr_b32 s90, s27, 1
  s_and_b32 s91, s27, 1
  s_mul_i32 s92, s90, 4096
  v_mov_b32 v8, 0x0
  v_bfe_u32 v15, v1, 0, 6
  v_lshl_add_u32 v8, v15, 4, v8
  v_add_u32 v8, s92, v8
  v_add_u32 v9, 65536, v8
  v_mov_b32 v14, 0x0
  v_bfe_u32 v15, v1, 2, 2
  v_lshl_add_u32 v14, v15, 8, v14
  v_bfe_u32 v15, v1, 4, 2
  v_lshl_add_u32 v14, v15, 10, v14
  v_bfe_u32 v15, v1, 0, 1
  v_lshl_add_u32 v14, v15, 4, v14
  v_bfe_u32 v16, v1, 2, 3
  v_bfe_u32 v15, v1, 1, 1
  v_xor_b32 v16, v16, v15
  s_mul_i32 s92, s91, 4
  s_add_u32 s93, s92, 0
  v_xor_b32 v15, s93, v16
  v_lshl_add_u32 v10, v15, 5, v14
  v_add_u32 v12, 65536, v10
  s_add_u32 s93, s92, 2
  v_xor_b32 v15, s93, v16
  v_lshl_add_u32 v11, v15, 5, v14
  v_add_u32 v13, 65536, v11
  s_waitcnt vmcnt(4)
  s_barrier
  ds_read_b128 v[20:23], v8 offset:0
  ds_read_b64_tr_b16 v[36:37], v10 offset:8192
  ds_read_b64_tr_b16 v[38:39], v10 offset:12288
  ds_read_b128 v[24:27], v8 offset:2048
  ds_read_b64_tr_b16 v[40:41], v10 offset:8200
  ds_read_b64_tr_b16 v[42:43], v10 offset:12296
  ds_read_b64_tr_b16 v[44:45], v11 offset:8192
  ds_read_b64_tr_b16 v[46:47], v11 offset:12288
  ds_read_b64_tr_b16 v[48:49], v11 offset:8200
  ds_read_b64_tr_b16 v[50:51], v11 offset:12296
  s_waitcnt lgkmcnt(0)
  v_mfma_f32_16x16x32_bf16 a[0:3], v[36:39], v[20:23], 0
  ds_read_b128 v[28:31], v8 offset:1024
  ds_read_b64_tr_b16 v[52:53], v10 offset:16384
  v_mfma_f32_16x16x32_bf16 a[4:7], v[40:43], v[20:23], 0
  ds_read_b64_tr_b16 v[54:55], v10 offset:20480
  ds_read_b128 v[32:35], v8 offset:3072
  v_mfma_f32_16x16x32_bf16 a[8:11], v[44:47], v[20:23], 0
  ds_read_b64_tr_b16 v[56:57], v10 offset:16392
  ds_read_b64_tr_b16 v[58:59], v10 offset:20488
  v_mfma_f32_16x16x32_bf16 a[12:15], v[48:51], v[20:23], 0
  ds_read_b64_tr_b16 v[60:61], v11 offset:16384
  ds_read_b64_tr_b16 v[62:63], v11 offset:20480
  v_mfma_f32_16x16x32_bf16 a[16:19], v[36:39], v[24:27], 0
  ds_read_b64_tr_b16 v[64:65], v11 offset:16392
  ds_read_b64_tr_b16 v[66:67], v11 offset:20488
  v_mfma_f32_16x16x32_bf16 a[20:23], v[40:43], v[24:27], 0
  v_mfma_f32_16x16x32_bf16 a[24:27], v[44:47], v[24:27], 0
  v_mfma_f32_16x16x32_bf16 a[28:31], v[48:51], v[24:27], 0
  s_waitcnt lgkmcnt(0)
  v_mfma_f32_16x16x32_bf16 a[0:3], v[52:55], v[28:31], a[0:3]
  ds_read_b128 v[20:23], v8 offset:24576
  ds_read_b64_tr_b16 v[36:37], v10 offset:32768
  v_mfma_f32_16x16x32_bf16 a[4:7], v[56:59], v[28:31], a[4:7]
  ds_read_b64_tr_b16 v[38:39], v10 offset:36864
  ds_read_b128 v[24:27], v8 offset:26624
  v_mfma_f32_16x16x32_bf16 a[8:11], v[60:63], v[28:31], a[8:11]
  ds_read_b64_tr_b16 v[40:41], v10 offset:32776
  ds_read_b64_tr_b16 v[42:43], v10 offset:36872
  v_mfma_f32_16x16x32_bf16 a[12:15], v[64:67], v[28:31], a[12:15]
  ds_read_b64_tr_b16 v[44:45], v11 offset:32768
  ds_read_b64_tr_b16 v[46:47], v11 offset:36864
  v_mfma_f32_16x16x32_bf16 a[16:19], v[52:55], v[32:35], a[16:19]
  ds_read_b64_tr_b16 v[48:49], v11 offset:32776
  ds_read_b64_tr_b16 v[50:51], v11 offset:36872
  v_mfma_f32_16x16x32_bf16 a[20:23], v[56:59], v[32:35], a[20:23]
  v_mfma_f32_16x16x32_bf16 a[24:27], v[60:63], v[32:35], a[24:27]
  v_mfma_f32_16x16x32_bf16 a[28:31], v[64:67], v[32:35], a[28:31]
  s_waitcnt lgkmcnt(0)
  v_mfma_f32_16x16x32_bf16 a[0:3], v[36:39], v[20:23], a[0:3]
  ds_read_b128 v[28:31], v8 offset:25600
  ds_read_b64_tr_b16 v[52:53], v10 offset:40960
  v_mfma_f32_16x16x32_bf16 a[4:7], v[40:43], v[20:23], a[4:7]
  ds_read_b64_tr_b16 v[54:55], v10 offset:45056
  ds_read_b128 v[32:35], v8 offset:27648
  v_mfma_f32_16x16x32_bf16 a[8:11], v[44:47], v[20:23], a[8:11]
  ds_read_b64_tr_b16 v[56:57], v10 offset:40968
  ds_read_b64_tr_b16 v[58:59], v10 offset:45064
  v_mfma_f32_16x16x32_bf16 a[12:15], v[48:51], v[20:23], a[12:15]
  ds_read_b64_tr_b16 v[60:61], v11 offset:40960
  ds_read_b64_tr_b16 v[62:63], v11 offset:45056
  v_mfma_f32_16x16x32_bf16 a[16:19], v[36:39], v[24:27], a[16:19]
  ds_read_b64_tr_b16 v[64:65], v11 offset:40968
  ds_read_b64_tr_b16 v[66:67], v11 offset:45064
  v_mfma_f32_16x16x32_bf16 a[20:23], v[40:43], v[24:27], a[20:23]
  v_mfma_f32_16x16x32_bf16 a[24:27], v[44:47], v[24:27], a[24:27]
  v_mfma_f32_16x16x32_bf16 a[28:31], v[48:51], v[24:27], a[28:31]
  s_waitcnt lgkmcnt(0)
  s_waitcnt vmcnt(0)
  s_barrier
  v_mfma_f32_16x16x32_bf16 a[0:3], v[52:55], v[28:31], a[0:3]
  ds_read_b128 v[20:23], v8 offset:49152
  ds_read_b64_tr_b16 v[36:37], v10 offset:57344
  v_mfma_f32_16x16x32_bf16 a[4:7], v[56:59], v[28:31], a[4:7]
  ds_read_b64_tr_b16 v[38:39], v10 offset:61440
  ds_read_b128 v[24:27], v8 offset:51200
  v_mfma_f32_16x16x32_bf16 a[8:11], v[60:63], v[28:31], a[8:11]
  ds_read_b64_tr_b16 v[40:41], v10 offset:57352
  ds_read_b64_tr_b16 v[42:43], v10 offset:61448
  v_mfma_f32_16x16x32_bf16 a[12:15], v[64:67], v[28:31], a[12:15]
  ds_read_b64_tr_b16 v[44:45], v11 offset:57344
  ds_read_b64_tr_b16 v[46:47], v11 offset:61440
  v_mfma_f32_16x16x32_bf16 a[16:19], v[52:55], v[32:35], a[16:19]
  ds_read_b64_tr_b16 v[48:49], v11 offset:57352
  ds_read_b64_tr_b16 v[50:51], v11 offset:61448
  v_mfma_f32_16x16x32_bf16 a[20:23], v[56:59], v[32:35], a[20:23]
  v_mfma_f32_16x16x32_bf16 a[24:27], v[60:63], v[32:35], a[24:27]
  v_mfma_f32_16x16x32_bf16 a[28:31], v[64:67], v[32:35], a[28:31]
  s_waitcnt lgkmcnt(0)
  v_mfma_f32_16x16x32_bf16 a[0:3], v[36:39], v[20:23], a[0:3]
  ds_read_b128 v[28:31], v8 offset:50176
  ds_read_b64_tr_b16 v[52:53], v12 offset:0
  v_mfma_f32_16x16x32_bf16 a[4:7], v[40:43], v[20:23], a[4:7]
  ds_read_b64_tr_b16 v[54:55], v12 offset:4096
  ds_read_b128 v[32:35], v8 offset:52224
  v_mfma_f32_16x16x32_bf16 a[8:11], v[44:47], v[20:23], a[8:11]
  ds_read_b64_tr_b16 v[56:57], v12 offset:8
  ds_read_b64_tr_b16 v[58:59], v12 offset:4104
  v_mfma_f32_16x16x32_bf16 a[12:15], v[48:51], v[20:23], a[12:15]
  ds_read_b64_tr_b16 v[60:61], v13 offset:0
  ds_read_b64_tr_b16 v[62:63], v13 offset:4096
  v_mfma_f32_16x16x32_bf16 a[16:19], v[36:39], v[24:27], a[16:19]
  ds_read_b64_tr_b16 v[64:65], v13 offset:8
  ds_read_b64_tr_b16 v[66:67], v13 offset:4104
  v_mfma_f32_16x16x32_bf16 a[20:23], v[40:43], v[24:27], a[20:23]
  v_mfma_f32_16x16x32_bf16 a[24:27], v[44:47], v[24:27], a[24:27]
  v_mfma_f32_16x16x32_bf16 a[28:31], v[48:51], v[24:27], a[28:31]
  s_waitcnt lgkmcnt(0)
  v_mfma_f32_16x16x32_bf16 a[0:3], v[52:55], v[28:31], a[0:3]
  ds_read_b128 v[20:23], v9 offset:8192
  ds_read_b64_tr_b16 v[36:37], v12 offset:16384
  v_mfma_f32_16x16x32_bf16 a[4:7], v[56:59], v[28:31], a[4:7]
  ds_read_b64_tr_b16 v[38:39], v12 offset:20480
  ds_read_b128 v[24:27], v9 offset:10240
  v_mfma_f32_16x16x32_bf16 a[8:11], v[60:63], v[28:31], a[8:11]
  ds_read_b64_tr_b16 v[40:41], v12 offset:16392
  ds_read_b64_tr_b16 v[42:43], v12 offset:20488
  v_mfma_f32_16x16x32_bf16 a[12:15], v[64:67], v[28:31], a[12:15]
  ds_read_b64_tr_b16 v[44:45], v13 offset:16384
  ds_read_b64_tr_b16 v[46:47], v13 offset:20480
  v_mfma_f32_16x16x32_bf16 a[16:19], v[52:55], v[32:35], a[16:19]
  ds_read_b64_tr_b16 v[48:49], v13 offset:16392
  ds_read_b64_tr_b16 v[50:51], v13 offset:20488
  v_mfma_f32_16x16x32_bf16 a[20:23], v[56:59], v[32:35], a[20:23]
  v_mfma_f32_16x16x32_bf16 a[24:27], v[60:63], v[32:35], a[24:27]
  v_mfma_f32_16x16x32_bf16 a[28:31], v[64:67], v[32:35], a[28:31]
  s_waitcnt lgkmcnt(0)
  v_mfma_f32_16x16x32_bf16 a[0:3], v[36:39], v[20:23], a[0:3]
  ds_read_b128 v[28:31], v9 offset:9216
  ds_read_b64_tr_b16 v[52:53], v12 offset:24576
  v_mfma_f32_16x16x32_bf16 a[4:7], v[40:43], v[20:23], a[4:7]
  ds_read_b64_tr_b16 v[54:55], v12 offset:28672
  ds_read_b128 v[32:35], v9 offset:11264
  v_mfma_f32_16x16x32_bf16 a[8:11], v[44:47], v[20:23], a[8:11]
  ds_read_b64_tr_b16 v[56:57], v12 offset:24584
  ds_read_b64_tr_b16 v[58:59], v12 offset:28680
  v_mfma_f32_16x16x32_bf16 a[12:15], v[48:51], v[20:23], a[12:15]
  ds_read_b64_tr_b16 v[60:61], v13 offset:24576
  ds_read_b64_tr_b16 v[62:63], v13 offset:28672
  v_mfma_f32_16x16x32_bf16 a[16:19], v[36:39], v[24:27], a[16:19]
  ds_read_b64_tr_b16 v[64:65], v13 offset:24584
  ds_read_b64_tr_b16 v[66:67], v13 offset:28680
  v_mfma_f32_16x16x32_bf16 a[20:23], v[40:43], v[24:27], a[20:23]
  v_mfma_f32_16x16x32_bf16 a[24:27], v[44:47], v[24:27], a[24:27]
  v_mfma_f32_16x16x32_bf16 a[28:31], v[48:51], v[24:27], a[28:31]
  s_waitcnt lgkmcnt(0)
  v_mfma_f32_16x16x32_bf16 a[0:3], v[52:55], v[28:31], a[0:3]
  v_mfma_f32_16x16x32_bf16 a[4:7], v[56:59], v[28:31], a[4:7]
  v_mfma_f32_16x16x32_bf16 a[8:11], v[60:63], v[28:31], a[8:11]
  v_mfma_f32_16x16x32_bf16 a[12:15], v[64:67], v[28:31], a[12:15]
  v_mfma_f32_16x16x32_bf16 a[16:19], v[52:55], v[32:35], a[16:19]
  v_mfma_f32_16x16x32_bf16 a[20:23], v[56:59], v[32:35], a[20:23]
  v_mfma_f32_16x16x32_bf16 a[24:27], v[60:63], v[32:35], a[24:27]
  v_mfma_f32_16x16x32_bf16 a[28:31], v[64:67], v[32:35], a[28:31]
  s_sub_u32 s40, s36, 28
  s_lshl_b32 s40, s40, 3
  s_add_u32 s40, s40, s50
  s_lshl_b32 s41, s40, 19
  s_add_u32 s41, s41, 0x6400000
  s_lshl_b32 s90, s48, 15
  s_add_u32 s42, s41, s90
  s_lshl_b32 s90, s32, 13
  s_add_u32 s42, s42, s90
  v_lshlrev_b32 v2, 4, v1
  buffer_store_dwordx4 a[0:3], v2, s[4:7], s42 offen offset:0 sc1
  buffer_store_dwordx4 a[4:7], v2, s[4:7], s42 offen offset:1024 sc1
  buffer_store_dwordx4 a[8:11], v2, s[4:7], s42 offen offset:2048 sc1
  buffer_store_dwordx4 a[12:15], v2, s[4:7], s42 offen offset:3072 sc1
  s_add_u32 s42, s42, 4096
  buffer_store_dwordx4 a[16:19], v2, s[4:7], s42 offen offset:0 sc1
  buffer_store_dwordx4 a[20:23], v2, s[4:7], s42 offen offset:1024 sc1
  buffer_store_dwordx4 a[24:27], v2, s[4:7], s42 offen offset:2048 sc1
  buffer_store_dwordx4 a[28:31], v2, s[4:7], s42 offen offset:3072 sc1
  s_lshl_b32 s40, s40, 7
  s_add_u32 s43, s40, 0x3d04000
  s_waitcnt vmcnt(0)
  s_barrier
  s_cmp_lg_u32 s32, 0
  s_cbranch_scc1 L_sig_35
  v_mov_b32 v254, 1
  v_mov_b32 v255, 0
  s_mov_b64 exec, 1
  buffer_atomic_add v254, v255, s[4:7], s43 offen offset:0 sc1
  s_mov_b64 exec, -1
L_sig_35:
  s_cmp_lg_u32 s32, 0
  s_cbranch_scc1 L_dd_37
  v_mov_b32 v228, 0x3d00000
  v_mov_b32 v232, 0x3d04000
L_dw_36:
  buffer_load_dword v234, v232, s[4:7], s40 offen offset:0 sc1
  s_waitcnt vmcnt(0)
  s_mov_b32 s44, 1
  v_readfirstlane_b32 s45, v234
  s_cmp_ge_u32 s45, 16
  s_cselect_b32 s44, s44, 0
  s_cmp_eq_u32 s44, 1
  s_cbranch_scc1 L_dd_37
  s_sleep 1
  s_add_u32 s3, s3, 1
  s_cmp_lt_u32 s3, 131072
  s_cbranch_scc1 L_dw_36
L_dd_37:
  s_barrier
  s_cmp_lg_u32 s32, 0
  s_cbranch_scc1 L_rq_38
  s_cmp_eq_u32 s39, 0
  s_cbranch_scc1 L_rq_38
  s_lshl_b32 s99, s33, 7
  s_add_u32 s99, s99, 0x3d00200
  v_mov_b32 v244, 1
  v_mov_b32 v245, 0
  s_mov_b64 exec, 1
  buffer_atomic_add v244, v245, s[4:7], s99 offen sc0 sc1
  s_mov_b64 exec, -1
L_rq_38:
  s_lshl_b32 s90, s48, 11
  s_add_u32 s41, s41, s90
  s_lshl_b32 s90, s32, 17
  s_add_u32 s41, s41, s90
  buffer_load_dwordx4 v[16:19], v2, s[4:7], s41 offen offset:0 sc1
  buffer_load_dwordx4 v[20:23], v2, s[4:7], s41 offen offset:1024 sc1
  s_add_u32 s41, s41, 0x8000
  buffer_load_dwordx4 v[24:27], v2, s[4:7], s41 offen offset:0 sc1
  buffer_load_dwordx4 v[28:31], v2, s[4:7], s41 offen offset:1024 sc1
  s_add_u32 s41, s41, 0x8000
  buffer_load_dwordx4 v[32:35], v2, s[4:7], s41 offen offset:0 sc1
  buffer_load_dwordx4 v[36:39], v2, s[4:7], s41 offen offset:1024 sc1
  s_add_u32 s41, s41, 0x8000
  buffer_load_dwordx4 v[40:43], v2, s[4:7], s41 offen offset:0 sc1
  buffer_load_dwordx4 v[44:47], v2, s[4:7], s41 offen offset:1024 sc1
  s_add_u32 s41, s41, 0x8000
  v_mov_b32 v3, 0x0
  v_bfe_u32 v4, v1, 0, 4
  v_lshl_add_u32 v3, v4, 12, v3
  v_bfe_u32 v4, v1, 4, 2
  v_lshl_add_u32 v3, v4, 4, v3
  s_lshr_b32 s90, s48, 3
  s_and_b32 s90, s90, 1
  s_lshl_b32 s90, s90, 17
  s_add_u32 s22, s22, s90
  s_lshr_b32 s90, s48, 2
  s_and_b32 s90, s90, 1
  s_lshl_b32 s90, s90, 7
  s_add_u32 s22, s22, s90
  s_lshr_b32 s90, s48, 1
  s_and_b32 s90, s90, 1
  s_lshl_b32 s90, s90, 16
  s_add_u32 s22, s22, s90
  s_lshr_b32 s90, s48, 0
  s_and_b32 s90, s90, 1
  s_lshl_b32 s90, s90, 6
  s_add_u32 s22, s22, s90
  s_lshl_b32 s90, s32, 11
  v_add_u32 v5, s90, v2
  s_waitcnt vmcnt(4)
  v_pk_add_f32 v[16:17], v[16:17], v[24:25]
  v_pk_add_f32 v[18:19], v[18:19], v[26:27]
  v_pk_add_f32 v[20:21], v[20:21], v[28:29]
  v_pk_add_f32 v[22:23], v[22:23], v[30:31]
  s_waitcnt vmcnt(2)
  v_pk_add_f32 v[16:17], v[16:17], v[32:33]
  v_pk_add_f32 v[18:19], v[18:19], v[34:35]
  v_pk_add_f32 v[20:21], v[20:21], v[36:37]
  v_pk_add_f32 v[22:23], v[22:23], v[38:39]
  s_waitcnt vmcnt(0)
  v_pk_add_f32 v[16:17], v[16:17], v[40:41]
  v_pk_add_f32 v[18:19], v[18:19], v[42:43]
  v_pk_add_f32 v[20:21], v[20:21], v[44:45]
  v_pk_add_f32 v[22:23], v[22:23], v[46:47]
  ds_write_b128 v5, v[16:19]
  ds_write_b128 v5, v[20:23] offset:1024
  s_waitcnt lgkmcnt(0)
  s_barrier
  s_cmp_lg_u32 s32, 0
  s_cbranch_scc1 L_aofd
  ds_read_b128 v[24:27], v2 offset:2048
  ds_read_b128 v[28:31], v2 offset:3072
  ds_read_b128 v[32:35], v2 offset:4096
  ds_read_b128 v[36:39], v2 offset:5120
  ds_read_b128 v[40:43], v2 offset:6144
  ds_read_b128 v[44:47], v2 offset:7168
  s_waitcnt lgkmcnt(0)
  v_pk_add_f32 v[16:17], v[16:17], v[24:25]
  v_pk_add_f32 v[18:19], v[18:19], v[26:27]
  v_pk_add_f32 v[20:21], v[20:21], v[28:29]
  v_pk_add_f32 v[22:23], v[22:23], v[30:31]
  v_pk_add_f32 v[16:17], v[16:17], v[32:33]
  v_pk_add_f32 v[18:19], v[18:19], v[34:35]
  v_pk_add_f32 v[20:21], v[20:21], v[36:37]
  v_pk_add_f32 v[22:23], v[22:23], v[38:39]
  v_pk_add_f32 v[16:17], v[16:17], v[40:41]
  v_pk_add_f32 v[18:19], v[18:19], v[42:43]
  v_pk_add_f32 v[20:21], v[20:21], v[44:45]
  v_pk_add_f32 v[22:23], v[22:23], v[46:47]
  v_cvt_pk_bf16_f32 v8, v16, v17
  v_cvt_pk_bf16_f32 v9, v18, v19
  v_cvt_pk_bf16_f32 v10, v20, v21
  v_cvt_pk_bf16_f32 v11, v22, v23
  buffer_store_dwordx4 v[8:11], v3, s[16:19], s22 offen
L_aofd:
  s_branch L_got
L_done:
  s_waitcnt vmcnt(0)
  s_barrier
  s_add_u32 s38, s38, 0x3d00000
  s_cmp_lg_u32 s32, 0
  s_cbranch_scc1 L_sig_39
  v_mov_b32 v254, s98
  v_mov_b32 v255, 0
  s_mov_b64 exec, 1
  buffer_atomic_add v254, v255, s[4:7], s38 offen offset:0 sc1
  s_mov_b64 exec, -1
L_sig_39:
  s_mov_b32 s59, 0
  s_branch L_got
L_exit:
  s_endpgm
.p2align 2
L_table:
.long 0x9
.long 0xa
.long 0x10009
.long 0x1000a
.long 0x20009
.long 0x2000a
.long 0x30009
.long 0x3000a
.long 0x40009
.long 0x4000a
.long 0x50009
.long 0x5000a
.long 0x60009
.long 0x6000a
.long 0x70009
.long 0x7000a
.long 0x109
.long 0x10a
.long 0x10109
.long 0x1010a
.long 0x20109
.long 0x2010a
.long 0x30109
.long 0x3010a
.long 0x40109
.long 0x4010a
.long 0x50109
.long 0x5010a
.long 0x60109
.long 0x6010a
.long 0x70109
.long 0x7010a
.long 0x209
.long 0x20a
.long 0x10209
.long 0x1020a
.long 0x20209
.long 0x2020a
.long 0x30209
.long 0x3020a
.long 0x40209
.long 0x4020a
.long 0x50209
.long 0x5020a
.long 0x60209
.long 0x6020a
.long 0x70209
.long 0x7020a
.long 0x201
.long 0x202
.long 0x10201
.long 0x10202
.long 0x20201
.long 0x20202
.long 0x30201
.long 0x30202
.long 0x301
.long 0x302
.long 0x10301
.long 0x10302
.long 0x20301
.long 0x20302
.long 0x30301
.long 0x30302
.long 0x309
.long 0x30a
.long 0x10309
.long 0x1030a
.long 0x20309
.long 0x2030a
.long 0x30309
.long 0x3030a
.long 0x40309
.long 0x4030a
.long 0x50309
.long 0x5030a
.long 0x60309
.long 0x6030a
.long 0x70309
.long 0x7030a
.long 0xc
.long 0x10c
.long 0x20c
.long 0x30c
.long 0x0
.long 0x10000
.long 0x20000
.long 0x30000
.long 0x100
.long 0x10100
.long 0x20100
.long 0x30100
.long 0x200
.long 0x10200
.long 0x20200
.long 0x30200
.long 0x401
.long 0x402
.long 0x10401
.long 0x10402
.long 0x20401
.long 0x20402
.long 0x30401
.long 0x30402
.long 0x501
.long 0x502
.long 0x10501
.long 0x10502
.long 0x20501
.long 0x20502
.long 0x30501
.long 0x30502
.long 0x300
.long 0x10300
.long 0x20300
.long 0x30300
.long 0x3
.long 0x10003
.long 0x20003
.long 0x103
.long 0x10103
.long 0x20103
.long 0x203
.long 0x10203
.long 0x20203
.long 0x303
.long 0x10303
.long 0x20303
.long 0x400
.long 0x10400
.long 0x20400
.long 0x30400
.long 0x500
.long 0x10500
.long 0x20500
.long 0x30500
.long 0x600
.long 0x10600
.long 0x20600
.long 0x30600
.long 0x700
.long 0x10700
.long 0x20700
.long 0x30700
.long 0xb
.long 0x1000b
.long 0x40b
.long 0x1040b
.long 0x403
.long 0x10403
.long 0x20403
.long 0x503
.long 0x10503
.long 0x20503
.long 0x603
.long 0x10603
.long 0x20603
.long 0x703
.long 0x10703
.long 0x20703
.long 0x601
.long 0x602
.long 0x10601
.long 0x10602
.long 0x20601
.long 0x20602
.long 0x30601
.long 0x30602
.long 0x701
.long 0x702
.long 0x10701
.long 0x10702
.long 0x20701
.long 0x20702
.long 0x30701
.long 0x30702
.long 0x80b
.long 0x1080b
.long 0xc0b
.long 0x10c0b
.long 0x100b
.long 0x1100b
.long 0x140b
.long 0x1140b
.long 0x180b
.long 0x1180b
.long 0x1c0b
.long 0x11c0b
.long 0x200b
.long 0x1200b
.long 0x240b
.long 0x1240b
.long 0x4
.long 0x10004
.long 0x20004
.long 0x30004
.long 0x104
.long 0x10104
.long 0x20104
.long 0x30104
.long 0x204
.long 0x10204
.long 0x20204
.long 0x30204
.long 0x304
.long 0x10304
.long 0x20304
.long 0x30304
.long 0x404
.long 0x10404
.long 0x20404
.long 0x30404
.long 0x504
.long 0x10504
.long 0x20504
.long 0x30504
.long 0x604
.long 0x10604
.long 0x20604
.long 0x30604
.long 0x280b
.long 0x1280b
.long 0x704
.long 0x10704
.long 0x20704
.long 0x30704
.long 0x5
.long 0x10005
.long 0x105
.long 0x10105
.long 0x205
.long 0x10205
.long 0x305
.long 0x10305
.long 0x405
.long 0x10405
.long 0x7
.long 0x10007
.long 0x107
.long 0x10107
.long 0x207
.long 0x10207
.long 0x307
.long 0x10307
.long 0x407
.long 0x10407
.long 0x507
.long 0x10507
.long 0x607
.long 0x10607
.long 0x707
.long 0x10707
.long 0x807
.long 0x10807
.long 0x907
.long 0x10907
.long 0x2c0b
.long 0x12c0b
.long 0x505
.long 0x10505
.long 0x605
.long 0x10605
.long 0x705
.long 0x10705
.long 0x805
.long 0x10805
.long 0x3006
.long 0x13006
.long 0x3106
.long 0x13106
.long 0x3206
.long 0x13206
.long 0x3306
.long 0x13306
.long 0xa07
.long 0x10a07
.long 0x905
.long 0x10905
.long 0x3406
.long 0x13406
.long 0xb07
.long 0x10b07
.long 0xc07
.long 0x10c07
.long 0x3506
.long 0x13506
.long 0x3606
.long 0x13606
.long 0x3706
.long 0x13706
.long 0xa05
.long 0x10a05
.long 0x3806
.long 0x13806
.long 0xd08
.long 0x10d08
.long 0x20d08
.long 0x30d08
.long 0x40d08
.long 0x50d08
.long 0x60d08
.long 0x70d08
.long 0x80d08
.long 0x90d08
.long 0xa0d08
.long 0xb0d08
.long 0xc0d08
.long 0xd0d08
.long 0xe0d08
.long 0xf0d08
.long 0xb05
.long 0x10b05
.long 0xc05
.long 0x10c05
.long 0x3906
.long 0x13906
.long 0x3a06
.long 0x13a06
.long 0x3b06
.long 0x13b06
.long 0x3c06
.long 0x13c06
.long 0x3d06
.long 0x13d06
.long 0x3e06
.long 0x13e06
.long 0x3f06
.long 0x13f06
.long 0xe08
.long 0x10e08
.long 0x20e08
.long 0x30e08
.long 0x40e08
.long 0x50e08
.long 0x60e08
.long 0x70e08
.long 0x80e08
.long 0x90e08
.long 0xa0e08
.long 0xb0e08
.long 0xc0e08
.long 0xd0e08
.long 0xe0e08
.long 0xf0e08
.long 0xd05
.long 0x10d05
.long 0xe05
.long 0x10e05
.long 0xf05
.long 0x10f05
.long 0xf08
.long 0x10f08
.long 0x20f08
.long 0x30f08
.long 0x40f08
.long 0x50f08
.long 0x60f08
.long 0x70f08
.long 0x80f08
.long 0x90f08
.long 0xa0f08
.long 0xb0f08
.long 0xc0f08
.long 0xd0f08
.long 0xe0f08
.long 0xf0f08
.long 0xf
.long 0x0
.long 0x0
.long 0x0
.section .rodata,"a"
.p2align 6
.amdhsa_kernel concat_heads__memory_aug_recurrent_mem_tr__sliding_local_dilated__prompt_kernel
  .amdhsa_next_free_vgpr 512
  .amdhsa_next_free_sgpr 102
  .amdhsa_accum_offset 256
  .amdhsa_group_segment_fixed_size 0
  .amdhsa_kernarg_size 104
  .amdhsa_user_sgpr_count 2
  .amdhsa_user_sgpr_kernarg_segment_ptr 1
  .amdhsa_system_sgpr_workgroup_id_x 1
  .amdhsa_float_denorm_mode_32 3
  .amdhsa_float_denorm_mode_16_64 3
.end_amdhsa_kernel
```

```asm
; @launch grid=(256,1,1) block=(256,1,1) lds=133184
.amdgcn_target "amdgcn-amd-amdhsa--gfx950"
.text
.globl concat_heads__memory_aug_recurrent_mem_tr__sliding_local_dilated__prompt_kernel
.p2align 8
.type concat_heads__memory_aug_recurrent_mem_tr__sliding_local_dilated__prompt_kernel,@function
concat_heads__memory_aug_recurrent_mem_tr__sliding_local_dilated__prompt_kernel:
  s_cmp_ge_u32 s2, 256
  s_cbranch_scc1 L_exit
  s_load_dwordx4 s[92:95], s[0:1], 88
  s_load_dwordx16 s[64:79], s[0:1], 0
  s_getreg_b32 s39, hwreg(HW_REG_XCC_ID, 0, 3)
  v_lshrrev_b32 v2, 6, v0
  s_nop 0
  v_readfirstlane_b32 s32, v2
  s_mov_b32 s3, 0
  s_getpc_b64 s[86:87]
L_pc0:
  s_lshr_b32 s90, s2, 3
  s_lshl_b32 s90, s90, 2
  s_add_u32 s90, s90, s32
  s_and_b32 s90, s90, 31
  s_lshl_b32 s90, s90, 12
  v_and_b32 v1, 63, v0
  v_lshlrev_b32 v1, 6, v1
  v_add_u32 v1, s90, v1
  v_min_u32 v1, L_table-L_pc0, v1
  global_load_dword v199, v1, s[86:87]
  v_lshlrev_b32 v1, 3, v0
  v_add_u32 v1, L_table-L_pc0, v1
  global_load_dwordx2 v[248:249], v1, s[86:87]
  s_waitcnt lgkmcnt(0)
  s_mov_b32 s4, s94
  s_and_b32 s5, s95, 0xffff
  s_mov_b32 s6, 0x10000000
  s_mov_b32 s7, 0x20000
  s_mov_b32 s28, s92
  s_and_b32 s29, s93, 0xffff
  s_mov_b32 s30, 0x100
  s_mov_b32 s31, 0x20000
  s_mov_b32 s100, 0
  s_lshr_b32 s41, s2, 3
  s_lshl_b32 s101, 1, s41
  s_cmp_lg_u32 s32, 0
  s_cbranch_scc1 L_sweep
  s_lshl_b32 s90, s39, 2
  v_mov_b32 v247, s101
  v_mov_b32 v2, 0
  s_mov_b64 exec, 1
  buffer_atomic_or v247, v2, s[28:31], s90 offen offset:0 sc0 sc1
  s_mov_b64 exec, -1
L_sweep:
  s_lshl_b32 s40, s39, 5
  s_add_u32 s40, s40, s41
  s_mov_b32 s43, 1
  s_branch L_role
L_fallback:
  s_load_dwordx4 s[92:95], s[0:1], 88
  s_load_dwordx16 s[64:79], s[0:1], 0
  s_getreg_b32 s39, hwreg(HW_REG_XCC_ID, 0, 3)
  s_mov_b32 s100, 4
  v_mbcnt_lo_u32_b32 v0, -1, 0
  v_mbcnt_hi_u32_b32 v0, -1, v0
  s_lshl_b32 s90, s32, 6
  v_add_u32 v0, s90, v0
  s_waitcnt vmcnt(0) lgkmcnt(0)
  s_barrier
  s_cmp_lg_u32 s32, 0
  s_cbranch_scc1 L_tkd
  s_lshl_b32 s90, s39, 2
  v_mov_b32 v1, 1
  v_mov_b32 v2, 0
  v_lshlrev_b32 v3, 2, v0
  s_mov_b64 exec, 1
  buffer_atomic_add v1, v2, s[28:31], s90 offen offset:192 sc0 sc1
  s_mov_b64 exec, 0xff
L_tkw:
  buffer_load_dword v4, v3, s[28:31], 0 offen offset:192 sc1
  s_waitcnt vmcnt(0)
  v_readfirstlane_b32 s40, v1
  s_mov_b32 s41, 0
  s_mov_b32 s42, 0
  s_mov_b32 s43, 1
  v_readlane_b32 s44, v4, 0
  s_add_u32 s41, s41, s44
  s_cmp_gt_u32 s39, 0
  s_cselect_b32 s45, s44, 0
  s_add_u32 s42, s42, s45
  s_cmp_eq_u32 s44, 32
  s_cselect_b32 s43, s43, 0
  v_readlane_b32 s44, v4, 1
  s_add_u32 s41, s41, s44
  s_cmp_gt_u32 s39, 1
  s_cselect_b32 s45, s44, 0
  s_add_u32 s42, s42, s45
  s_cmp_eq_u32 s44, 32
  s_cselect_b32 s43, s43, 0
  v_readlane_b32 s44, v4, 2
  s_add_u32 s41, s41, s44
  s_cmp_gt_u32 s39, 2
  s_cselect_b32 s45, s44, 0
  s_add_u32 s42, s42, s45
  s_cmp_eq_u32 s44, 32
  s_cselect_b32 s43, s43, 0
  v_readlane_b32 s44, v4, 3
  s_add_u32 s41, s41, s44
  s_cmp_gt_u32 s39, 3
  s_cselect_b32 s45, s44, 0
  s_add_u32 s42, s42, s45
  s_cmp_eq_u32 s44, 32
  s_cselect_b32 s43, s43, 0
  v_readlane_b32 s44, v4, 4
  s_add_u32 s41, s41, s44
  s_cmp_gt_u32 s39, 4
  s_cselect_b32 s45, s44, 0
  s_add_u32 s42, s42, s45
  v_readlane_b32 s44, v4, 5
  s_add_u32 s41, s41, s44
  s_cmp_gt_u32 s39, 5
  s_cselect_b32 s45, s44, 0
  s_add_u32 s42, s42, s45
  v_readlane_b32 s44, v4, 6
  s_add_u32 s41, s41, s44
  s_cmp_gt_u32 s39, 6
  s_cselect_b32 s45, s44, 0
  s_add_u32 s42, s42, s45
  v_readlane_b32 s44, v4, 7
  s_add_u32 s41, s41, s44
  s_cmp_gt_u32 s39, 7
  s_cselect_b32 s45, s44, 0
  s_add_u32 s42, s42, s45
  s_add_u32 s3, s3, 1
  s_cmp_ge_u32 s3, 131072
  s_cbranch_scc1 L_tkbad
  s_sleep 4
  s_cmp_lt_u32 s41, 256
  s_cbranch_scc1 L_tkw
  s_add_u32 s40, s40, s42
  s_lshl_b32 s43, s43, 16
  s_or_b32 s40, s40, s43
  s_branch L_tkok
L_tkbad:
  s_mov_b32 s40, 0xffff
L_tkok:
  s_mov_b64 exec, -1
  v_mov_b32 v1, s40
  v_mov_b32 v2, 131072
  ds_write_b32 v2, v1
  s_waitcnt lgkmcnt(0)
L_tkd:
  s_barrier
  v_mov_b32 v2, 131072
  ds_read_b32 v1, v2
  s_waitcnt lgkmcnt(0)
  v_readfirstlane_b32 s40, v1
  s_barrier
  s_lshr_b32 s43, s40, 16
  s_and_b32 s40, s40, 0xffff
  s_cmp_ge_u32 s40, 256
  s_cbranch_scc1 L_exit
L_role:
  s_cmp_ge_u32 s40, 128
  s_cbranch_scc1 L_worker
  s_lshr_b32 s33, s40, 5
  s_and_b32 s34, s40, 31
  s_cmp_eq_u32 s43, 0
  s_cbranch_scc1 L_recslow
  s_load_dwordx4 s[80:83], s[0:1], 8
  s_load_dwordx4 s[84:87], s[0:1], 24
  s_load_dwordx2 s[88:89], s[0:1], 40
  v_lshrrev_b32 v31, 6, v0
  s_nop 0
  v_readfirstlane_b32 s32, v31
  v_and_b32 v0, 63, v0
  s_lshr_b32 s35, s34, 4
  s_lshl_b32 s90, s33, 1
  s_add_u32 s35, s35, s90
  s_and_b32 s36, s34, 15
  s_lshr_b32 s37, s36, 2
  s_lshl_b32 s90, s35, 2
  s_add_u32 s37, s37, s90
  s_and_b32 s38, s36, 3
  s_waitcnt lgkmcnt(0)
  s_mov_b32 s24, s80
  s_and_b32 s25, s81, 0xffff
  s_mov_b32 s26, 0x4000
  s_mov_b32 s27, 0x20000
  s_mov_b32 s8, s82
  s_and_b32 s9, s83, 0xffff
  s_mov_b32 s10, 0x800000
  s_mov_b32 s11, 0x20000
  s_mov_b32 s12, s84
  s_and_b32 s13, s85, 0xffff
  s_mov_b32 s14, 0x800000
  s_mov_b32 s15, 0x20000
  s_mov_b32 s16, s86
  s_and_b32 s17, s87, 0xffff
  s_mov_b32 s18, 0x800000
  s_mov_b32 s19, 0x20000
  s_mov_b32 s20, s88
  s_and_b32 s21, s89, 0xffff
  s_mov_b32 s22, 0x800000
  s_mov_b32 s23, 0x20000
  s_lshl_b32 s90, s32, 21
  s_lshl_b32 s91, s37, 8
  s_add_u32 s90, s90, s91
  s_lshr_b32 s91, s38, 1
  s_lshl_b32 s91, s91, 7
  s_add_u32 s90, s90, s91
  v_mov_b32 v180, 0x0
  v_bfe_u32 v31, v0, 3, 3
  v_lshl_add_u32 v180, v31, 13, v180
  v_bfe_u32 v31, v0, 0, 3
  v_lshl_add_u32 v180, v31, 4, v180
  v_add_u32 v180, s90, v180
  v_xor_b32 v185, 128, v180
  s_lshl_b32 s90, s35, 2
  s_add_u32 s90, s90, s32
  s_lshl_b32 s90, s90, 18
  s_lshl_b32 s91, s36, 7
  s_add_u32 s90, s90, s91
  v_mov_b32 v181, 0x0
  v_bfe_u32 v31, v0, 3, 3
  v_lshl_add_u32 v181, v31, 11, v181
  v_bfe_u32 v31, v0, 0, 3
  v_lshl_add_u32 v181, v31, 4, v181
  v_add_u32 v181, s90, v181
  s_lshl_b32 s96, s32, 15
  s_and_b32 s91, s38, 1
  s_lshl_b32 s91, s91, 6
  s_add_u32 s91, s91, s96
  v_mov_b32 v182, 0x0
  v_bfe_u32 v31, v0, 5, 1
  v_lshl_add_u32 v182, v31, 11, v182
  v_bfe_u32 v31, v0, 4, 1
  v_lshl_add_u32 v182, v31, 10, v182
  v_bfe_u32 v31, v0, 2, 2
  v_lshl_add_u32 v182, v31, 7, v182
  v_bfe_u32 v31, v0, 0, 2
  v_lshl_add_u32 v182, v31, 3, v182
  v_add_u32 v182, s91, v182
  s_lshl_b32 s91, s32, 5
  v_mov_b32 v183, 0x0
  v_bfe_u32 v31, v0, 4, 1
  v_lshl_add_u32 v183, v31, 13, v183
  v_bfe_u32 v31, v0, 5, 1
  v_lshl_add_u32 v183, v31, 8, v183
  v_bfe_u32 v31, v0, 2, 1
  v_lshl_add_u32 v183, v31, 10, v183
  v_bfe_u32 v31, v0, 3, 1
  v_lshl_add_u32 v183, v31, 7, v183
  v_bfe_u32 v31, v0, 0, 2
  v_lshl_add_u32 v183, v31, 3, v183
  v_add_u32 v183, s91, v183
  v_add_u32 v184, 0x10000, v183
  s_lshl_b32 s97, s34, 2
  s_add_u32 s97, s97, s32
  s_lshl_b32 s98, s97, 14
  s_lshl_b32 s91, s33, 21
  s_add_u32 s98, s98, s91
  s_lshl_b32 s97, s97, 16
  s_lshl_b32 s91, s33, 11
  s_add_u32 s97, s97, s91
  v_mov_b32 v16, 0x0
  v_bfe_u32 v31, v0, 0, 4
  v_lshl_add_u32 v16, v31, 7, v16
  v_bfe_u32 v31, v0, 4, 2
  v_lshl_add_u32 v16, v31, 13, v16
  v_add_u32 v17, 0x8000, v16
  v_lshlrev_b32 v18, 7, v0
  v_add_u32 v19, 0x2000, v18
  s_lshl_b32 s97, s34, 2
  s_add_u32 s97, s97, s32
  s_lshl_b32 s98, s97, 14
  s_lshl_b32 s91, s33, 21
  s_add_u32 s98, s98, s91
  s_lshl_b32 s97, s97, 16
  s_lshl_b32 s91, s33, 11
  s_add_u32 s97, s97, s91
  v_mov_b32 v16, 0x180
  v_bfe_u32 v31, v0, 0, 1
  v_lshl_add_u32 v16, v31, 10, v16
  v_bfe_u32 v31, v0, 1, 3
  v_lshl_add_u32 v16, v31, 13, v16
  v_mov_b32 v17, 0x180
  v_bfe_u32 v31, v0, 0, 4
  v_lshl_add_u32 v17, v31, 10, v17
  s_mov_b64 exec, 0xffff
  buffer_load_dword v201, v16, s[12:15], s97 offen
  buffer_load_dword v202, v16, s[16:19], s97 offen
  buffer_load_dword v200, v16, s[8:11], s97 offen
  buffer_load_dword v203, v17, s[20:23], s98 offen
  s_mov_b64 exec, -1
  s_lshl_b32 s58, s33, 5
  s_add_u32 s58, s58, s34
  s_lshl_b32 s59, s32, 19
  s_add_u32 s59, s59, 0x3800000
  s_lshl_b32 s90, s58, 11
  s_add_u32 s90, s90, s59
  s_mul_i32 s91, s58, 3072
  s_add_u32 s91, s91, s59
  s_add_u32 s91, s91, 0x200000
  v_lshlrev_b32 v6, 4, v0
  v_mov_b32 v8, -1
  v_mov_b32 v12, 0
  v_mov_b32 v9, -1
  v_mov_b32 v13, 0
  v_mov_b32 v10, -1
  v_mov_b32 v14, 0
  v_mov_b32 v11, -1
  v_mov_b32 v15, 0
  buffer_store_dwordx4 v[8:11], v6, s[4:7], s90 offen offset:0 sc1
  buffer_store_dwordx4 v[8:11], v6, s[4:7], s90 offen offset:1024 sc1
  buffer_store_dwordx4 v[8:11], v6, s[4:7], s91 offen offset:0 sc1
  buffer_store_dwordx4 v[8:11], v6, s[4:7], s91 offen offset:1024 sc1
  buffer_store_dwordx4 v[8:11], v6, s[4:7], s91 offen offset:2048 sc1
  s_lshl_b32 s58, s58, 2
  s_add_u32 s58, s58, s32
  s_cmp_ge_u32 s58, 36
  s_cbranch_scc1 FL_nz_1
  s_lshl_b32 s90, s58, 10
  s_add_u32 s90, s90, 0x3d00000
  buffer_store_dwordx4 v[12:15], v6, s[4:7], s90 offen sc1
FL_nz_1:
  s_cmp_lg_u32 s58, 3
  s_cbranch_scc1 FL_np_2
  v_mov_b32 v6, 0x3840000
  v_bfe_u32 v31, v0, 0, 1
  v_lshl_add_u32 v6, v31, 13, v6
  v_bfe_u32 v31, v0, 1, 1
  s_mov_b32 s99, 4352
  v_mad_u32_u24 v6, v31, s99, v6
  v_bfe_u32 v31, v0, 2, 2
  s_mov_b32 s99, 82432
  v_mad_u32_u24 v6, v31, s99, v6
  v_mov_b32 v7, -1
  s_mov_b64 exec, 0xffff
  buffer_store_dword v7, v6, s[4:7], 0 offen sc1
  s_mov_b64 exec, -1
  s_waitcnt vmcnt(0)
FL_np_2:
  s_add_u32 m0, s96, 0
  s_mov_b32 s90, 0x0
  buffer_load_dwordx4 v180, s[12:15], s90 offen  lds
  s_add_u32 m0, s96, 1024
  s_mov_b32 s90, 0x10000
  buffer_load_dwordx4 v180, s[12:15], s90 offen  lds
  s_add_u32 m0, s96, 2048
  s_mov_b32 s90, 0x20000
  buffer_load_dwordx4 v180, s[12:15], s90 offen  lds
  s_add_u32 m0, s96, 3072
  s_mov_b32 s90, 0x30000
  buffer_load_dwordx4 v180, s[12:15], s90 offen  lds
  s_add_u32 m0, s96, 4096
  s_mov_b32 s90, 0x0
  buffer_load_dwordx4 v185, s[16:19], s90 offen  lds
  s_add_u32 m0, s96, 5120
  s_mov_b32 s90, 0x10000
  buffer_load_dwordx4 v185, s[16:19], s90 offen  lds
  s_add_u32 m0, s96, 6144
  s_mov_b32 s90, 0x20000
  buffer_load_dwordx4 v185, s[16:19], s90 offen  lds
  s_add_u32 m0, s96, 7168
  s_mov_b32 s90, 0x30000
  buffer_load_dwordx4 v185, s[16:19], s90 offen  lds
  s_add_u32 m0, s96, 8192
  s_mov_b32 s90, 0x40000
  buffer_load_dwordx4 v180, s[12:15], s90 offen  lds
  s_add_u32 m0, s96, 9216
  s_mov_b32 s90, 0x50000
  buffer_load_dwordx4 v180, s[12:15], s90 offen  lds
  s_add_u32 m0, s96, 10240
  s_mov_b32 s90, 0x60000
  buffer_load_dwordx4 v180, s[12:15], s90 offen  lds
  s_add_u32 m0, s96, 11264
  s_mov_b32 s90, 0x70000
  buffer_load_dwordx4 v180, s[12:15], s90 offen  lds
  s_add_u32 m0, s96, 12288
  s_mov_b32 s90, 0x40000
  buffer_load_dwordx4 v185, s[16:19], s90 offen  lds
  s_add_u32 m0, s96, 13312
  s_mov_b32 s90, 0x50000
  buffer_load_dwordx4 v185, s[16:19], s90 offen  lds
  s_add_u32 m0, s96, 14336
  s_mov_b32 s90, 0x60000
  buffer_load_dwordx4 v185, s[16:19], s90 offen  lds
  s_add_u32 m0, s96, 15360
  s_mov_b32 s90, 0x70000
  buffer_load_dwordx4 v185, s[16:19], s90 offen  lds
  s_add_u32 m0, s96, 16384
  s_mov_b32 s90, 0x80000
  buffer_load_dwordx4 v180, s[12:15], s90 offen  lds
  s_add_u32 m0, s96, 17408
  s_mov_b32 s90, 0x90000
  buffer_load_dwordx4 v180, s[12:15], s90 offen  lds
  s_add_u32 m0, s96, 18432
  s_mov_b32 s90, 0xa0000
  buffer_load_dwordx4 v180, s[12:15], s90 offen  lds
  s_add_u32 m0, s96, 19456
  s_mov_b32 s90, 0xb0000
  buffer_load_dwordx4 v180, s[12:15], s90 offen  lds
  s_add_u32 m0, s96, 20480
  s_mov_b32 s90, 0x80000
  buffer_load_dwordx4 v185, s[16:19], s90 offen  lds
  s_add_u32 m0, s96, 21504
  s_mov_b32 s90, 0x90000
  buffer_load_dwordx4 v185, s[16:19], s90 offen  lds
  s_add_u32 m0, s96, 22528
  s_mov_b32 s90, 0xa0000
  buffer_load_dwordx4 v185, s[16:19], s90 offen  lds
  s_add_u32 m0, s96, 23552
  s_mov_b32 s90, 0xb0000
  buffer_load_dwordx4 v185, s[16:19], s90 offen  lds
  s_add_u32 m0, s96, 24576
  s_mov_b32 s90, 0xc0000
  buffer_load_dwordx4 v180, s[12:15], s90 offen  lds
  s_add_u32 m0, s96, 25600
  s_mov_b32 s90, 0xd0000
  buffer_load_dwordx4 v180, s[12:15], s90 offen  lds
  s_add_u32 m0, s96, 26624
  s_mov_b32 s90, 0xe0000
  buffer_load_dwordx4 v180, s[12:15], s90 offen  lds
  s_add_u32 m0, s96, 27648
  s_mov_b32 s90, 0xf0000
  buffer_load_dwordx4 v180, s[12:15], s90 offen  lds
  s_add_u32 m0, s96, 28672
  s_mov_b32 s90, 0xc0000
  buffer_load_dwordx4 v185, s[16:19], s90 offen  lds
  s_add_u32 m0, s96, 29696
  s_mov_b32 s90, 0xd0000
  buffer_load_dwordx4 v185, s[16:19], s90 offen  lds
  s_add_u32 m0, s96, 30720
  s_mov_b32 s90, 0xe0000
  buffer_load_dwordx4 v185, s[16:19], s90 offen  lds
  s_add_u32 m0, s96, 31744
  s_mov_b32 s90, 0xf0000
  buffer_load_dwordx4 v185, s[16:19], s90 offen  lds
  s_cmp_lg_u32 s58, 3
  s_cbranch_scc1 FL_np_3
  s_add_u32 s92, s94, 0x3840000
  s_addc_u32 s93, s95, 0
  s_mov_b32 s62, -1
  s_mov_b32 s63, -1
  s_memtime s[56:57]
  s_waitcnt lgkmcnt(0)
  s_load_dword s60, s[92:93], 0x0
  s_waitcnt lgkmcnt(0)
  s_memtime s[58:59]
  s_waitcnt lgkmcnt(0)
  s_sub_u32 s58, s58, s56
  s_min_u32 s62, s62, s58
  s_memtime s[56:57]
  s_waitcnt lgkmcnt(0)
  s_load_dword s60, s[92:93], 0x2000
  s_waitcnt lgkmcnt(0)
  s_memtime s[58:59]
  s_waitcnt lgkmcnt(0)
  s_sub_u32 s58, s58, s56
  s_min_u32 s63, s63, s58
  s_memtime s[56:57]
  s_waitcnt lgkmcnt(0)
  s_load_dword s60, s[92:93], 0x1100
  s_waitcnt lgkmcnt(0)
  s_memtime s[58:59]
  s_waitcnt lgkmcnt(0)
  s_sub_u32 s58, s58, s56
  s_min_u32 s62, s62, s58
  s_memtime s[56:57]
  s_waitcnt lgkmcnt(0)
  s_load_dword s60, s[92:93], 0x3100
  s_waitcnt lgkmcnt(0)
  s_memtime s[58:59]
  s_waitcnt lgkmcnt(0)
  s_sub_u32 s58, s58, s56
  s_min_u32 s63, s63, s58
  s_memtime s[56:57]
  s_waitcnt lgkmcnt(0)
  s_load_dword s60, s[92:93], 0x14200
  s_waitcnt lgkmcnt(0)
  s_memtime s[58:59]
  s_waitcnt lgkmcnt(0)
  s_sub_u32 s58, s58, s56
  s_min_u32 s62, s62, s58
  s_memtime s[56:57]
  s_waitcnt lgkmcnt(0)
  s_load_dword s60, s[92:93], 0x16200
  s_waitcnt lgkmcnt(0)
  s_memtime s[58:59]
  s_waitcnt lgkmcnt(0)
  s_sub_u32 s58, s58, s56
  s_min_u32 s63, s63, s58
  s_memtime s[56:57]
  s_waitcnt lgkmcnt(0)
  s_load_dword s60, s[92:93], 0x15300
  s_waitcnt lgkmcnt(0)
  s_memtime s[58:59]
  s_waitcnt lgkmcnt(0)
  s_sub_u32 s58, s58, s56
  s_min_u32 s62, s62, s58
  s_memtime s[56:57]
  s_waitcnt lgkmcnt(0)
  s_load_dword s60, s[92:93], 0x17300
  s_waitcnt lgkmcnt(0)
  s_memtime s[58:59]
  s_waitcnt lgkmcnt(0)
  s_sub_u32 s58, s58, s56
  s_min_u32 s63, s63, s58
  s_cmp_lt_u32 s63, s62
  s_cselect_b32 s60, 2, 1
  v_mov_b32 v6, s60
  v_mov_b32 v7, s62
  v_mov_b32 v8, s63
  v_mov_b32 v9, 0
  s_mov_b64 exec, 1
  buffer_store_dword v6, v9, s[28:31], 0 offen offset:128 sc1
  s_mov_b64 exec, -1
FL_np_3:
  s_lshl_b32 s90, s34, 2
  s_add_u32 s90, s90, s32
  s_lshr_b32 s91, s90, 3
  s_lshl_b32 s91, s91, 14
  s_and_b32 s92, s90, 7
  s_lshl_b32 s92, s92, 10
  s_add_u32 s91, s91, s92
  v_mov_b32 v1, 0x0
  v_bfe_u32 v31, v0, 0, 6
  v_lshl_add_u32 v1, v31, 4, v1
  v_add_u32 v1, s91, v1
  v_lshrrev_b32 v30, 4, v0
  v_cmp_eq_u32 vcc, s33, v30
  v_xor_b32 v29, 0x2000, v1
  s_nop 0
  v_cndmask_b32 v1, v1, v29, vcc
  s_lshl_b32 s91, s33, 14
  s_lshl_b32 s92, s90, 7
  s_add_u32 s91, s91, s92
  v_mov_b32 v2, 0x200000
  v_bfe_u32 v31, v0, 0, 2
  v_lshl_add_u32 v2, v31, 2, v2
  v_bfe_u32 v31, v0, 2, 1
  v_lshl_add_u32 v2, v31, 6, v2
  v_bfe_u32 v31, v0, 4, 1
  v_lshl_add_u32 v2, v31, 4, v2
  v_bfe_u32 v31, v0, 5, 1
  v_lshl_add_u32 v2, v31, 5, v2
  v_bfe_u32 v31, v0, 3, 1
  v_lshl_add_u32 v2, v31, 31, v2
  v_add_u32 v2, s91, v2
  s_lshr_b32 s92, s90, 1
  s_lshl_b32 s92, s92, 5
  s_and_b32 s91, s90, 1
  s_lshl_b32 s91, s91, 13
  s_add_u32 s92, s92, s91
  v_mov_b32 v30, 0x0
  v_bfe_u32 v31, v0, 2, 1
  v_lshl_add_u32 v30, v31, 12, v30
  v_bfe_u32 v31, v0, 4, 1
  v_lshl_add_u32 v30, v31, 11, v30
  v_bfe_u32 v31, v0, 0, 2
  v_lshl_add_u32 v30, v31, 3, v30
  v_bfe_u32 v31, v0, 5, 1
  v_lshl_add_u32 v30, v31, 2, v30
  v_add_u32 v30, s92, v30
  buffer_load_dword v44, v30, s[24:27], 0 offen
  s_lshl_b32 s91, s33, 14
  s_lshl_b32 s92, s32, 12
  s_add_u32 s91, s91, s92
  v_mov_b32 v3, 0x200000
  v_bfe_u32 v31, v0, 0, 6
  v_lshl_add_u32 v3, v31, 4, v3
  v_add_u32 v3, s91, v3
  s_mul_i32 s91, s32, 3264
  v_mov_b32 v4, 0x0
  v_bfe_u32 v31, v0, 0, 6
  v_lshl_add_u32 v4, v31, 4, v4
  v_add_u32 v4, s91, v4
  s_lshl_b32 s91, s32, 6
  v_mov_b32 v6, 0x0
  v_bfe_u32 v31, v0, 0, 2
  v_lshl_add_u32 v6, v31, 4, v6
  v_bfe_u32 v31, v0, 2, 1
  v_lshl_add_u32 v6, v31, 2, v6
  v_bfe_u32 v31, v0, 3, 1
  s_mov_b32 s99, 1088
  v_mad_u32_u24 v6, v31, s99, v6
  v_bfe_u32 v31, v0, 4, 2
  v_lshl_add_u32 v6, v31, 8, v6
  v_add_u32 v6, s91, v6
  v_add_u32 v240, 3264, v6
  v_add_u32 v241, 6528, v6
  v_add_u32 v242, 9792, v6
  s_lshl_b32 s93, s37, 13
  s_lshl_b32 s91, s38, 10
  s_add_u32 s91, s91, s93
  s_lshl_b32 s92, s32, 8
  s_add_u32 s91, s91, s92
  v_mov_b32 v7, 0x210000
  v_bfe_u32 v31, v0, 0, 6
  v_lshl_add_u32 v7, v31, 2, v7
  v_add_u32 v7, s91, v7
  s_lshl_b32 s91, s37, 11
  s_lshl_b32 s92, s38, 9
  s_add_u32 s59, s91, s92
  s_lshl_b32 s92, s32, 7
  s_add_u32 s91, s59, s92
  v_mov_b32 v19, 0x83000000
  v_bfe_u32 v31, v0, 0, 3
  v_lshl_add_u32 v19, v31, 2, v19
  v_bfe_u32 v31, v0, 4, 2
  v_lshl_add_u32 v19, v31, 5, v19
  v_bfe_u32 v31, v0, 3, 1
  v_lshl_add_u32 v19, v31, 31, v19
  v_add_u32 v19, s91, v19
  s_lshl_b32 s91, s32, 8
  v_mov_b32 v5, 0x880
  v_bfe_u32 v31, v0, 0, 1
  v_lshl_add_u32 v5, v31, 7, v5
  v_bfe_u32 v31, v0, 1, 1
  v_lshl_add_u32 v5, v31, 3, v5
  v_bfe_u32 v31, v0, 2, 3
  v_lshl_add_u32 v5, v31, 4, v5
  v_add_u32 v5, s91, v5
  s_lshr_b32 s92, s38, 1
  s_xor_b32 s92, s92, 1
  s_lshl_b32 s92, s92, 10
  s_add_u32 s91, s91, s92
  s_add_u32 s91, s91, s93
  s_and_b32 s92, s38, 1
  s_lshl_b32 s92, s92, 7
  s_add_u32 s91, s91, s92
  v_mov_b32 v8, 0x211000
  v_bfe_u32 v31, v0, 0, 5
  v_lshl_add_u32 v8, v31, 2, v8
  v_bfe_u32 v31, v0, 5, 1
  v_lshl_add_u32 v8, v31, 31, v8
  v_add_u32 v8, s91, v8
  s_sub_u32 s91, s91, s93
  s_lshl_b32 s92, s37, 11
  s_add_u32 s91, s91, s92
  v_mov_b32 v20, 0x3400000
  v_bfe_u32 v31, v0, 0, 5
  v_lshl_add_u32 v20, v31, 2, v20
  v_bfe_u32 v31, v0, 5, 1
  v_lshl_add_u32 v20, v31, 31, v20
  v_add_u32 v20, s91, v20
  s_lshl_b32 s97, s35, 2
  s_add_u32 s97, s97, s32
  s_lshl_b32 s97, s97, 13
  v_mov_b32 v9, 0x210000
  v_bfe_u32 v31, v0, 0, 6
  v_lshl_add_u32 v9, v31, 4, v9
  v_add_u32 v9, s97, v9
  v_add_u32 v10, 4096, v9
  v_mov_b32 v11, 0x1000000
  v_bfe_u32 v31, v0, 0, 2
  v_lshl_add_u32 v11, v31, 4, v11
  v_bfe_u32 v31, v0, 2, 1
  v_lshl_add_u32 v11, v31, 7, v11
  v_bfe_u32 v31, v0, 3, 1
  v_lshl_add_u32 v11, v31, 12, v11
  v_bfe_u32 v31, v0, 4, 2
  v_lshl_add_u32 v11, v31, 8, v11
  v_add_u32 v11, s97, v11
  v_mov_b32 v12, 0x2000000
  v_bfe_u32 v31, v0, 0, 3
  v_lshl_add_u32 v12, v31, 4, v12
  v_bfe_u32 v31, v0, 3, 1
  v_lshl_add_u32 v12, v31, 11, v12
  v_bfe_u32 v31, v0, 4, 2
  v_lshl_add_u32 v12, v31, 8, v12
  v_add_u32 v12, s97, v12
  v_add_u32 v13, 4096, v12
  s_lshl_b32 s91, s36, 9
  s_add_u32 s91, s91, s97
  s_add_u32 s63, s91, 0x1000000
  v_mov_b32 v21, 0x1000000
  v_bfe_u32 v31, v0, 0, 2
  v_lshl_add_u32 v21, v31, 7, v21
  v_bfe_u32 v31, v0, 2, 1
  v_lshl_add_u32 v21, v31, 24, v21
  v_add_u32 v21, s91, v21
  v_cmp_gt_u32 vcc, 8, v0
  v_mov_b32 v30, 0x80000000
  s_nop 0
  v_cndmask_b32 v21, v30, v21, vcc
  s_lshl_b32 s91, s32, 11
  v_mov_b32 v30, 0x0
  v_bfe_u32 v31, v0, 2, 1
  v_lshl_add_u32 v30, v31, 6, v30
  v_bfe_u32 v31, v0, 0, 1
  v_lshl_add_u32 v30, v31, 5, v30
  v_bfe_u32 v31, v0, 1, 1
  v_lshl_add_u32 v30, v31, 4, v30
  v_mov_b32 v29, 0x0
  v_bfe_u32 v31, v0, 4, 2
  v_lshl_add_u32 v29, v31, 5, v29
  v_xor_b32 v30, v30, v29
  v_mov_b32 v14, 0x3400
  v_bfe_u32 v31, v0, 0, 4
  v_lshl_add_u32 v14, v31, 7, v14
  v_add_u32 v14, s91, v14
  v_add_u32 v14, v14, v30
  v_xor_b32 v15, 16, v14
  v_mov_b32 v30, 0x0
  v_bfe_u32 v31, v0, 5, 1
  v_lshl_add_u32 v30, v31, 6, v30
  v_bfe_u32 v31, v0, 1, 1
  v_lshl_add_u32 v30, v31, 5, v30
  v_bfe_u32 v31, v0, 4, 1
  v_lshl_add_u32 v30, v31, 4, v30
  v_mov_b32 v29, 0x0
  v_bfe_u32 v31, v0, 2, 2
  v_lshl_add_u32 v29, v31, 5, v29
  v_bfe_u32 v31, v0, 0, 1
  v_lshl_add_u32 v29, v31, 4, v29
  v_xor_b32 v30, v30, v29
  v_mov_b32 v16, 0x3400
  v_bfe_u32 v31, v0, 4, 2
  v_lshl_add_u32 v16, v31, 8, v16
  v_bfe_u32 v31, v0, 1, 1
  v_lshl_add_u32 v16, v31, 7, v16
  v_add_u32 v16, v16, v30
  s_lshl_b32 s98, s36, 14
  s_lshl_b32 s92, s35, 7
  s_add_u32 s98, s98, s92
  s_lshl_b32 s92, s32, 11
  s_add_u32 s91, s98, s92
  v_mov_b32 v17, 0x0
  v_bfe_u32 v31, v0, 0, 5
  v_lshl_add_u32 v17, v31, 2, v17
  v_bfe_u32 v31, v0, 5, 1
  v_lshl_add_u32 v17, v31, 10, v17
  v_add_u32 v17, s91, v17
  v_xor_b32 v18, 0x2000, v17
  s_mov_b32 s48, 0x33333333
  s_mov_b32 s49, 0x33333333
  s_mov_b32 s50, 0xffff0000
  s_mov_b32 s51, 0xffff0000
  s_mov_b32 s52, 0x0000ffff
  s_mov_b32 s53, 0x0000ffff
  s_mov_b32 s54, 0xfffffffe
  s_mov_b32 s47, 0x3e0293ee
  v_mov_b32 v30, 0x4444
  v_mov_b32 v31, 0xeeee
  v_cndmask_b32 v23, v31, v30, s[48:49]
  v_mov_b32 v22, -1
  v_mov_b32 v232, 0
  v_mov_b32 v233, 0
  v_mov_b32 v234, 0
  v_mov_b32 v235, 0
  v_mov_b32 v112, 0
  v_mov_b32 v113, 0
  s_mov_b32 s56, 0xf0f0f0f0
  s_mov_b32 s57, 0xf0f0f0f0
  v_mov_b32 v30, 0x3f80
  v_mov_b32 v31, 1.0
  v_cndmask_b32 v30, v30, v31, s[56:57]
  s_mov_b32 s56, 0x110011
  s_mov_b32 s57, 0x110011
  v_cndmask_b32 v24, 0, v30, s[56:57]
  s_mov_b32 s56, 0x220022
  s_mov_b32 s57, 0x220022
  v_cndmask_b32 v25, 0, v30, s[56:57]
  s_mov_b32 s56, 0x11001100
  s_mov_b32 s57, 0x11001100
  v_cndmask_b32 v26, 0, v30, s[56:57]
  s_mov_b32 s56, 0x22002200
  s_mov_b32 s57, 0x22002200
  v_cndmask_b32 v27, 0, v30, s[56:57]
  s_mov_b32 s40, 0
  s_mov_b32 s41, 0x3800000
  s_mov_b32 s43, 0x3900000
  s_mov_b32 s44, 0
  s_mov_b32 s55, 0x40000
  s_mov_b32 s45, 0
  s_waitcnt vmcnt(33)
  s_barrier
  s_cmp_lg_u32 s32, 0
  s_cbranch_scc1 FL_sig_4
  v_mov_b32 v254, 1
  v_mov_b32 v255, 0
  s_mov_b64 exec, 1
  buffer_atomic_add v254, v255, s[28:31], s100 offen offset:132 sc1
  s_mov_b64 exec, -1
FL_sig_4:
  s_waitcnt vmcnt(28)
  ds_read_b64_tr_b16 a[16:17], v182 offset:0
  ds_read_b64_tr_b16 a[18:19], v182 offset:512
  ds_read_b64_tr_b16 a[24:25], v182 offset:32
  ds_read_b64_tr_b16 a[26:27], v182 offset:544
  s_waitcnt lgkmcnt(0)
  s_add_u32 m0, s96, 0
  s_mov_b32 s90, 0x100000
  buffer_load_dwordx4 v180, s[12:15], s90 offen  lds
  s_add_u32 m0, s96, 1024
  s_mov_b32 s90, 0x110000
  buffer_load_dwordx4 v180, s[12:15], s90 offen  lds
  s_add_u32 m0, s96, 2048
  s_mov_b32 s90, 0x120000
  buffer_load_dwordx4 v180, s[12:15], s90 offen  lds
  s_add_u32 m0, s96, 3072
  s_mov_b32 s90, 0x130000
  buffer_load_dwordx4 v180, s[12:15], s90 offen  lds
  s_waitcnt vmcnt(28)
  ds_read_b64_tr_b16 a[32:33], v182 offset:4096
  ds_read_b64_tr_b16 a[34:35], v182 offset:4608
  ds_read_b64_tr_b16 a[40:41], v182 offset:4128
  ds_read_b64_tr_b16 a[42:43], v182 offset:4640
  s_waitcnt lgkmcnt(0)
  s_add_u32 m0, s96, 4096
  s_mov_b32 s90, 0x100000
  buffer_load_dwordx4 v185, s[16:19], s90 offen  lds
  s_add_u32 m0, s96, 5120
  s_mov_b32 s90, 0x110000
  buffer_load_dwordx4 v185, s[16:19], s90 offen  lds
  s_add_u32 m0, s96, 6144
  s_mov_b32 s90, 0x120000
  buffer_load_dwordx4 v185, s[16:19], s90 offen  lds
  s_add_u32 m0, s96, 7168
  s_mov_b32 s90, 0x130000
  buffer_load_dwordx4 v185, s[16:19], s90 offen  lds
  s_waitcnt vmcnt(28)
  ds_read_b64_tr_b16 a[20:21], v182 offset:8192
  ds_read_b64_tr_b16 a[22:23], v182 offset:8704
  ds_read_b64_tr_b16 a[28:29], v182 offset:8224
  ds_read_b64_tr_b16 a[30:31], v182 offset:8736
  s_waitcnt lgkmcnt(0)
  s_add_u32 m0, s96, 8192
  s_mov_b32 s90, 0x140000
  buffer_load_dwordx4 v180, s[12:15], s90 offen  lds
  s_add_u32 m0, s96, 9216
  s_mov_b32 s90, 0x150000
  buffer_load_dwordx4 v180, s[12:15], s90 offen  lds
  s_add_u32 m0, s96, 10240
  s_mov_b32 s90, 0x160000
  buffer_load_dwordx4 v180, s[12:15], s90 offen  lds
  s_add_u32 m0, s96, 11264
  s_mov_b32 s90, 0x170000
  buffer_load_dwordx4 v180, s[12:15], s90 offen  lds
  s_waitcnt vmcnt(28)
  ds_read_b64_tr_b16 a[36:37], v182 offset:12288
  ds_read_b64_tr_b16 a[38:39], v182 offset:12800
  ds_read_b64_tr_b16 a[44:45], v182 offset:12320
  ds_read_b64_tr_b16 a[46:47], v182 offset:12832
  s_waitcnt lgkmcnt(0)
  s_add_u32 m0, s96, 12288
  s_mov_b32 s90, 0x140000
  buffer_load_dwordx4 v185, s[16:19], s90 offen  lds
  s_add_u32 m0, s96, 13312
  s_mov_b32 s90, 0x150000
  buffer_load_dwordx4 v185, s[16:19], s90 offen  lds
  s_add_u32 m0, s96, 14336
  s_mov_b32 s90, 0x160000
  buffer_load_dwordx4 v185, s[16:19], s90 offen  lds
  s_add_u32 m0, s96, 15360
  s_mov_b32 s90, 0x170000
  buffer_load_dwordx4 v185, s[16:19], s90 offen  lds
  s_waitcnt vmcnt(28)
  ds_read_b64_tr_b16 a[64:65], v182 offset:16384
  ds_read_b64_tr_b16 a[66:67], v182 offset:16896
  ds_read_b64_tr_b16 a[72:73], v182 offset:16416
  ds_read_b64_tr_b16 a[74:75], v182 offset:16928
  s_waitcnt lgkmcnt(0)
  s_add_u32 m0, s96, 16384
  s_mov_b32 s90, 0x180000
  buffer_load_dwordx4 v180, s[12:15], s90 offen  lds
  s_add_u32 m0, s96, 17408
  s_mov_b32 s90, 0x190000
  buffer_load_dwordx4 v180, s[12:15], s90 offen  lds
  s_add_u32 m0, s96, 18432
  s_mov_b32 s90, 0x1a0000
  buffer_load_dwordx4 v180, s[12:15], s90 offen  lds
  s_add_u32 m0, s96, 19456
  s_mov_b32 s90, 0x1b0000
  buffer_load_dwordx4 v180, s[12:15], s90 offen  lds
  s_waitcnt vmcnt(28)
  ds_read_b64_tr_b16 a[80:81], v182 offset:20480
  ds_read_b64_tr_b16 a[82:83], v182 offset:20992
  ds_read_b64_tr_b16 a[88:89], v182 offset:20512
  ds_read_b64_tr_b16 a[90:91], v182 offset:21024
  s_waitcnt lgkmcnt(0)
  s_add_u32 m0, s96, 20480
  s_mov_b32 s90, 0x180000
  buffer_load_dwordx4 v185, s[16:19], s90 offen  lds
  s_add_u32 m0, s96, 21504
  s_mov_b32 s90, 0x190000
  buffer_load_dwordx4 v185, s[16:19], s90 offen  lds
  s_add_u32 m0, s96, 22528
  s_mov_b32 s90, 0x1a0000
  buffer_load_dwordx4 v185, s[16:19], s90 offen  lds
  s_add_u32 m0, s96, 23552
  s_mov_b32 s90, 0x1b0000
  buffer_load_dwordx4 v185, s[16:19], s90 offen  lds
  s_waitcnt vmcnt(28)
  ds_read_b64_tr_b16 a[68:69], v182 offset:24576
  ds_read_b64_tr_b16 a[70:71], v182 offset:25088
  ds_read_b64_tr_b16 a[76:77], v182 offset:24608
  ds_read_b64_tr_b16 a[78:79], v182 offset:25120
  s_waitcnt lgkmcnt(0)
  s_add_u32 m0, s96, 24576
  s_mov_b32 s90, 0x1c0000
  buffer_load_dwordx4 v180, s[12:15], s90 offen  lds
  s_add_u32 m0, s96, 25600
  s_mov_b32 s90, 0x1d0000
  buffer_load_dwordx4 v180, s[12:15], s90 offen  lds
  s_add_u32 m0, s96, 26624
  s_mov_b32 s90, 0x1e0000
  buffer_load_dwordx4 v180, s[12:15], s90 offen  lds
  s_add_u32 m0, s96, 27648
  s_mov_b32 s90, 0x1f0000
  buffer_load_dwordx4 v180, s[12:15], s90 offen  lds
  s_waitcnt vmcnt(28)
  ds_read_b64_tr_b16 a[84:85], v182 offset:28672
  ds_read_b64_tr_b16 a[86:87], v182 offset:29184
  ds_read_b64_tr_b16 a[92:93], v182 offset:28704
  ds_read_b64_tr_b16 a[94:95], v182 offset:29216
  s_waitcnt lgkmcnt(0)
  s_add_u32 m0, s96, 28672
  s_mov_b32 s90, 0x1c0000
  buffer_load_dwordx4 v185, s[16:19], s90 offen  lds
  s_add_u32 m0, s96, 29696
  s_mov_b32 s90, 0x1d0000
  buffer_load_dwordx4 v185, s[16:19], s90 offen  lds
  s_add_u32 m0, s96, 30720
  s_mov_b32 s90, 0x1e0000
  buffer_load_dwordx4 v185, s[16:19], s90 offen  lds
  s_add_u32 m0, s96, 31744
  s_mov_b32 s90, 0x1f0000
  buffer_load_dwordx4 v185, s[16:19], s90 offen  lds
  s_waitcnt vmcnt(28)
  ds_read_b64_tr_b16 a[112:113], v182 offset:0
  ds_read_b64_tr_b16 a[114:115], v182 offset:512
  ds_read_b64_tr_b16 a[120:121], v182 offset:32
  ds_read_b64_tr_b16 a[122:123], v182 offset:544
  s_waitcnt lgkmcnt(0)
  s_add_u32 m0, s96, 0
  s_mov_b32 s90, 0x0
  buffer_load_dwordx4 v180, s[8:11], s90 offen  lds
  s_add_u32 m0, s96, 1024
  s_mov_b32 s90, 0x10000
  buffer_load_dwordx4 v180, s[8:11], s90 offen  lds
  s_add_u32 m0, s96, 2048
  s_mov_b32 s90, 0x20000
  buffer_load_dwordx4 v180, s[8:11], s90 offen  lds
  s_add_u32 m0, s96, 3072
  s_mov_b32 s90, 0x30000
  buffer_load_dwordx4 v180, s[8:11], s90 offen  lds
  s_waitcnt vmcnt(28)
  ds_read_b64_tr_b16 a[128:129], v182 offset:4096
  ds_read_b64_tr_b16 a[130:131], v182 offset:4608
  ds_read_b64_tr_b16 a[136:137], v182 offset:4128
  ds_read_b64_tr_b16 a[138:139], v182 offset:4640
  s_waitcnt lgkmcnt(0)
  s_add_u32 m0, s96, 4096
  s_mov_b32 s90, 0x40000
  buffer_load_dwordx4 v180, s[8:11], s90 offen  lds
  s_add_u32 m0, s96, 5120
  s_mov_b32 s90, 0x50000
  buffer_load_dwordx4 v180, s[8:11], s90 offen  lds
  s_add_u32 m0, s96, 6144
  s_mov_b32 s90, 0x60000
  buffer_load_dwordx4 v180, s[8:11], s90 offen  lds
  s_add_u32 m0, s96, 7168
  s_mov_b32 s90, 0x70000
  buffer_load_dwordx4 v180, s[8:11], s90 offen  lds
  s_waitcnt vmcnt(28)
  ds_read_b64_tr_b16 a[116:117], v182 offset:8192
  ds_read_b64_tr_b16 a[118:119], v182 offset:8704
  ds_read_b64_tr_b16 a[124:125], v182 offset:8224
  ds_read_b64_tr_b16 a[126:127], v182 offset:8736
  s_waitcnt lgkmcnt(0)
  s_add_u32 m0, s96, 8192
  s_mov_b32 s90, 0x80000
  buffer_load_dwordx4 v180, s[8:11], s90 offen  lds
  s_add_u32 m0, s96, 9216
  s_mov_b32 s90, 0x90000
  buffer_load_dwordx4 v180, s[8:11], s90 offen  lds
  s_add_u32 m0, s96, 10240
  s_mov_b32 s90, 0xa0000
  buffer_load_dwordx4 v180, s[8:11], s90 offen  lds
  s_add_u32 m0, s96, 11264
  s_mov_b32 s90, 0xb0000
  buffer_load_dwordx4 v180, s[8:11], s90 offen  lds
  s_waitcnt vmcnt(28)
  ds_read_b64_tr_b16 a[132:133], v182 offset:12288
  ds_read_b64_tr_b16 a[134:135], v182 offset:12800
  ds_read_b64_tr_b16 a[140:141], v182 offset:12320
  ds_read_b64_tr_b16 a[142:143], v182 offset:12832
  s_waitcnt lgkmcnt(0)
  s_add_u32 m0, s96, 12288
  s_mov_b32 s90, 0xc0000
  buffer_load_dwordx4 v180, s[8:11], s90 offen  lds
  s_add_u32 m0, s96, 13312
  s_mov_b32 s90, 0xd0000
  buffer_load_dwordx4 v180, s[8:11], s90 offen  lds
  s_add_u32 m0, s96, 14336
  s_mov_b32 s90, 0xe0000
  buffer_load_dwordx4 v180, s[8:11], s90 offen  lds
  s_add_u32 m0, s96, 15360
  s_mov_b32 s90, 0xf0000
  buffer_load_dwordx4 v180, s[8:11], s90 offen  lds
  s_waitcnt vmcnt(28)
  ds_read_b64_tr_b16 a[160:161], v182 offset:16384
  ds_read_b64_tr_b16 a[162:163], v182 offset:16896
  ds_read_b64_tr_b16 a[168:169], v182 offset:16416
  ds_read_b64_tr_b16 a[170:171], v182 offset:16928
  s_waitcnt lgkmcnt(0)
  s_add_u32 m0, s96, 16384
  s_mov_b32 s90, 0x100000
  buffer_load_dwordx4 v180, s[8:11], s90 offen  lds
  s_add_u32 m0, s96, 17408
  s_mov_b32 s90, 0x110000
  buffer_load_dwordx4 v180, s[8:11], s90 offen  lds
  s_add_u32 m0, s96, 18432
  s_mov_b32 s90, 0x120000
  buffer_load_dwordx4 v180, s[8:11], s90 offen  lds
  s_add_u32 m0, s96, 19456
  s_mov_b32 s90, 0x130000
  buffer_load_dwordx4 v180, s[8:11], s90 offen  lds
  s_waitcnt vmcnt(28)
  ds_read_b64_tr_b16 a[176:177], v182 offset:20480
  ds_read_b64_tr_b16 a[178:179], v182 offset:20992
  ds_read_b64_tr_b16 a[184:185], v182 offset:20512
  ds_read_b64_tr_b16 a[186:187], v182 offset:21024
  s_waitcnt lgkmcnt(0)
  s_add_u32 m0, s96, 20480
  s_mov_b32 s90, 0x140000
  buffer_load_dwordx4 v180, s[8:11], s90 offen  lds
  s_add_u32 m0, s96, 21504
  s_mov_b32 s90, 0x150000
  buffer_load_dwordx4 v180, s[8:11], s90 offen  lds
  s_add_u32 m0, s96, 22528
  s_mov_b32 s90, 0x160000
  buffer_load_dwordx4 v180, s[8:11], s90 offen  lds
  s_add_u32 m0, s96, 23552
  s_mov_b32 s90, 0x170000
  buffer_load_dwordx4 v180, s[8:11], s90 offen  lds
  s_waitcnt vmcnt(28)
  ds_read_b64_tr_b16 a[164:165], v182 offset:24576
  ds_read_b64_tr_b16 a[166:167], v182 offset:25088
  ds_read_b64_tr_b16 a[172:173], v182 offset:24608
  ds_read_b64_tr_b16 a[174:175], v182 offset:25120
  s_waitcnt lgkmcnt(0)
  s_add_u32 m0, s96, 24576
  s_mov_b32 s90, 0x180000
  buffer_load_dwordx4 v180, s[8:11], s90 offen  lds
  s_add_u32 m0, s96, 25600
  s_mov_b32 s90, 0x190000
  buffer_load_dwordx4 v180, s[8:11], s90 offen  lds
  s_add_u32 m0, s96, 26624
  s_mov_b32 s90, 0x1a0000
  buffer_load_dwordx4 v180, s[8:11], s90 offen  lds
  s_add_u32 m0, s96, 27648
  s_mov_b32 s90, 0x1b0000
  buffer_load_dwordx4 v180, s[8:11], s90 offen  lds
  s_waitcnt vmcnt(28)
  ds_read_b64_tr_b16 a[180:181], v182 offset:28672
  ds_read_b64_tr_b16 a[182:183], v182 offset:29184
  ds_read_b64_tr_b16 a[188:189], v182 offset:28704
  ds_read_b64_tr_b16 a[190:191], v182 offset:29216
  s_waitcnt lgkmcnt(0)
  s_add_u32 m0, s96, 28672
  s_mov_b32 s90, 0x1c0000
  buffer_load_dwordx4 v180, s[8:11], s90 offen  lds
  s_add_u32 m0, s96, 29696
  s_mov_b32 s90, 0x1d0000
  buffer_load_dwordx4 v180, s[8:11], s90 offen  lds
  s_add_u32 m0, s96, 30720
  s_mov_b32 s90, 0x1e0000
  buffer_load_dwordx4 v180, s[8:11], s90 offen  lds
  s_add_u32 m0, s96, 31744
  s_mov_b32 s90, 0x1f0000
  buffer_load_dwordx4 v180, s[8:11], s90 offen  lds
  s_waitcnt vmcnt(28)
  ds_read_b64_tr_b16 a[0:1], v182 offset:0
  ds_read_b64_tr_b16 a[2:3], v182 offset:512
  ds_read_b64_tr_b16 a[8:9], v182 offset:32
  ds_read_b64_tr_b16 a[10:11], v182 offset:544
  s_waitcnt lgkmcnt(0)
  s_add_u32 m0, s96, 0
  s_mov_b32 s90, 0x0
  buffer_load_dwordx4 v181, s[20:23], s90 offen  lds
  s_add_u32 m0, s96, 1024
  s_mov_b32 s90, 0x4000
  buffer_load_dwordx4 v181, s[20:23], s90 offen  lds
  s_add_u32 m0, s96, 2048
  s_mov_b32 s90, 0x8000
  buffer_load_dwordx4 v181, s[20:23], s90 offen  lds
  s_add_u32 m0, s96, 3072
  s_mov_b32 s90, 0xc000
  buffer_load_dwordx4 v181, s[20:23], s90 offen  lds
  s_waitcnt vmcnt(28)
  ds_read_b64_tr_b16 a[4:5], v182 offset:4096
  ds_read_b64_tr_b16 a[6:7], v182 offset:4608
  ds_read_b64_tr_b16 a[12:13], v182 offset:4128
  ds_read_b64_tr_b16 a[14:15], v182 offset:4640
  s_waitcnt lgkmcnt(0)
  s_add_u32 m0, s96, 4096
  s_mov_b32 s90, 0x10000
  buffer_load_dwordx4 v181, s[20:23], s90 offen  lds
  s_add_u32 m0, s96, 5120
  s_mov_b32 s90, 0x14000
  buffer_load_dwordx4 v181, s[20:23], s90 offen  lds
  s_add_u32 m0, s96, 6144
  s_mov_b32 s90, 0x18000
  buffer_load_dwordx4 v181, s[20:23], s90 offen  lds
  s_add_u32 m0, s96, 7168
  s_mov_b32 s90, 0x1c000
  buffer_load_dwordx4 v181, s[20:23], s90 offen  lds
  s_waitcnt vmcnt(28)
  ds_read_b64_tr_b16 a[48:49], v182 offset:8192
  ds_read_b64_tr_b16 a[50:51], v182 offset:8704
  ds_read_b64_tr_b16 a[56:57], v182 offset:8224
  ds_read_b64_tr_b16 a[58:59], v182 offset:8736
  s_waitcnt lgkmcnt(0)
  s_add_u32 m0, s96, 8192
  s_mov_b32 s90, 0x20000
  buffer_load_dwordx4 v181, s[20:23], s90 offen  lds
  s_add_u32 m0, s96, 9216
  s_mov_b32 s90, 0x24000
  buffer_load_dwordx4 v181, s[20:23], s90 offen  lds
  s_add_u32 m0, s96, 10240
  s_mov_b32 s90, 0x28000
  buffer_load_dwordx4 v181, s[20:23], s90 offen  lds
  s_add_u32 m0, s96, 11264
  s_mov_b32 s90, 0x2c000
  buffer_load_dwordx4 v181, s[20:23], s90 offen  lds
  s_waitcnt vmcnt(28)
  ds_read_b64_tr_b16 a[52:53], v182 offset:12288
  ds_read_b64_tr_b16 a[54:55], v182 offset:12800
  ds_read_b64_tr_b16 a[60:61], v182 offset:12320
  ds_read_b64_tr_b16 a[62:63], v182 offset:12832
  s_waitcnt lgkmcnt(0)
  s_add_u32 m0, s96, 12288
  s_mov_b32 s90, 0x30000
  buffer_load_dwordx4 v181, s[20:23], s90 offen  lds
  s_add_u32 m0, s96, 13312
  s_mov_b32 s90, 0x34000
  buffer_load_dwordx4 v181, s[20:23], s90 offen  lds
  s_add_u32 m0, s96, 14336
  s_mov_b32 s90, 0x38000
  buffer_load_dwordx4 v181, s[20:23], s90 offen  lds
  s_add_u32 m0, s96, 15360
  s_mov_b32 s90, 0x3c000
  buffer_load_dwordx4 v181, s[20:23], s90 offen  lds
  s_mov_b32 s90, 0x3800000
  buffer_load_dword v204, v2, s[4:7], s90 offen sc1
  buffer_load_dword v204, v7, s[4:7], s90 offen sc1
  buffer_load_dword v204, v8, s[4:7], s90 offen sc1
  s_mov_b32 s90, 0x3880000
  buffer_load_dword v204, v2, s[4:7], s90 offen sc1
  buffer_load_dword v204, v7, s[4:7], s90 offen sc1
  buffer_load_dword v204, v8, s[4:7], s90 offen sc1
  s_mov_b32 s90, 0x3900000
  buffer_load_dword v204, v2, s[4:7], s90 offen sc1
  buffer_load_dword v204, v7, s[4:7], s90 offen sc1
  buffer_load_dword v204, v8, s[4:7], s90 offen sc1
  s_mov_b32 s90, 0x3980000
  buffer_load_dword v204, v2, s[4:7], s90 offen sc1
  buffer_load_dword v204, v7, s[4:7], s90 offen sc1
  buffer_load_dword v204, v8, s[4:7], s90 offen sc1
  s_waitcnt vmcnt(28)
  ds_read_b64_tr_b16 a[96:97], v182 offset:16384
  ds_read_b64_tr_b16 a[98:99], v182 offset:16896
  ds_read_b64_tr_b16 a[104:105], v182 offset:16416
  ds_read_b64_tr_b16 a[106:107], v182 offset:16928
  s_waitcnt vmcnt(24)
  ds_read_b64_tr_b16 a[100:101], v182 offset:20480
  ds_read_b64_tr_b16 a[102:103], v182 offset:20992
  ds_read_b64_tr_b16 a[108:109], v182 offset:20512
  ds_read_b64_tr_b16 a[110:111], v182 offset:21024
  s_waitcnt vmcnt(20)
  ds_read_b64_tr_b16 a[144:145], v182 offset:24576
  ds_read_b64_tr_b16 a[146:147], v182 offset:25088
  ds_read_b64_tr_b16 a[152:153], v182 offset:24608
  ds_read_b64_tr_b16 a[154:155], v182 offset:25120
  s_waitcnt vmcnt(16)
  ds_read_b64_tr_b16 a[148:149], v182 offset:28672
  ds_read_b64_tr_b16 a[150:151], v182 offset:29184
  ds_read_b64_tr_b16 a[156:157], v182 offset:28704
  ds_read_b64_tr_b16 a[158:159], v182 offset:29216
  v_mbcnt_lo_u32_b32 v250, -1, 0
  v_mbcnt_hi_u32_b32 v250, -1, v250
  s_lshl_b32 s90, s32, 9
  s_add_u32 s90, s90, 131136
  v_lshl_add_u32 v251, v250, 3, s90
  ds_write_b64 v251, v[248:249]
  s_waitcnt lgkmcnt(0)
  s_cmp_lg_u32 s32, 0
  s_cbranch_scc1 FL_vd_6
  v_lshlrev_b32 v250, 2, v250
  s_cmp_lg_u32 s100, 0
  s_cbranch_scc1 FL_vw_5
  v_readfirstlane_b32 s90, v247
  s_and_b32 s90, s90, s101
  s_cbranch_scc0 FL_vw_5
  v_mov_b32 v251, 1
  s_mov_b64 exec, 1
  buffer_store_dword v251, v250, s[28:31], 0 offen offset:32 sc1
  s_mov_b64 exec, -1
FL_vw_5:
  buffer_load_dword v251, v250, s[28:31], 0 offen sc1
  s_waitcnt vmcnt(0)
  v_cmp_eq_u32 vcc, -1, v251
  v_readlane_b32 s91, v251, 8
  v_readlane_b32 s92, v251, 32
  v_readlane_b32 s93, v251, 33
  v_readlane_b32 s90, v251, 34
  s_cmp_lg_u32 s100, 0
  s_cselect_b32 s93, s90, s93
  s_cselect_b32 s91, 0, s91
  s_cselect_b32 s92, 1, s92
  s_cselect_b32 s90, 0xff, vcc_lo
  s_cmp_lg_u32 s91, 0
  s_cselect_b32 s92, 3, s92
  s_cbranch_scc1 FL_vk_7
  s_add_u32 s3, s3, 1
  s_cmp_ge_u32 s3, 131072
  s_cselect_b32 s92, 4, s92
  s_cbranch_scc1 FL_vk_7
  s_sleep 8
  s_and_b32 s90, s90, 0xff
  s_cmp_lg_u32 s90, 0xff
  s_cbranch_scc1 FL_vw_5
  s_cmp_lt_u32 s93, 128
  s_cbranch_scc1 FL_vw_5
  s_cmp_eq_u32 s92, 0
  s_cbranch_scc1 FL_vw_5
FL_vk_7:
  v_mov_b32 v251, s92
  v_mov_b32 v250, 131072
  ds_write_b32 v250, v251
  s_waitcnt lgkmcnt(0)
FL_vd_6:
  s_barrier
  v_mov_b32 v250, 131072
  ds_read_b32 v251, v250
  s_waitcnt lgkmcnt(0)
  v_readfirstlane_b32 s92, v251
  s_barrier
  s_cmp_eq_u32 s92, 3
  s_cbranch_scc1 L_fallback
  s_cmp_eq_u32 s92, 4
  s_cbranch_scc1 L_exit
  s_sub_u32 s39, s92, 1
  s_and_b32 s39, s39, 1
  s_lshl_b32 s39, s39, 13
  s_waitcnt vmcnt(0)
  s_barrier
  ds_read_b64_tr_b16 a[192:193], v183 offset:0
  ds_read_b64_tr_b16 a[194:195], v183 offset:2048
  ds_read_b64_tr_b16 a[196:197], v183 offset:512
  ds_read_b64_tr_b16 a[198:199], v183 offset:2560
  ds_read_b64_tr_b16 a[200:201], v183 offset:4096
  ds_read_b64_tr_b16 a[202:203], v183 offset:6144
  ds_read_b64_tr_b16 a[204:205], v183 offset:4608
  ds_read_b64_tr_b16 a[206:207], v183 offset:6656
  s_waitcnt lgkmcnt(0)
  ds_read_b64_tr_b16 a[208:209], v183 offset:32768
  ds_read_b64_tr_b16 a[210:211], v183 offset:34816
  ds_read_b64_tr_b16 a[212:213], v183 offset:33280
  ds_read_b64_tr_b16 a[214:215], v183 offset:35328
  ds_read_b64_tr_b16 a[216:217], v183 offset:36864
  ds_read_b64_tr_b16 a[218:219], v183 offset:38912
  ds_read_b64_tr_b16 a[220:221], v183 offset:37376
  ds_read_b64_tr_b16 a[222:223], v183 offset:39424
  s_waitcnt lgkmcnt(0)
  ds_read_b64_tr_b16 a[224:225], v184 offset:0
  ds_read_b64_tr_b16 a[226:227], v184 offset:2048
  ds_read_b64_tr_b16 a[228:229], v184 offset:512
  ds_read_b64_tr_b16 a[230:231], v184 offset:2560
  ds_read_b64_tr_b16 a[232:233], v184 offset:4096
  ds_read_b64_tr_b16 a[234:235], v184 offset:6144
  ds_read_b64_tr_b16 a[236:237], v184 offset:4608
  ds_read_b64_tr_b16 a[238:239], v184 offset:6656
  s_waitcnt lgkmcnt(0)
  ds_read_b64_tr_b16 a[240:241], v184 offset:32768
  ds_read_b64_tr_b16 a[242:243], v184 offset:34816
  ds_read_b64_tr_b16 a[244:245], v184 offset:33280
  ds_read_b64_tr_b16 a[246:247], v184 offset:35328
  ds_read_b64_tr_b16 a[248:249], v184 offset:36864
  ds_read_b64_tr_b16 a[250:251], v184 offset:38912
  ds_read_b64_tr_b16 a[252:253], v184 offset:37376
  ds_read_b64_tr_b16 a[254:255], v184 offset:39424
  s_waitcnt lgkmcnt(0)
  s_barrier
  s_mov_b32 s46, 0
  v_xor_b32 v1, s39, v1
  v_xor_b32 v17, s39, v17
  v_xor_b32 v18, s39, v18
  s_mov_b32 s12, s63
  s_mov_b32 s90, 0x3800000
  s_mov_b32 s90, 0x3880000
  s_mov_b32 s90, 0x3900000
  s_mov_b32 s90, 0x3980000
  v_mov_b32 v248, 0x3f803f80
  v_mov_b32 v249, 0x3f803f80
  v_mov_b32 v250, 0x3f803f80
  v_mov_b32 v251, 0x3f803f80
  v_mov_b32 v252, 0x3f803f80
  v_mov_b32 v253, 0x3f803f80
  v_mov_b32 v254, 0x3f803f80
  v_mov_b32 v255, 0x3f803f80
  s_cmp_lg_u32 s32, 0
  s_cbranch_scc1 FL_kv0d
  s_lshl_b32 s90, s33, 7
  s_add_u32 s90, s90, 0x3d07000
  v_mov_b32 v30, s90
FL_kv0:
  buffer_load_dword v31, v30, s[4:7], 0 offen sc1
  s_waitcnt vmcnt(0)
  v_readfirstlane_b32 s90, v31
  s_add_u32 s46, s46, 1
  s_cmp_ge_u32 s46, 131072
  s_cbranch_scc1 FL_rec_abort
  s_sleep 2
  s_cmp_lt_u32 s90, 16
  s_cbranch_scc1 FL_kv0
FL_kv0d:
  s_barrier
  buffer_load_dwordx4 v[180:183], v12, s[4:7], s44 offen offset:0
  buffer_load_dwordx4 v[184:187], v12, s[4:7], s44 offen offset:128
  buffer_load_dwordx4 v[188:191], v12, s[4:7], s44 offen offset:1024
  buffer_load_dwordx4 v[192:195], v12, s[4:7], s44 offen offset:1152
  buffer_load_dwordx4 v[196:199], v13, s[4:7], s44 offen offset:0
  buffer_load_dwordx4 v[200:203], v13, s[4:7], s44 offen offset:128
  buffer_load_dwordx4 v[204:207], v13, s[4:7], s44 offen offset:1024
  buffer_load_dwordx4 v[208:211], v13, s[4:7], s44 offen offset:1152
  buffer_load_dwordx4 v[116:119], v11, s[4:7], s44 offen offset:0
  buffer_load_dwordx4 v[132:135], v11, s[4:7], s44 offen offset:64
  buffer_load_dwordx4 v[120:123], v11, s[4:7], s44 offen offset:1024
  buffer_load_dwordx4 v[136:139], v11, s[4:7], s44 offen offset:1088
  buffer_load_dwordx4 v[124:127], v11, s[4:7], s44 offen offset:2048
  buffer_load_dwordx4 v[140:143], v11, s[4:7], s44 offen offset:2112
  buffer_load_dwordx4 v[128:131], v11, s[4:7], s44 offen offset:3072
  buffer_load_dwordx4 v[144:147], v11, s[4:7], s44 offen offset:3136
  s_add_u32 s44, s44, 0x40000
  v_mov_b64 v[64:65], 0
  v_mov_b64 v[66:67], 0
  v_mov_b64 v[68:69], 0
  v_mov_b64 v[70:71], 0
  v_mov_b64 v[72:73], 0
  v_mov_b64 v[74:75], 0
  v_mov_b64 v[76:77], 0
  v_mov_b64 v[78:79], 0
  v_mov_b64 v[80:81], 0
  v_mov_b64 v[82:83], 0
  v_mov_b64 v[84:85], 0
  v_mov_b64 v[86:87], 0
  v_mov_b64 v[32:33], 0
  v_mov_b64 v[34:35], 0
  v_mov_b64 v[212:213], 0
  v_mov_b64 v[214:215], 0
  v_mov_b64 v[216:217], 0
  v_mov_b64 v[218:219], 0
  v_mov_b64 v[220:221], 0
  v_mov_b64 v[222:223], 0
  v_mov_b64 v[224:225], 0
  v_mov_b64 v[226:227], 0
  v_mov_b64 v[228:229], 0
  v_mov_b64 v[230:231], 0
  s_waitcnt vmcnt(0)
  v_min_u32 v44, s54, v44
  s_lshl_b32 s90, s33, 7
  s_add_u32 s90, s90, 0x3d07000
  v_mov_b32 v244, s90
  s_lshl_b32 s90, s34, 2
  s_add_u32 s90, s90, s32
  s_lshl_b32 s91, s33, 7
  s_add_u32 s91, s91, 0x3d00000
  v_mbcnt_lo_u32_b32 v30, -1, 0
  v_mbcnt_hi_u32_b32 v30, -1, v30
  v_add_u32 v30, s90, v30
  v_cmp_eq_u32 vcc, 0, v30
  v_mov_b32 v30, 0x80000000
  v_mov_b32 v31, s91
  v_cndmask_b32 v245, v30, v31, vcc
  s_mov_b64 s[8:9], s[94:95]
  s_mov_b64 s[10:11], s[94:95]
  s_branch FL_pubmem
FL_step:
  s_load_dword s16, s[8:9], 256
  s_load_dword s17, s[10:11], 256
  s_load_dword s18, s[8:9], 320
  s_load_dword s19, s[10:11], 320
  s_load_dword s20, s[8:9], 384
  s_load_dword s21, s[10:11], 384
  s_load_dword s22, s[8:9], 448
  s_load_dword s23, s[10:11], 448
  buffer_load_dwordx4 v[200:203], v13, s[4:7], s44 offen offset:128
  buffer_load_dwordx4 v[204:207], v13, s[4:7], s44 offen offset:1024
  buffer_load_dwordx4 v[208:211], v13, s[4:7], s44 offen offset:1152
  buffer_load_dwordx4 v[128:131], v11, s[4:7], s44 offen offset:3072
  buffer_load_dwordx4 v[144:147], v11, s[4:7], s44 offen offset:3136
  v_mov_b64 v[64:65], 0
  v_mov_b64 v[66:67], 0
  v_mov_b64 v[68:69], 0
  v_mov_b64 v[70:71], 0
  v_mov_b64 v[72:73], 0
  v_mov_b64 v[74:75], 0
  v_mov_b64 v[76:77], 0
  v_mov_b64 v[78:79], 0
  v_mov_b64 v[80:81], 0
  v_mov_b64 v[82:83], 0
  v_mov_b64 v[84:85], 0
  v_mov_b64 v[86:87], 0
  v_mov_b64 v[32:33], 0
  v_mov_b64 v[34:35], 0
  buffer_load_dwordx4 v[36:39], v1, s[4:7], s42 offen sc1
  buffer_store_dword v22, v18, s[4:7], s13 offen
  buffer_store_dword v22, v2, s[4:7], s13 offen
  buffer_store_dword v22, v7, s[4:7], s13 offen
  buffer_store_dword v22, v8, s[4:7], s13 offen
  s_add_u32 s44, s44, 0x40000
  s_min_u32 s44, s44, 0xfc0000
  s_add_u32 s45, s45, 0x10000
  s_waitcnt vmcnt(12)
FL_kv_chk:
  v_readfirstlane_b32 s90, v243
  s_cmp_lt_u32 s90, 16
  s_cbranch_scc1 FL_kv_f
  s_waitcnt vmcnt(4)
FL_g_chk:
  v_max3_u32 v31, v36, v37, v38
  v_max_u32 v31, v31, v39
  v_cmp_eq_u32 vcc, -1, v31
  v_mfma_f32_16x16x32_bf16 v[40:43], v[24:27], v[36:39], 0
  s_cbranch_vccnz FL_g_f
  s_nop 6
  v_add_f32_dpp v45, v40, v40 row_ror:8 row_mask:0xf bank_mask:0xf
  v_add_f32_dpp v46, v41, v41 row_ror:8 row_mask:0xf bank_mask:0xf
  v_cvt_pk_bf16_f32 v44, v45, v46
  v_min_u32 v44, s54, v44
FL_pubmem:
  buffer_store_dword v44, v2, s[4:7], s41 offen
  v_mov_b32 v148, v180
  v_mov_b32 v150, v181
  v_mov_b32 v152, v182
  v_mov_b32 v154, v183
  v_mov_b32 v149, v184
  v_mov_b32 v151, v185
  v_mov_b32 v153, v186
  v_mov_b32 v155, v187
  v_mov_b32 v156, v188
  v_mov_b32 v158, v189
  v_mov_b32 v160, v190
  v_mov_b32 v162, v191
  v_mov_b32 v157, v192
  v_mov_b32 v159, v193
  v_mov_b32 v161, v194
  v_mov_b32 v163, v195
  v_mov_b32 v164, v196
  v_mov_b32 v166, v197
  v_mov_b32 v168, v198
  v_mov_b32 v170, v199
  v_mov_b32 v165, v200
  v_mov_b32 v167, v201
  v_mov_b32 v169, v202
  v_mov_b32 v171, v203
  buffer_load_dwordx4 v[48:51], v3, s[4:7], s41 offen offset:0 sc1
  v_mov_b32 v172, v204
  v_mov_b32 v174, v205
  buffer_load_dwordx4 v[52:55], v3, s[4:7], s41 offen offset:1024 sc1
  v_mov_b32 v176, v206
  v_mov_b32 v178, v207
  buffer_load_dwordx4 v[56:59], v3, s[4:7], s41 offen offset:2048 sc1
  v_mov_b32 v173, v208
  v_mov_b32 v175, v209
  buffer_load_dwordx4 v[60:63], v3, s[4:7], s41 offen offset:3072 sc1
  v_mov_b32 v177, v210
  v_mov_b32 v179, v211
  s_waitcnt vmcnt(3)
  v_max3_u32 v31, v48, v49, v50
  v_max_u32 v31, v31, v51
  v_cmp_eq_u32 vcc, -1, v31
  s_cbranch_vccnz FL_m_f0
  v_smfmac_f32_16x16x64_bf16 v[64:67], v[48:51], a[0:7], v23
  s_waitcnt vmcnt(2)
  v_max3_u32 v31, v52, v53, v54
  v_max_u32 v31, v31, v55
  v_cmp_eq_u32 vcc, -1, v31
  v_smfmac_f32_16x16x64_bf16 v[68:71], v[48:51], a[8:15], v23
  v_smfmac_f32_16x16x64_bf16 v[72:75], v[48:51], a[16:23], v23
  v_smfmac_f32_16x16x64_bf16 v[76:79], v[48:51], a[24:31], v23
  s_cbranch_vccnz FL_m_f1
  v_smfmac_f32_16x16x64_bf16 v[64:67], v[52:55], a[48:55], v23
  s_waitcnt vmcnt(1)
  v_max3_u32 v31, v56, v57, v58
  v_max_u32 v31, v31, v59
  v_cmp_eq_u32 vcc, -1, v31
  v_smfmac_f32_16x16x64_bf16 v[68:71], v[52:55], a[56:63], v23
  v_smfmac_f32_16x16x64_bf16 v[72:75], v[52:55], a[64:71], v23
  v_smfmac_f32_16x16x64_bf16 v[76:79], v[52:55], a[72:79], v23
  s_cbranch_vccnz FL_m_f2
  v_smfmac_f32_16x16x64_bf16 v[64:67], v[56:59], a[96:103], v23
  s_waitcnt vmcnt(0)
  v_max3_u32 v31, v60, v61, v62
  v_max_u32 v31, v31, v63
  v_cmp_eq_u32 vcc, -1, v31
  v_smfmac_f32_16x16x64_bf16 v[68:71], v[56:59], a[104:111], v23
  v_smfmac_f32_16x16x64_bf16 v[72:75], v[56:59], a[112:119], v23
  v_smfmac_f32_16x16x64_bf16 v[76:79], v[56:59], a[120:127], v23
  s_cbranch_vccnz FL_m_f3
  v_smfmac_f32_16x16x64_bf16 v[64:67], v[60:63], a[144:151], v23
  v_smfmac_f32_16x16x64_bf16 v[68:71], v[60:63], a[152:159], v23
  v_smfmac_f32_16x16x64_bf16 v[72:75], v[60:63], a[160:167], v23
  v_smfmac_f32_16x16x64_bf16 v[76:79], v[60:63], a[168:175], v23
FL_m_done:
  s_nop 4
  v_pk_add_f32 v[88:89], v[64:65], v[66:67]
  v_pk_add_f32 v[90:91], v[68:69], v[70:71]
  ds_write_b128 v4, v[88:91] offset:0
  v_pk_add_f32 v[92:93], v[72:73], v[74:75]
  v_pk_add_f32 v[94:95], v[76:77], v[78:79]
  ds_write_b128 v4, v[92:95] offset:1088
  v_smfmac_f32_16x16x64_bf16 v[80:83], v[48:51], a[32:39], v23
  buffer_load_dwordx4 v[180:183], v12, s[4:7], s44 offen offset:0
  v_mov_b32 v36, 0
  v_smfmac_f32_16x16x64_bf16 v[84:87], v[48:51], a[40:47], v23
  buffer_load_dwordx4 v[184:187], v12, s[4:7], s44 offen offset:128
  v_mov_b32 v37, 0
  v_smfmac_f32_16x16x64_bf16 v[80:83], v[52:55], a[80:87], v23
  buffer_load_dwordx4 v[188:191], v12, s[4:7], s44 offen offset:1024
  v_mov_b32 v38, 0
  v_smfmac_f32_16x16x64_bf16 v[84:87], v[52:55], a[88:95], v23
  buffer_load_dwordx4 v[192:195], v12, s[4:7], s44 offen offset:1152
  v_mov_b32 v39, 0
  v_smfmac_f32_16x16x64_bf16 v[80:83], v[56:59], a[128:135], v23
  buffer_load_dwordx4 v[196:199], v13, s[4:7], s44 offen offset:0
  v_mov_b32 v40, 0
  s_waitcnt lgkmcnt(0)
  s_barrier
  ds_read2_b32 v[100:101], v6 offset0:0 offset1:2
  ds_read2_b32 v[102:103], v240 offset0:0 offset1:2
  ds_read2_b32 v[104:105], v241 offset0:0 offset1:2
  ds_read2_b32 v[106:107], v242 offset0:0 offset1:2
  v_smfmac_f32_16x16x64_bf16 v[84:87], v[56:59], a[136:143], v23
  v_mov_b32 v41, 0
  v_smfmac_f32_16x16x64_bf16 v[80:83], v[60:63], a[176:183], v23
  v_mov_b32 v42, 0
  v_smfmac_f32_16x16x64_bf16 v[84:87], v[60:63], a[184:191], v23
  v_mov_b32 v43, 0
  v_mov_b32 v44, 0
  v_mov_b32 v45, 0
  v_mov_b32 v46, 0
  v_mov_b32 v47, 0
  s_waitcnt lgkmcnt(2)
  v_pk_add_f32 v[100:101], v[100:101], v[102:103]
  s_waitcnt lgkmcnt(0)
  v_pk_add_f32 v[104:105], v[104:105], v[106:107]
  v_pk_add_f32 v[100:101], v[100:101], v[104:105]
  v_cvt_pk_bf16_f32 v112, v100, v101
  v_min_u32 v112, s54, v112
  buffer_store_dword v112, v7, s[4:7], s41 offen
  v_pk_add_f32 v[96:97], v[80:81], v[82:83]
  v_pk_add_f32 v[98:99], v[84:85], v[86:87]
  ds_write_b128 v4, v[96:99] offset:2176
  v_mov_b64 v[212:213], 0
  v_mov_b64 v[214:215], 0
  v_mov_b64 v[216:217], 0
  v_mov_b64 v[218:219], 0
  v_mov_b64 v[220:221], 0
  v_mov_b64 v[222:223], 0
  v_mov_b64 v[224:225], 0
  v_mov_b64 v[226:227], 0
  v_mov_b64 v[228:229], 0
  v_mov_b64 v[230:231], 0
  s_waitcnt lgkmcnt(0)
  s_barrier
  ds_read_b64 v[88:89], v5 offset:0
  buffer_load_dwordx4 v[64:67], v9, s[4:7], s41 offen offset:0 sc1
  s_mov_b32 s42, s41
  s_add_u32 s90, s40, 1
  ds_read_b64 v[90:91], v5 offset:3264
  buffer_load_dwordx4 v[68:71], v9, s[4:7], s41 offen offset:1024 sc1
  s_and_b32 s90, s90, 3
  s_lshl_b32 s90, s90, 19
  ds_read_b64 v[92:93], v5 offset:6528
  buffer_load_dwordx4 v[72:75], v9, s[4:7], s41 offen offset:2048 sc1
  s_add_u32 s91, s90, 0x3800000
  s_add_u32 s55, s55, 0x40000
  ds_read_b64 v[94:95], v5 offset:9792
  buffer_load_dwordx4 v[76:79], v9, s[4:7], s41 offen offset:3072 sc1
  s_min_u32 s55, s55, 0xfc0000
  s_nop 0
  s_waitcnt lgkmcnt(2)
  v_pk_add_f32 v[88:89], v[88:89], v[90:91]
  s_waitcnt lgkmcnt(0)
  v_pk_add_f32 v[92:93], v[92:93], v[94:95]
  v_pk_add_f32 v[88:89], v[88:89], v[92:93]
  v_cvt_pk_bf16_f32 v113, v88, v89
  v_min_u32 v113, s54, v113
  buffer_store_dword v113, v8, s[4:7], s41 offen
  s_add_u32 s8, s94, s55
  s_addc_u32 s9, s95, 0
  s_add_u32 s8, s8, s12
  s_addc_u32 s9, s9, 0
  s_add_u32 s10, s8, 0x1000000
  s_addc_u32 s11, s9, 0
  s_load_dword s16, s[8:9], 0
  s_load_dword s17, s[10:11], 0
  s_load_dword s18, s[8:9], 64
  s_load_dword s19, s[10:11], 64
  s_load_dword s20, s[8:9], 128
  s_load_dword s21, s[10:11], 128
  s_load_dword s22, s[8:9], 192
  s_load_dword s23, s[10:11], 192
  s_cmp_eq_u32 s40, 63
  s_cbranch_scc1 FL_last
  s_waitcnt vmcnt(4)
  v_max3_u32 v31, v64, v65, v66
  v_max_u32 v31, v31, v67
  v_cmp_eq_u32 vcc, -1, v31
  s_cbranch_vccnz FL_x_f0
  v_mfma_f32_16x16x32_bf16 v[44:47], v[64:67], v[64:67], v[44:47]
  s_waitcnt vmcnt(3)
  v_max3_u32 v31, v68, v69, v70
  v_max_u32 v31, v31, v71
  v_cmp_eq_u32 vcc, -1, v31
  v_mfma_f32_16x16x32_bf16 v[36:39], v[116:119], v[64:67], v[36:39]
  v_mfma_f32_16x16x32_bf16 v[40:43], v[132:135], v[64:67], v[40:43]
  s_cbranch_vccnz FL_x_f1
  v_mfma_f32_16x16x32_bf16 v[44:47], v[68:71], v[68:71], v[44:47]
  s_waitcnt vmcnt(2)
  v_max3_u32 v31, v72, v73, v74
  v_max_u32 v31, v31, v75
  v_cmp_eq_u32 vcc, -1, v31
  v_mfma_f32_16x16x32_bf16 v[36:39], v[120:123], v[68:71], v[36:39]
  v_mfma_f32_16x16x32_bf16 v[40:43], v[136:139], v[68:71], v[40:43]
  s_cbranch_vccnz FL_x_f2
  v_mfma_f32_16x16x32_bf16 v[44:47], v[72:75], v[72:75], v[44:47]
  s_waitcnt vmcnt(1)
  v_max3_u32 v31, v76, v77, v78
  v_max_u32 v31, v31, v79
  v_cmp_eq_u32 vcc, -1, v31
  v_mfma_f32_16x16x32_bf16 v[36:39], v[124:127], v[72:75], v[36:39]
  v_mfma_f32_16x16x32_bf16 v[40:43], v[140:143], v[72:75], v[40:43]
  s_cbranch_vccnz FL_x_f3
  v_mfma_f32_16x16x32_bf16 v[44:47], v[76:79], v[76:79], v[44:47]
  v_mfma_f32_16x16x32_bf16 v[36:39], v[128:131], v[76:79], v[36:39]
  v_mfma_f32_16x16x32_bf16 v[40:43], v[144:147], v[76:79], v[40:43]
FL_x_done:
  buffer_load_dwordx4 v[88:91], v10, s[4:7], s41 offen offset:0 sc1
  buffer_load_dwordx4 v[92:95], v10, s[4:7], s41 offen offset:1024 sc1
  s_mov_b64 vcc, s[48:49]
  s_nop 2
  v_max_f32 v30, v46, v47
  s_nop 0
  v_cndmask_b32_dpp v96, v40, v36, vcc quad_perm:[0,1,0,1] row_mask:0xf bank_mask:0xf
  v_cndmask_b32_dpp v97, v41, v37, vcc quad_perm:[0,1,0,1] row_mask:0xf bank_mask:0xf
  v_cndmask_b32_dpp v98, v42, v38, vcc quad_perm:[0,1,0,1] row_mask:0xf bank_mask:0xf
  v_cndmask_b32_dpp v99, v43, v39, vcc quad_perm:[0,1,0,1] row_mask:0xf bank_mask:0xf
  v_max3_f32 v29, v96, v97, v98
  s_nop 0
  v_max_f32_dpp v28, v30, v99 quad_perm:[0,1,0,1] row_mask:0xf bank_mask:0xf
  v_max_f32 v29, v29, v28
  s_nop 1
  v_max_f32_dpp v28, v29, v29 quad_perm:[2,3,0,1] row_mask:0xf bank_mask:0xf
  v_mov_b32 v29, v28
  s_nop 1
  v_permlane32_swap_b32 v28, v29
  v_max_f32 v28, v28, v29
  v_mov_b32 v29, v28
  s_nop 1
  v_permlane16_swap_b32 v28, v29
  v_max_f32 v28, v28, v29
  v_mul_f32 v28, s47, v28
  v_fma_f32 v96, v96, s47, -v28
  v_fma_f32 v97, v97, s47, -v28
  v_fma_f32 v98, v98, s47, -v28
  v_fma_f32 v99, v99, s47, -v28
  v_fma_f32 v46, v46, s47, -v28
  v_fma_f32 v47, v47, s47, -v28
  v_exp_f32 v96, v96
  v_exp_f32 v97, v97
  v_exp_f32 v98, v98
  v_exp_f32 v99, v99
  v_cvt_pk_bf16_f32 v236, v96, v97
  v_cvt_pk_bf16_f32 v237, v98, v99
  v_exp_f32 v46, v46
  v_mov_b32_dpp v100, v236 quad_perm:[0,1,0,1] row_mask:0xf bank_mask:0xf
  v_mov_b32_dpp v102, v236 quad_perm:[2,3,2,3] row_mask:0xf bank_mask:0xf
  v_mov_b32_dpp v101, v237 quad_perm:[0,1,0,1] row_mask:0xf bank_mask:0xf
  v_mov_b32_dpp v103, v237 quad_perm:[2,3,2,3] row_mask:0xf bank_mask:0xf
  v_exp_f32 v47, v47
  s_nop 0
  v_smfmac_f32_16x16x64_bf16 v[228:231], v[100:103], v[248:255], v23
  v_cvt_pk_bf16_f32 v238, v46, v47
  buffer_load_dwordx4 v[116:119], v11, s[4:7], s44 offen offset:0
  v_smfmac_f32_16x16x64_bf16 v[212:215], v[100:103], v[148:155], v23
  buffer_load_dwordx4 v[132:135], v11, s[4:7], s44 offen offset:64
  v_mov_b32_dpp v232, v238 quad_perm:[0,1,0,1] row_mask:0xf bank_mask:0xf
  v_smfmac_f32_16x16x64_bf16 v[216:219], v[100:103], v[156:163], v23
  buffer_load_dwordx4 v[120:123], v11, s[4:7], s44 offen offset:1024
  v_mov_b32_dpp v235, v238 quad_perm:[0,1,0,1] row_mask:0xf bank_mask:0xf
  v_smfmac_f32_16x16x64_bf16 v[220:223], v[100:103], v[164:171], v23
  buffer_load_dwordx4 v[136:139], v11, s[4:7], s44 offen offset:1088
  s_waitcnt vmcnt(4)
  v_max3_u32 v31, v88, v89, v90
  v_max3_u32 v31, v31, v91, v92
  v_smfmac_f32_16x16x32_bf16 v[228:231], v[232:233], v[248:251], v23
  v_max3_u32 v31, v31, v93, v94
  v_max_u32 v31, v31, v95
  v_cmp_eq_u32 vcc, -1, v31
  v_smfmac_f32_16x16x64_bf16 v[224:227], v[100:103], v[172:179], v23
  s_cbranch_vccnz FL_v_f
FL_v_ok:
  v_smfmac_f32_16x16x32_bf16 v[212:215], v[232:233], v[88:91], v23
  buffer_load_dwordx4 v[124:127], v11, s[4:7], s44 offen offset:2048
  buffer_load_dwordx4 v[140:143], v11, s[4:7], s44 offen offset:2112
  v_smfmac_f32_16x16x32_bf16 v[216:219], v[234:235], v[88:91], v23
  v_rcp_f32 v28, v228
  v_smfmac_f32_16x16x32_bf16 v[220:223], v[232:233], v[92:95], v23
  v_rcp_f32 v29, v229
  v_smfmac_f32_16x16x32_bf16 v[224:227], v[234:235], v[92:95], v23
  s_nop 0
  v_pk_mul_f32 v[212:213], v[212:213], v[28:29]
  v_pk_mul_f32 v[214:215], v[214:215], v[28:29]
  v_cvt_pk_bf16_f32 v104, v212, v214
  v_cvt_pk_bf16_f32 v108, v213, v215
  v_pk_mul_f32 v[216:217], v[216:217], v[28:29]
  v_pk_mul_f32 v[218:219], v[218:219], v[28:29]
  v_cvt_pk_bf16_f32 v105, v216, v218
  v_cvt_pk_bf16_f32 v109, v217, v219
  v_pk_mul_f32 v[220:221], v[220:221], v[28:29]
  v_pk_mul_f32 v[222:223], v[222:223], v[28:29]
  v_cvt_pk_bf16_f32 v106, v220, v222
  v_cvt_pk_bf16_f32 v110, v221, v223
  v_pk_mul_f32 v[224:225], v[224:225], v[28:29]
  v_pk_mul_f32 v[226:227], v[226:227], v[28:29]
  v_cvt_pk_bf16_f32 v107, v224, v226
  v_cvt_pk_bf16_f32 v111, v225, v227
  ds_write_b128 v14, v[104:107]
  ds_write_b128 v15, v[108:111]
  s_add_u32 s92, s40, 3
  s_min_u32 s92, s92, 63
  s_lshr_b32 s92, s92, 2
  s_lshl_b32 s92, s92, 9
  v_mov_b32 v246, s40
  s_waitcnt lgkmcnt(0)
  s_barrier
  ds_read_b128 v[48:51], v16 offset:0
  ds_read_b128 v[52:55], v16 offset:1024
  ds_read_b128 v[56:59], v16 offset:2048
  ds_read_b128 v[60:63], v16 offset:3072
  ds_read_b128 v[64:67], v16 offset:4096
  buffer_store_dword v22, v17, s[4:7], s43 offen sc1
  buffer_store_dword v112, v19, s[4:7], s45 offen sc1
  s_waitcnt lgkmcnt(4)
  v_smfmac_f32_16x16x64_bf16 v[32:35], v[48:51], a[192:199], v23
  ds_read_b128 v[68:71], v16 offset:5120
  buffer_store_dword v113, v20, s[4:7], s45 offen sc1
  s_waitcnt lgkmcnt(4)
  v_smfmac_f32_16x16x64_bf16 v[32:35], v[52:55], a[200:207], v23
  ds_read_b128 v[72:75], v16 offset:6144
  buffer_store_dword v246, v245, s[4:7], 0 offen sc1
  s_waitcnt lgkmcnt(4)
  v_smfmac_f32_16x16x64_bf16 v[32:35], v[56:59], a[208:215], v23
  ds_read_b128 v[76:79], v16 offset:7168
  buffer_load_dword v243, v244, s[4:7], s92 offen sc1
  s_waitcnt lgkmcnt(4)
  v_smfmac_f32_16x16x64_bf16 v[32:35], v[60:63], a[216:223], v23
  s_mov_b32 s13, s43
  s_waitcnt lgkmcnt(3)
  v_smfmac_f32_16x16x64_bf16 v[32:35], v[64:67], a[224:231], v23
  s_add_u32 s40, s40, 1
  s_waitcnt lgkmcnt(2)
  v_smfmac_f32_16x16x64_bf16 v[32:35], v[68:71], a[232:239], v23
  s_mov_b32 s41, s91
  s_waitcnt lgkmcnt(1)
  v_smfmac_f32_16x16x64_bf16 v[32:35], v[72:75], a[240:247], v23
  s_xor_b32 s43, s91, 0x100000
  s_waitcnt lgkmcnt(0)
  v_smfmac_f32_16x16x64_bf16 v[32:35], v[76:79], a[248:255], v23
  s_nop 7
  v_pk_add_f32 v[28:29], v[32:33], v[34:35]
  v_cvt_pk_bf16_f32 v28, v28, v29
  v_min_u32 v28, s54, v28
  buffer_store_dword v28, v17, s[4:7], s42 offen sc1
  buffer_store_dword v28, v18, s[4:7], s42 offen
  s_branch FL_step
FL_last:
  buffer_store_dword v112, v19, s[4:7], s45 offen sc1
  buffer_store_dword v113, v20, s[4:7], s45 offen sc1
  s_waitcnt vmcnt(0)
  s_barrier
  s_lshl_b32 s90, s35, 7
  s_add_u32 s90, s90, 0x3d01000
  s_cmp_lg_u32 s32, 0
  s_cbranch_scc1 FL_sig_8
  v_mov_b32 v254, 1
  v_mov_b32 v255, 0
  s_mov_b64 exec, 1
  buffer_atomic_add v254, v255, s[4:7], s90 offen offset:0 sc1
  s_mov_b64 exec, -1
FL_sig_8:
  s_waitcnt vmcnt(0)
  s_branch L_join
FL_kv_f:
  s_sleep 8
  buffer_load_dword v243, v244, s[4:7], s92 offen sc1
  s_add_u32 s46, s46, 1
  s_cmp_ge_u32 s46, 131072
  s_cbranch_scc1 FL_rec_abort
  s_waitcnt vmcnt(0)
  s_branch FL_kv_chk
FL_g_f:
  s_mov_b64 exec, vcc
  buffer_load_dwordx4 v[36:39], v1, s[4:7], s42 offen sc1
  s_mov_b64 exec, -1
  s_add_u32 s46, s46, 1
  s_cmp_ge_u32 s46, 131072
  s_cbranch_scc1 FL_rec_abort
  s_waitcnt vmcnt(0)
  s_branch FL_g_chk
FL_m_f0:
  s_mov_b64 exec, vcc
  buffer_load_dwordx4 v[48:51], v3, s[4:7], s41 offen offset:0 sc1
  s_mov_b64 exec, -1
  s_waitcnt vmcnt(1)
  s_branch FL_m_0123_c1
FL_m_f1:
  s_mov_b64 exec, vcc
  buffer_load_dwordx4 v[52:55], v3, s[4:7], s41 offen offset:1024 sc1
  s_mov_b64 exec, -1
  s_waitcnt vmcnt(1)
  s_branch FL_m_123_c2
FL_m_f2:
  s_mov_b64 exec, vcc
  buffer_load_dwordx4 v[56:59], v3, s[4:7], s41 offen offset:2048 sc1
  s_mov_b64 exec, -1
  s_waitcnt vmcnt(1)
  s_branch FL_m_23_c3
FL_m_f3:
  s_mov_b64 exec, vcc
  buffer_load_dwordx4 v[60:63], v3, s[4:7], s41 offen offset:3072 sc1
  s_mov_b64 exec, -1
  s_nop 7
  s_branch FL_m_3_c3
FL_m_0_c0:
  v_max3_u32 v31, v48, v49, v50
  v_max_u32 v31, v31, v51
  v_cmp_eq_u32 vcc, -1, v31
  s_cbranch_vccz FL_m_0_ok0
FL_m_0_x0:
  s_mov_b64 exec, vcc
  buffer_load_dwordx4 v[48:51], v3, s[4:7], s41 offen offset:0 sc1
  s_mov_b64 exec, -1
  s_add_u32 s46, s46, 1
  s_cmp_ge_u32 s46, 131072
  s_cbranch_scc1 FL_rec_abort
  s_waitcnt vmcnt(2)
  s_branch FL_m_0_c0
FL_m_0_ok0:
  v_smfmac_f32_16x16x64_bf16 v[64:67], v[48:51], a[0:7], v23
  v_smfmac_f32_16x16x64_bf16 v[68:71], v[48:51], a[8:15], v23
  v_smfmac_f32_16x16x64_bf16 v[72:75], v[48:51], a[16:23], v23
  v_smfmac_f32_16x16x64_bf16 v[76:79], v[48:51], a[24:31], v23
  s_branch FL_m_done
FL_m_1_c1:
  v_max3_u32 v31, v52, v53, v54
  v_max_u32 v31, v31, v55
  v_cmp_eq_u32 vcc, -1, v31
  s_cbranch_vccz FL_m_1_ok1
FL_m_1_x1:
  s_mov_b64 exec, vcc
  buffer_load_dwordx4 v[52:55], v3, s[4:7], s41 offen offset:1024 sc1
  s_mov_b64 exec, -1
  s_add_u32 s46, s46, 1
  s_cmp_ge_u32 s46, 131072
  s_cbranch_scc1 FL_rec_abort
  s_waitcnt vmcnt(2)
  s_branch FL_m_1_c1
FL_m_1_ok1:
  v_smfmac_f32_16x16x64_bf16 v[64:67], v[52:55], a[48:55], v23
  v_smfmac_f32_16x16x64_bf16 v[68:71], v[52:55], a[56:63], v23
  v_smfmac_f32_16x16x64_bf16 v[72:75], v[52:55], a[64:71], v23
  v_smfmac_f32_16x16x64_bf16 v[76:79], v[52:55], a[72:79], v23
  s_branch FL_m_done
FL_m_2_c2:
  v_max3_u32 v31, v56, v57, v58
  v_max_u32 v31, v31, v59
  v_cmp_eq_u32 vcc, -1, v31
  s_cbranch_vccz FL_m_2_ok2
FL_m_2_x2:
  s_mov_b64 exec, vcc
  buffer_load_dwordx4 v[56:59], v3, s[4:7], s41 offen offset:2048 sc1
  s_mov_b64 exec, -1
  s_add_u32 s46, s46, 1
  s_cmp_ge_u32 s46, 131072
  s_cbranch_scc1 FL_rec_abort
  s_waitcnt vmcnt(2)
  s_branch FL_m_2_c2
FL_m_2_ok2:
  v_smfmac_f32_16x16x64_bf16 v[64:67], v[56:59], a[96:103], v23
  v_smfmac_f32_16x16x64_bf16 v[68:71], v[56:59], a[104:111], v23
  v_smfmac_f32_16x16x64_bf16 v[72:75], v[56:59], a[112:119], v23
  v_smfmac_f32_16x16x64_bf16 v[76:79], v[56:59], a[120:127], v23
  s_branch FL_m_done
FL_m_3_c3:
  v_max3_u32 v31, v60, v61, v62
  v_max_u32 v31, v31, v63
  v_cmp_eq_u32 vcc, -1, v31
  s_cbranch_vccz FL_m_3_ok3
FL_m_3_x3:
  s_mov_b64 exec, vcc
  buffer_load_dwordx4 v[60:63], v3, s[4:7], s41 offen offset:3072 sc1
  s_mov_b64 exec, -1
  s_add_u32 s46, s46, 1
  s_cmp_ge_u32 s46, 131072
  s_cbranch_scc1 FL_rec_abort
  s_waitcnt vmcnt(2)
  s_branch FL_m_3_c3
FL_m_3_ok3:
  v_smfmac_f32_16x16x64_bf16 v[64:67], v[60:63], a[144:151], v23
  v_smfmac_f32_16x16x64_bf16 v[68:71], v[60:63], a[152:159], v23
  v_smfmac_f32_16x16x64_bf16 v[72:75], v[60:63], a[160:167], v23
  v_smfmac_f32_16x16x64_bf16 v[76:79], v[60:63], a[168:175], v23
  s_branch FL_m_done
FL_m_01_c0:
  v_max3_u32 v31, v48, v49, v50
  v_max_u32 v31, v31, v51
  v_cmp_eq_u32 vcc, -1, v31
  s_cbranch_vccz FL_m_01_ok0
FL_m_01_x0:
  s_mov_b64 exec, vcc
  buffer_load_dwordx4 v[48:51], v3, s[4:7], s41 offen offset:0 sc1
  s_mov_b64 exec, -1
FL_m_01_c1:
  v_max3_u32 v31, v52, v53, v54
  v_max_u32 v31, v31, v55
  v_cmp_eq_u32 vcc, -1, v31
  s_cbranch_vccz FL_m_01_ok1
FL_m_01_x1:
  s_mov_b64 exec, vcc
  buffer_load_dwordx4 v[52:55], v3, s[4:7], s41 offen offset:1024 sc1
  s_mov_b64 exec, -1
  s_add_u32 s46, s46, 1
  s_cmp_ge_u32 s46, 131072
  s_cbranch_scc1 FL_rec_abort
  s_waitcnt vmcnt(4)
  s_branch FL_m_01_c0
FL_m_01_ok0:
  v_smfmac_f32_16x16x64_bf16 v[64:67], v[48:51], a[0:7], v23
  v_max3_u32 v31, v52, v53, v54
  v_max_u32 v31, v31, v55
  v_cmp_eq_u32 vcc, -1, v31
  v_smfmac_f32_16x16x64_bf16 v[68:71], v[48:51], a[8:15], v23
  v_smfmac_f32_16x16x64_bf16 v[72:75], v[48:51], a[16:23], v23
  v_smfmac_f32_16x16x64_bf16 v[76:79], v[48:51], a[24:31], v23
  s_cbranch_vccz FL_m_1_ok1
  s_branch FL_m_1_x1
FL_m_01_ok1:
  v_smfmac_f32_16x16x64_bf16 v[64:67], v[52:55], a[48:55], v23
  v_max3_u32 v31, v48, v49, v50
  v_max_u32 v31, v31, v51
  v_cmp_eq_u32 vcc, -1, v31
  v_smfmac_f32_16x16x64_bf16 v[68:71], v[52:55], a[56:63], v23
  v_smfmac_f32_16x16x64_bf16 v[72:75], v[52:55], a[64:71], v23
  v_smfmac_f32_16x16x64_bf16 v[76:79], v[52:55], a[72:79], v23
  s_cbranch_vccz FL_m_0_ok0
  s_branch FL_m_0_x0
FL_m_02_c0:
  v_max3_u32 v31, v48, v49, v50
  v_max_u32 v31, v31, v51
  v_cmp_eq_u32 vcc, -1, v31
  s_cbranch_vccz FL_m_02_ok0
FL_m_02_x0:
  s_mov_b64 exec, vcc
  buffer_load_dwordx4 v[48:51], v3, s[4:7], s41 offen offset:0 sc1
  s_mov_b64 exec, -1
FL_m_02_c2:
  v_max3_u32 v31, v56, v57, v58
  v_max_u32 v31, v31, v59
  v_cmp_eq_u32 vcc, -1, v31
  s_cbranch_vccz FL_m_02_ok2
FL_m_02_x2:
  s_mov_b64 exec, vcc
  buffer_load_dwordx4 v[56:59], v3, s[4:7], s41 offen offset:2048 sc1
  s_mov_b64 exec, -1
  s_add_u32 s46, s46, 1
  s_cmp_ge_u32 s46, 131072
  s_cbranch_scc1 FL_rec_abort
  s_waitcnt vmcnt(4)
  s_branch FL_m_02_c0
FL_m_02_ok0:
  v_smfmac_f32_16x16x64_bf16 v[64:67], v[48:51], a[0:7], v23
  v_max3_u32 v31, v56, v57, v58
  v_max_u32 v31, v31, v59
  v_cmp_eq_u32 vcc, -1, v31
  v_smfmac_f32_16x16x64_bf16 v[68:71], v[48:51], a[8:15], v23
  v_smfmac_f32_16x16x64_bf16 v[72:75], v[48:51], a[16:23], v23
  v_smfmac_f32_16x16x64_bf16 v[76:79], v[48:51], a[24:31], v23
  s_cbranch_vccz FL_m_2_ok2
  s_branch FL_m_2_x2
FL_m_02_ok2:
  v_smfmac_f32_16x16x64_bf16 v[64:67], v[56:59], a[96:103], v23
  v_max3_u32 v31, v48, v49, v50
  v_max_u32 v31, v31, v51
  v_cmp_eq_u32 vcc, -1, v31
  v_smfmac_f32_16x16x64_bf16 v[68:71], v[56:59], a[104:111], v23
  v_smfmac_f32_16x16x64_bf16 v[72:75], v[56:59], a[112:119], v23
  v_smfmac_f32_16x16x64_bf16 v[76:79], v[56:59], a[120:127], v23
  s_cbranch_vccz FL_m_0_ok0
  s_branch FL_m_0_x0
FL_m_03_c0:
  v_max3_u32 v31, v48, v49, v50
  v_max_u32 v31, v31, v51
  v_cmp_eq_u32 vcc, -1, v31
  s_cbranch_vccz FL_m_03_ok0
FL_m_03_x0:
  s_mov_b64 exec, vcc
  buffer_load_dwordx4 v[48:51], v3, s[4:7], s41 offen offset:0 sc1
  s_mov_b64 exec, -1
FL_m_03_c3:
  v_max3_u32 v31, v60, v61, v62
  v_max_u32 v31, v31, v63
  v_cmp_eq_u32 vcc, -1, v31
  s_cbranch_vccz FL_m_03_ok3
FL_m_03_x3:
  s_mov_b64 exec, vcc
  buffer_load_dwordx4 v[60:63], v3, s[4:7], s41 offen offset:3072 sc1
  s_mov_b64 exec, -1
  s_add_u32 s46, s46, 1
  s_cmp_ge_u32 s46, 131072
  s_cbranch_scc1 FL_rec_abort
  s_waitcnt vmcnt(4)
  s_branch FL_m_03_c0
FL_m_03_ok0:
  v_smfmac_f32_16x16x64_bf16 v[64:67], v[48:51], a[0:7], v23
  v_max3_u32 v31, v60, v61, v62
  v_max_u32 v31, v31, v63
  v_cmp_eq_u32 vcc, -1, v31
  v_smfmac_f32_16x16x64_bf16 v[68:71], v[48:51], a[8:15], v23
  v_smfmac_f32_16x16x64_bf16 v[72:75], v[48:51], a[16:23], v23
  v_smfmac_f32_16x16x64_bf16 v[76:79], v[48:51], a[24:31], v23
  s_cbranch_vccz FL_m_3_ok3
  s_branch FL_m_3_x3
FL_m_03_ok3:
  v_smfmac_f32_16x16x64_bf16 v[64:67], v[60:63], a[144:151], v23
  v_max3_u32 v31, v48, v49, v50
  v_max_u32 v31, v31, v51
  v_cmp_eq_u32 vcc, -1, v31
  v_smfmac_f32_16x16x64_bf16 v[68:71], v[60:63], a[152:159], v23
  v_smfmac_f32_16x16x64_bf16 v[72:75], v[60:63], a[160:167], v23
  v_smfmac_f32_16x16x64_bf16 v[76:79], v[60:63], a[168:175], v23
  s_cbranch_vccz FL_m_0_ok0
  s_branch FL_m_0_x0
FL_m_12_c1:
  v_max3_u32 v31, v52, v53, v54
  v_max_u32 v31, v31, v55
  v_cmp_eq_u32 vcc, -1, v31
  s_cbranch_vccz FL_m_12_ok1
FL_m_12_x1:
  s_mov_b64 exec, vcc
  buffer_load_dwordx4 v[52:55], v3, s[4:7], s41 offen offset:1024 sc1
  s_mov_b64 exec, -1
FL_m_12_c2:
  v_max3_u32 v31, v56, v57, v58
  v_max_u32 v31, v31, v59
  v_cmp_eq_u32 vcc, -1, v31
  s_cbranch_vccz FL_m_12_ok2
FL_m_12_x2:
  s_mov_b64 exec, vcc
  buffer_load_dwordx4 v[56:59], v3, s[4:7], s41 offen offset:2048 sc1
  s_mov_b64 exec, -1
  s_add_u32 s46, s46, 1
  s_cmp_ge_u32 s46, 131072
  s_cbranch_scc1 FL_rec_abort
  s_waitcnt vmcnt(4)
  s_branch FL_m_12_c1
FL_m_12_ok1:
  v_smfmac_f32_16x16x64_bf16 v[64:67], v[52:55], a[48:55], v23
  v_max3_u32 v31, v56, v57, v58
  v_max_u32 v31, v31, v59
  v_cmp_eq_u32 vcc, -1, v31
  v_smfmac_f32_16x16x64_bf16 v[68:71], v[52:55], a[56:63], v23
  v_smfmac_f32_16x16x64_bf16 v[72:75], v[52:55], a[64:71], v23
  v_smfmac_f32_16x16x64_bf16 v[76:79], v[52:55], a[72:79], v23
  s_cbranch_vccz FL_m_2_ok2
  s_branch FL_m_2_x2
FL_m_12_ok2:
  v_smfmac_f32_16x16x64_bf16 v[64:67], v[56:59], a[96:103], v23
  v_max3_u32 v31, v52, v53, v54
  v_max_u32 v31, v31, v55
  v_cmp_eq_u32 vcc, -1, v31
  v_smfmac_f32_16x16x64_bf16 v[68:71], v[56:59], a[104:111], v23
  v_smfmac_f32_16x16x64_bf16 v[72:75], v[56:59], a[112:119], v23
  v_smfmac_f32_16x16x64_bf16 v[76:79], v[56:59], a[120:127], v23
  s_cbranch_vccz FL_m_1_ok1
  s_branch FL_m_1_x1
FL_m_13_c1:
  v_max3_u32 v31, v52, v53, v54
  v_max_u32 v31, v31, v55
  v_cmp_eq_u32 vcc, -1, v31
  s_cbranch_vccz FL_m_13_ok1
FL_m_13_x1:
  s_mov_b64 exec, vcc
  buffer_load_dwordx4 v[52:55], v3, s[4:7], s41 offen offset:1024 sc1
  s_mov_b64 exec, -1
FL_m_13_c3:
  v_max3_u32 v31, v60, v61, v62
  v_max_u32 v31, v31, v63
  v_cmp_eq_u32 vcc, -1, v31
  s_cbranch_vccz FL_m_13_ok3
FL_m_13_x3:
  s_mov_b64 exec, vcc
  buffer_load_dwordx4 v[60:63], v3, s[4:7], s41 offen offset:3072 sc1
  s_mov_b64 exec, -1
  s_add_u32 s46, s46, 1
  s_cmp_ge_u32 s46, 131072
  s_cbranch_scc1 FL_rec_abort
  s_waitcnt vmcnt(4)
  s_branch FL_m_13_c1
FL_m_13_ok1:
  v_smfmac_f32_16x16x64_bf16 v[64:67], v[52:55], a[48:55], v23
  v_max3_u32 v31, v60, v61, v62
  v_max_u32 v31, v31, v63
  v_cmp_eq_u32 vcc, -1, v31
  v_smfmac_f32_16x16x64_bf16 v[68:71], v[52:55], a[56:63], v23
  v_smfmac_f32_16x16x64_bf16 v[72:75], v[52:55], a[64:71], v23
  v_smfmac_f32_16x16x64_bf16 v[76:79], v[52:55], a[72:79], v23
  s_cbranch_vccz FL_m_3_ok3
  s_branch FL_m_3_x3
FL_m_13_ok3:
  v_smfmac_f32_16x16x64_bf16 v[64:67], v[60:63], a[144:151], v23
  v_max3_u32 v31, v52, v53, v54
  v_max_u32 v31, v31, v55
  v_cmp_eq_u32 vcc, -1, v31
  v_smfmac_f32_16x16x64_bf16 v[68:71], v[60:63], a[152:159], v23
  v_smfmac_f32_16x16x64_bf16 v[72:75], v[60:63], a[160:167], v23
  v_smfmac_f32_16x16x64_bf16 v[76:79], v[60:63], a[168:175], v23
  s_cbranch_vccz FL_m_1_ok1
  s_branch FL_m_1_x1
FL_m_23_c2:
  v_max3_u32 v31, v56, v57, v58
  v_max_u32 v31, v31, v59
  v_cmp_eq_u32 vcc, -1, v31
  s_cbranch_vccz FL_m_23_ok2
FL_m_23_x2:
  s_mov_b64 exec, vcc
  buffer_load_dwordx4 v[56:59], v3, s[4:7], s41 offen offset:2048 sc1
  s_mov_b64 exec, -1
FL_m_23_c3:
  v_max3_u32 v31, v60, v61, v62
  v_max_u32 v31, v31, v63
  v_cmp_eq_u32 vcc, -1, v31
  s_cbranch_vccz FL_m_23_ok3
FL_m_23_x3:
  s_mov_b64 exec, vcc
  buffer_load_dwordx4 v[60:63], v3, s[4:7], s41 offen offset:3072 sc1
  s_mov_b64 exec, -1
  s_add_u32 s46, s46, 1
  s_cmp_ge_u32 s46, 131072
  s_cbranch_scc1 FL_rec_abort
  s_waitcnt vmcnt(4)
  s_branch FL_m_23_c2
FL_m_23_ok2:
  v_smfmac_f32_16x16x64_bf16 v[64:67], v[56:59], a[96:103], v23
  v_max3_u32 v31, v60, v61, v62
  v_max_u32 v31, v31, v63
  v_cmp_eq_u32 vcc, -1, v31
  v_smfmac_f32_16x16x64_bf16 v[68:71], v[56:59], a[104:111], v23
  v_smfmac_f32_16x16x64_bf16 v[72:75], v[56:59], a[112:119], v23
  v_smfmac_f32_16x16x64_bf16 v[76:79], v[56:59], a[120:127], v23
  s_cbranch_vccz FL_m_3_ok3
  s_branch FL_m_3_x3
FL_m_23_ok3:
  v_smfmac_f32_16x16x64_bf16 v[64:67], v[60:63], a[144:151], v23
  v_max3_u32 v31, v56, v57, v58
  v_max_u32 v31, v31, v59
  v_cmp_eq_u32 vcc, -1, v31
  v_smfmac_f32_16x16x64_bf16 v[68:71], v[60:63], a[152:159], v23
  v_smfmac_f32_16x16x64_bf16 v[72:75], v[60:63], a[160:167], v23
  v_smfmac_f32_16x16x64_bf16 v[76:79], v[60:63], a[168:175], v23
  s_cbranch_vccz FL_m_2_ok2
  s_branch FL_m_2_x2
FL_m_012_c0:
  v_max3_u32 v31, v48, v49, v50
  v_max_u32 v31, v31, v51
  v_cmp_eq_u32 vcc, -1, v31
  s_cbranch_vccz FL_m_012_ok0
FL_m_012_x0:
  s_mov_b64 exec, vcc
  buffer_load_dwordx4 v[48:51], v3, s[4:7], s41 offen offset:0 sc1
  s_mov_b64 exec, -1
FL_m_012_c1:
  v_max3_u32 v31, v52, v53, v54
  v_max_u32 v31, v31, v55
  v_cmp_eq_u32 vcc, -1, v31
  s_cbranch_vccz FL_m_012_ok1
FL_m_012_x1:
  s_mov_b64 exec, vcc
  buffer_load_dwordx4 v[52:55], v3, s[4:7], s41 offen offset:1024 sc1
  s_mov_b64 exec, -1
FL_m_012_c2:
  v_max3_u32 v31, v56, v57, v58
  v_max_u32 v31, v31, v59
  v_cmp_eq_u32 vcc, -1, v31
  s_cbranch_vccz FL_m_012_ok2
FL_m_012_x2:
  s_mov_b64 exec, vcc
  buffer_load_dwordx4 v[56:59], v3, s[4:7], s41 offen offset:2048 sc1
  s_mov_b64 exec, -1
  s_add_u32 s46, s46, 1
  s_cmp_ge_u32 s46, 131072
  s_cbranch_scc1 FL_rec_abort
  s_waitcnt vmcnt(4)
  s_branch FL_m_012_c0
FL_m_012_ok0:
  v_smfmac_f32_16x16x64_bf16 v[64:67], v[48:51], a[0:7], v23
  v_max3_u32 v31, v52, v53, v54
  v_max_u32 v31, v31, v55
  v_cmp_eq_u32 vcc, -1, v31
  v_smfmac_f32_16x16x64_bf16 v[68:71], v[48:51], a[8:15], v23
  v_smfmac_f32_16x16x64_bf16 v[72:75], v[48:51], a[16:23], v23
  v_smfmac_f32_16x16x64_bf16 v[76:79], v[48:51], a[24:31], v23
  s_cbranch_vccz FL_m_12_ok1
  s_branch FL_m_12_x1
FL_m_012_ok1:
  v_smfmac_f32_16x16x64_bf16 v[64:67], v[52:55], a[48:55], v23
  v_max3_u32 v31, v56, v57, v58
  v_max_u32 v31, v31, v59
  v_cmp_eq_u32 vcc, -1, v31
  v_smfmac_f32_16x16x64_bf16 v[68:71], v[52:55], a[56:63], v23
  v_smfmac_f32_16x16x64_bf16 v[72:75], v[52:55], a[64:71], v23
  v_smfmac_f32_16x16x64_bf16 v[76:79], v[52:55], a[72:79], v23
  s_cbranch_vccz FL_m_02_ok2
  s_branch FL_m_02_x2
FL_m_012_ok2:
  v_smfmac_f32_16x16x64_bf16 v[64:67], v[56:59], a[96:103], v23
  v_max3_u32 v31, v48, v49, v50
  v_max_u32 v31, v31, v51
  v_cmp_eq_u32 vcc, -1, v31
  v_smfmac_f32_16x16x64_bf16 v[68:71], v[56:59], a[104:111], v23
  v_smfmac_f32_16x16x64_bf16 v[72:75], v[56:59], a[112:119], v23
  v_smfmac_f32_16x16x64_bf16 v[76:79], v[56:59], a[120:127], v23
  s_cbranch_vccz FL_m_01_ok0
  s_branch FL_m_01_x0
FL_m_013_c0:
  v_max3_u32 v31, v48, v49, v50
  v_max_u32 v31, v31, v51
  v_cmp_eq_u32 vcc, -1, v31
  s_cbranch_vccz FL_m_013_ok0
FL_m_013_x0:
  s_mov_b64 exec, vcc
  buffer_load_dwordx4 v[48:51], v3, s[4:7], s41 offen offset:0 sc1
  s_mov_b64 exec, -1
FL_m_013_c1:
  v_max3_u32 v31, v52, v53, v54
  v_max_u32 v31, v31, v55
  v_cmp_eq_u32 vcc, -1, v31
  s_cbranch_vccz FL_m_013_ok1
FL_m_013_x1:
  s_mov_b64 exec, vcc
  buffer_load_dwordx4 v[52:55], v3, s[4:7], s41 offen offset:1024 sc1
  s_mov_b64 exec, -1
FL_m_013_c3:
  v_max3_u32 v31, v60, v61, v62
  v_max_u32 v31, v31, v63
  v_cmp_eq_u32 vcc, -1, v31
  s_cbranch_vccz FL_m_013_ok3
FL_m_013_x3:
  s_mov_b64 exec, vcc
  buffer_load_dwordx4 v[60:63], v3, s[4:7], s41 offen offset:3072 sc1
  s_mov_b64 exec, -1
  s_add_u32 s46, s46, 1
  s_cmp_ge_u32 s46, 131072
  s_cbranch_scc1 FL_rec_abort
  s_waitcnt vmcnt(4)
  s_branch FL_m_013_c0
FL_m_013_ok0:
  v_smfmac_f32_16x16x64_bf16 v[64:67], v[48:51], a[0:7], v23
  v_max3_u32 v31, v52, v53, v54
  v_max_u32 v31, v31, v55
  v_cmp_eq_u32 vcc, -1, v31
  v_smfmac_f32_16x16x64_bf16 v[68:71], v[48:51], a[8:15], v23
  v_smfmac_f32_16x16x64_bf16 v[72:75], v[48:51], a[16:23], v23
  v_smfmac_f32_16x16x64_bf16 v[76:79], v[48:51], a[24:31], v23
  s_cbranch_vccz FL_m_13_ok1
  s_branch FL_m_13_x1
FL_m_013_ok1:
  v_smfmac_f32_16x16x64_bf16 v[64:67], v[52:55], a[48:55], v23
  v_max3_u32 v31, v60, v61, v62
  v_max_u32 v31, v31, v63
  v_cmp_eq_u32 vcc, -1, v31
  v_smfmac_f32_16x16x64_bf16 v[68:71], v[52:55], a[56:63], v23
  v_smfmac_f32_16x16x64_bf16 v[72:75], v[52:55], a[64:71], v23
  v_smfmac_f32_16x16x64_bf16 v[76:79], v[52:55], a[72:79], v23
  s_cbranch_vccz FL_m_03_ok3
  s_branch FL_m_03_x3
FL_m_013_ok3:
  v_smfmac_f32_16x16x64_bf16 v[64:67], v[60:63], a[144:151], v23
  v_max3_u32 v31, v48, v49, v50
  v_max_u32 v31, v31, v51
  v_cmp_eq_u32 vcc, -1, v31
  v_smfmac_f32_16x16x64_bf16 v[68:71], v[60:63], a[152:159], v23
  v_smfmac_f32_16x16x64_bf16 v[72:75], v[60:63], a[160:167], v23
  v_smfmac_f32_16x16x64_bf16 v[76:79], v[60:63], a[168:175], v23
  s_cbranch_vccz FL_m_01_ok0
  s_branch FL_m_01_x0
FL_m_023_c0:
  v_max3_u32 v31, v48, v49, v50
  v_max_u32 v31, v31, v51
  v_cmp_eq_u32 vcc, -1, v31
  s_cbranch_vccz FL_m_023_ok0
FL_m_023_x0:
  s_mov_b64 exec, vcc
  buffer_load_dwordx4 v[48:51], v3, s[4:7], s41 offen offset:0 sc1
  s_mov_b64 exec, -1
FL_m_023_c2:
  v_max3_u32 v31, v56, v57, v58
  v_max_u32 v31, v31, v59
  v_cmp_eq_u32 vcc, -1, v31
  s_cbranch_vccz FL_m_023_ok2
FL_m_023_x2:
  s_mov_b64 exec, vcc
  buffer_load_dwordx4 v[56:59], v3, s[4:7], s41 offen offset:2048 sc1
  s_mov_b64 exec, -1
FL_m_023_c3:
  v_max3_u32 v31, v60, v61, v62
  v_max_u32 v31, v31, v63
  v_cmp_eq_u32 vcc, -1, v31
  s_cbranch_vccz FL_m_023_ok3
FL_m_023_x3:
  s_mov_b64 exec, vcc
  buffer_load_dwordx4 v[60:63], v3, s[4:7], s41 offen offset:3072 sc1
  s_mov_b64 exec, -1
  s_add_u32 s46, s46, 1
  s_cmp_ge_u32 s46, 131072
  s_cbranch_scc1 FL_rec_abort
  s_waitcnt vmcnt(4)
  s_branch FL_m_023_c0
FL_m_023_ok0:
  v_smfmac_f32_16x16x64_bf16 v[64:67], v[48:51], a[0:7], v23
  v_max3_u32 v31, v56, v57, v58
  v_max_u32 v31, v31, v59
  v_cmp_eq_u32 vcc, -1, v31
  v_smfmac_f32_16x16x64_bf16 v[68:71], v[48:51], a[8:15], v23
  v_smfmac_f32_16x16x64_bf16 v[72:75], v[48:51], a[16:23], v23
  v_smfmac_f32_16x16x64_bf16 v[76:79], v[48:51], a[24:31], v23
  s_cbranch_vccz FL_m_23_ok2
  s_branch FL_m_23_x2
FL_m_023_ok2:
  v_smfmac_f32_16x16x64_bf16 v[64:67], v[56:59], a[96:103], v23
  v_max3_u32 v31, v60, v61, v62
  v_max_u32 v31, v31, v63
  v_cmp_eq_u32 vcc, -1, v31
  v_smfmac_f32_16x16x64_bf16 v[68:71], v[56:59], a[104:111], v23
  v_smfmac_f32_16x16x64_bf16 v[72:75], v[56:59], a[112:119], v23
  v_smfmac_f32_16x16x64_bf16 v[76:79], v[56:59], a[120:127], v23
  s_cbranch_vccz FL_m_03_ok3
  s_branch FL_m_03_x3
FL_m_023_ok3:
  v_smfmac_f32_16x16x64_bf16 v[64:67], v[60:63], a[144:151], v23
  v_max3_u32 v31, v48, v49, v50
  v_max_u32 v31, v31, v51
  v_cmp_eq_u32 vcc, -1, v31
  v_smfmac_f32_16x16x64_bf16 v[68:71], v[60:63], a[152:159], v23
  v_smfmac_f32_16x16x64_bf16 v[72:75], v[60:63], a[160:167], v23
  v_smfmac_f32_16x16x64_bf16 v[76:79], v[60:63], a[168:175], v23
  s_cbranch_vccz FL_m_02_ok0
  s_branch FL_m_02_x0
FL_m_123_c1:
  v_max3_u32 v31, v52, v53, v54
  v_max_u32 v31, v31, v55
  v_cmp_eq_u32 vcc, -1, v31
  s_cbranch_vccz FL_m_123_ok1
FL_m_123_x1:
  s_mov_b64 exec, vcc
  buffer_load_dwordx4 v[52:55], v3, s[4:7], s41 offen offset:1024 sc1
  s_mov_b64 exec, -1
FL_m_123_c2:
  v_max3_u32 v31, v56, v57, v58
  v_max_u32 v31, v31, v59
  v_cmp_eq_u32 vcc, -1, v31
  s_cbranch_vccz FL_m_123_ok2
FL_m_123_x2:
  s_mov_b64 exec, vcc
  buffer_load_dwordx4 v[56:59], v3, s[4:7], s41 offen offset:2048 sc1
  s_mov_b64 exec, -1
FL_m_123_c3:
  v_max3_u32 v31, v60, v61, v62
  v_max_u32 v31, v31, v63
  v_cmp_eq_u32 vcc, -1, v31
  s_cbranch_vccz FL_m_123_ok3
FL_m_123_x3:
  s_mov_b64 exec, vcc
  buffer_load_dwordx4 v[60:63], v3, s[4:7], s41 offen offset:3072 sc1
  s_mov_b64 exec, -1
  s_add_u32 s46, s46, 1
  s_cmp_ge_u32 s46, 131072
  s_cbranch_scc1 FL_rec_abort
  s_waitcnt vmcnt(4)
  s_branch FL_m_123_c1
FL_m_123_ok1:
  v_smfmac_f32_16x16x64_bf16 v[64:67], v[52:55], a[48:55], v23
  v_max3_u32 v31, v56, v57, v58
  v_max_u32 v31, v31, v59
  v_cmp_eq_u32 vcc, -1, v31
  v_smfmac_f32_16x16x64_bf16 v[68:71], v[52:55], a[56:63], v23
  v_smfmac_f32_16x16x64_bf16 v[72:75], v[52:55], a[64:71], v23
  v_smfmac_f32_16x16x64_bf16 v[76:79], v[52:55], a[72:79], v23
  s_cbranch_vccz FL_m_23_ok2
  s_branch FL_m_23_x2
FL_m_123_ok2:
  v_smfmac_f32_16x16x64_bf16 v[64:67], v[56:59], a[96:103], v23
  v_max3_u32 v31, v60, v61, v62
  v_max_u32 v31, v31, v63
  v_cmp_eq_u32 vcc, -1, v31
  v_smfmac_f32_16x16x64_bf16 v[68:71], v[56:59], a[104:111], v23
  v_smfmac_f32_16x16x64_bf16 v[72:75], v[56:59], a[112:119], v23
  v_smfmac_f32_16x16x64_bf16 v[76:79], v[56:59], a[120:127], v23
  s_cbranch_vccz FL_m_13_ok3
  s_branch FL_m_13_x3
FL_m_123_ok3:
  v_smfmac_f32_16x16x64_bf16 v[64:67], v[60:63], a[144:151], v23
  v_max3_u32 v31, v52, v53, v54
  v_max_u32 v31, v31, v55
  v_cmp_eq_u32 vcc, -1, v31
  v_smfmac_f32_16x16x64_bf16 v[68:71], v[60:63], a[152:159], v23
  v_smfmac_f32_16x16x64_bf16 v[72:75], v[60:63], a[160:167], v23
  v_smfmac_f32_16x16x64_bf16 v[76:79], v[60:63], a[168:175], v23
  s_cbranch_vccz FL_m_12_ok1
  s_branch FL_m_12_x1
FL_m_0123_c0:
  v_max3_u32 v31, v48, v49, v50
  v_max_u32 v31, v31, v51
  v_cmp_eq_u32 vcc, -1, v31
  s_cbranch_vccz FL_m_0123_ok0
FL_m_0123_x0:
  s_mov_b64 exec, vcc
  buffer_load_dwordx4 v[48:51], v3, s[4:7], s41 offen offset:0 sc1
  s_mov_b64 exec, -1
FL_m_0123_c1:
  v_max3_u32 v31, v52, v53, v54
  v_max_u32 v31, v31, v55
  v_cmp_eq_u32 vcc, -1, v31
  s_cbranch_vccz FL_m_0123_ok1
FL_m_0123_x1:
  s_mov_b64 exec, vcc
  buffer_load_dwordx4 v[52:55], v3, s[4:7], s41 offen offset:1024 sc1
  s_mov_b64 exec, -1
FL_m_0123_c2:
  v_max3_u32 v31, v56, v57, v58
  v_max_u32 v31, v31, v59
  v_cmp_eq_u32 vcc, -1, v31
  s_cbranch_vccz FL_m_0123_ok2
FL_m_0123_x2:
  s_mov_b64 exec, vcc
  buffer_load_dwordx4 v[56:59], v3, s[4:7], s41 offen offset:2048 sc1
  s_mov_b64 exec, -1
FL_m_0123_c3:
  v_max3_u32 v31, v60, v61, v62
  v_max_u32 v31, v31, v63
  v_cmp_eq_u32 vcc, -1, v31
  s_cbranch_vccz FL_m_0123_ok3
FL_m_0123_x3:
  s_mov_b64 exec, vcc
  buffer_load_dwordx4 v[60:63], v3, s[4:7], s41 offen offset:3072 sc1
  s_mov_b64 exec, -1
  s_add_u32 s46, s46, 1
  s_cmp_ge_u32 s46, 131072
  s_cbranch_scc1 FL_rec_abort
  s_waitcnt vmcnt(4)
  s_branch FL_m_0123_c0
FL_m_0123_ok0:
  v_smfmac_f32_16x16x64_bf16 v[64:67], v[48:51], a[0:7], v23
  v_max3_u32 v31, v52, v53, v54
  v_max_u32 v31, v31, v55
  v_cmp_eq_u32 vcc, -1, v31
  v_smfmac_f32_16x16x64_bf16 v[68:71], v[48:51], a[8:15], v23
  v_smfmac_f32_16x16x64_bf16 v[72:75], v[48:51], a[16:23], v23
  v_smfmac_f32_16x16x64_bf16 v[76:79], v[48:51], a[24:31], v23
  s_cbranch_vccz FL_m_123_ok1
  s_branch FL_m_123_x1
FL_m_0123_ok1:
  v_smfmac_f32_16x16x64_bf16 v[64:67], v[52:55], a[48:55], v23
  v_max3_u32 v31, v56, v57, v58
  v_max_u32 v31, v31, v59
  v_cmp_eq_u32 vcc, -1, v31
  v_smfmac_f32_16x16x64_bf16 v[68:71], v[52:55], a[56:63], v23
  v_smfmac_f32_16x16x64_bf16 v[72:75], v[52:55], a[64:71], v23
  v_smfmac_f32_16x16x64_bf16 v[76:79], v[52:55], a[72:79], v23
  s_cbranch_vccz FL_m_023_ok2
  s_branch FL_m_023_x2
FL_m_0123_ok2:
  v_smfmac_f32_16x16x64_bf16 v[64:67], v[56:59], a[96:103], v23
  v_max3_u32 v31, v60, v61, v62
  v_max_u32 v31, v31, v63
  v_cmp_eq_u32 vcc, -1, v31
  v_smfmac_f32_16x16x64_bf16 v[68:71], v[56:59], a[104:111], v23
  v_smfmac_f32_16x16x64_bf16 v[72:75], v[56:59], a[112:119], v23
  v_smfmac_f32_16x16x64_bf16 v[76:79], v[56:59], a[120:127], v23
  s_cbranch_vccz FL_m_013_ok3
  s_branch FL_m_013_x3
FL_m_0123_ok3:
  v_smfmac_f32_16x16x64_bf16 v[64:67], v[60:63], a[144:151], v23
  v_max3_u32 v31, v48, v49, v50
  v_max_u32 v31, v31, v51
  v_cmp_eq_u32 vcc, -1, v31
  v_smfmac_f32_16x16x64_bf16 v[68:71], v[60:63], a[152:159], v23
  v_smfmac_f32_16x16x64_bf16 v[72:75], v[60:63], a[160:167], v23
  v_smfmac_f32_16x16x64_bf16 v[76:79], v[60:63], a[168:175], v23
  s_cbranch_vccz FL_m_012_ok0
  s_branch FL_m_012_x0
FL_x_f0:
  s_mov_b64 exec, vcc
  buffer_load_dwordx4 v[64:67], v9, s[4:7], s41 offen offset:0 sc1
  s_mov_b64 exec, -1
  s_waitcnt vmcnt(2)
  s_branch FL_x_0123_c1
FL_x_f1:
  s_mov_b64 exec, vcc
  buffer_load_dwordx4 v[68:71], v9, s[4:7], s41 offen offset:1024 sc1
  s_mov_b64 exec, -1
  s_waitcnt vmcnt(2)
  s_branch FL_x_123_c2
FL_x_f2:
  s_mov_b64 exec, vcc
  buffer_load_dwordx4 v[72:75], v9, s[4:7], s41 offen offset:2048 sc1
  s_mov_b64 exec, -1
  s_waitcnt vmcnt(2)
  s_branch FL_x_23_c3
FL_x_f3:
  s_mov_b64 exec, vcc
  buffer_load_dwordx4 v[76:79], v9, s[4:7], s41 offen offset:3072 sc1
  s_mov_b64 exec, -1
  s_nop 7
  s_branch FL_x_3_c3
FL_x_0_c0:
  v_max3_u32 v31, v64, v65, v66
  v_max_u32 v31, v31, v67
  v_cmp_eq_u32 vcc, -1, v31
  s_cbranch_vccz FL_x_0_ok0
FL_x_0_x0:
  s_mov_b64 exec, vcc
  buffer_load_dwordx4 v[64:67], v9, s[4:7], s41 offen offset:0 sc1
  s_mov_b64 exec, -1
  s_add_u32 s46, s46, 1
  s_cmp_ge_u32 s46, 131072
  s_cbranch_scc1 FL_rec_abort
  s_waitcnt vmcnt(2)
  s_branch FL_x_0_c0
FL_x_0_ok0:
  v_mfma_f32_16x16x32_bf16 v[44:47], v[64:67], v[64:67], v[44:47]
  v_mfma_f32_16x16x32_bf16 v[36:39], v[116:119], v[64:67], v[36:39]
  v_mfma_f32_16x16x32_bf16 v[40:43], v[132:135], v[64:67], v[40:43]
  s_branch FL_x_done
FL_x_1_c1:
  v_max3_u32 v31, v68, v69, v70
  v_max_u32 v31, v31, v71
  v_cmp_eq_u32 vcc, -1, v31
  s_cbranch_vccz FL_x_1_ok1
FL_x_1_x1:
  s_mov_b64 exec, vcc
  buffer_load_dwordx4 v[68:71], v9, s[4:7], s41 offen offset:1024 sc1
  s_mov_b64 exec, -1
  s_add_u32 s46, s46, 1
  s_cmp_ge_u32 s46, 131072
  s_cbranch_scc1 FL_rec_abort
  s_waitcnt vmcnt(2)
  s_branch FL_x_1_c1
FL_x_1_ok1:
  v_mfma_f32_16x16x32_bf16 v[44:47], v[68:71], v[68:71], v[44:47]
  v_mfma_f32_16x16x32_bf16 v[36:39], v[120:123], v[68:71], v[36:39]
  v_mfma_f32_16x16x32_bf16 v[40:43], v[136:139], v[68:71], v[40:43]
  s_branch FL_x_done
FL_x_2_c2:
  v_max3_u32 v31, v72, v73, v74
  v_max_u32 v31, v31, v75
  v_cmp_eq_u32 vcc, -1, v31
  s_cbranch_vccz FL_x_2_ok2
FL_x_2_x2:
  s_mov_b64 exec, vcc
  buffer_load_dwordx4 v[72:75], v9, s[4:7], s41 offen offset:2048 sc1
  s_mov_b64 exec, -1
  s_add_u32 s46, s46, 1
  s_cmp_ge_u32 s46, 131072
  s_cbranch_scc1 FL_rec_abort
  s_waitcnt vmcnt(2)
  s_branch FL_x_2_c2
FL_x_2_ok2:
  v_mfma_f32_16x16x32_bf16 v[44:47], v[72:75], v[72:75], v[44:47]
  v_mfma_f32_16x16x32_bf16 v[36:39], v[124:127], v[72:75], v[36:39]
  v_mfma_f32_16x16x32_bf16 v[40:43], v[140:143], v[72:75], v[40:43]
  s_branch FL_x_done
FL_x_3_c3:
  v_max3_u32 v31, v76, v77, v78
  v_max_u32 v31, v31, v79
  v_cmp_eq_u32 vcc, -1, v31
  s_cbranch_vccz FL_x_3_ok3
FL_x_3_x3:
  s_mov_b64 exec, vcc
  buffer_load_dwordx4 v[76:79], v9, s[4:7], s41 offen offset:3072 sc1
  s_mov_b64 exec, -1
  s_add_u32 s46, s46, 1
  s_cmp_ge_u32 s46, 131072
  s_cbranch_scc1 FL_rec_abort
  s_waitcnt vmcnt(2)
  s_branch FL_x_3_c3
FL_x_3_ok3:
  v_mfma_f32_16x16x32_bf16 v[44:47], v[76:79], v[76:79], v[44:47]
  v_mfma_f32_16x16x32_bf16 v[36:39], v[128:131], v[76:79], v[36:39]
  v_mfma_f32_16x16x32_bf16 v[40:43], v[144:147], v[76:79], v[40:43]
  s_branch FL_x_done
FL_x_01_c0:
  v_max3_u32 v31, v64, v65, v66
  v_max_u32 v31, v31, v67
  v_cmp_eq_u32 vcc, -1, v31
  s_cbranch_vccz FL_x_01_ok0
FL_x_01_x0:
  s_mov_b64 exec, vcc
  buffer_load_dwordx4 v[64:67], v9, s[4:7], s41 offen offset:0 sc1
  s_mov_b64 exec, -1
FL_x_01_c1:
  v_max3_u32 v31, v68, v69, v70
  v_max_u32 v31, v31, v71
  v_cmp_eq_u32 vcc, -1, v31
  s_cbranch_vccz FL_x_01_ok1
FL_x_01_x1:
  s_mov_b64 exec, vcc
  buffer_load_dwordx4 v[68:71], v9, s[4:7], s41 offen offset:1024 sc1
  s_mov_b64 exec, -1
  s_add_u32 s46, s46, 1
  s_cmp_ge_u32 s46, 131072
  s_cbranch_scc1 FL_rec_abort
  s_waitcnt vmcnt(4)
  s_branch FL_x_01_c0
FL_x_01_ok0:
  v_mfma_f32_16x16x32_bf16 v[44:47], v[64:67], v[64:67], v[44:47]
  v_max3_u32 v31, v68, v69, v70
  v_max_u32 v31, v31, v71
  v_cmp_eq_u32 vcc, -1, v31
  v_mfma_f32_16x16x32_bf16 v[36:39], v[116:119], v[64:67], v[36:39]
  v_mfma_f32_16x16x32_bf16 v[40:43], v[132:135], v[64:67], v[40:43]
  s_cbranch_vccz FL_x_1_ok1
  s_branch FL_x_1_x1
FL_x_01_ok1:
  v_mfma_f32_16x16x32_bf16 v[44:47], v[68:71], v[68:71], v[44:47]
  v_max3_u32 v31, v64, v65, v66
  v_max_u32 v31, v31, v67
  v_cmp_eq_u32 vcc, -1, v31
  v_mfma_f32_16x16x32_bf16 v[36:39], v[120:123], v[68:71], v[36:39]
  v_mfma_f32_16x16x32_bf16 v[40:43], v[136:139], v[68:71], v[40:43]
  s_cbranch_vccz FL_x_0_ok0
  s_branch FL_x_0_x0
FL_x_02_c0:
  v_max3_u32 v31, v64, v65, v66
  v_max_u32 v31, v31, v67
  v_cmp_eq_u32 vcc, -1, v31
  s_cbranch_vccz FL_x_02_ok0
FL_x_02_x0:
  s_mov_b64 exec, vcc
  buffer_load_dwordx4 v[64:67], v9, s[4:7], s41 offen offset:0 sc1
  s_mov_b64 exec, -1
FL_x_02_c2:
  v_max3_u32 v31, v72, v73, v74
  v_max_u32 v31, v31, v75
  v_cmp_eq_u32 vcc, -1, v31
  s_cbranch_vccz FL_x_02_ok2
FL_x_02_x2:
  s_mov_b64 exec, vcc
  buffer_load_dwordx4 v[72:75], v9, s[4:7], s41 offen offset:2048 sc1
  s_mov_b64 exec, -1
  s_add_u32 s46, s46, 1
  s_cmp_ge_u32 s46, 131072
  s_cbranch_scc1 FL_rec_abort
  s_waitcnt vmcnt(4)
  s_branch FL_x_02_c0
FL_x_02_ok0:
  v_mfma_f32_16x16x32_bf16 v[44:47], v[64:67], v[64:67], v[44:47]
  v_max3_u32 v31, v72, v73, v74
  v_max_u32 v31, v31, v75
  v_cmp_eq_u32 vcc, -1, v31
  v_mfma_f32_16x16x32_bf16 v[36:39], v[116:119], v[64:67], v[36:39]
  v_mfma_f32_16x16x32_bf16 v[40:43], v[132:135], v[64:67], v[40:43]
  s_cbranch_vccz FL_x_2_ok2
  s_branch FL_x_2_x2
FL_x_02_ok2:
  v_mfma_f32_16x16x32_bf16 v[44:47], v[72:75], v[72:75], v[44:47]
  v_max3_u32 v31, v64, v65, v66
  v_max_u32 v31, v31, v67
  v_cmp_eq_u32 vcc, -1, v31
  v_mfma_f32_16x16x32_bf16 v[36:39], v[124:127], v[72:75], v[36:39]
  v_mfma_f32_16x16x32_bf16 v[40:43], v[140:143], v[72:75], v[40:43]
  s_cbranch_vccz FL_x_0_ok0
  s_branch FL_x_0_x0
FL_x_03_c0:
  v_max3_u32 v31, v64, v65, v66
  v_max_u32 v31, v31, v67
  v_cmp_eq_u32 vcc, -1, v31
  s_cbranch_vccz FL_x_03_ok0
FL_x_03_x0:
  s_mov_b64 exec, vcc
  buffer_load_dwordx4 v[64:67], v9, s[4:7], s41 offen offset:0 sc1
  s_mov_b64 exec, -1
FL_x_03_c3:
  v_max3_u32 v31, v76, v77, v78
  v_max_u32 v31, v31, v79
  v_cmp_eq_u32 vcc, -1, v31
  s_cbranch_vccz FL_x_03_ok3
FL_x_03_x3:
  s_mov_b64 exec, vcc
  buffer_load_dwordx4 v[76:79], v9, s[4:7], s41 offen offset:3072 sc1
  s_mov_b64 exec, -1
  s_add_u32 s46, s46, 1
  s_cmp_ge_u32 s46, 131072
  s_cbranch_scc1 FL_rec_abort
  s_waitcnt vmcnt(4)
  s_branch FL_x_03_c0
FL_x_03_ok0:
  v_mfma_f32_16x16x32_bf16 v[44:47], v[64:67], v[64:67], v[44:47]
  v_max3_u32 v31, v76, v77, v78
  v_max_u32 v31, v31, v79
  v_cmp_eq_u32 vcc, -1, v31
  v_mfma_f32_16x16x32_bf16 v[36:39], v[116:119], v[64:67], v[36:39]
  v_mfma_f32_16x16x32_bf16 v[40:43], v[132:135], v[64:67], v[40:43]
  s_cbranch_vccz FL_x_3_ok3
  s_branch FL_x_3_x3
FL_x_03_ok3:
  v_mfma_f32_16x16x32_bf16 v[44:47], v[76:79], v[76:79], v[44:47]
  v_max3_u32 v31, v64, v65, v66
  v_max_u32 v31, v31, v67
  v_cmp_eq_u32 vcc, -1, v31
  v_mfma_f32_16x16x32_bf16 v[36:39], v[128:131], v[76:79], v[36:39]
  v_mfma_f32_16x16x32_bf16 v[40:43], v[144:147], v[76:79], v[40:43]
  s_cbranch_vccz FL_x_0_ok0
  s_branch FL_x_0_x0
FL_x_12_c1:
  v_max3_u32 v31, v68, v69, v70
  v_max_u32 v31, v31, v71
  v_cmp_eq_u32 vcc, -1, v31
  s_cbranch_vccz FL_x_12_ok1
FL_x_12_x1:
  s_mov_b64 exec, vcc
  buffer_load_dwordx4 v[68:71], v9, s[4:7], s41 offen offset:1024 sc1
  s_mov_b64 exec, -1
FL_x_12_c2:
  v_max3_u32 v31, v72, v73, v74
  v_max_u32 v31, v31, v75
  v_cmp_eq_u32 vcc, -1, v31
  s_cbranch_vccz FL_x_12_ok2
FL_x_12_x2:
  s_mov_b64 exec, vcc
  buffer_load_dwordx4 v[72:75], v9, s[4:7], s41 offen offset:2048 sc1
  s_mov_b64 exec, -1
  s_add_u32 s46, s46, 1
  s_cmp_ge_u32 s46, 131072
  s_cbranch_scc1 FL_rec_abort
  s_waitcnt vmcnt(4)
  s_branch FL_x_12_c1
FL_x_12_ok1:
  v_mfma_f32_16x16x32_bf16 v[44:47], v[68:71], v[68:71], v[44:47]
  v_max3_u32 v31, v72, v73, v74
  v_max_u32 v31, v31, v75
  v_cmp_eq_u32 vcc, -1, v31
  v_mfma_f32_16x16x32_bf16 v[36:39], v[120:123], v[68:71], v[36:39]
  v_mfma_f32_16x16x32_bf16 v[40:43], v[136:139], v[68:71], v[40:43]
  s_cbranch_vccz FL_x_2_ok2
  s_branch FL_x_2_x2
FL_x_12_ok2:
  v_mfma_f32_16x16x32_bf16 v[44:47], v[72:75], v[72:75], v[44:47]
  v_max3_u32 v31, v68, v69, v70
  v_max_u32 v31, v31, v71
  v_cmp_eq_u32 vcc, -1, v31
  v_mfma_f32_16x16x32_bf16 v[36:39], v[124:127], v[72:75], v[36:39]
  v_mfma_f32_16x16x32_bf16 v[40:43], v[140:143], v[72:75], v[40:43]
  s_cbranch_vccz FL_x_1_ok1
  s_branch FL_x_1_x1
FL_x_13_c1:
  v_max3_u32 v31, v68, v69, v70
  v_max_u32 v31, v31, v71
  v_cmp_eq_u32 vcc, -1, v31
  s_cbranch_vccz FL_x_13_ok1
FL_x_13_x1:
  s_mov_b64 exec, vcc
  buffer_load_dwordx4 v[68:71], v9, s[4:7], s41 offen offset:1024 sc1
  s_mov_b64 exec, -1
FL_x_13_c3:
  v_max3_u32 v31, v76, v77, v78
  v_max_u32 v31, v31, v79
  v_cmp_eq_u32 vcc, -1, v31
  s_cbranch_vccz FL_x_13_ok3
FL_x_13_x3:
  s_mov_b64 exec, vcc
  buffer_load_dwordx4 v[76:79], v9, s[4:7], s41 offen offset:3072 sc1
  s_mov_b64 exec, -1
  s_add_u32 s46, s46, 1
  s_cmp_ge_u32 s46, 131072
  s_cbranch_scc1 FL_rec_abort
  s_waitcnt vmcnt(4)
  s_branch FL_x_13_c1
FL_x_13_ok1:
  v_mfma_f32_16x16x32_bf16 v[44:47], v[68:71], v[68:71], v[44:47]
  v_max3_u32 v31, v76, v77, v78
  v_max_u32 v31, v31, v79
  v_cmp_eq_u32 vcc, -1, v31
  v_mfma_f32_16x16x32_bf16 v[36:39], v[120:123], v[68:71], v[36:39]
  v_mfma_f32_16x16x32_bf16 v[40:43], v[136:139], v[68:71], v[40:43]
  s_cbranch_vccz FL_x_3_ok3
  s_branch FL_x_3_x3
FL_x_13_ok3:
  v_mfma_f32_16x16x32_bf16 v[44:47], v[76:79], v[76:79], v[44:47]
  v_max3_u32 v31, v68, v69, v70
  v_max_u32 v31, v31, v71
  v_cmp_eq_u32 vcc, -1, v31
  v_mfma_f32_16x16x32_bf16 v[36:39], v[128:131], v[76:79], v[36:39]
  v_mfma_f32_16x16x32_bf16 v[40:43], v[144:147], v[76:79], v[40:43]
  s_cbranch_vccz FL_x_1_ok1
  s_branch FL_x_1_x1
FL_x_23_c2:
  v_max3_u32 v31, v72, v73, v74
  v_max_u32 v31, v31, v75
  v_cmp_eq_u32 vcc, -1, v31
  s_cbranch_vccz FL_x_23_ok2
FL_x_23_x2:
  s_mov_b64 exec, vcc
  buffer_load_dwordx4 v[72:75], v9, s[4:7], s41 offen offset:2048 sc1
  s_mov_b64 exec, -1
FL_x_23_c3:
  v_max3_u32 v31, v76, v77, v78
  v_max_u32 v31, v31, v79
  v_cmp_eq_u32 vcc, -1, v31
  s_cbranch_vccz FL_x_23_ok3
FL_x_23_x3:
  s_mov_b64 exec, vcc
  buffer_load_dwordx4 v[76:79], v9, s[4:7], s41 offen offset:3072 sc1
  s_mov_b64 exec, -1
  s_add_u32 s46, s46, 1
  s_cmp_ge_u32 s46, 131072
  s_cbranch_scc1 FL_rec_abort
  s_waitcnt vmcnt(4)
  s_branch FL_x_23_c2
FL_x_23_ok2:
  v_mfma_f32_16x16x32_bf16 v[44:47], v[72:75], v[72:75], v[44:47]
  v_max3_u32 v31, v76, v77, v78
  v_max_u32 v31, v31, v79
  v_cmp_eq_u32 vcc, -1, v31
  v_mfma_f32_16x16x32_bf16 v[36:39], v[124:127], v[72:75], v[36:39]
  v_mfma_f32_16x16x32_bf16 v[40:43], v[140:143], v[72:75], v[40:43]
  s_cbranch_vccz FL_x_3_ok3
  s_branch FL_x_3_x3
FL_x_23_ok3:
  v_mfma_f32_16x16x32_bf16 v[44:47], v[76:79], v[76:79], v[44:47]
  v_max3_u32 v31, v72, v73, v74
  v_max_u32 v31, v31, v75
  v_cmp_eq_u32 vcc, -1, v31
  v_mfma_f32_16x16x32_bf16 v[36:39], v[128:131], v[76:79], v[36:39]
  v_mfma_f32_16x16x32_bf16 v[40:43], v[144:147], v[76:79], v[40:43]
  s_cbranch_vccz FL_x_2_ok2
  s_branch FL_x_2_x2
FL_x_012_c0:
  v_max3_u32 v31, v64, v65, v66
  v_max_u32 v31, v31, v67
  v_cmp_eq_u32 vcc, -1, v31
  s_cbranch_vccz FL_x_012_ok0
FL_x_012_x0:
  s_mov_b64 exec, vcc
  buffer_load_dwordx4 v[64:67], v9, s[4:7], s41 offen offset:0 sc1
  s_mov_b64 exec, -1
FL_x_012_c1:
  v_max3_u32 v31, v68, v69, v70
  v_max_u32 v31, v31, v71
  v_cmp_eq_u32 vcc, -1, v31
  s_cbranch_vccz FL_x_012_ok1
FL_x_012_x1:
  s_mov_b64 exec, vcc
  buffer_load_dwordx4 v[68:71], v9, s[4:7], s41 offen offset:1024 sc1
  s_mov_b64 exec, -1
FL_x_012_c2:
  v_max3_u32 v31, v72, v73, v74
  v_max_u32 v31, v31, v75
  v_cmp_eq_u32 vcc, -1, v31
  s_cbranch_vccz FL_x_012_ok2
FL_x_012_x2:
  s_mov_b64 exec, vcc
  buffer_load_dwordx4 v[72:75], v9, s[4:7], s41 offen offset:2048 sc1
  s_mov_b64 exec, -1
  s_add_u32 s46, s46, 1
  s_cmp_ge_u32 s46, 131072
  s_cbranch_scc1 FL_rec_abort
  s_waitcnt vmcnt(4)
  s_branch FL_x_012_c0
FL_x_012_ok0:
  v_mfma_f32_16x16x32_bf16 v[44:47], v[64:67], v[64:67], v[44:47]
  v_max3_u32 v31, v68, v69, v70
  v_max_u32 v31, v31, v71
  v_cmp_eq_u32 vcc, -1, v31
  v_mfma_f32_16x16x32_bf16 v[36:39], v[116:119], v[64:67], v[36:39]
  v_mfma_f32_16x16x32_bf16 v[40:43], v[132:135], v[64:67], v[40:43]
  s_cbranch_vccz FL_x_12_ok1
  s_branch FL_x_12_x1
FL_x_012_ok1:
  v_mfma_f32_16x16x32_bf16 v[44:47], v[68:71], v[68:71], v[44:47]
  v_max3_u32 v31, v72, v73, v74
  v_max_u32 v31, v31, v75
  v_cmp_eq_u32 vcc, -1, v31
  v_mfma_f32_16x16x32_bf16 v[36:39], v[120:123], v[68:71], v[36:39]
  v_mfma_f32_16x16x32_bf16 v[40:43], v[136:139], v[68:71], v[40:43]
  s_cbranch_vccz FL_x_02_ok2
  s_branch FL_x_02_x2
FL_x_012_ok2:
  v_mfma_f32_16x16x32_bf16 v[44:47], v[72:75], v[72:75], v[44:47]
  v_max3_u32 v31, v64, v65, v66
  v_max_u32 v31, v31, v67
  v_cmp_eq_u32 vcc, -1, v31
  v_mfma_f32_16x16x32_bf16 v[36:39], v[124:127], v[72:75], v[36:39]
  v_mfma_f32_16x16x32_bf16 v[40:43], v[140:143], v[72:75], v[40:43]
  s_cbranch_vccz FL_x_01_ok0
  s_branch FL_x_01_x0
FL_x_013_c0:
  v_max3_u32 v31, v64, v65, v66
  v_max_u32 v31, v31, v67
  v_cmp_eq_u32 vcc, -1, v31
  s_cbranch_vccz FL_x_013_ok0
FL_x_013_x0:
  s_mov_b64 exec, vcc
  buffer_load_dwordx4 v[64:67], v9, s[4:7], s41 offen offset:0 sc1
  s_mov_b64 exec, -1
FL_x_013_c1:
  v_max3_u32 v31, v68, v69, v70
  v_max_u32 v31, v31, v71
  v_cmp_eq_u32 vcc, -1, v31
  s_cbranch_vccz FL_x_013_ok1
FL_x_013_x1:
  s_mov_b64 exec, vcc
  buffer_load_dwordx4 v[68:71], v9, s[4:7], s41 offen offset:1024 sc1
  s_mov_b64 exec, -1
FL_x_013_c3:
  v_max3_u32 v31, v76, v77, v78
  v_max_u32 v31, v31, v79
  v_cmp_eq_u32 vcc, -1, v31
  s_cbranch_vccz FL_x_013_ok3
FL_x_013_x3:
  s_mov_b64 exec, vcc
  buffer_load_dwordx4 v[76:79], v9, s[4:7], s41 offen offset:3072 sc1
  s_mov_b64 exec, -1
  s_add_u32 s46, s46, 1
  s_cmp_ge_u32 s46, 131072
  s_cbranch_scc1 FL_rec_abort
  s_waitcnt vmcnt(4)
  s_branch FL_x_013_c0
FL_x_013_ok0:
  v_mfma_f32_16x16x32_bf16 v[44:47], v[64:67], v[64:67], v[44:47]
  v_max3_u32 v31, v68, v69, v70
  v_max_u32 v31, v31, v71
  v_cmp_eq_u32 vcc, -1, v31
  v_mfma_f32_16x16x32_bf16 v[36:39], v[116:119], v[64:67], v[36:39]
  v_mfma_f32_16x16x32_bf16 v[40:43], v[132:135], v[64:67], v[40:43]
  s_cbranch_vccz FL_x_13_ok1
  s_branch FL_x_13_x1
FL_x_013_ok1:
  v_mfma_f32_16x16x32_bf16 v[44:47], v[68:71], v[68:71], v[44:47]
  v_max3_u32 v31, v76, v77, v78
  v_max_u32 v31, v31, v79
  v_cmp_eq_u32 vcc, -1, v31
  v_mfma_f32_16x16x32_bf16 v[36:39], v[120:123], v[68:71], v[36:39]
  v_mfma_f32_16x16x32_bf16 v[40:43], v[136:139], v[68:71], v[40:43]
  s_cbranch_vccz FL_x_03_ok3
  s_branch FL_x_03_x3
FL_x_013_ok3:
  v_mfma_f32_16x16x32_bf16 v[44:47], v[76:79], v[76:79], v[44:47]
  v_max3_u32 v31, v64, v65, v66
  v_max_u32 v31, v31, v67
  v_cmp_eq_u32 vcc, -1, v31
  v_mfma_f32_16x16x32_bf16 v[36:39], v[128:131], v[76:79], v[36:39]
  v_mfma_f32_16x16x32_bf16 v[40:43], v[144:147], v[76:79], v[40:43]
  s_cbranch_vccz FL_x_01_ok0
  s_branch FL_x_01_x0
FL_x_023_c0:
  v_max3_u32 v31, v64, v65, v66
  v_max_u32 v31, v31, v67
  v_cmp_eq_u32 vcc, -1, v31
  s_cbranch_vccz FL_x_023_ok0
FL_x_023_x0:
  s_mov_b64 exec, vcc
  buffer_load_dwordx4 v[64:67], v9, s[4:7], s41 offen offset:0 sc1
  s_mov_b64 exec, -1
FL_x_023_c2:
  v_max3_u32 v31, v72, v73, v74
  v_max_u32 v31, v31, v75
  v_cmp_eq_u32 vcc, -1, v31
  s_cbranch_vccz FL_x_023_ok2
FL_x_023_x2:
  s_mov_b64 exec, vcc
  buffer_load_dwordx4 v[72:75], v9, s[4:7], s41 offen offset:2048 sc1
  s_mov_b64 exec, -1
FL_x_023_c3:
  v_max3_u32 v31, v76, v77, v78
  v_max_u32 v31, v31, v79
  v_cmp_eq_u32 vcc, -1, v31
  s_cbranch_vccz FL_x_023_ok3
FL_x_023_x3:
  s_mov_b64 exec, vcc
  buffer_load_dwordx4 v[76:79], v9, s[4:7], s41 offen offset:3072 sc1
  s_mov_b64 exec, -1
  s_add_u32 s46, s46, 1
  s_cmp_ge_u32 s46, 131072
  s_cbranch_scc1 FL_rec_abort
  s_waitcnt vmcnt(4)
  s_branch FL_x_023_c0
FL_x_023_ok0:
  v_mfma_f32_16x16x32_bf16 v[44:47], v[64:67], v[64:67], v[44:47]
  v_max3_u32 v31, v72, v73, v74
  v_max_u32 v31, v31, v75
  v_cmp_eq_u32 vcc, -1, v31
  v_mfma_f32_16x16x32_bf16 v[36:39], v[116:119], v[64:67], v[36:39]
  v_mfma_f32_16x16x32_bf16 v[40:43], v[132:135], v[64:67], v[40:43]
  s_cbranch_vccz FL_x_23_ok2
  s_branch FL_x_23_x2
FL_x_023_ok2:
  v_mfma_f32_16x16x32_bf16 v[44:47], v[72:75], v[72:75], v[44:47]
  v_max3_u32 v31, v76, v77, v78
  v_max_u32 v31, v31, v79
  v_cmp_eq_u32 vcc, -1, v31
  v_mfma_f32_16x16x32_bf16 v[36:39], v[124:127], v[72:75], v[36:39]
  v_mfma_f32_16x16x32_bf16 v[40:43], v[140:143], v[72:75], v[40:43]
  s_cbranch_vccz FL_x_03_ok3
  s_branch FL_x_03_x3
FL_x_023_ok3:
  v_mfma_f32_16x16x32_bf16 v[44:47], v[76:79], v[76:79], v[44:47]
  v_max3_u32 v31, v64, v65, v66
  v_max_u32 v31, v31, v67
  v_cmp_eq_u32 vcc, -1, v31
  v_mfma_f32_16x16x32_bf16 v[36:39], v[128:131], v[76:79], v[36:39]
  v_mfma_f32_16x16x32_bf16 v[40:43], v[144:147], v[76:79], v[40:43]
  s_cbranch_vccz FL_x_02_ok0
  s_branch FL_x_02_x0
FL_x_123_c1:
  v_max3_u32 v31, v68, v69, v70
  v_max_u32 v31, v31, v71
  v_cmp_eq_u32 vcc, -1, v31
  s_cbranch_vccz FL_x_123_ok1
FL_x_123_x1:
  s_mov_b64 exec, vcc
  buffer_load_dwordx4 v[68:71], v9, s[4:7], s41 offen offset:1024 sc1
  s_mov_b64 exec, -1
FL_x_123_c2:
  v_max3_u32 v31, v72, v73, v74
  v_max_u32 v31, v31, v75
  v_cmp_eq_u32 vcc, -1, v31
  s_cbranch_vccz FL_x_123_ok2
FL_x_123_x2:
  s_mov_b64 exec, vcc
  buffer_load_dwordx4 v[72:75], v9, s[4:7], s41 offen offset:2048 sc1
  s_mov_b64 exec, -1
FL_x_123_c3:
  v_max3_u32 v31, v76, v77, v78
  v_max_u32 v31, v31, v79
  v_cmp_eq_u32 vcc, -1, v31
  s_cbranch_vccz FL_x_123_ok3
FL_x_123_x3:
  s_mov_b64 exec, vcc
  buffer_load_dwordx4 v[76:79], v9, s[4:7], s41 offen offset:3072 sc1
  s_mov_b64 exec, -1
  s_add_u32 s46, s46, 1
  s_cmp_ge_u32 s46, 131072
  s_cbranch_scc1 FL_rec_abort
  s_waitcnt vmcnt(4)
  s_branch FL_x_123_c1
FL_x_123_ok1:
  v_mfma_f32_16x16x32_bf16 v[44:47], v[68:71], v[68:71], v[44:47]
  v_max3_u32 v31, v72, v73, v74
  v_max_u32 v31, v31, v75
  v_cmp_eq_u32 vcc, -1, v31
  v_mfma_f32_16x16x32_bf16 v[36:39], v[120:123], v[68:71], v[36:39]
  v_mfma_f32_16x16x32_bf16 v[40:43], v[136:139], v[68:71], v[40:43]
  s_cbranch_vccz FL_x_23_ok2
  s_branch FL_x_23_x2
FL_x_123_ok2:
  v_mfma_f32_16x16x32_bf16 v[44:47], v[72:75], v[72:75], v[44:47]
  v_max3_u32 v31, v76, v77, v78
  v_max_u32 v31, v31, v79
  v_cmp_eq_u32 vcc, -1, v31
  v_mfma_f32_16x16x32_bf16 v[36:39], v[124:127], v[72:75], v[36:39]
  v_mfma_f32_16x16x32_bf16 v[40:43], v[140:143], v[72:75], v[40:43]
  s_cbranch_vccz FL_x_13_ok3
  s_branch FL_x_13_x3
FL_x_123_ok3:
  v_mfma_f32_16x16x32_bf16 v[44:47], v[76:79], v[76:79], v[44:47]
  v_max3_u32 v31, v68, v69, v70
  v_max_u32 v31, v31, v71
  v_cmp_eq_u32 vcc, -1, v31
  v_mfma_f32_16x16x32_bf16 v[36:39], v[128:131], v[76:79], v[36:39]
  v_mfma_f32_16x16x32_bf16 v[40:43], v[144:147], v[76:79], v[40:43]
  s_cbranch_vccz FL_x_12_ok1
  s_branch FL_x_12_x1
FL_x_0123_c0:
  v_max3_u32 v31, v64, v65, v66
  v_max_u32 v31, v31, v67
  v_cmp_eq_u32 vcc, -1, v31
  s_cbranch_vccz FL_x_0123_ok0
FL_x_0123_x0:
  s_mov_b64 exec, vcc
  buffer_load_dwordx4 v[64:67], v9, s[4:7], s41 offen offset:0 sc1
  s_mov_b64 exec, -1
FL_x_0123_c1:
  v_max3_u32 v31, v68, v69, v70
  v_max_u32 v31, v31, v71
  v_cmp_eq_u32 vcc, -1, v31
  s_cbranch_vccz FL_x_0123_ok1
FL_x_0123_x1:
  s_mov_b64 exec, vcc
  buffer_load_dwordx4 v[68:71], v9, s[4:7], s41 offen offset:1024 sc1
  s_mov_b64 exec, -1
FL_x_0123_c2:
  v_max3_u32 v31, v72, v73, v74
  v_max_u32 v31, v31, v75
  v_cmp_eq_u32 vcc, -1, v31
  s_cbranch_vccz FL_x_0123_ok2
FL_x_0123_x2:
  s_mov_b64 exec, vcc
  buffer_load_dwordx4 v[72:75], v9, s[4:7], s41 offen offset:2048 sc1
  s_mov_b64 exec, -1
FL_x_0123_c3:
  v_max3_u32 v31, v76, v77, v78
  v_max_u32 v31, v31, v79
  v_cmp_eq_u32 vcc, -1, v31
  s_cbranch_vccz FL_x_0123_ok3
FL_x_0123_x3:
  s_mov_b64 exec, vcc
  buffer_load_dwordx4 v[76:79], v9, s[4:7], s41 offen offset:3072 sc1
  s_mov_b64 exec, -1
  s_add_u32 s46, s46, 1
  s_cmp_ge_u32 s46, 131072
  s_cbranch_scc1 FL_rec_abort
  s_waitcnt vmcnt(4)
  s_branch FL_x_0123_c0
FL_x_0123_ok0:
  v_mfma_f32_16x16x32_bf16 v[44:47], v[64:67], v[64:67], v[44:47]
  v_max3_u32 v31, v68, v69, v70
  v_max_u32 v31, v31, v71
  v_cmp_eq_u32 vcc, -1, v31
  v_mfma_f32_16x16x32_bf16 v[36:39], v[116:119], v[64:67], v[36:39]
  v_mfma_f32_16x16x32_bf16 v[40:43], v[132:135], v[64:67], v[40:43]
  s_cbranch_vccz FL_x_123_ok1
  s_branch FL_x_123_x1
FL_x_0123_ok1:
  v_mfma_f32_16x16x32_bf16 v[44:47], v[68:71], v[68:71], v[44:47]
  v_max3_u32 v31, v72, v73, v74
  v_max_u32 v31, v31, v75
  v_cmp_eq_u32 vcc, -1, v31
  v_mfma_f32_16x16x32_bf16 v[36:39], v[120:123], v[68:71], v[36:39]
  v_mfma_f32_16x16x32_bf16 v[40:43], v[136:139], v[68:71], v[40:43]
  s_cbranch_vccz FL_x_023_ok2
  s_branch FL_x_023_x2
FL_x_0123_ok2:
  v_mfma_f32_16x16x32_bf16 v[44:47], v[72:75], v[72:75], v[44:47]
  v_max3_u32 v31, v76, v77, v78
  v_max_u32 v31, v31, v79
  v_cmp_eq_u32 vcc, -1, v31
  v_mfma_f32_16x16x32_bf16 v[36:39], v[124:127], v[72:75], v[36:39]
  v_mfma_f32_16x16x32_bf16 v[40:43], v[140:143], v[72:75], v[40:43]
  s_cbranch_vccz FL_x_013_ok3
  s_branch FL_x_013_x3
FL_x_0123_ok3:
  v_mfma_f32_16x16x32_bf16 v[44:47], v[76:79], v[76:79], v[44:47]
  v_max3_u32 v31, v64, v65, v66
  v_max_u32 v31, v31, v67
  v_cmp_eq_u32 vcc, -1, v31
  v_mfma_f32_16x16x32_bf16 v[36:39], v[128:131], v[76:79], v[36:39]
  v_mfma_f32_16x16x32_bf16 v[40:43], v[144:147], v[76:79], v[40:43]
  s_cbranch_vccz FL_x_012_ok0
  s_branch FL_x_012_x0
FL_v_f:
  buffer_load_dwordx4 v[88:91], v10, s[4:7], s41 offen offset:0 sc1
  buffer_load_dwordx4 v[92:95], v10, s[4:7], s41 offen offset:1024 sc1
  s_add_u32 s46, s46, 1
  s_cmp_ge_u32 s46, 131072
  s_cbranch_scc1 FL_rec_abort
  s_waitcnt vmcnt(0)
  v_max3_u32 v31, v88, v89, v90
  v_max3_u32 v31, v31, v91, v92
  v_max3_u32 v31, v31, v93, v94
  v_max_u32 v31, v31, v95
  v_cmp_eq_u32 vcc, -1, v31
  s_cbranch_vccnz FL_v_f
  s_branch FL_v_ok
FL_rec_abort:
  s_waitcnt vmcnt(0)
  s_endpgm
L_recslow:
  s_load_dwordx4 s[80:83], s[0:1], 8
  s_load_dwordx4 s[84:87], s[0:1], 24
  s_load_dwordx2 s[88:89], s[0:1], 40
  v_lshrrev_b32 v31, 6, v0
  s_nop 0
  v_readfirstlane_b32 s32, v31
  v_and_b32 v0, 63, v0
  s_lshr_b32 s35, s34, 4
  s_lshl_b32 s90, s33, 1
  s_add_u32 s35, s35, s90
  s_and_b32 s36, s34, 15
  s_lshr_b32 s37, s36, 2
  s_lshl_b32 s90, s35, 2
  s_add_u32 s37, s37, s90
  s_and_b32 s38, s36, 3
  s_waitcnt lgkmcnt(0)
  s_mov_b32 s24, s80
  s_and_b32 s25, s81, 0xffff
  s_mov_b32 s26, 0x4000
  s_mov_b32 s27, 0x20000
  s_mov_b32 s8, s82
  s_and_b32 s9, s83, 0xffff
  s_mov_b32 s10, 0x800000
  s_mov_b32 s11, 0x20000
  s_mov_b32 s12, s84
  s_and_b32 s13, s85, 0xffff
  s_mov_b32 s14, 0x800000
  s_mov_b32 s15, 0x20000
  s_mov_b32 s16, s86
  s_and_b32 s17, s87, 0xffff
  s_mov_b32 s18, 0x800000
  s_mov_b32 s19, 0x20000
  s_mov_b32 s20, s88
  s_and_b32 s21, s89, 0xffff
  s_mov_b32 s22, 0x800000
  s_mov_b32 s23, 0x20000
  s_lshl_b32 s90, s32, 21
  s_lshl_b32 s91, s37, 8
  s_add_u32 s90, s90, s91
  s_lshr_b32 s91, s38, 1
  s_lshl_b32 s91, s91, 7
  s_add_u32 s90, s90, s91
  v_mov_b32 v180, 0x0
  v_bfe_u32 v31, v0, 3, 3
  v_lshl_add_u32 v180, v31, 13, v180
  v_bfe_u32 v31, v0, 0, 3
  v_lshl_add_u32 v180, v31, 4, v180
  v_add_u32 v180, s90, v180
  v_xor_b32 v185, 128, v180
  s_lshl_b32 s90, s35, 2
  s_add_u32 s90, s90, s32
  s_lshl_b32 s90, s90, 18
  s_lshl_b32 s91, s36, 7
  s_add_u32 s90, s90, s91
  v_mov_b32 v181, 0x0
  v_bfe_u32 v31, v0, 3, 3
  v_lshl_add_u32 v181, v31, 11, v181
  v_bfe_u32 v31, v0, 0, 3
  v_lshl_add_u32 v181, v31, 4, v181
  v_add_u32 v181, s90, v181
  s_lshl_b32 s96, s32, 15
  s_and_b32 s91, s38, 1
  s_lshl_b32 s91, s91, 6
  s_add_u32 s91, s91, s96
  v_mov_b32 v182, 0x0
  v_bfe_u32 v31, v0, 5, 1
  v_lshl_add_u32 v182, v31, 11, v182
  v_bfe_u32 v31, v0, 4, 1
  v_lshl_add_u32 v182, v31, 10, v182
  v_bfe_u32 v31, v0, 2, 2
  v_lshl_add_u32 v182, v31, 7, v182
  v_bfe_u32 v31, v0, 0, 2
  v_lshl_add_u32 v182, v31, 3, v182
  v_add_u32 v182, s91, v182
  s_lshl_b32 s91, s32, 5
  v_mov_b32 v183, 0x0
  v_bfe_u32 v31, v0, 4, 1
  v_lshl_add_u32 v183, v31, 13, v183
  v_bfe_u32 v31, v0, 5, 1
  v_lshl_add_u32 v183, v31, 8, v183
  v_bfe_u32 v31, v0, 2, 1
  v_lshl_add_u32 v183, v31, 10, v183
  v_bfe_u32 v31, v0, 3, 1
  v_lshl_add_u32 v183, v31, 7, v183
  v_bfe_u32 v31, v0, 0, 2
  v_lshl_add_u32 v183, v31, 3, v183
  v_add_u32 v183, s91, v183
  v_add_u32 v184, 0x10000, v183
  s_lshl_b32 s97, s34, 2
  s_add_u32 s97, s97, s32
  s_lshl_b32 s98, s97, 14
  s_lshl_b32 s91, s33, 21
  s_add_u32 s98, s98, s91
  s_lshl_b32 s97, s97, 16
  s_lshl_b32 s91, s33, 11
  s_add_u32 s97, s97, s91
  v_mov_b32 v16, 0x0
  v_bfe_u32 v31, v0, 0, 4
  v_lshl_add_u32 v16, v31, 7, v16
  v_bfe_u32 v31, v0, 4, 2
  v_lshl_add_u32 v16, v31, 13, v16
  v_add_u32 v17, 0x8000, v16
  v_lshlrev_b32 v18, 7, v0
  v_add_u32 v19, 0x2000, v18
  s_lshl_b32 s97, s34, 2
  s_add_u32 s97, s97, s32
  s_lshl_b32 s98, s97, 14
  s_lshl_b32 s91, s33, 21
  s_add_u32 s98, s98, s91
  s_lshl_b32 s97, s97, 16
  s_lshl_b32 s91, s33, 11
  s_add_u32 s97, s97, s91
  v_mov_b32 v16, 0x180
  v_bfe_u32 v31, v0, 0, 1
  v_lshl_add_u32 v16, v31, 10, v16
  v_bfe_u32 v31, v0, 1, 3
  v_lshl_add_u32 v16, v31, 13, v16
  v_mov_b32 v17, 0x180
  v_bfe_u32 v31, v0, 0, 4
  v_lshl_add_u32 v17, v31, 10, v17
  s_mov_b64 exec, 0xffff
  buffer_load_dword v201, v16, s[12:15], s97 offen
  buffer_load_dword v202, v16, s[16:19], s97 offen
  buffer_load_dword v200, v16, s[8:11], s97 offen
  buffer_load_dword v203, v17, s[20:23], s98 offen
  s_mov_b64 exec, -1
  s_lshl_b32 s58, s33, 5
  s_add_u32 s58, s58, s34
  s_lshl_b32 s59, s32, 19
  s_add_u32 s59, s59, 0x3800000
  s_lshl_b32 s90, s58, 11
  s_add_u32 s90, s90, s59
  s_mul_i32 s91, s58, 3072
  s_add_u32 s91, s91, s59
  s_add_u32 s91, s91, 0x200000
  v_lshlrev_b32 v6, 4, v0
  v_mov_b32 v8, -1
  v_mov_b32 v12, 0
  v_mov_b32 v9, -1
  v_mov_b32 v13, 0
  v_mov_b32 v10, -1
  v_mov_b32 v14, 0
  v_mov_b32 v11, -1
  v_mov_b32 v15, 0
  buffer_store_dwordx4 v[8:11], v6, s[4:7], s90 offen offset:0 sc1
  buffer_store_dwordx4 v[8:11], v6, s[4:7], s90 offen offset:1024 sc1
  buffer_store_dwordx4 v[8:11], v6, s[4:7], s91 offen offset:0 sc1
  buffer_store_dwordx4 v[8:11], v6, s[4:7], s91 offen offset:1024 sc1
  buffer_store_dwordx4 v[8:11], v6, s[4:7], s91 offen offset:2048 sc1
  s_lshl_b32 s58, s58, 2
  s_add_u32 s58, s58, s32
  s_cmp_ge_u32 s58, 36
  s_cbranch_scc1 SL_nz_1
  s_lshl_b32 s90, s58, 10
  s_add_u32 s90, s90, 0x3d00000
  buffer_store_dwordx4 v[12:15], v6, s[4:7], s90 offen sc1
SL_nz_1:
  s_add_u32 m0, s96, 0
  s_mov_b32 s90, 0x0
  buffer_load_dwordx4 v180, s[12:15], s90 offen  lds
  s_add_u32 m0, s96, 1024
  s_mov_b32 s90, 0x10000
  buffer_load_dwordx4 v180, s[12:15], s90 offen  lds
  s_add_u32 m0, s96, 2048
  s_mov_b32 s90, 0x20000
  buffer_load_dwordx4 v180, s[12:15], s90 offen  lds
  s_add_u32 m0, s96, 3072
  s_mov_b32 s90, 0x30000
  buffer_load_dwordx4 v180, s[12:15], s90 offen  lds
  s_add_u32 m0, s96, 4096
  s_mov_b32 s90, 0x0
  buffer_load_dwordx4 v185, s[16:19], s90 offen  lds
  s_add_u32 m0, s96, 5120
  s_mov_b32 s90, 0x10000
  buffer_load_dwordx4 v185, s[16:19], s90 offen  lds
  s_add_u32 m0, s96, 6144
  s_mov_b32 s90, 0x20000
  buffer_load_dwordx4 v185, s[16:19], s90 offen  lds
  s_add_u32 m0, s96, 7168
  s_mov_b32 s90, 0x30000
  buffer_load_dwordx4 v185, s[16:19], s90 offen  lds
  s_add_u32 m0, s96, 8192
  s_mov_b32 s90, 0x40000
  buffer_load_dwordx4 v180, s[12:15], s90 offen  lds
  s_add_u32 m0, s96, 9216
  s_mov_b32 s90, 0x50000
  buffer_load_dwordx4 v180, s[12:15], s90 offen  lds
  s_add_u32 m0, s96, 10240
  s_mov_b32 s90, 0x60000
  buffer_load_dwordx4 v180, s[12:15], s90 offen  lds
  s_add_u32 m0, s96, 11264
  s_mov_b32 s90, 0x70000
  buffer_load_dwordx4 v180, s[12:15], s90 offen  lds
  s_add_u32 m0, s96, 12288
  s_mov_b32 s90, 0x40000
  buffer_load_dwordx4 v185, s[16:19], s90 offen  lds
  s_add_u32 m0, s96, 13312
  s_mov_b32 s90, 0x50000
  buffer_load_dwordx4 v185, s[16:19], s90 offen  lds
  s_add_u32 m0, s96, 14336
  s_mov_b32 s90, 0x60000
  buffer_load_dwordx4 v185, s[16:19], s90 offen  lds
  s_add_u32 m0, s96, 15360
  s_mov_b32 s90, 0x70000
  buffer_load_dwordx4 v185, s[16:19], s90 offen  lds
  s_add_u32 m0, s96, 16384
  s_mov_b32 s90, 0x80000
  buffer_load_dwordx4 v180, s[12:15], s90 offen  lds
  s_add_u32 m0, s96, 17408
  s_mov_b32 s90, 0x90000
  buffer_load_dwordx4 v180, s[12:15], s90 offen  lds
  s_add_u32 m0, s96, 18432
  s_mov_b32 s90, 0xa0000
  buffer_load_dwordx4 v180, s[12:15], s90 offen  lds
  s_add_u32 m0, s96, 19456
  s_mov_b32 s90, 0xb0000
  buffer_load_dwordx4 v180, s[12:15], s90 offen  lds
  s_add_u32 m0, s96, 20480
  s_mov_b32 s90, 0x80000
  buffer_load_dwordx4 v185, s[16:19], s90 offen  lds
  s_add_u32 m0, s96, 21504
  s_mov_b32 s90, 0x90000
  buffer_load_dwordx4 v185, s[16:19], s90 offen  lds
  s_add_u32 m0, s96, 22528
  s_mov_b32 s90, 0xa0000
  buffer_load_dwordx4 v185, s[16:19], s90 offen  lds
  s_add_u32 m0, s96, 23552
  s_mov_b32 s90, 0xb0000
  buffer_load_dwordx4 v185, s[16:19], s90 offen  lds
  s_add_u32 m0, s96, 24576
  s_mov_b32 s90, 0xc0000
  buffer_load_dwordx4 v180, s[12:15], s90 offen  lds
  s_add_u32 m0, s96, 25600
  s_mov_b32 s90, 0xd0000
  buffer_load_dwordx4 v180, s[12:15], s90 offen  lds
  s_add_u32 m0, s96, 26624
  s_mov_b32 s90, 0xe0000
  buffer_load_dwordx4 v180, s[12:15], s90 offen  lds
  s_add_u32 m0, s96, 27648
  s_mov_b32 s90, 0xf0000
  buffer_load_dwordx4 v180, s[12:15], s90 offen  lds
  s_add_u32 m0, s96, 28672
  s_mov_b32 s90, 0xc0000
  buffer_load_dwordx4 v185, s[16:19], s90 offen  lds
  s_add_u32 m0, s96, 29696
  s_mov_b32 s90, 0xd0000
  buffer_load_dwordx4 v185, s[16:19], s90 offen  lds
  s_add_u32 m0, s96, 30720
  s_mov_b32 s90, 0xe0000
  buffer_load_dwordx4 v185, s[16:19], s90 offen  lds
  s_add_u32 m0, s96, 31744
  s_mov_b32 s90, 0xf0000
  buffer_load_dwordx4 v185, s[16:19], s90 offen  lds
  s_lshl_b32 s90, s34, 2
  s_add_u32 s90, s90, s32
  s_lshr_b32 s91, s90, 3
  s_lshl_b32 s91, s91, 14
  s_and_b32 s92, s90, 7
  s_lshl_b32 s92, s92, 10
  s_add_u32 s91, s91, s92
  v_mov_b32 v1, 0x0
  v_bfe_u32 v31, v0, 0, 6
  v_lshl_add_u32 v1, v31, 4, v1
  v_add_u32 v1, s91, v1
  v_lshrrev_b32 v30, 4, v0
  v_cmp_eq_u32 vcc, s33, v30
  v_xor_b32 v29, 0x2000, v1
  s_nop 0
  v_cndmask_b32 v1, v1, v29, vcc
  s_lshl_b32 s91, s33, 14
  s_lshl_b32 s92, s90, 7
  s_add_u32 s91, s91, s92
  v_mov_b32 v2, 0x200000
  v_bfe_u32 v31, v0, 0, 2
  v_lshl_add_u32 v2, v31, 2, v2
  v_bfe_u32 v31, v0, 2, 1
  v_lshl_add_u32 v2, v31, 6, v2
  v_bfe_u32 v31, v0, 4, 1
  v_lshl_add_u32 v2, v31, 4, v2
  v_bfe_u32 v31, v0, 5, 1
  v_lshl_add_u32 v2, v31, 5, v2
  v_bfe_u32 v31, v0, 3, 1
  v_lshl_add_u32 v2, v31, 31, v2
  v_add_u32 v2, s91, v2
  s_lshr_b32 s92, s90, 1
  s_lshl_b32 s92, s92, 5
  s_and_b32 s91, s90, 1
  s_lshl_b32 s91, s91, 13
  s_add_u32 s92, s92, s91
  v_mov_b32 v30, 0x0
  v_bfe_u32 v31, v0, 2, 1
  v_lshl_add_u32 v30, v31, 12, v30
  v_bfe_u32 v31, v0, 4, 1
  v_lshl_add_u32 v30, v31, 11, v30
  v_bfe_u32 v31, v0, 0, 2
  v_lshl_add_u32 v30, v31, 3, v30
  v_bfe_u32 v31, v0, 5, 1
  v_lshl_add_u32 v30, v31, 2, v30
  v_add_u32 v30, s92, v30
  buffer_load_dword v44, v30, s[24:27], 0 offen
  s_lshl_b32 s91, s33, 14
  s_lshl_b32 s92, s32, 12
  s_add_u32 s91, s91, s92
  v_mov_b32 v3, 0x200000
  v_bfe_u32 v31, v0, 0, 6
  v_lshl_add_u32 v3, v31, 4, v3
  v_add_u32 v3, s91, v3
  s_mul_i32 s91, s32, 3264
  v_mov_b32 v4, 0x0
  v_bfe_u32 v31, v0, 0, 6
  v_lshl_add_u32 v4, v31, 4, v4
  v_add_u32 v4, s91, v4
  s_lshl_b32 s91, s32, 6
  v_mov_b32 v6, 0x0
  v_bfe_u32 v31, v0, 0, 2
  v_lshl_add_u32 v6, v31, 4, v6
  v_bfe_u32 v31, v0, 2, 1
  v_lshl_add_u32 v6, v31, 2, v6
  v_bfe_u32 v31, v0, 3, 1
  s_mov_b32 s99, 1088
  v_mad_u32_u24 v6, v31, s99, v6
  v_bfe_u32 v31, v0, 4, 2
  v_lshl_add_u32 v6, v31, 8, v6
  v_add_u32 v6, s91, v6
  v_add_u32 v240, 3264, v6
  v_add_u32 v241, 6528, v6
  v_add_u32 v242, 9792, v6
  s_lshl_b32 s93, s37, 13
  s_lshl_b32 s91, s38, 10
  s_add_u32 s91, s91, s93
  s_lshl_b32 s92, s32, 8
  s_add_u32 s91, s91, s92
  v_mov_b32 v7, 0x210000
  v_bfe_u32 v31, v0, 0, 6
  v_lshl_add_u32 v7, v31, 2, v7
  v_add_u32 v7, s91, v7
  s_lshl_b32 s91, s37, 11
  s_lshl_b32 s92, s38, 9
  s_add_u32 s59, s91, s92
  s_lshl_b32 s92, s32, 7
  s_add_u32 s91, s59, s92
  v_mov_b32 v19, 0x83000000
  v_bfe_u32 v31, v0, 0, 3
  v_lshl_add_u32 v19, v31, 2, v19
  v_bfe_u32 v31, v0, 4, 2
  v_lshl_add_u32 v19, v31, 5, v19
  v_bfe_u32 v31, v0, 3, 1
  v_lshl_add_u32 v19, v31, 31, v19
  v_add_u32 v19, s91, v19
  s_lshl_b32 s91, s32, 8
  v_mov_b32 v5, 0x880
  v_bfe_u32 v31, v0, 0, 1
  v_lshl_add_u32 v5, v31, 7, v5
  v_bfe_u32 v31, v0, 1, 1
  v_lshl_add_u32 v5, v31, 3, v5
  v_bfe_u32 v31, v0, 2, 3
  v_lshl_add_u32 v5, v31, 4, v5
  v_add_u32 v5, s91, v5
  s_lshr_b32 s92, s38, 1
  s_xor_b32 s92, s92, 1
  s_lshl_b32 s92, s92, 10
  s_add_u32 s91, s91, s92
  s_add_u32 s91, s91, s93
  s_and_b32 s92, s38, 1
  s_lshl_b32 s92, s92, 7
  s_add_u32 s91, s91, s92
  v_mov_b32 v8, 0x211000
  v_bfe_u32 v31, v0, 0, 5
  v_lshl_add_u32 v8, v31, 2, v8
  v_bfe_u32 v31, v0, 5, 1
  v_lshl_add_u32 v8, v31, 31, v8
  v_add_u32 v8, s91, v8
  s_sub_u32 s91, s91, s93
  s_lshl_b32 s92, s37, 11
  s_add_u32 s91, s91, s92
  v_mov_b32 v20, 0x3400000
  v_bfe_u32 v31, v0, 0, 5
  v_lshl_add_u32 v20, v31, 2, v20
  v_bfe_u32 v31, v0, 5, 1
  v_lshl_add_u32 v20, v31, 31, v20
  v_add_u32 v20, s91, v20
  s_lshl_b32 s97, s35, 2
  s_add_u32 s97, s97, s32
  s_lshl_b32 s97, s97, 13
  v_mov_b32 v9, 0x210000
  v_bfe_u32 v31, v0, 0, 6
  v_lshl_add_u32 v9, v31, 4, v9
  v_add_u32 v9, s97, v9
  v_add_u32 v10, 4096, v9
  v_mov_b32 v11, 0x1000000
  v_bfe_u32 v31, v0, 0, 2
  v_lshl_add_u32 v11, v31, 4, v11
  v_bfe_u32 v31, v0, 2, 1
  v_lshl_add_u32 v11, v31, 7, v11
  v_bfe_u32 v31, v0, 3, 1
  v_lshl_add_u32 v11, v31, 12, v11
  v_bfe_u32 v31, v0, 4, 2
  v_lshl_add_u32 v11, v31, 8, v11
  v_add_u32 v11, s97, v11
  v_mov_b32 v12, 0x2000000
  v_bfe_u32 v31, v0, 0, 3
  v_lshl_add_u32 v12, v31, 4, v12
  v_bfe_u32 v31, v0, 3, 1
  v_lshl_add_u32 v12, v31, 11, v12
  v_bfe_u32 v31, v0, 4, 2
  v_lshl_add_u32 v12, v31, 8, v12
  v_add_u32 v12, s97, v12
  v_add_u32 v13, 4096, v12
  s_lshl_b32 s91, s36, 9
  s_add_u32 s91, s91, s97
  s_add_u32 s63, s91, 0x1000000
  v_mov_b32 v21, 0x1000000
  v_bfe_u32 v31, v0, 0, 2
  v_lshl_add_u32 v21, v31, 7, v21
  v_bfe_u32 v31, v0, 2, 1
  v_lshl_add_u32 v21, v31, 24, v21
  v_add_u32 v21, s91, v21
  v_cmp_gt_u32 vcc, 8, v0
  v_mov_b32 v30, 0x80000000
  s_nop 0
  v_cndmask_b32 v21, v30, v21, vcc
  s_lshl_b32 s91, s32, 11
  v_mov_b32 v30, 0x0
  v_bfe_u32 v31, v0, 2, 1
  v_lshl_add_u32 v30, v31, 6, v30
  v_bfe_u32 v31, v0, 0, 1
  v_lshl_add_u32 v30, v31, 5, v30
  v_bfe_u32 v31, v0, 1, 1
  v_lshl_add_u32 v30, v31, 4, v30
  v_mov_b32 v29, 0x0
  v_bfe_u32 v31, v0, 4, 2
  v_lshl_add_u32 v29, v31, 5, v29
  v_xor_b32 v30, v30, v29
  v_mov_b32 v14, 0x3400
  v_bfe_u32 v31, v0, 0, 4
  v_lshl_add_u32 v14, v31, 7, v14
  v_add_u32 v14, s91, v14
  v_add_u32 v14, v14, v30
  v_xor_b32 v15, 16, v14
  v_mov_b32 v30, 0x0
  v_bfe_u32 v31, v0, 5, 1
  v_lshl_add_u32 v30, v31, 6, v30
  v_bfe_u32 v31, v0, 1, 1
  v_lshl_add_u32 v30, v31, 5, v30
  v_bfe_u32 v31, v0, 4, 1
  v_lshl_add_u32 v30, v31, 4, v30
  v_mov_b32 v29, 0x0
  v_bfe_u32 v31, v0, 2, 2
  v_lshl_add_u32 v29, v31, 5, v29
  v_bfe_u32 v31, v0, 0, 1
  v_lshl_add_u32 v29, v31, 4, v29
  v_xor_b32 v30, v30, v29
  v_mov_b32 v16, 0x3400
  v_bfe_u32 v31, v0, 4, 2
  v_lshl_add_u32 v16, v31, 8, v16
  v_bfe_u32 v31, v0, 1, 1
  v_lshl_add_u32 v16, v31, 7, v16
  v_add_u32 v16, v16, v30
  s_lshl_b32 s98, s36, 14
  s_lshl_b32 s92, s35, 7
  s_add_u32 s98, s98, s92
  s_lshl_b32 s92, s32, 11
  s_add_u32 s91, s98, s92
  v_mov_b32 v17, 0x0
  v_bfe_u32 v31, v0, 0, 5
  v_lshl_add_u32 v17, v31, 2, v17
  v_bfe_u32 v31, v0, 5, 1
  v_lshl_add_u32 v17, v31, 10, v17
  v_add_u32 v17, s91, v17
  v_xor_b32 v18, 0x2000, v17
  s_mov_b32 s48, 0x33333333
  s_mov_b32 s49, 0x33333333
  s_mov_b32 s50, 0xffff0000
  s_mov_b32 s51, 0xffff0000
  s_mov_b32 s52, 0x0000ffff
  s_mov_b32 s53, 0x0000ffff
  s_mov_b32 s54, 0xfffffffe
  s_mov_b32 s47, 0x3e0293ee
  v_mov_b32 v30, 0x4444
  v_mov_b32 v31, 0xeeee
  v_cndmask_b32 v23, v31, v30, s[48:49]
  v_mov_b32 v22, -1
  v_mov_b32 v232, 0
  v_mov_b32 v233, 0
  v_mov_b32 v234, 0
  v_mov_b32 v235, 0
  v_mov_b32 v112, 0
  v_mov_b32 v113, 0
  s_mov_b32 s56, 0xf0f0f0f0
  s_mov_b32 s57, 0xf0f0f0f0
  v_mov_b32 v30, 0x3f80
  v_mov_b32 v31, 1.0
  v_cndmask_b32 v30, v30, v31, s[56:57]
  s_mov_b32 s56, 0x110011
  s_mov_b32 s57, 0x110011
  v_cndmask_b32 v24, 0, v30, s[56:57]
  s_mov_b32 s56, 0x220022
  s_mov_b32 s57, 0x220022
  v_cndmask_b32 v25, 0, v30, s[56:57]
  s_mov_b32 s56, 0x11001100
  s_mov_b32 s57, 0x11001100
  v_cndmask_b32 v26, 0, v30, s[56:57]
  s_mov_b32 s56, 0x22002200
  s_mov_b32 s57, 0x22002200
  v_cndmask_b32 v27, 0, v30, s[56:57]
  s_mov_b32 s40, 0
  s_mov_b32 s41, 0x3800000
  s_mov_b32 s43, 0x3900000
  s_mov_b32 s44, 0
  s_mov_b32 s55, 0x40000
  s_mov_b32 s45, 0
  s_waitcnt vmcnt(33)
  s_barrier
  s_cmp_lg_u32 s32, 0
  s_cbranch_scc1 SL_sig_2
  v_mov_b32 v254, 1
  v_mov_b32 v255, 0
  s_mov_b64 exec, 1
  buffer_atomic_add v254, v255, s[28:31], s100 offen offset:132 sc1
  s_mov_b64 exec, -1
SL_sig_2:
  s_waitcnt vmcnt(28)
  ds_read_b64_tr_b16 a[16:17], v182 offset:0
  ds_read_b64_tr_b16 a[18:19], v182 offset:512
  ds_read_b64_tr_b16 a[24:25], v182 offset:32
  ds_read_b64_tr_b16 a[26:27], v182 offset:544
  s_waitcnt lgkmcnt(0)
  s_add_u32 m0, s96, 0
  s_mov_b32 s90, 0x100000
  buffer_load_dwordx4 v180, s[12:15], s90 offen  lds
  s_add_u32 m0, s96, 1024
  s_mov_b32 s90, 0x110000
  buffer_load_dwordx4 v180, s[12:15], s90 offen  lds
  s_add_u32 m0, s96, 2048
  s_mov_b32 s90, 0x120000
  buffer_load_dwordx4 v180, s[12:15], s90 offen  lds
  s_add_u32 m0, s96, 3072
  s_mov_b32 s90, 0x130000
  buffer_load_dwordx4 v180, s[12:15], s90 offen  lds
  s_waitcnt vmcnt(28)
  ds_read_b64_tr_b16 a[32:33], v182 offset:4096
  ds_read_b64_tr_b16 a[34:35], v182 offset:4608
  ds_read_b64_tr_b16 a[40:41], v182 offset:4128
  ds_read_b64_tr_b16 a[42:43], v182 offset:4640
  s_waitcnt lgkmcnt(0)
  s_add_u32 m0, s96, 4096
  s_mov_b32 s90, 0x100000
  buffer_load_dwordx4 v185, s[16:19], s90 offen  lds
  s_add_u32 m0, s96, 5120
  s_mov_b32 s90, 0x110000
  buffer_load_dwordx4 v185, s[16:19], s90 offen  lds
  s_add_u32 m0, s96, 6144
  s_mov_b32 s90, 0x120000
  buffer_load_dwordx4 v185, s[16:19], s90 offen  lds
  s_add_u32 m0, s96, 7168
  s_mov_b32 s90, 0x130000
  buffer_load_dwordx4 v185, s[16:19], s90 offen  lds
  s_waitcnt vmcnt(28)
  ds_read_b64_tr_b16 a[20:21], v182 offset:8192
  ds_read_b64_tr_b16 a[22:23], v182 offset:8704
  ds_read_b64_tr_b16 a[28:29], v182 offset:8224
  ds_read_b64_tr_b16 a[30:31], v182 offset:8736
  s_waitcnt lgkmcnt(0)
  s_add_u32 m0, s96, 8192
  s_mov_b32 s90, 0x140000
  buffer_load_dwordx4 v180, s[12:15], s90 offen  lds
  s_add_u32 m0, s96, 9216
  s_mov_b32 s90, 0x150000
  buffer_load_dwordx4 v180, s[12:15], s90 offen  lds
  s_add_u32 m0, s96, 10240
  s_mov_b32 s90, 0x160000
  buffer_load_dwordx4 v180, s[12:15], s90 offen  lds
  s_add_u32 m0, s96, 11264
  s_mov_b32 s90, 0x170000
  buffer_load_dwordx4 v180, s[12:15], s90 offen  lds
  s_waitcnt vmcnt(28)
  ds_read_b64_tr_b16 a[36:37], v182 offset:12288
  ds_read_b64_tr_b16 a[38:39], v182 offset:12800
  ds_read_b64_tr_b16 a[44:45], v182 offset:12320
  ds_read_b64_tr_b16 a[46:47], v182 offset:12832
  s_waitcnt lgkmcnt(0)
  s_add_u32 m0, s96, 12288
  s_mov_b32 s90, 0x140000
  buffer_load_dwordx4 v185, s[16:19], s90 offen  lds
  s_add_u32 m0, s96, 13312
  s_mov_b32 s90, 0x150000
  buffer_load_dwordx4 v185, s[16:19], s90 offen  lds
  s_add_u32 m0, s96, 14336
  s_mov_b32 s90, 0x160000
  buffer_load_dwordx4 v185, s[16:19], s90 offen  lds
  s_add_u32 m0, s96, 15360
  s_mov_b32 s90, 0x170000
  buffer_load_dwordx4 v185, s[16:19], s90 offen  lds
  s_waitcnt vmcnt(28)
  ds_read_b64_tr_b16 a[64:65], v182 offset:16384
  ds_read_b64_tr_b16 a[66:67], v182 offset:16896
  ds_read_b64_tr_b16 a[72:73], v182 offset:16416
  ds_read_b64_tr_b16 a[74:75], v182 offset:16928
  s_waitcnt lgkmcnt(0)
  s_add_u32 m0, s96, 16384
  s_mov_b32 s90, 0x180000
  buffer_load_dwordx4 v180, s[12:15], s90 offen  lds
  s_add_u32 m0, s96, 17408
  s_mov_b32 s90, 0x190000
  buffer_load_dwordx4 v180, s[12:15], s90 offen  lds
  s_add_u32 m0, s96, 18432
  s_mov_b32 s90, 0x1a0000
  buffer_load_dwordx4 v180, s[12:15], s90 offen  lds
  s_add_u32 m0, s96, 19456
  s_mov_b32 s90, 0x1b0000
  buffer_load_dwordx4 v180, s[12:15], s90 offen  lds
  s_waitcnt vmcnt(28)
  ds_read_b64_tr_b16 a[80:81], v182 offset:20480
  ds_read_b64_tr_b16 a[82:83], v182 offset:20992
  ds_read_b64_tr_b16 a[88:89], v182 offset:20512
  ds_read_b64_tr_b16 a[90:91], v182 offset:21024
  s_waitcnt lgkmcnt(0)
  s_add_u32 m0, s96, 20480
  s_mov_b32 s90, 0x180000
  buffer_load_dwordx4 v185, s[16:19], s90 offen  lds
  s_add_u32 m0, s96, 21504
  s_mov_b32 s90, 0x190000
  buffer_load_dwordx4 v185, s[16:19], s90 offen  lds
  s_add_u32 m0, s96, 22528
  s_mov_b32 s90, 0x1a0000
  buffer_load_dwordx4 v185, s[16:19], s90 offen  lds
  s_add_u32 m0, s96, 23552
  s_mov_b32 s90, 0x1b0000
  buffer_load_dwordx4 v185, s[16:19], s90 offen  lds
  s_waitcnt vmcnt(28)
  ds_read_b64_tr_b16 a[68:69], v182 offset:24576
  ds_read_b64_tr_b16 a[70:71], v182 offset:25088
  ds_read_b64_tr_b16 a[76:77], v182 offset:24608
  ds_read_b64_tr_b16 a[78:79], v182 offset:25120
  s_waitcnt lgkmcnt(0)
  s_add_u32 m0, s96, 24576
  s_mov_b32 s90, 0x1c0000
  buffer_load_dwordx4 v180, s[12:15], s90 offen  lds
  s_add_u32 m0, s96, 25600
  s_mov_b32 s90, 0x1d0000
  buffer_load_dwordx4 v180, s[12:15], s90 offen  lds
  s_add_u32 m0, s96, 26624
  s_mov_b32 s90, 0x1e0000
  buffer_load_dwordx4 v180, s[12:15], s90 offen  lds
  s_add_u32 m0, s96, 27648
  s_mov_b32 s90, 0x1f0000
  buffer_load_dwordx4 v180, s[12:15], s90 offen  lds
  s_waitcnt vmcnt(28)
  ds_read_b64_tr_b16 a[84:85], v182 offset:28672
  ds_read_b64_tr_b16 a[86:87], v182 offset:29184
  ds_read_b64_tr_b16 a[92:93], v182 offset:28704
  ds_read_b64_tr_b16 a[94:95], v182 offset:29216
  s_waitcnt lgkmcnt(0)
  s_add_u32 m0, s96, 28672
  s_mov_b32 s90, 0x1c0000
  buffer_load_dwordx4 v185, s[16:19], s90 offen  lds
  s_add_u32 m0, s96, 29696
  s_mov_b32 s90, 0x1d0000
  buffer_load_dwordx4 v185, s[16:19], s90 offen  lds
  s_add_u32 m0, s96, 30720
  s_mov_b32 s90, 0x1e0000
  buffer_load_dwordx4 v185, s[16:19], s90 offen  lds
  s_add_u32 m0, s96, 31744
  s_mov_b32 s90, 0x1f0000
  buffer_load_dwordx4 v185, s[16:19], s90 offen  lds
  s_waitcnt vmcnt(28)
  ds_read_b64_tr_b16 a[112:113], v182 offset:0
  ds_read_b64_tr_b16 a[114:115], v182 offset:512
  ds_read_b64_tr_b16 a[120:121], v182 offset:32
  ds_read_b64_tr_b16 a[122:123], v182 offset:544
  s_waitcnt lgkmcnt(0)
  s_add_u32 m0, s96, 0
  s_mov_b32 s90, 0x0
  buffer_load_dwordx4 v180, s[8:11], s90 offen  lds
  s_add_u32 m0, s96, 1024
  s_mov_b32 s90, 0x10000
  buffer_load_dwordx4 v180, s[8:11], s90 offen  lds
  s_add_u32 m0, s96, 2048
  s_mov_b32 s90, 0x20000
  buffer_load_dwordx4 v180, s[8:11], s90 offen  lds
  s_add_u32 m0, s96, 3072
  s_mov_b32 s90, 0x30000
  buffer_load_dwordx4 v180, s[8:11], s90 offen  lds
  s_waitcnt vmcnt(28)
  ds_read_b64_tr_b16 a[128:129], v182 offset:4096
  ds_read_b64_tr_b16 a[130:131], v182 offset:4608
  ds_read_b64_tr_b16 a[136:137], v182 offset:4128
  ds_read_b64_tr_b16 a[138:139], v182 offset:4640
  s_waitcnt lgkmcnt(0)
  s_add_u32 m0, s96, 4096
  s_mov_b32 s90, 0x40000
  buffer_load_dwordx4 v180, s[8:11], s90 offen  lds
  s_add_u32 m0, s96, 5120
  s_mov_b32 s90, 0x50000
  buffer_load_dwordx4 v180, s[8:11], s90 offen  lds
  s_add_u32 m0, s96, 6144
  s_mov_b32 s90, 0x60000
  buffer_load_dwordx4 v180, s[8:11], s90 offen  lds
  s_add_u32 m0, s96, 7168
  s_mov_b32 s90, 0x70000
  buffer_load_dwordx4 v180, s[8:11], s90 offen  lds
  s_waitcnt vmcnt(28)
  ds_read_b64_tr_b16 a[116:117], v182 offset:8192
  ds_read_b64_tr_b16 a[118:119], v182 offset:8704
  ds_read_b64_tr_b16 a[124:125], v182 offset:8224
  ds_read_b64_tr_b16 a[126:127], v182 offset:8736
  s_waitcnt lgkmcnt(0)
  s_add_u32 m0, s96, 8192
  s_mov_b32 s90, 0x80000
  buffer_load_dwordx4 v180, s[8:11], s90 offen  lds
  s_add_u32 m0, s96, 9216
  s_mov_b32 s90, 0x90000
  buffer_load_dwordx4 v180, s[8:11], s90 offen  lds
  s_add_u32 m0, s96, 10240
  s_mov_b32 s90, 0xa0000
  buffer_load_dwordx4 v180, s[8:11], s90 offen  lds
  s_add_u32 m0, s96, 11264
  s_mov_b32 s90, 0xb0000
  buffer_load_dwordx4 v180, s[8:11], s90 offen  lds
  s_waitcnt vmcnt(28)
  ds_read_b64_tr_b16 a[132:133], v182 offset:12288
  ds_read_b64_tr_b16 a[134:135], v182 offset:12800
  ds_read_b64_tr_b16 a[140:141], v182 offset:12320
  ds_read_b64_tr_b16 a[142:143], v182 offset:12832
  s_waitcnt lgkmcnt(0)
  s_add_u32 m0, s96, 12288
  s_mov_b32 s90, 0xc0000
  buffer_load_dwordx4 v180, s[8:11], s90 offen  lds
  s_add_u32 m0, s96, 13312
  s_mov_b32 s90, 0xd0000
  buffer_load_dwordx4 v180, s[8:11], s90 offen  lds
  s_add_u32 m0, s96, 14336
  s_mov_b32 s90, 0xe0000
  buffer_load_dwordx4 v180, s[8:11], s90 offen  lds
  s_add_u32 m0, s96, 15360
  s_mov_b32 s90, 0xf0000
  buffer_load_dwordx4 v180, s[8:11], s90 offen  lds
  s_waitcnt vmcnt(28)
  ds_read_b64_tr_b16 a[160:161], v182 offset:16384
  ds_read_b64_tr_b16 a[162:163], v182 offset:16896
  ds_read_b64_tr_b16 a[168:169], v182 offset:16416
  ds_read_b64_tr_b16 a[170:171], v182 offset:16928
  s_waitcnt lgkmcnt(0)
  s_add_u32 m0, s96, 16384
  s_mov_b32 s90, 0x100000
  buffer_load_dwordx4 v180, s[8:11], s90 offen  lds
  s_add_u32 m0, s96, 17408
  s_mov_b32 s90, 0x110000
  buffer_load_dwordx4 v180, s[8:11], s90 offen  lds
  s_add_u32 m0, s96, 18432
  s_mov_b32 s90, 0x120000
  buffer_load_dwordx4 v180, s[8:11], s90 offen  lds
  s_add_u32 m0, s96, 19456
  s_mov_b32 s90, 0x130000
  buffer_load_dwordx4 v180, s[8:11], s90 offen  lds
  s_waitcnt vmcnt(28)
  ds_read_b64_tr_b16 a[176:177], v182 offset:20480
  ds_read_b64_tr_b16 a[178:179], v182 offset:20992
  ds_read_b64_tr_b16 a[184:185], v182 offset:20512
  ds_read_b64_tr_b16 a[186:187], v182 offset:21024
  s_waitcnt lgkmcnt(0)
  s_add_u32 m0, s96, 20480
  s_mov_b32 s90, 0x140000
  buffer_load_dwordx4 v180, s[8:11], s90 offen  lds
  s_add_u32 m0, s96, 21504
  s_mov_b32 s90, 0x150000
  buffer_load_dwordx4 v180, s[8:11], s90 offen  lds
  s_add_u32 m0, s96, 22528
  s_mov_b32 s90, 0x160000
  buffer_load_dwordx4 v180, s[8:11], s90 offen  lds
  s_add_u32 m0, s96, 23552
  s_mov_b32 s90, 0x170000
  buffer_load_dwordx4 v180, s[8:11], s90 offen  lds
  s_waitcnt vmcnt(28)
  ds_read_b64_tr_b16 a[164:165], v182 offset:24576
  ds_read_b64_tr_b16 a[166:167], v182 offset:25088
  ds_read_b64_tr_b16 a[172:173], v182 offset:24608
  ds_read_b64_tr_b16 a[174:175], v182 offset:25120
  s_waitcnt lgkmcnt(0)
  s_add_u32 m0, s96, 24576
  s_mov_b32 s90, 0x180000
  buffer_load_dwordx4 v180, s[8:11], s90 offen  lds
  s_add_u32 m0, s96, 25600
  s_mov_b32 s90, 0x190000
  buffer_load_dwordx4 v180, s[8:11], s90 offen  lds
  s_add_u32 m0, s96, 26624
  s_mov_b32 s90, 0x1a0000
  buffer_load_dwordx4 v180, s[8:11], s90 offen  lds
  s_add_u32 m0, s96, 27648
  s_mov_b32 s90, 0x1b0000
  buffer_load_dwordx4 v180, s[8:11], s90 offen  lds
  s_waitcnt vmcnt(28)
  ds_read_b64_tr_b16 a[180:181], v182 offset:28672
  ds_read_b64_tr_b16 a[182:183], v182 offset:29184
  ds_read_b64_tr_b16 a[188:189], v182 offset:28704
  ds_read_b64_tr_b16 a[190:191], v182 offset:29216
  s_waitcnt lgkmcnt(0)
  s_add_u32 m0, s96, 28672
  s_mov_b32 s90, 0x1c0000
  buffer_load_dwordx4 v180, s[8:11], s90 offen  lds
  s_add_u32 m0, s96, 29696
  s_mov_b32 s90, 0x1d0000
  buffer_load_dwordx4 v180, s[8:11], s90 offen  lds
  s_add_u32 m0, s96, 30720
  s_mov_b32 s90, 0x1e0000
  buffer_load_dwordx4 v180, s[8:11], s90 offen  lds
  s_add_u32 m0, s96, 31744
  s_mov_b32 s90, 0x1f0000
  buffer_load_dwordx4 v180, s[8:11], s90 offen  lds
  s_waitcnt vmcnt(28)
  ds_read_b64_tr_b16 a[0:1], v182 offset:0
  ds_read_b64_tr_b16 a[2:3], v182 offset:512
  ds_read_b64_tr_b16 a[8:9], v182 offset:32
  ds_read_b64_tr_b16 a[10:11], v182 offset:544
  s_waitcnt lgkmcnt(0)
  s_add_u32 m0, s96, 0
  s_mov_b32 s90, 0x0
  buffer_load_dwordx4 v181, s[20:23], s90 offen  lds
  s_add_u32 m0, s96, 1024
  s_mov_b32 s90, 0x4000
  buffer_load_dwordx4 v181, s[20:23], s90 offen  lds
  s_add_u32 m0, s96, 2048
  s_mov_b32 s90, 0x8000
  buffer_load_dwordx4 v181, s[20:23], s90 offen  lds
  s_add_u32 m0, s96, 3072
  s_mov_b32 s90, 0xc000
  buffer_load_dwordx4 v181, s[20:23], s90 offen  lds
  s_waitcnt vmcnt(28)
  ds_read_b64_tr_b16 a[4:5], v182 offset:4096
  ds_read_b64_tr_b16 a[6:7], v182 offset:4608
  ds_read_b64_tr_b16 a[12:13], v182 offset:4128
  ds_read_b64_tr_b16 a[14:15], v182 offset:4640
  s_waitcnt lgkmcnt(0)
  s_add_u32 m0, s96, 4096
  s_mov_b32 s90, 0x10000
  buffer_load_dwordx4 v181, s[20:23], s90 offen  lds
  s_add_u32 m0, s96, 5120
  s_mov_b32 s90, 0x14000
  buffer_load_dwordx4 v181, s[20:23], s90 offen  lds
  s_add_u32 m0, s96, 6144
  s_mov_b32 s90, 0x18000
  buffer_load_dwordx4 v181, s[20:23], s90 offen  lds
  s_add_u32 m0, s96, 7168
  s_mov_b32 s90, 0x1c000
  buffer_load_dwordx4 v181, s[20:23], s90 offen  lds
  s_waitcnt vmcnt(28)
  ds_read_b64_tr_b16 a[48:49], v182 offset:8192
  ds_read_b64_tr_b16 a[50:51], v182 offset:8704
  ds_read_b64_tr_b16 a[56:57], v182 offset:8224
  ds_read_b64_tr_b16 a[58:59], v182 offset:8736
  s_waitcnt lgkmcnt(0)
  s_add_u32 m0, s96, 8192
  s_mov_b32 s90, 0x20000
  buffer_load_dwordx4 v181, s[20:23], s90 offen  lds
  s_add_u32 m0, s96, 9216
  s_mov_b32 s90, 0x24000
  buffer_load_dwordx4 v181, s[20:23], s90 offen  lds
  s_add_u32 m0, s96, 10240
  s_mov_b32 s90, 0x28000
  buffer_load_dwordx4 v181, s[20:23], s90 offen  lds
  s_add_u32 m0, s96, 11264
  s_mov_b32 s90, 0x2c000
  buffer_load_dwordx4 v181, s[20:23], s90 offen  lds
  s_waitcnt vmcnt(28)
  ds_read_b64_tr_b16 a[52:53], v182 offset:12288
  ds_read_b64_tr_b16 a[54:55], v182 offset:12800
  ds_read_b64_tr_b16 a[60:61], v182 offset:12320
  ds_read_b64_tr_b16 a[62:63], v182 offset:12832
  s_waitcnt lgkmcnt(0)
  s_add_u32 m0, s96, 12288
  s_mov_b32 s90, 0x30000
  buffer_load_dwordx4 v181, s[20:23], s90 offen  lds
  s_add_u32 m0, s96, 13312
  s_mov_b32 s90, 0x34000
  buffer_load_dwordx4 v181, s[20:23], s90 offen  lds
  s_add_u32 m0, s96, 14336
  s_mov_b32 s90, 0x38000
  buffer_load_dwordx4 v181, s[20:23], s90 offen  lds
  s_add_u32 m0, s96, 15360
  s_mov_b32 s90, 0x3c000
  buffer_load_dwordx4 v181, s[20:23], s90 offen  lds
  s_mov_b32 s90, 0x3800000
  buffer_load_dword v204, v2, s[4:7], s90 offen sc1
  buffer_load_dword v204, v7, s[4:7], s90 offen sc1
  buffer_load_dword v204, v8, s[4:7], s90 offen sc1
  s_mov_b32 s90, 0x3880000
  buffer_load_dword v204, v2, s[4:7], s90 offen sc1
  buffer_load_dword v204, v7, s[4:7], s90 offen sc1
  buffer_load_dword v204, v8, s[4:7], s90 offen sc1
  s_mov_b32 s90, 0x3900000
  buffer_load_dword v204, v2, s[4:7], s90 offen sc1
  buffer_load_dword v204, v7, s[4:7], s90 offen sc1
  buffer_load_dword v204, v8, s[4:7], s90 offen sc1
  s_mov_b32 s90, 0x3980000
  buffer_load_dword v204, v2, s[4:7], s90 offen sc1
  buffer_load_dword v204, v7, s[4:7], s90 offen sc1
  buffer_load_dword v204, v8, s[4:7], s90 offen sc1
  s_waitcnt vmcnt(28)
  ds_read_b64_tr_b16 a[96:97], v182 offset:16384
  ds_read_b64_tr_b16 a[98:99], v182 offset:16896
  ds_read_b64_tr_b16 a[104:105], v182 offset:16416
  ds_read_b64_tr_b16 a[106:107], v182 offset:16928
  s_waitcnt vmcnt(24)
  ds_read_b64_tr_b16 a[100:101], v182 offset:20480
  ds_read_b64_tr_b16 a[102:103], v182 offset:20992
  ds_read_b64_tr_b16 a[108:109], v182 offset:20512
  ds_read_b64_tr_b16 a[110:111], v182 offset:21024
  s_waitcnt vmcnt(20)
  ds_read_b64_tr_b16 a[144:145], v182 offset:24576
  ds_read_b64_tr_b16 a[146:147], v182 offset:25088
  ds_read_b64_tr_b16 a[152:153], v182 offset:24608
  ds_read_b64_tr_b16 a[154:155], v182 offset:25120
  s_waitcnt vmcnt(16)
  ds_read_b64_tr_b16 a[148:149], v182 offset:28672
  ds_read_b64_tr_b16 a[150:151], v182 offset:29184
  ds_read_b64_tr_b16 a[156:157], v182 offset:28704
  ds_read_b64_tr_b16 a[158:159], v182 offset:29216
  v_mbcnt_lo_u32_b32 v250, -1, 0
  v_mbcnt_hi_u32_b32 v250, -1, v250
  s_lshl_b32 s90, s32, 9
  s_add_u32 s90, s90, 131136
  v_lshl_add_u32 v251, v250, 3, s90
  ds_write_b64 v251, v[248:249]
  s_waitcnt lgkmcnt(0)
  s_cmp_lg_u32 s32, 0
  s_cbranch_scc1 SL_vd_4
  v_lshlrev_b32 v250, 2, v250
  s_cmp_lg_u32 s100, 0
  s_cbranch_scc1 SL_vw_3
  v_readfirstlane_b32 s90, v247
  s_and_b32 s90, s90, s101
  s_cbranch_scc0 SL_vw_3
  v_mov_b32 v251, 1
  s_mov_b64 exec, 1
  buffer_store_dword v251, v250, s[28:31], 0 offen offset:32 sc1
  s_mov_b64 exec, -1
SL_vw_3:
  buffer_load_dword v251, v250, s[28:31], 0 offen sc1
  s_waitcnt vmcnt(0)
  v_cmp_eq_u32 vcc, -1, v251
  v_readlane_b32 s91, v251, 8
  v_readlane_b32 s92, v251, 32
  v_readlane_b32 s93, v251, 33
  v_readlane_b32 s90, v251, 34
  s_cmp_lg_u32 s100, 0
  s_cselect_b32 s93, s90, s93
  s_cselect_b32 s91, 0, s91
  s_cselect_b32 s92, 1, s92
  s_cselect_b32 s90, 0xff, vcc_lo
  s_cmp_lg_u32 s91, 0
  s_cselect_b32 s92, 3, s92
  s_cbranch_scc1 SL_vk_5
  s_add_u32 s3, s3, 1
  s_cmp_ge_u32 s3, 131072
  s_cselect_b32 s92, 4, s92
  s_cbranch_scc1 SL_vk_5
  s_sleep 8
  s_and_b32 s90, s90, 0xff
  s_cmp_lg_u32 s90, 0xff
  s_cbranch_scc1 SL_vw_3
  s_cmp_lt_u32 s93, 128
  s_cbranch_scc1 SL_vw_3
SL_vk_5:
  v_mov_b32 v251, s92
  v_mov_b32 v250, 131072
  ds_write_b32 v250, v251
  s_waitcnt lgkmcnt(0)
SL_vd_4:
  s_barrier
  v_mov_b32 v250, 131072
  ds_read_b32 v251, v250
  s_waitcnt lgkmcnt(0)
  v_readfirstlane_b32 s92, v251
  s_barrier
  s_cmp_eq_u32 s92, 3
  s_cbranch_scc1 L_fallback
  s_cmp_eq_u32 s92, 4
  s_cbranch_scc1 L_exit
  s_waitcnt vmcnt(0)
  s_barrier
  ds_read_b64_tr_b16 a[192:193], v183 offset:0
  ds_read_b64_tr_b16 a[194:195], v183 offset:2048
  ds_read_b64_tr_b16 a[196:197], v183 offset:512
  ds_read_b64_tr_b16 a[198:199], v183 offset:2560
  ds_read_b64_tr_b16 a[200:201], v183 offset:4096
  ds_read_b64_tr_b16 a[202:203], v183 offset:6144
  ds_read_b64_tr_b16 a[204:205], v183 offset:4608
  ds_read_b64_tr_b16 a[206:207], v183 offset:6656
  s_waitcnt lgkmcnt(0)
  ds_read_b64_tr_b16 a[208:209], v183 offset:32768
  ds_read_b64_tr_b16 a[210:211], v183 offset:34816
  ds_read_b64_tr_b16 a[212:213], v183 offset:33280
  ds_read_b64_tr_b16 a[214:215], v183 offset:35328
  ds_read_b64_tr_b16 a[216:217], v183 offset:36864
  ds_read_b64_tr_b16 a[218:219], v183 offset:38912
  ds_read_b64_tr_b16 a[220:221], v183 offset:37376
  ds_read_b64_tr_b16 a[222:223], v183 offset:39424
  s_waitcnt lgkmcnt(0)
  ds_read_b64_tr_b16 a[224:225], v184 offset:0
  ds_read_b64_tr_b16 a[226:227], v184 offset:2048
  ds_read_b64_tr_b16 a[228:229], v184 offset:512
  ds_read_b64_tr_b16 a[230:231], v184 offset:2560
  ds_read_b64_tr_b16 a[232:233], v184 offset:4096
  ds_read_b64_tr_b16 a[234:235], v184 offset:6144
  ds_read_b64_tr_b16 a[236:237], v184 offset:4608
  ds_read_b64_tr_b16 a[238:239], v184 offset:6656
  s_waitcnt lgkmcnt(0)
  ds_read_b64_tr_b16 a[240:241], v184 offset:32768
  ds_read_b64_tr_b16 a[242:243], v184 offset:34816
  ds_read_b64_tr_b16 a[244:245], v184 offset:33280
  ds_read_b64_tr_b16 a[246:247], v184 offset:35328
  ds_read_b64_tr_b16 a[248:249], v184 offset:36864
  ds_read_b64_tr_b16 a[250:251], v184 offset:38912
  ds_read_b64_tr_b16 a[252:253], v184 offset:37376
  ds_read_b64_tr_b16 a[254:255], v184 offset:39424
  s_waitcnt lgkmcnt(0)
  s_barrier
  s_mov_b32 s46, 0
  s_mov_b32 s39, 0
  v_xor_b32 v1, s39, v1
  v_xor_b32 v17, s39, v17
  v_xor_b32 v18, s39, v18
  s_mov_b32 s12, s63
  s_mov_b32 s90, 0x3800000
  s_mov_b32 s90, 0x3880000
  s_mov_b32 s90, 0x3900000
  s_mov_b32 s90, 0x3980000
  v_mov_b32 v248, 0x3f803f80
  v_mov_b32 v249, 0x3f803f80
  v_mov_b32 v250, 0x3f803f80
  v_mov_b32 v251, 0x3f803f80
  v_mov_b32 v252, 0x3f803f80
  v_mov_b32 v253, 0x3f803f80
  v_mov_b32 v254, 0x3f803f80
  v_mov_b32 v255, 0x3f803f80
  s_cmp_lg_u32 s32, 0
  s_cbranch_scc1 SL_kv0d
  s_lshl_b32 s90, s33, 7
  s_add_u32 s90, s90, 0x3d07000
  v_mov_b32 v30, s90
SL_kv0:
  buffer_load_dword v31, v30, s[4:7], 0 offen sc1
  s_waitcnt vmcnt(0)
  v_readfirstlane_b32 s90, v31
  s_add_u32 s46, s46, 1
  s_cmp_ge_u32 s46, 131072
  s_cbranch_scc1 SL_rec_abort
  s_sleep 2
  s_cmp_lt_u32 s90, 16
  s_cbranch_scc1 SL_kv0
SL_kv0d:
  s_barrier
  buffer_load_dwordx4 v[180:183], v12, s[4:7], s44 offen offset:0
  buffer_load_dwordx4 v[184:187], v12, s[4:7], s44 offen offset:128
  buffer_load_dwordx4 v[188:191], v12, s[4:7], s44 offen offset:1024
  buffer_load_dwordx4 v[192:195], v12, s[4:7], s44 offen offset:1152
  buffer_load_dwordx4 v[196:199], v13, s[4:7], s44 offen offset:0
  buffer_load_dwordx4 v[200:203], v13, s[4:7], s44 offen offset:128
  buffer_load_dwordx4 v[204:207], v13, s[4:7], s44 offen offset:1024
  buffer_load_dwordx4 v[208:211], v13, s[4:7], s44 offen offset:1152
  buffer_load_dwordx4 v[116:119], v11, s[4:7], s44 offen offset:0
  buffer_load_dwordx4 v[132:135], v11, s[4:7], s44 offen offset:64
  buffer_load_dwordx4 v[120:123], v11, s[4:7], s44 offen offset:1024
  buffer_load_dwordx4 v[136:139], v11, s[4:7], s44 offen offset:1088
  buffer_load_dwordx4 v[124:127], v11, s[4:7], s44 offen offset:2048
  buffer_load_dwordx4 v[140:143], v11, s[4:7], s44 offen offset:2112
  buffer_load_dwordx4 v[128:131], v11, s[4:7], s44 offen offset:3072
  buffer_load_dwordx4 v[144:147], v11, s[4:7], s44 offen offset:3136
  s_add_u32 s44, s44, 0x40000
  v_mov_b64 v[64:65], 0
  v_mov_b64 v[66:67], 0
  v_mov_b64 v[68:69], 0
  v_mov_b64 v[70:71], 0
  v_mov_b64 v[72:73], 0
  v_mov_b64 v[74:75], 0
  v_mov_b64 v[76:77], 0
  v_mov_b64 v[78:79], 0
  v_mov_b64 v[80:81], 0
  v_mov_b64 v[82:83], 0
  v_mov_b64 v[84:85], 0
  v_mov_b64 v[86:87], 0
  v_mov_b64 v[32:33], 0
  v_mov_b64 v[34:35], 0
  v_mov_b64 v[212:213], 0
  v_mov_b64 v[214:215], 0
  v_mov_b64 v[216:217], 0
  v_mov_b64 v[218:219], 0
  v_mov_b64 v[220:221], 0
  v_mov_b64 v[222:223], 0
  v_mov_b64 v[224:225], 0
  v_mov_b64 v[226:227], 0
  v_mov_b64 v[228:229], 0
  v_mov_b64 v[230:231], 0
  s_waitcnt vmcnt(0)
  v_min_u32 v44, s54, v44
  s_lshl_b32 s90, s33, 7
  s_add_u32 s90, s90, 0x3d07000
  v_mov_b32 v244, s90
  s_lshl_b32 s90, s34, 2
  s_add_u32 s90, s90, s32
  s_lshl_b32 s91, s33, 7
  s_add_u32 s91, s91, 0x3d00000
  v_mbcnt_lo_u32_b32 v30, -1, 0
  v_mbcnt_hi_u32_b32 v30, -1, v30
  v_add_u32 v30, s90, v30
  v_cmp_eq_u32 vcc, 0, v30
  v_mov_b32 v30, 0x80000000
  v_mov_b32 v31, s91
  v_cndmask_b32 v245, v30, v31, vcc
  s_mov_b64 s[8:9], s[94:95]
  s_mov_b64 s[10:11], s[94:95]
  s_branch SL_pubmem
SL_step:
  s_load_dword s16, s[8:9], 256
  s_load_dword s17, s[10:11], 256
  s_load_dword s18, s[8:9], 320
  s_load_dword s19, s[10:11], 320
  s_load_dword s20, s[8:9], 384
  s_load_dword s21, s[10:11], 384
  s_load_dword s22, s[8:9], 448
  s_load_dword s23, s[10:11], 448
  buffer_load_dwordx4 v[200:203], v13, s[4:7], s44 offen offset:128
  buffer_load_dwordx4 v[204:207], v13, s[4:7], s44 offen offset:1024
  buffer_load_dwordx4 v[208:211], v13, s[4:7], s44 offen offset:1152
  buffer_load_dwordx4 v[128:131], v11, s[4:7], s44 offen offset:3072
  buffer_load_dwordx4 v[144:147], v11, s[4:7], s44 offen offset:3136
  v_mov_b64 v[64:65], 0
  v_mov_b64 v[66:67], 0
  v_mov_b64 v[68:69], 0
  v_mov_b64 v[70:71], 0
  v_mov_b64 v[72:73], 0
  v_mov_b64 v[74:75], 0
  v_mov_b64 v[76:77], 0
  v_mov_b64 v[78:79], 0
  v_mov_b64 v[80:81], 0
  v_mov_b64 v[82:83], 0
  v_mov_b64 v[84:85], 0
  v_mov_b64 v[86:87], 0
  v_mov_b64 v[32:33], 0
  v_mov_b64 v[34:35], 0
  buffer_load_dwordx4 v[36:39], v1, s[4:7], s42 offen sc1
  buffer_store_dword v22, v18, s[4:7], s13 offen sc1
  buffer_store_dword v22, v2, s[4:7], s13 offen sc1
  buffer_store_dword v22, v7, s[4:7], s13 offen sc1
  buffer_store_dword v22, v8, s[4:7], s13 offen sc1
  s_add_u32 s44, s44, 0x40000
  s_min_u32 s44, s44, 0xfc0000
  s_add_u32 s45, s45, 0x10000
  s_waitcnt vmcnt(12)
SL_kv_chk:
  v_readfirstlane_b32 s90, v243
  s_cmp_lt_u32 s90, 16
  s_cbranch_scc1 SL_kv_f
  s_waitcnt vmcnt(4)
SL_g_chk:
  v_max3_u32 v31, v36, v37, v38
  v_max_u32 v31, v31, v39
  v_cmp_eq_u32 vcc, -1, v31
  v_mfma_f32_16x16x32_bf16 v[40:43], v[24:27], v[36:39], 0
  s_cbranch_vccnz SL_g_f
  s_nop 6
  v_add_f32_dpp v45, v40, v40 row_ror:8 row_mask:0xf bank_mask:0xf
  v_add_f32_dpp v46, v41, v41 row_ror:8 row_mask:0xf bank_mask:0xf
  v_cvt_pk_bf16_f32 v44, v45, v46
  v_min_u32 v44, s54, v44
SL_pubmem:
  buffer_store_dword v44, v2, s[4:7], s41 offen sc1
  v_mov_b32 v148, v180
  v_mov_b32 v150, v181
  v_mov_b32 v152, v182
  v_mov_b32 v154, v183
  v_mov_b32 v149, v184
  v_mov_b32 v151, v185
  v_mov_b32 v153, v186
  v_mov_b32 v155, v187
  v_mov_b32 v156, v188
  v_mov_b32 v158, v189
  v_mov_b32 v160, v190
  v_mov_b32 v162, v191
  v_mov_b32 v157, v192
  v_mov_b32 v159, v193
  v_mov_b32 v161, v194
  v_mov_b32 v163, v195
  v_mov_b32 v164, v196
  v_mov_b32 v166, v197
  v_mov_b32 v168, v198
  v_mov_b32 v170, v199
  v_mov_b32 v165, v200
  v_mov_b32 v167, v201
  v_mov_b32 v169, v202
  v_mov_b32 v171, v203
  buffer_load_dwordx4 v[48:51], v3, s[4:7], s41 offen offset:0 sc1
  v_mov_b32 v172, v204
  v_mov_b32 v174, v205
  buffer_load_dwordx4 v[52:55], v3, s[4:7], s41 offen offset:1024 sc1
  v_mov_b32 v176, v206
  v_mov_b32 v178, v207
  buffer_load_dwordx4 v[56:59], v3, s[4:7], s41 offen offset:2048 sc1
  v_mov_b32 v173, v208
  v_mov_b32 v175, v209
  buffer_load_dwordx4 v[60:63], v3, s[4:7], s41 offen offset:3072 sc1
  v_mov_b32 v177, v210
  v_mov_b32 v179, v211
  s_waitcnt vmcnt(3)
  v_max3_u32 v31, v48, v49, v50
  v_max_u32 v31, v31, v51
  v_cmp_eq_u32 vcc, -1, v31
  s_cbranch_vccnz SL_m_f0
  v_smfmac_f32_16x16x64_bf16 v[64:67], v[48:51], a[0:7], v23
  s_waitcnt vmcnt(2)
  v_max3_u32 v31, v52, v53, v54
  v_max_u32 v31, v31, v55
  v_cmp_eq_u32 vcc, -1, v31
  v_smfmac_f32_16x16x64_bf16 v[68:71], v[48:51], a[8:15], v23
  v_smfmac_f32_16x16x64_bf16 v[72:75], v[48:51], a[16:23], v23
  v_smfmac_f32_16x16x64_bf16 v[76:79], v[48:51], a[24:31], v23
  s_cbranch_vccnz SL_m_f1
  v_smfmac_f32_16x16x64_bf16 v[64:67], v[52:55], a[48:55], v23
  s_waitcnt vmcnt(1)
  v_max3_u32 v31, v56, v57, v58
  v_max_u32 v31, v31, v59
  v_cmp_eq_u32 vcc, -1, v31
  v_smfmac_f32_16x16x64_bf16 v[68:71], v[52:55], a[56:63], v23
  v_smfmac_f32_16x16x64_bf16 v[72:75], v[52:55], a[64:71], v23
  v_smfmac_f32_16x16x64_bf16 v[76:79], v[52:55], a[72:79], v23
  s_cbranch_vccnz SL_m_f2
  v_smfmac_f32_16x16x64_bf16 v[64:67], v[56:59], a[96:103], v23
  s_waitcnt vmcnt(0)
  v_max3_u32 v31, v60, v61, v62
  v_max_u32 v31, v31, v63
  v_cmp_eq_u32 vcc, -1, v31
  v_smfmac_f32_16x16x64_bf16 v[68:71], v[56:59], a[104:111], v23
  v_smfmac_f32_16x16x64_bf16 v[72:75], v[56:59], a[112:119], v23
  v_smfmac_f32_16x16x64_bf16 v[76:79], v[56:59], a[120:127], v23
  s_cbranch_vccnz SL_m_f3
  v_smfmac_f32_16x16x64_bf16 v[64:67], v[60:63], a[144:151], v23
  v_smfmac_f32_16x16x64_bf16 v[68:71], v[60:63], a[152:159], v23
  v_smfmac_f32_16x16x64_bf16 v[72:75], v[60:63], a[160:167], v23
  v_smfmac_f32_16x16x64_bf16 v[76:79], v[60:63], a[168:175], v23
SL_m_done:
  s_nop 4
  v_pk_add_f32 v[88:89], v[64:65], v[66:67]
  v_pk_add_f32 v[90:91], v[68:69], v[70:71]
  ds_write_b128 v4, v[88:91] offset:0
  v_pk_add_f32 v[92:93], v[72:73], v[74:75]
  v_pk_add_f32 v[94:95], v[76:77], v[78:79]
  ds_write_b128 v4, v[92:95] offset:1088
  v_smfmac_f32_16x16x64_bf16 v[80:83], v[48:51], a[32:39], v23
  buffer_load_dwordx4 v[180:183], v12, s[4:7], s44 offen offset:0
  v_mov_b32 v36, 0
  v_smfmac_f32_16x16x64_bf16 v[84:87], v[48:51], a[40:47], v23
  buffer_load_dwordx4 v[184:187], v12, s[4:7], s44 offen offset:128
  v_mov_b32 v37, 0
  v_smfmac_f32_16x16x64_bf16 v[80:83], v[52:55], a[80:87], v23
  buffer_load_dwordx4 v[188:191], v12, s[4:7], s44 offen offset:1024
  v_mov_b32 v38, 0
  v_smfmac_f32_16x16x64_bf16 v[84:87], v[52:55], a[88:95], v23
  buffer_load_dwordx4 v[192:195], v12, s[4:7], s44 offen offset:1152
  v_mov_b32 v39, 0
  v_smfmac_f32_16x16x64_bf16 v[80:83], v[56:59], a[128:135], v23
  buffer_load_dwordx4 v[196:199], v13, s[4:7], s44 offen offset:0
  v_mov_b32 v40, 0
  s_waitcnt lgkmcnt(0)
  s_barrier
  ds_read2_b32 v[100:101], v6 offset0:0 offset1:2
  ds_read2_b32 v[102:103], v240 offset0:0 offset1:2
  ds_read2_b32 v[104:105], v241 offset0:0 offset1:2
  ds_read2_b32 v[106:107], v242 offset0:0 offset1:2
  v_smfmac_f32_16x16x64_bf16 v[84:87], v[56:59], a[136:143], v23
  v_mov_b32 v41, 0
  v_smfmac_f32_16x16x64_bf16 v[80:83], v[60:63], a[176:183], v23
  v_mov_b32 v42, 0
  v_smfmac_f32_16x16x64_bf16 v[84:87], v[60:63], a[184:191], v23
  v_mov_b32 v43, 0
  v_mov_b32 v44, 0
  v_mov_b32 v45, 0
  v_mov_b32 v46, 0
  v_mov_b32 v47, 0
  s_waitcnt lgkmcnt(2)
  v_pk_add_f32 v[100:101], v[100:101], v[102:103]
  s_waitcnt lgkmcnt(0)
  v_pk_add_f32 v[104:105], v[104:105], v[106:107]
  v_pk_add_f32 v[100:101], v[100:101], v[104:105]
  v_cvt_pk_bf16_f32 v112, v100, v101
  v_min_u32 v112, s54, v112
  buffer_store_dword v112, v7, s[4:7], s41 offen sc1
  v_pk_add_f32 v[96:97], v[80:81], v[82:83]
  v_pk_add_f32 v[98:99], v[84:85], v[86:87]
  ds_write_b128 v4, v[96:99] offset:2176
  v_mov_b64 v[212:213], 0
  v_mov_b64 v[214:215], 0
  v_mov_b64 v[216:217], 0
  v_mov_b64 v[218:219], 0
  v_mov_b64 v[220:221], 0
  v_mov_b64 v[222:223], 0
  v_mov_b64 v[224:225], 0
  v_mov_b64 v[226:227], 0
  v_mov_b64 v[228:229], 0
  v_mov_b64 v[230:231], 0
  s_waitcnt lgkmcnt(0)
  s_barrier
  ds_read_b64 v[88:89], v5 offset:0
  buffer_load_dwordx4 v[64:67], v9, s[4:7], s41 offen offset:0 sc1
  s_mov_b32 s42, s41
  s_add_u32 s90, s40, 1
  ds_read_b64 v[90:91], v5 offset:3264
  buffer_load_dwordx4 v[68:71], v9, s[4:7], s41 offen offset:1024 sc1
  s_and_b32 s90, s90, 3
  s_lshl_b32 s90, s90, 19
  ds_read_b64 v[92:93], v5 offset:6528
  buffer_load_dwordx4 v[72:75], v9, s[4:7], s41 offen offset:2048 sc1
  s_add_u32 s91, s90, 0x3800000
  s_add_u32 s55, s55, 0x40000
  ds_read_b64 v[94:95], v5 offset:9792
  buffer_load_dwordx4 v[76:79], v9, s[4:7], s41 offen offset:3072 sc1
  s_min_u32 s55, s55, 0xfc0000
  s_nop 0
  s_waitcnt lgkmcnt(2)
  v_pk_add_f32 v[88:89], v[88:89], v[90:91]
  s_waitcnt lgkmcnt(0)
  v_pk_add_f32 v[92:93], v[92:93], v[94:95]
  v_pk_add_f32 v[88:89], v[88:89], v[92:93]
  v_cvt_pk_bf16_f32 v113, v88, v89
  v_min_u32 v113, s54, v113
  buffer_store_dword v113, v8, s[4:7], s41 offen sc1
  s_add_u32 s8, s94, s55
  s_addc_u32 s9, s95, 0
  s_add_u32 s8, s8, s12
  s_addc_u32 s9, s9, 0
  s_add_u32 s10, s8, 0x1000000
  s_addc_u32 s11, s9, 0
  s_load_dword s16, s[8:9], 0
  s_load_dword s17, s[10:11], 0
  s_load_dword s18, s[8:9], 64
  s_load_dword s19, s[10:11], 64
  s_load_dword s20, s[8:9], 128
  s_load_dword s21, s[10:11], 128
  s_load_dword s22, s[8:9], 192
  s_load_dword s23, s[10:11], 192
  s_cmp_eq_u32 s40, 63
  s_cbranch_scc1 SL_last
  s_waitcnt vmcnt(4)
  v_max3_u32 v31, v64, v65, v66
  v_max_u32 v31, v31, v67
  v_cmp_eq_u32 vcc, -1, v31
  s_cbranch_vccnz SL_x_f0
  v_mfma_f32_16x16x32_bf16 v[44:47], v[64:67], v[64:67], v[44:47]
  s_waitcnt vmcnt(3)
  v_max3_u32 v31, v68, v69, v70
  v_max_u32 v31, v31, v71
  v_cmp_eq_u32 vcc, -1, v31
  v_mfma_f32_16x16x32_bf16 v[36:39], v[116:119], v[64:67], v[36:39]
  v_mfma_f32_16x16x32_bf16 v[40:43], v[132:135], v[64:67], v[40:43]
  s_cbranch_vccnz SL_x_f1
  v_mfma_f32_16x16x32_bf16 v[44:47], v[68:71], v[68:71], v[44:47]
  s_waitcnt vmcnt(2)
  v_max3_u32 v31, v72, v73, v74
  v_max_u32 v31, v31, v75
  v_cmp_eq_u32 vcc, -1, v31
  v_mfma_f32_16x16x32_bf16 v[36:39], v[120:123], v[68:71], v[36:39]
  v_mfma_f32_16x16x32_bf16 v[40:43], v[136:139], v[68:71], v[40:43]
  s_cbranch_vccnz SL_x_f2
  v_mfma_f32_16x16x32_bf16 v[44:47], v[72:75], v[72:75], v[44:47]
  s_waitcnt vmcnt(1)
  v_max3_u32 v31, v76, v77, v78
  v_max_u32 v31, v31, v79
  v_cmp_eq_u32 vcc, -1, v31
  v_mfma_f32_16x16x32_bf16 v[36:39], v[124:127], v[72:75], v[36:39]
  v_mfma_f32_16x16x32_bf16 v[40:43], v[140:143], v[72:75], v[40:43]
  s_cbranch_vccnz SL_x_f3
  v_mfma_f32_16x16x32_bf16 v[44:47], v[76:79], v[76:79], v[44:47]
  v_mfma_f32_16x16x32_bf16 v[36:39], v[128:131], v[76:79], v[36:39]
  v_mfma_f32_16x16x32_bf16 v[40:43], v[144:147], v[76:79], v[40:43]
SL_x_done:
  buffer_load_dwordx4 v[88:91], v10, s[4:7], s41 offen offset:0 sc1
  buffer_load_dwordx4 v[92:95], v10, s[4:7], s41 offen offset:1024 sc1
  s_mov_b64 vcc, s[48:49]
  s_nop 2
  v_max_f32 v30, v46, v47
  s_nop 0
  v_cndmask_b32_dpp v96, v40, v36, vcc quad_perm:[0,1,0,1] row_mask:0xf bank_mask:0xf
  v_cndmask_b32_dpp v97, v41, v37, vcc quad_perm:[0,1,0,1] row_mask:0xf bank_mask:0xf
  v_cndmask_b32_dpp v98, v42, v38, vcc quad_perm:[0,1,0,1] row_mask:0xf bank_mask:0xf
  v_cndmask_b32_dpp v99, v43, v39, vcc quad_perm:[0,1,0,1] row_mask:0xf bank_mask:0xf
  v_max3_f32 v29, v96, v97, v98
  s_nop 0
  v_max_f32_dpp v28, v30, v99 quad_perm:[0,1,0,1] row_mask:0xf bank_mask:0xf
  v_max_f32 v29, v29, v28
  s_nop 1
  v_max_f32_dpp v28, v29, v29 quad_perm:[2,3,0,1] row_mask:0xf bank_mask:0xf
  v_mov_b32 v29, v28
  s_nop 1
  v_permlane32_swap_b32 v28, v29
  v_max_f32 v28, v28, v29
  v_mov_b32 v29, v28
  s_nop 1
  v_permlane16_swap_b32 v28, v29
  v_max_f32 v28, v28, v29
  v_mul_f32 v28, s47, v28
  v_fma_f32 v96, v96, s47, -v28
  v_fma_f32 v97, v97, s47, -v28
  v_fma_f32 v98, v98, s47, -v28
  v_fma_f32 v99, v99, s47, -v28
  v_fma_f32 v46, v46, s47, -v28
  v_fma_f32 v47, v47, s47, -v28
  v_exp_f32 v96, v96
  v_exp_f32 v97, v97
  v_exp_f32 v98, v98
  v_exp_f32 v99, v99
  v_cvt_pk_bf16_f32 v236, v96, v97
  v_cvt_pk_bf16_f32 v237, v98, v99
  v_exp_f32 v46, v46
  v_mov_b32_dpp v100, v236 quad_perm:[0,1,0,1] row_mask:0xf bank_mask:0xf
  v_mov_b32_dpp v102, v236 quad_perm:[2,3,2,3] row_mask:0xf bank_mask:0xf
  v_mov_b32_dpp v101, v237 quad_perm:[0,1,0,1] row_mask:0xf bank_mask:0xf
  v_mov_b32_dpp v103, v237 quad_perm:[2,3,2,3] row_mask:0xf bank_mask:0xf
  v_exp_f32 v47, v47
  s_nop 0
  v_smfmac_f32_16x16x64_bf16 v[228:231], v[100:103], v[248:255], v23
  v_cvt_pk_bf16_f32 v238, v46, v47
  buffer_load_dwordx4 v[116:119], v11, s[4:7], s44 offen offset:0
  v_smfmac_f32_16x16x64_bf16 v[212:215], v[100:103], v[148:155], v23
  buffer_load_dwordx4 v[132:135], v11, s[4:7], s44 offen offset:64
  v_mov_b32_dpp v232, v238 quad_perm:[0,1,0,1] row_mask:0xf bank_mask:0xf
  v_smfmac_f32_16x16x64_bf16 v[216:219], v[100:103], v[156:163], v23
  buffer_load_dwordx4 v[120:123], v11, s[4:7], s44 offen offset:1024
  v_mov_b32_dpp v235, v238 quad_perm:[0,1,0,1] row_mask:0xf bank_mask:0xf
  v_smfmac_f32_16x16x64_bf16 v[220:223], v[100:103], v[164:171], v23
  buffer_load_dwordx4 v[136:139], v11, s[4:7], s44 offen offset:1088
  s_waitcnt vmcnt(4)
  v_max3_u32 v31, v88, v89, v90
  v_max3_u32 v31, v31, v91, v92
  v_smfmac_f32_16x16x32_bf16 v[228:231], v[232:233], v[248:251], v23
  v_max3_u32 v31, v31, v93, v94
  v_max_u32 v31, v31, v95
  v_cmp_eq_u32 vcc, -1, v31
  v_smfmac_f32_16x16x64_bf16 v[224:227], v[100:103], v[172:179], v23
  s_cbranch_vccnz SL_v_f
SL_v_ok:
  v_smfmac_f32_16x16x32_bf16 v[212:215], v[232:233], v[88:91], v23
  buffer_load_dwordx4 v[124:127], v11, s[4:7], s44 offen offset:2048
  buffer_load_dwordx4 v[140:143], v11, s[4:7], s44 offen offset:2112
  v_smfmac_f32_16x16x32_bf16 v[216:219], v[234:235], v[88:91], v23
  v_rcp_f32 v28, v228
  v_smfmac_f32_16x16x32_bf16 v[220:223], v[232:233], v[92:95], v23
  v_rcp_f32 v29, v229
  v_smfmac_f32_16x16x32_bf16 v[224:227], v[234:235], v[92:95], v23
  s_nop 0
  v_pk_mul_f32 v[212:213], v[212:213], v[28:29]
  v_pk_mul_f32 v[214:215], v[214:215], v[28:29]
  v_cvt_pk_bf16_f32 v104, v212, v214
  v_cvt_pk_bf16_f32 v108, v213, v215
  v_pk_mul_f32 v[216:217], v[216:217], v[28:29]
  v_pk_mul_f32 v[218:219], v[218:219], v[28:29]
  v_cvt_pk_bf16_f32 v105, v216, v218
  v_cvt_pk_bf16_f32 v109, v217, v219
  v_pk_mul_f32 v[220:221], v[220:221], v[28:29]
  v_pk_mul_f32 v[222:223], v[222:223], v[28:29]
  v_cvt_pk_bf16_f32 v106, v220, v222
  v_cvt_pk_bf16_f32 v110, v221, v223
  v_pk_mul_f32 v[224:225], v[224:225], v[28:29]
  v_pk_mul_f32 v[226:227], v[226:227], v[28:29]
  v_cvt_pk_bf16_f32 v107, v224, v226
  v_cvt_pk_bf16_f32 v111, v225, v227
  ds_write_b128 v14, v[104:107]
  ds_write_b128 v15, v[108:111]
  s_add_u32 s92, s40, 3
  s_min_u32 s92, s92, 63
  s_lshr_b32 s92, s92, 2
  s_lshl_b32 s92, s92, 9
  v_mov_b32 v246, s40
  s_waitcnt lgkmcnt(0)
  s_barrier
  ds_read_b128 v[48:51], v16 offset:0
  ds_read_b128 v[52:55], v16 offset:1024
  ds_read_b128 v[56:59], v16 offset:2048
  ds_read_b128 v[60:63], v16 offset:3072
  ds_read_b128 v[64:67], v16 offset:4096
  buffer_store_dword v22, v17, s[4:7], s43 offen sc1
  buffer_store_dword v112, v19, s[4:7], s45 offen sc1
  s_waitcnt lgkmcnt(4)
  v_smfmac_f32_16x16x64_bf16 v[32:35], v[48:51], a[192:199], v23
  ds_read_b128 v[68:71], v16 offset:5120
  buffer_store_dword v113, v20, s[4:7], s45 offen sc1
  s_waitcnt lgkmcnt(4)
  v_smfmac_f32_16x16x64_bf16 v[32:35], v[52:55], a[200:207], v23
  ds_read_b128 v[72:75], v16 offset:6144
  buffer_store_dword v246, v245, s[4:7], 0 offen sc1
  s_waitcnt lgkmcnt(4)
  v_smfmac_f32_16x16x64_bf16 v[32:35], v[56:59], a[208:215], v23
  ds_read_b128 v[76:79], v16 offset:7168
  buffer_load_dword v243, v244, s[4:7], s92 offen sc1
  s_waitcnt lgkmcnt(4)
  v_smfmac_f32_16x16x64_bf16 v[32:35], v[60:63], a[216:223], v23
  s_mov_b32 s13, s43
  s_waitcnt lgkmcnt(3)
  v_smfmac_f32_16x16x64_bf16 v[32:35], v[64:67], a[224:231], v23
  s_add_u32 s40, s40, 1
  s_waitcnt lgkmcnt(2)
  v_smfmac_f32_16x16x64_bf16 v[32:35], v[68:71], a[232:239], v23
  s_mov_b32 s41, s91
  s_waitcnt lgkmcnt(1)
  v_smfmac_f32_16x16x64_bf16 v[32:35], v[72:75], a[240:247], v23
  s_xor_b32 s43, s91, 0x100000
  s_waitcnt lgkmcnt(0)
  v_smfmac_f32_16x16x64_bf16 v[32:35], v[76:79], a[248:255], v23
  s_nop 7
  v_pk_add_f32 v[28:29], v[32:33], v[34:35]
  v_cvt_pk_bf16_f32 v28, v28, v29
  v_min_u32 v28, s54, v28
  buffer_store_dword v28, v17, s[4:7], s42 offen sc1
  buffer_store_dword v28, v18, s[4:7], s42 offen sc1
  s_branch SL_step
SL_last:
  buffer_store_dword v112, v19, s[4:7], s45 offen sc1
  buffer_store_dword v113, v20, s[4:7], s45 offen sc1
  s_waitcnt vmcnt(0)
  s_barrier
  s_lshl_b32 s90, s35, 7
  s_add_u32 s90, s90, 0x3d01000
  s_cmp_lg_u32 s32, 0
  s_cbranch_scc1 SL_sig_6
  v_mov_b32 v254, 1
  v_mov_b32 v255, 0
  s_mov_b64 exec, 1
  buffer_atomic_add v254, v255, s[4:7], s90 offen offset:0 sc1
  s_mov_b64 exec, -1
SL_sig_6:
  s_waitcnt vmcnt(0)
  s_branch L_join
SL_kv_f:
  s_sleep 8
  buffer_load_dword v243, v244, s[4:7], s92 offen sc1
  s_add_u32 s46, s46, 1
  s_cmp_ge_u32 s46, 131072
  s_cbranch_scc1 SL_rec_abort
  s_waitcnt vmcnt(0)
  s_branch SL_kv_chk
SL_g_f:
  s_mov_b64 exec, vcc
  buffer_load_dwordx4 v[36:39], v1, s[4:7], s42 offen sc1
  s_mov_b64 exec, -1
  s_add_u32 s46, s46, 1
  s_cmp_ge_u32 s46, 131072
  s_cbranch_scc1 SL_rec_abort
  s_waitcnt vmcnt(0)
  s_branch SL_g_chk
SL_m_f0:
  s_mov_b64 exec, vcc
  buffer_load_dwordx4 v[48:51], v3, s[4:7], s41 offen offset:0 sc1
  s_mov_b64 exec, -1
  s_waitcnt vmcnt(1)
  s_branch SL_m_0123_c1
SL_m_f1:
  s_mov_b64 exec, vcc
  buffer_load_dwordx4 v[52:55], v3, s[4:7], s41 offen offset:1024 sc1
  s_mov_b64 exec, -1
  s_waitcnt vmcnt(1)
  s_branch SL_m_123_c2
SL_m_f2:
  s_mov_b64 exec, vcc
  buffer_load_dwordx4 v[56:59], v3, s[4:7], s41 offen offset:2048 sc1
  s_mov_b64 exec, -1
  s_waitcnt vmcnt(1)
  s_branch SL_m_23_c3
SL_m_f3:
  s_mov_b64 exec, vcc
  buffer_load_dwordx4 v[60:63], v3, s[4:7], s41 offen offset:3072 sc1
  s_mov_b64 exec, -1
  s_nop 7
  s_branch SL_m_3_c3
SL_m_0_c0:
  v_max3_u32 v31, v48, v49, v50
  v_max_u32 v31, v31, v51
  v_cmp_eq_u32 vcc, -1, v31
  s_cbranch_vccz SL_m_0_ok0
SL_m_0_x0:
  s_mov_b64 exec, vcc
  buffer_load_dwordx4 v[48:51], v3, s[4:7], s41 offen offset:0 sc1
  s_mov_b64 exec, -1
  s_add_u32 s46, s46, 1
  s_cmp_ge_u32 s46, 131072
  s_cbranch_scc1 SL_rec_abort
  s_waitcnt vmcnt(2)
  s_branch SL_m_0_c0
SL_m_0_ok0:
  v_smfmac_f32_16x16x64_bf16 v[64:67], v[48:51], a[0:7], v23
  v_smfmac_f32_16x16x64_bf16 v[68:71], v[48:51], a[8:15], v23
  v_smfmac_f32_16x16x64_bf16 v[72:75], v[48:51], a[16:23], v23
  v_smfmac_f32_16x16x64_bf16 v[76:79], v[48:51], a[24:31], v23
  s_branch SL_m_done
SL_m_1_c1:
  v_max3_u32 v31, v52, v53, v54
  v_max_u32 v31, v31, v55
  v_cmp_eq_u32 vcc, -1, v31
  s_cbranch_vccz SL_m_1_ok1
SL_m_1_x1:
  s_mov_b64 exec, vcc
  buffer_load_dwordx4 v[52:55], v3, s[4:7], s41 offen offset:1024 sc1
  s_mov_b64 exec, -1
  s_add_u32 s46, s46, 1
  s_cmp_ge_u32 s46, 131072
  s_cbranch_scc1 SL_rec_abort
  s_waitcnt vmcnt(2)
  s_branch SL_m_1_c1
SL_m_1_ok1:
  v_smfmac_f32_16x16x64_bf16 v[64:67], v[52:55], a[48:55], v23
  v_smfmac_f32_16x16x64_bf16 v[68:71], v[52:55], a[56:63], v23
  v_smfmac_f32_16x16x64_bf16 v[72:75], v[52:55], a[64:71], v23
  v_smfmac_f32_16x16x64_bf16 v[76:79], v[52:55], a[72:79], v23
  s_branch SL_m_done
SL_m_2_c2:
  v_max3_u32 v31, v56, v57, v58
  v_max_u32 v31, v31, v59
  v_cmp_eq_u32 vcc, -1, v31
  s_cbranch_vccz SL_m_2_ok2
SL_m_2_x2:
  s_mov_b64 exec, vcc
  buffer_load_dwordx4 v[56:59], v3, s[4:7], s41 offen offset:2048 sc1
  s_mov_b64 exec, -1
  s_add_u32 s46, s46, 1
  s_cmp_ge_u32 s46, 131072
  s_cbranch_scc1 SL_rec_abort
  s_waitcnt vmcnt(2)
  s_branch SL_m_2_c2
SL_m_2_ok2:
  v_smfmac_f32_16x16x64_bf16 v[64:67], v[56:59], a[96:103], v23
  v_smfmac_f32_16x16x64_bf16 v[68:71], v[56:59], a[104:111], v23
  v_smfmac_f32_16x16x64_bf16 v[72:75], v[56:59], a[112:119], v23
  v_smfmac_f32_16x16x64_bf16 v[76:79], v[56:59], a[120:127], v23
  s_branch SL_m_done
SL_m_3_c3:
  v_max3_u32 v31, v60, v61, v62
  v_max_u32 v31, v31, v63
  v_cmp_eq_u32 vcc, -1, v31
  s_cbranch_vccz SL_m_3_ok3
SL_m_3_x3:
  s_mov_b64 exec, vcc
  buffer_load_dwordx4 v[60:63], v3, s[4:7], s41 offen offset:3072 sc1
  s_mov_b64 exec, -1
  s_add_u32 s46, s46, 1
  s_cmp_ge_u32 s46, 131072
  s_cbranch_scc1 SL_rec_abort
  s_waitcnt vmcnt(2)
  s_branch SL_m_3_c3
SL_m_3_ok3:
  v_smfmac_f32_16x16x64_bf16 v[64:67], v[60:63], a[144:151], v23
  v_smfmac_f32_16x16x64_bf16 v[68:71], v[60:63], a[152:159], v23
  v_smfmac_f32_16x16x64_bf16 v[72:75], v[60:63], a[160:167], v23
  v_smfmac_f32_16x16x64_bf16 v[76:79], v[60:63], a[168:175], v23
  s_branch SL_m_done
SL_m_01_c0:
  v_max3_u32 v31, v48, v49, v50
  v_max_u32 v31, v31, v51
  v_cmp_eq_u32 vcc, -1, v31
  s_cbranch_vccz SL_m_01_ok0
SL_m_01_x0:
  s_mov_b64 exec, vcc
  buffer_load_dwordx4 v[48:51], v3, s[4:7], s41 offen offset:0 sc1
  s_mov_b64 exec, -1
SL_m_01_c1:
  v_max3_u32 v31, v52, v53, v54
  v_max_u32 v31, v31, v55
  v_cmp_eq_u32 vcc, -1, v31
  s_cbranch_vccz SL_m_01_ok1
SL_m_01_x1:
  s_mov_b64 exec, vcc
  buffer_load_dwordx4 v[52:55], v3, s[4:7], s41 offen offset:1024 sc1
  s_mov_b64 exec, -1
  s_add_u32 s46, s46, 1
  s_cmp_ge_u32 s46, 131072
  s_cbranch_scc1 SL_rec_abort
  s_waitcnt vmcnt(4)
  s_branch SL_m_01_c0
SL_m_01_ok0:
  v_smfmac_f32_16x16x64_bf16 v[64:67], v[48:51], a[0:7], v23
  v_max3_u32 v31, v52, v53, v54
  v_max_u32 v31, v31, v55
  v_cmp_eq_u32 vcc, -1, v31
  v_smfmac_f32_16x16x64_bf16 v[68:71], v[48:51], a[8:15], v23
  v_smfmac_f32_16x16x64_bf16 v[72:75], v[48:51], a[16:23], v23
  v_smfmac_f32_16x16x64_bf16 v[76:79], v[48:51], a[24:31], v23
  s_cbranch_vccz SL_m_1_ok1
  s_branch SL_m_1_x1
SL_m_01_ok1:
  v_smfmac_f32_16x16x64_bf16 v[64:67], v[52:55], a[48:55], v23
  v_max3_u32 v31, v48, v49, v50
  v_max_u32 v31, v31, v51
  v_cmp_eq_u32 vcc, -1, v31
  v_smfmac_f32_16x16x64_bf16 v[68:71], v[52:55], a[56:63], v23
  v_smfmac_f32_16x16x64_bf16 v[72:75], v[52:55], a[64:71], v23
  v_smfmac_f32_16x16x64_bf16 v[76:79], v[52:55], a[72:79], v23
  s_cbranch_vccz SL_m_0_ok0
  s_branch SL_m_0_x0
SL_m_02_c0:
  v_max3_u32 v31, v48, v49, v50
  v_max_u32 v31, v31, v51
  v_cmp_eq_u32 vcc, -1, v31
  s_cbranch_vccz SL_m_02_ok0
SL_m_02_x0:
  s_mov_b64 exec, vcc
  buffer_load_dwordx4 v[48:51], v3, s[4:7], s41 offen offset:0 sc1
  s_mov_b64 exec, -1
SL_m_02_c2:
  v_max3_u32 v31, v56, v57, v58
  v_max_u32 v31, v31, v59
  v_cmp_eq_u32 vcc, -1, v31
  s_cbranch_vccz SL_m_02_ok2
SL_m_02_x2:
  s_mov_b64 exec, vcc
  buffer_load_dwordx4 v[56:59], v3, s[4:7], s41 offen offset:2048 sc1
  s_mov_b64 exec, -1
  s_add_u32 s46, s46, 1
  s_cmp_ge_u32 s46, 131072
  s_cbranch_scc1 SL_rec_abort
  s_waitcnt vmcnt(4)
  s_branch SL_m_02_c0
SL_m_02_ok0:
  v_smfmac_f32_16x16x64_bf16 v[64:67], v[48:51], a[0:7], v23
  v_max3_u32 v31, v56, v57, v58
  v_max_u32 v31, v31, v59
  v_cmp_eq_u32 vcc, -1, v31
  v_smfmac_f32_16x16x64_bf16 v[68:71], v[48:51], a[8:15], v23
  v_smfmac_f32_16x16x64_bf16 v[72:75], v[48:51], a[16:23], v23
  v_smfmac_f32_16x16x64_bf16 v[76:79], v[48:51], a[24:31], v23
  s_cbranch_vccz SL_m_2_ok2
  s_branch SL_m_2_x2
SL_m_02_ok2:
  v_smfmac_f32_16x16x64_bf16 v[64:67], v[56:59], a[96:103], v23
  v_max3_u32 v31, v48, v49, v50
  v_max_u32 v31, v31, v51
  v_cmp_eq_u32 vcc, -1, v31
  v_smfmac_f32_16x16x64_bf16 v[68:71], v[56:59], a[104:111], v23
  v_smfmac_f32_16x16x64_bf16 v[72:75], v[56:59], a[112:119], v23
  v_smfmac_f32_16x16x64_bf16 v[76:79], v[56:59], a[120:127], v23
  s_cbranch_vccz SL_m_0_ok0
  s_branch SL_m_0_x0
SL_m_03_c0:
  v_max3_u32 v31, v48, v49, v50
  v_max_u32 v31, v31, v51
  v_cmp_eq_u32 vcc, -1, v31
  s_cbranch_vccz SL_m_03_ok0
SL_m_03_x0:
  s_mov_b64 exec, vcc
  buffer_load_dwordx4 v[48:51], v3, s[4:7], s41 offen offset:0 sc1
  s_mov_b64 exec, -1
SL_m_03_c3:
  v_max3_u32 v31, v60, v61, v62
  v_max_u32 v31, v31, v63
  v_cmp_eq_u32 vcc, -1, v31
  s_cbranch_vccz SL_m_03_ok3
SL_m_03_x3:
  s_mov_b64 exec, vcc
  buffer_load_dwordx4 v[60:63], v3, s[4:7], s41 offen offset:3072 sc1
  s_mov_b64 exec, -1
  s_add_u32 s46, s46, 1
  s_cmp_ge_u32 s46, 131072
  s_cbranch_scc1 SL_rec_abort
  s_waitcnt vmcnt(4)
  s_branch SL_m_03_c0
SL_m_03_ok0:
  v_smfmac_f32_16x16x64_bf16 v[64:67], v[48:51], a[0:7], v23
  v_max3_u32 v31, v60, v61, v62
  v_max_u32 v31, v31, v63
  v_cmp_eq_u32 vcc, -1, v31
  v_smfmac_f32_16x16x64_bf16 v[68:71], v[48:51], a[8:15], v23
  v_smfmac_f32_16x16x64_bf16 v[72:75], v[48:51], a[16:23], v23
  v_smfmac_f32_16x16x64_bf16 v[76:79], v[48:51], a[24:31], v23
  s_cbranch_vccz SL_m_3_ok3
  s_branch SL_m_3_x3
SL_m_03_ok3:
  v_smfmac_f32_16x16x64_bf16 v[64:67], v[60:63], a[144:151], v23
  v_max3_u32 v31, v48, v49, v50
  v_max_u32 v31, v31, v51
  v_cmp_eq_u32 vcc, -1, v31
  v_smfmac_f32_16x16x64_bf16 v[68:71], v[60:63], a[152:159], v23
  v_smfmac_f32_16x16x64_bf16 v[72:75], v[60:63], a[160:167], v23
  v_smfmac_f32_16x16x64_bf16 v[76:79], v[60:63], a[168:175], v23
  s_cbranch_vccz SL_m_0_ok0
  s_branch SL_m_0_x0
SL_m_12_c1:
  v_max3_u32 v31, v52, v53, v54
  v_max_u32 v31, v31, v55
  v_cmp_eq_u32 vcc, -1, v31
  s_cbranch_vccz SL_m_12_ok1
SL_m_12_x1:
  s_mov_b64 exec, vcc
  buffer_load_dwordx4 v[52:55], v3, s[4:7], s41 offen offset:1024 sc1
  s_mov_b64 exec, -1
SL_m_12_c2:
  v_max3_u32 v31, v56, v57, v58
  v_max_u32 v31, v31, v59
  v_cmp_eq_u32 vcc, -1, v31
  s_cbranch_vccz SL_m_12_ok2
SL_m_12_x2:
  s_mov_b64 exec, vcc
  buffer_load_dwordx4 v[56:59], v3, s[4:7], s41 offen offset:2048 sc1
  s_mov_b64 exec, -1
  s_add_u32 s46, s46, 1
  s_cmp_ge_u32 s46, 131072
  s_cbranch_scc1 SL_rec_abort
  s_waitcnt vmcnt(4)
  s_branch SL_m_12_c1
SL_m_12_ok1:
  v_smfmac_f32_16x16x64_bf16 v[64:67], v[52:55], a[48:55], v23
  v_max3_u32 v31, v56, v57, v58
  v_max_u32 v31, v31, v59
  v_cmp_eq_u32 vcc, -1, v31
  v_smfmac_f32_16x16x64_bf16 v[68:71], v[52:55], a[56:63], v23
  v_smfmac_f32_16x16x64_bf16 v[72:75], v[52:55], a[64:71], v23
  v_smfmac_f32_16x16x64_bf16 v[76:79], v[52:55], a[72:79], v23
  s_cbranch_vccz SL_m_2_ok2
  s_branch SL_m_2_x2
SL_m_12_ok2:
  v_smfmac_f32_16x16x64_bf16 v[64:67], v[56:59], a[96:103], v23
  v_max3_u32 v31, v52, v53, v54
  v_max_u32 v31, v31, v55
  v_cmp_eq_u32 vcc, -1, v31
  v_smfmac_f32_16x16x64_bf16 v[68:71], v[56:59], a[104:111], v23
  v_smfmac_f32_16x16x64_bf16 v[72:75], v[56:59], a[112:119], v23
  v_smfmac_f32_16x16x64_bf16 v[76:79], v[56:59], a[120:127], v23
  s_cbranch_vccz SL_m_1_ok1
  s_branch SL_m_1_x1
SL_m_13_c1:
  v_max3_u32 v31, v52, v53, v54
  v_max_u32 v31, v31, v55
  v_cmp_eq_u32 vcc, -1, v31
  s_cbranch_vccz SL_m_13_ok1
SL_m_13_x1:
  s_mov_b64 exec, vcc
  buffer_load_dwordx4 v[52:55], v3, s[4:7], s41 offen offset:1024 sc1
  s_mov_b64 exec, -1
SL_m_13_c3:
  v_max3_u32 v31, v60, v61, v62
  v_max_u32 v31, v31, v63
  v_cmp_eq_u32 vcc, -1, v31
  s_cbranch_vccz SL_m_13_ok3
SL_m_13_x3:
  s_mov_b64 exec, vcc
  buffer_load_dwordx4 v[60:63], v3, s[4:7], s41 offen offset:3072 sc1
  s_mov_b64 exec, -1
  s_add_u32 s46, s46, 1
  s_cmp_ge_u32 s46, 131072
  s_cbranch_scc1 SL_rec_abort
  s_waitcnt vmcnt(4)
  s_branch SL_m_13_c1
SL_m_13_ok1:
  v_smfmac_f32_16x16x64_bf16 v[64:67], v[52:55], a[48:55], v23
  v_max3_u32 v31, v60, v61, v62
  v_max_u32 v31, v31, v63
  v_cmp_eq_u32 vcc, -1, v31
  v_smfmac_f32_16x16x64_bf16 v[68:71], v[52:55], a[56:63], v23
  v_smfmac_f32_16x16x64_bf16 v[72:75], v[52:55], a[64:71], v23
  v_smfmac_f32_16x16x64_bf16 v[76:79], v[52:55], a[72:79], v23
  s_cbranch_vccz SL_m_3_ok3
  s_branch SL_m_3_x3
SL_m_13_ok3:
  v_smfmac_f32_16x16x64_bf16 v[64:67], v[60:63], a[144:151], v23
  v_max3_u32 v31, v52, v53, v54
  v_max_u32 v31, v31, v55
  v_cmp_eq_u32 vcc, -1, v31
  v_smfmac_f32_16x16x64_bf16 v[68:71], v[60:63], a[152:159], v23
  v_smfmac_f32_16x16x64_bf16 v[72:75], v[60:63], a[160:167], v23
  v_smfmac_f32_16x16x64_bf16 v[76:79], v[60:63], a[168:175], v23
  s_cbranch_vccz SL_m_1_ok1
  s_branch SL_m_1_x1
SL_m_23_c2:
  v_max3_u32 v31, v56, v57, v58
  v_max_u32 v31, v31, v59
  v_cmp_eq_u32 vcc, -1, v31
  s_cbranch_vccz SL_m_23_ok2
SL_m_23_x2:
  s_mov_b64 exec, vcc
  buffer_load_dwordx4 v[56:59], v3, s[4:7], s41 offen offset:2048 sc1
  s_mov_b64 exec, -1
SL_m_23_c3:
  v_max3_u32 v31, v60, v61, v62
  v_max_u32 v31, v31, v63
  v_cmp_eq_u32 vcc, -1, v31
  s_cbranch_vccz SL_m_23_ok3
SL_m_23_x3:
  s_mov_b64 exec, vcc
  buffer_load_dwordx4 v[60:63], v3, s[4:7], s41 offen offset:3072 sc1
  s_mov_b64 exec, -1
  s_add_u32 s46, s46, 1
  s_cmp_ge_u32 s46, 131072
  s_cbranch_scc1 SL_rec_abort
  s_waitcnt vmcnt(4)
  s_branch SL_m_23_c2
SL_m_23_ok2:
  v_smfmac_f32_16x16x64_bf16 v[64:67], v[56:59], a[96:103], v23
  v_max3_u32 v31, v60, v61, v62
  v_max_u32 v31, v31, v63
  v_cmp_eq_u32 vcc, -1, v31
  v_smfmac_f32_16x16x64_bf16 v[68:71], v[56:59], a[104:111], v23
  v_smfmac_f32_16x16x64_bf16 v[72:75], v[56:59], a[112:119], v23
  v_smfmac_f32_16x16x64_bf16 v[76:79], v[56:59], a[120:127], v23
  s_cbranch_vccz SL_m_3_ok3
  s_branch SL_m_3_x3
SL_m_23_ok3:
  v_smfmac_f32_16x16x64_bf16 v[64:67], v[60:63], a[144:151], v23
  v_max3_u32 v31, v56, v57, v58
  v_max_u32 v31, v31, v59
  v_cmp_eq_u32 vcc, -1, v31
  v_smfmac_f32_16x16x64_bf16 v[68:71], v[60:63], a[152:159], v23
  v_smfmac_f32_16x16x64_bf16 v[72:75], v[60:63], a[160:167], v23
  v_smfmac_f32_16x16x64_bf16 v[76:79], v[60:63], a[168:175], v23
  s_cbranch_vccz SL_m_2_ok2
  s_branch SL_m_2_x2
SL_m_012_c0:
  v_max3_u32 v31, v48, v49, v50
  v_max_u32 v31, v31, v51
  v_cmp_eq_u32 vcc, -1, v31
  s_cbranch_vccz SL_m_012_ok0
SL_m_012_x0:
  s_mov_b64 exec, vcc
  buffer_load_dwordx4 v[48:51], v3, s[4:7], s41 offen offset:0 sc1
  s_mov_b64 exec, -1
SL_m_012_c1:
  v_max3_u32 v31, v52, v53, v54
  v_max_u32 v31, v31, v55
  v_cmp_eq_u32 vcc, -1, v31
  s_cbranch_vccz SL_m_012_ok1
SL_m_012_x1:
  s_mov_b64 exec, vcc
  buffer_load_dwordx4 v[52:55], v3, s[4:7], s41 offen offset:1024 sc1
  s_mov_b64 exec, -1
SL_m_012_c2:
  v_max3_u32 v31, v56, v57, v58
  v_max_u32 v31, v31, v59
  v_cmp_eq_u32 vcc, -1, v31
  s_cbranch_vccz SL_m_012_ok2
SL_m_012_x2:
  s_mov_b64 exec, vcc
  buffer_load_dwordx4 v[56:59], v3, s[4:7], s41 offen offset:2048 sc1
  s_mov_b64 exec, -1
  s_add_u32 s46, s46, 1
  s_cmp_ge_u32 s46, 131072
  s_cbranch_scc1 SL_rec_abort
  s_waitcnt vmcnt(4)
  s_branch SL_m_012_c0
SL_m_012_ok0:
  v_smfmac_f32_16x16x64_bf16 v[64:67], v[48:51], a[0:7], v23
  v_max3_u32 v31, v52, v53, v54
  v_max_u32 v31, v31, v55
  v_cmp_eq_u32 vcc, -1, v31
  v_smfmac_f32_16x16x64_bf16 v[68:71], v[48:51], a[8:15], v23
  v_smfmac_f32_16x16x64_bf16 v[72:75], v[48:51], a[16:23], v23
  v_smfmac_f32_16x16x64_bf16 v[76:79], v[48:51], a[24:31], v23
  s_cbranch_vccz SL_m_12_ok1
  s_branch SL_m_12_x1
SL_m_012_ok1:
  v_smfmac_f32_16x16x64_bf16 v[64:67], v[52:55], a[48:55], v23
  v_max3_u32 v31, v56, v57, v58
  v_max_u32 v31, v31, v59
  v_cmp_eq_u32 vcc, -1, v31
  v_smfmac_f32_16x16x64_bf16 v[68:71], v[52:55], a[56:63], v23
  v_smfmac_f32_16x16x64_bf16 v[72:75], v[52:55], a[64:71], v23
  v_smfmac_f32_16x16x64_bf16 v[76:79], v[52:55], a[72:79], v23
  s_cbranch_vccz SL_m_02_ok2
  s_branch SL_m_02_x2
SL_m_012_ok2:
  v_smfmac_f32_16x16x64_bf16 v[64:67], v[56:59], a[96:103], v23
  v_max3_u32 v31, v48, v49, v50
  v_max_u32 v31, v31, v51
  v_cmp_eq_u32 vcc, -1, v31
  v_smfmac_f32_16x16x64_bf16 v[68:71], v[56:59], a[104:111], v23
  v_smfmac_f32_16x16x64_bf16 v[72:75], v[56:59], a[112:119], v23
  v_smfmac_f32_16x16x64_bf16 v[76:79], v[56:59], a[120:127], v23
  s_cbranch_vccz SL_m_01_ok0
  s_branch SL_m_01_x0
SL_m_013_c0:
  v_max3_u32 v31, v48, v49, v50
  v_max_u32 v31, v31, v51
  v_cmp_eq_u32 vcc, -1, v31
  s_cbranch_vccz SL_m_013_ok0
SL_m_013_x0:
  s_mov_b64 exec, vcc
  buffer_load_dwordx4 v[48:51], v3, s[4:7], s41 offen offset:0 sc1
  s_mov_b64 exec, -1
SL_m_013_c1:
  v_max3_u32 v31, v52, v53, v54
  v_max_u32 v31, v31, v55
  v_cmp_eq_u32 vcc, -1, v31
  s_cbranch_vccz SL_m_013_ok1
SL_m_013_x1:
  s_mov_b64 exec, vcc
  buffer_load_dwordx4 v[52:55], v3, s[4:7], s41 offen offset:1024 sc1
  s_mov_b64 exec, -1
SL_m_013_c3:
  v_max3_u32 v31, v60, v61, v62
  v_max_u32 v31, v31, v63
  v_cmp_eq_u32 vcc, -1, v31
  s_cbranch_vccz SL_m_013_ok3
SL_m_013_x3:
  s_mov_b64 exec, vcc
  buffer_load_dwordx4 v[60:63], v3, s[4:7], s41 offen offset:3072 sc1
  s_mov_b64 exec, -1
  s_add_u32 s46, s46, 1
  s_cmp_ge_u32 s46, 131072
  s_cbranch_scc1 SL_rec_abort
  s_waitcnt vmcnt(4)
  s_branch SL_m_013_c0
SL_m_013_ok0:
  v_smfmac_f32_16x16x64_bf16 v[64:67], v[48:51], a[0:7], v23
  v_max3_u32 v31, v52, v53, v54
  v_max_u32 v31, v31, v55
  v_cmp_eq_u32 vcc, -1, v31
  v_smfmac_f32_16x16x64_bf16 v[68:71], v[48:51], a[8:15], v23
  v_smfmac_f32_16x16x64_bf16 v[72:75], v[48:51], a[16:23], v23
  v_smfmac_f32_16x16x64_bf16 v[76:79], v[48:51], a[24:31], v23
  s_cbranch_vccz SL_m_13_ok1
  s_branch SL_m_13_x1
SL_m_013_ok1:
  v_smfmac_f32_16x16x64_bf16 v[64:67], v[52:55], a[48:55], v23
  v_max3_u32 v31, v60, v61, v62
  v_max_u32 v31, v31, v63
  v_cmp_eq_u32 vcc, -1, v31
  v_smfmac_f32_16x16x64_bf16 v[68:71], v[52:55], a[56:63], v23
  v_smfmac_f32_16x16x64_bf16 v[72:75], v[52:55], a[64:71], v23
  v_smfmac_f32_16x16x64_bf16 v[76:79], v[52:55], a[72:79], v23
  s_cbranch_vccz SL_m_03_ok3
  s_branch SL_m_03_x3
SL_m_013_ok3:
  v_smfmac_f32_16x16x64_bf16 v[64:67], v[60:63], a[144:151], v23
  v_max3_u32 v31, v48, v49, v50
  v_max_u32 v31, v31, v51
  v_cmp_eq_u32 vcc, -1, v31
  v_smfmac_f32_16x16x64_bf16 v[68:71], v[60:63], a[152:159], v23
  v_smfmac_f32_16x16x64_bf16 v[72:75], v[60:63], a[160:167], v23
  v_smfmac_f32_16x16x64_bf16 v[76:79], v[60:63], a[168:175], v23
  s_cbranch_vccz SL_m_01_ok0
  s_branch SL_m_01_x0
SL_m_023_c0:
  v_max3_u32 v31, v48, v49, v50
  v_max_u32 v31, v31, v51
  v_cmp_eq_u32 vcc, -1, v31
  s_cbranch_vccz SL_m_023_ok0
SL_m_023_x0:
  s_mov_b64 exec, vcc
  buffer_load_dwordx4 v[48:51], v3, s[4:7], s41 offen offset:0 sc1
  s_mov_b64 exec, -1
SL_m_023_c2:
  v_max3_u32 v31, v56, v57, v58
  v_max_u32 v31, v31, v59
  v_cmp_eq_u32 vcc, -1, v31
  s_cbranch_vccz SL_m_023_ok2
SL_m_023_x2:
  s_mov_b64 exec, vcc
  buffer_load_dwordx4 v[56:59], v3, s[4:7], s41 offen offset:2048 sc1
  s_mov_b64 exec, -1
SL_m_023_c3:
  v_max3_u32 v31, v60, v61, v62
  v_max_u32 v31, v31, v63
  v_cmp_eq_u32 vcc, -1, v31
  s_cbranch_vccz SL_m_023_ok3
SL_m_023_x3:
  s_mov_b64 exec, vcc
  buffer_load_dwordx4 v[60:63], v3, s[4:7], s41 offen offset:3072 sc1
  s_mov_b64 exec, -1
  s_add_u32 s46, s46, 1
  s_cmp_ge_u32 s46, 131072
  s_cbranch_scc1 SL_rec_abort
  s_waitcnt vmcnt(4)
  s_branch SL_m_023_c0
SL_m_023_ok0:
  v_smfmac_f32_16x16x64_bf16 v[64:67], v[48:51], a[0:7], v23
  v_max3_u32 v31, v56, v57, v58
  v_max_u32 v31, v31, v59
  v_cmp_eq_u32 vcc, -1, v31
  v_smfmac_f32_16x16x64_bf16 v[68:71], v[48:51], a[8:15], v23
  v_smfmac_f32_16x16x64_bf16 v[72:75], v[48:51], a[16:23], v23
  v_smfmac_f32_16x16x64_bf16 v[76:79], v[48:51], a[24:31], v23
  s_cbranch_vccz SL_m_23_ok2
  s_branch SL_m_23_x2
SL_m_023_ok2:
  v_smfmac_f32_16x16x64_bf16 v[64:67], v[56:59], a[96:103], v23
  v_max3_u32 v31, v60, v61, v62
  v_max_u32 v31, v31, v63
  v_cmp_eq_u32 vcc, -1, v31
  v_smfmac_f32_16x16x64_bf16 v[68:71], v[56:59], a[104:111], v23
  v_smfmac_f32_16x16x64_bf16 v[72:75], v[56:59], a[112:119], v23
  v_smfmac_f32_16x16x64_bf16 v[76:79], v[56:59], a[120:127], v23
  s_cbranch_vccz SL_m_03_ok3
  s_branch SL_m_03_x3
SL_m_023_ok3:
  v_smfmac_f32_16x16x64_bf16 v[64:67], v[60:63], a[144:151], v23
  v_max3_u32 v31, v48, v49, v50
  v_max_u32 v31, v31, v51
  v_cmp_eq_u32 vcc, -1, v31
  v_smfmac_f32_16x16x64_bf16 v[68:71], v[60:63], a[152:159], v23
  v_smfmac_f32_16x16x64_bf16 v[72:75], v[60:63], a[160:167], v23
  v_smfmac_f32_16x16x64_bf16 v[76:79], v[60:63], a[168:175], v23
  s_cbranch_vccz SL_m_02_ok0
  s_branch SL_m_02_x0
SL_m_123_c1:
  v_max3_u32 v31, v52, v53, v54
  v_max_u32 v31, v31, v55
  v_cmp_eq_u32 vcc, -1, v31
  s_cbranch_vccz SL_m_123_ok1
SL_m_123_x1:
  s_mov_b64 exec, vcc
  buffer_load_dwordx4 v[52:55], v3, s[4:7], s41 offen offset:1024 sc1
  s_mov_b64 exec, -1
SL_m_123_c2:
  v_max3_u32 v31, v56, v57, v58
  v_max_u32 v31, v31, v59
  v_cmp_eq_u32 vcc, -1, v31
  s_cbranch_vccz SL_m_123_ok2
SL_m_123_x2:
  s_mov_b64 exec, vcc
  buffer_load_dwordx4 v[56:59], v3, s[4:7], s41 offen offset:2048 sc1
  s_mov_b64 exec, -1
SL_m_123_c3:
  v_max3_u32 v31, v60, v61, v62
  v_max_u32 v31, v31, v63
  v_cmp_eq_u32 vcc, -1, v31
  s_cbranch_vccz SL_m_123_ok3
SL_m_123_x3:
  s_mov_b64 exec, vcc
  buffer_load_dwordx4 v[60:63], v3, s[4:7], s41 offen offset:3072 sc1
  s_mov_b64 exec, -1
  s_add_u32 s46, s46, 1
  s_cmp_ge_u32 s46, 131072
  s_cbranch_scc1 SL_rec_abort
  s_waitcnt vmcnt(4)
  s_branch SL_m_123_c1
SL_m_123_ok1:
  v_smfmac_f32_16x16x64_bf16 v[64:67], v[52:55], a[48:55], v23
  v_max3_u32 v31, v56, v57, v58
  v_max_u32 v31, v31, v59
  v_cmp_eq_u32 vcc, -1, v31
  v_smfmac_f32_16x16x64_bf16 v[68:71], v[52:55], a[56:63], v23
  v_smfmac_f32_16x16x64_bf16 v[72:75], v[52:55], a[64:71], v23
  v_smfmac_f32_16x16x64_bf16 v[76:79], v[52:55], a[72:79], v23
  s_cbranch_vccz SL_m_23_ok2
  s_branch SL_m_23_x2
SL_m_123_ok2:
  v_smfmac_f32_16x16x64_bf16 v[64:67], v[56:59], a[96:103], v23
  v_max3_u32 v31, v60, v61, v62
  v_max_u32 v31, v31, v63
  v_cmp_eq_u32 vcc, -1, v31
  v_smfmac_f32_16x16x64_bf16 v[68:71], v[56:59], a[104:111], v23
  v_smfmac_f32_16x16x64_bf16 v[72:75], v[56:59], a[112:119], v23
  v_smfmac_f32_16x16x64_bf16 v[76:79], v[56:59], a[120:127], v23
  s_cbranch_vccz SL_m_13_ok3
  s_branch SL_m_13_x3
SL_m_123_ok3:
  v_smfmac_f32_16x16x64_bf16 v[64:67], v[60:63], a[144:151], v23
  v_max3_u32 v31, v52, v53, v54
  v_max_u32 v31, v31, v55
  v_cmp_eq_u32 vcc, -1, v31
  v_smfmac_f32_16x16x64_bf16 v[68:71], v[60:63], a[152:159], v23
  v_smfmac_f32_16x16x64_bf16 v[72:75], v[60:63], a[160:167], v23
  v_smfmac_f32_16x16x64_bf16 v[76:79], v[60:63], a[168:175], v23
  s_cbranch_vccz SL_m_12_ok1
  s_branch SL_m_12_x1
SL_m_0123_c0:
  v_max3_u32 v31, v48, v49, v50
  v_max_u32 v31, v31, v51
  v_cmp_eq_u32 vcc, -1, v31
  s_cbranch_vccz SL_m_0123_ok0
SL_m_0123_x0:
  s_mov_b64 exec, vcc
  buffer_load_dwordx4 v[48:51], v3, s[4:7], s41 offen offset:0 sc1
  s_mov_b64 exec, -1
SL_m_0123_c1:
  v_max3_u32 v31, v52, v53, v54
  v_max_u32 v31, v31, v55
  v_cmp_eq_u32 vcc, -1, v31
  s_cbranch_vccz SL_m_0123_ok1
SL_m_0123_x1:
  s_mov_b64 exec, vcc
  buffer_load_dwordx4 v[52:55], v3, s[4:7], s41 offen offset:1024 sc1
  s_mov_b64 exec, -1
SL_m_0123_c2:
  v_max3_u32 v31, v56, v57, v58
  v_max_u32 v31, v31, v59
  v_cmp_eq_u32 vcc, -1, v31
  s_cbranch_vccz SL_m_0123_ok2
SL_m_0123_x2:
  s_mov_b64 exec, vcc
  buffer_load_dwordx4 v[56:59], v3, s[4:7], s41 offen offset:2048 sc1
  s_mov_b64 exec, -1
SL_m_0123_c3:
  v_max3_u32 v31, v60, v61, v62
  v_max_u32 v31, v31, v63
  v_cmp_eq_u32 vcc, -1, v31
  s_cbranch_vccz SL_m_0123_ok3
SL_m_0123_x3:
  s_mov_b64 exec, vcc
  buffer_load_dwordx4 v[60:63], v3, s[4:7], s41 offen offset:3072 sc1
  s_mov_b64 exec, -1
  s_add_u32 s46, s46, 1
  s_cmp_ge_u32 s46, 131072
  s_cbranch_scc1 SL_rec_abort
  s_waitcnt vmcnt(4)
  s_branch SL_m_0123_c0
SL_m_0123_ok0:
  v_smfmac_f32_16x16x64_bf16 v[64:67], v[48:51], a[0:7], v23
  v_max3_u32 v31, v52, v53, v54
  v_max_u32 v31, v31, v55
  v_cmp_eq_u32 vcc, -1, v31
  v_smfmac_f32_16x16x64_bf16 v[68:71], v[48:51], a[8:15], v23
  v_smfmac_f32_16x16x64_bf16 v[72:75], v[48:51], a[16:23], v23
  v_smfmac_f32_16x16x64_bf16 v[76:79], v[48:51], a[24:31], v23
  s_cbranch_vccz SL_m_123_ok1
  s_branch SL_m_123_x1
SL_m_0123_ok1:
  v_smfmac_f32_16x16x64_bf16 v[64:67], v[52:55], a[48:55], v23
  v_max3_u32 v31, v56, v57, v58
  v_max_u32 v31, v31, v59
  v_cmp_eq_u32 vcc, -1, v31
  v_smfmac_f32_16x16x64_bf16 v[68:71], v[52:55], a[56:63], v23
  v_smfmac_f32_16x16x64_bf16 v[72:75], v[52:55], a[64:71], v23
  v_smfmac_f32_16x16x64_bf16 v[76:79], v[52:55], a[72:79], v23
  s_cbranch_vccz SL_m_023_ok2
  s_branch SL_m_023_x2
SL_m_0123_ok2:
  v_smfmac_f32_16x16x64_bf16 v[64:67], v[56:59], a[96:103], v23
  v_max3_u32 v31, v60, v61, v62
  v_max_u32 v31, v31, v63
  v_cmp_eq_u32 vcc, -1, v31
  v_smfmac_f32_16x16x64_bf16 v[68:71], v[56:59], a[104:111], v23
  v_smfmac_f32_16x16x64_bf16 v[72:75], v[56:59], a[112:119], v23
  v_smfmac_f32_16x16x64_bf16 v[76:79], v[56:59], a[120:127], v23
  s_cbranch_vccz SL_m_013_ok3
  s_branch SL_m_013_x3
SL_m_0123_ok3:
  v_smfmac_f32_16x16x64_bf16 v[64:67], v[60:63], a[144:151], v23
  v_max3_u32 v31, v48, v49, v50
  v_max_u32 v31, v31, v51
  v_cmp_eq_u32 vcc, -1, v31
  v_smfmac_f32_16x16x64_bf16 v[68:71], v[60:63], a[152:159], v23
  v_smfmac_f32_16x16x64_bf16 v[72:75], v[60:63], a[160:167], v23
  v_smfmac_f32_16x16x64_bf16 v[76:79], v[60:63], a[168:175], v23
  s_cbranch_vccz SL_m_012_ok0
  s_branch SL_m_012_x0
SL_x_f0:
  s_mov_b64 exec, vcc
  buffer_load_dwordx4 v[64:67], v9, s[4:7], s41 offen offset:0 sc1
  s_mov_b64 exec, -1
  s_waitcnt vmcnt(2)
  s_branch SL_x_0123_c1
SL_x_f1:
  s_mov_b64 exec, vcc
  buffer_load_dwordx4 v[68:71], v9, s[4:7], s41 offen offset:1024 sc1
  s_mov_b64 exec, -1
  s_waitcnt vmcnt(2)
  s_branch SL_x_123_c2
SL_x_f2:
  s_mov_b64 exec, vcc
  buffer_load_dwordx4 v[72:75], v9, s[4:7], s41 offen offset:2048 sc1
  s_mov_b64 exec, -1
  s_waitcnt vmcnt(2)
  s_branch SL_x_23_c3
SL_x_f3:
  s_mov_b64 exec, vcc
  buffer_load_dwordx4 v[76:79], v9, s[4:7], s41 offen offset:3072 sc1
  s_mov_b64 exec, -1
  s_nop 7
  s_branch SL_x_3_c3
SL_x_0_c0:
  v_max3_u32 v31, v64, v65, v66
  v_max_u32 v31, v31, v67
  v_cmp_eq_u32 vcc, -1, v31
  s_cbranch_vccz SL_x_0_ok0
SL_x_0_x0:
  s_mov_b64 exec, vcc
  buffer_load_dwordx4 v[64:67], v9, s[4:7], s41 offen offset:0 sc1
  s_mov_b64 exec, -1
  s_add_u32 s46, s46, 1
  s_cmp_ge_u32 s46, 131072
  s_cbranch_scc1 SL_rec_abort
  s_waitcnt vmcnt(2)
  s_branch SL_x_0_c0
SL_x_0_ok0:
  v_mfma_f32_16x16x32_bf16 v[44:47], v[64:67], v[64:67], v[44:47]
  v_mfma_f32_16x16x32_bf16 v[36:39], v[116:119], v[64:67], v[36:39]
  v_mfma_f32_16x16x32_bf16 v[40:43], v[132:135], v[64:67], v[40:43]
  s_branch SL_x_done
SL_x_1_c1:
  v_max3_u32 v31, v68, v69, v70
  v_max_u32 v31, v31, v71
  v_cmp_eq_u32 vcc, -1, v31
  s_cbranch_vccz SL_x_1_ok1
SL_x_1_x1:
  s_mov_b64 exec, vcc
  buffer_load_dwordx4 v[68:71], v9, s[4:7], s41 offen offset:1024 sc1
  s_mov_b64 exec, -1
  s_add_u32 s46, s46, 1
  s_cmp_ge_u32 s46, 131072
  s_cbranch_scc1 SL_rec_abort
  s_waitcnt vmcnt(2)
  s_branch SL_x_1_c1
SL_x_1_ok1:
  v_mfma_f32_16x16x32_bf16 v[44:47], v[68:71], v[68:71], v[44:47]
  v_mfma_f32_16x16x32_bf16 v[36:39], v[120:123], v[68:71], v[36:39]
  v_mfma_f32_16x16x32_bf16 v[40:43], v[136:139], v[68:71], v[40:43]
  s_branch SL_x_done
SL_x_2_c2:
  v_max3_u32 v31, v72, v73, v74
  v_max_u32 v31, v31, v75
  v_cmp_eq_u32 vcc, -1, v31
  s_cbranch_vccz SL_x_2_ok2
SL_x_2_x2:
  s_mov_b64 exec, vcc
  buffer_load_dwordx4 v[72:75], v9, s[4:7], s41 offen offset:2048 sc1
  s_mov_b64 exec, -1
  s_add_u32 s46, s46, 1
  s_cmp_ge_u32 s46, 131072
  s_cbranch_scc1 SL_rec_abort
  s_waitcnt vmcnt(2)
  s_branch SL_x_2_c2
SL_x_2_ok2:
  v_mfma_f32_16x16x32_bf16 v[44:47], v[72:75], v[72:75], v[44:47]
  v_mfma_f32_16x16x32_bf16 v[36:39], v[124:127], v[72:75], v[36:39]
  v_mfma_f32_16x16x32_bf16 v[40:43], v[140:143], v[72:75], v[40:43]
  s_branch SL_x_done
SL_x_3_c3:
  v_max3_u32 v31, v76, v77, v78
  v_max_u32 v31, v31, v79
  v_cmp_eq_u32 vcc, -1, v31
  s_cbranch_vccz SL_x_3_ok3
SL_x_3_x3:
  s_mov_b64 exec, vcc
  buffer_load_dwordx4 v[76:79], v9, s[4:7], s41 offen offset:3072 sc1
  s_mov_b64 exec, -1
  s_add_u32 s46, s46, 1
  s_cmp_ge_u32 s46, 131072
  s_cbranch_scc1 SL_rec_abort
  s_waitcnt vmcnt(2)
  s_branch SL_x_3_c3
SL_x_3_ok3:
  v_mfma_f32_16x16x32_bf16 v[44:47], v[76:79], v[76:79], v[44:47]
  v_mfma_f32_16x16x32_bf16 v[36:39], v[128:131], v[76:79], v[36:39]
  v_mfma_f32_16x16x32_bf16 v[40:43], v[144:147], v[76:79], v[40:43]
  s_branch SL_x_done
SL_x_01_c0:
  v_max3_u32 v31, v64, v65, v66
  v_max_u32 v31, v31, v67
  v_cmp_eq_u32 vcc, -1, v31
  s_cbranch_vccz SL_x_01_ok0
SL_x_01_x0:
  s_mov_b64 exec, vcc
  buffer_load_dwordx4 v[64:67], v9, s[4:7], s41 offen offset:0 sc1
  s_mov_b64 exec, -1
SL_x_01_c1:
  v_max3_u32 v31, v68, v69, v70
  v_max_u32 v31, v31, v71
  v_cmp_eq_u32 vcc, -1, v31
  s_cbranch_vccz SL_x_01_ok1
SL_x_01_x1:
  s_mov_b64 exec, vcc
  buffer_load_dwordx4 v[68:71], v9, s[4:7], s41 offen offset:1024 sc1
  s_mov_b64 exec, -1
  s_add_u32 s46, s46, 1
  s_cmp_ge_u32 s46, 131072
  s_cbranch_scc1 SL_rec_abort
  s_waitcnt vmcnt(4)
  s_branch SL_x_01_c0
SL_x_01_ok0:
  v_mfma_f32_16x16x32_bf16 v[44:47], v[64:67], v[64:67], v[44:47]
  v_max3_u32 v31, v68, v69, v70
  v_max_u32 v31, v31, v71
  v_cmp_eq_u32 vcc, -1, v31
  v_mfma_f32_16x16x32_bf16 v[36:39], v[116:119], v[64:67], v[36:39]
  v_mfma_f32_16x16x32_bf16 v[40:43], v[132:135], v[64:67], v[40:43]
  s_cbranch_vccz SL_x_1_ok1
  s_branch SL_x_1_x1
SL_x_01_ok1:
  v_mfma_f32_16x16x32_bf16 v[44:47], v[68:71], v[68:71], v[44:47]
  v_max3_u32 v31, v64, v65, v66
  v_max_u32 v31, v31, v67
  v_cmp_eq_u32 vcc, -1, v31
  v_mfma_f32_16x16x32_bf16 v[36:39], v[120:123], v[68:71], v[36:39]
  v_mfma_f32_16x16x32_bf16 v[40:43], v[136:139], v[68:71], v[40:43]
  s_cbranch_vccz SL_x_0_ok0
  s_branch SL_x_0_x0
SL_x_02_c0:
  v_max3_u32 v31, v64, v65, v66
  v_max_u32 v31, v31, v67
  v_cmp_eq_u32 vcc, -1, v31
  s_cbranch_vccz SL_x_02_ok0
SL_x_02_x0:
  s_mov_b64 exec, vcc
  buffer_load_dwordx4 v[64:67], v9, s[4:7], s41 offen offset:0 sc1
  s_mov_b64 exec, -1
SL_x_02_c2:
  v_max3_u32 v31, v72, v73, v74
  v_max_u32 v31, v31, v75
  v_cmp_eq_u32 vcc, -1, v31
  s_cbranch_vccz SL_x_02_ok2
SL_x_02_x2:
  s_mov_b64 exec, vcc
  buffer_load_dwordx4 v[72:75], v9, s[4:7], s41 offen offset:2048 sc1
  s_mov_b64 exec, -1
  s_add_u32 s46, s46, 1
  s_cmp_ge_u32 s46, 131072
  s_cbranch_scc1 SL_rec_abort
  s_waitcnt vmcnt(4)
  s_branch SL_x_02_c0
SL_x_02_ok0:
  v_mfma_f32_16x16x32_bf16 v[44:47], v[64:67], v[64:67], v[44:47]
  v_max3_u32 v31, v72, v73, v74
  v_max_u32 v31, v31, v75
  v_cmp_eq_u32 vcc, -1, v31
  v_mfma_f32_16x16x32_bf16 v[36:39], v[116:119], v[64:67], v[36:39]
  v_mfma_f32_16x16x32_bf16 v[40:43], v[132:135], v[64:67], v[40:43]
  s_cbranch_vccz SL_x_2_ok2
  s_branch SL_x_2_x2
SL_x_02_ok2:
  v_mfma_f32_16x16x32_bf16 v[44:47], v[72:75], v[72:75], v[44:47]
  v_max3_u32 v31, v64, v65, v66
  v_max_u32 v31, v31, v67
  v_cmp_eq_u32 vcc, -1, v31
  v_mfma_f32_16x16x32_bf16 v[36:39], v[124:127], v[72:75], v[36:39]
  v_mfma_f32_16x16x32_bf16 v[40:43], v[140:143], v[72:75], v[40:43]
  s_cbranch_vccz SL_x_0_ok0
  s_branch SL_x_0_x0
SL_x_03_c0:
  v_max3_u32 v31, v64, v65, v66
  v_max_u32 v31, v31, v67
  v_cmp_eq_u32 vcc, -1, v31
  s_cbranch_vccz SL_x_03_ok0
SL_x_03_x0:
  s_mov_b64 exec, vcc
  buffer_load_dwordx4 v[64:67], v9, s[4:7], s41 offen offset:0 sc1
  s_mov_b64 exec, -1
SL_x_03_c3:
  v_max3_u32 v31, v76, v77, v78
  v_max_u32 v31, v31, v79
  v_cmp_eq_u32 vcc, -1, v31
  s_cbranch_vccz SL_x_03_ok3
SL_x_03_x3:
  s_mov_b64 exec, vcc
  buffer_load_dwordx4 v[76:79], v9, s[4:7], s41 offen offset:3072 sc1
  s_mov_b64 exec, -1
  s_add_u32 s46, s46, 1
  s_cmp_ge_u32 s46, 131072
  s_cbranch_scc1 SL_rec_abort
  s_waitcnt vmcnt(4)
  s_branch SL_x_03_c0
SL_x_03_ok0:
  v_mfma_f32_16x16x32_bf16 v[44:47], v[64:67], v[64:67], v[44:47]
  v_max3_u32 v31, v76, v77, v78
  v_max_u32 v31, v31, v79
  v_cmp_eq_u32 vcc, -1, v31
  v_mfma_f32_16x16x32_bf16 v[36:39], v[116:119], v[64:67], v[36:39]
  v_mfma_f32_16x16x32_bf16 v[40:43], v[132:135], v[64:67], v[40:43]
  s_cbranch_vccz SL_x_3_ok3
  s_branch SL_x_3_x3
SL_x_03_ok3:
  v_mfma_f32_16x16x32_bf16 v[44:47], v[76:79], v[76:79], v[44:47]
  v_max3_u32 v31, v64, v65, v66
  v_max_u32 v31, v31, v67
  v_cmp_eq_u32 vcc, -1, v31
  v_mfma_f32_16x16x32_bf16 v[36:39], v[128:131], v[76:79], v[36:39]
  v_mfma_f32_16x16x32_bf16 v[40:43], v[144:147], v[76:79], v[40:43]
  s_cbranch_vccz SL_x_0_ok0
  s_branch SL_x_0_x0
SL_x_12_c1:
  v_max3_u32 v31, v68, v69, v70
  v_max_u32 v31, v31, v71
  v_cmp_eq_u32 vcc, -1, v31
  s_cbranch_vccz SL_x_12_ok1
SL_x_12_x1:
  s_mov_b64 exec, vcc
  buffer_load_dwordx4 v[68:71], v9, s[4:7], s41 offen offset:1024 sc1
  s_mov_b64 exec, -1
SL_x_12_c2:
  v_max3_u32 v31, v72, v73, v74
  v_max_u32 v31, v31, v75
  v_cmp_eq_u32 vcc, -1, v31
  s_cbranch_vccz SL_x_12_ok2
SL_x_12_x2:
  s_mov_b64 exec, vcc
  buffer_load_dwordx4 v[72:75], v9, s[4:7], s41 offen offset:2048 sc1
  s_mov_b64 exec, -1
  s_add_u32 s46, s46, 1
  s_cmp_ge_u32 s46, 131072
  s_cbranch_scc1 SL_rec_abort
  s_waitcnt vmcnt(4)
  s_branch SL_x_12_c1
SL_x_12_ok1:
  v_mfma_f32_16x16x32_bf16 v[44:47], v[68:71], v[68:71], v[44:47]
  v_max3_u32 v31, v72, v73, v74
  v_max_u32 v31, v31, v75
  v_cmp_eq_u32 vcc, -1, v31
  v_mfma_f32_16x16x32_bf16 v[36:39], v[120:123], v[68:71], v[36:39]
  v_mfma_f32_16x16x32_bf16 v[40:43], v[136:139], v[68:71], v[40:43]
  s_cbranch_vccz SL_x_2_ok2
  s_branch SL_x_2_x2
SL_x_12_ok2:
  v_mfma_f32_16x16x32_bf16 v[44:47], v[72:75], v[72:75], v[44:47]
  v_max3_u32 v31, v68, v69, v70
  v_max_u32 v31, v31, v71
  v_cmp_eq_u32 vcc, -1, v31
  v_mfma_f32_16x16x32_bf16 v[36:39], v[124:127], v[72:75], v[36:39]
  v_mfma_f32_16x16x32_bf16 v[40:43], v[140:143], v[72:75], v[40:43]
  s_cbranch_vccz SL_x_1_ok1
  s_branch SL_x_1_x1
SL_x_13_c1:
  v_max3_u32 v31, v68, v69, v70
  v_max_u32 v31, v31, v71
  v_cmp_eq_u32 vcc, -1, v31
  s_cbranch_vccz SL_x_13_ok1
SL_x_13_x1:
  s_mov_b64 exec, vcc
  buffer_load_dwordx4 v[68:71], v9, s[4:7], s41 offen offset:1024 sc1
  s_mov_b64 exec, -1
SL_x_13_c3:
  v_max3_u32 v31, v76, v77, v78
  v_max_u32 v31, v31, v79
  v_cmp_eq_u32 vcc, -1, v31
  s_cbranch_vccz SL_x_13_ok3
SL_x_13_x3:
  s_mov_b64 exec, vcc
  buffer_load_dwordx4 v[76:79], v9, s[4:7], s41 offen offset:3072 sc1
  s_mov_b64 exec, -1
  s_add_u32 s46, s46, 1
  s_cmp_ge_u32 s46, 131072
  s_cbranch_scc1 SL_rec_abort
  s_waitcnt vmcnt(4)
  s_branch SL_x_13_c1
SL_x_13_ok1:
  v_mfma_f32_16x16x32_bf16 v[44:47], v[68:71], v[68:71], v[44:47]
  v_max3_u32 v31, v76, v77, v78
  v_max_u32 v31, v31, v79
  v_cmp_eq_u32 vcc, -1, v31
  v_mfma_f32_16x16x32_bf16 v[36:39], v[120:123], v[68:71], v[36:39]
  v_mfma_f32_16x16x32_bf16 v[40:43], v[136:139], v[68:71], v[40:43]
  s_cbranch_vccz SL_x_3_ok3
  s_branch SL_x_3_x3
SL_x_13_ok3:
  v_mfma_f32_16x16x32_bf16 v[44:47], v[76:79], v[76:79], v[44:47]
  v_max3_u32 v31, v68, v69, v70
  v_max_u32 v31, v31, v71
  v_cmp_eq_u32 vcc, -1, v31
  v_mfma_f32_16x16x32_bf16 v[36:39], v[128:131], v[76:79], v[36:39]
  v_mfma_f32_16x16x32_bf16 v[40:43], v[144:147], v[76:79], v[40:43]
  s_cbranch_vccz SL_x_1_ok1
  s_branch SL_x_1_x1
SL_x_23_c2:
  v_max3_u32 v31, v72, v73, v74
  v_max_u32 v31, v31, v75
  v_cmp_eq_u32 vcc, -1, v31
  s_cbranch_vccz SL_x_23_ok2
SL_x_23_x2:
  s_mov_b64 exec, vcc
  buffer_load_dwordx4 v[72:75], v9, s[4:7], s41 offen offset:2048 sc1
  s_mov_b64 exec, -1
SL_x_23_c3:
  v_max3_u32 v31, v76, v77, v78
  v_max_u32 v31, v31, v79
  v_cmp_eq_u32 vcc, -1, v31
  s_cbranch_vccz SL_x_23_ok3
SL_x_23_x3:
  s_mov_b64 exec, vcc
  buffer_load_dwordx4 v[76:79], v9, s[4:7], s41 offen offset:3072 sc1
  s_mov_b64 exec, -1
  s_add_u32 s46, s46, 1
  s_cmp_ge_u32 s46, 131072
  s_cbranch_scc1 SL_rec_abort
  s_waitcnt vmcnt(4)
  s_branch SL_x_23_c2
SL_x_23_ok2:
  v_mfma_f32_16x16x32_bf16 v[44:47], v[72:75], v[72:75], v[44:47]
  v_max3_u32 v31, v76, v77, v78
  v_max_u32 v31, v31, v79
  v_cmp_eq_u32 vcc, -1, v31
  v_mfma_f32_16x16x32_bf16 v[36:39], v[124:127], v[72:75], v[36:39]
  v_mfma_f32_16x16x32_bf16 v[40:43], v[140:143], v[72:75], v[40:43]
  s_cbranch_vccz SL_x_3_ok3
  s_branch SL_x_3_x3
SL_x_23_ok3:
  v_mfma_f32_16x16x32_bf16 v[44:47], v[76:79], v[76:79], v[44:47]
  v_max3_u32 v31, v72, v73, v74
  v_max_u32 v31, v31, v75
  v_cmp_eq_u32 vcc, -1, v31
  v_mfma_f32_16x16x32_bf16 v[36:39], v[128:131], v[76:79], v[36:39]
  v_mfma_f32_16x16x32_bf16 v[40:43], v[144:147], v[76:79], v[40:43]
  s_cbranch_vccz SL_x_2_ok2
  s_branch SL_x_2_x2
SL_x_012_c0:
  v_max3_u32 v31, v64, v65, v66
  v_max_u32 v31, v31, v67
  v_cmp_eq_u32 vcc, -1, v31
  s_cbranch_vccz SL_x_012_ok0
SL_x_012_x0:
  s_mov_b64 exec, vcc
  buffer_load_dwordx4 v[64:67], v9, s[4:7], s41 offen offset:0 sc1
  s_mov_b64 exec, -1
SL_x_012_c1:
  v_max3_u32 v31, v68, v69, v70
  v_max_u32 v31, v31, v71
  v_cmp_eq_u32 vcc, -1, v31
  s_cbranch_vccz SL_x_012_ok1
SL_x_012_x1:
  s_mov_b64 exec, vcc
  buffer_load_dwordx4 v[68:71], v9, s[4:7], s41 offen offset:1024 sc1
  s_mov_b64 exec, -1
SL_x_012_c2:
  v_max3_u32 v31, v72, v73, v74
  v_max_u32 v31, v31, v75
  v_cmp_eq_u32 vcc, -1, v31
  s_cbranch_vccz SL_x_012_ok2
SL_x_012_x2:
  s_mov_b64 exec, vcc
  buffer_load_dwordx4 v[72:75], v9, s[4:7], s41 offen offset:2048 sc1
  s_mov_b64 exec, -1
  s_add_u32 s46, s46, 1
  s_cmp_ge_u32 s46, 131072
  s_cbranch_scc1 SL_rec_abort
  s_waitcnt vmcnt(4)
  s_branch SL_x_012_c0
SL_x_012_ok0:
  v_mfma_f32_16x16x32_bf16 v[44:47], v[64:67], v[64:67], v[44:47]
  v_max3_u32 v31, v68, v69, v70
  v_max_u32 v31, v31, v71
  v_cmp_eq_u32 vcc, -1, v31
  v_mfma_f32_16x16x32_bf16 v[36:39], v[116:119], v[64:67], v[36:39]
  v_mfma_f32_16x16x32_bf16 v[40:43], v[132:135], v[64:67], v[40:43]
  s_cbranch_vccz SL_x_12_ok1
  s_branch SL_x_12_x1
SL_x_012_ok1:
  v_mfma_f32_16x16x32_bf16 v[44:47], v[68:71], v[68:71], v[44:47]
  v_max3_u32 v31, v72, v73, v74
  v_max_u32 v31, v31, v75
  v_cmp_eq_u32 vcc, -1, v31
  v_mfma_f32_16x16x32_bf16 v[36:39], v[120:123], v[68:71], v[36:39]
  v_mfma_f32_16x16x32_bf16 v[40:43], v[136:139], v[68:71], v[40:43]
  s_cbranch_vccz SL_x_02_ok2
  s_branch SL_x_02_x2
SL_x_012_ok2:
  v_mfma_f32_16x16x32_bf16 v[44:47], v[72:75], v[72:75], v[44:47]
  v_max3_u32 v31, v64, v65, v66
  v_max_u32 v31, v31, v67
  v_cmp_eq_u32 vcc, -1, v31
  v_mfma_f32_16x16x32_bf16 v[36:39], v[124:127], v[72:75], v[36:39]
  v_mfma_f32_16x16x32_bf16 v[40:43], v[140:143], v[72:75], v[40:43]
  s_cbranch_vccz SL_x_01_ok0
  s_branch SL_x_01_x0
SL_x_013_c0:
  v_max3_u32 v31, v64, v65, v66
  v_max_u32 v31, v31, v67
  v_cmp_eq_u32 vcc, -1, v31
  s_cbranch_vccz SL_x_013_ok0
SL_x_013_x0:
  s_mov_b64 exec, vcc
  buffer_load_dwordx4 v[64:67], v9, s[4:7], s41 offen offset:0 sc1
  s_mov_b64 exec, -1
SL_x_013_c1:
  v_max3_u32 v31, v68, v69, v70
  v_max_u32 v31, v31, v71
  v_cmp_eq_u32 vcc, -1, v31
  s_cbranch_vccz SL_x_013_ok1
SL_x_013_x1:
  s_mov_b64 exec, vcc
  buffer_load_dwordx4 v[68:71], v9, s[4:7], s41 offen offset:1024 sc1
  s_mov_b64 exec, -1
SL_x_013_c3:
  v_max3_u32 v31, v76, v77, v78
  v_max_u32 v31, v31, v79
  v_cmp_eq_u32 vcc, -1, v31
  s_cbranch_vccz SL_x_013_ok3
SL_x_013_x3:
  s_mov_b64 exec, vcc
  buffer_load_dwordx4 v[76:79], v9, s[4:7], s41 offen offset:3072 sc1
  s_mov_b64 exec, -1
  s_add_u32 s46, s46, 1
  s_cmp_ge_u32 s46, 131072
  s_cbranch_scc1 SL_rec_abort
  s_waitcnt vmcnt(4)
  s_branch SL_x_013_c0
SL_x_013_ok0:
  v_mfma_f32_16x16x32_bf16 v[44:47], v[64:67], v[64:67], v[44:47]
  v_max3_u32 v31, v68, v69, v70
  v_max_u32 v31, v31, v71
  v_cmp_eq_u32 vcc, -1, v31
  v_mfma_f32_16x16x32_bf16 v[36:39], v[116:119], v[64:67], v[36:39]
  v_mfma_f32_16x16x32_bf16 v[40:43], v[132:135], v[64:67], v[40:43]
  s_cbranch_vccz SL_x_13_ok1
  s_branch SL_x_13_x1
SL_x_013_ok1:
  v_mfma_f32_16x16x32_bf16 v[44:47], v[68:71], v[68:71], v[44:47]
  v_max3_u32 v31, v76, v77, v78
  v_max_u32 v31, v31, v79
  v_cmp_eq_u32 vcc, -1, v31
  v_mfma_f32_16x16x32_bf16 v[36:39], v[120:123], v[68:71], v[36:39]
  v_mfma_f32_16x16x32_bf16 v[40:43], v[136:139], v[68:71], v[40:43]
  s_cbranch_vccz SL_x_03_ok3
  s_branch SL_x_03_x3
SL_x_013_ok3:
  v_mfma_f32_16x16x32_bf16 v[44:47], v[76:79], v[76:79], v[44:47]
  v_max3_u32 v31, v64, v65, v66
  v_max_u32 v31, v31, v67
  v_cmp_eq_u32 vcc, -1, v31
  v_mfma_f32_16x16x32_bf16 v[36:39], v[128:131], v[76:79], v[36:39]
  v_mfma_f32_16x16x32_bf16 v[40:43], v[144:147], v[76:79], v[40:43]
  s_cbranch_vccz SL_x_01_ok0
  s_branch SL_x_01_x0
SL_x_023_c0:
  v_max3_u32 v31, v64, v65, v66
  v_max_u32 v31, v31, v67
  v_cmp_eq_u32 vcc, -1, v31
  s_cbranch_vccz SL_x_023_ok0
SL_x_023_x0:
  s_mov_b64 exec, vcc
  buffer_load_dwordx4 v[64:67], v9, s[4:7], s41 offen offset:0 sc1
  s_mov_b64 exec, -1
SL_x_023_c2:
  v_max3_u32 v31, v72, v73, v74
  v_max_u32 v31, v31, v75
  v_cmp_eq_u32 vcc, -1, v31
  s_cbranch_vccz SL_x_023_ok2
SL_x_023_x2:
  s_mov_b64 exec, vcc
  buffer_load_dwordx4 v[72:75], v9, s[4:7], s41 offen offset:2048 sc1
  s_mov_b64 exec, -1
SL_x_023_c3:
  v_max3_u32 v31, v76, v77, v78
  v_max_u32 v31, v31, v79
  v_cmp_eq_u32 vcc, -1, v31
  s_cbranch_vccz SL_x_023_ok3
SL_x_023_x3:
  s_mov_b64 exec, vcc
  buffer_load_dwordx4 v[76:79], v9, s[4:7], s41 offen offset:3072 sc1
  s_mov_b64 exec, -1
  s_add_u32 s46, s46, 1
  s_cmp_ge_u32 s46, 131072
  s_cbranch_scc1 SL_rec_abort
  s_waitcnt vmcnt(4)
  s_branch SL_x_023_c0
SL_x_023_ok0:
  v_mfma_f32_16x16x32_bf16 v[44:47], v[64:67], v[64:67], v[44:47]
  v_max3_u32 v31, v72, v73, v74
  v_max_u32 v31, v31, v75
  v_cmp_eq_u32 vcc, -1, v31
  v_mfma_f32_16x16x32_bf16 v[36:39], v[116:119], v[64:67], v[36:39]
  v_mfma_f32_16x16x32_bf16 v[40:43], v[132:135], v[64:67], v[40:43]
  s_cbranch_vccz SL_x_23_ok2
  s_branch SL_x_23_x2
SL_x_023_ok2:
  v_mfma_f32_16x16x32_bf16 v[44:47], v[72:75], v[72:75], v[44:47]
  v_max3_u32 v31, v76, v77, v78
  v_max_u32 v31, v31, v79
  v_cmp_eq_u32 vcc, -1, v31
  v_mfma_f32_16x16x32_bf16 v[36:39], v[124:127], v[72:75], v[36:39]
  v_mfma_f32_16x16x32_bf16 v[40:43], v[140:143], v[72:75], v[40:43]
  s_cbranch_vccz SL_x_03_ok3
  s_branch SL_x_03_x3
SL_x_023_ok3:
  v_mfma_f32_16x16x32_bf16 v[44:47], v[76:79], v[76:79], v[44:47]
  v_max3_u32 v31, v64, v65, v66
  v_max_u32 v31, v31, v67
  v_cmp_eq_u32 vcc, -1, v31
  v_mfma_f32_16x16x32_bf16 v[36:39], v[128:131], v[76:79], v[36:39]
  v_mfma_f32_16x16x32_bf16 v[40:43], v[144:147], v[76:79], v[40:43]
  s_cbranch_vccz SL_x_02_ok0
  s_branch SL_x_02_x0
SL_x_123_c1:
  v_max3_u32 v31, v68, v69, v70
  v_max_u32 v31, v31, v71
  v_cmp_eq_u32 vcc, -1, v31
  s_cbranch_vccz SL_x_123_ok1
SL_x_123_x1:
  s_mov_b64 exec, vcc
  buffer_load_dwordx4 v[68:71], v9, s[4:7], s41 offen offset:1024 sc1
  s_mov_b64 exec, -1
SL_x_123_c2:
  v_max3_u32 v31, v72, v73, v74
  v_max_u32 v31, v31, v75
  v_cmp_eq_u32 vcc, -1, v31
  s_cbranch_vccz SL_x_123_ok2
SL_x_123_x2:
  s_mov_b64 exec, vcc
  buffer_load_dwordx4 v[72:75], v9, s[4:7], s41 offen offset:2048 sc1
  s_mov_b64 exec, -1
SL_x_123_c3:
  v_max3_u32 v31, v76, v77, v78
  v_max_u32 v31, v31, v79
  v_cmp_eq_u32 vcc, -1, v31
  s_cbranch_vccz SL_x_123_ok3
SL_x_123_x3:
  s_mov_b64 exec, vcc
  buffer_load_dwordx4 v[76:79], v9, s[4:7], s41 offen offset:3072 sc1
  s_mov_b64 exec, -1
  s_add_u32 s46, s46, 1
  s_cmp_ge_u32 s46, 131072
  s_cbranch_scc1 SL_rec_abort
  s_waitcnt vmcnt(4)
  s_branch SL_x_123_c1
SL_x_123_ok1:
  v_mfma_f32_16x16x32_bf16 v[44:47], v[68:71], v[68:71], v[44:47]
  v_max3_u32 v31, v72, v73, v74
  v_max_u32 v31, v31, v75
  v_cmp_eq_u32 vcc, -1, v31
  v_mfma_f32_16x16x32_bf16 v[36:39], v[120:123], v[68:71], v[36:39]
  v_mfma_f32_16x16x32_bf16 v[40:43], v[136:139], v[68:71], v[40:43]
  s_cbranch_vccz SL_x_23_ok2
  s_branch SL_x_23_x2
SL_x_123_ok2:
  v_mfma_f32_16x16x32_bf16 v[44:47], v[72:75], v[72:75], v[44:47]
  v_max3_u32 v31, v76, v77, v78
  v_max_u32 v31, v31, v79
  v_cmp_eq_u32 vcc, -1, v31
  v_mfma_f32_16x16x32_bf16 v[36:39], v[124:127], v[72:75], v[36:39]
  v_mfma_f32_16x16x32_bf16 v[40:43], v[140:143], v[72:75], v[40:43]
  s_cbranch_vccz SL_x_13_ok3
  s_branch SL_x_13_x3
SL_x_123_ok3:
  v_mfma_f32_16x16x32_bf16 v[44:47], v[76:79], v[76:79], v[44:47]
  v_max3_u32 v31, v68, v69, v70
  v_max_u32 v31, v31, v71
  v_cmp_eq_u32 vcc, -1, v31
  v_mfma_f32_16x16x32_bf16 v[36:39], v[128:131], v[76:79], v[36:39]
  v_mfma_f32_16x16x32_bf16 v[40:43], v[144:147], v[76:79], v[40:43]
  s_cbranch_vccz SL_x_12_ok1
  s_branch SL_x_12_x1
SL_x_0123_c0:
  v_max3_u32 v31, v64, v65, v66
  v_max_u32 v31, v31, v67
  v_cmp_eq_u32 vcc, -1, v31
  s_cbranch_vccz SL_x_0123_ok0
SL_x_0123_x0:
  s_mov_b64 exec, vcc
  buffer_load_dwordx4 v[64:67], v9, s[4:7], s41 offen offset:0 sc1
  s_mov_b64 exec, -1
SL_x_0123_c1:
  v_max3_u32 v31, v68, v69, v70
  v_max_u32 v31, v31, v71
  v_cmp_eq_u32 vcc, -1, v31
  s_cbranch_vccz SL_x_0123_ok1
SL_x_0123_x1:
  s_mov_b64 exec, vcc
  buffer_load_dwordx4 v[68:71], v9, s[4:7], s41 offen offset:1024 sc1
  s_mov_b64 exec, -1
SL_x_0123_c2:
  v_max3_u32 v31, v72, v73, v74
  v_max_u32 v31, v31, v75
  v_cmp_eq_u32 vcc, -1, v31
  s_cbranch_vccz SL_x_0123_ok2
SL_x_0123_x2:
  s_mov_b64 exec, vcc
  buffer_load_dwordx4 v[72:75], v9, s[4:7], s41 offen offset:2048 sc1
  s_mov_b64 exec, -1
SL_x_0123_c3:
  v_max3_u32 v31, v76, v77, v78
  v_max_u32 v31, v31, v79
  v_cmp_eq_u32 vcc, -1, v31
  s_cbranch_vccz SL_x_0123_ok3
SL_x_0123_x3:
  s_mov_b64 exec, vcc
  buffer_load_dwordx4 v[76:79], v9, s[4:7], s41 offen offset:3072 sc1
  s_mov_b64 exec, -1
  s_add_u32 s46, s46, 1
  s_cmp_ge_u32 s46, 131072
  s_cbranch_scc1 SL_rec_abort
  s_waitcnt vmcnt(4)
  s_branch SL_x_0123_c0
SL_x_0123_ok0:
  v_mfma_f32_16x16x32_bf16 v[44:47], v[64:67], v[64:67], v[44:47]
  v_max3_u32 v31, v68, v69, v70
  v_max_u32 v31, v31, v71
  v_cmp_eq_u32 vcc, -1, v31
  v_mfma_f32_16x16x32_bf16 v[36:39], v[116:119], v[64:67], v[36:39]
  v_mfma_f32_16x16x32_bf16 v[40:43], v[132:135], v[64:67], v[40:43]
  s_cbranch_vccz SL_x_123_ok1
  s_branch SL_x_123_x1
SL_x_0123_ok1:
  v_mfma_f32_16x16x32_bf16 v[44:47], v[68:71], v[68:71], v[44:47]
  v_max3_u32 v31, v72, v73, v74
  v_max_u32 v31, v31, v75
  v_cmp_eq_u32 vcc, -1, v31
  v_mfma_f32_16x16x32_bf16 v[36:39], v[120:123], v[68:71], v[36:39]
  v_mfma_f32_16x16x32_bf16 v[40:43], v[136:139], v[68:71], v[40:43]
  s_cbranch_vccz SL_x_023_ok2
  s_branch SL_x_023_x2
SL_x_0123_ok2:
  v_mfma_f32_16x16x32_bf16 v[44:47], v[72:75], v[72:75], v[44:47]
  v_max3_u32 v31, v76, v77, v78
  v_max_u32 v31, v31, v79
  v_cmp_eq_u32 vcc, -1, v31
  v_mfma_f32_16x16x32_bf16 v[36:39], v[124:127], v[72:75], v[36:39]
  v_mfma_f32_16x16x32_bf16 v[40:43], v[140:143], v[72:75], v[40:43]
  s_cbranch_vccz SL_x_013_ok3
  s_branch SL_x_013_x3
SL_x_0123_ok3:
  v_mfma_f32_16x16x32_bf16 v[44:47], v[76:79], v[76:79], v[44:47]
  v_max3_u32 v31, v64, v65, v66
  v_max_u32 v31, v31, v67
  v_cmp_eq_u32 vcc, -1, v31
  v_mfma_f32_16x16x32_bf16 v[36:39], v[128:131], v[76:79], v[36:39]
  v_mfma_f32_16x16x32_bf16 v[40:43], v[144:147], v[76:79], v[40:43]
  s_cbranch_vccz SL_x_012_ok0
  s_branch SL_x_012_x0
SL_v_f:
  buffer_load_dwordx4 v[88:91], v10, s[4:7], s41 offen offset:0 sc1
  buffer_load_dwordx4 v[92:95], v10, s[4:7], s41 offen offset:1024 sc1
  s_add_u32 s46, s46, 1
  s_cmp_ge_u32 s46, 131072
  s_cbranch_scc1 SL_rec_abort
  s_waitcnt vmcnt(0)
  v_max3_u32 v31, v88, v89, v90
  v_max3_u32 v31, v31, v91, v92
  v_max3_u32 v31, v31, v93, v94
  v_max_u32 v31, v31, v95
  v_cmp_eq_u32 vcc, -1, v31
  s_cbranch_vccnz SL_v_f
  s_branch SL_v_ok
SL_rec_abort:
  s_waitcnt vmcnt(0)
  s_endpgm
L_join:
  s_load_dwordx16 s[64:79], s[0:1], 0
  v_mbcnt_lo_u32_b32 v0, -1, 0
  v_mbcnt_hi_u32_b32 v0, -1, v0
  s_lshl_b32 s90, s32, 6
  v_add_u32 v0, s90, v0
  s_lshl_b32 s40, s33, 5
  s_add_u32 s40, s40, 128
  s_mov_b32 s39, 1
  s_barrier
  s_branch L_worker1
L_worker:
  s_mov_b32 s39, 0
L_worker1:
  s_load_dwordx4 s[80:83], s[0:1], 64
  s_load_dwordx2 s[84:85], s[0:1], 80
  s_sub_u32 s33, s40, 128
  s_lshr_b32 s33, s33, 5
  s_and_b32 s34, s40, 31
  s_getpc_b64 s[86:87]
L_pc:
  s_add_u32 s86, s86, L_table-L_pc
  s_addc_u32 s87, s87, 0
  s_waitcnt lgkmcnt(0)
  s_mov_b32 s16, s84
  s_and_b32 s17, s85, 0xffff
  s_mov_b32 s18, 0x800000
  s_mov_b32 s19, 0x20000
  s_mov_b32 s8, s64
  s_and_b32 s9, s65, 0xffff
  s_mov_b32 s10, 0x400000
  s_mov_b32 s11, 0x20000
  s_mov_b32 s12, s70
  s_and_b32 s13, s71, 0xffff
  s_mov_b32 s14, 0x800000
  s_mov_b32 s15, 0x20000
  v_mov_b32 v1, 0
  v_mov_b32 v2, 0
  v_mov_b32 v3, 0
  v_mov_b32 v4, 0
  v_mov_b32 v5, 0
  v_mov_b32 v6, 0
  v_mov_b32 v7, 0
  v_mov_b32 v8, 0
  v_mov_b32 v9, 0
  v_mov_b32 v10, 0
  v_mov_b32 v11, 0
  v_mov_b32 v12, 0
  v_mov_b32 v13, 0
  v_mov_b32 v14, 0
  v_mov_b32 v15, 0
  v_mov_b32 v16, 0
  v_mov_b32 v17, 0
  v_mov_b32 v172, 0
  v_mov_b32 v173, 0
  s_mov_b32 s59, 0
  s_cmp_eq_u32 s39, 0
  s_cbranch_scc1 L_have
L_next:
  s_cmp_lg_u32 s32, 0
  s_cbranch_scc1 L_rq_1
  s_cmp_eq_u32 s39, 0
  s_cbranch_scc1 L_rq_1
  s_lshl_b32 s99, s33, 7
  s_add_u32 s99, s99, 0x3d00200
  v_mov_b32 v244, 1
  v_mov_b32 v245, 0
  s_mov_b64 exec, 1
  buffer_atomic_add v244, v245, s[4:7], s99 offen sc0 sc1
  s_mov_b64 exec, -1
L_rq_1:
  s_waitcnt vmcnt(0)
L_got:
  s_cmp_lg_u32 s32, 0
  s_cbranch_scc1 L_nx1
  v_mov_b32 v245, 131072
  s_mov_b64 exec, 1
  ds_write_b32 v245, v244
  s_mov_b64 exec, -1
  s_waitcnt lgkmcnt(0)
L_nx1:
  s_barrier
  v_mov_b32 v245, 131072
  ds_read_b32 v246, v245
  s_waitcnt lgkmcnt(0)
  v_min_u32 v245, 290, v246
  v_lshlrev_b32 v245, 2, v245
  v_add_u32 v245, 131264, v245
  ds_read_b32 v245, v245
  v_readfirstlane_b32 s34, v246
  s_add_u32 s34, s34, 32
  s_waitcnt lgkmcnt(0)
  v_readfirstlane_b32 s91, v245
  s_branch L_have1
L_have:
  s_lshl_b32 s90, s34, 2
  s_load_dword s91, s[86:87], s90
  s_waitcnt lgkmcnt(0)
L_have1:
  s_mov_b32 s98, 1
  s_and_b32 s35, s91, 255
  s_lshr_b32 s36, s91, 8
  s_and_b32 s36, s36, 255
  s_lshr_b32 s37, s91, 16
  s_cmp_eq_u32 s35, 0
  s_cbranch_scc1 L_aqkv
  s_cmp_eq_u32 s35, 1
  s_cbranch_scc1 L_aqkv
  s_cmp_eq_u32 s35, 2
  s_cbranch_scc1 L_aqkv
  s_cmp_eq_u32 s35, 3
  s_cbranch_scc1 L_bqkv
  s_cmp_eq_u32 s35, 9
  s_cbranch_scc1 L_small
  s_cmp_eq_u32 s35, 10
  s_cbranch_scc1 L_small
  s_mov_b32 s58, 0
L_epi:
  s_mov_b32 s46, 0x40000000
  s_mov_b32 s47, 0x40000000
  s_mov_b32 s49, 0
  s_cmp_eq_u32 s58, 1
  s_cselect_b64 vcc, -1, 0
  s_cmp_eq_u32 s59, 0
  s_cbranch_scc1 L_epid
  s_cmp_lg_u32 s59, 1
  s_cbranch_scc1 L_e0
  s_lshr_b32 s90, s27, 1
  s_and_b32 s91, s27, 1
  v_mov_b32 v172, 0x0
  v_bfe_u32 v45, v1, 0, 6
  v_lshl_add_u32 v172, v45, 4, v172
  v_add_u32 v173, 4096, v172
  s_mul_i32 s92, s90, 4
  s_mul_i32 s92, s92, s61
  s_add_u32 s92, s92, s60
  s_mul_i32 s93, s91, 8192
  s_add_u32 s92, s92, s93
  v_accvgpr_read_b32 v52, a0
  v_accvgpr_read_b32 v53, a4
  v_accvgpr_read_b32 v54, a1
  v_accvgpr_read_b32 v55, a5
  v_accvgpr_read_b32 v56, a2
  v_accvgpr_read_b32 v57, a6
  v_accvgpr_read_b32 v58, a3
  v_accvgpr_read_b32 v59, a7
  v_cvt_pk_bf16_f32 v48, v52, v53
  v_cvt_pk_bf16_f32 v49, v54, v55
  v_cvt_pk_bf16_f32 v50, v56, v57
  v_cvt_pk_bf16_f32 v51, v58, v59
  buffer_store_dwordx4 v[48:51], v172, s[4:7], s92 offen offset:0 sc1
  v_accvgpr_read_b32 v64, a128
  v_accvgpr_read_b32 v65, a132
  v_accvgpr_read_b32 v66, a129
  v_accvgpr_read_b32 v67, a133
  v_accvgpr_read_b32 v68, a130
  v_accvgpr_read_b32 v69, a134
  v_accvgpr_read_b32 v70, a131
  v_accvgpr_read_b32 v71, a135
  v_cvt_pk_bf16_f32 v176, v64, v65
  v_cvt_pk_bf16_f32 v177, v66, v67
  v_cvt_pk_bf16_f32 v178, v68, v69
  v_cvt_pk_bf16_f32 v179, v70, v71
  v_accvgpr_read_b32 v76, a8
  v_accvgpr_read_b32 v77, a12
  v_accvgpr_read_b32 v78, a9
  v_accvgpr_read_b32 v79, a13
  v_accvgpr_read_b32 v80, a10
  v_accvgpr_read_b32 v81, a14
  v_accvgpr_read_b32 v82, a11
  v_accvgpr_read_b32 v83, a15
  v_cvt_pk_bf16_f32 v72, v76, v77
  v_cvt_pk_bf16_f32 v73, v78, v79
  v_cvt_pk_bf16_f32 v74, v80, v81
  v_cvt_pk_bf16_f32 v75, v82, v83
  buffer_store_dwordx4 v[72:75], v172, s[4:7], s92 offen offset:1024 sc1
  v_accvgpr_read_b32 v88, a136
  v_accvgpr_read_b32 v89, a140
  v_accvgpr_read_b32 v90, a137
  v_accvgpr_read_b32 v91, a141
  v_accvgpr_read_b32 v92, a138
  v_accvgpr_read_b32 v93, a142
  v_accvgpr_read_b32 v94, a139
  v_accvgpr_read_b32 v95, a143
  v_cvt_pk_bf16_f32 v180, v88, v89
  v_cvt_pk_bf16_f32 v181, v90, v91
  v_cvt_pk_bf16_f32 v182, v92, v93
  v_cvt_pk_bf16_f32 v183, v94, v95
  v_accvgpr_read_b32 v52, a16
  v_accvgpr_read_b32 v53, a20
  v_accvgpr_read_b32 v54, a17
  v_accvgpr_read_b32 v55, a21
  v_accvgpr_read_b32 v56, a18
  v_accvgpr_read_b32 v57, a22
  v_accvgpr_read_b32 v58, a19
  v_accvgpr_read_b32 v59, a23
  v_cvt_pk_bf16_f32 v48, v52, v53
  v_cvt_pk_bf16_f32 v49, v54, v55
  v_cvt_pk_bf16_f32 v50, v56, v57
  v_cvt_pk_bf16_f32 v51, v58, v59
  buffer_store_dwordx4 v[48:51], v172, s[4:7], s92 offen offset:2048 sc1
  v_accvgpr_read_b32 v64, a144
  v_accvgpr_read_b32 v65, a148
  v_accvgpr_read_b32 v66, a145
  v_accvgpr_read_b32 v67, a149
  v_accvgpr_read_b32 v68, a146
  v_accvgpr_read_b32 v69, a150
  v_accvgpr_read_b32 v70, a147
  v_accvgpr_read_b32 v71, a151
  v_cvt_pk_bf16_f32 v184, v64, v65
  v_cvt_pk_bf16_f32 v185, v66, v67
  v_cvt_pk_bf16_f32 v186, v68, v69
  v_cvt_pk_bf16_f32 v187, v70, v71
  v_accvgpr_read_b32 v76, a24
  v_accvgpr_read_b32 v77, a28
  v_accvgpr_read_b32 v78, a25
  v_accvgpr_read_b32 v79, a29
  v_accvgpr_read_b32 v80, a26
  v_accvgpr_read_b32 v81, a30
  v_accvgpr_read_b32 v82, a27
  v_accvgpr_read_b32 v83, a31
  v_cvt_pk_bf16_f32 v72, v76, v77
  v_cvt_pk_bf16_f32 v73, v78, v79
  v_cvt_pk_bf16_f32 v74, v80, v81
  v_cvt_pk_bf16_f32 v75, v82, v83
  buffer_store_dwordx4 v[72:75], v172, s[4:7], s92 offen offset:3072 sc1
  v_accvgpr_read_b32 v88, a152
  v_accvgpr_read_b32 v89, a156
  v_accvgpr_read_b32 v90, a153
  v_accvgpr_read_b32 v91, a157
  v_accvgpr_read_b32 v92, a154
  v_accvgpr_read_b32 v93, a158
  v_accvgpr_read_b32 v94, a155
  v_accvgpr_read_b32 v95, a159
  v_cvt_pk_bf16_f32 v188, v88, v89
  v_cvt_pk_bf16_f32 v189, v90, v91
  v_cvt_pk_bf16_f32 v190, v92, v93
  v_cvt_pk_bf16_f32 v191, v94, v95
  v_accvgpr_read_b32 v52, a32
  v_accvgpr_read_b32 v53, a36
  v_accvgpr_read_b32 v54, a33
  v_accvgpr_read_b32 v55, a37
  v_accvgpr_read_b32 v56, a34
  v_accvgpr_read_b32 v57, a38
  v_accvgpr_read_b32 v58, a35
  v_accvgpr_read_b32 v59, a39
  v_cvt_pk_bf16_f32 v48, v52, v53
  v_cvt_pk_bf16_f32 v49, v54, v55
  v_cvt_pk_bf16_f32 v50, v56, v57
  v_cvt_pk_bf16_f32 v51, v58, v59
  buffer_store_dwordx4 v[48:51], v173, s[4:7], s92 offen offset:0 sc1
  v_accvgpr_read_b32 v64, a160
  v_accvgpr_read_b32 v65, a164
  v_accvgpr_read_b32 v66, a161
  v_accvgpr_read_b32 v67, a165
  v_accvgpr_read_b32 v68, a162
  v_accvgpr_read_b32 v69, a166
  v_accvgpr_read_b32 v70, a163
  v_accvgpr_read_b32 v71, a167
  v_cvt_pk_bf16_f32 v192, v64, v65
  v_cvt_pk_bf16_f32 v193, v66, v67
  v_cvt_pk_bf16_f32 v194, v68, v69
  v_cvt_pk_bf16_f32 v195, v70, v71
  v_accvgpr_read_b32 v76, a40
  v_accvgpr_read_b32 v77, a44
  v_accvgpr_read_b32 v78, a41
  v_accvgpr_read_b32 v79, a45
  v_accvgpr_read_b32 v80, a42
  v_accvgpr_read_b32 v81, a46
  v_accvgpr_read_b32 v82, a43
  v_accvgpr_read_b32 v83, a47
  v_cvt_pk_bf16_f32 v72, v76, v77
  v_cvt_pk_bf16_f32 v73, v78, v79
  v_cvt_pk_bf16_f32 v74, v80, v81
  v_cvt_pk_bf16_f32 v75, v82, v83
  buffer_store_dwordx4 v[72:75], v173, s[4:7], s92 offen offset:1024 sc1
  v_accvgpr_read_b32 v88, a168
  v_accvgpr_read_b32 v89, a172
  v_accvgpr_read_b32 v90, a169
  v_accvgpr_read_b32 v91, a173
  v_accvgpr_read_b32 v92, a170
  v_accvgpr_read_b32 v93, a174
  v_accvgpr_read_b32 v94, a171
  v_accvgpr_read_b32 v95, a175
  v_cvt_pk_bf16_f32 v196, v88, v89
  v_cvt_pk_bf16_f32 v197, v90, v91
  v_cvt_pk_bf16_f32 v198, v92, v93
  v_cvt_pk_bf16_f32 v199, v94, v95
  v_accvgpr_read_b32 v52, a48
  v_accvgpr_read_b32 v53, a52
  v_accvgpr_read_b32 v54, a49
  v_accvgpr_read_b32 v55, a53
  v_accvgpr_read_b32 v56, a50
  v_accvgpr_read_b32 v57, a54
  v_accvgpr_read_b32 v58, a51
  v_accvgpr_read_b32 v59, a55
  v_cvt_pk_bf16_f32 v48, v52, v53
  v_cvt_pk_bf16_f32 v49, v54, v55
  v_cvt_pk_bf16_f32 v50, v56, v57
  v_cvt_pk_bf16_f32 v51, v58, v59
  buffer_store_dwordx4 v[48:51], v173, s[4:7], s92 offen offset:2048 sc1
  v_accvgpr_read_b32 v64, a176
  v_accvgpr_read_b32 v65, a180
  v_accvgpr_read_b32 v66, a177
  v_accvgpr_read_b32 v67, a181
  v_accvgpr_read_b32 v68, a178
  v_accvgpr_read_b32 v69, a182
  v_accvgpr_read_b32 v70, a179
  v_accvgpr_read_b32 v71, a183
  v_cvt_pk_bf16_f32 v200, v64, v65
  v_cvt_pk_bf16_f32 v201, v66, v67
  v_cvt_pk_bf16_f32 v202, v68, v69
  v_cvt_pk_bf16_f32 v203, v70, v71
  v_accvgpr_read_b32 v76, a56
  v_accvgpr_read_b32 v77, a60
  v_accvgpr_read_b32 v78, a57
  v_accvgpr_read_b32 v79, a61
  v_accvgpr_read_b32 v80, a58
  v_accvgpr_read_b32 v81, a62
  v_accvgpr_read_b32 v82, a59
  v_accvgpr_read_b32 v83, a63
  v_cvt_pk_bf16_f32 v72, v76, v77
  v_cvt_pk_bf16_f32 v73, v78, v79
  v_cvt_pk_bf16_f32 v74, v80, v81
  v_cvt_pk_bf16_f32 v75, v82, v83
  buffer_store_dwordx4 v[72:75], v173, s[4:7], s92 offen offset:3072 sc1
  v_accvgpr_read_b32 v88, a184
  v_accvgpr_read_b32 v89, a188
  v_accvgpr_read_b32 v90, a185
  v_accvgpr_read_b32 v91, a189
  v_accvgpr_read_b32 v92, a186
  v_accvgpr_read_b32 v93, a190
  v_accvgpr_read_b32 v94, a187
  v_accvgpr_read_b32 v95, a191
  v_cvt_pk_bf16_f32 v204, v88, v89
  v_cvt_pk_bf16_f32 v205, v90, v91
  v_cvt_pk_bf16_f32 v206, v92, v93
  v_cvt_pk_bf16_f32 v207, v94, v95
  s_add_u32 s92, s92, s61
  v_accvgpr_read_b32 v52, a64
  v_accvgpr_read_b32 v53, a68
  v_accvgpr_read_b32 v54, a65
  v_accvgpr_read_b32 v55, a69
  v_accvgpr_read_b32 v56, a66
  v_accvgpr_read_b32 v57, a70
  v_accvgpr_read_b32 v58, a67
  v_accvgpr_read_b32 v59, a71
  v_cvt_pk_bf16_f32 v48, v52, v53
  v_cvt_pk_bf16_f32 v49, v54, v55
  v_cvt_pk_bf16_f32 v50, v56, v57
  v_cvt_pk_bf16_f32 v51, v58, v59
  buffer_store_dwordx4 v[48:51], v172, s[4:7], s92 offen offset:0 sc1
  v_accvgpr_read_b32 v64, a192
  v_accvgpr_read_b32 v65, a196
  v_accvgpr_read_b32 v66, a193
  v_accvgpr_read_b32 v67, a197
  v_accvgpr_read_b32 v68, a194
  v_accvgpr_read_b32 v69, a198
  v_accvgpr_read_b32 v70, a195
  v_accvgpr_read_b32 v71, a199
  v_cvt_pk_bf16_f32 v208, v64, v65
  v_cvt_pk_bf16_f32 v209, v66, v67
  v_cvt_pk_bf16_f32 v210, v68, v69
  v_cvt_pk_bf16_f32 v211, v70, v71
  v_accvgpr_read_b32 v76, a72
  v_accvgpr_read_b32 v77, a76
  v_accvgpr_read_b32 v78, a73
  v_accvgpr_read_b32 v79, a77
  v_accvgpr_read_b32 v80, a74
  v_accvgpr_read_b32 v81, a78
  v_accvgpr_read_b32 v82, a75
  v_accvgpr_read_b32 v83, a79
  v_cvt_pk_bf16_f32 v72, v76, v77
  v_cvt_pk_bf16_f32 v73, v78, v79
  v_cvt_pk_bf16_f32 v74, v80, v81
  v_cvt_pk_bf16_f32 v75, v82, v83
  buffer_store_dwordx4 v[72:75], v172, s[4:7], s92 offen offset:1024 sc1
  v_accvgpr_read_b32 v88, a200
  v_accvgpr_read_b32 v89, a204
  v_accvgpr_read_b32 v90, a201
  v_accvgpr_read_b32 v91, a205
  v_accvgpr_read_b32 v92, a202
  v_accvgpr_read_b32 v93, a206
  v_accvgpr_read_b32 v94, a203
  v_accvgpr_read_b32 v95, a207
  v_cvt_pk_bf16_f32 v212, v88, v89
  v_cvt_pk_bf16_f32 v213, v90, v91
  v_cvt_pk_bf16_f32 v214, v92, v93
  v_cvt_pk_bf16_f32 v215, v94, v95
  v_accvgpr_read_b32 v52, a80
  v_accvgpr_read_b32 v53, a84
  v_accvgpr_read_b32 v54, a81
  v_accvgpr_read_b32 v55, a85
  v_accvgpr_read_b32 v56, a82
  v_accvgpr_read_b32 v57, a86
  v_accvgpr_read_b32 v58, a83
  v_accvgpr_read_b32 v59, a87
  v_cvt_pk_bf16_f32 v48, v52, v53
  v_cvt_pk_bf16_f32 v49, v54, v55
  v_cvt_pk_bf16_f32 v50, v56, v57
  v_cvt_pk_bf16_f32 v51, v58, v59
  buffer_store_dwordx4 v[48:51], v172, s[4:7], s92 offen offset:2048 sc1
  v_accvgpr_read_b32 v64, a208
  v_accvgpr_read_b32 v65, a212
  v_accvgpr_read_b32 v66, a209
  v_accvgpr_read_b32 v67, a213
  v_accvgpr_read_b32 v68, a210
  v_accvgpr_read_b32 v69, a214
  v_accvgpr_read_b32 v70, a211
  v_accvgpr_read_b32 v71, a215
  v_cvt_pk_bf16_f32 v216, v64, v65
  v_cvt_pk_bf16_f32 v217, v66, v67
  v_cvt_pk_bf16_f32 v218, v68, v69
  v_cvt_pk_bf16_f32 v219, v70, v71
  v_accvgpr_read_b32 v76, a88
  v_accvgpr_read_b32 v77, a92
  v_accvgpr_read_b32 v78, a89
  v_accvgpr_read_b32 v79, a93
  v_accvgpr_read_b32 v80, a90
  v_accvgpr_read_b32 v81, a94
  v_accvgpr_read_b32 v82, a91
  v_accvgpr_read_b32 v83, a95
  v_cvt_pk_bf16_f32 v72, v76, v77
  v_cvt_pk_bf16_f32 v73, v78, v79
  v_cvt_pk_bf16_f32 v74, v80, v81
  v_cvt_pk_bf16_f32 v75, v82, v83
  buffer_store_dwordx4 v[72:75], v172, s[4:7], s92 offen offset:3072 sc1
  v_accvgpr_read_b32 v88, a216
  v_accvgpr_read_b32 v89, a220
  v_accvgpr_read_b32 v90, a217
  v_accvgpr_read_b32 v91, a221
  v_accvgpr_read_b32 v92, a218
  v_accvgpr_read_b32 v93, a222
  v_accvgpr_read_b32 v94, a219
  v_accvgpr_read_b32 v95, a223
  v_cvt_pk_bf16_f32 v220, v88, v89
  v_cvt_pk_bf16_f32 v221, v90, v91
  v_cvt_pk_bf16_f32 v222, v92, v93
  v_cvt_pk_bf16_f32 v223, v94, v95
  v_accvgpr_read_b32 v52, a96
  v_accvgpr_read_b32 v53, a100
  v_accvgpr_read_b32 v54, a97
  v_accvgpr_read_b32 v55, a101
  v_accvgpr_read_b32 v56, a98
  v_accvgpr_read_b32 v57, a102
  v_accvgpr_read_b32 v58, a99
  v_accvgpr_read_b32 v59, a103
  v_cvt_pk_bf16_f32 v48, v52, v53
  v_cvt_pk_bf16_f32 v49, v54, v55
  v_cvt_pk_bf16_f32 v50, v56, v57
  v_cvt_pk_bf16_f32 v51, v58, v59
  buffer_store_dwordx4 v[48:51], v173, s[4:7], s92 offen offset:0 sc1
  v_accvgpr_read_b32 v64, a224
  v_accvgpr_read_b32 v65, a228
  v_accvgpr_read_b32 v66, a225
  v_accvgpr_read_b32 v67, a229
  v_accvgpr_read_b32 v68, a226
  v_accvgpr_read_b32 v69, a230
  v_accvgpr_read_b32 v70, a227
  v_accvgpr_read_b32 v71, a231
  v_cvt_pk_bf16_f32 v224, v64, v65
  v_cvt_pk_bf16_f32 v225, v66, v67
  v_cvt_pk_bf16_f32 v226, v68, v69
  v_cvt_pk_bf16_f32 v227, v70, v71
  v_accvgpr_read_b32 v76, a104
  v_accvgpr_read_b32 v77, a108
  v_accvgpr_read_b32 v78, a105
  v_accvgpr_read_b32 v79, a109
  v_accvgpr_read_b32 v80, a106
  v_accvgpr_read_b32 v81, a110
  v_accvgpr_read_b32 v82, a107
  v_accvgpr_read_b32 v83, a111
  v_cvt_pk_bf16_f32 v72, v76, v77
  v_cvt_pk_bf16_f32 v73, v78, v79
  v_cvt_pk_bf16_f32 v74, v80, v81
  v_cvt_pk_bf16_f32 v75, v82, v83
  buffer_store_dwordx4 v[72:75], v173, s[4:7], s92 offen offset:1024 sc1
  v_accvgpr_read_b32 v88, a232
  v_accvgpr_read_b32 v89, a236
  v_accvgpr_read_b32 v90, a233
  v_accvgpr_read_b32 v91, a237
  v_accvgpr_read_b32 v92, a234
  v_accvgpr_read_b32 v93, a238
  v_accvgpr_read_b32 v94, a235
  v_accvgpr_read_b32 v95, a239
  v_cvt_pk_bf16_f32 v228, v88, v89
  v_cvt_pk_bf16_f32 v229, v90, v91
  v_cvt_pk_bf16_f32 v230, v92, v93
  v_cvt_pk_bf16_f32 v231, v94, v95
  v_accvgpr_read_b32 v52, a112
  v_accvgpr_read_b32 v53, a116
  v_accvgpr_read_b32 v54, a113
  v_accvgpr_read_b32 v55, a117
  v_accvgpr_read_b32 v56, a114
  v_accvgpr_read_b32 v57, a118
  v_accvgpr_read_b32 v58, a115
  v_accvgpr_read_b32 v59, a119
  v_cvt_pk_bf16_f32 v48, v52, v53
  v_cvt_pk_bf16_f32 v49, v54, v55
  v_cvt_pk_bf16_f32 v50, v56, v57
  v_cvt_pk_bf16_f32 v51, v58, v59
  buffer_store_dwordx4 v[48:51], v173, s[4:7], s92 offen offset:2048 sc1
  v_accvgpr_read_b32 v64, a240
  v_accvgpr_read_b32 v65, a244
  v_accvgpr_read_b32 v66, a241
  v_accvgpr_read_b32 v67, a245
  v_accvgpr_read_b32 v68, a242
  v_accvgpr_read_b32 v69, a246
  v_accvgpr_read_b32 v70, a243
  v_accvgpr_read_b32 v71, a247
  v_cvt_pk_bf16_f32 v232, v64, v65
  v_cvt_pk_bf16_f32 v233, v66, v67
  v_cvt_pk_bf16_f32 v234, v68, v69
  v_cvt_pk_bf16_f32 v235, v70, v71
  v_accvgpr_read_b32 v76, a120
  v_accvgpr_read_b32 v77, a124
  v_accvgpr_read_b32 v78, a121
  v_accvgpr_read_b32 v79, a125
  v_accvgpr_read_b32 v80, a122
  v_accvgpr_read_b32 v81, a126
  v_accvgpr_read_b32 v82, a123
  v_accvgpr_read_b32 v83, a127
  v_cvt_pk_bf16_f32 v72, v76, v77
  v_cvt_pk_bf16_f32 v73, v78, v79
  v_cvt_pk_bf16_f32 v74, v80, v81
  v_cvt_pk_bf16_f32 v75, v82, v83
  buffer_store_dwordx4 v[72:75], v173, s[4:7], s92 offen offset:3072 sc1
  v_accvgpr_read_b32 v88, a248
  v_accvgpr_read_b32 v89, a252
  v_accvgpr_read_b32 v90, a249
  v_accvgpr_read_b32 v91, a253
  v_accvgpr_read_b32 v92, a250
  v_accvgpr_read_b32 v93, a254
  v_accvgpr_read_b32 v94, a251
  v_accvgpr_read_b32 v95, a255
  v_cvt_pk_bf16_f32 v236, v88, v89
  v_cvt_pk_bf16_f32 v237, v90, v91
  v_cvt_pk_bf16_f32 v238, v92, v93
  v_cvt_pk_bf16_f32 v239, v94, v95
  s_add_u32 s92, s92, s61
  s_mov_b32 s46, s92
  s_add_u32 s47, s92, s61
  s_branch L_edef
L_e0:
  s_cmp_lg_u32 s59, 2
  s_cbranch_scc1 L_e1
  s_lshr_b32 s90, s27, 1
  s_and_b32 s91, s27, 1
  v_mov_b32 v172, 0x0
  v_bfe_u32 v45, v1, 0, 6
  v_lshl_add_u32 v172, v45, 4, v172
  v_add_u32 v173, 4096, v172
  s_mul_i32 s92, s90, 4
  s_mul_i32 s92, s92, s61
  s_add_u32 s92, s92, s60
  s_mul_i32 s93, s91, 8192
  s_add_u32 s92, s92, s93
  v_accvgpr_read_b32 v52, a0
  v_accvgpr_read_b32 v53, a1
  v_accvgpr_read_b32 v54, a2
  v_accvgpr_read_b32 v55, a3
  v_accvgpr_read_b32 v56, a32
  v_accvgpr_read_b32 v57, a33
  v_accvgpr_read_b32 v58, a34
  v_accvgpr_read_b32 v59, a35
  v_cvt_pk_bf16_f32 v48, v52, v53
  v_cvt_pk_bf16_f32 v49, v54, v55
  v_cvt_pk_bf16_f32 v50, v56, v57
  v_cvt_pk_bf16_f32 v51, v58, v59
  buffer_store_dwordx4 v[48:51], v172, s[4:7], s92 offen offset:0 sc1
  v_accvgpr_read_b32 v64, a128
  v_accvgpr_read_b32 v65, a129
  v_accvgpr_read_b32 v66, a130
  v_accvgpr_read_b32 v67, a131
  v_accvgpr_read_b32 v68, a160
  v_accvgpr_read_b32 v69, a161
  v_accvgpr_read_b32 v70, a162
  v_accvgpr_read_b32 v71, a163
  v_cvt_pk_bf16_f32 v176, v64, v65
  v_cvt_pk_bf16_f32 v177, v66, v67
  v_cvt_pk_bf16_f32 v178, v68, v69
  v_cvt_pk_bf16_f32 v179, v70, v71
  v_accvgpr_read_b32 v76, a4
  v_accvgpr_read_b32 v77, a5
  v_accvgpr_read_b32 v78, a6
  v_accvgpr_read_b32 v79, a7
  v_accvgpr_read_b32 v80, a36
  v_accvgpr_read_b32 v81, a37
  v_accvgpr_read_b32 v82, a38
  v_accvgpr_read_b32 v83, a39
  v_cvt_pk_bf16_f32 v72, v76, v77
  v_cvt_pk_bf16_f32 v73, v78, v79
  v_cvt_pk_bf16_f32 v74, v80, v81
  v_cvt_pk_bf16_f32 v75, v82, v83
  buffer_store_dwordx4 v[72:75], v172, s[4:7], s92 offen offset:1024 sc1
  v_accvgpr_read_b32 v88, a132
  v_accvgpr_read_b32 v89, a133
  v_accvgpr_read_b32 v90, a134
  v_accvgpr_read_b32 v91, a135
  v_accvgpr_read_b32 v92, a164
  v_accvgpr_read_b32 v93, a165
  v_accvgpr_read_b32 v94, a166
  v_accvgpr_read_b32 v95, a167
  v_cvt_pk_bf16_f32 v180, v88, v89
  v_cvt_pk_bf16_f32 v181, v90, v91
  v_cvt_pk_bf16_f32 v182, v92, v93
  v_cvt_pk_bf16_f32 v183, v94, v95
  v_accvgpr_read_b32 v52, a8
  v_accvgpr_read_b32 v53, a9
  v_accvgpr_read_b32 v54, a10
  v_accvgpr_read_b32 v55, a11
  v_accvgpr_read_b32 v56, a40
  v_accvgpr_read_b32 v57, a41
  v_accvgpr_read_b32 v58, a42
  v_accvgpr_read_b32 v59, a43
  v_cvt_pk_bf16_f32 v48, v52, v53
  v_cvt_pk_bf16_f32 v49, v54, v55
  v_cvt_pk_bf16_f32 v50, v56, v57
  v_cvt_pk_bf16_f32 v51, v58, v59
  buffer_store_dwordx4 v[48:51], v172, s[4:7], s92 offen offset:2048 sc1
  v_accvgpr_read_b32 v64, a136
  v_accvgpr_read_b32 v65, a137
  v_accvgpr_read_b32 v66, a138
  v_accvgpr_read_b32 v67, a139
  v_accvgpr_read_b32 v68, a168
  v_accvgpr_read_b32 v69, a169
  v_accvgpr_read_b32 v70, a170
  v_accvgpr_read_b32 v71, a171
  v_cvt_pk_bf16_f32 v184, v64, v65
  v_cvt_pk_bf16_f32 v185, v66, v67
  v_cvt_pk_bf16_f32 v186, v68, v69
  v_cvt_pk_bf16_f32 v187, v70, v71
  v_accvgpr_read_b32 v76, a12
  v_accvgpr_read_b32 v77, a13
  v_accvgpr_read_b32 v78, a14
  v_accvgpr_read_b32 v79, a15
  v_accvgpr_read_b32 v80, a44
  v_accvgpr_read_b32 v81, a45
  v_accvgpr_read_b32 v82, a46
  v_accvgpr_read_b32 v83, a47
  v_cvt_pk_bf16_f32 v72, v76, v77
  v_cvt_pk_bf16_f32 v73, v78, v79
  v_cvt_pk_bf16_f32 v74, v80, v81
  v_cvt_pk_bf16_f32 v75, v82, v83
  buffer_store_dwordx4 v[72:75], v172, s[4:7], s92 offen offset:3072 sc1
  v_accvgpr_read_b32 v88, a140
  v_accvgpr_read_b32 v89, a141
  v_accvgpr_read_b32 v90, a142
  v_accvgpr_read_b32 v91, a143
  v_accvgpr_read_b32 v92, a172
  v_accvgpr_read_b32 v93, a173
  v_accvgpr_read_b32 v94, a174
  v_accvgpr_read_b32 v95, a175
  v_cvt_pk_bf16_f32 v188, v88, v89
  v_cvt_pk_bf16_f32 v189, v90, v91
  v_cvt_pk_bf16_f32 v190, v92, v93
  v_cvt_pk_bf16_f32 v191, v94, v95
  v_accvgpr_read_b32 v52, a16
  v_accvgpr_read_b32 v53, a17
  v_accvgpr_read_b32 v54, a18
  v_accvgpr_read_b32 v55, a19
  v_accvgpr_read_b32 v56, a48
  v_accvgpr_read_b32 v57, a49
  v_accvgpr_read_b32 v58, a50
  v_accvgpr_read_b32 v59, a51
  v_cvt_pk_bf16_f32 v48, v52, v53
  v_cvt_pk_bf16_f32 v49, v54, v55
  v_cvt_pk_bf16_f32 v50, v56, v57
  v_cvt_pk_bf16_f32 v51, v58, v59
  buffer_store_dwordx4 v[48:51], v173, s[4:7], s92 offen offset:0 sc1
  v_accvgpr_read_b32 v64, a144
  v_accvgpr_read_b32 v65, a145
  v_accvgpr_read_b32 v66, a146
  v_accvgpr_read_b32 v67, a147
  v_accvgpr_read_b32 v68, a176
  v_accvgpr_read_b32 v69, a177
  v_accvgpr_read_b32 v70, a178
  v_accvgpr_read_b32 v71, a179
  v_cvt_pk_bf16_f32 v192, v64, v65
  v_cvt_pk_bf16_f32 v193, v66, v67
  v_cvt_pk_bf16_f32 v194, v68, v69
  v_cvt_pk_bf16_f32 v195, v70, v71
  v_accvgpr_read_b32 v76, a20
  v_accvgpr_read_b32 v77, a21
  v_accvgpr_read_b32 v78, a22
  v_accvgpr_read_b32 v79, a23
  v_accvgpr_read_b32 v80, a52
  v_accvgpr_read_b32 v81, a53
  v_accvgpr_read_b32 v82, a54
  v_accvgpr_read_b32 v83, a55
  v_cvt_pk_bf16_f32 v72, v76, v77
  v_cvt_pk_bf16_f32 v73, v78, v79
  v_cvt_pk_bf16_f32 v74, v80, v81
  v_cvt_pk_bf16_f32 v75, v82, v83
  buffer_store_dwordx4 v[72:75], v173, s[4:7], s92 offen offset:1024 sc1
  v_accvgpr_read_b32 v88, a148
  v_accvgpr_read_b32 v89, a149
  v_accvgpr_read_b32 v90, a150
  v_accvgpr_read_b32 v91, a151
  v_accvgpr_read_b32 v92, a180
  v_accvgpr_read_b32 v93, a181
  v_accvgpr_read_b32 v94, a182
  v_accvgpr_read_b32 v95, a183
  v_cvt_pk_bf16_f32 v196, v88, v89
  v_cvt_pk_bf16_f32 v197, v90, v91
  v_cvt_pk_bf16_f32 v198, v92, v93
  v_cvt_pk_bf16_f32 v199, v94, v95
  v_accvgpr_read_b32 v52, a24
  v_accvgpr_read_b32 v53, a25
  v_accvgpr_read_b32 v54, a26
  v_accvgpr_read_b32 v55, a27
  v_accvgpr_read_b32 v56, a56
  v_accvgpr_read_b32 v57, a57
  v_accvgpr_read_b32 v58, a58
  v_accvgpr_read_b32 v59, a59
  v_cvt_pk_bf16_f32 v48, v52, v53
  v_cvt_pk_bf16_f32 v49, v54, v55
  v_cvt_pk_bf16_f32 v50, v56, v57
  v_cvt_pk_bf16_f32 v51, v58, v59
  buffer_store_dwordx4 v[48:51], v173, s[4:7], s92 offen offset:2048 sc1
  v_accvgpr_read_b32 v64, a152
  v_accvgpr_read_b32 v65, a153
  v_accvgpr_read_b32 v66, a154
  v_accvgpr_read_b32 v67, a155
  v_accvgpr_read_b32 v68, a184
  v_accvgpr_read_b32 v69, a185
  v_accvgpr_read_b32 v70, a186
  v_accvgpr_read_b32 v71, a187
  v_cvt_pk_bf16_f32 v200, v64, v65
  v_cvt_pk_bf16_f32 v201, v66, v67
  v_cvt_pk_bf16_f32 v202, v68, v69
  v_cvt_pk_bf16_f32 v203, v70, v71
  v_accvgpr_read_b32 v76, a28
  v_accvgpr_read_b32 v77, a29
  v_accvgpr_read_b32 v78, a30
  v_accvgpr_read_b32 v79, a31
  v_accvgpr_read_b32 v80, a60
  v_accvgpr_read_b32 v81, a61
  v_accvgpr_read_b32 v82, a62
  v_accvgpr_read_b32 v83, a63
  v_cvt_pk_bf16_f32 v72, v76, v77
  v_cvt_pk_bf16_f32 v73, v78, v79
  v_cvt_pk_bf16_f32 v74, v80, v81
  v_cvt_pk_bf16_f32 v75, v82, v83
  buffer_store_dwordx4 v[72:75], v173, s[4:7], s92 offen offset:3072 sc1
  v_accvgpr_read_b32 v88, a156
  v_accvgpr_read_b32 v89, a157
  v_accvgpr_read_b32 v90, a158
  v_accvgpr_read_b32 v91, a159
  v_accvgpr_read_b32 v92, a188
  v_accvgpr_read_b32 v93, a189
  v_accvgpr_read_b32 v94, a190
  v_accvgpr_read_b32 v95, a191
  v_cvt_pk_bf16_f32 v204, v88, v89
  v_cvt_pk_bf16_f32 v205, v90, v91
  v_cvt_pk_bf16_f32 v206, v92, v93
  v_cvt_pk_bf16_f32 v207, v94, v95
  s_add_u32 s92, s92, s61
  v_accvgpr_read_b32 v52, a64
  v_accvgpr_read_b32 v53, a65
  v_accvgpr_read_b32 v54, a66
  v_accvgpr_read_b32 v55, a67
  v_accvgpr_read_b32 v56, a96
  v_accvgpr_read_b32 v57, a97
  v_accvgpr_read_b32 v58, a98
  v_accvgpr_read_b32 v59, a99
  v_cvt_pk_bf16_f32 v48, v52, v53
  v_cvt_pk_bf16_f32 v49, v54, v55
  v_cvt_pk_bf16_f32 v50, v56, v57
  v_cvt_pk_bf16_f32 v51, v58, v59
  buffer_store_dwordx4 v[48:51], v172, s[4:7], s92 offen offset:0 sc1
  v_accvgpr_read_b32 v64, a192
  v_accvgpr_read_b32 v65, a193
  v_accvgpr_read_b32 v66, a194
  v_accvgpr_read_b32 v67, a195
  v_accvgpr_read_b32 v68, a224
  v_accvgpr_read_b32 v69, a225
  v_accvgpr_read_b32 v70, a226
  v_accvgpr_read_b32 v71, a227
  v_cvt_pk_bf16_f32 v208, v64, v65
  v_cvt_pk_bf16_f32 v209, v66, v67
  v_cvt_pk_bf16_f32 v210, v68, v69
  v_cvt_pk_bf16_f32 v211, v70, v71
  v_accvgpr_read_b32 v76, a68
  v_accvgpr_read_b32 v77, a69
  v_accvgpr_read_b32 v78, a70
  v_accvgpr_read_b32 v79, a71
  v_accvgpr_read_b32 v80, a100
  v_accvgpr_read_b32 v81, a101
  v_accvgpr_read_b32 v82, a102
  v_accvgpr_read_b32 v83, a103
  v_cvt_pk_bf16_f32 v72, v76, v77
  v_cvt_pk_bf16_f32 v73, v78, v79
  v_cvt_pk_bf16_f32 v74, v80, v81
  v_cvt_pk_bf16_f32 v75, v82, v83
  buffer_store_dwordx4 v[72:75], v172, s[4:7], s92 offen offset:1024 sc1
  v_accvgpr_read_b32 v88, a196
  v_accvgpr_read_b32 v89, a197
  v_accvgpr_read_b32 v90, a198
  v_accvgpr_read_b32 v91, a199
  v_accvgpr_read_b32 v92, a228
  v_accvgpr_read_b32 v93, a229
  v_accvgpr_read_b32 v94, a230
  v_accvgpr_read_b32 v95, a231
  v_cvt_pk_bf16_f32 v212, v88, v89
  v_cvt_pk_bf16_f32 v213, v90, v91
  v_cvt_pk_bf16_f32 v214, v92, v93
  v_cvt_pk_bf16_f32 v215, v94, v95
  v_accvgpr_read_b32 v52, a72
  v_accvgpr_read_b32 v53, a73
  v_accvgpr_read_b32 v54, a74
  v_accvgpr_read_b32 v55, a75
  v_accvgpr_read_b32 v56, a104
  v_accvgpr_read_b32 v57, a105
  v_accvgpr_read_b32 v58, a106
  v_accvgpr_read_b32 v59, a107
  v_cvt_pk_bf16_f32 v48, v52, v53
  v_cvt_pk_bf16_f32 v49, v54, v55
  v_cvt_pk_bf16_f32 v50, v56, v57
  v_cvt_pk_bf16_f32 v51, v58, v59
  buffer_store_dwordx4 v[48:51], v172, s[4:7], s92 offen offset:2048 sc1
  v_accvgpr_read_b32 v64, a200
  v_accvgpr_read_b32 v65, a201
  v_accvgpr_read_b32 v66, a202
  v_accvgpr_read_b32 v67, a203
  v_accvgpr_read_b32 v68, a232
  v_accvgpr_read_b32 v69, a233
  v_accvgpr_read_b32 v70, a234
  v_accvgpr_read_b32 v71, a235
  v_cvt_pk_bf16_f32 v216, v64, v65
  v_cvt_pk_bf16_f32 v217, v66, v67
  v_cvt_pk_bf16_f32 v218, v68, v69
  v_cvt_pk_bf16_f32 v219, v70, v71
  v_accvgpr_read_b32 v76, a76
  v_accvgpr_read_b32 v77, a77
  v_accvgpr_read_b32 v78, a78
  v_accvgpr_read_b32 v79, a79
  v_accvgpr_read_b32 v80, a108
  v_accvgpr_read_b32 v81, a109
  v_accvgpr_read_b32 v82, a110
  v_accvgpr_read_b32 v83, a111
  v_cvt_pk_bf16_f32 v72, v76, v77
  v_cvt_pk_bf16_f32 v73, v78, v79
  v_cvt_pk_bf16_f32 v74, v80, v81
  v_cvt_pk_bf16_f32 v75, v82, v83
  buffer_store_dwordx4 v[72:75], v172, s[4:7], s92 offen offset:3072 sc1
  v_accvgpr_read_b32 v88, a204
  v_accvgpr_read_b32 v89, a205
  v_accvgpr_read_b32 v90, a206
  v_accvgpr_read_b32 v91, a207
  v_accvgpr_read_b32 v92, a236
  v_accvgpr_read_b32 v93, a237
  v_accvgpr_read_b32 v94, a238
  v_accvgpr_read_b32 v95, a239
  v_cvt_pk_bf16_f32 v220, v88, v89
  v_cvt_pk_bf16_f32 v221, v90, v91
  v_cvt_pk_bf16_f32 v222, v92, v93
  v_cvt_pk_bf16_f32 v223, v94, v95
  v_accvgpr_read_b32 v52, a80
  v_accvgpr_read_b32 v53, a81
  v_accvgpr_read_b32 v54, a82
  v_accvgpr_read_b32 v55, a83
  v_accvgpr_read_b32 v56, a112
  v_accvgpr_read_b32 v57, a113
  v_accvgpr_read_b32 v58, a114
  v_accvgpr_read_b32 v59, a115
  v_cvt_pk_bf16_f32 v48, v52, v53
  v_cvt_pk_bf16_f32 v49, v54, v55
  v_cvt_pk_bf16_f32 v50, v56, v57
  v_cvt_pk_bf16_f32 v51, v58, v59
  buffer_store_dwordx4 v[48:51], v173, s[4:7], s92 offen offset:0 sc1
  v_accvgpr_read_b32 v64, a208
  v_accvgpr_read_b32 v65, a209
  v_accvgpr_read_b32 v66, a210
  v_accvgpr_read_b32 v67, a211
  v_accvgpr_read_b32 v68, a240
  v_accvgpr_read_b32 v69, a241
  v_accvgpr_read_b32 v70, a242
  v_accvgpr_read_b32 v71, a243
  v_cvt_pk_bf16_f32 v224, v64, v65
  v_cvt_pk_bf16_f32 v225, v66, v67
  v_cvt_pk_bf16_f32 v226, v68, v69
  v_cvt_pk_bf16_f32 v227, v70, v71
  v_accvgpr_read_b32 v76, a84
  v_accvgpr_read_b32 v77, a85
  v_accvgpr_read_b32 v78, a86
  v_accvgpr_read_b32 v79, a87
  v_accvgpr_read_b32 v80, a116
  v_accvgpr_read_b32 v81, a117
  v_accvgpr_read_b32 v82, a118
  v_accvgpr_read_b32 v83, a119
  v_cvt_pk_bf16_f32 v72, v76, v77
  v_cvt_pk_bf16_f32 v73, v78, v79
  v_cvt_pk_bf16_f32 v74, v80, v81
  v_cvt_pk_bf16_f32 v75, v82, v83
  buffer_store_dwordx4 v[72:75], v173, s[4:7], s92 offen offset:1024 sc1
  v_accvgpr_read_b32 v88, a212
  v_accvgpr_read_b32 v89, a213
  v_accvgpr_read_b32 v90, a214
  v_accvgpr_read_b32 v91, a215
  v_accvgpr_read_b32 v92, a244
  v_accvgpr_read_b32 v93, a245
  v_accvgpr_read_b32 v94, a246
  v_accvgpr_read_b32 v95, a247
  v_cvt_pk_bf16_f32 v228, v88, v89
  v_cvt_pk_bf16_f32 v229, v90, v91
  v_cvt_pk_bf16_f32 v230, v92, v93
  v_cvt_pk_bf16_f32 v231, v94, v95
  v_accvgpr_read_b32 v52, a88
  v_accvgpr_read_b32 v53, a89
  v_accvgpr_read_b32 v54, a90
  v_accvgpr_read_b32 v55, a91
  v_accvgpr_read_b32 v56, a120
  v_accvgpr_read_b32 v57, a121
  v_accvgpr_read_b32 v58, a122
  v_accvgpr_read_b32 v59, a123
  v_cvt_pk_bf16_f32 v48, v52, v53
  v_cvt_pk_bf16_f32 v49, v54, v55
  v_cvt_pk_bf16_f32 v50, v56, v57
  v_cvt_pk_bf16_f32 v51, v58, v59
  buffer_store_dwordx4 v[48:51], v173, s[4:7], s92 offen offset:2048 sc1
  v_accvgpr_read_b32 v64, a216
  v_accvgpr_read_b32 v65, a217
  v_accvgpr_read_b32 v66, a218
  v_accvgpr_read_b32 v67, a219
  v_accvgpr_read_b32 v68, a248
  v_accvgpr_read_b32 v69, a249
  v_accvgpr_read_b32 v70, a250
  v_accvgpr_read_b32 v71, a251
  v_cvt_pk_bf16_f32 v232, v64, v65
  v_cvt_pk_bf16_f32 v233, v66, v67
  v_cvt_pk_bf16_f32 v234, v68, v69
  v_cvt_pk_bf16_f32 v235, v70, v71
  v_accvgpr_read_b32 v76, a92
  v_accvgpr_read_b32 v77, a93
  v_accvgpr_read_b32 v78, a94
  v_accvgpr_read_b32 v79, a95
  v_accvgpr_read_b32 v80, a124
  v_accvgpr_read_b32 v81, a125
  v_accvgpr_read_b32 v82, a126
  v_accvgpr_read_b32 v83, a127
  v_cvt_pk_bf16_f32 v72, v76, v77
  v_cvt_pk_bf16_f32 v73, v78, v79
  v_cvt_pk_bf16_f32 v74, v80, v81
  v_cvt_pk_bf16_f32 v75, v82, v83
  buffer_store_dwordx4 v[72:75], v173, s[4:7], s92 offen offset:3072 sc1
  v_accvgpr_read_b32 v88, a220
  v_accvgpr_read_b32 v89, a221
  v_accvgpr_read_b32 v90, a222
  v_accvgpr_read_b32 v91, a223
  v_accvgpr_read_b32 v92, a252
  v_accvgpr_read_b32 v93, a253
  v_accvgpr_read_b32 v94, a254
  v_accvgpr_read_b32 v95, a255
  v_cvt_pk_bf16_f32 v236, v88, v89
  v_cvt_pk_bf16_f32 v237, v90, v91
  v_cvt_pk_bf16_f32 v238, v92, v93
  v_cvt_pk_bf16_f32 v239, v94, v95
  s_add_u32 s92, s92, s61
  s_mov_b32 s46, s92
  s_add_u32 s47, s92, s61
  s_branch L_edef
L_e1:
  s_cmp_lg_u32 s59, 3
  s_cbranch_scc1 L_e2
  s_lshr_b32 s90, s27, 1
  s_and_b32 s91, s27, 1
  v_mov_b32 v178, 0x0
  v_bfe_u32 v177, v1, 0, 6
  v_lshl_add_u32 v178, v177, 4, v178
  v_add_u32 v176, 4096, v178
  s_mul_i32 s92, s90, 2
  s_mul_i32 s92, s92, s61
  s_add_u32 s92, s92, s60
  s_mul_i32 s93, s91, 2048
  s_add_u32 s92, s92, s93
  v_accvgpr_read_b32 v184, a0
  v_accvgpr_read_b32 v185, a4
  v_accvgpr_read_b32 v186, a1
  v_accvgpr_read_b32 v187, a5
  v_accvgpr_read_b32 v188, a2
  v_accvgpr_read_b32 v189, a6
  v_accvgpr_read_b32 v190, a3
  v_accvgpr_read_b32 v191, a7
  v_cvt_pk_bf16_f32 v180, v184, v185
  v_cvt_pk_bf16_f32 v181, v186, v187
  v_cvt_pk_bf16_f32 v182, v188, v189
  v_cvt_pk_bf16_f32 v183, v190, v191
  buffer_store_dwordx4 v[180:183], v178, s[4:7], s92 offen offset:0 sc1
  v_accvgpr_read_b32 v196, a8
  v_accvgpr_read_b32 v197, a12
  v_accvgpr_read_b32 v198, a9
  v_accvgpr_read_b32 v199, a13
  v_accvgpr_read_b32 v200, a10
  v_accvgpr_read_b32 v201, a14
  v_accvgpr_read_b32 v202, a11
  v_accvgpr_read_b32 v203, a15
  v_cvt_pk_bf16_f32 v192, v196, v197
  v_cvt_pk_bf16_f32 v193, v198, v199
  v_cvt_pk_bf16_f32 v194, v200, v201
  v_cvt_pk_bf16_f32 v195, v202, v203
  buffer_store_dwordx4 v[192:195], v178, s[4:7], s92 offen offset:1024 sc1
  v_accvgpr_read_b32 v208, a16
  v_accvgpr_read_b32 v209, a20
  v_accvgpr_read_b32 v210, a17
  v_accvgpr_read_b32 v211, a21
  v_accvgpr_read_b32 v212, a18
  v_accvgpr_read_b32 v213, a22
  v_accvgpr_read_b32 v214, a19
  v_accvgpr_read_b32 v215, a23
  v_cvt_pk_bf16_f32 v204, v208, v209
  v_cvt_pk_bf16_f32 v205, v210, v211
  v_cvt_pk_bf16_f32 v206, v212, v213
  v_cvt_pk_bf16_f32 v207, v214, v215
  buffer_store_dwordx4 v[204:207], v176, s[4:7], s92 offen offset:0 sc1
  v_accvgpr_read_b32 v220, a24
  v_accvgpr_read_b32 v221, a28
  v_accvgpr_read_b32 v222, a25
  v_accvgpr_read_b32 v223, a29
  v_accvgpr_read_b32 v224, a26
  v_accvgpr_read_b32 v225, a30
  v_accvgpr_read_b32 v226, a27
  v_accvgpr_read_b32 v227, a31
  v_cvt_pk_bf16_f32 v216, v220, v221
  v_cvt_pk_bf16_f32 v217, v222, v223
  v_cvt_pk_bf16_f32 v218, v224, v225
  v_cvt_pk_bf16_f32 v219, v226, v227
  buffer_store_dwordx4 v[216:219], v176, s[4:7], s92 offen offset:1024 sc1
  s_add_u32 s92, s92, s61
  v_accvgpr_read_b32 v184, a32
  v_accvgpr_read_b32 v185, a36
  v_accvgpr_read_b32 v186, a33
  v_accvgpr_read_b32 v187, a37
  v_accvgpr_read_b32 v188, a34
  v_accvgpr_read_b32 v189, a38
  v_accvgpr_read_b32 v190, a35
  v_accvgpr_read_b32 v191, a39
  v_cvt_pk_bf16_f32 v180, v184, v185
  v_cvt_pk_bf16_f32 v181, v186, v187
  v_cvt_pk_bf16_f32 v182, v188, v189
  v_cvt_pk_bf16_f32 v183, v190, v191
  buffer_store_dwordx4 v[180:183], v178, s[4:7], s92 offen offset:0 sc1
  v_accvgpr_read_b32 v196, a40
  v_accvgpr_read_b32 v197, a44
  v_accvgpr_read_b32 v198, a41
  v_accvgpr_read_b32 v199, a45
  v_accvgpr_read_b32 v200, a42
  v_accvgpr_read_b32 v201, a46
  v_accvgpr_read_b32 v202, a43
  v_accvgpr_read_b32 v203, a47
  v_cvt_pk_bf16_f32 v192, v196, v197
  v_cvt_pk_bf16_f32 v193, v198, v199
  v_cvt_pk_bf16_f32 v194, v200, v201
  v_cvt_pk_bf16_f32 v195, v202, v203
  buffer_store_dwordx4 v[192:195], v178, s[4:7], s92 offen offset:1024 sc1
  v_accvgpr_read_b32 v208, a48
  v_accvgpr_read_b32 v209, a52
  v_accvgpr_read_b32 v210, a49
  v_accvgpr_read_b32 v211, a53
  v_accvgpr_read_b32 v212, a50
  v_accvgpr_read_b32 v213, a54
  v_accvgpr_read_b32 v214, a51
  v_accvgpr_read_b32 v215, a55
  v_cvt_pk_bf16_f32 v204, v208, v209
  v_cvt_pk_bf16_f32 v205, v210, v211
  v_cvt_pk_bf16_f32 v206, v212, v213
  v_cvt_pk_bf16_f32 v207, v214, v215
  buffer_store_dwordx4 v[204:207], v176, s[4:7], s92 offen offset:0 sc1
  v_accvgpr_read_b32 v220, a56
  v_accvgpr_read_b32 v221, a60
  v_accvgpr_read_b32 v222, a57
  v_accvgpr_read_b32 v223, a61
  v_accvgpr_read_b32 v224, a58
  v_accvgpr_read_b32 v225, a62
  v_accvgpr_read_b32 v226, a59
  v_accvgpr_read_b32 v227, a63
  v_cvt_pk_bf16_f32 v216, v220, v221
  v_cvt_pk_bf16_f32 v217, v222, v223
  v_cvt_pk_bf16_f32 v218, v224, v225
  v_cvt_pk_bf16_f32 v219, v226, v227
  buffer_store_dwordx4 v[216:219], v176, s[4:7], s92 offen offset:1024 sc1
  s_add_u32 s92, s92, s61
  s_branch L_esig
L_e2:
  s_cmp_lg_u32 s59, 4
  s_cbranch_scc1 L_e3
  s_lshr_b32 s90, s27, 1
  s_and_b32 s91, s27, 1
  v_mov_b32 v178, 0x0
  v_bfe_u32 v177, v1, 0, 6
  v_lshl_add_u32 v178, v177, 4, v178
  v_add_u32 v176, 4096, v178
  s_mul_i32 s92, s90, 2
  s_mul_i32 s92, s92, s61
  s_add_u32 s92, s92, s60
  s_mul_i32 s93, s91, 4096
  s_add_u32 s92, s92, s93
  v_accvgpr_read_b32 v184, a0
  v_accvgpr_read_b32 v185, a1
  v_accvgpr_read_b32 v186, a2
  v_accvgpr_read_b32 v187, a3
  v_accvgpr_read_b32 v188, a16
  v_accvgpr_read_b32 v189, a17
  v_accvgpr_read_b32 v190, a18
  v_accvgpr_read_b32 v191, a19
  v_cvt_pk_bf16_f32 v180, v184, v185
  v_cvt_pk_bf16_f32 v181, v186, v187
  v_cvt_pk_bf16_f32 v182, v188, v189
  v_cvt_pk_bf16_f32 v183, v190, v191
  buffer_store_dwordx4 v[180:183], v178, s[4:7], s92 offen offset:0 sc1
  v_accvgpr_read_b32 v196, a4
  v_accvgpr_read_b32 v197, a5
  v_accvgpr_read_b32 v198, a6
  v_accvgpr_read_b32 v199, a7
  v_accvgpr_read_b32 v200, a20
  v_accvgpr_read_b32 v201, a21
  v_accvgpr_read_b32 v202, a22
  v_accvgpr_read_b32 v203, a23
  v_cvt_pk_bf16_f32 v192, v196, v197
  v_cvt_pk_bf16_f32 v193, v198, v199
  v_cvt_pk_bf16_f32 v194, v200, v201
  v_cvt_pk_bf16_f32 v195, v202, v203
  buffer_store_dwordx4 v[192:195], v178, s[4:7], s92 offen offset:1024 sc1
  v_accvgpr_read_b32 v208, a8
  v_accvgpr_read_b32 v209, a9
  v_accvgpr_read_b32 v210, a10
  v_accvgpr_read_b32 v211, a11
  v_accvgpr_read_b32 v212, a24
  v_accvgpr_read_b32 v213, a25
  v_accvgpr_read_b32 v214, a26
  v_accvgpr_read_b32 v215, a27
  v_cvt_pk_bf16_f32 v204, v208, v209
  v_cvt_pk_bf16_f32 v205, v210, v211
  v_cvt_pk_bf16_f32 v206, v212, v213
  v_cvt_pk_bf16_f32 v207, v214, v215
  buffer_store_dwordx4 v[204:207], v178, s[4:7], s92 offen offset:2048 sc1
  v_accvgpr_read_b32 v220, a12
  v_accvgpr_read_b32 v221, a13
  v_accvgpr_read_b32 v222, a14
  v_accvgpr_read_b32 v223, a15
  v_accvgpr_read_b32 v224, a28
  v_accvgpr_read_b32 v225, a29
  v_accvgpr_read_b32 v226, a30
  v_accvgpr_read_b32 v227, a31
  v_cvt_pk_bf16_f32 v216, v220, v221
  v_cvt_pk_bf16_f32 v217, v222, v223
  v_cvt_pk_bf16_f32 v218, v224, v225
  v_cvt_pk_bf16_f32 v219, v226, v227
  buffer_store_dwordx4 v[216:219], v178, s[4:7], s92 offen offset:3072 sc1
  s_add_u32 s92, s92, s61
  v_accvgpr_read_b32 v184, a32
  v_accvgpr_read_b32 v185, a33
  v_accvgpr_read_b32 v186, a34
  v_accvgpr_read_b32 v187, a35
  v_accvgpr_read_b32 v188, a48
  v_accvgpr_read_b32 v189, a49
  v_accvgpr_read_b32 v190, a50
  v_accvgpr_read_b32 v191, a51
  v_cvt_pk_bf16_f32 v180, v184, v185
  v_cvt_pk_bf16_f32 v181, v186, v187
  v_cvt_pk_bf16_f32 v182, v188, v189
  v_cvt_pk_bf16_f32 v183, v190, v191
  buffer_store_dwordx4 v[180:183], v178, s[4:7], s92 offen offset:0 sc1
  v_accvgpr_read_b32 v196, a36
  v_accvgpr_read_b32 v197, a37
  v_accvgpr_read_b32 v198, a38
  v_accvgpr_read_b32 v199, a39
  v_accvgpr_read_b32 v200, a52
  v_accvgpr_read_b32 v201, a53
  v_accvgpr_read_b32 v202, a54
  v_accvgpr_read_b32 v203, a55
  v_cvt_pk_bf16_f32 v192, v196, v197
  v_cvt_pk_bf16_f32 v193, v198, v199
  v_cvt_pk_bf16_f32 v194, v200, v201
  v_cvt_pk_bf16_f32 v195, v202, v203
  buffer_store_dwordx4 v[192:195], v178, s[4:7], s92 offen offset:1024 sc1
  v_accvgpr_read_b32 v208, a40
  v_accvgpr_read_b32 v209, a41
  v_accvgpr_read_b32 v210, a42
  v_accvgpr_read_b32 v211, a43
  v_accvgpr_read_b32 v212, a56
  v_accvgpr_read_b32 v213, a57
  v_accvgpr_read_b32 v214, a58
  v_accvgpr_read_b32 v215, a59
  v_cvt_pk_bf16_f32 v204, v208, v209
  v_cvt_pk_bf16_f32 v205, v210, v211
  v_cvt_pk_bf16_f32 v206, v212, v213
  v_cvt_pk_bf16_f32 v207, v214, v215
  buffer_store_dwordx4 v[204:207], v178, s[4:7], s92 offen offset:2048 sc1
  v_accvgpr_read_b32 v220, a44
  v_accvgpr_read_b32 v221, a45
  v_accvgpr_read_b32 v222, a46
  v_accvgpr_read_b32 v223, a47
  v_accvgpr_read_b32 v224, a60
  v_accvgpr_read_b32 v225, a61
  v_accvgpr_read_b32 v226, a62
  v_accvgpr_read_b32 v227, a63
  v_cvt_pk_bf16_f32 v216, v220, v221
  v_cvt_pk_bf16_f32 v217, v222, v223
  v_cvt_pk_bf16_f32 v218, v224, v225
  v_cvt_pk_bf16_f32 v219, v226, v227
  buffer_store_dwordx4 v[216:219], v178, s[4:7], s92 offen offset:3072 sc1
  s_add_u32 s92, s92, s61
  s_branch L_esig
L_e3:
  s_cmp_lg_u32 s59, 5
  s_cbranch_scc1 L_e4
  s_lshr_b32 s90, s27, 1
  s_and_b32 s91, s27, 1
  v_and_b32 v176, 15, v1
  v_mul_lo_u32 v176, v176, s61
  v_lshrrev_b32 v177, 4, v1
  v_lshl_add_u32 v178, v177, 4, v176
  s_mul_i32 s92, s90, 64
  s_mul_i32 s92, s92, s61
  s_add_u32 s92, s92, s60
  s_mul_i32 s93, s91, 128
  s_add_u32 s92, s92, s93
  s_lshl_b32 s94, s61, 4
  v_accvgpr_read_b32 v184, a0
  v_accvgpr_read_b32 v185, a1
  v_accvgpr_read_b32 v186, a2
  v_accvgpr_read_b32 v187, a3
  v_accvgpr_read_b32 v188, a4
  v_accvgpr_read_b32 v189, a5
  v_accvgpr_read_b32 v190, a6
  v_accvgpr_read_b32 v191, a7
  v_cvt_pk_bf16_f32 v180, v184, v185
  v_cvt_pk_bf16_f32 v181, v186, v187
  v_cvt_pk_bf16_f32 v182, v188, v189
  v_cvt_pk_bf16_f32 v183, v190, v191
  buffer_store_dwordx4 v[180:183], v178, s[16:19], s92 offen offset:0 sc1
  v_accvgpr_read_b32 v196, a8
  v_accvgpr_read_b32 v197, a9
  v_accvgpr_read_b32 v198, a10
  v_accvgpr_read_b32 v199, a11
  v_accvgpr_read_b32 v200, a12
  v_accvgpr_read_b32 v201, a13
  v_accvgpr_read_b32 v202, a14
  v_accvgpr_read_b32 v203, a15
  v_cvt_pk_bf16_f32 v192, v196, v197
  v_cvt_pk_bf16_f32 v193, v198, v199
  v_cvt_pk_bf16_f32 v194, v200, v201
  v_cvt_pk_bf16_f32 v195, v202, v203
  buffer_store_dwordx4 v[192:195], v178, s[16:19], s92 offen offset:64 sc1
  s_add_u32 s92, s92, s94
  v_accvgpr_read_b32 v208, a16
  v_accvgpr_read_b32 v209, a17
  v_accvgpr_read_b32 v210, a18
  v_accvgpr_read_b32 v211, a19
  v_accvgpr_read_b32 v212, a20
  v_accvgpr_read_b32 v213, a21
  v_accvgpr_read_b32 v214, a22
  v_accvgpr_read_b32 v215, a23
  v_cvt_pk_bf16_f32 v204, v208, v209
  v_cvt_pk_bf16_f32 v205, v210, v211
  v_cvt_pk_bf16_f32 v206, v212, v213
  v_cvt_pk_bf16_f32 v207, v214, v215
  buffer_store_dwordx4 v[204:207], v178, s[16:19], s92 offen offset:0 sc1
  v_accvgpr_read_b32 v220, a24
  v_accvgpr_read_b32 v221, a25
  v_accvgpr_read_b32 v222, a26
  v_accvgpr_read_b32 v223, a27
  v_accvgpr_read_b32 v224, a28
  v_accvgpr_read_b32 v225, a29
  v_accvgpr_read_b32 v226, a30
  v_accvgpr_read_b32 v227, a31
  v_cvt_pk_bf16_f32 v216, v220, v221
  v_cvt_pk_bf16_f32 v217, v222, v223
  v_cvt_pk_bf16_f32 v218, v224, v225
  v_cvt_pk_bf16_f32 v219, v226, v227
  buffer_store_dwordx4 v[216:219], v178, s[16:19], s92 offen offset:64 sc1
  s_add_u32 s92, s92, s94
  v_accvgpr_read_b32 v184, a32
  v_accvgpr_read_b32 v185, a33
  v_accvgpr_read_b32 v186, a34
  v_accvgpr_read_b32 v187, a35
  v_accvgpr_read_b32 v188, a36
  v_accvgpr_read_b32 v189, a37
  v_accvgpr_read_b32 v190, a38
  v_accvgpr_read_b32 v191, a39
  v_cvt_pk_bf16_f32 v180, v184, v185
  v_cvt_pk_bf16_f32 v181, v186, v187
  v_cvt_pk_bf16_f32 v182, v188, v189
  v_cvt_pk_bf16_f32 v183, v190, v191
  buffer_store_dwordx4 v[180:183], v178, s[16:19], s92 offen offset:0 sc1
  v_accvgpr_read_b32 v196, a40
  v_accvgpr_read_b32 v197, a41
  v_accvgpr_read_b32 v198, a42
  v_accvgpr_read_b32 v199, a43
  v_accvgpr_read_b32 v200, a44
  v_accvgpr_read_b32 v201, a45
  v_accvgpr_read_b32 v202, a46
  v_accvgpr_read_b32 v203, a47
  v_cvt_pk_bf16_f32 v192, v196, v197
  v_cvt_pk_bf16_f32 v193, v198, v199
  v_cvt_pk_bf16_f32 v194, v200, v201
  v_cvt_pk_bf16_f32 v195, v202, v203
  buffer_store_dwordx4 v[192:195], v178, s[16:19], s92 offen offset:64 sc1
  s_add_u32 s92, s92, s94
  v_accvgpr_read_b32 v208, a48
  v_accvgpr_read_b32 v209, a49
  v_accvgpr_read_b32 v210, a50
  v_accvgpr_read_b32 v211, a51
  v_accvgpr_read_b32 v212, a52
  v_accvgpr_read_b32 v213, a53
  v_accvgpr_read_b32 v214, a54
  v_accvgpr_read_b32 v215, a55
  v_cvt_pk_bf16_f32 v204, v208, v209
  v_cvt_pk_bf16_f32 v205, v210, v211
  v_cvt_pk_bf16_f32 v206, v212, v213
  v_cvt_pk_bf16_f32 v207, v214, v215
  buffer_store_dwordx4 v[204:207], v178, s[16:19], s92 offen offset:0 sc1
  v_accvgpr_read_b32 v220, a56
  v_accvgpr_read_b32 v221, a57
  v_accvgpr_read_b32 v222, a58
  v_accvgpr_read_b32 v223, a59
  v_accvgpr_read_b32 v224, a60
  v_accvgpr_read_b32 v225, a61
  v_accvgpr_read_b32 v226, a62
  v_accvgpr_read_b32 v227, a63
  v_cvt_pk_bf16_f32 v216, v220, v221
  v_cvt_pk_bf16_f32 v217, v222, v223
  v_cvt_pk_bf16_f32 v218, v224, v225
  v_cvt_pk_bf16_f32 v219, v226, v227
  buffer_store_dwordx4 v[216:219], v178, s[16:19], s92 offen offset:64 sc1
  s_add_u32 s92, s92, s94
  s_branch L_epid
L_e4:
L_edef:
  s_mov_b32 s49, 1
  s_cmp_eq_u32 s58, 1
  s_cbranch_scc1 L_epid
  s_mov_b32 s49, 0
  buffer_store_dwordx4 v[176:179], v172, s[4:7], s46 offen offset:0 sc1
  buffer_store_dwordx4 v[180:183], v172, s[4:7], s46 offen offset:1024 sc1
  buffer_store_dwordx4 v[184:187], v172, s[4:7], s46 offen offset:2048 sc1
  buffer_store_dwordx4 v[188:191], v172, s[4:7], s46 offen offset:3072 sc1
  buffer_store_dwordx4 v[192:195], v173, s[4:7], s46 offen offset:0 sc1
  buffer_store_dwordx4 v[196:199], v173, s[4:7], s46 offen offset:1024 sc1
  buffer_store_dwordx4 v[200:203], v173, s[4:7], s46 offen offset:2048 sc1
  buffer_store_dwordx4 v[204:207], v173, s[4:7], s46 offen offset:3072 sc1
  buffer_store_dwordx4 v[208:211], v172, s[4:7], s47 offen offset:0 sc1
  buffer_store_dwordx4 v[212:215], v172, s[4:7], s47 offen offset:1024 sc1
  buffer_store_dwordx4 v[216:219], v172, s[4:7], s47 offen offset:2048 sc1
  buffer_store_dwordx4 v[220:223], v172, s[4:7], s47 offen offset:3072 sc1
  buffer_store_dwordx4 v[224:227], v173, s[4:7], s47 offen offset:0 sc1
  buffer_store_dwordx4 v[228:231], v173, s[4:7], s47 offen offset:1024 sc1
  buffer_store_dwordx4 v[232:235], v173, s[4:7], s47 offen offset:2048 sc1
  buffer_store_dwordx4 v[236:239], v173, s[4:7], s47 offen offset:3072 sc1
  s_mov_b32 s46, 0x40000000
  s_mov_b32 s47, 0x40000000
L_esig:
  s_waitcnt vmcnt(0)
  s_cmp_lg_u32 s39, 0
  s_cbranch_scc1 L_vok
  v_mbcnt_lo_u32_b32 v250, -1, 0
  v_mbcnt_hi_u32_b32 v250, -1, v250
  s_lshl_b32 s90, s32, 9
  s_add_u32 s90, s90, 131136
  v_lshl_add_u32 v251, v250, 3, s90
  ds_write_b64 v251, v[248:249]
  s_waitcnt lgkmcnt(0)
  s_cmp_lg_u32 s32, 0
  s_cbranch_scc1 L_vd_3
  v_lshlrev_b32 v250, 2, v250
  s_cmp_lg_u32 s100, 0
  s_cbranch_scc1 L_vw_2
  v_readfirstlane_b32 s90, v247
  s_and_b32 s90, s90, s101
  s_cbranch_scc0 L_vw_2
  v_mov_b32 v251, 1
  s_mov_b64 exec, 1
  buffer_store_dword v251, v250, s[28:31], 0 offen offset:32 sc1
  s_mov_b64 exec, -1
L_vw_2:
  buffer_load_dword v251, v250, s[28:31], 0 offen sc1
  s_waitcnt vmcnt(0)
  v_cmp_eq_u32 vcc, -1, v251
  v_readlane_b32 s91, v251, 8
  v_readlane_b32 s92, v251, 32
  v_readlane_b32 s93, v251, 33
  v_readlane_b32 s90, v251, 34
  s_cmp_lg_u32 s100, 0
  s_cselect_b32 s93, s90, s93
  s_cselect_b32 s91, 0, s91
  s_cselect_b32 s92, 1, s92
  s_cselect_b32 s90, 0xff, vcc_lo
  s_cmp_lg_u32 s91, 0
  s_cselect_b32 s92, 3, s92
  s_cbranch_scc1 L_vk_4
  s_add_u32 s3, s3, 1
  s_cmp_ge_u32 s3, 131072
  s_cselect_b32 s92, 4, s92
  s_cbranch_scc1 L_vk_4
  s_sleep 8
  s_and_b32 s90, s90, 0xff
  s_cmp_lg_u32 s90, 0xff
  s_cbranch_scc1 L_vw_2
  s_cmp_lt_u32 s93, 128
  s_cbranch_scc1 L_vw_2
L_vk_4:
  v_mov_b32 v251, s92
  v_mov_b32 v250, 131072
  ds_write_b32 v250, v251
  s_waitcnt lgkmcnt(0)
L_vd_3:
  s_barrier
  v_mov_b32 v250, 131072
  ds_read_b32 v251, v250
  s_waitcnt lgkmcnt(0)
  v_readfirstlane_b32 s92, v251
  s_barrier
  s_cmp_eq_u32 s92, 3
  s_cbranch_scc1 L_fallback
  s_cmp_eq_u32 s92, 4
  s_cbranch_scc1 L_exit
  s_mov_b32 s39, 1
L_vok:
  s_barrier
  s_cmp_lg_u32 s32, 0
  s_cbranch_scc1 L_sig_5
  v_mov_b32 v254, s63
  v_mov_b32 v255, 0
  v_and_b32 v254, 3, v254
  v_mbcnt_lo_u32_b32 v255, -1, 0
  v_lshlrev_b32 v255, 9, v255
  s_cmp_ge_u32 s63, 2
  s_cselect_b64 exec, 3, 1
  buffer_atomic_add v254, v255, s[4:7], s62 offen offset:0 sc1
  s_mov_b64 exec, -1
L_sig_5:
L_epid:
  s_mov_b32 s59, 0
  s_cmp_eq_u32 s58, 1
  s_cbranch_scc1 L_r1
  s_cmp_eq_u32 s58, 2
  s_cbranch_scc1 L_r2
  s_cmp_eq_u32 s58, 3
  s_cbranch_scc1 L_next
  s_cmp_eq_u32 s35, 4
  s_cbranch_scc1 L_atb
  s_cmp_eq_u32 s35, 5
  s_cbranch_scc1 L_bo
  s_cmp_eq_u32 s35, 6
  s_cbranch_scc1 L_ata
  s_cmp_eq_u32 s35, 11
  s_cbranch_scc1 L_ata4
  s_cmp_eq_u32 s35, 7
  s_cbranch_scc1 L_ao
  s_cmp_eq_u32 s35, 8
  s_cbranch_scc1 L_aos
  s_cmp_eq_u32 s35, 12
  s_cbranch_scc1 L_swp
  s_cmp_eq_u32 s35, 14
  s_cbranch_scc1 L_ao4
  s_branch L_exit
L_aqkv:
  s_mov_b32 s8, s64
  s_and_b32 s9, s65, 0xffff
  s_mov_b32 s10, 0x400000
  s_mov_b32 s11, 0x20000
  s_cmp_eq_u32 s35, 0
  s_cselect_b64 s[88:89], s[68:69], s[70:71]
  s_cmp_eq_u32 s35, 2
  s_cselect_b64 s[88:89], s[72:73], s[88:89]
  s_mov_b32 s12, s88
  s_and_b32 s13, s89, 0xffff
  s_mov_b32 s14, 0x800000
  s_mov_b32 s15, 0x20000
  s_lshl_b32 s91, s33, 2
  s_add_u32 s91, s91, s37
  s_mov_b32 s24, 8192
  s_mov_b32 s26, 262144
  s_lshl_b32 s20, s36, 19
  s_lshl_b32 s21, s91, 9
  s_lshl_b32 s22, s35, 24
  s_lshl_b32 s90, s36, 21
  s_add_u32 s22, s22, s90
  s_lshl_b32 s90, s91, 14
  s_add_u32 s22, s22, s90
  s_lshl_b32 s38, s36, 9
  s_add_u32 s38, s38, 28672
  s_cmp_eq_u32 s35, 0
  s_cselect_b32 s38, 8192, s38
  s_cselect_b32 s98, 1, 2
  s_mov_b32 s48, s35
  s_branch L_g1
L_bqkv:
  s_mov_b32 s8, s78
  s_and_b32 s9, s79, 0xffff
  s_mov_b32 s10, 0x400000
  s_mov_b32 s11, 0x20000
  s_mov_b32 s12, s80
  s_and_b32 s13, s81, 0xffff
  s_mov_b32 s14, 0x600000
  s_mov_b32 s15, 0x20000
  s_lshl_b32 s91, s37, 2
  s_add_u32 s91, s91, s33
  s_mov_b32 s24, 6144
  s_mov_b32 s26, 65536
  s_lshl_b32 s20, s36, 19
  s_lshl_b32 s21, s91, 9
  s_lshl_b32 s22, s37, 22
  s_lshl_b32 s90, s36, 19
  s_add_u32 s22, s22, s90
  s_lshl_b32 s90, s33, 14
  s_add_u32 s22, s22, s90
  s_add_u32 s22, s22, 0x4000000
  s_mov_b32 s38, 12288
  s_mov_b32 s48, s37
  s_mov_b32 s98, 1
L_g1:
  s_lshl_b32 s90, s36, 9
  s_add_u32 s38, s38, s90
  s_lshl_b32 s90, s33, 7
  s_add_u32 s38, s38, s90
  s_mov_b32 s23, 2048
  s_mov_b32 s25, 8
  v_and_b32 v1, 63, v0
  v_lshrrev_b32 v38, 6, v0
  s_nop 0
  v_readfirstlane_b32 s27, v38
  s_mul_i32 s90, s27, 64
  v_lshrrev_b32 v38, 3, v1
  v_add_u32 v38, s90, v38
  v_mul_lo_u32 v38, v38, s23
  v_lshrrev_b32 v39, 4, v1
  v_xor_b32 v39, v39, v1
  v_and_b32 v39, 7, v39
  v_lshl_add_u32 v2, v39, 4, v38
  s_mul_i32 s91, s23, 8
  v_add_u32 v3, s91, v2
  v_xor_b32 v3, 64, v3
  v_add_u32 v4, s91, v3
  v_xor_b32 v4, 64, v4
  v_add_u32 v5, s91, v4
  v_xor_b32 v5, 64, v5
  v_add_u32 v6, s91, v5
  v_xor_b32 v6, 64, v6
  v_add_u32 v7, s91, v6
  v_xor_b32 v7, 64, v7
  v_add_u32 v8, s91, v7
  v_xor_b32 v8, 64, v8
  v_add_u32 v9, s91, v8
  v_xor_b32 v9, 64, v9
  s_mul_i32 s90, s27, 16
  v_lshrrev_b32 v38, 5, v1
  v_add_u32 v38, 0, v38
  v_add_u32 v38, s90, v38
  v_mov_b32 v174, v38
  v_and_b32 v39, 3, v38
  v_lshlrev_b32 v39, 1, v39
  v_and_b32 v40, 8, v38
  v_or_b32 v39, v39, v40
  v_xor_b32 v39, v39, v1
  v_and_b32 v39, 31, v39
  v_mul_lo_u32 v38, v38, s24
  v_lshl_add_u32 v10, v39, 4, v38
  v_lshrrev_b32 v38, 5, v1
  v_add_u32 v38, 2, v38
  v_add_u32 v38, s90, v38
  v_and_b32 v39, 3, v38
  v_lshlrev_b32 v39, 1, v39
  v_and_b32 v40, 8, v38
  v_or_b32 v39, v39, v40
  v_xor_b32 v39, v39, v1
  v_and_b32 v39, 31, v39
  v_mul_lo_u32 v38, v38, s24
  v_lshl_add_u32 v11, v39, 4, v38
  v_lshrrev_b32 v38, 5, v1
  v_add_u32 v38, 4, v38
  v_add_u32 v38, s90, v38
  v_and_b32 v39, 3, v38
  v_lshlrev_b32 v39, 1, v39
  v_and_b32 v40, 8, v38
  v_or_b32 v39, v39, v40
  v_xor_b32 v39, v39, v1
  v_and_b32 v39, 31, v39
  v_mul_lo_u32 v38, v38, s24
  v_lshl_add_u32 v12, v39, 4, v38
  v_lshrrev_b32 v38, 5, v1
  v_add_u32 v38, 6, v38
  v_add_u32 v38, s90, v38
  v_and_b32 v39, 3, v38
  v_lshlrev_b32 v39, 1, v39
  v_and_b32 v40, 8, v38
  v_or_b32 v39, v39, v40
  v_xor_b32 v39, v39, v1
  v_and_b32 v39, 31, v39
  v_mul_lo_u32 v38, v38, s24
  v_lshl_add_u32 v13, v39, 4, v38
  v_lshrrev_b32 v38, 5, v1
  v_add_u32 v38, 8, v38
  v_add_u32 v38, s90, v38
  v_and_b32 v39, 3, v38
  v_lshlrev_b32 v39, 1, v39
  v_and_b32 v40, 8, v38
  v_or_b32 v39, v39, v40
  v_xor_b32 v39, v39, v1
  v_and_b32 v39, 31, v39
  v_mul_lo_u32 v38, v38, s24
  v_lshl_add_u32 v14, v39, 4, v38
  v_lshrrev_b32 v38, 5, v1
  v_add_u32 v38, 10, v38
  v_add_u32 v38, s90, v38
  v_and_b32 v39, 3, v38
  v_lshlrev_b32 v39, 1, v39
  v_and_b32 v40, 8, v38
  v_or_b32 v39, v39, v40
  v_xor_b32 v39, v39, v1
  v_and_b32 v39, 31, v39
  v_mul_lo_u32 v38, v38, s24
  v_lshl_add_u32 v15, v39, 4, v38
  v_lshrrev_b32 v38, 5, v1
  v_add_u32 v38, 12, v38
  v_add_u32 v38, s90, v38
  v_and_b32 v39, 3, v38
  v_lshlrev_b32 v39, 1, v39
  v_and_b32 v40, 8, v38
  v_or_b32 v39, v39, v40
  v_xor_b32 v39, v39, v1
  v_and_b32 v39, 31, v39
  v_mul_lo_u32 v38, v38, s24
  v_lshl_add_u32 v16, v39, 4, v38
  v_lshrrev_b32 v38, 5, v1
  v_add_u32 v38, 14, v38
  v_add_u32 v38, s90, v38
  v_and_b32 v39, 3, v38
  v_lshlrev_b32 v39, 1, v39
  v_and_b32 v40, 8, v38
  v_or_b32 v39, v39, v40
  v_xor_b32 v39, v39, v1
  v_and_b32 v39, 31, v39
  v_mul_lo_u32 v38, v38, s24
  v_lshl_add_u32 v17, v39, 4, v38
  s_mul_i32 s51, s24, 64
  s_mul_i32 s52, s27, 8192
  s_mul_i32 s53, s27, 8192
  s_add_u32 s53, s53, 32768
  s_add_u32 m0, s52, 0
  s_nop 0
  buffer_load_dwordx4 v2, s[8:11], s20 offen  lds
  s_add_u32 m0, s53, 0
  s_nop 0
  buffer_load_dwordx4 v10, s[12:15], s21 offen  lds
  s_add_u32 m0, s52, 1024
  s_nop 0
  buffer_load_dwordx4 v3, s[8:11], s20 offen  lds
  s_add_u32 m0, s53, 1024
  s_nop 0
  buffer_load_dwordx4 v11, s[12:15], s21 offen  lds
  s_add_u32 m0, s52, 2048
  s_nop 0
  buffer_load_dwordx4 v4, s[8:11], s20 offen  lds
  s_add_u32 m0, s53, 2048
  s_nop 0
  buffer_load_dwordx4 v12, s[12:15], s21 offen  lds
  s_add_u32 m0, s52, 3072
  s_nop 0
  buffer_load_dwordx4 v5, s[8:11], s20 offen  lds
  s_add_u32 m0, s53, 3072
  s_nop 0
  buffer_load_dwordx4 v13, s[12:15], s21 offen  lds
  s_add_u32 m0, s52, 4096
  s_nop 0
  buffer_load_dwordx4 v6, s[8:11], s20 offen  lds
  s_add_u32 m0, s53, 4096
  s_nop 0
  buffer_load_dwordx4 v14, s[12:15], s21 offen  lds
  s_add_u32 m0, s52, 5120
  s_nop 0
  buffer_load_dwordx4 v7, s[8:11], s20 offen  lds
  s_add_u32 m0, s53, 5120
  s_nop 0
  buffer_load_dwordx4 v15, s[12:15], s21 offen  lds
  s_add_u32 m0, s52, 6144
  s_nop 0
  buffer_load_dwordx4 v8, s[8:11], s20 offen  lds
  s_add_u32 m0, s53, 6144
  s_nop 0
  buffer_load_dwordx4 v16, s[12:15], s21 offen  lds
  s_add_u32 m0, s52, 7168
  s_nop 0
  buffer_load_dwordx4 v9, s[8:11], s20 offen  lds
  s_add_u32 m0, s53, 7168
  s_nop 0
  buffer_load_dwordx4 v17, s[12:15], s21 offen  lds
  s_add_u32 s20, s20, 128
  s_add_u32 s21, s21, s51
  s_add_u32 m0, s52, 65536
  s_nop 0
  buffer_load_dwordx4 v2, s[8:11], s20 offen  lds
  s_add_u32 m0, s53, 65536
  s_nop 0
  buffer_load_dwordx4 v10, s[12:15], s21 offen  lds
  s_add_u32 m0, s52, 66560
  s_nop 0
  buffer_load_dwordx4 v3, s[8:11], s20 offen  lds
  s_add_u32 m0, s53, 66560
  s_nop 0
  buffer_load_dwordx4 v11, s[12:15], s21 offen  lds
  s_add_u32 m0, s52, 67584
  s_nop 0
  buffer_load_dwordx4 v4, s[8:11], s20 offen  lds
  s_add_u32 m0, s53, 67584
  s_nop 0
  buffer_load_dwordx4 v12, s[12:15], s21 offen  lds
  s_add_u32 m0, s52, 68608
  s_nop 0
  buffer_load_dwordx4 v5, s[8:11], s20 offen  lds
  s_add_u32 m0, s53, 68608
  s_nop 0
  buffer_load_dwordx4 v13, s[12:15], s21 offen  lds
  s_add_u32 m0, s52, 69632
  s_nop 0
  buffer_load_dwordx4 v6, s[8:11], s20 offen  lds
  s_add_u32 m0, s53, 69632
  s_nop 0
  buffer_load_dwordx4 v14, s[12:15], s21 offen  lds
  s_add_u32 m0, s52, 70656
  s_nop 0
  buffer_load_dwordx4 v7, s[8:11], s20 offen  lds
  s_add_u32 m0, s53, 70656
  s_nop 0
  buffer_load_dwordx4 v15, s[12:15], s21 offen  lds
  s_add_u32 m0, s52, 71680
  s_nop 0
  buffer_load_dwordx4 v8, s[8:11], s20 offen  lds
  s_add_u32 m0, s53, 71680
  s_nop 0
  buffer_load_dwordx4 v16, s[12:15], s21 offen  lds
  s_add_u32 m0, s52, 72704
  s_nop 0
  buffer_load_dwordx4 v9, s[8:11], s20 offen  lds
  s_add_u32 m0, s53, 72704
  s_nop 0
  buffer_load_dwordx4 v17, s[12:15], s21 offen  lds
  s_add_u32 s20, s20, 128
  s_add_u32 s21, s21, s51
  s_lshr_b32 s90, s27, 1
  s_and_b32 s91, s27, 1
  s_mul_i32 s92, s90, 16384
  v_mov_b32 v38, 0x0
  v_bfe_u32 v39, v1, 0, 4
  v_lshl_add_u32 v38, v39, 7, v38
  v_add_u32 v38, s92, v38
  v_lshrrev_b32 v39, 1, v1
  v_and_b32 v39, 7, v39
  v_lshrrev_b32 v40, 4, v1
  v_xor_b32 v39, v39, v40
  v_lshl_add_u32 v18, v39, 4, v38
  v_xor_b32 v19, 64, v18
  v_add_u32 v20, 65536, v18
  v_add_u32 v21, 65536, v19
  v_mov_b32 v38, 0x0
  v_bfe_u32 v39, v1, 2, 2
  v_lshl_add_u32 v38, v39, 9, v38
  v_bfe_u32 v39, v1, 4, 2
  v_lshl_add_u32 v38, v39, 12, v38
  v_bfe_u32 v39, v1, 0, 2
  v_lshl_add_u32 v38, v39, 3, v38
  v_bfe_u32 v40, v1, 2, 3
  s_mul_i32 s92, s91, 8
  s_add_u32 s93, s92, 0
  v_xor_b32 v39, s93, v40
  v_lshl_add_u32 v22, v39, 5, v38
  v_add_u32 v30, 65536, v22
  s_add_u32 s93, s92, 1
  v_xor_b32 v39, s93, v40
  v_lshl_add_u32 v23, v39, 5, v38
  v_add_u32 v31, 65536, v23
  s_add_u32 s93, s92, 2
  v_xor_b32 v39, s93, v40
  v_lshl_add_u32 v24, v39, 5, v38
  v_add_u32 v32, 65536, v24
  s_add_u32 s93, s92, 3
  v_xor_b32 v39, s93, v40
  v_lshl_add_u32 v25, v39, 5, v38
  v_add_u32 v33, 65536, v25
  s_add_u32 s93, s92, 4
  v_xor_b32 v39, s93, v40
  v_lshl_add_u32 v26, v39, 5, v38
  v_add_u32 v34, 65536, v26
  s_add_u32 s93, s92, 5
  v_xor_b32 v39, s93, v40
  v_lshl_add_u32 v27, v39, 5, v38
  v_add_u32 v35, 65536, v27
  s_add_u32 s93, s92, 6
  v_xor_b32 v39, s93, v40
  v_lshl_add_u32 v28, v39, 5, v38
  v_add_u32 v36, 65536, v28
  s_add_u32 s93, s92, 7
  v_xor_b32 v39, s93, v40
  v_lshl_add_u32 v29, v39, 5, v38
  v_add_u32 v37, 65536, v29
  v_mov_b32 v241, 131072
  v_lshrrev_b32 v175, 4, v0
  v_add_u32 v175, v175, v241
  s_mov_b32 s58, 1
  s_branch L_epi
L_r1:
  s_cmp_eq_u32 s49, 1
  s_cbranch_scc1 L_r1c
  s_waitcnt vmcnt(16)
L_r1c:
  s_cmp_eq_u32 s48, 2
  s_cbranch_scc1 L_g2
  s_waitcnt vmcnt(16)
  s_barrier
  ds_read_b128 v[44:47], v18 offset:0
  ds_read_b64_tr_b16 v[108:109], v22 offset:32768
  ds_read_b64_tr_b16 v[110:111], v22 offset:34816
  ds_read_b128 v[48:51], v18 offset:2048
  ds_read_b64_tr_b16 v[112:113], v23 offset:32768
  ds_read_b64_tr_b16 v[114:115], v23 offset:34816
  ds_read_b128 v[52:55], v18 offset:4096
  ds_read_b64_tr_b16 v[116:117], v24 offset:32768
  ds_read_b64_tr_b16 v[118:119], v24 offset:34816
  ds_read_b128 v[56:59], v18 offset:6144
  ds_read_b64_tr_b16 v[120:121], v25 offset:32768
  ds_read_b64_tr_b16 v[122:123], v25 offset:34816
  ds_read_b128 v[60:63], v18 offset:8192
  ds_read_b64_tr_b16 v[124:125], v26 offset:32768
  ds_read_b64_tr_b16 v[126:127], v26 offset:34816
  ds_read_b128 v[64:67], v18 offset:10240
  ds_read_b64_tr_b16 v[128:129], v27 offset:32768
  ds_read_b64_tr_b16 v[130:131], v27 offset:34816
  ds_read_b128 v[68:71], v18 offset:12288
  ds_read_b64_tr_b16 v[132:133], v28 offset:32768
  ds_read_b64_tr_b16 v[134:135], v28 offset:34816
  ds_read_b128 v[72:75], v18 offset:14336
  ds_read_b64_tr_b16 v[136:137], v29 offset:32768
  ds_read_b64_tr_b16 v[138:139], v29 offset:34816
  s_sub_u32 s25, s25, 1
  s_waitcnt lgkmcnt(0)
  s_nop 0
  v_mfma_f32_16x16x32_bf16 a[0:3], v[108:111], v[44:47], 0
  buffer_store_dwordx4 v[176:179], v172, s[4:7], s46 offen offset:0 sc1
  ds_read_b128 v[76:79], v19 offset:0
  v_mfma_f32_16x16x32_bf16 a[4:7], v[112:115], v[44:47], 0
  v_mfma_f32_16x16x32_bf16 a[8:11], v[116:119], v[44:47], 0
  ds_read_b64_tr_b16 v[140:141], v22 offset:49152
  v_mfma_f32_16x16x32_bf16 a[12:15], v[120:123], v[44:47], 0
  s_nop 0
  v_mfma_f32_16x16x32_bf16 a[16:19], v[124:127], v[44:47], 0
  buffer_store_dwordx4 v[180:183], v172, s[4:7], s46 offen offset:1024 sc1
  ds_read_b64_tr_b16 v[142:143], v22 offset:51200
  v_mfma_f32_16x16x32_bf16 a[20:23], v[128:131], v[44:47], 0
  v_mfma_f32_16x16x32_bf16 a[24:27], v[132:135], v[44:47], 0
  ds_read_b128 v[80:83], v19 offset:2048
  v_mfma_f32_16x16x32_bf16 a[28:31], v[136:139], v[44:47], 0
  s_nop 0
  v_mfma_f32_16x16x32_bf16 a[32:35], v[108:111], v[48:51], 0
  buffer_store_dwordx4 v[184:187], v172, s[4:7], s46 offen offset:2048 sc1
  ds_read_b64_tr_b16 v[144:145], v23 offset:49152
  v_mfma_f32_16x16x32_bf16 a[36:39], v[112:115], v[48:51], 0
  v_mfma_f32_16x16x32_bf16 a[40:43], v[116:119], v[48:51], 0
  ds_read_b64_tr_b16 v[146:147], v23 offset:51200
  v_mfma_f32_16x16x32_bf16 a[44:47], v[120:123], v[48:51], 0
  s_nop 0
  v_mfma_f32_16x16x32_bf16 a[48:51], v[124:127], v[48:51], 0
  buffer_store_dwordx4 v[188:191], v172, s[4:7], s46 offen offset:3072 sc1
  ds_read_b128 v[84:87], v19 offset:4096
  v_mfma_f32_16x16x32_bf16 a[52:55], v[128:131], v[48:51], 0
  v_mfma_f32_16x16x32_bf16 a[56:59], v[132:135], v[48:51], 0
  ds_read_b64_tr_b16 v[148:149], v24 offset:49152
  v_mfma_f32_16x16x32_bf16 a[60:63], v[136:139], v[48:51], 0
  s_nop 0
  v_mfma_f32_16x16x32_bf16 a[64:67], v[108:111], v[52:55], 0
  buffer_store_dwordx4 v[192:195], v173, s[4:7], s46 offen offset:0 sc1
  ds_read_b64_tr_b16 v[150:151], v24 offset:51200
  v_mfma_f32_16x16x32_bf16 a[68:71], v[112:115], v[52:55], 0
  v_mfma_f32_16x16x32_bf16 a[72:75], v[116:119], v[52:55], 0
  ds_read_b128 v[88:91], v19 offset:6144
  v_mfma_f32_16x16x32_bf16 a[76:79], v[120:123], v[52:55], 0
  s_nop 0
  v_mfma_f32_16x16x32_bf16 a[80:83], v[124:127], v[52:55], 0
  buffer_store_dwordx4 v[196:199], v173, s[4:7], s46 offen offset:1024 sc1
  ds_read_b64_tr_b16 v[152:153], v25 offset:49152
  v_mfma_f32_16x16x32_bf16 a[84:87], v[128:131], v[52:55], 0
  v_mfma_f32_16x16x32_bf16 a[88:91], v[132:135], v[52:55], 0
  ds_read_b64_tr_b16 v[154:155], v25 offset:51200
  v_mfma_f32_16x16x32_bf16 a[92:95], v[136:139], v[52:55], 0
  s_nop 0
  v_mfma_f32_16x16x32_bf16 a[96:99], v[108:111], v[56:59], 0
  buffer_store_dwordx4 v[200:203], v173, s[4:7], s46 offen offset:2048 sc1
  ds_read_b128 v[92:95], v19 offset:8192
  v_mfma_f32_16x16x32_bf16 a[100:103], v[112:115], v[56:59], 0
  v_mfma_f32_16x16x32_bf16 a[104:107], v[116:119], v[56:59], 0
  ds_read_b64_tr_b16 v[156:157], v26 offset:49152
  v_mfma_f32_16x16x32_bf16 a[108:111], v[120:123], v[56:59], 0
  s_nop 0
  v_mfma_f32_16x16x32_bf16 a[112:115], v[124:127], v[56:59], 0
  buffer_store_dwordx4 v[204:207], v173, s[4:7], s46 offen offset:3072 sc1
  ds_read_b64_tr_b16 v[158:159], v26 offset:51200
  v_mfma_f32_16x16x32_bf16 a[116:119], v[128:131], v[56:59], 0
  v_mfma_f32_16x16x32_bf16 a[120:123], v[132:135], v[56:59], 0
  ds_read_b128 v[96:99], v19 offset:10240
  v_mfma_f32_16x16x32_bf16 a[124:127], v[136:139], v[56:59], 0
  s_nop 0
  v_mfma_f32_16x16x32_bf16 a[128:131], v[108:111], v[60:63], 0
  buffer_store_dwordx4 v[208:211], v172, s[4:7], s47 offen offset:0 sc1
  ds_read_b64_tr_b16 v[160:161], v27 offset:49152
  v_mfma_f32_16x16x32_bf16 a[132:135], v[112:115], v[60:63], 0
  v_mfma_f32_16x16x32_bf16 a[136:139], v[116:119], v[60:63], 0
  ds_read_b64_tr_b16 v[162:163], v27 offset:51200
  v_mfma_f32_16x16x32_bf16 a[140:143], v[120:123], v[60:63], 0
  s_nop 0
  v_mfma_f32_16x16x32_bf16 a[144:147], v[124:127], v[60:63], 0
  buffer_store_dwordx4 v[212:215], v172, s[4:7], s47 offen offset:1024 sc1
  ds_read_b128 v[100:103], v19 offset:12288
  v_mfma_f32_16x16x32_bf16 a[148:151], v[128:131], v[60:63], 0
  v_mfma_f32_16x16x32_bf16 a[152:155], v[132:135], v[60:63], 0
  ds_read_b64_tr_b16 v[164:165], v28 offset:49152
  v_mfma_f32_16x16x32_bf16 a[156:159], v[136:139], v[60:63], 0
  s_nop 0
  v_mfma_f32_16x16x32_bf16 a[160:163], v[108:111], v[64:67], 0
  buffer_store_dwordx4 v[216:219], v172, s[4:7], s47 offen offset:2048 sc1
  ds_read_b64_tr_b16 v[166:167], v28 offset:51200
  v_mfma_f32_16x16x32_bf16 a[164:167], v[112:115], v[64:67], 0
  v_mfma_f32_16x16x32_bf16 a[168:171], v[116:119], v[64:67], 0
  ds_read_b128 v[104:107], v19 offset:14336
  v_mfma_f32_16x16x32_bf16 a[172:175], v[120:123], v[64:67], 0
  s_nop 0
  v_mfma_f32_16x16x32_bf16 a[176:179], v[124:127], v[64:67], 0
  buffer_store_dwordx4 v[220:223], v172, s[4:7], s47 offen offset:3072 sc1
  ds_read_b64_tr_b16 v[168:169], v29 offset:49152
  v_mfma_f32_16x16x32_bf16 a[180:183], v[128:131], v[64:67], 0
  v_mfma_f32_16x16x32_bf16 a[184:187], v[132:135], v[64:67], 0
  ds_read_b64_tr_b16 v[170:171], v29 offset:51200
  v_mfma_f32_16x16x32_bf16 a[188:191], v[136:139], v[64:67], 0
  s_nop 0
  v_mfma_f32_16x16x32_bf16 a[192:195], v[108:111], v[68:71], 0
  buffer_store_dwordx4 v[224:227], v173, s[4:7], s47 offen offset:0 sc1
  v_mfma_f32_16x16x32_bf16 a[196:199], v[112:115], v[68:71], 0
  v_mfma_f32_16x16x32_bf16 a[200:203], v[116:119], v[68:71], 0
  v_mfma_f32_16x16x32_bf16 a[204:207], v[120:123], v[68:71], 0
  s_nop 0
  v_mfma_f32_16x16x32_bf16 a[208:211], v[124:127], v[68:71], 0
  buffer_store_dwordx4 v[228:231], v173, s[4:7], s47 offen offset:1024 sc1
  v_mfma_f32_16x16x32_bf16 a[212:215], v[128:131], v[68:71], 0
  v_mfma_f32_16x16x32_bf16 a[216:219], v[132:135], v[68:71], 0
  v_mfma_f32_16x16x32_bf16 a[220:223], v[136:139], v[68:71], 0
  s_nop 0
  v_mfma_f32_16x16x32_bf16 a[224:227], v[108:111], v[72:75], 0
  buffer_store_dwordx4 v[232:235], v173, s[4:7], s47 offen offset:2048 sc1
  v_mfma_f32_16x16x32_bf16 a[228:231], v[112:115], v[72:75], 0
  v_mfma_f32_16x16x32_bf16 a[232:235], v[116:119], v[72:75], 0
  v_mfma_f32_16x16x32_bf16 a[236:239], v[120:123], v[72:75], 0
  s_nop 0
  v_mfma_f32_16x16x32_bf16 a[240:243], v[124:127], v[72:75], 0
  buffer_store_dwordx4 v[236:239], v173, s[4:7], s47 offen offset:3072 sc1
  v_mfma_f32_16x16x32_bf16 a[244:247], v[128:131], v[72:75], 0
  v_mfma_f32_16x16x32_bf16 a[248:251], v[132:135], v[72:75], 0
  v_mfma_f32_16x16x32_bf16 a[252:255], v[136:139], v[72:75], 0
  s_waitcnt lgkmcnt(0)
  v_mfma_f32_16x16x32_bf16 a[0:3], v[140:143], v[76:79], a[0:3]
  s_waitcnt vmcnt(16)
  s_barrier
  s_add_u32 m0, s52, 0
  v_mfma_f32_16x16x32_bf16 a[4:7], v[144:147], v[76:79], a[4:7]
  buffer_load_dwordx4 v2, s[8:11], s20 offen  lds
  ds_read_b128 v[44:47], v20 offset:0
  v_mfma_f32_16x16x32_bf16 a[8:11], v[148:151], v[76:79], a[8:11]
  v_mfma_f32_16x16x32_bf16 a[12:15], v[152:155], v[76:79], a[12:15]
  ds_read_b64_tr_b16 v[108:109], v30 offset:32768
  s_add_u32 m0, s53, 0
  v_mfma_f32_16x16x32_bf16 a[16:19], v[156:159], v[76:79], a[16:19]
  buffer_load_dwordx4 v10, s[12:15], s21 offen  lds
  v_mfma_f32_16x16x32_bf16 a[20:23], v[160:163], v[76:79], a[20:23]
  ds_read_b64_tr_b16 v[110:111], v30 offset:34816
  v_mfma_f32_16x16x32_bf16 a[24:27], v[164:167], v[76:79], a[24:27]
  v_mfma_f32_16x16x32_bf16 a[28:31], v[168:171], v[76:79], a[28:31]
  ds_read_b128 v[48:51], v20 offset:2048
  s_add_u32 m0, s52, 1024
  v_mfma_f32_16x16x32_bf16 a[32:35], v[140:143], v[80:83], a[32:35]
  buffer_load_dwordx4 v3, s[8:11], s20 offen  lds
  v_mfma_f32_16x16x32_bf16 a[36:39], v[144:147], v[80:83], a[36:39]
  ds_read_b64_tr_b16 v[112:113], v31 offset:32768
  v_mfma_f32_16x16x32_bf16 a[40:43], v[148:151], v[80:83], a[40:43]
  v_mfma_f32_16x16x32_bf16 a[44:47], v[152:155], v[80:83], a[44:47]
  ds_read_b64_tr_b16 v[114:115], v31 offset:34816
  s_add_u32 m0, s53, 1024
  v_mfma_f32_16x16x32_bf16 a[48:51], v[156:159], v[80:83], a[48:51]
  buffer_load_dwordx4 v11, s[12:15], s21 offen  lds
  v_mfma_f32_16x16x32_bf16 a[52:55], v[160:163], v[80:83], a[52:55]
  ds_read_b128 v[52:55], v20 offset:4096
  v_mfma_f32_16x16x32_bf16 a[56:59], v[164:167], v[80:83], a[56:59]
  s_add_u32 m0, s52, 2048
  v_mfma_f32_16x16x32_bf16 a[60:63], v[168:171], v[80:83], a[60:63]
  buffer_load_dwordx4 v4, s[8:11], s20 offen  lds
  ds_read_b64_tr_b16 v[116:117], v32 offset:32768
  v_mfma_f32_16x16x32_bf16 a[64:67], v[140:143], v[84:87], a[64:67]
  v_mfma_f32_16x16x32_bf16 a[68:71], v[144:147], v[84:87], a[68:71]
  ds_read_b64_tr_b16 v[118:119], v32 offset:34816
  v_mfma_f32_16x16x32_bf16 a[72:75], v[148:151], v[84:87], a[72:75]
  s_add_u32 m0, s53, 2048
  v_mfma_f32_16x16x32_bf16 a[76:79], v[152:155], v[84:87], a[76:79]
  buffer_load_dwordx4 v12, s[12:15], s21 offen  lds
  ds_read_b128 v[56:59], v20 offset:6144
  v_mfma_f32_16x16x32_bf16 a[80:83], v[156:159], v[84:87], a[80:83]
  v_mfma_f32_16x16x32_bf16 a[84:87], v[160:163], v[84:87], a[84:87]
  ds_read_b64_tr_b16 v[120:121], v33 offset:32768
  v_mfma_f32_16x16x32_bf16 a[88:91], v[164:167], v[84:87], a[88:91]
  s_add_u32 m0, s52, 3072
  v_mfma_f32_16x16x32_bf16 a[92:95], v[168:171], v[84:87], a[92:95]
  buffer_load_dwordx4 v5, s[8:11], s20 offen  lds
  ds_read_b64_tr_b16 v[122:123], v33 offset:34816
  v_mfma_f32_16x16x32_bf16 a[96:99], v[140:143], v[88:91], a[96:99]
  v_mfma_f32_16x16x32_bf16 a[100:103], v[144:147], v[88:91], a[100:103]
  ds_read_b128 v[60:63], v20 offset:8192
  s_add_u32 m0, s53, 3072
  v_mfma_f32_16x16x32_bf16 a[104:107], v[148:151], v[88:91], a[104:107]
  buffer_load_dwordx4 v13, s[12:15], s21 offen  lds
  v_mfma_f32_16x16x32_bf16 a[108:111], v[152:155], v[88:91], a[108:111]
  ds_read_b64_tr_b16 v[124:125], v34 offset:32768
  v_mfma_f32_16x16x32_bf16 a[112:115], v[156:159], v[88:91], a[112:115]
  v_mfma_f32_16x16x32_bf16 a[116:119], v[160:163], v[88:91], a[116:119]
  ds_read_b64_tr_b16 v[126:127], v34 offset:34816
  s_add_u32 m0, s52, 4096
  v_mfma_f32_16x16x32_bf16 a[120:123], v[164:167], v[88:91], a[120:123]
  buffer_load_dwordx4 v6, s[8:11], s20 offen  lds
  v_mfma_f32_16x16x32_bf16 a[124:127], v[168:171], v[88:91], a[124:127]
  ds_read_b128 v[64:67], v20 offset:10240
  v_mfma_f32_16x16x32_bf16 a[128:131], v[140:143], v[92:95], a[128:131]
  v_mfma_f32_16x16x32_bf16 a[132:135], v[144:147], v[92:95], a[132:135]
  ds_read_b64_tr_b16 v[128:129], v35 offset:32768
  s_add_u32 m0, s53, 4096
  v_mfma_f32_16x16x32_bf16 a[136:139], v[148:151], v[92:95], a[136:139]
  buffer_load_dwordx4 v14, s[12:15], s21 offen  lds
  v_mfma_f32_16x16x32_bf16 a[140:143], v[152:155], v[92:95], a[140:143]
  ds_read_b64_tr_b16 v[130:131], v35 offset:34816
  v_mfma_f32_16x16x32_bf16 a[144:147], v[156:159], v[92:95], a[144:147]
  v_mfma_f32_16x16x32_bf16 a[148:151], v[160:163], v[92:95], a[148:151]
  ds_read_b128 v[68:71], v20 offset:12288
  s_add_u32 m0, s52, 5120
  v_mfma_f32_16x16x32_bf16 a[152:155], v[164:167], v[92:95], a[152:155]
  buffer_load_dwordx4 v7, s[8:11], s20 offen  lds
  v_mfma_f32_16x16x32_bf16 a[156:159], v[168:171], v[92:95], a[156:159]
  ds_read_b64_tr_b16 v[132:133], v36 offset:32768
  v_mfma_f32_16x16x32_bf16 a[160:163], v[140:143], v[96:99], a[160:163]
  s_add_u32 m0, s53, 5120
  v_mfma_f32_16x16x32_bf16 a[164:167], v[144:147], v[96:99], a[164:167]
  buffer_load_dwordx4 v15, s[12:15], s21 offen  lds
  ds_read_b64_tr_b16 v[134:135], v36 offset:34816
  v_mfma_f32_16x16x32_bf16 a[168:171], v[148:151], v[96:99], a[168:171]
  v_mfma_f32_16x16x32_bf16 a[172:175], v[152:155], v[96:99], a[172:175]
  ds_read_b128 v[72:75], v20 offset:14336
  v_mfma_f32_16x16x32_bf16 a[176:179], v[156:159], v[96:99], a[176:179]
  s_add_u32 m0, s52, 6144
  v_mfma_f32_16x16x32_bf16 a[180:183], v[160:163], v[96:99], a[180:183]
  buffer_load_dwordx4 v8, s[8:11], s20 offen  lds
  ds_read_b64_tr_b16 v[136:137], v37 offset:32768
  v_mfma_f32_16x16x32_bf16 a[184:187], v[164:167], v[96:99], a[184:187]
  v_mfma_f32_16x16x32_bf16 a[188:191], v[168:171], v[96:99], a[188:191]
  ds_read_b64_tr_b16 v[138:139], v37 offset:34816
  v_mfma_f32_16x16x32_bf16 a[192:195], v[140:143], v[100:103], a[192:195]
  s_add_u32 m0, s53, 6144
  v_mfma_f32_16x16x32_bf16 a[196:199], v[144:147], v[100:103], a[196:199]
  buffer_load_dwordx4 v16, s[12:15], s21 offen  lds
  v_mfma_f32_16x16x32_bf16 a[200:203], v[148:151], v[100:103], a[200:203]
  v_mfma_f32_16x16x32_bf16 a[204:207], v[152:155], v[100:103], a[204:207]
  s_add_u32 m0, s52, 7168
  v_mfma_f32_16x16x32_bf16 a[208:211], v[156:159], v[100:103], a[208:211]
  buffer_load_dwordx4 v9, s[8:11], s20 offen  lds
  v_mfma_f32_16x16x32_bf16 a[212:215], v[160:163], v[100:103], a[212:215]
  v_mfma_f32_16x16x32_bf16 a[216:219], v[164:167], v[100:103], a[216:219]
  v_mfma_f32_16x16x32_bf16 a[220:223], v[168:171], v[100:103], a[220:223]
  s_add_u32 m0, s53, 7168
  v_mfma_f32_16x16x32_bf16 a[224:227], v[140:143], v[104:107], a[224:227]
  buffer_load_dwordx4 v17, s[12:15], s21 offen  lds
  v_mfma_f32_16x16x32_bf16 a[228:231], v[144:147], v[104:107], a[228:231]
  v_mfma_f32_16x16x32_bf16 a[232:235], v[148:151], v[104:107], a[232:235]
  v_mfma_f32_16x16x32_bf16 a[236:239], v[152:155], v[104:107], a[236:239]
  s_add_u32 s20, s20, 128
  v_mfma_f32_16x16x32_bf16 a[240:243], v[156:159], v[104:107], a[240:243]
  s_add_u32 s21, s21, s51
  v_mfma_f32_16x16x32_bf16 a[244:247], v[160:163], v[104:107], a[244:247]
  v_mfma_f32_16x16x32_bf16 a[248:251], v[164:167], v[104:107], a[248:251]
  v_mfma_f32_16x16x32_bf16 a[252:255], v[168:171], v[104:107], a[252:255]
  s_waitcnt lgkmcnt(0)
  v_mfma_f32_16x16x32_bf16 a[0:3], v[108:111], v[44:47], a[0:3]
  ds_read_b128 v[76:79], v21 offset:0
  v_mfma_f32_16x16x32_bf16 a[4:7], v[112:115], v[44:47], a[4:7]
  v_mfma_f32_16x16x32_bf16 a[8:11], v[116:119], v[44:47], a[8:11]
  ds_read_b64_tr_b16 v[140:141], v30 offset:49152
  v_mfma_f32_16x16x32_bf16 a[12:15], v[120:123], v[44:47], a[12:15]
  v_mfma_f32_16x16x32_bf16 a[16:19], v[124:127], v[44:47], a[16:19]
  ds_read_b64_tr_b16 v[142:143], v30 offset:51200
  v_mfma_f32_16x16x32_bf16 a[20:23], v[128:131], v[44:47], a[20:23]
  v_mfma_f32_16x16x32_bf16 a[24:27], v[132:135], v[44:47], a[24:27]
  ds_read_b128 v[80:83], v21 offset:2048
  v_mfma_f32_16x16x32_bf16 a[28:31], v[136:139], v[44:47], a[28:31]
  v_mfma_f32_16x16x32_bf16 a[32:35], v[108:111], v[48:51], a[32:35]
  ds_read_b64_tr_b16 v[144:145], v31 offset:49152
  v_mfma_f32_16x16x32_bf16 a[36:39], v[112:115], v[48:51], a[36:39]
  v_mfma_f32_16x16x32_bf16 a[40:43], v[116:119], v[48:51], a[40:43]
  ds_read_b64_tr_b16 v[146:147], v31 offset:51200
  v_mfma_f32_16x16x32_bf16 a[44:47], v[120:123], v[48:51], a[44:47]
  v_mfma_f32_16x16x32_bf16 a[48:51], v[124:127], v[48:51], a[48:51]
  ds_read_b128 v[84:87], v21 offset:4096
  v_mfma_f32_16x16x32_bf16 a[52:55], v[128:131], v[48:51], a[52:55]
  v_mfma_f32_16x16x32_bf16 a[56:59], v[132:135], v[48:51], a[56:59]
  ds_read_b64_tr_b16 v[148:149], v32 offset:49152
  v_mfma_f32_16x16x32_bf16 a[60:63], v[136:139], v[48:51], a[60:63]
  v_mfma_f32_16x16x32_bf16 a[64:67], v[108:111], v[52:55], a[64:67]
  ds_read_b64_tr_b16 v[150:151], v32 offset:51200
  v_mfma_f32_16x16x32_bf16 a[68:71], v[112:115], v[52:55], a[68:71]
  v_mfma_f32_16x16x32_bf16 a[72:75], v[116:119], v[52:55], a[72:75]
  ds_read_b128 v[88:91], v21 offset:6144
  v_mfma_f32_16x16x32_bf16 a[76:79], v[120:123], v[52:55], a[76:79]
  v_mfma_f32_16x16x32_bf16 a[80:83], v[124:127], v[52:55], a[80:83]
  ds_read_b64_tr_b16 v[152:153], v33 offset:49152
  v_mfma_f32_16x16x32_bf16 a[84:87], v[128:131], v[52:55], a[84:87]
  v_mfma_f32_16x16x32_bf16 a[88:91], v[132:135], v[52:55], a[88:91]
  ds_read_b64_tr_b16 v[154:155], v33 offset:51200
  v_mfma_f32_16x16x32_bf16 a[92:95], v[136:139], v[52:55], a[92:95]
  v_mfma_f32_16x16x32_bf16 a[96:99], v[108:111], v[56:59], a[96:99]
  ds_read_b128 v[92:95], v21 offset:8192
  v_mfma_f32_16x16x32_bf16 a[100:103], v[112:115], v[56:59], a[100:103]
  v_mfma_f32_16x16x32_bf16 a[104:107], v[116:119], v[56:59], a[104:107]
  ds_read_b64_tr_b16 v[156:157], v34 offset:49152
  v_mfma_f32_16x16x32_bf16 a[108:111], v[120:123], v[56:59], a[108:111]
  v_mfma_f32_16x16x32_bf16 a[112:115], v[124:127], v[56:59], a[112:115]
  ds_read_b64_tr_b16 v[158:159], v34 offset:51200
  v_mfma_f32_16x16x32_bf16 a[116:119], v[128:131], v[56:59], a[116:119]
  v_mfma_f32_16x16x32_bf16 a[120:123], v[132:135], v[56:59], a[120:123]
  ds_read_b128 v[96:99], v21 offset:10240
  v_mfma_f32_16x16x32_bf16 a[124:127], v[136:139], v[56:59], a[124:127]
  v_mfma_f32_16x16x32_bf16 a[128:131], v[108:111], v[60:63], a[128:131]
  ds_read_b64_tr_b16 v[160:161], v35 offset:49152
  v_mfma_f32_16x16x32_bf16 a[132:135], v[112:115], v[60:63], a[132:135]
  v_mfma_f32_16x16x32_bf16 a[136:139], v[116:119], v[60:63], a[136:139]
  ds_read_b64_tr_b16 v[162:163], v35 offset:51200
  v_mfma_f32_16x16x32_bf16 a[140:143], v[120:123], v[60:63], a[140:143]
  v_mfma_f32_16x16x32_bf16 a[144:147], v[124:127], v[60:63], a[144:147]
  ds_read_b128 v[100:103], v21 offset:12288
  v_mfma_f32_16x16x32_bf16 a[148:151], v[128:131], v[60:63], a[148:151]
  v_mfma_f32_16x16x32_bf16 a[152:155], v[132:135], v[60:63], a[152:155]
  ds_read_b64_tr_b16 v[164:165], v36 offset:49152
  v_mfma_f32_16x16x32_bf16 a[156:159], v[136:139], v[60:63], a[156:159]
  v_mfma_f32_16x16x32_bf16 a[160:163], v[108:111], v[64:67], a[160:163]
  ds_read_b64_tr_b16 v[166:167], v36 offset:51200
  v_mfma_f32_16x16x32_bf16 a[164:167], v[112:115], v[64:67], a[164:167]
  v_mfma_f32_16x16x32_bf16 a[168:171], v[116:119], v[64:67], a[168:171]
  ds_read_b128 v[104:107], v21 offset:14336
  v_mfma_f32_16x16x32_bf16 a[172:175], v[120:123], v[64:67], a[172:175]
  v_mfma_f32_16x16x32_bf16 a[176:179], v[124:127], v[64:67], a[176:179]
  ds_read_b64_tr_b16 v[168:169], v37 offset:49152
  v_mfma_f32_16x16x32_bf16 a[180:183], v[128:131], v[64:67], a[180:183]
  v_mfma_f32_16x16x32_bf16 a[184:187], v[132:135], v[64:67], a[184:187]
  ds_read_b64_tr_b16 v[170:171], v37 offset:51200
  v_mfma_f32_16x16x32_bf16 a[188:191], v[136:139], v[64:67], a[188:191]
  v_mfma_f32_16x16x32_bf16 a[192:195], v[108:111], v[68:71], a[192:195]
  v_mfma_f32_16x16x32_bf16 a[196:199], v[112:115], v[68:71], a[196:199]
  v_mfma_f32_16x16x32_bf16 a[200:203], v[116:119], v[68:71], a[200:203]
  v_mfma_f32_16x16x32_bf16 a[204:207], v[120:123], v[68:71], a[204:207]
  v_mfma_f32_16x16x32_bf16 a[208:211], v[124:127], v[68:71], a[208:211]
  v_mfma_f32_16x16x32_bf16 a[212:215], v[128:131], v[68:71], a[212:215]
  v_mfma_f32_16x16x32_bf16 a[216:219], v[132:135], v[68:71], a[216:219]
  v_mfma_f32_16x16x32_bf16 a[220:223], v[136:139], v[68:71], a[220:223]
  v_mfma_f32_16x16x32_bf16 a[224:227], v[108:111], v[72:75], a[224:227]
  v_mfma_f32_16x16x32_bf16 a[228:231], v[112:115], v[72:75], a[228:231]
  v_mfma_f32_16x16x32_bf16 a[232:235], v[116:119], v[72:75], a[232:235]
  v_mfma_f32_16x16x32_bf16 a[236:239], v[120:123], v[72:75], a[236:239]
  v_mfma_f32_16x16x32_bf16 a[240:243], v[124:127], v[72:75], a[240:243]
  v_mfma_f32_16x16x32_bf16 a[244:247], v[128:131], v[72:75], a[244:247]
  v_mfma_f32_16x16x32_bf16 a[248:251], v[132:135], v[72:75], a[248:251]
  v_mfma_f32_16x16x32_bf16 a[252:255], v[136:139], v[72:75], a[252:255]
  s_waitcnt lgkmcnt(0)
  v_mfma_f32_16x16x32_bf16 a[0:3], v[140:143], v[76:79], a[0:3]
  s_waitcnt vmcnt(0)
  s_barrier
  s_cmp_eq_u32 s49, 0
  s_cbranch_scc1 L_hs_6
  s_cmp_lg_u32 s32, 0
  s_cbranch_scc1 L_sig_7
  v_mov_b32 v254, s63
  v_mov_b32 v255, 0
  v_and_b32 v254, 3, v254
  v_mbcnt_lo_u32_b32 v255, -1, 0
  v_lshlrev_b32 v255, 9, v255
  s_cmp_ge_u32 s63, 2
  s_cselect_b64 exec, 3, 1
  buffer_atomic_add v254, v255, s[4:7], s62 offen offset:0 sc1
  s_mov_b64 exec, -1
L_sig_7:
L_hs_6:
  s_add_u32 m0, s52, 65536
  v_mfma_f32_16x16x32_bf16 a[4:7], v[144:147], v[76:79], a[4:7]
  buffer_load_dwordx4 v2, s[8:11], s20 offen  lds
  ds_read_b128 v[44:47], v18 offset:0
  v_mfma_f32_16x16x32_bf16 a[8:11], v[148:151], v[76:79], a[8:11]
  v_mfma_f32_16x16x32_bf16 a[12:15], v[152:155], v[76:79], a[12:15]
  ds_read_b64_tr_b16 v[108:109], v22 offset:32768
  s_add_u32 m0, s53, 65536
  v_mfma_f32_16x16x32_bf16 a[16:19], v[156:159], v[76:79], a[16:19]
  buffer_load_dwordx4 v10, s[12:15], s21 offen  lds
  v_mfma_f32_16x16x32_bf16 a[20:23], v[160:163], v[76:79], a[20:23]
  ds_read_b64_tr_b16 v[110:111], v22 offset:34816
  v_mfma_f32_16x16x32_bf16 a[24:27], v[164:167], v[76:79], a[24:27]
  v_mfma_f32_16x16x32_bf16 a[28:31], v[168:171], v[76:79], a[28:31]
  ds_read_b128 v[48:51], v18 offset:2048
  s_add_u32 m0, s52, 66560
  v_mfma_f32_16x16x32_bf16 a[32:35], v[140:143], v[80:83], a[32:35]
  buffer_load_dwordx4 v3, s[8:11], s20 offen  lds
  v_mfma_f32_16x16x32_bf16 a[36:39], v[144:147], v[80:83], a[36:39]
  ds_read_b64_tr_b16 v[112:113], v23 offset:32768
  v_mfma_f32_16x16x32_bf16 a[40:43], v[148:151], v[80:83], a[40:43]
  v_mfma_f32_16x16x32_bf16 a[44:47], v[152:155], v[80:83], a[44:47]
  ds_read_b64_tr_b16 v[114:115], v23 offset:34816
  s_add_u32 m0, s53, 66560
  v_mfma_f32_16x16x32_bf16 a[48:51], v[156:159], v[80:83], a[48:51]
  buffer_load_dwordx4 v11, s[12:15], s21 offen  lds
  v_mfma_f32_16x16x32_bf16 a[52:55], v[160:163], v[80:83], a[52:55]
  ds_read_b128 v[52:55], v18 offset:4096
  v_mfma_f32_16x16x32_bf16 a[56:59], v[164:167], v[80:83], a[56:59]
  s_add_u32 m0, s52, 67584
  v_mfma_f32_16x16x32_bf16 a[60:63], v[168:171], v[80:83], a[60:63]
  buffer_load_dwordx4 v4, s[8:11], s20 offen  lds
  ds_read_b64_tr_b16 v[116:117], v24 offset:32768
  v_mfma_f32_16x16x32_bf16 a[64:67], v[140:143], v[84:87], a[64:67]
  v_mfma_f32_16x16x32_bf16 a[68:71], v[144:147], v[84:87], a[68:71]
  ds_read_b64_tr_b16 v[118:119], v24 offset:34816
  v_mfma_f32_16x16x32_bf16 a[72:75], v[148:151], v[84:87], a[72:75]
  s_add_u32 m0, s53, 67584
  v_mfma_f32_16x16x32_bf16 a[76:79], v[152:155], v[84:87], a[76:79]
  buffer_load_dwordx4 v12, s[12:15], s21 offen  lds
  ds_read_b128 v[56:59], v18 offset:6144
  v_mfma_f32_16x16x32_bf16 a[80:83], v[156:159], v[84:87], a[80:83]
  v_mfma_f32_16x16x32_bf16 a[84:87], v[160:163], v[84:87], a[84:87]
  ds_read_b64_tr_b16 v[120:121], v25 offset:32768
  v_mfma_f32_16x16x32_bf16 a[88:91], v[164:167], v[84:87], a[88:91]
  s_add_u32 m0, s52, 68608
  v_mfma_f32_16x16x32_bf16 a[92:95], v[168:171], v[84:87], a[92:95]
  buffer_load_dwordx4 v5, s[8:11], s20 offen  lds
  ds_read_b64_tr_b16 v[122:123], v25 offset:34816
  v_mfma_f32_16x16x32_bf16 a[96:99], v[140:143], v[88:91], a[96:99]
  v_mfma_f32_16x16x32_bf16 a[100:103], v[144:147], v[88:91], a[100:103]
  ds_read_b128 v[60:63], v18 offset:8192
  s_add_u32 m0, s53, 68608
  v_mfma_f32_16x16x32_bf16 a[104:107], v[148:151], v[88:91], a[104:107]
  buffer_load_dwordx4 v13, s[12:15], s21 offen  lds
  v_mfma_f32_16x16x32_bf16 a[108:111], v[152:155], v[88:91], a[108:111]
  ds_read_b64_tr_b16 v[124:125], v26 offset:32768
  v_mfma_f32_16x16x32_bf16 a[112:115], v[156:159], v[88:91], a[112:115]
  v_mfma_f32_16x16x32_bf16 a[116:119], v[160:163], v[88:91], a[116:119]
  ds_read_b64_tr_b16 v[126:127], v26 offset:34816
  s_add_u32 m0, s52, 69632
  v_mfma_f32_16x16x32_bf16 a[120:123], v[164:167], v[88:91], a[120:123]
  buffer_load_dwordx4 v6, s[8:11], s20 offen  lds
  v_mfma_f32_16x16x32_bf16 a[124:127], v[168:171], v[88:91], a[124:127]
  ds_read_b128 v[64:67], v18 offset:10240
  v_mfma_f32_16x16x32_bf16 a[128:131], v[140:143], v[92:95], a[128:131]
  v_mfma_f32_16x16x32_bf16 a[132:135], v[144:147], v[92:95], a[132:135]
  ds_read_b64_tr_b16 v[128:129], v27 offset:32768
  s_add_u32 m0, s53, 69632
  v_mfma_f32_16x16x32_bf16 a[136:139], v[148:151], v[92:95], a[136:139]
  buffer_load_dwordx4 v14, s[12:15], s21 offen  lds
  v_mfma_f32_16x16x32_bf16 a[140:143], v[152:155], v[92:95], a[140:143]
  ds_read_b64_tr_b16 v[130:131], v27 offset:34816
  v_mfma_f32_16x16x32_bf16 a[144:147], v[156:159], v[92:95], a[144:147]
  v_mfma_f32_16x16x32_bf16 a[148:151], v[160:163], v[92:95], a[148:151]
  ds_read_b128 v[68:71], v18 offset:12288
  s_add_u32 m0, s52, 70656
  v_mfma_f32_16x16x32_bf16 a[152:155], v[164:167], v[92:95], a[152:155]
  buffer_load_dwordx4 v7, s[8:11], s20 offen  lds
  v_mfma_f32_16x16x32_bf16 a[156:159], v[168:171], v[92:95], a[156:159]
  ds_read_b64_tr_b16 v[132:133], v28 offset:32768
  v_mfma_f32_16x16x32_bf16 a[160:163], v[140:143], v[96:99], a[160:163]
  s_add_u32 m0, s53, 70656
  v_mfma_f32_16x16x32_bf16 a[164:167], v[144:147], v[96:99], a[164:167]
  buffer_load_dwordx4 v15, s[12:15], s21 offen  lds
  ds_read_b64_tr_b16 v[134:135], v28 offset:34816
  v_mfma_f32_16x16x32_bf16 a[168:171], v[148:151], v[96:99], a[168:171]
  v_mfma_f32_16x16x32_bf16 a[172:175], v[152:155], v[96:99], a[172:175]
  ds_read_b128 v[72:75], v18 offset:14336
  v_mfma_f32_16x16x32_bf16 a[176:179], v[156:159], v[96:99], a[176:179]
  s_add_u32 m0, s52, 71680
  v_mfma_f32_16x16x32_bf16 a[180:183], v[160:163], v[96:99], a[180:183]
  buffer_load_dwordx4 v8, s[8:11], s20 offen  lds
  ds_read_b64_tr_b16 v[136:137], v29 offset:32768
  v_mfma_f32_16x16x32_bf16 a[184:187], v[164:167], v[96:99], a[184:187]
  v_mfma_f32_16x16x32_bf16 a[188:191], v[168:171], v[96:99], a[188:191]
  ds_read_b64_tr_b16 v[138:139], v29 offset:34816
  v_mfma_f32_16x16x32_bf16 a[192:195], v[140:143], v[100:103], a[192:195]
  s_add_u32 m0, s53, 71680
  v_mfma_f32_16x16x32_bf16 a[196:199], v[144:147], v[100:103], a[196:199]
  buffer_load_dwordx4 v16, s[12:15], s21 offen  lds
  v_mfma_f32_16x16x32_bf16 a[200:203], v[148:151], v[100:103], a[200:203]
  v_mfma_f32_16x16x32_bf16 a[204:207], v[152:155], v[100:103], a[204:207]
  s_add_u32 m0, s52, 72704
  v_mfma_f32_16x16x32_bf16 a[208:211], v[156:159], v[100:103], a[208:211]
  buffer_load_dwordx4 v9, s[8:11], s20 offen  lds
  v_mfma_f32_16x16x32_bf16 a[212:215], v[160:163], v[100:103], a[212:215]
  v_mfma_f32_16x16x32_bf16 a[216:219], v[164:167], v[100:103], a[216:219]
  v_mfma_f32_16x16x32_bf16 a[220:223], v[168:171], v[100:103], a[220:223]
  s_add_u32 m0, s53, 72704
  v_mfma_f32_16x16x32_bf16 a[224:227], v[140:143], v[104:107], a[224:227]
  buffer_load_dwordx4 v17, s[12:15], s21 offen  lds
  v_mfma_f32_16x16x32_bf16 a[228:231], v[144:147], v[104:107], a[228:231]
  v_mfma_f32_16x16x32_bf16 a[232:235], v[148:151], v[104:107], a[232:235]
  v_mfma_f32_16x16x32_bf16 a[236:239], v[152:155], v[104:107], a[236:239]
  s_add_u32 s20, s20, 128
  v_mfma_f32_16x16x32_bf16 a[240:243], v[156:159], v[104:107], a[240:243]
  s_add_u32 s21, s21, s51
  v_mfma_f32_16x16x32_bf16 a[244:247], v[160:163], v[104:107], a[244:247]
  v_mfma_f32_16x16x32_bf16 a[248:251], v[164:167], v[104:107], a[248:251]
  v_mfma_f32_16x16x32_bf16 a[252:255], v[168:171], v[104:107], a[252:255]
L_g1_loop:
  s_sub_u32 s25, s25, 1
  s_cmp_eq_u32 s25, 0
  s_cbranch_scc1 L_g1_fin
  s_waitcnt lgkmcnt(0)
  v_mfma_f32_16x16x32_bf16 a[0:3], v[108:111], v[44:47], a[0:3]
  ds_read_b128 v[76:79], v19 offset:0
  v_mfma_f32_16x16x32_bf16 a[4:7], v[112:115], v[44:47], a[4:7]
  v_mfma_f32_16x16x32_bf16 a[8:11], v[116:119], v[44:47], a[8:11]
  ds_read_b64_tr_b16 v[140:141], v22 offset:49152
  v_mfma_f32_16x16x32_bf16 a[12:15], v[120:123], v[44:47], a[12:15]
  v_mfma_f32_16x16x32_bf16 a[16:19], v[124:127], v[44:47], a[16:19]
  ds_read_b64_tr_b16 v[142:143], v22 offset:51200
  v_mfma_f32_16x16x32_bf16 a[20:23], v[128:131], v[44:47], a[20:23]
  v_mfma_f32_16x16x32_bf16 a[24:27], v[132:135], v[44:47], a[24:27]
  ds_read_b128 v[80:83], v19 offset:2048
  v_mfma_f32_16x16x32_bf16 a[28:31], v[136:139], v[44:47], a[28:31]
  v_mfma_f32_16x16x32_bf16 a[32:35], v[108:111], v[48:51], a[32:35]
  ds_read_b64_tr_b16 v[144:145], v23 offset:49152
  v_mfma_f32_16x16x32_bf16 a[36:39], v[112:115], v[48:51], a[36:39]
  v_mfma_f32_16x16x32_bf16 a[40:43], v[116:119], v[48:51], a[40:43]
  ds_read_b64_tr_b16 v[146:147], v23 offset:51200
  v_mfma_f32_16x16x32_bf16 a[44:47], v[120:123], v[48:51], a[44:47]
  v_mfma_f32_16x16x32_bf16 a[48:51], v[124:127], v[48:51], a[48:51]
  ds_read_b128 v[84:87], v19 offset:4096
  v_mfma_f32_16x16x32_bf16 a[52:55], v[128:131], v[48:51], a[52:55]
  v_mfma_f32_16x16x32_bf16 a[56:59], v[132:135], v[48:51], a[56:59]
  ds_read_b64_tr_b16 v[148:149], v24 offset:49152
  v_mfma_f32_16x16x32_bf16 a[60:63], v[136:139], v[48:51], a[60:63]
  v_mfma_f32_16x16x32_bf16 a[64:67], v[108:111], v[52:55], a[64:67]
  ds_read_b64_tr_b16 v[150:151], v24 offset:51200
  v_mfma_f32_16x16x32_bf16 a[68:71], v[112:115], v[52:55], a[68:71]
  v_mfma_f32_16x16x32_bf16 a[72:75], v[116:119], v[52:55], a[72:75]
  ds_read_b128 v[88:91], v19 offset:6144
  v_mfma_f32_16x16x32_bf16 a[76:79], v[120:123], v[52:55], a[76:79]
  v_mfma_f32_16x16x32_bf16 a[80:83], v[124:127], v[52:55], a[80:83]
  ds_read_b64_tr_b16 v[152:153], v25 offset:49152
  v_mfma_f32_16x16x32_bf16 a[84:87], v[128:131], v[52:55], a[84:87]
  v_mfma_f32_16x16x32_bf16 a[88:91], v[132:135], v[52:55], a[88:91]
  ds_read_b64_tr_b16 v[154:155], v25 offset:51200
  v_mfma_f32_16x16x32_bf16 a[92:95], v[136:139], v[52:55], a[92:95]
  v_mfma_f32_16x16x32_bf16 a[96:99], v[108:111], v[56:59], a[96:99]
  ds_read_b128 v[92:95], v19 offset:8192
  v_mfma_f32_16x16x32_bf16 a[100:103], v[112:115], v[56:59], a[100:103]
  v_mfma_f32_16x16x32_bf16 a[104:107], v[116:119], v[56:59], a[104:107]
  ds_read_b64_tr_b16 v[156:157], v26 offset:49152
  v_mfma_f32_16x16x32_bf16 a[108:111], v[120:123], v[56:59], a[108:111]
  v_mfma_f32_16x16x32_bf16 a[112:115], v[124:127], v[56:59], a[112:115]
  ds_read_b64_tr_b16 v[158:159], v26 offset:51200
  v_mfma_f32_16x16x32_bf16 a[116:119], v[128:131], v[56:59], a[116:119]
  v_mfma_f32_16x16x32_bf16 a[120:123], v[132:135], v[56:59], a[120:123]
  ds_read_b128 v[96:99], v19 offset:10240
  v_mfma_f32_16x16x32_bf16 a[124:127], v[136:139], v[56:59], a[124:127]
  v_mfma_f32_16x16x32_bf16 a[128:131], v[108:111], v[60:63], a[128:131]
  ds_read_b64_tr_b16 v[160:161], v27 offset:49152
  v_mfma_f32_16x16x32_bf16 a[132:135], v[112:115], v[60:63], a[132:135]
  v_mfma_f32_16x16x32_bf16 a[136:139], v[116:119], v[60:63], a[136:139]
  ds_read_b64_tr_b16 v[162:163], v27 offset:51200
  v_mfma_f32_16x16x32_bf16 a[140:143], v[120:123], v[60:63], a[140:143]
  v_mfma_f32_16x16x32_bf16 a[144:147], v[124:127], v[60:63], a[144:147]
  ds_read_b128 v[100:103], v19 offset:12288
  v_mfma_f32_16x16x32_bf16 a[148:151], v[128:131], v[60:63], a[148:151]
  v_mfma_f32_16x16x32_bf16 a[152:155], v[132:135], v[60:63], a[152:155]
  ds_read_b64_tr_b16 v[164:165], v28 offset:49152
  v_mfma_f32_16x16x32_bf16 a[156:159], v[136:139], v[60:63], a[156:159]
  v_mfma_f32_16x16x32_bf16 a[160:163], v[108:111], v[64:67], a[160:163]
  ds_read_b64_tr_b16 v[166:167], v28 offset:51200
  v_mfma_f32_16x16x32_bf16 a[164:167], v[112:115], v[64:67], a[164:167]
  v_mfma_f32_16x16x32_bf16 a[168:171], v[116:119], v[64:67], a[168:171]
  ds_read_b128 v[104:107], v19 offset:14336
  v_mfma_f32_16x16x32_bf16 a[172:175], v[120:123], v[64:67], a[172:175]
  v_mfma_f32_16x16x32_bf16 a[176:179], v[124:127], v[64:67], a[176:179]
  ds_read_b64_tr_b16 v[168:169], v29 offset:49152
  v_mfma_f32_16x16x32_bf16 a[180:183], v[128:131], v[64:67], a[180:183]
  v_mfma_f32_16x16x32_bf16 a[184:187], v[132:135], v[64:67], a[184:187]
  ds_read_b64_tr_b16 v[170:171], v29 offset:51200
  v_mfma_f32_16x16x32_bf16 a[188:191], v[136:139], v[64:67], a[188:191]
  v_mfma_f32_16x16x32_bf16 a[192:195], v[108:111], v[68:71], a[192:195]
  v_mfma_f32_16x16x32_bf16 a[196:199], v[112:115], v[68:71], a[196:199]
  v_mfma_f32_16x16x32_bf16 a[200:203], v[116:119], v[68:71], a[200:203]
  v_mfma_f32_16x16x32_bf16 a[204:207], v[120:123], v[68:71], a[204:207]
  v_mfma_f32_16x16x32_bf16 a[208:211], v[124:127], v[68:71], a[208:211]
  v_mfma_f32_16x16x32_bf16 a[212:215], v[128:131], v[68:71], a[212:215]
  v_mfma_f32_16x16x32_bf16 a[216:219], v[132:135], v[68:71], a[216:219]
  v_mfma_f32_16x16x32_bf16 a[220:223], v[136:139], v[68:71], a[220:223]
  v_mfma_f32_16x16x32_bf16 a[224:227], v[108:111], v[72:75], a[224:227]
  v_mfma_f32_16x16x32_bf16 a[228:231], v[112:115], v[72:75], a[228:231]
  v_mfma_f32_16x16x32_bf16 a[232:235], v[116:119], v[72:75], a[232:235]
  v_mfma_f32_16x16x32_bf16 a[236:239], v[120:123], v[72:75], a[236:239]
  v_mfma_f32_16x16x32_bf16 a[240:243], v[124:127], v[72:75], a[240:243]
  v_mfma_f32_16x16x32_bf16 a[244:247], v[128:131], v[72:75], a[244:247]
  v_mfma_f32_16x16x32_bf16 a[248:251], v[132:135], v[72:75], a[248:251]
  v_mfma_f32_16x16x32_bf16 a[252:255], v[136:139], v[72:75], a[252:255]
  s_waitcnt lgkmcnt(0)
  v_mfma_f32_16x16x32_bf16 a[0:3], v[140:143], v[76:79], a[0:3]
  s_waitcnt vmcnt(0)
  s_barrier
  s_add_u32 m0, s52, 0
  v_mfma_f32_16x16x32_bf16 a[4:7], v[144:147], v[76:79], a[4:7]
  buffer_load_dwordx4 v2, s[8:11], s20 offen  lds
  ds_read_b128 v[44:47], v20 offset:0
  v_mfma_f32_16x16x32_bf16 a[8:11], v[148:151], v[76:79], a[8:11]
  v_mfma_f32_16x16x32_bf16 a[12:15], v[152:155], v[76:79], a[12:15]
  ds_read_b64_tr_b16 v[108:109], v30 offset:32768
  s_add_u32 m0, s53, 0
  v_mfma_f32_16x16x32_bf16 a[16:19], v[156:159], v[76:79], a[16:19]
  buffer_load_dwordx4 v10, s[12:15], s21 offen  lds
  v_mfma_f32_16x16x32_bf16 a[20:23], v[160:163], v[76:79], a[20:23]
  ds_read_b64_tr_b16 v[110:111], v30 offset:34816
  v_mfma_f32_16x16x32_bf16 a[24:27], v[164:167], v[76:79], a[24:27]
  v_mfma_f32_16x16x32_bf16 a[28:31], v[168:171], v[76:79], a[28:31]
  ds_read_b128 v[48:51], v20 offset:2048
  s_add_u32 m0, s52, 1024
  v_mfma_f32_16x16x32_bf16 a[32:35], v[140:143], v[80:83], a[32:35]
  buffer_load_dwordx4 v3, s[8:11], s20 offen  lds
  v_mfma_f32_16x16x32_bf16 a[36:39], v[144:147], v[80:83], a[36:39]
  ds_read_b64_tr_b16 v[112:113], v31 offset:32768
  v_mfma_f32_16x16x32_bf16 a[40:43], v[148:151], v[80:83], a[40:43]
  v_mfma_f32_16x16x32_bf16 a[44:47], v[152:155], v[80:83], a[44:47]
  ds_read_b64_tr_b16 v[114:115], v31 offset:34816
  s_add_u32 m0, s53, 1024
  v_mfma_f32_16x16x32_bf16 a[48:51], v[156:159], v[80:83], a[48:51]
  buffer_load_dwordx4 v11, s[12:15], s21 offen  lds
  v_mfma_f32_16x16x32_bf16 a[52:55], v[160:163], v[80:83], a[52:55]
  ds_read_b128 v[52:55], v20 offset:4096
  v_mfma_f32_16x16x32_bf16 a[56:59], v[164:167], v[80:83], a[56:59]
  s_add_u32 m0, s52, 2048
  v_mfma_f32_16x16x32_bf16 a[60:63], v[168:171], v[80:83], a[60:63]
  buffer_load_dwordx4 v4, s[8:11], s20 offen  lds
  ds_read_b64_tr_b16 v[116:117], v32 offset:32768
  v_mfma_f32_16x16x32_bf16 a[64:67], v[140:143], v[84:87], a[64:67]
  v_mfma_f32_16x16x32_bf16 a[68:71], v[144:147], v[84:87], a[68:71]
  ds_read_b64_tr_b16 v[118:119], v32 offset:34816
  v_mfma_f32_16x16x32_bf16 a[72:75], v[148:151], v[84:87], a[72:75]
  s_add_u32 m0, s53, 2048
  v_mfma_f32_16x16x32_bf16 a[76:79], v[152:155], v[84:87], a[76:79]
  buffer_load_dwordx4 v12, s[12:15], s21 offen  lds
  ds_read_b128 v[56:59], v20 offset:6144
  v_mfma_f32_16x16x32_bf16 a[80:83], v[156:159], v[84:87], a[80:83]
  v_mfma_f32_16x16x32_bf16 a[84:87], v[160:163], v[84:87], a[84:87]
  ds_read_b64_tr_b16 v[120:121], v33 offset:32768
  v_mfma_f32_16x16x32_bf16 a[88:91], v[164:167], v[84:87], a[88:91]
  s_add_u32 m0, s52, 3072
  v_mfma_f32_16x16x32_bf16 a[92:95], v[168:171], v[84:87], a[92:95]
  buffer_load_dwordx4 v5, s[8:11], s20 offen  lds
  ds_read_b64_tr_b16 v[122:123], v33 offset:34816
  v_mfma_f32_16x16x32_bf16 a[96:99], v[140:143], v[88:91], a[96:99]
  v_mfma_f32_16x16x32_bf16 a[100:103], v[144:147], v[88:91], a[100:103]
  ds_read_b128 v[60:63], v20 offset:8192
  s_add_u32 m0, s53, 3072
  v_mfma_f32_16x16x32_bf16 a[104:107], v[148:151], v[88:91], a[104:107]
  buffer_load_dwordx4 v13, s[12:15], s21 offen  lds
  v_mfma_f32_16x16x32_bf16 a[108:111], v[152:155], v[88:91], a[108:111]
  ds_read_b64_tr_b16 v[124:125], v34 offset:32768
  v_mfma_f32_16x16x32_bf16 a[112:115], v[156:159], v[88:91], a[112:115]
  v_mfma_f32_16x16x32_bf16 a[116:119], v[160:163], v[88:91], a[116:119]
  ds_read_b64_tr_b16 v[126:127], v34 offset:34816
  s_add_u32 m0, s52, 4096
  v_mfma_f32_16x16x32_bf16 a[120:123], v[164:167], v[88:91], a[120:123]
  buffer_load_dwordx4 v6, s[8:11], s20 offen  lds
  v_mfma_f32_16x16x32_bf16 a[124:127], v[168:171], v[88:91], a[124:127]
  ds_read_b128 v[64:67], v20 offset:10240
  v_mfma_f32_16x16x32_bf16 a[128:131], v[140:143], v[92:95], a[128:131]
  v_mfma_f32_16x16x32_bf16 a[132:135], v[144:147], v[92:95], a[132:135]
  ds_read_b64_tr_b16 v[128:129], v35 offset:32768
  s_add_u32 m0, s53, 4096
  v_mfma_f32_16x16x32_bf16 a[136:139], v[148:151], v[92:95], a[136:139]
  buffer_load_dwordx4 v14, s[12:15], s21 offen  lds
  v_mfma_f32_16x16x32_bf16 a[140:143], v[152:155], v[92:95], a[140:143]
  ds_read_b64_tr_b16 v[130:131], v35 offset:34816
  v_mfma_f32_16x16x32_bf16 a[144:147], v[156:159], v[92:95], a[144:147]
  v_mfma_f32_16x16x32_bf16 a[148:151], v[160:163], v[92:95], a[148:151]
  ds_read_b128 v[68:71], v20 offset:12288
  s_add_u32 m0, s52, 5120
  v_mfma_f32_16x16x32_bf16 a[152:155], v[164:167], v[92:95], a[152:155]
  buffer_load_dwordx4 v7, s[8:11], s20 offen  lds
  v_mfma_f32_16x16x32_bf16 a[156:159], v[168:171], v[92:95], a[156:159]
  ds_read_b64_tr_b16 v[132:133], v36 offset:32768
  v_mfma_f32_16x16x32_bf16 a[160:163], v[140:143], v[96:99], a[160:163]
  s_add_u32 m0, s53, 5120
  v_mfma_f32_16x16x32_bf16 a[164:167], v[144:147], v[96:99], a[164:167]
  buffer_load_dwordx4 v15, s[12:15], s21 offen  lds
  ds_read_b64_tr_b16 v[134:135], v36 offset:34816
  v_mfma_f32_16x16x32_bf16 a[168:171], v[148:151], v[96:99], a[168:171]
  v_mfma_f32_16x16x32_bf16 a[172:175], v[152:155], v[96:99], a[172:175]
  ds_read_b128 v[72:75], v20 offset:14336
  v_mfma_f32_16x16x32_bf16 a[176:179], v[156:159], v[96:99], a[176:179]
  s_add_u32 m0, s52, 6144
  v_mfma_f32_16x16x32_bf16 a[180:183], v[160:163], v[96:99], a[180:183]
  buffer_load_dwordx4 v8, s[8:11], s20 offen  lds
  ds_read_b64_tr_b16 v[136:137], v37 offset:32768
  v_mfma_f32_16x16x32_bf16 a[184:187], v[164:167], v[96:99], a[184:187]
  v_mfma_f32_16x16x32_bf16 a[188:191], v[168:171], v[96:99], a[188:191]
  ds_read_b64_tr_b16 v[138:139], v37 offset:34816
  v_mfma_f32_16x16x32_bf16 a[192:195], v[140:143], v[100:103], a[192:195]
  s_add_u32 m0, s53, 6144
  v_mfma_f32_16x16x32_bf16 a[196:199], v[144:147], v[100:103], a[196:199]
  buffer_load_dwordx4 v16, s[12:15], s21 offen  lds
  v_mfma_f32_16x16x32_bf16 a[200:203], v[148:151], v[100:103], a[200:203]
  v_mfma_f32_16x16x32_bf16 a[204:207], v[152:155], v[100:103], a[204:207]
  s_add_u32 m0, s52, 7168
  v_mfma_f32_16x16x32_bf16 a[208:211], v[156:159], v[100:103], a[208:211]
  buffer_load_dwordx4 v9, s[8:11], s20 offen  lds
  v_mfma_f32_16x16x32_bf16 a[212:215], v[160:163], v[100:103], a[212:215]
  v_mfma_f32_16x16x32_bf16 a[216:219], v[164:167], v[100:103], a[216:219]
  v_mfma_f32_16x16x32_bf16 a[220:223], v[168:171], v[100:103], a[220:223]
  s_add_u32 m0, s53, 7168
  v_mfma_f32_16x16x32_bf16 a[224:227], v[140:143], v[104:107], a[224:227]
  buffer_load_dwordx4 v17, s[12:15], s21 offen  lds
  v_mfma_f32_16x16x32_bf16 a[228:231], v[144:147], v[104:107], a[228:231]
  v_mfma_f32_16x16x32_bf16 a[232:235], v[148:151], v[104:107], a[232:235]
  v_mfma_f32_16x16x32_bf16 a[236:239], v[152:155], v[104:107], a[236:239]
  s_add_u32 s20, s20, 128
  v_mfma_f32_16x16x32_bf16 a[240:243], v[156:159], v[104:107], a[240:243]
  s_add_u32 s21, s21, s51
  v_mfma_f32_16x16x32_bf16 a[244:247], v[160:163], v[104:107], a[244:247]
  v_mfma_f32_16x16x32_bf16 a[248:251], v[164:167], v[104:107], a[248:251]
  v_mfma_f32_16x16x32_bf16 a[252:255], v[168:171], v[104:107], a[252:255]
  s_waitcnt lgkmcnt(0)
  s_cmp_eq_u32 s25, 1
  s_cbranch_scc1 L_g1_cw
L_g1_cwb:
  v_mfma_f32_16x16x32_bf16 a[0:3], v[108:111], v[44:47], a[0:3]
  ds_read_b128 v[76:79], v21 offset:0
  v_mfma_f32_16x16x32_bf16 a[4:7], v[112:115], v[44:47], a[4:7]
  v_mfma_f32_16x16x32_bf16 a[8:11], v[116:119], v[44:47], a[8:11]
  ds_read_b64_tr_b16 v[140:141], v30 offset:49152
  v_mfma_f32_16x16x32_bf16 a[12:15], v[120:123], v[44:47], a[12:15]
  v_mfma_f32_16x16x32_bf16 a[16:19], v[124:127], v[44:47], a[16:19]
  ds_read_b64_tr_b16 v[142:143], v30 offset:51200
  v_mfma_f32_16x16x32_bf16 a[20:23], v[128:131], v[44:47], a[20:23]
  v_mfma_f32_16x16x32_bf16 a[24:27], v[132:135], v[44:47], a[24:27]
  ds_read_b128 v[80:83], v21 offset:2048
  v_mfma_f32_16x16x32_bf16 a[28:31], v[136:139], v[44:47], a[28:31]
  v_mfma_f32_16x16x32_bf16 a[32:35], v[108:111], v[48:51], a[32:35]
  ds_read_b64_tr_b16 v[144:145], v31 offset:49152
  v_mfma_f32_16x16x32_bf16 a[36:39], v[112:115], v[48:51], a[36:39]
  v_mfma_f32_16x16x32_bf16 a[40:43], v[116:119], v[48:51], a[40:43]
  ds_read_b64_tr_b16 v[146:147], v31 offset:51200
  v_mfma_f32_16x16x32_bf16 a[44:47], v[120:123], v[48:51], a[44:47]
  v_mfma_f32_16x16x32_bf16 a[48:51], v[124:127], v[48:51], a[48:51]
  ds_read_b128 v[84:87], v21 offset:4096
  v_mfma_f32_16x16x32_bf16 a[52:55], v[128:131], v[48:51], a[52:55]
  v_mfma_f32_16x16x32_bf16 a[56:59], v[132:135], v[48:51], a[56:59]
  ds_read_b64_tr_b16 v[148:149], v32 offset:49152
  v_mfma_f32_16x16x32_bf16 a[60:63], v[136:139], v[48:51], a[60:63]
  v_mfma_f32_16x16x32_bf16 a[64:67], v[108:111], v[52:55], a[64:67]
  ds_read_b64_tr_b16 v[150:151], v32 offset:51200
  v_mfma_f32_16x16x32_bf16 a[68:71], v[112:115], v[52:55], a[68:71]
  v_mfma_f32_16x16x32_bf16 a[72:75], v[116:119], v[52:55], a[72:75]
  ds_read_b128 v[88:91], v21 offset:6144
  v_mfma_f32_16x16x32_bf16 a[76:79], v[120:123], v[52:55], a[76:79]
  v_mfma_f32_16x16x32_bf16 a[80:83], v[124:127], v[52:55], a[80:83]
  ds_read_b64_tr_b16 v[152:153], v33 offset:49152
  v_mfma_f32_16x16x32_bf16 a[84:87], v[128:131], v[52:55], a[84:87]
  v_mfma_f32_16x16x32_bf16 a[88:91], v[132:135], v[52:55], a[88:91]
  ds_read_b64_tr_b16 v[154:155], v33 offset:51200
  v_mfma_f32_16x16x32_bf16 a[92:95], v[136:139], v[52:55], a[92:95]
  v_mfma_f32_16x16x32_bf16 a[96:99], v[108:111], v[56:59], a[96:99]
  ds_read_b128 v[92:95], v21 offset:8192
  v_mfma_f32_16x16x32_bf16 a[100:103], v[112:115], v[56:59], a[100:103]
  v_mfma_f32_16x16x32_bf16 a[104:107], v[116:119], v[56:59], a[104:107]
  ds_read_b64_tr_b16 v[156:157], v34 offset:49152
  v_mfma_f32_16x16x32_bf16 a[108:111], v[120:123], v[56:59], a[108:111]
  v_mfma_f32_16x16x32_bf16 a[112:115], v[124:127], v[56:59], a[112:115]
  ds_read_b64_tr_b16 v[158:159], v34 offset:51200
  v_mfma_f32_16x16x32_bf16 a[116:119], v[128:131], v[56:59], a[116:119]
  v_mfma_f32_16x16x32_bf16 a[120:123], v[132:135], v[56:59], a[120:123]
  ds_read_b128 v[96:99], v21 offset:10240
  v_mfma_f32_16x16x32_bf16 a[124:127], v[136:139], v[56:59], a[124:127]
  v_mfma_f32_16x16x32_bf16 a[128:131], v[108:111], v[60:63], a[128:131]
  ds_read_b64_tr_b16 v[160:161], v35 offset:49152
  v_mfma_f32_16x16x32_bf16 a[132:135], v[112:115], v[60:63], a[132:135]
  v_mfma_f32_16x16x32_bf16 a[136:139], v[116:119], v[60:63], a[136:139]
  ds_read_b64_tr_b16 v[162:163], v35 offset:51200
  v_mfma_f32_16x16x32_bf16 a[140:143], v[120:123], v[60:63], a[140:143]
  v_mfma_f32_16x16x32_bf16 a[144:147], v[124:127], v[60:63], a[144:147]
  ds_read_b128 v[100:103], v21 offset:12288
  v_mfma_f32_16x16x32_bf16 a[148:151], v[128:131], v[60:63], a[148:151]
  v_mfma_f32_16x16x32_bf16 a[152:155], v[132:135], v[60:63], a[152:155]
  ds_read_b64_tr_b16 v[164:165], v36 offset:49152
  v_mfma_f32_16x16x32_bf16 a[156:159], v[136:139], v[60:63], a[156:159]
  v_mfma_f32_16x16x32_bf16 a[160:163], v[108:111], v[64:67], a[160:163]
  ds_read_b64_tr_b16 v[166:167], v36 offset:51200
  v_mfma_f32_16x16x32_bf16 a[164:167], v[112:115], v[64:67], a[164:167]
  v_mfma_f32_16x16x32_bf16 a[168:171], v[116:119], v[64:67], a[168:171]
  ds_read_b128 v[104:107], v21 offset:14336
  v_mfma_f32_16x16x32_bf16 a[172:175], v[120:123], v[64:67], a[172:175]
  v_mfma_f32_16x16x32_bf16 a[176:179], v[124:127], v[64:67], a[176:179]
  ds_read_b64_tr_b16 v[168:169], v37 offset:49152
  v_mfma_f32_16x16x32_bf16 a[180:183], v[128:131], v[64:67], a[180:183]
  v_mfma_f32_16x16x32_bf16 a[184:187], v[132:135], v[64:67], a[184:187]
  ds_read_b64_tr_b16 v[170:171], v37 offset:51200
  v_mfma_f32_16x16x32_bf16 a[188:191], v[136:139], v[64:67], a[188:191]
  v_mfma_f32_16x16x32_bf16 a[192:195], v[108:111], v[68:71], a[192:195]
  v_mfma_f32_16x16x32_bf16 a[196:199], v[112:115], v[68:71], a[196:199]
  v_mfma_f32_16x16x32_bf16 a[200:203], v[116:119], v[68:71], a[200:203]
  v_mfma_f32_16x16x32_bf16 a[204:207], v[120:123], v[68:71], a[204:207]
  v_mfma_f32_16x16x32_bf16 a[208:211], v[124:127], v[68:71], a[208:211]
  v_mfma_f32_16x16x32_bf16 a[212:215], v[128:131], v[68:71], a[212:215]
  v_mfma_f32_16x16x32_bf16 a[216:219], v[132:135], v[68:71], a[216:219]
  v_mfma_f32_16x16x32_bf16 a[220:223], v[136:139], v[68:71], a[220:223]
  v_mfma_f32_16x16x32_bf16 a[224:227], v[108:111], v[72:75], a[224:227]
  v_mfma_f32_16x16x32_bf16 a[228:231], v[112:115], v[72:75], a[228:231]
  v_mfma_f32_16x16x32_bf16 a[232:235], v[116:119], v[72:75], a[232:235]
  v_mfma_f32_16x16x32_bf16 a[236:239], v[120:123], v[72:75], a[236:239]
  v_mfma_f32_16x16x32_bf16 a[240:243], v[124:127], v[72:75], a[240:243]
  v_mfma_f32_16x16x32_bf16 a[244:247], v[128:131], v[72:75], a[244:247]
  v_mfma_f32_16x16x32_bf16 a[248:251], v[132:135], v[72:75], a[248:251]
  v_mfma_f32_16x16x32_bf16 a[252:255], v[136:139], v[72:75], a[252:255]
  s_waitcnt lgkmcnt(0)
  v_mfma_f32_16x16x32_bf16 a[0:3], v[140:143], v[76:79], a[0:3]
  s_waitcnt vmcnt(0)
  s_barrier
  s_cmp_le_u32 s25, 2
  s_cbranch_scc1 L_g1_cr
L_g1_crb:
  s_add_u32 m0, s52, 65536
  v_mfma_f32_16x16x32_bf16 a[4:7], v[144:147], v[76:79], a[4:7]
  buffer_load_dwordx4 v2, s[8:11], s20 offen  lds
  ds_read_b128 v[44:47], v18 offset:0
  v_mfma_f32_16x16x32_bf16 a[8:11], v[148:151], v[76:79], a[8:11]
  v_mfma_f32_16x16x32_bf16 a[12:15], v[152:155], v[76:79], a[12:15]
  ds_read_b64_tr_b16 v[108:109], v22 offset:32768
  s_add_u32 m0, s53, 65536
  v_mfma_f32_16x16x32_bf16 a[16:19], v[156:159], v[76:79], a[16:19]
  buffer_load_dwordx4 v10, s[12:15], s21 offen  lds
  v_mfma_f32_16x16x32_bf16 a[20:23], v[160:163], v[76:79], a[20:23]
  ds_read_b64_tr_b16 v[110:111], v22 offset:34816
  v_mfma_f32_16x16x32_bf16 a[24:27], v[164:167], v[76:79], a[24:27]
  v_mfma_f32_16x16x32_bf16 a[28:31], v[168:171], v[76:79], a[28:31]
  ds_read_b128 v[48:51], v18 offset:2048
  s_add_u32 m0, s52, 66560
  v_mfma_f32_16x16x32_bf16 a[32:35], v[140:143], v[80:83], a[32:35]
  buffer_load_dwordx4 v3, s[8:11], s20 offen  lds
  v_mfma_f32_16x16x32_bf16 a[36:39], v[144:147], v[80:83], a[36:39]
  ds_read_b64_tr_b16 v[112:113], v23 offset:32768
  v_mfma_f32_16x16x32_bf16 a[40:43], v[148:151], v[80:83], a[40:43]
  v_mfma_f32_16x16x32_bf16 a[44:47], v[152:155], v[80:83], a[44:47]
  ds_read_b64_tr_b16 v[114:115], v23 offset:34816
  s_add_u32 m0, s53, 66560
  v_mfma_f32_16x16x32_bf16 a[48:51], v[156:159], v[80:83], a[48:51]
  buffer_load_dwordx4 v11, s[12:15], s21 offen  lds
  v_mfma_f32_16x16x32_bf16 a[52:55], v[160:163], v[80:83], a[52:55]
  ds_read_b128 v[52:55], v18 offset:4096
  v_mfma_f32_16x16x32_bf16 a[56:59], v[164:167], v[80:83], a[56:59]
  s_add_u32 m0, s52, 67584
  v_mfma_f32_16x16x32_bf16 a[60:63], v[168:171], v[80:83], a[60:63]
  buffer_load_dwordx4 v4, s[8:11], s20 offen  lds
  ds_read_b64_tr_b16 v[116:117], v24 offset:32768
  v_mfma_f32_16x16x32_bf16 a[64:67], v[140:143], v[84:87], a[64:67]
  v_mfma_f32_16x16x32_bf16 a[68:71], v[144:147], v[84:87], a[68:71]
  ds_read_b64_tr_b16 v[118:119], v24 offset:34816
  v_mfma_f32_16x16x32_bf16 a[72:75], v[148:151], v[84:87], a[72:75]
  s_add_u32 m0, s53, 67584
  v_mfma_f32_16x16x32_bf16 a[76:79], v[152:155], v[84:87], a[76:79]
  buffer_load_dwordx4 v12, s[12:15], s21 offen  lds
  ds_read_b128 v[56:59], v18 offset:6144
  v_mfma_f32_16x16x32_bf16 a[80:83], v[156:159], v[84:87], a[80:83]
  v_mfma_f32_16x16x32_bf16 a[84:87], v[160:163], v[84:87], a[84:87]
  ds_read_b64_tr_b16 v[120:121], v25 offset:32768
  v_mfma_f32_16x16x32_bf16 a[88:91], v[164:167], v[84:87], a[88:91]
  s_add_u32 m0, s52, 68608
  v_mfma_f32_16x16x32_bf16 a[92:95], v[168:171], v[84:87], a[92:95]
  buffer_load_dwordx4 v5, s[8:11], s20 offen  lds
  ds_read_b64_tr_b16 v[122:123], v25 offset:34816
  v_mfma_f32_16x16x32_bf16 a[96:99], v[140:143], v[88:91], a[96:99]
  v_mfma_f32_16x16x32_bf16 a[100:103], v[144:147], v[88:91], a[100:103]
  ds_read_b128 v[60:63], v18 offset:8192
  s_add_u32 m0, s53, 68608
  v_mfma_f32_16x16x32_bf16 a[104:107], v[148:151], v[88:91], a[104:107]
  buffer_load_dwordx4 v13, s[12:15], s21 offen  lds
  v_mfma_f32_16x16x32_bf16 a[108:111], v[152:155], v[88:91], a[108:111]
  ds_read_b64_tr_b16 v[124:125], v26 offset:32768
  v_mfma_f32_16x16x32_bf16 a[112:115], v[156:159], v[88:91], a[112:115]
  v_mfma_f32_16x16x32_bf16 a[116:119], v[160:163], v[88:91], a[116:119]
  ds_read_b64_tr_b16 v[126:127], v26 offset:34816
  s_add_u32 m0, s52, 69632
  v_mfma_f32_16x16x32_bf16 a[120:123], v[164:167], v[88:91], a[120:123]
  buffer_load_dwordx4 v6, s[8:11], s20 offen  lds
  v_mfma_f32_16x16x32_bf16 a[124:127], v[168:171], v[88:91], a[124:127]
  ds_read_b128 v[64:67], v18 offset:10240
  v_mfma_f32_16x16x32_bf16 a[128:131], v[140:143], v[92:95], a[128:131]
  v_mfma_f32_16x16x32_bf16 a[132:135], v[144:147], v[92:95], a[132:135]
  ds_read_b64_tr_b16 v[128:129], v27 offset:32768
  s_add_u32 m0, s53, 69632
  v_mfma_f32_16x16x32_bf16 a[136:139], v[148:151], v[92:95], a[136:139]
  buffer_load_dwordx4 v14, s[12:15], s21 offen  lds
  v_mfma_f32_16x16x32_bf16 a[140:143], v[152:155], v[92:95], a[140:143]
  ds_read_b64_tr_b16 v[130:131], v27 offset:34816
  v_mfma_f32_16x16x32_bf16 a[144:147], v[156:159], v[92:95], a[144:147]
  v_mfma_f32_16x16x32_bf16 a[148:151], v[160:163], v[92:95], a[148:151]
  ds_read_b128 v[68:71], v18 offset:12288
  s_add_u32 m0, s52, 70656
  v_mfma_f32_16x16x32_bf16 a[152:155], v[164:167], v[92:95], a[152:155]
  buffer_load_dwordx4 v7, s[8:11], s20 offen  lds
  v_mfma_f32_16x16x32_bf16 a[156:159], v[168:171], v[92:95], a[156:159]
  ds_read_b64_tr_b16 v[132:133], v28 offset:32768
  v_mfma_f32_16x16x32_bf16 a[160:163], v[140:143], v[96:99], a[160:163]
  s_add_u32 m0, s53, 70656
  v_mfma_f32_16x16x32_bf16 a[164:167], v[144:147], v[96:99], a[164:167]
  buffer_load_dwordx4 v15, s[12:15], s21 offen  lds
  ds_read_b64_tr_b16 v[134:135], v28 offset:34816
  v_mfma_f32_16x16x32_bf16 a[168:171], v[148:151], v[96:99], a[168:171]
  v_mfma_f32_16x16x32_bf16 a[172:175], v[152:155], v[96:99], a[172:175]
  ds_read_b128 v[72:75], v18 offset:14336
  v_mfma_f32_16x16x32_bf16 a[176:179], v[156:159], v[96:99], a[176:179]
  s_add_u32 m0, s52, 71680
  v_mfma_f32_16x16x32_bf16 a[180:183], v[160:163], v[96:99], a[180:183]
  buffer_load_dwordx4 v8, s[8:11], s20 offen  lds
  ds_read_b64_tr_b16 v[136:137], v29 offset:32768
  v_mfma_f32_16x16x32_bf16 a[184:187], v[164:167], v[96:99], a[184:187]
  v_mfma_f32_16x16x32_bf16 a[188:191], v[168:171], v[96:99], a[188:191]
  ds_read_b64_tr_b16 v[138:139], v29 offset:34816
  v_mfma_f32_16x16x32_bf16 a[192:195], v[140:143], v[100:103], a[192:195]
  s_add_u32 m0, s53, 71680
  v_mfma_f32_16x16x32_bf16 a[196:199], v[144:147], v[100:103], a[196:199]
  buffer_load_dwordx4 v16, s[12:15], s21 offen  lds
  v_mfma_f32_16x16x32_bf16 a[200:203], v[148:151], v[100:103], a[200:203]
  v_mfma_f32_16x16x32_bf16 a[204:207], v[152:155], v[100:103], a[204:207]
  s_add_u32 m0, s52, 72704
  v_mfma_f32_16x16x32_bf16 a[208:211], v[156:159], v[100:103], a[208:211]
  buffer_load_dwordx4 v9, s[8:11], s20 offen  lds
  v_mfma_f32_16x16x32_bf16 a[212:215], v[160:163], v[100:103], a[212:215]
  v_mfma_f32_16x16x32_bf16 a[216:219], v[164:167], v[100:103], a[216:219]
  v_mfma_f32_16x16x32_bf16 a[220:223], v[168:171], v[100:103], a[220:223]
  s_add_u32 m0, s53, 72704
  v_mfma_f32_16x16x32_bf16 a[224:227], v[140:143], v[104:107], a[224:227]
  buffer_load_dwordx4 v17, s[12:15], s21 offen  lds
  v_mfma_f32_16x16x32_bf16 a[228:231], v[144:147], v[104:107], a[228:231]
  v_mfma_f32_16x16x32_bf16 a[232:235], v[148:151], v[104:107], a[232:235]
  v_mfma_f32_16x16x32_bf16 a[236:239], v[152:155], v[104:107], a[236:239]
  s_add_u32 s20, s20, 128
  v_mfma_f32_16x16x32_bf16 a[240:243], v[156:159], v[104:107], a[240:243]
  s_add_u32 s21, s21, s51
  v_mfma_f32_16x16x32_bf16 a[244:247], v[160:163], v[104:107], a[244:247]
  v_mfma_f32_16x16x32_bf16 a[248:251], v[164:167], v[104:107], a[248:251]
  v_mfma_f32_16x16x32_bf16 a[252:255], v[168:171], v[104:107], a[252:255]
  s_branch L_g1_loop
L_g1_fin:
  s_mov_b32 s59, 1
  s_mov_b32 s60, s22
  s_mov_b32 s61, s26
  s_add_u32 s62, s38, 0x3d00000
  s_mov_b32 s63, s98
  s_waitcnt lgkmcnt(0)
  v_min_u32 v245, 290, v246
  v_lshlrev_b32 v245, 2, v245
  v_add_u32 v245, 131264, v245
  ds_read_b32 v245, v245
  v_readfirstlane_b32 s34, v246
  s_add_u32 s34, s34, 32
  v_mfma_f32_16x16x32_bf16 a[0:3], v[108:111], v[44:47], a[0:3]
  ds_read_b128 v[76:79], v19 offset:0
  v_mfma_f32_16x16x32_bf16 a[4:7], v[112:115], v[44:47], a[4:7]
  v_mfma_f32_16x16x32_bf16 a[8:11], v[116:119], v[44:47], a[8:11]
  ds_read_b64_tr_b16 v[140:141], v22 offset:49152
  v_mfma_f32_16x16x32_bf16 a[12:15], v[120:123], v[44:47], a[12:15]
  v_mfma_f32_16x16x32_bf16 a[16:19], v[124:127], v[44:47], a[16:19]
  ds_read_b64_tr_b16 v[142:143], v22 offset:51200
  v_mfma_f32_16x16x32_bf16 a[20:23], v[128:131], v[44:47], a[20:23]
  v_mfma_f32_16x16x32_bf16 a[24:27], v[132:135], v[44:47], a[24:27]
  ds_read_b128 v[80:83], v19 offset:2048
  v_mfma_f32_16x16x32_bf16 a[28:31], v[136:139], v[44:47], a[28:31]
  v_mfma_f32_16x16x32_bf16 a[32:35], v[108:111], v[48:51], a[32:35]
  ds_read_b64_tr_b16 v[144:145], v23 offset:49152
  v_mfma_f32_16x16x32_bf16 a[36:39], v[112:115], v[48:51], a[36:39]
  v_mfma_f32_16x16x32_bf16 a[40:43], v[116:119], v[48:51], a[40:43]
  ds_read_b64_tr_b16 v[146:147], v23 offset:51200
  v_mfma_f32_16x16x32_bf16 a[44:47], v[120:123], v[48:51], a[44:47]
  v_mfma_f32_16x16x32_bf16 a[48:51], v[124:127], v[48:51], a[48:51]
  ds_read_b128 v[84:87], v19 offset:4096
  v_mfma_f32_16x16x32_bf16 a[52:55], v[128:131], v[48:51], a[52:55]
  v_mfma_f32_16x16x32_bf16 a[56:59], v[132:135], v[48:51], a[56:59]
  ds_read_b64_tr_b16 v[148:149], v24 offset:49152
  v_mfma_f32_16x16x32_bf16 a[60:63], v[136:139], v[48:51], a[60:63]
  v_mfma_f32_16x16x32_bf16 a[64:67], v[108:111], v[52:55], a[64:67]
  ds_read_b64_tr_b16 v[150:151], v24 offset:51200
  v_mfma_f32_16x16x32_bf16 a[68:71], v[112:115], v[52:55], a[68:71]
  v_mfma_f32_16x16x32_bf16 a[72:75], v[116:119], v[52:55], a[72:75]
  ds_read_b128 v[88:91], v19 offset:6144
  v_mfma_f32_16x16x32_bf16 a[76:79], v[120:123], v[52:55], a[76:79]
  v_mfma_f32_16x16x32_bf16 a[80:83], v[124:127], v[52:55], a[80:83]
  ds_read_b64_tr_b16 v[152:153], v25 offset:49152
  v_mfma_f32_16x16x32_bf16 a[84:87], v[128:131], v[52:55], a[84:87]
  v_mfma_f32_16x16x32_bf16 a[88:91], v[132:135], v[52:55], a[88:91]
  ds_read_b64_tr_b16 v[154:155], v25 offset:51200
  v_mfma_f32_16x16x32_bf16 a[92:95], v[136:139], v[52:55], a[92:95]
  v_mfma_f32_16x16x32_bf16 a[96:99], v[108:111], v[56:59], a[96:99]
  ds_read_b128 v[92:95], v19 offset:8192
  v_mfma_f32_16x16x32_bf16 a[100:103], v[112:115], v[56:59], a[100:103]
  v_mfma_f32_16x16x32_bf16 a[104:107], v[116:119], v[56:59], a[104:107]
  ds_read_b64_tr_b16 v[156:157], v26 offset:49152
  v_mfma_f32_16x16x32_bf16 a[108:111], v[120:123], v[56:59], a[108:111]
  v_mfma_f32_16x16x32_bf16 a[112:115], v[124:127], v[56:59], a[112:115]
  ds_read_b64_tr_b16 v[158:159], v26 offset:51200
  v_mfma_f32_16x16x32_bf16 a[116:119], v[128:131], v[56:59], a[116:119]
  v_mfma_f32_16x16x32_bf16 a[120:123], v[132:135], v[56:59], a[120:123]
  ds_read_b128 v[96:99], v19 offset:10240
  v_mfma_f32_16x16x32_bf16 a[124:127], v[136:139], v[56:59], a[124:127]
  v_mfma_f32_16x16x32_bf16 a[128:131], v[108:111], v[60:63], a[128:131]
  ds_read_b64_tr_b16 v[160:161], v27 offset:49152
  v_mfma_f32_16x16x32_bf16 a[132:135], v[112:115], v[60:63], a[132:135]
  v_mfma_f32_16x16x32_bf16 a[136:139], v[116:119], v[60:63], a[136:139]
  ds_read_b64_tr_b16 v[162:163], v27 offset:51200
  v_mfma_f32_16x16x32_bf16 a[140:143], v[120:123], v[60:63], a[140:143]
  v_mfma_f32_16x16x32_bf16 a[144:147], v[124:127], v[60:63], a[144:147]
  ds_read_b128 v[100:103], v19 offset:12288
  v_mfma_f32_16x16x32_bf16 a[148:151], v[128:131], v[60:63], a[148:151]
  v_mfma_f32_16x16x32_bf16 a[152:155], v[132:135], v[60:63], a[152:155]
  ds_read_b64_tr_b16 v[164:165], v28 offset:49152
  v_mfma_f32_16x16x32_bf16 a[156:159], v[136:139], v[60:63], a[156:159]
  v_mfma_f32_16x16x32_bf16 a[160:163], v[108:111], v[64:67], a[160:163]
  ds_read_b64_tr_b16 v[166:167], v28 offset:51200
  v_mfma_f32_16x16x32_bf16 a[164:167], v[112:115], v[64:67], a[164:167]
  v_mfma_f32_16x16x32_bf16 a[168:171], v[116:119], v[64:67], a[168:171]
  ds_read_b128 v[104:107], v19 offset:14336
  v_mfma_f32_16x16x32_bf16 a[172:175], v[120:123], v[64:67], a[172:175]
  v_mfma_f32_16x16x32_bf16 a[176:179], v[124:127], v[64:67], a[176:179]
  ds_read_b64_tr_b16 v[168:169], v29 offset:49152
  v_mfma_f32_16x16x32_bf16 a[180:183], v[128:131], v[64:67], a[180:183]
  v_mfma_f32_16x16x32_bf16 a[184:187], v[132:135], v[64:67], a[184:187]
  ds_read_b64_tr_b16 v[170:171], v29 offset:51200
  v_mfma_f32_16x16x32_bf16 a[188:191], v[136:139], v[64:67], a[188:191]
  v_mfma_f32_16x16x32_bf16 a[192:195], v[108:111], v[68:71], a[192:195]
  v_mfma_f32_16x16x32_bf16 a[196:199], v[112:115], v[68:71], a[196:199]
  v_mfma_f32_16x16x32_bf16 a[200:203], v[116:119], v[68:71], a[200:203]
  v_mfma_f32_16x16x32_bf16 a[204:207], v[120:123], v[68:71], a[204:207]
  v_mfma_f32_16x16x32_bf16 a[208:211], v[124:127], v[68:71], a[208:211]
  v_mfma_f32_16x16x32_bf16 a[212:215], v[128:131], v[68:71], a[212:215]
  v_mfma_f32_16x16x32_bf16 a[216:219], v[132:135], v[68:71], a[216:219]
  v_mfma_f32_16x16x32_bf16 a[220:223], v[136:139], v[68:71], a[220:223]
  v_mfma_f32_16x16x32_bf16 a[224:227], v[108:111], v[72:75], a[224:227]
  v_mfma_f32_16x16x32_bf16 a[228:231], v[112:115], v[72:75], a[228:231]
  v_mfma_f32_16x16x32_bf16 a[232:235], v[116:119], v[72:75], a[232:235]
  v_mfma_f32_16x16x32_bf16 a[236:239], v[120:123], v[72:75], a[236:239]
  v_mfma_f32_16x16x32_bf16 a[240:243], v[124:127], v[72:75], a[240:243]
  v_mfma_f32_16x16x32_bf16 a[244:247], v[128:131], v[72:75], a[244:247]
  v_mfma_f32_16x16x32_bf16 a[248:251], v[132:135], v[72:75], a[248:251]
  v_mfma_f32_16x16x32_bf16 a[252:255], v[136:139], v[72:75], a[252:255]
  s_waitcnt lgkmcnt(0)
  v_mfma_f32_16x16x32_bf16 a[0:3], v[140:143], v[76:79], a[0:3]
  s_waitcnt vmcnt(0)
  s_barrier
  v_readfirstlane_b32 s91, v245
  s_and_b32 s35, s91, 255
  s_lshr_b32 s36, s91, 8
  s_and_b32 s36, s36, 255
  s_lshr_b32 s37, s91, 16
  s_mov_b32 s92, s24
  s_cmp_gt_u32 s35, 3
  s_cbranch_scc1 L_cd_10
  s_cmp_eq_u32 s35, 3
  s_cbranch_scc1 L_cd_8
  s_mov_b32 s8, s64
  s_and_b32 s9, s65, 0xffff
  s_mov_b32 s10, 0x400000
  s_mov_b32 s11, 0x20000
  s_cmp_eq_u32 s35, 0
  s_cselect_b64 s[88:89], s[68:69], s[70:71]
  s_cmp_eq_u32 s35, 2
  s_cselect_b64 s[88:89], s[72:73], s[88:89]
  s_mov_b32 s12, s88
  s_and_b32 s13, s89, 0xffff
  s_mov_b32 s14, 0x800000
  s_mov_b32 s15, 0x20000
  s_lshl_b32 s91, s33, 2
  s_add_u32 s91, s91, s37
  s_mov_b32 s24, 8192
  s_mov_b32 s26, 262144
  s_lshl_b32 s20, s36, 19
  s_lshl_b32 s21, s91, 9
  s_lshl_b32 s22, s35, 24
  s_lshl_b32 s90, s36, 21
  s_add_u32 s22, s22, s90
  s_lshl_b32 s90, s91, 14
  s_add_u32 s22, s22, s90
  s_lshl_b32 s38, s36, 9
  s_add_u32 s38, s38, 28672
  s_cmp_eq_u32 s35, 0
  s_cselect_b32 s38, 8192, s38
  s_cselect_b32 s98, 1, 2
  s_mov_b32 s48, s35
  s_branch L_cd_9
L_cd_10:
  s_mov_b64 vcc, 0
  s_mov_b32 s58, 0
  s_branch L_cd_11
L_cd_8:
  s_mov_b32 s8, s78
  s_and_b32 s9, s79, 0xffff
  s_mov_b32 s10, 0x400000
  s_mov_b32 s11, 0x20000
  s_mov_b32 s12, s80
  s_and_b32 s13, s81, 0xffff
  s_mov_b32 s14, 0x600000
  s_mov_b32 s15, 0x20000
  s_lshl_b32 s91, s37, 2
  s_add_u32 s91, s91, s33
  s_mov_b32 s24, 6144
  s_mov_b32 s26, 65536
  s_lshl_b32 s20, s36, 19
  s_lshl_b32 s21, s91, 9
  s_lshl_b32 s22, s37, 22
  s_lshl_b32 s90, s36, 19
  s_add_u32 s22, s22, s90
  s_lshl_b32 s90, s33, 14
  s_add_u32 s22, s22, s90
  s_add_u32 s22, s22, 0x4000000
  s_mov_b32 s38, 12288
  s_mov_b32 s48, s37
  s_mov_b32 s98, 1
L_cd_9:
  s_lshl_b32 s90, s36, 9
  s_add_u32 s38, s38, s90
  s_lshl_b32 s90, s33, 7
  s_add_u32 s38, s38, s90
  s_mov_b32 s23, 2048
  s_mov_b32 s25, 8
  s_mov_b64 vcc, -1
  s_sub_i32 s92, s24, s92
  s_lshl_b32 s51, s24, 6
  v_mul_i32_i24 v38, s92, v174
  s_mul_i32 s92, s92, 2
  s_mov_b32 s93, 0
  v_add3_u32 v10, v10, v38, s93
  s_add_u32 s93, s93, s92
  v_add3_u32 v11, v11, v38, s93
  s_add_u32 s93, s93, s92
  v_add3_u32 v12, v12, v38, s93
  s_add_u32 s93, s93, s92
  v_add3_u32 v13, v13, v38, s93
  s_add_u32 s93, s93, s92
  v_add3_u32 v14, v14, v38, s93
  s_add_u32 s93, s93, s92
  v_add3_u32 v15, v15, v38, s93
  s_add_u32 s93, s93, s92
  v_add3_u32 v16, v16, v38, s93
  s_add_u32 s93, s93, s92
  v_add3_u32 v17, v17, v38, s93
  s_add_u32 s93, s93, s92
L_cd_11:
  s_add_u32 m0, s52, 0
  v_mfma_f32_16x16x32_bf16 a[4:7], v[144:147], v[76:79], a[4:7]
  s_cbranch_vccz L_gd_12
  buffer_load_dwordx4 v2, s[8:11], s20 offen  lds
L_gd_12:
  ds_read_b128 v[44:47], v20 offset:0
  v_mfma_f32_16x16x32_bf16 a[8:11], v[148:151], v[76:79], a[8:11]
  v_mfma_f32_16x16x32_bf16 a[12:15], v[152:155], v[76:79], a[12:15]
  ds_read_b64_tr_b16 v[108:109], v30 offset:32768
  s_add_u32 m0, s53, 0
  v_mfma_f32_16x16x32_bf16 a[16:19], v[156:159], v[76:79], a[16:19]
  s_cbranch_vccz L_gd_13
  buffer_load_dwordx4 v10, s[12:15], s21 offen  lds
L_gd_13:
  v_mfma_f32_16x16x32_bf16 a[20:23], v[160:163], v[76:79], a[20:23]
  ds_read_b64_tr_b16 v[110:111], v30 offset:34816
  v_mfma_f32_16x16x32_bf16 a[24:27], v[164:167], v[76:79], a[24:27]
  v_mfma_f32_16x16x32_bf16 a[28:31], v[168:171], v[76:79], a[28:31]
  ds_read_b128 v[48:51], v20 offset:2048
  s_add_u32 m0, s52, 1024
  v_mfma_f32_16x16x32_bf16 a[32:35], v[140:143], v[80:83], a[32:35]
  s_cbranch_vccz L_gd_14
  buffer_load_dwordx4 v3, s[8:11], s20 offen  lds
L_gd_14:
  v_mfma_f32_16x16x32_bf16 a[36:39], v[144:147], v[80:83], a[36:39]
  ds_read_b64_tr_b16 v[112:113], v31 offset:32768
  v_mfma_f32_16x16x32_bf16 a[40:43], v[148:151], v[80:83], a[40:43]
  v_mfma_f32_16x16x32_bf16 a[44:47], v[152:155], v[80:83], a[44:47]
  ds_read_b64_tr_b16 v[114:115], v31 offset:34816
  s_add_u32 m0, s53, 1024
  v_mfma_f32_16x16x32_bf16 a[48:51], v[156:159], v[80:83], a[48:51]
  s_cbranch_vccz L_gd_15
  buffer_load_dwordx4 v11, s[12:15], s21 offen  lds
L_gd_15:
  v_mfma_f32_16x16x32_bf16 a[52:55], v[160:163], v[80:83], a[52:55]
  ds_read_b128 v[52:55], v20 offset:4096
  v_mfma_f32_16x16x32_bf16 a[56:59], v[164:167], v[80:83], a[56:59]
  v_mfma_f32_16x16x32_bf16 a[60:63], v[168:171], v[80:83], a[60:63]
  ds_read_b64_tr_b16 v[116:117], v32 offset:32768
  s_add_u32 m0, s52, 2048
  v_mfma_f32_16x16x32_bf16 a[64:67], v[140:143], v[84:87], a[64:67]
  s_cbranch_vccz L_gd_16
  buffer_load_dwordx4 v4, s[8:11], s20 offen  lds
L_gd_16:
  v_mfma_f32_16x16x32_bf16 a[68:71], v[144:147], v[84:87], a[68:71]
  ds_read_b64_tr_b16 v[118:119], v32 offset:34816
  v_mfma_f32_16x16x32_bf16 a[72:75], v[148:151], v[84:87], a[72:75]
  v_mfma_f32_16x16x32_bf16 a[76:79], v[152:155], v[84:87], a[76:79]
  ds_read_b128 v[56:59], v20 offset:6144
  s_add_u32 m0, s53, 2048
  v_mfma_f32_16x16x32_bf16 a[80:83], v[156:159], v[84:87], a[80:83]
  s_cbranch_vccz L_gd_17
  buffer_load_dwordx4 v12, s[12:15], s21 offen  lds
L_gd_17:
  v_mfma_f32_16x16x32_bf16 a[84:87], v[160:163], v[84:87], a[84:87]
  ds_read_b64_tr_b16 v[120:121], v33 offset:32768
  v_mfma_f32_16x16x32_bf16 a[88:91], v[164:167], v[84:87], a[88:91]
  v_mfma_f32_16x16x32_bf16 a[92:95], v[168:171], v[84:87], a[92:95]
  ds_read_b64_tr_b16 v[122:123], v33 offset:34816
  s_add_u32 m0, s52, 3072
  v_mfma_f32_16x16x32_bf16 a[96:99], v[140:143], v[88:91], a[96:99]
  s_cbranch_vccz L_gd_18
  buffer_load_dwordx4 v5, s[8:11], s20 offen  lds
L_gd_18:
  v_mfma_f32_16x16x32_bf16 a[100:103], v[144:147], v[88:91], a[100:103]
  ds_read_b128 v[60:63], v20 offset:8192
  v_mfma_f32_16x16x32_bf16 a[104:107], v[148:151], v[88:91], a[104:107]
  v_mfma_f32_16x16x32_bf16 a[108:111], v[152:155], v[88:91], a[108:111]
  ds_read_b64_tr_b16 v[124:125], v34 offset:32768
  s_add_u32 m0, s53, 3072
  v_mfma_f32_16x16x32_bf16 a[112:115], v[156:159], v[88:91], a[112:115]
  s_cbranch_vccz L_gd_19
  buffer_load_dwordx4 v13, s[12:15], s21 offen  lds
L_gd_19:
  v_mfma_f32_16x16x32_bf16 a[116:119], v[160:163], v[88:91], a[116:119]
  ds_read_b64_tr_b16 v[126:127], v34 offset:34816
  v_mfma_f32_16x16x32_bf16 a[120:123], v[164:167], v[88:91], a[120:123]
  v_mfma_f32_16x16x32_bf16 a[124:127], v[168:171], v[88:91], a[124:127]
  ds_read_b128 v[64:67], v20 offset:10240
  s_add_u32 m0, s52, 4096
  v_mfma_f32_16x16x32_bf16 a[128:131], v[140:143], v[92:95], a[128:131]
  s_cbranch_vccz L_gd_20
  buffer_load_dwordx4 v6, s[8:11], s20 offen  lds
L_gd_20:
  v_mfma_f32_16x16x32_bf16 a[132:135], v[144:147], v[92:95], a[132:135]
  ds_read_b64_tr_b16 v[128:129], v35 offset:32768
  v_mfma_f32_16x16x32_bf16 a[136:139], v[148:151], v[92:95], a[136:139]
  v_mfma_f32_16x16x32_bf16 a[140:143], v[152:155], v[92:95], a[140:143]
  ds_read_b64_tr_b16 v[130:131], v35 offset:34816
  s_add_u32 m0, s53, 4096
  v_mfma_f32_16x16x32_bf16 a[144:147], v[156:159], v[92:95], a[144:147]
  s_cbranch_vccz L_gd_21
  buffer_load_dwordx4 v14, s[12:15], s21 offen  lds
L_gd_21:
  v_mfma_f32_16x16x32_bf16 a[148:151], v[160:163], v[92:95], a[148:151]
  ds_read_b128 v[68:71], v20 offset:12288
  v_mfma_f32_16x16x32_bf16 a[152:155], v[164:167], v[92:95], a[152:155]
  v_mfma_f32_16x16x32_bf16 a[156:159], v[168:171], v[92:95], a[156:159]
  ds_read_b64_tr_b16 v[132:133], v36 offset:32768
  s_add_u32 m0, s52, 5120
  v_mfma_f32_16x16x32_bf16 a[160:163], v[140:143], v[96:99], a[160:163]
  s_cbranch_vccz L_gd_22
  buffer_load_dwordx4 v7, s[8:11], s20 offen  lds
L_gd_22:
  v_mfma_f32_16x16x32_bf16 a[164:167], v[144:147], v[96:99], a[164:167]
  ds_read_b64_tr_b16 v[134:135], v36 offset:34816
  v_mfma_f32_16x16x32_bf16 a[168:171], v[148:151], v[96:99], a[168:171]
  v_mfma_f32_16x16x32_bf16 a[172:175], v[152:155], v[96:99], a[172:175]
  ds_read_b128 v[72:75], v20 offset:14336
  s_add_u32 m0, s53, 5120
  v_mfma_f32_16x16x32_bf16 a[176:179], v[156:159], v[96:99], a[176:179]
  s_cbranch_vccz L_gd_23
  buffer_load_dwordx4 v15, s[12:15], s21 offen  lds
L_gd_23:
  v_mfma_f32_16x16x32_bf16 a[180:183], v[160:163], v[96:99], a[180:183]
  ds_read_b64_tr_b16 v[136:137], v37 offset:32768
  v_mfma_f32_16x16x32_bf16 a[184:187], v[164:167], v[96:99], a[184:187]
  v_mfma_f32_16x16x32_bf16 a[188:191], v[168:171], v[96:99], a[188:191]
  ds_read_b64_tr_b16 v[138:139], v37 offset:34816
  s_add_u32 m0, s52, 6144
  v_mfma_f32_16x16x32_bf16 a[192:195], v[140:143], v[100:103], a[192:195]
  s_cbranch_vccz L_gd_24
  buffer_load_dwordx4 v8, s[8:11], s20 offen  lds
L_gd_24:
  v_mfma_f32_16x16x32_bf16 a[196:199], v[144:147], v[100:103], a[196:199]
  v_mfma_f32_16x16x32_bf16 a[200:203], v[148:151], v[100:103], a[200:203]
  v_mfma_f32_16x16x32_bf16 a[204:207], v[152:155], v[100:103], a[204:207]
  s_add_u32 m0, s53, 6144
  v_mfma_f32_16x16x32_bf16 a[208:211], v[156:159], v[100:103], a[208:211]
  s_cbranch_vccz L_gd_25
  buffer_load_dwordx4 v16, s[12:15], s21 offen  lds
L_gd_25:
  v_mfma_f32_16x16x32_bf16 a[212:215], v[160:163], v[100:103], a[212:215]
  v_mfma_f32_16x16x32_bf16 a[216:219], v[164:167], v[100:103], a[216:219]
  v_mfma_f32_16x16x32_bf16 a[220:223], v[168:171], v[100:103], a[220:223]
  s_add_u32 m0, s52, 7168
  v_mfma_f32_16x16x32_bf16 a[224:227], v[140:143], v[104:107], a[224:227]
  s_cbranch_vccz L_gd_26
  buffer_load_dwordx4 v9, s[8:11], s20 offen  lds
L_gd_26:
  v_mfma_f32_16x16x32_bf16 a[228:231], v[144:147], v[104:107], a[228:231]
  v_mfma_f32_16x16x32_bf16 a[232:235], v[148:151], v[104:107], a[232:235]
  v_mfma_f32_16x16x32_bf16 a[236:239], v[152:155], v[104:107], a[236:239]
  s_add_u32 m0, s53, 7168
  v_mfma_f32_16x16x32_bf16 a[240:243], v[156:159], v[104:107], a[240:243]
  s_cbranch_vccz L_gd_27
  buffer_load_dwordx4 v17, s[12:15], s21 offen  lds
  s_add_u32 s20, s20, 128
  s_add_u32 s21, s21, s51
L_gd_27:
  v_mfma_f32_16x16x32_bf16 a[244:247], v[160:163], v[104:107], a[244:247]
  v_mfma_f32_16x16x32_bf16 a[248:251], v[164:167], v[104:107], a[248:251]
  v_mfma_f32_16x16x32_bf16 a[252:255], v[168:171], v[104:107], a[252:255]
  s_waitcnt lgkmcnt(0)
  v_mfma_f32_16x16x32_bf16 a[0:3], v[108:111], v[44:47], a[0:3]
  ds_read_b128 v[76:79], v21 offset:0
  v_mfma_f32_16x16x32_bf16 a[4:7], v[112:115], v[44:47], a[4:7]
  v_mfma_f32_16x16x32_bf16 a[8:11], v[116:119], v[44:47], a[8:11]
  ds_read_b64_tr_b16 v[140:141], v30 offset:49152
  v_mfma_f32_16x16x32_bf16 a[12:15], v[120:123], v[44:47], a[12:15]
  v_mfma_f32_16x16x32_bf16 a[16:19], v[124:127], v[44:47], a[16:19]
  ds_read_b64_tr_b16 v[142:143], v30 offset:51200
  v_mfma_f32_16x16x32_bf16 a[20:23], v[128:131], v[44:47], a[20:23]
  v_mfma_f32_16x16x32_bf16 a[24:27], v[132:135], v[44:47], a[24:27]
  ds_read_b128 v[80:83], v21 offset:2048
  v_mfma_f32_16x16x32_bf16 a[28:31], v[136:139], v[44:47], a[28:31]
  v_mfma_f32_16x16x32_bf16 a[32:35], v[108:111], v[48:51], a[32:35]
  ds_read_b64_tr_b16 v[144:145], v31 offset:49152
  v_mfma_f32_16x16x32_bf16 a[36:39], v[112:115], v[48:51], a[36:39]
  v_mfma_f32_16x16x32_bf16 a[40:43], v[116:119], v[48:51], a[40:43]
  ds_read_b64_tr_b16 v[146:147], v31 offset:51200
  v_mfma_f32_16x16x32_bf16 a[44:47], v[120:123], v[48:51], a[44:47]
  v_mfma_f32_16x16x32_bf16 a[48:51], v[124:127], v[48:51], a[48:51]
  ds_read_b128 v[84:87], v21 offset:4096
  v_mfma_f32_16x16x32_bf16 a[52:55], v[128:131], v[48:51], a[52:55]
  v_mfma_f32_16x16x32_bf16 a[56:59], v[132:135], v[48:51], a[56:59]
  ds_read_b64_tr_b16 v[148:149], v32 offset:49152
  v_mfma_f32_16x16x32_bf16 a[60:63], v[136:139], v[48:51], a[60:63]
  v_mfma_f32_16x16x32_bf16 a[64:67], v[108:111], v[52:55], a[64:67]
  ds_read_b64_tr_b16 v[150:151], v32 offset:51200
  v_mfma_f32_16x16x32_bf16 a[68:71], v[112:115], v[52:55], a[68:71]
  v_mfma_f32_16x16x32_bf16 a[72:75], v[116:119], v[52:55], a[72:75]
  ds_read_b128 v[88:91], v21 offset:6144
  v_mfma_f32_16x16x32_bf16 a[76:79], v[120:123], v[52:55], a[76:79]
  v_mfma_f32_16x16x32_bf16 a[80:83], v[124:127], v[52:55], a[80:83]
  ds_read_b64_tr_b16 v[152:153], v33 offset:49152
  v_mfma_f32_16x16x32_bf16 a[84:87], v[128:131], v[52:55], a[84:87]
  v_mfma_f32_16x16x32_bf16 a[88:91], v[132:135], v[52:55], a[88:91]
  ds_read_b64_tr_b16 v[154:155], v33 offset:51200
  v_mfma_f32_16x16x32_bf16 a[92:95], v[136:139], v[52:55], a[92:95]
  v_mfma_f32_16x16x32_bf16 a[96:99], v[108:111], v[56:59], a[96:99]
  ds_read_b128 v[92:95], v21 offset:8192
  v_mfma_f32_16x16x32_bf16 a[100:103], v[112:115], v[56:59], a[100:103]
  v_mfma_f32_16x16x32_bf16 a[104:107], v[116:119], v[56:59], a[104:107]
  ds_read_b64_tr_b16 v[156:157], v34 offset:49152
  v_mfma_f32_16x16x32_bf16 a[108:111], v[120:123], v[56:59], a[108:111]
  v_mfma_f32_16x16x32_bf16 a[112:115], v[124:127], v[56:59], a[112:115]
  ds_read_b64_tr_b16 v[158:159], v34 offset:51200
  v_mfma_f32_16x16x32_bf16 a[116:119], v[128:131], v[56:59], a[116:119]
  v_mfma_f32_16x16x32_bf16 a[120:123], v[132:135], v[56:59], a[120:123]
  ds_read_b128 v[96:99], v21 offset:10240
  v_mfma_f32_16x16x32_bf16 a[124:127], v[136:139], v[56:59], a[124:127]
  v_mfma_f32_16x16x32_bf16 a[128:131], v[108:111], v[60:63], a[128:131]
  ds_read_b64_tr_b16 v[160:161], v35 offset:49152
  v_mfma_f32_16x16x32_bf16 a[132:135], v[112:115], v[60:63], a[132:135]
  v_mfma_f32_16x16x32_bf16 a[136:139], v[116:119], v[60:63], a[136:139]
  ds_read_b64_tr_b16 v[162:163], v35 offset:51200
  v_mfma_f32_16x16x32_bf16 a[140:143], v[120:123], v[60:63], a[140:143]
  v_mfma_f32_16x16x32_bf16 a[144:147], v[124:127], v[60:63], a[144:147]
  ds_read_b128 v[100:103], v21 offset:12288
  v_mfma_f32_16x16x32_bf16 a[148:151], v[128:131], v[60:63], a[148:151]
  v_mfma_f32_16x16x32_bf16 a[152:155], v[132:135], v[60:63], a[152:155]
  ds_read_b64_tr_b16 v[164:165], v36 offset:49152
  v_mfma_f32_16x16x32_bf16 a[156:159], v[136:139], v[60:63], a[156:159]
  v_mfma_f32_16x16x32_bf16 a[160:163], v[108:111], v[64:67], a[160:163]
  ds_read_b64_tr_b16 v[166:167], v36 offset:51200
  v_mfma_f32_16x16x32_bf16 a[164:167], v[112:115], v[64:67], a[164:167]
  v_mfma_f32_16x16x32_bf16 a[168:171], v[116:119], v[64:67], a[168:171]
  ds_read_b128 v[104:107], v21 offset:14336
  v_mfma_f32_16x16x32_bf16 a[172:175], v[120:123], v[64:67], a[172:175]
  v_mfma_f32_16x16x32_bf16 a[176:179], v[124:127], v[64:67], a[176:179]
  ds_read_b64_tr_b16 v[168:169], v37 offset:49152
  v_mfma_f32_16x16x32_bf16 a[180:183], v[128:131], v[64:67], a[180:183]
  v_mfma_f32_16x16x32_bf16 a[184:187], v[132:135], v[64:67], a[184:187]
  ds_read_b64_tr_b16 v[170:171], v37 offset:51200
  v_mfma_f32_16x16x32_bf16 a[188:191], v[136:139], v[64:67], a[188:191]
  v_mfma_f32_16x16x32_bf16 a[192:195], v[108:111], v[68:71], a[192:195]
  v_mfma_f32_16x16x32_bf16 a[196:199], v[112:115], v[68:71], a[196:199]
  v_mfma_f32_16x16x32_bf16 a[200:203], v[116:119], v[68:71], a[200:203]
  v_mfma_f32_16x16x32_bf16 a[204:207], v[120:123], v[68:71], a[204:207]
  v_mfma_f32_16x16x32_bf16 a[208:211], v[124:127], v[68:71], a[208:211]
  v_mfma_f32_16x16x32_bf16 a[212:215], v[128:131], v[68:71], a[212:215]
  v_mfma_f32_16x16x32_bf16 a[216:219], v[132:135], v[68:71], a[216:219]
  v_mfma_f32_16x16x32_bf16 a[220:223], v[136:139], v[68:71], a[220:223]
  v_mfma_f32_16x16x32_bf16 a[224:227], v[108:111], v[72:75], a[224:227]
  v_mfma_f32_16x16x32_bf16 a[228:231], v[112:115], v[72:75], a[228:231]
  v_mfma_f32_16x16x32_bf16 a[232:235], v[116:119], v[72:75], a[232:235]
  v_mfma_f32_16x16x32_bf16 a[236:239], v[120:123], v[72:75], a[236:239]
  v_mfma_f32_16x16x32_bf16 a[240:243], v[124:127], v[72:75], a[240:243]
  v_mfma_f32_16x16x32_bf16 a[244:247], v[128:131], v[72:75], a[244:247]
  v_mfma_f32_16x16x32_bf16 a[248:251], v[132:135], v[72:75], a[248:251]
  v_mfma_f32_16x16x32_bf16 a[252:255], v[136:139], v[72:75], a[252:255]
  s_waitcnt lgkmcnt(0)
  v_mfma_f32_16x16x32_bf16 a[0:3], v[140:143], v[76:79], a[0:3]
  s_barrier
  s_add_u32 m0, s52, 65536
  v_mfma_f32_16x16x32_bf16 a[4:7], v[144:147], v[76:79], a[4:7]
  s_cbranch_vccz L_gd_28
  buffer_load_dwordx4 v2, s[8:11], s20 offen  lds
L_gd_28:
  v_mfma_f32_16x16x32_bf16 a[8:11], v[148:151], v[76:79], a[8:11]
  v_mfma_f32_16x16x32_bf16 a[12:15], v[152:155], v[76:79], a[12:15]
  s_add_u32 m0, s53, 65536
  v_mfma_f32_16x16x32_bf16 a[16:19], v[156:159], v[76:79], a[16:19]
  s_cbranch_vccz L_gd_29
  buffer_load_dwordx4 v10, s[12:15], s21 offen  lds
L_gd_29:
  v_mfma_f32_16x16x32_bf16 a[20:23], v[160:163], v[76:79], a[20:23]
  v_mfma_f32_16x16x32_bf16 a[24:27], v[164:167], v[76:79], a[24:27]
  v_mfma_f32_16x16x32_bf16 a[28:31], v[168:171], v[76:79], a[28:31]
  s_add_u32 m0, s52, 66560
  v_mfma_f32_16x16x32_bf16 a[32:35], v[140:143], v[80:83], a[32:35]
  s_cbranch_vccz L_gd_30
  buffer_load_dwordx4 v3, s[8:11], s20 offen  lds
L_gd_30:
  v_mfma_f32_16x16x32_bf16 a[36:39], v[144:147], v[80:83], a[36:39]
  v_mfma_f32_16x16x32_bf16 a[40:43], v[148:151], v[80:83], a[40:43]
  v_mfma_f32_16x16x32_bf16 a[44:47], v[152:155], v[80:83], a[44:47]
  s_add_u32 m0, s53, 66560
  v_mfma_f32_16x16x32_bf16 a[48:51], v[156:159], v[80:83], a[48:51]
  s_cbranch_vccz L_gd_31
  buffer_load_dwordx4 v11, s[12:15], s21 offen  lds
L_gd_31:
  v_mfma_f32_16x16x32_bf16 a[52:55], v[160:163], v[80:83], a[52:55]
  v_mfma_f32_16x16x32_bf16 a[56:59], v[164:167], v[80:83], a[56:59]
  v_mfma_f32_16x16x32_bf16 a[60:63], v[168:171], v[80:83], a[60:63]
  s_add_u32 m0, s52, 67584
  v_mfma_f32_16x16x32_bf16 a[64:67], v[140:143], v[84:87], a[64:67]
  s_cbranch_vccz L_gd_32
  buffer_load_dwordx4 v4, s[8:11], s20 offen  lds
L_gd_32:
  v_mfma_f32_16x16x32_bf16 a[68:71], v[144:147], v[84:87], a[68:71]
  v_mfma_f32_16x16x32_bf16 a[72:75], v[148:151], v[84:87], a[72:75]
  v_mfma_f32_16x16x32_bf16 a[76:79], v[152:155], v[84:87], a[76:79]
  s_add_u32 m0, s53, 67584
  v_mfma_f32_16x16x32_bf16 a[80:83], v[156:159], v[84:87], a[80:83]
  s_cbranch_vccz L_gd_33
  buffer_load_dwordx4 v12, s[12:15], s21 offen  lds
L_gd_33:
  v_mfma_f32_16x16x32_bf16 a[84:87], v[160:163], v[84:87], a[84:87]
  v_mfma_f32_16x16x32_bf16 a[88:91], v[164:167], v[84:87], a[88:91]
  v_mfma_f32_16x16x32_bf16 a[92:95], v[168:171], v[84:87], a[92:95]
  s_add_u32 m0, s52, 68608
  v_mfma_f32_16x16x32_bf16 a[96:99], v[140:143], v[88:91], a[96:99]
  s_cbranch_vccz L_gd_34
  buffer_load_dwordx4 v5, s[8:11], s20 offen  lds
L_gd_34:
  v_mfma_f32_16x16x32_bf16 a[100:103], v[144:147], v[88:91], a[100:103]
  v_mfma_f32_16x16x32_bf16 a[104:107], v[148:151], v[88:91], a[104:107]
  v_mfma_f32_16x16x32_bf16 a[108:111], v[152:155], v[88:91], a[108:111]
  s_add_u32 m0, s53, 68608
  v_mfma_f32_16x16x32_bf16 a[112:115], v[156:159], v[88:91], a[112:115]
  s_cbranch_vccz L_gd_35
  buffer_load_dwordx4 v13, s[12:15], s21 offen  lds
L_gd_35:
  v_mfma_f32_16x16x32_bf16 a[116:119], v[160:163], v[88:91], a[116:119]
  v_mfma_f32_16x16x32_bf16 a[120:123], v[164:167], v[88:91], a[120:123]
  v_mfma_f32_16x16x32_bf16 a[124:127], v[168:171], v[88:91], a[124:127]
  s_add_u32 m0, s52, 69632
  v_mfma_f32_16x16x32_bf16 a[128:131], v[140:143], v[92:95], a[128:131]
  s_cbranch_vccz L_gd_36
  buffer_load_dwordx4 v6, s[8:11], s20 offen  lds
L_gd_36:
  v_mfma_f32_16x16x32_bf16 a[132:135], v[144:147], v[92:95], a[132:135]
  v_mfma_f32_16x16x32_bf16 a[136:139], v[148:151], v[92:95], a[136:139]
  v_mfma_f32_16x16x32_bf16 a[140:143], v[152:155], v[92:95], a[140:143]
  s_add_u32 m0, s53, 69632
  v_mfma_f32_16x16x32_bf16 a[144:147], v[156:159], v[92:95], a[144:147]
  s_cbranch_vccz L_gd_37
  buffer_load_dwordx4 v14, s[12:15], s21 offen  lds
L_gd_37:
  v_mfma_f32_16x16x32_bf16 a[148:151], v[160:163], v[92:95], a[148:151]
  v_mfma_f32_16x16x32_bf16 a[152:155], v[164:167], v[92:95], a[152:155]
  v_mfma_f32_16x16x32_bf16 a[156:159], v[168:171], v[92:95], a[156:159]
  s_add_u32 m0, s52, 70656
  v_mfma_f32_16x16x32_bf16 a[160:163], v[140:143], v[96:99], a[160:163]
  s_cbranch_vccz L_gd_38
  buffer_load_dwordx4 v7, s[8:11], s20 offen  lds
L_gd_38:
  v_mfma_f32_16x16x32_bf16 a[164:167], v[144:147], v[96:99], a[164:167]
  v_mfma_f32_16x16x32_bf16 a[168:171], v[148:151], v[96:99], a[168:171]
  v_mfma_f32_16x16x32_bf16 a[172:175], v[152:155], v[96:99], a[172:175]
  s_add_u32 m0, s53, 70656
  v_mfma_f32_16x16x32_bf16 a[176:179], v[156:159], v[96:99], a[176:179]
  s_cbranch_vccz L_gd_39
  buffer_load_dwordx4 v15, s[12:15], s21 offen  lds
L_gd_39:
  v_mfma_f32_16x16x32_bf16 a[180:183], v[160:163], v[96:99], a[180:183]
  v_mfma_f32_16x16x32_bf16 a[184:187], v[164:167], v[96:99], a[184:187]
  v_mfma_f32_16x16x32_bf16 a[188:191], v[168:171], v[96:99], a[188:191]
  s_add_u32 m0, s52, 71680
  v_mfma_f32_16x16x32_bf16 a[192:195], v[140:143], v[100:103], a[192:195]
  s_cbranch_vccz L_gd_40
  buffer_load_dwordx4 v8, s[8:11], s20 offen  lds
L_gd_40:
  v_mfma_f32_16x16x32_bf16 a[196:199], v[144:147], v[100:103], a[196:199]
  v_mfma_f32_16x16x32_bf16 a[200:203], v[148:151], v[100:103], a[200:203]
  v_mfma_f32_16x16x32_bf16 a[204:207], v[152:155], v[100:103], a[204:207]
  s_add_u32 m0, s53, 71680
  v_mfma_f32_16x16x32_bf16 a[208:211], v[156:159], v[100:103], a[208:211]
  s_cbranch_vccz L_gd_41
  buffer_load_dwordx4 v16, s[12:15], s21 offen  lds
L_gd_41:
  v_mfma_f32_16x16x32_bf16 a[212:215], v[160:163], v[100:103], a[212:215]
  v_mfma_f32_16x16x32_bf16 a[216:219], v[164:167], v[100:103], a[216:219]
  v_mfma_f32_16x16x32_bf16 a[220:223], v[168:171], v[100:103], a[220:223]
  s_add_u32 m0, s52, 72704
  v_mfma_f32_16x16x32_bf16 a[224:227], v[140:143], v[104:107], a[224:227]
  s_cbranch_vccz L_gd_42
  buffer_load_dwordx4 v9, s[8:11], s20 offen  lds
L_gd_42:
  v_mfma_f32_16x16x32_bf16 a[228:231], v[144:147], v[104:107], a[228:231]
  v_mfma_f32_16x16x32_bf16 a[232:235], v[148:151], v[104:107], a[232:235]
  v_mfma_f32_16x16x32_bf16 a[236:239], v[152:155], v[104:107], a[236:239]
  s_add_u32 m0, s53, 72704
  v_mfma_f32_16x16x32_bf16 a[240:243], v[156:159], v[104:107], a[240:243]
  s_cbranch_vccz L_gd_43
  buffer_load_dwordx4 v17, s[12:15], s21 offen  lds
  s_add_u32 s20, s20, 128
  s_add_u32 s21, s21, s51
L_gd_43:
  v_mfma_f32_16x16x32_bf16 a[244:247], v[160:163], v[104:107], a[244:247]
  v_mfma_f32_16x16x32_bf16 a[248:251], v[164:167], v[104:107], a[248:251]
  v_mfma_f32_16x16x32_bf16 a[252:255], v[168:171], v[104:107], a[252:255]
  s_cmp_eq_u32 s58, 1
  s_cbranch_scc1 L_epi
  s_branch L_have1
L_g1_cw:
  s_mov_b64 exec, 1
  ds_write_b32 v175, v244
  s_mov_b64 exec, -1
  s_branch L_g1_cwb
L_g1_cr:
  ds_read_b32 v246, v241
  s_cmp_eq_u32 s25, 1
  s_cbranch_scc1 L_g1_crb
  s_cmp_lg_u32 s32, 0
  s_cbranch_scc1 L_rq_44
  s_cmp_eq_u32 s39, 0
  s_cbranch_scc1 L_rq_44
  s_lshl_b32 s99, s33, 7
  s_add_u32 s99, s99, 0x3d00200
  v_mov_b32 v244, 1
  v_mov_b32 v245, 0
  s_mov_b64 exec, 1
  buffer_atomic_add v244, v245, s[4:7], s99 offen sc0 sc1
  s_mov_b64 exec, -1
L_rq_44:
  s_branch L_g1_crb
L_g2:
  s_waitcnt vmcnt(16)
  s_barrier
  ds_read_b128 v[44:47], v18 offset:0
  ds_read_b64_tr_b16 v[108:109], v22 offset:32768
  ds_read_b64_tr_b16 v[110:111], v22 offset:34816
  ds_read_b128 v[48:51], v18 offset:2048
  ds_read_b64_tr_b16 v[112:113], v23 offset:32768
  ds_read_b64_tr_b16 v[114:115], v23 offset:34816
  ds_read_b128 v[52:55], v18 offset:4096
  ds_read_b64_tr_b16 v[116:117], v24 offset:32768
  ds_read_b64_tr_b16 v[118:119], v24 offset:34816
  ds_read_b128 v[56:59], v18 offset:6144
  ds_read_b64_tr_b16 v[120:121], v25 offset:32768
  ds_read_b64_tr_b16 v[122:123], v25 offset:34816
  ds_read_b128 v[60:63], v18 offset:8192
  ds_read_b64_tr_b16 v[124:125], v26 offset:32768
  ds_read_b64_tr_b16 v[126:127], v26 offset:34816
  ds_read_b128 v[64:67], v18 offset:10240
  ds_read_b64_tr_b16 v[128:129], v27 offset:32768
  ds_read_b64_tr_b16 v[130:131], v27 offset:34816
  ds_read_b128 v[68:71], v18 offset:12288
  ds_read_b64_tr_b16 v[132:133], v28 offset:32768
  ds_read_b64_tr_b16 v[134:135], v28 offset:34816
  ds_read_b128 v[72:75], v18 offset:14336
  ds_read_b64_tr_b16 v[136:137], v29 offset:32768
  ds_read_b64_tr_b16 v[138:139], v29 offset:34816
  s_sub_u32 s25, s25, 1
  s_waitcnt lgkmcnt(0)
  s_nop 0
  v_mfma_f32_16x16x32_bf16 a[0:3], v[44:47], v[108:111], 0
  buffer_store_dwordx4 v[176:179], v172, s[4:7], s46 offen offset:0 sc1
  ds_read_b128 v[76:79], v19 offset:0
  v_mfma_f32_16x16x32_bf16 a[4:7], v[44:47], v[112:115], 0
  v_mfma_f32_16x16x32_bf16 a[8:11], v[44:47], v[116:119], 0
  ds_read_b64_tr_b16 v[140:141], v22 offset:49152
  v_mfma_f32_16x16x32_bf16 a[12:15], v[44:47], v[120:123], 0
  s_nop 0
  v_mfma_f32_16x16x32_bf16 a[16:19], v[44:47], v[124:127], 0
  buffer_store_dwordx4 v[180:183], v172, s[4:7], s46 offen offset:1024 sc1
  ds_read_b64_tr_b16 v[142:143], v22 offset:51200
  v_mfma_f32_16x16x32_bf16 a[20:23], v[44:47], v[128:131], 0
  v_mfma_f32_16x16x32_bf16 a[24:27], v[44:47], v[132:135], 0
  ds_read_b128 v[80:83], v19 offset:2048
  v_mfma_f32_16x16x32_bf16 a[28:31], v[44:47], v[136:139], 0
  s_nop 0
  v_mfma_f32_16x16x32_bf16 a[32:35], v[48:51], v[108:111], 0
  buffer_store_dwordx4 v[184:187], v172, s[4:7], s46 offen offset:2048 sc1
  ds_read_b64_tr_b16 v[144:145], v23 offset:49152
  v_mfma_f32_16x16x32_bf16 a[36:39], v[48:51], v[112:115], 0
  v_mfma_f32_16x16x32_bf16 a[40:43], v[48:51], v[116:119], 0
  ds_read_b64_tr_b16 v[146:147], v23 offset:51200
  v_mfma_f32_16x16x32_bf16 a[44:47], v[48:51], v[120:123], 0
  s_nop 0
  v_mfma_f32_16x16x32_bf16 a[48:51], v[48:51], v[124:127], 0
  buffer_store_dwordx4 v[188:191], v172, s[4:7], s46 offen offset:3072 sc1
  ds_read_b128 v[84:87], v19 offset:4096
  v_mfma_f32_16x16x32_bf16 a[52:55], v[48:51], v[128:131], 0
  v_mfma_f32_16x16x32_bf16 a[56:59], v[48:51], v[132:135], 0
  ds_read_b64_tr_b16 v[148:149], v24 offset:49152
  v_mfma_f32_16x16x32_bf16 a[60:63], v[48:51], v[136:139], 0
  s_nop 0
  v_mfma_f32_16x16x32_bf16 a[64:67], v[52:55], v[108:111], 0
  buffer_store_dwordx4 v[192:195], v173, s[4:7], s46 offen offset:0 sc1
  ds_read_b64_tr_b16 v[150:151], v24 offset:51200
  v_mfma_f32_16x16x32_bf16 a[68:71], v[52:55], v[112:115], 0
  v_mfma_f32_16x16x32_bf16 a[72:75], v[52:55], v[116:119], 0
  ds_read_b128 v[88:91], v19 offset:6144
  v_mfma_f32_16x16x32_bf16 a[76:79], v[52:55], v[120:123], 0
  s_nop 0
  v_mfma_f32_16x16x32_bf16 a[80:83], v[52:55], v[124:127], 0
  buffer_store_dwordx4 v[196:199], v173, s[4:7], s46 offen offset:1024 sc1
  ds_read_b64_tr_b16 v[152:153], v25 offset:49152
  v_mfma_f32_16x16x32_bf16 a[84:87], v[52:55], v[128:131], 0
  v_mfma_f32_16x16x32_bf16 a[88:91], v[52:55], v[132:135], 0
  ds_read_b64_tr_b16 v[154:155], v25 offset:51200
  v_mfma_f32_16x16x32_bf16 a[92:95], v[52:55], v[136:139], 0
  s_nop 0
  v_mfma_f32_16x16x32_bf16 a[96:99], v[56:59], v[108:111], 0
  buffer_store_dwordx4 v[200:203], v173, s[4:7], s46 offen offset:2048 sc1
  ds_read_b128 v[92:95], v19 offset:8192
  v_mfma_f32_16x16x32_bf16 a[100:103], v[56:59], v[112:115], 0
  v_mfma_f32_16x16x32_bf16 a[104:107], v[56:59], v[116:119], 0
  ds_read_b64_tr_b16 v[156:157], v26 offset:49152
  v_mfma_f32_16x16x32_bf16 a[108:111], v[56:59], v[120:123], 0
  s_nop 0
  v_mfma_f32_16x16x32_bf16 a[112:115], v[56:59], v[124:127], 0
  buffer_store_dwordx4 v[204:207], v173, s[4:7], s46 offen offset:3072 sc1
  ds_read_b64_tr_b16 v[158:159], v26 offset:51200
  v_mfma_f32_16x16x32_bf16 a[116:119], v[56:59], v[128:131], 0
  v_mfma_f32_16x16x32_bf16 a[120:123], v[56:59], v[132:135], 0
  ds_read_b128 v[96:99], v19 offset:10240
  v_mfma_f32_16x16x32_bf16 a[124:127], v[56:59], v[136:139], 0
  s_nop 0
  v_mfma_f32_16x16x32_bf16 a[128:131], v[60:63], v[108:111], 0
  buffer_store_dwordx4 v[208:211], v172, s[4:7], s47 offen offset:0 sc1
  ds_read_b64_tr_b16 v[160:161], v27 offset:49152
  v_mfma_f32_16x16x32_bf16 a[132:135], v[60:63], v[112:115], 0
  v_mfma_f32_16x16x32_bf16 a[136:139], v[60:63], v[116:119], 0
  ds_read_b64_tr_b16 v[162:163], v27 offset:51200
  v_mfma_f32_16x16x32_bf16 a[140:143], v[60:63], v[120:123], 0
  s_nop 0
  v_mfma_f32_16x16x32_bf16 a[144:147], v[60:63], v[124:127], 0
  buffer_store_dwordx4 v[212:215], v172, s[4:7], s47 offen offset:1024 sc1
  ds_read_b128 v[100:103], v19 offset:12288
  v_mfma_f32_16x16x32_bf16 a[148:151], v[60:63], v[128:131], 0
  v_mfma_f32_16x16x32_bf16 a[152:155], v[60:63], v[132:135], 0
  ds_read_b64_tr_b16 v[164:165], v28 offset:49152
  v_mfma_f32_16x16x32_bf16 a[156:159], v[60:63], v[136:139], 0
  s_nop 0
  v_mfma_f32_16x16x32_bf16 a[160:163], v[64:67], v[108:111], 0
  buffer_store_dwordx4 v[216:219], v172, s[4:7], s47 offen offset:2048 sc1
  ds_read_b64_tr_b16 v[166:167], v28 offset:51200
  v_mfma_f32_16x16x32_bf16 a[164:167], v[64:67], v[112:115], 0
  v_mfma_f32_16x16x32_bf16 a[168:171], v[64:67], v[116:119], 0
  ds_read_b128 v[104:107], v19 offset:14336
  v_mfma_f32_16x16x32_bf16 a[172:175], v[64:67], v[120:123], 0
  s_nop 0
  v_mfma_f32_16x16x32_bf16 a[176:179], v[64:67], v[124:127], 0
  buffer_store_dwordx4 v[220:223], v172, s[4:7], s47 offen offset:3072 sc1
  ds_read_b64_tr_b16 v[168:169], v29 offset:49152
  v_mfma_f32_16x16x32_bf16 a[180:183], v[64:67], v[128:131], 0
  v_mfma_f32_16x16x32_bf16 a[184:187], v[64:67], v[132:135], 0
  ds_read_b64_tr_b16 v[170:171], v29 offset:51200
  v_mfma_f32_16x16x32_bf16 a[188:191], v[64:67], v[136:139], 0
  s_nop 0
  v_mfma_f32_16x16x32_bf16 a[192:195], v[68:71], v[108:111], 0
  buffer_store_dwordx4 v[224:227], v173, s[4:7], s47 offen offset:0 sc1
  v_mfma_f32_16x16x32_bf16 a[196:199], v[68:71], v[112:115], 0
  v_mfma_f32_16x16x32_bf16 a[200:203], v[68:71], v[116:119], 0
  v_mfma_f32_16x16x32_bf16 a[204:207], v[68:71], v[120:123], 0
  s_nop 0
  v_mfma_f32_16x16x32_bf16 a[208:211], v[68:71], v[124:127], 0
  buffer_store_dwordx4 v[228:231], v173, s[4:7], s47 offen offset:1024 sc1
  v_mfma_f32_16x16x32_bf16 a[212:215], v[68:71], v[128:131], 0
  v_mfma_f32_16x16x32_bf16 a[216:219], v[68:71], v[132:135], 0
  v_mfma_f32_16x16x32_bf16 a[220:223], v[68:71], v[136:139], 0
  s_nop 0
  v_mfma_f32_16x16x32_bf16 a[224:227], v[72:75], v[108:111], 0
  buffer_store_dwordx4 v[232:235], v173, s[4:7], s47 offen offset:2048 sc1
  v_mfma_f32_16x16x32_bf16 a[228:231], v[72:75], v[112:115], 0
  v_mfma_f32_16x16x32_bf16 a[232:235], v[72:75], v[116:119], 0
  v_mfma_f32_16x16x32_bf16 a[236:239], v[72:75], v[120:123], 0
  s_nop 0
  v_mfma_f32_16x16x32_bf16 a[240:243], v[72:75], v[124:127], 0
  buffer_store_dwordx4 v[236:239], v173, s[4:7], s47 offen offset:3072 sc1
  v_mfma_f32_16x16x32_bf16 a[244:247], v[72:75], v[128:131], 0
  v_mfma_f32_16x16x32_bf16 a[248:251], v[72:75], v[132:135], 0
  v_mfma_f32_16x16x32_bf16 a[252:255], v[72:75], v[136:139], 0
  s_waitcnt lgkmcnt(0)
  v_mfma_f32_16x16x32_bf16 a[0:3], v[76:79], v[140:143], a[0:3]
  s_waitcnt vmcnt(16)
  s_barrier
  s_add_u32 m0, s52, 0
  v_mfma_f32_16x16x32_bf16 a[4:7], v[76:79], v[144:147], a[4:7]
  buffer_load_dwordx4 v2, s[8:11], s20 offen  lds
  ds_read_b128 v[44:47], v20 offset:0
  v_mfma_f32_16x16x32_bf16 a[8:11], v[76:79], v[148:151], a[8:11]
  v_mfma_f32_16x16x32_bf16 a[12:15], v[76:79], v[152:155], a[12:15]
  ds_read_b64_tr_b16 v[108:109], v30 offset:32768
  s_add_u32 m0, s53, 0
  v_mfma_f32_16x16x32_bf16 a[16:19], v[76:79], v[156:159], a[16:19]
  buffer_load_dwordx4 v10, s[12:15], s21 offen  lds
  v_mfma_f32_16x16x32_bf16 a[20:23], v[76:79], v[160:163], a[20:23]
  ds_read_b64_tr_b16 v[110:111], v30 offset:34816
  v_mfma_f32_16x16x32_bf16 a[24:27], v[76:79], v[164:167], a[24:27]
  v_mfma_f32_16x16x32_bf16 a[28:31], v[76:79], v[168:171], a[28:31]
  ds_read_b128 v[48:51], v20 offset:2048
  s_add_u32 m0, s52, 1024
  v_mfma_f32_16x16x32_bf16 a[32:35], v[80:83], v[140:143], a[32:35]
  buffer_load_dwordx4 v3, s[8:11], s20 offen  lds
  v_mfma_f32_16x16x32_bf16 a[36:39], v[80:83], v[144:147], a[36:39]
  ds_read_b64_tr_b16 v[112:113], v31 offset:32768
  v_mfma_f32_16x16x32_bf16 a[40:43], v[80:83], v[148:151], a[40:43]
  v_mfma_f32_16x16x32_bf16 a[44:47], v[80:83], v[152:155], a[44:47]
  ds_read_b64_tr_b16 v[114:115], v31 offset:34816
  s_add_u32 m0, s53, 1024
  v_mfma_f32_16x16x32_bf16 a[48:51], v[80:83], v[156:159], a[48:51]
  buffer_load_dwordx4 v11, s[12:15], s21 offen  lds
  v_mfma_f32_16x16x32_bf16 a[52:55], v[80:83], v[160:163], a[52:55]
  ds_read_b128 v[52:55], v20 offset:4096
  v_mfma_f32_16x16x32_bf16 a[56:59], v[80:83], v[164:167], a[56:59]
  s_add_u32 m0, s52, 2048
  v_mfma_f32_16x16x32_bf16 a[60:63], v[80:83], v[168:171], a[60:63]
  buffer_load_dwordx4 v4, s[8:11], s20 offen  lds
  ds_read_b64_tr_b16 v[116:117], v32 offset:32768
  v_mfma_f32_16x16x32_bf16 a[64:67], v[84:87], v[140:143], a[64:67]
  v_mfma_f32_16x16x32_bf16 a[68:71], v[84:87], v[144:147], a[68:71]
  ds_read_b64_tr_b16 v[118:119], v32 offset:34816
  v_mfma_f32_16x16x32_bf16 a[72:75], v[84:87], v[148:151], a[72:75]
  s_add_u32 m0, s53, 2048
  v_mfma_f32_16x16x32_bf16 a[76:79], v[84:87], v[152:155], a[76:79]
  buffer_load_dwordx4 v12, s[12:15], s21 offen  lds
  ds_read_b128 v[56:59], v20 offset:6144
  v_mfma_f32_16x16x32_bf16 a[80:83], v[84:87], v[156:159], a[80:83]
  v_mfma_f32_16x16x32_bf16 a[84:87], v[84:87], v[160:163], a[84:87]
  ds_read_b64_tr_b16 v[120:121], v33 offset:32768
  v_mfma_f32_16x16x32_bf16 a[88:91], v[84:87], v[164:167], a[88:91]
  s_add_u32 m0, s52, 3072
  v_mfma_f32_16x16x32_bf16 a[92:95], v[84:87], v[168:171], a[92:95]
  buffer_load_dwordx4 v5, s[8:11], s20 offen  lds
  ds_read_b64_tr_b16 v[122:123], v33 offset:34816
  v_mfma_f32_16x16x32_bf16 a[96:99], v[88:91], v[140:143], a[96:99]
  v_mfma_f32_16x16x32_bf16 a[100:103], v[88:91], v[144:147], a[100:103]
  ds_read_b128 v[60:63], v20 offset:8192
  s_add_u32 m0, s53, 3072
  v_mfma_f32_16x16x32_bf16 a[104:107], v[88:91], v[148:151], a[104:107]
  buffer_load_dwordx4 v13, s[12:15], s21 offen  lds
  v_mfma_f32_16x16x32_bf16 a[108:111], v[88:91], v[152:155], a[108:111]
  ds_read_b64_tr_b16 v[124:125], v34 offset:32768
  v_mfma_f32_16x16x32_bf16 a[112:115], v[88:91], v[156:159], a[112:115]
  v_mfma_f32_16x16x32_bf16 a[116:119], v[88:91], v[160:163], a[116:119]
  ds_read_b64_tr_b16 v[126:127], v34 offset:34816
  s_add_u32 m0, s52, 4096
  v_mfma_f32_16x16x32_bf16 a[120:123], v[88:91], v[164:167], a[120:123]
  buffer_load_dwordx4 v6, s[8:11], s20 offen  lds
  v_mfma_f32_16x16x32_bf16 a[124:127], v[88:91], v[168:171], a[124:127]
  ds_read_b128 v[64:67], v20 offset:10240
  v_mfma_f32_16x16x32_bf16 a[128:131], v[92:95], v[140:143], a[128:131]
  v_mfma_f32_16x16x32_bf16 a[132:135], v[92:95], v[144:147], a[132:135]
  ds_read_b64_tr_b16 v[128:129], v35 offset:32768
  s_add_u32 m0, s53, 4096
  v_mfma_f32_16x16x32_bf16 a[136:139], v[92:95], v[148:151], a[136:139]
  buffer_load_dwordx4 v14, s[12:15], s21 offen  lds
  v_mfma_f32_16x16x32_bf16 a[140:143], v[92:95], v[152:155], a[140:143]
  ds_read_b64_tr_b16 v[130:131], v35 offset:34816
  v_mfma_f32_16x16x32_bf16 a[144:147], v[92:95], v[156:159], a[144:147]
  v_mfma_f32_16x16x32_bf16 a[148:151], v[92:95], v[160:163], a[148:151]
  ds_read_b128 v[68:71], v20 offset:12288
  s_add_u32 m0, s52, 5120
  v_mfma_f32_16x16x32_bf16 a[152:155], v[92:95], v[164:167], a[152:155]
  buffer_load_dwordx4 v7, s[8:11], s20 offen  lds
  v_mfma_f32_16x16x32_bf16 a[156:159], v[92:95], v[168:171], a[156:159]
  ds_read_b64_tr_b16 v[132:133], v36 offset:32768
  v_mfma_f32_16x16x32_bf16 a[160:163], v[96:99], v[140:143], a[160:163]
  s_add_u32 m0, s53, 5120
  v_mfma_f32_16x16x32_bf16 a[164:167], v[96:99], v[144:147], a[164:167]
  buffer_load_dwordx4 v15, s[12:15], s21 offen  lds
  ds_read_b64_tr_b16 v[134:135], v36 offset:34816
  v_mfma_f32_16x16x32_bf16 a[168:171], v[96:99], v[148:151], a[168:171]
  v_mfma_f32_16x16x32_bf16 a[172:175], v[96:99], v[152:155], a[172:175]
  ds_read_b128 v[72:75], v20 offset:14336
  v_mfma_f32_16x16x32_bf16 a[176:179], v[96:99], v[156:159], a[176:179]
  s_add_u32 m0, s52, 6144
  v_mfma_f32_16x16x32_bf16 a[180:183], v[96:99], v[160:163], a[180:183]
  buffer_load_dwordx4 v8, s[8:11], s20 offen  lds
  ds_read_b64_tr_b16 v[136:137], v37 offset:32768
  v_mfma_f32_16x16x32_bf16 a[184:187], v[96:99], v[164:167], a[184:187]
  v_mfma_f32_16x16x32_bf16 a[188:191], v[96:99], v[168:171], a[188:191]
  ds_read_b64_tr_b16 v[138:139], v37 offset:34816
  v_mfma_f32_16x16x32_bf16 a[192:195], v[100:103], v[140:143], a[192:195]
  s_add_u32 m0, s53, 6144
  v_mfma_f32_16x16x32_bf16 a[196:199], v[100:103], v[144:147], a[196:199]
  buffer_load_dwordx4 v16, s[12:15], s21 offen  lds
  v_mfma_f32_16x16x32_bf16 a[200:203], v[100:103], v[148:151], a[200:203]
  v_mfma_f32_16x16x32_bf16 a[204:207], v[100:103], v[152:155], a[204:207]
  s_add_u32 m0, s52, 7168
  v_mfma_f32_16x16x32_bf16 a[208:211], v[100:103], v[156:159], a[208:211]
  buffer_load_dwordx4 v9, s[8:11], s20 offen  lds
  v_mfma_f32_16x16x32_bf16 a[212:215], v[100:103], v[160:163], a[212:215]
  v_mfma_f32_16x16x32_bf16 a[216:219], v[100:103], v[164:167], a[216:219]
  v_mfma_f32_16x16x32_bf16 a[220:223], v[100:103], v[168:171], a[220:223]
  s_add_u32 m0, s53, 7168
  v_mfma_f32_16x16x32_bf16 a[224:227], v[104:107], v[140:143], a[224:227]
  buffer_load_dwordx4 v17, s[12:15], s21 offen  lds
  v_mfma_f32_16x16x32_bf16 a[228:231], v[104:107], v[144:147], a[228:231]
  v_mfma_f32_16x16x32_bf16 a[232:235], v[104:107], v[148:151], a[232:235]
  v_mfma_f32_16x16x32_bf16 a[236:239], v[104:107], v[152:155], a[236:239]
  s_add_u32 s20, s20, 128
  v_mfma_f32_16x16x32_bf16 a[240:243], v[104:107], v[156:159], a[240:243]
  s_add_u32 s21, s21, s51
  v_mfma_f32_16x16x32_bf16 a[244:247], v[104:107], v[160:163], a[244:247]
  v_mfma_f32_16x16x32_bf16 a[248:251], v[104:107], v[164:167], a[248:251]
  v_mfma_f32_16x16x32_bf16 a[252:255], v[104:107], v[168:171], a[252:255]
  s_waitcnt lgkmcnt(0)
  v_mfma_f32_16x16x32_bf16 a[0:3], v[44:47], v[108:111], a[0:3]
  ds_read_b128 v[76:79], v21 offset:0
  v_mfma_f32_16x16x32_bf16 a[4:7], v[44:47], v[112:115], a[4:7]
  v_mfma_f32_16x16x32_bf16 a[8:11], v[44:47], v[116:119], a[8:11]
  ds_read_b64_tr_b16 v[140:141], v30 offset:49152
  v_mfma_f32_16x16x32_bf16 a[12:15], v[44:47], v[120:123], a[12:15]
  v_mfma_f32_16x16x32_bf16 a[16:19], v[44:47], v[124:127], a[16:19]
  ds_read_b64_tr_b16 v[142:143], v30 offset:51200
  v_mfma_f32_16x16x32_bf16 a[20:23], v[44:47], v[128:131], a[20:23]
  v_mfma_f32_16x16x32_bf16 a[24:27], v[44:47], v[132:135], a[24:27]
  ds_read_b128 v[80:83], v21 offset:2048
  v_mfma_f32_16x16x32_bf16 a[28:31], v[44:47], v[136:139], a[28:31]
  v_mfma_f32_16x16x32_bf16 a[32:35], v[48:51], v[108:111], a[32:35]
  ds_read_b64_tr_b16 v[144:145], v31 offset:49152
  v_mfma_f32_16x16x32_bf16 a[36:39], v[48:51], v[112:115], a[36:39]
  v_mfma_f32_16x16x32_bf16 a[40:43], v[48:51], v[116:119], a[40:43]
  ds_read_b64_tr_b16 v[146:147], v31 offset:51200
  v_mfma_f32_16x16x32_bf16 a[44:47], v[48:51], v[120:123], a[44:47]
  v_mfma_f32_16x16x32_bf16 a[48:51], v[48:51], v[124:127], a[48:51]
  ds_read_b128 v[84:87], v21 offset:4096
  v_mfma_f32_16x16x32_bf16 a[52:55], v[48:51], v[128:131], a[52:55]
  v_mfma_f32_16x16x32_bf16 a[56:59], v[48:51], v[132:135], a[56:59]
  ds_read_b64_tr_b16 v[148:149], v32 offset:49152
  v_mfma_f32_16x16x32_bf16 a[60:63], v[48:51], v[136:139], a[60:63]
  v_mfma_f32_16x16x32_bf16 a[64:67], v[52:55], v[108:111], a[64:67]
  ds_read_b64_tr_b16 v[150:151], v32 offset:51200
  v_mfma_f32_16x16x32_bf16 a[68:71], v[52:55], v[112:115], a[68:71]
  v_mfma_f32_16x16x32_bf16 a[72:75], v[52:55], v[116:119], a[72:75]
  ds_read_b128 v[88:91], v21 offset:6144
  v_mfma_f32_16x16x32_bf16 a[76:79], v[52:55], v[120:123], a[76:79]
  v_mfma_f32_16x16x32_bf16 a[80:83], v[52:55], v[124:127], a[80:83]
  ds_read_b64_tr_b16 v[152:153], v33 offset:49152
  v_mfma_f32_16x16x32_bf16 a[84:87], v[52:55], v[128:131], a[84:87]
  v_mfma_f32_16x16x32_bf16 a[88:91], v[52:55], v[132:135], a[88:91]
  ds_read_b64_tr_b16 v[154:155], v33 offset:51200
  v_mfma_f32_16x16x32_bf16 a[92:95], v[52:55], v[136:139], a[92:95]
  v_mfma_f32_16x16x32_bf16 a[96:99], v[56:59], v[108:111], a[96:99]
  ds_read_b128 v[92:95], v21 offset:8192
  v_mfma_f32_16x16x32_bf16 a[100:103], v[56:59], v[112:115], a[100:103]
  v_mfma_f32_16x16x32_bf16 a[104:107], v[56:59], v[116:119], a[104:107]
  ds_read_b64_tr_b16 v[156:157], v34 offset:49152
  v_mfma_f32_16x16x32_bf16 a[108:111], v[56:59], v[120:123], a[108:111]
  v_mfma_f32_16x16x32_bf16 a[112:115], v[56:59], v[124:127], a[112:115]
  ds_read_b64_tr_b16 v[158:159], v34 offset:51200
  v_mfma_f32_16x16x32_bf16 a[116:119], v[56:59], v[128:131], a[116:119]
  v_mfma_f32_16x16x32_bf16 a[120:123], v[56:59], v[132:135], a[120:123]
  ds_read_b128 v[96:99], v21 offset:10240
  v_mfma_f32_16x16x32_bf16 a[124:127], v[56:59], v[136:139], a[124:127]
  v_mfma_f32_16x16x32_bf16 a[128:131], v[60:63], v[108:111], a[128:131]
  ds_read_b64_tr_b16 v[160:161], v35 offset:49152
  v_mfma_f32_16x16x32_bf16 a[132:135], v[60:63], v[112:115], a[132:135]
  v_mfma_f32_16x16x32_bf16 a[136:139], v[60:63], v[116:119], a[136:139]
  ds_read_b64_tr_b16 v[162:163], v35 offset:51200
  v_mfma_f32_16x16x32_bf16 a[140:143], v[60:63], v[120:123], a[140:143]
  v_mfma_f32_16x16x32_bf16 a[144:147], v[60:63], v[124:127], a[144:147]
  ds_read_b128 v[100:103], v21 offset:12288
  v_mfma_f32_16x16x32_bf16 a[148:151], v[60:63], v[128:131], a[148:151]
  v_mfma_f32_16x16x32_bf16 a[152:155], v[60:63], v[132:135], a[152:155]
  ds_read_b64_tr_b16 v[164:165], v36 offset:49152
  v_mfma_f32_16x16x32_bf16 a[156:159], v[60:63], v[136:139], a[156:159]
  v_mfma_f32_16x16x32_bf16 a[160:163], v[64:67], v[108:111], a[160:163]
  ds_read_b64_tr_b16 v[166:167], v36 offset:51200
  v_mfma_f32_16x16x32_bf16 a[164:167], v[64:67], v[112:115], a[164:167]
  v_mfma_f32_16x16x32_bf16 a[168:171], v[64:67], v[116:119], a[168:171]
  ds_read_b128 v[104:107], v21 offset:14336
  v_mfma_f32_16x16x32_bf16 a[172:175], v[64:67], v[120:123], a[172:175]
  v_mfma_f32_16x16x32_bf16 a[176:179], v[64:67], v[124:127], a[176:179]
  ds_read_b64_tr_b16 v[168:169], v37 offset:49152
  v_mfma_f32_16x16x32_bf16 a[180:183], v[64:67], v[128:131], a[180:183]
  v_mfma_f32_16x16x32_bf16 a[184:187], v[64:67], v[132:135], a[184:187]
  ds_read_b64_tr_b16 v[170:171], v37 offset:51200
  v_mfma_f32_16x16x32_bf16 a[188:191], v[64:67], v[136:139], a[188:191]
  v_mfma_f32_16x16x32_bf16 a[192:195], v[68:71], v[108:111], a[192:195]
  v_mfma_f32_16x16x32_bf16 a[196:199], v[68:71], v[112:115], a[196:199]
  v_mfma_f32_16x16x32_bf16 a[200:203], v[68:71], v[116:119], a[200:203]
  v_mfma_f32_16x16x32_bf16 a[204:207], v[68:71], v[120:123], a[204:207]
  v_mfma_f32_16x16x32_bf16 a[208:211], v[68:71], v[124:127], a[208:211]
  v_mfma_f32_16x16x32_bf16 a[212:215], v[68:71], v[128:131], a[212:215]
  v_mfma_f32_16x16x32_bf16 a[216:219], v[68:71], v[132:135], a[216:219]
  v_mfma_f32_16x16x32_bf16 a[220:223], v[68:71], v[136:139], a[220:223]
  v_mfma_f32_16x16x32_bf16 a[224:227], v[72:75], v[108:111], a[224:227]
  v_mfma_f32_16x16x32_bf16 a[228:231], v[72:75], v[112:115], a[228:231]
  v_mfma_f32_16x16x32_bf16 a[232:235], v[72:75], v[116:119], a[232:235]
  v_mfma_f32_16x16x32_bf16 a[236:239], v[72:75], v[120:123], a[236:239]
  v_mfma_f32_16x16x32_bf16 a[240:243], v[72:75], v[124:127], a[240:243]
  v_mfma_f32_16x16x32_bf16 a[244:247], v[72:75], v[128:131], a[244:247]
  v_mfma_f32_16x16x32_bf16 a[248:251], v[72:75], v[132:135], a[248:251]
  v_mfma_f32_16x16x32_bf16 a[252:255], v[72:75], v[136:139], a[252:255]
  s_waitcnt lgkmcnt(0)
  v_mfma_f32_16x16x32_bf16 a[0:3], v[76:79], v[140:143], a[0:3]
  s_waitcnt vmcnt(0)
  s_barrier
  s_cmp_eq_u32 s49, 0
  s_cbranch_scc1 L_hs_45
  s_cmp_lg_u32 s32, 0
  s_cbranch_scc1 L_sig_46
  v_mov_b32 v254, s63
  v_mov_b32 v255, 0
  v_and_b32 v254, 3, v254
  v_mbcnt_lo_u32_b32 v255, -1, 0
  v_lshlrev_b32 v255, 9, v255
  s_cmp_ge_u32 s63, 2
  s_cselect_b64 exec, 3, 1
  buffer_atomic_add v254, v255, s[4:7], s62 offen offset:0 sc1
  s_mov_b64 exec, -1
L_sig_46:
L_hs_45:
  s_add_u32 m0, s52, 65536
  v_mfma_f32_16x16x32_bf16 a[4:7], v[76:79], v[144:147], a[4:7]
  buffer_load_dwordx4 v2, s[8:11], s20 offen  lds
  ds_read_b128 v[44:47], v18 offset:0
  v_mfma_f32_16x16x32_bf16 a[8:11], v[76:79], v[148:151], a[8:11]
  v_mfma_f32_16x16x32_bf16 a[12:15], v[76:79], v[152:155], a[12:15]
  ds_read_b64_tr_b16 v[108:109], v22 offset:32768
  s_add_u32 m0, s53, 65536
  v_mfma_f32_16x16x32_bf16 a[16:19], v[76:79], v[156:159], a[16:19]
  buffer_load_dwordx4 v10, s[12:15], s21 offen  lds
  v_mfma_f32_16x16x32_bf16 a[20:23], v[76:79], v[160:163], a[20:23]
  ds_read_b64_tr_b16 v[110:111], v22 offset:34816
  v_mfma_f32_16x16x32_bf16 a[24:27], v[76:79], v[164:167], a[24:27]
  v_mfma_f32_16x16x32_bf16 a[28:31], v[76:79], v[168:171], a[28:31]
  ds_read_b128 v[48:51], v18 offset:2048
  s_add_u32 m0, s52, 66560
  v_mfma_f32_16x16x32_bf16 a[32:35], v[80:83], v[140:143], a[32:35]
  buffer_load_dwordx4 v3, s[8:11], s20 offen  lds
  v_mfma_f32_16x16x32_bf16 a[36:39], v[80:83], v[144:147], a[36:39]
  ds_read_b64_tr_b16 v[112:113], v23 offset:32768
  v_mfma_f32_16x16x32_bf16 a[40:43], v[80:83], v[148:151], a[40:43]
  v_mfma_f32_16x16x32_bf16 a[44:47], v[80:83], v[152:155], a[44:47]
  ds_read_b64_tr_b16 v[114:115], v23 offset:34816
  s_add_u32 m0, s53, 66560
  v_mfma_f32_16x16x32_bf16 a[48:51], v[80:83], v[156:159], a[48:51]
  buffer_load_dwordx4 v11, s[12:15], s21 offen  lds
  v_mfma_f32_16x16x32_bf16 a[52:55], v[80:83], v[160:163], a[52:55]
  ds_read_b128 v[52:55], v18 offset:4096
  v_mfma_f32_16x16x32_bf16 a[56:59], v[80:83], v[164:167], a[56:59]
  s_add_u32 m0, s52, 67584
  v_mfma_f32_16x16x32_bf16 a[60:63], v[80:83], v[168:171], a[60:63]
  buffer_load_dwordx4 v4, s[8:11], s20 offen  lds
  ds_read_b64_tr_b16 v[116:117], v24 offset:32768
  v_mfma_f32_16x16x32_bf16 a[64:67], v[84:87], v[140:143], a[64:67]
  v_mfma_f32_16x16x32_bf16 a[68:71], v[84:87], v[144:147], a[68:71]
  ds_read_b64_tr_b16 v[118:119], v24 offset:34816
  v_mfma_f32_16x16x32_bf16 a[72:75], v[84:87], v[148:151], a[72:75]
  s_add_u32 m0, s53, 67584
  v_mfma_f32_16x16x32_bf16 a[76:79], v[84:87], v[152:155], a[76:79]
  buffer_load_dwordx4 v12, s[12:15], s21 offen  lds
  ds_read_b128 v[56:59], v18 offset:6144
  v_mfma_f32_16x16x32_bf16 a[80:83], v[84:87], v[156:159], a[80:83]
  v_mfma_f32_16x16x32_bf16 a[84:87], v[84:87], v[160:163], a[84:87]
  ds_read_b64_tr_b16 v[120:121], v25 offset:32768
  v_mfma_f32_16x16x32_bf16 a[88:91], v[84:87], v[164:167], a[88:91]
  s_add_u32 m0, s52, 68608
  v_mfma_f32_16x16x32_bf16 a[92:95], v[84:87], v[168:171], a[92:95]
  buffer_load_dwordx4 v5, s[8:11], s20 offen  lds
  ds_read_b64_tr_b16 v[122:123], v25 offset:34816
  v_mfma_f32_16x16x32_bf16 a[96:99], v[88:91], v[140:143], a[96:99]
  v_mfma_f32_16x16x32_bf16 a[100:103], v[88:91], v[144:147], a[100:103]
  ds_read_b128 v[60:63], v18 offset:8192
  s_add_u32 m0, s53, 68608
  v_mfma_f32_16x16x32_bf16 a[104:107], v[88:91], v[148:151], a[104:107]
  buffer_load_dwordx4 v13, s[12:15], s21 offen  lds
  v_mfma_f32_16x16x32_bf16 a[108:111], v[88:91], v[152:155], a[108:111]
  ds_read_b64_tr_b16 v[124:125], v26 offset:32768
  v_mfma_f32_16x16x32_bf16 a[112:115], v[88:91], v[156:159], a[112:115]
  v_mfma_f32_16x16x32_bf16 a[116:119], v[88:91], v[160:163], a[116:119]
  ds_read_b64_tr_b16 v[126:127], v26 offset:34816
  s_add_u32 m0, s52, 69632
  v_mfma_f32_16x16x32_bf16 a[120:123], v[88:91], v[164:167], a[120:123]
  buffer_load_dwordx4 v6, s[8:11], s20 offen  lds
  v_mfma_f32_16x16x32_bf16 a[124:127], v[88:91], v[168:171], a[124:127]
  ds_read_b128 v[64:67], v18 offset:10240
  v_mfma_f32_16x16x32_bf16 a[128:131], v[92:95], v[140:143], a[128:131]
  v_mfma_f32_16x16x32_bf16 a[132:135], v[92:95], v[144:147], a[132:135]
  ds_read_b64_tr_b16 v[128:129], v27 offset:32768
  s_add_u32 m0, s53, 69632
  v_mfma_f32_16x16x32_bf16 a[136:139], v[92:95], v[148:151], a[136:139]
  buffer_load_dwordx4 v14, s[12:15], s21 offen  lds
  v_mfma_f32_16x16x32_bf16 a[140:143], v[92:95], v[152:155], a[140:143]
  ds_read_b64_tr_b16 v[130:131], v27 offset:34816
  v_mfma_f32_16x16x32_bf16 a[144:147], v[92:95], v[156:159], a[144:147]
  v_mfma_f32_16x16x32_bf16 a[148:151], v[92:95], v[160:163], a[148:151]
  ds_read_b128 v[68:71], v18 offset:12288
  s_add_u32 m0, s52, 70656
  v_mfma_f32_16x16x32_bf16 a[152:155], v[92:95], v[164:167], a[152:155]
  buffer_load_dwordx4 v7, s[8:11], s20 offen  lds
  v_mfma_f32_16x16x32_bf16 a[156:159], v[92:95], v[168:171], a[156:159]
  ds_read_b64_tr_b16 v[132:133], v28 offset:32768
  v_mfma_f32_16x16x32_bf16 a[160:163], v[96:99], v[140:143], a[160:163]
  s_add_u32 m0, s53, 70656
  v_mfma_f32_16x16x32_bf16 a[164:167], v[96:99], v[144:147], a[164:167]
  buffer_load_dwordx4 v15, s[12:15], s21 offen  lds
  ds_read_b64_tr_b16 v[134:135], v28 offset:34816
  v_mfma_f32_16x16x32_bf16 a[168:171], v[96:99], v[148:151], a[168:171]
  v_mfma_f32_16x16x32_bf16 a[172:175], v[96:99], v[152:155], a[172:175]
  ds_read_b128 v[72:75], v18 offset:14336
  v_mfma_f32_16x16x32_bf16 a[176:179], v[96:99], v[156:159], a[176:179]
  s_add_u32 m0, s52, 71680
  v_mfma_f32_16x16x32_bf16 a[180:183], v[96:99], v[160:163], a[180:183]
  buffer_load_dwordx4 v8, s[8:11], s20 offen  lds
  ds_read_b64_tr_b16 v[136:137], v29 offset:32768
  v_mfma_f32_16x16x32_bf16 a[184:187], v[96:99], v[164:167], a[184:187]
  v_mfma_f32_16x16x32_bf16 a[188:191], v[96:99], v[168:171], a[188:191]
  ds_read_b64_tr_b16 v[138:139], v29 offset:34816
  v_mfma_f32_16x16x32_bf16 a[192:195], v[100:103], v[140:143], a[192:195]
  s_add_u32 m0, s53, 71680
  v_mfma_f32_16x16x32_bf16 a[196:199], v[100:103], v[144:147], a[196:199]
  buffer_load_dwordx4 v16, s[12:15], s21 offen  lds
  v_mfma_f32_16x16x32_bf16 a[200:203], v[100:103], v[148:151], a[200:203]
  v_mfma_f32_16x16x32_bf16 a[204:207], v[100:103], v[152:155], a[204:207]
  s_add_u32 m0, s52, 72704
  v_mfma_f32_16x16x32_bf16 a[208:211], v[100:103], v[156:159], a[208:211]
  buffer_load_dwordx4 v9, s[8:11], s20 offen  lds
  v_mfma_f32_16x16x32_bf16 a[212:215], v[100:103], v[160:163], a[212:215]
  v_mfma_f32_16x16x32_bf16 a[216:219], v[100:103], v[164:167], a[216:219]
  v_mfma_f32_16x16x32_bf16 a[220:223], v[100:103], v[168:171], a[220:223]
  s_add_u32 m0, s53, 72704
  v_mfma_f32_16x16x32_bf16 a[224:227], v[104:107], v[140:143], a[224:227]
  buffer_load_dwordx4 v17, s[12:15], s21 offen  lds
  v_mfma_f32_16x16x32_bf16 a[228:231], v[104:107], v[144:147], a[228:231]
  v_mfma_f32_16x16x32_bf16 a[232:235], v[104:107], v[148:151], a[232:235]
  v_mfma_f32_16x16x32_bf16 a[236:239], v[104:107], v[152:155], a[236:239]
  s_add_u32 s20, s20, 128
  v_mfma_f32_16x16x32_bf16 a[240:243], v[104:107], v[156:159], a[240:243]
  s_add_u32 s21, s21, s51
  v_mfma_f32_16x16x32_bf16 a[244:247], v[104:107], v[160:163], a[244:247]
  v_mfma_f32_16x16x32_bf16 a[248:251], v[104:107], v[164:167], a[248:251]
  v_mfma_f32_16x16x32_bf16 a[252:255], v[104:107], v[168:171], a[252:255]
L_g2_loop:
  s_sub_u32 s25, s25, 1
  s_cmp_eq_u32 s25, 0
  s_cbranch_scc1 L_g2_fin
  s_waitcnt lgkmcnt(0)
  v_mfma_f32_16x16x32_bf16 a[0:3], v[44:47], v[108:111], a[0:3]
  ds_read_b128 v[76:79], v19 offset:0
  v_mfma_f32_16x16x32_bf16 a[4:7], v[44:47], v[112:115], a[4:7]
  v_mfma_f32_16x16x32_bf16 a[8:11], v[44:47], v[116:119], a[8:11]
  ds_read_b64_tr_b16 v[140:141], v22 offset:49152
  v_mfma_f32_16x16x32_bf16 a[12:15], v[44:47], v[120:123], a[12:15]
  v_mfma_f32_16x16x32_bf16 a[16:19], v[44:47], v[124:127], a[16:19]
  ds_read_b64_tr_b16 v[142:143], v22 offset:51200
  v_mfma_f32_16x16x32_bf16 a[20:23], v[44:47], v[128:131], a[20:23]
  v_mfma_f32_16x16x32_bf16 a[24:27], v[44:47], v[132:135], a[24:27]
  ds_read_b128 v[80:83], v19 offset:2048
  v_mfma_f32_16x16x32_bf16 a[28:31], v[44:47], v[136:139], a[28:31]
  v_mfma_f32_16x16x32_bf16 a[32:35], v[48:51], v[108:111], a[32:35]
  ds_read_b64_tr_b16 v[144:145], v23 offset:49152
  v_mfma_f32_16x16x32_bf16 a[36:39], v[48:51], v[112:115], a[36:39]
  v_mfma_f32_16x16x32_bf16 a[40:43], v[48:51], v[116:119], a[40:43]
  ds_read_b64_tr_b16 v[146:147], v23 offset:51200
  v_mfma_f32_16x16x32_bf16 a[44:47], v[48:51], v[120:123], a[44:47]
  v_mfma_f32_16x16x32_bf16 a[48:51], v[48:51], v[124:127], a[48:51]
  ds_read_b128 v[84:87], v19 offset:4096
  v_mfma_f32_16x16x32_bf16 a[52:55], v[48:51], v[128:131], a[52:55]
  v_mfma_f32_16x16x32_bf16 a[56:59], v[48:51], v[132:135], a[56:59]
  ds_read_b64_tr_b16 v[148:149], v24 offset:49152
  v_mfma_f32_16x16x32_bf16 a[60:63], v[48:51], v[136:139], a[60:63]
  v_mfma_f32_16x16x32_bf16 a[64:67], v[52:55], v[108:111], a[64:67]
  ds_read_b64_tr_b16 v[150:151], v24 offset:51200
  v_mfma_f32_16x16x32_bf16 a[68:71], v[52:55], v[112:115], a[68:71]
  v_mfma_f32_16x16x32_bf16 a[72:75], v[52:55], v[116:119], a[72:75]
  ds_read_b128 v[88:91], v19 offset:6144
  v_mfma_f32_16x16x32_bf16 a[76:79], v[52:55], v[120:123], a[76:79]
  v_mfma_f32_16x16x32_bf16 a[80:83], v[52:55], v[124:127], a[80:83]
  ds_read_b64_tr_b16 v[152:153], v25 offset:49152
  v_mfma_f32_16x16x32_bf16 a[84:87], v[52:55], v[128:131], a[84:87]
  v_mfma_f32_16x16x32_bf16 a[88:91], v[52:55], v[132:135], a[88:91]
  ds_read_b64_tr_b16 v[154:155], v25 offset:51200
  v_mfma_f32_16x16x32_bf16 a[92:95], v[52:55], v[136:139], a[92:95]
  v_mfma_f32_16x16x32_bf16 a[96:99], v[56:59], v[108:111], a[96:99]
  ds_read_b128 v[92:95], v19 offset:8192
  v_mfma_f32_16x16x32_bf16 a[100:103], v[56:59], v[112:115], a[100:103]
  v_mfma_f32_16x16x32_bf16 a[104:107], v[56:59], v[116:119], a[104:107]
  ds_read_b64_tr_b16 v[156:157], v26 offset:49152
  v_mfma_f32_16x16x32_bf16 a[108:111], v[56:59], v[120:123], a[108:111]
  v_mfma_f32_16x16x32_bf16 a[112:115], v[56:59], v[124:127], a[112:115]
  ds_read_b64_tr_b16 v[158:159], v26 offset:51200
  v_mfma_f32_16x16x32_bf16 a[116:119], v[56:59], v[128:131], a[116:119]
  v_mfma_f32_16x16x32_bf16 a[120:123], v[56:59], v[132:135], a[120:123]
  ds_read_b128 v[96:99], v19 offset:10240
  v_mfma_f32_16x16x32_bf16 a[124:127], v[56:59], v[136:139], a[124:127]
  v_mfma_f32_16x16x32_bf16 a[128:131], v[60:63], v[108:111], a[128:131]
  ds_read_b64_tr_b16 v[160:161], v27 offset:49152
  v_mfma_f32_16x16x32_bf16 a[132:135], v[60:63], v[112:115], a[132:135]
  v_mfma_f32_16x16x32_bf16 a[136:139], v[60:63], v[116:119], a[136:139]
  ds_read_b64_tr_b16 v[162:163], v27 offset:51200
  v_mfma_f32_16x16x32_bf16 a[140:143], v[60:63], v[120:123], a[140:143]
  v_mfma_f32_16x16x32_bf16 a[144:147], v[60:63], v[124:127], a[144:147]
  ds_read_b128 v[100:103], v19 offset:12288
  v_mfma_f32_16x16x32_bf16 a[148:151], v[60:63], v[128:131], a[148:151]
  v_mfma_f32_16x16x32_bf16 a[152:155], v[60:63], v[132:135], a[152:155]
  ds_read_b64_tr_b16 v[164:165], v28 offset:49152
  v_mfma_f32_16x16x32_bf16 a[156:159], v[60:63], v[136:139], a[156:159]
  v_mfma_f32_16x16x32_bf16 a[160:163], v[64:67], v[108:111], a[160:163]
  ds_read_b64_tr_b16 v[166:167], v28 offset:51200
  v_mfma_f32_16x16x32_bf16 a[164:167], v[64:67], v[112:115], a[164:167]
  v_mfma_f32_16x16x32_bf16 a[168:171], v[64:67], v[116:119], a[168:171]
  ds_read_b128 v[104:107], v19 offset:14336
  v_mfma_f32_16x16x32_bf16 a[172:175], v[64:67], v[120:123], a[172:175]
  v_mfma_f32_16x16x32_bf16 a[176:179], v[64:67], v[124:127], a[176:179]
  ds_read_b64_tr_b16 v[168:169], v29 offset:49152
  v_mfma_f32_16x16x32_bf16 a[180:183], v[64:67], v[128:131], a[180:183]
  v_mfma_f32_16x16x32_bf16 a[184:187], v[64:67], v[132:135], a[184:187]
  ds_read_b64_tr_b16 v[170:171], v29 offset:51200
  v_mfma_f32_16x16x32_bf16 a[188:191], v[64:67], v[136:139], a[188:191]
  v_mfma_f32_16x16x32_bf16 a[192:195], v[68:71], v[108:111], a[192:195]
  v_mfma_f32_16x16x32_bf16 a[196:199], v[68:71], v[112:115], a[196:199]
  v_mfma_f32_16x16x32_bf16 a[200:203], v[68:71], v[116:119], a[200:203]
  v_mfma_f32_16x16x32_bf16 a[204:207], v[68:71], v[120:123], a[204:207]
  v_mfma_f32_16x16x32_bf16 a[208:211], v[68:71], v[124:127], a[208:211]
  v_mfma_f32_16x16x32_bf16 a[212:215], v[68:71], v[128:131], a[212:215]
  v_mfma_f32_16x16x32_bf16 a[216:219], v[68:71], v[132:135], a[216:219]
  v_mfma_f32_16x16x32_bf16 a[220:223], v[68:71], v[136:139], a[220:223]
  v_mfma_f32_16x16x32_bf16 a[224:227], v[72:75], v[108:111], a[224:227]
  v_mfma_f32_16x16x32_bf16 a[228:231], v[72:75], v[112:115], a[228:231]
  v_mfma_f32_16x16x32_bf16 a[232:235], v[72:75], v[116:119], a[232:235]
  v_mfma_f32_16x16x32_bf16 a[236:239], v[72:75], v[120:123], a[236:239]
  v_mfma_f32_16x16x32_bf16 a[240:243], v[72:75], v[124:127], a[240:243]
  v_mfma_f32_16x16x32_bf16 a[244:247], v[72:75], v[128:131], a[244:247]
  v_mfma_f32_16x16x32_bf16 a[248:251], v[72:75], v[132:135], a[248:251]
  v_mfma_f32_16x16x32_bf16 a[252:255], v[72:75], v[136:139], a[252:255]
  s_waitcnt lgkmcnt(0)
  v_mfma_f32_16x16x32_bf16 a[0:3], v[76:79], v[140:143], a[0:3]
  s_waitcnt vmcnt(0)
  s_barrier
  s_add_u32 m0, s52, 0
  v_mfma_f32_16x16x32_bf16 a[4:7], v[76:79], v[144:147], a[4:7]
  buffer_load_dwordx4 v2, s[8:11], s20 offen  lds
  ds_read_b128 v[44:47], v20 offset:0
  v_mfma_f32_16x16x32_bf16 a[8:11], v[76:79], v[148:151], a[8:11]
  v_mfma_f32_16x16x32_bf16 a[12:15], v[76:79], v[152:155], a[12:15]
  ds_read_b64_tr_b16 v[108:109], v30 offset:32768
  s_add_u32 m0, s53, 0
  v_mfma_f32_16x16x32_bf16 a[16:19], v[76:79], v[156:159], a[16:19]
  buffer_load_dwordx4 v10, s[12:15], s21 offen  lds
  v_mfma_f32_16x16x32_bf16 a[20:23], v[76:79], v[160:163], a[20:23]
  ds_read_b64_tr_b16 v[110:111], v30 offset:34816
  v_mfma_f32_16x16x32_bf16 a[24:27], v[76:79], v[164:167], a[24:27]
  v_mfma_f32_16x16x32_bf16 a[28:31], v[76:79], v[168:171], a[28:31]
  ds_read_b128 v[48:51], v20 offset:2048
  s_add_u32 m0, s52, 1024
  v_mfma_f32_16x16x32_bf16 a[32:35], v[80:83], v[140:143], a[32:35]
  buffer_load_dwordx4 v3, s[8:11], s20 offen  lds
  v_mfma_f32_16x16x32_bf16 a[36:39], v[80:83], v[144:147], a[36:39]
  ds_read_b64_tr_b16 v[112:113], v31 offset:32768
  v_mfma_f32_16x16x32_bf16 a[40:43], v[80:83], v[148:151], a[40:43]
  v_mfma_f32_16x16x32_bf16 a[44:47], v[80:83], v[152:155], a[44:47]
  ds_read_b64_tr_b16 v[114:115], v31 offset:34816
  s_add_u32 m0, s53, 1024
  v_mfma_f32_16x16x32_bf16 a[48:51], v[80:83], v[156:159], a[48:51]
  buffer_load_dwordx4 v11, s[12:15], s21 offen  lds
  v_mfma_f32_16x16x32_bf16 a[52:55], v[80:83], v[160:163], a[52:55]
  ds_read_b128 v[52:55], v20 offset:4096
  v_mfma_f32_16x16x32_bf16 a[56:59], v[80:83], v[164:167], a[56:59]
  s_add_u32 m0, s52, 2048
  v_mfma_f32_16x16x32_bf16 a[60:63], v[80:83], v[168:171], a[60:63]
  buffer_load_dwordx4 v4, s[8:11], s20 offen  lds
  ds_read_b64_tr_b16 v[116:117], v32 offset:32768
  v_mfma_f32_16x16x32_bf16 a[64:67], v[84:87], v[140:143], a[64:67]
  v_mfma_f32_16x16x32_bf16 a[68:71], v[84:87], v[144:147], a[68:71]
  ds_read_b64_tr_b16 v[118:119], v32 offset:34816
  v_mfma_f32_16x16x32_bf16 a[72:75], v[84:87], v[148:151], a[72:75]
  s_add_u32 m0, s53, 2048
  v_mfma_f32_16x16x32_bf16 a[76:79], v[84:87], v[152:155], a[76:79]
  buffer_load_dwordx4 v12, s[12:15], s21 offen  lds
  ds_read_b128 v[56:59], v20 offset:6144
  v_mfma_f32_16x16x32_bf16 a[80:83], v[84:87], v[156:159], a[80:83]
  v_mfma_f32_16x16x32_bf16 a[84:87], v[84:87], v[160:163], a[84:87]
  ds_read_b64_tr_b16 v[120:121], v33 offset:32768
  v_mfma_f32_16x16x32_bf16 a[88:91], v[84:87], v[164:167], a[88:91]
  s_add_u32 m0, s52, 3072
  v_mfma_f32_16x16x32_bf16 a[92:95], v[84:87], v[168:171], a[92:95]
  buffer_load_dwordx4 v5, s[8:11], s20 offen  lds
  ds_read_b64_tr_b16 v[122:123], v33 offset:34816
  v_mfma_f32_16x16x32_bf16 a[96:99], v[88:91], v[140:143], a[96:99]
  v_mfma_f32_16x16x32_bf16 a[100:103], v[88:91], v[144:147], a[100:103]
  ds_read_b128 v[60:63], v20 offset:8192
  s_add_u32 m0, s53, 3072
  v_mfma_f32_16x16x32_bf16 a[104:107], v[88:91], v[148:151], a[104:107]
  buffer_load_dwordx4 v13, s[12:15], s21 offen  lds
  v_mfma_f32_16x16x32_bf16 a[108:111], v[88:91], v[152:155], a[108:111]
  ds_read_b64_tr_b16 v[124:125], v34 offset:32768
  v_mfma_f32_16x16x32_bf16 a[112:115], v[88:91], v[156:159], a[112:115]
  v_mfma_f32_16x16x32_bf16 a[116:119], v[88:91], v[160:163], a[116:119]
  ds_read_b64_tr_b16 v[126:127], v34 offset:34816
  s_add_u32 m0, s52, 4096
  v_mfma_f32_16x16x32_bf16 a[120:123], v[88:91], v[164:167], a[120:123]
  buffer_load_dwordx4 v6, s[8:11], s20 offen  lds
  v_mfma_f32_16x16x32_bf16 a[124:127], v[88:91], v[168:171], a[124:127]
  ds_read_b128 v[64:67], v20 offset:10240
  v_mfma_f32_16x16x32_bf16 a[128:131], v[92:95], v[140:143], a[128:131]
  v_mfma_f32_16x16x32_bf16 a[132:135], v[92:95], v[144:147], a[132:135]
  ds_read_b64_tr_b16 v[128:129], v35 offset:32768
  s_add_u32 m0, s53, 4096
  v_mfma_f32_16x16x32_bf16 a[136:139], v[92:95], v[148:151], a[136:139]
  buffer_load_dwordx4 v14, s[12:15], s21 offen  lds
  v_mfma_f32_16x16x32_bf16 a[140:143], v[92:95], v[152:155], a[140:143]
  ds_read_b64_tr_b16 v[130:131], v35 offset:34816
  v_mfma_f32_16x16x32_bf16 a[144:147], v[92:95], v[156:159], a[144:147]
  v_mfma_f32_16x16x32_bf16 a[148:151], v[92:95], v[160:163], a[148:151]
  ds_read_b128 v[68:71], v20 offset:12288
  s_add_u32 m0, s52, 5120
  v_mfma_f32_16x16x32_bf16 a[152:155], v[92:95], v[164:167], a[152:155]
  buffer_load_dwordx4 v7, s[8:11], s20 offen  lds
  v_mfma_f32_16x16x32_bf16 a[156:159], v[92:95], v[168:171], a[156:159]
  ds_read_b64_tr_b16 v[132:133], v36 offset:32768
  v_mfma_f32_16x16x32_bf16 a[160:163], v[96:99], v[140:143], a[160:163]
  s_add_u32 m0, s53, 5120
  v_mfma_f32_16x16x32_bf16 a[164:167], v[96:99], v[144:147], a[164:167]
  buffer_load_dwordx4 v15, s[12:15], s21 offen  lds
  ds_read_b64_tr_b16 v[134:135], v36 offset:34816
  v_mfma_f32_16x16x32_bf16 a[168:171], v[96:99], v[148:151], a[168:171]
  v_mfma_f32_16x16x32_bf16 a[172:175], v[96:99], v[152:155], a[172:175]
  ds_read_b128 v[72:75], v20 offset:14336
  v_mfma_f32_16x16x32_bf16 a[176:179], v[96:99], v[156:159], a[176:179]
  s_add_u32 m0, s52, 6144
  v_mfma_f32_16x16x32_bf16 a[180:183], v[96:99], v[160:163], a[180:183]
  buffer_load_dwordx4 v8, s[8:11], s20 offen  lds
  ds_read_b64_tr_b16 v[136:137], v37 offset:32768
  v_mfma_f32_16x16x32_bf16 a[184:187], v[96:99], v[164:167], a[184:187]
  v_mfma_f32_16x16x32_bf16 a[188:191], v[96:99], v[168:171], a[188:191]
  ds_read_b64_tr_b16 v[138:139], v37 offset:34816
  v_mfma_f32_16x16x32_bf16 a[192:195], v[100:103], v[140:143], a[192:195]
  s_add_u32 m0, s53, 6144
  v_mfma_f32_16x16x32_bf16 a[196:199], v[100:103], v[144:147], a[196:199]
  buffer_load_dwordx4 v16, s[12:15], s21 offen  lds
  v_mfma_f32_16x16x32_bf16 a[200:203], v[100:103], v[148:151], a[200:203]
  v_mfma_f32_16x16x32_bf16 a[204:207], v[100:103], v[152:155], a[204:207]
  s_add_u32 m0, s52, 7168
  v_mfma_f32_16x16x32_bf16 a[208:211], v[100:103], v[156:159], a[208:211]
  buffer_load_dwordx4 v9, s[8:11], s20 offen  lds
  v_mfma_f32_16x16x32_bf16 a[212:215], v[100:103], v[160:163], a[212:215]
  v_mfma_f32_16x16x32_bf16 a[216:219], v[100:103], v[164:167], a[216:219]
  v_mfma_f32_16x16x32_bf16 a[220:223], v[100:103], v[168:171], a[220:223]
  s_add_u32 m0, s53, 7168
  v_mfma_f32_16x16x32_bf16 a[224:227], v[104:107], v[140:143], a[224:227]
  buffer_load_dwordx4 v17, s[12:15], s21 offen  lds
  v_mfma_f32_16x16x32_bf16 a[228:231], v[104:107], v[144:147], a[228:231]
  v_mfma_f32_16x16x32_bf16 a[232:235], v[104:107], v[148:151], a[232:235]
  v_mfma_f32_16x16x32_bf16 a[236:239], v[104:107], v[152:155], a[236:239]
  s_add_u32 s20, s20, 128
  v_mfma_f32_16x16x32_bf16 a[240:243], v[104:107], v[156:159], a[240:243]
  s_add_u32 s21, s21, s51
  v_mfma_f32_16x16x32_bf16 a[244:247], v[104:107], v[160:163], a[244:247]
  v_mfma_f32_16x16x32_bf16 a[248:251], v[104:107], v[164:167], a[248:251]
  v_mfma_f32_16x16x32_bf16 a[252:255], v[104:107], v[168:171], a[252:255]
  s_waitcnt lgkmcnt(0)
  s_cmp_eq_u32 s25, 1
  s_cbranch_scc1 L_g2_cw
L_g2_cwb:
  v_mfma_f32_16x16x32_bf16 a[0:3], v[44:47], v[108:111], a[0:3]
  ds_read_b128 v[76:79], v21 offset:0
  v_mfma_f32_16x16x32_bf16 a[4:7], v[44:47], v[112:115], a[4:7]
  v_mfma_f32_16x16x32_bf16 a[8:11], v[44:47], v[116:119], a[8:11]
  ds_read_b64_tr_b16 v[140:141], v30 offset:49152
  v_mfma_f32_16x16x32_bf16 a[12:15], v[44:47], v[120:123], a[12:15]
  v_mfma_f32_16x16x32_bf16 a[16:19], v[44:47], v[124:127], a[16:19]
  ds_read_b64_tr_b16 v[142:143], v30 offset:51200
  v_mfma_f32_16x16x32_bf16 a[20:23], v[44:47], v[128:131], a[20:23]
  v_mfma_f32_16x16x32_bf16 a[24:27], v[44:47], v[132:135], a[24:27]
  ds_read_b128 v[80:83], v21 offset:2048
  v_mfma_f32_16x16x32_bf16 a[28:31], v[44:47], v[136:139], a[28:31]
  v_mfma_f32_16x16x32_bf16 a[32:35], v[48:51], v[108:111], a[32:35]
  ds_read_b64_tr_b16 v[144:145], v31 offset:49152
  v_mfma_f32_16x16x32_bf16 a[36:39], v[48:51], v[112:115], a[36:39]
  v_mfma_f32_16x16x32_bf16 a[40:43], v[48:51], v[116:119], a[40:43]
  ds_read_b64_tr_b16 v[146:147], v31 offset:51200
  v_mfma_f32_16x16x32_bf16 a[44:47], v[48:51], v[120:123], a[44:47]
  v_mfma_f32_16x16x32_bf16 a[48:51], v[48:51], v[124:127], a[48:51]
  ds_read_b128 v[84:87], v21 offset:4096
  v_mfma_f32_16x16x32_bf16 a[52:55], v[48:51], v[128:131], a[52:55]
  v_mfma_f32_16x16x32_bf16 a[56:59], v[48:51], v[132:135], a[56:59]
  ds_read_b64_tr_b16 v[148:149], v32 offset:49152
  v_mfma_f32_16x16x32_bf16 a[60:63], v[48:51], v[136:139], a[60:63]
  v_mfma_f32_16x16x32_bf16 a[64:67], v[52:55], v[108:111], a[64:67]
  ds_read_b64_tr_b16 v[150:151], v32 offset:51200
  v_mfma_f32_16x16x32_bf16 a[68:71], v[52:55], v[112:115], a[68:71]
  v_mfma_f32_16x16x32_bf16 a[72:75], v[52:55], v[116:119], a[72:75]
  ds_read_b128 v[88:91], v21 offset:6144
  v_mfma_f32_16x16x32_bf16 a[76:79], v[52:55], v[120:123], a[76:79]
  v_mfma_f32_16x16x32_bf16 a[80:83], v[52:55], v[124:127], a[80:83]
  ds_read_b64_tr_b16 v[152:153], v33 offset:49152
  v_mfma_f32_16x16x32_bf16 a[84:87], v[52:55], v[128:131], a[84:87]
  v_mfma_f32_16x16x32_bf16 a[88:91], v[52:55], v[132:135], a[88:91]
  ds_read_b64_tr_b16 v[154:155], v33 offset:51200
  v_mfma_f32_16x16x32_bf16 a[92:95], v[52:55], v[136:139], a[92:95]
  v_mfma_f32_16x16x32_bf16 a[96:99], v[56:59], v[108:111], a[96:99]
  ds_read_b128 v[92:95], v21 offset:8192
  v_mfma_f32_16x16x32_bf16 a[100:103], v[56:59], v[112:115], a[100:103]
  v_mfma_f32_16x16x32_bf16 a[104:107], v[56:59], v[116:119], a[104:107]
  ds_read_b64_tr_b16 v[156:157], v34 offset:49152
  v_mfma_f32_16x16x32_bf16 a[108:111], v[56:59], v[120:123], a[108:111]
  v_mfma_f32_16x16x32_bf16 a[112:115], v[56:59], v[124:127], a[112:115]
  ds_read_b64_tr_b16 v[158:159], v34 offset:51200
  v_mfma_f32_16x16x32_bf16 a[116:119], v[56:59], v[128:131], a[116:119]
  v_mfma_f32_16x16x32_bf16 a[120:123], v[56:59], v[132:135], a[120:123]
  ds_read_b128 v[96:99], v21 offset:10240
  v_mfma_f32_16x16x32_bf16 a[124:127], v[56:59], v[136:139], a[124:127]
  v_mfma_f32_16x16x32_bf16 a[128:131], v[60:63], v[108:111], a[128:131]
  ds_read_b64_tr_b16 v[160:161], v35 offset:49152
  v_mfma_f32_16x16x32_bf16 a[132:135], v[60:63], v[112:115], a[132:135]
  v_mfma_f32_16x16x32_bf16 a[136:139], v[60:63], v[116:119], a[136:139]
  ds_read_b64_tr_b16 v[162:163], v35 offset:51200
  v_mfma_f32_16x16x32_bf16 a[140:143], v[60:63], v[120:123], a[140:143]
  v_mfma_f32_16x16x32_bf16 a[144:147], v[60:63], v[124:127], a[144:147]
  ds_read_b128 v[100:103], v21 offset:12288
  v_mfma_f32_16x16x32_bf16 a[148:151], v[60:63], v[128:131], a[148:151]
  v_mfma_f32_16x16x32_bf16 a[152:155], v[60:63], v[132:135], a[152:155]
  ds_read_b64_tr_b16 v[164:165], v36 offset:49152
  v_mfma_f32_16x16x32_bf16 a[156:159], v[60:63], v[136:139], a[156:159]
  v_mfma_f32_16x16x32_bf16 a[160:163], v[64:67], v[108:111], a[160:163]
  ds_read_b64_tr_b16 v[166:167], v36 offset:51200
  v_mfma_f32_16x16x32_bf16 a[164:167], v[64:67], v[112:115], a[164:167]
  v_mfma_f32_16x16x32_bf16 a[168:171], v[64:67], v[116:119], a[168:171]
  ds_read_b128 v[104:107], v21 offset:14336
  v_mfma_f32_16x16x32_bf16 a[172:175], v[64:67], v[120:123], a[172:175]
  v_mfma_f32_16x16x32_bf16 a[176:179], v[64:67], v[124:127], a[176:179]
  ds_read_b64_tr_b16 v[168:169], v37 offset:49152
  v_mfma_f32_16x16x32_bf16 a[180:183], v[64:67], v[128:131], a[180:183]
  v_mfma_f32_16x16x32_bf16 a[184:187], v[64:67], v[132:135], a[184:187]
  ds_read_b64_tr_b16 v[170:171], v37 offset:51200
  v_mfma_f32_16x16x32_bf16 a[188:191], v[64:67], v[136:139], a[188:191]
  v_mfma_f32_16x16x32_bf16 a[192:195], v[68:71], v[108:111], a[192:195]
  v_mfma_f32_16x16x32_bf16 a[196:199], v[68:71], v[112:115], a[196:199]
  v_mfma_f32_16x16x32_bf16 a[200:203], v[68:71], v[116:119], a[200:203]
  v_mfma_f32_16x16x32_bf16 a[204:207], v[68:71], v[120:123], a[204:207]
  v_mfma_f32_16x16x32_bf16 a[208:211], v[68:71], v[124:127], a[208:211]
  v_mfma_f32_16x16x32_bf16 a[212:215], v[68:71], v[128:131], a[212:215]
  v_mfma_f32_16x16x32_bf16 a[216:219], v[68:71], v[132:135], a[216:219]
  v_mfma_f32_16x16x32_bf16 a[220:223], v[68:71], v[136:139], a[220:223]
  v_mfma_f32_16x16x32_bf16 a[224:227], v[72:75], v[108:111], a[224:227]
  v_mfma_f32_16x16x32_bf16 a[228:231], v[72:75], v[112:115], a[228:231]
  v_mfma_f32_16x16x32_bf16 a[232:235], v[72:75], v[116:119], a[232:235]
  v_mfma_f32_16x16x32_bf16 a[236:239], v[72:75], v[120:123], a[236:239]
  v_mfma_f32_16x16x32_bf16 a[240:243], v[72:75], v[124:127], a[240:243]
  v_mfma_f32_16x16x32_bf16 a[244:247], v[72:75], v[128:131], a[244:247]
  v_mfma_f32_16x16x32_bf16 a[248:251], v[72:75], v[132:135], a[248:251]
  v_mfma_f32_16x16x32_bf16 a[252:255], v[72:75], v[136:139], a[252:255]
  s_waitcnt lgkmcnt(0)
  v_mfma_f32_16x16x32_bf16 a[0:3], v[76:79], v[140:143], a[0:3]
  s_waitcnt vmcnt(0)
  s_barrier
  s_cmp_le_u32 s25, 2
  s_cbranch_scc1 L_g2_cr
L_g2_crb:
  s_add_u32 m0, s52, 65536
  v_mfma_f32_16x16x32_bf16 a[4:7], v[76:79], v[144:147], a[4:7]
  buffer_load_dwordx4 v2, s[8:11], s20 offen  lds
  ds_read_b128 v[44:47], v18 offset:0
  v_mfma_f32_16x16x32_bf16 a[8:11], v[76:79], v[148:151], a[8:11]
  v_mfma_f32_16x16x32_bf16 a[12:15], v[76:79], v[152:155], a[12:15]
  ds_read_b64_tr_b16 v[108:109], v22 offset:32768
  s_add_u32 m0, s53, 65536
  v_mfma_f32_16x16x32_bf16 a[16:19], v[76:79], v[156:159], a[16:19]
  buffer_load_dwordx4 v10, s[12:15], s21 offen  lds
  v_mfma_f32_16x16x32_bf16 a[20:23], v[76:79], v[160:163], a[20:23]
  ds_read_b64_tr_b16 v[110:111], v22 offset:34816
  v_mfma_f32_16x16x32_bf16 a[24:27], v[76:79], v[164:167], a[24:27]
  v_mfma_f32_16x16x32_bf16 a[28:31], v[76:79], v[168:171], a[28:31]
  ds_read_b128 v[48:51], v18 offset:2048
  s_add_u32 m0, s52, 66560
  v_mfma_f32_16x16x32_bf16 a[32:35], v[80:83], v[140:143], a[32:35]
  buffer_load_dwordx4 v3, s[8:11], s20 offen  lds
  v_mfma_f32_16x16x32_bf16 a[36:39], v[80:83], v[144:147], a[36:39]
  ds_read_b64_tr_b16 v[112:113], v23 offset:32768
  v_mfma_f32_16x16x32_bf16 a[40:43], v[80:83], v[148:151], a[40:43]
  v_mfma_f32_16x16x32_bf16 a[44:47], v[80:83], v[152:155], a[44:47]
  ds_read_b64_tr_b16 v[114:115], v23 offset:34816
  s_add_u32 m0, s53, 66560
  v_mfma_f32_16x16x32_bf16 a[48:51], v[80:83], v[156:159], a[48:51]
  buffer_load_dwordx4 v11, s[12:15], s21 offen  lds
  v_mfma_f32_16x16x32_bf16 a[52:55], v[80:83], v[160:163], a[52:55]
  ds_read_b128 v[52:55], v18 offset:4096
  v_mfma_f32_16x16x32_bf16 a[56:59], v[80:83], v[164:167], a[56:59]
  s_add_u32 m0, s52, 67584
  v_mfma_f32_16x16x32_bf16 a[60:63], v[80:83], v[168:171], a[60:63]
  buffer_load_dwordx4 v4, s[8:11], s20 offen  lds
  ds_read_b64_tr_b16 v[116:117], v24 offset:32768
  v_mfma_f32_16x16x32_bf16 a[64:67], v[84:87], v[140:143], a[64:67]
  v_mfma_f32_16x16x32_bf16 a[68:71], v[84:87], v[144:147], a[68:71]
  ds_read_b64_tr_b16 v[118:119], v24 offset:34816
  v_mfma_f32_16x16x32_bf16 a[72:75], v[84:87], v[148:151], a[72:75]
  s_add_u32 m0, s53, 67584
  v_mfma_f32_16x16x32_bf16 a[76:79], v[84:87], v[152:155], a[76:79]
  buffer_load_dwordx4 v12, s[12:15], s21 offen  lds
  ds_read_b128 v[56:59], v18 offset:6144
  v_mfma_f32_16x16x32_bf16 a[80:83], v[84:87], v[156:159], a[80:83]
  v_mfma_f32_16x16x32_bf16 a[84:87], v[84:87], v[160:163], a[84:87]
  ds_read_b64_tr_b16 v[120:121], v25 offset:32768
  v_mfma_f32_16x16x32_bf16 a[88:91], v[84:87], v[164:167], a[88:91]
  s_add_u32 m0, s52, 68608
  v_mfma_f32_16x16x32_bf16 a[92:95], v[84:87], v[168:171], a[92:95]
  buffer_load_dwordx4 v5, s[8:11], s20 offen  lds
  ds_read_b64_tr_b16 v[122:123], v25 offset:34816
  v_mfma_f32_16x16x32_bf16 a[96:99], v[88:91], v[140:143], a[96:99]
  v_mfma_f32_16x16x32_bf16 a[100:103], v[88:91], v[144:147], a[100:103]
  ds_read_b128 v[60:63], v18 offset:8192
  s_add_u32 m0, s53, 68608
  v_mfma_f32_16x16x32_bf16 a[104:107], v[88:91], v[148:151], a[104:107]
  buffer_load_dwordx4 v13, s[12:15], s21 offen  lds
  v_mfma_f32_16x16x32_bf16 a[108:111], v[88:91], v[152:155], a[108:111]
  ds_read_b64_tr_b16 v[124:125], v26 offset:32768
  v_mfma_f32_16x16x32_bf16 a[112:115], v[88:91], v[156:159], a[112:115]
  v_mfma_f32_16x16x32_bf16 a[116:119], v[88:91], v[160:163], a[116:119]
  ds_read_b64_tr_b16 v[126:127], v26 offset:34816
  s_add_u32 m0, s52, 69632
  v_mfma_f32_16x16x32_bf16 a[120:123], v[88:91], v[164:167], a[120:123]
  buffer_load_dwordx4 v6, s[8:11], s20 offen  lds
  v_mfma_f32_16x16x32_bf16 a[124:127], v[88:91], v[168:171], a[124:127]
  ds_read_b128 v[64:67], v18 offset:10240
  v_mfma_f32_16x16x32_bf16 a[128:131], v[92:95], v[140:143], a[128:131]
  v_mfma_f32_16x16x32_bf16 a[132:135], v[92:95], v[144:147], a[132:135]
  ds_read_b64_tr_b16 v[128:129], v27 offset:32768
  s_add_u32 m0, s53, 69632
  v_mfma_f32_16x16x32_bf16 a[136:139], v[92:95], v[148:151], a[136:139]
  buffer_load_dwordx4 v14, s[12:15], s21 offen  lds
  v_mfma_f32_16x16x32_bf16 a[140:143], v[92:95], v[152:155], a[140:143]
  ds_read_b64_tr_b16 v[130:131], v27 offset:34816
  v_mfma_f32_16x16x32_bf16 a[144:147], v[92:95], v[156:159], a[144:147]
  v_mfma_f32_16x16x32_bf16 a[148:151], v[92:95], v[160:163], a[148:151]
  ds_read_b128 v[68:71], v18 offset:12288
  s_add_u32 m0, s52, 70656
  v_mfma_f32_16x16x32_bf16 a[152:155], v[92:95], v[164:167], a[152:155]
  buffer_load_dwordx4 v7, s[8:11], s20 offen  lds
  v_mfma_f32_16x16x32_bf16 a[156:159], v[92:95], v[168:171], a[156:159]
  ds_read_b64_tr_b16 v[132:133], v28 offset:32768
  v_mfma_f32_16x16x32_bf16 a[160:163], v[96:99], v[140:143], a[160:163]
  s_add_u32 m0, s53, 70656
  v_mfma_f32_16x16x32_bf16 a[164:167], v[96:99], v[144:147], a[164:167]
  buffer_load_dwordx4 v15, s[12:15], s21 offen  lds
  ds_read_b64_tr_b16 v[134:135], v28 offset:34816
  v_mfma_f32_16x16x32_bf16 a[168:171], v[96:99], v[148:151], a[168:171]
  v_mfma_f32_16x16x32_bf16 a[172:175], v[96:99], v[152:155], a[172:175]
  ds_read_b128 v[72:75], v18 offset:14336
  v_mfma_f32_16x16x32_bf16 a[176:179], v[96:99], v[156:159], a[176:179]
  s_add_u32 m0, s52, 71680
  v_mfma_f32_16x16x32_bf16 a[180:183], v[96:99], v[160:163], a[180:183]
  buffer_load_dwordx4 v8, s[8:11], s20 offen  lds
  ds_read_b64_tr_b16 v[136:137], v29 offset:32768
  v_mfma_f32_16x16x32_bf16 a[184:187], v[96:99], v[164:167], a[184:187]
  v_mfma_f32_16x16x32_bf16 a[188:191], v[96:99], v[168:171], a[188:191]
  ds_read_b64_tr_b16 v[138:139], v29 offset:34816
  v_mfma_f32_16x16x32_bf16 a[192:195], v[100:103], v[140:143], a[192:195]
  s_add_u32 m0, s53, 71680
  v_mfma_f32_16x16x32_bf16 a[196:199], v[100:103], v[144:147], a[196:199]
  buffer_load_dwordx4 v16, s[12:15], s21 offen  lds
  v_mfma_f32_16x16x32_bf16 a[200:203], v[100:103], v[148:151], a[200:203]
  v_mfma_f32_16x16x32_bf16 a[204:207], v[100:103], v[152:155], a[204:207]
  s_add_u32 m0, s52, 72704
  v_mfma_f32_16x16x32_bf16 a[208:211], v[100:103], v[156:159], a[208:211]
  buffer_load_dwordx4 v9, s[8:11], s20 offen  lds
  v_mfma_f32_16x16x32_bf16 a[212:215], v[100:103], v[160:163], a[212:215]
  v_mfma_f32_16x16x32_bf16 a[216:219], v[100:103], v[164:167], a[216:219]
  v_mfma_f32_16x16x32_bf16 a[220:223], v[100:103], v[168:171], a[220:223]
  s_add_u32 m0, s53, 72704
  v_mfma_f32_16x16x32_bf16 a[224:227], v[104:107], v[140:143], a[224:227]
  buffer_load_dwordx4 v17, s[12:15], s21 offen  lds
  v_mfma_f32_16x16x32_bf16 a[228:231], v[104:107], v[144:147], a[228:231]
  v_mfma_f32_16x16x32_bf16 a[232:235], v[104:107], v[148:151], a[232:235]
  v_mfma_f32_16x16x32_bf16 a[236:239], v[104:107], v[152:155], a[236:239]
  s_add_u32 s20, s20, 128
  v_mfma_f32_16x16x32_bf16 a[240:243], v[104:107], v[156:159], a[240:243]
  s_add_u32 s21, s21, s51
  v_mfma_f32_16x16x32_bf16 a[244:247], v[104:107], v[160:163], a[244:247]
  v_mfma_f32_16x16x32_bf16 a[248:251], v[104:107], v[164:167], a[248:251]
  v_mfma_f32_16x16x32_bf16 a[252:255], v[104:107], v[168:171], a[252:255]
  s_branch L_g2_loop
L_g2_fin:
  s_mov_b32 s59, 2
  s_mov_b32 s60, s22
  s_mov_b32 s61, s26
  s_add_u32 s62, s38, 0x3d00000
  s_mov_b32 s63, s98
  s_waitcnt lgkmcnt(0)
  v_min_u32 v245, 290, v246
  v_lshlrev_b32 v245, 2, v245
  v_add_u32 v245, 131264, v245
  ds_read_b32 v245, v245
  v_readfirstlane_b32 s34, v246
  s_add_u32 s34, s34, 32
  v_mfma_f32_16x16x32_bf16 a[0:3], v[44:47], v[108:111], a[0:3]
  ds_read_b128 v[76:79], v19 offset:0
  v_mfma_f32_16x16x32_bf16 a[4:7], v[44:47], v[112:115], a[4:7]
  v_mfma_f32_16x16x32_bf16 a[8:11], v[44:47], v[116:119], a[8:11]
  ds_read_b64_tr_b16 v[140:141], v22 offset:49152
  v_mfma_f32_16x16x32_bf16 a[12:15], v[44:47], v[120:123], a[12:15]
  v_mfma_f32_16x16x32_bf16 a[16:19], v[44:47], v[124:127], a[16:19]
  ds_read_b64_tr_b16 v[142:143], v22 offset:51200
  v_mfma_f32_16x16x32_bf16 a[20:23], v[44:47], v[128:131], a[20:23]
  v_mfma_f32_16x16x32_bf16 a[24:27], v[44:47], v[132:135], a[24:27]
  ds_read_b128 v[80:83], v19 offset:2048
  v_mfma_f32_16x16x32_bf16 a[28:31], v[44:47], v[136:139], a[28:31]
  v_mfma_f32_16x16x32_bf16 a[32:35], v[48:51], v[108:111], a[32:35]
  ds_read_b64_tr_b16 v[144:145], v23 offset:49152
  v_mfma_f32_16x16x32_bf16 a[36:39], v[48:51], v[112:115], a[36:39]
  v_mfma_f32_16x16x32_bf16 a[40:43], v[48:51], v[116:119], a[40:43]
  ds_read_b64_tr_b16 v[146:147], v23 offset:51200
  v_mfma_f32_16x16x32_bf16 a[44:47], v[48:51], v[120:123], a[44:47]
  v_mfma_f32_16x16x32_bf16 a[48:51], v[48:51], v[124:127], a[48:51]
  ds_read_b128 v[84:87], v19 offset:4096
  v_mfma_f32_16x16x32_bf16 a[52:55], v[48:51], v[128:131], a[52:55]
  v_mfma_f32_16x16x32_bf16 a[56:59], v[48:51], v[132:135], a[56:59]
  ds_read_b64_tr_b16 v[148:149], v24 offset:49152
  v_mfma_f32_16x16x32_bf16 a[60:63], v[48:51], v[136:139], a[60:63]
  v_mfma_f32_16x16x32_bf16 a[64:67], v[52:55], v[108:111], a[64:67]
  ds_read_b64_tr_b16 v[150:151], v24 offset:51200
  v_mfma_f32_16x16x32_bf16 a[68:71], v[52:55], v[112:115], a[68:71]
  v_mfma_f32_16x16x32_bf16 a[72:75], v[52:55], v[116:119], a[72:75]
  ds_read_b128 v[88:91], v19 offset:6144
  v_mfma_f32_16x16x32_bf16 a[76:79], v[52:55], v[120:123], a[76:79]
  v_mfma_f32_16x16x32_bf16 a[80:83], v[52:55], v[124:127], a[80:83]
  ds_read_b64_tr_b16 v[152:153], v25 offset:49152
  v_mfma_f32_16x16x32_bf16 a[84:87], v[52:55], v[128:131], a[84:87]
  v_mfma_f32_16x16x32_bf16 a[88:91], v[52:55], v[132:135], a[88:91]
  ds_read_b64_tr_b16 v[154:155], v25 offset:51200
  v_mfma_f32_16x16x32_bf16 a[92:95], v[52:55], v[136:139], a[92:95]
  v_mfma_f32_16x16x32_bf16 a[96:99], v[56:59], v[108:111], a[96:99]
  ds_read_b128 v[92:95], v19 offset:8192
  v_mfma_f32_16x16x32_bf16 a[100:103], v[56:59], v[112:115], a[100:103]
  v_mfma_f32_16x16x32_bf16 a[104:107], v[56:59], v[116:119], a[104:107]
  ds_read_b64_tr_b16 v[156:157], v26 offset:49152
  v_mfma_f32_16x16x32_bf16 a[108:111], v[56:59], v[120:123], a[108:111]
  v_mfma_f32_16x16x32_bf16 a[112:115], v[56:59], v[124:127], a[112:115]
  ds_read_b64_tr_b16 v[158:159], v26 offset:51200
  v_mfma_f32_16x16x32_bf16 a[116:119], v[56:59], v[128:131], a[116:119]
  v_mfma_f32_16x16x32_bf16 a[120:123], v[56:59], v[132:135], a[120:123]
  ds_read_b128 v[96:99], v19 offset:10240
  v_mfma_f32_16x16x32_bf16 a[124:127], v[56:59], v[136:139], a[124:127]
  v_mfma_f32_16x16x32_bf16 a[128:131], v[60:63], v[108:111], a[128:131]
  ds_read_b64_tr_b16 v[160:161], v27 offset:49152
  v_mfma_f32_16x16x32_bf16 a[132:135], v[60:63], v[112:115], a[132:135]
  v_mfma_f32_16x16x32_bf16 a[136:139], v[60:63], v[116:119], a[136:139]
  ds_read_b64_tr_b16 v[162:163], v27 offset:51200
  v_mfma_f32_16x16x32_bf16 a[140:143], v[60:63], v[120:123], a[140:143]
  v_mfma_f32_16x16x32_bf16 a[144:147], v[60:63], v[124:127], a[144:147]
  ds_read_b128 v[100:103], v19 offset:12288
  v_mfma_f32_16x16x32_bf16 a[148:151], v[60:63], v[128:131], a[148:151]
  v_mfma_f32_16x16x32_bf16 a[152:155], v[60:63], v[132:135], a[152:155]
  ds_read_b64_tr_b16 v[164:165], v28 offset:49152
  v_mfma_f32_16x16x32_bf16 a[156:159], v[60:63], v[136:139], a[156:159]
  v_mfma_f32_16x16x32_bf16 a[160:163], v[64:67], v[108:111], a[160:163]
  ds_read_b64_tr_b16 v[166:167], v28 offset:51200
  v_mfma_f32_16x16x32_bf16 a[164:167], v[64:67], v[112:115], a[164:167]
  v_mfma_f32_16x16x32_bf16 a[168:171], v[64:67], v[116:119], a[168:171]
  ds_read_b128 v[104:107], v19 offset:14336
  v_mfma_f32_16x16x32_bf16 a[172:175], v[64:67], v[120:123], a[172:175]
  v_mfma_f32_16x16x32_bf16 a[176:179], v[64:67], v[124:127], a[176:179]
  ds_read_b64_tr_b16 v[168:169], v29 offset:49152
  v_mfma_f32_16x16x32_bf16 a[180:183], v[64:67], v[128:131], a[180:183]
  v_mfma_f32_16x16x32_bf16 a[184:187], v[64:67], v[132:135], a[184:187]
  ds_read_b64_tr_b16 v[170:171], v29 offset:51200
  v_mfma_f32_16x16x32_bf16 a[188:191], v[64:67], v[136:139], a[188:191]
  v_mfma_f32_16x16x32_bf16 a[192:195], v[68:71], v[108:111], a[192:195]
  v_mfma_f32_16x16x32_bf16 a[196:199], v[68:71], v[112:115], a[196:199]
  v_mfma_f32_16x16x32_bf16 a[200:203], v[68:71], v[116:119], a[200:203]
  v_mfma_f32_16x16x32_bf16 a[204:207], v[68:71], v[120:123], a[204:207]
  v_mfma_f32_16x16x32_bf16 a[208:211], v[68:71], v[124:127], a[208:211]
  v_mfma_f32_16x16x32_bf16 a[212:215], v[68:71], v[128:131], a[212:215]
  v_mfma_f32_16x16x32_bf16 a[216:219], v[68:71], v[132:135], a[216:219]
  v_mfma_f32_16x16x32_bf16 a[220:223], v[68:71], v[136:139], a[220:223]
  v_mfma_f32_16x16x32_bf16 a[224:227], v[72:75], v[108:111], a[224:227]
  v_mfma_f32_16x16x32_bf16 a[228:231], v[72:75], v[112:115], a[228:231]
  v_mfma_f32_16x16x32_bf16 a[232:235], v[72:75], v[116:119], a[232:235]
  v_mfma_f32_16x16x32_bf16 a[236:239], v[72:75], v[120:123], a[236:239]
  v_mfma_f32_16x16x32_bf16 a[240:243], v[72:75], v[124:127], a[240:243]
  v_mfma_f32_16x16x32_bf16 a[244:247], v[72:75], v[128:131], a[244:247]
  v_mfma_f32_16x16x32_bf16 a[248:251], v[72:75], v[132:135], a[248:251]
  v_mfma_f32_16x16x32_bf16 a[252:255], v[72:75], v[136:139], a[252:255]
  s_waitcnt lgkmcnt(0)
  v_mfma_f32_16x16x32_bf16 a[0:3], v[76:79], v[140:143], a[0:3]
  s_waitcnt vmcnt(0)
  s_barrier
  v_readfirstlane_b32 s91, v245
  s_and_b32 s35, s91, 255
  s_lshr_b32 s36, s91, 8
  s_and_b32 s36, s36, 255
  s_lshr_b32 s37, s91, 16
  s_mov_b32 s92, s24
  s_cmp_gt_u32 s35, 3
  s_cbranch_scc1 L_cd_49
  s_cmp_eq_u32 s35, 3
  s_cbranch_scc1 L_cd_47
  s_mov_b32 s8, s64
  s_and_b32 s9, s65, 0xffff
  s_mov_b32 s10, 0x400000
  s_mov_b32 s11, 0x20000
  s_cmp_eq_u32 s35, 0
  s_cselect_b64 s[88:89], s[68:69], s[70:71]
  s_cmp_eq_u32 s35, 2
  s_cselect_b64 s[88:89], s[72:73], s[88:89]
  s_mov_b32 s12, s88
  s_and_b32 s13, s89, 0xffff
  s_mov_b32 s14, 0x800000
  s_mov_b32 s15, 0x20000
  s_lshl_b32 s91, s33, 2
  s_add_u32 s91, s91, s37
  s_mov_b32 s24, 8192
  s_mov_b32 s26, 262144
  s_lshl_b32 s20, s36, 19
  s_lshl_b32 s21, s91, 9
  s_lshl_b32 s22, s35, 24
  s_lshl_b32 s90, s36, 21
  s_add_u32 s22, s22, s90
  s_lshl_b32 s90, s91, 14
  s_add_u32 s22, s22, s90
  s_lshl_b32 s38, s36, 9
  s_add_u32 s38, s38, 28672
  s_cmp_eq_u32 s35, 0
  s_cselect_b32 s38, 8192, s38
  s_cselect_b32 s98, 1, 2
  s_mov_b32 s48, s35
  s_branch L_cd_48
L_cd_49:
  s_mov_b64 vcc, 0
  s_mov_b32 s58, 0
  s_branch L_cd_50
L_cd_47:
  s_mov_b32 s8, s78
  s_and_b32 s9, s79, 0xffff
  s_mov_b32 s10, 0x400000
  s_mov_b32 s11, 0x20000
  s_mov_b32 s12, s80
  s_and_b32 s13, s81, 0xffff
  s_mov_b32 s14, 0x600000
  s_mov_b32 s15, 0x20000
  s_lshl_b32 s91, s37, 2
  s_add_u32 s91, s91, s33
  s_mov_b32 s24, 6144
  s_mov_b32 s26, 65536
  s_lshl_b32 s20, s36, 19
  s_lshl_b32 s21, s91, 9
  s_lshl_b32 s22, s37, 22
  s_lshl_b32 s90, s36, 19
  s_add_u32 s22, s22, s90
  s_lshl_b32 s90, s33, 14
  s_add_u32 s22, s22, s90
  s_add_u32 s22, s22, 0x4000000
  s_mov_b32 s38, 12288
  s_mov_b32 s48, s37
  s_mov_b32 s98, 1
L_cd_48:
  s_lshl_b32 s90, s36, 9
  s_add_u32 s38, s38, s90
  s_lshl_b32 s90, s33, 7
  s_add_u32 s38, s38, s90
  s_mov_b32 s23, 2048
  s_mov_b32 s25, 8
  s_mov_b64 vcc, -1
  s_sub_i32 s92, s24, s92
  s_lshl_b32 s51, s24, 6
  v_mul_i32_i24 v38, s92, v174
  s_mul_i32 s92, s92, 2
  s_mov_b32 s93, 0
  v_add3_u32 v10, v10, v38, s93
  s_add_u32 s93, s93, s92
  v_add3_u32 v11, v11, v38, s93
  s_add_u32 s93, s93, s92
  v_add3_u32 v12, v12, v38, s93
  s_add_u32 s93, s93, s92
  v_add3_u32 v13, v13, v38, s93
  s_add_u32 s93, s93, s92
  v_add3_u32 v14, v14, v38, s93
  s_add_u32 s93, s93, s92
  v_add3_u32 v15, v15, v38, s93
  s_add_u32 s93, s93, s92
  v_add3_u32 v16, v16, v38, s93
  s_add_u32 s93, s93, s92
  v_add3_u32 v17, v17, v38, s93
  s_add_u32 s93, s93, s92
L_cd_50:
  s_add_u32 m0, s52, 0
  v_mfma_f32_16x16x32_bf16 a[4:7], v[76:79], v[144:147], a[4:7]
  s_cbranch_vccz L_gd_51
  buffer_load_dwordx4 v2, s[8:11], s20 offen  lds
L_gd_51:
  ds_read_b128 v[44:47], v20 offset:0
  v_mfma_f32_16x16x32_bf16 a[8:11], v[76:79], v[148:151], a[8:11]
  v_mfma_f32_16x16x32_bf16 a[12:15], v[76:79], v[152:155], a[12:15]
  ds_read_b64_tr_b16 v[108:109], v30 offset:32768
  s_add_u32 m0, s53, 0
  v_mfma_f32_16x16x32_bf16 a[16:19], v[76:79], v[156:159], a[16:19]
  s_cbranch_vccz L_gd_52
  buffer_load_dwordx4 v10, s[12:15], s21 offen  lds
L_gd_52:
  v_mfma_f32_16x16x32_bf16 a[20:23], v[76:79], v[160:163], a[20:23]
  ds_read_b64_tr_b16 v[110:111], v30 offset:34816
  v_mfma_f32_16x16x32_bf16 a[24:27], v[76:79], v[164:167], a[24:27]
  v_mfma_f32_16x16x32_bf16 a[28:31], v[76:79], v[168:171], a[28:31]
  ds_read_b128 v[48:51], v20 offset:2048
  s_add_u32 m0, s52, 1024
  v_mfma_f32_16x16x32_bf16 a[32:35], v[80:83], v[140:143], a[32:35]
  s_cbranch_vccz L_gd_53
  buffer_load_dwordx4 v3, s[8:11], s20 offen  lds
L_gd_53:
  v_mfma_f32_16x16x32_bf16 a[36:39], v[80:83], v[144:147], a[36:39]
  ds_read_b64_tr_b16 v[112:113], v31 offset:32768
  v_mfma_f32_16x16x32_bf16 a[40:43], v[80:83], v[148:151], a[40:43]
  v_mfma_f32_16x16x32_bf16 a[44:47], v[80:83], v[152:155], a[44:47]
  ds_read_b64_tr_b16 v[114:115], v31 offset:34816
  s_add_u32 m0, s53, 1024
  v_mfma_f32_16x16x32_bf16 a[48:51], v[80:83], v[156:159], a[48:51]
  s_cbranch_vccz L_gd_54
  buffer_load_dwordx4 v11, s[12:15], s21 offen  lds
L_gd_54:
  v_mfma_f32_16x16x32_bf16 a[52:55], v[80:83], v[160:163], a[52:55]
  ds_read_b128 v[52:55], v20 offset:4096
  v_mfma_f32_16x16x32_bf16 a[56:59], v[80:83], v[164:167], a[56:59]
  v_mfma_f32_16x16x32_bf16 a[60:63], v[80:83], v[168:171], a[60:63]
  ds_read_b64_tr_b16 v[116:117], v32 offset:32768
  s_add_u32 m0, s52, 2048
  v_mfma_f32_16x16x32_bf16 a[64:67], v[84:87], v[140:143], a[64:67]
  s_cbranch_vccz L_gd_55
  buffer_load_dwordx4 v4, s[8:11], s20 offen  lds
L_gd_55:
  v_mfma_f32_16x16x32_bf16 a[68:71], v[84:87], v[144:147], a[68:71]
  ds_read_b64_tr_b16 v[118:119], v32 offset:34816
  v_mfma_f32_16x16x32_bf16 a[72:75], v[84:87], v[148:151], a[72:75]
  v_mfma_f32_16x16x32_bf16 a[76:79], v[84:87], v[152:155], a[76:79]
  ds_read_b128 v[56:59], v20 offset:6144
  s_add_u32 m0, s53, 2048
  v_mfma_f32_16x16x32_bf16 a[80:83], v[84:87], v[156:159], a[80:83]
  s_cbranch_vccz L_gd_56
  buffer_load_dwordx4 v12, s[12:15], s21 offen  lds
L_gd_56:
  v_mfma_f32_16x16x32_bf16 a[84:87], v[84:87], v[160:163], a[84:87]
  ds_read_b64_tr_b16 v[120:121], v33 offset:32768
  v_mfma_f32_16x16x32_bf16 a[88:91], v[84:87], v[164:167], a[88:91]
  v_mfma_f32_16x16x32_bf16 a[92:95], v[84:87], v[168:171], a[92:95]
  ds_read_b64_tr_b16 v[122:123], v33 offset:34816
  s_add_u32 m0, s52, 3072
  v_mfma_f32_16x16x32_bf16 a[96:99], v[88:91], v[140:143], a[96:99]
  s_cbranch_vccz L_gd_57
  buffer_load_dwordx4 v5, s[8:11], s20 offen  lds
L_gd_57:
  v_mfma_f32_16x16x32_bf16 a[100:103], v[88:91], v[144:147], a[100:103]
  ds_read_b128 v[60:63], v20 offset:8192
  v_mfma_f32_16x16x32_bf16 a[104:107], v[88:91], v[148:151], a[104:107]
  v_mfma_f32_16x16x32_bf16 a[108:111], v[88:91], v[152:155], a[108:111]
  ds_read_b64_tr_b16 v[124:125], v34 offset:32768
  s_add_u32 m0, s53, 3072
  v_mfma_f32_16x16x32_bf16 a[112:115], v[88:91], v[156:159], a[112:115]
  s_cbranch_vccz L_gd_58
  buffer_load_dwordx4 v13, s[12:15], s21 offen  lds
L_gd_58:
  v_mfma_f32_16x16x32_bf16 a[116:119], v[88:91], v[160:163], a[116:119]
  ds_read_b64_tr_b16 v[126:127], v34 offset:34816
  v_mfma_f32_16x16x32_bf16 a[120:123], v[88:91], v[164:167], a[120:123]
  v_mfma_f32_16x16x32_bf16 a[124:127], v[88:91], v[168:171], a[124:127]
  ds_read_b128 v[64:67], v20 offset:10240
  s_add_u32 m0, s52, 4096
  v_mfma_f32_16x16x32_bf16 a[128:131], v[92:95], v[140:143], a[128:131]
  s_cbranch_vccz L_gd_59
  buffer_load_dwordx4 v6, s[8:11], s20 offen  lds
L_gd_59:
  v_mfma_f32_16x16x32_bf16 a[132:135], v[92:95], v[144:147], a[132:135]
  ds_read_b64_tr_b16 v[128:129], v35 offset:32768
  v_mfma_f32_16x16x32_bf16 a[136:139], v[92:95], v[148:151], a[136:139]
  v_mfma_f32_16x16x32_bf16 a[140:143], v[92:95], v[152:155], a[140:143]
  ds_read_b64_tr_b16 v[130:131], v35 offset:34816
  s_add_u32 m0, s53, 4096
  v_mfma_f32_16x16x32_bf16 a[144:147], v[92:95], v[156:159], a[144:147]
  s_cbranch_vccz L_gd_60
  buffer_load_dwordx4 v14, s[12:15], s21 offen  lds
L_gd_60:
  v_mfma_f32_16x16x32_bf16 a[148:151], v[92:95], v[160:163], a[148:151]
  ds_read_b128 v[68:71], v20 offset:12288
  v_mfma_f32_16x16x32_bf16 a[152:155], v[92:95], v[164:167], a[152:155]
  v_mfma_f32_16x16x32_bf16 a[156:159], v[92:95], v[168:171], a[156:159]
  ds_read_b64_tr_b16 v[132:133], v36 offset:32768
  s_add_u32 m0, s52, 5120
  v_mfma_f32_16x16x32_bf16 a[160:163], v[96:99], v[140:143], a[160:163]
  s_cbranch_vccz L_gd_61
  buffer_load_dwordx4 v7, s[8:11], s20 offen  lds
L_gd_61:
  v_mfma_f32_16x16x32_bf16 a[164:167], v[96:99], v[144:147], a[164:167]
  ds_read_b64_tr_b16 v[134:135], v36 offset:34816
  v_mfma_f32_16x16x32_bf16 a[168:171], v[96:99], v[148:151], a[168:171]
  v_mfma_f32_16x16x32_bf16 a[172:175], v[96:99], v[152:155], a[172:175]
  ds_read_b128 v[72:75], v20 offset:14336
  s_add_u32 m0, s53, 5120
  v_mfma_f32_16x16x32_bf16 a[176:179], v[96:99], v[156:159], a[176:179]
  s_cbranch_vccz L_gd_62
  buffer_load_dwordx4 v15, s[12:15], s21 offen  lds
L_gd_62:
  v_mfma_f32_16x16x32_bf16 a[180:183], v[96:99], v[160:163], a[180:183]
  ds_read_b64_tr_b16 v[136:137], v37 offset:32768
  v_mfma_f32_16x16x32_bf16 a[184:187], v[96:99], v[164:167], a[184:187]
  v_mfma_f32_16x16x32_bf16 a[188:191], v[96:99], v[168:171], a[188:191]
  ds_read_b64_tr_b16 v[138:139], v37 offset:34816
  s_add_u32 m0, s52, 6144
  v_mfma_f32_16x16x32_bf16 a[192:195], v[100:103], v[140:143], a[192:195]
  s_cbranch_vccz L_gd_63
  buffer_load_dwordx4 v8, s[8:11], s20 offen  lds
L_gd_63:
  v_mfma_f32_16x16x32_bf16 a[196:199], v[100:103], v[144:147], a[196:199]
  v_mfma_f32_16x16x32_bf16 a[200:203], v[100:103], v[148:151], a[200:203]
  v_mfma_f32_16x16x32_bf16 a[204:207], v[100:103], v[152:155], a[204:207]
  s_add_u32 m0, s53, 6144
  v_mfma_f32_16x16x32_bf16 a[208:211], v[100:103], v[156:159], a[208:211]
  s_cbranch_vccz L_gd_64
  buffer_load_dwordx4 v16, s[12:15], s21 offen  lds
L_gd_64:
  v_mfma_f32_16x16x32_bf16 a[212:215], v[100:103], v[160:163], a[212:215]
  v_mfma_f32_16x16x32_bf16 a[216:219], v[100:103], v[164:167], a[216:219]
  v_mfma_f32_16x16x32_bf16 a[220:223], v[100:103], v[168:171], a[220:223]
  s_add_u32 m0, s52, 7168
  v_mfma_f32_16x16x32_bf16 a[224:227], v[104:107], v[140:143], a[224:227]
  s_cbranch_vccz L_gd_65
  buffer_load_dwordx4 v9, s[8:11], s20 offen  lds
L_gd_65:
  v_mfma_f32_16x16x32_bf16 a[228:231], v[104:107], v[144:147], a[228:231]
  v_mfma_f32_16x16x32_bf16 a[232:235], v[104:107], v[148:151], a[232:235]
  v_mfma_f32_16x16x32_bf16 a[236:239], v[104:107], v[152:155], a[236:239]
  s_add_u32 m0, s53, 7168
  v_mfma_f32_16x16x32_bf16 a[240:243], v[104:107], v[156:159], a[240:243]
  s_cbranch_vccz L_gd_66
  buffer_load_dwordx4 v17, s[12:15], s21 offen  lds
  s_add_u32 s20, s20, 128
  s_add_u32 s21, s21, s51
L_gd_66:
  v_mfma_f32_16x16x32_bf16 a[244:247], v[104:107], v[160:163], a[244:247]
  v_mfma_f32_16x16x32_bf16 a[248:251], v[104:107], v[164:167], a[248:251]
  v_mfma_f32_16x16x32_bf16 a[252:255], v[104:107], v[168:171], a[252:255]
  s_waitcnt lgkmcnt(0)
  v_mfma_f32_16x16x32_bf16 a[0:3], v[44:47], v[108:111], a[0:3]
  ds_read_b128 v[76:79], v21 offset:0
  v_mfma_f32_16x16x32_bf16 a[4:7], v[44:47], v[112:115], a[4:7]
  v_mfma_f32_16x16x32_bf16 a[8:11], v[44:47], v[116:119], a[8:11]
  ds_read_b64_tr_b16 v[140:141], v30 offset:49152
  v_mfma_f32_16x16x32_bf16 a[12:15], v[44:47], v[120:123], a[12:15]
  v_mfma_f32_16x16x32_bf16 a[16:19], v[44:47], v[124:127], a[16:19]
  ds_read_b64_tr_b16 v[142:143], v30 offset:51200
  v_mfma_f32_16x16x32_bf16 a[20:23], v[44:47], v[128:131], a[20:23]
  v_mfma_f32_16x16x32_bf16 a[24:27], v[44:47], v[132:135], a[24:27]
  ds_read_b128 v[80:83], v21 offset:2048
  v_mfma_f32_16x16x32_bf16 a[28:31], v[44:47], v[136:139], a[28:31]
  v_mfma_f32_16x16x32_bf16 a[32:35], v[48:51], v[108:111], a[32:35]
  ds_read_b64_tr_b16 v[144:145], v31 offset:49152
  v_mfma_f32_16x16x32_bf16 a[36:39], v[48:51], v[112:115], a[36:39]
  v_mfma_f32_16x16x32_bf16 a[40:43], v[48:51], v[116:119], a[40:43]
  ds_read_b64_tr_b16 v[146:147], v31 offset:51200
  v_mfma_f32_16x16x32_bf16 a[44:47], v[48:51], v[120:123], a[44:47]
  v_mfma_f32_16x16x32_bf16 a[48:51], v[48:51], v[124:127], a[48:51]
  ds_read_b128 v[84:87], v21 offset:4096
  v_mfma_f32_16x16x32_bf16 a[52:55], v[48:51], v[128:131], a[52:55]
  v_mfma_f32_16x16x32_bf16 a[56:59], v[48:51], v[132:135], a[56:59]
  ds_read_b64_tr_b16 v[148:149], v32 offset:49152
  v_mfma_f32_16x16x32_bf16 a[60:63], v[48:51], v[136:139], a[60:63]
  v_mfma_f32_16x16x32_bf16 a[64:67], v[52:55], v[108:111], a[64:67]
  ds_read_b64_tr_b16 v[150:151], v32 offset:51200
  v_mfma_f32_16x16x32_bf16 a[68:71], v[52:55], v[112:115], a[68:71]
  v_mfma_f32_16x16x32_bf16 a[72:75], v[52:55], v[116:119], a[72:75]
  ds_read_b128 v[88:91], v21 offset:6144
  v_mfma_f32_16x16x32_bf16 a[76:79], v[52:55], v[120:123], a[76:79]
  v_mfma_f32_16x16x32_bf16 a[80:83], v[52:55], v[124:127], a[80:83]
  ds_read_b64_tr_b16 v[152:153], v33 offset:49152
  v_mfma_f32_16x16x32_bf16 a[84:87], v[52:55], v[128:131], a[84:87]
  v_mfma_f32_16x16x32_bf16 a[88:91], v[52:55], v[132:135], a[88:91]
  ds_read_b64_tr_b16 v[154:155], v33 offset:51200
  v_mfma_f32_16x16x32_bf16 a[92:95], v[52:55], v[136:139], a[92:95]
  v_mfma_f32_16x16x32_bf16 a[96:99], v[56:59], v[108:111], a[96:99]
  ds_read_b128 v[92:95], v21 offset:8192
  v_mfma_f32_16x16x32_bf16 a[100:103], v[56:59], v[112:115], a[100:103]
  v_mfma_f32_16x16x32_bf16 a[104:107], v[56:59], v[116:119], a[104:107]
  ds_read_b64_tr_b16 v[156:157], v34 offset:49152
  v_mfma_f32_16x16x32_bf16 a[108:111], v[56:59], v[120:123], a[108:111]
  v_mfma_f32_16x16x32_bf16 a[112:115], v[56:59], v[124:127], a[112:115]
  ds_read_b64_tr_b16 v[158:159], v34 offset:51200
  v_mfma_f32_16x16x32_bf16 a[116:119], v[56:59], v[128:131], a[116:119]
  v_mfma_f32_16x16x32_bf16 a[120:123], v[56:59], v[132:135], a[120:123]
  ds_read_b128 v[96:99], v21 offset:10240
  v_mfma_f32_16x16x32_bf16 a[124:127], v[56:59], v[136:139], a[124:127]
  v_mfma_f32_16x16x32_bf16 a[128:131], v[60:63], v[108:111], a[128:131]
  ds_read_b64_tr_b16 v[160:161], v35 offset:49152
  v_mfma_f32_16x16x32_bf16 a[132:135], v[60:63], v[112:115], a[132:135]
  v_mfma_f32_16x16x32_bf16 a[136:139], v[60:63], v[116:119], a[136:139]
  ds_read_b64_tr_b16 v[162:163], v35 offset:51200
  v_mfma_f32_16x16x32_bf16 a[140:143], v[60:63], v[120:123], a[140:143]
  v_mfma_f32_16x16x32_bf16 a[144:147], v[60:63], v[124:127], a[144:147]
  ds_read_b128 v[100:103], v21 offset:12288
  v_mfma_f32_16x16x32_bf16 a[148:151], v[60:63], v[128:131], a[148:151]
  v_mfma_f32_16x16x32_bf16 a[152:155], v[60:63], v[132:135], a[152:155]
  ds_read_b64_tr_b16 v[164:165], v36 offset:49152
  v_mfma_f32_16x16x32_bf16 a[156:159], v[60:63], v[136:139], a[156:159]
  v_mfma_f32_16x16x32_bf16 a[160:163], v[64:67], v[108:111], a[160:163]
  ds_read_b64_tr_b16 v[166:167], v36 offset:51200
  v_mfma_f32_16x16x32_bf16 a[164:167], v[64:67], v[112:115], a[164:167]
  v_mfma_f32_16x16x32_bf16 a[168:171], v[64:67], v[116:119], a[168:171]
  ds_read_b128 v[104:107], v21 offset:14336
  v_mfma_f32_16x16x32_bf16 a[172:175], v[64:67], v[120:123], a[172:175]
  v_mfma_f32_16x16x32_bf16 a[176:179], v[64:67], v[124:127], a[176:179]
  ds_read_b64_tr_b16 v[168:169], v37 offset:49152
  v_mfma_f32_16x16x32_bf16 a[180:183], v[64:67], v[128:131], a[180:183]
  v_mfma_f32_16x16x32_bf16 a[184:187], v[64:67], v[132:135], a[184:187]
  ds_read_b64_tr_b16 v[170:171], v37 offset:51200
  v_mfma_f32_16x16x32_bf16 a[188:191], v[64:67], v[136:139], a[188:191]
  v_mfma_f32_16x16x32_bf16 a[192:195], v[68:71], v[108:111], a[192:195]
  v_mfma_f32_16x16x32_bf16 a[196:199], v[68:71], v[112:115], a[196:199]
  v_mfma_f32_16x16x32_bf16 a[200:203], v[68:71], v[116:119], a[200:203]
  v_mfma_f32_16x16x32_bf16 a[204:207], v[68:71], v[120:123], a[204:207]
  v_mfma_f32_16x16x32_bf16 a[208:211], v[68:71], v[124:127], a[208:211]
  v_mfma_f32_16x16x32_bf16 a[212:215], v[68:71], v[128:131], a[212:215]
  v_mfma_f32_16x16x32_bf16 a[216:219], v[68:71], v[132:135], a[216:219]
  v_mfma_f32_16x16x32_bf16 a[220:223], v[68:71], v[136:139], a[220:223]
  v_mfma_f32_16x16x32_bf16 a[224:227], v[72:75], v[108:111], a[224:227]
  v_mfma_f32_16x16x32_bf16 a[228:231], v[72:75], v[112:115], a[228:231]
  v_mfma_f32_16x16x32_bf16 a[232:235], v[72:75], v[116:119], a[232:235]
  v_mfma_f32_16x16x32_bf16 a[236:239], v[72:75], v[120:123], a[236:239]
  v_mfma_f32_16x16x32_bf16 a[240:243], v[72:75], v[124:127], a[240:243]
  v_mfma_f32_16x16x32_bf16 a[244:247], v[72:75], v[128:131], a[244:247]
  v_mfma_f32_16x16x32_bf16 a[248:251], v[72:75], v[132:135], a[248:251]
  v_mfma_f32_16x16x32_bf16 a[252:255], v[72:75], v[136:139], a[252:255]
  s_waitcnt lgkmcnt(0)
  v_mfma_f32_16x16x32_bf16 a[0:3], v[76:79], v[140:143], a[0:3]
  s_barrier
  s_add_u32 m0, s52, 65536
  v_mfma_f32_16x16x32_bf16 a[4:7], v[76:79], v[144:147], a[4:7]
  s_cbranch_vccz L_gd_67
  buffer_load_dwordx4 v2, s[8:11], s20 offen  lds
L_gd_67:
  v_mfma_f32_16x16x32_bf16 a[8:11], v[76:79], v[148:151], a[8:11]
  v_mfma_f32_16x16x32_bf16 a[12:15], v[76:79], v[152:155], a[12:15]
  s_add_u32 m0, s53, 65536
  v_mfma_f32_16x16x32_bf16 a[16:19], v[76:79], v[156:159], a[16:19]
  s_cbranch_vccz L_gd_68
  buffer_load_dwordx4 v10, s[12:15], s21 offen  lds
L_gd_68:
  v_mfma_f32_16x16x32_bf16 a[20:23], v[76:79], v[160:163], a[20:23]
  v_mfma_f32_16x16x32_bf16 a[24:27], v[76:79], v[164:167], a[24:27]
  v_mfma_f32_16x16x32_bf16 a[28:31], v[76:79], v[168:171], a[28:31]
  s_add_u32 m0, s52, 66560
  v_mfma_f32_16x16x32_bf16 a[32:35], v[80:83], v[140:143], a[32:35]
  s_cbranch_vccz L_gd_69
  buffer_load_dwordx4 v3, s[8:11], s20 offen  lds
L_gd_69:
  v_mfma_f32_16x16x32_bf16 a[36:39], v[80:83], v[144:147], a[36:39]
  v_mfma_f32_16x16x32_bf16 a[40:43], v[80:83], v[148:151], a[40:43]
  v_mfma_f32_16x16x32_bf16 a[44:47], v[80:83], v[152:155], a[44:47]
  s_add_u32 m0, s53, 66560
  v_mfma_f32_16x16x32_bf16 a[48:51], v[80:83], v[156:159], a[48:51]
  s_cbranch_vccz L_gd_70
  buffer_load_dwordx4 v11, s[12:15], s21 offen  lds
L_gd_70:
  v_mfma_f32_16x16x32_bf16 a[52:55], v[80:83], v[160:163], a[52:55]
  v_mfma_f32_16x16x32_bf16 a[56:59], v[80:83], v[164:167], a[56:59]
  v_mfma_f32_16x16x32_bf16 a[60:63], v[80:83], v[168:171], a[60:63]
  s_add_u32 m0, s52, 67584
  v_mfma_f32_16x16x32_bf16 a[64:67], v[84:87], v[140:143], a[64:67]
  s_cbranch_vccz L_gd_71
  buffer_load_dwordx4 v4, s[8:11], s20 offen  lds
L_gd_71:
  v_mfma_f32_16x16x32_bf16 a[68:71], v[84:87], v[144:147], a[68:71]
  v_mfma_f32_16x16x32_bf16 a[72:75], v[84:87], v[148:151], a[72:75]
  v_mfma_f32_16x16x32_bf16 a[76:79], v[84:87], v[152:155], a[76:79]
  s_add_u32 m0, s53, 67584
  v_mfma_f32_16x16x32_bf16 a[80:83], v[84:87], v[156:159], a[80:83]
  s_cbranch_vccz L_gd_72
  buffer_load_dwordx4 v12, s[12:15], s21 offen  lds
L_gd_72:
  v_mfma_f32_16x16x32_bf16 a[84:87], v[84:87], v[160:163], a[84:87]
  v_mfma_f32_16x16x32_bf16 a[88:91], v[84:87], v[164:167], a[88:91]
  v_mfma_f32_16x16x32_bf16 a[92:95], v[84:87], v[168:171], a[92:95]
  s_add_u32 m0, s52, 68608
  v_mfma_f32_16x16x32_bf16 a[96:99], v[88:91], v[140:143], a[96:99]
  s_cbranch_vccz L_gd_73
  buffer_load_dwordx4 v5, s[8:11], s20 offen  lds
L_gd_73:
  v_mfma_f32_16x16x32_bf16 a[100:103], v[88:91], v[144:147], a[100:103]
  v_mfma_f32_16x16x32_bf16 a[104:107], v[88:91], v[148:151], a[104:107]
  v_mfma_f32_16x16x32_bf16 a[108:111], v[88:91], v[152:155], a[108:111]
  s_add_u32 m0, s53, 68608
  v_mfma_f32_16x16x32_bf16 a[112:115], v[88:91], v[156:159], a[112:115]
  s_cbranch_vccz L_gd_74
  buffer_load_dwordx4 v13, s[12:15], s21 offen  lds
L_gd_74:
  v_mfma_f32_16x16x32_bf16 a[116:119], v[88:91], v[160:163], a[116:119]
  v_mfma_f32_16x16x32_bf16 a[120:123], v[88:91], v[164:167], a[120:123]
  v_mfma_f32_16x16x32_bf16 a[124:127], v[88:91], v[168:171], a[124:127]
  s_add_u32 m0, s52, 69632
  v_mfma_f32_16x16x32_bf16 a[128:131], v[92:95], v[140:143], a[128:131]
  s_cbranch_vccz L_gd_75
  buffer_load_dwordx4 v6, s[8:11], s20 offen  lds
L_gd_75:
  v_mfma_f32_16x16x32_bf16 a[132:135], v[92:95], v[144:147], a[132:135]
  v_mfma_f32_16x16x32_bf16 a[136:139], v[92:95], v[148:151], a[136:139]
  v_mfma_f32_16x16x32_bf16 a[140:143], v[92:95], v[152:155], a[140:143]
  s_add_u32 m0, s53, 69632
  v_mfma_f32_16x16x32_bf16 a[144:147], v[92:95], v[156:159], a[144:147]
  s_cbranch_vccz L_gd_76
  buffer_load_dwordx4 v14, s[12:15], s21 offen  lds
L_gd_76:
  v_mfma_f32_16x16x32_bf16 a[148:151], v[92:95], v[160:163], a[148:151]
  v_mfma_f32_16x16x32_bf16 a[152:155], v[92:95], v[164:167], a[152:155]
  v_mfma_f32_16x16x32_bf16 a[156:159], v[92:95], v[168:171], a[156:159]
  s_add_u32 m0, s52, 70656
  v_mfma_f32_16x16x32_bf16 a[160:163], v[96:99], v[140:143], a[160:163]
  s_cbranch_vccz L_gd_77
  buffer_load_dwordx4 v7, s[8:11], s20 offen  lds
L_gd_77:
  v_mfma_f32_16x16x32_bf16 a[164:167], v[96:99], v[144:147], a[164:167]
  v_mfma_f32_16x16x32_bf16 a[168:171], v[96:99], v[148:151], a[168:171]
  v_mfma_f32_16x16x32_bf16 a[172:175], v[96:99], v[152:155], a[172:175]
  s_add_u32 m0, s53, 70656
  v_mfma_f32_16x16x32_bf16 a[176:179], v[96:99], v[156:159], a[176:179]
  s_cbranch_vccz L_gd_78
  buffer_load_dwordx4 v15, s[12:15], s21 offen  lds
L_gd_78:
  v_mfma_f32_16x16x32_bf16 a[180:183], v[96:99], v[160:163], a[180:183]
  v_mfma_f32_16x16x32_bf16 a[184:187], v[96:99], v[164:167], a[184:187]
  v_mfma_f32_16x16x32_bf16 a[188:191], v[96:99], v[168:171], a[188:191]
  s_add_u32 m0, s52, 71680
  v_mfma_f32_16x16x32_bf16 a[192:195], v[100:103], v[140:143], a[192:195]
  s_cbranch_vccz L_gd_79
  buffer_load_dwordx4 v8, s[8:11], s20 offen  lds
L_gd_79:
  v_mfma_f32_16x16x32_bf16 a[196:199], v[100:103], v[144:147], a[196:199]
  v_mfma_f32_16x16x32_bf16 a[200:203], v[100:103], v[148:151], a[200:203]
  v_mfma_f32_16x16x32_bf16 a[204:207], v[100:103], v[152:155], a[204:207]
  s_add_u32 m0, s53, 71680
  v_mfma_f32_16x16x32_bf16 a[208:211], v[100:103], v[156:159], a[208:211]
  s_cbranch_vccz L_gd_80
  buffer_load_dwordx4 v16, s[12:15], s21 offen  lds
L_gd_80:
  v_mfma_f32_16x16x32_bf16 a[212:215], v[100:103], v[160:163], a[212:215]
  v_mfma_f32_16x16x32_bf16 a[216:219], v[100:103], v[164:167], a[216:219]
  v_mfma_f32_16x16x32_bf16 a[220:223], v[100:103], v[168:171], a[220:223]
  s_add_u32 m0, s52, 72704
  v_mfma_f32_16x16x32_bf16 a[224:227], v[104:107], v[140:143], a[224:227]
  s_cbranch_vccz L_gd_81
  buffer_load_dwordx4 v9, s[8:11], s20 offen  lds
L_gd_81:
  v_mfma_f32_16x16x32_bf16 a[228:231], v[104:107], v[144:147], a[228:231]
  v_mfma_f32_16x16x32_bf16 a[232:235], v[104:107], v[148:151], a[232:235]
  v_mfma_f32_16x16x32_bf16 a[236:239], v[104:107], v[152:155], a[236:239]
  s_add_u32 m0, s53, 72704
  v_mfma_f32_16x16x32_bf16 a[240:243], v[104:107], v[156:159], a[240:243]
  s_cbranch_vccz L_gd_82
  buffer_load_dwordx4 v17, s[12:15], s21 offen  lds
  s_add_u32 s20, s20, 128
  s_add_u32 s21, s21, s51
L_gd_82:
  v_mfma_f32_16x16x32_bf16 a[244:247], v[104:107], v[160:163], a[244:247]
  v_mfma_f32_16x16x32_bf16 a[248:251], v[104:107], v[164:167], a[248:251]
  v_mfma_f32_16x16x32_bf16 a[252:255], v[104:107], v[168:171], a[252:255]
  s_cmp_eq_u32 s58, 1
  s_cbranch_scc1 L_epi
  s_branch L_have1
L_g2_cw:
  s_mov_b64 exec, 1
  ds_write_b32 v175, v244
  s_mov_b64 exec, -1
  s_branch L_g2_cwb
L_g2_cr:
  ds_read_b32 v246, v241
  s_cmp_eq_u32 s25, 1
  s_cbranch_scc1 L_g2_crb
  s_cmp_lg_u32 s32, 0
  s_cbranch_scc1 L_rq_83
  s_cmp_eq_u32 s39, 0
  s_cbranch_scc1 L_rq_83
  s_lshl_b32 s99, s33, 7
  s_add_u32 s99, s99, 0x3d00200
  v_mov_b32 v244, 1
  v_mov_b32 v245, 0
  s_mov_b64 exec, 1
  buffer_atomic_add v244, v245, s[4:7], s99 offen sc0 sc1
  s_mov_b64 exec, -1
L_rq_83:
  s_branch L_g2_crb
L_small:
  s_mov_b32 s8, s64
  s_and_b32 s9, s65, 0xffff
  s_mov_b32 s10, 0x400000
  s_mov_b32 s11, 0x20000
  s_cmp_eq_u32 s35, 9
  s_cselect_b64 s[88:89], s[70:71], s[72:73]
  s_mov_b32 s12, s88
  s_and_b32 s13, s89, 0xffff
  s_mov_b32 s14, 0x800000
  s_mov_b32 s15, 0x20000
  s_lshl_b32 s91, s33, 3
  s_add_u32 s91, s91, s37
  s_mov_b32 s24, 8192
  s_mov_b32 s26, 262144
  s_mov_b32 s23, 2048
  s_mov_b32 s25, 4
  s_lshl_b32 s20, s36, 18
  s_lshl_b32 s21, s91, 8
  s_sub_u32 s22, s35, 8
  s_lshl_b32 s22, s22, 24
  s_lshl_b32 s90, s36, 20
  s_add_u32 s22, s22, s90
  s_lshl_b32 s90, s91, 13
  s_add_u32 s22, s22, s90
  s_lshl_b32 s38, s36, 9
  s_add_u32 s38, s38, 28672
  s_lshl_b32 s90, s33, 7
  s_add_u32 s38, s38, s90
  v_and_b32 v1, 63, v0
  v_lshrrev_b32 v22, 6, v0
  s_nop 0
  v_readfirstlane_b32 s27, v22
  s_mul_i32 s90, s27, 32
  v_lshrrev_b32 v22, 3, v1
  v_add_u32 v22, s90, v22
  v_mul_lo_u32 v22, v22, s23
  v_lshrrev_b32 v23, 4, v1
  v_xor_b32 v23, v23, v1
  v_and_b32 v23, 7, v23
  v_lshl_add_u32 v2, v23, 4, v22
  s_mul_i32 s91, s23, 8
  v_add_u32 v3, s91, v2
  v_xor_b32 v3, 64, v3
  v_add_u32 v4, s91, v3
  v_xor_b32 v4, 64, v4
  v_add_u32 v5, s91, v4
  v_xor_b32 v5, 64, v5
  s_mul_i32 s90, s27, 16
  v_lshrrev_b32 v22, 4, v1
  v_add_u32 v22, 0, v22
  v_add_u32 v22, s90, v22
  v_and_b32 v23, 3, v22
  v_lshlrev_b32 v23, 1, v23
  v_and_b32 v24, 8, v22
  v_or_b32 v23, v23, v24
  v_xor_b32 v23, v23, v1
  v_and_b32 v23, 15, v23
  v_mul_lo_u32 v22, v22, s24
  v_lshl_add_u32 v6, v23, 4, v22
  v_lshrrev_b32 v22, 4, v1
  v_add_u32 v22, 4, v22
  v_add_u32 v22, s90, v22
  v_and_b32 v23, 3, v22
  v_lshlrev_b32 v23, 1, v23
  v_and_b32 v24, 8, v22
  v_or_b32 v23, v23, v24
  v_xor_b32 v23, v23, v1
  v_and_b32 v23, 15, v23
  v_mul_lo_u32 v22, v22, s24
  v_lshl_add_u32 v7, v23, 4, v22
  v_lshrrev_b32 v22, 4, v1
  v_add_u32 v22, 8, v22
  v_add_u32 v22, s90, v22
  v_and_b32 v23, 3, v22
  v_lshlrev_b32 v23, 1, v23
  v_and_b32 v24, 8, v22
  v_or_b32 v23, v23, v24
  v_xor_b32 v23, v23, v1
  v_and_b32 v23, 15, v23
  v_mul_lo_u32 v22, v22, s24
  v_lshl_add_u32 v8, v23, 4, v22
  v_lshrrev_b32 v22, 4, v1
  v_add_u32 v22, 12, v22
  v_add_u32 v22, s90, v22
  v_and_b32 v23, 3, v22
  v_lshlrev_b32 v23, 1, v23
  v_and_b32 v24, 8, v22
  v_or_b32 v23, v23, v24
  v_xor_b32 v23, v23, v1
  v_and_b32 v23, 15, v23
  v_mul_lo_u32 v22, v22, s24
  v_lshl_add_u32 v9, v23, 4, v22
  s_mul_i32 s51, s24, 64
  s_mul_i32 s52, s27, 4096
  s_mul_i32 s53, s27, 4096
  s_add_u32 s53, s53, 16384
  s_add_u32 m0, s52, 0
  s_nop 0
  buffer_load_dwordx4 v2, s[8:11], s20 offen  lds
  s_add_u32 m0, s53, 0
  s_nop 0
  buffer_load_dwordx4 v6, s[12:15], s21 offen  lds
  s_add_u32 m0, s52, 1024
  s_nop 0
  buffer_load_dwordx4 v3, s[8:11], s20 offen  lds
  s_add_u32 m0, s53, 1024
  s_nop 0
  buffer_load_dwordx4 v7, s[12:15], s21 offen  lds
  s_add_u32 m0, s52, 2048
  s_nop 0
  buffer_load_dwordx4 v4, s[8:11], s20 offen  lds
  s_add_u32 m0, s53, 2048
  s_nop 0
  buffer_load_dwordx4 v8, s[12:15], s21 offen  lds
  s_add_u32 m0, s52, 3072
  s_nop 0
  buffer_load_dwordx4 v5, s[8:11], s20 offen  lds
  s_add_u32 m0, s53, 3072
  s_nop 0
  buffer_load_dwordx4 v9, s[12:15], s21 offen  lds
  s_add_u32 s20, s20, 128
  s_add_u32 s21, s21, s51
  s_add_u32 m0, s52, 32768
  s_nop 0
  buffer_load_dwordx4 v2, s[8:11], s20 offen  lds
  s_add_u32 m0, s53, 32768
  s_nop 0
  buffer_load_dwordx4 v6, s[12:15], s21 offen  lds
  s_add_u32 m0, s52, 33792
  s_nop 0
  buffer_load_dwordx4 v3, s[8:11], s20 offen  lds
  s_add_u32 m0, s53, 33792
  s_nop 0
  buffer_load_dwordx4 v7, s[12:15], s21 offen  lds
  s_add_u32 m0, s52, 34816
  s_nop 0
  buffer_load_dwordx4 v4, s[8:11], s20 offen  lds
  s_add_u32 m0, s53, 34816
  s_nop 0
  buffer_load_dwordx4 v8, s[12:15], s21 offen  lds
  s_add_u32 m0, s52, 35840
  s_nop 0
  buffer_load_dwordx4 v5, s[8:11], s20 offen  lds
  s_add_u32 m0, s53, 35840
  s_nop 0
  buffer_load_dwordx4 v9, s[12:15], s21 offen  lds
  s_add_u32 s20, s20, 128
  s_add_u32 s21, s21, s51
  s_add_u32 m0, s52, 65536
  s_nop 0
  buffer_load_dwordx4 v2, s[8:11], s20 offen  lds
  s_add_u32 m0, s53, 65536
  s_nop 0
  buffer_load_dwordx4 v6, s[12:15], s21 offen  lds
  s_add_u32 m0, s52, 66560
  s_nop 0
  buffer_load_dwordx4 v3, s[8:11], s20 offen  lds
  s_add_u32 m0, s53, 66560
  s_nop 0
  buffer_load_dwordx4 v7, s[12:15], s21 offen  lds
  s_add_u32 m0, s52, 67584
  s_nop 0
  buffer_load_dwordx4 v4, s[8:11], s20 offen  lds
  s_add_u32 m0, s53, 67584
  s_nop 0
  buffer_load_dwordx4 v8, s[12:15], s21 offen  lds
  s_add_u32 m0, s52, 68608
  s_nop 0
  buffer_load_dwordx4 v5, s[8:11], s20 offen  lds
  s_add_u32 m0, s53, 68608
  s_nop 0
  buffer_load_dwordx4 v9, s[12:15], s21 offen  lds
  s_add_u32 s20, s20, 128
  s_add_u32 s21, s21, s51
  s_add_u32 m0, s52, 98304
  s_nop 0
  buffer_load_dwordx4 v2, s[8:11], s20 offen  lds
  s_add_u32 m0, s53, 98304
  s_nop 0
  buffer_load_dwordx4 v6, s[12:15], s21 offen  lds
  s_add_u32 m0, s52, 99328
  s_nop 0
  buffer_load_dwordx4 v3, s[8:11], s20 offen  lds
  s_add_u32 m0, s53, 99328
  s_nop 0
  buffer_load_dwordx4 v7, s[12:15], s21 offen  lds
  s_add_u32 m0, s52, 100352
  s_nop 0
  buffer_load_dwordx4 v4, s[8:11], s20 offen  lds
  s_add_u32 m0, s53, 100352
  s_nop 0
  buffer_load_dwordx4 v8, s[12:15], s21 offen  lds
  s_add_u32 m0, s52, 101376
  s_nop 0
  buffer_load_dwordx4 v5, s[8:11], s20 offen  lds
  s_add_u32 m0, s53, 101376
  s_nop 0
  buffer_load_dwordx4 v9, s[12:15], s21 offen  lds
  s_add_u32 s20, s20, 128
  s_add_u32 s21, s21, s51
  s_lshr_b32 s90, s27, 1
  s_and_b32 s91, s27, 1
  s_mul_i32 s92, s90, 8192
  v_mov_b32 v22, 0x0
  v_bfe_u32 v23, v1, 0, 4
  v_lshl_add_u32 v22, v23, 7, v22
  v_add_u32 v22, s92, v22
  v_lshrrev_b32 v23, 1, v1
  v_and_b32 v23, 7, v23
  v_lshrrev_b32 v24, 4, v1
  v_xor_b32 v23, v23, v24
  v_lshl_add_u32 v10, v23, 4, v22
  v_xor_b32 v11, 64, v10
  v_add_u32 v12, 65536, v10
  v_add_u32 v13, 65536, v11
  v_mov_b32 v22, 0x0
  v_bfe_u32 v23, v1, 2, 2
  v_lshl_add_u32 v22, v23, 8, v22
  v_bfe_u32 v23, v1, 4, 2
  v_lshl_add_u32 v22, v23, 11, v22
  v_bfe_u32 v23, v1, 0, 2
  v_lshl_add_u32 v22, v23, 3, v22
  v_bfe_u32 v24, v1, 2, 3
  s_mul_i32 s92, s91, 4
  s_add_u32 s93, s92, 0
  v_xor_b32 v23, s93, v24
  v_lshl_add_u32 v14, v23, 5, v22
  v_add_u32 v18, 65536, v14
  s_add_u32 s93, s92, 1
  v_xor_b32 v23, s93, v24
  v_lshl_add_u32 v15, v23, 5, v22
  v_add_u32 v19, 65536, v15
  s_add_u32 s93, s92, 2
  v_xor_b32 v23, s93, v24
  v_lshl_add_u32 v16, v23, 5, v22
  v_add_u32 v20, 65536, v16
  s_add_u32 s93, s92, 3
  v_xor_b32 v23, s93, v24
  v_lshl_add_u32 v17, v23, 5, v22
  v_add_u32 v21, 65536, v17
  s_mov_b32 s58, 2
  s_branch L_epi
L_r2:
  v_lshlrev_b32 v174, 7, v1
  s_sub_u32 s42, s34, 32
  s_lshl_b32 s40, s42, 2
  s_add_u32 s40, s40, s33
  s_lshl_b32 s40, s40, 2
  s_add_u32 s40, s40, s32
  s_lshl_b32 s40, s40, 13
  s_cmp_ge_u32 s42, 16
  s_cselect_b32 s40, 0x40000000, s40
  s_add_u32 s41, s40, 2097152
  s_mov_b32 s44, s64
  s_and_b32 s45, s65, 0xffff
  s_mov_b32 s46, 0x400000
  s_mov_b32 s47, 0x20000
  buffer_load_dword v175, v174, s[44:47], s40 offen
  s_mov_b32 s44, s64
  s_and_b32 s45, s65, 0xffff
  s_mov_b32 s46, 0x400000
  s_mov_b32 s47, 0x20000
  buffer_load_dword v175, v174, s[44:47], s41 offen
  s_cmp_eq_u32 s35, 10
  s_cbranch_scc1 L_g5
  s_waitcnt vmcnt(26)
  s_barrier
  ds_read_b128 v[28:31], v10 offset:0
  ds_read_b64_tr_b16 v[60:61], v14 offset:16384
  ds_read_b64_tr_b16 v[62:63], v14 offset:17408
  ds_read_b128 v[32:35], v10 offset:2048
  ds_read_b64_tr_b16 v[64:65], v15 offset:16384
  ds_read_b64_tr_b16 v[66:67], v15 offset:17408
  ds_read_b128 v[36:39], v10 offset:4096
  ds_read_b64_tr_b16 v[68:69], v16 offset:16384
  ds_read_b64_tr_b16 v[70:71], v16 offset:17408
  ds_read_b128 v[40:43], v10 offset:6144
  ds_read_b64_tr_b16 v[72:73], v17 offset:16384
  ds_read_b64_tr_b16 v[74:75], v17 offset:17408
  s_sub_u32 s25, s25, 1
  s_waitcnt lgkmcnt(0)
  v_mfma_f32_16x16x32_bf16 a[0:3], v[60:63], v[28:31], 0
  ds_read_b128 v[44:47], v11 offset:0
  v_mfma_f32_16x16x32_bf16 a[4:7], v[64:67], v[28:31], 0
  ds_read_b64_tr_b16 v[76:77], v14 offset:24576
  v_mfma_f32_16x16x32_bf16 a[8:11], v[68:71], v[28:31], 0
  ds_read_b64_tr_b16 v[78:79], v14 offset:25600
  v_mfma_f32_16x16x32_bf16 a[12:15], v[72:75], v[28:31], 0
  ds_read_b128 v[48:51], v11 offset:2048
  v_mfma_f32_16x16x32_bf16 a[16:19], v[60:63], v[32:35], 0
  ds_read_b64_tr_b16 v[80:81], v15 offset:24576
  v_mfma_f32_16x16x32_bf16 a[20:23], v[64:67], v[32:35], 0
  ds_read_b64_tr_b16 v[82:83], v15 offset:25600
  v_mfma_f32_16x16x32_bf16 a[24:27], v[68:71], v[32:35], 0
  ds_read_b128 v[52:55], v11 offset:4096
  v_mfma_f32_16x16x32_bf16 a[28:31], v[72:75], v[32:35], 0
  ds_read_b64_tr_b16 v[84:85], v16 offset:24576
  v_mfma_f32_16x16x32_bf16 a[32:35], v[60:63], v[36:39], 0
  ds_read_b64_tr_b16 v[86:87], v16 offset:25600
  v_mfma_f32_16x16x32_bf16 a[36:39], v[64:67], v[36:39], 0
  ds_read_b128 v[56:59], v11 offset:6144
  v_mfma_f32_16x16x32_bf16 a[40:43], v[68:71], v[36:39], 0
  ds_read_b64_tr_b16 v[88:89], v17 offset:24576
  v_mfma_f32_16x16x32_bf16 a[44:47], v[72:75], v[36:39], 0
  ds_read_b64_tr_b16 v[90:91], v17 offset:25600
  v_mfma_f32_16x16x32_bf16 a[48:51], v[60:63], v[40:43], 0
  v_mfma_f32_16x16x32_bf16 a[52:55], v[64:67], v[40:43], 0
  v_mfma_f32_16x16x32_bf16 a[56:59], v[68:71], v[40:43], 0
  v_mfma_f32_16x16x32_bf16 a[60:63], v[72:75], v[40:43], 0
  s_waitcnt lgkmcnt(0)
  v_mfma_f32_16x16x32_bf16 a[0:3], v[76:79], v[44:47], a[0:3]
  s_waitcnt vmcnt(18)
  s_barrier
  s_add_u32 m0, s52, 0
  v_mfma_f32_16x16x32_bf16 a[4:7], v[80:83], v[44:47], a[4:7]
  buffer_load_dwordx4 v2, s[8:11], s20 offen  lds
  ds_read_b128 v[28:31], v10 offset:32768
  v_mfma_f32_16x16x32_bf16 a[8:11], v[84:87], v[44:47], a[8:11]
  ds_read_b64_tr_b16 v[60:61], v14 offset:49152
  v_mfma_f32_16x16x32_bf16 a[12:15], v[88:91], v[44:47], a[12:15]
  ds_read_b64_tr_b16 v[62:63], v14 offset:50176
  s_add_u32 m0, s53, 0
  v_mfma_f32_16x16x32_bf16 a[16:19], v[76:79], v[48:51], a[16:19]
  buffer_load_dwordx4 v6, s[12:15], s21 offen  lds
  ds_read_b128 v[32:35], v10 offset:34816
  v_mfma_f32_16x16x32_bf16 a[20:23], v[80:83], v[48:51], a[20:23]
  ds_read_b64_tr_b16 v[64:65], v15 offset:49152
  v_mfma_f32_16x16x32_bf16 a[24:27], v[84:87], v[48:51], a[24:27]
  ds_read_b64_tr_b16 v[66:67], v15 offset:50176
  s_add_u32 m0, s52, 1024
  v_mfma_f32_16x16x32_bf16 a[28:31], v[88:91], v[48:51], a[28:31]
  buffer_load_dwordx4 v3, s[8:11], s20 offen  lds
  ds_read_b128 v[36:39], v10 offset:36864
  v_mfma_f32_16x16x32_bf16 a[32:35], v[76:79], v[52:55], a[32:35]
  ds_read_b64_tr_b16 v[68:69], v16 offset:49152
  v_mfma_f32_16x16x32_bf16 a[36:39], v[80:83], v[52:55], a[36:39]
  ds_read_b64_tr_b16 v[70:71], v16 offset:50176
  s_add_u32 m0, s53, 1024
  v_mfma_f32_16x16x32_bf16 a[40:43], v[84:87], v[52:55], a[40:43]
  buffer_load_dwordx4 v7, s[12:15], s21 offen  lds
  ds_read_b128 v[40:43], v10 offset:38912
  v_mfma_f32_16x16x32_bf16 a[44:47], v[88:91], v[52:55], a[44:47]
  ds_read_b64_tr_b16 v[72:73], v17 offset:49152
  v_mfma_f32_16x16x32_bf16 a[48:51], v[76:79], v[56:59], a[48:51]
  ds_read_b64_tr_b16 v[74:75], v17 offset:50176
  s_add_u32 m0, s52, 2048
  v_mfma_f32_16x16x32_bf16 a[52:55], v[80:83], v[56:59], a[52:55]
  buffer_load_dwordx4 v4, s[8:11], s20 offen  lds
  v_mfma_f32_16x16x32_bf16 a[56:59], v[84:87], v[56:59], a[56:59]
  v_mfma_f32_16x16x32_bf16 a[60:63], v[88:91], v[56:59], a[60:63]
  s_waitcnt lgkmcnt(0)
  s_add_u32 m0, s53, 2048
  v_mfma_f32_16x16x32_bf16 a[0:3], v[60:63], v[28:31], a[0:3]
  buffer_load_dwordx4 v8, s[12:15], s21 offen  lds
  ds_read_b128 v[44:47], v11 offset:32768
  v_mfma_f32_16x16x32_bf16 a[4:7], v[64:67], v[28:31], a[4:7]
  ds_read_b64_tr_b16 v[76:77], v14 offset:57344
  v_mfma_f32_16x16x32_bf16 a[8:11], v[68:71], v[28:31], a[8:11]
  ds_read_b64_tr_b16 v[78:79], v14 offset:58368
  v_mfma_f32_16x16x32_bf16 a[12:15], v[72:75], v[28:31], a[12:15]
  ds_read_b128 v[48:51], v11 offset:34816
  s_add_u32 m0, s52, 3072
  v_mfma_f32_16x16x32_bf16 a[16:19], v[60:63], v[32:35], a[16:19]
  buffer_load_dwordx4 v5, s[8:11], s20 offen  lds
  ds_read_b64_tr_b16 v[80:81], v15 offset:57344
  v_mfma_f32_16x16x32_bf16 a[20:23], v[64:67], v[32:35], a[20:23]
  ds_read_b64_tr_b16 v[82:83], v15 offset:58368
  v_mfma_f32_16x16x32_bf16 a[24:27], v[68:71], v[32:35], a[24:27]
  ds_read_b128 v[52:55], v11 offset:36864
  v_mfma_f32_16x16x32_bf16 a[28:31], v[72:75], v[32:35], a[28:31]
  ds_read_b64_tr_b16 v[84:85], v16 offset:57344
  s_add_u32 m0, s53, 3072
  v_mfma_f32_16x16x32_bf16 a[32:35], v[60:63], v[36:39], a[32:35]
  buffer_load_dwordx4 v9, s[12:15], s21 offen  lds
  ds_read_b64_tr_b16 v[86:87], v16 offset:58368
  v_mfma_f32_16x16x32_bf16 a[36:39], v[64:67], v[36:39], a[36:39]
  ds_read_b128 v[56:59], v11 offset:38912
  v_mfma_f32_16x16x32_bf16 a[40:43], v[68:71], v[36:39], a[40:43]
  ds_read_b64_tr_b16 v[88:89], v17 offset:57344
  v_mfma_f32_16x16x32_bf16 a[44:47], v[72:75], v[36:39], a[44:47]
  ds_read_b64_tr_b16 v[90:91], v17 offset:58368
  s_add_u32 s20, s20, 128
  v_mfma_f32_16x16x32_bf16 a[48:51], v[60:63], v[40:43], a[48:51]
  s_add_u32 s21, s21, s51
  v_mfma_f32_16x16x32_bf16 a[52:55], v[64:67], v[40:43], a[52:55]
  v_mfma_f32_16x16x32_bf16 a[56:59], v[68:71], v[40:43], a[56:59]
  v_mfma_f32_16x16x32_bf16 a[60:63], v[72:75], v[40:43], a[60:63]
  s_waitcnt lgkmcnt(0)
  v_mfma_f32_16x16x32_bf16 a[0:3], v[76:79], v[44:47], a[0:3]
  s_waitcnt vmcnt(18)
  s_barrier
  s_add_u32 m0, s52, 32768
  v_mfma_f32_16x16x32_bf16 a[4:7], v[80:83], v[44:47], a[4:7]
  buffer_load_dwordx4 v2, s[8:11], s20 offen  lds
  ds_read_b128 v[28:31], v12 offset:0
  v_mfma_f32_16x16x32_bf16 a[8:11], v[84:87], v[44:47], a[8:11]
  ds_read_b64_tr_b16 v[60:61], v18 offset:16384
  v_mfma_f32_16x16x32_bf16 a[12:15], v[88:91], v[44:47], a[12:15]
  ds_read_b64_tr_b16 v[62:63], v18 offset:17408
  s_add_u32 m0, s53, 32768
  v_mfma_f32_16x16x32_bf16 a[16:19], v[76:79], v[48:51], a[16:19]
  buffer_load_dwordx4 v6, s[12:15], s21 offen  lds
  ds_read_b128 v[32:35], v12 offset:2048
  v_mfma_f32_16x16x32_bf16 a[20:23], v[80:83], v[48:51], a[20:23]
  ds_read_b64_tr_b16 v[64:65], v19 offset:16384
  v_mfma_f32_16x16x32_bf16 a[24:27], v[84:87], v[48:51], a[24:27]
  ds_read_b64_tr_b16 v[66:67], v19 offset:17408
  s_add_u32 m0, s52, 33792
  v_mfma_f32_16x16x32_bf16 a[28:31], v[88:91], v[48:51], a[28:31]
  buffer_load_dwordx4 v3, s[8:11], s20 offen  lds
  ds_read_b128 v[36:39], v12 offset:4096
  v_mfma_f32_16x16x32_bf16 a[32:35], v[76:79], v[52:55], a[32:35]
  ds_read_b64_tr_b16 v[68:69], v20 offset:16384
  v_mfma_f32_16x16x32_bf16 a[36:39], v[80:83], v[52:55], a[36:39]
  ds_read_b64_tr_b16 v[70:71], v20 offset:17408
  s_add_u32 m0, s53, 33792
  v_mfma_f32_16x16x32_bf16 a[40:43], v[84:87], v[52:55], a[40:43]
  buffer_load_dwordx4 v7, s[12:15], s21 offen  lds
  ds_read_b128 v[40:43], v12 offset:6144
  v_mfma_f32_16x16x32_bf16 a[44:47], v[88:91], v[52:55], a[44:47]
  ds_read_b64_tr_b16 v[72:73], v21 offset:16384
  v_mfma_f32_16x16x32_bf16 a[48:51], v[76:79], v[56:59], a[48:51]
  ds_read_b64_tr_b16 v[74:75], v21 offset:17408
  s_add_u32 m0, s52, 34816
  v_mfma_f32_16x16x32_bf16 a[52:55], v[80:83], v[56:59], a[52:55]
  buffer_load_dwordx4 v4, s[8:11], s20 offen  lds
  v_mfma_f32_16x16x32_bf16 a[56:59], v[84:87], v[56:59], a[56:59]
  v_mfma_f32_16x16x32_bf16 a[60:63], v[88:91], v[56:59], a[60:63]
  s_waitcnt lgkmcnt(0)
  s_add_u32 m0, s53, 34816
  v_mfma_f32_16x16x32_bf16 a[0:3], v[60:63], v[28:31], a[0:3]
  buffer_load_dwordx4 v8, s[12:15], s21 offen  lds
  ds_read_b128 v[44:47], v13 offset:0
  v_mfma_f32_16x16x32_bf16 a[4:7], v[64:67], v[28:31], a[4:7]
  ds_read_b64_tr_b16 v[76:77], v18 offset:24576
  v_mfma_f32_16x16x32_bf16 a[8:11], v[68:71], v[28:31], a[8:11]
  ds_read_b64_tr_b16 v[78:79], v18 offset:25600
  v_mfma_f32_16x16x32_bf16 a[12:15], v[72:75], v[28:31], a[12:15]
  ds_read_b128 v[48:51], v13 offset:2048
  s_add_u32 m0, s52, 35840
  v_mfma_f32_16x16x32_bf16 a[16:19], v[60:63], v[32:35], a[16:19]
  buffer_load_dwordx4 v5, s[8:11], s20 offen  lds
  ds_read_b64_tr_b16 v[80:81], v19 offset:24576
  v_mfma_f32_16x16x32_bf16 a[20:23], v[64:67], v[32:35], a[20:23]
  ds_read_b64_tr_b16 v[82:83], v19 offset:25600
  v_mfma_f32_16x16x32_bf16 a[24:27], v[68:71], v[32:35], a[24:27]
  ds_read_b128 v[52:55], v13 offset:4096
  v_mfma_f32_16x16x32_bf16 a[28:31], v[72:75], v[32:35], a[28:31]
  ds_read_b64_tr_b16 v[84:85], v20 offset:24576
  s_add_u32 m0, s53, 35840
  v_mfma_f32_16x16x32_bf16 a[32:35], v[60:63], v[36:39], a[32:35]
  buffer_load_dwordx4 v9, s[12:15], s21 offen  lds
  ds_read_b64_tr_b16 v[86:87], v20 offset:25600
  v_mfma_f32_16x16x32_bf16 a[36:39], v[64:67], v[36:39], a[36:39]
  ds_read_b128 v[56:59], v13 offset:6144
  v_mfma_f32_16x16x32_bf16 a[40:43], v[68:71], v[36:39], a[40:43]
  ds_read_b64_tr_b16 v[88:89], v21 offset:24576
  v_mfma_f32_16x16x32_bf16 a[44:47], v[72:75], v[36:39], a[44:47]
  ds_read_b64_tr_b16 v[90:91], v21 offset:25600
  s_add_u32 s20, s20, 128
  v_mfma_f32_16x16x32_bf16 a[48:51], v[60:63], v[40:43], a[48:51]
  s_add_u32 s21, s21, s51
  v_mfma_f32_16x16x32_bf16 a[52:55], v[64:67], v[40:43], a[52:55]
  v_mfma_f32_16x16x32_bf16 a[56:59], v[68:71], v[40:43], a[56:59]
  v_mfma_f32_16x16x32_bf16 a[60:63], v[72:75], v[40:43], a[60:63]
  s_waitcnt lgkmcnt(0)
  v_mfma_f32_16x16x32_bf16 a[0:3], v[76:79], v[44:47], a[0:3]
  s_waitcnt vmcnt(18)
  s_barrier
  s_add_u32 m0, s52, 65536
  v_mfma_f32_16x16x32_bf16 a[4:7], v[80:83], v[44:47], a[4:7]
  buffer_load_dwordx4 v2, s[8:11], s20 offen  lds
  ds_read_b128 v[28:31], v12 offset:32768
  v_mfma_f32_16x16x32_bf16 a[8:11], v[84:87], v[44:47], a[8:11]
  ds_read_b64_tr_b16 v[60:61], v18 offset:49152
  v_mfma_f32_16x16x32_bf16 a[12:15], v[88:91], v[44:47], a[12:15]
  ds_read_b64_tr_b16 v[62:63], v18 offset:50176
  s_add_u32 m0, s53, 65536
  v_mfma_f32_16x16x32_bf16 a[16:19], v[76:79], v[48:51], a[16:19]
  buffer_load_dwordx4 v6, s[12:15], s21 offen  lds
  ds_read_b128 v[32:35], v12 offset:34816
  v_mfma_f32_16x16x32_bf16 a[20:23], v[80:83], v[48:51], a[20:23]
  ds_read_b64_tr_b16 v[64:65], v19 offset:49152
  v_mfma_f32_16x16x32_bf16 a[24:27], v[84:87], v[48:51], a[24:27]
  ds_read_b64_tr_b16 v[66:67], v19 offset:50176
  s_add_u32 m0, s52, 66560
  v_mfma_f32_16x16x32_bf16 a[28:31], v[88:91], v[48:51], a[28:31]
  buffer_load_dwordx4 v3, s[8:11], s20 offen  lds
  ds_read_b128 v[36:39], v12 offset:36864
  v_mfma_f32_16x16x32_bf16 a[32:35], v[76:79], v[52:55], a[32:35]
  ds_read_b64_tr_b16 v[68:69], v20 offset:49152
  v_mfma_f32_16x16x32_bf16 a[36:39], v[80:83], v[52:55], a[36:39]
  ds_read_b64_tr_b16 v[70:71], v20 offset:50176
  s_add_u32 m0, s53, 66560
  v_mfma_f32_16x16x32_bf16 a[40:43], v[84:87], v[52:55], a[40:43]
  buffer_load_dwordx4 v7, s[12:15], s21 offen  lds
  ds_read_b128 v[40:43], v12 offset:38912
  v_mfma_f32_16x16x32_bf16 a[44:47], v[88:91], v[52:55], a[44:47]
  ds_read_b64_tr_b16 v[72:73], v21 offset:49152
  v_mfma_f32_16x16x32_bf16 a[48:51], v[76:79], v[56:59], a[48:51]
  ds_read_b64_tr_b16 v[74:75], v21 offset:50176
  s_add_u32 m0, s52, 67584
  v_mfma_f32_16x16x32_bf16 a[52:55], v[80:83], v[56:59], a[52:55]
  buffer_load_dwordx4 v4, s[8:11], s20 offen  lds
  v_mfma_f32_16x16x32_bf16 a[56:59], v[84:87], v[56:59], a[56:59]
  v_mfma_f32_16x16x32_bf16 a[60:63], v[88:91], v[56:59], a[60:63]
  s_waitcnt lgkmcnt(0)
  s_add_u32 m0, s53, 67584
  v_mfma_f32_16x16x32_bf16 a[0:3], v[60:63], v[28:31], a[0:3]
  buffer_load_dwordx4 v8, s[12:15], s21 offen  lds
  ds_read_b128 v[44:47], v13 offset:32768
  v_mfma_f32_16x16x32_bf16 a[4:7], v[64:67], v[28:31], a[4:7]
  ds_read_b64_tr_b16 v[76:77], v18 offset:57344
  v_mfma_f32_16x16x32_bf16 a[8:11], v[68:71], v[28:31], a[8:11]
  ds_read_b64_tr_b16 v[78:79], v18 offset:58368
  v_mfma_f32_16x16x32_bf16 a[12:15], v[72:75], v[28:31], a[12:15]
  ds_read_b128 v[48:51], v13 offset:34816
  s_add_u32 m0, s52, 68608
  v_mfma_f32_16x16x32_bf16 a[16:19], v[60:63], v[32:35], a[16:19]
  buffer_load_dwordx4 v5, s[8:11], s20 offen  lds
  ds_read_b64_tr_b16 v[80:81], v19 offset:57344
  v_mfma_f32_16x16x32_bf16 a[20:23], v[64:67], v[32:35], a[20:23]
  ds_read_b64_tr_b16 v[82:83], v19 offset:58368
  v_mfma_f32_16x16x32_bf16 a[24:27], v[68:71], v[32:35], a[24:27]
  ds_read_b128 v[52:55], v13 offset:36864
  v_mfma_f32_16x16x32_bf16 a[28:31], v[72:75], v[32:35], a[28:31]
  ds_read_b64_tr_b16 v[84:85], v20 offset:57344
  s_add_u32 m0, s53, 68608
  v_mfma_f32_16x16x32_bf16 a[32:35], v[60:63], v[36:39], a[32:35]
  buffer_load_dwordx4 v9, s[12:15], s21 offen  lds
  ds_read_b64_tr_b16 v[86:87], v20 offset:58368
  v_mfma_f32_16x16x32_bf16 a[36:39], v[64:67], v[36:39], a[36:39]
  ds_read_b128 v[56:59], v13 offset:38912
  v_mfma_f32_16x16x32_bf16 a[40:43], v[68:71], v[36:39], a[40:43]
  ds_read_b64_tr_b16 v[88:89], v21 offset:57344
  v_mfma_f32_16x16x32_bf16 a[44:47], v[72:75], v[36:39], a[44:47]
  ds_read_b64_tr_b16 v[90:91], v21 offset:58368
  s_add_u32 s20, s20, 128
  v_mfma_f32_16x16x32_bf16 a[48:51], v[60:63], v[40:43], a[48:51]
  s_add_u32 s21, s21, s51
  v_mfma_f32_16x16x32_bf16 a[52:55], v[64:67], v[40:43], a[52:55]
  v_mfma_f32_16x16x32_bf16 a[56:59], v[68:71], v[40:43], a[56:59]
  v_mfma_f32_16x16x32_bf16 a[60:63], v[72:75], v[40:43], a[60:63]
  s_waitcnt lgkmcnt(0)
  v_mfma_f32_16x16x32_bf16 a[0:3], v[76:79], v[44:47], a[0:3]
  s_waitcnt vmcnt(16)
  s_barrier
  s_add_u32 m0, s52, 98304
  v_mfma_f32_16x16x32_bf16 a[4:7], v[80:83], v[44:47], a[4:7]
  buffer_load_dwordx4 v2, s[8:11], s20 offen  lds
  ds_read_b128 v[28:31], v10 offset:0
  v_mfma_f32_16x16x32_bf16 a[8:11], v[84:87], v[44:47], a[8:11]
  ds_read_b64_tr_b16 v[60:61], v14 offset:16384
  v_mfma_f32_16x16x32_bf16 a[12:15], v[88:91], v[44:47], a[12:15]
  ds_read_b64_tr_b16 v[62:63], v14 offset:17408
  s_add_u32 m0, s53, 98304
  v_mfma_f32_16x16x32_bf16 a[16:19], v[76:79], v[48:51], a[16:19]
  buffer_load_dwordx4 v6, s[12:15], s21 offen  lds
  ds_read_b128 v[32:35], v10 offset:2048
  v_mfma_f32_16x16x32_bf16 a[20:23], v[80:83], v[48:51], a[20:23]
  ds_read_b64_tr_b16 v[64:65], v15 offset:16384
  v_mfma_f32_16x16x32_bf16 a[24:27], v[84:87], v[48:51], a[24:27]
  ds_read_b64_tr_b16 v[66:67], v15 offset:17408
  s_add_u32 m0, s52, 99328
  v_mfma_f32_16x16x32_bf16 a[28:31], v[88:91], v[48:51], a[28:31]
  buffer_load_dwordx4 v3, s[8:11], s20 offen  lds
  ds_read_b128 v[36:39], v10 offset:4096
  v_mfma_f32_16x16x32_bf16 a[32:35], v[76:79], v[52:55], a[32:35]
  ds_read_b64_tr_b16 v[68:69], v16 offset:16384
  v_mfma_f32_16x16x32_bf16 a[36:39], v[80:83], v[52:55], a[36:39]
  ds_read_b64_tr_b16 v[70:71], v16 offset:17408
  s_add_u32 m0, s53, 99328
  v_mfma_f32_16x16x32_bf16 a[40:43], v[84:87], v[52:55], a[40:43]
  buffer_load_dwordx4 v7, s[12:15], s21 offen  lds
  ds_read_b128 v[40:43], v10 offset:6144
  v_mfma_f32_16x16x32_bf16 a[44:47], v[88:91], v[52:55], a[44:47]
  ds_read_b64_tr_b16 v[72:73], v17 offset:16384
  v_mfma_f32_16x16x32_bf16 a[48:51], v[76:79], v[56:59], a[48:51]
  ds_read_b64_tr_b16 v[74:75], v17 offset:17408
  s_add_u32 m0, s52, 100352
  v_mfma_f32_16x16x32_bf16 a[52:55], v[80:83], v[56:59], a[52:55]
  buffer_load_dwordx4 v4, s[8:11], s20 offen  lds
  v_mfma_f32_16x16x32_bf16 a[56:59], v[84:87], v[56:59], a[56:59]
  v_mfma_f32_16x16x32_bf16 a[60:63], v[88:91], v[56:59], a[60:63]
L_g4_loop:
  s_sub_u32 s25, s25, 1
  s_cmp_eq_u32 s25, 0
  s_cbranch_scc1 L_g4_fin
  s_waitcnt lgkmcnt(0)
  s_add_u32 m0, s53, 100352
  v_mfma_f32_16x16x32_bf16 a[0:3], v[60:63], v[28:31], a[0:3]
  buffer_load_dwordx4 v8, s[12:15], s21 offen  lds
  ds_read_b128 v[44:47], v11 offset:0
  v_mfma_f32_16x16x32_bf16 a[4:7], v[64:67], v[28:31], a[4:7]
  ds_read_b64_tr_b16 v[76:77], v14 offset:24576
  v_mfma_f32_16x16x32_bf16 a[8:11], v[68:71], v[28:31], a[8:11]
  ds_read_b64_tr_b16 v[78:79], v14 offset:25600
  v_mfma_f32_16x16x32_bf16 a[12:15], v[72:75], v[28:31], a[12:15]
  ds_read_b128 v[48:51], v11 offset:2048
  s_add_u32 m0, s52, 101376
  v_mfma_f32_16x16x32_bf16 a[16:19], v[60:63], v[32:35], a[16:19]
  buffer_load_dwordx4 v5, s[8:11], s20 offen  lds
  ds_read_b64_tr_b16 v[80:81], v15 offset:24576
  v_mfma_f32_16x16x32_bf16 a[20:23], v[64:67], v[32:35], a[20:23]
  ds_read_b64_tr_b16 v[82:83], v15 offset:25600
  v_mfma_f32_16x16x32_bf16 a[24:27], v[68:71], v[32:35], a[24:27]
  ds_read_b128 v[52:55], v11 offset:4096
  v_mfma_f32_16x16x32_bf16 a[28:31], v[72:75], v[32:35], a[28:31]
  ds_read_b64_tr_b16 v[84:85], v16 offset:24576
  s_add_u32 m0, s53, 101376
  v_mfma_f32_16x16x32_bf16 a[32:35], v[60:63], v[36:39], a[32:35]
  buffer_load_dwordx4 v9, s[12:15], s21 offen  lds
  ds_read_b64_tr_b16 v[86:87], v16 offset:25600
  v_mfma_f32_16x16x32_bf16 a[36:39], v[64:67], v[36:39], a[36:39]
  ds_read_b128 v[56:59], v11 offset:6144
  v_mfma_f32_16x16x32_bf16 a[40:43], v[68:71], v[36:39], a[40:43]
  ds_read_b64_tr_b16 v[88:89], v17 offset:24576
  v_mfma_f32_16x16x32_bf16 a[44:47], v[72:75], v[36:39], a[44:47]
  ds_read_b64_tr_b16 v[90:91], v17 offset:25600
  s_add_u32 s20, s20, 128
  v_mfma_f32_16x16x32_bf16 a[48:51], v[60:63], v[40:43], a[48:51]
  s_add_u32 s21, s21, s51
  v_mfma_f32_16x16x32_bf16 a[52:55], v[64:67], v[40:43], a[52:55]
  v_mfma_f32_16x16x32_bf16 a[56:59], v[68:71], v[40:43], a[56:59]
  v_mfma_f32_16x16x32_bf16 a[60:63], v[72:75], v[40:43], a[60:63]
  s_waitcnt lgkmcnt(0)
  v_mfma_f32_16x16x32_bf16 a[0:3], v[76:79], v[44:47], a[0:3]
  s_waitcnt vmcnt(16)
  s_barrier
  s_add_u32 m0, s52, 0
  v_mfma_f32_16x16x32_bf16 a[4:7], v[80:83], v[44:47], a[4:7]
  buffer_load_dwordx4 v2, s[8:11], s20 offen  lds
  ds_read_b128 v[28:31], v10 offset:32768
  v_mfma_f32_16x16x32_bf16 a[8:11], v[84:87], v[44:47], a[8:11]
  ds_read_b64_tr_b16 v[60:61], v14 offset:49152
  v_mfma_f32_16x16x32_bf16 a[12:15], v[88:91], v[44:47], a[12:15]
  ds_read_b64_tr_b16 v[62:63], v14 offset:50176
  s_add_u32 m0, s53, 0
  v_mfma_f32_16x16x32_bf16 a[16:19], v[76:79], v[48:51], a[16:19]
  buffer_load_dwordx4 v6, s[12:15], s21 offen  lds
  ds_read_b128 v[32:35], v10 offset:34816
  v_mfma_f32_16x16x32_bf16 a[20:23], v[80:83], v[48:51], a[20:23]
  ds_read_b64_tr_b16 v[64:65], v15 offset:49152
  v_mfma_f32_16x16x32_bf16 a[24:27], v[84:87], v[48:51], a[24:27]
  ds_read_b64_tr_b16 v[66:67], v15 offset:50176
  s_add_u32 m0, s52, 1024
  v_mfma_f32_16x16x32_bf16 a[28:31], v[88:91], v[48:51], a[28:31]
  buffer_load_dwordx4 v3, s[8:11], s20 offen  lds
  ds_read_b128 v[36:39], v10 offset:36864
  v_mfma_f32_16x16x32_bf16 a[32:35], v[76:79], v[52:55], a[32:35]
  ds_read_b64_tr_b16 v[68:69], v16 offset:49152
  v_mfma_f32_16x16x32_bf16 a[36:39], v[80:83], v[52:55], a[36:39]
  ds_read_b64_tr_b16 v[70:71], v16 offset:50176
  s_add_u32 m0, s53, 1024
  v_mfma_f32_16x16x32_bf16 a[40:43], v[84:87], v[52:55], a[40:43]
  buffer_load_dwordx4 v7, s[12:15], s21 offen  lds
  ds_read_b128 v[40:43], v10 offset:38912
  v_mfma_f32_16x16x32_bf16 a[44:47], v[88:91], v[52:55], a[44:47]
  ds_read_b64_tr_b16 v[72:73], v17 offset:49152
  v_mfma_f32_16x16x32_bf16 a[48:51], v[76:79], v[56:59], a[48:51]
  ds_read_b64_tr_b16 v[74:75], v17 offset:50176
  s_add_u32 m0, s52, 2048
  v_mfma_f32_16x16x32_bf16 a[52:55], v[80:83], v[56:59], a[52:55]
  buffer_load_dwordx4 v4, s[8:11], s20 offen  lds
  v_mfma_f32_16x16x32_bf16 a[56:59], v[84:87], v[56:59], a[56:59]
  v_mfma_f32_16x16x32_bf16 a[60:63], v[88:91], v[56:59], a[60:63]
  s_waitcnt lgkmcnt(0)
  s_add_u32 m0, s53, 2048
  v_mfma_f32_16x16x32_bf16 a[0:3], v[60:63], v[28:31], a[0:3]
  buffer_load_dwordx4 v8, s[12:15], s21 offen  lds
  ds_read_b128 v[44:47], v11 offset:32768
  v_mfma_f32_16x16x32_bf16 a[4:7], v[64:67], v[28:31], a[4:7]
  ds_read_b64_tr_b16 v[76:77], v14 offset:57344
  v_mfma_f32_16x16x32_bf16 a[8:11], v[68:71], v[28:31], a[8:11]
  ds_read_b64_tr_b16 v[78:79], v14 offset:58368
  v_mfma_f32_16x16x32_bf16 a[12:15], v[72:75], v[28:31], a[12:15]
  ds_read_b128 v[48:51], v11 offset:34816
  s_add_u32 m0, s52, 3072
  v_mfma_f32_16x16x32_bf16 a[16:19], v[60:63], v[32:35], a[16:19]
  buffer_load_dwordx4 v5, s[8:11], s20 offen  lds
  ds_read_b64_tr_b16 v[80:81], v15 offset:57344
  v_mfma_f32_16x16x32_bf16 a[20:23], v[64:67], v[32:35], a[20:23]
  ds_read_b64_tr_b16 v[82:83], v15 offset:58368
  v_mfma_f32_16x16x32_bf16 a[24:27], v[68:71], v[32:35], a[24:27]
  ds_read_b128 v[52:55], v11 offset:36864
  v_mfma_f32_16x16x32_bf16 a[28:31], v[72:75], v[32:35], a[28:31]
  ds_read_b64_tr_b16 v[84:85], v16 offset:57344
  s_add_u32 m0, s53, 3072
  v_mfma_f32_16x16x32_bf16 a[32:35], v[60:63], v[36:39], a[32:35]
  buffer_load_dwordx4 v9, s[12:15], s21 offen  lds
  ds_read_b64_tr_b16 v[86:87], v16 offset:58368
  v_mfma_f32_16x16x32_bf16 a[36:39], v[64:67], v[36:39], a[36:39]
  ds_read_b128 v[56:59], v11 offset:38912
  v_mfma_f32_16x16x32_bf16 a[40:43], v[68:71], v[36:39], a[40:43]
  ds_read_b64_tr_b16 v[88:89], v17 offset:57344
  v_mfma_f32_16x16x32_bf16 a[44:47], v[72:75], v[36:39], a[44:47]
  ds_read_b64_tr_b16 v[90:91], v17 offset:58368
  s_add_u32 s20, s20, 128
  v_mfma_f32_16x16x32_bf16 a[48:51], v[60:63], v[40:43], a[48:51]
  s_add_u32 s21, s21, s51
  v_mfma_f32_16x16x32_bf16 a[52:55], v[64:67], v[40:43], a[52:55]
  v_mfma_f32_16x16x32_bf16 a[56:59], v[68:71], v[40:43], a[56:59]
  v_mfma_f32_16x16x32_bf16 a[60:63], v[72:75], v[40:43], a[60:63]
  s_waitcnt lgkmcnt(0)
  v_mfma_f32_16x16x32_bf16 a[0:3], v[76:79], v[44:47], a[0:3]
  s_waitcnt vmcnt(16)
  s_barrier
  s_add_u32 m0, s52, 32768
  v_mfma_f32_16x16x32_bf16 a[4:7], v[80:83], v[44:47], a[4:7]
  buffer_load_dwordx4 v2, s[8:11], s20 offen  lds
  ds_read_b128 v[28:31], v12 offset:0
  v_mfma_f32_16x16x32_bf16 a[8:11], v[84:87], v[44:47], a[8:11]
  ds_read_b64_tr_b16 v[60:61], v18 offset:16384
  v_mfma_f32_16x16x32_bf16 a[12:15], v[88:91], v[44:47], a[12:15]
  ds_read_b64_tr_b16 v[62:63], v18 offset:17408
  s_add_u32 m0, s53, 32768
  v_mfma_f32_16x16x32_bf16 a[16:19], v[76:79], v[48:51], a[16:19]
  buffer_load_dwordx4 v6, s[12:15], s21 offen  lds
  ds_read_b128 v[32:35], v12 offset:2048
  v_mfma_f32_16x16x32_bf16 a[20:23], v[80:83], v[48:51], a[20:23]
  ds_read_b64_tr_b16 v[64:65], v19 offset:16384
  v_mfma_f32_16x16x32_bf16 a[24:27], v[84:87], v[48:51], a[24:27]
  ds_read_b64_tr_b16 v[66:67], v19 offset:17408
  s_add_u32 m0, s52, 33792
  v_mfma_f32_16x16x32_bf16 a[28:31], v[88:91], v[48:51], a[28:31]
  buffer_load_dwordx4 v3, s[8:11], s20 offen  lds
  ds_read_b128 v[36:39], v12 offset:4096
  v_mfma_f32_16x16x32_bf16 a[32:35], v[76:79], v[52:55], a[32:35]
  ds_read_b64_tr_b16 v[68:69], v20 offset:16384
  v_mfma_f32_16x16x32_bf16 a[36:39], v[80:83], v[52:55], a[36:39]
  ds_read_b64_tr_b16 v[70:71], v20 offset:17408
  s_add_u32 m0, s53, 33792
  v_mfma_f32_16x16x32_bf16 a[40:43], v[84:87], v[52:55], a[40:43]
  buffer_load_dwordx4 v7, s[12:15], s21 offen  lds
  ds_read_b128 v[40:43], v12 offset:6144
  v_mfma_f32_16x16x32_bf16 a[44:47], v[88:91], v[52:55], a[44:47]
  ds_read_b64_tr_b16 v[72:73], v21 offset:16384
  v_mfma_f32_16x16x32_bf16 a[48:51], v[76:79], v[56:59], a[48:51]
  ds_read_b64_tr_b16 v[74:75], v21 offset:17408
  s_add_u32 m0, s52, 34816
  v_mfma_f32_16x16x32_bf16 a[52:55], v[80:83], v[56:59], a[52:55]
  buffer_load_dwordx4 v4, s[8:11], s20 offen  lds
  v_mfma_f32_16x16x32_bf16 a[56:59], v[84:87], v[56:59], a[56:59]
  v_mfma_f32_16x16x32_bf16 a[60:63], v[88:91], v[56:59], a[60:63]
  s_waitcnt lgkmcnt(0)
  s_add_u32 m0, s53, 34816
  v_mfma_f32_16x16x32_bf16 a[0:3], v[60:63], v[28:31], a[0:3]
  buffer_load_dwordx4 v8, s[12:15], s21 offen  lds
  ds_read_b128 v[44:47], v13 offset:0
  v_mfma_f32_16x16x32_bf16 a[4:7], v[64:67], v[28:31], a[4:7]
  ds_read_b64_tr_b16 v[76:77], v18 offset:24576
  v_mfma_f32_16x16x32_bf16 a[8:11], v[68:71], v[28:31], a[8:11]
  ds_read_b64_tr_b16 v[78:79], v18 offset:25600
  v_mfma_f32_16x16x32_bf16 a[12:15], v[72:75], v[28:31], a[12:15]
  ds_read_b128 v[48:51], v13 offset:2048
  s_add_u32 m0, s52, 35840
  v_mfma_f32_16x16x32_bf16 a[16:19], v[60:63], v[32:35], a[16:19]
  buffer_load_dwordx4 v5, s[8:11], s20 offen  lds
  ds_read_b64_tr_b16 v[80:81], v19 offset:24576
  v_mfma_f32_16x16x32_bf16 a[20:23], v[64:67], v[32:35], a[20:23]
  ds_read_b64_tr_b16 v[82:83], v19 offset:25600
  v_mfma_f32_16x16x32_bf16 a[24:27], v[68:71], v[32:35], a[24:27]
  ds_read_b128 v[52:55], v13 offset:4096
  v_mfma_f32_16x16x32_bf16 a[28:31], v[72:75], v[32:35], a[28:31]
  ds_read_b64_tr_b16 v[84:85], v20 offset:24576
  s_add_u32 m0, s53, 35840
  v_mfma_f32_16x16x32_bf16 a[32:35], v[60:63], v[36:39], a[32:35]
  buffer_load_dwordx4 v9, s[12:15], s21 offen  lds
  ds_read_b64_tr_b16 v[86:87], v20 offset:25600
  v_mfma_f32_16x16x32_bf16 a[36:39], v[64:67], v[36:39], a[36:39]
  ds_read_b128 v[56:59], v13 offset:6144
  v_mfma_f32_16x16x32_bf16 a[40:43], v[68:71], v[36:39], a[40:43]
  ds_read_b64_tr_b16 v[88:89], v21 offset:24576
  v_mfma_f32_16x16x32_bf16 a[44:47], v[72:75], v[36:39], a[44:47]
  ds_read_b64_tr_b16 v[90:91], v21 offset:25600
  s_add_u32 s20, s20, 128
  v_mfma_f32_16x16x32_bf16 a[48:51], v[60:63], v[40:43], a[48:51]
  s_add_u32 s21, s21, s51
  v_mfma_f32_16x16x32_bf16 a[52:55], v[64:67], v[40:43], a[52:55]
  v_mfma_f32_16x16x32_bf16 a[56:59], v[68:71], v[40:43], a[56:59]
  v_mfma_f32_16x16x32_bf16 a[60:63], v[72:75], v[40:43], a[60:63]
  s_waitcnt lgkmcnt(0)
  v_mfma_f32_16x16x32_bf16 a[0:3], v[76:79], v[44:47], a[0:3]
  s_waitcnt vmcnt(16)
  s_barrier
  s_add_u32 m0, s52, 65536
  v_mfma_f32_16x16x32_bf16 a[4:7], v[80:83], v[44:47], a[4:7]
  buffer_load_dwordx4 v2, s[8:11], s20 offen  lds
  ds_read_b128 v[28:31], v12 offset:32768
  v_mfma_f32_16x16x32_bf16 a[8:11], v[84:87], v[44:47], a[8:11]
  ds_read_b64_tr_b16 v[60:61], v18 offset:49152
  v_mfma_f32_16x16x32_bf16 a[12:15], v[88:91], v[44:47], a[12:15]
  ds_read_b64_tr_b16 v[62:63], v18 offset:50176
  s_add_u32 m0, s53, 65536
  v_mfma_f32_16x16x32_bf16 a[16:19], v[76:79], v[48:51], a[16:19]
  buffer_load_dwordx4 v6, s[12:15], s21 offen  lds
  ds_read_b128 v[32:35], v12 offset:34816
  v_mfma_f32_16x16x32_bf16 a[20:23], v[80:83], v[48:51], a[20:23]
  ds_read_b64_tr_b16 v[64:65], v19 offset:49152
  v_mfma_f32_16x16x32_bf16 a[24:27], v[84:87], v[48:51], a[24:27]
  ds_read_b64_tr_b16 v[66:67], v19 offset:50176
  s_add_u32 m0, s52, 66560
  v_mfma_f32_16x16x32_bf16 a[28:31], v[88:91], v[48:51], a[28:31]
  buffer_load_dwordx4 v3, s[8:11], s20 offen  lds
  ds_read_b128 v[36:39], v12 offset:36864
  v_mfma_f32_16x16x32_bf16 a[32:35], v[76:79], v[52:55], a[32:35]
  ds_read_b64_tr_b16 v[68:69], v20 offset:49152
  v_mfma_f32_16x16x32_bf16 a[36:39], v[80:83], v[52:55], a[36:39]
  ds_read_b64_tr_b16 v[70:71], v20 offset:50176
  s_add_u32 m0, s53, 66560
  v_mfma_f32_16x16x32_bf16 a[40:43], v[84:87], v[52:55], a[40:43]
  buffer_load_dwordx4 v7, s[12:15], s21 offen  lds
  ds_read_b128 v[40:43], v12 offset:38912
  v_mfma_f32_16x16x32_bf16 a[44:47], v[88:91], v[52:55], a[44:47]
  ds_read_b64_tr_b16 v[72:73], v21 offset:49152
  v_mfma_f32_16x16x32_bf16 a[48:51], v[76:79], v[56:59], a[48:51]
  ds_read_b64_tr_b16 v[74:75], v21 offset:50176
  s_add_u32 m0, s52, 67584
  v_mfma_f32_16x16x32_bf16 a[52:55], v[80:83], v[56:59], a[52:55]
  buffer_load_dwordx4 v4, s[8:11], s20 offen  lds
  v_mfma_f32_16x16x32_bf16 a[56:59], v[84:87], v[56:59], a[56:59]
  v_mfma_f32_16x16x32_bf16 a[60:63], v[88:91], v[56:59], a[60:63]
  s_waitcnt lgkmcnt(0)
  s_add_u32 m0, s53, 67584
  v_mfma_f32_16x16x32_bf16 a[0:3], v[60:63], v[28:31], a[0:3]
  buffer_load_dwordx4 v8, s[12:15], s21 offen  lds
  ds_read_b128 v[44:47], v13 offset:32768
  v_mfma_f32_16x16x32_bf16 a[4:7], v[64:67], v[28:31], a[4:7]
  ds_read_b64_tr_b16 v[76:77], v18 offset:57344
  v_mfma_f32_16x16x32_bf16 a[8:11], v[68:71], v[28:31], a[8:11]
  ds_read_b64_tr_b16 v[78:79], v18 offset:58368
  v_mfma_f32_16x16x32_bf16 a[12:15], v[72:75], v[28:31], a[12:15]
  ds_read_b128 v[48:51], v13 offset:34816
  s_add_u32 m0, s52, 68608
  v_mfma_f32_16x16x32_bf16 a[16:19], v[60:63], v[32:35], a[16:19]
  buffer_load_dwordx4 v5, s[8:11], s20 offen  lds
  ds_read_b64_tr_b16 v[80:81], v19 offset:57344
  v_mfma_f32_16x16x32_bf16 a[20:23], v[64:67], v[32:35], a[20:23]
  ds_read_b64_tr_b16 v[82:83], v19 offset:58368
  v_mfma_f32_16x16x32_bf16 a[24:27], v[68:71], v[32:35], a[24:27]
  ds_read_b128 v[52:55], v13 offset:36864
  v_mfma_f32_16x16x32_bf16 a[28:31], v[72:75], v[32:35], a[28:31]
  ds_read_b64_tr_b16 v[84:85], v20 offset:57344
  s_add_u32 m0, s53, 68608
  v_mfma_f32_16x16x32_bf16 a[32:35], v[60:63], v[36:39], a[32:35]
  buffer_load_dwordx4 v9, s[12:15], s21 offen  lds
  ds_read_b64_tr_b16 v[86:87], v20 offset:58368
  v_mfma_f32_16x16x32_bf16 a[36:39], v[64:67], v[36:39], a[36:39]
  ds_read_b128 v[56:59], v13 offset:38912
  v_mfma_f32_16x16x32_bf16 a[40:43], v[68:71], v[36:39], a[40:43]
  ds_read_b64_tr_b16 v[88:89], v21 offset:57344
  v_mfma_f32_16x16x32_bf16 a[44:47], v[72:75], v[36:39], a[44:47]
  ds_read_b64_tr_b16 v[90:91], v21 offset:58368
  s_add_u32 s20, s20, 128
  v_mfma_f32_16x16x32_bf16 a[48:51], v[60:63], v[40:43], a[48:51]
  s_add_u32 s21, s21, s51
  v_mfma_f32_16x16x32_bf16 a[52:55], v[64:67], v[40:43], a[52:55]
  v_mfma_f32_16x16x32_bf16 a[56:59], v[68:71], v[40:43], a[56:59]
  v_mfma_f32_16x16x32_bf16 a[60:63], v[72:75], v[40:43], a[60:63]
  s_waitcnt lgkmcnt(0)
  v_mfma_f32_16x16x32_bf16 a[0:3], v[76:79], v[44:47], a[0:3]
  s_waitcnt vmcnt(16)
  s_barrier
  s_add_u32 m0, s52, 98304
  v_mfma_f32_16x16x32_bf16 a[4:7], v[80:83], v[44:47], a[4:7]
  buffer_load_dwordx4 v2, s[8:11], s20 offen  lds
  ds_read_b128 v[28:31], v10 offset:0
  v_mfma_f32_16x16x32_bf16 a[8:11], v[84:87], v[44:47], a[8:11]
  ds_read_b64_tr_b16 v[60:61], v14 offset:16384
  v_mfma_f32_16x16x32_bf16 a[12:15], v[88:91], v[44:47], a[12:15]
  ds_read_b64_tr_b16 v[62:63], v14 offset:17408
  s_add_u32 m0, s53, 98304
  v_mfma_f32_16x16x32_bf16 a[16:19], v[76:79], v[48:51], a[16:19]
  buffer_load_dwordx4 v6, s[12:15], s21 offen  lds
  ds_read_b128 v[32:35], v10 offset:2048
  v_mfma_f32_16x16x32_bf16 a[20:23], v[80:83], v[48:51], a[20:23]
  ds_read_b64_tr_b16 v[64:65], v15 offset:16384
  v_mfma_f32_16x16x32_bf16 a[24:27], v[84:87], v[48:51], a[24:27]
  ds_read_b64_tr_b16 v[66:67], v15 offset:17408
  s_add_u32 m0, s52, 99328
  v_mfma_f32_16x16x32_bf16 a[28:31], v[88:91], v[48:51], a[28:31]
  buffer_load_dwordx4 v3, s[8:11], s20 offen  lds
  ds_read_b128 v[36:39], v10 offset:4096
  v_mfma_f32_16x16x32_bf16 a[32:35], v[76:79], v[52:55], a[32:35]
  ds_read_b64_tr_b16 v[68:69], v16 offset:16384
  v_mfma_f32_16x16x32_bf16 a[36:39], v[80:83], v[52:55], a[36:39]
  ds_read_b64_tr_b16 v[70:71], v16 offset:17408
  s_add_u32 m0, s53, 99328
  v_mfma_f32_16x16x32_bf16 a[40:43], v[84:87], v[52:55], a[40:43]
  buffer_load_dwordx4 v7, s[12:15], s21 offen  lds
  ds_read_b128 v[40:43], v10 offset:6144
  v_mfma_f32_16x16x32_bf16 a[44:47], v[88:91], v[52:55], a[44:47]
  ds_read_b64_tr_b16 v[72:73], v17 offset:16384
  v_mfma_f32_16x16x32_bf16 a[48:51], v[76:79], v[56:59], a[48:51]
  ds_read_b64_tr_b16 v[74:75], v17 offset:17408
  s_add_u32 m0, s52, 100352
  v_mfma_f32_16x16x32_bf16 a[52:55], v[80:83], v[56:59], a[52:55]
  buffer_load_dwordx4 v4, s[8:11], s20 offen  lds
  v_mfma_f32_16x16x32_bf16 a[56:59], v[84:87], v[56:59], a[56:59]
  v_mfma_f32_16x16x32_bf16 a[60:63], v[88:91], v[56:59], a[60:63]
  s_branch L_g4_loop
L_g4_fin:
  s_cmp_lg_u32 s32, 0
  s_cbranch_scc1 L_rq_84
  s_cmp_eq_u32 s39, 0
  s_cbranch_scc1 L_rq_84
  s_lshl_b32 s99, s33, 7
  s_add_u32 s99, s99, 0x3d00200
  v_mov_b32 v244, 1
  v_mov_b32 v245, 0
  s_mov_b64 exec, 1
  buffer_atomic_add v244, v245, s[4:7], s99 offen sc0 sc1
  s_mov_b64 exec, -1
L_rq_84:
  s_waitcnt lgkmcnt(0)
  s_add_u32 m0, s53, 100352
  v_mfma_f32_16x16x32_bf16 a[0:3], v[60:63], v[28:31], a[0:3]
  buffer_load_dwordx4 v8, s[12:15], s21 offen  lds
  ds_read_b128 v[44:47], v11 offset:0
  v_mfma_f32_16x16x32_bf16 a[4:7], v[64:67], v[28:31], a[4:7]
  ds_read_b64_tr_b16 v[76:77], v14 offset:24576
  v_mfma_f32_16x16x32_bf16 a[8:11], v[68:71], v[28:31], a[8:11]
  ds_read_b64_tr_b16 v[78:79], v14 offset:25600
  v_mfma_f32_16x16x32_bf16 a[12:15], v[72:75], v[28:31], a[12:15]
  ds_read_b128 v[48:51], v11 offset:2048
  s_add_u32 m0, s52, 101376
  v_mfma_f32_16x16x32_bf16 a[16:19], v[60:63], v[32:35], a[16:19]
  buffer_load_dwordx4 v5, s[8:11], s20 offen  lds
  ds_read_b64_tr_b16 v[80:81], v15 offset:24576
  v_mfma_f32_16x16x32_bf16 a[20:23], v[64:67], v[32:35], a[20:23]
  ds_read_b64_tr_b16 v[82:83], v15 offset:25600
  v_mfma_f32_16x16x32_bf16 a[24:27], v[68:71], v[32:35], a[24:27]
  ds_read_b128 v[52:55], v11 offset:4096
  v_mfma_f32_16x16x32_bf16 a[28:31], v[72:75], v[32:35], a[28:31]
  ds_read_b64_tr_b16 v[84:85], v16 offset:24576
  s_add_u32 m0, s53, 101376
  v_mfma_f32_16x16x32_bf16 a[32:35], v[60:63], v[36:39], a[32:35]
  buffer_load_dwordx4 v9, s[12:15], s21 offen  lds
  ds_read_b64_tr_b16 v[86:87], v16 offset:25600
  v_mfma_f32_16x16x32_bf16 a[36:39], v[64:67], v[36:39], a[36:39]
  ds_read_b128 v[56:59], v11 offset:6144
  v_mfma_f32_16x16x32_bf16 a[40:43], v[68:71], v[36:39], a[40:43]
  ds_read_b64_tr_b16 v[88:89], v17 offset:24576
  v_mfma_f32_16x16x32_bf16 a[44:47], v[72:75], v[36:39], a[44:47]
  ds_read_b64_tr_b16 v[90:91], v17 offset:25600
  s_add_u32 s20, s20, 128
  v_mfma_f32_16x16x32_bf16 a[48:51], v[60:63], v[40:43], a[48:51]
  s_add_u32 s21, s21, s51
  v_mfma_f32_16x16x32_bf16 a[52:55], v[64:67], v[40:43], a[52:55]
  v_mfma_f32_16x16x32_bf16 a[56:59], v[68:71], v[40:43], a[56:59]
  v_mfma_f32_16x16x32_bf16 a[60:63], v[72:75], v[40:43], a[60:63]
  s_waitcnt lgkmcnt(0)
  v_mfma_f32_16x16x32_bf16 a[0:3], v[76:79], v[44:47], a[0:3]
  s_waitcnt vmcnt(16)
  s_barrier
  v_mfma_f32_16x16x32_bf16 a[4:7], v[80:83], v[44:47], a[4:7]
  ds_read_b128 v[28:31], v10 offset:32768
  v_mfma_f32_16x16x32_bf16 a[8:11], v[84:87], v[44:47], a[8:11]
  ds_read_b64_tr_b16 v[60:61], v14 offset:49152
  v_mfma_f32_16x16x32_bf16 a[12:15], v[88:91], v[44:47], a[12:15]
  ds_read_b64_tr_b16 v[62:63], v14 offset:50176
  v_mfma_f32_16x16x32_bf16 a[16:19], v[76:79], v[48:51], a[16:19]
  ds_read_b128 v[32:35], v10 offset:34816
  v_mfma_f32_16x16x32_bf16 a[20:23], v[80:83], v[48:51], a[20:23]
  ds_read_b64_tr_b16 v[64:65], v15 offset:49152
  v_mfma_f32_16x16x32_bf16 a[24:27], v[84:87], v[48:51], a[24:27]
  ds_read_b64_tr_b16 v[66:67], v15 offset:50176
  v_mfma_f32_16x16x32_bf16 a[28:31], v[88:91], v[48:51], a[28:31]
  ds_read_b128 v[36:39], v10 offset:36864
  v_mfma_f32_16x16x32_bf16 a[32:35], v[76:79], v[52:55], a[32:35]
  ds_read_b64_tr_b16 v[68:69], v16 offset:49152
  v_mfma_f32_16x16x32_bf16 a[36:39], v[80:83], v[52:55], a[36:39]
  ds_read_b64_tr_b16 v[70:71], v16 offset:50176
  v_mfma_f32_16x16x32_bf16 a[40:43], v[84:87], v[52:55], a[40:43]
  ds_read_b128 v[40:43], v10 offset:38912
  v_mfma_f32_16x16x32_bf16 a[44:47], v[88:91], v[52:55], a[44:47]
  ds_read_b64_tr_b16 v[72:73], v17 offset:49152
  v_mfma_f32_16x16x32_bf16 a[48:51], v[76:79], v[56:59], a[48:51]
  ds_read_b64_tr_b16 v[74:75], v17 offset:50176
  v_mfma_f32_16x16x32_bf16 a[52:55], v[80:83], v[56:59], a[52:55]
  v_mfma_f32_16x16x32_bf16 a[56:59], v[84:87], v[56:59], a[56:59]
  v_mfma_f32_16x16x32_bf16 a[60:63], v[88:91], v[56:59], a[60:63]
  s_waitcnt lgkmcnt(0)
  v_mfma_f32_16x16x32_bf16 a[0:3], v[60:63], v[28:31], a[0:3]
  ds_read_b128 v[44:47], v11 offset:32768
  v_mfma_f32_16x16x32_bf16 a[4:7], v[64:67], v[28:31], a[4:7]
  ds_read_b64_tr_b16 v[76:77], v14 offset:57344
  v_mfma_f32_16x16x32_bf16 a[8:11], v[68:71], v[28:31], a[8:11]
  ds_read_b64_tr_b16 v[78:79], v14 offset:58368
  v_mfma_f32_16x16x32_bf16 a[12:15], v[72:75], v[28:31], a[12:15]
  ds_read_b128 v[48:51], v11 offset:34816
  v_mfma_f32_16x16x32_bf16 a[16:19], v[60:63], v[32:35], a[16:19]
  ds_read_b64_tr_b16 v[80:81], v15 offset:57344
  v_mfma_f32_16x16x32_bf16 a[20:23], v[64:67], v[32:35], a[20:23]
  ds_read_b64_tr_b16 v[82:83], v15 offset:58368
  v_mfma_f32_16x16x32_bf16 a[24:27], v[68:71], v[32:35], a[24:27]
  ds_read_b128 v[52:55], v11 offset:36864
  v_mfma_f32_16x16x32_bf16 a[28:31], v[72:75], v[32:35], a[28:31]
  ds_read_b64_tr_b16 v[84:85], v16 offset:57344
  v_mfma_f32_16x16x32_bf16 a[32:35], v[60:63], v[36:39], a[32:35]
  ds_read_b64_tr_b16 v[86:87], v16 offset:58368
  v_mfma_f32_16x16x32_bf16 a[36:39], v[64:67], v[36:39], a[36:39]
  ds_read_b128 v[56:59], v11 offset:38912
  v_mfma_f32_16x16x32_bf16 a[40:43], v[68:71], v[36:39], a[40:43]
  ds_read_b64_tr_b16 v[88:89], v17 offset:57344
  v_mfma_f32_16x16x32_bf16 a[44:47], v[72:75], v[36:39], a[44:47]
  ds_read_b64_tr_b16 v[90:91], v17 offset:58368
  v_mfma_f32_16x16x32_bf16 a[48:51], v[60:63], v[40:43], a[48:51]
  v_mfma_f32_16x16x32_bf16 a[52:55], v[64:67], v[40:43], a[52:55]
  v_mfma_f32_16x16x32_bf16 a[56:59], v[68:71], v[40:43], a[56:59]
  v_mfma_f32_16x16x32_bf16 a[60:63], v[72:75], v[40:43], a[60:63]
  s_waitcnt lgkmcnt(0)
  v_mfma_f32_16x16x32_bf16 a[0:3], v[76:79], v[44:47], a[0:3]
  s_waitcnt vmcnt(8)
  s_barrier
  v_mfma_f32_16x16x32_bf16 a[4:7], v[80:83], v[44:47], a[4:7]
  ds_read_b128 v[28:31], v12 offset:0
  v_mfma_f32_16x16x32_bf16 a[8:11], v[84:87], v[44:47], a[8:11]
  ds_read_b64_tr_b16 v[60:61], v18 offset:16384
  v_mfma_f32_16x16x32_bf16 a[12:15], v[88:91], v[44:47], a[12:15]
  ds_read_b64_tr_b16 v[62:63], v18 offset:17408
  v_mfma_f32_16x16x32_bf16 a[16:19], v[76:79], v[48:51], a[16:19]
  ds_read_b128 v[32:35], v12 offset:2048
  v_mfma_f32_16x16x32_bf16 a[20:23], v[80:83], v[48:51], a[20:23]
  ds_read_b64_tr_b16 v[64:65], v19 offset:16384
  v_mfma_f32_16x16x32_bf16 a[24:27], v[84:87], v[48:51], a[24:27]
  ds_read_b64_tr_b16 v[66:67], v19 offset:17408
  v_mfma_f32_16x16x32_bf16 a[28:31], v[88:91], v[48:51], a[28:31]
  ds_read_b128 v[36:39], v12 offset:4096
  v_mfma_f32_16x16x32_bf16 a[32:35], v[76:79], v[52:55], a[32:35]
  ds_read_b64_tr_b16 v[68:69], v20 offset:16384
  v_mfma_f32_16x16x32_bf16 a[36:39], v[80:83], v[52:55], a[36:39]
  ds_read_b64_tr_b16 v[70:71], v20 offset:17408
  v_mfma_f32_16x16x32_bf16 a[40:43], v[84:87], v[52:55], a[40:43]
  ds_read_b128 v[40:43], v12 offset:6144
  v_mfma_f32_16x16x32_bf16 a[44:47], v[88:91], v[52:55], a[44:47]
  ds_read_b64_tr_b16 v[72:73], v21 offset:16384
  v_mfma_f32_16x16x32_bf16 a[48:51], v[76:79], v[56:59], a[48:51]
  ds_read_b64_tr_b16 v[74:75], v21 offset:17408
  v_mfma_f32_16x16x32_bf16 a[52:55], v[80:83], v[56:59], a[52:55]
  v_mfma_f32_16x16x32_bf16 a[56:59], v[84:87], v[56:59], a[56:59]
  v_mfma_f32_16x16x32_bf16 a[60:63], v[88:91], v[56:59], a[60:63]
  s_waitcnt lgkmcnt(0)
  v_mfma_f32_16x16x32_bf16 a[0:3], v[60:63], v[28:31], a[0:3]
  ds_read_b128 v[44:47], v13 offset:0
  v_mfma_f32_16x16x32_bf16 a[4:7], v[64:67], v[28:31], a[4:7]
  ds_read_b64_tr_b16 v[76:77], v18 offset:24576
  v_mfma_f32_16x16x32_bf16 a[8:11], v[68:71], v[28:31], a[8:11]
  ds_read_b64_tr_b16 v[78:79], v18 offset:25600
  v_mfma_f32_16x16x32_bf16 a[12:15], v[72:75], v[28:31], a[12:15]
  ds_read_b128 v[48:51], v13 offset:2048
  v_mfma_f32_16x16x32_bf16 a[16:19], v[60:63], v[32:35], a[16:19]
  ds_read_b64_tr_b16 v[80:81], v19 offset:24576
  v_mfma_f32_16x16x32_bf16 a[20:23], v[64:67], v[32:35], a[20:23]
  ds_read_b64_tr_b16 v[82:83], v19 offset:25600
  v_mfma_f32_16x16x32_bf16 a[24:27], v[68:71], v[32:35], a[24:27]
  ds_read_b128 v[52:55], v13 offset:4096
  v_mfma_f32_16x16x32_bf16 a[28:31], v[72:75], v[32:35], a[28:31]
  ds_read_b64_tr_b16 v[84:85], v20 offset:24576
  v_mfma_f32_16x16x32_bf16 a[32:35], v[60:63], v[36:39], a[32:35]
  ds_read_b64_tr_b16 v[86:87], v20 offset:25600
  v_mfma_f32_16x16x32_bf16 a[36:39], v[64:67], v[36:39], a[36:39]
  ds_read_b128 v[56:59], v13 offset:6144
  v_mfma_f32_16x16x32_bf16 a[40:43], v[68:71], v[36:39], a[40:43]
  ds_read_b64_tr_b16 v[88:89], v21 offset:24576
  v_mfma_f32_16x16x32_bf16 a[44:47], v[72:75], v[36:39], a[44:47]
  ds_read_b64_tr_b16 v[90:91], v21 offset:25600
  v_mfma_f32_16x16x32_bf16 a[48:51], v[60:63], v[40:43], a[48:51]
  v_mfma_f32_16x16x32_bf16 a[52:55], v[64:67], v[40:43], a[52:55]
  v_mfma_f32_16x16x32_bf16 a[56:59], v[68:71], v[40:43], a[56:59]
  v_mfma_f32_16x16x32_bf16 a[60:63], v[72:75], v[40:43], a[60:63]
  s_waitcnt lgkmcnt(0)
  v_mfma_f32_16x16x32_bf16 a[0:3], v[76:79], v[44:47], a[0:3]
  s_waitcnt vmcnt(0)
  s_barrier
  v_mfma_f32_16x16x32_bf16 a[4:7], v[80:83], v[44:47], a[4:7]
  ds_read_b128 v[28:31], v12 offset:32768
  v_mfma_f32_16x16x32_bf16 a[8:11], v[84:87], v[44:47], a[8:11]
  ds_read_b64_tr_b16 v[60:61], v18 offset:49152
  v_mfma_f32_16x16x32_bf16 a[12:15], v[88:91], v[44:47], a[12:15]
  ds_read_b64_tr_b16 v[62:63], v18 offset:50176
  v_mfma_f32_16x16x32_bf16 a[16:19], v[76:79], v[48:51], a[16:19]
  ds_read_b128 v[32:35], v12 offset:34816
  v_mfma_f32_16x16x32_bf16 a[20:23], v[80:83], v[48:51], a[20:23]
  ds_read_b64_tr_b16 v[64:65], v19 offset:49152
  v_mfma_f32_16x16x32_bf16 a[24:27], v[84:87], v[48:51], a[24:27]
  ds_read_b64_tr_b16 v[66:67], v19 offset:50176
  v_mfma_f32_16x16x32_bf16 a[28:31], v[88:91], v[48:51], a[28:31]
  ds_read_b128 v[36:39], v12 offset:36864
  v_mfma_f32_16x16x32_bf16 a[32:35], v[76:79], v[52:55], a[32:35]
  ds_read_b64_tr_b16 v[68:69], v20 offset:49152
  v_mfma_f32_16x16x32_bf16 a[36:39], v[80:83], v[52:55], a[36:39]
  ds_read_b64_tr_b16 v[70:71], v20 offset:50176
  v_mfma_f32_16x16x32_bf16 a[40:43], v[84:87], v[52:55], a[40:43]
  ds_read_b128 v[40:43], v12 offset:38912
  v_mfma_f32_16x16x32_bf16 a[44:47], v[88:91], v[52:55], a[44:47]
  ds_read_b64_tr_b16 v[72:73], v21 offset:49152
  v_mfma_f32_16x16x32_bf16 a[48:51], v[76:79], v[56:59], a[48:51]
  ds_read_b64_tr_b16 v[74:75], v21 offset:50176
  v_mfma_f32_16x16x32_bf16 a[52:55], v[80:83], v[56:59], a[52:55]
  v_mfma_f32_16x16x32_bf16 a[56:59], v[84:87], v[56:59], a[56:59]
  v_mfma_f32_16x16x32_bf16 a[60:63], v[88:91], v[56:59], a[60:63]
  s_waitcnt lgkmcnt(0)
  v_mfma_f32_16x16x32_bf16 a[0:3], v[60:63], v[28:31], a[0:3]
  ds_read_b128 v[44:47], v13 offset:32768
  v_mfma_f32_16x16x32_bf16 a[4:7], v[64:67], v[28:31], a[4:7]
  ds_read_b64_tr_b16 v[76:77], v18 offset:57344
  v_mfma_f32_16x16x32_bf16 a[8:11], v[68:71], v[28:31], a[8:11]
  ds_read_b64_tr_b16 v[78:79], v18 offset:58368
  v_mfma_f32_16x16x32_bf16 a[12:15], v[72:75], v[28:31], a[12:15]
  ds_read_b128 v[48:51], v13 offset:34816
  v_mfma_f32_16x16x32_bf16 a[16:19], v[60:63], v[32:35], a[16:19]
  ds_read_b64_tr_b16 v[80:81], v19 offset:57344
  v_mfma_f32_16x16x32_bf16 a[20:23], v[64:67], v[32:35], a[20:23]
  ds_read_b64_tr_b16 v[82:83], v19 offset:58368
  v_mfma_f32_16x16x32_bf16 a[24:27], v[68:71], v[32:35], a[24:27]
  ds_read_b128 v[52:55], v13 offset:36864
  v_mfma_f32_16x16x32_bf16 a[28:31], v[72:75], v[32:35], a[28:31]
  ds_read_b64_tr_b16 v[84:85], v20 offset:57344
  v_mfma_f32_16x16x32_bf16 a[32:35], v[60:63], v[36:39], a[32:35]
  ds_read_b64_tr_b16 v[86:87], v20 offset:58368
  v_mfma_f32_16x16x32_bf16 a[36:39], v[64:67], v[36:39], a[36:39]
  ds_read_b128 v[56:59], v13 offset:38912
  v_mfma_f32_16x16x32_bf16 a[40:43], v[68:71], v[36:39], a[40:43]
  ds_read_b64_tr_b16 v[88:89], v21 offset:57344
  v_mfma_f32_16x16x32_bf16 a[44:47], v[72:75], v[36:39], a[44:47]
  ds_read_b64_tr_b16 v[90:91], v21 offset:58368
  v_mfma_f32_16x16x32_bf16 a[48:51], v[60:63], v[40:43], a[48:51]
  v_mfma_f32_16x16x32_bf16 a[52:55], v[64:67], v[40:43], a[52:55]
  v_mfma_f32_16x16x32_bf16 a[56:59], v[68:71], v[40:43], a[56:59]
  v_mfma_f32_16x16x32_bf16 a[60:63], v[72:75], v[40:43], a[60:63]
  s_waitcnt lgkmcnt(0)
  v_mfma_f32_16x16x32_bf16 a[0:3], v[76:79], v[44:47], a[0:3]
  v_mfma_f32_16x16x32_bf16 a[4:7], v[80:83], v[44:47], a[4:7]
  v_mfma_f32_16x16x32_bf16 a[8:11], v[84:87], v[44:47], a[8:11]
  v_mfma_f32_16x16x32_bf16 a[12:15], v[88:91], v[44:47], a[12:15]
  v_mfma_f32_16x16x32_bf16 a[16:19], v[76:79], v[48:51], a[16:19]
  v_mfma_f32_16x16x32_bf16 a[20:23], v[80:83], v[48:51], a[20:23]
  v_mfma_f32_16x16x32_bf16 a[24:27], v[84:87], v[48:51], a[24:27]
  v_mfma_f32_16x16x32_bf16 a[28:31], v[88:91], v[48:51], a[28:31]
  v_mfma_f32_16x16x32_bf16 a[32:35], v[76:79], v[52:55], a[32:35]
  v_mfma_f32_16x16x32_bf16 a[36:39], v[80:83], v[52:55], a[36:39]
  v_mfma_f32_16x16x32_bf16 a[40:43], v[84:87], v[52:55], a[40:43]
  v_mfma_f32_16x16x32_bf16 a[44:47], v[88:91], v[52:55], a[44:47]
  v_mfma_f32_16x16x32_bf16 a[48:51], v[76:79], v[56:59], a[48:51]
  v_mfma_f32_16x16x32_bf16 a[52:55], v[80:83], v[56:59], a[52:55]
  v_mfma_f32_16x16x32_bf16 a[56:59], v[84:87], v[56:59], a[56:59]
  v_mfma_f32_16x16x32_bf16 a[60:63], v[88:91], v[56:59], a[60:63]
  s_mov_b32 s59, 3
  s_mov_b32 s60, s22
  s_mov_b32 s61, s26
  s_add_u32 s62, s38, 0x3d00000
  s_mov_b32 s63, s98
  s_cmp_lg_u32 s39, 0
  s_cbranch_scc1 L_got
  s_mov_b32 s58, 3
  s_branch L_epi
L_g5:
  s_waitcnt vmcnt(26)
  s_barrier
  ds_read_b128 v[28:31], v10 offset:0
  ds_read_b64_tr_b16 v[60:61], v14 offset:16384
  ds_read_b64_tr_b16 v[62:63], v14 offset:17408
  ds_read_b128 v[32:35], v10 offset:2048
  ds_read_b64_tr_b16 v[64:65], v15 offset:16384
  ds_read_b64_tr_b16 v[66:67], v15 offset:17408
  ds_read_b128 v[36:39], v10 offset:4096
  ds_read_b64_tr_b16 v[68:69], v16 offset:16384
  ds_read_b64_tr_b16 v[70:71], v16 offset:17408
  ds_read_b128 v[40:43], v10 offset:6144
  ds_read_b64_tr_b16 v[72:73], v17 offset:16384
  ds_read_b64_tr_b16 v[74:75], v17 offset:17408
  s_sub_u32 s25, s25, 1
  s_waitcnt lgkmcnt(0)
  v_mfma_f32_16x16x32_bf16 a[0:3], v[28:31], v[60:63], 0
  ds_read_b128 v[44:47], v11 offset:0
  v_mfma_f32_16x16x32_bf16 a[4:7], v[28:31], v[64:67], 0
  ds_read_b64_tr_b16 v[76:77], v14 offset:24576
  v_mfma_f32_16x16x32_bf16 a[8:11], v[28:31], v[68:71], 0
  ds_read_b64_tr_b16 v[78:79], v14 offset:25600
  v_mfma_f32_16x16x32_bf16 a[12:15], v[28:31], v[72:75], 0
  ds_read_b128 v[48:51], v11 offset:2048
  v_mfma_f32_16x16x32_bf16 a[16:19], v[32:35], v[60:63], 0
  ds_read_b64_tr_b16 v[80:81], v15 offset:24576
  v_mfma_f32_16x16x32_bf16 a[20:23], v[32:35], v[64:67], 0
  ds_read_b64_tr_b16 v[82:83], v15 offset:25600
  v_mfma_f32_16x16x32_bf16 a[24:27], v[32:35], v[68:71], 0
  ds_read_b128 v[52:55], v11 offset:4096
  v_mfma_f32_16x16x32_bf16 a[28:31], v[32:35], v[72:75], 0
  ds_read_b64_tr_b16 v[84:85], v16 offset:24576
  v_mfma_f32_16x16x32_bf16 a[32:35], v[36:39], v[60:63], 0
  ds_read_b64_tr_b16 v[86:87], v16 offset:25600
  v_mfma_f32_16x16x32_bf16 a[36:39], v[36:39], v[64:67], 0
  ds_read_b128 v[56:59], v11 offset:6144
  v_mfma_f32_16x16x32_bf16 a[40:43], v[36:39], v[68:71], 0
  ds_read_b64_tr_b16 v[88:89], v17 offset:24576
  v_mfma_f32_16x16x32_bf16 a[44:47], v[36:39], v[72:75], 0
  ds_read_b64_tr_b16 v[90:91], v17 offset:25600
  v_mfma_f32_16x16x32_bf16 a[48:51], v[40:43], v[60:63], 0
  v_mfma_f32_16x16x32_bf16 a[52:55], v[40:43], v[64:67], 0
  v_mfma_f32_16x16x32_bf16 a[56:59], v[40:43], v[68:71], 0
  v_mfma_f32_16x16x32_bf16 a[60:63], v[40:43], v[72:75], 0
  s_waitcnt lgkmcnt(0)
  v_mfma_f32_16x16x32_bf16 a[0:3], v[44:47], v[76:79], a[0:3]
  s_waitcnt vmcnt(18)
  s_barrier
  s_add_u32 m0, s52, 0
  v_mfma_f32_16x16x32_bf16 a[4:7], v[44:47], v[80:83], a[4:7]
  buffer_load_dwordx4 v2, s[8:11], s20 offen  lds
  ds_read_b128 v[28:31], v10 offset:32768
  v_mfma_f32_16x16x32_bf16 a[8:11], v[44:47], v[84:87], a[8:11]
  ds_read_b64_tr_b16 v[60:61], v14 offset:49152
  v_mfma_f32_16x16x32_bf16 a[12:15], v[44:47], v[88:91], a[12:15]
  ds_read_b64_tr_b16 v[62:63], v14 offset:50176
  s_add_u32 m0, s53, 0
  v_mfma_f32_16x16x32_bf16 a[16:19], v[48:51], v[76:79], a[16:19]
  buffer_load_dwordx4 v6, s[12:15], s21 offen  lds
  ds_read_b128 v[32:35], v10 offset:34816
  v_mfma_f32_16x16x32_bf16 a[20:23], v[48:51], v[80:83], a[20:23]
  ds_read_b64_tr_b16 v[64:65], v15 offset:49152
  v_mfma_f32_16x16x32_bf16 a[24:27], v[48:51], v[84:87], a[24:27]
  ds_read_b64_tr_b16 v[66:67], v15 offset:50176
  s_add_u32 m0, s52, 1024
  v_mfma_f32_16x16x32_bf16 a[28:31], v[48:51], v[88:91], a[28:31]
  buffer_load_dwordx4 v3, s[8:11], s20 offen  lds
  ds_read_b128 v[36:39], v10 offset:36864
  v_mfma_f32_16x16x32_bf16 a[32:35], v[52:55], v[76:79], a[32:35]
  ds_read_b64_tr_b16 v[68:69], v16 offset:49152
  v_mfma_f32_16x16x32_bf16 a[36:39], v[52:55], v[80:83], a[36:39]
  ds_read_b64_tr_b16 v[70:71], v16 offset:50176
  s_add_u32 m0, s53, 1024
  v_mfma_f32_16x16x32_bf16 a[40:43], v[52:55], v[84:87], a[40:43]
  buffer_load_dwordx4 v7, s[12:15], s21 offen  lds
  ds_read_b128 v[40:43], v10 offset:38912
  v_mfma_f32_16x16x32_bf16 a[44:47], v[52:55], v[88:91], a[44:47]
  ds_read_b64_tr_b16 v[72:73], v17 offset:49152
  v_mfma_f32_16x16x32_bf16 a[48:51], v[56:59], v[76:79], a[48:51]
  ds_read_b64_tr_b16 v[74:75], v17 offset:50176
  s_add_u32 m0, s52, 2048
  v_mfma_f32_16x16x32_bf16 a[52:55], v[56:59], v[80:83], a[52:55]
  buffer_load_dwordx4 v4, s[8:11], s20 offen  lds
  v_mfma_f32_16x16x32_bf16 a[56:59], v[56:59], v[84:87], a[56:59]
  v_mfma_f32_16x16x32_bf16 a[60:63], v[56:59], v[88:91], a[60:63]
  s_waitcnt lgkmcnt(0)
  s_add_u32 m0, s53, 2048
  v_mfma_f32_16x16x32_bf16 a[0:3], v[28:31], v[60:63], a[0:3]
  buffer_load_dwordx4 v8, s[12:15], s21 offen  lds
  ds_read_b128 v[44:47], v11 offset:32768
  v_mfma_f32_16x16x32_bf16 a[4:7], v[28:31], v[64:67], a[4:7]
  ds_read_b64_tr_b16 v[76:77], v14 offset:57344
  v_mfma_f32_16x16x32_bf16 a[8:11], v[28:31], v[68:71], a[8:11]
  ds_read_b64_tr_b16 v[78:79], v14 offset:58368
  v_mfma_f32_16x16x32_bf16 a[12:15], v[28:31], v[72:75], a[12:15]
  ds_read_b128 v[48:51], v11 offset:34816
  s_add_u32 m0, s52, 3072
  v_mfma_f32_16x16x32_bf16 a[16:19], v[32:35], v[60:63], a[16:19]
  buffer_load_dwordx4 v5, s[8:11], s20 offen  lds
  ds_read_b64_tr_b16 v[80:81], v15 offset:57344
  v_mfma_f32_16x16x32_bf16 a[20:23], v[32:35], v[64:67], a[20:23]
  ds_read_b64_tr_b16 v[82:83], v15 offset:58368
  v_mfma_f32_16x16x32_bf16 a[24:27], v[32:35], v[68:71], a[24:27]
  ds_read_b128 v[52:55], v11 offset:36864
  v_mfma_f32_16x16x32_bf16 a[28:31], v[32:35], v[72:75], a[28:31]
  ds_read_b64_tr_b16 v[84:85], v16 offset:57344
  s_add_u32 m0, s53, 3072
  v_mfma_f32_16x16x32_bf16 a[32:35], v[36:39], v[60:63], a[32:35]
  buffer_load_dwordx4 v9, s[12:15], s21 offen  lds
  ds_read_b64_tr_b16 v[86:87], v16 offset:58368
  v_mfma_f32_16x16x32_bf16 a[36:39], v[36:39], v[64:67], a[36:39]
  ds_read_b128 v[56:59], v11 offset:38912
  v_mfma_f32_16x16x32_bf16 a[40:43], v[36:39], v[68:71], a[40:43]
  ds_read_b64_tr_b16 v[88:89], v17 offset:57344
  v_mfma_f32_16x16x32_bf16 a[44:47], v[36:39], v[72:75], a[44:47]
  ds_read_b64_tr_b16 v[90:91], v17 offset:58368
  s_add_u32 s20, s20, 128
  v_mfma_f32_16x16x32_bf16 a[48:51], v[40:43], v[60:63], a[48:51]
  s_add_u32 s21, s21, s51
  v_mfma_f32_16x16x32_bf16 a[52:55], v[40:43], v[64:67], a[52:55]
  v_mfma_f32_16x16x32_bf16 a[56:59], v[40:43], v[68:71], a[56:59]
  v_mfma_f32_16x16x32_bf16 a[60:63], v[40:43], v[72:75], a[60:63]
  s_waitcnt lgkmcnt(0)
  v_mfma_f32_16x16x32_bf16 a[0:3], v[44:47], v[76:79], a[0:3]
  s_waitcnt vmcnt(18)
  s_barrier
  s_add_u32 m0, s52, 32768
  v_mfma_f32_16x16x32_bf16 a[4:7], v[44:47], v[80:83], a[4:7]
  buffer_load_dwordx4 v2, s[8:11], s20 offen  lds
  ds_read_b128 v[28:31], v12 offset:0
  v_mfma_f32_16x16x32_bf16 a[8:11], v[44:47], v[84:87], a[8:11]
  ds_read_b64_tr_b16 v[60:61], v18 offset:16384
  v_mfma_f32_16x16x32_bf16 a[12:15], v[44:47], v[88:91], a[12:15]
  ds_read_b64_tr_b16 v[62:63], v18 offset:17408
  s_add_u32 m0, s53, 32768
  v_mfma_f32_16x16x32_bf16 a[16:19], v[48:51], v[76:79], a[16:19]
  buffer_load_dwordx4 v6, s[12:15], s21 offen  lds
  ds_read_b128 v[32:35], v12 offset:2048
  v_mfma_f32_16x16x32_bf16 a[20:23], v[48:51], v[80:83], a[20:23]
  ds_read_b64_tr_b16 v[64:65], v19 offset:16384
  v_mfma_f32_16x16x32_bf16 a[24:27], v[48:51], v[84:87], a[24:27]
  ds_read_b64_tr_b16 v[66:67], v19 offset:17408
  s_add_u32 m0, s52, 33792
  v_mfma_f32_16x16x32_bf16 a[28:31], v[48:51], v[88:91], a[28:31]
  buffer_load_dwordx4 v3, s[8:11], s20 offen  lds
  ds_read_b128 v[36:39], v12 offset:4096
  v_mfma_f32_16x16x32_bf16 a[32:35], v[52:55], v[76:79], a[32:35]
  ds_read_b64_tr_b16 v[68:69], v20 offset:16384
  v_mfma_f32_16x16x32_bf16 a[36:39], v[52:55], v[80:83], a[36:39]
  ds_read_b64_tr_b16 v[70:71], v20 offset:17408
  s_add_u32 m0, s53, 33792
  v_mfma_f32_16x16x32_bf16 a[40:43], v[52:55], v[84:87], a[40:43]
  buffer_load_dwordx4 v7, s[12:15], s21 offen  lds
  ds_read_b128 v[40:43], v12 offset:6144
  v_mfma_f32_16x16x32_bf16 a[44:47], v[52:55], v[88:91], a[44:47]
  ds_read_b64_tr_b16 v[72:73], v21 offset:16384
  v_mfma_f32_16x16x32_bf16 a[48:51], v[56:59], v[76:79], a[48:51]
  ds_read_b64_tr_b16 v[74:75], v21 offset:17408
  s_add_u32 m0, s52, 34816
  v_mfma_f32_16x16x32_bf16 a[52:55], v[56:59], v[80:83], a[52:55]
  buffer_load_dwordx4 v4, s[8:11], s20 offen  lds
  v_mfma_f32_16x16x32_bf16 a[56:59], v[56:59], v[84:87], a[56:59]
  v_mfma_f32_16x16x32_bf16 a[60:63], v[56:59], v[88:91], a[60:63]
  s_waitcnt lgkmcnt(0)
  s_add_u32 m0, s53, 34816
  v_mfma_f32_16x16x32_bf16 a[0:3], v[28:31], v[60:63], a[0:3]
  buffer_load_dwordx4 v8, s[12:15], s21 offen  lds
  ds_read_b128 v[44:47], v13 offset:0
  v_mfma_f32_16x16x32_bf16 a[4:7], v[28:31], v[64:67], a[4:7]
  ds_read_b64_tr_b16 v[76:77], v18 offset:24576
  v_mfma_f32_16x16x32_bf16 a[8:11], v[28:31], v[68:71], a[8:11]
  ds_read_b64_tr_b16 v[78:79], v18 offset:25600
  v_mfma_f32_16x16x32_bf16 a[12:15], v[28:31], v[72:75], a[12:15]
  ds_read_b128 v[48:51], v13 offset:2048
  s_add_u32 m0, s52, 35840
  v_mfma_f32_16x16x32_bf16 a[16:19], v[32:35], v[60:63], a[16:19]
  buffer_load_dwordx4 v5, s[8:11], s20 offen  lds
  ds_read_b64_tr_b16 v[80:81], v19 offset:24576
  v_mfma_f32_16x16x32_bf16 a[20:23], v[32:35], v[64:67], a[20:23]
  ds_read_b64_tr_b16 v[82:83], v19 offset:25600
  v_mfma_f32_16x16x32_bf16 a[24:27], v[32:35], v[68:71], a[24:27]
  ds_read_b128 v[52:55], v13 offset:4096
  v_mfma_f32_16x16x32_bf16 a[28:31], v[32:35], v[72:75], a[28:31]
  ds_read_b64_tr_b16 v[84:85], v20 offset:24576
  s_add_u32 m0, s53, 35840
  v_mfma_f32_16x16x32_bf16 a[32:35], v[36:39], v[60:63], a[32:35]
  buffer_load_dwordx4 v9, s[12:15], s21 offen  lds
  ds_read_b64_tr_b16 v[86:87], v20 offset:25600
  v_mfma_f32_16x16x32_bf16 a[36:39], v[36:39], v[64:67], a[36:39]
  ds_read_b128 v[56:59], v13 offset:6144
  v_mfma_f32_16x16x32_bf16 a[40:43], v[36:39], v[68:71], a[40:43]
  ds_read_b64_tr_b16 v[88:89], v21 offset:24576
  v_mfma_f32_16x16x32_bf16 a[44:47], v[36:39], v[72:75], a[44:47]
  ds_read_b64_tr_b16 v[90:91], v21 offset:25600
  s_add_u32 s20, s20, 128
  v_mfma_f32_16x16x32_bf16 a[48:51], v[40:43], v[60:63], a[48:51]
  s_add_u32 s21, s21, s51
  v_mfma_f32_16x16x32_bf16 a[52:55], v[40:43], v[64:67], a[52:55]
  v_mfma_f32_16x16x32_bf16 a[56:59], v[40:43], v[68:71], a[56:59]
  v_mfma_f32_16x16x32_bf16 a[60:63], v[40:43], v[72:75], a[60:63]
  s_waitcnt lgkmcnt(0)
  v_mfma_f32_16x16x32_bf16 a[0:3], v[44:47], v[76:79], a[0:3]
  s_waitcnt vmcnt(18)
  s_barrier
  s_add_u32 m0, s52, 65536
  v_mfma_f32_16x16x32_bf16 a[4:7], v[44:47], v[80:83], a[4:7]
  buffer_load_dwordx4 v2, s[8:11], s20 offen  lds
  ds_read_b128 v[28:31], v12 offset:32768
  v_mfma_f32_16x16x32_bf16 a[8:11], v[44:47], v[84:87], a[8:11]
  ds_read_b64_tr_b16 v[60:61], v18 offset:49152
  v_mfma_f32_16x16x32_bf16 a[12:15], v[44:47], v[88:91], a[12:15]
  ds_read_b64_tr_b16 v[62:63], v18 offset:50176
  s_add_u32 m0, s53, 65536
  v_mfma_f32_16x16x32_bf16 a[16:19], v[48:51], v[76:79], a[16:19]
  buffer_load_dwordx4 v6, s[12:15], s21 offen  lds
  ds_read_b128 v[32:35], v12 offset:34816
  v_mfma_f32_16x16x32_bf16 a[20:23], v[48:51], v[80:83], a[20:23]
  ds_read_b64_tr_b16 v[64:65], v19 offset:49152
  v_mfma_f32_16x16x32_bf16 a[24:27], v[48:51], v[84:87], a[24:27]
  ds_read_b64_tr_b16 v[66:67], v19 offset:50176
  s_add_u32 m0, s52, 66560
  v_mfma_f32_16x16x32_bf16 a[28:31], v[48:51], v[88:91], a[28:31]
  buffer_load_dwordx4 v3, s[8:11], s20 offen  lds
  ds_read_b128 v[36:39], v12 offset:36864
  v_mfma_f32_16x16x32_bf16 a[32:35], v[52:55], v[76:79], a[32:35]
  ds_read_b64_tr_b16 v[68:69], v20 offset:49152
  v_mfma_f32_16x16x32_bf16 a[36:39], v[52:55], v[80:83], a[36:39]
  ds_read_b64_tr_b16 v[70:71], v20 offset:50176
  s_add_u32 m0, s53, 66560
  v_mfma_f32_16x16x32_bf16 a[40:43], v[52:55], v[84:87], a[40:43]
  buffer_load_dwordx4 v7, s[12:15], s21 offen  lds
  ds_read_b128 v[40:43], v12 offset:38912
  v_mfma_f32_16x16x32_bf16 a[44:47], v[52:55], v[88:91], a[44:47]
  ds_read_b64_tr_b16 v[72:73], v21 offset:49152
  v_mfma_f32_16x16x32_bf16 a[48:51], v[56:59], v[76:79], a[48:51]
  ds_read_b64_tr_b16 v[74:75], v21 offset:50176
  s_add_u32 m0, s52, 67584
  v_mfma_f32_16x16x32_bf16 a[52:55], v[56:59], v[80:83], a[52:55]
  buffer_load_dwordx4 v4, s[8:11], s20 offen  lds
  v_mfma_f32_16x16x32_bf16 a[56:59], v[56:59], v[84:87], a[56:59]
  v_mfma_f32_16x16x32_bf16 a[60:63], v[56:59], v[88:91], a[60:63]
  s_waitcnt lgkmcnt(0)
  s_add_u32 m0, s53, 67584
  v_mfma_f32_16x16x32_bf16 a[0:3], v[28:31], v[60:63], a[0:3]
  buffer_load_dwordx4 v8, s[12:15], s21 offen  lds
  ds_read_b128 v[44:47], v13 offset:32768
  v_mfma_f32_16x16x32_bf16 a[4:7], v[28:31], v[64:67], a[4:7]
  ds_read_b64_tr_b16 v[76:77], v18 offset:57344
  v_mfma_f32_16x16x32_bf16 a[8:11], v[28:31], v[68:71], a[8:11]
  ds_read_b64_tr_b16 v[78:79], v18 offset:58368
  v_mfma_f32_16x16x32_bf16 a[12:15], v[28:31], v[72:75], a[12:15]
  ds_read_b128 v[48:51], v13 offset:34816
  s_add_u32 m0, s52, 68608
  v_mfma_f32_16x16x32_bf16 a[16:19], v[32:35], v[60:63], a[16:19]
  buffer_load_dwordx4 v5, s[8:11], s20 offen  lds
  ds_read_b64_tr_b16 v[80:81], v19 offset:57344
  v_mfma_f32_16x16x32_bf16 a[20:23], v[32:35], v[64:67], a[20:23]
  ds_read_b64_tr_b16 v[82:83], v19 offset:58368
  v_mfma_f32_16x16x32_bf16 a[24:27], v[32:35], v[68:71], a[24:27]
  ds_read_b128 v[52:55], v13 offset:36864
  v_mfma_f32_16x16x32_bf16 a[28:31], v[32:35], v[72:75], a[28:31]
  ds_read_b64_tr_b16 v[84:85], v20 offset:57344
  s_add_u32 m0, s53, 68608
  v_mfma_f32_16x16x32_bf16 a[32:35], v[36:39], v[60:63], a[32:35]
  buffer_load_dwordx4 v9, s[12:15], s21 offen  lds
  ds_read_b64_tr_b16 v[86:87], v20 offset:58368
  v_mfma_f32_16x16x32_bf16 a[36:39], v[36:39], v[64:67], a[36:39]
  ds_read_b128 v[56:59], v13 offset:38912
  v_mfma_f32_16x16x32_bf16 a[40:43], v[36:39], v[68:71], a[40:43]
  ds_read_b64_tr_b16 v[88:89], v21 offset:57344
  v_mfma_f32_16x16x32_bf16 a[44:47], v[36:39], v[72:75], a[44:47]
  ds_read_b64_tr_b16 v[90:91], v21 offset:58368
  s_add_u32 s20, s20, 128
  v_mfma_f32_16x16x32_bf16 a[48:51], v[40:43], v[60:63], a[48:51]
  s_add_u32 s21, s21, s51
  v_mfma_f32_16x16x32_bf16 a[52:55], v[40:43], v[64:67], a[52:55]
  v_mfma_f32_16x16x32_bf16 a[56:59], v[40:43], v[68:71], a[56:59]
  v_mfma_f32_16x16x32_bf16 a[60:63], v[40:43], v[72:75], a[60:63]
  s_waitcnt lgkmcnt(0)
  v_mfma_f32_16x16x32_bf16 a[0:3], v[44:47], v[76:79], a[0:3]
  s_waitcnt vmcnt(16)
  s_barrier
  s_add_u32 m0, s52, 98304
  v_mfma_f32_16x16x32_bf16 a[4:7], v[44:47], v[80:83], a[4:7]
  buffer_load_dwordx4 v2, s[8:11], s20 offen  lds
  ds_read_b128 v[28:31], v10 offset:0
  v_mfma_f32_16x16x32_bf16 a[8:11], v[44:47], v[84:87], a[8:11]
  ds_read_b64_tr_b16 v[60:61], v14 offset:16384
  v_mfma_f32_16x16x32_bf16 a[12:15], v[44:47], v[88:91], a[12:15]
  ds_read_b64_tr_b16 v[62:63], v14 offset:17408
  s_add_u32 m0, s53, 98304
  v_mfma_f32_16x16x32_bf16 a[16:19], v[48:51], v[76:79], a[16:19]
  buffer_load_dwordx4 v6, s[12:15], s21 offen  lds
  ds_read_b128 v[32:35], v10 offset:2048
  v_mfma_f32_16x16x32_bf16 a[20:23], v[48:51], v[80:83], a[20:23]
  ds_read_b64_tr_b16 v[64:65], v15 offset:16384
  v_mfma_f32_16x16x32_bf16 a[24:27], v[48:51], v[84:87], a[24:27]
  ds_read_b64_tr_b16 v[66:67], v15 offset:17408
  s_add_u32 m0, s52, 99328
  v_mfma_f32_16x16x32_bf16 a[28:31], v[48:51], v[88:91], a[28:31]
  buffer_load_dwordx4 v3, s[8:11], s20 offen  lds
  ds_read_b128 v[36:39], v10 offset:4096
  v_mfma_f32_16x16x32_bf16 a[32:35], v[52:55], v[76:79], a[32:35]
  ds_read_b64_tr_b16 v[68:69], v16 offset:16384
  v_mfma_f32_16x16x32_bf16 a[36:39], v[52:55], v[80:83], a[36:39]
  ds_read_b64_tr_b16 v[70:71], v16 offset:17408
  s_add_u32 m0, s53, 99328
  v_mfma_f32_16x16x32_bf16 a[40:43], v[52:55], v[84:87], a[40:43]
  buffer_load_dwordx4 v7, s[12:15], s21 offen  lds
  ds_read_b128 v[40:43], v10 offset:6144
  v_mfma_f32_16x16x32_bf16 a[44:47], v[52:55], v[88:91], a[44:47]
  ds_read_b64_tr_b16 v[72:73], v17 offset:16384
  v_mfma_f32_16x16x32_bf16 a[48:51], v[56:59], v[76:79], a[48:51]
  ds_read_b64_tr_b16 v[74:75], v17 offset:17408
  s_add_u32 m0, s52, 100352
  v_mfma_f32_16x16x32_bf16 a[52:55], v[56:59], v[80:83], a[52:55]
  buffer_load_dwordx4 v4, s[8:11], s20 offen  lds
  v_mfma_f32_16x16x32_bf16 a[56:59], v[56:59], v[84:87], a[56:59]
  v_mfma_f32_16x16x32_bf16 a[60:63], v[56:59], v[88:91], a[60:63]
L_g5_loop:
  s_sub_u32 s25, s25, 1
  s_cmp_eq_u32 s25, 0
  s_cbranch_scc1 L_g5_fin
  s_waitcnt lgkmcnt(0)
  s_add_u32 m0, s53, 100352
  v_mfma_f32_16x16x32_bf16 a[0:3], v[28:31], v[60:63], a[0:3]
  buffer_load_dwordx4 v8, s[12:15], s21 offen  lds
  ds_read_b128 v[44:47], v11 offset:0
  v_mfma_f32_16x16x32_bf16 a[4:7], v[28:31], v[64:67], a[4:7]
  ds_read_b64_tr_b16 v[76:77], v14 offset:24576
  v_mfma_f32_16x16x32_bf16 a[8:11], v[28:31], v[68:71], a[8:11]
  ds_read_b64_tr_b16 v[78:79], v14 offset:25600
  v_mfma_f32_16x16x32_bf16 a[12:15], v[28:31], v[72:75], a[12:15]
  ds_read_b128 v[48:51], v11 offset:2048
  s_add_u32 m0, s52, 101376
  v_mfma_f32_16x16x32_bf16 a[16:19], v[32:35], v[60:63], a[16:19]
  buffer_load_dwordx4 v5, s[8:11], s20 offen  lds
  ds_read_b64_tr_b16 v[80:81], v15 offset:24576
  v_mfma_f32_16x16x32_bf16 a[20:23], v[32:35], v[64:67], a[20:23]
  ds_read_b64_tr_b16 v[82:83], v15 offset:25600
  v_mfma_f32_16x16x32_bf16 a[24:27], v[32:35], v[68:71], a[24:27]
  ds_read_b128 v[52:55], v11 offset:4096
  v_mfma_f32_16x16x32_bf16 a[28:31], v[32:35], v[72:75], a[28:31]
  ds_read_b64_tr_b16 v[84:85], v16 offset:24576
  s_add_u32 m0, s53, 101376
  v_mfma_f32_16x16x32_bf16 a[32:35], v[36:39], v[60:63], a[32:35]
  buffer_load_dwordx4 v9, s[12:15], s21 offen  lds
  ds_read_b64_tr_b16 v[86:87], v16 offset:25600
  v_mfma_f32_16x16x32_bf16 a[36:39], v[36:39], v[64:67], a[36:39]
  ds_read_b128 v[56:59], v11 offset:6144
  v_mfma_f32_16x16x32_bf16 a[40:43], v[36:39], v[68:71], a[40:43]
  ds_read_b64_tr_b16 v[88:89], v17 offset:24576
  v_mfma_f32_16x16x32_bf16 a[44:47], v[36:39], v[72:75], a[44:47]
  ds_read_b64_tr_b16 v[90:91], v17 offset:25600
  s_add_u32 s20, s20, 128
  v_mfma_f32_16x16x32_bf16 a[48:51], v[40:43], v[60:63], a[48:51]
  s_add_u32 s21, s21, s51
  v_mfma_f32_16x16x32_bf16 a[52:55], v[40:43], v[64:67], a[52:55]
  v_mfma_f32_16x16x32_bf16 a[56:59], v[40:43], v[68:71], a[56:59]
  v_mfma_f32_16x16x32_bf16 a[60:63], v[40:43], v[72:75], a[60:63]
  s_waitcnt lgkmcnt(0)
  v_mfma_f32_16x16x32_bf16 a[0:3], v[44:47], v[76:79], a[0:3]
  s_waitcnt vmcnt(16)
  s_barrier
  s_add_u32 m0, s52, 0
  v_mfma_f32_16x16x32_bf16 a[4:7], v[44:47], v[80:83], a[4:7]
  buffer_load_dwordx4 v2, s[8:11], s20 offen  lds
  ds_read_b128 v[28:31], v10 offset:32768
  v_mfma_f32_16x16x32_bf16 a[8:11], v[44:47], v[84:87], a[8:11]
  ds_read_b64_tr_b16 v[60:61], v14 offset:49152
  v_mfma_f32_16x16x32_bf16 a[12:15], v[44:47], v[88:91], a[12:15]
  ds_read_b64_tr_b16 v[62:63], v14 offset:50176
  s_add_u32 m0, s53, 0
  v_mfma_f32_16x16x32_bf16 a[16:19], v[48:51], v[76:79], a[16:19]
  buffer_load_dwordx4 v6, s[12:15], s21 offen  lds
  ds_read_b128 v[32:35], v10 offset:34816
  v_mfma_f32_16x16x32_bf16 a[20:23], v[48:51], v[80:83], a[20:23]
  ds_read_b64_tr_b16 v[64:65], v15 offset:49152
  v_mfma_f32_16x16x32_bf16 a[24:27], v[48:51], v[84:87], a[24:27]
  ds_read_b64_tr_b16 v[66:67], v15 offset:50176
  s_add_u32 m0, s52, 1024
  v_mfma_f32_16x16x32_bf16 a[28:31], v[48:51], v[88:91], a[28:31]
  buffer_load_dwordx4 v3, s[8:11], s20 offen  lds
  ds_read_b128 v[36:39], v10 offset:36864
  v_mfma_f32_16x16x32_bf16 a[32:35], v[52:55], v[76:79], a[32:35]
  ds_read_b64_tr_b16 v[68:69], v16 offset:49152
  v_mfma_f32_16x16x32_bf16 a[36:39], v[52:55], v[80:83], a[36:39]
  ds_read_b64_tr_b16 v[70:71], v16 offset:50176
  s_add_u32 m0, s53, 1024
  v_mfma_f32_16x16x32_bf16 a[40:43], v[52:55], v[84:87], a[40:43]
  buffer_load_dwordx4 v7, s[12:15], s21 offen  lds
  ds_read_b128 v[40:43], v10 offset:38912
  v_mfma_f32_16x16x32_bf16 a[44:47], v[52:55], v[88:91], a[44:47]
  ds_read_b64_tr_b16 v[72:73], v17 offset:49152
  v_mfma_f32_16x16x32_bf16 a[48:51], v[56:59], v[76:79], a[48:51]
  ds_read_b64_tr_b16 v[74:75], v17 offset:50176
  s_add_u32 m0, s52, 2048
  v_mfma_f32_16x16x32_bf16 a[52:55], v[56:59], v[80:83], a[52:55]
  buffer_load_dwordx4 v4, s[8:11], s20 offen  lds
  v_mfma_f32_16x16x32_bf16 a[56:59], v[56:59], v[84:87], a[56:59]
  v_mfma_f32_16x16x32_bf16 a[60:63], v[56:59], v[88:91], a[60:63]
  s_waitcnt lgkmcnt(0)
  s_add_u32 m0, s53, 2048
  v_mfma_f32_16x16x32_bf16 a[0:3], v[28:31], v[60:63], a[0:3]
  buffer_load_dwordx4 v8, s[12:15], s21 offen  lds
  ds_read_b128 v[44:47], v11 offset:32768
  v_mfma_f32_16x16x32_bf16 a[4:7], v[28:31], v[64:67], a[4:7]
  ds_read_b64_tr_b16 v[76:77], v14 offset:57344
  v_mfma_f32_16x16x32_bf16 a[8:11], v[28:31], v[68:71], a[8:11]
  ds_read_b64_tr_b16 v[78:79], v14 offset:58368
  v_mfma_f32_16x16x32_bf16 a[12:15], v[28:31], v[72:75], a[12:15]
  ds_read_b128 v[48:51], v11 offset:34816
  s_add_u32 m0, s52, 3072
  v_mfma_f32_16x16x32_bf16 a[16:19], v[32:35], v[60:63], a[16:19]
  buffer_load_dwordx4 v5, s[8:11], s20 offen  lds
  ds_read_b64_tr_b16 v[80:81], v15 offset:57344
  v_mfma_f32_16x16x32_bf16 a[20:23], v[32:35], v[64:67], a[20:23]
  ds_read_b64_tr_b16 v[82:83], v15 offset:58368
  v_mfma_f32_16x16x32_bf16 a[24:27], v[32:35], v[68:71], a[24:27]
  ds_read_b128 v[52:55], v11 offset:36864
  v_mfma_f32_16x16x32_bf16 a[28:31], v[32:35], v[72:75], a[28:31]
  ds_read_b64_tr_b16 v[84:85], v16 offset:57344
  s_add_u32 m0, s53, 3072
  v_mfma_f32_16x16x32_bf16 a[32:35], v[36:39], v[60:63], a[32:35]
  buffer_load_dwordx4 v9, s[12:15], s21 offen  lds
  ds_read_b64_tr_b16 v[86:87], v16 offset:58368
  v_mfma_f32_16x16x32_bf16 a[36:39], v[36:39], v[64:67], a[36:39]
  ds_read_b128 v[56:59], v11 offset:38912
  v_mfma_f32_16x16x32_bf16 a[40:43], v[36:39], v[68:71], a[40:43]
  ds_read_b64_tr_b16 v[88:89], v17 offset:57344
  v_mfma_f32_16x16x32_bf16 a[44:47], v[36:39], v[72:75], a[44:47]
  ds_read_b64_tr_b16 v[90:91], v17 offset:58368
  s_add_u32 s20, s20, 128
  v_mfma_f32_16x16x32_bf16 a[48:51], v[40:43], v[60:63], a[48:51]
  s_add_u32 s21, s21, s51
  v_mfma_f32_16x16x32_bf16 a[52:55], v[40:43], v[64:67], a[52:55]
  v_mfma_f32_16x16x32_bf16 a[56:59], v[40:43], v[68:71], a[56:59]
  v_mfma_f32_16x16x32_bf16 a[60:63], v[40:43], v[72:75], a[60:63]
  s_waitcnt lgkmcnt(0)
  v_mfma_f32_16x16x32_bf16 a[0:3], v[44:47], v[76:79], a[0:3]
  s_waitcnt vmcnt(16)
  s_barrier
  s_add_u32 m0, s52, 32768
  v_mfma_f32_16x16x32_bf16 a[4:7], v[44:47], v[80:83], a[4:7]
  buffer_load_dwordx4 v2, s[8:11], s20 offen  lds
  ds_read_b128 v[28:31], v12 offset:0
  v_mfma_f32_16x16x32_bf16 a[8:11], v[44:47], v[84:87], a[8:11]
  ds_read_b64_tr_b16 v[60:61], v18 offset:16384
  v_mfma_f32_16x16x32_bf16 a[12:15], v[44:47], v[88:91], a[12:15]
  ds_read_b64_tr_b16 v[62:63], v18 offset:17408
  s_add_u32 m0, s53, 32768
  v_mfma_f32_16x16x32_bf16 a[16:19], v[48:51], v[76:79], a[16:19]
  buffer_load_dwordx4 v6, s[12:15], s21 offen  lds
  ds_read_b128 v[32:35], v12 offset:2048
  v_mfma_f32_16x16x32_bf16 a[20:23], v[48:51], v[80:83], a[20:23]
  ds_read_b64_tr_b16 v[64:65], v19 offset:16384
  v_mfma_f32_16x16x32_bf16 a[24:27], v[48:51], v[84:87], a[24:27]
  ds_read_b64_tr_b16 v[66:67], v19 offset:17408
  s_add_u32 m0, s52, 33792
  v_mfma_f32_16x16x32_bf16 a[28:31], v[48:51], v[88:91], a[28:31]
  buffer_load_dwordx4 v3, s[8:11], s20 offen  lds
  ds_read_b128 v[36:39], v12 offset:4096
  v_mfma_f32_16x16x32_bf16 a[32:35], v[52:55], v[76:79], a[32:35]
  ds_read_b64_tr_b16 v[68:69], v20 offset:16384
  v_mfma_f32_16x16x32_bf16 a[36:39], v[52:55], v[80:83], a[36:39]
  ds_read_b64_tr_b16 v[70:71], v20 offset:17408
  s_add_u32 m0, s53, 33792
  v_mfma_f32_16x16x32_bf16 a[40:43], v[52:55], v[84:87], a[40:43]
  buffer_load_dwordx4 v7, s[12:15], s21 offen  lds
  ds_read_b128 v[40:43], v12 offset:6144
  v_mfma_f32_16x16x32_bf16 a[44:47], v[52:55], v[88:91], a[44:47]
  ds_read_b64_tr_b16 v[72:73], v21 offset:16384
  v_mfma_f32_16x16x32_bf16 a[48:51], v[56:59], v[76:79], a[48:51]
  ds_read_b64_tr_b16 v[74:75], v21 offset:17408
  s_add_u32 m0, s52, 34816
  v_mfma_f32_16x16x32_bf16 a[52:55], v[56:59], v[80:83], a[52:55]
  buffer_load_dwordx4 v4, s[8:11], s20 offen  lds
  v_mfma_f32_16x16x32_bf16 a[56:59], v[56:59], v[84:87], a[56:59]
  v_mfma_f32_16x16x32_bf16 a[60:63], v[56:59], v[88:91], a[60:63]
  s_waitcnt lgkmcnt(0)
  s_add_u32 m0, s53, 34816
  v_mfma_f32_16x16x32_bf16 a[0:3], v[28:31], v[60:63], a[0:3]
  buffer_load_dwordx4 v8, s[12:15], s21 offen  lds
  ds_read_b128 v[44:47], v13 offset:0
  v_mfma_f32_16x16x32_bf16 a[4:7], v[28:31], v[64:67], a[4:7]
  ds_read_b64_tr_b16 v[76:77], v18 offset:24576
  v_mfma_f32_16x16x32_bf16 a[8:11], v[28:31], v[68:71], a[8:11]
  ds_read_b64_tr_b16 v[78:79], v18 offset:25600
  v_mfma_f32_16x16x32_bf16 a[12:15], v[28:31], v[72:75], a[12:15]
  ds_read_b128 v[48:51], v13 offset:2048
  s_add_u32 m0, s52, 35840
  v_mfma_f32_16x16x32_bf16 a[16:19], v[32:35], v[60:63], a[16:19]
  buffer_load_dwordx4 v5, s[8:11], s20 offen  lds
  ds_read_b64_tr_b16 v[80:81], v19 offset:24576
  v_mfma_f32_16x16x32_bf16 a[20:23], v[32:35], v[64:67], a[20:23]
  ds_read_b64_tr_b16 v[82:83], v19 offset:25600
  v_mfma_f32_16x16x32_bf16 a[24:27], v[32:35], v[68:71], a[24:27]
  ds_read_b128 v[52:55], v13 offset:4096
  v_mfma_f32_16x16x32_bf16 a[28:31], v[32:35], v[72:75], a[28:31]
  ds_read_b64_tr_b16 v[84:85], v20 offset:24576
  s_add_u32 m0, s53, 35840
  v_mfma_f32_16x16x32_bf16 a[32:35], v[36:39], v[60:63], a[32:35]
  buffer_load_dwordx4 v9, s[12:15], s21 offen  lds
  ds_read_b64_tr_b16 v[86:87], v20 offset:25600
  v_mfma_f32_16x16x32_bf16 a[36:39], v[36:39], v[64:67], a[36:39]
  ds_read_b128 v[56:59], v13 offset:6144
  v_mfma_f32_16x16x32_bf16 a[40:43], v[36:39], v[68:71], a[40:43]
  ds_read_b64_tr_b16 v[88:89], v21 offset:24576
  v_mfma_f32_16x16x32_bf16 a[44:47], v[36:39], v[72:75], a[44:47]
  ds_read_b64_tr_b16 v[90:91], v21 offset:25600
  s_add_u32 s20, s20, 128
  v_mfma_f32_16x16x32_bf16 a[48:51], v[40:43], v[60:63], a[48:51]
  s_add_u32 s21, s21, s51
  v_mfma_f32_16x16x32_bf16 a[52:55], v[40:43], v[64:67], a[52:55]
  v_mfma_f32_16x16x32_bf16 a[56:59], v[40:43], v[68:71], a[56:59]
  v_mfma_f32_16x16x32_bf16 a[60:63], v[40:43], v[72:75], a[60:63]
  s_waitcnt lgkmcnt(0)
  v_mfma_f32_16x16x32_bf16 a[0:3], v[44:47], v[76:79], a[0:3]
  s_waitcnt vmcnt(16)
  s_barrier
  s_add_u32 m0, s52, 65536
  v_mfma_f32_16x16x32_bf16 a[4:7], v[44:47], v[80:83], a[4:7]
  buffer_load_dwordx4 v2, s[8:11], s20 offen  lds
  ds_read_b128 v[28:31], v12 offset:32768
  v_mfma_f32_16x16x32_bf16 a[8:11], v[44:47], v[84:87], a[8:11]
  ds_read_b64_tr_b16 v[60:61], v18 offset:49152
  v_mfma_f32_16x16x32_bf16 a[12:15], v[44:47], v[88:91], a[12:15]
  ds_read_b64_tr_b16 v[62:63], v18 offset:50176
  s_add_u32 m0, s53, 65536
  v_mfma_f32_16x16x32_bf16 a[16:19], v[48:51], v[76:79], a[16:19]
  buffer_load_dwordx4 v6, s[12:15], s21 offen  lds
  ds_read_b128 v[32:35], v12 offset:34816
  v_mfma_f32_16x16x32_bf16 a[20:23], v[48:51], v[80:83], a[20:23]
  ds_read_b64_tr_b16 v[64:65], v19 offset:49152
  v_mfma_f32_16x16x32_bf16 a[24:27], v[48:51], v[84:87], a[24:27]
  ds_read_b64_tr_b16 v[66:67], v19 offset:50176
  s_add_u32 m0, s52, 66560
  v_mfma_f32_16x16x32_bf16 a[28:31], v[48:51], v[88:91], a[28:31]
  buffer_load_dwordx4 v3, s[8:11], s20 offen  lds
  ds_read_b128 v[36:39], v12 offset:36864
  v_mfma_f32_16x16x32_bf16 a[32:35], v[52:55], v[76:79], a[32:35]
  ds_read_b64_tr_b16 v[68:69], v20 offset:49152
  v_mfma_f32_16x16x32_bf16 a[36:39], v[52:55], v[80:83], a[36:39]
  ds_read_b64_tr_b16 v[70:71], v20 offset:50176
  s_add_u32 m0, s53, 66560
  v_mfma_f32_16x16x32_bf16 a[40:43], v[52:55], v[84:87], a[40:43]
  buffer_load_dwordx4 v7, s[12:15], s21 offen  lds
  ds_read_b128 v[40:43], v12 offset:38912
  v_mfma_f32_16x16x32_bf16 a[44:47], v[52:55], v[88:91], a[44:47]
  ds_read_b64_tr_b16 v[72:73], v21 offset:49152
  v_mfma_f32_16x16x32_bf16 a[48:51], v[56:59], v[76:79], a[48:51]
  ds_read_b64_tr_b16 v[74:75], v21 offset:50176
  s_add_u32 m0, s52, 67584
  v_mfma_f32_16x16x32_bf16 a[52:55], v[56:59], v[80:83], a[52:55]
  buffer_load_dwordx4 v4, s[8:11], s20 offen  lds
  v_mfma_f32_16x16x32_bf16 a[56:59], v[56:59], v[84:87], a[56:59]
  v_mfma_f32_16x16x32_bf16 a[60:63], v[56:59], v[88:91], a[60:63]
  s_waitcnt lgkmcnt(0)
  s_add_u32 m0, s53, 67584
  v_mfma_f32_16x16x32_bf16 a[0:3], v[28:31], v[60:63], a[0:3]
  buffer_load_dwordx4 v8, s[12:15], s21 offen  lds
  ds_read_b128 v[44:47], v13 offset:32768
  v_mfma_f32_16x16x32_bf16 a[4:7], v[28:31], v[64:67], a[4:7]
  ds_read_b64_tr_b16 v[76:77], v18 offset:57344
  v_mfma_f32_16x16x32_bf16 a[8:11], v[28:31], v[68:71], a[8:11]
  ds_read_b64_tr_b16 v[78:79], v18 offset:58368
  v_mfma_f32_16x16x32_bf16 a[12:15], v[28:31], v[72:75], a[12:15]
  ds_read_b128 v[48:51], v13 offset:34816
  s_add_u32 m0, s52, 68608
  v_mfma_f32_16x16x32_bf16 a[16:19], v[32:35], v[60:63], a[16:19]
  buffer_load_dwordx4 v5, s[8:11], s20 offen  lds
  ds_read_b64_tr_b16 v[80:81], v19 offset:57344
  v_mfma_f32_16x16x32_bf16 a[20:23], v[32:35], v[64:67], a[20:23]
  ds_read_b64_tr_b16 v[82:83], v19 offset:58368
  v_mfma_f32_16x16x32_bf16 a[24:27], v[32:35], v[68:71], a[24:27]
  ds_read_b128 v[52:55], v13 offset:36864
  v_mfma_f32_16x16x32_bf16 a[28:31], v[32:35], v[72:75], a[28:31]
  ds_read_b64_tr_b16 v[84:85], v20 offset:57344
  s_add_u32 m0, s53, 68608
  v_mfma_f32_16x16x32_bf16 a[32:35], v[36:39], v[60:63], a[32:35]
  buffer_load_dwordx4 v9, s[12:15], s21 offen  lds
  ds_read_b64_tr_b16 v[86:87], v20 offset:58368
  v_mfma_f32_16x16x32_bf16 a[36:39], v[36:39], v[64:67], a[36:39]
  ds_read_b128 v[56:59], v13 offset:38912
  v_mfma_f32_16x16x32_bf16 a[40:43], v[36:39], v[68:71], a[40:43]
  ds_read_b64_tr_b16 v[88:89], v21 offset:57344
  v_mfma_f32_16x16x32_bf16 a[44:47], v[36:39], v[72:75], a[44:47]
  ds_read_b64_tr_b16 v[90:91], v21 offset:58368
  s_add_u32 s20, s20, 128
  v_mfma_f32_16x16x32_bf16 a[48:51], v[40:43], v[60:63], a[48:51]
  s_add_u32 s21, s21, s51
  v_mfma_f32_16x16x32_bf16 a[52:55], v[40:43], v[64:67], a[52:55]
  v_mfma_f32_16x16x32_bf16 a[56:59], v[40:43], v[68:71], a[56:59]
  v_mfma_f32_16x16x32_bf16 a[60:63], v[40:43], v[72:75], a[60:63]
  s_waitcnt lgkmcnt(0)
  v_mfma_f32_16x16x32_bf16 a[0:3], v[44:47], v[76:79], a[0:3]
  s_waitcnt vmcnt(16)
  s_barrier
  s_add_u32 m0, s52, 98304
  v_mfma_f32_16x16x32_bf16 a[4:7], v[44:47], v[80:83], a[4:7]
  buffer_load_dwordx4 v2, s[8:11], s20 offen  lds
  ds_read_b128 v[28:31], v10 offset:0
  v_mfma_f32_16x16x32_bf16 a[8:11], v[44:47], v[84:87], a[8:11]
  ds_read_b64_tr_b16 v[60:61], v14 offset:16384
  v_mfma_f32_16x16x32_bf16 a[12:15], v[44:47], v[88:91], a[12:15]
  ds_read_b64_tr_b16 v[62:63], v14 offset:17408
  s_add_u32 m0, s53, 98304
  v_mfma_f32_16x16x32_bf16 a[16:19], v[48:51], v[76:79], a[16:19]
  buffer_load_dwordx4 v6, s[12:15], s21 offen  lds
  ds_read_b128 v[32:35], v10 offset:2048
  v_mfma_f32_16x16x32_bf16 a[20:23], v[48:51], v[80:83], a[20:23]
  ds_read_b64_tr_b16 v[64:65], v15 offset:16384
  v_mfma_f32_16x16x32_bf16 a[24:27], v[48:51], v[84:87], a[24:27]
  ds_read_b64_tr_b16 v[66:67], v15 offset:17408
  s_add_u32 m0, s52, 99328
  v_mfma_f32_16x16x32_bf16 a[28:31], v[48:51], v[88:91], a[28:31]
  buffer_load_dwordx4 v3, s[8:11], s20 offen  lds
  ds_read_b128 v[36:39], v10 offset:4096
  v_mfma_f32_16x16x32_bf16 a[32:35], v[52:55], v[76:79], a[32:35]
  ds_read_b64_tr_b16 v[68:69], v16 offset:16384
  v_mfma_f32_16x16x32_bf16 a[36:39], v[52:55], v[80:83], a[36:39]
  ds_read_b64_tr_b16 v[70:71], v16 offset:17408
  s_add_u32 m0, s53, 99328
  v_mfma_f32_16x16x32_bf16 a[40:43], v[52:55], v[84:87], a[40:43]
  buffer_load_dwordx4 v7, s[12:15], s21 offen  lds
  ds_read_b128 v[40:43], v10 offset:6144
  v_mfma_f32_16x16x32_bf16 a[44:47], v[52:55], v[88:91], a[44:47]
  ds_read_b64_tr_b16 v[72:73], v17 offset:16384
  v_mfma_f32_16x16x32_bf16 a[48:51], v[56:59], v[76:79], a[48:51]
  ds_read_b64_tr_b16 v[74:75], v17 offset:17408
  s_add_u32 m0, s52, 100352
  v_mfma_f32_16x16x32_bf16 a[52:55], v[56:59], v[80:83], a[52:55]
  buffer_load_dwordx4 v4, s[8:11], s20 offen  lds
  v_mfma_f32_16x16x32_bf16 a[56:59], v[56:59], v[84:87], a[56:59]
  v_mfma_f32_16x16x32_bf16 a[60:63], v[56:59], v[88:91], a[60:63]
  s_branch L_g5_loop
L_g5_fin:
  s_cmp_lg_u32 s32, 0
  s_cbranch_scc1 L_rq_85
  s_cmp_eq_u32 s39, 0
  s_cbranch_scc1 L_rq_85
  s_lshl_b32 s99, s33, 7
  s_add_u32 s99, s99, 0x3d00200
  v_mov_b32 v244, 1
  v_mov_b32 v245, 0
  s_mov_b64 exec, 1
  buffer_atomic_add v244, v245, s[4:7], s99 offen sc0 sc1
  s_mov_b64 exec, -1
L_rq_85:
  s_waitcnt lgkmcnt(0)
  s_add_u32 m0, s53, 100352
  v_mfma_f32_16x16x32_bf16 a[0:3], v[28:31], v[60:63], a[0:3]
  buffer_load_dwordx4 v8, s[12:15], s21 offen  lds
  ds_read_b128 v[44:47], v11 offset:0
  v_mfma_f32_16x16x32_bf16 a[4:7], v[28:31], v[64:67], a[4:7]
  ds_read_b64_tr_b16 v[76:77], v14 offset:24576
  v_mfma_f32_16x16x32_bf16 a[8:11], v[28:31], v[68:71], a[8:11]
  ds_read_b64_tr_b16 v[78:79], v14 offset:25600
  v_mfma_f32_16x16x32_bf16 a[12:15], v[28:31], v[72:75], a[12:15]
  ds_read_b128 v[48:51], v11 offset:2048
  s_add_u32 m0, s52, 101376
  v_mfma_f32_16x16x32_bf16 a[16:19], v[32:35], v[60:63], a[16:19]
  buffer_load_dwordx4 v5, s[8:11], s20 offen  lds
  ds_read_b64_tr_b16 v[80:81], v15 offset:24576
  v_mfma_f32_16x16x32_bf16 a[20:23], v[32:35], v[64:67], a[20:23]
  ds_read_b64_tr_b16 v[82:83], v15 offset:25600
  v_mfma_f32_16x16x32_bf16 a[24:27], v[32:35], v[68:71], a[24:27]
  ds_read_b128 v[52:55], v11 offset:4096
  v_mfma_f32_16x16x32_bf16 a[28:31], v[32:35], v[72:75], a[28:31]
  ds_read_b64_tr_b16 v[84:85], v16 offset:24576
  s_add_u32 m0, s53, 101376
  v_mfma_f32_16x16x32_bf16 a[32:35], v[36:39], v[60:63], a[32:35]
  buffer_load_dwordx4 v9, s[12:15], s21 offen  lds
  ds_read_b64_tr_b16 v[86:87], v16 offset:25600
  v_mfma_f32_16x16x32_bf16 a[36:39], v[36:39], v[64:67], a[36:39]
  ds_read_b128 v[56:59], v11 offset:6144
  v_mfma_f32_16x16x32_bf16 a[40:43], v[36:39], v[68:71], a[40:43]
  ds_read_b64_tr_b16 v[88:89], v17 offset:24576
  v_mfma_f32_16x16x32_bf16 a[44:47], v[36:39], v[72:75], a[44:47]
  ds_read_b64_tr_b16 v[90:91], v17 offset:25600
  s_add_u32 s20, s20, 128
  v_mfma_f32_16x16x32_bf16 a[48:51], v[40:43], v[60:63], a[48:51]
  s_add_u32 s21, s21, s51
  v_mfma_f32_16x16x32_bf16 a[52:55], v[40:43], v[64:67], a[52:55]
  v_mfma_f32_16x16x32_bf16 a[56:59], v[40:43], v[68:71], a[56:59]
  v_mfma_f32_16x16x32_bf16 a[60:63], v[40:43], v[72:75], a[60:63]
  s_waitcnt lgkmcnt(0)
  v_mfma_f32_16x16x32_bf16 a[0:3], v[44:47], v[76:79], a[0:3]
  s_waitcnt vmcnt(16)
  s_barrier
  v_mfma_f32_16x16x32_bf16 a[4:7], v[44:47], v[80:83], a[4:7]
  ds_read_b128 v[28:31], v10 offset:32768
  v_mfma_f32_16x16x32_bf16 a[8:11], v[44:47], v[84:87], a[8:11]
  ds_read_b64_tr_b16 v[60:61], v14 offset:49152
  v_mfma_f32_16x16x32_bf16 a[12:15], v[44:47], v[88:91], a[12:15]
  ds_read_b64_tr_b16 v[62:63], v14 offset:50176
  v_mfma_f32_16x16x32_bf16 a[16:19], v[48:51], v[76:79], a[16:19]
  ds_read_b128 v[32:35], v10 offset:34816
  v_mfma_f32_16x16x32_bf16 a[20:23], v[48:51], v[80:83], a[20:23]
  ds_read_b64_tr_b16 v[64:65], v15 offset:49152
  v_mfma_f32_16x16x32_bf16 a[24:27], v[48:51], v[84:87], a[24:27]
  ds_read_b64_tr_b16 v[66:67], v15 offset:50176
  v_mfma_f32_16x16x32_bf16 a[28:31], v[48:51], v[88:91], a[28:31]
  ds_read_b128 v[36:39], v10 offset:36864
  v_mfma_f32_16x16x32_bf16 a[32:35], v[52:55], v[76:79], a[32:35]
  ds_read_b64_tr_b16 v[68:69], v16 offset:49152
  v_mfma_f32_16x16x32_bf16 a[36:39], v[52:55], v[80:83], a[36:39]
  ds_read_b64_tr_b16 v[70:71], v16 offset:50176
  v_mfma_f32_16x16x32_bf16 a[40:43], v[52:55], v[84:87], a[40:43]
  ds_read_b128 v[40:43], v10 offset:38912
  v_mfma_f32_16x16x32_bf16 a[44:47], v[52:55], v[88:91], a[44:47]
  ds_read_b64_tr_b16 v[72:73], v17 offset:49152
  v_mfma_f32_16x16x32_bf16 a[48:51], v[56:59], v[76:79], a[48:51]
  ds_read_b64_tr_b16 v[74:75], v17 offset:50176
  v_mfma_f32_16x16x32_bf16 a[52:55], v[56:59], v[80:83], a[52:55]
  v_mfma_f32_16x16x32_bf16 a[56:59], v[56:59], v[84:87], a[56:59]
  v_mfma_f32_16x16x32_bf16 a[60:63], v[56:59], v[88:91], a[60:63]
  s_waitcnt lgkmcnt(0)
  v_mfma_f32_16x16x32_bf16 a[0:3], v[28:31], v[60:63], a[0:3]
  ds_read_b128 v[44:47], v11 offset:32768
  v_mfma_f32_16x16x32_bf16 a[4:7], v[28:31], v[64:67], a[4:7]
  ds_read_b64_tr_b16 v[76:77], v14 offset:57344
  v_mfma_f32_16x16x32_bf16 a[8:11], v[28:31], v[68:71], a[8:11]
  ds_read_b64_tr_b16 v[78:79], v14 offset:58368
  v_mfma_f32_16x16x32_bf16 a[12:15], v[28:31], v[72:75], a[12:15]
  ds_read_b128 v[48:51], v11 offset:34816
  v_mfma_f32_16x16x32_bf16 a[16:19], v[32:35], v[60:63], a[16:19]
  ds_read_b64_tr_b16 v[80:81], v15 offset:57344
  v_mfma_f32_16x16x32_bf16 a[20:23], v[32:35], v[64:67], a[20:23]
  ds_read_b64_tr_b16 v[82:83], v15 offset:58368
  v_mfma_f32_16x16x32_bf16 a[24:27], v[32:35], v[68:71], a[24:27]
  ds_read_b128 v[52:55], v11 offset:36864
  v_mfma_f32_16x16x32_bf16 a[28:31], v[32:35], v[72:75], a[28:31]
  ds_read_b64_tr_b16 v[84:85], v16 offset:57344
  v_mfma_f32_16x16x32_bf16 a[32:35], v[36:39], v[60:63], a[32:35]
  ds_read_b64_tr_b16 v[86:87], v16 offset:58368
  v_mfma_f32_16x16x32_bf16 a[36:39], v[36:39], v[64:67], a[36:39]
  ds_read_b128 v[56:59], v11 offset:38912
  v_mfma_f32_16x16x32_bf16 a[40:43], v[36:39], v[68:71], a[40:43]
  ds_read_b64_tr_b16 v[88:89], v17 offset:57344
  v_mfma_f32_16x16x32_bf16 a[44:47], v[36:39], v[72:75], a[44:47]
  ds_read_b64_tr_b16 v[90:91], v17 offset:58368
  v_mfma_f32_16x16x32_bf16 a[48:51], v[40:43], v[60:63], a[48:51]
  v_mfma_f32_16x16x32_bf16 a[52:55], v[40:43], v[64:67], a[52:55]
  v_mfma_f32_16x16x32_bf16 a[56:59], v[40:43], v[68:71], a[56:59]
  v_mfma_f32_16x16x32_bf16 a[60:63], v[40:43], v[72:75], a[60:63]
  s_waitcnt lgkmcnt(0)
  v_mfma_f32_16x16x32_bf16 a[0:3], v[44:47], v[76:79], a[0:3]
  s_waitcnt vmcnt(8)
  s_barrier
  v_mfma_f32_16x16x32_bf16 a[4:7], v[44:47], v[80:83], a[4:7]
  ds_read_b128 v[28:31], v12 offset:0
  v_mfma_f32_16x16x32_bf16 a[8:11], v[44:47], v[84:87], a[8:11]
  ds_read_b64_tr_b16 v[60:61], v18 offset:16384
  v_mfma_f32_16x16x32_bf16 a[12:15], v[44:47], v[88:91], a[12:15]
  ds_read_b64_tr_b16 v[62:63], v18 offset:17408
  v_mfma_f32_16x16x32_bf16 a[16:19], v[48:51], v[76:79], a[16:19]
  ds_read_b128 v[32:35], v12 offset:2048
  v_mfma_f32_16x16x32_bf16 a[20:23], v[48:51], v[80:83], a[20:23]
  ds_read_b64_tr_b16 v[64:65], v19 offset:16384
  v_mfma_f32_16x16x32_bf16 a[24:27], v[48:51], v[84:87], a[24:27]
  ds_read_b64_tr_b16 v[66:67], v19 offset:17408
  v_mfma_f32_16x16x32_bf16 a[28:31], v[48:51], v[88:91], a[28:31]
  ds_read_b128 v[36:39], v12 offset:4096
  v_mfma_f32_16x16x32_bf16 a[32:35], v[52:55], v[76:79], a[32:35]
  ds_read_b64_tr_b16 v[68:69], v20 offset:16384
  v_mfma_f32_16x16x32_bf16 a[36:39], v[52:55], v[80:83], a[36:39]
  ds_read_b64_tr_b16 v[70:71], v20 offset:17408
  v_mfma_f32_16x16x32_bf16 a[40:43], v[52:55], v[84:87], a[40:43]
  ds_read_b128 v[40:43], v12 offset:6144
  v_mfma_f32_16x16x32_bf16 a[44:47], v[52:55], v[88:91], a[44:47]
  ds_read_b64_tr_b16 v[72:73], v21 offset:16384
  v_mfma_f32_16x16x32_bf16 a[48:51], v[56:59], v[76:79], a[48:51]
  ds_read_b64_tr_b16 v[74:75], v21 offset:17408
  v_mfma_f32_16x16x32_bf16 a[52:55], v[56:59], v[80:83], a[52:55]
  v_mfma_f32_16x16x32_bf16 a[56:59], v[56:59], v[84:87], a[56:59]
  v_mfma_f32_16x16x32_bf16 a[60:63], v[56:59], v[88:91], a[60:63]
  s_waitcnt lgkmcnt(0)
  v_mfma_f32_16x16x32_bf16 a[0:3], v[28:31], v[60:63], a[0:3]
  ds_read_b128 v[44:47], v13 offset:0
  v_mfma_f32_16x16x32_bf16 a[4:7], v[28:31], v[64:67], a[4:7]
  ds_read_b64_tr_b16 v[76:77], v18 offset:24576
  v_mfma_f32_16x16x32_bf16 a[8:11], v[28:31], v[68:71], a[8:11]
  ds_read_b64_tr_b16 v[78:79], v18 offset:25600
  v_mfma_f32_16x16x32_bf16 a[12:15], v[28:31], v[72:75], a[12:15]
  ds_read_b128 v[48:51], v13 offset:2048
  v_mfma_f32_16x16x32_bf16 a[16:19], v[32:35], v[60:63], a[16:19]
  ds_read_b64_tr_b16 v[80:81], v19 offset:24576
  v_mfma_f32_16x16x32_bf16 a[20:23], v[32:35], v[64:67], a[20:23]
  ds_read_b64_tr_b16 v[82:83], v19 offset:25600
  v_mfma_f32_16x16x32_bf16 a[24:27], v[32:35], v[68:71], a[24:27]
  ds_read_b128 v[52:55], v13 offset:4096
  v_mfma_f32_16x16x32_bf16 a[28:31], v[32:35], v[72:75], a[28:31]
  ds_read_b64_tr_b16 v[84:85], v20 offset:24576
  v_mfma_f32_16x16x32_bf16 a[32:35], v[36:39], v[60:63], a[32:35]
  ds_read_b64_tr_b16 v[86:87], v20 offset:25600
  v_mfma_f32_16x16x32_bf16 a[36:39], v[36:39], v[64:67], a[36:39]
  ds_read_b128 v[56:59], v13 offset:6144
  v_mfma_f32_16x16x32_bf16 a[40:43], v[36:39], v[68:71], a[40:43]
  ds_read_b64_tr_b16 v[88:89], v21 offset:24576
  v_mfma_f32_16x16x32_bf16 a[44:47], v[36:39], v[72:75], a[44:47]
  ds_read_b64_tr_b16 v[90:91], v21 offset:25600
  v_mfma_f32_16x16x32_bf16 a[48:51], v[40:43], v[60:63], a[48:51]
  v_mfma_f32_16x16x32_bf16 a[52:55], v[40:43], v[64:67], a[52:55]
  v_mfma_f32_16x16x32_bf16 a[56:59], v[40:43], v[68:71], a[56:59]
  v_mfma_f32_16x16x32_bf16 a[60:63], v[40:43], v[72:75], a[60:63]
  s_waitcnt lgkmcnt(0)
  v_mfma_f32_16x16x32_bf16 a[0:3], v[44:47], v[76:79], a[0:3]
  s_waitcnt vmcnt(0)
  s_barrier
  v_mfma_f32_16x16x32_bf16 a[4:7], v[44:47], v[80:83], a[4:7]
  ds_read_b128 v[28:31], v12 offset:32768
  v_mfma_f32_16x16x32_bf16 a[8:11], v[44:47], v[84:87], a[8:11]
  ds_read_b64_tr_b16 v[60:61], v18 offset:49152
  v_mfma_f32_16x16x32_bf16 a[12:15], v[44:47], v[88:91], a[12:15]
  ds_read_b64_tr_b16 v[62:63], v18 offset:50176
  v_mfma_f32_16x16x32_bf16 a[16:19], v[48:51], v[76:79], a[16:19]
  ds_read_b128 v[32:35], v12 offset:34816
  v_mfma_f32_16x16x32_bf16 a[20:23], v[48:51], v[80:83], a[20:23]
  ds_read_b64_tr_b16 v[64:65], v19 offset:49152
  v_mfma_f32_16x16x32_bf16 a[24:27], v[48:51], v[84:87], a[24:27]
  ds_read_b64_tr_b16 v[66:67], v19 offset:50176
  v_mfma_f32_16x16x32_bf16 a[28:31], v[48:51], v[88:91], a[28:31]
  ds_read_b128 v[36:39], v12 offset:36864
  v_mfma_f32_16x16x32_bf16 a[32:35], v[52:55], v[76:79], a[32:35]
  ds_read_b64_tr_b16 v[68:69], v20 offset:49152
  v_mfma_f32_16x16x32_bf16 a[36:39], v[52:55], v[80:83], a[36:39]
  ds_read_b64_tr_b16 v[70:71], v20 offset:50176
  v_mfma_f32_16x16x32_bf16 a[40:43], v[52:55], v[84:87], a[40:43]
  ds_read_b128 v[40:43], v12 offset:38912
  v_mfma_f32_16x16x32_bf16 a[44:47], v[52:55], v[88:91], a[44:47]
  ds_read_b64_tr_b16 v[72:73], v21 offset:49152
  v_mfma_f32_16x16x32_bf16 a[48:51], v[56:59], v[76:79], a[48:51]
  ds_read_b64_tr_b16 v[74:75], v21 offset:50176
  v_mfma_f32_16x16x32_bf16 a[52:55], v[56:59], v[80:83], a[52:55]
  v_mfma_f32_16x16x32_bf16 a[56:59], v[56:59], v[84:87], a[56:59]
  v_mfma_f32_16x16x32_bf16 a[60:63], v[56:59], v[88:91], a[60:63]
  s_waitcnt lgkmcnt(0)
  v_mfma_f32_16x16x32_bf16 a[0:3], v[28:31], v[60:63], a[0:3]
  ds_read_b128 v[44:47], v13 offset:32768
  v_mfma_f32_16x16x32_bf16 a[4:7], v[28:31], v[64:67], a[4:7]
  ds_read_b64_tr_b16 v[76:77], v18 offset:57344
  v_mfma_f32_16x16x32_bf16 a[8:11], v[28:31], v[68:71], a[8:11]
  ds_read_b64_tr_b16 v[78:79], v18 offset:58368
  v_mfma_f32_16x16x32_bf16 a[12:15], v[28:31], v[72:75], a[12:15]
  ds_read_b128 v[48:51], v13 offset:34816
  v_mfma_f32_16x16x32_bf16 a[16:19], v[32:35], v[60:63], a[16:19]
  ds_read_b64_tr_b16 v[80:81], v19 offset:57344
  v_mfma_f32_16x16x32_bf16 a[20:23], v[32:35], v[64:67], a[20:23]
  ds_read_b64_tr_b16 v[82:83], v19 offset:58368
  v_mfma_f32_16x16x32_bf16 a[24:27], v[32:35], v[68:71], a[24:27]
  ds_read_b128 v[52:55], v13 offset:36864
  v_mfma_f32_16x16x32_bf16 a[28:31], v[32:35], v[72:75], a[28:31]
  ds_read_b64_tr_b16 v[84:85], v20 offset:57344
  v_mfma_f32_16x16x32_bf16 a[32:35], v[36:39], v[60:63], a[32:35]
  ds_read_b64_tr_b16 v[86:87], v20 offset:58368
  v_mfma_f32_16x16x32_bf16 a[36:39], v[36:39], v[64:67], a[36:39]
  ds_read_b128 v[56:59], v13 offset:38912
  v_mfma_f32_16x16x32_bf16 a[40:43], v[36:39], v[68:71], a[40:43]
  ds_read_b64_tr_b16 v[88:89], v21 offset:57344
  v_mfma_f32_16x16x32_bf16 a[44:47], v[36:39], v[72:75], a[44:47]
  ds_read_b64_tr_b16 v[90:91], v21 offset:58368
  v_mfma_f32_16x16x32_bf16 a[48:51], v[40:43], v[60:63], a[48:51]
  v_mfma_f32_16x16x32_bf16 a[52:55], v[40:43], v[64:67], a[52:55]
  v_mfma_f32_16x16x32_bf16 a[56:59], v[40:43], v[68:71], a[56:59]
  v_mfma_f32_16x16x32_bf16 a[60:63], v[40:43], v[72:75], a[60:63]
  s_waitcnt lgkmcnt(0)
  v_mfma_f32_16x16x32_bf16 a[0:3], v[44:47], v[76:79], a[0:3]
  v_mfma_f32_16x16x32_bf16 a[4:7], v[44:47], v[80:83], a[4:7]
  v_mfma_f32_16x16x32_bf16 a[8:11], v[44:47], v[84:87], a[8:11]
  v_mfma_f32_16x16x32_bf16 a[12:15], v[44:47], v[88:91], a[12:15]
  v_mfma_f32_16x16x32_bf16 a[16:19], v[48:51], v[76:79], a[16:19]
  v_mfma_f32_16x16x32_bf16 a[20:23], v[48:51], v[80:83], a[20:23]
  v_mfma_f32_16x16x32_bf16 a[24:27], v[48:51], v[84:87], a[24:27]
  v_mfma_f32_16x16x32_bf16 a[28:31], v[48:51], v[88:91], a[28:31]
  v_mfma_f32_16x16x32_bf16 a[32:35], v[52:55], v[76:79], a[32:35]
  v_mfma_f32_16x16x32_bf16 a[36:39], v[52:55], v[80:83], a[36:39]
  v_mfma_f32_16x16x32_bf16 a[40:43], v[52:55], v[84:87], a[40:43]
  v_mfma_f32_16x16x32_bf16 a[44:47], v[52:55], v[88:91], a[44:47]
  v_mfma_f32_16x16x32_bf16 a[48:51], v[56:59], v[76:79], a[48:51]
  v_mfma_f32_16x16x32_bf16 a[52:55], v[56:59], v[80:83], a[52:55]
  v_mfma_f32_16x16x32_bf16 a[56:59], v[56:59], v[84:87], a[56:59]
  v_mfma_f32_16x16x32_bf16 a[60:63], v[56:59], v[88:91], a[60:63]
  s_mov_b32 s59, 4
  s_mov_b32 s60, s22
  s_mov_b32 s61, s26
  s_add_u32 s62, s38, 0x3d00000
  s_mov_b32 s63, s98
  s_cmp_lg_u32 s39, 0
  s_cbranch_scc1 L_got
  s_mov_b32 s58, 3
  s_branch L_epi
L_swp:
  s_barrier
  v_and_b32 v1, 63, v0
  v_lshlrev_b32 v2, 7, v1
  s_lshl_b32 s40, s36, 2
  s_add_u32 s40, s40, s33
  s_lshl_b32 s40, s40, 2
  s_add_u32 s40, s40, s32
  s_lshl_b32 s40, s40, 13
  s_mov_b32 s44, s78
  s_and_b32 s45, s79, 0xffff
  s_mov_b32 s46, 0x400000
  s_mov_b32 s47, 0x20000
  s_mov_b32 s41, s40
  buffer_load_dword v4, v2, s[44:47], s41 offen
  s_add_u32 s41, s41, 524288
  buffer_load_dword v5, v2, s[44:47], s41 offen
  s_add_u32 s41, s41, 524288
  buffer_load_dword v6, v2, s[44:47], s41 offen
  s_add_u32 s41, s41, 524288
  buffer_load_dword v7, v2, s[44:47], s41 offen
  s_add_u32 s41, s41, 524288
  buffer_load_dword v8, v2, s[44:47], s41 offen
  s_add_u32 s41, s41, 524288
  buffer_load_dword v9, v2, s[44:47], s41 offen
  s_add_u32 s41, s41, 524288
  buffer_load_dword v10, v2, s[44:47], s41 offen
  s_add_u32 s41, s41, 524288
  buffer_load_dword v11, v2, s[44:47], s41 offen
  s_add_u32 s41, s41, 524288
  s_mov_b32 s44, s80
  s_and_b32 s45, s81, 0xffff
  s_mov_b32 s46, 0x600000
  s_mov_b32 s47, 0x20000
  s_mov_b32 s41, s40
  buffer_load_dword v4, v2, s[44:47], s41 offen
  s_add_u32 s41, s41, 524288
  buffer_load_dword v5, v2, s[44:47], s41 offen
  s_add_u32 s41, s41, 524288
  buffer_load_dword v6, v2, s[44:47], s41 offen
  s_add_u32 s41, s41, 524288
  buffer_load_dword v7, v2, s[44:47], s41 offen
  s_add_u32 s41, s41, 524288
  buffer_load_dword v8, v2, s[44:47], s41 offen
  s_add_u32 s41, s41, 524288
  buffer_load_dword v9, v2, s[44:47], s41 offen
  s_add_u32 s41, s41, 524288
  buffer_load_dword v10, v2, s[44:47], s41 offen
  s_add_u32 s41, s41, 524288
  buffer_load_dword v11, v2, s[44:47], s41 offen
  s_add_u32 s41, s41, 524288
  buffer_load_dword v12, v2, s[44:47], s41 offen
  s_add_u32 s41, s41, 524288
  buffer_load_dword v13, v2, s[44:47], s41 offen
  s_add_u32 s41, s41, 524288
  buffer_load_dword v14, v2, s[44:47], s41 offen
  s_add_u32 s41, s41, 524288
  buffer_load_dword v15, v2, s[44:47], s41 offen
  s_add_u32 s41, s41, 524288
  s_mov_b32 s44, s82
  s_and_b32 s45, s83, 0xffff
  s_mov_b32 s46, 0x200000
  s_mov_b32 s47, 0x20000
  s_mov_b32 s41, s40
  buffer_load_dword v4, v2, s[44:47], s41 offen
  s_add_u32 s41, s41, 524288
  buffer_load_dword v5, v2, s[44:47], s41 offen
  s_add_u32 s41, s41, 524288
  buffer_load_dword v6, v2, s[44:47], s41 offen
  s_add_u32 s41, s41, 524288
  buffer_load_dword v7, v2, s[44:47], s41 offen
  s_add_u32 s41, s41, 524288
  s_branch L_next
L_atb:
  s_lshl_b32 s90, s33, 7
  s_lshl_b32 s40, s36, 9
  s_add_u32 s40, s40, s90
  s_max_u32 s41, s36, 1
  s_sub_u32 s41, s41, 1
  s_lshl_b32 s41, s41, 9
  s_add_u32 s41, s41, s90
  s_cmp_lg_u32 s32, 0
  s_cbranch_scc1 L_dd_87
  v_mov_b32 v228, 0x3d00000
  v_mov_b32 v231, 0x3d03000
L_dw_86:
  buffer_load_dword v234, v231, s[4:7], s40 offen offset:0 sc1
  buffer_load_dword v235, v231, s[4:7], s41 offen offset:0 sc1
  s_waitcnt vmcnt(0)
  s_mov_b32 s44, 1
  v_readfirstlane_b32 s45, v234
  s_cmp_ge_u32 s45, 3
  s_cselect_b32 s44, s44, 0
  v_readfirstlane_b32 s45, v235
  s_cmp_ge_u32 s45, 3
  s_cselect_b32 s44, s44, 0
  s_cmp_eq_u32 s44, 1
  s_cbranch_scc1 L_dd_87
  s_sleep 6
  s_add_u32 s3, s3, 1
  s_cmp_lt_u32 s3, 131072
  s_cbranch_scc1 L_dw_86
L_dd_87:
  s_barrier
  s_lshl_b32 s38, s36, 7
  s_add_u32 s38, s38, 1024
  s_lshl_b32 s46, s36, 3
  s_lshl_b32 s90, s37, 1
  s_add_u32 s99, s46, s90
  s_lshr_b32 s90, s32, 1
  s_add_u32 s99, s99, s90
  s_lshl_b32 s99, s99, 3
  s_lshl_b32 s90, s33, 1
  s_add_u32 s99, s99, s90
  s_and_b32 s90, s32, 1
  s_add_u32 s20, s99, s90
  v_and_b32 v1, 63, v0
  s_lshl_b32 s90, s20, 13
  s_sub_u32 s91, s90, 65536
  s_cmp_lt_u32 s20, 8
  s_cselect_b32 s91, s90, s91
  v_mov_b32 v2, 0x0
  v_bfe_u32 v7, v1, 0, 6
  v_lshl_add_u32 v2, v7, 4, v2
  v_add_u32 v3, 4096, v2
  s_add_u32 s92, s90, 67108864
  s_add_u32 s93, s90, 71303168
  s_add_u32 s94, s91, 71303168
  s_add_u32 s95, s90, 75497472
  s_add_u32 s96, s91, 75497472
  s_add_u32 s97, s90, 100663296
  buffer_load_dwordx4 v[8:11], v2, s[4:7], s92 offen offset:0 sc1
  buffer_load_dwordx4 v[12:15], v2, s[4:7], s92 offen offset:1024 sc1
  buffer_load_dwordx4 v[16:19], v2, s[4:7], s92 offen offset:2048 sc1
  buffer_load_dwordx4 v[20:23], v2, s[4:7], s92 offen offset:3072 sc1
  buffer_load_dwordx4 v[24:27], v3, s[4:7], s92 offen offset:0 sc1
  buffer_load_dwordx4 v[28:31], v3, s[4:7], s92 offen offset:1024 sc1
  buffer_load_dwordx4 v[32:35], v3, s[4:7], s92 offen offset:2048 sc1
  buffer_load_dwordx4 v[36:39], v3, s[4:7], s92 offen offset:3072 sc1
  buffer_load_dwordx4 v[40:43], v3, s[4:7], s94 offen offset:0 sc1
  buffer_load_dwordx4 v[44:47], v3, s[4:7], s94 offen offset:1024 sc1
  buffer_load_dwordx4 v[48:51], v3, s[4:7], s94 offen offset:2048 sc1
  buffer_load_dwordx4 v[52:55], v3, s[4:7], s94 offen offset:3072 sc1
  buffer_load_dwordx4 v[56:59], v2, s[4:7], s93 offen offset:0 sc1
  buffer_load_dwordx4 v[60:63], v2, s[4:7], s93 offen offset:1024 sc1
  buffer_load_dwordx4 v[64:67], v2, s[4:7], s93 offen offset:2048 sc1
  buffer_load_dwordx4 v[68:71], v2, s[4:7], s93 offen offset:3072 sc1
  buffer_load_dwordx4 v[72:75], v3, s[4:7], s93 offen offset:0 sc1
  buffer_load_dwordx4 v[76:79], v3, s[4:7], s93 offen offset:1024 sc1
  buffer_load_dwordx4 v[80:83], v3, s[4:7], s93 offen offset:2048 sc1
  buffer_load_dwordx4 v[84:87], v3, s[4:7], s93 offen offset:3072 sc1
  buffer_load_dwordx2 v[88:89], v2, s[4:7], s96 offen offset:8 sc1
  buffer_load_dwordx2 v[94:95], v2, s[4:7], s96 offen offset:1032 sc1
  buffer_load_dwordx2 v[100:101], v2, s[4:7], s96 offen offset:2056 sc1
  buffer_load_dwordx2 v[106:107], v2, s[4:7], s96 offen offset:3080 sc1
  buffer_load_dwordx2 v[112:113], v3, s[4:7], s96 offen offset:8 sc1
  buffer_load_dwordx2 v[118:119], v3, s[4:7], s96 offen offset:1032 sc1
  buffer_load_dwordx2 v[124:125], v3, s[4:7], s96 offen offset:2056 sc1
  buffer_load_dwordx2 v[130:131], v3, s[4:7], s96 offen offset:3080 sc1
  buffer_load_dwordx4 v[90:93], v2, s[4:7], s95 offen offset:0 sc1
  buffer_load_dwordx4 v[96:99], v2, s[4:7], s95 offen offset:1024 sc1
  buffer_load_dwordx4 v[102:105], v2, s[4:7], s95 offen offset:2048 sc1
  buffer_load_dwordx4 v[108:111], v2, s[4:7], s95 offen offset:3072 sc1
  buffer_load_dwordx4 v[114:117], v3, s[4:7], s95 offen offset:0 sc1
  buffer_load_dwordx4 v[120:123], v3, s[4:7], s95 offen offset:1024 sc1
  buffer_load_dwordx4 v[126:129], v3, s[4:7], s95 offen offset:2048 sc1
  buffer_load_dwordx4 v[132:135], v3, s[4:7], s95 offen offset:3072 sc1
  s_mov_b32 s40, 0x50000
  s_mov_b32 s41, 0x5550055
  s_mov_b32 s42, 0xa0000
  s_mov_b32 s43, 0xaaa00aa
  s_mov_b32 s44, 0x150001
  s_mov_b32 s45, 0x15550155
  s_mov_b32 s46, 0x2a0002
  s_mov_b32 s47, 0x2aaa02aa
  s_mov_b32 s48, 0x55505555
  s_mov_b32 s49, 0x50005500
  s_mov_b32 s50, 0xaaa0aaaa
  s_mov_b32 s51, 0xa000aa00
  s_mov_b32 s52, 0x55405554
  s_mov_b32 s53, 0x40005400
  s_mov_b32 s54, 0xaa80aaa8
  s_mov_b32 s55, 0x8000a800
  s_cmp_lt_u32 s20, 8
  s_cselect_b64 s[56:57], 0, s[40:41]
  s_cselect_b64 s[58:59], 0, s[42:43]
  s_cselect_b64 s[60:61], 0, s[44:45]
  s_cselect_b64 s[62:63], 0, s[46:47]
  s_mov_b32 s21, 0x3e8293ee
  v_mov_b32 v6, 0xcfa8965f
  s_waitcnt vmcnt(16)
  v_mfma_f32_16x16x32_bf16 v[136:139], v[40:43], v[8:11], 0
  v_mfma_f32_16x16x32_bf16 v[140:143], v[56:59], v[8:11], 0
  v_mfma_f32_16x16x32_bf16 v[144:147], v[44:47], v[12:15], 0
  v_mfma_f32_16x16x32_bf16 v[148:151], v[60:63], v[12:15], 0
  v_mfma_f32_16x16x32_bf16 v[152:155], v[48:51], v[16:19], 0
  v_mfma_f32_16x16x32_bf16 v[156:159], v[64:67], v[16:19], 0
  v_mfma_f32_16x16x32_bf16 v[160:163], v[52:55], v[20:23], 0
  v_mfma_f32_16x16x32_bf16 v[164:167], v[68:71], v[20:23], 0
  v_mfma_f32_16x16x32_bf16 v[168:171], v[56:59], v[24:27], 0
  v_mfma_f32_16x16x32_bf16 v[172:175], v[72:75], v[24:27], 0
  v_mfma_f32_16x16x32_bf16 v[176:179], v[60:63], v[28:31], 0
  v_mfma_f32_16x16x32_bf16 v[180:183], v[76:79], v[28:31], 0
  v_mfma_f32_16x16x32_bf16 v[184:187], v[64:67], v[32:35], 0
  v_mfma_f32_16x16x32_bf16 v[188:191], v[80:83], v[32:35], 0
  v_mfma_f32_16x16x32_bf16 v[192:195], v[68:71], v[36:39], 0
  v_mfma_f32_16x16x32_bf16 v[196:199], v[84:87], v[36:39], 0
  v_cndmask_b32 v136, v6, v136, s[56:57]
  v_cndmask_b32 v137, v6, v137, s[58:59]
  v_cndmask_b32 v138, v6, v138, s[60:61]
  v_cndmask_b32 v139, v6, v139, s[62:63]
  v_cndmask_b32 v140, v6, v140, s[48:49]
  v_cndmask_b32 v141, v6, v141, s[50:51]
  v_cndmask_b32 v142, v6, v142, s[52:53]
  v_cndmask_b32 v143, v6, v143, s[54:55]
  v_max3_f32 v4, v136, v137, v138
  v_max3_f32 v4, v4, v139, v140
  v_max3_f32 v4, v4, v141, v142
  v_max_f32 v4, v4, v143
  v_mov_b32 v5, v4
  s_nop 1
  v_permlane32_swap_b32 v4, v5
  v_max_f32 v4, v4, v5
  v_mov_b32 v5, v4
  s_nop 1
  v_permlane16_swap_b32 v4, v5
  v_max_f32 v4, v4, v5
  v_mul_f32 v4, s21, v4
  v_fma_f32 v136, v136, s21, -v4
  v_fma_f32 v137, v137, s21, -v4
  v_fma_f32 v138, v138, s21, -v4
  v_fma_f32 v139, v139, s21, -v4
  v_fma_f32 v140, v140, s21, -v4
  v_fma_f32 v141, v141, s21, -v4
  v_fma_f32 v142, v142, s21, -v4
  v_fma_f32 v143, v143, s21, -v4
  v_exp_f32 v136, v136
  v_exp_f32 v137, v137
  v_exp_f32 v138, v138
  v_exp_f32 v139, v139
  v_exp_f32 v140, v140
  v_exp_f32 v141, v141
  v_exp_f32 v142, v142
  v_exp_f32 v143, v143
  v_add_f32 v4, v136, v137
  v_add_f32 v4, v4, v138
  v_add_f32 v4, v4, v139
  v_add_f32 v4, v4, v140
  v_add_f32 v4, v4, v141
  v_add_f32 v4, v4, v142
  v_add_f32 v4, v4, v143
  v_mov_b32 v5, v4
  s_nop 1
  v_permlane32_swap_b32 v4, v5
  v_add_f32 v4, v4, v5
  v_mov_b32 v5, v4
  s_nop 1
  v_permlane16_swap_b32 v4, v5
  v_add_f32 v4, v4, v5
  v_rcp_f32 v4, v4
  s_nop 0
  v_mul_f32 v136, v136, v4
  v_mul_f32 v137, v137, v4
  v_mul_f32 v138, v138, v4
  v_mul_f32 v139, v139, v4
  v_mul_f32 v140, v140, v4
  v_mul_f32 v141, v141, v4
  v_mul_f32 v142, v142, v4
  v_mul_f32 v143, v143, v4
  v_cvt_pk_bf16_f32 v8, v136, v137
  v_cvt_pk_bf16_f32 v9, v138, v139
  v_cvt_pk_bf16_f32 v10, v140, v141
  v_cvt_pk_bf16_f32 v11, v142, v143
  v_cndmask_b32 v144, v6, v144, s[56:57]
  v_cndmask_b32 v145, v6, v145, s[58:59]
  v_cndmask_b32 v146, v6, v146, s[60:61]
  v_cndmask_b32 v147, v6, v147, s[62:63]
  v_cndmask_b32 v148, v6, v148, s[48:49]
  v_cndmask_b32 v149, v6, v149, s[50:51]
  v_cndmask_b32 v150, v6, v150, s[52:53]
  v_cndmask_b32 v151, v6, v151, s[54:55]
  v_max3_f32 v4, v144, v145, v146
  v_max3_f32 v4, v4, v147, v148
  v_max3_f32 v4, v4, v149, v150
  v_max_f32 v4, v4, v151
  v_mov_b32 v5, v4
  s_nop 1
  v_permlane32_swap_b32 v4, v5
  v_max_f32 v4, v4, v5
  v_mov_b32 v5, v4
  s_nop 1
  v_permlane16_swap_b32 v4, v5
  v_max_f32 v4, v4, v5
  v_mul_f32 v4, s21, v4
  v_fma_f32 v144, v144, s21, -v4
  v_fma_f32 v145, v145, s21, -v4
  v_fma_f32 v146, v146, s21, -v4
  v_fma_f32 v147, v147, s21, -v4
  v_fma_f32 v148, v148, s21, -v4
  v_fma_f32 v149, v149, s21, -v4
  v_fma_f32 v150, v150, s21, -v4
  v_fma_f32 v151, v151, s21, -v4
  v_exp_f32 v144, v144
  v_exp_f32 v145, v145
  v_exp_f32 v146, v146
  v_exp_f32 v147, v147
  v_exp_f32 v148, v148
  v_exp_f32 v149, v149
  v_exp_f32 v150, v150
  v_exp_f32 v151, v151
  v_add_f32 v4, v144, v145
  v_add_f32 v4, v4, v146
  v_add_f32 v4, v4, v147
  v_add_f32 v4, v4, v148
  v_add_f32 v4, v4, v149
  v_add_f32 v4, v4, v150
  v_add_f32 v4, v4, v151
  v_mov_b32 v5, v4
  s_nop 1
  v_permlane32_swap_b32 v4, v5
  v_add_f32 v4, v4, v5
  v_mov_b32 v5, v4
  s_nop 1
  v_permlane16_swap_b32 v4, v5
  v_add_f32 v4, v4, v5
  v_rcp_f32 v4, v4
  s_nop 0
  v_mul_f32 v144, v144, v4
  v_mul_f32 v145, v145, v4
  v_mul_f32 v146, v146, v4
  v_mul_f32 v147, v147, v4
  v_mul_f32 v148, v148, v4
  v_mul_f32 v149, v149, v4
  v_mul_f32 v150, v150, v4
  v_mul_f32 v151, v151, v4
  v_cvt_pk_bf16_f32 v12, v144, v145
  v_cvt_pk_bf16_f32 v13, v146, v147
  v_cvt_pk_bf16_f32 v14, v148, v149
  v_cvt_pk_bf16_f32 v15, v150, v151
  v_cndmask_b32 v152, v6, v152, s[56:57]
  v_cndmask_b32 v153, v6, v153, s[58:59]
  v_cndmask_b32 v154, v6, v154, s[60:61]
  v_cndmask_b32 v155, v6, v155, s[62:63]
  v_cndmask_b32 v156, v6, v156, s[48:49]
  v_cndmask_b32 v157, v6, v157, s[50:51]
  v_cndmask_b32 v158, v6, v158, s[52:53]
  v_cndmask_b32 v159, v6, v159, s[54:55]
  v_max3_f32 v4, v152, v153, v154
  v_max3_f32 v4, v4, v155, v156
  v_max3_f32 v4, v4, v157, v158
  v_max_f32 v4, v4, v159
  v_mov_b32 v5, v4
  s_nop 1
  v_permlane32_swap_b32 v4, v5
  v_max_f32 v4, v4, v5
  v_mov_b32 v5, v4
  s_nop 1
  v_permlane16_swap_b32 v4, v5
  v_max_f32 v4, v4, v5
  v_mul_f32 v4, s21, v4
  v_fma_f32 v152, v152, s21, -v4
  v_fma_f32 v153, v153, s21, -v4
  v_fma_f32 v154, v154, s21, -v4
  v_fma_f32 v155, v155, s21, -v4
  v_fma_f32 v156, v156, s21, -v4
  v_fma_f32 v157, v157, s21, -v4
  v_fma_f32 v158, v158, s21, -v4
  v_fma_f32 v159, v159, s21, -v4
  v_exp_f32 v152, v152
  v_exp_f32 v153, v153
  v_exp_f32 v154, v154
  v_exp_f32 v155, v155
  v_exp_f32 v156, v156
  v_exp_f32 v157, v157
  v_exp_f32 v158, v158
  v_exp_f32 v159, v159
  v_add_f32 v4, v152, v153
  v_add_f32 v4, v4, v154
  v_add_f32 v4, v4, v155
  v_add_f32 v4, v4, v156
  v_add_f32 v4, v4, v157
  v_add_f32 v4, v4, v158
  v_add_f32 v4, v4, v159
  v_mov_b32 v5, v4
  s_nop 1
  v_permlane32_swap_b32 v4, v5
  v_add_f32 v4, v4, v5
  v_mov_b32 v5, v4
  s_nop 1
  v_permlane16_swap_b32 v4, v5
  v_add_f32 v4, v4, v5
  v_rcp_f32 v4, v4
  s_nop 0
  v_mul_f32 v152, v152, v4
  v_mul_f32 v153, v153, v4
  v_mul_f32 v154, v154, v4
  v_mul_f32 v155, v155, v4
  v_mul_f32 v156, v156, v4
  v_mul_f32 v157, v157, v4
  v_mul_f32 v158, v158, v4
  v_mul_f32 v159, v159, v4
  v_cvt_pk_bf16_f32 v16, v152, v153
  v_cvt_pk_bf16_f32 v17, v154, v155
  v_cvt_pk_bf16_f32 v18, v156, v157
  v_cvt_pk_bf16_f32 v19, v158, v159
  v_cndmask_b32 v160, v6, v160, s[56:57]
  v_cndmask_b32 v161, v6, v161, s[58:59]
  v_cndmask_b32 v162, v6, v162, s[60:61]
  v_cndmask_b32 v163, v6, v163, s[62:63]
  v_cndmask_b32 v164, v6, v164, s[48:49]
  v_cndmask_b32 v165, v6, v165, s[50:51]
  v_cndmask_b32 v166, v6, v166, s[52:53]
  v_cndmask_b32 v167, v6, v167, s[54:55]
  v_max3_f32 v4, v160, v161, v162
  v_max3_f32 v4, v4, v163, v164
  v_max3_f32 v4, v4, v165, v166
  v_max_f32 v4, v4, v167
  v_mov_b32 v5, v4
  s_nop 1
  v_permlane32_swap_b32 v4, v5
  v_max_f32 v4, v4, v5
  v_mov_b32 v5, v4
  s_nop 1
  v_permlane16_swap_b32 v4, v5
  v_max_f32 v4, v4, v5
  v_mul_f32 v4, s21, v4
  v_fma_f32 v160, v160, s21, -v4
  v_fma_f32 v161, v161, s21, -v4
  v_fma_f32 v162, v162, s21, -v4
  v_fma_f32 v163, v163, s21, -v4
  v_fma_f32 v164, v164, s21, -v4
  v_fma_f32 v165, v165, s21, -v4
  v_fma_f32 v166, v166, s21, -v4
  v_fma_f32 v167, v167, s21, -v4
  v_exp_f32 v160, v160
  v_exp_f32 v161, v161
  v_exp_f32 v162, v162
  v_exp_f32 v163, v163
  v_exp_f32 v164, v164
  v_exp_f32 v165, v165
  v_exp_f32 v166, v166
  v_exp_f32 v167, v167
  v_add_f32 v4, v160, v161
  v_add_f32 v4, v4, v162
  v_add_f32 v4, v4, v163
  v_add_f32 v4, v4, v164
  v_add_f32 v4, v4, v165
  v_add_f32 v4, v4, v166
  v_add_f32 v4, v4, v167
  v_mov_b32 v5, v4
  s_nop 1
  v_permlane32_swap_b32 v4, v5
  v_add_f32 v4, v4, v5
  v_mov_b32 v5, v4
  s_nop 1
  v_permlane16_swap_b32 v4, v5
  v_add_f32 v4, v4, v5
  v_rcp_f32 v4, v4
  s_nop 0
  v_mul_f32 v160, v160, v4
  v_mul_f32 v161, v161, v4
  v_mul_f32 v162, v162, v4
  v_mul_f32 v163, v163, v4
  v_mul_f32 v164, v164, v4
  v_mul_f32 v165, v165, v4
  v_mul_f32 v166, v166, v4
  v_mul_f32 v167, v167, v4
  v_cvt_pk_bf16_f32 v20, v160, v161
  v_cvt_pk_bf16_f32 v21, v162, v163
  v_cvt_pk_bf16_f32 v22, v164, v165
  v_cvt_pk_bf16_f32 v23, v166, v167
  v_cndmask_b32 v168, v6, v168, s[40:41]
  v_cndmask_b32 v169, v6, v169, s[42:43]
  v_cndmask_b32 v170, v6, v170, s[44:45]
  v_cndmask_b32 v171, v6, v171, s[46:47]
  v_cndmask_b32 v172, v6, v172, s[48:49]
  v_cndmask_b32 v173, v6, v173, s[50:51]
  v_cndmask_b32 v174, v6, v174, s[52:53]
  v_cndmask_b32 v175, v6, v175, s[54:55]
  v_max3_f32 v4, v168, v169, v170
  v_max3_f32 v4, v4, v171, v172
  v_max3_f32 v4, v4, v173, v174
  v_max_f32 v4, v4, v175
  v_mov_b32 v5, v4
  s_nop 1
  v_permlane32_swap_b32 v4, v5
  v_max_f32 v4, v4, v5
  v_mov_b32 v5, v4
  s_nop 1
  v_permlane16_swap_b32 v4, v5
  v_max_f32 v4, v4, v5
  v_mul_f32 v4, s21, v4
  v_fma_f32 v168, v168, s21, -v4
  v_fma_f32 v169, v169, s21, -v4
  v_fma_f32 v170, v170, s21, -v4
  v_fma_f32 v171, v171, s21, -v4
  v_fma_f32 v172, v172, s21, -v4
  v_fma_f32 v173, v173, s21, -v4
  v_fma_f32 v174, v174, s21, -v4
  v_fma_f32 v175, v175, s21, -v4
  v_exp_f32 v168, v168
  v_exp_f32 v169, v169
  v_exp_f32 v170, v170
  v_exp_f32 v171, v171
  v_exp_f32 v172, v172
  v_exp_f32 v173, v173
  v_exp_f32 v174, v174
  v_exp_f32 v175, v175
  v_add_f32 v4, v168, v169
  v_add_f32 v4, v4, v170
  v_add_f32 v4, v4, v171
  v_add_f32 v4, v4, v172
  v_add_f32 v4, v4, v173
  v_add_f32 v4, v4, v174
  v_add_f32 v4, v4, v175
  v_mov_b32 v5, v4
  s_nop 1
  v_permlane32_swap_b32 v4, v5
  v_add_f32 v4, v4, v5
  v_mov_b32 v5, v4
  s_nop 1
  v_permlane16_swap_b32 v4, v5
  v_add_f32 v4, v4, v5
  v_rcp_f32 v4, v4
  s_nop 0
  v_mul_f32 v168, v168, v4
  v_mul_f32 v169, v169, v4
  v_mul_f32 v170, v170, v4
  v_mul_f32 v171, v171, v4
  v_mul_f32 v172, v172, v4
  v_mul_f32 v173, v173, v4
  v_mul_f32 v174, v174, v4
  v_mul_f32 v175, v175, v4
  v_cvt_pk_bf16_f32 v24, v168, v169
  v_cvt_pk_bf16_f32 v25, v170, v171
  v_cvt_pk_bf16_f32 v26, v172, v173
  v_cvt_pk_bf16_f32 v27, v174, v175
  v_cndmask_b32 v176, v6, v176, s[40:41]
  v_cndmask_b32 v177, v6, v177, s[42:43]
  v_cndmask_b32 v178, v6, v178, s[44:45]
  v_cndmask_b32 v179, v6, v179, s[46:47]
  v_cndmask_b32 v180, v6, v180, s[48:49]
  v_cndmask_b32 v181, v6, v181, s[50:51]
  v_cndmask_b32 v182, v6, v182, s[52:53]
  v_cndmask_b32 v183, v6, v183, s[54:55]
  v_max3_f32 v4, v176, v177, v178
  v_max3_f32 v4, v4, v179, v180
  v_max3_f32 v4, v4, v181, v182
  v_max_f32 v4, v4, v183
  v_mov_b32 v5, v4
  s_nop 1
  v_permlane32_swap_b32 v4, v5
  v_max_f32 v4, v4, v5
  v_mov_b32 v5, v4
  s_nop 1
  v_permlane16_swap_b32 v4, v5
  v_max_f32 v4, v4, v5
  v_mul_f32 v4, s21, v4
  v_fma_f32 v176, v176, s21, -v4
  v_fma_f32 v177, v177, s21, -v4
  v_fma_f32 v178, v178, s21, -v4
  v_fma_f32 v179, v179, s21, -v4
  v_fma_f32 v180, v180, s21, -v4
  v_fma_f32 v181, v181, s21, -v4
  v_fma_f32 v182, v182, s21, -v4
  v_fma_f32 v183, v183, s21, -v4
  v_exp_f32 v176, v176
  v_exp_f32 v177, v177
  v_exp_f32 v178, v178
  v_exp_f32 v179, v179
  v_exp_f32 v180, v180
  v_exp_f32 v181, v181
  v_exp_f32 v182, v182
  v_exp_f32 v183, v183
  v_add_f32 v4, v176, v177
  v_add_f32 v4, v4, v178
  v_add_f32 v4, v4, v179
  v_add_f32 v4, v4, v180
  v_add_f32 v4, v4, v181
  v_add_f32 v4, v4, v182
  v_add_f32 v4, v4, v183
  v_mov_b32 v5, v4
  s_nop 1
  v_permlane32_swap_b32 v4, v5
  v_add_f32 v4, v4, v5
  v_mov_b32 v5, v4
  s_nop 1
  v_permlane16_swap_b32 v4, v5
  v_add_f32 v4, v4, v5
  v_rcp_f32 v4, v4
  s_nop 0
  v_mul_f32 v176, v176, v4
  v_mul_f32 v177, v177, v4
  v_mul_f32 v178, v178, v4
  v_mul_f32 v179, v179, v4
  v_mul_f32 v180, v180, v4
  v_mul_f32 v181, v181, v4
  v_mul_f32 v182, v182, v4
  v_mul_f32 v183, v183, v4
  v_cvt_pk_bf16_f32 v28, v176, v177
  v_cvt_pk_bf16_f32 v29, v178, v179
  v_cvt_pk_bf16_f32 v30, v180, v181
  v_cvt_pk_bf16_f32 v31, v182, v183
  v_cndmask_b32 v184, v6, v184, s[40:41]
  v_cndmask_b32 v185, v6, v185, s[42:43]
  v_cndmask_b32 v186, v6, v186, s[44:45]
  v_cndmask_b32 v187, v6, v187, s[46:47]
  v_cndmask_b32 v188, v6, v188, s[48:49]
  v_cndmask_b32 v189, v6, v189, s[50:51]
  v_cndmask_b32 v190, v6, v190, s[52:53]
  v_cndmask_b32 v191, v6, v191, s[54:55]
  v_max3_f32 v4, v184, v185, v186
  v_max3_f32 v4, v4, v187, v188
  v_max3_f32 v4, v4, v189, v190
  v_max_f32 v4, v4, v191
  v_mov_b32 v5, v4
  s_nop 1
  v_permlane32_swap_b32 v4, v5
  v_max_f32 v4, v4, v5
  v_mov_b32 v5, v4
  s_nop 1
  v_permlane16_swap_b32 v4, v5
  v_max_f32 v4, v4, v5
  v_mul_f32 v4, s21, v4
  v_fma_f32 v184, v184, s21, -v4
  v_fma_f32 v185, v185, s21, -v4
  v_fma_f32 v186, v186, s21, -v4
  v_fma_f32 v187, v187, s21, -v4
  v_fma_f32 v188, v188, s21, -v4
  v_fma_f32 v189, v189, s21, -v4
  v_fma_f32 v190, v190, s21, -v4
  v_fma_f32 v191, v191, s21, -v4
  v_exp_f32 v184, v184
  v_exp_f32 v185, v185
  v_exp_f32 v186, v186
  v_exp_f32 v187, v187
  v_exp_f32 v188, v188
  v_exp_f32 v189, v189
  v_exp_f32 v190, v190
  v_exp_f32 v191, v191
  v_add_f32 v4, v184, v185
  v_add_f32 v4, v4, v186
  v_add_f32 v4, v4, v187
  v_add_f32 v4, v4, v188
  v_add_f32 v4, v4, v189
  v_add_f32 v4, v4, v190
  v_add_f32 v4, v4, v191
  v_mov_b32 v5, v4
  s_nop 1
  v_permlane32_swap_b32 v4, v5
  v_add_f32 v4, v4, v5
  v_mov_b32 v5, v4
  s_nop 1
  v_permlane16_swap_b32 v4, v5
  v_add_f32 v4, v4, v5
  v_rcp_f32 v4, v4
  s_nop 0
  v_mul_f32 v184, v184, v4
  v_mul_f32 v185, v185, v4
  v_mul_f32 v186, v186, v4
  v_mul_f32 v187, v187, v4
  v_mul_f32 v188, v188, v4
  v_mul_f32 v189, v189, v4
  v_mul_f32 v190, v190, v4
  v_mul_f32 v191, v191, v4
  v_cvt_pk_bf16_f32 v32, v184, v185
  v_cvt_pk_bf16_f32 v33, v186, v187
  v_cvt_pk_bf16_f32 v34, v188, v189
  v_cvt_pk_bf16_f32 v35, v190, v191
  v_cndmask_b32 v192, v6, v192, s[40:41]
  v_cndmask_b32 v193, v6, v193, s[42:43]
  v_cndmask_b32 v194, v6, v194, s[44:45]
  v_cndmask_b32 v195, v6, v195, s[46:47]
  v_cndmask_b32 v196, v6, v196, s[48:49]
  v_cndmask_b32 v197, v6, v197, s[50:51]
  v_cndmask_b32 v198, v6, v198, s[52:53]
  v_cndmask_b32 v199, v6, v199, s[54:55]
  v_max3_f32 v4, v192, v193, v194
  v_max3_f32 v4, v4, v195, v196
  v_max3_f32 v4, v4, v197, v198
  v_max_f32 v4, v4, v199
  v_mov_b32 v5, v4
  s_nop 1
  v_permlane32_swap_b32 v4, v5
  v_max_f32 v4, v4, v5
  v_mov_b32 v5, v4
  s_nop 1
  v_permlane16_swap_b32 v4, v5
  v_max_f32 v4, v4, v5
  v_mul_f32 v4, s21, v4
  v_fma_f32 v192, v192, s21, -v4
  v_fma_f32 v193, v193, s21, -v4
  v_fma_f32 v194, v194, s21, -v4
  v_fma_f32 v195, v195, s21, -v4
  v_fma_f32 v196, v196, s21, -v4
  v_fma_f32 v197, v197, s21, -v4
  v_fma_f32 v198, v198, s21, -v4
  v_fma_f32 v199, v199, s21, -v4
  v_exp_f32 v192, v192
  v_exp_f32 v193, v193
  v_exp_f32 v194, v194
  v_exp_f32 v195, v195
  v_exp_f32 v196, v196
  v_exp_f32 v197, v197
  v_exp_f32 v198, v198
  v_exp_f32 v199, v199
  v_add_f32 v4, v192, v193
  v_add_f32 v4, v4, v194
  v_add_f32 v4, v4, v195
  v_add_f32 v4, v4, v196
  v_add_f32 v4, v4, v197
  v_add_f32 v4, v4, v198
  v_add_f32 v4, v4, v199
  v_mov_b32 v5, v4
  s_nop 1
  v_permlane32_swap_b32 v4, v5
  v_add_f32 v4, v4, v5
  v_mov_b32 v5, v4
  s_nop 1
  v_permlane16_swap_b32 v4, v5
  v_add_f32 v4, v4, v5
  v_rcp_f32 v4, v4
  s_nop 0
  v_mul_f32 v192, v192, v4
  v_mul_f32 v193, v193, v4
  v_mul_f32 v194, v194, v4
  v_mul_f32 v195, v195, v4
  v_mul_f32 v196, v196, v4
  v_mul_f32 v197, v197, v4
  v_mul_f32 v198, v198, v4
  v_mul_f32 v199, v199, v4
  v_cvt_pk_bf16_f32 v36, v192, v193
  v_cvt_pk_bf16_f32 v37, v194, v195
  v_cvt_pk_bf16_f32 v38, v196, v197
  v_cvt_pk_bf16_f32 v39, v198, v199
  s_waitcnt vmcnt(0)
  s_cmp_lg_u32 s32, 0
  s_cbranch_scc1 L_rq_88
  s_cmp_eq_u32 s39, 0
  s_cbranch_scc1 L_rq_88
  s_lshl_b32 s99, s33, 7
  s_add_u32 s99, s99, 0x3d00200
  v_mov_b32 v244, 1
  v_mov_b32 v245, 0
  s_mov_b64 exec, 1
  buffer_atomic_add v244, v245, s[4:7], s99 offen sc0 sc1
  s_mov_b64 exec, -1
L_rq_88:
  v_mfma_f32_16x16x32_bf16 v[136:139], v[88:91], v[8:11], 0
  v_mfma_f32_16x16x32_bf16 v[140:143], v[94:97], v[8:11], 0
  v_mfma_f32_16x16x32_bf16 v[144:147], v[100:103], v[12:15], 0
  v_mfma_f32_16x16x32_bf16 v[148:151], v[106:109], v[12:15], 0
  v_mfma_f32_16x16x32_bf16 v[152:155], v[112:115], v[16:19], 0
  v_mfma_f32_16x16x32_bf16 v[156:159], v[118:121], v[16:19], 0
  v_mfma_f32_16x16x32_bf16 v[160:163], v[124:127], v[20:23], 0
  v_mfma_f32_16x16x32_bf16 v[164:167], v[130:133], v[20:23], 0
  v_mfma_f32_16x16x32_bf16 v[168:171], v[90:93], v[24:27], 0
  v_mfma_f32_16x16x32_bf16 v[172:175], v[96:99], v[24:27], 0
  v_mfma_f32_16x16x32_bf16 v[176:179], v[102:105], v[28:31], 0
  v_mfma_f32_16x16x32_bf16 v[180:183], v[108:111], v[28:31], 0
  v_mfma_f32_16x16x32_bf16 v[184:187], v[114:117], v[32:35], 0
  v_mfma_f32_16x16x32_bf16 v[188:191], v[120:123], v[32:35], 0
  v_mfma_f32_16x16x32_bf16 v[192:195], v[126:129], v[36:39], 0
  v_mfma_f32_16x16x32_bf16 v[196:199], v[132:135], v[36:39], 0
  v_cvt_pk_bf16_f32 v40, v136, v137
  v_cvt_pk_bf16_f32 v41, v138, v139
  v_cvt_pk_bf16_f32 v42, v140, v141
  v_cvt_pk_bf16_f32 v43, v142, v143
  buffer_store_dwordx4 v[40:43], v2, s[4:7], s97 offen offset:0 sc1
  v_cvt_pk_bf16_f32 v44, v144, v145
  v_cvt_pk_bf16_f32 v45, v146, v147
  v_cvt_pk_bf16_f32 v46, v148, v149
  v_cvt_pk_bf16_f32 v47, v150, v151
  buffer_store_dwordx4 v[44:47], v2, s[4:7], s97 offen offset:1024 sc1
  v_cvt_pk_bf16_f32 v48, v152, v153
  v_cvt_pk_bf16_f32 v49, v154, v155
  v_cvt_pk_bf16_f32 v50, v156, v157
  v_cvt_pk_bf16_f32 v51, v158, v159
  buffer_store_dwordx4 v[48:51], v2, s[4:7], s97 offen offset:2048 sc1
  v_cvt_pk_bf16_f32 v52, v160, v161
  v_cvt_pk_bf16_f32 v53, v162, v163
  v_cvt_pk_bf16_f32 v54, v164, v165
  v_cvt_pk_bf16_f32 v55, v166, v167
  buffer_store_dwordx4 v[52:55], v2, s[4:7], s97 offen offset:3072 sc1
  v_cvt_pk_bf16_f32 v56, v168, v169
  v_cvt_pk_bf16_f32 v57, v170, v171
  v_cvt_pk_bf16_f32 v58, v172, v173
  v_cvt_pk_bf16_f32 v59, v174, v175
  buffer_store_dwordx4 v[56:59], v3, s[4:7], s97 offen offset:0 sc1
  v_cvt_pk_bf16_f32 v60, v176, v177
  v_cvt_pk_bf16_f32 v61, v178, v179
  v_cvt_pk_bf16_f32 v62, v180, v181
  v_cvt_pk_bf16_f32 v63, v182, v183
  buffer_store_dwordx4 v[60:63], v3, s[4:7], s97 offen offset:1024 sc1
  v_cvt_pk_bf16_f32 v64, v184, v185
  v_cvt_pk_bf16_f32 v65, v186, v187
  v_cvt_pk_bf16_f32 v66, v188, v189
  v_cvt_pk_bf16_f32 v67, v190, v191
  buffer_store_dwordx4 v[64:67], v3, s[4:7], s97 offen offset:2048 sc1
  v_cvt_pk_bf16_f32 v68, v192, v193
  v_cvt_pk_bf16_f32 v69, v194, v195
  v_cvt_pk_bf16_f32 v70, v196, v197
  v_cvt_pk_bf16_f32 v71, v198, v199
  buffer_store_dwordx4 v[68:71], v3, s[4:7], s97 offen offset:3072 sc1
  s_branch L_done
L_ata:
  s_mov_b32 s50, 0
L_ata_c:
  s_lshr_b32 s40, s36, 3
  s_lshl_b32 s40, s40, 9
  s_lshl_b32 s90, s33, 7
  s_add_u32 s40, s40, s90
  s_add_u32 s41, s36, 1
  s_lshr_b32 s43, s36, 2
  s_lshl_b32 s43, s43, 9
  s_add_u32 s43, s43, s90
  s_add_u32 s43, s43, 28672
  s_lshl_b32 s42, s33, 1
  s_add_u32 s42, s42, s37
  s_lshl_b32 s42, s42, 7
  s_add_u32 s42, s42, 4096
  s_cmp_ge_u32 s50, 2
  s_cbranch_scc1 L_ata_s
  s_cmp_lg_u32 s32, 0
  s_cbranch_scc1 L_dd_90
  v_mov_b32 v228, 0x3d00000
  v_mov_b32 v230, 0x3d02000
L_dw_89:
  buffer_load_dword v234, v230, s[4:7], s40 offen offset:0 sc1
  buffer_load_dword v235, v228, s[4:7], s43 offen offset:0 sc1
  s_waitcnt vmcnt(0)
  s_mov_b32 s44, 1
  v_readfirstlane_b32 s45, v234
  s_cmp_ge_u32 s45, 4
  s_cselect_b32 s44, s44, 0
  v_readfirstlane_b32 s45, v235
  s_cmp_ge_u32 s45, 16
  s_cselect_b32 s44, s44, 0
  s_cmp_eq_u32 s44, 1
  s_cbranch_scc1 L_dd_90
  s_sleep 6
  s_add_u32 s3, s3, 1
  s_cmp_lt_u32 s3, 131072
  s_cbranch_scc1 L_dw_89
L_dd_90:
  s_barrier
L_ata_s:
  s_mov_b32 s98, 1
  s_lshr_b32 s38, s36, 2
  s_lshl_b32 s38, s38, 7
  s_add_u32 s38, s38, 2048
  s_lshr_b32 s90, s36, 1
  s_sub_u32 s90, s90, 24
  s_lshl_b32 s90, s90, 2
  s_add_u32 s90, s90, s33
  s_lshl_b32 s90, s90, 1
  s_add_u32 s90, s90, s37
  s_lshl_b32 s90, s90, 7
  s_add_u32 s90, s90, 20480
  s_cmp_ge_u32 s36, 60
  s_cselect_b32 s38, s90, s38
  s_lshl_b32 s20, s36, 5
  s_lshl_b32 s90, s33, 3
  s_add_u32 s20, s20, s90
  s_lshl_b32 s90, s37, 2
  s_add_u32 s20, s20, s90
  s_add_u32 s20, s20, s32
  v_and_b32 v1, 63, v0
  s_lshl_b32 s90, s20, 13
  s_lshl_b32 s91, s20, 11
  v_mov_b32 v2, 0x0
  v_bfe_u32 v7, v1, 0, 6
  v_lshl_add_u32 v2, v7, 4, v2
  v_add_u32 v3, 4096, v2
  v_mov_b32 v4, 0x3000000
  v_bfe_u32 v7, v1, 0, 1
  v_lshl_add_u32 v4, v7, 4, v4
  v_bfe_u32 v7, v1, 2, 2
  v_lshl_add_u32 v4, v7, 5, v4
  v_bfe_u32 v7, v1, 4, 2
  v_lshl_add_u32 v4, v7, 7, v4
  v_add_u32 v5, 0x3400000, v2
  v_mov_b32 v8, 0x0
  v_bfe_u32 v7, v1, 0, 3
  v_lshl_add_u32 v8, v7, 4, v8
  v_bfe_u32 v7, v1, 3, 1
  v_lshl_add_u32 v8, v7, 11, v8
  v_bfe_u32 v7, v1, 4, 2
  v_lshl_add_u32 v8, v7, 8, v8
  v_add_u32 v9, 4096, v8
  v_mov_b32 v10, 0x0
  v_bfe_u32 v7, v1, 0, 4
  v_lshl_add_u32 v10, v7, 4, v10
  v_bfe_u32 v7, v1, 4, 1
  v_lshl_add_u32 v10, v7, 8, v10
  v_bfe_u32 v7, v1, 5, 1
  v_lshl_add_u32 v10, v7, 10, v10
  v_add_u32 v11, 4096, v10
  s_add_u32 s92, s90, 16777216
  s_add_u32 s93, s90, 33554432
  s_add_u32 s94, s90, 0
  s_add_u32 s95, s90, 83886080
  buffer_load_dwordx4 v[16:19], v2, s[4:7], s94 offen offset:0 sc1
  buffer_load_dwordx4 v[20:23], v2, s[4:7], s94 offen offset:1024 sc1
  buffer_load_dwordx4 v[24:27], v2, s[4:7], s94 offen offset:2048 sc1
  buffer_load_dwordx4 v[28:31], v2, s[4:7], s94 offen offset:3072 sc1
  buffer_load_dwordx4 v[32:35], v3, s[4:7], s94 offen offset:0 sc1
  buffer_load_dwordx4 v[36:39], v3, s[4:7], s94 offen offset:1024 sc1
  buffer_load_dwordx4 v[40:43], v3, s[4:7], s94 offen offset:2048 sc1
  buffer_load_dwordx4 v[44:47], v3, s[4:7], s94 offen offset:3072 sc1
  buffer_load_dwordx4 v[48:51], v2, s[4:7], s92 offen offset:0 sc1
  buffer_load_dwordx4 v[52:55], v2, s[4:7], s92 offen offset:1024 sc1
  buffer_load_dwordx4 v[56:59], v2, s[4:7], s92 offen offset:2048 sc1
  buffer_load_dwordx4 v[60:63], v2, s[4:7], s92 offen offset:3072 sc1
  buffer_load_dwordx4 v[64:67], v3, s[4:7], s92 offen offset:0 sc1
  buffer_load_dwordx4 v[68:71], v3, s[4:7], s92 offen offset:1024 sc1
  buffer_load_dwordx4 v[72:75], v3, s[4:7], s92 offen offset:2048 sc1
  buffer_load_dwordx4 v[76:79], v3, s[4:7], s92 offen offset:3072 sc1
  buffer_load_dwordx4 v[80:83], v8, s[4:7], s93 offen offset:0 sc1
  buffer_load_dwordx4 v[84:87], v8, s[4:7], s93 offen offset:128 sc1
  buffer_load_dwordx4 v[88:91], v8, s[4:7], s93 offen offset:1024 sc1
  buffer_load_dwordx4 v[92:95], v8, s[4:7], s93 offen offset:1152 sc1
  buffer_load_dwordx4 v[96:99], v9, s[4:7], s93 offen offset:0 sc1
  buffer_load_dwordx4 v[100:103], v9, s[4:7], s93 offen offset:128 sc1
  buffer_load_dwordx4 v[104:107], v9, s[4:7], s93 offen offset:1024 sc1
  buffer_load_dwordx4 v[108:111], v9, s[4:7], s93 offen offset:1152 sc1
  s_cmp_lg_u32 s32, 0
  s_cbranch_scc1 L_dd_92
  v_mov_b32 v228, 0x3d00000
L_dw_91:
  s_lshl_b32 s45, s33, 7
  buffer_load_dword v238, v228, s[4:7], s45 offen offset:0 sc1
  buffer_load_dword v239, v228, s[4:7], s42 offen sc1
  s_waitcnt vmcnt(0)
  s_mov_b32 s44, 1
  v_readfirstlane_b32 s45, v238
  v_readfirstlane_b32 s47, v239
  s_cmp_ge_u32 s47, 16
  s_cselect_b32 s45, 64, s45
  s_cmp_ge_u32 s45, s41
  s_cselect_b32 s44, s44, 0
  s_cmp_eq_u32 s44, 1
  s_cbranch_scc1 L_dd_92
  s_sleep 3
  s_add_u32 s3, s3, 1
  s_cmp_lt_u32 s3, 131072
  s_cbranch_scc1 L_dw_91
L_dd_92:
  s_barrier
  buffer_load_dwordx4 v[112:115], v4, s[4:7], s91 offen offset:0 sc1
  buffer_load_dwordx4 v[116:119], v4, s[4:7], s91 offen offset:512 sc1
  buffer_load_dwordx4 v[120:123], v4, s[4:7], s91 offen offset:1024 sc1
  buffer_load_dwordx4 v[124:127], v4, s[4:7], s91 offen offset:1536 sc1
  buffer_load_dwordx4 v[128:131], v5, s[4:7], s91 offen offset:0 sc1
  buffer_load_dwordx4 v[132:135], v5, s[4:7], s91 offen offset:1024 sc1
  s_add_u32 s92, s92, 262144
  s_add_u32 s93, s93, 262144
  s_add_u32 s94, s94, 262144
  s_add_u32 s91, s91, 65536
  s_mov_b32 s40, 0xfff0ffff
  s_mov_b32 s41, 0xf000ff00
  s_mov_b32 s42, 0xffe0fffe
  s_mov_b32 s43, 0xe000fe00
  s_mov_b32 s44, 0xffc0fffc
  s_mov_b32 s45, 0xc000fc00
  s_mov_b32 s46, 0xff80fff8
  s_mov_b32 s47, 0x8000f800
  s_mov_b32 s50, 0x3e0293ee
  v_mov_b32 v6, 0xd028965f
  s_waitcnt vmcnt(0)
  s_cmp_lt_u32 s36, 60
  s_cbranch_scc1 L_rf_93
  s_cmp_lg_u32 s32, 0
  s_cbranch_scc1 L_rq_94
  s_cmp_eq_u32 s39, 0
  s_cbranch_scc1 L_rq_94
  s_lshl_b32 s99, s33, 7
  s_add_u32 s99, s99, 0x3d00200
  v_mov_b32 v244, 1
  v_mov_b32 v245, 0
  s_mov_b64 exec, 1
  buffer_atomic_add v244, v245, s[4:7], s99 offen sc0 sc1
  s_mov_b64 exec, -1
L_rq_94:
L_rf_93:
  v_mfma_f32_16x16x32_bf16 v[136:139], v[112:115], v[16:19], 0
  v_mfma_f32_16x16x32_bf16 v[140:143], v[48:51], v[16:19], 0
  v_mfma_f32_16x16x32_bf16 v[144:147], v[112:115], v[32:35], 0
  v_mfma_f32_16x16x32_bf16 v[148:151], v[48:51], v[32:35], 0
  v_mfma_f32_16x16x32_bf16 v[152:155], v[64:67], v[32:35], 0
  v_mfma_f32_16x16x32_bf16 v[136:139], v[116:119], v[20:23], v[136:139]
  v_mfma_f32_16x16x32_bf16 v[140:143], v[52:55], v[20:23], v[140:143]
  v_mfma_f32_16x16x32_bf16 v[144:147], v[116:119], v[36:39], v[144:147]
  v_mfma_f32_16x16x32_bf16 v[148:151], v[52:55], v[36:39], v[148:151]
  v_mfma_f32_16x16x32_bf16 v[152:155], v[68:71], v[36:39], v[152:155]
  v_mfma_f32_16x16x32_bf16 v[136:139], v[120:123], v[24:27], v[136:139]
  v_mfma_f32_16x16x32_bf16 v[140:143], v[56:59], v[24:27], v[140:143]
  v_mfma_f32_16x16x32_bf16 v[144:147], v[120:123], v[40:43], v[144:147]
  v_mfma_f32_16x16x32_bf16 v[148:151], v[56:59], v[40:43], v[148:151]
  v_mfma_f32_16x16x32_bf16 v[152:155], v[72:75], v[40:43], v[152:155]
  v_mfma_f32_16x16x32_bf16 v[136:139], v[124:127], v[28:31], v[136:139]
  v_mfma_f32_16x16x32_bf16 v[140:143], v[60:63], v[28:31], v[140:143]
  v_mfma_f32_16x16x32_bf16 v[144:147], v[124:127], v[44:47], v[144:147]
  v_mfma_f32_16x16x32_bf16 v[148:151], v[60:63], v[44:47], v[148:151]
  v_mfma_f32_16x16x32_bf16 v[152:155], v[76:79], v[44:47], v[152:155]
  s_nop 4
  v_cndmask_b32 v140, v6, v140, s[40:41]
  v_cndmask_b32 v141, v6, v141, s[42:43]
  v_cndmask_b32 v142, v6, v142, s[44:45]
  v_cndmask_b32 v143, v6, v143, s[46:47]
  v_max3_f32 v12, v136, v137, v140
  v_max3_f32 v12, v12, v141, v142
  v_max_f32 v12, v12, v143
  v_mov_b32 v13, v12
  s_nop 1
  v_permlane32_swap_b32 v12, v13
  v_max_f32 v12, v12, v13
  v_mov_b32 v13, v12
  s_nop 1
  v_permlane16_swap_b32 v12, v13
  v_max_f32 v12, v12, v13
  v_mul_f32 v12, s50, v12
  v_fma_f32 v136, v136, s50, -v12
  v_fma_f32 v137, v137, s50, -v12
  v_fma_f32 v140, v140, s50, -v12
  v_fma_f32 v141, v141, s50, -v12
  v_fma_f32 v142, v142, s50, -v12
  v_fma_f32 v143, v143, s50, -v12
  v_exp_f32 v136, v136
  v_exp_f32 v137, v137
  v_exp_f32 v140, v140
  v_exp_f32 v141, v141
  v_exp_f32 v142, v142
  v_exp_f32 v143, v143
  v_add_f32 v12, v136, v137
  v_add_f32 v12, v12, v140
  v_add_f32 v12, v12, v141
  v_add_f32 v12, v12, v142
  v_add_f32 v12, v12, v143
  v_mov_b32 v13, v12
  s_nop 1
  v_permlane32_swap_b32 v12, v13
  v_add_f32 v12, v12, v13
  v_mov_b32 v13, v12
  s_nop 1
  v_permlane16_swap_b32 v12, v13
  v_add_f32 v12, v12, v13
  v_rcp_f32 v12, v12
  s_nop 0
  v_mul_f32 v136, v136, v12
  v_mul_f32 v137, v137, v12
  v_mul_f32 v140, v140, v12
  v_mul_f32 v141, v141, v12
  v_mul_f32 v142, v142, v12
  v_mul_f32 v143, v143, v12
  v_cvt_pk_bf16_f32 v160, v136, v137
  v_mov_b32 v161, 0
  v_mov_b32 v162, 0
  v_mov_b32 v163, v160
  v_cvt_pk_bf16_f32 v156, v140, v141
  v_cvt_pk_bf16_f32 v157, v142, v143
  v_mov_b32 v158, 0
  v_mov_b32 v159, 0
  v_cndmask_b32 v152, v6, v152, s[40:41]
  v_cndmask_b32 v153, v6, v153, s[42:43]
  v_cndmask_b32 v154, v6, v154, s[44:45]
  v_cndmask_b32 v155, v6, v155, s[46:47]
  v_max3_f32 v12, v144, v145, v148
  v_max3_f32 v12, v12, v149, v150
  v_max3_f32 v12, v12, v151, v152
  v_max3_f32 v12, v12, v153, v154
  v_max_f32 v12, v12, v155
  v_mov_b32 v13, v12
  s_nop 1
  v_permlane32_swap_b32 v12, v13
  v_max_f32 v12, v12, v13
  v_mov_b32 v13, v12
  s_nop 1
  v_permlane16_swap_b32 v12, v13
  v_max_f32 v12, v12, v13
  v_mul_f32 v12, s50, v12
  v_fma_f32 v144, v144, s50, -v12
  v_fma_f32 v145, v145, s50, -v12
  v_fma_f32 v148, v148, s50, -v12
  v_fma_f32 v149, v149, s50, -v12
  v_fma_f32 v150, v150, s50, -v12
  v_fma_f32 v151, v151, s50, -v12
  v_fma_f32 v152, v152, s50, -v12
  v_fma_f32 v153, v153, s50, -v12
  v_fma_f32 v154, v154, s50, -v12
  v_fma_f32 v155, v155, s50, -v12
  v_exp_f32 v144, v144
  v_exp_f32 v145, v145
  v_exp_f32 v148, v148
  v_exp_f32 v149, v149
  v_exp_f32 v150, v150
  v_exp_f32 v151, v151
  v_exp_f32 v152, v152
  v_exp_f32 v153, v153
  v_exp_f32 v154, v154
  v_exp_f32 v155, v155
  v_add_f32 v12, v144, v145
  v_add_f32 v12, v12, v148
  v_add_f32 v12, v12, v149
  v_add_f32 v12, v12, v150
  v_add_f32 v12, v12, v151
  v_add_f32 v12, v12, v152
  v_add_f32 v12, v12, v153
  v_add_f32 v12, v12, v154
  v_add_f32 v12, v12, v155
  v_mov_b32 v13, v12
  s_nop 1
  v_permlane32_swap_b32 v12, v13
  v_add_f32 v12, v12, v13
  v_mov_b32 v13, v12
  s_nop 1
  v_permlane16_swap_b32 v12, v13
  v_add_f32 v12, v12, v13
  v_rcp_f32 v12, v12
  s_nop 0
  v_mul_f32 v144, v144, v12
  v_mul_f32 v145, v145, v12
  v_mul_f32 v148, v148, v12
  v_mul_f32 v149, v149, v12
  v_mul_f32 v150, v150, v12
  v_mul_f32 v151, v151, v12
  v_mul_f32 v152, v152, v12
  v_mul_f32 v153, v153, v12
  v_mul_f32 v154, v154, v12
  v_mul_f32 v155, v155, v12
  v_cvt_pk_bf16_f32 v168, v144, v145
  v_mov_b32 v169, 0
  v_mov_b32 v170, 0
  v_mov_b32 v171, v168
  v_cvt_pk_bf16_f32 v164, v148, v149
  v_cvt_pk_bf16_f32 v165, v150, v151
  v_cvt_pk_bf16_f32 v166, v152, v153
  v_cvt_pk_bf16_f32 v167, v154, v155
  v_mfma_f32_16x16x32_bf16 v[176:179], v[80:83], v[156:159], 0
  v_mfma_f32_16x16x32_bf16 v[180:183], v[84:87], v[156:159], 0
  v_mfma_f32_16x16x32_bf16 v[184:187], v[88:91], v[156:159], 0
  v_mfma_f32_16x16x32_bf16 v[188:191], v[92:95], v[156:159], 0
  v_mfma_f32_16x16x32_bf16 v[192:195], v[96:99], v[156:159], 0
  v_mfma_f32_16x16x32_bf16 v[196:199], v[100:103], v[156:159], 0
  v_mfma_f32_16x16x32_bf16 v[200:203], v[104:107], v[156:159], 0
  v_mfma_f32_16x16x32_bf16 v[204:207], v[108:111], v[156:159], 0
  v_mfma_f32_16x16x16_bf16 v[176:179], v[128:129], v[160:161], v[176:179]
  v_mfma_f32_16x16x16_bf16 v[180:183], v[128:129], v[162:163], v[180:183]
  v_mfma_f32_16x16x16_bf16 v[184:187], v[130:131], v[160:161], v[184:187]
  v_mfma_f32_16x16x16_bf16 v[188:191], v[130:131], v[162:163], v[188:191]
  v_mfma_f32_16x16x16_bf16 v[192:195], v[132:133], v[160:161], v[192:195]
  v_mfma_f32_16x16x16_bf16 v[196:199], v[132:133], v[162:163], v[196:199]
  v_mfma_f32_16x16x16_bf16 v[200:203], v[134:135], v[160:161], v[200:203]
  v_mfma_f32_16x16x16_bf16 v[204:207], v[134:135], v[162:163], v[204:207]
  v_mfma_f32_16x16x32_bf16 v[208:211], v[80:83], v[164:167], 0
  v_mfma_f32_16x16x32_bf16 v[212:215], v[84:87], v[164:167], 0
  v_mfma_f32_16x16x32_bf16 v[216:219], v[88:91], v[164:167], 0
  v_mfma_f32_16x16x32_bf16 v[220:223], v[92:95], v[164:167], 0
  v_mfma_f32_16x16x32_bf16 v[224:227], v[96:99], v[164:167], 0
  v_mfma_f32_16x16x32_bf16 v[228:231], v[100:103], v[164:167], 0
  v_mfma_f32_16x16x32_bf16 v[232:235], v[104:107], v[164:167], 0
  v_mfma_f32_16x16x32_bf16 v[236:239], v[108:111], v[164:167], 0
  v_mfma_f32_16x16x16_bf16 v[208:211], v[128:129], v[168:169], v[208:211]
  v_mfma_f32_16x16x16_bf16 v[212:215], v[128:129], v[170:171], v[212:215]
  v_mfma_f32_16x16x16_bf16 v[216:219], v[130:131], v[168:169], v[216:219]
  v_mfma_f32_16x16x16_bf16 v[220:223], v[130:131], v[170:171], v[220:223]
  v_mfma_f32_16x16x16_bf16 v[224:227], v[132:133], v[168:169], v[224:227]
  v_mfma_f32_16x16x16_bf16 v[228:231], v[132:133], v[170:171], v[228:231]
  v_mfma_f32_16x16x16_bf16 v[232:235], v[134:135], v[168:169], v[232:235]
  v_mfma_f32_16x16x16_bf16 v[236:239], v[134:135], v[170:171], v[236:239]
  v_cvt_pk_bf16_f32 v136, v176, v177
  v_cvt_pk_bf16_f32 v137, v178, v179
  v_cvt_pk_bf16_f32 v138, v184, v185
  v_cvt_pk_bf16_f32 v139, v186, v187
  buffer_store_dwordx4 v[136:139], v10, s[4:7], s95 offen offset:0 sc1
  v_cvt_pk_bf16_f32 v140, v180, v181
  v_cvt_pk_bf16_f32 v141, v182, v183
  v_cvt_pk_bf16_f32 v142, v188, v189
  v_cvt_pk_bf16_f32 v143, v190, v191
  buffer_store_dwordx4 v[140:143], v10, s[4:7], s95 offen offset:512 sc1
  v_cvt_pk_bf16_f32 v144, v192, v193
  v_cvt_pk_bf16_f32 v145, v194, v195
  v_cvt_pk_bf16_f32 v146, v200, v201
  v_cvt_pk_bf16_f32 v147, v202, v203
  buffer_store_dwordx4 v[144:147], v10, s[4:7], s95 offen offset:2048 sc1
  v_cvt_pk_bf16_f32 v148, v196, v197
  v_cvt_pk_bf16_f32 v149, v198, v199
  v_cvt_pk_bf16_f32 v150, v204, v205
  v_cvt_pk_bf16_f32 v151, v206, v207
  buffer_store_dwordx4 v[148:151], v10, s[4:7], s95 offen offset:2560 sc1
  v_cvt_pk_bf16_f32 v136, v208, v209
  v_cvt_pk_bf16_f32 v137, v210, v211
  v_cvt_pk_bf16_f32 v138, v216, v217
  v_cvt_pk_bf16_f32 v139, v218, v219
  buffer_store_dwordx4 v[136:139], v11, s[4:7], s95 offen offset:0 sc1
  v_cvt_pk_bf16_f32 v140, v212, v213
  v_cvt_pk_bf16_f32 v141, v214, v215
  v_cvt_pk_bf16_f32 v142, v220, v221
  v_cvt_pk_bf16_f32 v143, v222, v223
  buffer_store_dwordx4 v[140:143], v11, s[4:7], s95 offen offset:512 sc1
  v_cvt_pk_bf16_f32 v144, v224, v225
  v_cvt_pk_bf16_f32 v145, v226, v227
  v_cvt_pk_bf16_f32 v146, v232, v233
  v_cvt_pk_bf16_f32 v147, v234, v235
  buffer_store_dwordx4 v[144:147], v11, s[4:7], s95 offen offset:2048 sc1
  v_cvt_pk_bf16_f32 v148, v228, v229
  v_cvt_pk_bf16_f32 v149, v230, v231
  v_cvt_pk_bf16_f32 v150, v236, v237
  v_cvt_pk_bf16_f32 v151, v238, v239
  buffer_store_dwordx4 v[148:151], v11, s[4:7], s95 offen offset:2560 sc1
  s_add_u32 s95, s95, 262144
  s_branch L_done
L_ata4:
  s_lshr_b32 s40, s36, 3
  s_lshl_b32 s40, s40, 9
  s_lshl_b32 s90, s33, 7
  s_add_u32 s40, s40, s90
  s_add_u32 s41, s36, 4
  s_lshr_b32 s43, s36, 2
  s_lshl_b32 s43, s43, 9
  s_add_u32 s43, s43, s90
  s_add_u32 s43, s43, 28672
  s_lshl_b32 s42, s33, 1
  s_add_u32 s42, s42, s37
  s_lshl_b32 s42, s42, 7
  s_add_u32 s42, s42, 4096
  s_cmp_lg_u32 s32, 0
  s_cbranch_scc1 L_dd_96
  v_mov_b32 v228, 0x3d00000
  v_mov_b32 v230, 0x3d02000
L_dw_95:
  buffer_load_dword v234, v230, s[4:7], s40 offen offset:0 sc1
  buffer_load_dword v235, v228, s[4:7], s43 offen offset:0 sc1
  s_lshl_b32 s45, s33, 7
  buffer_load_dword v238, v228, s[4:7], s45 offen offset:0 sc1
  buffer_load_dword v239, v228, s[4:7], s42 offen sc1
  s_waitcnt vmcnt(0)
  s_mov_b32 s44, 1
  v_readfirstlane_b32 s45, v234
  s_cmp_ge_u32 s45, 4
  s_cselect_b32 s44, s44, 0
  v_readfirstlane_b32 s45, v235
  s_cmp_ge_u32 s45, 16
  s_cselect_b32 s44, s44, 0
  v_readfirstlane_b32 s45, v238
  v_readfirstlane_b32 s47, v239
  s_cmp_ge_u32 s47, 16
  s_cselect_b32 s45, 64, s45
  s_cmp_ge_u32 s45, s41
  s_cselect_b32 s44, s44, 0
  s_cmp_eq_u32 s44, 1
  s_cbranch_scc1 L_dd_96
  s_sleep 6
  s_add_u32 s3, s3, 1
  s_cmp_lt_u32 s3, 131072
  s_cbranch_scc1 L_dw_95
L_dd_96:
  s_barrier
  s_mov_b32 s98, 4
  s_lshr_b32 s38, s36, 2
  s_lshl_b32 s38, s38, 7
  s_add_u32 s38, s38, 2048
  s_lshl_b32 s20, s36, 5
  s_lshl_b32 s90, s33, 3
  s_add_u32 s20, s20, s90
  s_lshl_b32 s90, s37, 2
  s_add_u32 s20, s20, s90
  s_add_u32 s20, s20, s32
  v_and_b32 v1, 63, v0
  s_lshl_b32 s90, s20, 13
  s_lshl_b32 s91, s20, 11
  v_mov_b32 v2, 0x0
  v_bfe_u32 v7, v1, 0, 6
  v_lshl_add_u32 v2, v7, 4, v2
  v_add_u32 v3, 4096, v2
  v_mov_b32 v4, 0x3000000
  v_bfe_u32 v7, v1, 0, 1
  v_lshl_add_u32 v4, v7, 4, v4
  v_bfe_u32 v7, v1, 2, 2
  v_lshl_add_u32 v4, v7, 5, v4
  v_bfe_u32 v7, v1, 4, 2
  v_lshl_add_u32 v4, v7, 7, v4
  v_add_u32 v5, 0x3400000, v2
  v_mov_b32 v8, 0x0
  v_bfe_u32 v7, v1, 0, 3
  v_lshl_add_u32 v8, v7, 4, v8
  v_bfe_u32 v7, v1, 3, 1
  v_lshl_add_u32 v8, v7, 11, v8
  v_bfe_u32 v7, v1, 4, 2
  v_lshl_add_u32 v8, v7, 8, v8
  v_add_u32 v9, 4096, v8
  v_mov_b32 v10, 0x0
  v_bfe_u32 v7, v1, 0, 4
  v_lshl_add_u32 v10, v7, 4, v10
  v_bfe_u32 v7, v1, 4, 1
  v_lshl_add_u32 v10, v7, 8, v10
  v_bfe_u32 v7, v1, 5, 1
  v_lshl_add_u32 v10, v7, 10, v10
  v_add_u32 v11, 4096, v10
  s_add_u32 s92, s90, 16777216
  s_add_u32 s93, s90, 33554432
  s_add_u32 s94, s90, 0
  s_add_u32 s95, s90, 83886080
  buffer_load_dwordx4 v[16:19], v2, s[4:7], s94 offen offset:0 sc1
  buffer_load_dwordx4 v[20:23], v2, s[4:7], s94 offen offset:1024 sc1
  buffer_load_dwordx4 v[24:27], v2, s[4:7], s94 offen offset:2048 sc1
  buffer_load_dwordx4 v[28:31], v2, s[4:7], s94 offen offset:3072 sc1
  buffer_load_dwordx4 v[32:35], v3, s[4:7], s94 offen offset:0 sc1
  buffer_load_dwordx4 v[36:39], v3, s[4:7], s94 offen offset:1024 sc1
  buffer_load_dwordx4 v[40:43], v3, s[4:7], s94 offen offset:2048 sc1
  buffer_load_dwordx4 v[44:47], v3, s[4:7], s94 offen offset:3072 sc1
  buffer_load_dwordx4 v[48:51], v2, s[4:7], s92 offen offset:0 sc1
  buffer_load_dwordx4 v[52:55], v2, s[4:7], s92 offen offset:1024 sc1
  buffer_load_dwordx4 v[56:59], v2, s[4:7], s92 offen offset:2048 sc1
  buffer_load_dwordx4 v[60:63], v2, s[4:7], s92 offen offset:3072 sc1
  buffer_load_dwordx4 v[64:67], v3, s[4:7], s92 offen offset:0 sc1
  buffer_load_dwordx4 v[68:71], v3, s[4:7], s92 offen offset:1024 sc1
  buffer_load_dwordx4 v[72:75], v3, s[4:7], s92 offen offset:2048 sc1
  buffer_load_dwordx4 v[76:79], v3, s[4:7], s92 offen offset:3072 sc1
  buffer_load_dwordx4 v[80:83], v8, s[4:7], s93 offen offset:0 sc1
  buffer_load_dwordx4 v[84:87], v8, s[4:7], s93 offen offset:128 sc1
  buffer_load_dwordx4 v[88:91], v8, s[4:7], s93 offen offset:1024 sc1
  buffer_load_dwordx4 v[92:95], v8, s[4:7], s93 offen offset:1152 sc1
  buffer_load_dwordx4 v[96:99], v9, s[4:7], s93 offen offset:0 sc1
  buffer_load_dwordx4 v[100:103], v9, s[4:7], s93 offen offset:128 sc1
  buffer_load_dwordx4 v[104:107], v9, s[4:7], s93 offen offset:1024 sc1
  buffer_load_dwordx4 v[108:111], v9, s[4:7], s93 offen offset:1152 sc1
  buffer_load_dwordx4 v[112:115], v4, s[4:7], s91 offen offset:0 sc1
  buffer_load_dwordx4 v[116:119], v4, s[4:7], s91 offen offset:512 sc1
  buffer_load_dwordx4 v[120:123], v4, s[4:7], s91 offen offset:1024 sc1
  buffer_load_dwordx4 v[124:127], v4, s[4:7], s91 offen offset:1536 sc1
  buffer_load_dwordx4 v[128:131], v5, s[4:7], s91 offen offset:0 sc1
  buffer_load_dwordx4 v[132:135], v5, s[4:7], s91 offen offset:1024 sc1
  s_add_u32 s92, s92, 262144
  s_add_u32 s93, s93, 262144
  s_add_u32 s94, s94, 262144
  s_add_u32 s91, s91, 65536
  buffer_load_dwordx4 a[0:3], v2, s[4:7], s94 offen offset:0 sc1
  buffer_load_dwordx4 a[4:7], v2, s[4:7], s94 offen offset:1024 sc1
  buffer_load_dwordx4 a[8:11], v2, s[4:7], s94 offen offset:2048 sc1
  buffer_load_dwordx4 a[12:15], v2, s[4:7], s94 offen offset:3072 sc1
  buffer_load_dwordx4 a[16:19], v3, s[4:7], s94 offen offset:0 sc1
  buffer_load_dwordx4 a[20:23], v3, s[4:7], s94 offen offset:1024 sc1
  buffer_load_dwordx4 a[24:27], v3, s[4:7], s94 offen offset:2048 sc1
  buffer_load_dwordx4 a[28:31], v3, s[4:7], s94 offen offset:3072 sc1
  buffer_load_dwordx4 a[32:35], v2, s[4:7], s92 offen offset:0 sc1
  buffer_load_dwordx4 a[36:39], v2, s[4:7], s92 offen offset:1024 sc1
  buffer_load_dwordx4 a[40:43], v2, s[4:7], s92 offen offset:2048 sc1
  buffer_load_dwordx4 a[44:47], v2, s[4:7], s92 offen offset:3072 sc1
  buffer_load_dwordx4 a[48:51], v3, s[4:7], s92 offen offset:0 sc1
  buffer_load_dwordx4 a[52:55], v3, s[4:7], s92 offen offset:1024 sc1
  buffer_load_dwordx4 a[56:59], v3, s[4:7], s92 offen offset:2048 sc1
  buffer_load_dwordx4 a[60:63], v3, s[4:7], s92 offen offset:3072 sc1
  buffer_load_dwordx4 a[64:67], v8, s[4:7], s93 offen offset:0 sc1
  buffer_load_dwordx4 a[68:71], v8, s[4:7], s93 offen offset:128 sc1
  buffer_load_dwordx4 a[72:75], v8, s[4:7], s93 offen offset:1024 sc1
  buffer_load_dwordx4 a[76:79], v8, s[4:7], s93 offen offset:1152 sc1
  buffer_load_dwordx4 a[80:83], v9, s[4:7], s93 offen offset:0 sc1
  buffer_load_dwordx4 a[84:87], v9, s[4:7], s93 offen offset:128 sc1
  buffer_load_dwordx4 a[88:91], v9, s[4:7], s93 offen offset:1024 sc1
  buffer_load_dwordx4 a[92:95], v9, s[4:7], s93 offen offset:1152 sc1
  buffer_load_dwordx4 a[96:99], v4, s[4:7], s91 offen offset:0 sc1
  buffer_load_dwordx4 a[100:103], v4, s[4:7], s91 offen offset:512 sc1
  buffer_load_dwordx4 a[104:107], v4, s[4:7], s91 offen offset:1024 sc1
  buffer_load_dwordx4 a[108:111], v4, s[4:7], s91 offen offset:1536 sc1
  buffer_load_dwordx4 a[112:115], v5, s[4:7], s91 offen offset:0 sc1
  buffer_load_dwordx4 a[116:119], v5, s[4:7], s91 offen offset:1024 sc1
  s_add_u32 s92, s92, 262144
  s_add_u32 s93, s93, 262144
  s_add_u32 s94, s94, 262144
  s_add_u32 s91, s91, 65536
  s_mov_b32 s40, 0xfff0ffff
  s_mov_b32 s41, 0xf000ff00
  s_mov_b32 s42, 0xffe0fffe
  s_mov_b32 s43, 0xe000fe00
  s_mov_b32 s44, 0xffc0fffc
  s_mov_b32 s45, 0xc000fc00
  s_mov_b32 s46, 0xff80fff8
  s_mov_b32 s47, 0x8000f800
  s_mov_b32 s50, 0x3e0293ee
  v_mov_b32 v6, 0xd028965f
  s_waitcnt vmcnt(30)
  v_mfma_f32_16x16x32_bf16 v[136:139], v[112:115], v[16:19], 0
  v_mfma_f32_16x16x32_bf16 v[140:143], v[48:51], v[16:19], 0
  v_mfma_f32_16x16x32_bf16 v[144:147], v[112:115], v[32:35], 0
  v_mfma_f32_16x16x32_bf16 v[148:151], v[48:51], v[32:35], 0
  v_mfma_f32_16x16x32_bf16 v[152:155], v[64:67], v[32:35], 0
  v_mfma_f32_16x16x32_bf16 v[136:139], v[116:119], v[20:23], v[136:139]
  v_mfma_f32_16x16x32_bf16 v[140:143], v[52:55], v[20:23], v[140:143]
  v_mfma_f32_16x16x32_bf16 v[144:147], v[116:119], v[36:39], v[144:147]
  v_mfma_f32_16x16x32_bf16 v[148:151], v[52:55], v[36:39], v[148:151]
  v_mfma_f32_16x16x32_bf16 v[152:155], v[68:71], v[36:39], v[152:155]
  v_mfma_f32_16x16x32_bf16 v[136:139], v[120:123], v[24:27], v[136:139]
  v_mfma_f32_16x16x32_bf16 v[140:143], v[56:59], v[24:27], v[140:143]
  v_mfma_f32_16x16x32_bf16 v[144:147], v[120:123], v[40:43], v[144:147]
  v_mfma_f32_16x16x32_bf16 v[148:151], v[56:59], v[40:43], v[148:151]
  v_mfma_f32_16x16x32_bf16 v[152:155], v[72:75], v[40:43], v[152:155]
  v_mfma_f32_16x16x32_bf16 v[136:139], v[124:127], v[28:31], v[136:139]
  v_mfma_f32_16x16x32_bf16 v[140:143], v[60:63], v[28:31], v[140:143]
  v_mfma_f32_16x16x32_bf16 v[144:147], v[124:127], v[44:47], v[144:147]
  v_mfma_f32_16x16x32_bf16 v[148:151], v[60:63], v[44:47], v[148:151]
  v_mfma_f32_16x16x32_bf16 v[152:155], v[76:79], v[44:47], v[152:155]
  s_nop 4
  v_cndmask_b32 v140, v6, v140, s[40:41]
  v_cndmask_b32 v141, v6, v141, s[42:43]
  v_cndmask_b32 v142, v6, v142, s[44:45]
  v_cndmask_b32 v143, v6, v143, s[46:47]
  v_max3_f32 v12, v136, v137, v140
  v_max3_f32 v12, v12, v141, v142
  v_max_f32 v12, v12, v143
  v_mov_b32 v13, v12
  s_nop 1
  v_permlane32_swap_b32 v12, v13
  v_max_f32 v12, v12, v13
  v_mov_b32 v13, v12
  s_nop 1
  v_permlane16_swap_b32 v12, v13
  v_max_f32 v12, v12, v13
  v_mul_f32 v12, s50, v12
  v_fma_f32 v136, v136, s50, -v12
  v_fma_f32 v137, v137, s50, -v12
  v_fma_f32 v140, v140, s50, -v12
  v_fma_f32 v141, v141, s50, -v12
  v_fma_f32 v142, v142, s50, -v12
  v_fma_f32 v143, v143, s50, -v12
  v_exp_f32 v136, v136
  v_exp_f32 v137, v137
  v_exp_f32 v140, v140
  v_exp_f32 v141, v141
  v_exp_f32 v142, v142
  v_exp_f32 v143, v143
  v_add_f32 v12, v136, v137
  v_add_f32 v12, v12, v140
  v_add_f32 v12, v12, v141
  v_add_f32 v12, v12, v142
  v_add_f32 v12, v12, v143
  v_mov_b32 v13, v12
  s_nop 1
  v_permlane32_swap_b32 v12, v13
  v_add_f32 v12, v12, v13
  v_mov_b32 v13, v12
  s_nop 1
  v_permlane16_swap_b32 v12, v13
  v_add_f32 v12, v12, v13
  v_rcp_f32 v12, v12
  s_nop 0
  v_mul_f32 v136, v136, v12
  v_mul_f32 v137, v137, v12
  v_mul_f32 v140, v140, v12
  v_mul_f32 v141, v141, v12
  v_mul_f32 v142, v142, v12
  v_mul_f32 v143, v143, v12
  v_cvt_pk_bf16_f32 v160, v136, v137
  v_mov_b32 v161, 0
  v_mov_b32 v162, 0
  v_mov_b32 v163, v160
  v_cvt_pk_bf16_f32 v156, v140, v141
  v_cvt_pk_bf16_f32 v157, v142, v143
  v_mov_b32 v158, 0
  v_mov_b32 v159, 0
  v_cndmask_b32 v152, v6, v152, s[40:41]
  v_cndmask_b32 v153, v6, v153, s[42:43]
  v_cndmask_b32 v154, v6, v154, s[44:45]
  v_cndmask_b32 v155, v6, v155, s[46:47]
  v_max3_f32 v12, v144, v145, v148
  v_max3_f32 v12, v12, v149, v150
  v_max3_f32 v12, v12, v151, v152
  v_max3_f32 v12, v12, v153, v154
  v_max_f32 v12, v12, v155
  v_mov_b32 v13, v12
  s_nop 1
  v_permlane32_swap_b32 v12, v13
  v_max_f32 v12, v12, v13
  v_mov_b32 v13, v12
  s_nop 1
  v_permlane16_swap_b32 v12, v13
  v_max_f32 v12, v12, v13
  v_mul_f32 v12, s50, v12
  v_fma_f32 v144, v144, s50, -v12
  v_fma_f32 v145, v145, s50, -v12
  v_fma_f32 v148, v148, s50, -v12
  v_fma_f32 v149, v149, s50, -v12
  v_fma_f32 v150, v150, s50, -v12
  v_fma_f32 v151, v151, s50, -v12
  v_fma_f32 v152, v152, s50, -v12
  v_fma_f32 v153, v153, s50, -v12
  v_fma_f32 v154, v154, s50, -v12
  v_fma_f32 v155, v155, s50, -v12
  v_exp_f32 v144, v144
  v_exp_f32 v145, v145
  v_exp_f32 v148, v148
  v_exp_f32 v149, v149
  v_exp_f32 v150, v150
  v_exp_f32 v151, v151
  v_exp_f32 v152, v152
  v_exp_f32 v153, v153
  v_exp_f32 v154, v154
  v_exp_f32 v155, v155
  v_add_f32 v12, v144, v145
  v_add_f32 v12, v12, v148
  v_add_f32 v12, v12, v149
  v_add_f32 v12, v12, v150
  v_add_f32 v12, v12, v151
  v_add_f32 v12, v12, v152
  v_add_f32 v12, v12, v153
  v_add_f32 v12, v12, v154
  v_add_f32 v12, v12, v155
  v_mov_b32 v13, v12
  s_nop 1
  v_permlane32_swap_b32 v12, v13
  v_add_f32 v12, v12, v13
  v_mov_b32 v13, v12
  s_nop 1
  v_permlane16_swap_b32 v12, v13
  v_add_f32 v12, v12, v13
  v_rcp_f32 v12, v12
  s_nop 0
  v_mul_f32 v144, v144, v12
  v_mul_f32 v145, v145, v12
  v_mul_f32 v148, v148, v12
  v_mul_f32 v149, v149, v12
  v_mul_f32 v150, v150, v12
  v_mul_f32 v151, v151, v12
  v_mul_f32 v152, v152, v12
  v_mul_f32 v153, v153, v12
  v_mul_f32 v154, v154, v12
  v_mul_f32 v155, v155, v12
  v_cvt_pk_bf16_f32 v168, v144, v145
  v_mov_b32 v169, 0
  v_mov_b32 v170, 0
  v_mov_b32 v171, v168
  v_cvt_pk_bf16_f32 v164, v148, v149
  v_cvt_pk_bf16_f32 v165, v150, v151
  v_cvt_pk_bf16_f32 v166, v152, v153
  v_cvt_pk_bf16_f32 v167, v154, v155
  v_mfma_f32_16x16x32_bf16 v[176:179], v[80:83], v[156:159], 0
  v_mfma_f32_16x16x32_bf16 v[180:183], v[84:87], v[156:159], 0
  v_mfma_f32_16x16x32_bf16 v[184:187], v[88:91], v[156:159], 0
  v_mfma_f32_16x16x32_bf16 v[188:191], v[92:95], v[156:159], 0
  v_mfma_f32_16x16x32_bf16 v[192:195], v[96:99], v[156:159], 0
  v_mfma_f32_16x16x32_bf16 v[196:199], v[100:103], v[156:159], 0
  v_mfma_f32_16x16x32_bf16 v[200:203], v[104:107], v[156:159], 0
  v_mfma_f32_16x16x32_bf16 v[204:207], v[108:111], v[156:159], 0
  v_mfma_f32_16x16x16_bf16 v[176:179], v[128:129], v[160:161], v[176:179]
  v_mfma_f32_16x16x16_bf16 v[180:183], v[128:129], v[162:163], v[180:183]
  v_mfma_f32_16x16x16_bf16 v[184:187], v[130:131], v[160:161], v[184:187]
  v_mfma_f32_16x16x16_bf16 v[188:191], v[130:131], v[162:163], v[188:191]
  v_mfma_f32_16x16x16_bf16 v[192:195], v[132:133], v[160:161], v[192:195]
  v_mfma_f32_16x16x16_bf16 v[196:199], v[132:133], v[162:163], v[196:199]
  v_mfma_f32_16x16x16_bf16 v[200:203], v[134:135], v[160:161], v[200:203]
  v_mfma_f32_16x16x16_bf16 v[204:207], v[134:135], v[162:163], v[204:207]
  v_mfma_f32_16x16x32_bf16 v[208:211], v[80:83], v[164:167], 0
  v_mfma_f32_16x16x32_bf16 v[212:215], v[84:87], v[164:167], 0
  v_mfma_f32_16x16x32_bf16 v[216:219], v[88:91], v[164:167], 0
  v_mfma_f32_16x16x32_bf16 v[220:223], v[92:95], v[164:167], 0
  v_mfma_f32_16x16x32_bf16 v[224:227], v[96:99], v[164:167], 0
  v_mfma_f32_16x16x32_bf16 v[228:231], v[100:103], v[164:167], 0
  v_mfma_f32_16x16x32_bf16 v[232:235], v[104:107], v[164:167], 0
  v_mfma_f32_16x16x32_bf16 v[236:239], v[108:111], v[164:167], 0
  v_mfma_f32_16x16x16_bf16 v[208:211], v[128:129], v[168:169], v[208:211]
  v_mfma_f32_16x16x16_bf16 v[212:215], v[128:129], v[170:171], v[212:215]
  v_mfma_f32_16x16x16_bf16 v[216:219], v[130:131], v[168:169], v[216:219]
  v_mfma_f32_16x16x16_bf16 v[220:223], v[130:131], v[170:171], v[220:223]
  v_mfma_f32_16x16x16_bf16 v[224:227], v[132:133], v[168:169], v[224:227]
  v_mfma_f32_16x16x16_bf16 v[228:231], v[132:133], v[170:171], v[228:231]
  v_mfma_f32_16x16x16_bf16 v[232:235], v[134:135], v[168:169], v[232:235]
  v_mfma_f32_16x16x16_bf16 v[236:239], v[134:135], v[170:171], v[236:239]
  buffer_load_dwordx4 v[16:19], v2, s[4:7], s94 offen offset:0 sc1
  buffer_load_dwordx4 v[20:23], v2, s[4:7], s94 offen offset:1024 sc1
  buffer_load_dwordx4 v[24:27], v2, s[4:7], s94 offen offset:2048 sc1
  buffer_load_dwordx4 v[28:31], v2, s[4:7], s94 offen offset:3072 sc1
  buffer_load_dwordx4 v[32:35], v3, s[4:7], s94 offen offset:0 sc1
  buffer_load_dwordx4 v[36:39], v3, s[4:7], s94 offen offset:1024 sc1
  buffer_load_dwordx4 v[40:43], v3, s[4:7], s94 offen offset:2048 sc1
  buffer_load_dwordx4 v[44:47], v3, s[4:7], s94 offen offset:3072 sc1
  buffer_load_dwordx4 v[48:51], v2, s[4:7], s92 offen offset:0 sc1
  buffer_load_dwordx4 v[52:55], v2, s[4:7], s92 offen offset:1024 sc1
  buffer_load_dwordx4 v[56:59], v2, s[4:7], s92 offen offset:2048 sc1
  buffer_load_dwordx4 v[60:63], v2, s[4:7], s92 offen offset:3072 sc1
  buffer_load_dwordx4 v[64:67], v3, s[4:7], s92 offen offset:0 sc1
  buffer_load_dwordx4 v[68:71], v3, s[4:7], s92 offen offset:1024 sc1
  buffer_load_dwordx4 v[72:75], v3, s[4:7], s92 offen offset:2048 sc1
  buffer_load_dwordx4 v[76:79], v3, s[4:7], s92 offen offset:3072 sc1
  buffer_load_dwordx4 v[80:83], v8, s[4:7], s93 offen offset:0 sc1
  buffer_load_dwordx4 v[84:87], v8, s[4:7], s93 offen offset:128 sc1
  buffer_load_dwordx4 v[88:91], v8, s[4:7], s93 offen offset:1024 sc1
  buffer_load_dwordx4 v[92:95], v8, s[4:7], s93 offen offset:1152 sc1
  buffer_load_dwordx4 v[96:99], v9, s[4:7], s93 offen offset:0 sc1
  buffer_load_dwordx4 v[100:103], v9, s[4:7], s93 offen offset:128 sc1
  buffer_load_dwordx4 v[104:107], v9, s[4:7], s93 offen offset:1024 sc1
  buffer_load_dwordx4 v[108:111], v9, s[4:7], s93 offen offset:1152 sc1
  buffer_load_dwordx4 v[112:115], v4, s[4:7], s91 offen offset:0 sc1
  buffer_load_dwordx4 v[116:119], v4, s[4:7], s91 offen offset:512 sc1
  buffer_load_dwordx4 v[120:123], v4, s[4:7], s91 offen offset:1024 sc1
  buffer_load_dwordx4 v[124:127], v4, s[4:7], s91 offen offset:1536 sc1
  buffer_load_dwordx4 v[128:131], v5, s[4:7], s91 offen offset:0 sc1
  buffer_load_dwordx4 v[132:135], v5, s[4:7], s91 offen offset:1024 sc1
  s_add_u32 s92, s92, 262144
  s_add_u32 s93, s93, 262144
  s_add_u32 s94, s94, 262144
  s_add_u32 s91, s91, 65536
  v_cvt_pk_bf16_f32 v136, v176, v177
  v_cvt_pk_bf16_f32 v137, v178, v179
  v_cvt_pk_bf16_f32 v138, v184, v185
  v_cvt_pk_bf16_f32 v139, v186, v187
  buffer_store_dwordx4 v[136:139], v10, s[4:7], s95 offen offset:0 sc1
  v_cvt_pk_bf16_f32 v140, v180, v181
  v_cvt_pk_bf16_f32 v141, v182, v183
  v_cvt_pk_bf16_f32 v142, v188, v189
  v_cvt_pk_bf16_f32 v143, v190, v191
  buffer_store_dwordx4 v[140:143], v10, s[4:7], s95 offen offset:512 sc1
  v_cvt_pk_bf16_f32 v144, v192, v193
  v_cvt_pk_bf16_f32 v145, v194, v195
  v_cvt_pk_bf16_f32 v146, v200, v201
  v_cvt_pk_bf16_f32 v147, v202, v203
  buffer_store_dwordx4 v[144:147], v10, s[4:7], s95 offen offset:2048 sc1
  v_cvt_pk_bf16_f32 v148, v196, v197
  v_cvt_pk_bf16_f32 v149, v198, v199
  v_cvt_pk_bf16_f32 v150, v204, v205
  v_cvt_pk_bf16_f32 v151, v206, v207
  buffer_store_dwordx4 v[148:151], v10, s[4:7], s95 offen offset:2560 sc1
  v_cvt_pk_bf16_f32 v136, v208, v209
  v_cvt_pk_bf16_f32 v137, v210, v211
  v_cvt_pk_bf16_f32 v138, v216, v217
  v_cvt_pk_bf16_f32 v139, v218, v219
  buffer_store_dwordx4 v[136:139], v11, s[4:7], s95 offen offset:0 sc1
  v_cvt_pk_bf16_f32 v140, v212, v213
  v_cvt_pk_bf16_f32 v141, v214, v215
  v_cvt_pk_bf16_f32 v142, v220, v221
  v_cvt_pk_bf16_f32 v143, v222, v223
  buffer_store_dwordx4 v[140:143], v11, s[4:7], s95 offen offset:512 sc1
  v_cvt_pk_bf16_f32 v144, v224, v225
  v_cvt_pk_bf16_f32 v145, v226, v227
  v_cvt_pk_bf16_f32 v146, v232, v233
  v_cvt_pk_bf16_f32 v147, v234, v235
  buffer_store_dwordx4 v[144:147], v11, s[4:7], s95 offen offset:2048 sc1
  v_cvt_pk_bf16_f32 v148, v228, v229
  v_cvt_pk_bf16_f32 v149, v230, v231
  v_cvt_pk_bf16_f32 v150, v236, v237
  v_cvt_pk_bf16_f32 v151, v238, v239
  buffer_store_dwordx4 v[148:151], v11, s[4:7], s95 offen offset:2560 sc1
  s_add_u32 s95, s95, 262144
  s_waitcnt vmcnt(38)
  v_mfma_f32_16x16x32_bf16 v[136:139], a[96:99], a[0:3], 0
  v_mfma_f32_16x16x32_bf16 v[140:143], a[32:35], a[0:3], 0
  v_mfma_f32_16x16x32_bf16 v[144:147], a[96:99], a[16:19], 0
  v_mfma_f32_16x16x32_bf16 v[148:151], a[32:35], a[16:19], 0
  v_mfma_f32_16x16x32_bf16 v[152:155], a[48:51], a[16:19], 0
  v_mfma_f32_16x16x32_bf16 v[136:139], a[100:103], a[4:7], v[136:139]
  v_mfma_f32_16x16x32_bf16 v[140:143], a[36:39], a[4:7], v[140:143]
  v_mfma_f32_16x16x32_bf16 v[144:147], a[100:103], a[20:23], v[144:147]
  v_mfma_f32_16x16x32_bf16 v[148:151], a[36:39], a[20:23], v[148:151]
  v_mfma_f32_16x16x32_bf16 v[152:155], a[52:55], a[20:23], v[152:155]
  v_mfma_f32_16x16x32_bf16 v[136:139], a[104:107], a[8:11], v[136:139]
  v_mfma_f32_16x16x32_bf16 v[140:143], a[40:43], a[8:11], v[140:143]
  v_mfma_f32_16x16x32_bf16 v[144:147], a[104:107], a[24:27], v[144:147]
  v_mfma_f32_16x16x32_bf16 v[148:151], a[40:43], a[24:27], v[148:151]
  v_mfma_f32_16x16x32_bf16 v[152:155], a[56:59], a[24:27], v[152:155]
  v_mfma_f32_16x16x32_bf16 v[136:139], a[108:111], a[12:15], v[136:139]
  v_mfma_f32_16x16x32_bf16 v[140:143], a[44:47], a[12:15], v[140:143]
  v_mfma_f32_16x16x32_bf16 v[144:147], a[108:111], a[28:31], v[144:147]
  v_mfma_f32_16x16x32_bf16 v[148:151], a[44:47], a[28:31], v[148:151]
  v_mfma_f32_16x16x32_bf16 v[152:155], a[60:63], a[28:31], v[152:155]
  s_nop 4
  v_cndmask_b32 v140, v6, v140, s[40:41]
  v_cndmask_b32 v141, v6, v141, s[42:43]
  v_cndmask_b32 v142, v6, v142, s[44:45]
  v_cndmask_b32 v143, v6, v143, s[46:47]
  v_max3_f32 v12, v136, v137, v140
  v_max3_f32 v12, v12, v141, v142
  v_max_f32 v12, v12, v143
  v_mov_b32 v13, v12
  s_nop 1
  v_permlane32_swap_b32 v12, v13
  v_max_f32 v12, v12, v13
  v_mov_b32 v13, v12
  s_nop 1
  v_permlane16_swap_b32 v12, v13
  v_max_f32 v12, v12, v13
  v_mul_f32 v12, s50, v12
  v_fma_f32 v136, v136, s50, -v12
  v_fma_f32 v137, v137, s50, -v12
  v_fma_f32 v140, v140, s50, -v12
  v_fma_f32 v141, v141, s50, -v12
  v_fma_f32 v142, v142, s50, -v12
  v_fma_f32 v143, v143, s50, -v12
  v_exp_f32 v136, v136
  v_exp_f32 v137, v137
  v_exp_f32 v140, v140
  v_exp_f32 v141, v141
  v_exp_f32 v142, v142
  v_exp_f32 v143, v143
  v_add_f32 v12, v136, v137
  v_add_f32 v12, v12, v140
  v_add_f32 v12, v12, v141
  v_add_f32 v12, v12, v142
  v_add_f32 v12, v12, v143
  v_mov_b32 v13, v12
  s_nop 1
  v_permlane32_swap_b32 v12, v13
  v_add_f32 v12, v12, v13
  v_mov_b32 v13, v12
  s_nop 1
  v_permlane16_swap_b32 v12, v13
  v_add_f32 v12, v12, v13
  v_rcp_f32 v12, v12
  s_nop 0
  v_mul_f32 v136, v136, v12
  v_mul_f32 v137, v137, v12
  v_mul_f32 v140, v140, v12
  v_mul_f32 v141, v141, v12
  v_mul_f32 v142, v142, v12
  v_mul_f32 v143, v143, v12
  v_cvt_pk_bf16_f32 v160, v136, v137
  v_mov_b32 v161, 0
  v_mov_b32 v162, 0
  v_mov_b32 v163, v160
  v_cvt_pk_bf16_f32 v156, v140, v141
  v_cvt_pk_bf16_f32 v157, v142, v143
  v_mov_b32 v158, 0
  v_mov_b32 v159, 0
  v_cndmask_b32 v152, v6, v152, s[40:41]
  v_cndmask_b32 v153, v6, v153, s[42:43]
  v_cndmask_b32 v154, v6, v154, s[44:45]
  v_cndmask_b32 v155, v6, v155, s[46:47]
  v_max3_f32 v12, v144, v145, v148
  v_max3_f32 v12, v12, v149, v150
  v_max3_f32 v12, v12, v151, v152
  v_max3_f32 v12, v12, v153, v154
  v_max_f32 v12, v12, v155
  v_mov_b32 v13, v12
  s_nop 1
  v_permlane32_swap_b32 v12, v13
  v_max_f32 v12, v12, v13
  v_mov_b32 v13, v12
  s_nop 1
  v_permlane16_swap_b32 v12, v13
  v_max_f32 v12, v12, v13
  v_mul_f32 v12, s50, v12
  v_fma_f32 v144, v144, s50, -v12
  v_fma_f32 v145, v145, s50, -v12
  v_fma_f32 v148, v148, s50, -v12
  v_fma_f32 v149, v149, s50, -v12
  v_fma_f32 v150, v150, s50, -v12
  v_fma_f32 v151, v151, s50, -v12
  v_fma_f32 v152, v152, s50, -v12
  v_fma_f32 v153, v153, s50, -v12
  v_fma_f32 v154, v154, s50, -v12
  v_fma_f32 v155, v155, s50, -v12
  v_exp_f32 v144, v144
  v_exp_f32 v145, v145
  v_exp_f32 v148, v148
  v_exp_f32 v149, v149
  v_exp_f32 v150, v150
  v_exp_f32 v151, v151
  v_exp_f32 v152, v152
  v_exp_f32 v153, v153
  v_exp_f32 v154, v154
  v_exp_f32 v155, v155
  v_add_f32 v12, v144, v145
  v_add_f32 v12, v12, v148
  v_add_f32 v12, v12, v149
  v_add_f32 v12, v12, v150
  v_add_f32 v12, v12, v151
  v_add_f32 v12, v12, v152
  v_add_f32 v12, v12, v153
  v_add_f32 v12, v12, v154
  v_add_f32 v12, v12, v155
  v_mov_b32 v13, v12
  s_nop 1
  v_permlane32_swap_b32 v12, v13
  v_add_f32 v12, v12, v13
  v_mov_b32 v13, v12
  s_nop 1
  v_permlane16_swap_b32 v12, v13
  v_add_f32 v12, v12, v13
  v_rcp_f32 v12, v12
  s_nop 0
  v_mul_f32 v144, v144, v12
  v_mul_f32 v145, v145, v12
  v_mul_f32 v148, v148, v12
  v_mul_f32 v149, v149, v12
  v_mul_f32 v150, v150, v12
  v_mul_f32 v151, v151, v12
  v_mul_f32 v152, v152, v12
  v_mul_f32 v153, v153, v12
  v_mul_f32 v154, v154, v12
  v_mul_f32 v155, v155, v12
  v_cvt_pk_bf16_f32 v168, v144, v145
  v_mov_b32 v169, 0
  v_mov_b32 v170, 0
  v_mov_b32 v171, v168
  v_cvt_pk_bf16_f32 v164, v148, v149
  v_cvt_pk_bf16_f32 v165, v150, v151
  v_cvt_pk_bf16_f32 v166, v152, v153
  v_cvt_pk_bf16_f32 v167, v154, v155
  v_mfma_f32_16x16x32_bf16 v[176:179], a[64:67], v[156:159], 0
  v_mfma_f32_16x16x32_bf16 v[180:183], a[68:71], v[156:159], 0
  v_mfma_f32_16x16x32_bf16 v[184:187], a[72:75], v[156:159], 0
  v_mfma_f32_16x16x32_bf16 v[188:191], a[76:79], v[156:159], 0
  v_mfma_f32_16x16x32_bf16 v[192:195], a[80:83], v[156:159], 0
  v_mfma_f32_16x16x32_bf16 v[196:199], a[84:87], v[156:159], 0
  v_mfma_f32_16x16x32_bf16 v[200:203], a[88:91], v[156:159], 0
  v_mfma_f32_16x16x32_bf16 v[204:207], a[92:95], v[156:159], 0
  v_mfma_f32_16x16x16_bf16 v[176:179], a[112:113], v[160:161], v[176:179]
  v_mfma_f32_16x16x16_bf16 v[180:183], a[112:113], v[162:163], v[180:183]
  v_mfma_f32_16x16x16_bf16 v[184:187], a[114:115], v[160:161], v[184:187]
  v_mfma_f32_16x16x16_bf16 v[188:191], a[114:115], v[162:163], v[188:191]
  v_mfma_f32_16x16x16_bf16 v[192:195], a[116:117], v[160:161], v[192:195]
  v_mfma_f32_16x16x16_bf16 v[196:199], a[116:117], v[162:163], v[196:199]
  v_mfma_f32_16x16x16_bf16 v[200:203], a[118:119], v[160:161], v[200:203]
  v_mfma_f32_16x16x16_bf16 v[204:207], a[118:119], v[162:163], v[204:207]
  v_mfma_f32_16x16x32_bf16 v[208:211], a[64:67], v[164:167], 0
  v_mfma_f32_16x16x32_bf16 v[212:215], a[68:71], v[164:167], 0
  v_mfma_f32_16x16x32_bf16 v[216:219], a[72:75], v[164:167], 0
  v_mfma_f32_16x16x32_bf16 v[220:223], a[76:79], v[164:167], 0
  v_mfma_f32_16x16x32_bf16 v[224:227], a[80:83], v[164:167], 0
  v_mfma_f32_16x16x32_bf16 v[228:231], a[84:87], v[164:167], 0
  v_mfma_f32_16x16x32_bf16 v[232:235], a[88:91], v[164:167], 0
  v_mfma_f32_16x16x32_bf16 v[236:239], a[92:95], v[164:167], 0
  v_mfma_f32_16x16x16_bf16 v[208:211], a[112:113], v[168:169], v[208:211]
  v_mfma_f32_16x16x16_bf16 v[212:215], a[112:113], v[170:171], v[212:215]
  v_mfma_f32_16x16x16_bf16 v[216:219], a[114:115], v[168:169], v[216:219]
  v_mfma_f32_16x16x16_bf16 v[220:223], a[114:115], v[170:171], v[220:223]
  v_mfma_f32_16x16x16_bf16 v[224:227], a[116:117], v[168:169], v[224:227]
  v_mfma_f32_16x16x16_bf16 v[228:231], a[116:117], v[170:171], v[228:231]
  v_mfma_f32_16x16x16_bf16 v[232:235], a[118:119], v[168:169], v[232:235]
  v_mfma_f32_16x16x16_bf16 v[236:239], a[118:119], v[170:171], v[236:239]
  buffer_load_dwordx4 a[0:3], v2, s[4:7], s94 offen offset:0 sc1
  buffer_load_dwordx4 a[4:7], v2, s[4:7], s94 offen offset:1024 sc1
  buffer_load_dwordx4 a[8:11], v2, s[4:7], s94 offen offset:2048 sc1
  buffer_load_dwordx4 a[12:15], v2, s[4:7], s94 offen offset:3072 sc1
  buffer_load_dwordx4 a[16:19], v3, s[4:7], s94 offen offset:0 sc1
  buffer_load_dwordx4 a[20:23], v3, s[4:7], s94 offen offset:1024 sc1
  buffer_load_dwordx4 a[24:27], v3, s[4:7], s94 offen offset:2048 sc1
  buffer_load_dwordx4 a[28:31], v3, s[4:7], s94 offen offset:3072 sc1
  buffer_load_dwordx4 a[32:35], v2, s[4:7], s92 offen offset:0 sc1
  buffer_load_dwordx4 a[36:39], v2, s[4:7], s92 offen offset:1024 sc1
  buffer_load_dwordx4 a[40:43], v2, s[4:7], s92 offen offset:2048 sc1
  buffer_load_dwordx4 a[44:47], v2, s[4:7], s92 offen offset:3072 sc1
  buffer_load_dwordx4 a[48:51], v3, s[4:7], s92 offen offset:0 sc1
  buffer_load_dwordx4 a[52:55], v3, s[4:7], s92 offen offset:1024 sc1
  buffer_load_dwordx4 a[56:59], v3, s[4:7], s92 offen offset:2048 sc1
  buffer_load_dwordx4 a[60:63], v3, s[4:7], s92 offen offset:3072 sc1
  buffer_load_dwordx4 a[64:67], v8, s[4:7], s93 offen offset:0 sc1
  buffer_load_dwordx4 a[68:71], v8, s[4:7], s93 offen offset:128 sc1
  buffer_load_dwordx4 a[72:75], v8, s[4:7], s93 offen offset:1024 sc1
  buffer_load_dwordx4 a[76:79], v8, s[4:7], s93 offen offset:1152 sc1
  buffer_load_dwordx4 a[80:83], v9, s[4:7], s93 offen offset:0 sc1
  buffer_load_dwordx4 a[84:87], v9, s[4:7], s93 offen offset:128 sc1
  buffer_load_dwordx4 a[88:91], v9, s[4:7], s93 offen offset:1024 sc1
  buffer_load_dwordx4 a[92:95], v9, s[4:7], s93 offen offset:1152 sc1
  buffer_load_dwordx4 a[96:99], v4, s[4:7], s91 offen offset:0 sc1
  buffer_load_dwordx4 a[100:103], v4, s[4:7], s91 offen offset:512 sc1
  buffer_load_dwordx4 a[104:107], v4, s[4:7], s91 offen offset:1024 sc1
  buffer_load_dwordx4 a[108:111], v4, s[4:7], s91 offen offset:1536 sc1
  buffer_load_dwordx4 a[112:115], v5, s[4:7], s91 offen offset:0 sc1
  buffer_load_dwordx4 a[116:119], v5, s[4:7], s91 offen offset:1024 sc1
  s_add_u32 s92, s92, 262144
  s_add_u32 s93, s93, 262144
  s_add_u32 s94, s94, 262144
  s_add_u32 s91, s91, 65536
  v_cvt_pk_bf16_f32 v136, v176, v177
  v_cvt_pk_bf16_f32 v137, v178, v179
  v_cvt_pk_bf16_f32 v138, v184, v185
  v_cvt_pk_bf16_f32 v139, v186, v187
  buffer_store_dwordx4 v[136:139], v10, s[4:7], s95 offen offset:0 sc1
  v_cvt_pk_bf16_f32 v140, v180, v181
  v_cvt_pk_bf16_f32 v141, v182, v183
  v_cvt_pk_bf16_f32 v142, v188, v189
  v_cvt_pk_bf16_f32 v143, v190, v191
  buffer_store_dwordx4 v[140:143], v10, s[4:7], s95 offen offset:512 sc1
  v_cvt_pk_bf16_f32 v144, v192, v193
  v_cvt_pk_bf16_f32 v145, v194, v195
  v_cvt_pk_bf16_f32 v146, v200, v201
  v_cvt_pk_bf16_f32 v147, v202, v203
  buffer_store_dwordx4 v[144:147], v10, s[4:7], s95 offen offset:2048 sc1
  v_cvt_pk_bf16_f32 v148, v196, v197
  v_cvt_pk_bf16_f32 v149, v198, v199
  v_cvt_pk_bf16_f32 v150, v204, v205
  v_cvt_pk_bf16_f32 v151, v206, v207
  buffer_store_dwordx4 v[148:151], v10, s[4:7], s95 offen offset:2560 sc1
  v_cvt_pk_bf16_f32 v136, v208, v209
  v_cvt_pk_bf16_f32 v137, v210, v211
  v_cvt_pk_bf16_f32 v138, v216, v217
  v_cvt_pk_bf16_f32 v139, v218, v219
  buffer_store_dwordx4 v[136:139], v11, s[4:7], s95 offen offset:0 sc1
  v_cvt_pk_bf16_f32 v140, v212, v213
  v_cvt_pk_bf16_f32 v141, v214, v215
  v_cvt_pk_bf16_f32 v142, v220, v221
  v_cvt_pk_bf16_f32 v143, v222, v223
  buffer_store_dwordx4 v[140:143], v11, s[4:7], s95 offen offset:512 sc1
  v_cvt_pk_bf16_f32 v144, v224, v225
  v_cvt_pk_bf16_f32 v145, v226, v227
  v_cvt_pk_bf16_f32 v146, v232, v233
  v_cvt_pk_bf16_f32 v147, v234, v235
  buffer_store_dwordx4 v[144:147], v11, s[4:7], s95 offen offset:2048 sc1
  v_cvt_pk_bf16_f32 v148, v228, v229
  v_cvt_pk_bf16_f32 v149, v230, v231
  v_cvt_pk_bf16_f32 v150, v236, v237
  v_cvt_pk_bf16_f32 v151, v238, v239
  buffer_store_dwordx4 v[148:151], v11, s[4:7], s95 offen offset:2560 sc1
  s_add_u32 s95, s95, 262144
  s_waitcnt vmcnt(46)
  v_mfma_f32_16x16x32_bf16 v[136:139], v[112:115], v[16:19], 0
  v_mfma_f32_16x16x32_bf16 v[140:143], v[48:51], v[16:19], 0
  v_mfma_f32_16x16x32_bf16 v[144:147], v[112:115], v[32:35], 0
  v_mfma_f32_16x16x32_bf16 v[148:151], v[48:51], v[32:35], 0
  v_mfma_f32_16x16x32_bf16 v[152:155], v[64:67], v[32:35], 0
  v_mfma_f32_16x16x32_bf16 v[136:139], v[116:119], v[20:23], v[136:139]
  v_mfma_f32_16x16x32_bf16 v[140:143], v[52:55], v[20:23], v[140:143]
  v_mfma_f32_16x16x32_bf16 v[144:147], v[116:119], v[36:39], v[144:147]
  v_mfma_f32_16x16x32_bf16 v[148:151], v[52:55], v[36:39], v[148:151]
  v_mfma_f32_16x16x32_bf16 v[152:155], v[68:71], v[36:39], v[152:155]
  v_mfma_f32_16x16x32_bf16 v[136:139], v[120:123], v[24:27], v[136:139]
  v_mfma_f32_16x16x32_bf16 v[140:143], v[56:59], v[24:27], v[140:143]
  v_mfma_f32_16x16x32_bf16 v[144:147], v[120:123], v[40:43], v[144:147]
  v_mfma_f32_16x16x32_bf16 v[148:151], v[56:59], v[40:43], v[148:151]
  v_mfma_f32_16x16x32_bf16 v[152:155], v[72:75], v[40:43], v[152:155]
  v_mfma_f32_16x16x32_bf16 v[136:139], v[124:127], v[28:31], v[136:139]
  v_mfma_f32_16x16x32_bf16 v[140:143], v[60:63], v[28:31], v[140:143]
  v_mfma_f32_16x16x32_bf16 v[144:147], v[124:127], v[44:47], v[144:147]
  v_mfma_f32_16x16x32_bf16 v[148:151], v[60:63], v[44:47], v[148:151]
  v_mfma_f32_16x16x32_bf16 v[152:155], v[76:79], v[44:47], v[152:155]
  s_nop 4
  v_cndmask_b32 v140, v6, v140, s[40:41]
  v_cndmask_b32 v141, v6, v141, s[42:43]
  v_cndmask_b32 v142, v6, v142, s[44:45]
  v_cndmask_b32 v143, v6, v143, s[46:47]
  v_max3_f32 v12, v136, v137, v140
  v_max3_f32 v12, v12, v141, v142
  v_max_f32 v12, v12, v143
  v_mov_b32 v13, v12
  s_nop 1
  v_permlane32_swap_b32 v12, v13
  v_max_f32 v12, v12, v13
  v_mov_b32 v13, v12
  s_nop 1
  v_permlane16_swap_b32 v12, v13
  v_max_f32 v12, v12, v13
  v_mul_f32 v12, s50, v12
  v_fma_f32 v136, v136, s50, -v12
  v_fma_f32 v137, v137, s50, -v12
  v_fma_f32 v140, v140, s50, -v12
  v_fma_f32 v141, v141, s50, -v12
  v_fma_f32 v142, v142, s50, -v12
  v_fma_f32 v143, v143, s50, -v12
  v_exp_f32 v136, v136
  v_exp_f32 v137, v137
  v_exp_f32 v140, v140
  v_exp_f32 v141, v141
  v_exp_f32 v142, v142
  v_exp_f32 v143, v143
  v_add_f32 v12, v136, v137
  v_add_f32 v12, v12, v140
  v_add_f32 v12, v12, v141
  v_add_f32 v12, v12, v142
  v_add_f32 v12, v12, v143
  v_mov_b32 v13, v12
  s_nop 1
  v_permlane32_swap_b32 v12, v13
  v_add_f32 v12, v12, v13
  v_mov_b32 v13, v12
  s_nop 1
  v_permlane16_swap_b32 v12, v13
  v_add_f32 v12, v12, v13
  v_rcp_f32 v12, v12
  s_nop 0
  v_mul_f32 v136, v136, v12
  v_mul_f32 v137, v137, v12
  v_mul_f32 v140, v140, v12
  v_mul_f32 v141, v141, v12
  v_mul_f32 v142, v142, v12
  v_mul_f32 v143, v143, v12
  v_cvt_pk_bf16_f32 v160, v136, v137
  v_mov_b32 v161, 0
  v_mov_b32 v162, 0
  v_mov_b32 v163, v160
  v_cvt_pk_bf16_f32 v156, v140, v141
  v_cvt_pk_bf16_f32 v157, v142, v143
  v_mov_b32 v158, 0
  v_mov_b32 v159, 0
  v_cndmask_b32 v152, v6, v152, s[40:41]
  v_cndmask_b32 v153, v6, v153, s[42:43]
  v_cndmask_b32 v154, v6, v154, s[44:45]
  v_cndmask_b32 v155, v6, v155, s[46:47]
  v_max3_f32 v12, v144, v145, v148
  v_max3_f32 v12, v12, v149, v150
  v_max3_f32 v12, v12, v151, v152
  v_max3_f32 v12, v12, v153, v154
  v_max_f32 v12, v12, v155
  v_mov_b32 v13, v12
  s_nop 1
  v_permlane32_swap_b32 v12, v13
  v_max_f32 v12, v12, v13
  v_mov_b32 v13, v12
  s_nop 1
  v_permlane16_swap_b32 v12, v13
  v_max_f32 v12, v12, v13
  v_mul_f32 v12, s50, v12
  v_fma_f32 v144, v144, s50, -v12
  v_fma_f32 v145, v145, s50, -v12
  v_fma_f32 v148, v148, s50, -v12
  v_fma_f32 v149, v149, s50, -v12
  v_fma_f32 v150, v150, s50, -v12
  v_fma_f32 v151, v151, s50, -v12
  v_fma_f32 v152, v152, s50, -v12
  v_fma_f32 v153, v153, s50, -v12
  v_fma_f32 v154, v154, s50, -v12
  v_fma_f32 v155, v155, s50, -v12
  v_exp_f32 v144, v144
  v_exp_f32 v145, v145
  v_exp_f32 v148, v148
  v_exp_f32 v149, v149
  v_exp_f32 v150, v150
  v_exp_f32 v151, v151
  v_exp_f32 v152, v152
  v_exp_f32 v153, v153
  v_exp_f32 v154, v154
  v_exp_f32 v155, v155
  v_add_f32 v12, v144, v145
  v_add_f32 v12, v12, v148
  v_add_f32 v12, v12, v149
  v_add_f32 v12, v12, v150
  v_add_f32 v12, v12, v151
  v_add_f32 v12, v12, v152
  v_add_f32 v12, v12, v153
  v_add_f32 v12, v12, v154
  v_add_f32 v12, v12, v155
  v_mov_b32 v13, v12
  s_nop 1
  v_permlane32_swap_b32 v12, v13
  v_add_f32 v12, v12, v13
  v_mov_b32 v13, v12
  s_nop 1
  v_permlane16_swap_b32 v12, v13
  v_add_f32 v12, v12, v13
  v_rcp_f32 v12, v12
  s_nop 0
  v_mul_f32 v144, v144, v12
  v_mul_f32 v145, v145, v12
  v_mul_f32 v148, v148, v12
  v_mul_f32 v149, v149, v12
  v_mul_f32 v150, v150, v12
  v_mul_f32 v151, v151, v12
  v_mul_f32 v152, v152, v12
  v_mul_f32 v153, v153, v12
  v_mul_f32 v154, v154, v12
  v_mul_f32 v155, v155, v12
  v_cvt_pk_bf16_f32 v168, v144, v145
  v_mov_b32 v169, 0
  v_mov_b32 v170, 0
  v_mov_b32 v171, v168
  v_cvt_pk_bf16_f32 v164, v148, v149
  v_cvt_pk_bf16_f32 v165, v150, v151
  v_cvt_pk_bf16_f32 v166, v152, v153
  v_cvt_pk_bf16_f32 v167, v154, v155
  v_mfma_f32_16x16x32_bf16 v[176:179], v[80:83], v[156:159], 0
  v_mfma_f32_16x16x32_bf16 v[180:183], v[84:87], v[156:159], 0
  v_mfma_f32_16x16x32_bf16 v[184:187], v[88:91], v[156:159], 0
  v_mfma_f32_16x16x32_bf16 v[188:191], v[92:95], v[156:159], 0
  v_mfma_f32_16x16x32_bf16 v[192:195], v[96:99], v[156:159], 0
  v_mfma_f32_16x16x32_bf16 v[196:199], v[100:103], v[156:159], 0
  v_mfma_f32_16x16x32_bf16 v[200:203], v[104:107], v[156:159], 0
  v_mfma_f32_16x16x32_bf16 v[204:207], v[108:111], v[156:159], 0
  v_mfma_f32_16x16x16_bf16 v[176:179], v[128:129], v[160:161], v[176:179]
  v_mfma_f32_16x16x16_bf16 v[180:183], v[128:129], v[162:163], v[180:183]
  v_mfma_f32_16x16x16_bf16 v[184:187], v[130:131], v[160:161], v[184:187]
  v_mfma_f32_16x16x16_bf16 v[188:191], v[130:131], v[162:163], v[188:191]
  v_mfma_f32_16x16x16_bf16 v[192:195], v[132:133], v[160:161], v[192:195]
  v_mfma_f32_16x16x16_bf16 v[196:199], v[132:133], v[162:163], v[196:199]
  v_mfma_f32_16x16x16_bf16 v[200:203], v[134:135], v[160:161], v[200:203]
  v_mfma_f32_16x16x16_bf16 v[204:207], v[134:135], v[162:163], v[204:207]
  v_mfma_f32_16x16x32_bf16 v[208:211], v[80:83], v[164:167], 0
  v_mfma_f32_16x16x32_bf16 v[212:215], v[84:87], v[164:167], 0
  v_mfma_f32_16x16x32_bf16 v[216:219], v[88:91], v[164:167], 0
  v_mfma_f32_16x16x32_bf16 v[220:223], v[92:95], v[164:167], 0
  v_mfma_f32_16x16x32_bf16 v[224:227], v[96:99], v[164:167], 0
  v_mfma_f32_16x16x32_bf16 v[228:231], v[100:103], v[164:167], 0
  v_mfma_f32_16x16x32_bf16 v[232:235], v[104:107], v[164:167], 0
  v_mfma_f32_16x16x32_bf16 v[236:239], v[108:111], v[164:167], 0
  v_mfma_f32_16x16x16_bf16 v[208:211], v[128:129], v[168:169], v[208:211]
  v_mfma_f32_16x16x16_bf16 v[212:215], v[128:129], v[170:171], v[212:215]
  v_mfma_f32_16x16x16_bf16 v[216:219], v[130:131], v[168:169], v[216:219]
  v_mfma_f32_16x16x16_bf16 v[220:223], v[130:131], v[170:171], v[220:223]
  v_mfma_f32_16x16x16_bf16 v[224:227], v[132:133], v[168:169], v[224:227]
  v_mfma_f32_16x16x16_bf16 v[228:231], v[132:133], v[170:171], v[228:231]
  v_mfma_f32_16x16x16_bf16 v[232:235], v[134:135], v[168:169], v[232:235]
  v_mfma_f32_16x16x16_bf16 v[236:239], v[134:135], v[170:171], v[236:239]
  v_cvt_pk_bf16_f32 v136, v176, v177
  v_cvt_pk_bf16_f32 v137, v178, v179
  v_cvt_pk_bf16_f32 v138, v184, v185
  v_cvt_pk_bf16_f32 v139, v186, v187
  buffer_store_dwordx4 v[136:139], v10, s[4:7], s95 offen offset:0 sc1
  v_cvt_pk_bf16_f32 v140, v180, v181
  v_cvt_pk_bf16_f32 v141, v182, v183
  v_cvt_pk_bf16_f32 v142, v188, v189
  v_cvt_pk_bf16_f32 v143, v190, v191
  buffer_store_dwordx4 v[140:143], v10, s[4:7], s95 offen offset:512 sc1
  v_cvt_pk_bf16_f32 v144, v192, v193
  v_cvt_pk_bf16_f32 v145, v194, v195
  v_cvt_pk_bf16_f32 v146, v200, v201
  v_cvt_pk_bf16_f32 v147, v202, v203
  buffer_store_dwordx4 v[144:147], v10, s[4:7], s95 offen offset:2048 sc1
  v_cvt_pk_bf16_f32 v148, v196, v197
  v_cvt_pk_bf16_f32 v149, v198, v199
  v_cvt_pk_bf16_f32 v150, v204, v205
  v_cvt_pk_bf16_f32 v151, v206, v207
  buffer_store_dwordx4 v[148:151], v10, s[4:7], s95 offen offset:2560 sc1
  v_cvt_pk_bf16_f32 v136, v208, v209
  v_cvt_pk_bf16_f32 v137, v210, v211
  v_cvt_pk_bf16_f32 v138, v216, v217
  v_cvt_pk_bf16_f32 v139, v218, v219
  buffer_store_dwordx4 v[136:139], v11, s[4:7], s95 offen offset:0 sc1
  v_cvt_pk_bf16_f32 v140, v212, v213
  v_cvt_pk_bf16_f32 v141, v214, v215
  v_cvt_pk_bf16_f32 v142, v220, v221
  v_cvt_pk_bf16_f32 v143, v222, v223
  buffer_store_dwordx4 v[140:143], v11, s[4:7], s95 offen offset:512 sc1
  v_cvt_pk_bf16_f32 v144, v224, v225
  v_cvt_pk_bf16_f32 v145, v226, v227
  v_cvt_pk_bf16_f32 v146, v232, v233
  v_cvt_pk_bf16_f32 v147, v234, v235
  buffer_store_dwordx4 v[144:147], v11, s[4:7], s95 offen offset:2048 sc1
  v_cvt_pk_bf16_f32 v148, v228, v229
  v_cvt_pk_bf16_f32 v149, v230, v231
  v_cvt_pk_bf16_f32 v150, v236, v237
  v_cvt_pk_bf16_f32 v151, v238, v239
  buffer_store_dwordx4 v[148:151], v11, s[4:7], s95 offen offset:2560 sc1
  s_add_u32 s95, s95, 262144
  s_waitcnt vmcnt(16)
  s_cmp_lg_u32 s32, 0
  s_cbranch_scc1 L_rq_97
  s_cmp_eq_u32 s39, 0
  s_cbranch_scc1 L_rq_97
  s_lshl_b32 s99, s33, 7
  s_add_u32 s99, s99, 0x3d00200
  v_mov_b32 v244, 1
  v_mov_b32 v245, 0
  s_mov_b64 exec, 1
  buffer_atomic_add v244, v245, s[4:7], s99 offen sc0 sc1
  s_mov_b64 exec, -1
L_rq_97:
  v_mfma_f32_16x16x32_bf16 v[136:139], a[96:99], a[0:3], 0
  v_mfma_f32_16x16x32_bf16 v[140:143], a[32:35], a[0:3], 0
  v_mfma_f32_16x16x32_bf16 v[144:147], a[96:99], a[16:19], 0
  v_mfma_f32_16x16x32_bf16 v[148:151], a[32:35], a[16:19], 0
  v_mfma_f32_16x16x32_bf16 v[152:155], a[48:51], a[16:19], 0
  v_mfma_f32_16x16x32_bf16 v[136:139], a[100:103], a[4:7], v[136:139]
  v_mfma_f32_16x16x32_bf16 v[140:143], a[36:39], a[4:7], v[140:143]
  v_mfma_f32_16x16x32_bf16 v[144:147], a[100:103], a[20:23], v[144:147]
  v_mfma_f32_16x16x32_bf16 v[148:151], a[36:39], a[20:23], v[148:151]
  v_mfma_f32_16x16x32_bf16 v[152:155], a[52:55], a[20:23], v[152:155]
  v_mfma_f32_16x16x32_bf16 v[136:139], a[104:107], a[8:11], v[136:139]
  v_mfma_f32_16x16x32_bf16 v[140:143], a[40:43], a[8:11], v[140:143]
  v_mfma_f32_16x16x32_bf16 v[144:147], a[104:107], a[24:27], v[144:147]
  v_mfma_f32_16x16x32_bf16 v[148:151], a[40:43], a[24:27], v[148:151]
  v_mfma_f32_16x16x32_bf16 v[152:155], a[56:59], a[24:27], v[152:155]
  v_mfma_f32_16x16x32_bf16 v[136:139], a[108:111], a[12:15], v[136:139]
  v_mfma_f32_16x16x32_bf16 v[140:143], a[44:47], a[12:15], v[140:143]
  v_mfma_f32_16x16x32_bf16 v[144:147], a[108:111], a[28:31], v[144:147]
  v_mfma_f32_16x16x32_bf16 v[148:151], a[44:47], a[28:31], v[148:151]
  v_mfma_f32_16x16x32_bf16 v[152:155], a[60:63], a[28:31], v[152:155]
  s_nop 4
  v_cndmask_b32 v140, v6, v140, s[40:41]
  v_cndmask_b32 v141, v6, v141, s[42:43]
  v_cndmask_b32 v142, v6, v142, s[44:45]
  v_cndmask_b32 v143, v6, v143, s[46:47]
  v_max3_f32 v12, v136, v137, v140
  v_max3_f32 v12, v12, v141, v142
  v_max_f32 v12, v12, v143
  v_mov_b32 v13, v12
  s_nop 1
  v_permlane32_swap_b32 v12, v13
  v_max_f32 v12, v12, v13
  v_mov_b32 v13, v12
  s_nop 1
  v_permlane16_swap_b32 v12, v13
  v_max_f32 v12, v12, v13
  v_mul_f32 v12, s50, v12
  v_fma_f32 v136, v136, s50, -v12
  v_fma_f32 v137, v137, s50, -v12
  v_fma_f32 v140, v140, s50, -v12
  v_fma_f32 v141, v141, s50, -v12
  v_fma_f32 v142, v142, s50, -v12
  v_fma_f32 v143, v143, s50, -v12
  v_exp_f32 v136, v136
  v_exp_f32 v137, v137
  v_exp_f32 v140, v140
  v_exp_f32 v141, v141
  v_exp_f32 v142, v142
  v_exp_f32 v143, v143
  v_add_f32 v12, v136, v137
  v_add_f32 v12, v12, v140
  v_add_f32 v12, v12, v141
  v_add_f32 v12, v12, v142
  v_add_f32 v12, v12, v143
  v_mov_b32 v13, v12
  s_nop 1
  v_permlane32_swap_b32 v12, v13
  v_add_f32 v12, v12, v13
  v_mov_b32 v13, v12
  s_nop 1
  v_permlane16_swap_b32 v12, v13
  v_add_f32 v12, v12, v13
  v_rcp_f32 v12, v12
  s_nop 0
  v_mul_f32 v136, v136, v12
  v_mul_f32 v137, v137, v12
  v_mul_f32 v140, v140, v12
  v_mul_f32 v141, v141, v12
  v_mul_f32 v142, v142, v12
  v_mul_f32 v143, v143, v12
  v_cvt_pk_bf16_f32 v160, v136, v137
  v_mov_b32 v161, 0
  v_mov_b32 v162, 0
  v_mov_b32 v163, v160
  v_cvt_pk_bf16_f32 v156, v140, v141
  v_cvt_pk_bf16_f32 v157, v142, v143
  v_mov_b32 v158, 0
  v_mov_b32 v159, 0
  v_cndmask_b32 v152, v6, v152, s[40:41]
  v_cndmask_b32 v153, v6, v153, s[42:43]
  v_cndmask_b32 v154, v6, v154, s[44:45]
  v_cndmask_b32 v155, v6, v155, s[46:47]
  v_max3_f32 v12, v144, v145, v148
  v_max3_f32 v12, v12, v149, v150
  v_max3_f32 v12, v12, v151, v152
  v_max3_f32 v12, v12, v153, v154
  v_max_f32 v12, v12, v155
  v_mov_b32 v13, v12
  s_nop 1
  v_permlane32_swap_b32 v12, v13
  v_max_f32 v12, v12, v13
  v_mov_b32 v13, v12
  s_nop 1
  v_permlane16_swap_b32 v12, v13
  v_max_f32 v12, v12, v13
  v_mul_f32 v12, s50, v12
  v_fma_f32 v144, v144, s50, -v12
  v_fma_f32 v145, v145, s50, -v12
  v_fma_f32 v148, v148, s50, -v12
  v_fma_f32 v149, v149, s50, -v12
  v_fma_f32 v150, v150, s50, -v12
  v_fma_f32 v151, v151, s50, -v12
  v_fma_f32 v152, v152, s50, -v12
  v_fma_f32 v153, v153, s50, -v12
  v_fma_f32 v154, v154, s50, -v12
  v_fma_f32 v155, v155, s50, -v12
  v_exp_f32 v144, v144
  v_exp_f32 v145, v145
  v_exp_f32 v148, v148
  v_exp_f32 v149, v149
  v_exp_f32 v150, v150
  v_exp_f32 v151, v151
  v_exp_f32 v152, v152
  v_exp_f32 v153, v153
  v_exp_f32 v154, v154
  v_exp_f32 v155, v155
  v_add_f32 v12, v144, v145
  v_add_f32 v12, v12, v148
  v_add_f32 v12, v12, v149
  v_add_f32 v12, v12, v150
  v_add_f32 v12, v12, v151
  v_add_f32 v12, v12, v152
  v_add_f32 v12, v12, v153
  v_add_f32 v12, v12, v154
  v_add_f32 v12, v12, v155
  v_mov_b32 v13, v12
  s_nop 1
  v_permlane32_swap_b32 v12, v13
  v_add_f32 v12, v12, v13
  v_mov_b32 v13, v12
  s_nop 1
  v_permlane16_swap_b32 v12, v13
  v_add_f32 v12, v12, v13
  v_rcp_f32 v12, v12
  s_nop 0
  v_mul_f32 v144, v144, v12
  v_mul_f32 v145, v145, v12
  v_mul_f32 v148, v148, v12
  v_mul_f32 v149, v149, v12
  v_mul_f32 v150, v150, v12
  v_mul_f32 v151, v151, v12
  v_mul_f32 v152, v152, v12
  v_mul_f32 v153, v153, v12
  v_mul_f32 v154, v154, v12
  v_mul_f32 v155, v155, v12
  v_cvt_pk_bf16_f32 v168, v144, v145
  v_mov_b32 v169, 0
  v_mov_b32 v170, 0
  v_mov_b32 v171, v168
  v_cvt_pk_bf16_f32 v164, v148, v149
  v_cvt_pk_bf16_f32 v165, v150, v151
  v_cvt_pk_bf16_f32 v166, v152, v153
  v_cvt_pk_bf16_f32 v167, v154, v155
  v_mfma_f32_16x16x32_bf16 v[176:179], a[64:67], v[156:159], 0
  v_mfma_f32_16x16x32_bf16 v[180:183], a[68:71], v[156:159], 0
  v_mfma_f32_16x16x32_bf16 v[184:187], a[72:75], v[156:159], 0
  v_mfma_f32_16x16x32_bf16 v[188:191], a[76:79], v[156:159], 0
  v_mfma_f32_16x16x32_bf16 v[192:195], a[80:83], v[156:159], 0
  v_mfma_f32_16x16x32_bf16 v[196:199], a[84:87], v[156:159], 0
  v_mfma_f32_16x16x32_bf16 v[200:203], a[88:91], v[156:159], 0
  v_mfma_f32_16x16x32_bf16 v[204:207], a[92:95], v[156:159], 0
  v_mfma_f32_16x16x16_bf16 v[176:179], a[112:113], v[160:161], v[176:179]
  v_mfma_f32_16x16x16_bf16 v[180:183], a[112:113], v[162:163], v[180:183]
  v_mfma_f32_16x16x16_bf16 v[184:187], a[114:115], v[160:161], v[184:187]
  v_mfma_f32_16x16x16_bf16 v[188:191], a[114:115], v[162:163], v[188:191]
  v_mfma_f32_16x16x16_bf16 v[192:195], a[116:117], v[160:161], v[192:195]
  v_mfma_f32_16x16x16_bf16 v[196:199], a[116:117], v[162:163], v[196:199]
  v_mfma_f32_16x16x16_bf16 v[200:203], a[118:119], v[160:161], v[200:203]
  v_mfma_f32_16x16x16_bf16 v[204:207], a[118:119], v[162:163], v[204:207]
  v_mfma_f32_16x16x32_bf16 v[208:211], a[64:67], v[164:167], 0
  v_mfma_f32_16x16x32_bf16 v[212:215], a[68:71], v[164:167], 0
  v_mfma_f32_16x16x32_bf16 v[216:219], a[72:75], v[164:167], 0
  v_mfma_f32_16x16x32_bf16 v[220:223], a[76:79], v[164:167], 0
  v_mfma_f32_16x16x32_bf16 v[224:227], a[80:83], v[164:167], 0
  v_mfma_f32_16x16x32_bf16 v[228:231], a[84:87], v[164:167], 0
  v_mfma_f32_16x16x32_bf16 v[232:235], a[88:91], v[164:167], 0
  v_mfma_f32_16x16x32_bf16 v[236:239], a[92:95], v[164:167], 0
  v_mfma_f32_16x16x16_bf16 v[208:211], a[112:113], v[168:169], v[208:211]
  v_mfma_f32_16x16x16_bf16 v[212:215], a[112:113], v[170:171], v[212:215]
  v_mfma_f32_16x16x16_bf16 v[216:219], a[114:115], v[168:169], v[216:219]
  v_mfma_f32_16x16x16_bf16 v[220:223], a[114:115], v[170:171], v[220:223]
  v_mfma_f32_16x16x16_bf16 v[224:227], a[116:117], v[168:169], v[224:227]
  v_mfma_f32_16x16x16_bf16 v[228:231], a[116:117], v[170:171], v[228:231]
  v_mfma_f32_16x16x16_bf16 v[232:235], a[118:119], v[168:169], v[232:235]
  v_mfma_f32_16x16x16_bf16 v[236:239], a[118:119], v[170:171], v[236:239]
  v_cvt_pk_bf16_f32 v136, v176, v177
  v_cvt_pk_bf16_f32 v137, v178, v179
  v_cvt_pk_bf16_f32 v138, v184, v185
  v_cvt_pk_bf16_f32 v139, v186, v187
  buffer_store_dwordx4 v[136:139], v10, s[4:7], s95 offen offset:0 sc1
  v_cvt_pk_bf16_f32 v140, v180, v181
  v_cvt_pk_bf16_f32 v141, v182, v183
  v_cvt_pk_bf16_f32 v142, v188, v189
  v_cvt_pk_bf16_f32 v143, v190, v191
  buffer_store_dwordx4 v[140:143], v10, s[4:7], s95 offen offset:512 sc1
  v_cvt_pk_bf16_f32 v144, v192, v193
  v_cvt_pk_bf16_f32 v145, v194, v195
  v_cvt_pk_bf16_f32 v146, v200, v201
  v_cvt_pk_bf16_f32 v147, v202, v203
  buffer_store_dwordx4 v[144:147], v10, s[4:7], s95 offen offset:2048 sc1
  v_cvt_pk_bf16_f32 v148, v196, v197
  v_cvt_pk_bf16_f32 v149, v198, v199
  v_cvt_pk_bf16_f32 v150, v204, v205
  v_cvt_pk_bf16_f32 v151, v206, v207
  buffer_store_dwordx4 v[148:151], v10, s[4:7], s95 offen offset:2560 sc1
  v_cvt_pk_bf16_f32 v136, v208, v209
  v_cvt_pk_bf16_f32 v137, v210, v211
  v_cvt_pk_bf16_f32 v138, v216, v217
  v_cvt_pk_bf16_f32 v139, v218, v219
  buffer_store_dwordx4 v[136:139], v11, s[4:7], s95 offen offset:0 sc1
  v_cvt_pk_bf16_f32 v140, v212, v213
  v_cvt_pk_bf16_f32 v141, v214, v215
  v_cvt_pk_bf16_f32 v142, v220, v221
  v_cvt_pk_bf16_f32 v143, v222, v223
  buffer_store_dwordx4 v[140:143], v11, s[4:7], s95 offen offset:512 sc1
  v_cvt_pk_bf16_f32 v144, v224, v225
  v_cvt_pk_bf16_f32 v145, v226, v227
  v_cvt_pk_bf16_f32 v146, v232, v233
  v_cvt_pk_bf16_f32 v147, v234, v235
  buffer_store_dwordx4 v[144:147], v11, s[4:7], s95 offen offset:2048 sc1
  v_cvt_pk_bf16_f32 v148, v228, v229
  v_cvt_pk_bf16_f32 v149, v230, v231
  v_cvt_pk_bf16_f32 v150, v236, v237
  v_cvt_pk_bf16_f32 v151, v238, v239
  buffer_store_dwordx4 v[148:151], v11, s[4:7], s95 offen offset:2560 sc1
  s_add_u32 s95, s95, 262144
  s_branch L_done
L_bo:
  s_lshr_b32 s40, s36, 1
  s_lshl_b32 s40, s40, 7
  s_add_u32 s40, s40, 1024
  s_mov_b32 s41, 16
  s_mov_b32 s12, s82
  s_and_b32 s13, s83, 0xffff
  s_mov_b32 s14, 0x200000
  s_mov_b32 s15, 0x20000
  s_mov_b32 s23, 65536
  s_mov_b32 s25, 4
  s_lshl_b32 s20, s36, 18
  s_add_u32 s20, s20, 0x6000000
  s_mov_b32 s22, 2048
  s_branch L_g3
L_aos:
  s_mov_b32 s12, s74
  s_and_b32 s13, s75, 0xffff
  s_mov_b32 s14, 0x800000
  s_mov_b32 s15, 0x20000
  s_and_b32 s48, s37, 7
  s_lshr_b32 s37, s37, 3
  s_sub_u32 s40, s36, 12
  s_lshl_b32 s40, s40, 4
  s_add_u32 s40, s40, s48
  s_lshl_b32 s40, s40, 7
  s_add_u32 s40, s40, 20480
  s_mov_b32 s41, 2
  s_add_u32 s42, s40, 1024
  s_mov_b32 s23, 262144
  s_mov_b32 s25, 2
  s_lshl_b32 s20, s36, 20
  s_add_u32 s20, s20, 0x5000000
  s_lshl_b32 s90, s48, 15
  s_add_u32 s20, s20, s90
  s_mov_b32 s22, 0
  s_lshl_b32 s49, s48, 20
  s_branch L_g3b
L_ao4:
  s_lshl_b32 s40, s36, 7
  s_add_u32 s40, s40, 2048
  s_mov_b32 s41, 32
  s_mov_b32 s42, s40
  s_mov_b32 s12, s74
  s_and_b32 s13, s75, 0xffff
  s_mov_b32 s14, 0x800000
  s_mov_b32 s15, 0x20000
  s_and_b32 s48, s37, 3
  s_lshr_b32 s37, s37, 2
  s_mov_b32 s23, 262144
  s_mov_b32 s25, 4
  s_lshl_b32 s20, s36, 20
  s_add_u32 s20, s20, 0x5000000
  s_lshl_b32 s90, s48, 16
  s_add_u32 s20, s20, s90
  s_mov_b32 s22, 0
  s_lshl_b32 s49, s48, 21
  s_branch L_g3b
L_ao:
  s_lshl_b32 s40, s36, 7
  s_add_u32 s40, s40, 2048
  s_mov_b32 s41, 32
  s_mov_b32 s12, s74
  s_and_b32 s13, s75, 0xffff
  s_mov_b32 s14, 0x800000
  s_mov_b32 s15, 0x20000
  s_mov_b32 s23, 262144
  s_mov_b32 s25, 16
  s_lshl_b32 s20, s36, 20
  s_add_u32 s20, s20, 0x5000000
  s_mov_b32 s22, 0
L_g3:
  s_mov_b32 s49, 0
  s_mov_b32 s42, s40
L_g3b:
  s_mov_b32 s8, s4
  s_and_b32 s9, s5, 0xffff
  s_mov_b32 s10, 0x10000000
  s_mov_b32 s11, 0x20000
  s_lshl_b32 s91, s33, 1
  s_add_u32 s91, s91, s37
  s_mov_b32 s24, 2048
  s_mov_b32 s26, 4096
  s_lshl_b32 s21, s91, 8
  s_add_u32 s22, s22, s21
  s_lshl_b32 s90, s36, 19
  s_add_u32 s22, s22, s90
  s_add_u32 s21, s21, s49
  s_mov_b32 s50, s91
  v_and_b32 v1, 63, v0
  v_lshrrev_b32 v16, 6, v0
  s_nop 0
  v_readfirstlane_b32 s27, v16
  s_mul_i32 s90, s27, 1
  s_mul_i32 s90, s90, s23
  v_mov_b32 v2, 0x0
  v_bfe_u32 v17, v1, 0, 6
  v_lshl_add_u32 v2, v17, 4, v2
  v_add_u32 v2, s90, v2
  v_mov_b32 v3, 0x400
  v_bfe_u32 v17, v1, 0, 6
  v_lshl_add_u32 v3, v17, 4, v3
  v_add_u32 v3, s90, v3
  v_mov_b32 v4, 0x1000
  v_bfe_u32 v17, v1, 0, 6
  v_lshl_add_u32 v4, v17, 4, v4
  v_add_u32 v4, s90, v4
  v_mov_b32 v5, 0x1400
  v_bfe_u32 v17, v1, 0, 6
  v_lshl_add_u32 v5, v17, 4, v5
  v_add_u32 v5, s90, v5
  s_mul_i32 s90, s27, 16
  v_lshrrev_b32 v16, 4, v1
  v_add_u32 v16, 0, v16
  v_add_u32 v16, s90, v16
  v_and_b32 v17, 7, v16
  v_lshlrev_b32 v17, 1, v17
  v_xor_b32 v17, v17, v1
  v_and_b32 v17, 15, v17
  v_mul_lo_u32 v16, v16, s24
  v_lshl_add_u32 v6, v17, 4, v16
  v_lshrrev_b32 v16, 4, v1
  v_add_u32 v16, 4, v16
  v_add_u32 v16, s90, v16
  v_and_b32 v17, 7, v16
  v_lshlrev_b32 v17, 1, v17
  v_xor_b32 v17, v17, v1
  v_and_b32 v17, 15, v17
  v_mul_lo_u32 v16, v16, s24
  v_lshl_add_u32 v7, v17, 4, v16
  v_lshrrev_b32 v16, 4, v1
  v_add_u32 v16, 8, v16
  v_add_u32 v16, s90, v16
  v_and_b32 v17, 7, v16
  v_lshlrev_b32 v17, 1, v17
  v_xor_b32 v17, v17, v1
  v_and_b32 v17, 15, v17
  v_mul_lo_u32 v16, v16, s24
  v_lshl_add_u32 v8, v17, 4, v16
  v_lshrrev_b32 v16, 4, v1
  v_add_u32 v16, 12, v16
  v_add_u32 v16, s90, v16
  v_and_b32 v17, 7, v16
  v_lshlrev_b32 v17, 1, v17
  v_xor_b32 v17, v17, v1
  v_and_b32 v17, 15, v17
  v_mul_lo_u32 v16, v16, s24
  v_lshl_add_u32 v9, v17, 4, v16
  s_mul_i32 s51, s24, 64
  s_mul_i32 s52, s27, 4096
  s_mul_i32 s53, s27, 4096
  s_add_u32 s53, s53, 16384
  s_add_u32 m0, s53, 0
  s_nop 0
  buffer_load_dwordx4 v6, s[12:15], s21 offen  lds
  s_add_u32 m0, s53, 1024
  s_nop 0
  buffer_load_dwordx4 v7, s[12:15], s21 offen  lds
  s_add_u32 m0, s53, 2048
  s_nop 0
  buffer_load_dwordx4 v8, s[12:15], s21 offen  lds
  s_add_u32 m0, s53, 3072
  s_nop 0
  buffer_load_dwordx4 v9, s[12:15], s21 offen  lds
  s_add_u32 s21, s21, s51
  s_add_u32 m0, s53, 32768
  s_nop 0
  buffer_load_dwordx4 v6, s[12:15], s21 offen  lds
  s_add_u32 m0, s53, 33792
  s_nop 0
  buffer_load_dwordx4 v7, s[12:15], s21 offen  lds
  s_add_u32 m0, s53, 34816
  s_nop 0
  buffer_load_dwordx4 v8, s[12:15], s21 offen  lds
  s_add_u32 m0, s53, 35840
  s_nop 0
  buffer_load_dwordx4 v9, s[12:15], s21 offen  lds
  s_add_u32 s21, s21, s51
  s_add_u32 m0, s53, 65536
  s_nop 0
  buffer_load_dwordx4 v6, s[12:15], s21 offen  lds
  s_add_u32 m0, s53, 66560
  s_nop 0
  buffer_load_dwordx4 v7, s[12:15], s21 offen  lds
  s_add_u32 m0, s53, 67584
  s_nop 0
  buffer_load_dwordx4 v8, s[12:15], s21 offen  lds
  s_add_u32 m0, s53, 68608
  s_nop 0
  buffer_load_dwordx4 v9, s[12:15], s21 offen  lds
  s_add_u32 s21, s21, s51
  s_add_u32 m0, s53, 98304
  s_nop 0
  buffer_load_dwordx4 v6, s[12:15], s21 offen  lds
  s_add_u32 m0, s53, 99328
  s_nop 0
  buffer_load_dwordx4 v7, s[12:15], s21 offen  lds
  s_add_u32 m0, s53, 100352
  s_nop 0
  buffer_load_dwordx4 v8, s[12:15], s21 offen  lds
  s_add_u32 m0, s53, 101376
  s_nop 0
  buffer_load_dwordx4 v9, s[12:15], s21 offen  lds
  s_add_u32 s21, s21, s51
  s_cmp_lg_u32 s32, 0
  s_cbranch_scc1 L_dd_99
  v_mov_b32 v228, 0x3d00000
L_dw_98:
  buffer_load_dword v234, v228, s[4:7], s40 offen offset:0 sc1
  buffer_load_dword v235, v228, s[4:7], s42 offen offset:0 sc1
  s_waitcnt vmcnt(0)
  s_mov_b32 s44, 1
  v_readfirstlane_b32 s45, v234
  s_cmp_ge_u32 s45, s41
  s_cselect_b32 s44, s44, 0
  v_readfirstlane_b32 s45, v235
  s_cmp_ge_u32 s45, s41
  s_cselect_b32 s44, s44, 0
  s_cmp_eq_u32 s44, 1
  s_cbranch_scc1 L_dd_99
  s_sleep 3
  s_add_u32 s3, s3, 1
  s_cmp_lt_u32 s3, 131072
  s_cbranch_scc1 L_dw_98
L_dd_99:
  s_barrier
  s_add_u32 m0, s52, 0
  s_nop 0
  buffer_load_dwordx4 v2, s[8:11], s20 offen sc1 lds
  s_add_u32 m0, s52, 1024
  s_nop 0
  buffer_load_dwordx4 v3, s[8:11], s20 offen sc1 lds
  s_add_u32 m0, s52, 2048
  s_nop 0
  buffer_load_dwordx4 v4, s[8:11], s20 offen sc1 lds
  s_add_u32 m0, s52, 3072
  s_nop 0
  buffer_load_dwordx4 v5, s[8:11], s20 offen sc1 lds
  s_add_u32 s20, s20, 2048
  s_add_u32 m0, s52, 32768
  s_nop 0
  buffer_load_dwordx4 v2, s[8:11], s20 offen sc1 lds
  s_add_u32 m0, s52, 33792
  s_nop 0
  buffer_load_dwordx4 v3, s[8:11], s20 offen sc1 lds
  s_add_u32 m0, s52, 34816
  s_nop 0
  buffer_load_dwordx4 v4, s[8:11], s20 offen sc1 lds
  s_add_u32 m0, s52, 35840
  s_nop 0
  buffer_load_dwordx4 v5, s[8:11], s20 offen sc1 lds
  s_add_u32 s20, s20, 6144
  s_add_u32 m0, s52, 65536
  s_nop 0
  buffer_load_dwordx4 v2, s[8:11], s20 offen sc1 lds
  s_add_u32 m0, s52, 66560
  s_nop 0
  buffer_load_dwordx4 v3, s[8:11], s20 offen sc1 lds
  s_add_u32 m0, s52, 67584
  s_nop 0
  buffer_load_dwordx4 v4, s[8:11], s20 offen sc1 lds
  s_add_u32 m0, s52, 68608
  s_nop 0
  buffer_load_dwordx4 v5, s[8:11], s20 offen sc1 lds
  s_add_u32 s20, s20, 2048
  s_add_u32 m0, s52, 98304
  s_nop 0
  buffer_load_dwordx4 v2, s[8:11], s20 offen sc1 lds
  s_add_u32 m0, s52, 99328
  s_nop 0
  buffer_load_dwordx4 v3, s[8:11], s20 offen sc1 lds
  s_add_u32 m0, s52, 100352
  s_nop 0
  buffer_load_dwordx4 v4, s[8:11], s20 offen sc1 lds
  s_add_u32 m0, s52, 101376
  s_nop 0
  buffer_load_dwordx4 v5, s[8:11], s20 offen sc1 lds
  s_add_u32 s20, s20, 6144
  s_lshr_b32 s90, s27, 1
  s_and_b32 s91, s27, 1
  s_mul_i32 s92, s90, 8192
  v_mov_b32 v10, 0x0
  v_bfe_u32 v17, v1, 0, 6
  v_lshl_add_u32 v10, v17, 4, v10
  v_add_u32 v10, s92, v10
  v_add_u32 v11, 65536, v10
  v_mov_b32 v16, 0x0
  v_bfe_u32 v17, v1, 2, 2
  v_lshl_add_u32 v16, v17, 8, v16
  v_bfe_u32 v17, v1, 4, 2
  v_lshl_add_u32 v16, v17, 10, v16
  v_bfe_u32 v17, v1, 0, 1
  v_lshl_add_u32 v16, v17, 4, v16
  v_bfe_u32 v18, v1, 2, 3
  v_bfe_u32 v17, v1, 1, 1
  v_xor_b32 v18, v18, v17
  s_mul_i32 s92, s91, 4
  s_add_u32 s93, s92, 0
  v_xor_b32 v17, s93, v18
  v_lshl_add_u32 v12, v17, 5, v16
  v_add_u32 v14, 65536, v12
  s_add_u32 s93, s92, 2
  v_xor_b32 v17, s93, v18
  v_lshl_add_u32 v13, v17, 5, v16
  v_add_u32 v15, 65536, v13
  s_waitcnt vmcnt(12)
  s_barrier
  ds_read_b128 v[20:23], v10 offset:0
  ds_read_b64_tr_b16 v[52:53], v12 offset:16384
  ds_read_b64_tr_b16 v[54:55], v12 offset:20480
  ds_read_b128 v[24:27], v10 offset:2048
  ds_read_b64_tr_b16 v[56:57], v12 offset:16392
  ds_read_b64_tr_b16 v[58:59], v12 offset:20488
  ds_read_b128 v[28:31], v10 offset:4096
  ds_read_b64_tr_b16 v[60:61], v13 offset:16384
  ds_read_b64_tr_b16 v[62:63], v13 offset:20480
  ds_read_b128 v[32:35], v10 offset:6144
  ds_read_b64_tr_b16 v[64:65], v13 offset:16392
  ds_read_b64_tr_b16 v[66:67], v13 offset:20488
  s_sub_u32 s25, s25, 1
  s_waitcnt lgkmcnt(0)
  v_mfma_f32_16x16x32_bf16 a[0:3], v[52:55], v[20:23], 0
  ds_read_b128 v[36:39], v10 offset:1024
  v_mfma_f32_16x16x32_bf16 a[4:7], v[56:59], v[20:23], 0
  ds_read_b64_tr_b16 v[68:69], v12 offset:24576
  v_mfma_f32_16x16x32_bf16 a[8:11], v[60:63], v[20:23], 0
  ds_read_b64_tr_b16 v[70:71], v12 offset:28672
  v_mfma_f32_16x16x32_bf16 a[12:15], v[64:67], v[20:23], 0
  ds_read_b128 v[40:43], v10 offset:3072
  v_mfma_f32_16x16x32_bf16 a[16:19], v[52:55], v[24:27], 0
  ds_read_b64_tr_b16 v[72:73], v12 offset:24584
  v_mfma_f32_16x16x32_bf16 a[20:23], v[56:59], v[24:27], 0
  ds_read_b64_tr_b16 v[74:75], v12 offset:28680
  v_mfma_f32_16x16x32_bf16 a[24:27], v[60:63], v[24:27], 0
  ds_read_b128 v[44:47], v10 offset:5120
  v_mfma_f32_16x16x32_bf16 a[28:31], v[64:67], v[24:27], 0
  ds_read_b64_tr_b16 v[76:77], v13 offset:24576
  v_mfma_f32_16x16x32_bf16 a[32:35], v[52:55], v[28:31], 0
  ds_read_b64_tr_b16 v[78:79], v13 offset:28672
  v_mfma_f32_16x16x32_bf16 a[36:39], v[56:59], v[28:31], 0
  ds_read_b128 v[48:51], v10 offset:7168
  v_mfma_f32_16x16x32_bf16 a[40:43], v[60:63], v[28:31], 0
  ds_read_b64_tr_b16 v[80:81], v13 offset:24584
  v_mfma_f32_16x16x32_bf16 a[44:47], v[64:67], v[28:31], 0
  ds_read_b64_tr_b16 v[82:83], v13 offset:28680
  v_mfma_f32_16x16x32_bf16 a[48:51], v[52:55], v[32:35], 0
  v_mfma_f32_16x16x32_bf16 a[52:55], v[56:59], v[32:35], 0
  v_mfma_f32_16x16x32_bf16 a[56:59], v[60:63], v[32:35], 0
  v_mfma_f32_16x16x32_bf16 a[60:63], v[64:67], v[32:35], 0
  s_waitcnt lgkmcnt(0)
  v_mfma_f32_16x16x32_bf16 a[0:3], v[68:71], v[36:39], a[0:3]
  s_waitcnt vmcnt(8)
  s_barrier
  s_add_u32 m0, s52, 0
  v_mfma_f32_16x16x32_bf16 a[4:7], v[72:75], v[36:39], a[4:7]
  buffer_load_dwordx4 v2, s[8:11], s20 offen sc1 lds
  ds_read_b128 v[20:23], v10 offset:32768
  v_mfma_f32_16x16x32_bf16 a[8:11], v[76:79], v[36:39], a[8:11]
  ds_read_b64_tr_b16 v[52:53], v12 offset:49152
  v_mfma_f32_16x16x32_bf16 a[12:15], v[80:83], v[36:39], a[12:15]
  ds_read_b64_tr_b16 v[54:55], v12 offset:53248
  s_add_u32 m0, s53, 0
  v_mfma_f32_16x16x32_bf16 a[16:19], v[68:71], v[40:43], a[16:19]
  buffer_load_dwordx4 v6, s[12:15], s21 offen  lds
  ds_read_b128 v[24:27], v10 offset:34816
  v_mfma_f32_16x16x32_bf16 a[20:23], v[72:75], v[40:43], a[20:23]
  ds_read_b64_tr_b16 v[56:57], v12 offset:49160
  v_mfma_f32_16x16x32_bf16 a[24:27], v[76:79], v[40:43], a[24:27]
  ds_read_b64_tr_b16 v[58:59], v12 offset:53256
  s_add_u32 m0, s52, 1024
  v_mfma_f32_16x16x32_bf16 a[28:31], v[80:83], v[40:43], a[28:31]
  buffer_load_dwordx4 v3, s[8:11], s20 offen sc1 lds
  ds_read_b128 v[28:31], v10 offset:36864
  v_mfma_f32_16x16x32_bf16 a[32:35], v[68:71], v[44:47], a[32:35]
  ds_read_b64_tr_b16 v[60:61], v13 offset:49152
  v_mfma_f32_16x16x32_bf16 a[36:39], v[72:75], v[44:47], a[36:39]
  ds_read_b64_tr_b16 v[62:63], v13 offset:53248
  s_add_u32 m0, s53, 1024
  v_mfma_f32_16x16x32_bf16 a[40:43], v[76:79], v[44:47], a[40:43]
  buffer_load_dwordx4 v7, s[12:15], s21 offen  lds
  ds_read_b128 v[32:35], v10 offset:38912
  v_mfma_f32_16x16x32_bf16 a[44:47], v[80:83], v[44:47], a[44:47]
  ds_read_b64_tr_b16 v[64:65], v13 offset:49160
  v_mfma_f32_16x16x32_bf16 a[48:51], v[68:71], v[48:51], a[48:51]
  ds_read_b64_tr_b16 v[66:67], v13 offset:53256
  s_add_u32 m0, s52, 2048
  v_mfma_f32_16x16x32_bf16 a[52:55], v[72:75], v[48:51], a[52:55]
  buffer_load_dwordx4 v4, s[8:11], s20 offen sc1 lds
  v_mfma_f32_16x16x32_bf16 a[56:59], v[76:79], v[48:51], a[56:59]
  v_mfma_f32_16x16x32_bf16 a[60:63], v[80:83], v[48:51], a[60:63]
  s_waitcnt lgkmcnt(0)
  s_add_u32 m0, s53, 2048
  v_mfma_f32_16x16x32_bf16 a[0:3], v[52:55], v[20:23], a[0:3]
  buffer_load_dwordx4 v8, s[12:15], s21 offen  lds
  ds_read_b128 v[36:39], v10 offset:33792
  v_mfma_f32_16x16x32_bf16 a[4:7], v[56:59], v[20:23], a[4:7]
  ds_read_b64_tr_b16 v[68:69], v12 offset:57344
  v_mfma_f32_16x16x32_bf16 a[8:11], v[60:63], v[20:23], a[8:11]
  ds_read_b64_tr_b16 v[70:71], v12 offset:61440
  v_mfma_f32_16x16x32_bf16 a[12:15], v[64:67], v[20:23], a[12:15]
  ds_read_b128 v[40:43], v10 offset:35840
  s_add_u32 m0, s52, 3072
  v_mfma_f32_16x16x32_bf16 a[16:19], v[52:55], v[24:27], a[16:19]
  buffer_load_dwordx4 v5, s[8:11], s20 offen sc1 lds
  ds_read_b64_tr_b16 v[72:73], v12 offset:57352
  v_mfma_f32_16x16x32_bf16 a[20:23], v[56:59], v[24:27], a[20:23]
  ds_read_b64_tr_b16 v[74:75], v12 offset:61448
  v_mfma_f32_16x16x32_bf16 a[24:27], v[60:63], v[24:27], a[24:27]
  ds_read_b128 v[44:47], v10 offset:37888
  v_mfma_f32_16x16x32_bf16 a[28:31], v[64:67], v[24:27], a[28:31]
  ds_read_b64_tr_b16 v[76:77], v13 offset:57344
  s_add_u32 m0, s53, 3072
  v_mfma_f32_16x16x32_bf16 a[32:35], v[52:55], v[28:31], a[32:35]
  buffer_load_dwordx4 v9, s[12:15], s21 offen  lds
  ds_read_b64_tr_b16 v[78:79], v13 offset:61440
  v_mfma_f32_16x16x32_bf16 a[36:39], v[56:59], v[28:31], a[36:39]
  ds_read_b128 v[48:51], v10 offset:39936
  v_mfma_f32_16x16x32_bf16 a[40:43], v[60:63], v[28:31], a[40:43]
  ds_read_b64_tr_b16 v[80:81], v13 offset:57352
  v_mfma_f32_16x16x32_bf16 a[44:47], v[64:67], v[28:31], a[44:47]
  ds_read_b64_tr_b16 v[82:83], v13 offset:61448
  s_add_u32 s20, s20, 2048
  v_mfma_f32_16x16x32_bf16 a[48:51], v[52:55], v[32:35], a[48:51]
  s_add_u32 s21, s21, s51
  v_mfma_f32_16x16x32_bf16 a[52:55], v[56:59], v[32:35], a[52:55]
  v_mfma_f32_16x16x32_bf16 a[56:59], v[60:63], v[32:35], a[56:59]
  v_mfma_f32_16x16x32_bf16 a[60:63], v[64:67], v[32:35], a[60:63]
  s_waitcnt lgkmcnt(0)
  v_mfma_f32_16x16x32_bf16 a[0:3], v[68:71], v[36:39], a[0:3]
  s_waitcnt vmcnt(12)
  s_barrier
  s_add_u32 m0, s52, 32768
  v_mfma_f32_16x16x32_bf16 a[4:7], v[72:75], v[36:39], a[4:7]
  buffer_load_dwordx4 v2, s[8:11], s20 offen sc1 lds
  ds_read_b128 v[20:23], v11 offset:0
  v_mfma_f32_16x16x32_bf16 a[8:11], v[76:79], v[36:39], a[8:11]
  ds_read_b64_tr_b16 v[52:53], v14 offset:16384
  v_mfma_f32_16x16x32_bf16 a[12:15], v[80:83], v[36:39], a[12:15]
  ds_read_b64_tr_b16 v[54:55], v14 offset:20480
  s_add_u32 m0, s53, 32768
  v_mfma_f32_16x16x32_bf16 a[16:19], v[68:71], v[40:43], a[16:19]
  buffer_load_dwordx4 v6, s[12:15], s21 offen  lds
  ds_read_b128 v[24:27], v11 offset:2048
  v_mfma_f32_16x16x32_bf16 a[20:23], v[72:75], v[40:43], a[20:23]
  ds_read_b64_tr_b16 v[56:57], v14 offset:16392
  v_mfma_f32_16x16x32_bf16 a[24:27], v[76:79], v[40:43], a[24:27]
  ds_read_b64_tr_b16 v[58:59], v14 offset:20488
  s_add_u32 m0, s52, 33792
  v_mfma_f32_16x16x32_bf16 a[28:31], v[80:83], v[40:43], a[28:31]
  buffer_load_dwordx4 v3, s[8:11], s20 offen sc1 lds
  ds_read_b128 v[28:31], v11 offset:4096
  v_mfma_f32_16x16x32_bf16 a[32:35], v[68:71], v[44:47], a[32:35]
  ds_read_b64_tr_b16 v[60:61], v15 offset:16384
  v_mfma_f32_16x16x32_bf16 a[36:39], v[72:75], v[44:47], a[36:39]
  ds_read_b64_tr_b16 v[62:63], v15 offset:20480
  s_add_u32 m0, s53, 33792
  v_mfma_f32_16x16x32_bf16 a[40:43], v[76:79], v[44:47], a[40:43]
  buffer_load_dwordx4 v7, s[12:15], s21 offen  lds
  ds_read_b128 v[32:35], v11 offset:6144
  v_mfma_f32_16x16x32_bf16 a[44:47], v[80:83], v[44:47], a[44:47]
  ds_read_b64_tr_b16 v[64:65], v15 offset:16392
  v_mfma_f32_16x16x32_bf16 a[48:51], v[68:71], v[48:51], a[48:51]
  ds_read_b64_tr_b16 v[66:67], v15 offset:20488
  s_add_u32 m0, s52, 34816
  v_mfma_f32_16x16x32_bf16 a[52:55], v[72:75], v[48:51], a[52:55]
  buffer_load_dwordx4 v4, s[8:11], s20 offen sc1 lds
  v_mfma_f32_16x16x32_bf16 a[56:59], v[76:79], v[48:51], a[56:59]
  v_mfma_f32_16x16x32_bf16 a[60:63], v[80:83], v[48:51], a[60:63]
  s_waitcnt lgkmcnt(0)
  s_add_u32 m0, s53, 34816
  v_mfma_f32_16x16x32_bf16 a[0:3], v[52:55], v[20:23], a[0:3]
  buffer_load_dwordx4 v8, s[12:15], s21 offen  lds
  ds_read_b128 v[36:39], v11 offset:1024
  v_mfma_f32_16x16x32_bf16 a[4:7], v[56:59], v[20:23], a[4:7]
  ds_read_b64_tr_b16 v[68:69], v14 offset:24576
  v_mfma_f32_16x16x32_bf16 a[8:11], v[60:63], v[20:23], a[8:11]
  ds_read_b64_tr_b16 v[70:71], v14 offset:28672
  v_mfma_f32_16x16x32_bf16 a[12:15], v[64:67], v[20:23], a[12:15]
  ds_read_b128 v[40:43], v11 offset:3072
  s_add_u32 m0, s52, 35840
  v_mfma_f32_16x16x32_bf16 a[16:19], v[52:55], v[24:27], a[16:19]
  buffer_load_dwordx4 v5, s[8:11], s20 offen sc1 lds
  ds_read_b64_tr_b16 v[72:73], v14 offset:24584
  v_mfma_f32_16x16x32_bf16 a[20:23], v[56:59], v[24:27], a[20:23]
  ds_read_b64_tr_b16 v[74:75], v14 offset:28680
  v_mfma_f32_16x16x32_bf16 a[24:27], v[60:63], v[24:27], a[24:27]
  ds_read_b128 v[44:47], v11 offset:5120
  v_mfma_f32_16x16x32_bf16 a[28:31], v[64:67], v[24:27], a[28:31]
  ds_read_b64_tr_b16 v[76:77], v15 offset:24576
  s_add_u32 m0, s53, 35840
  v_mfma_f32_16x16x32_bf16 a[32:35], v[52:55], v[28:31], a[32:35]
  buffer_load_dwordx4 v9, s[12:15], s21 offen  lds
  ds_read_b64_tr_b16 v[78:79], v15 offset:28672
  v_mfma_f32_16x16x32_bf16 a[36:39], v[56:59], v[28:31], a[36:39]
  ds_read_b128 v[48:51], v11 offset:7168
  v_mfma_f32_16x16x32_bf16 a[40:43], v[60:63], v[28:31], a[40:43]
  ds_read_b64_tr_b16 v[80:81], v15 offset:24584
  v_mfma_f32_16x16x32_bf16 a[44:47], v[64:67], v[28:31], a[44:47]
  ds_read_b64_tr_b16 v[82:83], v15 offset:28680
  s_add_u32 s20, s20, 6144
  v_mfma_f32_16x16x32_bf16 a[48:51], v[52:55], v[32:35], a[48:51]
  s_add_u32 s21, s21, s51
  v_mfma_f32_16x16x32_bf16 a[52:55], v[56:59], v[32:35], a[52:55]
  v_mfma_f32_16x16x32_bf16 a[56:59], v[60:63], v[32:35], a[56:59]
  v_mfma_f32_16x16x32_bf16 a[60:63], v[64:67], v[32:35], a[60:63]
  s_waitcnt lgkmcnt(0)
  v_mfma_f32_16x16x32_bf16 a[0:3], v[68:71], v[36:39], a[0:3]
  s_waitcnt vmcnt(16)
  s_barrier
  s_add_u32 m0, s52, 65536
  v_mfma_f32_16x16x32_bf16 a[4:7], v[72:75], v[36:39], a[4:7]
  buffer_load_dwordx4 v2, s[8:11], s20 offen sc1 lds
  ds_read_b128 v[20:23], v11 offset:32768
  v_mfma_f32_16x16x32_bf16 a[8:11], v[76:79], v[36:39], a[8:11]
  ds_read_b64_tr_b16 v[52:53], v14 offset:49152
  v_mfma_f32_16x16x32_bf16 a[12:15], v[80:83], v[36:39], a[12:15]
  ds_read_b64_tr_b16 v[54:55], v14 offset:53248
  s_add_u32 m0, s53, 65536
  v_mfma_f32_16x16x32_bf16 a[16:19], v[68:71], v[40:43], a[16:19]
  buffer_load_dwordx4 v6, s[12:15], s21 offen  lds
  ds_read_b128 v[24:27], v11 offset:34816
  v_mfma_f32_16x16x32_bf16 a[20:23], v[72:75], v[40:43], a[20:23]
  ds_read_b64_tr_b16 v[56:57], v14 offset:49160
  v_mfma_f32_16x16x32_bf16 a[24:27], v[76:79], v[40:43], a[24:27]
  ds_read_b64_tr_b16 v[58:59], v14 offset:53256
  s_add_u32 m0, s52, 66560
  v_mfma_f32_16x16x32_bf16 a[28:31], v[80:83], v[40:43], a[28:31]
  buffer_load_dwordx4 v3, s[8:11], s20 offen sc1 lds
  ds_read_b128 v[28:31], v11 offset:36864
  v_mfma_f32_16x16x32_bf16 a[32:35], v[68:71], v[44:47], a[32:35]
  ds_read_b64_tr_b16 v[60:61], v15 offset:49152
  v_mfma_f32_16x16x32_bf16 a[36:39], v[72:75], v[44:47], a[36:39]
  ds_read_b64_tr_b16 v[62:63], v15 offset:53248
  s_add_u32 m0, s53, 66560
  v_mfma_f32_16x16x32_bf16 a[40:43], v[76:79], v[44:47], a[40:43]
  buffer_load_dwordx4 v7, s[12:15], s21 offen  lds
  ds_read_b128 v[32:35], v11 offset:38912
  v_mfma_f32_16x16x32_bf16 a[44:47], v[80:83], v[44:47], a[44:47]
  ds_read_b64_tr_b16 v[64:65], v15 offset:49160
  v_mfma_f32_16x16x32_bf16 a[48:51], v[68:71], v[48:51], a[48:51]
  ds_read_b64_tr_b16 v[66:67], v15 offset:53256
  s_add_u32 m0, s52, 67584
  v_mfma_f32_16x16x32_bf16 a[52:55], v[72:75], v[48:51], a[52:55]
  buffer_load_dwordx4 v4, s[8:11], s20 offen sc1 lds
  v_mfma_f32_16x16x32_bf16 a[56:59], v[76:79], v[48:51], a[56:59]
  v_mfma_f32_16x16x32_bf16 a[60:63], v[80:83], v[48:51], a[60:63]
  s_waitcnt lgkmcnt(0)
  s_add_u32 m0, s53, 67584
  v_mfma_f32_16x16x32_bf16 a[0:3], v[52:55], v[20:23], a[0:3]
  buffer_load_dwordx4 v8, s[12:15], s21 offen  lds
  ds_read_b128 v[36:39], v11 offset:33792
  v_mfma_f32_16x16x32_bf16 a[4:7], v[56:59], v[20:23], a[4:7]
  ds_read_b64_tr_b16 v[68:69], v14 offset:57344
  v_mfma_f32_16x16x32_bf16 a[8:11], v[60:63], v[20:23], a[8:11]
  ds_read_b64_tr_b16 v[70:71], v14 offset:61440
  v_mfma_f32_16x16x32_bf16 a[12:15], v[64:67], v[20:23], a[12:15]
  ds_read_b128 v[40:43], v11 offset:35840
  s_add_u32 m0, s52, 68608
  v_mfma_f32_16x16x32_bf16 a[16:19], v[52:55], v[24:27], a[16:19]
  buffer_load_dwordx4 v5, s[8:11], s20 offen sc1 lds
  ds_read_b64_tr_b16 v[72:73], v14 offset:57352
  v_mfma_f32_16x16x32_bf16 a[20:23], v[56:59], v[24:27], a[20:23]
  ds_read_b64_tr_b16 v[74:75], v14 offset:61448
  v_mfma_f32_16x16x32_bf16 a[24:27], v[60:63], v[24:27], a[24:27]
  ds_read_b128 v[44:47], v11 offset:37888
  v_mfma_f32_16x16x32_bf16 a[28:31], v[64:67], v[24:27], a[28:31]
  ds_read_b64_tr_b16 v[76:77], v15 offset:57344
  s_add_u32 m0, s53, 68608
  v_mfma_f32_16x16x32_bf16 a[32:35], v[52:55], v[28:31], a[32:35]
  buffer_load_dwordx4 v9, s[12:15], s21 offen  lds
  ds_read_b64_tr_b16 v[78:79], v15 offset:61440
  v_mfma_f32_16x16x32_bf16 a[36:39], v[56:59], v[28:31], a[36:39]
  ds_read_b128 v[48:51], v11 offset:39936
  v_mfma_f32_16x16x32_bf16 a[40:43], v[60:63], v[28:31], a[40:43]
  ds_read_b64_tr_b16 v[80:81], v15 offset:57352
  v_mfma_f32_16x16x32_bf16 a[44:47], v[64:67], v[28:31], a[44:47]
  ds_read_b64_tr_b16 v[82:83], v15 offset:61448
  s_add_u32 s20, s20, 2048
  v_mfma_f32_16x16x32_bf16 a[48:51], v[52:55], v[32:35], a[48:51]
  s_add_u32 s21, s21, s51
  v_mfma_f32_16x16x32_bf16 a[52:55], v[56:59], v[32:35], a[52:55]
  v_mfma_f32_16x16x32_bf16 a[56:59], v[60:63], v[32:35], a[56:59]
  v_mfma_f32_16x16x32_bf16 a[60:63], v[64:67], v[32:35], a[60:63]
  s_waitcnt lgkmcnt(0)
  v_mfma_f32_16x16x32_bf16 a[0:3], v[68:71], v[36:39], a[0:3]
  s_waitcnt vmcnt(16)
  s_barrier
  s_add_u32 m0, s52, 98304
  v_mfma_f32_16x16x32_bf16 a[4:7], v[72:75], v[36:39], a[4:7]
  buffer_load_dwordx4 v2, s[8:11], s20 offen sc1 lds
  ds_read_b128 v[20:23], v10 offset:0
  v_mfma_f32_16x16x32_bf16 a[8:11], v[76:79], v[36:39], a[8:11]
  ds_read_b64_tr_b16 v[52:53], v12 offset:16384
  v_mfma_f32_16x16x32_bf16 a[12:15], v[80:83], v[36:39], a[12:15]
  ds_read_b64_tr_b16 v[54:55], v12 offset:20480
  s_add_u32 m0, s53, 98304
  v_mfma_f32_16x16x32_bf16 a[16:19], v[68:71], v[40:43], a[16:19]
  buffer_load_dwordx4 v6, s[12:15], s21 offen  lds
  ds_read_b128 v[24:27], v10 offset:2048
  v_mfma_f32_16x16x32_bf16 a[20:23], v[72:75], v[40:43], a[20:23]
  ds_read_b64_tr_b16 v[56:57], v12 offset:16392
  v_mfma_f32_16x16x32_bf16 a[24:27], v[76:79], v[40:43], a[24:27]
  ds_read_b64_tr_b16 v[58:59], v12 offset:20488
  s_add_u32 m0, s52, 99328
  v_mfma_f32_16x16x32_bf16 a[28:31], v[80:83], v[40:43], a[28:31]
  buffer_load_dwordx4 v3, s[8:11], s20 offen sc1 lds
  ds_read_b128 v[28:31], v10 offset:4096
  v_mfma_f32_16x16x32_bf16 a[32:35], v[68:71], v[44:47], a[32:35]
  ds_read_b64_tr_b16 v[60:61], v13 offset:16384
  v_mfma_f32_16x16x32_bf16 a[36:39], v[72:75], v[44:47], a[36:39]
  ds_read_b64_tr_b16 v[62:63], v13 offset:20480
  s_add_u32 m0, s53, 99328
  v_mfma_f32_16x16x32_bf16 a[40:43], v[76:79], v[44:47], a[40:43]
  buffer_load_dwordx4 v7, s[12:15], s21 offen  lds
  ds_read_b128 v[32:35], v10 offset:6144
  v_mfma_f32_16x16x32_bf16 a[44:47], v[80:83], v[44:47], a[44:47]
  ds_read_b64_tr_b16 v[64:65], v13 offset:16392
  v_mfma_f32_16x16x32_bf16 a[48:51], v[68:71], v[48:51], a[48:51]
  ds_read_b64_tr_b16 v[66:67], v13 offset:20488
  s_add_u32 m0, s52, 100352
  v_mfma_f32_16x16x32_bf16 a[52:55], v[72:75], v[48:51], a[52:55]
  buffer_load_dwordx4 v4, s[8:11], s20 offen sc1 lds
  v_mfma_f32_16x16x32_bf16 a[56:59], v[76:79], v[48:51], a[56:59]
  v_mfma_f32_16x16x32_bf16 a[60:63], v[80:83], v[48:51], a[60:63]
L_g3_loop:
  s_sub_u32 s25, s25, 1
  s_cmp_eq_u32 s25, 0
  s_cbranch_scc1 L_g3_fin
  s_waitcnt lgkmcnt(0)
  s_add_u32 m0, s53, 100352
  v_mfma_f32_16x16x32_bf16 a[0:3], v[52:55], v[20:23], a[0:3]
  buffer_load_dwordx4 v8, s[12:15], s21 offen  lds
  ds_read_b128 v[36:39], v10 offset:1024
  v_mfma_f32_16x16x32_bf16 a[4:7], v[56:59], v[20:23], a[4:7]
  ds_read_b64_tr_b16 v[68:69], v12 offset:24576
  v_mfma_f32_16x16x32_bf16 a[8:11], v[60:63], v[20:23], a[8:11]
  ds_read_b64_tr_b16 v[70:71], v12 offset:28672
  v_mfma_f32_16x16x32_bf16 a[12:15], v[64:67], v[20:23], a[12:15]
  ds_read_b128 v[40:43], v10 offset:3072
  s_add_u32 m0, s52, 101376
  v_mfma_f32_16x16x32_bf16 a[16:19], v[52:55], v[24:27], a[16:19]
  buffer_load_dwordx4 v5, s[8:11], s20 offen sc1 lds
  ds_read_b64_tr_b16 v[72:73], v12 offset:24584
  v_mfma_f32_16x16x32_bf16 a[20:23], v[56:59], v[24:27], a[20:23]
  ds_read_b64_tr_b16 v[74:75], v12 offset:28680
  v_mfma_f32_16x16x32_bf16 a[24:27], v[60:63], v[24:27], a[24:27]
  ds_read_b128 v[44:47], v10 offset:5120
  v_mfma_f32_16x16x32_bf16 a[28:31], v[64:67], v[24:27], a[28:31]
  ds_read_b64_tr_b16 v[76:77], v13 offset:24576
  s_add_u32 m0, s53, 101376
  v_mfma_f32_16x16x32_bf16 a[32:35], v[52:55], v[28:31], a[32:35]
  buffer_load_dwordx4 v9, s[12:15], s21 offen  lds
  ds_read_b64_tr_b16 v[78:79], v13 offset:28672
  v_mfma_f32_16x16x32_bf16 a[36:39], v[56:59], v[28:31], a[36:39]
  ds_read_b128 v[48:51], v10 offset:7168
  v_mfma_f32_16x16x32_bf16 a[40:43], v[60:63], v[28:31], a[40:43]
  ds_read_b64_tr_b16 v[80:81], v13 offset:24584
  v_mfma_f32_16x16x32_bf16 a[44:47], v[64:67], v[28:31], a[44:47]
  ds_read_b64_tr_b16 v[82:83], v13 offset:28680
  s_add_u32 s20, s20, 6144
  v_mfma_f32_16x16x32_bf16 a[48:51], v[52:55], v[32:35], a[48:51]
  s_add_u32 s21, s21, s51
  v_mfma_f32_16x16x32_bf16 a[52:55], v[56:59], v[32:35], a[52:55]
  v_mfma_f32_16x16x32_bf16 a[56:59], v[60:63], v[32:35], a[56:59]
  v_mfma_f32_16x16x32_bf16 a[60:63], v[64:67], v[32:35], a[60:63]
  s_waitcnt lgkmcnt(0)
  v_mfma_f32_16x16x32_bf16 a[0:3], v[68:71], v[36:39], a[0:3]
  s_waitcnt vmcnt(16)
  s_barrier
  s_add_u32 m0, s52, 0
  v_mfma_f32_16x16x32_bf16 a[4:7], v[72:75], v[36:39], a[4:7]
  buffer_load_dwordx4 v2, s[8:11], s20 offen sc1 lds
  ds_read_b128 v[20:23], v10 offset:32768
  v_mfma_f32_16x16x32_bf16 a[8:11], v[76:79], v[36:39], a[8:11]
  ds_read_b64_tr_b16 v[52:53], v12 offset:49152
  v_mfma_f32_16x16x32_bf16 a[12:15], v[80:83], v[36:39], a[12:15]
  ds_read_b64_tr_b16 v[54:55], v12 offset:53248
  s_add_u32 m0, s53, 0
  v_mfma_f32_16x16x32_bf16 a[16:19], v[68:71], v[40:43], a[16:19]
  buffer_load_dwordx4 v6, s[12:15], s21 offen  lds
  ds_read_b128 v[24:27], v10 offset:34816
  v_mfma_f32_16x16x32_bf16 a[20:23], v[72:75], v[40:43], a[20:23]
  ds_read_b64_tr_b16 v[56:57], v12 offset:49160
  v_mfma_f32_16x16x32_bf16 a[24:27], v[76:79], v[40:43], a[24:27]
  ds_read_b64_tr_b16 v[58:59], v12 offset:53256
  s_add_u32 m0, s52, 1024
  v_mfma_f32_16x16x32_bf16 a[28:31], v[80:83], v[40:43], a[28:31]
  buffer_load_dwordx4 v3, s[8:11], s20 offen sc1 lds
  ds_read_b128 v[28:31], v10 offset:36864
  v_mfma_f32_16x16x32_bf16 a[32:35], v[68:71], v[44:47], a[32:35]
  ds_read_b64_tr_b16 v[60:61], v13 offset:49152
  v_mfma_f32_16x16x32_bf16 a[36:39], v[72:75], v[44:47], a[36:39]
  ds_read_b64_tr_b16 v[62:63], v13 offset:53248
  s_add_u32 m0, s53, 1024
  v_mfma_f32_16x16x32_bf16 a[40:43], v[76:79], v[44:47], a[40:43]
  buffer_load_dwordx4 v7, s[12:15], s21 offen  lds
  ds_read_b128 v[32:35], v10 offset:38912
  v_mfma_f32_16x16x32_bf16 a[44:47], v[80:83], v[44:47], a[44:47]
  ds_read_b64_tr_b16 v[64:65], v13 offset:49160
  v_mfma_f32_16x16x32_bf16 a[48:51], v[68:71], v[48:51], a[48:51]
  ds_read_b64_tr_b16 v[66:67], v13 offset:53256
  s_add_u32 m0, s52, 2048
  v_mfma_f32_16x16x32_bf16 a[52:55], v[72:75], v[48:51], a[52:55]
  buffer_load_dwordx4 v4, s[8:11], s20 offen sc1 lds
  v_mfma_f32_16x16x32_bf16 a[56:59], v[76:79], v[48:51], a[56:59]
  v_mfma_f32_16x16x32_bf16 a[60:63], v[80:83], v[48:51], a[60:63]
  s_waitcnt lgkmcnt(0)
  s_add_u32 m0, s53, 2048
  v_mfma_f32_16x16x32_bf16 a[0:3], v[52:55], v[20:23], a[0:3]
  buffer_load_dwordx4 v8, s[12:15], s21 offen  lds
  ds_read_b128 v[36:39], v10 offset:33792
  v_mfma_f32_16x16x32_bf16 a[4:7], v[56:59], v[20:23], a[4:7]
  ds_read_b64_tr_b16 v[68:69], v12 offset:57344
  v_mfma_f32_16x16x32_bf16 a[8:11], v[60:63], v[20:23], a[8:11]
  ds_read_b64_tr_b16 v[70:71], v12 offset:61440
  v_mfma_f32_16x16x32_bf16 a[12:15], v[64:67], v[20:23], a[12:15]
  ds_read_b128 v[40:43], v10 offset:35840
  s_add_u32 m0, s52, 3072
  v_mfma_f32_16x16x32_bf16 a[16:19], v[52:55], v[24:27], a[16:19]
  buffer_load_dwordx4 v5, s[8:11], s20 offen sc1 lds
  ds_read_b64_tr_b16 v[72:73], v12 offset:57352
  v_mfma_f32_16x16x32_bf16 a[20:23], v[56:59], v[24:27], a[20:23]
  ds_read_b64_tr_b16 v[74:75], v12 offset:61448
  v_mfma_f32_16x16x32_bf16 a[24:27], v[60:63], v[24:27], a[24:27]
  ds_read_b128 v[44:47], v10 offset:37888
  v_mfma_f32_16x16x32_bf16 a[28:31], v[64:67], v[24:27], a[28:31]
  ds_read_b64_tr_b16 v[76:77], v13 offset:57344
  s_add_u32 m0, s53, 3072
  v_mfma_f32_16x16x32_bf16 a[32:35], v[52:55], v[28:31], a[32:35]
  buffer_load_dwordx4 v9, s[12:15], s21 offen  lds
  ds_read_b64_tr_b16 v[78:79], v13 offset:61440
  v_mfma_f32_16x16x32_bf16 a[36:39], v[56:59], v[28:31], a[36:39]
  ds_read_b128 v[48:51], v10 offset:39936
  v_mfma_f32_16x16x32_bf16 a[40:43], v[60:63], v[28:31], a[40:43]
  ds_read_b64_tr_b16 v[80:81], v13 offset:57352
  v_mfma_f32_16x16x32_bf16 a[44:47], v[64:67], v[28:31], a[44:47]
  ds_read_b64_tr_b16 v[82:83], v13 offset:61448
  s_add_u32 s20, s20, 2048
  v_mfma_f32_16x16x32_bf16 a[48:51], v[52:55], v[32:35], a[48:51]
  s_add_u32 s21, s21, s51
  v_mfma_f32_16x16x32_bf16 a[52:55], v[56:59], v[32:35], a[52:55]
  v_mfma_f32_16x16x32_bf16 a[56:59], v[60:63], v[32:35], a[56:59]
  v_mfma_f32_16x16x32_bf16 a[60:63], v[64:67], v[32:35], a[60:63]
  s_waitcnt lgkmcnt(0)
  v_mfma_f32_16x16x32_bf16 a[0:3], v[68:71], v[36:39], a[0:3]
  s_waitcnt vmcnt(16)
  s_barrier
  s_add_u32 m0, s52, 32768
  v_mfma_f32_16x16x32_bf16 a[4:7], v[72:75], v[36:39], a[4:7]
  buffer_load_dwordx4 v2, s[8:11], s20 offen sc1 lds
  ds_read_b128 v[20:23], v11 offset:0
  v_mfma_f32_16x16x32_bf16 a[8:11], v[76:79], v[36:39], a[8:11]
  ds_read_b64_tr_b16 v[52:53], v14 offset:16384
  v_mfma_f32_16x16x32_bf16 a[12:15], v[80:83], v[36:39], a[12:15]
  ds_read_b64_tr_b16 v[54:55], v14 offset:20480
  s_add_u32 m0, s53, 32768
  v_mfma_f32_16x16x32_bf16 a[16:19], v[68:71], v[40:43], a[16:19]
  buffer_load_dwordx4 v6, s[12:15], s21 offen  lds
  ds_read_b128 v[24:27], v11 offset:2048
  v_mfma_f32_16x16x32_bf16 a[20:23], v[72:75], v[40:43], a[20:23]
  ds_read_b64_tr_b16 v[56:57], v14 offset:16392
  v_mfma_f32_16x16x32_bf16 a[24:27], v[76:79], v[40:43], a[24:27]
  ds_read_b64_tr_b16 v[58:59], v14 offset:20488
  s_add_u32 m0, s52, 33792
  v_mfma_f32_16x16x32_bf16 a[28:31], v[80:83], v[40:43], a[28:31]
  buffer_load_dwordx4 v3, s[8:11], s20 offen sc1 lds
  ds_read_b128 v[28:31], v11 offset:4096
  v_mfma_f32_16x16x32_bf16 a[32:35], v[68:71], v[44:47], a[32:35]
  ds_read_b64_tr_b16 v[60:61], v15 offset:16384
  v_mfma_f32_16x16x32_bf16 a[36:39], v[72:75], v[44:47], a[36:39]
  ds_read_b64_tr_b16 v[62:63], v15 offset:20480
  s_add_u32 m0, s53, 33792
  v_mfma_f32_16x16x32_bf16 a[40:43], v[76:79], v[44:47], a[40:43]
  buffer_load_dwordx4 v7, s[12:15], s21 offen  lds
  ds_read_b128 v[32:35], v11 offset:6144
  v_mfma_f32_16x16x32_bf16 a[44:47], v[80:83], v[44:47], a[44:47]
  ds_read_b64_tr_b16 v[64:65], v15 offset:16392
  v_mfma_f32_16x16x32_bf16 a[48:51], v[68:71], v[48:51], a[48:51]
  ds_read_b64_tr_b16 v[66:67], v15 offset:20488
  s_add_u32 m0, s52, 34816
  v_mfma_f32_16x16x32_bf16 a[52:55], v[72:75], v[48:51], a[52:55]
  buffer_load_dwordx4 v4, s[8:11], s20 offen sc1 lds
  v_mfma_f32_16x16x32_bf16 a[56:59], v[76:79], v[48:51], a[56:59]
  v_mfma_f32_16x16x32_bf16 a[60:63], v[80:83], v[48:51], a[60:63]
  s_waitcnt lgkmcnt(0)
  s_add_u32 m0, s53, 34816
  v_mfma_f32_16x16x32_bf16 a[0:3], v[52:55], v[20:23], a[0:3]
  buffer_load_dwordx4 v8, s[12:15], s21 offen  lds
  ds_read_b128 v[36:39], v11 offset:1024
  v_mfma_f32_16x16x32_bf16 a[4:7], v[56:59], v[20:23], a[4:7]
  ds_read_b64_tr_b16 v[68:69], v14 offset:24576
  v_mfma_f32_16x16x32_bf16 a[8:11], v[60:63], v[20:23], a[8:11]
  ds_read_b64_tr_b16 v[70:71], v14 offset:28672
  v_mfma_f32_16x16x32_bf16 a[12:15], v[64:67], v[20:23], a[12:15]
  ds_read_b128 v[40:43], v11 offset:3072
  s_add_u32 m0, s52, 35840
  v_mfma_f32_16x16x32_bf16 a[16:19], v[52:55], v[24:27], a[16:19]
  buffer_load_dwordx4 v5, s[8:11], s20 offen sc1 lds
  ds_read_b64_tr_b16 v[72:73], v14 offset:24584
  v_mfma_f32_16x16x32_bf16 a[20:23], v[56:59], v[24:27], a[20:23]
  ds_read_b64_tr_b16 v[74:75], v14 offset:28680
  v_mfma_f32_16x16x32_bf16 a[24:27], v[60:63], v[24:27], a[24:27]
  ds_read_b128 v[44:47], v11 offset:5120
  v_mfma_f32_16x16x32_bf16 a[28:31], v[64:67], v[24:27], a[28:31]
  ds_read_b64_tr_b16 v[76:77], v15 offset:24576
  s_add_u32 m0, s53, 35840
  v_mfma_f32_16x16x32_bf16 a[32:35], v[52:55], v[28:31], a[32:35]
  buffer_load_dwordx4 v9, s[12:15], s21 offen  lds
  ds_read_b64_tr_b16 v[78:79], v15 offset:28672
  v_mfma_f32_16x16x32_bf16 a[36:39], v[56:59], v[28:31], a[36:39]
  ds_read_b128 v[48:51], v11 offset:7168
  v_mfma_f32_16x16x32_bf16 a[40:43], v[60:63], v[28:31], a[40:43]
  ds_read_b64_tr_b16 v[80:81], v15 offset:24584
  v_mfma_f32_16x16x32_bf16 a[44:47], v[64:67], v[28:31], a[44:47]
  ds_read_b64_tr_b16 v[82:83], v15 offset:28680
  s_add_u32 s20, s20, 6144
  v_mfma_f32_16x16x32_bf16 a[48:51], v[52:55], v[32:35], a[48:51]
  s_add_u32 s21, s21, s51
  v_mfma_f32_16x16x32_bf16 a[52:55], v[56:59], v[32:35], a[52:55]
  v_mfma_f32_16x16x32_bf16 a[56:59], v[60:63], v[32:35], a[56:59]
  v_mfma_f32_16x16x32_bf16 a[60:63], v[64:67], v[32:35], a[60:63]
  s_waitcnt lgkmcnt(0)
  v_mfma_f32_16x16x32_bf16 a[0:3], v[68:71], v[36:39], a[0:3]
  s_waitcnt vmcnt(16)
  s_barrier
  s_add_u32 m0, s52, 65536
  v_mfma_f32_16x16x32_bf16 a[4:7], v[72:75], v[36:39], a[4:7]
  buffer_load_dwordx4 v2, s[8:11], s20 offen sc1 lds
  ds_read_b128 v[20:23], v11 offset:32768
  v_mfma_f32_16x16x32_bf16 a[8:11], v[76:79], v[36:39], a[8:11]
  ds_read_b64_tr_b16 v[52:53], v14 offset:49152
  v_mfma_f32_16x16x32_bf16 a[12:15], v[80:83], v[36:39], a[12:15]
  ds_read_b64_tr_b16 v[54:55], v14 offset:53248
  s_add_u32 m0, s53, 65536
  v_mfma_f32_16x16x32_bf16 a[16:19], v[68:71], v[40:43], a[16:19]
  buffer_load_dwordx4 v6, s[12:15], s21 offen  lds
  ds_read_b128 v[24:27], v11 offset:34816
  v_mfma_f32_16x16x32_bf16 a[20:23], v[72:75], v[40:43], a[20:23]
  ds_read_b64_tr_b16 v[56:57], v14 offset:49160
  v_mfma_f32_16x16x32_bf16 a[24:27], v[76:79], v[40:43], a[24:27]
  ds_read_b64_tr_b16 v[58:59], v14 offset:53256
  s_add_u32 m0, s52, 66560
  v_mfma_f32_16x16x32_bf16 a[28:31], v[80:83], v[40:43], a[28:31]
  buffer_load_dwordx4 v3, s[8:11], s20 offen sc1 lds
  ds_read_b128 v[28:31], v11 offset:36864
  v_mfma_f32_16x16x32_bf16 a[32:35], v[68:71], v[44:47], a[32:35]
  ds_read_b64_tr_b16 v[60:61], v15 offset:49152
  v_mfma_f32_16x16x32_bf16 a[36:39], v[72:75], v[44:47], a[36:39]
  ds_read_b64_tr_b16 v[62:63], v15 offset:53248
  s_add_u32 m0, s53, 66560
  v_mfma_f32_16x16x32_bf16 a[40:43], v[76:79], v[44:47], a[40:43]
  buffer_load_dwordx4 v7, s[12:15], s21 offen  lds
  ds_read_b128 v[32:35], v11 offset:38912
  v_mfma_f32_16x16x32_bf16 a[44:47], v[80:83], v[44:47], a[44:47]
  ds_read_b64_tr_b16 v[64:65], v15 offset:49160
  v_mfma_f32_16x16x32_bf16 a[48:51], v[68:71], v[48:51], a[48:51]
  ds_read_b64_tr_b16 v[66:67], v15 offset:53256
  s_add_u32 m0, s52, 67584
  v_mfma_f32_16x16x32_bf16 a[52:55], v[72:75], v[48:51], a[52:55]
  buffer_load_dwordx4 v4, s[8:11], s20 offen sc1 lds
  v_mfma_f32_16x16x32_bf16 a[56:59], v[76:79], v[48:51], a[56:59]
  v_mfma_f32_16x16x32_bf16 a[60:63], v[80:83], v[48:51], a[60:63]
  s_waitcnt lgkmcnt(0)
  s_add_u32 m0, s53, 67584
  v_mfma_f32_16x16x32_bf16 a[0:3], v[52:55], v[20:23], a[0:3]
  buffer_load_dwordx4 v8, s[12:15], s21 offen  lds
  ds_read_b128 v[36:39], v11 offset:33792
  v_mfma_f32_16x16x32_bf16 a[4:7], v[56:59], v[20:23], a[4:7]
  ds_read_b64_tr_b16 v[68:69], v14 offset:57344
  v_mfma_f32_16x16x32_bf16 a[8:11], v[60:63], v[20:23], a[8:11]
  ds_read_b64_tr_b16 v[70:71], v14 offset:61440
  v_mfma_f32_16x16x32_bf16 a[12:15], v[64:67], v[20:23], a[12:15]
  ds_read_b128 v[40:43], v11 offset:35840
  s_add_u32 m0, s52, 68608
  v_mfma_f32_16x16x32_bf16 a[16:19], v[52:55], v[24:27], a[16:19]
  buffer_load_dwordx4 v5, s[8:11], s20 offen sc1 lds
  ds_read_b64_tr_b16 v[72:73], v14 offset:57352
  v_mfma_f32_16x16x32_bf16 a[20:23], v[56:59], v[24:27], a[20:23]
  ds_read_b64_tr_b16 v[74:75], v14 offset:61448
  v_mfma_f32_16x16x32_bf16 a[24:27], v[60:63], v[24:27], a[24:27]
  ds_read_b128 v[44:47], v11 offset:37888
  v_mfma_f32_16x16x32_bf16 a[28:31], v[64:67], v[24:27], a[28:31]
  ds_read_b64_tr_b16 v[76:77], v15 offset:57344
  s_add_u32 m0, s53, 68608
  v_mfma_f32_16x16x32_bf16 a[32:35], v[52:55], v[28:31], a[32:35]
  buffer_load_dwordx4 v9, s[12:15], s21 offen  lds
  ds_read_b64_tr_b16 v[78:79], v15 offset:61440
  v_mfma_f32_16x16x32_bf16 a[36:39], v[56:59], v[28:31], a[36:39]
  ds_read_b128 v[48:51], v11 offset:39936
  v_mfma_f32_16x16x32_bf16 a[40:43], v[60:63], v[28:31], a[40:43]
  ds_read_b64_tr_b16 v[80:81], v15 offset:57352
  v_mfma_f32_16x16x32_bf16 a[44:47], v[64:67], v[28:31], a[44:47]
  ds_read_b64_tr_b16 v[82:83], v15 offset:61448
  s_add_u32 s20, s20, 2048
  v_mfma_f32_16x16x32_bf16 a[48:51], v[52:55], v[32:35], a[48:51]
  s_add_u32 s21, s21, s51
  v_mfma_f32_16x16x32_bf16 a[52:55], v[56:59], v[32:35], a[52:55]
  v_mfma_f32_16x16x32_bf16 a[56:59], v[60:63], v[32:35], a[56:59]
  v_mfma_f32_16x16x32_bf16 a[60:63], v[64:67], v[32:35], a[60:63]
  s_waitcnt lgkmcnt(0)
  v_mfma_f32_16x16x32_bf16 a[0:3], v[68:71], v[36:39], a[0:3]
  s_waitcnt vmcnt(16)
  s_barrier
  s_add_u32 m0, s52, 98304
  v_mfma_f32_16x16x32_bf16 a[4:7], v[72:75], v[36:39], a[4:7]
  buffer_load_dwordx4 v2, s[8:11], s20 offen sc1 lds
  ds_read_b128 v[20:23], v10 offset:0
  v_mfma_f32_16x16x32_bf16 a[8:11], v[76:79], v[36:39], a[8:11]
  ds_read_b64_tr_b16 v[52:53], v12 offset:16384
  v_mfma_f32_16x16x32_bf16 a[12:15], v[80:83], v[36:39], a[12:15]
  ds_read_b64_tr_b16 v[54:55], v12 offset:20480
  s_add_u32 m0, s53, 98304
  v_mfma_f32_16x16x32_bf16 a[16:19], v[68:71], v[40:43], a[16:19]
  buffer_load_dwordx4 v6, s[12:15], s21 offen  lds
  ds_read_b128 v[24:27], v10 offset:2048
  v_mfma_f32_16x16x32_bf16 a[20:23], v[72:75], v[40:43], a[20:23]
  ds_read_b64_tr_b16 v[56:57], v12 offset:16392
  v_mfma_f32_16x16x32_bf16 a[24:27], v[76:79], v[40:43], a[24:27]
  ds_read_b64_tr_b16 v[58:59], v12 offset:20488
  s_add_u32 m0, s52, 99328
  v_mfma_f32_16x16x32_bf16 a[28:31], v[80:83], v[40:43], a[28:31]
  buffer_load_dwordx4 v3, s[8:11], s20 offen sc1 lds
  ds_read_b128 v[28:31], v10 offset:4096
  v_mfma_f32_16x16x32_bf16 a[32:35], v[68:71], v[44:47], a[32:35]
  ds_read_b64_tr_b16 v[60:61], v13 offset:16384
  v_mfma_f32_16x16x32_bf16 a[36:39], v[72:75], v[44:47], a[36:39]
  ds_read_b64_tr_b16 v[62:63], v13 offset:20480
  s_add_u32 m0, s53, 99328
  v_mfma_f32_16x16x32_bf16 a[40:43], v[76:79], v[44:47], a[40:43]
  buffer_load_dwordx4 v7, s[12:15], s21 offen  lds
  ds_read_b128 v[32:35], v10 offset:6144
  v_mfma_f32_16x16x32_bf16 a[44:47], v[80:83], v[44:47], a[44:47]
  ds_read_b64_tr_b16 v[64:65], v13 offset:16392
  v_mfma_f32_16x16x32_bf16 a[48:51], v[68:71], v[48:51], a[48:51]
  ds_read_b64_tr_b16 v[66:67], v13 offset:20488
  s_add_u32 m0, s52, 100352
  v_mfma_f32_16x16x32_bf16 a[52:55], v[72:75], v[48:51], a[52:55]
  buffer_load_dwordx4 v4, s[8:11], s20 offen sc1 lds
  v_mfma_f32_16x16x32_bf16 a[56:59], v[76:79], v[48:51], a[56:59]
  v_mfma_f32_16x16x32_bf16 a[60:63], v[80:83], v[48:51], a[60:63]
  s_branch L_g3_loop
L_g3_fin:
  s_cmp_ge_u32 s35, 8
  s_cbranch_scc1 L_r3_100
  s_cmp_lg_u32 s32, 0
  s_cbranch_scc1 L_rq_101
  s_cmp_eq_u32 s39, 0
  s_cbranch_scc1 L_rq_101
  s_lshl_b32 s99, s33, 7
  s_add_u32 s99, s99, 0x3d00200
  v_mov_b32 v244, 1
  v_mov_b32 v245, 0
  s_mov_b64 exec, 1
  buffer_atomic_add v244, v245, s[4:7], s99 offen sc0 sc1
  s_mov_b64 exec, -1
L_rq_101:
L_r3_100:
  s_waitcnt lgkmcnt(0)
  s_add_u32 m0, s53, 100352
  v_mfma_f32_16x16x32_bf16 a[0:3], v[52:55], v[20:23], a[0:3]
  buffer_load_dwordx4 v8, s[12:15], s21 offen  lds
  ds_read_b128 v[36:39], v10 offset:1024
  v_mfma_f32_16x16x32_bf16 a[4:7], v[56:59], v[20:23], a[4:7]
  ds_read_b64_tr_b16 v[68:69], v12 offset:24576
  v_mfma_f32_16x16x32_bf16 a[8:11], v[60:63], v[20:23], a[8:11]
  ds_read_b64_tr_b16 v[70:71], v12 offset:28672
  v_mfma_f32_16x16x32_bf16 a[12:15], v[64:67], v[20:23], a[12:15]
  ds_read_b128 v[40:43], v10 offset:3072
  s_add_u32 m0, s52, 101376
  v_mfma_f32_16x16x32_bf16 a[16:19], v[52:55], v[24:27], a[16:19]
  buffer_load_dwordx4 v5, s[8:11], s20 offen sc1 lds
  ds_read_b64_tr_b16 v[72:73], v12 offset:24584
  v_mfma_f32_16x16x32_bf16 a[20:23], v[56:59], v[24:27], a[20:23]
  ds_read_b64_tr_b16 v[74:75], v12 offset:28680
  v_mfma_f32_16x16x32_bf16 a[24:27], v[60:63], v[24:27], a[24:27]
  ds_read_b128 v[44:47], v10 offset:5120
  v_mfma_f32_16x16x32_bf16 a[28:31], v[64:67], v[24:27], a[28:31]
  ds_read_b64_tr_b16 v[76:77], v13 offset:24576
  s_add_u32 m0, s53, 101376
  v_mfma_f32_16x16x32_bf16 a[32:35], v[52:55], v[28:31], a[32:35]
  buffer_load_dwordx4 v9, s[12:15], s21 offen  lds
  ds_read_b64_tr_b16 v[78:79], v13 offset:28672
  v_mfma_f32_16x16x32_bf16 a[36:39], v[56:59], v[28:31], a[36:39]
  ds_read_b128 v[48:51], v10 offset:7168
  v_mfma_f32_16x16x32_bf16 a[40:43], v[60:63], v[28:31], a[40:43]
  ds_read_b64_tr_b16 v[80:81], v13 offset:24584
  v_mfma_f32_16x16x32_bf16 a[44:47], v[64:67], v[28:31], a[44:47]
  ds_read_b64_tr_b16 v[82:83], v13 offset:28680
  s_add_u32 s20, s20, 6144
  v_mfma_f32_16x16x32_bf16 a[48:51], v[52:55], v[32:35], a[48:51]
  s_add_u32 s21, s21, s51
  v_mfma_f32_16x16x32_bf16 a[52:55], v[56:59], v[32:35], a[52:55]
  v_mfma_f32_16x16x32_bf16 a[56:59], v[60:63], v[32:35], a[56:59]
  v_mfma_f32_16x16x32_bf16 a[60:63], v[64:67], v[32:35], a[60:63]
  s_waitcnt lgkmcnt(0)
  v_mfma_f32_16x16x32_bf16 a[0:3], v[68:71], v[36:39], a[0:3]
  s_waitcnt vmcnt(16)
  s_barrier
  v_mfma_f32_16x16x32_bf16 a[4:7], v[72:75], v[36:39], a[4:7]
  ds_read_b128 v[20:23], v10 offset:32768
  v_mfma_f32_16x16x32_bf16 a[8:11], v[76:79], v[36:39], a[8:11]
  ds_read_b64_tr_b16 v[52:53], v12 offset:49152
  v_mfma_f32_16x16x32_bf16 a[12:15], v[80:83], v[36:39], a[12:15]
  ds_read_b64_tr_b16 v[54:55], v12 offset:53248
  v_mfma_f32_16x16x32_bf16 a[16:19], v[68:71], v[40:43], a[16:19]
  ds_read_b128 v[24:27], v10 offset:34816
  v_mfma_f32_16x16x32_bf16 a[20:23], v[72:75], v[40:43], a[20:23]
  ds_read_b64_tr_b16 v[56:57], v12 offset:49160
  v_mfma_f32_16x16x32_bf16 a[24:27], v[76:79], v[40:43], a[24:27]
  ds_read_b64_tr_b16 v[58:59], v12 offset:53256
  v_mfma_f32_16x16x32_bf16 a[28:31], v[80:83], v[40:43], a[28:31]
  ds_read_b128 v[28:31], v10 offset:36864
  v_mfma_f32_16x16x32_bf16 a[32:35], v[68:71], v[44:47], a[32:35]
  ds_read_b64_tr_b16 v[60:61], v13 offset:49152
  v_mfma_f32_16x16x32_bf16 a[36:39], v[72:75], v[44:47], a[36:39]
  ds_read_b64_tr_b16 v[62:63], v13 offset:53248
  v_mfma_f32_16x16x32_bf16 a[40:43], v[76:79], v[44:47], a[40:43]
  ds_read_b128 v[32:35], v10 offset:38912
  v_mfma_f32_16x16x32_bf16 a[44:47], v[80:83], v[44:47], a[44:47]
  ds_read_b64_tr_b16 v[64:65], v13 offset:49160
  v_mfma_f32_16x16x32_bf16 a[48:51], v[68:71], v[48:51], a[48:51]
  ds_read_b64_tr_b16 v[66:67], v13 offset:53256
  v_mfma_f32_16x16x32_bf16 a[52:55], v[72:75], v[48:51], a[52:55]
  v_mfma_f32_16x16x32_bf16 a[56:59], v[76:79], v[48:51], a[56:59]
  v_mfma_f32_16x16x32_bf16 a[60:63], v[80:83], v[48:51], a[60:63]
  s_waitcnt lgkmcnt(0)
  v_mfma_f32_16x16x32_bf16 a[0:3], v[52:55], v[20:23], a[0:3]
  ds_read_b128 v[36:39], v10 offset:33792
  v_mfma_f32_16x16x32_bf16 a[4:7], v[56:59], v[20:23], a[4:7]
  ds_read_b64_tr_b16 v[68:69], v12 offset:57344
  v_mfma_f32_16x16x32_bf16 a[8:11], v[60:63], v[20:23], a[8:11]
  ds_read_b64_tr_b16 v[70:71], v12 offset:61440
  v_mfma_f32_16x16x32_bf16 a[12:15], v[64:67], v[20:23], a[12:15]
  ds_read_b128 v[40:43], v10 offset:35840
  v_mfma_f32_16x16x32_bf16 a[16:19], v[52:55], v[24:27], a[16:19]
  ds_read_b64_tr_b16 v[72:73], v12 offset:57352
  v_mfma_f32_16x16x32_bf16 a[20:23], v[56:59], v[24:27], a[20:23]
  ds_read_b64_tr_b16 v[74:75], v12 offset:61448
  v_mfma_f32_16x16x32_bf16 a[24:27], v[60:63], v[24:27], a[24:27]
  ds_read_b128 v[44:47], v10 offset:37888
  v_mfma_f32_16x16x32_bf16 a[28:31], v[64:67], v[24:27], a[28:31]
  ds_read_b64_tr_b16 v[76:77], v13 offset:57344
  v_mfma_f32_16x16x32_bf16 a[32:35], v[52:55], v[28:31], a[32:35]
  ds_read_b64_tr_b16 v[78:79], v13 offset:61440
  v_mfma_f32_16x16x32_bf16 a[36:39], v[56:59], v[28:31], a[36:39]
  ds_read_b128 v[48:51], v10 offset:39936
  v_mfma_f32_16x16x32_bf16 a[40:43], v[60:63], v[28:31], a[40:43]
  ds_read_b64_tr_b16 v[80:81], v13 offset:57352
  v_mfma_f32_16x16x32_bf16 a[44:47], v[64:67], v[28:31], a[44:47]
  ds_read_b64_tr_b16 v[82:83], v13 offset:61448
  v_mfma_f32_16x16x32_bf16 a[48:51], v[52:55], v[32:35], a[48:51]
  v_mfma_f32_16x16x32_bf16 a[52:55], v[56:59], v[32:35], a[52:55]
  v_mfma_f32_16x16x32_bf16 a[56:59], v[60:63], v[32:35], a[56:59]
  v_mfma_f32_16x16x32_bf16 a[60:63], v[64:67], v[32:35], a[60:63]
  s_waitcnt lgkmcnt(0)
  v_mfma_f32_16x16x32_bf16 a[0:3], v[68:71], v[36:39], a[0:3]
  s_waitcnt vmcnt(8)
  s_barrier
  v_mfma_f32_16x16x32_bf16 a[4:7], v[72:75], v[36:39], a[4:7]
  ds_read_b128 v[20:23], v11 offset:0
  v_mfma_f32_16x16x32_bf16 a[8:11], v[76:79], v[36:39], a[8:11]
  ds_read_b64_tr_b16 v[52:53], v14 offset:16384
  v_mfma_f32_16x16x32_bf16 a[12:15], v[80:83], v[36:39], a[12:15]
  ds_read_b64_tr_b16 v[54:55], v14 offset:20480
  v_mfma_f32_16x16x32_bf16 a[16:19], v[68:71], v[40:43], a[16:19]
  ds_read_b128 v[24:27], v11 offset:2048
  v_mfma_f32_16x16x32_bf16 a[20:23], v[72:75], v[40:43], a[20:23]
  ds_read_b64_tr_b16 v[56:57], v14 offset:16392
  v_mfma_f32_16x16x32_bf16 a[24:27], v[76:79], v[40:43], a[24:27]
  ds_read_b64_tr_b16 v[58:59], v14 offset:20488
  v_mfma_f32_16x16x32_bf16 a[28:31], v[80:83], v[40:43], a[28:31]
  ds_read_b128 v[28:31], v11 offset:4096
  v_mfma_f32_16x16x32_bf16 a[32:35], v[68:71], v[44:47], a[32:35]
  ds_read_b64_tr_b16 v[60:61], v15 offset:16384
  v_mfma_f32_16x16x32_bf16 a[36:39], v[72:75], v[44:47], a[36:39]
  ds_read_b64_tr_b16 v[62:63], v15 offset:20480
  v_mfma_f32_16x16x32_bf16 a[40:43], v[76:79], v[44:47], a[40:43]
  ds_read_b128 v[32:35], v11 offset:6144
  v_mfma_f32_16x16x32_bf16 a[44:47], v[80:83], v[44:47], a[44:47]
  ds_read_b64_tr_b16 v[64:65], v15 offset:16392
  v_mfma_f32_16x16x32_bf16 a[48:51], v[68:71], v[48:51], a[48:51]
  ds_read_b64_tr_b16 v[66:67], v15 offset:20488
  v_mfma_f32_16x16x32_bf16 a[52:55], v[72:75], v[48:51], a[52:55]
  v_mfma_f32_16x16x32_bf16 a[56:59], v[76:79], v[48:51], a[56:59]
  v_mfma_f32_16x16x32_bf16 a[60:63], v[80:83], v[48:51], a[60:63]
  s_waitcnt lgkmcnt(0)
  v_mfma_f32_16x16x32_bf16 a[0:3], v[52:55], v[20:23], a[0:3]
  ds_read_b128 v[36:39], v11 offset:1024
  v_mfma_f32_16x16x32_bf16 a[4:7], v[56:59], v[20:23], a[4:7]
  ds_read_b64_tr_b16 v[68:69], v14 offset:24576
  v_mfma_f32_16x16x32_bf16 a[8:11], v[60:63], v[20:23], a[8:11]
  ds_read_b64_tr_b16 v[70:71], v14 offset:28672
  v_mfma_f32_16x16x32_bf16 a[12:15], v[64:67], v[20:23], a[12:15]
  ds_read_b128 v[40:43], v11 offset:3072
  v_mfma_f32_16x16x32_bf16 a[16:19], v[52:55], v[24:27], a[16:19]
  ds_read_b64_tr_b16 v[72:73], v14 offset:24584
  v_mfma_f32_16x16x32_bf16 a[20:23], v[56:59], v[24:27], a[20:23]
  ds_read_b64_tr_b16 v[74:75], v14 offset:28680
  v_mfma_f32_16x16x32_bf16 a[24:27], v[60:63], v[24:27], a[24:27]
  ds_read_b128 v[44:47], v11 offset:5120
  v_mfma_f32_16x16x32_bf16 a[28:31], v[64:67], v[24:27], a[28:31]
  ds_read_b64_tr_b16 v[76:77], v15 offset:24576
  v_mfma_f32_16x16x32_bf16 a[32:35], v[52:55], v[28:31], a[32:35]
  ds_read_b64_tr_b16 v[78:79], v15 offset:28672
  v_mfma_f32_16x16x32_bf16 a[36:39], v[56:59], v[28:31], a[36:39]
  ds_read_b128 v[48:51], v11 offset:7168
  v_mfma_f32_16x16x32_bf16 a[40:43], v[60:63], v[28:31], a[40:43]
  ds_read_b64_tr_b16 v[80:81], v15 offset:24584
  v_mfma_f32_16x16x32_bf16 a[44:47], v[64:67], v[28:31], a[44:47]
  ds_read_b64_tr_b16 v[82:83], v15 offset:28680
  v_mfma_f32_16x16x32_bf16 a[48:51], v[52:55], v[32:35], a[48:51]
  v_mfma_f32_16x16x32_bf16 a[52:55], v[56:59], v[32:35], a[52:55]
  v_mfma_f32_16x16x32_bf16 a[56:59], v[60:63], v[32:35], a[56:59]
  v_mfma_f32_16x16x32_bf16 a[60:63], v[64:67], v[32:35], a[60:63]
  s_waitcnt lgkmcnt(0)
  v_mfma_f32_16x16x32_bf16 a[0:3], v[68:71], v[36:39], a[0:3]
  s_waitcnt vmcnt(0)
  s_barrier
  v_mfma_f32_16x16x32_bf16 a[4:7], v[72:75], v[36:39], a[4:7]
  ds_read_b128 v[20:23], v11 offset:32768
  v_mfma_f32_16x16x32_bf16 a[8:11], v[76:79], v[36:39], a[8:11]
  ds_read_b64_tr_b16 v[52:53], v14 offset:49152
  v_mfma_f32_16x16x32_bf16 a[12:15], v[80:83], v[36:39], a[12:15]
  ds_read_b64_tr_b16 v[54:55], v14 offset:53248
  v_mfma_f32_16x16x32_bf16 a[16:19], v[68:71], v[40:43], a[16:19]
  ds_read_b128 v[24:27], v11 offset:34816
  v_mfma_f32_16x16x32_bf16 a[20:23], v[72:75], v[40:43], a[20:23]
  ds_read_b64_tr_b16 v[56:57], v14 offset:49160
  v_mfma_f32_16x16x32_bf16 a[24:27], v[76:79], v[40:43], a[24:27]
  ds_read_b64_tr_b16 v[58:59], v14 offset:53256
  v_mfma_f32_16x16x32_bf16 a[28:31], v[80:83], v[40:43], a[28:31]
  ds_read_b128 v[28:31], v11 offset:36864
  v_mfma_f32_16x16x32_bf16 a[32:35], v[68:71], v[44:47], a[32:35]
  ds_read_b64_tr_b16 v[60:61], v15 offset:49152
  v_mfma_f32_16x16x32_bf16 a[36:39], v[72:75], v[44:47], a[36:39]
  ds_read_b64_tr_b16 v[62:63], v15 offset:53248
  v_mfma_f32_16x16x32_bf16 a[40:43], v[76:79], v[44:47], a[40:43]
  ds_read_b128 v[32:35], v11 offset:38912
  v_mfma_f32_16x16x32_bf16 a[44:47], v[80:83], v[44:47], a[44:47]
  ds_read_b64_tr_b16 v[64:65], v15 offset:49160
  v_mfma_f32_16x16x32_bf16 a[48:51], v[68:71], v[48:51], a[48:51]
  ds_read_b64_tr_b16 v[66:67], v15 offset:53256
  v_mfma_f32_16x16x32_bf16 a[52:55], v[72:75], v[48:51], a[52:55]
  v_mfma_f32_16x16x32_bf16 a[56:59], v[76:79], v[48:51], a[56:59]
  v_mfma_f32_16x16x32_bf16 a[60:63], v[80:83], v[48:51], a[60:63]
  s_waitcnt lgkmcnt(0)
  v_mfma_f32_16x16x32_bf16 a[0:3], v[52:55], v[20:23], a[0:3]
  ds_read_b128 v[36:39], v11 offset:33792
  v_mfma_f32_16x16x32_bf16 a[4:7], v[56:59], v[20:23], a[4:7]
  ds_read_b64_tr_b16 v[68:69], v14 offset:57344
  v_mfma_f32_16x16x32_bf16 a[8:11], v[60:63], v[20:23], a[8:11]
  ds_read_b64_tr_b16 v[70:71], v14 offset:61440
  v_mfma_f32_16x16x32_bf16 a[12:15], v[64:67], v[20:23], a[12:15]
  ds_read_b128 v[40:43], v11 offset:35840
  v_mfma_f32_16x16x32_bf16 a[16:19], v[52:55], v[24:27], a[16:19]
  ds_read_b64_tr_b16 v[72:73], v14 offset:57352
  v_mfma_f32_16x16x32_bf16 a[20:23], v[56:59], v[24:27], a[20:23]
  ds_read_b64_tr_b16 v[74:75], v14 offset:61448
  v_mfma_f32_16x16x32_bf16 a[24:27], v[60:63], v[24:27], a[24:27]
  ds_read_b128 v[44:47], v11 offset:37888
  v_mfma_f32_16x16x32_bf16 a[28:31], v[64:67], v[24:27], a[28:31]
  ds_read_b64_tr_b16 v[76:77], v15 offset:57344
  v_mfma_f32_16x16x32_bf16 a[32:35], v[52:55], v[28:31], a[32:35]
  ds_read_b64_tr_b16 v[78:79], v15 offset:61440
  v_mfma_f32_16x16x32_bf16 a[36:39], v[56:59], v[28:31], a[36:39]
  ds_read_b128 v[48:51], v11 offset:39936
  v_mfma_f32_16x16x32_bf16 a[40:43], v[60:63], v[28:31], a[40:43]
  ds_read_b64_tr_b16 v[80:81], v15 offset:57352
  v_mfma_f32_16x16x32_bf16 a[44:47], v[64:67], v[28:31], a[44:47]
  ds_read_b64_tr_b16 v[82:83], v15 offset:61448
  v_mfma_f32_16x16x32_bf16 a[48:51], v[52:55], v[32:35], a[48:51]
  v_mfma_f32_16x16x32_bf16 a[52:55], v[56:59], v[32:35], a[52:55]
  v_mfma_f32_16x16x32_bf16 a[56:59], v[60:63], v[32:35], a[56:59]
  v_mfma_f32_16x16x32_bf16 a[60:63], v[64:67], v[32:35], a[60:63]
  s_waitcnt lgkmcnt(0)
  v_mfma_f32_16x16x32_bf16 a[0:3], v[68:71], v[36:39], a[0:3]
  v_mfma_f32_16x16x32_bf16 a[4:7], v[72:75], v[36:39], a[4:7]
  v_mfma_f32_16x16x32_bf16 a[8:11], v[76:79], v[36:39], a[8:11]
  v_mfma_f32_16x16x32_bf16 a[12:15], v[80:83], v[36:39], a[12:15]
  v_mfma_f32_16x16x32_bf16 a[16:19], v[68:71], v[40:43], a[16:19]
  v_mfma_f32_16x16x32_bf16 a[20:23], v[72:75], v[40:43], a[20:23]
  v_mfma_f32_16x16x32_bf16 a[24:27], v[76:79], v[40:43], a[24:27]
  v_mfma_f32_16x16x32_bf16 a[28:31], v[80:83], v[40:43], a[28:31]
  v_mfma_f32_16x16x32_bf16 a[32:35], v[68:71], v[44:47], a[32:35]
  v_mfma_f32_16x16x32_bf16 a[36:39], v[72:75], v[44:47], a[36:39]
  v_mfma_f32_16x16x32_bf16 a[40:43], v[76:79], v[44:47], a[40:43]
  v_mfma_f32_16x16x32_bf16 a[44:47], v[80:83], v[44:47], a[44:47]
  v_mfma_f32_16x16x32_bf16 a[48:51], v[68:71], v[48:51], a[48:51]
  v_mfma_f32_16x16x32_bf16 a[52:55], v[72:75], v[48:51], a[52:55]
  v_mfma_f32_16x16x32_bf16 a[56:59], v[76:79], v[48:51], a[56:59]
  v_mfma_f32_16x16x32_bf16 a[60:63], v[80:83], v[48:51], a[60:63]
  s_cmp_ge_u32 s35, 8
  s_cbranch_scc1 L_part
  s_mov_b32 s59, 5
  s_mov_b32 s60, s22
  s_mov_b32 s61, s26
  s_add_u32 s62, s38, 0x3d00000
  s_mov_b32 s63, s98
  s_cmp_lg_u32 s39, 0
  s_cbranch_scc1 L_got
  s_mov_b32 s58, 3
  s_branch L_epi
L_part:
  s_sub_u32 s40, s36, 12
  s_lshl_b32 s40, s40, 3
  s_add_u32 s40, s40, s50
  s_lshl_b32 s41, s40, 19
  s_add_u32 s41, s41, 0x6400000
  s_lshl_b32 s90, s32, 14
  s_add_u32 s41, s41, s90
  s_lshl_b32 s90, s48, 16
  s_add_u32 s42, s41, s90
  v_lshlrev_b32 v2, 4, v1
  buffer_store_dwordx4 a[0:3], v2, s[4:7], s42 offen offset:0 sc1
  buffer_store_dwordx4 a[4:7], v2, s[4:7], s42 offen offset:1024 sc1
  buffer_store_dwordx4 a[8:11], v2, s[4:7], s42 offen offset:2048 sc1
  buffer_store_dwordx4 a[12:15], v2, s[4:7], s42 offen offset:3072 sc1
  s_add_u32 s42, s42, 4096
  buffer_store_dwordx4 a[16:19], v2, s[4:7], s42 offen offset:0 sc1
  buffer_store_dwordx4 a[20:23], v2, s[4:7], s42 offen offset:1024 sc1
  buffer_store_dwordx4 a[24:27], v2, s[4:7], s42 offen offset:2048 sc1
  buffer_store_dwordx4 a[28:31], v2, s[4:7], s42 offen offset:3072 sc1
  s_add_u32 s42, s42, 4096
  buffer_store_dwordx4 a[32:35], v2, s[4:7], s42 offen offset:0 sc1
  buffer_store_dwordx4 a[36:39], v2, s[4:7], s42 offen offset:1024 sc1
  buffer_store_dwordx4 a[40:43], v2, s[4:7], s42 offen offset:2048 sc1
  buffer_store_dwordx4 a[44:47], v2, s[4:7], s42 offen offset:3072 sc1
  s_add_u32 s42, s42, 4096
  buffer_store_dwordx4 a[48:51], v2, s[4:7], s42 offen offset:0 sc1
  buffer_store_dwordx4 a[52:55], v2, s[4:7], s42 offen offset:1024 sc1
  buffer_store_dwordx4 a[56:59], v2, s[4:7], s42 offen offset:2048 sc1
  buffer_store_dwordx4 a[60:63], v2, s[4:7], s42 offen offset:3072 sc1
  s_lshl_b32 s40, s40, 7
  s_add_u32 s43, s40, 0x3d04000
  s_waitcnt vmcnt(0)
  s_barrier
  s_cmp_lg_u32 s32, 0
  s_cbranch_scc1 L_sig_102
  v_mov_b32 v254, 1
  v_mov_b32 v255, 0
  s_mov_b64 exec, 1
  buffer_atomic_add v254, v255, s[4:7], s43 offen offset:0 sc1
  s_mov_b64 exec, -1
L_sig_102:
  s_cmp_eq_u32 s35, 8
  s_cselect_b32 s43, 8, 4
  s_cmp_lg_u32 s32, 0
  s_cbranch_scc1 L_dd_104
  v_mov_b32 v228, 0x3d00000
  v_mov_b32 v232, 0x3d04000
L_dw_103:
  buffer_load_dword v234, v232, s[4:7], s40 offen offset:0 sc1
  s_waitcnt vmcnt(0)
  s_mov_b32 s44, 1
  v_readfirstlane_b32 s45, v234
  s_cmp_ge_u32 s45, s43
  s_cselect_b32 s44, s44, 0
  s_cmp_eq_u32 s44, 1
  s_cbranch_scc1 L_dd_104
  s_sleep 1
  s_add_u32 s3, s3, 1
  s_cmp_lt_u32 s3, 131072
  s_cbranch_scc1 L_dw_103
L_dd_104:
  s_barrier
  s_cmp_lg_u32 s32, 0
  s_cbranch_scc1 L_rq_105
  s_cmp_eq_u32 s39, 0
  s_cbranch_scc1 L_rq_105
  s_lshl_b32 s99, s33, 7
  s_add_u32 s99, s99, 0x3d00200
  v_mov_b32 v244, 1
  v_mov_b32 v245, 0
  s_mov_b64 exec, 1
  buffer_atomic_add v244, v245, s[4:7], s99 offen sc0 sc1
  s_mov_b64 exec, -1
L_rq_105:
  s_cmp_eq_u32 s35, 14
  s_cbranch_scc1 L_part4
  s_lshl_b32 s90, s48, 11
  s_add_u32 s41, s41, s90
  buffer_load_dwordx4 v[16:19], v2, s[4:7], s41 offen offset:0 sc1
  buffer_load_dwordx4 v[20:23], v2, s[4:7], s41 offen offset:1024 sc1
  s_add_u32 s41, s41, 0x10000
  buffer_load_dwordx4 v[24:27], v2, s[4:7], s41 offen offset:0 sc1
  buffer_load_dwordx4 v[28:31], v2, s[4:7], s41 offen offset:1024 sc1
  s_add_u32 s41, s41, 0x10000
  buffer_load_dwordx4 v[32:35], v2, s[4:7], s41 offen offset:0 sc1
  buffer_load_dwordx4 v[36:39], v2, s[4:7], s41 offen offset:1024 sc1
  s_add_u32 s41, s41, 0x10000
  buffer_load_dwordx4 v[40:43], v2, s[4:7], s41 offen offset:0 sc1
  buffer_load_dwordx4 v[44:47], v2, s[4:7], s41 offen offset:1024 sc1
  s_add_u32 s41, s41, 0x10000
  buffer_load_dwordx4 v[48:51], v2, s[4:7], s41 offen offset:0 sc1
  buffer_load_dwordx4 v[52:55], v2, s[4:7], s41 offen offset:1024 sc1
  s_add_u32 s41, s41, 0x10000
  buffer_load_dwordx4 v[56:59], v2, s[4:7], s41 offen offset:0 sc1
  buffer_load_dwordx4 v[60:63], v2, s[4:7], s41 offen offset:1024 sc1
  s_add_u32 s41, s41, 0x10000
  buffer_load_dwordx4 v[64:67], v2, s[4:7], s41 offen offset:0 sc1
  buffer_load_dwordx4 v[68:71], v2, s[4:7], s41 offen offset:1024 sc1
  s_add_u32 s41, s41, 0x10000
  buffer_load_dwordx4 v[72:75], v2, s[4:7], s41 offen offset:0 sc1
  buffer_load_dwordx4 v[76:79], v2, s[4:7], s41 offen offset:1024 sc1
  s_add_u32 s41, s41, 0x10000
  v_mov_b32 v3, 0x0
  v_bfe_u32 v4, v1, 0, 4
  v_lshl_add_u32 v3, v4, 12, v3
  v_bfe_u32 v4, v1, 4, 2
  v_lshl_add_u32 v3, v4, 4, v3
  s_lshr_b32 s90, s32, 1
  s_lshl_b32 s90, s90, 18
  s_add_u32 s22, s22, s90
  s_and_b32 s90, s32, 1
  s_lshl_b32 s90, s90, 7
  s_add_u32 s22, s22, s90
  s_lshr_b32 s90, s48, 1
  s_lshl_b32 s90, s90, 16
  s_add_u32 s22, s22, s90
  s_and_b32 s90, s48, 1
  s_lshl_b32 s90, s90, 6
  s_add_u32 s22, s22, s90
  s_waitcnt vmcnt(12)
  v_pk_add_f32 v[16:17], v[16:17], v[24:25]
  v_pk_add_f32 v[18:19], v[18:19], v[26:27]
  v_pk_add_f32 v[20:21], v[20:21], v[28:29]
  v_pk_add_f32 v[22:23], v[22:23], v[30:31]
  s_waitcnt vmcnt(10)
  v_pk_add_f32 v[16:17], v[16:17], v[32:33]
  v_pk_add_f32 v[18:19], v[18:19], v[34:35]
  v_pk_add_f32 v[20:21], v[20:21], v[36:37]
  v_pk_add_f32 v[22:23], v[22:23], v[38:39]
  s_waitcnt vmcnt(8)
  v_pk_add_f32 v[16:17], v[16:17], v[40:41]
  v_pk_add_f32 v[18:19], v[18:19], v[42:43]
  v_pk_add_f32 v[20:21], v[20:21], v[44:45]
  v_pk_add_f32 v[22:23], v[22:23], v[46:47]
  s_waitcnt vmcnt(6)
  v_pk_add_f32 v[16:17], v[16:17], v[48:49]
  v_pk_add_f32 v[18:19], v[18:19], v[50:51]
  v_pk_add_f32 v[20:21], v[20:21], v[52:53]
  v_pk_add_f32 v[22:23], v[22:23], v[54:55]
  s_waitcnt vmcnt(4)
  v_pk_add_f32 v[16:17], v[16:17], v[56:57]
  v_pk_add_f32 v[18:19], v[18:19], v[58:59]
  v_pk_add_f32 v[20:21], v[20:21], v[60:61]
  v_pk_add_f32 v[22:23], v[22:23], v[62:63]
  s_waitcnt vmcnt(2)
  v_pk_add_f32 v[16:17], v[16:17], v[64:65]
  v_pk_add_f32 v[18:19], v[18:19], v[66:67]
  v_pk_add_f32 v[20:21], v[20:21], v[68:69]
  v_pk_add_f32 v[22:23], v[22:23], v[70:71]
  s_waitcnt vmcnt(0)
  v_pk_add_f32 v[16:17], v[16:17], v[72:73]
  v_pk_add_f32 v[18:19], v[18:19], v[74:75]
  v_pk_add_f32 v[20:21], v[20:21], v[76:77]
  v_pk_add_f32 v[22:23], v[22:23], v[78:79]
  v_cvt_pk_bf16_f32 v8, v16, v17
  v_cvt_pk_bf16_f32 v9, v18, v19
  v_cvt_pk_bf16_f32 v10, v20, v21
  v_cvt_pk_bf16_f32 v11, v22, v23
  buffer_store_dwordx4 v[8:11], v3, s[16:19], s22 offen sc1
  s_branch L_got
L_part4:
  s_lshl_b32 s90, s48, 12
  s_add_u32 s41, s41, s90
  buffer_load_dwordx4 v[16:19], v2, s[4:7], s41 offen offset:0 sc1
  buffer_load_dwordx4 v[20:23], v2, s[4:7], s41 offen offset:1024 sc1
  buffer_load_dwordx4 v[24:27], v2, s[4:7], s41 offen offset:2048 sc1
  buffer_load_dwordx4 v[28:31], v2, s[4:7], s41 offen offset:3072 sc1
  s_add_u32 s41, s41, 0x10000
  buffer_load_dwordx4 v[32:35], v2, s[4:7], s41 offen offset:0 sc1
  buffer_load_dwordx4 v[36:39], v2, s[4:7], s41 offen offset:1024 sc1
  buffer_load_dwordx4 v[40:43], v2, s[4:7], s41 offen offset:2048 sc1
  buffer_load_dwordx4 v[44:47], v2, s[4:7], s41 offen offset:3072 sc1
  s_add_u32 s41, s41, 0x10000
  buffer_load_dwordx4 v[48:51], v2, s[4:7], s41 offen offset:0 sc1
  buffer_load_dwordx4 v[52:55], v2, s[4:7], s41 offen offset:1024 sc1
  buffer_load_dwordx4 v[56:59], v2, s[4:7], s41 offen offset:2048 sc1
  buffer_load_dwordx4 v[60:63], v2, s[4:7], s41 offen offset:3072 sc1
  s_add_u32 s41, s41, 0x10000
  buffer_load_dwordx4 v[64:67], v2, s[4:7], s41 offen offset:0 sc1
  buffer_load_dwordx4 v[68:71], v2, s[4:7], s41 offen offset:1024 sc1
  buffer_load_dwordx4 v[72:75], v2, s[4:7], s41 offen offset:2048 sc1
  buffer_load_dwordx4 v[76:79], v2, s[4:7], s41 offen offset:3072 sc1
  s_add_u32 s41, s41, 0x10000
  v_mov_b32 v3, 0x0
  v_bfe_u32 v4, v1, 0, 4
  v_lshl_add_u32 v3, v4, 12, v3
  v_bfe_u32 v4, v1, 4, 2
  v_lshl_add_u32 v3, v4, 4, v3
  s_lshr_b32 s90, s32, 1
  s_lshl_b32 s90, s90, 18
  s_add_u32 s22, s22, s90
  s_and_b32 s90, s32, 1
  s_lshl_b32 s90, s90, 7
  s_add_u32 s22, s22, s90
  s_lshl_b32 s90, s48, 16
  s_add_u32 s22, s22, s90
  s_waitcnt vmcnt(8)
  v_pk_add_f32 v[16:17], v[16:17], v[32:33]
  v_pk_add_f32 v[18:19], v[18:19], v[34:35]
  v_pk_add_f32 v[20:21], v[20:21], v[36:37]
  v_pk_add_f32 v[22:23], v[22:23], v[38:39]
  v_pk_add_f32 v[24:25], v[24:25], v[40:41]
  v_pk_add_f32 v[26:27], v[26:27], v[42:43]
  v_pk_add_f32 v[28:29], v[28:29], v[44:45]
  v_pk_add_f32 v[30:31], v[30:31], v[46:47]
  s_waitcnt vmcnt(4)
  v_pk_add_f32 v[16:17], v[16:17], v[48:49]
  v_pk_add_f32 v[18:19], v[18:19], v[50:51]
  v_pk_add_f32 v[20:21], v[20:21], v[52:53]
  v_pk_add_f32 v[22:23], v[22:23], v[54:55]
  v_pk_add_f32 v[24:25], v[24:25], v[56:57]
  v_pk_add_f32 v[26:27], v[26:27], v[58:59]
  v_pk_add_f32 v[28:29], v[28:29], v[60:61]
  v_pk_add_f32 v[30:31], v[30:31], v[62:63]
  s_waitcnt vmcnt(0)
  v_pk_add_f32 v[16:17], v[16:17], v[64:65]
  v_pk_add_f32 v[18:19], v[18:19], v[66:67]
  v_pk_add_f32 v[20:21], v[20:21], v[68:69]
  v_pk_add_f32 v[22:23], v[22:23], v[70:71]
  v_pk_add_f32 v[24:25], v[24:25], v[72:73]
  v_pk_add_f32 v[26:27], v[26:27], v[74:75]
  v_pk_add_f32 v[28:29], v[28:29], v[76:77]
  v_pk_add_f32 v[30:31], v[30:31], v[78:79]
  v_cvt_pk_bf16_f32 v8, v16, v17
  v_cvt_pk_bf16_f32 v9, v18, v19
  v_cvt_pk_bf16_f32 v10, v20, v21
  v_cvt_pk_bf16_f32 v11, v22, v23
  v_cvt_pk_bf16_f32 v12, v24, v25
  v_cvt_pk_bf16_f32 v13, v26, v27
  v_cvt_pk_bf16_f32 v14, v28, v29
  v_cvt_pk_bf16_f32 v15, v30, v31
  buffer_store_dwordx4 v[8:11], v3, s[16:19], s22 offen offset:0 sc1
  buffer_store_dwordx4 v[12:15], v3, s[16:19], s22 offen offset:64 sc1
  s_branch L_got
L_done:
  s_waitcnt vmcnt(0)
  s_barrier
  s_add_u32 s38, s38, 0x3d00000
  s_cmp_lg_u32 s32, 0
  s_cbranch_scc1 L_sig_106
  v_mov_b32 v254, s98
  v_mov_b32 v255, 0
  s_mov_b64 exec, 1
  buffer_atomic_add v254, v255, s[4:7], s38 offen offset:0 sc1
  s_mov_b64 exec, -1
L_sig_106:
  s_mov_b32 s59, 0
  s_cmp_lg_u32 s35, 6
  s_cbranch_scc1 L_got
  s_add_u32 s36, s36, 2
  s_and_b32 s50, s36, 7
  s_cmp_lt_u32 s36, 62
  s_cbranch_scc1 L_ata_c
  s_branch L_got
L_exit:
  s_endpgm
.p2align 3
L_table:
.long 0x9
.long 0xa
.long 0x10009
.long 0x1000a
.long 0x20009
.long 0x2000a
.long 0x30009
.long 0x3000a
.long 0x40009
.long 0x4000a
.long 0x50009
.long 0x5000a
.long 0x60009
.long 0x6000a
.long 0x70009
.long 0x7000a
.long 0x109
.long 0x10a
.long 0x10109
.long 0x1010a
.long 0x20109
.long 0x2010a
.long 0x30109
.long 0x3010a
.long 0x40109
.long 0x4010a
.long 0x50109
.long 0x5010a
.long 0x60109
.long 0x6010a
.long 0x70109
.long 0x7010a
.long 0x209
.long 0x20a
.long 0x10209
.long 0x1020a
.long 0x20209
.long 0x2020a
.long 0x30209
.long 0x3020a
.long 0x40209
.long 0x4020a
.long 0x50209
.long 0x5020a
.long 0x60209
.long 0x6020a
.long 0x70209
.long 0x7020a
.long 0x201
.long 0x202
.long 0x10201
.long 0x10202
.long 0x20201
.long 0x20202
.long 0x30201
.long 0x30202
.long 0x301
.long 0x302
.long 0x10301
.long 0x10302
.long 0x20301
.long 0x20302
.long 0x30301
.long 0x30302
.long 0x309
.long 0x30a
.long 0x10309
.long 0x1030a
.long 0x20309
.long 0x2030a
.long 0x30309
.long 0x3030a
.long 0x40309
.long 0x4030a
.long 0x50309
.long 0x5030a
.long 0x60309
.long 0x6030a
.long 0x70309
.long 0x7030a
.long 0xc
.long 0x10c
.long 0x20c
.long 0x30c
.long 0x0
.long 0x10000
.long 0x20000
.long 0x30000
.long 0x100
.long 0x10100
.long 0x20100
.long 0x30100
.long 0x200
.long 0x10200
.long 0x20200
.long 0x30200
.long 0x401
.long 0x402
.long 0x10401
.long 0x10402
.long 0x20401
.long 0x20402
.long 0x30401
.long 0x30402
.long 0x501
.long 0x502
.long 0x10501
.long 0x10502
.long 0x20501
.long 0x20502
.long 0x30501
.long 0x30502
.long 0x300
.long 0x10300
.long 0x20300
.long 0x30300
.long 0x3
.long 0x10003
.long 0x20003
.long 0x103
.long 0x10103
.long 0x20103
.long 0x203
.long 0x10203
.long 0x20203
.long 0x303
.long 0x10303
.long 0x20303
.long 0x400
.long 0x10400
.long 0x20400
.long 0x30400
.long 0x500
.long 0x10500
.long 0x20500
.long 0x30500
.long 0x600
.long 0x10600
.long 0x20600
.long 0x30600
.long 0x700
.long 0x10700
.long 0x20700
.long 0x30700
.long 0xb
.long 0x1000b
.long 0x40b
.long 0x1040b
.long 0x80b
.long 0x1080b
.long 0xc0b
.long 0x10c0b
.long 0x403
.long 0x10403
.long 0x20403
.long 0x503
.long 0x10503
.long 0x20503
.long 0x603
.long 0x10603
.long 0x601
.long 0x602
.long 0x10601
.long 0x10602
.long 0x20601
.long 0x20602
.long 0x30601
.long 0x30602
.long 0x701
.long 0x702
.long 0x10701
.long 0x10702
.long 0x20701
.long 0x20702
.long 0x30701
.long 0x30702
.long 0x100b
.long 0x1100b
.long 0x140b
.long 0x1140b
.long 0x180b
.long 0x1180b
.long 0x1c0b
.long 0x11c0b
.long 0x200b
.long 0x1200b
.long 0x240b
.long 0x1240b
.long 0x2806
.long 0x12806
.long 0x2906
.long 0x12906
.long 0x7
.long 0x10007
.long 0x107
.long 0x10107
.long 0x207
.long 0x10207
.long 0x307
.long 0x10307
.long 0x407
.long 0x10407
.long 0x507
.long 0x10507
.long 0x607
.long 0x10607
.long 0x707
.long 0x10707
.long 0x20603
.long 0x703
.long 0x10703
.long 0x20703
.long 0x4
.long 0x10004
.long 0x20004
.long 0x30004
.long 0x104
.long 0x10104
.long 0x20104
.long 0x30104
.long 0x204
.long 0x10204
.long 0x20204
.long 0x30204
.long 0x807
.long 0x10807
.long 0x907
.long 0x10907
.long 0xa07
.long 0x10a07
.long 0x304
.long 0x10304
.long 0x20304
.long 0x30304
.long 0xb07
.long 0x10b07
.long 0xc07
.long 0x10c07
.long 0x404
.long 0x10404
.long 0x20404
.long 0x30404
.long 0x504
.long 0x10504
.long 0x20504
.long 0x30504
.long 0x604
.long 0x10604
.long 0x20604
.long 0x30604
.long 0x704
.long 0x10704
.long 0x20704
.long 0x30704
.long 0x5
.long 0x10005
.long 0x105
.long 0x10105
.long 0x205
.long 0x10205
.long 0x305
.long 0x10305
.long 0x405
.long 0x10405
.long 0xd0e
.long 0x10d0e
.long 0x20d0e
.long 0x30d0e
.long 0x40d0e
.long 0x50d0e
.long 0x60d0e
.long 0x70d0e
.long 0x505
.long 0x10505
.long 0x605
.long 0x10605
.long 0x705
.long 0x10705
.long 0x805
.long 0x10805
.long 0x905
.long 0x10905
.long 0xa05
.long 0x10a05
.long 0xb05
.long 0x10b05
.long 0x3e06
.long 0x13e06
.long 0x3f06
.long 0x13f06
.long 0xe0e
.long 0x10e0e
.long 0x20e0e
.long 0x30e0e
.long 0x40e0e
.long 0x50e0e
.long 0x60e0e
.long 0x70e0e
.long 0xc05
.long 0x10c05
.long 0xd05
.long 0x10d05
.long 0xe05
.long 0x10e05
.long 0xf05
.long 0x10f05
.long 0xf08
.long 0x10f08
.long 0x20f08
.long 0x30f08
.long 0x40f08
.long 0x50f08
.long 0x60f08
.long 0x70f08
.long 0x80f08
.long 0x90f08
.long 0xa0f08
.long 0xb0f08
.long 0xc0f08
.long 0xd0f08
.long 0xe0f08
.long 0xf0f08
.long 0xf
.long 0x0
.long 0x0
.long 0x0
.fill 186, 4, 0
.section .rodata,"a"
.p2align 6
.amdhsa_kernel concat_heads__memory_aug_recurrent_mem_tr__sliding_local_dilated__prompt_kernel
  .amdhsa_next_free_vgpr 512
  .amdhsa_next_free_sgpr 102
  .amdhsa_accum_offset 256
  .amdhsa_group_segment_fixed_size 0
  .amdhsa_kernarg_size 104
  .amdhsa_user_sgpr_count 2
  .amdhsa_user_sgpr_kernarg_segment_ptr 1
  .amdhsa_system_sgpr_workgroup_id_x 1
  .amdhsa_float_denorm_mode_32 3
  .amdhsa_float_denorm_mode_16_64 3
.end_amdhsa_kernel
```

```asm
; @launch grid=(256,1,1) block=(256,1,1) lds=149568
.amdgcn_target "amdgcn-amd-amdhsa--gfx950"
.text
.globl concat_heads__memory_aug_recurrent_mem_tr__sliding_local_dilated__prompt_kernel
.p2align 8
.type concat_heads__memory_aug_recurrent_mem_tr__sliding_local_dilated__prompt_kernel,@function
concat_heads__memory_aug_recurrent_mem_tr__sliding_local_dilated__prompt_kernel:
  s_cmp_ge_u32 s2, 256
  s_cbranch_scc1 L_exit
  s_load_dwordx4 s[92:95], s[0:1], 88
  s_load_dwordx16 s[64:79], s[0:1], 0
  s_getreg_b32 s39, hwreg(HW_REG_XCC_ID, 0, 3)
  v_lshrrev_b32 v2, 6, v0
  s_nop 0
  v_readfirstlane_b32 s32, v2
  s_mov_b32 s3, 0
  s_getpc_b64 s[86:87]
L_pc0:
  s_lshr_b32 s90, s2, 3
  s_lshl_b32 s90, s90, 2
  s_add_u32 s90, s90, s32
  s_and_b32 s90, s90, 31
  s_lshl_b32 s90, s90, 12
  v_and_b32 v1, 63, v0
  v_lshlrev_b32 v1, 6, v1
  v_add_u32 v1, s90, v1
  v_min_u32 v1, L_table-L_pc0, v1
  global_load_dword v199, v1, s[86:87]
  v_lshlrev_b32 v1, 3, v0
  v_add_u32 v1, L_table-L_pc0, v1
  global_load_dwordx2 v[248:249], v1, s[86:87]
  s_waitcnt lgkmcnt(0)
  s_mov_b32 s4, s94
  s_and_b32 s5, s95, 0xffff
  s_mov_b32 s6, 0x10000000
  s_mov_b32 s7, 0x20000
  s_mov_b32 s28, s92
  s_and_b32 s29, s93, 0xffff
  s_mov_b32 s30, 0x100
  s_mov_b32 s31, 0x20000
  s_mov_b32 s100, 0
  s_lshr_b32 s41, s2, 3
  s_lshl_b32 s101, 1, s41
  s_cmp_lg_u32 s32, 0
  s_cbranch_scc1 L_sweep
  s_lshl_b32 s90, s39, 2
  v_mov_b32 v247, s101
  v_mov_b32 v2, 0
  s_mov_b64 exec, 1
  buffer_atomic_or v247, v2, s[28:31], s90 offen offset:0 sc0 sc1
  s_mov_b64 exec, -1
L_sweep:
  s_lshl_b32 s40, s39, 5
  s_add_u32 s40, s40, s41
  s_mov_b32 s43, 1
  s_branch L_role
L_fallback:
  s_load_dwordx4 s[92:95], s[0:1], 88
  s_load_dwordx16 s[64:79], s[0:1], 0
  s_getreg_b32 s39, hwreg(HW_REG_XCC_ID, 0, 3)
  s_mov_b32 s100, 4
  v_mbcnt_lo_u32_b32 v0, -1, 0
  v_mbcnt_hi_u32_b32 v0, -1, v0
  s_lshl_b32 s90, s32, 6
  v_add_u32 v0, s90, v0
  s_waitcnt vmcnt(0) lgkmcnt(0)
  s_barrier
  s_cmp_lg_u32 s32, 0
  s_cbranch_scc1 L_tkd
  s_lshl_b32 s90, s39, 2
  v_mov_b32 v1, 1
  v_mov_b32 v2, 0
  v_lshlrev_b32 v3, 2, v0
  s_mov_b64 exec, 1
  buffer_atomic_add v1, v2, s[28:31], s90 offen offset:192 sc0 sc1
  s_mov_b64 exec, 0xff
L_tkw:
  buffer_load_dword v4, v3, s[28:31], 0 offen offset:192 sc1
  s_waitcnt vmcnt(0)
  v_readfirstlane_b32 s40, v1
  s_mov_b32 s41, 0
  s_mov_b32 s42, 0
  s_mov_b32 s43, 1
  v_readlane_b32 s44, v4, 0
  s_add_u32 s41, s41, s44
  s_cmp_gt_u32 s39, 0
  s_cselect_b32 s45, s44, 0
  s_add_u32 s42, s42, s45
  s_cmp_eq_u32 s44, 32
  s_cselect_b32 s43, s43, 0
  v_readlane_b32 s44, v4, 1
  s_add_u32 s41, s41, s44
  s_cmp_gt_u32 s39, 1
  s_cselect_b32 s45, s44, 0
  s_add_u32 s42, s42, s45
  s_cmp_eq_u32 s44, 32
  s_cselect_b32 s43, s43, 0
  v_readlane_b32 s44, v4, 2
  s_add_u32 s41, s41, s44
  s_cmp_gt_u32 s39, 2
  s_cselect_b32 s45, s44, 0
  s_add_u32 s42, s42, s45
  s_cmp_eq_u32 s44, 32
  s_cselect_b32 s43, s43, 0
  v_readlane_b32 s44, v4, 3
  s_add_u32 s41, s41, s44
  s_cmp_gt_u32 s39, 3
  s_cselect_b32 s45, s44, 0
  s_add_u32 s42, s42, s45
  s_cmp_eq_u32 s44, 32
  s_cselect_b32 s43, s43, 0
  v_readlane_b32 s44, v4, 4
  s_add_u32 s41, s41, s44
  s_cmp_gt_u32 s39, 4
  s_cselect_b32 s45, s44, 0
  s_add_u32 s42, s42, s45
  v_readlane_b32 s44, v4, 5
  s_add_u32 s41, s41, s44
  s_cmp_gt_u32 s39, 5
  s_cselect_b32 s45, s44, 0
  s_add_u32 s42, s42, s45
  v_readlane_b32 s44, v4, 6
  s_add_u32 s41, s41, s44
  s_cmp_gt_u32 s39, 6
  s_cselect_b32 s45, s44, 0
  s_add_u32 s42, s42, s45
  v_readlane_b32 s44, v4, 7
  s_add_u32 s41, s41, s44
  s_cmp_gt_u32 s39, 7
  s_cselect_b32 s45, s44, 0
  s_add_u32 s42, s42, s45
  s_add_u32 s3, s3, 1
  s_cmp_ge_u32 s3, 131072
  s_cbranch_scc1 L_tkbad
  s_sleep 4
  s_cmp_lt_u32 s41, 256
  s_cbranch_scc1 L_tkw
  s_add_u32 s40, s40, s42
  s_lshl_b32 s43, s43, 16
  s_or_b32 s40, s40, s43
  s_branch L_tkok
L_tkbad:
  s_mov_b32 s40, 0xffff
L_tkok:
  s_mov_b64 exec, -1
  v_mov_b32 v1, s40
  v_mov_b32 v2, 147456
  ds_write_b32 v2, v1
  s_waitcnt lgkmcnt(0)
L_tkd:
  s_barrier
  v_mov_b32 v2, 147456
  ds_read_b32 v1, v2
  s_waitcnt lgkmcnt(0)
  v_readfirstlane_b32 s40, v1
  s_barrier
  s_lshr_b32 s43, s40, 16
  s_and_b32 s40, s40, 0xffff
  s_cmp_ge_u32 s40, 256
  s_cbranch_scc1 L_exit
L_role:
  s_cmp_ge_u32 s40, 128
  s_cbranch_scc1 L_worker
  s_lshr_b32 s33, s40, 5
  s_and_b32 s34, s40, 31
  s_cmp_eq_u32 s43, 0
  s_cbranch_scc1 L_recslow
  s_load_dwordx4 s[80:83], s[0:1], 8
  s_load_dwordx4 s[84:87], s[0:1], 24
  s_load_dwordx2 s[88:89], s[0:1], 40
  v_lshrrev_b32 v31, 6, v0
  s_nop 0
  v_readfirstlane_b32 s32, v31
  v_and_b32 v0, 63, v0
  s_lshr_b32 s35, s34, 4
  s_lshl_b32 s90, s33, 1
  s_add_u32 s35, s35, s90
  s_and_b32 s36, s34, 15
  s_lshr_b32 s37, s36, 2
  s_lshl_b32 s90, s35, 2
  s_add_u32 s37, s37, s90
  s_and_b32 s38, s36, 3
  s_waitcnt lgkmcnt(0)
  s_mov_b32 s24, s80
  s_and_b32 s25, s81, 0xffff
  s_mov_b32 s26, 0x4000
  s_mov_b32 s27, 0x20000
  s_mov_b32 s8, s82
  s_and_b32 s9, s83, 0xffff
  s_mov_b32 s10, 0x800000
  s_mov_b32 s11, 0x20000
  s_mov_b32 s12, s84
  s_and_b32 s13, s85, 0xffff
  s_mov_b32 s14, 0x800000
  s_mov_b32 s15, 0x20000
  s_mov_b32 s16, s86
  s_and_b32 s17, s87, 0xffff
  s_mov_b32 s18, 0x800000
  s_mov_b32 s19, 0x20000
  s_mov_b32 s20, s88
  s_and_b32 s21, s89, 0xffff
  s_mov_b32 s22, 0x800000
  s_mov_b32 s23, 0x20000
  s_lshl_b32 s90, s32, 21
  s_lshl_b32 s91, s37, 8
  s_add_u32 s90, s90, s91
  s_lshr_b32 s91, s38, 1
  s_lshl_b32 s91, s91, 7
  s_add_u32 s90, s90, s91
  v_mov_b32 v180, 0x0
  v_bfe_u32 v31, v0, 3, 3
  v_lshl_add_u32 v180, v31, 13, v180
  v_bfe_u32 v31, v0, 0, 3
  v_lshl_add_u32 v180, v31, 4, v180
  v_add_u32 v180, s90, v180
  v_xor_b32 v185, 128, v180
  s_lshl_b32 s90, s35, 2
  s_add_u32 s90, s90, s32
  s_lshl_b32 s90, s90, 18
  s_lshl_b32 s91, s36, 7
  s_add_u32 s90, s90, s91
  v_mov_b32 v181, 0x0
  v_bfe_u32 v31, v0, 3, 3
  v_lshl_add_u32 v181, v31, 11, v181
  v_bfe_u32 v31, v0, 0, 3
  v_lshl_add_u32 v181, v31, 4, v181
  v_add_u32 v181, s90, v181
  s_lshl_b32 s96, s32, 15
  s_and_b32 s91, s38, 1
  s_lshl_b32 s91, s91, 6
  s_add_u32 s91, s91, s96
  v_mov_b32 v182, 0x0
  v_bfe_u32 v31, v0, 5, 1
  v_lshl_add_u32 v182, v31, 11, v182
  v_bfe_u32 v31, v0, 4, 1
  v_lshl_add_u32 v182, v31, 10, v182
  v_bfe_u32 v31, v0, 2, 2
  v_lshl_add_u32 v182, v31, 7, v182
  v_bfe_u32 v31, v0, 0, 2
  v_lshl_add_u32 v182, v31, 3, v182
  v_add_u32 v182, s91, v182
  s_lshl_b32 s91, s32, 5
  v_mov_b32 v183, 0x0
  v_bfe_u32 v31, v0, 4, 1
  v_lshl_add_u32 v183, v31, 13, v183
  v_bfe_u32 v31, v0, 5, 1
  v_lshl_add_u32 v183, v31, 8, v183
  v_bfe_u32 v31, v0, 2, 1
  v_lshl_add_u32 v183, v31, 10, v183
  v_bfe_u32 v31, v0, 3, 1
  v_lshl_add_u32 v183, v31, 7, v183
  v_bfe_u32 v31, v0, 0, 2
  v_lshl_add_u32 v183, v31, 3, v183
  v_add_u32 v183, s91, v183
  v_add_u32 v184, 0x10000, v183
  s_lshl_b32 s97, s34, 2
  s_add_u32 s97, s97, s32
  s_lshl_b32 s98, s97, 14
  s_lshl_b32 s91, s33, 21
  s_add_u32 s98, s98, s91
  s_lshl_b32 s97, s97, 16
  s_lshl_b32 s91, s33, 11
  s_add_u32 s97, s97, s91
  v_mov_b32 v16, 0x0
  v_bfe_u32 v31, v0, 0, 4
  v_lshl_add_u32 v16, v31, 7, v16
  v_bfe_u32 v31, v0, 4, 2
  v_lshl_add_u32 v16, v31, 13, v16
  v_add_u32 v17, 0x8000, v16
  v_lshlrev_b32 v18, 7, v0
  v_add_u32 v19, 0x2000, v18
  s_lshl_b32 s97, s34, 2
  s_add_u32 s97, s97, s32
  s_lshl_b32 s98, s97, 14
  s_lshl_b32 s91, s33, 21
  s_add_u32 s98, s98, s91
  s_lshl_b32 s97, s97, 16
  s_lshl_b32 s91, s33, 11
  s_add_u32 s97, s97, s91
  v_mov_b32 v16, 0x180
  v_bfe_u32 v31, v0, 0, 1
  v_lshl_add_u32 v16, v31, 10, v16
  v_bfe_u32 v31, v0, 1, 3
  v_lshl_add_u32 v16, v31, 13, v16
  v_mov_b32 v17, 0x180
  v_bfe_u32 v31, v0, 0, 4
  v_lshl_add_u32 v17, v31, 10, v17
  s_mov_b64 exec, 0xffff
  buffer_load_dword v201, v16, s[12:15], s97 offen
  buffer_load_dword v202, v16, s[16:19], s97 offen
  buffer_load_dword v200, v16, s[8:11], s97 offen
  buffer_load_dword v203, v17, s[20:23], s98 offen
  s_mov_b64 exec, -1
  s_lshl_b32 s58, s33, 5
  s_add_u32 s58, s58, s34
  s_lshl_b32 s59, s32, 19
  s_add_u32 s59, s59, 0x3800000
  s_lshl_b32 s90, s58, 11
  s_add_u32 s90, s90, s59
  s_mul_i32 s91, s58, 3072
  s_add_u32 s91, s91, s59
  s_add_u32 s91, s91, 0x200000
  v_lshlrev_b32 v6, 4, v0
  v_mov_b32 v8, -1
  v_mov_b32 v12, 0
  v_mov_b32 v9, -1
  v_mov_b32 v13, 0
  v_mov_b32 v10, -1
  v_mov_b32 v14, 0
  v_mov_b32 v11, -1
  v_mov_b32 v15, 0
  buffer_store_dwordx4 v[8:11], v6, s[4:7], s90 offen offset:0 sc1
  buffer_store_dwordx4 v[8:11], v6, s[4:7], s90 offen offset:1024 sc1
  buffer_store_dwordx4 v[8:11], v6, s[4:7], s91 offen offset:0 sc1
  buffer_store_dwordx4 v[8:11], v6, s[4:7], s91 offen offset:1024 sc1
  buffer_store_dwordx4 v[8:11], v6, s[4:7], s91 offen offset:2048 sc1
  s_lshl_b32 s58, s58, 2
  s_add_u32 s58, s58, s32
  s_cmp_ge_u32 s58, 36
  s_cbranch_scc1 FL_nz_1
  s_lshl_b32 s90, s58, 10
  s_add_u32 s90, s90, 0x3d00000
  buffer_store_dwordx4 v[12:15], v6, s[4:7], s90 offen sc1
FL_nz_1:
  s_cmp_lg_u32 s58, 3
  s_cbranch_scc1 FL_np_2
  v_mov_b32 v6, 0x3840000
  v_bfe_u32 v31, v0, 0, 1
  v_lshl_add_u32 v6, v31, 13, v6
  v_bfe_u32 v31, v0, 1, 1
  s_mov_b32 s99, 4352
  v_mad_u32_u24 v6, v31, s99, v6
  v_bfe_u32 v31, v0, 2, 2
  s_mov_b32 s99, 82432
  v_mad_u32_u24 v6, v31, s99, v6
  v_mov_b32 v7, -1
  s_mov_b64 exec, 0xffff
  buffer_store_dword v7, v6, s[4:7], 0 offen sc1
  s_mov_b64 exec, -1
  s_waitcnt vmcnt(0)
FL_np_2:
  s_add_u32 m0, s96, 0
  s_mov_b32 s90, 0x0
  buffer_load_dwordx4 v180, s[12:15], s90 offen  lds
  s_add_u32 m0, s96, 1024
  s_mov_b32 s90, 0x10000
  buffer_load_dwordx4 v180, s[12:15], s90 offen  lds
  s_add_u32 m0, s96, 2048
  s_mov_b32 s90, 0x20000
  buffer_load_dwordx4 v180, s[12:15], s90 offen  lds
  s_add_u32 m0, s96, 3072
  s_mov_b32 s90, 0x30000
  buffer_load_dwordx4 v180, s[12:15], s90 offen  lds
  s_add_u32 m0, s96, 4096
  s_mov_b32 s90, 0x0
  buffer_load_dwordx4 v185, s[16:19], s90 offen  lds
  s_add_u32 m0, s96, 5120
  s_mov_b32 s90, 0x10000
  buffer_load_dwordx4 v185, s[16:19], s90 offen  lds
  s_add_u32 m0, s96, 6144
  s_mov_b32 s90, 0x20000
  buffer_load_dwordx4 v185, s[16:19], s90 offen  lds
  s_add_u32 m0, s96, 7168
  s_mov_b32 s90, 0x30000
  buffer_load_dwordx4 v185, s[16:19], s90 offen  lds
  s_add_u32 m0, s96, 8192
  s_mov_b32 s90, 0x40000
  buffer_load_dwordx4 v180, s[12:15], s90 offen  lds
  s_add_u32 m0, s96, 9216
  s_mov_b32 s90, 0x50000
  buffer_load_dwordx4 v180, s[12:15], s90 offen  lds
  s_add_u32 m0, s96, 10240
  s_mov_b32 s90, 0x60000
  buffer_load_dwordx4 v180, s[12:15], s90 offen  lds
  s_add_u32 m0, s96, 11264
  s_mov_b32 s90, 0x70000
  buffer_load_dwordx4 v180, s[12:15], s90 offen  lds
  s_add_u32 m0, s96, 12288
  s_mov_b32 s90, 0x40000
  buffer_load_dwordx4 v185, s[16:19], s90 offen  lds
  s_add_u32 m0, s96, 13312
  s_mov_b32 s90, 0x50000
  buffer_load_dwordx4 v185, s[16:19], s90 offen  lds
  s_add_u32 m0, s96, 14336
  s_mov_b32 s90, 0x60000
  buffer_load_dwordx4 v185, s[16:19], s90 offen  lds
  s_add_u32 m0, s96, 15360
  s_mov_b32 s90, 0x70000
  buffer_load_dwordx4 v185, s[16:19], s90 offen  lds
  s_add_u32 m0, s96, 16384
  s_mov_b32 s90, 0x80000
  buffer_load_dwordx4 v180, s[12:15], s90 offen  lds
  s_add_u32 m0, s96, 17408
  s_mov_b32 s90, 0x90000
  buffer_load_dwordx4 v180, s[12:15], s90 offen  lds
  s_add_u32 m0, s96, 18432
  s_mov_b32 s90, 0xa0000
  buffer_load_dwordx4 v180, s[12:15], s90 offen  lds
  s_add_u32 m0, s96, 19456
  s_mov_b32 s90, 0xb0000
  buffer_load_dwordx4 v180, s[12:15], s90 offen  lds
  s_add_u32 m0, s96, 20480
  s_mov_b32 s90, 0x80000
  buffer_load_dwordx4 v185, s[16:19], s90 offen  lds
  s_add_u32 m0, s96, 21504
  s_mov_b32 s90, 0x90000
  buffer_load_dwordx4 v185, s[16:19], s90 offen  lds
  s_add_u32 m0, s96, 22528
  s_mov_b32 s90, 0xa0000
  buffer_load_dwordx4 v185, s[16:19], s90 offen  lds
  s_add_u32 m0, s96, 23552
  s_mov_b32 s90, 0xb0000
  buffer_load_dwordx4 v185, s[16:19], s90 offen  lds
  s_add_u32 m0, s96, 24576
  s_mov_b32 s90, 0xc0000
  buffer_load_dwordx4 v180, s[12:15], s90 offen  lds
  s_add_u32 m0, s96, 25600
  s_mov_b32 s90, 0xd0000
  buffer_load_dwordx4 v180, s[12:15], s90 offen  lds
  s_add_u32 m0, s96, 26624
  s_mov_b32 s90, 0xe0000
  buffer_load_dwordx4 v180, s[12:15], s90 offen  lds
  s_add_u32 m0, s96, 27648
  s_mov_b32 s90, 0xf0000
  buffer_load_dwordx4 v180, s[12:15], s90 offen  lds
  s_add_u32 m0, s96, 28672
  s_mov_b32 s90, 0xc0000
  buffer_load_dwordx4 v185, s[16:19], s90 offen  lds
  s_add_u32 m0, s96, 29696
  s_mov_b32 s90, 0xd0000
  buffer_load_dwordx4 v185, s[16:19], s90 offen  lds
  s_add_u32 m0, s96, 30720
  s_mov_b32 s90, 0xe0000
  buffer_load_dwordx4 v185, s[16:19], s90 offen  lds
  s_add_u32 m0, s96, 31744
  s_mov_b32 s90, 0xf0000
  buffer_load_dwordx4 v185, s[16:19], s90 offen  lds
  s_cmp_lg_u32 s58, 3
  s_cbranch_scc1 FL_np_3
  s_add_u32 s92, s94, 0x3840000
  s_addc_u32 s93, s95, 0
  s_mov_b32 s62, -1
  s_mov_b32 s63, -1
  s_memtime s[56:57]
  s_waitcnt lgkmcnt(0)
  s_load_dword s60, s[92:93], 0x0
  s_waitcnt lgkmcnt(0)
  s_memtime s[58:59]
  s_waitcnt lgkmcnt(0)
  s_sub_u32 s58, s58, s56
  s_min_u32 s62, s62, s58
  s_memtime s[56:57]
  s_waitcnt lgkmcnt(0)
  s_load_dword s60, s[92:93], 0x2000
  s_waitcnt lgkmcnt(0)
  s_memtime s[58:59]
  s_waitcnt lgkmcnt(0)
  s_sub_u32 s58, s58, s56
  s_min_u32 s63, s63, s58
  s_memtime s[56:57]
  s_waitcnt lgkmcnt(0)
  s_load_dword s60, s[92:93], 0x1100
  s_waitcnt lgkmcnt(0)
  s_memtime s[58:59]
  s_waitcnt lgkmcnt(0)
  s_sub_u32 s58, s58, s56
  s_min_u32 s62, s62, s58
  s_memtime s[56:57]
  s_waitcnt lgkmcnt(0)
  s_load_dword s60, s[92:93], 0x3100
  s_waitcnt lgkmcnt(0)
  s_memtime s[58:59]
  s_waitcnt lgkmcnt(0)
  s_sub_u32 s58, s58, s56
  s_min_u32 s63, s63, s58
  s_memtime s[56:57]
  s_waitcnt lgkmcnt(0)
  s_load_dword s60, s[92:93], 0x14200
  s_waitcnt lgkmcnt(0)
  s_memtime s[58:59]
  s_waitcnt lgkmcnt(0)
  s_sub_u32 s58, s58, s56
  s_min_u32 s62, s62, s58
  s_memtime s[56:57]
  s_waitcnt lgkmcnt(0)
  s_load_dword s60, s[92:93], 0x16200
  s_waitcnt lgkmcnt(0)
  s_memtime s[58:59]
  s_waitcnt lgkmcnt(0)
  s_sub_u32 s58, s58, s56
  s_min_u32 s63, s63, s58
  s_memtime s[56:57]
  s_waitcnt lgkmcnt(0)
  s_load_dword s60, s[92:93], 0x15300
  s_waitcnt lgkmcnt(0)
  s_memtime s[58:59]
  s_waitcnt lgkmcnt(0)
  s_sub_u32 s58, s58, s56
  s_min_u32 s62, s62, s58
  s_memtime s[56:57]
  s_waitcnt lgkmcnt(0)
  s_load_dword s60, s[92:93], 0x17300
  s_waitcnt lgkmcnt(0)
  s_memtime s[58:59]
  s_waitcnt lgkmcnt(0)
  s_sub_u32 s58, s58, s56
  s_min_u32 s63, s63, s58
  s_cmp_lt_u32 s63, s62
  s_cselect_b32 s60, 2, 1
  v_mov_b32 v6, s60
  v_mov_b32 v7, s62
  v_mov_b32 v8, s63
  v_mov_b32 v9, 0
  s_mov_b64 exec, 1
  buffer_store_dword v6, v9, s[28:31], 0 offen offset:128 sc1
  s_mov_b64 exec, -1
FL_np_3:
  s_lshl_b32 s90, s34, 2
  s_add_u32 s90, s90, s32
  s_lshr_b32 s91, s90, 3
  s_lshl_b32 s91, s91, 14
  s_and_b32 s92, s90, 7
  s_lshl_b32 s92, s92, 10
  s_add_u32 s91, s91, s92
  v_mov_b32 v1, 0x0
  v_bfe_u32 v31, v0, 0, 6
  v_lshl_add_u32 v1, v31, 4, v1
  v_add_u32 v1, s91, v1
  v_lshrrev_b32 v30, 4, v0
  v_cmp_eq_u32 vcc, s33, v30
  v_xor_b32 v29, 0x2000, v1
  s_nop 0
  v_cndmask_b32 v1, v1, v29, vcc
  s_lshl_b32 s91, s33, 14
  s_lshl_b32 s92, s90, 7
  s_add_u32 s91, s91, s92
  v_mov_b32 v2, 0x200000
  v_bfe_u32 v31, v0, 0, 2
  v_lshl_add_u32 v2, v31, 2, v2
  v_bfe_u32 v31, v0, 2, 1
  v_lshl_add_u32 v2, v31, 6, v2
  v_bfe_u32 v31, v0, 4, 1
  v_lshl_add_u32 v2, v31, 4, v2
  v_bfe_u32 v31, v0, 5, 1
  v_lshl_add_u32 v2, v31, 5, v2
  v_bfe_u32 v31, v0, 3, 1
  v_lshl_add_u32 v2, v31, 31, v2
  v_add_u32 v2, s91, v2
  s_lshr_b32 s92, s90, 1
  s_lshl_b32 s92, s92, 5
  s_and_b32 s91, s90, 1
  s_lshl_b32 s91, s91, 13
  s_add_u32 s92, s92, s91
  v_mov_b32 v30, 0x0
  v_bfe_u32 v31, v0, 2, 1
  v_lshl_add_u32 v30, v31, 12, v30
  v_bfe_u32 v31, v0, 4, 1
  v_lshl_add_u32 v30, v31, 11, v30
  v_bfe_u32 v31, v0, 0, 2
  v_lshl_add_u32 v30, v31, 3, v30
  v_bfe_u32 v31, v0, 5, 1
  v_lshl_add_u32 v30, v31, 2, v30
  v_add_u32 v30, s92, v30
  buffer_load_dword v44, v30, s[24:27], 0 offen
  s_lshl_b32 s91, s33, 14
  s_lshl_b32 s92, s32, 12
  s_add_u32 s91, s91, s92
  v_mov_b32 v3, 0x200000
  v_bfe_u32 v31, v0, 0, 6
  v_lshl_add_u32 v3, v31, 4, v3
  v_add_u32 v3, s91, v3
  s_mul_i32 s91, s32, 3264
  v_mov_b32 v4, 0x0
  v_bfe_u32 v31, v0, 0, 6
  v_lshl_add_u32 v4, v31, 4, v4
  v_add_u32 v4, s91, v4
  s_lshl_b32 s91, s32, 6
  v_mov_b32 v6, 0x0
  v_bfe_u32 v31, v0, 0, 2
  v_lshl_add_u32 v6, v31, 4, v6
  v_bfe_u32 v31, v0, 2, 1
  v_lshl_add_u32 v6, v31, 2, v6
  v_bfe_u32 v31, v0, 3, 1
  s_mov_b32 s99, 1088
  v_mad_u32_u24 v6, v31, s99, v6
  v_bfe_u32 v31, v0, 4, 2
  v_lshl_add_u32 v6, v31, 8, v6
  v_add_u32 v6, s91, v6
  v_add_u32 v240, 3264, v6
  v_add_u32 v241, 6528, v6
  v_add_u32 v242, 9792, v6
  s_lshl_b32 s93, s37, 13
  s_lshl_b32 s91, s38, 10
  s_add_u32 s91, s91, s93
  s_lshl_b32 s92, s32, 8
  s_add_u32 s91, s91, s92
  v_mov_b32 v7, 0x210000
  v_bfe_u32 v31, v0, 0, 6
  v_lshl_add_u32 v7, v31, 2, v7
  v_add_u32 v7, s91, v7
  s_lshl_b32 s91, s37, 11
  s_lshl_b32 s92, s38, 9
  s_add_u32 s59, s91, s92
  s_lshl_b32 s92, s32, 7
  s_add_u32 s91, s59, s92
  v_mov_b32 v19, 0x83000000
  v_bfe_u32 v31, v0, 0, 3
  v_lshl_add_u32 v19, v31, 2, v19
  v_bfe_u32 v31, v0, 4, 2
  v_lshl_add_u32 v19, v31, 5, v19
  v_bfe_u32 v31, v0, 3, 1
  v_lshl_add_u32 v19, v31, 31, v19
  v_add_u32 v19, s91, v19
  s_lshl_b32 s91, s32, 8
  v_mov_b32 v5, 0x880
  v_bfe_u32 v31, v0, 0, 1
  v_lshl_add_u32 v5, v31, 7, v5
  v_bfe_u32 v31, v0, 1, 1
  v_lshl_add_u32 v5, v31, 3, v5
  v_bfe_u32 v31, v0, 2, 3
  v_lshl_add_u32 v5, v31, 4, v5
  v_add_u32 v5, s91, v5
  s_lshr_b32 s92, s38, 1
  s_xor_b32 s92, s92, 1
  s_lshl_b32 s92, s92, 10
  s_add_u32 s91, s91, s92
  s_add_u32 s91, s91, s93
  s_and_b32 s92, s38, 1
  s_lshl_b32 s92, s92, 7
  s_add_u32 s91, s91, s92
  v_mov_b32 v8, 0x211000
  v_bfe_u32 v31, v0, 0, 5
  v_lshl_add_u32 v8, v31, 2, v8
  v_bfe_u32 v31, v0, 5, 1
  v_lshl_add_u32 v8, v31, 31, v8
  v_add_u32 v8, s91, v8
  s_sub_u32 s91, s91, s93
  s_lshl_b32 s92, s37, 11
  s_add_u32 s91, s91, s92
  v_mov_b32 v20, 0x3400000
  v_bfe_u32 v31, v0, 0, 5
  v_lshl_add_u32 v20, v31, 2, v20
  v_bfe_u32 v31, v0, 5, 1
  v_lshl_add_u32 v20, v31, 31, v20
  v_add_u32 v20, s91, v20
  s_lshl_b32 s97, s35, 2
  s_add_u32 s97, s97, s32
  s_lshl_b32 s97, s97, 13
  v_mov_b32 v9, 0x210000
  v_bfe_u32 v31, v0, 0, 6
  v_lshl_add_u32 v9, v31, 4, v9
  v_add_u32 v9, s97, v9
  v_add_u32 v10, 4096, v9
  v_mov_b32 v11, 0x1000000
  v_bfe_u32 v31, v0, 0, 2
  v_lshl_add_u32 v11, v31, 4, v11
  v_bfe_u32 v31, v0, 2, 1
  v_lshl_add_u32 v11, v31, 7, v11
  v_bfe_u32 v31, v0, 3, 1
  v_lshl_add_u32 v11, v31, 12, v11
  v_bfe_u32 v31, v0, 4, 2
  v_lshl_add_u32 v11, v31, 8, v11
  v_add_u32 v11, s97, v11
  v_mov_b32 v12, 0x2000000
  v_bfe_u32 v31, v0, 0, 3
  v_lshl_add_u32 v12, v31, 4, v12
  v_bfe_u32 v31, v0, 3, 1
  v_lshl_add_u32 v12, v31, 11, v12
  v_bfe_u32 v31, v0, 4, 2
  v_lshl_add_u32 v12, v31, 8, v12
  v_add_u32 v12, s97, v12
  v_add_u32 v13, 4096, v12
  s_lshl_b32 s91, s36, 9
  s_add_u32 s91, s91, s97
  s_add_u32 s63, s91, 0x1000000
  v_mov_b32 v21, 0x1000000
  v_bfe_u32 v31, v0, 0, 2
  v_lshl_add_u32 v21, v31, 7, v21
  v_bfe_u32 v31, v0, 2, 1
  v_lshl_add_u32 v21, v31, 24, v21
  v_add_u32 v21, s91, v21
  v_cmp_gt_u32 vcc, 8, v0
  v_mov_b32 v30, 0x80000000
  s_nop 0
  v_cndmask_b32 v21, v30, v21, vcc
  s_lshl_b32 s91, s32, 11
  v_mov_b32 v30, 0x0
  v_bfe_u32 v31, v0, 2, 1
  v_lshl_add_u32 v30, v31, 6, v30
  v_bfe_u32 v31, v0, 0, 1
  v_lshl_add_u32 v30, v31, 5, v30
  v_bfe_u32 v31, v0, 1, 1
  v_lshl_add_u32 v30, v31, 4, v30
  v_mov_b32 v29, 0x0
  v_bfe_u32 v31, v0, 4, 2
  v_lshl_add_u32 v29, v31, 5, v29
  v_xor_b32 v30, v30, v29
  v_mov_b32 v14, 0x3400
  v_bfe_u32 v31, v0, 0, 4
  v_lshl_add_u32 v14, v31, 7, v14
  v_add_u32 v14, s91, v14
  v_add_u32 v14, v14, v30
  v_xor_b32 v15, 16, v14
  v_mov_b32 v30, 0x0
  v_bfe_u32 v31, v0, 5, 1
  v_lshl_add_u32 v30, v31, 6, v30
  v_bfe_u32 v31, v0, 1, 1
  v_lshl_add_u32 v30, v31, 5, v30
  v_bfe_u32 v31, v0, 4, 1
  v_lshl_add_u32 v30, v31, 4, v30
  v_mov_b32 v29, 0x0
  v_bfe_u32 v31, v0, 2, 2
  v_lshl_add_u32 v29, v31, 5, v29
  v_bfe_u32 v31, v0, 0, 1
  v_lshl_add_u32 v29, v31, 4, v29
  v_xor_b32 v30, v30, v29
  v_mov_b32 v16, 0x3400
  v_bfe_u32 v31, v0, 4, 2
  v_lshl_add_u32 v16, v31, 8, v16
  v_bfe_u32 v31, v0, 1, 1
  v_lshl_add_u32 v16, v31, 7, v16
  v_add_u32 v16, v16, v30
  s_lshl_b32 s98, s36, 14
  s_lshl_b32 s92, s35, 7
  s_add_u32 s98, s98, s92
  s_lshl_b32 s92, s32, 11
  s_add_u32 s91, s98, s92
  v_mov_b32 v17, 0x0
  v_bfe_u32 v31, v0, 0, 5
  v_lshl_add_u32 v17, v31, 2, v17
  v_bfe_u32 v31, v0, 5, 1
  v_lshl_add_u32 v17, v31, 10, v17
  v_add_u32 v17, s91, v17
  v_xor_b32 v18, 0x2000, v17
  s_mov_b32 s48, 0x33333333
  s_mov_b32 s49, 0x33333333
  s_mov_b32 s50, 0xffff0000
  s_mov_b32 s51, 0xffff0000
  s_mov_b32 s52, 0x0000ffff
  s_mov_b32 s53, 0x0000ffff
  s_mov_b32 s54, 0xfffffffe
  s_mov_b32 s47, 0x3e0293ee
  v_mov_b32 v30, 0x4444
  v_mov_b32 v31, 0xeeee
  v_cndmask_b32 v23, v31, v30, s[48:49]
  v_mov_b32 v22, -1
  v_mov_b32 v232, 0
  v_mov_b32 v233, 0
  v_mov_b32 v234, 0
  v_mov_b32 v235, 0
  v_mov_b32 v112, 0
  v_mov_b32 v113, 0
  s_mov_b32 s56, 0xf0f0f0f0
  s_mov_b32 s57, 0xf0f0f0f0
  v_mov_b32 v30, 0x3f80
  v_mov_b32 v31, 1.0
  v_cndmask_b32 v30, v30, v31, s[56:57]
  s_mov_b32 s56, 0x110011
  s_mov_b32 s57, 0x110011
  v_cndmask_b32 v24, 0, v30, s[56:57]
  s_mov_b32 s56, 0x220022
  s_mov_b32 s57, 0x220022
  v_cndmask_b32 v25, 0, v30, s[56:57]
  s_mov_b32 s56, 0x11001100
  s_mov_b32 s57, 0x11001100
  v_cndmask_b32 v26, 0, v30, s[56:57]
  s_mov_b32 s56, 0x22002200
  s_mov_b32 s57, 0x22002200
  v_cndmask_b32 v27, 0, v30, s[56:57]
  s_mov_b32 s40, 0
  s_mov_b32 s41, 0x3800000
  s_mov_b32 s43, 0x3900000
  s_mov_b32 s44, 0
  s_mov_b32 s55, 0x40000
  s_mov_b32 s45, 0
  s_waitcnt vmcnt(33)
  s_barrier
  s_cmp_lg_u32 s32, 0
  s_cbranch_scc1 FL_sig_4
  v_mov_b32 v254, 1
  v_mov_b32 v255, 0
  s_mov_b64 exec, 1
  buffer_atomic_add v254, v255, s[28:31], s100 offen offset:132 sc1
  s_mov_b64 exec, -1
FL_sig_4:
  s_mov_b32 s90, 0x3e0000
  buffer_store_dword v22, v19, s[4:7], s90 offen sc1
  buffer_store_dword v22, v20, s[4:7], s90 offen sc1
  s_mov_b32 s90, 0x3f0000
  buffer_store_dword v22, v19, s[4:7], s90 offen sc1
  buffer_store_dword v22, v20, s[4:7], s90 offen sc1
  s_waitcnt vmcnt(28)
  ds_read_b64_tr_b16 a[16:17], v182 offset:0
  ds_read_b64_tr_b16 a[18:19], v182 offset:512
  ds_read_b64_tr_b16 a[24:25], v182 offset:32
  ds_read_b64_tr_b16 a[26:27], v182 offset:544
  s_waitcnt lgkmcnt(0)
  s_add_u32 m0, s96, 0
  s_mov_b32 s90, 0x100000
  buffer_load_dwordx4 v180, s[12:15], s90 offen  lds
  s_add_u32 m0, s96, 1024
  s_mov_b32 s90, 0x110000
  buffer_load_dwordx4 v180, s[12:15], s90 offen  lds
  s_add_u32 m0, s96, 2048
  s_mov_b32 s90, 0x120000
  buffer_load_dwordx4 v180, s[12:15], s90 offen  lds
  s_add_u32 m0, s96, 3072
  s_mov_b32 s90, 0x130000
  buffer_load_dwordx4 v180, s[12:15], s90 offen  lds
  s_waitcnt vmcnt(28)
  ds_read_b64_tr_b16 a[32:33], v182 offset:4096
  ds_read_b64_tr_b16 a[34:35], v182 offset:4608
  ds_read_b64_tr_b16 a[40:41], v182 offset:4128
  ds_read_b64_tr_b16 a[42:43], v182 offset:4640
  s_waitcnt lgkmcnt(0)
  s_add_u32 m0, s96, 4096
  s_mov_b32 s90, 0x100000
  buffer_load_dwordx4 v185, s[16:19], s90 offen  lds
  s_add_u32 m0, s96, 5120
  s_mov_b32 s90, 0x110000
  buffer_load_dwordx4 v185, s[16:19], s90 offen  lds
  s_add_u32 m0, s96, 6144
  s_mov_b32 s90, 0x120000
  buffer_load_dwordx4 v185, s[16:19], s90 offen  lds
  s_add_u32 m0, s96, 7168
  s_mov_b32 s90, 0x130000
  buffer_load_dwordx4 v185, s[16:19], s90 offen  lds
  s_waitcnt vmcnt(28)
  ds_read_b64_tr_b16 a[20:21], v182 offset:8192
  ds_read_b64_tr_b16 a[22:23], v182 offset:8704
  ds_read_b64_tr_b16 a[28:29], v182 offset:8224
  ds_read_b64_tr_b16 a[30:31], v182 offset:8736
  s_waitcnt lgkmcnt(0)
  s_add_u32 m0, s96, 8192
  s_mov_b32 s90, 0x140000
  buffer_load_dwordx4 v180, s[12:15], s90 offen  lds
  s_add_u32 m0, s96, 9216
  s_mov_b32 s90, 0x150000
  buffer_load_dwordx4 v180, s[12:15], s90 offen  lds
  s_add_u32 m0, s96, 10240
  s_mov_b32 s90, 0x160000
  buffer_load_dwordx4 v180, s[12:15], s90 offen  lds
  s_add_u32 m0, s96, 11264
  s_mov_b32 s90, 0x170000
  buffer_load_dwordx4 v180, s[12:15], s90 offen  lds
  s_waitcnt vmcnt(28)
  ds_read_b64_tr_b16 a[36:37], v182 offset:12288
  ds_read_b64_tr_b16 a[38:39], v182 offset:12800
  ds_read_b64_tr_b16 a[44:45], v182 offset:12320
  ds_read_b64_tr_b16 a[46:47], v182 offset:12832
  s_waitcnt lgkmcnt(0)
  s_add_u32 m0, s96, 12288
  s_mov_b32 s90, 0x140000
  buffer_load_dwordx4 v185, s[16:19], s90 offen  lds
  s_add_u32 m0, s96, 13312
  s_mov_b32 s90, 0x150000
  buffer_load_dwordx4 v185, s[16:19], s90 offen  lds
  s_add_u32 m0, s96, 14336
  s_mov_b32 s90, 0x160000
  buffer_load_dwordx4 v185, s[16:19], s90 offen  lds
  s_add_u32 m0, s96, 15360
  s_mov_b32 s90, 0x170000
  buffer_load_dwordx4 v185, s[16:19], s90 offen  lds
  s_waitcnt vmcnt(28)
  ds_read_b64_tr_b16 a[64:65], v182 offset:16384
  ds_read_b64_tr_b16 a[66:67], v182 offset:16896
  ds_read_b64_tr_b16 a[72:73], v182 offset:16416
  ds_read_b64_tr_b16 a[74:75], v182 offset:16928
  s_waitcnt lgkmcnt(0)
  s_add_u32 m0, s96, 16384
  s_mov_b32 s90, 0x180000
  buffer_load_dwordx4 v180, s[12:15], s90 offen  lds
  s_add_u32 m0, s96, 17408
  s_mov_b32 s90, 0x190000
  buffer_load_dwordx4 v180, s[12:15], s90 offen  lds
  s_add_u32 m0, s96, 18432
  s_mov_b32 s90, 0x1a0000
  buffer_load_dwordx4 v180, s[12:15], s90 offen  lds
  s_add_u32 m0, s96, 19456
  s_mov_b32 s90, 0x1b0000
  buffer_load_dwordx4 v180, s[12:15], s90 offen  lds
  s_waitcnt vmcnt(28)
  ds_read_b64_tr_b16 a[80:81], v182 offset:20480
  ds_read_b64_tr_b16 a[82:83], v182 offset:20992
  ds_read_b64_tr_b16 a[88:89], v182 offset:20512
  ds_read_b64_tr_b16 a[90:91], v182 offset:21024
  s_waitcnt lgkmcnt(0)
  s_add_u32 m0, s96, 20480
  s_mov_b32 s90, 0x180000
  buffer_load_dwordx4 v185, s[16:19], s90 offen  lds
  s_add_u32 m0, s96, 21504
  s_mov_b32 s90, 0x190000
  buffer_load_dwordx4 v185, s[16:19], s90 offen  lds
  s_add_u32 m0, s96, 22528
  s_mov_b32 s90, 0x1a0000
  buffer_load_dwordx4 v185, s[16:19], s90 offen  lds
  s_add_u32 m0, s96, 23552
  s_mov_b32 s90, 0x1b0000
  buffer_load_dwordx4 v185, s[16:19], s90 offen  lds
  s_waitcnt vmcnt(28)
  ds_read_b64_tr_b16 a[68:69], v182 offset:24576
  ds_read_b64_tr_b16 a[70:71], v182 offset:25088
  ds_read_b64_tr_b16 a[76:77], v182 offset:24608
  ds_read_b64_tr_b16 a[78:79], v182 offset:25120
  s_waitcnt lgkmcnt(0)
  s_add_u32 m0, s96, 24576
  s_mov_b32 s90, 0x1c0000
  buffer_load_dwordx4 v180, s[12:15], s90 offen  lds
  s_add_u32 m0, s96, 25600
  s_mov_b32 s90, 0x1d0000
  buffer_load_dwordx4 v180, s[12:15], s90 offen  lds
  s_add_u32 m0, s96, 26624
  s_mov_b32 s90, 0x1e0000
  buffer_load_dwordx4 v180, s[12:15], s90 offen  lds
  s_add_u32 m0, s96, 27648
  s_mov_b32 s90, 0x1f0000
  buffer_load_dwordx4 v180, s[12:15], s90 offen  lds
  s_waitcnt vmcnt(28)
  ds_read_b64_tr_b16 a[84:85], v182 offset:28672
  ds_read_b64_tr_b16 a[86:87], v182 offset:29184
  ds_read_b64_tr_b16 a[92:93], v182 offset:28704
  ds_read_b64_tr_b16 a[94:95], v182 offset:29216
  s_waitcnt lgkmcnt(0)
  s_add_u32 m0, s96, 28672
  s_mov_b32 s90, 0x1c0000
  buffer_load_dwordx4 v185, s[16:19], s90 offen  lds
  s_add_u32 m0, s96, 29696
  s_mov_b32 s90, 0x1d0000
  buffer_load_dwordx4 v185, s[16:19], s90 offen  lds
  s_add_u32 m0, s96, 30720
  s_mov_b32 s90, 0x1e0000
  buffer_load_dwordx4 v185, s[16:19], s90 offen  lds
  s_add_u32 m0, s96, 31744
  s_mov_b32 s90, 0x1f0000
  buffer_load_dwordx4 v185, s[16:19], s90 offen  lds
  s_waitcnt vmcnt(28)
  ds_read_b64_tr_b16 a[112:113], v182 offset:0
  ds_read_b64_tr_b16 a[114:115], v182 offset:512
  ds_read_b64_tr_b16 a[120:121], v182 offset:32
  ds_read_b64_tr_b16 a[122:123], v182 offset:544
  s_waitcnt lgkmcnt(0)
  s_add_u32 m0, s96, 0
  s_mov_b32 s90, 0x0
  buffer_load_dwordx4 v180, s[8:11], s90 offen  lds
  s_add_u32 m0, s96, 1024
  s_mov_b32 s90, 0x10000
  buffer_load_dwordx4 v180, s[8:11], s90 offen  lds
  s_add_u32 m0, s96, 2048
  s_mov_b32 s90, 0x20000
  buffer_load_dwordx4 v180, s[8:11], s90 offen  lds
  s_add_u32 m0, s96, 3072
  s_mov_b32 s90, 0x30000
  buffer_load_dwordx4 v180, s[8:11], s90 offen  lds
  s_waitcnt vmcnt(28)
  ds_read_b64_tr_b16 a[128:129], v182 offset:4096
  ds_read_b64_tr_b16 a[130:131], v182 offset:4608
  ds_read_b64_tr_b16 a[136:137], v182 offset:4128
  ds_read_b64_tr_b16 a[138:139], v182 offset:4640
  s_waitcnt lgkmcnt(0)
  s_add_u32 m0, s96, 4096
  s_mov_b32 s90, 0x40000
  buffer_load_dwordx4 v180, s[8:11], s90 offen  lds
  s_add_u32 m0, s96, 5120
  s_mov_b32 s90, 0x50000
  buffer_load_dwordx4 v180, s[8:11], s90 offen  lds
  s_add_u32 m0, s96, 6144
  s_mov_b32 s90, 0x60000
  buffer_load_dwordx4 v180, s[8:11], s90 offen  lds
  s_add_u32 m0, s96, 7168
  s_mov_b32 s90, 0x70000
  buffer_load_dwordx4 v180, s[8:11], s90 offen  lds
  s_waitcnt vmcnt(28)
  ds_read_b64_tr_b16 a[116:117], v182 offset:8192
  ds_read_b64_tr_b16 a[118:119], v182 offset:8704
  ds_read_b64_tr_b16 a[124:125], v182 offset:8224
  ds_read_b64_tr_b16 a[126:127], v182 offset:8736
  s_waitcnt lgkmcnt(0)
  s_add_u32 m0, s96, 8192
  s_mov_b32 s90, 0x80000
  buffer_load_dwordx4 v180, s[8:11], s90 offen  lds
  s_add_u32 m0, s96, 9216
  s_mov_b32 s90, 0x90000
  buffer_load_dwordx4 v180, s[8:11], s90 offen  lds
  s_add_u32 m0, s96, 10240
  s_mov_b32 s90, 0xa0000
  buffer_load_dwordx4 v180, s[8:11], s90 offen  lds
  s_add_u32 m0, s96, 11264
  s_mov_b32 s90, 0xb0000
  buffer_load_dwordx4 v180, s[8:11], s90 offen  lds
  s_waitcnt vmcnt(28)
  ds_read_b64_tr_b16 a[132:133], v182 offset:12288
  ds_read_b64_tr_b16 a[134:135], v182 offset:12800
  ds_read_b64_tr_b16 a[140:141], v182 offset:12320
  ds_read_b64_tr_b16 a[142:143], v182 offset:12832
  s_waitcnt lgkmcnt(0)
  s_add_u32 m0, s96, 12288
  s_mov_b32 s90, 0xc0000
  buffer_load_dwordx4 v180, s[8:11], s90 offen  lds
  s_add_u32 m0, s96, 13312
  s_mov_b32 s90, 0xd0000
  buffer_load_dwordx4 v180, s[8:11], s90 offen  lds
  s_add_u32 m0, s96, 14336
  s_mov_b32 s90, 0xe0000
  buffer_load_dwordx4 v180, s[8:11], s90 offen  lds
  s_add_u32 m0, s96, 15360
  s_mov_b32 s90, 0xf0000
  buffer_load_dwordx4 v180, s[8:11], s90 offen  lds
  s_waitcnt vmcnt(28)
  ds_read_b64_tr_b16 a[160:161], v182 offset:16384
  ds_read_b64_tr_b16 a[162:163], v182 offset:16896
  ds_read_b64_tr_b16 a[168:169], v182 offset:16416
  ds_read_b64_tr_b16 a[170:171], v182 offset:16928
  s_waitcnt lgkmcnt(0)
  s_add_u32 m0, s96, 16384
  s_mov_b32 s90, 0x100000
  buffer_load_dwordx4 v180, s[8:11], s90 offen  lds
  s_add_u32 m0, s96, 17408
  s_mov_b32 s90, 0x110000
  buffer_load_dwordx4 v180, s[8:11], s90 offen  lds
  s_add_u32 m0, s96, 18432
  s_mov_b32 s90, 0x120000
  buffer_load_dwordx4 v180, s[8:11], s90 offen  lds
  s_add_u32 m0, s96, 19456
  s_mov_b32 s90, 0x130000
  buffer_load_dwordx4 v180, s[8:11], s90 offen  lds
  s_waitcnt vmcnt(28)
  ds_read_b64_tr_b16 a[176:177], v182 offset:20480
  ds_read_b64_tr_b16 a[178:179], v182 offset:20992
  ds_read_b64_tr_b16 a[184:185], v182 offset:20512
  ds_read_b64_tr_b16 a[186:187], v182 offset:21024
  s_waitcnt lgkmcnt(0)
  s_add_u32 m0, s96, 20480
  s_mov_b32 s90, 0x140000
  buffer_load_dwordx4 v180, s[8:11], s90 offen  lds
  s_add_u32 m0, s96, 21504
  s_mov_b32 s90, 0x150000
  buffer_load_dwordx4 v180, s[8:11], s90 offen  lds
  s_add_u32 m0, s96, 22528
  s_mov_b32 s90, 0x160000
  buffer_load_dwordx4 v180, s[8:11], s90 offen  lds
  s_add_u32 m0, s96, 23552
  s_mov_b32 s90, 0x170000
  buffer_load_dwordx4 v180, s[8:11], s90 offen  lds
  s_waitcnt vmcnt(28)
  ds_read_b64_tr_b16 a[164:165], v182 offset:24576
  ds_read_b64_tr_b16 a[166:167], v182 offset:25088
  ds_read_b64_tr_b16 a[172:173], v182 offset:24608
  ds_read_b64_tr_b16 a[174:175], v182 offset:25120
  s_waitcnt lgkmcnt(0)
  s_add_u32 m0, s96, 24576
  s_mov_b32 s90, 0x180000
  buffer_load_dwordx4 v180, s[8:11], s90 offen  lds
  s_add_u32 m0, s96, 25600
  s_mov_b32 s90, 0x190000
  buffer_load_dwordx4 v180, s[8:11], s90 offen  lds
  s_add_u32 m0, s96, 26624
  s_mov_b32 s90, 0x1a0000
  buffer_load_dwordx4 v180, s[8:11], s90 offen  lds
  s_add_u32 m0, s96, 27648
  s_mov_b32 s90, 0x1b0000
  buffer_load_dwordx4 v180, s[8:11], s90 offen  lds
  s_waitcnt vmcnt(28)
  ds_read_b64_tr_b16 a[180:181], v182 offset:28672
  ds_read_b64_tr_b16 a[182:183], v182 offset:29184
  ds_read_b64_tr_b16 a[188:189], v182 offset:28704
  ds_read_b64_tr_b16 a[190:191], v182 offset:29216
  s_waitcnt lgkmcnt(0)
  s_add_u32 m0, s96, 28672
  s_mov_b32 s90, 0x1c0000
  buffer_load_dwordx4 v180, s[8:11], s90 offen  lds
  s_add_u32 m0, s96, 29696
  s_mov_b32 s90, 0x1d0000
  buffer_load_dwordx4 v180, s[8:11], s90 offen  lds
  s_add_u32 m0, s96, 30720
  s_mov_b32 s90, 0x1e0000
  buffer_load_dwordx4 v180, s[8:11], s90 offen  lds
  s_add_u32 m0, s96, 31744
  s_mov_b32 s90, 0x1f0000
  buffer_load_dwordx4 v180, s[8:11], s90 offen  lds
  s_waitcnt vmcnt(28)
  ds_read_b64_tr_b16 a[0:1], v182 offset:0
  ds_read_b64_tr_b16 a[2:3], v182 offset:512
  ds_read_b64_tr_b16 a[8:9], v182 offset:32
  ds_read_b64_tr_b16 a[10:11], v182 offset:544
  s_waitcnt lgkmcnt(0)
  s_add_u32 m0, s96, 0
  s_mov_b32 s90, 0x0
  buffer_load_dwordx4 v181, s[20:23], s90 offen  lds
  s_add_u32 m0, s96, 1024
  s_mov_b32 s90, 0x4000
  buffer_load_dwordx4 v181, s[20:23], s90 offen  lds
  s_add_u32 m0, s96, 2048
  s_mov_b32 s90, 0x8000
  buffer_load_dwordx4 v181, s[20:23], s90 offen  lds
  s_add_u32 m0, s96, 3072
  s_mov_b32 s90, 0xc000
  buffer_load_dwordx4 v181, s[20:23], s90 offen  lds
  s_waitcnt vmcnt(28)
  ds_read_b64_tr_b16 a[4:5], v182 offset:4096
  ds_read_b64_tr_b16 a[6:7], v182 offset:4608
  ds_read_b64_tr_b16 a[12:13], v182 offset:4128
  ds_read_b64_tr_b16 a[14:15], v182 offset:4640
  s_waitcnt lgkmcnt(0)
  s_add_u32 m0, s96, 4096
  s_mov_b32 s90, 0x10000
  buffer_load_dwordx4 v181, s[20:23], s90 offen  lds
  s_add_u32 m0, s96, 5120
  s_mov_b32 s90, 0x14000
  buffer_load_dwordx4 v181, s[20:23], s90 offen  lds
  s_add_u32 m0, s96, 6144
  s_mov_b32 s90, 0x18000
  buffer_load_dwordx4 v181, s[20:23], s90 offen  lds
  s_add_u32 m0, s96, 7168
  s_mov_b32 s90, 0x1c000
  buffer_load_dwordx4 v181, s[20:23], s90 offen  lds
  s_waitcnt vmcnt(28)
  ds_read_b64_tr_b16 a[48:49], v182 offset:8192
  ds_read_b64_tr_b16 a[50:51], v182 offset:8704
  ds_read_b64_tr_b16 a[56:57], v182 offset:8224
  ds_read_b64_tr_b16 a[58:59], v182 offset:8736
  s_waitcnt lgkmcnt(0)
  s_add_u32 m0, s96, 8192
  s_mov_b32 s90, 0x20000
  buffer_load_dwordx4 v181, s[20:23], s90 offen  lds
  s_add_u32 m0, s96, 9216
  s_mov_b32 s90, 0x24000
  buffer_load_dwordx4 v181, s[20:23], s90 offen  lds
  s_add_u32 m0, s96, 10240
  s_mov_b32 s90, 0x28000
  buffer_load_dwordx4 v181, s[20:23], s90 offen  lds
  s_add_u32 m0, s96, 11264
  s_mov_b32 s90, 0x2c000
  buffer_load_dwordx4 v181, s[20:23], s90 offen  lds
  s_waitcnt vmcnt(28)
  ds_read_b64_tr_b16 a[52:53], v182 offset:12288
  ds_read_b64_tr_b16 a[54:55], v182 offset:12800
  ds_read_b64_tr_b16 a[60:61], v182 offset:12320
  ds_read_b64_tr_b16 a[62:63], v182 offset:12832
  s_waitcnt lgkmcnt(0)
  s_add_u32 m0, s96, 12288
  s_mov_b32 s90, 0x30000
  buffer_load_dwordx4 v181, s[20:23], s90 offen  lds
  s_add_u32 m0, s96, 13312
  s_mov_b32 s90, 0x34000
  buffer_load_dwordx4 v181, s[20:23], s90 offen  lds
  s_add_u32 m0, s96, 14336
  s_mov_b32 s90, 0x38000
  buffer_load_dwordx4 v181, s[20:23], s90 offen  lds
  s_add_u32 m0, s96, 15360
  s_mov_b32 s90, 0x3c000
  buffer_load_dwordx4 v181, s[20:23], s90 offen  lds
  s_mov_b32 s90, 0x3800000
  buffer_load_dword v204, v2, s[4:7], s90 offen sc1
  buffer_load_dword v204, v7, s[4:7], s90 offen sc1
  buffer_load_dword v204, v8, s[4:7], s90 offen sc1
  s_mov_b32 s90, 0x3880000
  buffer_load_dword v204, v2, s[4:7], s90 offen sc1
  buffer_load_dword v204, v7, s[4:7], s90 offen sc1
  buffer_load_dword v204, v8, s[4:7], s90 offen sc1
  s_mov_b32 s90, 0x3900000
  buffer_load_dword v204, v2, s[4:7], s90 offen sc1
  buffer_load_dword v204, v7, s[4:7], s90 offen sc1
  buffer_load_dword v204, v8, s[4:7], s90 offen sc1
  s_mov_b32 s90, 0x3980000
  buffer_load_dword v204, v2, s[4:7], s90 offen sc1
  buffer_load_dword v204, v7, s[4:7], s90 offen sc1
  buffer_load_dword v204, v8, s[4:7], s90 offen sc1
  s_waitcnt vmcnt(28)
  ds_read_b64_tr_b16 a[96:97], v182 offset:16384
  ds_read_b64_tr_b16 a[98:99], v182 offset:16896
  ds_read_b64_tr_b16 a[104:105], v182 offset:16416
  ds_read_b64_tr_b16 a[106:107], v182 offset:16928
  s_waitcnt vmcnt(24)
  ds_read_b64_tr_b16 a[100:101], v182 offset:20480
  ds_read_b64_tr_b16 a[102:103], v182 offset:20992
  ds_read_b64_tr_b16 a[108:109], v182 offset:20512
  ds_read_b64_tr_b16 a[110:111], v182 offset:21024
  s_waitcnt vmcnt(20)
  ds_read_b64_tr_b16 a[144:145], v182 offset:24576
  ds_read_b64_tr_b16 a[146:147], v182 offset:25088
  ds_read_b64_tr_b16 a[152:153], v182 offset:24608
  ds_read_b64_tr_b16 a[154:155], v182 offset:25120
  s_waitcnt vmcnt(16)
  ds_read_b64_tr_b16 a[148:149], v182 offset:28672
  ds_read_b64_tr_b16 a[150:151], v182 offset:29184
  ds_read_b64_tr_b16 a[156:157], v182 offset:28704
  ds_read_b64_tr_b16 a[158:159], v182 offset:29216
  v_mbcnt_lo_u32_b32 v250, -1, 0
  v_mbcnt_hi_u32_b32 v250, -1, v250
  s_lshl_b32 s90, s32, 9
  s_add_u32 s90, s90, 147520
  v_lshl_add_u32 v251, v250, 3, s90
  ds_write_b64 v251, v[248:249]
  s_waitcnt lgkmcnt(0)
  s_cmp_lg_u32 s32, 0
  s_cbranch_scc1 FL_vd_6
  v_lshlrev_b32 v250, 2, v250
  s_cmp_lg_u32 s100, 0
  s_cbranch_scc1 FL_vw_5
  v_readfirstlane_b32 s90, v247
  s_and_b32 s90, s90, s101
  s_cbranch_scc0 FL_vw_5
  v_mov_b32 v251, 1
  s_mov_b64 exec, 1
  buffer_store_dword v251, v250, s[28:31], 0 offen offset:32 sc1
  s_mov_b64 exec, -1
FL_vw_5:
  buffer_load_dword v251, v250, s[28:31], 0 offen sc1
  s_waitcnt vmcnt(0)
  v_cmp_eq_u32 vcc, -1, v251
  v_readlane_b32 s91, v251, 8
  v_readlane_b32 s92, v251, 32
  v_readlane_b32 s93, v251, 33
  v_readlane_b32 s90, v251, 34
  s_cmp_lg_u32 s100, 0
  s_cselect_b32 s93, s90, s93
  s_cselect_b32 s91, 0, s91
  s_cselect_b32 s92, 1, s92
  s_cselect_b32 s90, 0xff, vcc_lo
  s_cmp_lg_u32 s91, 0
  s_cselect_b32 s92, 3, s92
  s_cbranch_scc1 FL_vk_7
  s_add_u32 s3, s3, 1
  s_cmp_ge_u32 s3, 131072
  s_cselect_b32 s92, 4, s92
  s_cbranch_scc1 FL_vk_7
  s_sleep 8
  s_and_b32 s90, s90, 0xff
  s_cmp_lg_u32 s90, 0xff
  s_cbranch_scc1 FL_vw_5
  s_cmp_lt_u32 s93, 128
  s_cbranch_scc1 FL_vw_5
  s_cmp_eq_u32 s92, 0
  s_cbranch_scc1 FL_vw_5
FL_vk_7:
  v_mov_b32 v251, s92
  v_mov_b32 v250, 147456
  ds_write_b32 v250, v251
  s_waitcnt lgkmcnt(0)
FL_vd_6:
  s_barrier
  v_mov_b32 v250, 147456
  ds_read_b32 v251, v250
  s_waitcnt lgkmcnt(0)
  v_readfirstlane_b32 s92, v251
  s_barrier
  s_cmp_eq_u32 s92, 3
  s_cbranch_scc1 L_fallback
  s_cmp_eq_u32 s92, 4
  s_cbranch_scc1 L_exit
  s_sub_u32 s39, s92, 1
  s_and_b32 s39, s39, 1
  s_lshl_b32 s39, s39, 13
  s_waitcnt vmcnt(0)
  s_barrier
  ds_read_b64_tr_b16 a[192:193], v183 offset:0
  ds_read_b64_tr_b16 a[194:195], v183 offset:2048
  ds_read_b64_tr_b16 a[196:197], v183 offset:512
  ds_read_b64_tr_b16 a[198:199], v183 offset:2560
  ds_read_b64_tr_b16 a[200:201], v183 offset:4096
  ds_read_b64_tr_b16 a[202:203], v183 offset:6144
  ds_read_b64_tr_b16 a[204:205], v183 offset:4608
  ds_read_b64_tr_b16 a[206:207], v183 offset:6656
  s_waitcnt lgkmcnt(0)
  ds_read_b64_tr_b16 a[208:209], v183 offset:32768
  ds_read_b64_tr_b16 a[210:211], v183 offset:34816
  ds_read_b64_tr_b16 a[212:213], v183 offset:33280
  ds_read_b64_tr_b16 a[214:215], v183 offset:35328
  ds_read_b64_tr_b16 a[216:217], v183 offset:36864
  ds_read_b64_tr_b16 a[218:219], v183 offset:38912
  ds_read_b64_tr_b16 a[220:221], v183 offset:37376
  ds_read_b64_tr_b16 a[222:223], v183 offset:39424
  s_waitcnt lgkmcnt(0)
  ds_read_b64_tr_b16 a[224:225], v184 offset:0
  ds_read_b64_tr_b16 a[226:227], v184 offset:2048
  ds_read_b64_tr_b16 a[228:229], v184 offset:512
  ds_read_b64_tr_b16 a[230:231], v184 offset:2560
  ds_read_b64_tr_b16 a[232:233], v184 offset:4096
  ds_read_b64_tr_b16 a[234:235], v184 offset:6144
  ds_read_b64_tr_b16 a[236:237], v184 offset:4608
  ds_read_b64_tr_b16 a[238:239], v184 offset:6656
  s_waitcnt lgkmcnt(0)
  ds_read_b64_tr_b16 a[240:241], v184 offset:32768
  ds_read_b64_tr_b16 a[242:243], v184 offset:34816
  ds_read_b64_tr_b16 a[244:245], v184 offset:33280
  ds_read_b64_tr_b16 a[246:247], v184 offset:35328
  ds_read_b64_tr_b16 a[248:249], v184 offset:36864
  ds_read_b64_tr_b16 a[250:251], v184 offset:38912
  ds_read_b64_tr_b16 a[252:253], v184 offset:37376
  ds_read_b64_tr_b16 a[254:255], v184 offset:39424
  s_waitcnt lgkmcnt(0)
  s_barrier
  s_mov_b32 s46, 0
  v_xor_b32 v1, s39, v1
  v_xor_b32 v17, s39, v17
  v_xor_b32 v18, s39, v18
  s_mov_b32 s12, s63
  s_mov_b32 s90, 0x3800000
  s_mov_b32 s90, 0x3880000
  s_mov_b32 s90, 0x3900000
  s_mov_b32 s90, 0x3980000
  v_mov_b32 v248, 0x3f803f80
  v_mov_b32 v249, 0x3f803f80
  v_mov_b32 v250, 0x3f803f80
  v_mov_b32 v251, 0x3f803f80
  v_mov_b32 v252, 0x3f803f80
  v_mov_b32 v253, 0x3f803f80
  v_mov_b32 v254, 0x3f803f80
  v_mov_b32 v255, 0x3f803f80
  s_cmp_lg_u32 s32, 0
  s_cbranch_scc1 FL_kv0d
  s_lshl_b32 s90, s33, 7
  s_add_u32 s90, s90, 0x3d07000
  v_mov_b32 v30, s90
FL_kv0:
  buffer_load_dword v31, v30, s[4:7], 0 offen sc1
  s_waitcnt vmcnt(0)
  v_readfirstlane_b32 s90, v31
  s_add_u32 s46, s46, 1
  s_cmp_ge_u32 s46, 131072
  s_cbranch_scc1 FL_rec_abort
  s_sleep 2
  s_cmp_lt_u32 s90, 16
  s_cbranch_scc1 FL_kv0
FL_kv0d:
  s_barrier
  buffer_load_dwordx4 v[180:183], v12, s[4:7], s44 offen offset:0
  buffer_load_dwordx4 v[184:187], v12, s[4:7], s44 offen offset:128
  buffer_load_dwordx4 v[188:191], v12, s[4:7], s44 offen offset:1024
  buffer_load_dwordx4 v[192:195], v12, s[4:7], s44 offen offset:1152
  buffer_load_dwordx4 v[196:199], v13, s[4:7], s44 offen offset:0
  buffer_load_dwordx4 v[200:203], v13, s[4:7], s44 offen offset:128
  buffer_load_dwordx4 v[204:207], v13, s[4:7], s44 offen offset:1024
  buffer_load_dwordx4 v[208:211], v13, s[4:7], s44 offen offset:1152
  buffer_load_dwordx4 v[116:119], v11, s[4:7], s44 offen offset:0
  buffer_load_dwordx4 v[132:135], v11, s[4:7], s44 offen offset:64
  buffer_load_dwordx4 v[120:123], v11, s[4:7], s44 offen offset:1024
  buffer_load_dwordx4 v[136:139], v11, s[4:7], s44 offen offset:1088
  buffer_load_dwordx4 v[124:127], v11, s[4:7], s44 offen offset:2048
  buffer_load_dwordx4 v[140:143], v11, s[4:7], s44 offen offset:2112
  buffer_load_dwordx4 v[128:131], v11, s[4:7], s44 offen offset:3072
  buffer_load_dwordx4 v[144:147], v11, s[4:7], s44 offen offset:3136
  s_add_u32 s44, s44, 0x40000
  v_mov_b64 v[64:65], 0
  v_mov_b64 v[66:67], 0
  v_mov_b64 v[68:69], 0
  v_mov_b64 v[70:71], 0
  v_mov_b64 v[72:73], 0
  v_mov_b64 v[74:75], 0
  v_mov_b64 v[76:77], 0
  v_mov_b64 v[78:79], 0
  v_mov_b64 v[80:81], 0
  v_mov_b64 v[82:83], 0
  v_mov_b64 v[84:85], 0
  v_mov_b64 v[86:87], 0
  v_mov_b64 v[32:33], 0
  v_mov_b64 v[34:35], 0
  v_mov_b64 v[212:213], 0
  v_mov_b64 v[214:215], 0
  v_mov_b64 v[216:217], 0
  v_mov_b64 v[218:219], 0
  v_mov_b64 v[220:221], 0
  v_mov_b64 v[222:223], 0
  v_mov_b64 v[224:225], 0
  v_mov_b64 v[226:227], 0
  v_mov_b64 v[228:229], 0
  v_mov_b64 v[230:231], 0
  s_waitcnt vmcnt(0)
  v_min_u32 v44, s54, v44
  s_lshl_b32 s90, s33, 7
  s_add_u32 s90, s90, 0x3d07000
  v_mov_b32 v244, s90
  s_lshl_b32 s90, s34, 2
  s_add_u32 s90, s90, s32
  s_lshl_b32 s91, s33, 7
  s_add_u32 s91, s91, 0x3d00000
  v_mbcnt_lo_u32_b32 v30, -1, 0
  v_mbcnt_hi_u32_b32 v30, -1, v30
  v_add_u32 v30, s90, v30
  v_cmp_eq_u32 vcc, 0, v30
  v_mov_b32 v30, 0x80000000
  v_mov_b32 v31, s91
  v_cndmask_b32 v245, v30, v31, vcc
  s_mov_b64 s[8:9], s[94:95]
  s_mov_b64 s[10:11], s[94:95]
  s_branch FL_pubmem
FL_step:
  s_load_dword s16, s[8:9], 256
  s_load_dword s17, s[10:11], 256
  s_load_dword s18, s[8:9], 320
  s_load_dword s19, s[10:11], 320
  s_load_dword s20, s[8:9], 384
  s_load_dword s21, s[10:11], 384
  s_load_dword s22, s[8:9], 448
  s_load_dword s23, s[10:11], 448
  buffer_load_dwordx4 v[200:203], v13, s[4:7], s44 offen offset:128
  buffer_load_dwordx4 v[204:207], v13, s[4:7], s44 offen offset:1024
  buffer_load_dwordx4 v[208:211], v13, s[4:7], s44 offen offset:1152
  buffer_load_dwordx4 v[128:131], v11, s[4:7], s44 offen offset:3072
  buffer_load_dwordx4 v[144:147], v11, s[4:7], s44 offen offset:3136
  v_mov_b64 v[64:65], 0
  v_mov_b64 v[66:67], 0
  v_mov_b64 v[68:69], 0
  v_mov_b64 v[70:71], 0
  v_mov_b64 v[72:73], 0
  v_mov_b64 v[74:75], 0
  v_mov_b64 v[76:77], 0
  v_mov_b64 v[78:79], 0
  v_mov_b64 v[80:81], 0
  v_mov_b64 v[82:83], 0
  v_mov_b64 v[84:85], 0
  v_mov_b64 v[86:87], 0
  v_mov_b64 v[32:33], 0
  v_mov_b64 v[34:35], 0
  buffer_load_dwordx4 v[36:39], v1, s[4:7], s42 offen sc1
  buffer_store_dword v22, v18, s[4:7], s13 offen
  buffer_store_dword v22, v2, s[4:7], s13 offen
  buffer_store_dword v22, v7, s[4:7], s13 offen
  buffer_store_dword v22, v8, s[4:7], s13 offen
  s_add_u32 s44, s44, 0x40000
  s_min_u32 s44, s44, 0xfc0000
  s_add_u32 s45, s45, 0x10000
  s_waitcnt vmcnt(12)
FL_kv_chk:
  v_readfirstlane_b32 s90, v243
  s_cmp_lt_u32 s90, 16
  s_cbranch_scc1 FL_kv_f
  s_waitcnt vmcnt(4)
FL_g_chk:
  v_max3_u32 v31, v36, v37, v38
  v_max_u32 v31, v31, v39
  v_cmp_eq_u32 vcc, -1, v31
  v_mfma_f32_16x16x32_bf16 v[40:43], v[24:27], v[36:39], 0
  s_cbranch_vccnz FL_g_f
  s_nop 6
  v_add_f32_dpp v45, v40, v40 row_ror:8 row_mask:0xf bank_mask:0xf
  v_add_f32_dpp v46, v41, v41 row_ror:8 row_mask:0xf bank_mask:0xf
  v_cvt_pk_bf16_f32 v44, v45, v46
  v_min_u32 v44, s54, v44
FL_pubmem:
  buffer_store_dword v44, v2, s[4:7], s41 offen
  v_mov_b32 v148, v180
  v_mov_b32 v150, v181
  v_mov_b32 v152, v182
  v_mov_b32 v154, v183
  v_mov_b32 v149, v184
  v_mov_b32 v151, v185
  v_mov_b32 v153, v186
  v_mov_b32 v155, v187
  v_mov_b32 v156, v188
  v_mov_b32 v158, v189
  v_mov_b32 v160, v190
  v_mov_b32 v162, v191
  v_mov_b32 v157, v192
  v_mov_b32 v159, v193
  v_mov_b32 v161, v194
  v_mov_b32 v163, v195
  v_mov_b32 v164, v196
  v_mov_b32 v166, v197
  v_mov_b32 v168, v198
  v_mov_b32 v170, v199
  v_mov_b32 v165, v200
  v_mov_b32 v167, v201
  v_mov_b32 v169, v202
  v_mov_b32 v171, v203
  buffer_load_dwordx4 v[48:51], v3, s[4:7], s41 offen offset:0 sc1
  v_mov_b32 v172, v204
  v_mov_b32 v174, v205
  buffer_load_dwordx4 v[52:55], v3, s[4:7], s41 offen offset:1024 sc1
  v_mov_b32 v176, v206
  v_mov_b32 v178, v207
  buffer_load_dwordx4 v[56:59], v3, s[4:7], s41 offen offset:2048 sc1
  v_mov_b32 v173, v208
  v_mov_b32 v175, v209
  buffer_load_dwordx4 v[60:63], v3, s[4:7], s41 offen offset:3072 sc1
  v_mov_b32 v177, v210
  v_mov_b32 v179, v211
  s_waitcnt vmcnt(3)
  v_max3_u32 v31, v48, v49, v50
  v_max_u32 v31, v31, v51
  v_cmp_eq_u32 vcc, -1, v31
  s_cbranch_vccnz FL_m_f0
  v_smfmac_f32_16x16x64_bf16 v[64:67], v[48:51], a[0:7], v23
  s_waitcnt vmcnt(2)
  v_max3_u32 v31, v52, v53, v54
  v_max_u32 v31, v31, v55
  v_cmp_eq_u32 vcc, -1, v31
  v_smfmac_f32_16x16x64_bf16 v[68:71], v[48:51], a[8:15], v23
  v_smfmac_f32_16x16x64_bf16 v[72:75], v[48:51], a[16:23], v23
  v_smfmac_f32_16x16x64_bf16 v[76:79], v[48:51], a[24:31], v23
  s_cbranch_vccnz FL_m_f1
  v_smfmac_f32_16x16x64_bf16 v[64:67], v[52:55], a[48:55], v23
  s_waitcnt vmcnt(1)
  v_max3_u32 v31, v56, v57, v58
  v_max_u32 v31, v31, v59
  v_cmp_eq_u32 vcc, -1, v31
  v_smfmac_f32_16x16x64_bf16 v[68:71], v[52:55], a[56:63], v23
  v_smfmac_f32_16x16x64_bf16 v[72:75], v[52:55], a[64:71], v23
  v_smfmac_f32_16x16x64_bf16 v[76:79], v[52:55], a[72:79], v23
  s_cbranch_vccnz FL_m_f2
  v_smfmac_f32_16x16x64_bf16 v[64:67], v[56:59], a[96:103], v23
  s_waitcnt vmcnt(0)
  v_max3_u32 v31, v60, v61, v62
  v_max_u32 v31, v31, v63
  v_cmp_eq_u32 vcc, -1, v31
  v_smfmac_f32_16x16x64_bf16 v[68:71], v[56:59], a[104:111], v23
  v_smfmac_f32_16x16x64_bf16 v[72:75], v[56:59], a[112:119], v23
  v_smfmac_f32_16x16x64_bf16 v[76:79], v[56:59], a[120:127], v23
  s_cbranch_vccnz FL_m_f3
  v_smfmac_f32_16x16x64_bf16 v[64:67], v[60:63], a[144:151], v23
  v_smfmac_f32_16x16x64_bf16 v[68:71], v[60:63], a[152:159], v23
  v_smfmac_f32_16x16x64_bf16 v[72:75], v[60:63], a[160:167], v23
  v_smfmac_f32_16x16x64_bf16 v[76:79], v[60:63], a[168:175], v23
FL_m_done:
  s_nop 4
  v_pk_add_f32 v[88:89], v[64:65], v[66:67]
  v_pk_add_f32 v[90:91], v[68:69], v[70:71]
  ds_write_b128 v4, v[88:91] offset:0
  v_pk_add_f32 v[92:93], v[72:73], v[74:75]
  v_pk_add_f32 v[94:95], v[76:77], v[78:79]
  ds_write_b128 v4, v[92:95] offset:1088
  v_smfmac_f32_16x16x64_bf16 v[80:83], v[48:51], a[32:39], v23
  buffer_load_dwordx4 v[180:183], v12, s[4:7], s44 offen offset:0
  v_mov_b32 v36, 0
  v_smfmac_f32_16x16x64_bf16 v[84:87], v[48:51], a[40:47], v23
  buffer_load_dwordx4 v[184:187], v12, s[4:7], s44 offen offset:128
  v_mov_b32 v37, 0
  v_smfmac_f32_16x16x64_bf16 v[80:83], v[52:55], a[80:87], v23
  buffer_load_dwordx4 v[188:191], v12, s[4:7], s44 offen offset:1024
  v_mov_b32 v38, 0
  v_smfmac_f32_16x16x64_bf16 v[84:87], v[52:55], a[88:95], v23
  buffer_load_dwordx4 v[192:195], v12, s[4:7], s44 offen offset:1152
  v_mov_b32 v39, 0
  v_smfmac_f32_16x16x64_bf16 v[80:83], v[56:59], a[128:135], v23
  buffer_load_dwordx4 v[196:199], v13, s[4:7], s44 offen offset:0
  v_mov_b32 v40, 0
  s_waitcnt lgkmcnt(0)
  s_barrier
  ds_read2_b32 v[100:101], v6 offset0:0 offset1:2
  ds_read2_b32 v[102:103], v240 offset0:0 offset1:2
  ds_read2_b32 v[104:105], v241 offset0:0 offset1:2
  ds_read2_b32 v[106:107], v242 offset0:0 offset1:2
  v_smfmac_f32_16x16x64_bf16 v[84:87], v[56:59], a[136:143], v23
  v_mov_b32 v41, 0
  v_smfmac_f32_16x16x64_bf16 v[80:83], v[60:63], a[176:183], v23
  v_mov_b32 v42, 0
  v_smfmac_f32_16x16x64_bf16 v[84:87], v[60:63], a[184:191], v23
  v_mov_b32 v43, 0
  v_mov_b32 v44, 0
  v_mov_b32 v45, 0
  v_mov_b32 v46, 0
  v_mov_b32 v47, 0
  s_waitcnt lgkmcnt(2)
  v_pk_add_f32 v[100:101], v[100:101], v[102:103]
  s_waitcnt lgkmcnt(0)
  v_pk_add_f32 v[104:105], v[104:105], v[106:107]
  v_pk_add_f32 v[100:101], v[100:101], v[104:105]
  v_cvt_pk_bf16_f32 v112, v100, v101
  v_min_u32 v112, s54, v112
  buffer_store_dword v112, v7, s[4:7], s41 offen
  v_pk_add_f32 v[96:97], v[80:81], v[82:83]
  v_pk_add_f32 v[98:99], v[84:85], v[86:87]
  ds_write_b128 v4, v[96:99] offset:2176
  v_mov_b64 v[212:213], 0
  v_mov_b64 v[214:215], 0
  v_mov_b64 v[216:217], 0
  v_mov_b64 v[218:219], 0
  v_mov_b64 v[220:221], 0
  v_mov_b64 v[222:223], 0
  v_mov_b64 v[224:225], 0
  v_mov_b64 v[226:227], 0
  v_mov_b64 v[228:229], 0
  v_mov_b64 v[230:231], 0
  s_waitcnt lgkmcnt(0)
  s_barrier
  ds_read_b64 v[88:89], v5 offset:0
  buffer_load_dwordx4 v[64:67], v9, s[4:7], s41 offen offset:0 sc1
  s_mov_b32 s42, s41
  s_add_u32 s90, s40, 1
  ds_read_b64 v[90:91], v5 offset:3264
  buffer_load_dwordx4 v[68:71], v9, s[4:7], s41 offen offset:1024 sc1
  s_and_b32 s90, s90, 3
  s_lshl_b32 s90, s90, 19
  ds_read_b64 v[92:93], v5 offset:6528
  buffer_load_dwordx4 v[72:75], v9, s[4:7], s41 offen offset:2048 sc1
  s_add_u32 s91, s90, 0x3800000
  s_add_u32 s55, s55, 0x40000
  ds_read_b64 v[94:95], v5 offset:9792
  buffer_load_dwordx4 v[76:79], v9, s[4:7], s41 offen offset:3072 sc1
  s_min_u32 s55, s55, 0xfc0000
  s_nop 0
  s_waitcnt lgkmcnt(2)
  v_pk_add_f32 v[88:89], v[88:89], v[90:91]
  s_waitcnt lgkmcnt(0)
  v_pk_add_f32 v[92:93], v[92:93], v[94:95]
  v_pk_add_f32 v[88:89], v[88:89], v[92:93]
  v_cvt_pk_bf16_f32 v113, v88, v89
  v_min_u32 v113, s54, v113
  buffer_store_dword v113, v8, s[4:7], s41 offen
  s_add_u32 s8, s94, s55
  s_addc_u32 s9, s95, 0
  s_add_u32 s8, s8, s12
  s_addc_u32 s9, s9, 0
  s_add_u32 s10, s8, 0x1000000
  s_addc_u32 s11, s9, 0
  s_load_dword s16, s[8:9], 0
  s_load_dword s17, s[10:11], 0
  s_load_dword s18, s[8:9], 64
  s_load_dword s19, s[10:11], 64
  s_load_dword s20, s[8:9], 128
  s_load_dword s21, s[10:11], 128
  s_load_dword s22, s[8:9], 192
  s_load_dword s23, s[10:11], 192
  s_cmp_eq_u32 s40, 63
  s_cbranch_scc1 FL_last
  s_waitcnt vmcnt(4)
  v_max3_u32 v31, v64, v65, v66
  v_max_u32 v31, v31, v67
  v_cmp_eq_u32 vcc, -1, v31
  s_cbranch_vccnz FL_x_f0
  v_mfma_f32_16x16x32_bf16 v[44:47], v[64:67], v[64:67], v[44:47]
  s_waitcnt vmcnt(3)
  v_max3_u32 v31, v68, v69, v70
  v_max_u32 v31, v31, v71
  v_cmp_eq_u32 vcc, -1, v31
  v_mfma_f32_16x16x32_bf16 v[36:39], v[116:119], v[64:67], v[36:39]
  v_mfma_f32_16x16x32_bf16 v[40:43], v[132:135], v[64:67], v[40:43]
  s_cbranch_vccnz FL_x_f1
  v_mfma_f32_16x16x32_bf16 v[44:47], v[68:71], v[68:71], v[44:47]
  s_waitcnt vmcnt(2)
  v_max3_u32 v31, v72, v73, v74
  v_max_u32 v31, v31, v75
  v_cmp_eq_u32 vcc, -1, v31
  v_mfma_f32_16x16x32_bf16 v[36:39], v[120:123], v[68:71], v[36:39]
  v_mfma_f32_16x16x32_bf16 v[40:43], v[136:139], v[68:71], v[40:43]
  s_cbranch_vccnz FL_x_f2
  v_mfma_f32_16x16x32_bf16 v[44:47], v[72:75], v[72:75], v[44:47]
  s_waitcnt vmcnt(1)
  v_max3_u32 v31, v76, v77, v78
  v_max_u32 v31, v31, v79
  v_cmp_eq_u32 vcc, -1, v31
  v_mfma_f32_16x16x32_bf16 v[36:39], v[124:127], v[72:75], v[36:39]
  v_mfma_f32_16x16x32_bf16 v[40:43], v[140:143], v[72:75], v[40:43]
  s_cbranch_vccnz FL_x_f3
  v_mfma_f32_16x16x32_bf16 v[44:47], v[76:79], v[76:79], v[44:47]
  v_mfma_f32_16x16x32_bf16 v[36:39], v[128:131], v[76:79], v[36:39]
  v_mfma_f32_16x16x32_bf16 v[40:43], v[144:147], v[76:79], v[40:43]
FL_x_done:
  buffer_load_dwordx4 v[88:91], v10, s[4:7], s41 offen offset:0 sc1
  buffer_load_dwordx4 v[92:95], v10, s[4:7], s41 offen offset:1024 sc1
  s_mov_b64 vcc, s[48:49]
  s_nop 2
  v_max_f32 v30, v46, v47
  s_nop 0
  v_cndmask_b32_dpp v96, v40, v36, vcc quad_perm:[0,1,0,1] row_mask:0xf bank_mask:0xf
  v_cndmask_b32_dpp v97, v41, v37, vcc quad_perm:[0,1,0,1] row_mask:0xf bank_mask:0xf
  v_cndmask_b32_dpp v98, v42, v38, vcc quad_perm:[0,1,0,1] row_mask:0xf bank_mask:0xf
  v_cndmask_b32_dpp v99, v43, v39, vcc quad_perm:[0,1,0,1] row_mask:0xf bank_mask:0xf
  v_max3_f32 v29, v96, v97, v98
  s_nop 0
  v_max_f32_dpp v28, v30, v99 quad_perm:[0,1,0,1] row_mask:0xf bank_mask:0xf
  v_max_f32 v29, v29, v28
  s_nop 1
  v_max_f32_dpp v28, v29, v29 quad_perm:[2,3,0,1] row_mask:0xf bank_mask:0xf
  v_mov_b32 v29, v28
  s_nop 1
  v_permlane32_swap_b32 v28, v29
  v_max_f32 v28, v28, v29
  v_mov_b32 v29, v28
  s_nop 1
  v_permlane16_swap_b32 v28, v29
  v_max_f32 v28, v28, v29
  v_mul_f32 v28, s47, v28
  v_fma_f32 v96, v96, s47, -v28
  v_fma_f32 v97, v97, s47, -v28
  v_fma_f32 v98, v98, s47, -v28
  v_fma_f32 v99, v99, s47, -v28
  v_fma_f32 v46, v46, s47, -v28
  v_fma_f32 v47, v47, s47, -v28
  v_exp_f32 v96, v96
  v_exp_f32 v97, v97
  v_exp_f32 v98, v98
  v_exp_f32 v99, v99
  v_cvt_pk_bf16_f32 v236, v96, v97
  v_cvt_pk_bf16_f32 v237, v98, v99
  v_exp_f32 v46, v46
  v_mov_b32_dpp v100, v236 quad_perm:[0,1,0,1] row_mask:0xf bank_mask:0xf
  v_mov_b32_dpp v102, v236 quad_perm:[2,3,2,3] row_mask:0xf bank_mask:0xf
  v_mov_b32_dpp v101, v237 quad_perm:[0,1,0,1] row_mask:0xf bank_mask:0xf
  v_mov_b32_dpp v103, v237 quad_perm:[2,3,2,3] row_mask:0xf bank_mask:0xf
  v_exp_f32 v47, v47
  s_nop 0
  v_smfmac_f32_16x16x64_bf16 v[228:231], v[100:103], v[248:255], v23
  v_cvt_pk_bf16_f32 v238, v46, v47
  buffer_load_dwordx4 v[116:119], v11, s[4:7], s44 offen offset:0
  v_smfmac_f32_16x16x64_bf16 v[212:215], v[100:103], v[148:155], v23
  buffer_load_dwordx4 v[132:135], v11, s[4:7], s44 offen offset:64
  v_mov_b32_dpp v232, v238 quad_perm:[0,1,0,1] row_mask:0xf bank_mask:0xf
  v_smfmac_f32_16x16x64_bf16 v[216:219], v[100:103], v[156:163], v23
  buffer_load_dwordx4 v[120:123], v11, s[4:7], s44 offen offset:1024
  v_mov_b32_dpp v235, v238 quad_perm:[0,1,0,1] row_mask:0xf bank_mask:0xf
  v_smfmac_f32_16x16x64_bf16 v[220:223], v[100:103], v[164:171], v23
  buffer_load_dwordx4 v[136:139], v11, s[4:7], s44 offen offset:1088
  s_waitcnt vmcnt(4)
  v_max3_u32 v31, v88, v89, v90
  v_max3_u32 v31, v31, v91, v92
  v_smfmac_f32_16x16x32_bf16 v[228:231], v[232:233], v[248:251], v23
  v_max3_u32 v31, v31, v93, v94
  v_max_u32 v31, v31, v95
  v_cmp_eq_u32 vcc, -1, v31
  v_smfmac_f32_16x16x64_bf16 v[224:227], v[100:103], v[172:179], v23
  s_cbranch_vccnz FL_v_f
FL_v_ok:
  v_smfmac_f32_16x16x32_bf16 v[212:215], v[232:233], v[88:91], v23
  buffer_load_dwordx4 v[124:127], v11, s[4:7], s44 offen offset:2048
  buffer_load_dwordx4 v[140:143], v11, s[4:7], s44 offen offset:2112
  v_smfmac_f32_16x16x32_bf16 v[216:219], v[234:235], v[88:91], v23
  v_rcp_f32 v28, v228
  v_smfmac_f32_16x16x32_bf16 v[220:223], v[232:233], v[92:95], v23
  v_rcp_f32 v29, v229
  v_smfmac_f32_16x16x32_bf16 v[224:227], v[234:235], v[92:95], v23
  s_nop 0
  v_pk_mul_f32 v[212:213], v[212:213], v[28:29]
  v_pk_mul_f32 v[214:215], v[214:215], v[28:29]
  v_cvt_pk_bf16_f32 v104, v212, v214
  v_cvt_pk_bf16_f32 v108, v213, v215
  v_pk_mul_f32 v[216:217], v[216:217], v[28:29]
  v_pk_mul_f32 v[218:219], v[218:219], v[28:29]
  v_cvt_pk_bf16_f32 v105, v216, v218
  v_cvt_pk_bf16_f32 v109, v217, v219
  v_pk_mul_f32 v[220:221], v[220:221], v[28:29]
  v_pk_mul_f32 v[222:223], v[222:223], v[28:29]
  v_cvt_pk_bf16_f32 v106, v220, v222
  v_cvt_pk_bf16_f32 v110, v221, v223
  v_pk_mul_f32 v[224:225], v[224:225], v[28:29]
  v_pk_mul_f32 v[226:227], v[226:227], v[28:29]
  v_cvt_pk_bf16_f32 v107, v224, v226
  v_cvt_pk_bf16_f32 v111, v225, v227
  ds_write_b128 v14, v[104:107]
  ds_write_b128 v15, v[108:111]
  s_add_u32 s92, s40, 3
  s_min_u32 s92, s92, 63
  s_lshr_b32 s92, s92, 2
  s_lshl_b32 s92, s92, 9
  v_mov_b32 v246, s40
  s_waitcnt lgkmcnt(0)
  s_barrier
  ds_read_b128 v[48:51], v16 offset:0
  ds_read_b128 v[52:55], v16 offset:1024
  ds_read_b128 v[56:59], v16 offset:2048
  ds_read_b128 v[60:63], v16 offset:3072
  ds_read_b128 v[64:67], v16 offset:4096
  buffer_store_dword v22, v17, s[4:7], s43 offen sc1
  buffer_store_dword v112, v19, s[4:7], s45 offen sc1
  s_waitcnt lgkmcnt(4)
  v_smfmac_f32_16x16x64_bf16 v[32:35], v[48:51], a[192:199], v23
  ds_read_b128 v[68:71], v16 offset:5120
  buffer_store_dword v113, v20, s[4:7], s45 offen sc1
  s_waitcnt lgkmcnt(4)
  v_smfmac_f32_16x16x64_bf16 v[32:35], v[52:55], a[200:207], v23
  ds_read_b128 v[72:75], v16 offset:6144
  buffer_store_dword v246, v245, s[4:7], 0 offen sc1
  s_waitcnt lgkmcnt(4)
  v_smfmac_f32_16x16x64_bf16 v[32:35], v[56:59], a[208:215], v23
  ds_read_b128 v[76:79], v16 offset:7168
  buffer_load_dword v243, v244, s[4:7], s92 offen sc1
  s_waitcnt lgkmcnt(4)
  v_smfmac_f32_16x16x64_bf16 v[32:35], v[60:63], a[216:223], v23
  s_mov_b32 s13, s43
  s_waitcnt lgkmcnt(3)
  v_smfmac_f32_16x16x64_bf16 v[32:35], v[64:67], a[224:231], v23
  s_add_u32 s40, s40, 1
  s_waitcnt lgkmcnt(2)
  v_smfmac_f32_16x16x64_bf16 v[32:35], v[68:71], a[232:239], v23
  s_mov_b32 s41, s91
  s_waitcnt lgkmcnt(1)
  v_smfmac_f32_16x16x64_bf16 v[32:35], v[72:75], a[240:247], v23
  s_xor_b32 s43, s91, 0x100000
  s_waitcnt lgkmcnt(0)
  v_smfmac_f32_16x16x64_bf16 v[32:35], v[76:79], a[248:255], v23
  s_nop 7
  v_pk_add_f32 v[28:29], v[32:33], v[34:35]
  v_cvt_pk_bf16_f32 v28, v28, v29
  v_min_u32 v28, s54, v28
  buffer_store_dword v28, v17, s[4:7], s42 offen sc1
  buffer_store_dword v28, v18, s[4:7], s42 offen
  s_branch FL_step
FL_last:
  buffer_store_dword v112, v19, s[4:7], s45 offen sc1
  buffer_store_dword v113, v20, s[4:7], s45 offen sc1
  s_branch L_join
FL_kv_f:
  s_sleep 8
  buffer_load_dword v243, v244, s[4:7], s92 offen sc1
  s_add_u32 s46, s46, 1
  s_cmp_ge_u32 s46, 131072
  s_cbranch_scc1 FL_rec_abort
  s_waitcnt vmcnt(0)
  s_branch FL_kv_chk
FL_g_f:
  s_mov_b64 exec, vcc
  buffer_load_dwordx4 v[36:39], v1, s[4:7], s42 offen sc1
  s_mov_b64 exec, -1
  s_add_u32 s46, s46, 1
  s_cmp_ge_u32 s46, 131072
  s_cbranch_scc1 FL_rec_abort
  s_waitcnt vmcnt(0)
  s_branch FL_g_chk
FL_m_f0:
  s_mov_b64 exec, vcc
  buffer_load_dwordx4 v[48:51], v3, s[4:7], s41 offen offset:0 sc1
  s_mov_b64 exec, -1
  s_waitcnt vmcnt(1)
  s_branch FL_m_0123_c1
FL_m_f1:
  s_mov_b64 exec, vcc
  buffer_load_dwordx4 v[52:55], v3, s[4:7], s41 offen offset:1024 sc1
  s_mov_b64 exec, -1
  s_waitcnt vmcnt(1)
  s_branch FL_m_123_c2
FL_m_f2:
  s_mov_b64 exec, vcc
  buffer_load_dwordx4 v[56:59], v3, s[4:7], s41 offen offset:2048 sc1
  s_mov_b64 exec, -1
  s_waitcnt vmcnt(1)
  s_branch FL_m_23_c3
FL_m_f3:
  s_mov_b64 exec, vcc
  buffer_load_dwordx4 v[60:63], v3, s[4:7], s41 offen offset:3072 sc1
  s_mov_b64 exec, -1
  s_nop 7
  s_branch FL_m_3_c3
FL_m_0_c0:
  v_max3_u32 v31, v48, v49, v50
  v_max_u32 v31, v31, v51
  v_cmp_eq_u32 vcc, -1, v31
  s_cbranch_vccz FL_m_0_ok0
FL_m_0_x0:
  s_mov_b64 exec, vcc
  buffer_load_dwordx4 v[48:51], v3, s[4:7], s41 offen offset:0 sc1
  s_mov_b64 exec, -1
  s_add_u32 s46, s46, 1
  s_cmp_ge_u32 s46, 131072
  s_cbranch_scc1 FL_rec_abort
  s_waitcnt vmcnt(2)
  s_branch FL_m_0_c0
FL_m_0_ok0:
  v_smfmac_f32_16x16x64_bf16 v[64:67], v[48:51], a[0:7], v23
  v_smfmac_f32_16x16x64_bf16 v[68:71], v[48:51], a[8:15], v23
  v_smfmac_f32_16x16x64_bf16 v[72:75], v[48:51], a[16:23], v23
  v_smfmac_f32_16x16x64_bf16 v[76:79], v[48:51], a[24:31], v23
  s_branch FL_m_done
FL_m_1_c1:
  v_max3_u32 v31, v52, v53, v54
  v_max_u32 v31, v31, v55
  v_cmp_eq_u32 vcc, -1, v31
  s_cbranch_vccz FL_m_1_ok1
FL_m_1_x1:
  s_mov_b64 exec, vcc
  buffer_load_dwordx4 v[52:55], v3, s[4:7], s41 offen offset:1024 sc1
  s_mov_b64 exec, -1
  s_add_u32 s46, s46, 1
  s_cmp_ge_u32 s46, 131072
  s_cbranch_scc1 FL_rec_abort
  s_waitcnt vmcnt(2)
  s_branch FL_m_1_c1
FL_m_1_ok1:
  v_smfmac_f32_16x16x64_bf16 v[64:67], v[52:55], a[48:55], v23
  v_smfmac_f32_16x16x64_bf16 v[68:71], v[52:55], a[56:63], v23
  v_smfmac_f32_16x16x64_bf16 v[72:75], v[52:55], a[64:71], v23
  v_smfmac_f32_16x16x64_bf16 v[76:79], v[52:55], a[72:79], v23
  s_branch FL_m_done
FL_m_2_c2:
  v_max3_u32 v31, v56, v57, v58
  v_max_u32 v31, v31, v59
  v_cmp_eq_u32 vcc, -1, v31
  s_cbranch_vccz FL_m_2_ok2
FL_m_2_x2:
  s_mov_b64 exec, vcc
  buffer_load_dwordx4 v[56:59], v3, s[4:7], s41 offen offset:2048 sc1
  s_mov_b64 exec, -1
  s_add_u32 s46, s46, 1
  s_cmp_ge_u32 s46, 131072
  s_cbranch_scc1 FL_rec_abort
  s_waitcnt vmcnt(2)
  s_branch FL_m_2_c2
FL_m_2_ok2:
  v_smfmac_f32_16x16x64_bf16 v[64:67], v[56:59], a[96:103], v23
  v_smfmac_f32_16x16x64_bf16 v[68:71], v[56:59], a[104:111], v23
  v_smfmac_f32_16x16x64_bf16 v[72:75], v[56:59], a[112:119], v23
  v_smfmac_f32_16x16x64_bf16 v[76:79], v[56:59], a[120:127], v23
  s_branch FL_m_done
FL_m_3_c3:
  v_max3_u32 v31, v60, v61, v62
  v_max_u32 v31, v31, v63
  v_cmp_eq_u32 vcc, -1, v31
  s_cbranch_vccz FL_m_3_ok3
FL_m_3_x3:
  s_mov_b64 exec, vcc
  buffer_load_dwordx4 v[60:63], v3, s[4:7], s41 offen offset:3072 sc1
  s_mov_b64 exec, -1
  s_add_u32 s46, s46, 1
  s_cmp_ge_u32 s46, 131072
  s_cbranch_scc1 FL_rec_abort
  s_waitcnt vmcnt(2)
  s_branch FL_m_3_c3
FL_m_3_ok3:
  v_smfmac_f32_16x16x64_bf16 v[64:67], v[60:63], a[144:151], v23
  v_smfmac_f32_16x16x64_bf16 v[68:71], v[60:63], a[152:159], v23
  v_smfmac_f32_16x16x64_bf16 v[72:75], v[60:63], a[160:167], v23
  v_smfmac_f32_16x16x64_bf16 v[76:79], v[60:63], a[168:175], v23
  s_branch FL_m_done
FL_m_01_c0:
  v_max3_u32 v31, v48, v49, v50
  v_max_u32 v31, v31, v51
  v_cmp_eq_u32 vcc, -1, v31
  s_cbranch_vccz FL_m_01_ok0
FL_m_01_x0:
  s_mov_b64 exec, vcc
  buffer_load_dwordx4 v[48:51], v3, s[4:7], s41 offen offset:0 sc1
  s_mov_b64 exec, -1
FL_m_01_c1:
  v_max3_u32 v31, v52, v53, v54
  v_max_u32 v31, v31, v55
  v_cmp_eq_u32 vcc, -1, v31
  s_cbranch_vccz FL_m_01_ok1
FL_m_01_x1:
  s_mov_b64 exec, vcc
  buffer_load_dwordx4 v[52:55], v3, s[4:7], s41 offen offset:1024 sc1
  s_mov_b64 exec, -1
  s_add_u32 s46, s46, 1
  s_cmp_ge_u32 s46, 131072
  s_cbranch_scc1 FL_rec_abort
  s_waitcnt vmcnt(4)
  s_branch FL_m_01_c0
FL_m_01_ok0:
  v_smfmac_f32_16x16x64_bf16 v[64:67], v[48:51], a[0:7], v23
  v_max3_u32 v31, v52, v53, v54
  v_max_u32 v31, v31, v55
  v_cmp_eq_u32 vcc, -1, v31
  v_smfmac_f32_16x16x64_bf16 v[68:71], v[48:51], a[8:15], v23
  v_smfmac_f32_16x16x64_bf16 v[72:75], v[48:51], a[16:23], v23
  v_smfmac_f32_16x16x64_bf16 v[76:79], v[48:51], a[24:31], v23
  s_cbranch_vccz FL_m_1_ok1
  s_branch FL_m_1_x1
FL_m_01_ok1:
  v_smfmac_f32_16x16x64_bf16 v[64:67], v[52:55], a[48:55], v23
  v_max3_u32 v31, v48, v49, v50
  v_max_u32 v31, v31, v51
  v_cmp_eq_u32 vcc, -1, v31
  v_smfmac_f32_16x16x64_bf16 v[68:71], v[52:55], a[56:63], v23
  v_smfmac_f32_16x16x64_bf16 v[72:75], v[52:55], a[64:71], v23
  v_smfmac_f32_16x16x64_bf16 v[76:79], v[52:55], a[72:79], v23
  s_cbranch_vccz FL_m_0_ok0
  s_branch FL_m_0_x0
FL_m_02_c0:
  v_max3_u32 v31, v48, v49, v50
  v_max_u32 v31, v31, v51
  v_cmp_eq_u32 vcc, -1, v31
  s_cbranch_vccz FL_m_02_ok0
FL_m_02_x0:
  s_mov_b64 exec, vcc
  buffer_load_dwordx4 v[48:51], v3, s[4:7], s41 offen offset:0 sc1
  s_mov_b64 exec, -1
FL_m_02_c2:
  v_max3_u32 v31, v56, v57, v58
  v_max_u32 v31, v31, v59
  v_cmp_eq_u32 vcc, -1, v31
  s_cbranch_vccz FL_m_02_ok2
FL_m_02_x2:
  s_mov_b64 exec, vcc
  buffer_load_dwordx4 v[56:59], v3, s[4:7], s41 offen offset:2048 sc1
  s_mov_b64 exec, -1
  s_add_u32 s46, s46, 1
  s_cmp_ge_u32 s46, 131072
  s_cbranch_scc1 FL_rec_abort
  s_waitcnt vmcnt(4)
  s_branch FL_m_02_c0
FL_m_02_ok0:
  v_smfmac_f32_16x16x64_bf16 v[64:67], v[48:51], a[0:7], v23
  v_max3_u32 v31, v56, v57, v58
  v_max_u32 v31, v31, v59
  v_cmp_eq_u32 vcc, -1, v31
  v_smfmac_f32_16x16x64_bf16 v[68:71], v[48:51], a[8:15], v23
  v_smfmac_f32_16x16x64_bf16 v[72:75], v[48:51], a[16:23], v23
  v_smfmac_f32_16x16x64_bf16 v[76:79], v[48:51], a[24:31], v23
  s_cbranch_vccz FL_m_2_ok2
  s_branch FL_m_2_x2
FL_m_02_ok2:
  v_smfmac_f32_16x16x64_bf16 v[64:67], v[56:59], a[96:103], v23
  v_max3_u32 v31, v48, v49, v50
  v_max_u32 v31, v31, v51
  v_cmp_eq_u32 vcc, -1, v31
  v_smfmac_f32_16x16x64_bf16 v[68:71], v[56:59], a[104:111], v23
  v_smfmac_f32_16x16x64_bf16 v[72:75], v[56:59], a[112:119], v23
  v_smfmac_f32_16x16x64_bf16 v[76:79], v[56:59], a[120:127], v23
  s_cbranch_vccz FL_m_0_ok0
  s_branch FL_m_0_x0
FL_m_03_c0:
  v_max3_u32 v31, v48, v49, v50
  v_max_u32 v31, v31, v51
  v_cmp_eq_u32 vcc, -1, v31
  s_cbranch_vccz FL_m_03_ok0
FL_m_03_x0:
  s_mov_b64 exec, vcc
  buffer_load_dwordx4 v[48:51], v3, s[4:7], s41 offen offset:0 sc1
  s_mov_b64 exec, -1
FL_m_03_c3:
  v_max3_u32 v31, v60, v61, v62
  v_max_u32 v31, v31, v63
  v_cmp_eq_u32 vcc, -1, v31
  s_cbranch_vccz FL_m_03_ok3
FL_m_03_x3:
  s_mov_b64 exec, vcc
  buffer_load_dwordx4 v[60:63], v3, s[4:7], s41 offen offset:3072 sc1
  s_mov_b64 exec, -1
  s_add_u32 s46, s46, 1
  s_cmp_ge_u32 s46, 131072
  s_cbranch_scc1 FL_rec_abort
  s_waitcnt vmcnt(4)
  s_branch FL_m_03_c0
FL_m_03_ok0:
  v_smfmac_f32_16x16x64_bf16 v[64:67], v[48:51], a[0:7], v23
  v_max3_u32 v31, v60, v61, v62
  v_max_u32 v31, v31, v63
  v_cmp_eq_u32 vcc, -1, v31
  v_smfmac_f32_16x16x64_bf16 v[68:71], v[48:51], a[8:15], v23
  v_smfmac_f32_16x16x64_bf16 v[72:75], v[48:51], a[16:23], v23
  v_smfmac_f32_16x16x64_bf16 v[76:79], v[48:51], a[24:31], v23
  s_cbranch_vccz FL_m_3_ok3
  s_branch FL_m_3_x3
FL_m_03_ok3:
  v_smfmac_f32_16x16x64_bf16 v[64:67], v[60:63], a[144:151], v23
  v_max3_u32 v31, v48, v49, v50
  v_max_u32 v31, v31, v51
  v_cmp_eq_u32 vcc, -1, v31
  v_smfmac_f32_16x16x64_bf16 v[68:71], v[60:63], a[152:159], v23
  v_smfmac_f32_16x16x64_bf16 v[72:75], v[60:63], a[160:167], v23
  v_smfmac_f32_16x16x64_bf16 v[76:79], v[60:63], a[168:175], v23
  s_cbranch_vccz FL_m_0_ok0
  s_branch FL_m_0_x0
FL_m_12_c1:
  v_max3_u32 v31, v52, v53, v54
  v_max_u32 v31, v31, v55
  v_cmp_eq_u32 vcc, -1, v31
  s_cbranch_vccz FL_m_12_ok1
FL_m_12_x1:
  s_mov_b64 exec, vcc
  buffer_load_dwordx4 v[52:55], v3, s[4:7], s41 offen offset:1024 sc1
  s_mov_b64 exec, -1
FL_m_12_c2:
  v_max3_u32 v31, v56, v57, v58
  v_max_u32 v31, v31, v59
  v_cmp_eq_u32 vcc, -1, v31
  s_cbranch_vccz FL_m_12_ok2
FL_m_12_x2:
  s_mov_b64 exec, vcc
  buffer_load_dwordx4 v[56:59], v3, s[4:7], s41 offen offset:2048 sc1
  s_mov_b64 exec, -1
  s_add_u32 s46, s46, 1
  s_cmp_ge_u32 s46, 131072
  s_cbranch_scc1 FL_rec_abort
  s_waitcnt vmcnt(4)
  s_branch FL_m_12_c1
FL_m_12_ok1:
  v_smfmac_f32_16x16x64_bf16 v[64:67], v[52:55], a[48:55], v23
  v_max3_u32 v31, v56, v57, v58
  v_max_u32 v31, v31, v59
  v_cmp_eq_u32 vcc, -1, v31
  v_smfmac_f32_16x16x64_bf16 v[68:71], v[52:55], a[56:63], v23
  v_smfmac_f32_16x16x64_bf16 v[72:75], v[52:55], a[64:71], v23
  v_smfmac_f32_16x16x64_bf16 v[76:79], v[52:55], a[72:79], v23
  s_cbranch_vccz FL_m_2_ok2
  s_branch FL_m_2_x2
FL_m_12_ok2:
  v_smfmac_f32_16x16x64_bf16 v[64:67], v[56:59], a[96:103], v23
  v_max3_u32 v31, v52, v53, v54
  v_max_u32 v31, v31, v55
  v_cmp_eq_u32 vcc, -1, v31
  v_smfmac_f32_16x16x64_bf16 v[68:71], v[56:59], a[104:111], v23
  v_smfmac_f32_16x16x64_bf16 v[72:75], v[56:59], a[112:119], v23
  v_smfmac_f32_16x16x64_bf16 v[76:79], v[56:59], a[120:127], v23
  s_cbranch_vccz FL_m_1_ok1
  s_branch FL_m_1_x1
FL_m_13_c1:
  v_max3_u32 v31, v52, v53, v54
  v_max_u32 v31, v31, v55
  v_cmp_eq_u32 vcc, -1, v31
  s_cbranch_vccz FL_m_13_ok1
FL_m_13_x1:
  s_mov_b64 exec, vcc
  buffer_load_dwordx4 v[52:55], v3, s[4:7], s41 offen offset:1024 sc1
  s_mov_b64 exec, -1
FL_m_13_c3:
  v_max3_u32 v31, v60, v61, v62
  v_max_u32 v31, v31, v63
  v_cmp_eq_u32 vcc, -1, v31
  s_cbranch_vccz FL_m_13_ok3
FL_m_13_x3:
  s_mov_b64 exec, vcc
  buffer_load_dwordx4 v[60:63], v3, s[4:7], s41 offen offset:3072 sc1
  s_mov_b64 exec, -1
  s_add_u32 s46, s46, 1
  s_cmp_ge_u32 s46, 131072
  s_cbranch_scc1 FL_rec_abort
  s_waitcnt vmcnt(4)
  s_branch FL_m_13_c1
FL_m_13_ok1:
  v_smfmac_f32_16x16x64_bf16 v[64:67], v[52:55], a[48:55], v23
  v_max3_u32 v31, v60, v61, v62
  v_max_u32 v31, v31, v63
  v_cmp_eq_u32 vcc, -1, v31
  v_smfmac_f32_16x16x64_bf16 v[68:71], v[52:55], a[56:63], v23
  v_smfmac_f32_16x16x64_bf16 v[72:75], v[52:55], a[64:71], v23
  v_smfmac_f32_16x16x64_bf16 v[76:79], v[52:55], a[72:79], v23
  s_cbranch_vccz FL_m_3_ok3
  s_branch FL_m_3_x3
FL_m_13_ok3:
  v_smfmac_f32_16x16x64_bf16 v[64:67], v[60:63], a[144:151], v23
  v_max3_u32 v31, v52, v53, v54
  v_max_u32 v31, v31, v55
  v_cmp_eq_u32 vcc, -1, v31
  v_smfmac_f32_16x16x64_bf16 v[68:71], v[60:63], a[152:159], v23
  v_smfmac_f32_16x16x64_bf16 v[72:75], v[60:63], a[160:167], v23
  v_smfmac_f32_16x16x64_bf16 v[76:79], v[60:63], a[168:175], v23
  s_cbranch_vccz FL_m_1_ok1
  s_branch FL_m_1_x1
FL_m_23_c2:
  v_max3_u32 v31, v56, v57, v58
  v_max_u32 v31, v31, v59
  v_cmp_eq_u32 vcc, -1, v31
  s_cbranch_vccz FL_m_23_ok2
FL_m_23_x2:
  s_mov_b64 exec, vcc
  buffer_load_dwordx4 v[56:59], v3, s[4:7], s41 offen offset:2048 sc1
  s_mov_b64 exec, -1
FL_m_23_c3:
  v_max3_u32 v31, v60, v61, v62
  v_max_u32 v31, v31, v63
  v_cmp_eq_u32 vcc, -1, v31
  s_cbranch_vccz FL_m_23_ok3
FL_m_23_x3:
  s_mov_b64 exec, vcc
  buffer_load_dwordx4 v[60:63], v3, s[4:7], s41 offen offset:3072 sc1
  s_mov_b64 exec, -1
  s_add_u32 s46, s46, 1
  s_cmp_ge_u32 s46, 131072
  s_cbranch_scc1 FL_rec_abort
  s_waitcnt vmcnt(4)
  s_branch FL_m_23_c2
FL_m_23_ok2:
  v_smfmac_f32_16x16x64_bf16 v[64:67], v[56:59], a[96:103], v23
  v_max3_u32 v31, v60, v61, v62
  v_max_u32 v31, v31, v63
  v_cmp_eq_u32 vcc, -1, v31
  v_smfmac_f32_16x16x64_bf16 v[68:71], v[56:59], a[104:111], v23
  v_smfmac_f32_16x16x64_bf16 v[72:75], v[56:59], a[112:119], v23
  v_smfmac_f32_16x16x64_bf16 v[76:79], v[56:59], a[120:127], v23
  s_cbranch_vccz FL_m_3_ok3
  s_branch FL_m_3_x3
FL_m_23_ok3:
  v_smfmac_f32_16x16x64_bf16 v[64:67], v[60:63], a[144:151], v23
  v_max3_u32 v31, v56, v57, v58
  v_max_u32 v31, v31, v59
  v_cmp_eq_u32 vcc, -1, v31
  v_smfmac_f32_16x16x64_bf16 v[68:71], v[60:63], a[152:159], v23
  v_smfmac_f32_16x16x64_bf16 v[72:75], v[60:63], a[160:167], v23
  v_smfmac_f32_16x16x64_bf16 v[76:79], v[60:63], a[168:175], v23
  s_cbranch_vccz FL_m_2_ok2
  s_branch FL_m_2_x2
FL_m_012_c0:
  v_max3_u32 v31, v48, v49, v50
  v_max_u32 v31, v31, v51
  v_cmp_eq_u32 vcc, -1, v31
  s_cbranch_vccz FL_m_012_ok0
FL_m_012_x0:
  s_mov_b64 exec, vcc
  buffer_load_dwordx4 v[48:51], v3, s[4:7], s41 offen offset:0 sc1
  s_mov_b64 exec, -1
FL_m_012_c1:
  v_max3_u32 v31, v52, v53, v54
  v_max_u32 v31, v31, v55
  v_cmp_eq_u32 vcc, -1, v31
  s_cbranch_vccz FL_m_012_ok1
FL_m_012_x1:
  s_mov_b64 exec, vcc
  buffer_load_dwordx4 v[52:55], v3, s[4:7], s41 offen offset:1024 sc1
  s_mov_b64 exec, -1
FL_m_012_c2:
  v_max3_u32 v31, v56, v57, v58
  v_max_u32 v31, v31, v59
  v_cmp_eq_u32 vcc, -1, v31
  s_cbranch_vccz FL_m_012_ok2
FL_m_012_x2:
  s_mov_b64 exec, vcc
  buffer_load_dwordx4 v[56:59], v3, s[4:7], s41 offen offset:2048 sc1
  s_mov_b64 exec, -1
  s_add_u32 s46, s46, 1
  s_cmp_ge_u32 s46, 131072
  s_cbranch_scc1 FL_rec_abort
  s_waitcnt vmcnt(4)
  s_branch FL_m_012_c0
FL_m_012_ok0:
  v_smfmac_f32_16x16x64_bf16 v[64:67], v[48:51], a[0:7], v23
  v_max3_u32 v31, v52, v53, v54
  v_max_u32 v31, v31, v55
  v_cmp_eq_u32 vcc, -1, v31
  v_smfmac_f32_16x16x64_bf16 v[68:71], v[48:51], a[8:15], v23
  v_smfmac_f32_16x16x64_bf16 v[72:75], v[48:51], a[16:23], v23
  v_smfmac_f32_16x16x64_bf16 v[76:79], v[48:51], a[24:31], v23
  s_cbranch_vccz FL_m_12_ok1
  s_branch FL_m_12_x1
FL_m_012_ok1:
  v_smfmac_f32_16x16x64_bf16 v[64:67], v[52:55], a[48:55], v23
  v_max3_u32 v31, v56, v57, v58
  v_max_u32 v31, v31, v59
  v_cmp_eq_u32 vcc, -1, v31
  v_smfmac_f32_16x16x64_bf16 v[68:71], v[52:55], a[56:63], v23
  v_smfmac_f32_16x16x64_bf16 v[72:75], v[52:55], a[64:71], v23
  v_smfmac_f32_16x16x64_bf16 v[76:79], v[52:55], a[72:79], v23
  s_cbranch_vccz FL_m_02_ok2
  s_branch FL_m_02_x2
FL_m_012_ok2:
  v_smfmac_f32_16x16x64_bf16 v[64:67], v[56:59], a[96:103], v23
  v_max3_u32 v31, v48, v49, v50
  v_max_u32 v31, v31, v51
  v_cmp_eq_u32 vcc, -1, v31
  v_smfmac_f32_16x16x64_bf16 v[68:71], v[56:59], a[104:111], v23
  v_smfmac_f32_16x16x64_bf16 v[72:75], v[56:59], a[112:119], v23
  v_smfmac_f32_16x16x64_bf16 v[76:79], v[56:59], a[120:127], v23
  s_cbranch_vccz FL_m_01_ok0
  s_branch FL_m_01_x0
FL_m_013_c0:
  v_max3_u32 v31, v48, v49, v50
  v_max_u32 v31, v31, v51
  v_cmp_eq_u32 vcc, -1, v31
  s_cbranch_vccz FL_m_013_ok0
FL_m_013_x0:
  s_mov_b64 exec, vcc
  buffer_load_dwordx4 v[48:51], v3, s[4:7], s41 offen offset:0 sc1
  s_mov_b64 exec, -1
FL_m_013_c1:
  v_max3_u32 v31, v52, v53, v54
  v_max_u32 v31, v31, v55
  v_cmp_eq_u32 vcc, -1, v31
  s_cbranch_vccz FL_m_013_ok1
FL_m_013_x1:
  s_mov_b64 exec, vcc
  buffer_load_dwordx4 v[52:55], v3, s[4:7], s41 offen offset:1024 sc1
  s_mov_b64 exec, -1
FL_m_013_c3:
  v_max3_u32 v31, v60, v61, v62
  v_max_u32 v31, v31, v63
  v_cmp_eq_u32 vcc, -1, v31
  s_cbranch_vccz FL_m_013_ok3
FL_m_013_x3:
  s_mov_b64 exec, vcc
  buffer_load_dwordx4 v[60:63], v3, s[4:7], s41 offen offset:3072 sc1
  s_mov_b64 exec, -1
  s_add_u32 s46, s46, 1
  s_cmp_ge_u32 s46, 131072
  s_cbranch_scc1 FL_rec_abort
  s_waitcnt vmcnt(4)
  s_branch FL_m_013_c0
FL_m_013_ok0:
  v_smfmac_f32_16x16x64_bf16 v[64:67], v[48:51], a[0:7], v23
  v_max3_u32 v31, v52, v53, v54
  v_max_u32 v31, v31, v55
  v_cmp_eq_u32 vcc, -1, v31
  v_smfmac_f32_16x16x64_bf16 v[68:71], v[48:51], a[8:15], v23
  v_smfmac_f32_16x16x64_bf16 v[72:75], v[48:51], a[16:23], v23
  v_smfmac_f32_16x16x64_bf16 v[76:79], v[48:51], a[24:31], v23
  s_cbranch_vccz FL_m_13_ok1
  s_branch FL_m_13_x1
FL_m_013_ok1:
  v_smfmac_f32_16x16x64_bf16 v[64:67], v[52:55], a[48:55], v23
  v_max3_u32 v31, v60, v61, v62
  v_max_u32 v31, v31, v63
  v_cmp_eq_u32 vcc, -1, v31
  v_smfmac_f32_16x16x64_bf16 v[68:71], v[52:55], a[56:63], v23
  v_smfmac_f32_16x16x64_bf16 v[72:75], v[52:55], a[64:71], v23
  v_smfmac_f32_16x16x64_bf16 v[76:79], v[52:55], a[72:79], v23
  s_cbranch_vccz FL_m_03_ok3
  s_branch FL_m_03_x3
FL_m_013_ok3:
  v_smfmac_f32_16x16x64_bf16 v[64:67], v[60:63], a[144:151], v23
  v_max3_u32 v31, v48, v49, v50
  v_max_u32 v31, v31, v51
  v_cmp_eq_u32 vcc, -1, v31
  v_smfmac_f32_16x16x64_bf16 v[68:71], v[60:63], a[152:159], v23
  v_smfmac_f32_16x16x64_bf16 v[72:75], v[60:63], a[160:167], v23
  v_smfmac_f32_16x16x64_bf16 v[76:79], v[60:63], a[168:175], v23
  s_cbranch_vccz FL_m_01_ok0
  s_branch FL_m_01_x0
FL_m_023_c0:
  v_max3_u32 v31, v48, v49, v50
  v_max_u32 v31, v31, v51
  v_cmp_eq_u32 vcc, -1, v31
  s_cbranch_vccz FL_m_023_ok0
FL_m_023_x0:
  s_mov_b64 exec, vcc
  buffer_load_dwordx4 v[48:51], v3, s[4:7], s41 offen offset:0 sc1
  s_mov_b64 exec, -1
FL_m_023_c2:
  v_max3_u32 v31, v56, v57, v58
  v_max_u32 v31, v31, v59
  v_cmp_eq_u32 vcc, -1, v31
  s_cbranch_vccz FL_m_023_ok2
FL_m_023_x2:
  s_mov_b64 exec, vcc
  buffer_load_dwordx4 v[56:59], v3, s[4:7], s41 offen offset:2048 sc1
  s_mov_b64 exec, -1
FL_m_023_c3:
  v_max3_u32 v31, v60, v61, v62
  v_max_u32 v31, v31, v63
  v_cmp_eq_u32 vcc, -1, v31
  s_cbranch_vccz FL_m_023_ok3
FL_m_023_x3:
  s_mov_b64 exec, vcc
  buffer_load_dwordx4 v[60:63], v3, s[4:7], s41 offen offset:3072 sc1
  s_mov_b64 exec, -1
  s_add_u32 s46, s46, 1
  s_cmp_ge_u32 s46, 131072
  s_cbranch_scc1 FL_rec_abort
  s_waitcnt vmcnt(4)
  s_branch FL_m_023_c0
FL_m_023_ok0:
  v_smfmac_f32_16x16x64_bf16 v[64:67], v[48:51], a[0:7], v23
  v_max3_u32 v31, v56, v57, v58
  v_max_u32 v31, v31, v59
  v_cmp_eq_u32 vcc, -1, v31
  v_smfmac_f32_16x16x64_bf16 v[68:71], v[48:51], a[8:15], v23
  v_smfmac_f32_16x16x64_bf16 v[72:75], v[48:51], a[16:23], v23
  v_smfmac_f32_16x16x64_bf16 v[76:79], v[48:51], a[24:31], v23
  s_cbranch_vccz FL_m_23_ok2
  s_branch FL_m_23_x2
FL_m_023_ok2:
  v_smfmac_f32_16x16x64_bf16 v[64:67], v[56:59], a[96:103], v23
  v_max3_u32 v31, v60, v61, v62
  v_max_u32 v31, v31, v63
  v_cmp_eq_u32 vcc, -1, v31
  v_smfmac_f32_16x16x64_bf16 v[68:71], v[56:59], a[104:111], v23
  v_smfmac_f32_16x16x64_bf16 v[72:75], v[56:59], a[112:119], v23
  v_smfmac_f32_16x16x64_bf16 v[76:79], v[56:59], a[120:127], v23
  s_cbranch_vccz FL_m_03_ok3
  s_branch FL_m_03_x3
FL_m_023_ok3:
  v_smfmac_f32_16x16x64_bf16 v[64:67], v[60:63], a[144:151], v23
  v_max3_u32 v31, v48, v49, v50
  v_max_u32 v31, v31, v51
  v_cmp_eq_u32 vcc, -1, v31
  v_smfmac_f32_16x16x64_bf16 v[68:71], v[60:63], a[152:159], v23
  v_smfmac_f32_16x16x64_bf16 v[72:75], v[60:63], a[160:167], v23
  v_smfmac_f32_16x16x64_bf16 v[76:79], v[60:63], a[168:175], v23
  s_cbranch_vccz FL_m_02_ok0
  s_branch FL_m_02_x0
FL_m_123_c1:
  v_max3_u32 v31, v52, v53, v54
  v_max_u32 v31, v31, v55
  v_cmp_eq_u32 vcc, -1, v31
  s_cbranch_vccz FL_m_123_ok1
FL_m_123_x1:
  s_mov_b64 exec, vcc
  buffer_load_dwordx4 v[52:55], v3, s[4:7], s41 offen offset:1024 sc1
  s_mov_b64 exec, -1
FL_m_123_c2:
  v_max3_u32 v31, v56, v57, v58
  v_max_u32 v31, v31, v59
  v_cmp_eq_u32 vcc, -1, v31
  s_cbranch_vccz FL_m_123_ok2
FL_m_123_x2:
  s_mov_b64 exec, vcc
  buffer_load_dwordx4 v[56:59], v3, s[4:7], s41 offen offset:2048 sc1
  s_mov_b64 exec, -1
FL_m_123_c3:
  v_max3_u32 v31, v60, v61, v62
  v_max_u32 v31, v31, v63
  v_cmp_eq_u32 vcc, -1, v31
  s_cbranch_vccz FL_m_123_ok3
FL_m_123_x3:
  s_mov_b64 exec, vcc
  buffer_load_dwordx4 v[60:63], v3, s[4:7], s41 offen offset:3072 sc1
  s_mov_b64 exec, -1
  s_add_u32 s46, s46, 1
  s_cmp_ge_u32 s46, 131072
  s_cbranch_scc1 FL_rec_abort
  s_waitcnt vmcnt(4)
  s_branch FL_m_123_c1
FL_m_123_ok1:
  v_smfmac_f32_16x16x64_bf16 v[64:67], v[52:55], a[48:55], v23
  v_max3_u32 v31, v56, v57, v58
  v_max_u32 v31, v31, v59
  v_cmp_eq_u32 vcc, -1, v31
  v_smfmac_f32_16x16x64_bf16 v[68:71], v[52:55], a[56:63], v23
  v_smfmac_f32_16x16x64_bf16 v[72:75], v[52:55], a[64:71], v23
  v_smfmac_f32_16x16x64_bf16 v[76:79], v[52:55], a[72:79], v23
  s_cbranch_vccz FL_m_23_ok2
  s_branch FL_m_23_x2
FL_m_123_ok2:
  v_smfmac_f32_16x16x64_bf16 v[64:67], v[56:59], a[96:103], v23
  v_max3_u32 v31, v60, v61, v62
  v_max_u32 v31, v31, v63
  v_cmp_eq_u32 vcc, -1, v31
  v_smfmac_f32_16x16x64_bf16 v[68:71], v[56:59], a[104:111], v23
  v_smfmac_f32_16x16x64_bf16 v[72:75], v[56:59], a[112:119], v23
  v_smfmac_f32_16x16x64_bf16 v[76:79], v[56:59], a[120:127], v23
  s_cbranch_vccz FL_m_13_ok3
  s_branch FL_m_13_x3
FL_m_123_ok3:
  v_smfmac_f32_16x16x64_bf16 v[64:67], v[60:63], a[144:151], v23
  v_max3_u32 v31, v52, v53, v54
  v_max_u32 v31, v31, v55
  v_cmp_eq_u32 vcc, -1, v31
  v_smfmac_f32_16x16x64_bf16 v[68:71], v[60:63], a[152:159], v23
  v_smfmac_f32_16x16x64_bf16 v[72:75], v[60:63], a[160:167], v23
  v_smfmac_f32_16x16x64_bf16 v[76:79], v[60:63], a[168:175], v23
  s_cbranch_vccz FL_m_12_ok1
  s_branch FL_m_12_x1
FL_m_0123_c0:
  v_max3_u32 v31, v48, v49, v50
  v_max_u32 v31, v31, v51
  v_cmp_eq_u32 vcc, -1, v31
  s_cbranch_vccz FL_m_0123_ok0
FL_m_0123_x0:
  s_mov_b64 exec, vcc
  buffer_load_dwordx4 v[48:51], v3, s[4:7], s41 offen offset:0 sc1
  s_mov_b64 exec, -1
FL_m_0123_c1:
  v_max3_u32 v31, v52, v53, v54
  v_max_u32 v31, v31, v55
  v_cmp_eq_u32 vcc, -1, v31
  s_cbranch_vccz FL_m_0123_ok1
FL_m_0123_x1:
  s_mov_b64 exec, vcc
  buffer_load_dwordx4 v[52:55], v3, s[4:7], s41 offen offset:1024 sc1
  s_mov_b64 exec, -1
FL_m_0123_c2:
  v_max3_u32 v31, v56, v57, v58
  v_max_u32 v31, v31, v59
  v_cmp_eq_u32 vcc, -1, v31
  s_cbranch_vccz FL_m_0123_ok2
FL_m_0123_x2:
  s_mov_b64 exec, vcc
  buffer_load_dwordx4 v[56:59], v3, s[4:7], s41 offen offset:2048 sc1
  s_mov_b64 exec, -1
FL_m_0123_c3:
  v_max3_u32 v31, v60, v61, v62
  v_max_u32 v31, v31, v63
  v_cmp_eq_u32 vcc, -1, v31
  s_cbranch_vccz FL_m_0123_ok3
FL_m_0123_x3:
  s_mov_b64 exec, vcc
  buffer_load_dwordx4 v[60:63], v3, s[4:7], s41 offen offset:3072 sc1
  s_mov_b64 exec, -1
  s_add_u32 s46, s46, 1
  s_cmp_ge_u32 s46, 131072
  s_cbranch_scc1 FL_rec_abort
  s_waitcnt vmcnt(4)
  s_branch FL_m_0123_c0
FL_m_0123_ok0:
  v_smfmac_f32_16x16x64_bf16 v[64:67], v[48:51], a[0:7], v23
  v_max3_u32 v31, v52, v53, v54
  v_max_u32 v31, v31, v55
  v_cmp_eq_u32 vcc, -1, v31
  v_smfmac_f32_16x16x64_bf16 v[68:71], v[48:51], a[8:15], v23
  v_smfmac_f32_16x16x64_bf16 v[72:75], v[48:51], a[16:23], v23
  v_smfmac_f32_16x16x64_bf16 v[76:79], v[48:51], a[24:31], v23
  s_cbranch_vccz FL_m_123_ok1
  s_branch FL_m_123_x1
FL_m_0123_ok1:
  v_smfmac_f32_16x16x64_bf16 v[64:67], v[52:55], a[48:55], v23
  v_max3_u32 v31, v56, v57, v58
  v_max_u32 v31, v31, v59
  v_cmp_eq_u32 vcc, -1, v31
  v_smfmac_f32_16x16x64_bf16 v[68:71], v[52:55], a[56:63], v23
  v_smfmac_f32_16x16x64_bf16 v[72:75], v[52:55], a[64:71], v23
  v_smfmac_f32_16x16x64_bf16 v[76:79], v[52:55], a[72:79], v23
  s_cbranch_vccz FL_m_023_ok2
  s_branch FL_m_023_x2
FL_m_0123_ok2:
  v_smfmac_f32_16x16x64_bf16 v[64:67], v[56:59], a[96:103], v23
  v_max3_u32 v31, v60, v61, v62
  v_max_u32 v31, v31, v63
  v_cmp_eq_u32 vcc, -1, v31
  v_smfmac_f32_16x16x64_bf16 v[68:71], v[56:59], a[104:111], v23
  v_smfmac_f32_16x16x64_bf16 v[72:75], v[56:59], a[112:119], v23
  v_smfmac_f32_16x16x64_bf16 v[76:79], v[56:59], a[120:127], v23
  s_cbranch_vccz FL_m_013_ok3
  s_branch FL_m_013_x3
FL_m_0123_ok3:
  v_smfmac_f32_16x16x64_bf16 v[64:67], v[60:63], a[144:151], v23
  v_max3_u32 v31, v48, v49, v50
  v_max_u32 v31, v31, v51
  v_cmp_eq_u32 vcc, -1, v31
  v_smfmac_f32_16x16x64_bf16 v[68:71], v[60:63], a[152:159], v23
  v_smfmac_f32_16x16x64_bf16 v[72:75], v[60:63], a[160:167], v23
  v_smfmac_f32_16x16x64_bf16 v[76:79], v[60:63], a[168:175], v23
  s_cbranch_vccz FL_m_012_ok0
  s_branch FL_m_012_x0
FL_x_f0:
  s_mov_b64 exec, vcc
  buffer_load_dwordx4 v[64:67], v9, s[4:7], s41 offen offset:0 sc1
  s_mov_b64 exec, -1
  s_waitcnt vmcnt(2)
  s_branch FL_x_0123_c1
FL_x_f1:
  s_mov_b64 exec, vcc
  buffer_load_dwordx4 v[68:71], v9, s[4:7], s41 offen offset:1024 sc1
  s_mov_b64 exec, -1
  s_waitcnt vmcnt(2)
  s_branch FL_x_123_c2
FL_x_f2:
  s_mov_b64 exec, vcc
  buffer_load_dwordx4 v[72:75], v9, s[4:7], s41 offen offset:2048 sc1
  s_mov_b64 exec, -1
  s_waitcnt vmcnt(2)
  s_branch FL_x_23_c3
FL_x_f3:
  s_mov_b64 exec, vcc
  buffer_load_dwordx4 v[76:79], v9, s[4:7], s41 offen offset:3072 sc1
  s_mov_b64 exec, -1
  s_nop 7
  s_branch FL_x_3_c3
FL_x_0_c0:
  v_max3_u32 v31, v64, v65, v66
  v_max_u32 v31, v31, v67
  v_cmp_eq_u32 vcc, -1, v31
  s_cbranch_vccz FL_x_0_ok0
FL_x_0_x0:
  s_mov_b64 exec, vcc
  buffer_load_dwordx4 v[64:67], v9, s[4:7], s41 offen offset:0 sc1
  s_mov_b64 exec, -1
  s_add_u32 s46, s46, 1
  s_cmp_ge_u32 s46, 131072
  s_cbranch_scc1 FL_rec_abort
  s_waitcnt vmcnt(2)
  s_branch FL_x_0_c0
FL_x_0_ok0:
  v_mfma_f32_16x16x32_bf16 v[44:47], v[64:67], v[64:67], v[44:47]
  v_mfma_f32_16x16x32_bf16 v[36:39], v[116:119], v[64:67], v[36:39]
  v_mfma_f32_16x16x32_bf16 v[40:43], v[132:135], v[64:67], v[40:43]
  s_branch FL_x_done
FL_x_1_c1:
  v_max3_u32 v31, v68, v69, v70
  v_max_u32 v31, v31, v71
  v_cmp_eq_u32 vcc, -1, v31
  s_cbranch_vccz FL_x_1_ok1
FL_x_1_x1:
  s_mov_b64 exec, vcc
  buffer_load_dwordx4 v[68:71], v9, s[4:7], s41 offen offset:1024 sc1
  s_mov_b64 exec, -1
  s_add_u32 s46, s46, 1
  s_cmp_ge_u32 s46, 131072
  s_cbranch_scc1 FL_rec_abort
  s_waitcnt vmcnt(2)
  s_branch FL_x_1_c1
FL_x_1_ok1:
  v_mfma_f32_16x16x32_bf16 v[44:47], v[68:71], v[68:71], v[44:47]
  v_mfma_f32_16x16x32_bf16 v[36:39], v[120:123], v[68:71], v[36:39]
  v_mfma_f32_16x16x32_bf16 v[40:43], v[136:139], v[68:71], v[40:43]
  s_branch FL_x_done
FL_x_2_c2:
  v_max3_u32 v31, v72, v73, v74
  v_max_u32 v31, v31, v75
  v_cmp_eq_u32 vcc, -1, v31
  s_cbranch_vccz FL_x_2_ok2
FL_x_2_x2:
  s_mov_b64 exec, vcc
  buffer_load_dwordx4 v[72:75], v9, s[4:7], s41 offen offset:2048 sc1
  s_mov_b64 exec, -1
  s_add_u32 s46, s46, 1
  s_cmp_ge_u32 s46, 131072
  s_cbranch_scc1 FL_rec_abort
  s_waitcnt vmcnt(2)
  s_branch FL_x_2_c2
FL_x_2_ok2:
  v_mfma_f32_16x16x32_bf16 v[44:47], v[72:75], v[72:75], v[44:47]
  v_mfma_f32_16x16x32_bf16 v[36:39], v[124:127], v[72:75], v[36:39]
  v_mfma_f32_16x16x32_bf16 v[40:43], v[140:143], v[72:75], v[40:43]
  s_branch FL_x_done
FL_x_3_c3:
  v_max3_u32 v31, v76, v77, v78
  v_max_u32 v31, v31, v79
  v_cmp_eq_u32 vcc, -1, v31
  s_cbranch_vccz FL_x_3_ok3
FL_x_3_x3:
  s_mov_b64 exec, vcc
  buffer_load_dwordx4 v[76:79], v9, s[4:7], s41 offen offset:3072 sc1
  s_mov_b64 exec, -1
  s_add_u32 s46, s46, 1
  s_cmp_ge_u32 s46, 131072
  s_cbranch_scc1 FL_rec_abort
  s_waitcnt vmcnt(2)
  s_branch FL_x_3_c3
FL_x_3_ok3:
  v_mfma_f32_16x16x32_bf16 v[44:47], v[76:79], v[76:79], v[44:47]
  v_mfma_f32_16x16x32_bf16 v[36:39], v[128:131], v[76:79], v[36:39]
  v_mfma_f32_16x16x32_bf16 v[40:43], v[144:147], v[76:79], v[40:43]
  s_branch FL_x_done
FL_x_01_c0:
  v_max3_u32 v31, v64, v65, v66
  v_max_u32 v31, v31, v67
  v_cmp_eq_u32 vcc, -1, v31
  s_cbranch_vccz FL_x_01_ok0
FL_x_01_x0:
  s_mov_b64 exec, vcc
  buffer_load_dwordx4 v[64:67], v9, s[4:7], s41 offen offset:0 sc1
  s_mov_b64 exec, -1
FL_x_01_c1:
  v_max3_u32 v31, v68, v69, v70
  v_max_u32 v31, v31, v71
  v_cmp_eq_u32 vcc, -1, v31
  s_cbranch_vccz FL_x_01_ok1
FL_x_01_x1:
  s_mov_b64 exec, vcc
  buffer_load_dwordx4 v[68:71], v9, s[4:7], s41 offen offset:1024 sc1
  s_mov_b64 exec, -1
  s_add_u32 s46, s46, 1
  s_cmp_ge_u32 s46, 131072
  s_cbranch_scc1 FL_rec_abort
  s_waitcnt vmcnt(4)
  s_branch FL_x_01_c0
FL_x_01_ok0:
  v_mfma_f32_16x16x32_bf16 v[44:47], v[64:67], v[64:67], v[44:47]
  v_max3_u32 v31, v68, v69, v70
  v_max_u32 v31, v31, v71
  v_cmp_eq_u32 vcc, -1, v31
  v_mfma_f32_16x16x32_bf16 v[36:39], v[116:119], v[64:67], v[36:39]
  v_mfma_f32_16x16x32_bf16 v[40:43], v[132:135], v[64:67], v[40:43]
  s_cbranch_vccz FL_x_1_ok1
  s_branch FL_x_1_x1
FL_x_01_ok1:
  v_mfma_f32_16x16x32_bf16 v[44:47], v[68:71], v[68:71], v[44:47]
  v_max3_u32 v31, v64, v65, v66
  v_max_u32 v31, v31, v67
  v_cmp_eq_u32 vcc, -1, v31
  v_mfma_f32_16x16x32_bf16 v[36:39], v[120:123], v[68:71], v[36:39]
  v_mfma_f32_16x16x32_bf16 v[40:43], v[136:139], v[68:71], v[40:43]
  s_cbranch_vccz FL_x_0_ok0
  s_branch FL_x_0_x0
FL_x_02_c0:
  v_max3_u32 v31, v64, v65, v66
  v_max_u32 v31, v31, v67
  v_cmp_eq_u32 vcc, -1, v31
  s_cbranch_vccz FL_x_02_ok0
FL_x_02_x0:
  s_mov_b64 exec, vcc
  buffer_load_dwordx4 v[64:67], v9, s[4:7], s41 offen offset:0 sc1
  s_mov_b64 exec, -1
FL_x_02_c2:
  v_max3_u32 v31, v72, v73, v74
  v_max_u32 v31, v31, v75
  v_cmp_eq_u32 vcc, -1, v31
  s_cbranch_vccz FL_x_02_ok2
FL_x_02_x2:
  s_mov_b64 exec, vcc
  buffer_load_dwordx4 v[72:75], v9, s[4:7], s41 offen offset:2048 sc1
  s_mov_b64 exec, -1
  s_add_u32 s46, s46, 1
  s_cmp_ge_u32 s46, 131072
  s_cbranch_scc1 FL_rec_abort
  s_waitcnt vmcnt(4)
  s_branch FL_x_02_c0
FL_x_02_ok0:
  v_mfma_f32_16x16x32_bf16 v[44:47], v[64:67], v[64:67], v[44:47]
  v_max3_u32 v31, v72, v73, v74
  v_max_u32 v31, v31, v75
  v_cmp_eq_u32 vcc, -1, v31
  v_mfma_f32_16x16x32_bf16 v[36:39], v[116:119], v[64:67], v[36:39]
  v_mfma_f32_16x16x32_bf16 v[40:43], v[132:135], v[64:67], v[40:43]
  s_cbranch_vccz FL_x_2_ok2
  s_branch FL_x_2_x2
FL_x_02_ok2:
  v_mfma_f32_16x16x32_bf16 v[44:47], v[72:75], v[72:75], v[44:47]
  v_max3_u32 v31, v64, v65, v66
  v_max_u32 v31, v31, v67
  v_cmp_eq_u32 vcc, -1, v31
  v_mfma_f32_16x16x32_bf16 v[36:39], v[124:127], v[72:75], v[36:39]
  v_mfma_f32_16x16x32_bf16 v[40:43], v[140:143], v[72:75], v[40:43]
  s_cbranch_vccz FL_x_0_ok0
  s_branch FL_x_0_x0
FL_x_03_c0:
  v_max3_u32 v31, v64, v65, v66
  v_max_u32 v31, v31, v67
  v_cmp_eq_u32 vcc, -1, v31
  s_cbranch_vccz FL_x_03_ok0
FL_x_03_x0:
  s_mov_b64 exec, vcc
  buffer_load_dwordx4 v[64:67], v9, s[4:7], s41 offen offset:0 sc1
  s_mov_b64 exec, -1
FL_x_03_c3:
  v_max3_u32 v31, v76, v77, v78
  v_max_u32 v31, v31, v79
  v_cmp_eq_u32 vcc, -1, v31
  s_cbranch_vccz FL_x_03_ok3
FL_x_03_x3:
  s_mov_b64 exec, vcc
  buffer_load_dwordx4 v[76:79], v9, s[4:7], s41 offen offset:3072 sc1
  s_mov_b64 exec, -1
  s_add_u32 s46, s46, 1
  s_cmp_ge_u32 s46, 131072
  s_cbranch_scc1 FL_rec_abort
  s_waitcnt vmcnt(4)
  s_branch FL_x_03_c0
FL_x_03_ok0:
  v_mfma_f32_16x16x32_bf16 v[44:47], v[64:67], v[64:67], v[44:47]
  v_max3_u32 v31, v76, v77, v78
  v_max_u32 v31, v31, v79
  v_cmp_eq_u32 vcc, -1, v31
  v_mfma_f32_16x16x32_bf16 v[36:39], v[116:119], v[64:67], v[36:39]
  v_mfma_f32_16x16x32_bf16 v[40:43], v[132:135], v[64:67], v[40:43]
  s_cbranch_vccz FL_x_3_ok3
  s_branch FL_x_3_x3
FL_x_03_ok3:
  v_mfma_f32_16x16x32_bf16 v[44:47], v[76:79], v[76:79], v[44:47]
  v_max3_u32 v31, v64, v65, v66
  v_max_u32 v31, v31, v67
  v_cmp_eq_u32 vcc, -1, v31
  v_mfma_f32_16x16x32_bf16 v[36:39], v[128:131], v[76:79], v[36:39]
  v_mfma_f32_16x16x32_bf16 v[40:43], v[144:147], v[76:79], v[40:43]
  s_cbranch_vccz FL_x_0_ok0
  s_branch FL_x_0_x0
FL_x_12_c1:
  v_max3_u32 v31, v68, v69, v70
  v_max_u32 v31, v31, v71
  v_cmp_eq_u32 vcc, -1, v31
  s_cbranch_vccz FL_x_12_ok1
FL_x_12_x1:
  s_mov_b64 exec, vcc
  buffer_load_dwordx4 v[68:71], v9, s[4:7], s41 offen offset:1024 sc1
  s_mov_b64 exec, -1
FL_x_12_c2:
  v_max3_u32 v31, v72, v73, v74
  v_max_u32 v31, v31, v75
  v_cmp_eq_u32 vcc, -1, v31
  s_cbranch_vccz FL_x_12_ok2
FL_x_12_x2:
  s_mov_b64 exec, vcc
  buffer_load_dwordx4 v[72:75], v9, s[4:7], s41 offen offset:2048 sc1
  s_mov_b64 exec, -1
  s_add_u32 s46, s46, 1
  s_cmp_ge_u32 s46, 131072
  s_cbranch_scc1 FL_rec_abort
  s_waitcnt vmcnt(4)
  s_branch FL_x_12_c1
FL_x_12_ok1:
  v_mfma_f32_16x16x32_bf16 v[44:47], v[68:71], v[68:71], v[44:47]
  v_max3_u32 v31, v72, v73, v74
  v_max_u32 v31, v31, v75
  v_cmp_eq_u32 vcc, -1, v31
  v_mfma_f32_16x16x32_bf16 v[36:39], v[120:123], v[68:71], v[36:39]
  v_mfma_f32_16x16x32_bf16 v[40:43], v[136:139], v[68:71], v[40:43]
  s_cbranch_vccz FL_x_2_ok2
  s_branch FL_x_2_x2
FL_x_12_ok2:
  v_mfma_f32_16x16x32_bf16 v[44:47], v[72:75], v[72:75], v[44:47]
  v_max3_u32 v31, v68, v69, v70
  v_max_u32 v31, v31, v71
  v_cmp_eq_u32 vcc, -1, v31
  v_mfma_f32_16x16x32_bf16 v[36:39], v[124:127], v[72:75], v[36:39]
  v_mfma_f32_16x16x32_bf16 v[40:43], v[140:143], v[72:75], v[40:43]
  s_cbranch_vccz FL_x_1_ok1
  s_branch FL_x_1_x1
FL_x_13_c1:
  v_max3_u32 v31, v68, v69, v70
  v_max_u32 v31, v31, v71
  v_cmp_eq_u32 vcc, -1, v31
  s_cbranch_vccz FL_x_13_ok1
FL_x_13_x1:
  s_mov_b64 exec, vcc
  buffer_load_dwordx4 v[68:71], v9, s[4:7], s41 offen offset:1024 sc1
  s_mov_b64 exec, -1
FL_x_13_c3:
  v_max3_u32 v31, v76, v77, v78
  v_max_u32 v31, v31, v79
  v_cmp_eq_u32 vcc, -1, v31
  s_cbranch_vccz FL_x_13_ok3
FL_x_13_x3:
  s_mov_b64 exec, vcc
  buffer_load_dwordx4 v[76:79], v9, s[4:7], s41 offen offset:3072 sc1
  s_mov_b64 exec, -1
  s_add_u32 s46, s46, 1
  s_cmp_ge_u32 s46, 131072
  s_cbranch_scc1 FL_rec_abort
  s_waitcnt vmcnt(4)
  s_branch FL_x_13_c1
FL_x_13_ok1:
  v_mfma_f32_16x16x32_bf16 v[44:47], v[68:71], v[68:71], v[44:47]
  v_max3_u32 v31, v76, v77, v78
  v_max_u32 v31, v31, v79
  v_cmp_eq_u32 vcc, -1, v31
  v_mfma_f32_16x16x32_bf16 v[36:39], v[120:123], v[68:71], v[36:39]
  v_mfma_f32_16x16x32_bf16 v[40:43], v[136:139], v[68:71], v[40:43]
  s_cbranch_vccz FL_x_3_ok3
  s_branch FL_x_3_x3
FL_x_13_ok3:
  v_mfma_f32_16x16x32_bf16 v[44:47], v[76:79], v[76:79], v[44:47]
  v_max3_u32 v31, v68, v69, v70
  v_max_u32 v31, v31, v71
  v_cmp_eq_u32 vcc, -1, v31
  v_mfma_f32_16x16x32_bf16 v[36:39], v[128:131], v[76:79], v[36:39]
  v_mfma_f32_16x16x32_bf16 v[40:43], v[144:147], v[76:79], v[40:43]
  s_cbranch_vccz FL_x_1_ok1
  s_branch FL_x_1_x1
FL_x_23_c2:
  v_max3_u32 v31, v72, v73, v74
  v_max_u32 v31, v31, v75
  v_cmp_eq_u32 vcc, -1, v31
  s_cbranch_vccz FL_x_23_ok2
FL_x_23_x2:
  s_mov_b64 exec, vcc
  buffer_load_dwordx4 v[72:75], v9, s[4:7], s41 offen offset:2048 sc1
  s_mov_b64 exec, -1
FL_x_23_c3:
  v_max3_u32 v31, v76, v77, v78
  v_max_u32 v31, v31, v79
  v_cmp_eq_u32 vcc, -1, v31
  s_cbranch_vccz FL_x_23_ok3
FL_x_23_x3:
  s_mov_b64 exec, vcc
  buffer_load_dwordx4 v[76:79], v9, s[4:7], s41 offen offset:3072 sc1
  s_mov_b64 exec, -1
  s_add_u32 s46, s46, 1
  s_cmp_ge_u32 s46, 131072
  s_cbranch_scc1 FL_rec_abort
  s_waitcnt vmcnt(4)
  s_branch FL_x_23_c2
FL_x_23_ok2:
  v_mfma_f32_16x16x32_bf16 v[44:47], v[72:75], v[72:75], v[44:47]
  v_max3_u32 v31, v76, v77, v78
  v_max_u32 v31, v31, v79
  v_cmp_eq_u32 vcc, -1, v31
  v_mfma_f32_16x16x32_bf16 v[36:39], v[124:127], v[72:75], v[36:39]
  v_mfma_f32_16x16x32_bf16 v[40:43], v[140:143], v[72:75], v[40:43]
  s_cbranch_vccz FL_x_3_ok3
  s_branch FL_x_3_x3
FL_x_23_ok3:
  v_mfma_f32_16x16x32_bf16 v[44:47], v[76:79], v[76:79], v[44:47]
  v_max3_u32 v31, v72, v73, v74
  v_max_u32 v31, v31, v75
  v_cmp_eq_u32 vcc, -1, v31
  v_mfma_f32_16x16x32_bf16 v[36:39], v[128:131], v[76:79], v[36:39]
  v_mfma_f32_16x16x32_bf16 v[40:43], v[144:147], v[76:79], v[40:43]
  s_cbranch_vccz FL_x_2_ok2
  s_branch FL_x_2_x2
FL_x_012_c0:
  v_max3_u32 v31, v64, v65, v66
  v_max_u32 v31, v31, v67
  v_cmp_eq_u32 vcc, -1, v31
  s_cbranch_vccz FL_x_012_ok0
FL_x_012_x0:
  s_mov_b64 exec, vcc
  buffer_load_dwordx4 v[64:67], v9, s[4:7], s41 offen offset:0 sc1
  s_mov_b64 exec, -1
FL_x_012_c1:
  v_max3_u32 v31, v68, v69, v70
  v_max_u32 v31, v31, v71
  v_cmp_eq_u32 vcc, -1, v31
  s_cbranch_vccz FL_x_012_ok1
FL_x_012_x1:
  s_mov_b64 exec, vcc
  buffer_load_dwordx4 v[68:71], v9, s[4:7], s41 offen offset:1024 sc1
  s_mov_b64 exec, -1
FL_x_012_c2:
  v_max3_u32 v31, v72, v73, v74
  v_max_u32 v31, v31, v75
  v_cmp_eq_u32 vcc, -1, v31
  s_cbranch_vccz FL_x_012_ok2
FL_x_012_x2:
  s_mov_b64 exec, vcc
  buffer_load_dwordx4 v[72:75], v9, s[4:7], s41 offen offset:2048 sc1
  s_mov_b64 exec, -1
  s_add_u32 s46, s46, 1
  s_cmp_ge_u32 s46, 131072
  s_cbranch_scc1 FL_rec_abort
  s_waitcnt vmcnt(4)
  s_branch FL_x_012_c0
FL_x_012_ok0:
  v_mfma_f32_16x16x32_bf16 v[44:47], v[64:67], v[64:67], v[44:47]
  v_max3_u32 v31, v68, v69, v70
  v_max_u32 v31, v31, v71
  v_cmp_eq_u32 vcc, -1, v31
  v_mfma_f32_16x16x32_bf16 v[36:39], v[116:119], v[64:67], v[36:39]
  v_mfma_f32_16x16x32_bf16 v[40:43], v[132:135], v[64:67], v[40:43]
  s_cbranch_vccz FL_x_12_ok1
  s_branch FL_x_12_x1
FL_x_012_ok1:
  v_mfma_f32_16x16x32_bf16 v[44:47], v[68:71], v[68:71], v[44:47]
  v_max3_u32 v31, v72, v73, v74
  v_max_u32 v31, v31, v75
  v_cmp_eq_u32 vcc, -1, v31
  v_mfma_f32_16x16x32_bf16 v[36:39], v[120:123], v[68:71], v[36:39]
  v_mfma_f32_16x16x32_bf16 v[40:43], v[136:139], v[68:71], v[40:43]
  s_cbranch_vccz FL_x_02_ok2
  s_branch FL_x_02_x2
FL_x_012_ok2:
  v_mfma_f32_16x16x32_bf16 v[44:47], v[72:75], v[72:75], v[44:47]
  v_max3_u32 v31, v64, v65, v66
  v_max_u32 v31, v31, v67
  v_cmp_eq_u32 vcc, -1, v31
  v_mfma_f32_16x16x32_bf16 v[36:39], v[124:127], v[72:75], v[36:39]
  v_mfma_f32_16x16x32_bf16 v[40:43], v[140:143], v[72:75], v[40:43]
  s_cbranch_vccz FL_x_01_ok0
  s_branch FL_x_01_x0
FL_x_013_c0:
  v_max3_u32 v31, v64, v65, v66
  v_max_u32 v31, v31, v67
  v_cmp_eq_u32 vcc, -1, v31
  s_cbranch_vccz FL_x_013_ok0
FL_x_013_x0:
  s_mov_b64 exec, vcc
  buffer_load_dwordx4 v[64:67], v9, s[4:7], s41 offen offset:0 sc1
  s_mov_b64 exec, -1
FL_x_013_c1:
  v_max3_u32 v31, v68, v69, v70
  v_max_u32 v31, v31, v71
  v_cmp_eq_u32 vcc, -1, v31
  s_cbranch_vccz FL_x_013_ok1
FL_x_013_x1:
  s_mov_b64 exec, vcc
  buffer_load_dwordx4 v[68:71], v9, s[4:7], s41 offen offset:1024 sc1
  s_mov_b64 exec, -1
FL_x_013_c3:
  v_max3_u32 v31, v76, v77, v78
  v_max_u32 v31, v31, v79
  v_cmp_eq_u32 vcc, -1, v31
  s_cbranch_vccz FL_x_013_ok3
FL_x_013_x3:
  s_mov_b64 exec, vcc
  buffer_load_dwordx4 v[76:79], v9, s[4:7], s41 offen offset:3072 sc1
  s_mov_b64 exec, -1
  s_add_u32 s46, s46, 1
  s_cmp_ge_u32 s46, 131072
  s_cbranch_scc1 FL_rec_abort
  s_waitcnt vmcnt(4)
  s_branch FL_x_013_c0
FL_x_013_ok0:
  v_mfma_f32_16x16x32_bf16 v[44:47], v[64:67], v[64:67], v[44:47]
  v_max3_u32 v31, v68, v69, v70
  v_max_u32 v31, v31, v71
  v_cmp_eq_u32 vcc, -1, v31
  v_mfma_f32_16x16x32_bf16 v[36:39], v[116:119], v[64:67], v[36:39]
  v_mfma_f32_16x16x32_bf16 v[40:43], v[132:135], v[64:67], v[40:43]
  s_cbranch_vccz FL_x_13_ok1
  s_branch FL_x_13_x1
FL_x_013_ok1:
  v_mfma_f32_16x16x32_bf16 v[44:47], v[68:71], v[68:71], v[44:47]
  v_max3_u32 v31, v76, v77, v78
  v_max_u32 v31, v31, v79
  v_cmp_eq_u32 vcc, -1, v31
  v_mfma_f32_16x16x32_bf16 v[36:39], v[120:123], v[68:71], v[36:39]
  v_mfma_f32_16x16x32_bf16 v[40:43], v[136:139], v[68:71], v[40:43]
  s_cbranch_vccz FL_x_03_ok3
  s_branch FL_x_03_x3
FL_x_013_ok3:
  v_mfma_f32_16x16x32_bf16 v[44:47], v[76:79], v[76:79], v[44:47]
  v_max3_u32 v31, v64, v65, v66
  v_max_u32 v31, v31, v67
  v_cmp_eq_u32 vcc, -1, v31
  v_mfma_f32_16x16x32_bf16 v[36:39], v[128:131], v[76:79], v[36:39]
  v_mfma_f32_16x16x32_bf16 v[40:43], v[144:147], v[76:79], v[40:43]
  s_cbranch_vccz FL_x_01_ok0
  s_branch FL_x_01_x0
FL_x_023_c0:
  v_max3_u32 v31, v64, v65, v66
  v_max_u32 v31, v31, v67
  v_cmp_eq_u32 vcc, -1, v31
  s_cbranch_vccz FL_x_023_ok0
FL_x_023_x0:
  s_mov_b64 exec, vcc
  buffer_load_dwordx4 v[64:67], v9, s[4:7], s41 offen offset:0 sc1
  s_mov_b64 exec, -1
FL_x_023_c2:
  v_max3_u32 v31, v72, v73, v74
  v_max_u32 v31, v31, v75
  v_cmp_eq_u32 vcc, -1, v31
  s_cbranch_vccz FL_x_023_ok2
FL_x_023_x2:
  s_mov_b64 exec, vcc
  buffer_load_dwordx4 v[72:75], v9, s[4:7], s41 offen offset:2048 sc1
  s_mov_b64 exec, -1
FL_x_023_c3:
  v_max3_u32 v31, v76, v77, v78
  v_max_u32 v31, v31, v79
  v_cmp_eq_u32 vcc, -1, v31
  s_cbranch_vccz FL_x_023_ok3
FL_x_023_x3:
  s_mov_b64 exec, vcc
  buffer_load_dwordx4 v[76:79], v9, s[4:7], s41 offen offset:3072 sc1
  s_mov_b64 exec, -1
  s_add_u32 s46, s46, 1
  s_cmp_ge_u32 s46, 131072
  s_cbranch_scc1 FL_rec_abort
  s_waitcnt vmcnt(4)
  s_branch FL_x_023_c0
FL_x_023_ok0:
  v_mfma_f32_16x16x32_bf16 v[44:47], v[64:67], v[64:67], v[44:47]
  v_max3_u32 v31, v72, v73, v74
  v_max_u32 v31, v31, v75
  v_cmp_eq_u32 vcc, -1, v31
  v_mfma_f32_16x16x32_bf16 v[36:39], v[116:119], v[64:67], v[36:39]
  v_mfma_f32_16x16x32_bf16 v[40:43], v[132:135], v[64:67], v[40:43]
  s_cbranch_vccz FL_x_23_ok2
  s_branch FL_x_23_x2
FL_x_023_ok2:
  v_mfma_f32_16x16x32_bf16 v[44:47], v[72:75], v[72:75], v[44:47]
  v_max3_u32 v31, v76, v77, v78
  v_max_u32 v31, v31, v79
  v_cmp_eq_u32 vcc, -1, v31
  v_mfma_f32_16x16x32_bf16 v[36:39], v[124:127], v[72:75], v[36:39]
  v_mfma_f32_16x16x32_bf16 v[40:43], v[140:143], v[72:75], v[40:43]
  s_cbranch_vccz FL_x_03_ok3
  s_branch FL_x_03_x3
FL_x_023_ok3:
  v_mfma_f32_16x16x32_bf16 v[44:47], v[76:79], v[76:79], v[44:47]
  v_max3_u32 v31, v64, v65, v66
  v_max_u32 v31, v31, v67
  v_cmp_eq_u32 vcc, -1, v31
  v_mfma_f32_16x16x32_bf16 v[36:39], v[128:131], v[76:79], v[36:39]
  v_mfma_f32_16x16x32_bf16 v[40:43], v[144:147], v[76:79], v[40:43]
  s_cbranch_vccz FL_x_02_ok0
  s_branch FL_x_02_x0
FL_x_123_c1:
  v_max3_u32 v31, v68, v69, v70
  v_max_u32 v31, v31, v71
  v_cmp_eq_u32 vcc, -1, v31
  s_cbranch_vccz FL_x_123_ok1
FL_x_123_x1:
  s_mov_b64 exec, vcc
  buffer_load_dwordx4 v[68:71], v9, s[4:7], s41 offen offset:1024 sc1
  s_mov_b64 exec, -1
FL_x_123_c2:
  v_max3_u32 v31, v72, v73, v74
  v_max_u32 v31, v31, v75
  v_cmp_eq_u32 vcc, -1, v31
  s_cbranch_vccz FL_x_123_ok2
FL_x_123_x2:
  s_mov_b64 exec, vcc
  buffer_load_dwordx4 v[72:75], v9, s[4:7], s41 offen offset:2048 sc1
  s_mov_b64 exec, -1
FL_x_123_c3:
  v_max3_u32 v31, v76, v77, v78
  v_max_u32 v31, v31, v79
  v_cmp_eq_u32 vcc, -1, v31
  s_cbranch_vccz FL_x_123_ok3
FL_x_123_x3:
  s_mov_b64 exec, vcc
  buffer_load_dwordx4 v[76:79], v9, s[4:7], s41 offen offset:3072 sc1
  s_mov_b64 exec, -1
  s_add_u32 s46, s46, 1
  s_cmp_ge_u32 s46, 131072
  s_cbranch_scc1 FL_rec_abort
  s_waitcnt vmcnt(4)
  s_branch FL_x_123_c1
FL_x_123_ok1:
  v_mfma_f32_16x16x32_bf16 v[44:47], v[68:71], v[68:71], v[44:47]
  v_max3_u32 v31, v72, v73, v74
  v_max_u32 v31, v31, v75
  v_cmp_eq_u32 vcc, -1, v31
  v_mfma_f32_16x16x32_bf16 v[36:39], v[120:123], v[68:71], v[36:39]
  v_mfma_f32_16x16x32_bf16 v[40:43], v[136:139], v[68:71], v[40:43]
  s_cbranch_vccz FL_x_23_ok2
  s_branch FL_x_23_x2
FL_x_123_ok2:
  v_mfma_f32_16x16x32_bf16 v[44:47], v[72:75], v[72:75], v[44:47]
  v_max3_u32 v31, v76, v77, v78
  v_max_u32 v31, v31, v79
  v_cmp_eq_u32 vcc, -1, v31
  v_mfma_f32_16x16x32_bf16 v[36:39], v[124:127], v[72:75], v[36:39]
  v_mfma_f32_16x16x32_bf16 v[40:43], v[140:143], v[72:75], v[40:43]
  s_cbranch_vccz FL_x_13_ok3
  s_branch FL_x_13_x3
FL_x_123_ok3:
  v_mfma_f32_16x16x32_bf16 v[44:47], v[76:79], v[76:79], v[44:47]
  v_max3_u32 v31, v68, v69, v70
  v_max_u32 v31, v31, v71
  v_cmp_eq_u32 vcc, -1, v31
  v_mfma_f32_16x16x32_bf16 v[36:39], v[128:131], v[76:79], v[36:39]
  v_mfma_f32_16x16x32_bf16 v[40:43], v[144:147], v[76:79], v[40:43]
  s_cbranch_vccz FL_x_12_ok1
  s_branch FL_x_12_x1
FL_x_0123_c0:
  v_max3_u32 v31, v64, v65, v66
  v_max_u32 v31, v31, v67
  v_cmp_eq_u32 vcc, -1, v31
  s_cbranch_vccz FL_x_0123_ok0
FL_x_0123_x0:
  s_mov_b64 exec, vcc
  buffer_load_dwordx4 v[64:67], v9, s[4:7], s41 offen offset:0 sc1
  s_mov_b64 exec, -1
FL_x_0123_c1:
  v_max3_u32 v31, v68, v69, v70
  v_max_u32 v31, v31, v71
  v_cmp_eq_u32 vcc, -1, v31
  s_cbranch_vccz FL_x_0123_ok1
FL_x_0123_x1:
  s_mov_b64 exec, vcc
  buffer_load_dwordx4 v[68:71], v9, s[4:7], s41 offen offset:1024 sc1
  s_mov_b64 exec, -1
FL_x_0123_c2:
  v_max3_u32 v31, v72, v73, v74
  v_max_u32 v31, v31, v75
  v_cmp_eq_u32 vcc, -1, v31
  s_cbranch_vccz FL_x_0123_ok2
FL_x_0123_x2:
  s_mov_b64 exec, vcc
  buffer_load_dwordx4 v[72:75], v9, s[4:7], s41 offen offset:2048 sc1
  s_mov_b64 exec, -1
FL_x_0123_c3:
  v_max3_u32 v31, v76, v77, v78
  v_max_u32 v31, v31, v79
  v_cmp_eq_u32 vcc, -1, v31
  s_cbranch_vccz FL_x_0123_ok3
FL_x_0123_x3:
  s_mov_b64 exec, vcc
  buffer_load_dwordx4 v[76:79], v9, s[4:7], s41 offen offset:3072 sc1
  s_mov_b64 exec, -1
  s_add_u32 s46, s46, 1
  s_cmp_ge_u32 s46, 131072
  s_cbranch_scc1 FL_rec_abort
  s_waitcnt vmcnt(4)
  s_branch FL_x_0123_c0
FL_x_0123_ok0:
  v_mfma_f32_16x16x32_bf16 v[44:47], v[64:67], v[64:67], v[44:47]
  v_max3_u32 v31, v68, v69, v70
  v_max_u32 v31, v31, v71
  v_cmp_eq_u32 vcc, -1, v31
  v_mfma_f32_16x16x32_bf16 v[36:39], v[116:119], v[64:67], v[36:39]
  v_mfma_f32_16x16x32_bf16 v[40:43], v[132:135], v[64:67], v[40:43]
  s_cbranch_vccz FL_x_123_ok1
  s_branch FL_x_123_x1
FL_x_0123_ok1:
  v_mfma_f32_16x16x32_bf16 v[44:47], v[68:71], v[68:71], v[44:47]
  v_max3_u32 v31, v72, v73, v74
  v_max_u32 v31, v31, v75
  v_cmp_eq_u32 vcc, -1, v31
  v_mfma_f32_16x16x32_bf16 v[36:39], v[120:123], v[68:71], v[36:39]
  v_mfma_f32_16x16x32_bf16 v[40:43], v[136:139], v[68:71], v[40:43]
  s_cbranch_vccz FL_x_023_ok2
  s_branch FL_x_023_x2
FL_x_0123_ok2:
  v_mfma_f32_16x16x32_bf16 v[44:47], v[72:75], v[72:75], v[44:47]
  v_max3_u32 v31, v76, v77, v78
  v_max_u32 v31, v31, v79
  v_cmp_eq_u32 vcc, -1, v31
  v_mfma_f32_16x16x32_bf16 v[36:39], v[124:127], v[72:75], v[36:39]
  v_mfma_f32_16x16x32_bf16 v[40:43], v[140:143], v[72:75], v[40:43]
  s_cbranch_vccz FL_x_013_ok3
  s_branch FL_x_013_x3
FL_x_0123_ok3:
  v_mfma_f32_16x16x32_bf16 v[44:47], v[76:79], v[76:79], v[44:47]
  v_max3_u32 v31, v64, v65, v66
  v_max_u32 v31, v31, v67
  v_cmp_eq_u32 vcc, -1, v31
  v_mfma_f32_16x16x32_bf16 v[36:39], v[128:131], v[76:79], v[36:39]
  v_mfma_f32_16x16x32_bf16 v[40:43], v[144:147], v[76:79], v[40:43]
  s_cbranch_vccz FL_x_012_ok0
  s_branch FL_x_012_x0
FL_v_f:
  buffer_load_dwordx4 v[88:91], v10, s[4:7], s41 offen offset:0 sc1
  buffer_load_dwordx4 v[92:95], v10, s[4:7], s41 offen offset:1024 sc1
  s_add_u32 s46, s46, 1
  s_cmp_ge_u32 s46, 131072
  s_cbranch_scc1 FL_rec_abort
  s_waitcnt vmcnt(0)
  v_max3_u32 v31, v88, v89, v90
  v_max3_u32 v31, v31, v91, v92
  v_max3_u32 v31, v31, v93, v94
  v_max_u32 v31, v31, v95
  v_cmp_eq_u32 vcc, -1, v31
  s_cbranch_vccnz FL_v_f
  s_branch FL_v_ok
FL_rec_abort:
  s_waitcnt vmcnt(0)
  s_endpgm
L_recslow:
  s_load_dwordx4 s[80:83], s[0:1], 8
  s_load_dwordx4 s[84:87], s[0:1], 24
  s_load_dwordx2 s[88:89], s[0:1], 40
  v_lshrrev_b32 v31, 6, v0
  s_nop 0
  v_readfirstlane_b32 s32, v31
  v_and_b32 v0, 63, v0
  s_lshr_b32 s35, s34, 4
  s_lshl_b32 s90, s33, 1
  s_add_u32 s35, s35, s90
  s_and_b32 s36, s34, 15
  s_lshr_b32 s37, s36, 2
  s_lshl_b32 s90, s35, 2
  s_add_u32 s37, s37, s90
  s_and_b32 s38, s36, 3
  s_waitcnt lgkmcnt(0)
  s_mov_b32 s24, s80
  s_and_b32 s25, s81, 0xffff
  s_mov_b32 s26, 0x4000
  s_mov_b32 s27, 0x20000
  s_mov_b32 s8, s82
  s_and_b32 s9, s83, 0xffff
  s_mov_b32 s10, 0x800000
  s_mov_b32 s11, 0x20000
  s_mov_b32 s12, s84
  s_and_b32 s13, s85, 0xffff
  s_mov_b32 s14, 0x800000
  s_mov_b32 s15, 0x20000
  s_mov_b32 s16, s86
  s_and_b32 s17, s87, 0xffff
  s_mov_b32 s18, 0x800000
  s_mov_b32 s19, 0x20000
  s_mov_b32 s20, s88
  s_and_b32 s21, s89, 0xffff
  s_mov_b32 s22, 0x800000
  s_mov_b32 s23, 0x20000
  s_lshl_b32 s90, s32, 21
  s_lshl_b32 s91, s37, 8
  s_add_u32 s90, s90, s91
  s_lshr_b32 s91, s38, 1
  s_lshl_b32 s91, s91, 7
  s_add_u32 s90, s90, s91
  v_mov_b32 v180, 0x0
  v_bfe_u32 v31, v0, 3, 3
  v_lshl_add_u32 v180, v31, 13, v180
  v_bfe_u32 v31, v0, 0, 3
  v_lshl_add_u32 v180, v31, 4, v180
  v_add_u32 v180, s90, v180
  v_xor_b32 v185, 128, v180
  s_lshl_b32 s90, s35, 2
  s_add_u32 s90, s90, s32
  s_lshl_b32 s90, s90, 18
  s_lshl_b32 s91, s36, 7
  s_add_u32 s90, s90, s91
  v_mov_b32 v181, 0x0
  v_bfe_u32 v31, v0, 3, 3
  v_lshl_add_u32 v181, v31, 11, v181
  v_bfe_u32 v31, v0, 0, 3
  v_lshl_add_u32 v181, v31, 4, v181
  v_add_u32 v181, s90, v181
  s_lshl_b32 s96, s32, 15
  s_and_b32 s91, s38, 1
  s_lshl_b32 s91, s91, 6
  s_add_u32 s91, s91, s96
  v_mov_b32 v182, 0x0
  v_bfe_u32 v31, v0, 5, 1
  v_lshl_add_u32 v182, v31, 11, v182
  v_bfe_u32 v31, v0, 4, 1
  v_lshl_add_u32 v182, v31, 10, v182
  v_bfe_u32 v31, v0, 2, 2
  v_lshl_add_u32 v182, v31, 7, v182
  v_bfe_u32 v31, v0, 0, 2
  v_lshl_add_u32 v182, v31, 3, v182
  v_add_u32 v182, s91, v182
  s_lshl_b32 s91, s32, 5
  v_mov_b32 v183, 0x0
  v_bfe_u32 v31, v0, 4, 1
  v_lshl_add_u32 v183, v31, 13, v183
  v_bfe_u32 v31, v0, 5, 1
  v_lshl_add_u32 v183, v31, 8, v183
  v_bfe_u32 v31, v0, 2, 1
  v_lshl_add_u32 v183, v31, 10, v183
  v_bfe_u32 v31, v0, 3, 1
  v_lshl_add_u32 v183, v31, 7, v183
  v_bfe_u32 v31, v0, 0, 2
  v_lshl_add_u32 v183, v31, 3, v183
  v_add_u32 v183, s91, v183
  v_add_u32 v184, 0x10000, v183
  s_lshl_b32 s97, s34, 2
  s_add_u32 s97, s97, s32
  s_lshl_b32 s98, s97, 14
  s_lshl_b32 s91, s33, 21
  s_add_u32 s98, s98, s91
  s_lshl_b32 s97, s97, 16
  s_lshl_b32 s91, s33, 11
  s_add_u32 s97, s97, s91
  v_mov_b32 v16, 0x0
  v_bfe_u32 v31, v0, 0, 4
  v_lshl_add_u32 v16, v31, 7, v16
  v_bfe_u32 v31, v0, 4, 2
  v_lshl_add_u32 v16, v31, 13, v16
  v_add_u32 v17, 0x8000, v16
  v_lshlrev_b32 v18, 7, v0
  v_add_u32 v19, 0x2000, v18
  s_lshl_b32 s97, s34, 2
  s_add_u32 s97, s97, s32
  s_lshl_b32 s98, s97, 14
  s_lshl_b32 s91, s33, 21
  s_add_u32 s98, s98, s91
  s_lshl_b32 s97, s97, 16
  s_lshl_b32 s91, s33, 11
  s_add_u32 s97, s97, s91
  v_mov_b32 v16, 0x180
  v_bfe_u32 v31, v0, 0, 1
  v_lshl_add_u32 v16, v31, 10, v16
  v_bfe_u32 v31, v0, 1, 3
  v_lshl_add_u32 v16, v31, 13, v16
  v_mov_b32 v17, 0x180
  v_bfe_u32 v31, v0, 0, 4
  v_lshl_add_u32 v17, v31, 10, v17
  s_mov_b64 exec, 0xffff
  buffer_load_dword v201, v16, s[12:15], s97 offen
  buffer_load_dword v202, v16, s[16:19], s97 offen
  buffer_load_dword v200, v16, s[8:11], s97 offen
  buffer_load_dword v203, v17, s[20:23], s98 offen
  s_mov_b64 exec, -1
  s_lshl_b32 s58, s33, 5
  s_add_u32 s58, s58, s34
  s_lshl_b32 s59, s32, 19
  s_add_u32 s59, s59, 0x3800000
  s_lshl_b32 s90, s58, 11
  s_add_u32 s90, s90, s59
  s_mul_i32 s91, s58, 3072
  s_add_u32 s91, s91, s59
  s_add_u32 s91, s91, 0x200000
  v_lshlrev_b32 v6, 4, v0
  v_mov_b32 v8, -1
  v_mov_b32 v12, 0
  v_mov_b32 v9, -1
  v_mov_b32 v13, 0
  v_mov_b32 v10, -1
  v_mov_b32 v14, 0
  v_mov_b32 v11, -1
  v_mov_b32 v15, 0
  buffer_store_dwordx4 v[8:11], v6, s[4:7], s90 offen offset:0 sc1
  buffer_store_dwordx4 v[8:11], v6, s[4:7], s90 offen offset:1024 sc1
  buffer_store_dwordx4 v[8:11], v6, s[4:7], s91 offen offset:0 sc1
  buffer_store_dwordx4 v[8:11], v6, s[4:7], s91 offen offset:1024 sc1
  buffer_store_dwordx4 v[8:11], v6, s[4:7], s91 offen offset:2048 sc1
  s_lshl_b32 s58, s58, 2
  s_add_u32 s58, s58, s32
  s_cmp_ge_u32 s58, 36
  s_cbranch_scc1 SL_nz_1
  s_lshl_b32 s90, s58, 10
  s_add_u32 s90, s90, 0x3d00000
  buffer_store_dwordx4 v[12:15], v6, s[4:7], s90 offen sc1
SL_nz_1:
  s_add_u32 m0, s96, 0
  s_mov_b32 s90, 0x0
  buffer_load_dwordx4 v180, s[12:15], s90 offen  lds
  s_add_u32 m0, s96, 1024
  s_mov_b32 s90, 0x10000
  buffer_load_dwordx4 v180, s[12:15], s90 offen  lds
  s_add_u32 m0, s96, 2048
  s_mov_b32 s90, 0x20000
  buffer_load_dwordx4 v180, s[12:15], s90 offen  lds
  s_add_u32 m0, s96, 3072
  s_mov_b32 s90, 0x30000
  buffer_load_dwordx4 v180, s[12:15], s90 offen  lds
  s_add_u32 m0, s96, 4096
  s_mov_b32 s90, 0x0
  buffer_load_dwordx4 v185, s[16:19], s90 offen  lds
  s_add_u32 m0, s96, 5120
  s_mov_b32 s90, 0x10000
  buffer_load_dwordx4 v185, s[16:19], s90 offen  lds
  s_add_u32 m0, s96, 6144
  s_mov_b32 s90, 0x20000
  buffer_load_dwordx4 v185, s[16:19], s90 offen  lds
  s_add_u32 m0, s96, 7168
  s_mov_b32 s90, 0x30000
  buffer_load_dwordx4 v185, s[16:19], s90 offen  lds
  s_add_u32 m0, s96, 8192
  s_mov_b32 s90, 0x40000
  buffer_load_dwordx4 v180, s[12:15], s90 offen  lds
  s_add_u32 m0, s96, 9216
  s_mov_b32 s90, 0x50000
  buffer_load_dwordx4 v180, s[12:15], s90 offen  lds
  s_add_u32 m0, s96, 10240
  s_mov_b32 s90, 0x60000
  buffer_load_dwordx4 v180, s[12:15], s90 offen  lds
  s_add_u32 m0, s96, 11264
  s_mov_b32 s90, 0x70000
  buffer_load_dwordx4 v180, s[12:15], s90 offen  lds
  s_add_u32 m0, s96, 12288
  s_mov_b32 s90, 0x40000
  buffer_load_dwordx4 v185, s[16:19], s90 offen  lds
  s_add_u32 m0, s96, 13312
  s_mov_b32 s90, 0x50000
  buffer_load_dwordx4 v185, s[16:19], s90 offen  lds
  s_add_u32 m0, s96, 14336
  s_mov_b32 s90, 0x60000
  buffer_load_dwordx4 v185, s[16:19], s90 offen  lds
  s_add_u32 m0, s96, 15360
  s_mov_b32 s90, 0x70000
  buffer_load_dwordx4 v185, s[16:19], s90 offen  lds
  s_add_u32 m0, s96, 16384
  s_mov_b32 s90, 0x80000
  buffer_load_dwordx4 v180, s[12:15], s90 offen  lds
  s_add_u32 m0, s96, 17408
  s_mov_b32 s90, 0x90000
  buffer_load_dwordx4 v180, s[12:15], s90 offen  lds
  s_add_u32 m0, s96, 18432
  s_mov_b32 s90, 0xa0000
  buffer_load_dwordx4 v180, s[12:15], s90 offen  lds
  s_add_u32 m0, s96, 19456
  s_mov_b32 s90, 0xb0000
  buffer_load_dwordx4 v180, s[12:15], s90 offen  lds
  s_add_u32 m0, s96, 20480
  s_mov_b32 s90, 0x80000
  buffer_load_dwordx4 v185, s[16:19], s90 offen  lds
  s_add_u32 m0, s96, 21504
  s_mov_b32 s90, 0x90000
  buffer_load_dwordx4 v185, s[16:19], s90 offen  lds
  s_add_u32 m0, s96, 22528
  s_mov_b32 s90, 0xa0000
  buffer_load_dwordx4 v185, s[16:19], s90 offen  lds
  s_add_u32 m0, s96, 23552
  s_mov_b32 s90, 0xb0000
  buffer_load_dwordx4 v185, s[16:19], s90 offen  lds
  s_add_u32 m0, s96, 24576
  s_mov_b32 s90, 0xc0000
  buffer_load_dwordx4 v180, s[12:15], s90 offen  lds
  s_add_u32 m0, s96, 25600
  s_mov_b32 s90, 0xd0000
  buffer_load_dwordx4 v180, s[12:15], s90 offen  lds
  s_add_u32 m0, s96, 26624
  s_mov_b32 s90, 0xe0000
  buffer_load_dwordx4 v180, s[12:15], s90 offen  lds
  s_add_u32 m0, s96, 27648
  s_mov_b32 s90, 0xf0000
  buffer_load_dwordx4 v180, s[12:15], s90 offen  lds
  s_add_u32 m0, s96, 28672
  s_mov_b32 s90, 0xc0000
  buffer_load_dwordx4 v185, s[16:19], s90 offen  lds
  s_add_u32 m0, s96, 29696
  s_mov_b32 s90, 0xd0000
  buffer_load_dwordx4 v185, s[16:19], s90 offen  lds
  s_add_u32 m0, s96, 30720
  s_mov_b32 s90, 0xe0000
  buffer_load_dwordx4 v185, s[16:19], s90 offen  lds
  s_add_u32 m0, s96, 31744
  s_mov_b32 s90, 0xf0000
  buffer_load_dwordx4 v185, s[16:19], s90 offen  lds
  s_lshl_b32 s90, s34, 2
  s_add_u32 s90, s90, s32
  s_lshr_b32 s91, s90, 3
  s_lshl_b32 s91, s91, 14
  s_and_b32 s92, s90, 7
  s_lshl_b32 s92, s92, 10
  s_add_u32 s91, s91, s92
  v_mov_b32 v1, 0x0
  v_bfe_u32 v31, v0, 0, 6
  v_lshl_add_u32 v1, v31, 4, v1
  v_add_u32 v1, s91, v1
  v_lshrrev_b32 v30, 4, v0
  v_cmp_eq_u32 vcc, s33, v30
  v_xor_b32 v29, 0x2000, v1
  s_nop 0
  v_cndmask_b32 v1, v1, v29, vcc
  s_lshl_b32 s91, s33, 14
  s_lshl_b32 s92, s90, 7
  s_add_u32 s91, s91, s92
  v_mov_b32 v2, 0x200000
  v_bfe_u32 v31, v0, 0, 2
  v_lshl_add_u32 v2, v31, 2, v2
  v_bfe_u32 v31, v0, 2, 1
  v_lshl_add_u32 v2, v31, 6, v2
  v_bfe_u32 v31, v0, 4, 1
  v_lshl_add_u32 v2, v31, 4, v2
  v_bfe_u32 v31, v0, 5, 1
  v_lshl_add_u32 v2, v31, 5, v2
  v_bfe_u32 v31, v0, 3, 1
  v_lshl_add_u32 v2, v31, 31, v2
  v_add_u32 v2, s91, v2
  s_lshr_b32 s92, s90, 1
  s_lshl_b32 s92, s92, 5
  s_and_b32 s91, s90, 1
  s_lshl_b32 s91, s91, 13
  s_add_u32 s92, s92, s91
  v_mov_b32 v30, 0x0
  v_bfe_u32 v31, v0, 2, 1
  v_lshl_add_u32 v30, v31, 12, v30
  v_bfe_u32 v31, v0, 4, 1
  v_lshl_add_u32 v30, v31, 11, v30
  v_bfe_u32 v31, v0, 0, 2
  v_lshl_add_u32 v30, v31, 3, v30
  v_bfe_u32 v31, v0, 5, 1
  v_lshl_add_u32 v30, v31, 2, v30
  v_add_u32 v30, s92, v30
  buffer_load_dword v44, v30, s[24:27], 0 offen
  s_lshl_b32 s91, s33, 14
  s_lshl_b32 s92, s32, 12
  s_add_u32 s91, s91, s92
  v_mov_b32 v3, 0x200000
  v_bfe_u32 v31, v0, 0, 6
  v_lshl_add_u32 v3, v31, 4, v3
  v_add_u32 v3, s91, v3
  s_mul_i32 s91, s32, 3264
  v_mov_b32 v4, 0x0
  v_bfe_u32 v31, v0, 0, 6
  v_lshl_add_u32 v4, v31, 4, v4
  v_add_u32 v4, s91, v4
  s_lshl_b32 s91, s32, 6
  v_mov_b32 v6, 0x0
  v_bfe_u32 v31, v0, 0, 2
  v_lshl_add_u32 v6, v31, 4, v6
  v_bfe_u32 v31, v0, 2, 1
  v_lshl_add_u32 v6, v31, 2, v6
  v_bfe_u32 v31, v0, 3, 1
  s_mov_b32 s99, 1088
  v_mad_u32_u24 v6, v31, s99, v6
  v_bfe_u32 v31, v0, 4, 2
  v_lshl_add_u32 v6, v31, 8, v6
  v_add_u32 v6, s91, v6
  v_add_u32 v240, 3264, v6
  v_add_u32 v241, 6528, v6
  v_add_u32 v242, 9792, v6
  s_lshl_b32 s93, s37, 13
  s_lshl_b32 s91, s38, 10
  s_add_u32 s91, s91, s93
  s_lshl_b32 s92, s32, 8
  s_add_u32 s91, s91, s92
  v_mov_b32 v7, 0x210000
  v_bfe_u32 v31, v0, 0, 6
  v_lshl_add_u32 v7, v31, 2, v7
  v_add_u32 v7, s91, v7
  s_lshl_b32 s91, s37, 11
  s_lshl_b32 s92, s38, 9
  s_add_u32 s59, s91, s92
  s_lshl_b32 s92, s32, 7
  s_add_u32 s91, s59, s92
  v_mov_b32 v19, 0x83000000
  v_bfe_u32 v31, v0, 0, 3
  v_lshl_add_u32 v19, v31, 2, v19
  v_bfe_u32 v31, v0, 4, 2
  v_lshl_add_u32 v19, v31, 5, v19
  v_bfe_u32 v31, v0, 3, 1
  v_lshl_add_u32 v19, v31, 31, v19
  v_add_u32 v19, s91, v19
  s_lshl_b32 s91, s32, 8
  v_mov_b32 v5, 0x880
  v_bfe_u32 v31, v0, 0, 1
  v_lshl_add_u32 v5, v31, 7, v5
  v_bfe_u32 v31, v0, 1, 1
  v_lshl_add_u32 v5, v31, 3, v5
  v_bfe_u32 v31, v0, 2, 3
  v_lshl_add_u32 v5, v31, 4, v5
  v_add_u32 v5, s91, v5
  s_lshr_b32 s92, s38, 1
  s_xor_b32 s92, s92, 1
  s_lshl_b32 s92, s92, 10
  s_add_u32 s91, s91, s92
  s_add_u32 s91, s91, s93
  s_and_b32 s92, s38, 1
  s_lshl_b32 s92, s92, 7
  s_add_u32 s91, s91, s92
  v_mov_b32 v8, 0x211000
  v_bfe_u32 v31, v0, 0, 5
  v_lshl_add_u32 v8, v31, 2, v8
  v_bfe_u32 v31, v0, 5, 1
  v_lshl_add_u32 v8, v31, 31, v8
  v_add_u32 v8, s91, v8
  s_sub_u32 s91, s91, s93
  s_lshl_b32 s92, s37, 11
  s_add_u32 s91, s91, s92
  v_mov_b32 v20, 0x3400000
  v_bfe_u32 v31, v0, 0, 5
  v_lshl_add_u32 v20, v31, 2, v20
  v_bfe_u32 v31, v0, 5, 1
  v_lshl_add_u32 v20, v31, 31, v20
  v_add_u32 v20, s91, v20
  s_lshl_b32 s97, s35, 2
  s_add_u32 s97, s97, s32
  s_lshl_b32 s97, s97, 13
  v_mov_b32 v9, 0x210000
  v_bfe_u32 v31, v0, 0, 6
  v_lshl_add_u32 v9, v31, 4, v9
  v_add_u32 v9, s97, v9
  v_add_u32 v10, 4096, v9
  v_mov_b32 v11, 0x1000000
  v_bfe_u32 v31, v0, 0, 2
  v_lshl_add_u32 v11, v31, 4, v11
  v_bfe_u32 v31, v0, 2, 1
  v_lshl_add_u32 v11, v31, 7, v11
  v_bfe_u32 v31, v0, 3, 1
  v_lshl_add_u32 v11, v31, 12, v11
  v_bfe_u32 v31, v0, 4, 2
  v_lshl_add_u32 v11, v31, 8, v11
  v_add_u32 v11, s97, v11
  v_mov_b32 v12, 0x2000000
  v_bfe_u32 v31, v0, 0, 3
  v_lshl_add_u32 v12, v31, 4, v12
  v_bfe_u32 v31, v0, 3, 1
  v_lshl_add_u32 v12, v31, 11, v12
  v_bfe_u32 v31, v0, 4, 2
  v_lshl_add_u32 v12, v31, 8, v12
  v_add_u32 v12, s97, v12
  v_add_u32 v13, 4096, v12
  s_lshl_b32 s91, s36, 9
  s_add_u32 s91, s91, s97
  s_add_u32 s63, s91, 0x1000000
  v_mov_b32 v21, 0x1000000
  v_bfe_u32 v31, v0, 0, 2
  v_lshl_add_u32 v21, v31, 7, v21
  v_bfe_u32 v31, v0, 2, 1
  v_lshl_add_u32 v21, v31, 24, v21
  v_add_u32 v21, s91, v21
  v_cmp_gt_u32 vcc, 8, v0
  v_mov_b32 v30, 0x80000000
  s_nop 0
  v_cndmask_b32 v21, v30, v21, vcc
  s_lshl_b32 s91, s32, 11
  v_mov_b32 v30, 0x0
  v_bfe_u32 v31, v0, 2, 1
  v_lshl_add_u32 v30, v31, 6, v30
  v_bfe_u32 v31, v0, 0, 1
  v_lshl_add_u32 v30, v31, 5, v30
  v_bfe_u32 v31, v0, 1, 1
  v_lshl_add_u32 v30, v31, 4, v30
  v_mov_b32 v29, 0x0
  v_bfe_u32 v31, v0, 4, 2
  v_lshl_add_u32 v29, v31, 5, v29
  v_xor_b32 v30, v30, v29
  v_mov_b32 v14, 0x3400
  v_bfe_u32 v31, v0, 0, 4
  v_lshl_add_u32 v14, v31, 7, v14
  v_add_u32 v14, s91, v14
  v_add_u32 v14, v14, v30
  v_xor_b32 v15, 16, v14
  v_mov_b32 v30, 0x0
  v_bfe_u32 v31, v0, 5, 1
  v_lshl_add_u32 v30, v31, 6, v30
  v_bfe_u32 v31, v0, 1, 1
  v_lshl_add_u32 v30, v31, 5, v30
  v_bfe_u32 v31, v0, 4, 1
  v_lshl_add_u32 v30, v31, 4, v30
  v_mov_b32 v29, 0x0
  v_bfe_u32 v31, v0, 2, 2
  v_lshl_add_u32 v29, v31, 5, v29
  v_bfe_u32 v31, v0, 0, 1
  v_lshl_add_u32 v29, v31, 4, v29
  v_xor_b32 v30, v30, v29
  v_mov_b32 v16, 0x3400
  v_bfe_u32 v31, v0, 4, 2
  v_lshl_add_u32 v16, v31, 8, v16
  v_bfe_u32 v31, v0, 1, 1
  v_lshl_add_u32 v16, v31, 7, v16
  v_add_u32 v16, v16, v30
  s_lshl_b32 s98, s36, 14
  s_lshl_b32 s92, s35, 7
  s_add_u32 s98, s98, s92
  s_lshl_b32 s92, s32, 11
  s_add_u32 s91, s98, s92
  v_mov_b32 v17, 0x0
  v_bfe_u32 v31, v0, 0, 5
  v_lshl_add_u32 v17, v31, 2, v17
  v_bfe_u32 v31, v0, 5, 1
  v_lshl_add_u32 v17, v31, 10, v17
  v_add_u32 v17, s91, v17
  v_xor_b32 v18, 0x2000, v17
  s_mov_b32 s48, 0x33333333
  s_mov_b32 s49, 0x33333333
  s_mov_b32 s50, 0xffff0000
  s_mov_b32 s51, 0xffff0000
  s_mov_b32 s52, 0x0000ffff
  s_mov_b32 s53, 0x0000ffff
  s_mov_b32 s54, 0xfffffffe
  s_mov_b32 s47, 0x3e0293ee
  v_mov_b32 v30, 0x4444
  v_mov_b32 v31, 0xeeee
  v_cndmask_b32 v23, v31, v30, s[48:49]
  v_mov_b32 v22, -1
  v_mov_b32 v232, 0
  v_mov_b32 v233, 0
  v_mov_b32 v234, 0
  v_mov_b32 v235, 0
  v_mov_b32 v112, 0
  v_mov_b32 v113, 0
  s_mov_b32 s56, 0xf0f0f0f0
  s_mov_b32 s57, 0xf0f0f0f0
  v_mov_b32 v30, 0x3f80
  v_mov_b32 v31, 1.0
  v_cndmask_b32 v30, v30, v31, s[56:57]
  s_mov_b32 s56, 0x110011
  s_mov_b32 s57, 0x110011
  v_cndmask_b32 v24, 0, v30, s[56:57]
  s_mov_b32 s56, 0x220022
  s_mov_b32 s57, 0x220022
  v_cndmask_b32 v25, 0, v30, s[56:57]
  s_mov_b32 s56, 0x11001100
  s_mov_b32 s57, 0x11001100
  v_cndmask_b32 v26, 0, v30, s[56:57]
  s_mov_b32 s56, 0x22002200
  s_mov_b32 s57, 0x22002200
  v_cndmask_b32 v27, 0, v30, s[56:57]
  s_mov_b32 s40, 0
  s_mov_b32 s41, 0x3800000
  s_mov_b32 s43, 0x3900000
  s_mov_b32 s44, 0
  s_mov_b32 s55, 0x40000
  s_mov_b32 s45, 0
  s_waitcnt vmcnt(33)
  s_barrier
  s_cmp_lg_u32 s32, 0
  s_cbranch_scc1 SL_sig_2
  v_mov_b32 v254, 1
  v_mov_b32 v255, 0
  s_mov_b64 exec, 1
  buffer_atomic_add v254, v255, s[28:31], s100 offen offset:132 sc1
  s_mov_b64 exec, -1
SL_sig_2:
  s_mov_b32 s90, 0x3e0000
  buffer_store_dword v22, v19, s[4:7], s90 offen sc1
  buffer_store_dword v22, v20, s[4:7], s90 offen sc1
  s_mov_b32 s90, 0x3f0000
  buffer_store_dword v22, v19, s[4:7], s90 offen sc1
  buffer_store_dword v22, v20, s[4:7], s90 offen sc1
  s_waitcnt vmcnt(28)
  ds_read_b64_tr_b16 a[16:17], v182 offset:0
  ds_read_b64_tr_b16 a[18:19], v182 offset:512
  ds_read_b64_tr_b16 a[24:25], v182 offset:32
  ds_read_b64_tr_b16 a[26:27], v182 offset:544
  s_waitcnt lgkmcnt(0)
  s_add_u32 m0, s96, 0
  s_mov_b32 s90, 0x100000
  buffer_load_dwordx4 v180, s[12:15], s90 offen  lds
  s_add_u32 m0, s96, 1024
  s_mov_b32 s90, 0x110000
  buffer_load_dwordx4 v180, s[12:15], s90 offen  lds
  s_add_u32 m0, s96, 2048
  s_mov_b32 s90, 0x120000
  buffer_load_dwordx4 v180, s[12:15], s90 offen  lds
  s_add_u32 m0, s96, 3072
  s_mov_b32 s90, 0x130000
  buffer_load_dwordx4 v180, s[12:15], s90 offen  lds
  s_waitcnt vmcnt(28)
  ds_read_b64_tr_b16 a[32:33], v182 offset:4096
  ds_read_b64_tr_b16 a[34:35], v182 offset:4608
  ds_read_b64_tr_b16 a[40:41], v182 offset:4128
  ds_read_b64_tr_b16 a[42:43], v182 offset:4640
  s_waitcnt lgkmcnt(0)
  s_add_u32 m0, s96, 4096
  s_mov_b32 s90, 0x100000
  buffer_load_dwordx4 v185, s[16:19], s90 offen  lds
  s_add_u32 m0, s96, 5120
  s_mov_b32 s90, 0x110000
  buffer_load_dwordx4 v185, s[16:19], s90 offen  lds
  s_add_u32 m0, s96, 6144
  s_mov_b32 s90, 0x120000
  buffer_load_dwordx4 v185, s[16:19], s90 offen  lds
  s_add_u32 m0, s96, 7168
  s_mov_b32 s90, 0x130000
  buffer_load_dwordx4 v185, s[16:19], s90 offen  lds
  s_waitcnt vmcnt(28)
  ds_read_b64_tr_b16 a[20:21], v182 offset:8192
  ds_read_b64_tr_b16 a[22:23], v182 offset:8704
  ds_read_b64_tr_b16 a[28:29], v182 offset:8224
  ds_read_b64_tr_b16 a[30:31], v182 offset:8736
  s_waitcnt lgkmcnt(0)
  s_add_u32 m0, s96, 8192
  s_mov_b32 s90, 0x140000
  buffer_load_dwordx4 v180, s[12:15], s90 offen  lds
  s_add_u32 m0, s96, 9216
  s_mov_b32 s90, 0x150000
  buffer_load_dwordx4 v180, s[12:15], s90 offen  lds
  s_add_u32 m0, s96, 10240
  s_mov_b32 s90, 0x160000
  buffer_load_dwordx4 v180, s[12:15], s90 offen  lds
  s_add_u32 m0, s96, 11264
  s_mov_b32 s90, 0x170000
  buffer_load_dwordx4 v180, s[12:15], s90 offen  lds
  s_waitcnt vmcnt(28)
  ds_read_b64_tr_b16 a[36:37], v182 offset:12288
  ds_read_b64_tr_b16 a[38:39], v182 offset:12800
  ds_read_b64_tr_b16 a[44:45], v182 offset:12320
  ds_read_b64_tr_b16 a[46:47], v182 offset:12832
  s_waitcnt lgkmcnt(0)
  s_add_u32 m0, s96, 12288
  s_mov_b32 s90, 0x140000
  buffer_load_dwordx4 v185, s[16:19], s90 offen  lds
  s_add_u32 m0, s96, 13312
  s_mov_b32 s90, 0x150000
  buffer_load_dwordx4 v185, s[16:19], s90 offen  lds
  s_add_u32 m0, s96, 14336
  s_mov_b32 s90, 0x160000
  buffer_load_dwordx4 v185, s[16:19], s90 offen  lds
  s_add_u32 m0, s96, 15360
  s_mov_b32 s90, 0x170000
  buffer_load_dwordx4 v185, s[16:19], s90 offen  lds
  s_waitcnt vmcnt(28)
  ds_read_b64_tr_b16 a[64:65], v182 offset:16384
  ds_read_b64_tr_b16 a[66:67], v182 offset:16896
  ds_read_b64_tr_b16 a[72:73], v182 offset:16416
  ds_read_b64_tr_b16 a[74:75], v182 offset:16928
  s_waitcnt lgkmcnt(0)
  s_add_u32 m0, s96, 16384
  s_mov_b32 s90, 0x180000
  buffer_load_dwordx4 v180, s[12:15], s90 offen  lds
  s_add_u32 m0, s96, 17408
  s_mov_b32 s90, 0x190000
  buffer_load_dwordx4 v180, s[12:15], s90 offen  lds
  s_add_u32 m0, s96, 18432
  s_mov_b32 s90, 0x1a0000
  buffer_load_dwordx4 v180, s[12:15], s90 offen  lds
  s_add_u32 m0, s96, 19456
  s_mov_b32 s90, 0x1b0000
  buffer_load_dwordx4 v180, s[12:15], s90 offen  lds
  s_waitcnt vmcnt(28)
  ds_read_b64_tr_b16 a[80:81], v182 offset:20480
  ds_read_b64_tr_b16 a[82:83], v182 offset:20992
  ds_read_b64_tr_b16 a[88:89], v182 offset:20512
  ds_read_b64_tr_b16 a[90:91], v182 offset:21024
  s_waitcnt lgkmcnt(0)
  s_add_u32 m0, s96, 20480
  s_mov_b32 s90, 0x180000
  buffer_load_dwordx4 v185, s[16:19], s90 offen  lds
  s_add_u32 m0, s96, 21504
  s_mov_b32 s90, 0x190000
  buffer_load_dwordx4 v185, s[16:19], s90 offen  lds
  s_add_u32 m0, s96, 22528
  s_mov_b32 s90, 0x1a0000
  buffer_load_dwordx4 v185, s[16:19], s90 offen  lds
  s_add_u32 m0, s96, 23552
  s_mov_b32 s90, 0x1b0000
  buffer_load_dwordx4 v185, s[16:19], s90 offen  lds
  s_waitcnt vmcnt(28)
  ds_read_b64_tr_b16 a[68:69], v182 offset:24576
  ds_read_b64_tr_b16 a[70:71], v182 offset:25088
  ds_read_b64_tr_b16 a[76:77], v182 offset:24608
  ds_read_b64_tr_b16 a[78:79], v182 offset:25120
  s_waitcnt lgkmcnt(0)
  s_add_u32 m0, s96, 24576
  s_mov_b32 s90, 0x1c0000
  buffer_load_dwordx4 v180, s[12:15], s90 offen  lds
  s_add_u32 m0, s96, 25600
  s_mov_b32 s90, 0x1d0000
  buffer_load_dwordx4 v180, s[12:15], s90 offen  lds
  s_add_u32 m0, s96, 26624
  s_mov_b32 s90, 0x1e0000
  buffer_load_dwordx4 v180, s[12:15], s90 offen  lds
  s_add_u32 m0, s96, 27648
  s_mov_b32 s90, 0x1f0000
  buffer_load_dwordx4 v180, s[12:15], s90 offen  lds
  s_waitcnt vmcnt(28)
  ds_read_b64_tr_b16 a[84:85], v182 offset:28672
  ds_read_b64_tr_b16 a[86:87], v182 offset:29184
  ds_read_b64_tr_b16 a[92:93], v182 offset:28704
  ds_read_b64_tr_b16 a[94:95], v182 offset:29216
  s_waitcnt lgkmcnt(0)
  s_add_u32 m0, s96, 28672
  s_mov_b32 s90, 0x1c0000
  buffer_load_dwordx4 v185, s[16:19], s90 offen  lds
  s_add_u32 m0, s96, 29696
  s_mov_b32 s90, 0x1d0000
  buffer_load_dwordx4 v185, s[16:19], s90 offen  lds
  s_add_u32 m0, s96, 30720
  s_mov_b32 s90, 0x1e0000
  buffer_load_dwordx4 v185, s[16:19], s90 offen  lds
  s_add_u32 m0, s96, 31744
  s_mov_b32 s90, 0x1f0000
  buffer_load_dwordx4 v185, s[16:19], s90 offen  lds
  s_waitcnt vmcnt(28)
  ds_read_b64_tr_b16 a[112:113], v182 offset:0
  ds_read_b64_tr_b16 a[114:115], v182 offset:512
  ds_read_b64_tr_b16 a[120:121], v182 offset:32
  ds_read_b64_tr_b16 a[122:123], v182 offset:544
  s_waitcnt lgkmcnt(0)
  s_add_u32 m0, s96, 0
  s_mov_b32 s90, 0x0
  buffer_load_dwordx4 v180, s[8:11], s90 offen  lds
  s_add_u32 m0, s96, 1024
  s_mov_b32 s90, 0x10000
  buffer_load_dwordx4 v180, s[8:11], s90 offen  lds
  s_add_u32 m0, s96, 2048
  s_mov_b32 s90, 0x20000
  buffer_load_dwordx4 v180, s[8:11], s90 offen  lds
  s_add_u32 m0, s96, 3072
  s_mov_b32 s90, 0x30000
  buffer_load_dwordx4 v180, s[8:11], s90 offen  lds
  s_waitcnt vmcnt(28)
  ds_read_b64_tr_b16 a[128:129], v182 offset:4096
  ds_read_b64_tr_b16 a[130:131], v182 offset:4608
  ds_read_b64_tr_b16 a[136:137], v182 offset:4128
  ds_read_b64_tr_b16 a[138:139], v182 offset:4640
  s_waitcnt lgkmcnt(0)
  s_add_u32 m0, s96, 4096
  s_mov_b32 s90, 0x40000
  buffer_load_dwordx4 v180, s[8:11], s90 offen  lds
  s_add_u32 m0, s96, 5120
  s_mov_b32 s90, 0x50000
  buffer_load_dwordx4 v180, s[8:11], s90 offen  lds
  s_add_u32 m0, s96, 6144
  s_mov_b32 s90, 0x60000
  buffer_load_dwordx4 v180, s[8:11], s90 offen  lds
  s_add_u32 m0, s96, 7168
  s_mov_b32 s90, 0x70000
  buffer_load_dwordx4 v180, s[8:11], s90 offen  lds
  s_waitcnt vmcnt(28)
  ds_read_b64_tr_b16 a[116:117], v182 offset:8192
  ds_read_b64_tr_b16 a[118:119], v182 offset:8704
  ds_read_b64_tr_b16 a[124:125], v182 offset:8224
  ds_read_b64_tr_b16 a[126:127], v182 offset:8736
  s_waitcnt lgkmcnt(0)
  s_add_u32 m0, s96, 8192
  s_mov_b32 s90, 0x80000
  buffer_load_dwordx4 v180, s[8:11], s90 offen  lds
  s_add_u32 m0, s96, 9216
  s_mov_b32 s90, 0x90000
  buffer_load_dwordx4 v180, s[8:11], s90 offen  lds
  s_add_u32 m0, s96, 10240
  s_mov_b32 s90, 0xa0000
  buffer_load_dwordx4 v180, s[8:11], s90 offen  lds
  s_add_u32 m0, s96, 11264
  s_mov_b32 s90, 0xb0000
  buffer_load_dwordx4 v180, s[8:11], s90 offen  lds
  s_waitcnt vmcnt(28)
  ds_read_b64_tr_b16 a[132:133], v182 offset:12288
  ds_read_b64_tr_b16 a[134:135], v182 offset:12800
  ds_read_b64_tr_b16 a[140:141], v182 offset:12320
  ds_read_b64_tr_b16 a[142:143], v182 offset:12832
  s_waitcnt lgkmcnt(0)
  s_add_u32 m0, s96, 12288
  s_mov_b32 s90, 0xc0000
  buffer_load_dwordx4 v180, s[8:11], s90 offen  lds
  s_add_u32 m0, s96, 13312
  s_mov_b32 s90, 0xd0000
  buffer_load_dwordx4 v180, s[8:11], s90 offen  lds
  s_add_u32 m0, s96, 14336
  s_mov_b32 s90, 0xe0000
  buffer_load_dwordx4 v180, s[8:11], s90 offen  lds
  s_add_u32 m0, s96, 15360
  s_mov_b32 s90, 0xf0000
  buffer_load_dwordx4 v180, s[8:11], s90 offen  lds
  s_waitcnt vmcnt(28)
  ds_read_b64_tr_b16 a[160:161], v182 offset:16384
  ds_read_b64_tr_b16 a[162:163], v182 offset:16896
  ds_read_b64_tr_b16 a[168:169], v182 offset:16416
  ds_read_b64_tr_b16 a[170:171], v182 offset:16928
  s_waitcnt lgkmcnt(0)
  s_add_u32 m0, s96, 16384
  s_mov_b32 s90, 0x100000
  buffer_load_dwordx4 v180, s[8:11], s90 offen  lds
  s_add_u32 m0, s96, 17408
  s_mov_b32 s90, 0x110000
  buffer_load_dwordx4 v180, s[8:11], s90 offen  lds
  s_add_u32 m0, s96, 18432
  s_mov_b32 s90, 0x120000
  buffer_load_dwordx4 v180, s[8:11], s90 offen  lds
  s_add_u32 m0, s96, 19456
  s_mov_b32 s90, 0x130000
  buffer_load_dwordx4 v180, s[8:11], s90 offen  lds
  s_waitcnt vmcnt(28)
  ds_read_b64_tr_b16 a[176:177], v182 offset:20480
  ds_read_b64_tr_b16 a[178:179], v182 offset:20992
  ds_read_b64_tr_b16 a[184:185], v182 offset:20512
  ds_read_b64_tr_b16 a[186:187], v182 offset:21024
  s_waitcnt lgkmcnt(0)
  s_add_u32 m0, s96, 20480
  s_mov_b32 s90, 0x140000
  buffer_load_dwordx4 v180, s[8:11], s90 offen  lds
  s_add_u32 m0, s96, 21504
  s_mov_b32 s90, 0x150000
  buffer_load_dwordx4 v180, s[8:11], s90 offen  lds
  s_add_u32 m0, s96, 22528
  s_mov_b32 s90, 0x160000
  buffer_load_dwordx4 v180, s[8:11], s90 offen  lds
  s_add_u32 m0, s96, 23552
  s_mov_b32 s90, 0x170000
  buffer_load_dwordx4 v180, s[8:11], s90 offen  lds
  s_waitcnt vmcnt(28)
  ds_read_b64_tr_b16 a[164:165], v182 offset:24576
  ds_read_b64_tr_b16 a[166:167], v182 offset:25088
  ds_read_b64_tr_b16 a[172:173], v182 offset:24608
  ds_read_b64_tr_b16 a[174:175], v182 offset:25120
  s_waitcnt lgkmcnt(0)
  s_add_u32 m0, s96, 24576
  s_mov_b32 s90, 0x180000
  buffer_load_dwordx4 v180, s[8:11], s90 offen  lds
  s_add_u32 m0, s96, 25600
  s_mov_b32 s90, 0x190000
  buffer_load_dwordx4 v180, s[8:11], s90 offen  lds
  s_add_u32 m0, s96, 26624
  s_mov_b32 s90, 0x1a0000
  buffer_load_dwordx4 v180, s[8:11], s90 offen  lds
  s_add_u32 m0, s96, 27648
  s_mov_b32 s90, 0x1b0000
  buffer_load_dwordx4 v180, s[8:11], s90 offen  lds
  s_waitcnt vmcnt(28)
  ds_read_b64_tr_b16 a[180:181], v182 offset:28672
  ds_read_b64_tr_b16 a[182:183], v182 offset:29184
  ds_read_b64_tr_b16 a[188:189], v182 offset:28704
  ds_read_b64_tr_b16 a[190:191], v182 offset:29216
  s_waitcnt lgkmcnt(0)
  s_add_u32 m0, s96, 28672
  s_mov_b32 s90, 0x1c0000
  buffer_load_dwordx4 v180, s[8:11], s90 offen  lds
  s_add_u32 m0, s96, 29696
  s_mov_b32 s90, 0x1d0000
  buffer_load_dwordx4 v180, s[8:11], s90 offen  lds
  s_add_u32 m0, s96, 30720
  s_mov_b32 s90, 0x1e0000
  buffer_load_dwordx4 v180, s[8:11], s90 offen  lds
  s_add_u32 m0, s96, 31744
  s_mov_b32 s90, 0x1f0000
  buffer_load_dwordx4 v180, s[8:11], s90 offen  lds
  s_waitcnt vmcnt(28)
  ds_read_b64_tr_b16 a[0:1], v182 offset:0
  ds_read_b64_tr_b16 a[2:3], v182 offset:512
  ds_read_b64_tr_b16 a[8:9], v182 offset:32
  ds_read_b64_tr_b16 a[10:11], v182 offset:544
  s_waitcnt lgkmcnt(0)
  s_add_u32 m0, s96, 0
  s_mov_b32 s90, 0x0
  buffer_load_dwordx4 v181, s[20:23], s90 offen  lds
  s_add_u32 m0, s96, 1024
  s_mov_b32 s90, 0x4000
  buffer_load_dwordx4 v181, s[20:23], s90 offen  lds
  s_add_u32 m0, s96, 2048
  s_mov_b32 s90, 0x8000
  buffer_load_dwordx4 v181, s[20:23], s90 offen  lds
  s_add_u32 m0, s96, 3072
  s_mov_b32 s90, 0xc000
  buffer_load_dwordx4 v181, s[20:23], s90 offen  lds
  s_waitcnt vmcnt(28)
  ds_read_b64_tr_b16 a[4:5], v182 offset:4096
  ds_read_b64_tr_b16 a[6:7], v182 offset:4608
  ds_read_b64_tr_b16 a[12:13], v182 offset:4128
  ds_read_b64_tr_b16 a[14:15], v182 offset:4640
  s_waitcnt lgkmcnt(0)
  s_add_u32 m0, s96, 4096
  s_mov_b32 s90, 0x10000
  buffer_load_dwordx4 v181, s[20:23], s90 offen  lds
  s_add_u32 m0, s96, 5120
  s_mov_b32 s90, 0x14000
  buffer_load_dwordx4 v181, s[20:23], s90 offen  lds
  s_add_u32 m0, s96, 6144
  s_mov_b32 s90, 0x18000
  buffer_load_dwordx4 v181, s[20:23], s90 offen  lds
  s_add_u32 m0, s96, 7168
  s_mov_b32 s90, 0x1c000
  buffer_load_dwordx4 v181, s[20:23], s90 offen  lds
  s_waitcnt vmcnt(28)
  ds_read_b64_tr_b16 a[48:49], v182 offset:8192
  ds_read_b64_tr_b16 a[50:51], v182 offset:8704
  ds_read_b64_tr_b16 a[56:57], v182 offset:8224
  ds_read_b64_tr_b16 a[58:59], v182 offset:8736
  s_waitcnt lgkmcnt(0)
  s_add_u32 m0, s96, 8192
  s_mov_b32 s90, 0x20000
  buffer_load_dwordx4 v181, s[20:23], s90 offen  lds
  s_add_u32 m0, s96, 9216
  s_mov_b32 s90, 0x24000
  buffer_load_dwordx4 v181, s[20:23], s90 offen  lds
  s_add_u32 m0, s96, 10240
  s_mov_b32 s90, 0x28000
  buffer_load_dwordx4 v181, s[20:23], s90 offen  lds
  s_add_u32 m0, s96, 11264
  s_mov_b32 s90, 0x2c000
  buffer_load_dwordx4 v181, s[20:23], s90 offen  lds
  s_waitcnt vmcnt(28)
  ds_read_b64_tr_b16 a[52:53], v182 offset:12288
  ds_read_b64_tr_b16 a[54:55], v182 offset:12800
  ds_read_b64_tr_b16 a[60:61], v182 offset:12320
  ds_read_b64_tr_b16 a[62:63], v182 offset:12832
  s_waitcnt lgkmcnt(0)
  s_add_u32 m0, s96, 12288
  s_mov_b32 s90, 0x30000
  buffer_load_dwordx4 v181, s[20:23], s90 offen  lds
  s_add_u32 m0, s96, 13312
  s_mov_b32 s90, 0x34000
  buffer_load_dwordx4 v181, s[20:23], s90 offen  lds
  s_add_u32 m0, s96, 14336
  s_mov_b32 s90, 0x38000
  buffer_load_dwordx4 v181, s[20:23], s90 offen  lds
  s_add_u32 m0, s96, 15360
  s_mov_b32 s90, 0x3c000
  buffer_load_dwordx4 v181, s[20:23], s90 offen  lds
  s_mov_b32 s90, 0x3800000
  buffer_load_dword v204, v2, s[4:7], s90 offen sc1
  buffer_load_dword v204, v7, s[4:7], s90 offen sc1
  buffer_load_dword v204, v8, s[4:7], s90 offen sc1
  s_mov_b32 s90, 0x3880000
  buffer_load_dword v204, v2, s[4:7], s90 offen sc1
  buffer_load_dword v204, v7, s[4:7], s90 offen sc1
  buffer_load_dword v204, v8, s[4:7], s90 offen sc1
  s_mov_b32 s90, 0x3900000
  buffer_load_dword v204, v2, s[4:7], s90 offen sc1
  buffer_load_dword v204, v7, s[4:7], s90 offen sc1
  buffer_load_dword v204, v8, s[4:7], s90 offen sc1
  s_mov_b32 s90, 0x3980000
  buffer_load_dword v204, v2, s[4:7], s90 offen sc1
  buffer_load_dword v204, v7, s[4:7], s90 offen sc1
  buffer_load_dword v204, v8, s[4:7], s90 offen sc1
  s_waitcnt vmcnt(28)
  ds_read_b64_tr_b16 a[96:97], v182 offset:16384
  ds_read_b64_tr_b16 a[98:99], v182 offset:16896
  ds_read_b64_tr_b16 a[104:105], v182 offset:16416
  ds_read_b64_tr_b16 a[106:107], v182 offset:16928
  s_waitcnt vmcnt(24)
  ds_read_b64_tr_b16 a[100:101], v182 offset:20480
  ds_read_b64_tr_b16 a[102:103], v182 offset:20992
  ds_read_b64_tr_b16 a[108:109], v182 offset:20512
  ds_read_b64_tr_b16 a[110:111], v182 offset:21024
  s_waitcnt vmcnt(20)
  ds_read_b64_tr_b16 a[144:145], v182 offset:24576
  ds_read_b64_tr_b16 a[146:147], v182 offset:25088
  ds_read_b64_tr_b16 a[152:153], v182 offset:24608
  ds_read_b64_tr_b16 a[154:155], v182 offset:25120
  s_waitcnt vmcnt(16)
  ds_read_b64_tr_b16 a[148:149], v182 offset:28672
  ds_read_b64_tr_b16 a[150:151], v182 offset:29184
  ds_read_b64_tr_b16 a[156:157], v182 offset:28704
  ds_read_b64_tr_b16 a[158:159], v182 offset:29216
  v_mbcnt_lo_u32_b32 v250, -1, 0
  v_mbcnt_hi_u32_b32 v250, -1, v250
  s_lshl_b32 s90, s32, 9
  s_add_u32 s90, s90, 147520
  v_lshl_add_u32 v251, v250, 3, s90
  ds_write_b64 v251, v[248:249]
  s_waitcnt lgkmcnt(0)
  s_cmp_lg_u32 s32, 0
  s_cbranch_scc1 SL_vd_4
  v_lshlrev_b32 v250, 2, v250
  s_cmp_lg_u32 s100, 0
  s_cbranch_scc1 SL_vw_3
  v_readfirstlane_b32 s90, v247
  s_and_b32 s90, s90, s101
  s_cbranch_scc0 SL_vw_3
  v_mov_b32 v251, 1
  s_mov_b64 exec, 1
  buffer_store_dword v251, v250, s[28:31], 0 offen offset:32 sc1
  s_mov_b64 exec, -1
SL_vw_3:
  buffer_load_dword v251, v250, s[28:31], 0 offen sc1
  s_waitcnt vmcnt(0)
  v_cmp_eq_u32 vcc, -1, v251
  v_readlane_b32 s91, v251, 8
  v_readlane_b32 s92, v251, 32
  v_readlane_b32 s93, v251, 33
  v_readlane_b32 s90, v251, 34
  s_cmp_lg_u32 s100, 0
  s_cselect_b32 s93, s90, s93
  s_cselect_b32 s91, 0, s91
  s_cselect_b32 s92, 1, s92
  s_cselect_b32 s90, 0xff, vcc_lo
  s_cmp_lg_u32 s91, 0
  s_cselect_b32 s92, 3, s92
  s_cbranch_scc1 SL_vk_5
  s_add_u32 s3, s3, 1
  s_cmp_ge_u32 s3, 131072
  s_cselect_b32 s92, 4, s92
  s_cbranch_scc1 SL_vk_5
  s_sleep 8
  s_and_b32 s90, s90, 0xff
  s_cmp_lg_u32 s90, 0xff
  s_cbranch_scc1 SL_vw_3
  s_cmp_lt_u32 s93, 128
  s_cbranch_scc1 SL_vw_3
SL_vk_5:
  v_mov_b32 v251, s92
  v_mov_b32 v250, 147456
  ds_write_b32 v250, v251
  s_waitcnt lgkmcnt(0)
SL_vd_4:
  s_barrier
  v_mov_b32 v250, 147456
  ds_read_b32 v251, v250
  s_waitcnt lgkmcnt(0)
  v_readfirstlane_b32 s92, v251
  s_barrier
  s_cmp_eq_u32 s92, 3
  s_cbranch_scc1 L_fallback
  s_cmp_eq_u32 s92, 4
  s_cbranch_scc1 L_exit
  s_waitcnt vmcnt(0)
  s_barrier
  ds_read_b64_tr_b16 a[192:193], v183 offset:0
  ds_read_b64_tr_b16 a[194:195], v183 offset:2048
  ds_read_b64_tr_b16 a[196:197], v183 offset:512
  ds_read_b64_tr_b16 a[198:199], v183 offset:2560
  ds_read_b64_tr_b16 a[200:201], v183 offset:4096
  ds_read_b64_tr_b16 a[202:203], v183 offset:6144
  ds_read_b64_tr_b16 a[204:205], v183 offset:4608
  ds_read_b64_tr_b16 a[206:207], v183 offset:6656
  s_waitcnt lgkmcnt(0)
  ds_read_b64_tr_b16 a[208:209], v183 offset:32768
  ds_read_b64_tr_b16 a[210:211], v183 offset:34816
  ds_read_b64_tr_b16 a[212:213], v183 offset:33280
  ds_read_b64_tr_b16 a[214:215], v183 offset:35328
  ds_read_b64_tr_b16 a[216:217], v183 offset:36864
  ds_read_b64_tr_b16 a[218:219], v183 offset:38912
  ds_read_b64_tr_b16 a[220:221], v183 offset:37376
  ds_read_b64_tr_b16 a[222:223], v183 offset:39424
  s_waitcnt lgkmcnt(0)
  ds_read_b64_tr_b16 a[224:225], v184 offset:0
  ds_read_b64_tr_b16 a[226:227], v184 offset:2048
  ds_read_b64_tr_b16 a[228:229], v184 offset:512
  ds_read_b64_tr_b16 a[230:231], v184 offset:2560
  ds_read_b64_tr_b16 a[232:233], v184 offset:4096
  ds_read_b64_tr_b16 a[234:235], v184 offset:6144
  ds_read_b64_tr_b16 a[236:237], v184 offset:4608
  ds_read_b64_tr_b16 a[238:239], v184 offset:6656
  s_waitcnt lgkmcnt(0)
  ds_read_b64_tr_b16 a[240:241], v184 offset:32768
  ds_read_b64_tr_b16 a[242:243], v184 offset:34816
  ds_read_b64_tr_b16 a[244:245], v184 offset:33280
  ds_read_b64_tr_b16 a[246:247], v184 offset:35328
  ds_read_b64_tr_b16 a[248:249], v184 offset:36864
  ds_read_b64_tr_b16 a[250:251], v184 offset:38912
  ds_read_b64_tr_b16 a[252:253], v184 offset:37376
  ds_read_b64_tr_b16 a[254:255], v184 offset:39424
  s_waitcnt lgkmcnt(0)
  s_barrier
  s_mov_b32 s46, 0
  s_mov_b32 s39, 0
  v_xor_b32 v1, s39, v1
  v_xor_b32 v17, s39, v17
  v_xor_b32 v18, s39, v18
  s_mov_b32 s12, s63
  s_mov_b32 s90, 0x3800000
  s_mov_b32 s90, 0x3880000
  s_mov_b32 s90, 0x3900000
  s_mov_b32 s90, 0x3980000
  v_mov_b32 v248, 0x3f803f80
  v_mov_b32 v249, 0x3f803f80
  v_mov_b32 v250, 0x3f803f80
  v_mov_b32 v251, 0x3f803f80
  v_mov_b32 v252, 0x3f803f80
  v_mov_b32 v253, 0x3f803f80
  v_mov_b32 v254, 0x3f803f80
  v_mov_b32 v255, 0x3f803f80
  s_cmp_lg_u32 s32, 0
  s_cbranch_scc1 SL_kv0d
  s_lshl_b32 s90, s33, 7
  s_add_u32 s90, s90, 0x3d07000
  v_mov_b32 v30, s90
SL_kv0:
  buffer_load_dword v31, v30, s[4:7], 0 offen sc1
  s_waitcnt vmcnt(0)
  v_readfirstlane_b32 s90, v31
  s_add_u32 s46, s46, 1
  s_cmp_ge_u32 s46, 131072
  s_cbranch_scc1 SL_rec_abort
  s_sleep 2
  s_cmp_lt_u32 s90, 16
  s_cbranch_scc1 SL_kv0
SL_kv0d:
  s_barrier
  buffer_load_dwordx4 v[180:183], v12, s[4:7], s44 offen offset:0
  buffer_load_dwordx4 v[184:187], v12, s[4:7], s44 offen offset:128
  buffer_load_dwordx4 v[188:191], v12, s[4:7], s44 offen offset:1024
  buffer_load_dwordx4 v[192:195], v12, s[4:7], s44 offen offset:1152
  buffer_load_dwordx4 v[196:199], v13, s[4:7], s44 offen offset:0
  buffer_load_dwordx4 v[200:203], v13, s[4:7], s44 offen offset:128
  buffer_load_dwordx4 v[204:207], v13, s[4:7], s44 offen offset:1024
  buffer_load_dwordx4 v[208:211], v13, s[4:7], s44 offen offset:1152
  buffer_load_dwordx4 v[116:119], v11, s[4:7], s44 offen offset:0
  buffer_load_dwordx4 v[132:135], v11, s[4:7], s44 offen offset:64
  buffer_load_dwordx4 v[120:123], v11, s[4:7], s44 offen offset:1024
  buffer_load_dwordx4 v[136:139], v11, s[4:7], s44 offen offset:1088
  buffer_load_dwordx4 v[124:127], v11, s[4:7], s44 offen offset:2048
  buffer_load_dwordx4 v[140:143], v11, s[4:7], s44 offen offset:2112
  buffer_load_dwordx4 v[128:131], v11, s[4:7], s44 offen offset:3072
  buffer_load_dwordx4 v[144:147], v11, s[4:7], s44 offen offset:3136
  s_add_u32 s44, s44, 0x40000
  v_mov_b64 v[64:65], 0
  v_mov_b64 v[66:67], 0
  v_mov_b64 v[68:69], 0
  v_mov_b64 v[70:71], 0
  v_mov_b64 v[72:73], 0
  v_mov_b64 v[74:75], 0
  v_mov_b64 v[76:77], 0
  v_mov_b64 v[78:79], 0
  v_mov_b64 v[80:81], 0
  v_mov_b64 v[82:83], 0
  v_mov_b64 v[84:85], 0
  v_mov_b64 v[86:87], 0
  v_mov_b64 v[32:33], 0
  v_mov_b64 v[34:35], 0
  v_mov_b64 v[212:213], 0
  v_mov_b64 v[214:215], 0
  v_mov_b64 v[216:217], 0
  v_mov_b64 v[218:219], 0
  v_mov_b64 v[220:221], 0
  v_mov_b64 v[222:223], 0
  v_mov_b64 v[224:225], 0
  v_mov_b64 v[226:227], 0
  v_mov_b64 v[228:229], 0
  v_mov_b64 v[230:231], 0
  s_waitcnt vmcnt(0)
  v_min_u32 v44, s54, v44
  s_lshl_b32 s90, s33, 7
  s_add_u32 s90, s90, 0x3d07000
  v_mov_b32 v244, s90
  s_lshl_b32 s90, s34, 2
  s_add_u32 s90, s90, s32
  s_lshl_b32 s91, s33, 7
  s_add_u32 s91, s91, 0x3d00000
  v_mbcnt_lo_u32_b32 v30, -1, 0
  v_mbcnt_hi_u32_b32 v30, -1, v30
  v_add_u32 v30, s90, v30
  v_cmp_eq_u32 vcc, 0, v30
  v_mov_b32 v30, 0x80000000
  v_mov_b32 v31, s91
  v_cndmask_b32 v245, v30, v31, vcc
  s_mov_b64 s[8:9], s[94:95]
  s_mov_b64 s[10:11], s[94:95]
  s_branch SL_pubmem
SL_step:
  s_load_dword s16, s[8:9], 256
  s_load_dword s17, s[10:11], 256
  s_load_dword s18, s[8:9], 320
  s_load_dword s19, s[10:11], 320
  s_load_dword s20, s[8:9], 384
  s_load_dword s21, s[10:11], 384
  s_load_dword s22, s[8:9], 448
  s_load_dword s23, s[10:11], 448
  buffer_load_dwordx4 v[200:203], v13, s[4:7], s44 offen offset:128
  buffer_load_dwordx4 v[204:207], v13, s[4:7], s44 offen offset:1024
  buffer_load_dwordx4 v[208:211], v13, s[4:7], s44 offen offset:1152
  buffer_load_dwordx4 v[128:131], v11, s[4:7], s44 offen offset:3072
  buffer_load_dwordx4 v[144:147], v11, s[4:7], s44 offen offset:3136
  v_mov_b64 v[64:65], 0
  v_mov_b64 v[66:67], 0
  v_mov_b64 v[68:69], 0
  v_mov_b64 v[70:71], 0
  v_mov_b64 v[72:73], 0
  v_mov_b64 v[74:75], 0
  v_mov_b64 v[76:77], 0
  v_mov_b64 v[78:79], 0
  v_mov_b64 v[80:81], 0
  v_mov_b64 v[82:83], 0
  v_mov_b64 v[84:85], 0
  v_mov_b64 v[86:87], 0
  v_mov_b64 v[32:33], 0
  v_mov_b64 v[34:35], 0
  buffer_load_dwordx4 v[36:39], v1, s[4:7], s42 offen sc1
  buffer_store_dword v22, v18, s[4:7], s13 offen sc1
  buffer_store_dword v22, v2, s[4:7], s13 offen sc1
  buffer_store_dword v22, v7, s[4:7], s13 offen sc1
  buffer_store_dword v22, v8, s[4:7], s13 offen sc1
  s_add_u32 s44, s44, 0x40000
  s_min_u32 s44, s44, 0xfc0000
  s_add_u32 s45, s45, 0x10000
  s_waitcnt vmcnt(12)
SL_kv_chk:
  v_readfirstlane_b32 s90, v243
  s_cmp_lt_u32 s90, 16
  s_cbranch_scc1 SL_kv_f
  s_waitcnt vmcnt(4)
SL_g_chk:
  v_max3_u32 v31, v36, v37, v38
  v_max_u32 v31, v31, v39
  v_cmp_eq_u32 vcc, -1, v31
  v_mfma_f32_16x16x32_bf16 v[40:43], v[24:27], v[36:39], 0
  s_cbranch_vccnz SL_g_f
  s_nop 6
  v_add_f32_dpp v45, v40, v40 row_ror:8 row_mask:0xf bank_mask:0xf
  v_add_f32_dpp v46, v41, v41 row_ror:8 row_mask:0xf bank_mask:0xf
  v_cvt_pk_bf16_f32 v44, v45, v46
  v_min_u32 v44, s54, v44
SL_pubmem:
  buffer_store_dword v44, v2, s[4:7], s41 offen sc1
  v_mov_b32 v148, v180
  v_mov_b32 v150, v181
  v_mov_b32 v152, v182
  v_mov_b32 v154, v183
  v_mov_b32 v149, v184
  v_mov_b32 v151, v185
  v_mov_b32 v153, v186
  v_mov_b32 v155, v187
  v_mov_b32 v156, v188
  v_mov_b32 v158, v189
  v_mov_b32 v160, v190
  v_mov_b32 v162, v191
  v_mov_b32 v157, v192
  v_mov_b32 v159, v193
  v_mov_b32 v161, v194
  v_mov_b32 v163, v195
  v_mov_b32 v164, v196
  v_mov_b32 v166, v197
  v_mov_b32 v168, v198
  v_mov_b32 v170, v199
  v_mov_b32 v165, v200
  v_mov_b32 v167, v201
  v_mov_b32 v169, v202
  v_mov_b32 v171, v203
  buffer_load_dwordx4 v[48:51], v3, s[4:7], s41 offen offset:0 sc1
  v_mov_b32 v172, v204
  v_mov_b32 v174, v205
  buffer_load_dwordx4 v[52:55], v3, s[4:7], s41 offen offset:1024 sc1
  v_mov_b32 v176, v206
  v_mov_b32 v178, v207
  buffer_load_dwordx4 v[56:59], v3, s[4:7], s41 offen offset:2048 sc1
  v_mov_b32 v173, v208
  v_mov_b32 v175, v209
  buffer_load_dwordx4 v[60:63], v3, s[4:7], s41 offen offset:3072 sc1
  v_mov_b32 v177, v210
  v_mov_b32 v179, v211
  s_waitcnt vmcnt(3)
  v_max3_u32 v31, v48, v49, v50
  v_max_u32 v31, v31, v51
  v_cmp_eq_u32 vcc, -1, v31
  s_cbranch_vccnz SL_m_f0
  v_smfmac_f32_16x16x64_bf16 v[64:67], v[48:51], a[0:7], v23
  s_waitcnt vmcnt(2)
  v_max3_u32 v31, v52, v53, v54
  v_max_u32 v31, v31, v55
  v_cmp_eq_u32 vcc, -1, v31
  v_smfmac_f32_16x16x64_bf16 v[68:71], v[48:51], a[8:15], v23
  v_smfmac_f32_16x16x64_bf16 v[72:75], v[48:51], a[16:23], v23
  v_smfmac_f32_16x16x64_bf16 v[76:79], v[48:51], a[24:31], v23
  s_cbranch_vccnz SL_m_f1
  v_smfmac_f32_16x16x64_bf16 v[64:67], v[52:55], a[48:55], v23
  s_waitcnt vmcnt(1)
  v_max3_u32 v31, v56, v57, v58
  v_max_u32 v31, v31, v59
  v_cmp_eq_u32 vcc, -1, v31
  v_smfmac_f32_16x16x64_bf16 v[68:71], v[52:55], a[56:63], v23
  v_smfmac_f32_16x16x64_bf16 v[72:75], v[52:55], a[64:71], v23
  v_smfmac_f32_16x16x64_bf16 v[76:79], v[52:55], a[72:79], v23
  s_cbranch_vccnz SL_m_f2
  v_smfmac_f32_16x16x64_bf16 v[64:67], v[56:59], a[96:103], v23
  s_waitcnt vmcnt(0)
  v_max3_u32 v31, v60, v61, v62
  v_max_u32 v31, v31, v63
  v_cmp_eq_u32 vcc, -1, v31
  v_smfmac_f32_16x16x64_bf16 v[68:71], v[56:59], a[104:111], v23
  v_smfmac_f32_16x16x64_bf16 v[72:75], v[56:59], a[112:119], v23
  v_smfmac_f32_16x16x64_bf16 v[76:79], v[56:59], a[120:127], v23
  s_cbranch_vccnz SL_m_f3
  v_smfmac_f32_16x16x64_bf16 v[64:67], v[60:63], a[144:151], v23
  v_smfmac_f32_16x16x64_bf16 v[68:71], v[60:63], a[152:159], v23
  v_smfmac_f32_16x16x64_bf16 v[72:75], v[60:63], a[160:167], v23
  v_smfmac_f32_16x16x64_bf16 v[76:79], v[60:63], a[168:175], v23
SL_m_done:
  s_nop 4
  v_pk_add_f32 v[88:89], v[64:65], v[66:67]
  v_pk_add_f32 v[90:91], v[68:69], v[70:71]
  ds_write_b128 v4, v[88:91] offset:0
  v_pk_add_f32 v[92:93], v[72:73], v[74:75]
  v_pk_add_f32 v[94:95], v[76:77], v[78:79]
  ds_write_b128 v4, v[92:95] offset:1088
  v_smfmac_f32_16x16x64_bf16 v[80:83], v[48:51], a[32:39], v23
  buffer_load_dwordx4 v[180:183], v12, s[4:7], s44 offen offset:0
  v_mov_b32 v36, 0
  v_smfmac_f32_16x16x64_bf16 v[84:87], v[48:51], a[40:47], v23
  buffer_load_dwordx4 v[184:187], v12, s[4:7], s44 offen offset:128
  v_mov_b32 v37, 0
  v_smfmac_f32_16x16x64_bf16 v[80:83], v[52:55], a[80:87], v23
  buffer_load_dwordx4 v[188:191], v12, s[4:7], s44 offen offset:1024
  v_mov_b32 v38, 0
  v_smfmac_f32_16x16x64_bf16 v[84:87], v[52:55], a[88:95], v23
  buffer_load_dwordx4 v[192:195], v12, s[4:7], s44 offen offset:1152
  v_mov_b32 v39, 0
  v_smfmac_f32_16x16x64_bf16 v[80:83], v[56:59], a[128:135], v23
  buffer_load_dwordx4 v[196:199], v13, s[4:7], s44 offen offset:0
  v_mov_b32 v40, 0
  s_waitcnt lgkmcnt(0)
  s_barrier
  ds_read2_b32 v[100:101], v6 offset0:0 offset1:2
  ds_read2_b32 v[102:103], v240 offset0:0 offset1:2
  ds_read2_b32 v[104:105], v241 offset0:0 offset1:2
  ds_read2_b32 v[106:107], v242 offset0:0 offset1:2
  v_smfmac_f32_16x16x64_bf16 v[84:87], v[56:59], a[136:143], v23
  v_mov_b32 v41, 0
  v_smfmac_f32_16x16x64_bf16 v[80:83], v[60:63], a[176:183], v23
  v_mov_b32 v42, 0
  v_smfmac_f32_16x16x64_bf16 v[84:87], v[60:63], a[184:191], v23
  v_mov_b32 v43, 0
  v_mov_b32 v44, 0
  v_mov_b32 v45, 0
  v_mov_b32 v46, 0
  v_mov_b32 v47, 0
  s_waitcnt lgkmcnt(2)
  v_pk_add_f32 v[100:101], v[100:101], v[102:103]
  s_waitcnt lgkmcnt(0)
  v_pk_add_f32 v[104:105], v[104:105], v[106:107]
  v_pk_add_f32 v[100:101], v[100:101], v[104:105]
  v_cvt_pk_bf16_f32 v112, v100, v101
  v_min_u32 v112, s54, v112
  buffer_store_dword v112, v7, s[4:7], s41 offen sc1
  v_pk_add_f32 v[96:97], v[80:81], v[82:83]
  v_pk_add_f32 v[98:99], v[84:85], v[86:87]
  ds_write_b128 v4, v[96:99] offset:2176
  v_mov_b64 v[212:213], 0
  v_mov_b64 v[214:215], 0
  v_mov_b64 v[216:217], 0
  v_mov_b64 v[218:219], 0
  v_mov_b64 v[220:221], 0
  v_mov_b64 v[222:223], 0
  v_mov_b64 v[224:225], 0
  v_mov_b64 v[226:227], 0
  v_mov_b64 v[228:229], 0
  v_mov_b64 v[230:231], 0
  s_waitcnt lgkmcnt(0)
  s_barrier
  ds_read_b64 v[88:89], v5 offset:0
  buffer_load_dwordx4 v[64:67], v9, s[4:7], s41 offen offset:0 sc1
  s_mov_b32 s42, s41
  s_add_u32 s90, s40, 1
  ds_read_b64 v[90:91], v5 offset:3264
  buffer_load_dwordx4 v[68:71], v9, s[4:7], s41 offen offset:1024 sc1
  s_and_b32 s90, s90, 3
  s_lshl_b32 s90, s90, 19
  ds_read_b64 v[92:93], v5 offset:6528
  buffer_load_dwordx4 v[72:75], v9, s[4:7], s41 offen offset:2048 sc1
  s_add_u32 s91, s90, 0x3800000
  s_add_u32 s55, s55, 0x40000
  ds_read_b64 v[94:95], v5 offset:9792
  buffer_load_dwordx4 v[76:79], v9, s[4:7], s41 offen offset:3072 sc1
  s_min_u32 s55, s55, 0xfc0000
  s_nop 0
  s_waitcnt lgkmcnt(2)
  v_pk_add_f32 v[88:89], v[88:89], v[90:91]
  s_waitcnt lgkmcnt(0)
  v_pk_add_f32 v[92:93], v[92:93], v[94:95]
  v_pk_add_f32 v[88:89], v[88:89], v[92:93]
  v_cvt_pk_bf16_f32 v113, v88, v89
  v_min_u32 v113, s54, v113
  buffer_store_dword v113, v8, s[4:7], s41 offen sc1
  s_add_u32 s8, s94, s55
  s_addc_u32 s9, s95, 0
  s_add_u32 s8, s8, s12
  s_addc_u32 s9, s9, 0
  s_add_u32 s10, s8, 0x1000000
  s_addc_u32 s11, s9, 0
  s_load_dword s16, s[8:9], 0
  s_load_dword s17, s[10:11], 0
  s_load_dword s18, s[8:9], 64
  s_load_dword s19, s[10:11], 64
  s_load_dword s20, s[8:9], 128
  s_load_dword s21, s[10:11], 128
  s_load_dword s22, s[8:9], 192
  s_load_dword s23, s[10:11], 192
  s_cmp_eq_u32 s40, 63
  s_cbranch_scc1 SL_last
  s_waitcnt vmcnt(4)
  v_max3_u32 v31, v64, v65, v66
  v_max_u32 v31, v31, v67
  v_cmp_eq_u32 vcc, -1, v31
  s_cbranch_vccnz SL_x_f0
  v_mfma_f32_16x16x32_bf16 v[44:47], v[64:67], v[64:67], v[44:47]
  s_waitcnt vmcnt(3)
  v_max3_u32 v31, v68, v69, v70
  v_max_u32 v31, v31, v71
  v_cmp_eq_u32 vcc, -1, v31
  v_mfma_f32_16x16x32_bf16 v[36:39], v[116:119], v[64:67], v[36:39]
  v_mfma_f32_16x16x32_bf16 v[40:43], v[132:135], v[64:67], v[40:43]
  s_cbranch_vccnz SL_x_f1
  v_mfma_f32_16x16x32_bf16 v[44:47], v[68:71], v[68:71], v[44:47]
  s_waitcnt vmcnt(2)
  v_max3_u32 v31, v72, v73, v74
  v_max_u32 v31, v31, v75
  v_cmp_eq_u32 vcc, -1, v31
  v_mfma_f32_16x16x32_bf16 v[36:39], v[120:123], v[68:71], v[36:39]
  v_mfma_f32_16x16x32_bf16 v[40:43], v[136:139], v[68:71], v[40:43]
  s_cbranch_vccnz SL_x_f2
  v_mfma_f32_16x16x32_bf16 v[44:47], v[72:75], v[72:75], v[44:47]
  s_waitcnt vmcnt(1)
  v_max3_u32 v31, v76, v77, v78
  v_max_u32 v31, v31, v79
  v_cmp_eq_u32 vcc, -1, v31
  v_mfma_f32_16x16x32_bf16 v[36:39], v[124:127], v[72:75], v[36:39]
  v_mfma_f32_16x16x32_bf16 v[40:43], v[140:143], v[72:75], v[40:43]
  s_cbranch_vccnz SL_x_f3
  v_mfma_f32_16x16x32_bf16 v[44:47], v[76:79], v[76:79], v[44:47]
  v_mfma_f32_16x16x32_bf16 v[36:39], v[128:131], v[76:79], v[36:39]
  v_mfma_f32_16x16x32_bf16 v[40:43], v[144:147], v[76:79], v[40:43]
SL_x_done:
  buffer_load_dwordx4 v[88:91], v10, s[4:7], s41 offen offset:0 sc1
  buffer_load_dwordx4 v[92:95], v10, s[4:7], s41 offen offset:1024 sc1
  s_mov_b64 vcc, s[48:49]
  s_nop 2
  v_max_f32 v30, v46, v47
  s_nop 0
  v_cndmask_b32_dpp v96, v40, v36, vcc quad_perm:[0,1,0,1] row_mask:0xf bank_mask:0xf
  v_cndmask_b32_dpp v97, v41, v37, vcc quad_perm:[0,1,0,1] row_mask:0xf bank_mask:0xf
  v_cndmask_b32_dpp v98, v42, v38, vcc quad_perm:[0,1,0,1] row_mask:0xf bank_mask:0xf
  v_cndmask_b32_dpp v99, v43, v39, vcc quad_perm:[0,1,0,1] row_mask:0xf bank_mask:0xf
  v_max3_f32 v29, v96, v97, v98
  s_nop 0
  v_max_f32_dpp v28, v30, v99 quad_perm:[0,1,0,1] row_mask:0xf bank_mask:0xf
  v_max_f32 v29, v29, v28
  s_nop 1
  v_max_f32_dpp v28, v29, v29 quad_perm:[2,3,0,1] row_mask:0xf bank_mask:0xf
  v_mov_b32 v29, v28
  s_nop 1
  v_permlane32_swap_b32 v28, v29
  v_max_f32 v28, v28, v29
  v_mov_b32 v29, v28
  s_nop 1
  v_permlane16_swap_b32 v28, v29
  v_max_f32 v28, v28, v29
  v_mul_f32 v28, s47, v28
  v_fma_f32 v96, v96, s47, -v28
  v_fma_f32 v97, v97, s47, -v28
  v_fma_f32 v98, v98, s47, -v28
  v_fma_f32 v99, v99, s47, -v28
  v_fma_f32 v46, v46, s47, -v28
  v_fma_f32 v47, v47, s47, -v28
  v_exp_f32 v96, v96
  v_exp_f32 v97, v97
  v_exp_f32 v98, v98
  v_exp_f32 v99, v99
  v_cvt_pk_bf16_f32 v236, v96, v97
  v_cvt_pk_bf16_f32 v237, v98, v99
  v_exp_f32 v46, v46
  v_mov_b32_dpp v100, v236 quad_perm:[0,1,0,1] row_mask:0xf bank_mask:0xf
  v_mov_b32_dpp v102, v236 quad_perm:[2,3,2,3] row_mask:0xf bank_mask:0xf
  v_mov_b32_dpp v101, v237 quad_perm:[0,1,0,1] row_mask:0xf bank_mask:0xf
  v_mov_b32_dpp v103, v237 quad_perm:[2,3,2,3] row_mask:0xf bank_mask:0xf
  v_exp_f32 v47, v47
  s_nop 0
  v_smfmac_f32_16x16x64_bf16 v[228:231], v[100:103], v[248:255], v23
  v_cvt_pk_bf16_f32 v238, v46, v47
  buffer_load_dwordx4 v[116:119], v11, s[4:7], s44 offen offset:0
  v_smfmac_f32_16x16x64_bf16 v[212:215], v[100:103], v[148:155], v23
  buffer_load_dwordx4 v[132:135], v11, s[4:7], s44 offen offset:64
  v_mov_b32_dpp v232, v238 quad_perm:[0,1,0,1] row_mask:0xf bank_mask:0xf
  v_smfmac_f32_16x16x64_bf16 v[216:219], v[100:103], v[156:163], v23
  buffer_load_dwordx4 v[120:123], v11, s[4:7], s44 offen offset:1024
  v_mov_b32_dpp v235, v238 quad_perm:[0,1,0,1] row_mask:0xf bank_mask:0xf
  v_smfmac_f32_16x16x64_bf16 v[220:223], v[100:103], v[164:171], v23
  buffer_load_dwordx4 v[136:139], v11, s[4:7], s44 offen offset:1088
  s_waitcnt vmcnt(4)
  v_max3_u32 v31, v88, v89, v90
  v_max3_u32 v31, v31, v91, v92
  v_smfmac_f32_16x16x32_bf16 v[228:231], v[232:233], v[248:251], v23
  v_max3_u32 v31, v31, v93, v94
  v_max_u32 v31, v31, v95
  v_cmp_eq_u32 vcc, -1, v31
  v_smfmac_f32_16x16x64_bf16 v[224:227], v[100:103], v[172:179], v23
  s_cbranch_vccnz SL_v_f
SL_v_ok:
  v_smfmac_f32_16x16x32_bf16 v[212:215], v[232:233], v[88:91], v23
  buffer_load_dwordx4 v[124:127], v11, s[4:7], s44 offen offset:2048
  buffer_load_dwordx4 v[140:143], v11, s[4:7], s44 offen offset:2112
  v_smfmac_f32_16x16x32_bf16 v[216:219], v[234:235], v[88:91], v23
  v_rcp_f32 v28, v228
  v_smfmac_f32_16x16x32_bf16 v[220:223], v[232:233], v[92:95], v23
  v_rcp_f32 v29, v229
  v_smfmac_f32_16x16x32_bf16 v[224:227], v[234:235], v[92:95], v23
  s_nop 0
  v_pk_mul_f32 v[212:213], v[212:213], v[28:29]
  v_pk_mul_f32 v[214:215], v[214:215], v[28:29]
  v_cvt_pk_bf16_f32 v104, v212, v214
  v_cvt_pk_bf16_f32 v108, v213, v215
  v_pk_mul_f32 v[216:217], v[216:217], v[28:29]
  v_pk_mul_f32 v[218:219], v[218:219], v[28:29]
  v_cvt_pk_bf16_f32 v105, v216, v218
  v_cvt_pk_bf16_f32 v109, v217, v219
  v_pk_mul_f32 v[220:221], v[220:221], v[28:29]
  v_pk_mul_f32 v[222:223], v[222:223], v[28:29]
  v_cvt_pk_bf16_f32 v106, v220, v222
  v_cvt_pk_bf16_f32 v110, v221, v223
  v_pk_mul_f32 v[224:225], v[224:225], v[28:29]
  v_pk_mul_f32 v[226:227], v[226:227], v[28:29]
  v_cvt_pk_bf16_f32 v107, v224, v226
  v_cvt_pk_bf16_f32 v111, v225, v227
  ds_write_b128 v14, v[104:107]
  ds_write_b128 v15, v[108:111]
  s_add_u32 s92, s40, 3
  s_min_u32 s92, s92, 63
  s_lshr_b32 s92, s92, 2
  s_lshl_b32 s92, s92, 9
  v_mov_b32 v246, s40
  s_waitcnt lgkmcnt(0)
  s_barrier
  ds_read_b128 v[48:51], v16 offset:0
  ds_read_b128 v[52:55], v16 offset:1024
  ds_read_b128 v[56:59], v16 offset:2048
  ds_read_b128 v[60:63], v16 offset:3072
  ds_read_b128 v[64:67], v16 offset:4096
  buffer_store_dword v22, v17, s[4:7], s43 offen sc1
  buffer_store_dword v112, v19, s[4:7], s45 offen sc1
  s_waitcnt lgkmcnt(4)
  v_smfmac_f32_16x16x64_bf16 v[32:35], v[48:51], a[192:199], v23
  ds_read_b128 v[68:71], v16 offset:5120
  buffer_store_dword v113, v20, s[4:7], s45 offen sc1
  s_waitcnt lgkmcnt(4)
  v_smfmac_f32_16x16x64_bf16 v[32:35], v[52:55], a[200:207], v23
  ds_read_b128 v[72:75], v16 offset:6144
  buffer_store_dword v246, v245, s[4:7], 0 offen sc1
  s_waitcnt lgkmcnt(4)
  v_smfmac_f32_16x16x64_bf16 v[32:35], v[56:59], a[208:215], v23
  ds_read_b128 v[76:79], v16 offset:7168
  buffer_load_dword v243, v244, s[4:7], s92 offen sc1
  s_waitcnt lgkmcnt(4)
  v_smfmac_f32_16x16x64_bf16 v[32:35], v[60:63], a[216:223], v23
  s_mov_b32 s13, s43
  s_waitcnt lgkmcnt(3)
  v_smfmac_f32_16x16x64_bf16 v[32:35], v[64:67], a[224:231], v23
  s_add_u32 s40, s40, 1
  s_waitcnt lgkmcnt(2)
  v_smfmac_f32_16x16x64_bf16 v[32:35], v[68:71], a[232:239], v23
  s_mov_b32 s41, s91
  s_waitcnt lgkmcnt(1)
  v_smfmac_f32_16x16x64_bf16 v[32:35], v[72:75], a[240:247], v23
  s_xor_b32 s43, s91, 0x100000
  s_waitcnt lgkmcnt(0)
  v_smfmac_f32_16x16x64_bf16 v[32:35], v[76:79], a[248:255], v23
  s_nop 7
  v_pk_add_f32 v[28:29], v[32:33], v[34:35]
  v_cvt_pk_bf16_f32 v28, v28, v29
  v_min_u32 v28, s54, v28
  buffer_store_dword v28, v17, s[4:7], s42 offen sc1
  buffer_store_dword v28, v18, s[4:7], s42 offen sc1
  s_branch SL_step
SL_last:
  buffer_store_dword v112, v19, s[4:7], s45 offen sc1
  buffer_store_dword v113, v20, s[4:7], s45 offen sc1
  s_branch L_join
SL_kv_f:
  s_sleep 8
  buffer_load_dword v243, v244, s[4:7], s92 offen sc1
  s_add_u32 s46, s46, 1
  s_cmp_ge_u32 s46, 131072
  s_cbranch_scc1 SL_rec_abort
  s_waitcnt vmcnt(0)
  s_branch SL_kv_chk
SL_g_f:
  s_mov_b64 exec, vcc
  buffer_load_dwordx4 v[36:39], v1, s[4:7], s42 offen sc1
  s_mov_b64 exec, -1
  s_add_u32 s46, s46, 1
  s_cmp_ge_u32 s46, 131072
  s_cbranch_scc1 SL_rec_abort
  s_waitcnt vmcnt(0)
  s_branch SL_g_chk
SL_m_f0:
  s_mov_b64 exec, vcc
  buffer_load_dwordx4 v[48:51], v3, s[4:7], s41 offen offset:0 sc1
  s_mov_b64 exec, -1
  s_waitcnt vmcnt(1)
  s_branch SL_m_0123_c1
SL_m_f1:
  s_mov_b64 exec, vcc
  buffer_load_dwordx4 v[52:55], v3, s[4:7], s41 offen offset:1024 sc1
  s_mov_b64 exec, -1
  s_waitcnt vmcnt(1)
  s_branch SL_m_123_c2
SL_m_f2:
  s_mov_b64 exec, vcc
  buffer_load_dwordx4 v[56:59], v3, s[4:7], s41 offen offset:2048 sc1
  s_mov_b64 exec, -1
  s_waitcnt vmcnt(1)
  s_branch SL_m_23_c3
SL_m_f3:
  s_mov_b64 exec, vcc
  buffer_load_dwordx4 v[60:63], v3, s[4:7], s41 offen offset:3072 sc1
  s_mov_b64 exec, -1
  s_nop 7
  s_branch SL_m_3_c3
SL_m_0_c0:
  v_max3_u32 v31, v48, v49, v50
  v_max_u32 v31, v31, v51
  v_cmp_eq_u32 vcc, -1, v31
  s_cbranch_vccz SL_m_0_ok0
SL_m_0_x0:
  s_mov_b64 exec, vcc
  buffer_load_dwordx4 v[48:51], v3, s[4:7], s41 offen offset:0 sc1
  s_mov_b64 exec, -1
  s_add_u32 s46, s46, 1
  s_cmp_ge_u32 s46, 131072
  s_cbranch_scc1 SL_rec_abort
  s_waitcnt vmcnt(2)
  s_branch SL_m_0_c0
SL_m_0_ok0:
  v_smfmac_f32_16x16x64_bf16 v[64:67], v[48:51], a[0:7], v23
  v_smfmac_f32_16x16x64_bf16 v[68:71], v[48:51], a[8:15], v23
  v_smfmac_f32_16x16x64_bf16 v[72:75], v[48:51], a[16:23], v23
  v_smfmac_f32_16x16x64_bf16 v[76:79], v[48:51], a[24:31], v23
  s_branch SL_m_done
SL_m_1_c1:
  v_max3_u32 v31, v52, v53, v54
  v_max_u32 v31, v31, v55
  v_cmp_eq_u32 vcc, -1, v31
  s_cbranch_vccz SL_m_1_ok1
SL_m_1_x1:
  s_mov_b64 exec, vcc
  buffer_load_dwordx4 v[52:55], v3, s[4:7], s41 offen offset:1024 sc1
  s_mov_b64 exec, -1
  s_add_u32 s46, s46, 1
  s_cmp_ge_u32 s46, 131072
  s_cbranch_scc1 SL_rec_abort
  s_waitcnt vmcnt(2)
  s_branch SL_m_1_c1
SL_m_1_ok1:
  v_smfmac_f32_16x16x64_bf16 v[64:67], v[52:55], a[48:55], v23
  v_smfmac_f32_16x16x64_bf16 v[68:71], v[52:55], a[56:63], v23
  v_smfmac_f32_16x16x64_bf16 v[72:75], v[52:55], a[64:71], v23
  v_smfmac_f32_16x16x64_bf16 v[76:79], v[52:55], a[72:79], v23
  s_branch SL_m_done
SL_m_2_c2:
  v_max3_u32 v31, v56, v57, v58
  v_max_u32 v31, v31, v59
  v_cmp_eq_u32 vcc, -1, v31
  s_cbranch_vccz SL_m_2_ok2
SL_m_2_x2:
  s_mov_b64 exec, vcc
  buffer_load_dwordx4 v[56:59], v3, s[4:7], s41 offen offset:2048 sc1
  s_mov_b64 exec, -1
  s_add_u32 s46, s46, 1
  s_cmp_ge_u32 s46, 131072
  s_cbranch_scc1 SL_rec_abort
  s_waitcnt vmcnt(2)
  s_branch SL_m_2_c2
SL_m_2_ok2:
  v_smfmac_f32_16x16x64_bf16 v[64:67], v[56:59], a[96:103], v23
  v_smfmac_f32_16x16x64_bf16 v[68:71], v[56:59], a[104:111], v23
  v_smfmac_f32_16x16x64_bf16 v[72:75], v[56:59], a[112:119], v23
  v_smfmac_f32_16x16x64_bf16 v[76:79], v[56:59], a[120:127], v23
  s_branch SL_m_done
SL_m_3_c3:
  v_max3_u32 v31, v60, v61, v62
  v_max_u32 v31, v31, v63
  v_cmp_eq_u32 vcc, -1, v31
  s_cbranch_vccz SL_m_3_ok3
SL_m_3_x3:
  s_mov_b64 exec, vcc
  buffer_load_dwordx4 v[60:63], v3, s[4:7], s41 offen offset:3072 sc1
  s_mov_b64 exec, -1
  s_add_u32 s46, s46, 1
  s_cmp_ge_u32 s46, 131072
  s_cbranch_scc1 SL_rec_abort
  s_waitcnt vmcnt(2)
  s_branch SL_m_3_c3
SL_m_3_ok3:
  v_smfmac_f32_16x16x64_bf16 v[64:67], v[60:63], a[144:151], v23
  v_smfmac_f32_16x16x64_bf16 v[68:71], v[60:63], a[152:159], v23
  v_smfmac_f32_16x16x64_bf16 v[72:75], v[60:63], a[160:167], v23
  v_smfmac_f32_16x16x64_bf16 v[76:79], v[60:63], a[168:175], v23
  s_branch SL_m_done
SL_m_01_c0:
  v_max3_u32 v31, v48, v49, v50
  v_max_u32 v31, v31, v51
  v_cmp_eq_u32 vcc, -1, v31
  s_cbranch_vccz SL_m_01_ok0
SL_m_01_x0:
  s_mov_b64 exec, vcc
  buffer_load_dwordx4 v[48:51], v3, s[4:7], s41 offen offset:0 sc1
  s_mov_b64 exec, -1
SL_m_01_c1:
  v_max3_u32 v31, v52, v53, v54
  v_max_u32 v31, v31, v55
  v_cmp_eq_u32 vcc, -1, v31
  s_cbranch_vccz SL_m_01_ok1
SL_m_01_x1:
  s_mov_b64 exec, vcc
  buffer_load_dwordx4 v[52:55], v3, s[4:7], s41 offen offset:1024 sc1
  s_mov_b64 exec, -1
  s_add_u32 s46, s46, 1
  s_cmp_ge_u32 s46, 131072
  s_cbranch_scc1 SL_rec_abort
  s_waitcnt vmcnt(4)
  s_branch SL_m_01_c0
SL_m_01_ok0:
  v_smfmac_f32_16x16x64_bf16 v[64:67], v[48:51], a[0:7], v23
  v_max3_u32 v31, v52, v53, v54
  v_max_u32 v31, v31, v55
  v_cmp_eq_u32 vcc, -1, v31
  v_smfmac_f32_16x16x64_bf16 v[68:71], v[48:51], a[8:15], v23
  v_smfmac_f32_16x16x64_bf16 v[72:75], v[48:51], a[16:23], v23
  v_smfmac_f32_16x16x64_bf16 v[76:79], v[48:51], a[24:31], v23
  s_cbranch_vccz SL_m_1_ok1
  s_branch SL_m_1_x1
SL_m_01_ok1:
  v_smfmac_f32_16x16x64_bf16 v[64:67], v[52:55], a[48:55], v23
  v_max3_u32 v31, v48, v49, v50
  v_max_u32 v31, v31, v51
  v_cmp_eq_u32 vcc, -1, v31
  v_smfmac_f32_16x16x64_bf16 v[68:71], v[52:55], a[56:63], v23
  v_smfmac_f32_16x16x64_bf16 v[72:75], v[52:55], a[64:71], v23
  v_smfmac_f32_16x16x64_bf16 v[76:79], v[52:55], a[72:79], v23
  s_cbranch_vccz SL_m_0_ok0
  s_branch SL_m_0_x0
SL_m_02_c0:
  v_max3_u32 v31, v48, v49, v50
  v_max_u32 v31, v31, v51
  v_cmp_eq_u32 vcc, -1, v31
  s_cbranch_vccz SL_m_02_ok0
SL_m_02_x0:
  s_mov_b64 exec, vcc
  buffer_load_dwordx4 v[48:51], v3, s[4:7], s41 offen offset:0 sc1
  s_mov_b64 exec, -1
SL_m_02_c2:
  v_max3_u32 v31, v56, v57, v58
  v_max_u32 v31, v31, v59
  v_cmp_eq_u32 vcc, -1, v31
  s_cbranch_vccz SL_m_02_ok2
SL_m_02_x2:
  s_mov_b64 exec, vcc
  buffer_load_dwordx4 v[56:59], v3, s[4:7], s41 offen offset:2048 sc1
  s_mov_b64 exec, -1
  s_add_u32 s46, s46, 1
  s_cmp_ge_u32 s46, 131072
  s_cbranch_scc1 SL_rec_abort
  s_waitcnt vmcnt(4)
  s_branch SL_m_02_c0
SL_m_02_ok0:
  v_smfmac_f32_16x16x64_bf16 v[64:67], v[48:51], a[0:7], v23
  v_max3_u32 v31, v56, v57, v58
  v_max_u32 v31, v31, v59
  v_cmp_eq_u32 vcc, -1, v31
  v_smfmac_f32_16x16x64_bf16 v[68:71], v[48:51], a[8:15], v23
  v_smfmac_f32_16x16x64_bf16 v[72:75], v[48:51], a[16:23], v23
  v_smfmac_f32_16x16x64_bf16 v[76:79], v[48:51], a[24:31], v23
  s_cbranch_vccz SL_m_2_ok2
  s_branch SL_m_2_x2
SL_m_02_ok2:
  v_smfmac_f32_16x16x64_bf16 v[64:67], v[56:59], a[96:103], v23
  v_max3_u32 v31, v48, v49, v50
  v_max_u32 v31, v31, v51
  v_cmp_eq_u32 vcc, -1, v31
  v_smfmac_f32_16x16x64_bf16 v[68:71], v[56:59], a[104:111], v23
  v_smfmac_f32_16x16x64_bf16 v[72:75], v[56:59], a[112:119], v23
  v_smfmac_f32_16x16x64_bf16 v[76:79], v[56:59], a[120:127], v23
  s_cbranch_vccz SL_m_0_ok0
  s_branch SL_m_0_x0
SL_m_03_c0:
  v_max3_u32 v31, v48, v49, v50
  v_max_u32 v31, v31, v51
  v_cmp_eq_u32 vcc, -1, v31
  s_cbranch_vccz SL_m_03_ok0
SL_m_03_x0:
  s_mov_b64 exec, vcc
  buffer_load_dwordx4 v[48:51], v3, s[4:7], s41 offen offset:0 sc1
  s_mov_b64 exec, -1
SL_m_03_c3:
  v_max3_u32 v31, v60, v61, v62
  v_max_u32 v31, v31, v63
  v_cmp_eq_u32 vcc, -1, v31
  s_cbranch_vccz SL_m_03_ok3
SL_m_03_x3:
  s_mov_b64 exec, vcc
  buffer_load_dwordx4 v[60:63], v3, s[4:7], s41 offen offset:3072 sc1
  s_mov_b64 exec, -1
  s_add_u32 s46, s46, 1
  s_cmp_ge_u32 s46, 131072
  s_cbranch_scc1 SL_rec_abort
  s_waitcnt vmcnt(4)
  s_branch SL_m_03_c0
SL_m_03_ok0:
  v_smfmac_f32_16x16x64_bf16 v[64:67], v[48:51], a[0:7], v23
  v_max3_u32 v31, v60, v61, v62
  v_max_u32 v31, v31, v63
  v_cmp_eq_u32 vcc, -1, v31
  v_smfmac_f32_16x16x64_bf16 v[68:71], v[48:51], a[8:15], v23
  v_smfmac_f32_16x16x64_bf16 v[72:75], v[48:51], a[16:23], v23
  v_smfmac_f32_16x16x64_bf16 v[76:79], v[48:51], a[24:31], v23
  s_cbranch_vccz SL_m_3_ok3
  s_branch SL_m_3_x3
SL_m_03_ok3:
  v_smfmac_f32_16x16x64_bf16 v[64:67], v[60:63], a[144:151], v23
  v_max3_u32 v31, v48, v49, v50
  v_max_u32 v31, v31, v51
  v_cmp_eq_u32 vcc, -1, v31
  v_smfmac_f32_16x16x64_bf16 v[68:71], v[60:63], a[152:159], v23
  v_smfmac_f32_16x16x64_bf16 v[72:75], v[60:63], a[160:167], v23
  v_smfmac_f32_16x16x64_bf16 v[76:79], v[60:63], a[168:175], v23
  s_cbranch_vccz SL_m_0_ok0
  s_branch SL_m_0_x0
SL_m_12_c1:
  v_max3_u32 v31, v52, v53, v54
  v_max_u32 v31, v31, v55
  v_cmp_eq_u32 vcc, -1, v31
  s_cbranch_vccz SL_m_12_ok1
SL_m_12_x1:
  s_mov_b64 exec, vcc
  buffer_load_dwordx4 v[52:55], v3, s[4:7], s41 offen offset:1024 sc1
  s_mov_b64 exec, -1
SL_m_12_c2:
  v_max3_u32 v31, v56, v57, v58
  v_max_u32 v31, v31, v59
  v_cmp_eq_u32 vcc, -1, v31
  s_cbranch_vccz SL_m_12_ok2
SL_m_12_x2:
  s_mov_b64 exec, vcc
  buffer_load_dwordx4 v[56:59], v3, s[4:7], s41 offen offset:2048 sc1
  s_mov_b64 exec, -1
  s_add_u32 s46, s46, 1
  s_cmp_ge_u32 s46, 131072
  s_cbranch_scc1 SL_rec_abort
  s_waitcnt vmcnt(4)
  s_branch SL_m_12_c1
SL_m_12_ok1:
  v_smfmac_f32_16x16x64_bf16 v[64:67], v[52:55], a[48:55], v23
  v_max3_u32 v31, v56, v57, v58
  v_max_u32 v31, v31, v59
  v_cmp_eq_u32 vcc, -1, v31
  v_smfmac_f32_16x16x64_bf16 v[68:71], v[52:55], a[56:63], v23
  v_smfmac_f32_16x16x64_bf16 v[72:75], v[52:55], a[64:71], v23
  v_smfmac_f32_16x16x64_bf16 v[76:79], v[52:55], a[72:79], v23
  s_cbranch_vccz SL_m_2_ok2
  s_branch SL_m_2_x2
SL_m_12_ok2:
  v_smfmac_f32_16x16x64_bf16 v[64:67], v[56:59], a[96:103], v23
  v_max3_u32 v31, v52, v53, v54
  v_max_u32 v31, v31, v55
  v_cmp_eq_u32 vcc, -1, v31
  v_smfmac_f32_16x16x64_bf16 v[68:71], v[56:59], a[104:111], v23
  v_smfmac_f32_16x16x64_bf16 v[72:75], v[56:59], a[112:119], v23
  v_smfmac_f32_16x16x64_bf16 v[76:79], v[56:59], a[120:127], v23
  s_cbranch_vccz SL_m_1_ok1
  s_branch SL_m_1_x1
SL_m_13_c1:
  v_max3_u32 v31, v52, v53, v54
  v_max_u32 v31, v31, v55
  v_cmp_eq_u32 vcc, -1, v31
  s_cbranch_vccz SL_m_13_ok1
SL_m_13_x1:
  s_mov_b64 exec, vcc
  buffer_load_dwordx4 v[52:55], v3, s[4:7], s41 offen offset:1024 sc1
  s_mov_b64 exec, -1
SL_m_13_c3:
  v_max3_u32 v31, v60, v61, v62
  v_max_u32 v31, v31, v63
  v_cmp_eq_u32 vcc, -1, v31
  s_cbranch_vccz SL_m_13_ok3
SL_m_13_x3:
  s_mov_b64 exec, vcc
  buffer_load_dwordx4 v[60:63], v3, s[4:7], s41 offen offset:3072 sc1
  s_mov_b64 exec, -1
  s_add_u32 s46, s46, 1
  s_cmp_ge_u32 s46, 131072
  s_cbranch_scc1 SL_rec_abort
  s_waitcnt vmcnt(4)
  s_branch SL_m_13_c1
SL_m_13_ok1:
  v_smfmac_f32_16x16x64_bf16 v[64:67], v[52:55], a[48:55], v23
  v_max3_u32 v31, v60, v61, v62
  v_max_u32 v31, v31, v63
  v_cmp_eq_u32 vcc, -1, v31
  v_smfmac_f32_16x16x64_bf16 v[68:71], v[52:55], a[56:63], v23
  v_smfmac_f32_16x16x64_bf16 v[72:75], v[52:55], a[64:71], v23
  v_smfmac_f32_16x16x64_bf16 v[76:79], v[52:55], a[72:79], v23
  s_cbranch_vccz SL_m_3_ok3
  s_branch SL_m_3_x3
SL_m_13_ok3:
  v_smfmac_f32_16x16x64_bf16 v[64:67], v[60:63], a[144:151], v23
  v_max3_u32 v31, v52, v53, v54
  v_max_u32 v31, v31, v55
  v_cmp_eq_u32 vcc, -1, v31
  v_smfmac_f32_16x16x64_bf16 v[68:71], v[60:63], a[152:159], v23
  v_smfmac_f32_16x16x64_bf16 v[72:75], v[60:63], a[160:167], v23
  v_smfmac_f32_16x16x64_bf16 v[76:79], v[60:63], a[168:175], v23
  s_cbranch_vccz SL_m_1_ok1
  s_branch SL_m_1_x1
SL_m_23_c2:
  v_max3_u32 v31, v56, v57, v58
  v_max_u32 v31, v31, v59
  v_cmp_eq_u32 vcc, -1, v31
  s_cbranch_vccz SL_m_23_ok2
SL_m_23_x2:
  s_mov_b64 exec, vcc
  buffer_load_dwordx4 v[56:59], v3, s[4:7], s41 offen offset:2048 sc1
  s_mov_b64 exec, -1
SL_m_23_c3:
  v_max3_u32 v31, v60, v61, v62
  v_max_u32 v31, v31, v63
  v_cmp_eq_u32 vcc, -1, v31
  s_cbranch_vccz SL_m_23_ok3
SL_m_23_x3:
  s_mov_b64 exec, vcc
  buffer_load_dwordx4 v[60:63], v3, s[4:7], s41 offen offset:3072 sc1
  s_mov_b64 exec, -1
  s_add_u32 s46, s46, 1
  s_cmp_ge_u32 s46, 131072
  s_cbranch_scc1 SL_rec_abort
  s_waitcnt vmcnt(4)
  s_branch SL_m_23_c2
SL_m_23_ok2:
  v_smfmac_f32_16x16x64_bf16 v[64:67], v[56:59], a[96:103], v23
  v_max3_u32 v31, v60, v61, v62
  v_max_u32 v31, v31, v63
  v_cmp_eq_u32 vcc, -1, v31
  v_smfmac_f32_16x16x64_bf16 v[68:71], v[56:59], a[104:111], v23
  v_smfmac_f32_16x16x64_bf16 v[72:75], v[56:59], a[112:119], v23
  v_smfmac_f32_16x16x64_bf16 v[76:79], v[56:59], a[120:127], v23
  s_cbranch_vccz SL_m_3_ok3
  s_branch SL_m_3_x3
SL_m_23_ok3:
  v_smfmac_f32_16x16x64_bf16 v[64:67], v[60:63], a[144:151], v23
  v_max3_u32 v31, v56, v57, v58
  v_max_u32 v31, v31, v59
  v_cmp_eq_u32 vcc, -1, v31
  v_smfmac_f32_16x16x64_bf16 v[68:71], v[60:63], a[152:159], v23
  v_smfmac_f32_16x16x64_bf16 v[72:75], v[60:63], a[160:167], v23
  v_smfmac_f32_16x16x64_bf16 v[76:79], v[60:63], a[168:175], v23
  s_cbranch_vccz SL_m_2_ok2
  s_branch SL_m_2_x2
SL_m_012_c0:
  v_max3_u32 v31, v48, v49, v50
  v_max_u32 v31, v31, v51
  v_cmp_eq_u32 vcc, -1, v31
  s_cbranch_vccz SL_m_012_ok0
SL_m_012_x0:
  s_mov_b64 exec, vcc
  buffer_load_dwordx4 v[48:51], v3, s[4:7], s41 offen offset:0 sc1
  s_mov_b64 exec, -1
SL_m_012_c1:
  v_max3_u32 v31, v52, v53, v54
  v_max_u32 v31, v31, v55
  v_cmp_eq_u32 vcc, -1, v31
  s_cbranch_vccz SL_m_012_ok1
SL_m_012_x1:
  s_mov_b64 exec, vcc
  buffer_load_dwordx4 v[52:55], v3, s[4:7], s41 offen offset:1024 sc1
  s_mov_b64 exec, -1
SL_m_012_c2:
  v_max3_u32 v31, v56, v57, v58
  v_max_u32 v31, v31, v59
  v_cmp_eq_u32 vcc, -1, v31
  s_cbranch_vccz SL_m_012_ok2
SL_m_012_x2:
  s_mov_b64 exec, vcc
  buffer_load_dwordx4 v[56:59], v3, s[4:7], s41 offen offset:2048 sc1
  s_mov_b64 exec, -1
  s_add_u32 s46, s46, 1
  s_cmp_ge_u32 s46, 131072
  s_cbranch_scc1 SL_rec_abort
  s_waitcnt vmcnt(4)
  s_branch SL_m_012_c0
SL_m_012_ok0:
  v_smfmac_f32_16x16x64_bf16 v[64:67], v[48:51], a[0:7], v23
  v_max3_u32 v31, v52, v53, v54
  v_max_u32 v31, v31, v55
  v_cmp_eq_u32 vcc, -1, v31
  v_smfmac_f32_16x16x64_bf16 v[68:71], v[48:51], a[8:15], v23
  v_smfmac_f32_16x16x64_bf16 v[72:75], v[48:51], a[16:23], v23
  v_smfmac_f32_16x16x64_bf16 v[76:79], v[48:51], a[24:31], v23
  s_cbranch_vccz SL_m_12_ok1
  s_branch SL_m_12_x1
SL_m_012_ok1:
  v_smfmac_f32_16x16x64_bf16 v[64:67], v[52:55], a[48:55], v23
  v_max3_u32 v31, v56, v57, v58
  v_max_u32 v31, v31, v59
  v_cmp_eq_u32 vcc, -1, v31
  v_smfmac_f32_16x16x64_bf16 v[68:71], v[52:55], a[56:63], v23
  v_smfmac_f32_16x16x64_bf16 v[72:75], v[52:55], a[64:71], v23
  v_smfmac_f32_16x16x64_bf16 v[76:79], v[52:55], a[72:79], v23
  s_cbranch_vccz SL_m_02_ok2
  s_branch SL_m_02_x2
SL_m_012_ok2:
  v_smfmac_f32_16x16x64_bf16 v[64:67], v[56:59], a[96:103], v23
  v_max3_u32 v31, v48, v49, v50
  v_max_u32 v31, v31, v51
  v_cmp_eq_u32 vcc, -1, v31
  v_smfmac_f32_16x16x64_bf16 v[68:71], v[56:59], a[104:111], v23
  v_smfmac_f32_16x16x64_bf16 v[72:75], v[56:59], a[112:119], v23
  v_smfmac_f32_16x16x64_bf16 v[76:79], v[56:59], a[120:127], v23
  s_cbranch_vccz SL_m_01_ok0
  s_branch SL_m_01_x0
SL_m_013_c0:
  v_max3_u32 v31, v48, v49, v50
  v_max_u32 v31, v31, v51
  v_cmp_eq_u32 vcc, -1, v31
  s_cbranch_vccz SL_m_013_ok0
SL_m_013_x0:
  s_mov_b64 exec, vcc
  buffer_load_dwordx4 v[48:51], v3, s[4:7], s41 offen offset:0 sc1
  s_mov_b64 exec, -1
SL_m_013_c1:
  v_max3_u32 v31, v52, v53, v54
  v_max_u32 v31, v31, v55
  v_cmp_eq_u32 vcc, -1, v31
  s_cbranch_vccz SL_m_013_ok1
SL_m_013_x1:
  s_mov_b64 exec, vcc
  buffer_load_dwordx4 v[52:55], v3, s[4:7], s41 offen offset:1024 sc1
  s_mov_b64 exec, -1
SL_m_013_c3:
  v_max3_u32 v31, v60, v61, v62
  v_max_u32 v31, v31, v63
  v_cmp_eq_u32 vcc, -1, v31
  s_cbranch_vccz SL_m_013_ok3
SL_m_013_x3:
  s_mov_b64 exec, vcc
  buffer_load_dwordx4 v[60:63], v3, s[4:7], s41 offen offset:3072 sc1
  s_mov_b64 exec, -1
  s_add_u32 s46, s46, 1
  s_cmp_ge_u32 s46, 131072
  s_cbranch_scc1 SL_rec_abort
  s_waitcnt vmcnt(4)
  s_branch SL_m_013_c0
SL_m_013_ok0:
  v_smfmac_f32_16x16x64_bf16 v[64:67], v[48:51], a[0:7], v23
  v_max3_u32 v31, v52, v53, v54
  v_max_u32 v31, v31, v55
  v_cmp_eq_u32 vcc, -1, v31
  v_smfmac_f32_16x16x64_bf16 v[68:71], v[48:51], a[8:15], v23
  v_smfmac_f32_16x16x64_bf16 v[72:75], v[48:51], a[16:23], v23
  v_smfmac_f32_16x16x64_bf16 v[76:79], v[48:51], a[24:31], v23
  s_cbranch_vccz SL_m_13_ok1
  s_branch SL_m_13_x1
SL_m_013_ok1:
  v_smfmac_f32_16x16x64_bf16 v[64:67], v[52:55], a[48:55], v23
  v_max3_u32 v31, v60, v61, v62
  v_max_u32 v31, v31, v63
  v_cmp_eq_u32 vcc, -1, v31
  v_smfmac_f32_16x16x64_bf16 v[68:71], v[52:55], a[56:63], v23
  v_smfmac_f32_16x16x64_bf16 v[72:75], v[52:55], a[64:71], v23
  v_smfmac_f32_16x16x64_bf16 v[76:79], v[52:55], a[72:79], v23
  s_cbranch_vccz SL_m_03_ok3
  s_branch SL_m_03_x3
SL_m_013_ok3:
  v_smfmac_f32_16x16x64_bf16 v[64:67], v[60:63], a[144:151], v23
  v_max3_u32 v31, v48, v49, v50
  v_max_u32 v31, v31, v51
  v_cmp_eq_u32 vcc, -1, v31
  v_smfmac_f32_16x16x64_bf16 v[68:71], v[60:63], a[152:159], v23
  v_smfmac_f32_16x16x64_bf16 v[72:75], v[60:63], a[160:167], v23
  v_smfmac_f32_16x16x64_bf16 v[76:79], v[60:63], a[168:175], v23
  s_cbranch_vccz SL_m_01_ok0
  s_branch SL_m_01_x0
SL_m_023_c0:
  v_max3_u32 v31, v48, v49, v50
  v_max_u32 v31, v31, v51
  v_cmp_eq_u32 vcc, -1, v31
  s_cbranch_vccz SL_m_023_ok0
SL_m_023_x0:
  s_mov_b64 exec, vcc
  buffer_load_dwordx4 v[48:51], v3, s[4:7], s41 offen offset:0 sc1
  s_mov_b64 exec, -1
SL_m_023_c2:
  v_max3_u32 v31, v56, v57, v58
  v_max_u32 v31, v31, v59
  v_cmp_eq_u32 vcc, -1, v31
  s_cbranch_vccz SL_m_023_ok2
SL_m_023_x2:
  s_mov_b64 exec, vcc
  buffer_load_dwordx4 v[56:59], v3, s[4:7], s41 offen offset:2048 sc1
  s_mov_b64 exec, -1
SL_m_023_c3:
  v_max3_u32 v31, v60, v61, v62
  v_max_u32 v31, v31, v63
  v_cmp_eq_u32 vcc, -1, v31
  s_cbranch_vccz SL_m_023_ok3
SL_m_023_x3:
  s_mov_b64 exec, vcc
  buffer_load_dwordx4 v[60:63], v3, s[4:7], s41 offen offset:3072 sc1
  s_mov_b64 exec, -1
  s_add_u32 s46, s46, 1
  s_cmp_ge_u32 s46, 131072
  s_cbranch_scc1 SL_rec_abort
  s_waitcnt vmcnt(4)
  s_branch SL_m_023_c0
SL_m_023_ok0:
  v_smfmac_f32_16x16x64_bf16 v[64:67], v[48:51], a[0:7], v23
  v_max3_u32 v31, v56, v57, v58
  v_max_u32 v31, v31, v59
  v_cmp_eq_u32 vcc, -1, v31
  v_smfmac_f32_16x16x64_bf16 v[68:71], v[48:51], a[8:15], v23
  v_smfmac_f32_16x16x64_bf16 v[72:75], v[48:51], a[16:23], v23
  v_smfmac_f32_16x16x64_bf16 v[76:79], v[48:51], a[24:31], v23
  s_cbranch_vccz SL_m_23_ok2
  s_branch SL_m_23_x2
SL_m_023_ok2:
  v_smfmac_f32_16x16x64_bf16 v[64:67], v[56:59], a[96:103], v23
  v_max3_u32 v31, v60, v61, v62
  v_max_u32 v31, v31, v63
  v_cmp_eq_u32 vcc, -1, v31
  v_smfmac_f32_16x16x64_bf16 v[68:71], v[56:59], a[104:111], v23
  v_smfmac_f32_16x16x64_bf16 v[72:75], v[56:59], a[112:119], v23
  v_smfmac_f32_16x16x64_bf16 v[76:79], v[56:59], a[120:127], v23
  s_cbranch_vccz SL_m_03_ok3
  s_branch SL_m_03_x3
SL_m_023_ok3:
  v_smfmac_f32_16x16x64_bf16 v[64:67], v[60:63], a[144:151], v23
  v_max3_u32 v31, v48, v49, v50
  v_max_u32 v31, v31, v51
  v_cmp_eq_u32 vcc, -1, v31
  v_smfmac_f32_16x16x64_bf16 v[68:71], v[60:63], a[152:159], v23
  v_smfmac_f32_16x16x64_bf16 v[72:75], v[60:63], a[160:167], v23
  v_smfmac_f32_16x16x64_bf16 v[76:79], v[60:63], a[168:175], v23
  s_cbranch_vccz SL_m_02_ok0
  s_branch SL_m_02_x0
SL_m_123_c1:
  v_max3_u32 v31, v52, v53, v54
  v_max_u32 v31, v31, v55
  v_cmp_eq_u32 vcc, -1, v31
  s_cbranch_vccz SL_m_123_ok1
SL_m_123_x1:
  s_mov_b64 exec, vcc
  buffer_load_dwordx4 v[52:55], v3, s[4:7], s41 offen offset:1024 sc1
  s_mov_b64 exec, -1
SL_m_123_c2:
  v_max3_u32 v31, v56, v57, v58
  v_max_u32 v31, v31, v59
  v_cmp_eq_u32 vcc, -1, v31
  s_cbranch_vccz SL_m_123_ok2
SL_m_123_x2:
  s_mov_b64 exec, vcc
  buffer_load_dwordx4 v[56:59], v3, s[4:7], s41 offen offset:2048 sc1
  s_mov_b64 exec, -1
SL_m_123_c3:
  v_max3_u32 v31, v60, v61, v62
  v_max_u32 v31, v31, v63
  v_cmp_eq_u32 vcc, -1, v31
  s_cbranch_vccz SL_m_123_ok3
SL_m_123_x3:
  s_mov_b64 exec, vcc
  buffer_load_dwordx4 v[60:63], v3, s[4:7], s41 offen offset:3072 sc1
  s_mov_b64 exec, -1
  s_add_u32 s46, s46, 1
  s_cmp_ge_u32 s46, 131072
  s_cbranch_scc1 SL_rec_abort
  s_waitcnt vmcnt(4)
  s_branch SL_m_123_c1
SL_m_123_ok1:
  v_smfmac_f32_16x16x64_bf16 v[64:67], v[52:55], a[48:55], v23
  v_max3_u32 v31, v56, v57, v58
  v_max_u32 v31, v31, v59
  v_cmp_eq_u32 vcc, -1, v31
  v_smfmac_f32_16x16x64_bf16 v[68:71], v[52:55], a[56:63], v23
  v_smfmac_f32_16x16x64_bf16 v[72:75], v[52:55], a[64:71], v23
  v_smfmac_f32_16x16x64_bf16 v[76:79], v[52:55], a[72:79], v23
  s_cbranch_vccz SL_m_23_ok2
  s_branch SL_m_23_x2
SL_m_123_ok2:
  v_smfmac_f32_16x16x64_bf16 v[64:67], v[56:59], a[96:103], v23
  v_max3_u32 v31, v60, v61, v62
  v_max_u32 v31, v31, v63
  v_cmp_eq_u32 vcc, -1, v31
  v_smfmac_f32_16x16x64_bf16 v[68:71], v[56:59], a[104:111], v23
  v_smfmac_f32_16x16x64_bf16 v[72:75], v[56:59], a[112:119], v23
  v_smfmac_f32_16x16x64_bf16 v[76:79], v[56:59], a[120:127], v23
  s_cbranch_vccz SL_m_13_ok3
  s_branch SL_m_13_x3
SL_m_123_ok3:
  v_smfmac_f32_16x16x64_bf16 v[64:67], v[60:63], a[144:151], v23
  v_max3_u32 v31, v52, v53, v54
  v_max_u32 v31, v31, v55
  v_cmp_eq_u32 vcc, -1, v31
  v_smfmac_f32_16x16x64_bf16 v[68:71], v[60:63], a[152:159], v23
  v_smfmac_f32_16x16x64_bf16 v[72:75], v[60:63], a[160:167], v23
  v_smfmac_f32_16x16x64_bf16 v[76:79], v[60:63], a[168:175], v23
  s_cbranch_vccz SL_m_12_ok1
  s_branch SL_m_12_x1
SL_m_0123_c0:
  v_max3_u32 v31, v48, v49, v50
  v_max_u32 v31, v31, v51
  v_cmp_eq_u32 vcc, -1, v31
  s_cbranch_vccz SL_m_0123_ok0
SL_m_0123_x0:
  s_mov_b64 exec, vcc
  buffer_load_dwordx4 v[48:51], v3, s[4:7], s41 offen offset:0 sc1
  s_mov_b64 exec, -1
SL_m_0123_c1:
  v_max3_u32 v31, v52, v53, v54
  v_max_u32 v31, v31, v55
  v_cmp_eq_u32 vcc, -1, v31
  s_cbranch_vccz SL_m_0123_ok1
SL_m_0123_x1:
  s_mov_b64 exec, vcc
  buffer_load_dwordx4 v[52:55], v3, s[4:7], s41 offen offset:1024 sc1
  s_mov_b64 exec, -1
SL_m_0123_c2:
  v_max3_u32 v31, v56, v57, v58
  v_max_u32 v31, v31, v59
  v_cmp_eq_u32 vcc, -1, v31
  s_cbranch_vccz SL_m_0123_ok2
SL_m_0123_x2:
  s_mov_b64 exec, vcc
  buffer_load_dwordx4 v[56:59], v3, s[4:7], s41 offen offset:2048 sc1
  s_mov_b64 exec, -1
SL_m_0123_c3:
  v_max3_u32 v31, v60, v61, v62
  v_max_u32 v31, v31, v63
  v_cmp_eq_u32 vcc, -1, v31
  s_cbranch_vccz SL_m_0123_ok3
SL_m_0123_x3:
  s_mov_b64 exec, vcc
  buffer_load_dwordx4 v[60:63], v3, s[4:7], s41 offen offset:3072 sc1
  s_mov_b64 exec, -1
  s_add_u32 s46, s46, 1
  s_cmp_ge_u32 s46, 131072
  s_cbranch_scc1 SL_rec_abort
  s_waitcnt vmcnt(4)
  s_branch SL_m_0123_c0
SL_m_0123_ok0:
  v_smfmac_f32_16x16x64_bf16 v[64:67], v[48:51], a[0:7], v23
  v_max3_u32 v31, v52, v53, v54
  v_max_u32 v31, v31, v55
  v_cmp_eq_u32 vcc, -1, v31
  v_smfmac_f32_16x16x64_bf16 v[68:71], v[48:51], a[8:15], v23
  v_smfmac_f32_16x16x64_bf16 v[72:75], v[48:51], a[16:23], v23
  v_smfmac_f32_16x16x64_bf16 v[76:79], v[48:51], a[24:31], v23
  s_cbranch_vccz SL_m_123_ok1
  s_branch SL_m_123_x1
SL_m_0123_ok1:
  v_smfmac_f32_16x16x64_bf16 v[64:67], v[52:55], a[48:55], v23
  v_max3_u32 v31, v56, v57, v58
  v_max_u32 v31, v31, v59
  v_cmp_eq_u32 vcc, -1, v31
  v_smfmac_f32_16x16x64_bf16 v[68:71], v[52:55], a[56:63], v23
  v_smfmac_f32_16x16x64_bf16 v[72:75], v[52:55], a[64:71], v23
  v_smfmac_f32_16x16x64_bf16 v[76:79], v[52:55], a[72:79], v23
  s_cbranch_vccz SL_m_023_ok2
  s_branch SL_m_023_x2
SL_m_0123_ok2:
  v_smfmac_f32_16x16x64_bf16 v[64:67], v[56:59], a[96:103], v23
  v_max3_u32 v31, v60, v61, v62
  v_max_u32 v31, v31, v63
  v_cmp_eq_u32 vcc, -1, v31
  v_smfmac_f32_16x16x64_bf16 v[68:71], v[56:59], a[104:111], v23
  v_smfmac_f32_16x16x64_bf16 v[72:75], v[56:59], a[112:119], v23
  v_smfmac_f32_16x16x64_bf16 v[76:79], v[56:59], a[120:127], v23
  s_cbranch_vccz SL_m_013_ok3
  s_branch SL_m_013_x3
SL_m_0123_ok3:
  v_smfmac_f32_16x16x64_bf16 v[64:67], v[60:63], a[144:151], v23
  v_max3_u32 v31, v48, v49, v50
  v_max_u32 v31, v31, v51
  v_cmp_eq_u32 vcc, -1, v31
  v_smfmac_f32_16x16x64_bf16 v[68:71], v[60:63], a[152:159], v23
  v_smfmac_f32_16x16x64_bf16 v[72:75], v[60:63], a[160:167], v23
  v_smfmac_f32_16x16x64_bf16 v[76:79], v[60:63], a[168:175], v23
  s_cbranch_vccz SL_m_012_ok0
  s_branch SL_m_012_x0
SL_x_f0:
  s_mov_b64 exec, vcc
  buffer_load_dwordx4 v[64:67], v9, s[4:7], s41 offen offset:0 sc1
  s_mov_b64 exec, -1
  s_waitcnt vmcnt(2)
  s_branch SL_x_0123_c1
SL_x_f1:
  s_mov_b64 exec, vcc
  buffer_load_dwordx4 v[68:71], v9, s[4:7], s41 offen offset:1024 sc1
  s_mov_b64 exec, -1
  s_waitcnt vmcnt(2)
  s_branch SL_x_123_c2
SL_x_f2:
  s_mov_b64 exec, vcc
  buffer_load_dwordx4 v[72:75], v9, s[4:7], s41 offen offset:2048 sc1
  s_mov_b64 exec, -1
  s_waitcnt vmcnt(2)
  s_branch SL_x_23_c3
SL_x_f3:
  s_mov_b64 exec, vcc
  buffer_load_dwordx4 v[76:79], v9, s[4:7], s41 offen offset:3072 sc1
  s_mov_b64 exec, -1
  s_nop 7
  s_branch SL_x_3_c3
SL_x_0_c0:
  v_max3_u32 v31, v64, v65, v66
  v_max_u32 v31, v31, v67
  v_cmp_eq_u32 vcc, -1, v31
  s_cbranch_vccz SL_x_0_ok0
SL_x_0_x0:
  s_mov_b64 exec, vcc
  buffer_load_dwordx4 v[64:67], v9, s[4:7], s41 offen offset:0 sc1
  s_mov_b64 exec, -1
  s_add_u32 s46, s46, 1
  s_cmp_ge_u32 s46, 131072
  s_cbranch_scc1 SL_rec_abort
  s_waitcnt vmcnt(2)
  s_branch SL_x_0_c0
SL_x_0_ok0:
  v_mfma_f32_16x16x32_bf16 v[44:47], v[64:67], v[64:67], v[44:47]
  v_mfma_f32_16x16x32_bf16 v[36:39], v[116:119], v[64:67], v[36:39]
  v_mfma_f32_16x16x32_bf16 v[40:43], v[132:135], v[64:67], v[40:43]
  s_branch SL_x_done
SL_x_1_c1:
  v_max3_u32 v31, v68, v69, v70
  v_max_u32 v31, v31, v71
  v_cmp_eq_u32 vcc, -1, v31
  s_cbranch_vccz SL_x_1_ok1
SL_x_1_x1:
  s_mov_b64 exec, vcc
  buffer_load_dwordx4 v[68:71], v9, s[4:7], s41 offen offset:1024 sc1
  s_mov_b64 exec, -1
  s_add_u32 s46, s46, 1
  s_cmp_ge_u32 s46, 131072
  s_cbranch_scc1 SL_rec_abort
  s_waitcnt vmcnt(2)
  s_branch SL_x_1_c1
SL_x_1_ok1:
  v_mfma_f32_16x16x32_bf16 v[44:47], v[68:71], v[68:71], v[44:47]
  v_mfma_f32_16x16x32_bf16 v[36:39], v[120:123], v[68:71], v[36:39]
  v_mfma_f32_16x16x32_bf16 v[40:43], v[136:139], v[68:71], v[40:43]
  s_branch SL_x_done
SL_x_2_c2:
  v_max3_u32 v31, v72, v73, v74
  v_max_u32 v31, v31, v75
  v_cmp_eq_u32 vcc, -1, v31
  s_cbranch_vccz SL_x_2_ok2
SL_x_2_x2:
  s_mov_b64 exec, vcc
  buffer_load_dwordx4 v[72:75], v9, s[4:7], s41 offen offset:2048 sc1
  s_mov_b64 exec, -1
  s_add_u32 s46, s46, 1
  s_cmp_ge_u32 s46, 131072
  s_cbranch_scc1 SL_rec_abort
  s_waitcnt vmcnt(2)
  s_branch SL_x_2_c2
SL_x_2_ok2:
  v_mfma_f32_16x16x32_bf16 v[44:47], v[72:75], v[72:75], v[44:47]
  v_mfma_f32_16x16x32_bf16 v[36:39], v[124:127], v[72:75], v[36:39]
  v_mfma_f32_16x16x32_bf16 v[40:43], v[140:143], v[72:75], v[40:43]
  s_branch SL_x_done
SL_x_3_c3:
  v_max3_u32 v31, v76, v77, v78
  v_max_u32 v31, v31, v79
  v_cmp_eq_u32 vcc, -1, v31
  s_cbranch_vccz SL_x_3_ok3
SL_x_3_x3:
  s_mov_b64 exec, vcc
  buffer_load_dwordx4 v[76:79], v9, s[4:7], s41 offen offset:3072 sc1
  s_mov_b64 exec, -1
  s_add_u32 s46, s46, 1
  s_cmp_ge_u32 s46, 131072
  s_cbranch_scc1 SL_rec_abort
  s_waitcnt vmcnt(2)
  s_branch SL_x_3_c3
SL_x_3_ok3:
  v_mfma_f32_16x16x32_bf16 v[44:47], v[76:79], v[76:79], v[44:47]
  v_mfma_f32_16x16x32_bf16 v[36:39], v[128:131], v[76:79], v[36:39]
  v_mfma_f32_16x16x32_bf16 v[40:43], v[144:147], v[76:79], v[40:43]
  s_branch SL_x_done
SL_x_01_c0:
  v_max3_u32 v31, v64, v65, v66
  v_max_u32 v31, v31, v67
  v_cmp_eq_u32 vcc, -1, v31
  s_cbranch_vccz SL_x_01_ok0
SL_x_01_x0:
  s_mov_b64 exec, vcc
  buffer_load_dwordx4 v[64:67], v9, s[4:7], s41 offen offset:0 sc1
  s_mov_b64 exec, -1
SL_x_01_c1:
  v_max3_u32 v31, v68, v69, v70
  v_max_u32 v31, v31, v71
  v_cmp_eq_u32 vcc, -1, v31
  s_cbranch_vccz SL_x_01_ok1
SL_x_01_x1:
  s_mov_b64 exec, vcc
  buffer_load_dwordx4 v[68:71], v9, s[4:7], s41 offen offset:1024 sc1
  s_mov_b64 exec, -1
  s_add_u32 s46, s46, 1
  s_cmp_ge_u32 s46, 131072
  s_cbranch_scc1 SL_rec_abort
  s_waitcnt vmcnt(4)
  s_branch SL_x_01_c0
SL_x_01_ok0:
  v_mfma_f32_16x16x32_bf16 v[44:47], v[64:67], v[64:67], v[44:47]
  v_max3_u32 v31, v68, v69, v70
  v_max_u32 v31, v31, v71
  v_cmp_eq_u32 vcc, -1, v31
  v_mfma_f32_16x16x32_bf16 v[36:39], v[116:119], v[64:67], v[36:39]
  v_mfma_f32_16x16x32_bf16 v[40:43], v[132:135], v[64:67], v[40:43]
  s_cbranch_vccz SL_x_1_ok1
  s_branch SL_x_1_x1
SL_x_01_ok1:
  v_mfma_f32_16x16x32_bf16 v[44:47], v[68:71], v[68:71], v[44:47]
  v_max3_u32 v31, v64, v65, v66
  v_max_u32 v31, v31, v67
  v_cmp_eq_u32 vcc, -1, v31
  v_mfma_f32_16x16x32_bf16 v[36:39], v[120:123], v[68:71], v[36:39]
  v_mfma_f32_16x16x32_bf16 v[40:43], v[136:139], v[68:71], v[40:43]
  s_cbranch_vccz SL_x_0_ok0
  s_branch SL_x_0_x0
SL_x_02_c0:
  v_max3_u32 v31, v64, v65, v66
  v_max_u32 v31, v31, v67
  v_cmp_eq_u32 vcc, -1, v31
  s_cbranch_vccz SL_x_02_ok0
SL_x_02_x0:
  s_mov_b64 exec, vcc
  buffer_load_dwordx4 v[64:67], v9, s[4:7], s41 offen offset:0 sc1
  s_mov_b64 exec, -1
SL_x_02_c2:
  v_max3_u32 v31, v72, v73, v74
  v_max_u32 v31, v31, v75
  v_cmp_eq_u32 vcc, -1, v31
  s_cbranch_vccz SL_x_02_ok2
SL_x_02_x2:
  s_mov_b64 exec, vcc
  buffer_load_dwordx4 v[72:75], v9, s[4:7], s41 offen offset:2048 sc1
  s_mov_b64 exec, -1
  s_add_u32 s46, s46, 1
  s_cmp_ge_u32 s46, 131072
  s_cbranch_scc1 SL_rec_abort
  s_waitcnt vmcnt(4)
  s_branch SL_x_02_c0
SL_x_02_ok0:
  v_mfma_f32_16x16x32_bf16 v[44:47], v[64:67], v[64:67], v[44:47]
  v_max3_u32 v31, v72, v73, v74
  v_max_u32 v31, v31, v75
  v_cmp_eq_u32 vcc, -1, v31
  v_mfma_f32_16x16x32_bf16 v[36:39], v[116:119], v[64:67], v[36:39]
  v_mfma_f32_16x16x32_bf16 v[40:43], v[132:135], v[64:67], v[40:43]
  s_cbranch_vccz SL_x_2_ok2
  s_branch SL_x_2_x2
SL_x_02_ok2:
  v_mfma_f32_16x16x32_bf16 v[44:47], v[72:75], v[72:75], v[44:47]
  v_max3_u32 v31, v64, v65, v66
  v_max_u32 v31, v31, v67
  v_cmp_eq_u32 vcc, -1, v31
  v_mfma_f32_16x16x32_bf16 v[36:39], v[124:127], v[72:75], v[36:39]
  v_mfma_f32_16x16x32_bf16 v[40:43], v[140:143], v[72:75], v[40:43]
  s_cbranch_vccz SL_x_0_ok0
  s_branch SL_x_0_x0
SL_x_03_c0:
  v_max3_u32 v31, v64, v65, v66
  v_max_u32 v31, v31, v67
  v_cmp_eq_u32 vcc, -1, v31
  s_cbranch_vccz SL_x_03_ok0
SL_x_03_x0:
  s_mov_b64 exec, vcc
  buffer_load_dwordx4 v[64:67], v9, s[4:7], s41 offen offset:0 sc1
  s_mov_b64 exec, -1
SL_x_03_c3:
  v_max3_u32 v31, v76, v77, v78
  v_max_u32 v31, v31, v79
  v_cmp_eq_u32 vcc, -1, v31
  s_cbranch_vccz SL_x_03_ok3
SL_x_03_x3:
  s_mov_b64 exec, vcc
  buffer_load_dwordx4 v[76:79], v9, s[4:7], s41 offen offset:3072 sc1
  s_mov_b64 exec, -1
  s_add_u32 s46, s46, 1
  s_cmp_ge_u32 s46, 131072
  s_cbranch_scc1 SL_rec_abort
  s_waitcnt vmcnt(4)
  s_branch SL_x_03_c0
SL_x_03_ok0:
  v_mfma_f32_16x16x32_bf16 v[44:47], v[64:67], v[64:67], v[44:47]
  v_max3_u32 v31, v76, v77, v78
  v_max_u32 v31, v31, v79
  v_cmp_eq_u32 vcc, -1, v31
  v_mfma_f32_16x16x32_bf16 v[36:39], v[116:119], v[64:67], v[36:39]
  v_mfma_f32_16x16x32_bf16 v[40:43], v[132:135], v[64:67], v[40:43]
  s_cbranch_vccz SL_x_3_ok3
  s_branch SL_x_3_x3
SL_x_03_ok3:
  v_mfma_f32_16x16x32_bf16 v[44:47], v[76:79], v[76:79], v[44:47]
  v_max3_u32 v31, v64, v65, v66
  v_max_u32 v31, v31, v67
  v_cmp_eq_u32 vcc, -1, v31
  v_mfma_f32_16x16x32_bf16 v[36:39], v[128:131], v[76:79], v[36:39]
  v_mfma_f32_16x16x32_bf16 v[40:43], v[144:147], v[76:79], v[40:43]
  s_cbranch_vccz SL_x_0_ok0
  s_branch SL_x_0_x0
SL_x_12_c1:
  v_max3_u32 v31, v68, v69, v70
  v_max_u32 v31, v31, v71
  v_cmp_eq_u32 vcc, -1, v31
  s_cbranch_vccz SL_x_12_ok1
SL_x_12_x1:
  s_mov_b64 exec, vcc
  buffer_load_dwordx4 v[68:71], v9, s[4:7], s41 offen offset:1024 sc1
  s_mov_b64 exec, -1
SL_x_12_c2:
  v_max3_u32 v31, v72, v73, v74
  v_max_u32 v31, v31, v75
  v_cmp_eq_u32 vcc, -1, v31
  s_cbranch_vccz SL_x_12_ok2
SL_x_12_x2:
  s_mov_b64 exec, vcc
  buffer_load_dwordx4 v[72:75], v9, s[4:7], s41 offen offset:2048 sc1
  s_mov_b64 exec, -1
  s_add_u32 s46, s46, 1
  s_cmp_ge_u32 s46, 131072
  s_cbranch_scc1 SL_rec_abort
  s_waitcnt vmcnt(4)
  s_branch SL_x_12_c1
SL_x_12_ok1:
  v_mfma_f32_16x16x32_bf16 v[44:47], v[68:71], v[68:71], v[44:47]
  v_max3_u32 v31, v72, v73, v74
  v_max_u32 v31, v31, v75
  v_cmp_eq_u32 vcc, -1, v31
  v_mfma_f32_16x16x32_bf16 v[36:39], v[120:123], v[68:71], v[36:39]
  v_mfma_f32_16x16x32_bf16 v[40:43], v[136:139], v[68:71], v[40:43]
  s_cbranch_vccz SL_x_2_ok2
  s_branch SL_x_2_x2
SL_x_12_ok2:
  v_mfma_f32_16x16x32_bf16 v[44:47], v[72:75], v[72:75], v[44:47]
  v_max3_u32 v31, v68, v69, v70
  v_max_u32 v31, v31, v71
  v_cmp_eq_u32 vcc, -1, v31
  v_mfma_f32_16x16x32_bf16 v[36:39], v[124:127], v[72:75], v[36:39]
  v_mfma_f32_16x16x32_bf16 v[40:43], v[140:143], v[72:75], v[40:43]
  s_cbranch_vccz SL_x_1_ok1
  s_branch SL_x_1_x1
SL_x_13_c1:
  v_max3_u32 v31, v68, v69, v70
  v_max_u32 v31, v31, v71
  v_cmp_eq_u32 vcc, -1, v31
  s_cbranch_vccz SL_x_13_ok1
SL_x_13_x1:
  s_mov_b64 exec, vcc
  buffer_load_dwordx4 v[68:71], v9, s[4:7], s41 offen offset:1024 sc1
  s_mov_b64 exec, -1
SL_x_13_c3:
  v_max3_u32 v31, v76, v77, v78
  v_max_u32 v31, v31, v79
  v_cmp_eq_u32 vcc, -1, v31
  s_cbranch_vccz SL_x_13_ok3
SL_x_13_x3:
  s_mov_b64 exec, vcc
  buffer_load_dwordx4 v[76:79], v9, s[4:7], s41 offen offset:3072 sc1
  s_mov_b64 exec, -1
  s_add_u32 s46, s46, 1
  s_cmp_ge_u32 s46, 131072
  s_cbranch_scc1 SL_rec_abort
  s_waitcnt vmcnt(4)
  s_branch SL_x_13_c1
SL_x_13_ok1:
  v_mfma_f32_16x16x32_bf16 v[44:47], v[68:71], v[68:71], v[44:47]
  v_max3_u32 v31, v76, v77, v78
  v_max_u32 v31, v31, v79
  v_cmp_eq_u32 vcc, -1, v31
  v_mfma_f32_16x16x32_bf16 v[36:39], v[120:123], v[68:71], v[36:39]
  v_mfma_f32_16x16x32_bf16 v[40:43], v[136:139], v[68:71], v[40:43]
  s_cbranch_vccz SL_x_3_ok3
  s_branch SL_x_3_x3
SL_x_13_ok3:
  v_mfma_f32_16x16x32_bf16 v[44:47], v[76:79], v[76:79], v[44:47]
  v_max3_u32 v31, v68, v69, v70
  v_max_u32 v31, v31, v71
  v_cmp_eq_u32 vcc, -1, v31
  v_mfma_f32_16x16x32_bf16 v[36:39], v[128:131], v[76:79], v[36:39]
  v_mfma_f32_16x16x32_bf16 v[40:43], v[144:147], v[76:79], v[40:43]
  s_cbranch_vccz SL_x_1_ok1
  s_branch SL_x_1_x1
SL_x_23_c2:
  v_max3_u32 v31, v72, v73, v74
  v_max_u32 v31, v31, v75
  v_cmp_eq_u32 vcc, -1, v31
  s_cbranch_vccz SL_x_23_ok2
SL_x_23_x2:
  s_mov_b64 exec, vcc
  buffer_load_dwordx4 v[72:75], v9, s[4:7], s41 offen offset:2048 sc1
  s_mov_b64 exec, -1
SL_x_23_c3:
  v_max3_u32 v31, v76, v77, v78
  v_max_u32 v31, v31, v79
  v_cmp_eq_u32 vcc, -1, v31
  s_cbranch_vccz SL_x_23_ok3
SL_x_23_x3:
  s_mov_b64 exec, vcc
  buffer_load_dwordx4 v[76:79], v9, s[4:7], s41 offen offset:3072 sc1
  s_mov_b64 exec, -1
  s_add_u32 s46, s46, 1
  s_cmp_ge_u32 s46, 131072
  s_cbranch_scc1 SL_rec_abort
  s_waitcnt vmcnt(4)
  s_branch SL_x_23_c2
SL_x_23_ok2:
  v_mfma_f32_16x16x32_bf16 v[44:47], v[72:75], v[72:75], v[44:47]
  v_max3_u32 v31, v76, v77, v78
  v_max_u32 v31, v31, v79
  v_cmp_eq_u32 vcc, -1, v31
  v_mfma_f32_16x16x32_bf16 v[36:39], v[124:127], v[72:75], v[36:39]
  v_mfma_f32_16x16x32_bf16 v[40:43], v[140:143], v[72:75], v[40:43]
  s_cbranch_vccz SL_x_3_ok3
  s_branch SL_x_3_x3
SL_x_23_ok3:
  v_mfma_f32_16x16x32_bf16 v[44:47], v[76:79], v[76:79], v[44:47]
  v_max3_u32 v31, v72, v73, v74
  v_max_u32 v31, v31, v75
  v_cmp_eq_u32 vcc, -1, v31
  v_mfma_f32_16x16x32_bf16 v[36:39], v[128:131], v[76:79], v[36:39]
  v_mfma_f32_16x16x32_bf16 v[40:43], v[144:147], v[76:79], v[40:43]
  s_cbranch_vccz SL_x_2_ok2
  s_branch SL_x_2_x2
SL_x_012_c0:
  v_max3_u32 v31, v64, v65, v66
  v_max_u32 v31, v31, v67
  v_cmp_eq_u32 vcc, -1, v31
  s_cbranch_vccz SL_x_012_ok0
SL_x_012_x0:
  s_mov_b64 exec, vcc
  buffer_load_dwordx4 v[64:67], v9, s[4:7], s41 offen offset:0 sc1
  s_mov_b64 exec, -1
SL_x_012_c1:
  v_max3_u32 v31, v68, v69, v70
  v_max_u32 v31, v31, v71
  v_cmp_eq_u32 vcc, -1, v31
  s_cbranch_vccz SL_x_012_ok1
SL_x_012_x1:
  s_mov_b64 exec, vcc
  buffer_load_dwordx4 v[68:71], v9, s[4:7], s41 offen offset:1024 sc1
  s_mov_b64 exec, -1
SL_x_012_c2:
  v_max3_u32 v31, v72, v73, v74
  v_max_u32 v31, v31, v75
  v_cmp_eq_u32 vcc, -1, v31
  s_cbranch_vccz SL_x_012_ok2
SL_x_012_x2:
  s_mov_b64 exec, vcc
  buffer_load_dwordx4 v[72:75], v9, s[4:7], s41 offen offset:2048 sc1
  s_mov_b64 exec, -1
  s_add_u32 s46, s46, 1
  s_cmp_ge_u32 s46, 131072
  s_cbranch_scc1 SL_rec_abort
  s_waitcnt vmcnt(4)
  s_branch SL_x_012_c0
SL_x_012_ok0:
  v_mfma_f32_16x16x32_bf16 v[44:47], v[64:67], v[64:67], v[44:47]
  v_max3_u32 v31, v68, v69, v70
  v_max_u32 v31, v31, v71
  v_cmp_eq_u32 vcc, -1, v31
  v_mfma_f32_16x16x32_bf16 v[36:39], v[116:119], v[64:67], v[36:39]
  v_mfma_f32_16x16x32_bf16 v[40:43], v[132:135], v[64:67], v[40:43]
  s_cbranch_vccz SL_x_12_ok1
  s_branch SL_x_12_x1
SL_x_012_ok1:
  v_mfma_f32_16x16x32_bf16 v[44:47], v[68:71], v[68:71], v[44:47]
  v_max3_u32 v31, v72, v73, v74
  v_max_u32 v31, v31, v75
  v_cmp_eq_u32 vcc, -1, v31
  v_mfma_f32_16x16x32_bf16 v[36:39], v[120:123], v[68:71], v[36:39]
  v_mfma_f32_16x16x32_bf16 v[40:43], v[136:139], v[68:71], v[40:43]
  s_cbranch_vccz SL_x_02_ok2
  s_branch SL_x_02_x2
SL_x_012_ok2:
  v_mfma_f32_16x16x32_bf16 v[44:47], v[72:75], v[72:75], v[44:47]
  v_max3_u32 v31, v64, v65, v66
  v_max_u32 v31, v31, v67
  v_cmp_eq_u32 vcc, -1, v31
  v_mfma_f32_16x16x32_bf16 v[36:39], v[124:127], v[72:75], v[36:39]
  v_mfma_f32_16x16x32_bf16 v[40:43], v[140:143], v[72:75], v[40:43]
  s_cbranch_vccz SL_x_01_ok0
  s_branch SL_x_01_x0
SL_x_013_c0:
  v_max3_u32 v31, v64, v65, v66
  v_max_u32 v31, v31, v67
  v_cmp_eq_u32 vcc, -1, v31
  s_cbranch_vccz SL_x_013_ok0
SL_x_013_x0:
  s_mov_b64 exec, vcc
  buffer_load_dwordx4 v[64:67], v9, s[4:7], s41 offen offset:0 sc1
  s_mov_b64 exec, -1
SL_x_013_c1:
  v_max3_u32 v31, v68, v69, v70
  v_max_u32 v31, v31, v71
  v_cmp_eq_u32 vcc, -1, v31
  s_cbranch_vccz SL_x_013_ok1
SL_x_013_x1:
  s_mov_b64 exec, vcc
  buffer_load_dwordx4 v[68:71], v9, s[4:7], s41 offen offset:1024 sc1
  s_mov_b64 exec, -1
SL_x_013_c3:
  v_max3_u32 v31, v76, v77, v78
  v_max_u32 v31, v31, v79
  v_cmp_eq_u32 vcc, -1, v31
  s_cbranch_vccz SL_x_013_ok3
SL_x_013_x3:
  s_mov_b64 exec, vcc
  buffer_load_dwordx4 v[76:79], v9, s[4:7], s41 offen offset:3072 sc1
  s_mov_b64 exec, -1
  s_add_u32 s46, s46, 1
  s_cmp_ge_u32 s46, 131072
  s_cbranch_scc1 SL_rec_abort
  s_waitcnt vmcnt(4)
  s_branch SL_x_013_c0
SL_x_013_ok0:
  v_mfma_f32_16x16x32_bf16 v[44:47], v[64:67], v[64:67], v[44:47]
  v_max3_u32 v31, v68, v69, v70
  v_max_u32 v31, v31, v71
  v_cmp_eq_u32 vcc, -1, v31
  v_mfma_f32_16x16x32_bf16 v[36:39], v[116:119], v[64:67], v[36:39]
  v_mfma_f32_16x16x32_bf16 v[40:43], v[132:135], v[64:67], v[40:43]
  s_cbranch_vccz SL_x_13_ok1
  s_branch SL_x_13_x1
SL_x_013_ok1:
  v_mfma_f32_16x16x32_bf16 v[44:47], v[68:71], v[68:71], v[44:47]
  v_max3_u32 v31, v76, v77, v78
  v_max_u32 v31, v31, v79
  v_cmp_eq_u32 vcc, -1, v31
  v_mfma_f32_16x16x32_bf16 v[36:39], v[120:123], v[68:71], v[36:39]
  v_mfma_f32_16x16x32_bf16 v[40:43], v[136:139], v[68:71], v[40:43]
  s_cbranch_vccz SL_x_03_ok3
  s_branch SL_x_03_x3
SL_x_013_ok3:
  v_mfma_f32_16x16x32_bf16 v[44:47], v[76:79], v[76:79], v[44:47]
  v_max3_u32 v31, v64, v65, v66
  v_max_u32 v31, v31, v67
  v_cmp_eq_u32 vcc, -1, v31
  v_mfma_f32_16x16x32_bf16 v[36:39], v[128:131], v[76:79], v[36:39]
  v_mfma_f32_16x16x32_bf16 v[40:43], v[144:147], v[76:79], v[40:43]
  s_cbranch_vccz SL_x_01_ok0
  s_branch SL_x_01_x0
SL_x_023_c0:
  v_max3_u32 v31, v64, v65, v66
  v_max_u32 v31, v31, v67
  v_cmp_eq_u32 vcc, -1, v31
  s_cbranch_vccz SL_x_023_ok0
SL_x_023_x0:
  s_mov_b64 exec, vcc
  buffer_load_dwordx4 v[64:67], v9, s[4:7], s41 offen offset:0 sc1
  s_mov_b64 exec, -1
SL_x_023_c2:
  v_max3_u32 v31, v72, v73, v74
  v_max_u32 v31, v31, v75
  v_cmp_eq_u32 vcc, -1, v31
  s_cbranch_vccz SL_x_023_ok2
SL_x_023_x2:
  s_mov_b64 exec, vcc
  buffer_load_dwordx4 v[72:75], v9, s[4:7], s41 offen offset:2048 sc1
  s_mov_b64 exec, -1
SL_x_023_c3:
  v_max3_u32 v31, v76, v77, v78
  v_max_u32 v31, v31, v79
  v_cmp_eq_u32 vcc, -1, v31
  s_cbranch_vccz SL_x_023_ok3
SL_x_023_x3:
  s_mov_b64 exec, vcc
  buffer_load_dwordx4 v[76:79], v9, s[4:7], s41 offen offset:3072 sc1
  s_mov_b64 exec, -1
  s_add_u32 s46, s46, 1
  s_cmp_ge_u32 s46, 131072
  s_cbranch_scc1 SL_rec_abort
  s_waitcnt vmcnt(4)
  s_branch SL_x_023_c0
SL_x_023_ok0:
  v_mfma_f32_16x16x32_bf16 v[44:47], v[64:67], v[64:67], v[44:47]
  v_max3_u32 v31, v72, v73, v74
  v_max_u32 v31, v31, v75
  v_cmp_eq_u32 vcc, -1, v31
  v_mfma_f32_16x16x32_bf16 v[36:39], v[116:119], v[64:67], v[36:39]
  v_mfma_f32_16x16x32_bf16 v[40:43], v[132:135], v[64:67], v[40:43]
  s_cbranch_vccz SL_x_23_ok2
  s_branch SL_x_23_x2
SL_x_023_ok2:
  v_mfma_f32_16x16x32_bf16 v[44:47], v[72:75], v[72:75], v[44:47]
  v_max3_u32 v31, v76, v77, v78
  v_max_u32 v31, v31, v79
  v_cmp_eq_u32 vcc, -1, v31
  v_mfma_f32_16x16x32_bf16 v[36:39], v[124:127], v[72:75], v[36:39]
  v_mfma_f32_16x16x32_bf16 v[40:43], v[140:143], v[72:75], v[40:43]
  s_cbranch_vccz SL_x_03_ok3
  s_branch SL_x_03_x3
SL_x_023_ok3:
  v_mfma_f32_16x16x32_bf16 v[44:47], v[76:79], v[76:79], v[44:47]
  v_max3_u32 v31, v64, v65, v66
  v_max_u32 v31, v31, v67
  v_cmp_eq_u32 vcc, -1, v31
  v_mfma_f32_16x16x32_bf16 v[36:39], v[128:131], v[76:79], v[36:39]
  v_mfma_f32_16x16x32_bf16 v[40:43], v[144:147], v[76:79], v[40:43]
  s_cbranch_vccz SL_x_02_ok0
  s_branch SL_x_02_x0
SL_x_123_c1:
  v_max3_u32 v31, v68, v69, v70
  v_max_u32 v31, v31, v71
  v_cmp_eq_u32 vcc, -1, v31
  s_cbranch_vccz SL_x_123_ok1
SL_x_123_x1:
  s_mov_b64 exec, vcc
  buffer_load_dwordx4 v[68:71], v9, s[4:7], s41 offen offset:1024 sc1
  s_mov_b64 exec, -1
SL_x_123_c2:
  v_max3_u32 v31, v72, v73, v74
  v_max_u32 v31, v31, v75
  v_cmp_eq_u32 vcc, -1, v31
  s_cbranch_vccz SL_x_123_ok2
SL_x_123_x2:
  s_mov_b64 exec, vcc
  buffer_load_dwordx4 v[72:75], v9, s[4:7], s41 offen offset:2048 sc1
  s_mov_b64 exec, -1
SL_x_123_c3:
  v_max3_u32 v31, v76, v77, v78
  v_max_u32 v31, v31, v79
  v_cmp_eq_u32 vcc, -1, v31
  s_cbranch_vccz SL_x_123_ok3
SL_x_123_x3:
  s_mov_b64 exec, vcc
  buffer_load_dwordx4 v[76:79], v9, s[4:7], s41 offen offset:3072 sc1
  s_mov_b64 exec, -1
  s_add_u32 s46, s46, 1
  s_cmp_ge_u32 s46, 131072
  s_cbranch_scc1 SL_rec_abort
  s_waitcnt vmcnt(4)
  s_branch SL_x_123_c1
SL_x_123_ok1:
  v_mfma_f32_16x16x32_bf16 v[44:47], v[68:71], v[68:71], v[44:47]
  v_max3_u32 v31, v72, v73, v74
  v_max_u32 v31, v31, v75
  v_cmp_eq_u32 vcc, -1, v31
  v_mfma_f32_16x16x32_bf16 v[36:39], v[120:123], v[68:71], v[36:39]
  v_mfma_f32_16x16x32_bf16 v[40:43], v[136:139], v[68:71], v[40:43]
  s_cbranch_vccz SL_x_23_ok2
  s_branch SL_x_23_x2
SL_x_123_ok2:
  v_mfma_f32_16x16x32_bf16 v[44:47], v[72:75], v[72:75], v[44:47]
  v_max3_u32 v31, v76, v77, v78
  v_max_u32 v31, v31, v79
  v_cmp_eq_u32 vcc, -1, v31
  v_mfma_f32_16x16x32_bf16 v[36:39], v[124:127], v[72:75], v[36:39]
  v_mfma_f32_16x16x32_bf16 v[40:43], v[140:143], v[72:75], v[40:43]
  s_cbranch_vccz SL_x_13_ok3
  s_branch SL_x_13_x3
SL_x_123_ok3:
  v_mfma_f32_16x16x32_bf16 v[44:47], v[76:79], v[76:79], v[44:47]
  v_max3_u32 v31, v68, v69, v70
  v_max_u32 v31, v31, v71
  v_cmp_eq_u32 vcc, -1, v31
  v_mfma_f32_16x16x32_bf16 v[36:39], v[128:131], v[76:79], v[36:39]
  v_mfma_f32_16x16x32_bf16 v[40:43], v[144:147], v[76:79], v[40:43]
  s_cbranch_vccz SL_x_12_ok1
  s_branch SL_x_12_x1
SL_x_0123_c0:
  v_max3_u32 v31, v64, v65, v66
  v_max_u32 v31, v31, v67
  v_cmp_eq_u32 vcc, -1, v31
  s_cbranch_vccz SL_x_0123_ok0
SL_x_0123_x0:
  s_mov_b64 exec, vcc
  buffer_load_dwordx4 v[64:67], v9, s[4:7], s41 offen offset:0 sc1
  s_mov_b64 exec, -1
SL_x_0123_c1:
  v_max3_u32 v31, v68, v69, v70
  v_max_u32 v31, v31, v71
  v_cmp_eq_u32 vcc, -1, v31
  s_cbranch_vccz SL_x_0123_ok1
SL_x_0123_x1:
  s_mov_b64 exec, vcc
  buffer_load_dwordx4 v[68:71], v9, s[4:7], s41 offen offset:1024 sc1
  s_mov_b64 exec, -1
SL_x_0123_c2:
  v_max3_u32 v31, v72, v73, v74
  v_max_u32 v31, v31, v75
  v_cmp_eq_u32 vcc, -1, v31
  s_cbranch_vccz SL_x_0123_ok2
SL_x_0123_x2:
  s_mov_b64 exec, vcc
  buffer_load_dwordx4 v[72:75], v9, s[4:7], s41 offen offset:2048 sc1
  s_mov_b64 exec, -1
SL_x_0123_c3:
  v_max3_u32 v31, v76, v77, v78
  v_max_u32 v31, v31, v79
  v_cmp_eq_u32 vcc, -1, v31
  s_cbranch_vccz SL_x_0123_ok3
SL_x_0123_x3:
  s_mov_b64 exec, vcc
  buffer_load_dwordx4 v[76:79], v9, s[4:7], s41 offen offset:3072 sc1
  s_mov_b64 exec, -1
  s_add_u32 s46, s46, 1
  s_cmp_ge_u32 s46, 131072
  s_cbranch_scc1 SL_rec_abort
  s_waitcnt vmcnt(4)
  s_branch SL_x_0123_c0
SL_x_0123_ok0:
  v_mfma_f32_16x16x32_bf16 v[44:47], v[64:67], v[64:67], v[44:47]
  v_max3_u32 v31, v68, v69, v70
  v_max_u32 v31, v31, v71
  v_cmp_eq_u32 vcc, -1, v31
  v_mfma_f32_16x16x32_bf16 v[36:39], v[116:119], v[64:67], v[36:39]
  v_mfma_f32_16x16x32_bf16 v[40:43], v[132:135], v[64:67], v[40:43]
  s_cbranch_vccz SL_x_123_ok1
  s_branch SL_x_123_x1
SL_x_0123_ok1:
  v_mfma_f32_16x16x32_bf16 v[44:47], v[68:71], v[68:71], v[44:47]
  v_max3_u32 v31, v72, v73, v74
  v_max_u32 v31, v31, v75
  v_cmp_eq_u32 vcc, -1, v31
  v_mfma_f32_16x16x32_bf16 v[36:39], v[120:123], v[68:71], v[36:39]
  v_mfma_f32_16x16x32_bf16 v[40:43], v[136:139], v[68:71], v[40:43]
  s_cbranch_vccz SL_x_023_ok2
  s_branch SL_x_023_x2
SL_x_0123_ok2:
  v_mfma_f32_16x16x32_bf16 v[44:47], v[72:75], v[72:75], v[44:47]
  v_max3_u32 v31, v76, v77, v78
  v_max_u32 v31, v31, v79
  v_cmp_eq_u32 vcc, -1, v31
  v_mfma_f32_16x16x32_bf16 v[36:39], v[124:127], v[72:75], v[36:39]
  v_mfma_f32_16x16x32_bf16 v[40:43], v[140:143], v[72:75], v[40:43]
  s_cbranch_vccz SL_x_013_ok3
  s_branch SL_x_013_x3
SL_x_0123_ok3:
  v_mfma_f32_16x16x32_bf16 v[44:47], v[76:79], v[76:79], v[44:47]
  v_max3_u32 v31, v64, v65, v66
  v_max_u32 v31, v31, v67
  v_cmp_eq_u32 vcc, -1, v31
  v_mfma_f32_16x16x32_bf16 v[36:39], v[128:131], v[76:79], v[36:39]
  v_mfma_f32_16x16x32_bf16 v[40:43], v[144:147], v[76:79], v[40:43]
  s_cbranch_vccz SL_x_012_ok0
  s_branch SL_x_012_x0
SL_v_f:
  buffer_load_dwordx4 v[88:91], v10, s[4:7], s41 offen offset:0 sc1
  buffer_load_dwordx4 v[92:95], v10, s[4:7], s41 offen offset:1024 sc1
  s_add_u32 s46, s46, 1
  s_cmp_ge_u32 s46, 131072
  s_cbranch_scc1 SL_rec_abort
  s_waitcnt vmcnt(0)
  v_max3_u32 v31, v88, v89, v90
  v_max3_u32 v31, v31, v91, v92
  v_max3_u32 v31, v31, v93, v94
  v_max_u32 v31, v31, v95
  v_cmp_eq_u32 vcc, -1, v31
  s_cbranch_vccnz SL_v_f
  s_branch SL_v_ok
SL_rec_abort:
  s_waitcnt vmcnt(0)
  s_endpgm
L_join:
  s_load_dwordx16 s[64:79], s[0:1], 0
  s_mov_b32 s39, 1
  s_cmp_lg_u32 s32, 0
  s_cbranch_scc1 L_rq_1
  s_cmp_eq_u32 s39, 0
  s_cbranch_scc1 L_rq_1
  s_lshl_b32 s99, s33, 7
  s_add_u32 s99, s99, 0x3d00200
  v_mov_b32 v244, 1
  v_mov_b32 v245, 0
  s_mov_b64 exec, 1
  buffer_atomic_add v244, v245, s[4:7], s99 offen sc0 sc1
  s_mov_b64 exec, -1
L_rq_1:
  v_mbcnt_lo_u32_b32 v0, -1, 0
  v_mbcnt_hi_u32_b32 v0, -1, v0
  s_lshl_b32 s90, s32, 6
  v_add_u32 v0, s90, v0
  s_lshl_b32 s40, s33, 5
  s_add_u32 s40, s40, 128
  s_mov_b32 s39, 1
  s_barrier
  s_branch L_worker1
L_worker:
  s_mov_b32 s39, 0
L_worker1:
  s_load_dwordx4 s[80:83], s[0:1], 64
  s_load_dwordx2 s[84:85], s[0:1], 80
  s_sub_u32 s33, s40, 128
  s_lshr_b32 s33, s33, 5
  s_and_b32 s34, s40, 31
  s_getpc_b64 s[86:87]
L_pc:
  s_add_u32 s86, s86, L_table-L_pc
  s_addc_u32 s87, s87, 0
  s_waitcnt lgkmcnt(0)
  s_mov_b32 s16, s84
  s_and_b32 s17, s85, 0xffff
  s_mov_b32 s18, 0x800000
  s_mov_b32 s19, 0x20000
  s_mov_b32 s8, s64
  s_and_b32 s9, s65, 0xffff
  s_mov_b32 s10, 0x400000
  s_mov_b32 s11, 0x20000
  s_mov_b32 s12, s70
  s_and_b32 s13, s71, 0xffff
  s_mov_b32 s14, 0x800000
  s_mov_b32 s15, 0x20000
  v_mov_b32 v1, 0
  v_mov_b32 v2, 0
  v_mov_b32 v3, 0
  v_mov_b32 v4, 0
  v_mov_b32 v5, 0
  v_mov_b32 v6, 0
  v_mov_b32 v7, 0
  v_mov_b32 v8, 0
  v_mov_b32 v9, 0
  v_mov_b32 v10, 0
  v_mov_b32 v11, 0
  v_mov_b32 v12, 0
  v_mov_b32 v13, 0
  v_mov_b32 v14, 0
  v_mov_b32 v15, 0
  v_mov_b32 v16, 0
  v_mov_b32 v17, 0
  v_mov_b32 v172, 0
  v_mov_b32 v173, 0
  s_mov_b32 s59, 0
  s_cmp_eq_u32 s39, 0
  s_cbranch_scc1 L_have
  s_branch L_next1
L_next:
  s_cmp_lg_u32 s32, 0
  s_cbranch_scc1 L_rq_2
  s_cmp_eq_u32 s39, 0
  s_cbranch_scc1 L_rq_2
  s_lshl_b32 s99, s33, 7
  s_add_u32 s99, s99, 0x3d00200
  v_mov_b32 v244, 1
  v_mov_b32 v245, 0
  s_mov_b64 exec, 1
  buffer_atomic_add v244, v245, s[4:7], s99 offen sc0 sc1
  s_mov_b64 exec, -1
L_rq_2:
L_next1:
  s_waitcnt vmcnt(0)
L_got:
  s_cmp_lg_u32 s32, 0
  s_cbranch_scc1 L_nx1
  v_mov_b32 v245, 147456
  s_mov_b64 exec, 1
  ds_write_b32 v245, v244
  s_mov_b64 exec, -1
  s_waitcnt lgkmcnt(0)
L_nx1:
  s_barrier
  v_mov_b32 v245, 147456
  ds_read_b32 v246, v245
  s_waitcnt lgkmcnt(0)
  v_min_u32 v245, 270, v246
  v_lshlrev_b32 v245, 2, v245
  v_add_u32 v245, 147648, v245
  ds_read_b32 v245, v245
  v_readfirstlane_b32 s34, v246
  s_add_u32 s34, s34, 32
  s_waitcnt lgkmcnt(0)
  v_readfirstlane_b32 s91, v245
  s_branch L_have1
L_have:
  s_lshl_b32 s90, s34, 2
  s_load_dword s91, s[86:87], s90
  s_waitcnt lgkmcnt(0)
L_have1:
  s_mov_b32 s98, 1
  s_and_b32 s35, s91, 255
  s_lshr_b32 s36, s91, 8
  s_and_b32 s36, s36, 255
  s_lshr_b32 s37, s91, 16
  s_cmp_eq_u32 s35, 0
  s_cbranch_scc1 L_aqkv
  s_cmp_eq_u32 s35, 1
  s_cbranch_scc1 L_aqkv
  s_cmp_eq_u32 s35, 2
  s_cbranch_scc1 L_aqkv
  s_cmp_eq_u32 s35, 3
  s_cbranch_scc1 L_bqkv
  s_cmp_eq_u32 s35, 9
  s_cbranch_scc1 L_small
  s_cmp_eq_u32 s35, 10
  s_cbranch_scc1 L_small
  s_mov_b32 s58, 0
L_epi:
  s_mov_b32 s46, 0x40000000
  s_mov_b32 s47, 0x40000000
  s_mov_b32 s49, 0
  s_cmp_eq_u32 s58, 1
  s_cselect_b64 vcc, -1, 0
  s_cmp_eq_u32 s59, 0
  s_cbranch_scc1 L_epid
  s_cmp_lg_u32 s59, 1
  s_cbranch_scc1 L_e0
  s_lshr_b32 s90, s27, 1
  s_and_b32 s91, s27, 1
  v_mov_b32 v172, 0x0
  v_bfe_u32 v45, v1, 0, 6
  v_lshl_add_u32 v172, v45, 4, v172
  v_add_u32 v173, 4096, v172
  s_mul_i32 s92, s90, 4
  s_mul_i32 s92, s92, s61
  s_add_u32 s92, s92, s60
  s_mul_i32 s93, s91, 8192
  s_add_u32 s92, s92, s93
  v_accvgpr_read_b32 v52, a0
  v_accvgpr_read_b32 v53, a4
  v_accvgpr_read_b32 v54, a1
  v_accvgpr_read_b32 v55, a5
  v_accvgpr_read_b32 v56, a2
  v_accvgpr_read_b32 v57, a6
  v_accvgpr_read_b32 v58, a3
  v_accvgpr_read_b32 v59, a7
  v_cvt_pk_bf16_f32 v48, v52, v53
  v_cvt_pk_bf16_f32 v49, v54, v55
  v_cvt_pk_bf16_f32 v50, v56, v57
  v_cvt_pk_bf16_f32 v51, v58, v59
  buffer_store_dwordx4 v[48:51], v172, s[4:7], s92 offen offset:0 sc1
  v_accvgpr_read_b32 v64, a128
  v_accvgpr_read_b32 v65, a132
  v_accvgpr_read_b32 v66, a129
  v_accvgpr_read_b32 v67, a133
  v_accvgpr_read_b32 v68, a130
  v_accvgpr_read_b32 v69, a134
  v_accvgpr_read_b32 v70, a131
  v_accvgpr_read_b32 v71, a135
  v_cvt_pk_bf16_f32 v176, v64, v65
  v_cvt_pk_bf16_f32 v177, v66, v67
  v_cvt_pk_bf16_f32 v178, v68, v69
  v_cvt_pk_bf16_f32 v179, v70, v71
  v_accvgpr_read_b32 v76, a8
  v_accvgpr_read_b32 v77, a12
  v_accvgpr_read_b32 v78, a9
  v_accvgpr_read_b32 v79, a13
  v_accvgpr_read_b32 v80, a10
  v_accvgpr_read_b32 v81, a14
  v_accvgpr_read_b32 v82, a11
  v_accvgpr_read_b32 v83, a15
  v_cvt_pk_bf16_f32 v72, v76, v77
  v_cvt_pk_bf16_f32 v73, v78, v79
  v_cvt_pk_bf16_f32 v74, v80, v81
  v_cvt_pk_bf16_f32 v75, v82, v83
  buffer_store_dwordx4 v[72:75], v172, s[4:7], s92 offen offset:1024 sc1
  v_accvgpr_read_b32 v88, a136
  v_accvgpr_read_b32 v89, a140
  v_accvgpr_read_b32 v90, a137
  v_accvgpr_read_b32 v91, a141
  v_accvgpr_read_b32 v92, a138
  v_accvgpr_read_b32 v93, a142
  v_accvgpr_read_b32 v94, a139
  v_accvgpr_read_b32 v95, a143
  v_cvt_pk_bf16_f32 v180, v88, v89
  v_cvt_pk_bf16_f32 v181, v90, v91
  v_cvt_pk_bf16_f32 v182, v92, v93
  v_cvt_pk_bf16_f32 v183, v94, v95
  v_accvgpr_read_b32 v52, a16
  v_accvgpr_read_b32 v53, a20
  v_accvgpr_read_b32 v54, a17
  v_accvgpr_read_b32 v55, a21
  v_accvgpr_read_b32 v56, a18
  v_accvgpr_read_b32 v57, a22
  v_accvgpr_read_b32 v58, a19
  v_accvgpr_read_b32 v59, a23
  v_cvt_pk_bf16_f32 v48, v52, v53
  v_cvt_pk_bf16_f32 v49, v54, v55
  v_cvt_pk_bf16_f32 v50, v56, v57
  v_cvt_pk_bf16_f32 v51, v58, v59
  buffer_store_dwordx4 v[48:51], v172, s[4:7], s92 offen offset:2048 sc1
  v_accvgpr_read_b32 v64, a144
  v_accvgpr_read_b32 v65, a148
  v_accvgpr_read_b32 v66, a145
  v_accvgpr_read_b32 v67, a149
  v_accvgpr_read_b32 v68, a146
  v_accvgpr_read_b32 v69, a150
  v_accvgpr_read_b32 v70, a147
  v_accvgpr_read_b32 v71, a151
  v_cvt_pk_bf16_f32 v184, v64, v65
  v_cvt_pk_bf16_f32 v185, v66, v67
  v_cvt_pk_bf16_f32 v186, v68, v69
  v_cvt_pk_bf16_f32 v187, v70, v71
  v_accvgpr_read_b32 v76, a24
  v_accvgpr_read_b32 v77, a28
  v_accvgpr_read_b32 v78, a25
  v_accvgpr_read_b32 v79, a29
  v_accvgpr_read_b32 v80, a26
  v_accvgpr_read_b32 v81, a30
  v_accvgpr_read_b32 v82, a27
  v_accvgpr_read_b32 v83, a31
  v_cvt_pk_bf16_f32 v72, v76, v77
  v_cvt_pk_bf16_f32 v73, v78, v79
  v_cvt_pk_bf16_f32 v74, v80, v81
  v_cvt_pk_bf16_f32 v75, v82, v83
  buffer_store_dwordx4 v[72:75], v172, s[4:7], s92 offen offset:3072 sc1
  v_accvgpr_read_b32 v88, a152
  v_accvgpr_read_b32 v89, a156
  v_accvgpr_read_b32 v90, a153
  v_accvgpr_read_b32 v91, a157
  v_accvgpr_read_b32 v92, a154
  v_accvgpr_read_b32 v93, a158
  v_accvgpr_read_b32 v94, a155
  v_accvgpr_read_b32 v95, a159
  v_cvt_pk_bf16_f32 v188, v88, v89
  v_cvt_pk_bf16_f32 v189, v90, v91
  v_cvt_pk_bf16_f32 v190, v92, v93
  v_cvt_pk_bf16_f32 v191, v94, v95
  v_accvgpr_read_b32 v52, a32
  v_accvgpr_read_b32 v53, a36
  v_accvgpr_read_b32 v54, a33
  v_accvgpr_read_b32 v55, a37
  v_accvgpr_read_b32 v56, a34
  v_accvgpr_read_b32 v57, a38
  v_accvgpr_read_b32 v58, a35
  v_accvgpr_read_b32 v59, a39
  v_cvt_pk_bf16_f32 v48, v52, v53
  v_cvt_pk_bf16_f32 v49, v54, v55
  v_cvt_pk_bf16_f32 v50, v56, v57
  v_cvt_pk_bf16_f32 v51, v58, v59
  buffer_store_dwordx4 v[48:51], v173, s[4:7], s92 offen offset:0 sc1
  v_accvgpr_read_b32 v64, a160
  v_accvgpr_read_b32 v65, a164
  v_accvgpr_read_b32 v66, a161
  v_accvgpr_read_b32 v67, a165
  v_accvgpr_read_b32 v68, a162
  v_accvgpr_read_b32 v69, a166
  v_accvgpr_read_b32 v70, a163
  v_accvgpr_read_b32 v71, a167
  v_cvt_pk_bf16_f32 v192, v64, v65
  v_cvt_pk_bf16_f32 v193, v66, v67
  v_cvt_pk_bf16_f32 v194, v68, v69
  v_cvt_pk_bf16_f32 v195, v70, v71
  v_accvgpr_read_b32 v76, a40
  v_accvgpr_read_b32 v77, a44
  v_accvgpr_read_b32 v78, a41
  v_accvgpr_read_b32 v79, a45
  v_accvgpr_read_b32 v80, a42
  v_accvgpr_read_b32 v81, a46
  v_accvgpr_read_b32 v82, a43
  v_accvgpr_read_b32 v83, a47
  v_cvt_pk_bf16_f32 v72, v76, v77
  v_cvt_pk_bf16_f32 v73, v78, v79
  v_cvt_pk_bf16_f32 v74, v80, v81
  v_cvt_pk_bf16_f32 v75, v82, v83
  buffer_store_dwordx4 v[72:75], v173, s[4:7], s92 offen offset:1024 sc1
  v_accvgpr_read_b32 v88, a168
  v_accvgpr_read_b32 v89, a172
  v_accvgpr_read_b32 v90, a169
  v_accvgpr_read_b32 v91, a173
  v_accvgpr_read_b32 v92, a170
  v_accvgpr_read_b32 v93, a174
  v_accvgpr_read_b32 v94, a171
  v_accvgpr_read_b32 v95, a175
  v_cvt_pk_bf16_f32 v196, v88, v89
  v_cvt_pk_bf16_f32 v197, v90, v91
  v_cvt_pk_bf16_f32 v198, v92, v93
  v_cvt_pk_bf16_f32 v199, v94, v95
  v_accvgpr_read_b32 v52, a48
  v_accvgpr_read_b32 v53, a52
  v_accvgpr_read_b32 v54, a49
  v_accvgpr_read_b32 v55, a53
  v_accvgpr_read_b32 v56, a50
  v_accvgpr_read_b32 v57, a54
  v_accvgpr_read_b32 v58, a51
  v_accvgpr_read_b32 v59, a55
  v_cvt_pk_bf16_f32 v48, v52, v53
  v_cvt_pk_bf16_f32 v49, v54, v55
  v_cvt_pk_bf16_f32 v50, v56, v57
  v_cvt_pk_bf16_f32 v51, v58, v59
  buffer_store_dwordx4 v[48:51], v173, s[4:7], s92 offen offset:2048 sc1
  v_accvgpr_read_b32 v64, a176
  v_accvgpr_read_b32 v65, a180
  v_accvgpr_read_b32 v66, a177
  v_accvgpr_read_b32 v67, a181
  v_accvgpr_read_b32 v68, a178
  v_accvgpr_read_b32 v69, a182
  v_accvgpr_read_b32 v70, a179
  v_accvgpr_read_b32 v71, a183
  v_cvt_pk_bf16_f32 v200, v64, v65
  v_cvt_pk_bf16_f32 v201, v66, v67
  v_cvt_pk_bf16_f32 v202, v68, v69
  v_cvt_pk_bf16_f32 v203, v70, v71
  v_accvgpr_read_b32 v76, a56
  v_accvgpr_read_b32 v77, a60
  v_accvgpr_read_b32 v78, a57
  v_accvgpr_read_b32 v79, a61
  v_accvgpr_read_b32 v80, a58
  v_accvgpr_read_b32 v81, a62
  v_accvgpr_read_b32 v82, a59
  v_accvgpr_read_b32 v83, a63
  v_cvt_pk_bf16_f32 v72, v76, v77
  v_cvt_pk_bf16_f32 v73, v78, v79
  v_cvt_pk_bf16_f32 v74, v80, v81
  v_cvt_pk_bf16_f32 v75, v82, v83
  buffer_store_dwordx4 v[72:75], v173, s[4:7], s92 offen offset:3072 sc1
  v_accvgpr_read_b32 v88, a184
  v_accvgpr_read_b32 v89, a188
  v_accvgpr_read_b32 v90, a185
  v_accvgpr_read_b32 v91, a189
  v_accvgpr_read_b32 v92, a186
  v_accvgpr_read_b32 v93, a190
  v_accvgpr_read_b32 v94, a187
  v_accvgpr_read_b32 v95, a191
  v_cvt_pk_bf16_f32 v204, v88, v89
  v_cvt_pk_bf16_f32 v205, v90, v91
  v_cvt_pk_bf16_f32 v206, v92, v93
  v_cvt_pk_bf16_f32 v207, v94, v95
  s_add_u32 s92, s92, s61
  v_accvgpr_read_b32 v52, a64
  v_accvgpr_read_b32 v53, a68
  v_accvgpr_read_b32 v54, a65
  v_accvgpr_read_b32 v55, a69
  v_accvgpr_read_b32 v56, a66
  v_accvgpr_read_b32 v57, a70
  v_accvgpr_read_b32 v58, a67
  v_accvgpr_read_b32 v59, a71
  v_cvt_pk_bf16_f32 v48, v52, v53
  v_cvt_pk_bf16_f32 v49, v54, v55
  v_cvt_pk_bf16_f32 v50, v56, v57
  v_cvt_pk_bf16_f32 v51, v58, v59
  buffer_store_dwordx4 v[48:51], v172, s[4:7], s92 offen offset:0 sc1
  v_accvgpr_read_b32 v64, a192
  v_accvgpr_read_b32 v65, a196
  v_accvgpr_read_b32 v66, a193
  v_accvgpr_read_b32 v67, a197
  v_accvgpr_read_b32 v68, a194
  v_accvgpr_read_b32 v69, a198
  v_accvgpr_read_b32 v70, a195
  v_accvgpr_read_b32 v71, a199
  v_cvt_pk_bf16_f32 v208, v64, v65
  v_cvt_pk_bf16_f32 v209, v66, v67
  v_cvt_pk_bf16_f32 v210, v68, v69
  v_cvt_pk_bf16_f32 v211, v70, v71
  v_accvgpr_read_b32 v76, a72
  v_accvgpr_read_b32 v77, a76
  v_accvgpr_read_b32 v78, a73
  v_accvgpr_read_b32 v79, a77
  v_accvgpr_read_b32 v80, a74
  v_accvgpr_read_b32 v81, a78
  v_accvgpr_read_b32 v82, a75
  v_accvgpr_read_b32 v83, a79
  v_cvt_pk_bf16_f32 v72, v76, v77
  v_cvt_pk_bf16_f32 v73, v78, v79
  v_cvt_pk_bf16_f32 v74, v80, v81
  v_cvt_pk_bf16_f32 v75, v82, v83
  buffer_store_dwordx4 v[72:75], v172, s[4:7], s92 offen offset:1024 sc1
  v_accvgpr_read_b32 v88, a200
  v_accvgpr_read_b32 v89, a204
  v_accvgpr_read_b32 v90, a201
  v_accvgpr_read_b32 v91, a205
  v_accvgpr_read_b32 v92, a202
  v_accvgpr_read_b32 v93, a206
  v_accvgpr_read_b32 v94, a203
  v_accvgpr_read_b32 v95, a207
  v_cvt_pk_bf16_f32 v212, v88, v89
  v_cvt_pk_bf16_f32 v213, v90, v91
  v_cvt_pk_bf16_f32 v214, v92, v93
  v_cvt_pk_bf16_f32 v215, v94, v95
  v_accvgpr_read_b32 v52, a80
  v_accvgpr_read_b32 v53, a84
  v_accvgpr_read_b32 v54, a81
  v_accvgpr_read_b32 v55, a85
  v_accvgpr_read_b32 v56, a82
  v_accvgpr_read_b32 v57, a86
  v_accvgpr_read_b32 v58, a83
  v_accvgpr_read_b32 v59, a87
  v_cvt_pk_bf16_f32 v48, v52, v53
  v_cvt_pk_bf16_f32 v49, v54, v55
  v_cvt_pk_bf16_f32 v50, v56, v57
  v_cvt_pk_bf16_f32 v51, v58, v59
  buffer_store_dwordx4 v[48:51], v172, s[4:7], s92 offen offset:2048 sc1
  v_accvgpr_read_b32 v64, a208
  v_accvgpr_read_b32 v65, a212
  v_accvgpr_read_b32 v66, a209
  v_accvgpr_read_b32 v67, a213
  v_accvgpr_read_b32 v68, a210
  v_accvgpr_read_b32 v69, a214
  v_accvgpr_read_b32 v70, a211
  v_accvgpr_read_b32 v71, a215
  v_cvt_pk_bf16_f32 v216, v64, v65
  v_cvt_pk_bf16_f32 v217, v66, v67
  v_cvt_pk_bf16_f32 v218, v68, v69
  v_cvt_pk_bf16_f32 v219, v70, v71
  v_accvgpr_read_b32 v76, a88
  v_accvgpr_read_b32 v77, a92
  v_accvgpr_read_b32 v78, a89
  v_accvgpr_read_b32 v79, a93
  v_accvgpr_read_b32 v80, a90
  v_accvgpr_read_b32 v81, a94
  v_accvgpr_read_b32 v82, a91
  v_accvgpr_read_b32 v83, a95
  v_cvt_pk_bf16_f32 v72, v76, v77
  v_cvt_pk_bf16_f32 v73, v78, v79
  v_cvt_pk_bf16_f32 v74, v80, v81
  v_cvt_pk_bf16_f32 v75, v82, v83
  buffer_store_dwordx4 v[72:75], v172, s[4:7], s92 offen offset:3072 sc1
  v_accvgpr_read_b32 v88, a216
  v_accvgpr_read_b32 v89, a220
  v_accvgpr_read_b32 v90, a217
  v_accvgpr_read_b32 v91, a221
  v_accvgpr_read_b32 v92, a218
  v_accvgpr_read_b32 v93, a222
  v_accvgpr_read_b32 v94, a219
  v_accvgpr_read_b32 v95, a223
  v_cvt_pk_bf16_f32 v220, v88, v89
  v_cvt_pk_bf16_f32 v221, v90, v91
  v_cvt_pk_bf16_f32 v222, v92, v93
  v_cvt_pk_bf16_f32 v223, v94, v95
  v_accvgpr_read_b32 v52, a96
  v_accvgpr_read_b32 v53, a100
  v_accvgpr_read_b32 v54, a97
  v_accvgpr_read_b32 v55, a101
  v_accvgpr_read_b32 v56, a98
  v_accvgpr_read_b32 v57, a102
  v_accvgpr_read_b32 v58, a99
  v_accvgpr_read_b32 v59, a103
  v_cvt_pk_bf16_f32 v48, v52, v53
  v_cvt_pk_bf16_f32 v49, v54, v55
  v_cvt_pk_bf16_f32 v50, v56, v57
  v_cvt_pk_bf16_f32 v51, v58, v59
  buffer_store_dwordx4 v[48:51], v173, s[4:7], s92 offen offset:0 sc1
  v_accvgpr_read_b32 v64, a224
  v_accvgpr_read_b32 v65, a228
  v_accvgpr_read_b32 v66, a225
  v_accvgpr_read_b32 v67, a229
  v_accvgpr_read_b32 v68, a226
  v_accvgpr_read_b32 v69, a230
  v_accvgpr_read_b32 v70, a227
  v_accvgpr_read_b32 v71, a231
  v_cvt_pk_bf16_f32 v224, v64, v65
  v_cvt_pk_bf16_f32 v225, v66, v67
  v_cvt_pk_bf16_f32 v226, v68, v69
  v_cvt_pk_bf16_f32 v227, v70, v71
  v_accvgpr_read_b32 v76, a104
  v_accvgpr_read_b32 v77, a108
  v_accvgpr_read_b32 v78, a105
  v_accvgpr_read_b32 v79, a109
  v_accvgpr_read_b32 v80, a106
  v_accvgpr_read_b32 v81, a110
  v_accvgpr_read_b32 v82, a107
  v_accvgpr_read_b32 v83, a111
  v_cvt_pk_bf16_f32 v72, v76, v77
  v_cvt_pk_bf16_f32 v73, v78, v79
  v_cvt_pk_bf16_f32 v74, v80, v81
  v_cvt_pk_bf16_f32 v75, v82, v83
  buffer_store_dwordx4 v[72:75], v173, s[4:7], s92 offen offset:1024 sc1
  v_accvgpr_read_b32 v88, a232
  v_accvgpr_read_b32 v89, a236
  v_accvgpr_read_b32 v90, a233
  v_accvgpr_read_b32 v91, a237
  v_accvgpr_read_b32 v92, a234
  v_accvgpr_read_b32 v93, a238
  v_accvgpr_read_b32 v94, a235
  v_accvgpr_read_b32 v95, a239
  v_cvt_pk_bf16_f32 v228, v88, v89
  v_cvt_pk_bf16_f32 v229, v90, v91
  v_cvt_pk_bf16_f32 v230, v92, v93
  v_cvt_pk_bf16_f32 v231, v94, v95
  v_accvgpr_read_b32 v52, a112
  v_accvgpr_read_b32 v53, a116
  v_accvgpr_read_b32 v54, a113
  v_accvgpr_read_b32 v55, a117
  v_accvgpr_read_b32 v56, a114
  v_accvgpr_read_b32 v57, a118
  v_accvgpr_read_b32 v58, a115
  v_accvgpr_read_b32 v59, a119
  v_cvt_pk_bf16_f32 v48, v52, v53
  v_cvt_pk_bf16_f32 v49, v54, v55
  v_cvt_pk_bf16_f32 v50, v56, v57
  v_cvt_pk_bf16_f32 v51, v58, v59
  buffer_store_dwordx4 v[48:51], v173, s[4:7], s92 offen offset:2048 sc1
  v_accvgpr_read_b32 v64, a240
  v_accvgpr_read_b32 v65, a244
  v_accvgpr_read_b32 v66, a241
  v_accvgpr_read_b32 v67, a245
  v_accvgpr_read_b32 v68, a242
  v_accvgpr_read_b32 v69, a246
  v_accvgpr_read_b32 v70, a243
  v_accvgpr_read_b32 v71, a247
  v_cvt_pk_bf16_f32 v232, v64, v65
  v_cvt_pk_bf16_f32 v233, v66, v67
  v_cvt_pk_bf16_f32 v234, v68, v69
  v_cvt_pk_bf16_f32 v235, v70, v71
  v_accvgpr_read_b32 v76, a120
  v_accvgpr_read_b32 v77, a124
  v_accvgpr_read_b32 v78, a121
  v_accvgpr_read_b32 v79, a125
  v_accvgpr_read_b32 v80, a122
  v_accvgpr_read_b32 v81, a126
  v_accvgpr_read_b32 v82, a123
  v_accvgpr_read_b32 v83, a127
  v_cvt_pk_bf16_f32 v72, v76, v77
  v_cvt_pk_bf16_f32 v73, v78, v79
  v_cvt_pk_bf16_f32 v74, v80, v81
  v_cvt_pk_bf16_f32 v75, v82, v83
  buffer_store_dwordx4 v[72:75], v173, s[4:7], s92 offen offset:3072 sc1
  v_accvgpr_read_b32 v88, a248
  v_accvgpr_read_b32 v89, a252
  v_accvgpr_read_b32 v90, a249
  v_accvgpr_read_b32 v91, a253
  v_accvgpr_read_b32 v92, a250
  v_accvgpr_read_b32 v93, a254
  v_accvgpr_read_b32 v94, a251
  v_accvgpr_read_b32 v95, a255
  v_cvt_pk_bf16_f32 v236, v88, v89
  v_cvt_pk_bf16_f32 v237, v90, v91
  v_cvt_pk_bf16_f32 v238, v92, v93
  v_cvt_pk_bf16_f32 v239, v94, v95
  s_add_u32 s92, s92, s61
  s_mov_b32 s46, s92
  s_add_u32 s47, s92, s61
  s_branch L_edef
L_e0:
  s_cmp_lg_u32 s59, 2
  s_cbranch_scc1 L_e1
  s_lshr_b32 s90, s27, 1
  s_and_b32 s91, s27, 1
  v_mov_b32 v172, 0x0
  v_bfe_u32 v45, v1, 0, 6
  v_lshl_add_u32 v172, v45, 4, v172
  v_add_u32 v173, 4096, v172
  s_mul_i32 s92, s90, 4
  s_mul_i32 s92, s92, s61
  s_add_u32 s92, s92, s60
  s_mul_i32 s93, s91, 8192
  s_add_u32 s92, s92, s93
  v_accvgpr_read_b32 v52, a0
  v_accvgpr_read_b32 v53, a1
  v_accvgpr_read_b32 v54, a2
  v_accvgpr_read_b32 v55, a3
  v_accvgpr_read_b32 v56, a32
  v_accvgpr_read_b32 v57, a33
  v_accvgpr_read_b32 v58, a34
  v_accvgpr_read_b32 v59, a35
  v_cvt_pk_bf16_f32 v48, v52, v53
  v_cvt_pk_bf16_f32 v49, v54, v55
  v_cvt_pk_bf16_f32 v50, v56, v57
  v_cvt_pk_bf16_f32 v51, v58, v59
  buffer_store_dwordx4 v[48:51], v172, s[4:7], s92 offen offset:0 sc1
  v_accvgpr_read_b32 v64, a128
  v_accvgpr_read_b32 v65, a129
  v_accvgpr_read_b32 v66, a130
  v_accvgpr_read_b32 v67, a131
  v_accvgpr_read_b32 v68, a160
  v_accvgpr_read_b32 v69, a161
  v_accvgpr_read_b32 v70, a162
  v_accvgpr_read_b32 v71, a163
  v_cvt_pk_bf16_f32 v176, v64, v65
  v_cvt_pk_bf16_f32 v177, v66, v67
  v_cvt_pk_bf16_f32 v178, v68, v69
  v_cvt_pk_bf16_f32 v179, v70, v71
  v_accvgpr_read_b32 v76, a4
  v_accvgpr_read_b32 v77, a5
  v_accvgpr_read_b32 v78, a6
  v_accvgpr_read_b32 v79, a7
  v_accvgpr_read_b32 v80, a36
  v_accvgpr_read_b32 v81, a37
  v_accvgpr_read_b32 v82, a38
  v_accvgpr_read_b32 v83, a39
  v_cvt_pk_bf16_f32 v72, v76, v77
  v_cvt_pk_bf16_f32 v73, v78, v79
  v_cvt_pk_bf16_f32 v74, v80, v81
  v_cvt_pk_bf16_f32 v75, v82, v83
  buffer_store_dwordx4 v[72:75], v172, s[4:7], s92 offen offset:1024 sc1
  v_accvgpr_read_b32 v88, a132
  v_accvgpr_read_b32 v89, a133
  v_accvgpr_read_b32 v90, a134
  v_accvgpr_read_b32 v91, a135
  v_accvgpr_read_b32 v92, a164
  v_accvgpr_read_b32 v93, a165
  v_accvgpr_read_b32 v94, a166
  v_accvgpr_read_b32 v95, a167
  v_cvt_pk_bf16_f32 v180, v88, v89
  v_cvt_pk_bf16_f32 v181, v90, v91
  v_cvt_pk_bf16_f32 v182, v92, v93
  v_cvt_pk_bf16_f32 v183, v94, v95
  v_accvgpr_read_b32 v52, a8
  v_accvgpr_read_b32 v53, a9
  v_accvgpr_read_b32 v54, a10
  v_accvgpr_read_b32 v55, a11
  v_accvgpr_read_b32 v56, a40
  v_accvgpr_read_b32 v57, a41
  v_accvgpr_read_b32 v58, a42
  v_accvgpr_read_b32 v59, a43
  v_cvt_pk_bf16_f32 v48, v52, v53
  v_cvt_pk_bf16_f32 v49, v54, v55
  v_cvt_pk_bf16_f32 v50, v56, v57
  v_cvt_pk_bf16_f32 v51, v58, v59
  buffer_store_dwordx4 v[48:51], v172, s[4:7], s92 offen offset:2048 sc1
  v_accvgpr_read_b32 v64, a136
  v_accvgpr_read_b32 v65, a137
  v_accvgpr_read_b32 v66, a138
  v_accvgpr_read_b32 v67, a139
  v_accvgpr_read_b32 v68, a168
  v_accvgpr_read_b32 v69, a169
  v_accvgpr_read_b32 v70, a170
  v_accvgpr_read_b32 v71, a171
  v_cvt_pk_bf16_f32 v184, v64, v65
  v_cvt_pk_bf16_f32 v185, v66, v67
  v_cvt_pk_bf16_f32 v186, v68, v69
  v_cvt_pk_bf16_f32 v187, v70, v71
  v_accvgpr_read_b32 v76, a12
  v_accvgpr_read_b32 v77, a13
  v_accvgpr_read_b32 v78, a14
  v_accvgpr_read_b32 v79, a15
  v_accvgpr_read_b32 v80, a44
  v_accvgpr_read_b32 v81, a45
  v_accvgpr_read_b32 v82, a46
  v_accvgpr_read_b32 v83, a47
  v_cvt_pk_bf16_f32 v72, v76, v77
  v_cvt_pk_bf16_f32 v73, v78, v79
  v_cvt_pk_bf16_f32 v74, v80, v81
  v_cvt_pk_bf16_f32 v75, v82, v83
  buffer_store_dwordx4 v[72:75], v172, s[4:7], s92 offen offset:3072 sc1
  v_accvgpr_read_b32 v88, a140
  v_accvgpr_read_b32 v89, a141
  v_accvgpr_read_b32 v90, a142
  v_accvgpr_read_b32 v91, a143
  v_accvgpr_read_b32 v92, a172
  v_accvgpr_read_b32 v93, a173
  v_accvgpr_read_b32 v94, a174
  v_accvgpr_read_b32 v95, a175
  v_cvt_pk_bf16_f32 v188, v88, v89
  v_cvt_pk_bf16_f32 v189, v90, v91
  v_cvt_pk_bf16_f32 v190, v92, v93
  v_cvt_pk_bf16_f32 v191, v94, v95
  v_accvgpr_read_b32 v52, a16
  v_accvgpr_read_b32 v53, a17
  v_accvgpr_read_b32 v54, a18
  v_accvgpr_read_b32 v55, a19
  v_accvgpr_read_b32 v56, a48
  v_accvgpr_read_b32 v57, a49
  v_accvgpr_read_b32 v58, a50
  v_accvgpr_read_b32 v59, a51
  v_cvt_pk_bf16_f32 v48, v52, v53
  v_cvt_pk_bf16_f32 v49, v54, v55
  v_cvt_pk_bf16_f32 v50, v56, v57
  v_cvt_pk_bf16_f32 v51, v58, v59
  buffer_store_dwordx4 v[48:51], v173, s[4:7], s92 offen offset:0 sc1
  v_accvgpr_read_b32 v64, a144
  v_accvgpr_read_b32 v65, a145
  v_accvgpr_read_b32 v66, a146
  v_accvgpr_read_b32 v67, a147
  v_accvgpr_read_b32 v68, a176
  v_accvgpr_read_b32 v69, a177
  v_accvgpr_read_b32 v70, a178
  v_accvgpr_read_b32 v71, a179
  v_cvt_pk_bf16_f32 v192, v64, v65
  v_cvt_pk_bf16_f32 v193, v66, v67
  v_cvt_pk_bf16_f32 v194, v68, v69
  v_cvt_pk_bf16_f32 v195, v70, v71
  v_accvgpr_read_b32 v76, a20
  v_accvgpr_read_b32 v77, a21
  v_accvgpr_read_b32 v78, a22
  v_accvgpr_read_b32 v79, a23
  v_accvgpr_read_b32 v80, a52
  v_accvgpr_read_b32 v81, a53
  v_accvgpr_read_b32 v82, a54
  v_accvgpr_read_b32 v83, a55
  v_cvt_pk_bf16_f32 v72, v76, v77
  v_cvt_pk_bf16_f32 v73, v78, v79
  v_cvt_pk_bf16_f32 v74, v80, v81
  v_cvt_pk_bf16_f32 v75, v82, v83
  buffer_store_dwordx4 v[72:75], v173, s[4:7], s92 offen offset:1024 sc1
  v_accvgpr_read_b32 v88, a148
  v_accvgpr_read_b32 v89, a149
  v_accvgpr_read_b32 v90, a150
  v_accvgpr_read_b32 v91, a151
  v_accvgpr_read_b32 v92, a180
  v_accvgpr_read_b32 v93, a181
  v_accvgpr_read_b32 v94, a182
  v_accvgpr_read_b32 v95, a183
  v_cvt_pk_bf16_f32 v196, v88, v89
  v_cvt_pk_bf16_f32 v197, v90, v91
  v_cvt_pk_bf16_f32 v198, v92, v93
  v_cvt_pk_bf16_f32 v199, v94, v95
  v_accvgpr_read_b32 v52, a24
  v_accvgpr_read_b32 v53, a25
  v_accvgpr_read_b32 v54, a26
  v_accvgpr_read_b32 v55, a27
  v_accvgpr_read_b32 v56, a56
  v_accvgpr_read_b32 v57, a57
  v_accvgpr_read_b32 v58, a58
  v_accvgpr_read_b32 v59, a59
  v_cvt_pk_bf16_f32 v48, v52, v53
  v_cvt_pk_bf16_f32 v49, v54, v55
  v_cvt_pk_bf16_f32 v50, v56, v57
  v_cvt_pk_bf16_f32 v51, v58, v59
  buffer_store_dwordx4 v[48:51], v173, s[4:7], s92 offen offset:2048 sc1
  v_accvgpr_read_b32 v64, a152
  v_accvgpr_read_b32 v65, a153
  v_accvgpr_read_b32 v66, a154
  v_accvgpr_read_b32 v67, a155
  v_accvgpr_read_b32 v68, a184
  v_accvgpr_read_b32 v69, a185
  v_accvgpr_read_b32 v70, a186
  v_accvgpr_read_b32 v71, a187
  v_cvt_pk_bf16_f32 v200, v64, v65
  v_cvt_pk_bf16_f32 v201, v66, v67
  v_cvt_pk_bf16_f32 v202, v68, v69
  v_cvt_pk_bf16_f32 v203, v70, v71
  v_accvgpr_read_b32 v76, a28
  v_accvgpr_read_b32 v77, a29
  v_accvgpr_read_b32 v78, a30
  v_accvgpr_read_b32 v79, a31
  v_accvgpr_read_b32 v80, a60
  v_accvgpr_read_b32 v81, a61
  v_accvgpr_read_b32 v82, a62
  v_accvgpr_read_b32 v83, a63
  v_cvt_pk_bf16_f32 v72, v76, v77
  v_cvt_pk_bf16_f32 v73, v78, v79
  v_cvt_pk_bf16_f32 v74, v80, v81
  v_cvt_pk_bf16_f32 v75, v82, v83
  buffer_store_dwordx4 v[72:75], v173, s[4:7], s92 offen offset:3072 sc1
  v_accvgpr_read_b32 v88, a156
  v_accvgpr_read_b32 v89, a157
  v_accvgpr_read_b32 v90, a158
  v_accvgpr_read_b32 v91, a159
  v_accvgpr_read_b32 v92, a188
  v_accvgpr_read_b32 v93, a189
  v_accvgpr_read_b32 v94, a190
  v_accvgpr_read_b32 v95, a191
  v_cvt_pk_bf16_f32 v204, v88, v89
  v_cvt_pk_bf16_f32 v205, v90, v91
  v_cvt_pk_bf16_f32 v206, v92, v93
  v_cvt_pk_bf16_f32 v207, v94, v95
  s_add_u32 s92, s92, s61
  v_accvgpr_read_b32 v52, a64
  v_accvgpr_read_b32 v53, a65
  v_accvgpr_read_b32 v54, a66
  v_accvgpr_read_b32 v55, a67
  v_accvgpr_read_b32 v56, a96
  v_accvgpr_read_b32 v57, a97
  v_accvgpr_read_b32 v58, a98
  v_accvgpr_read_b32 v59, a99
  v_cvt_pk_bf16_f32 v48, v52, v53
  v_cvt_pk_bf16_f32 v49, v54, v55
  v_cvt_pk_bf16_f32 v50, v56, v57
  v_cvt_pk_bf16_f32 v51, v58, v59
  buffer_store_dwordx4 v[48:51], v172, s[4:7], s92 offen offset:0 sc1
  v_accvgpr_read_b32 v64, a192
  v_accvgpr_read_b32 v65, a193
  v_accvgpr_read_b32 v66, a194
  v_accvgpr_read_b32 v67, a195
  v_accvgpr_read_b32 v68, a224
  v_accvgpr_read_b32 v69, a225
  v_accvgpr_read_b32 v70, a226
  v_accvgpr_read_b32 v71, a227
  v_cvt_pk_bf16_f32 v208, v64, v65
  v_cvt_pk_bf16_f32 v209, v66, v67
  v_cvt_pk_bf16_f32 v210, v68, v69
  v_cvt_pk_bf16_f32 v211, v70, v71
  v_accvgpr_read_b32 v76, a68
  v_accvgpr_read_b32 v77, a69
  v_accvgpr_read_b32 v78, a70
  v_accvgpr_read_b32 v79, a71
  v_accvgpr_read_b32 v80, a100
  v_accvgpr_read_b32 v81, a101
  v_accvgpr_read_b32 v82, a102
  v_accvgpr_read_b32 v83, a103
  v_cvt_pk_bf16_f32 v72, v76, v77
  v_cvt_pk_bf16_f32 v73, v78, v79
  v_cvt_pk_bf16_f32 v74, v80, v81
  v_cvt_pk_bf16_f32 v75, v82, v83
  buffer_store_dwordx4 v[72:75], v172, s[4:7], s92 offen offset:1024 sc1
  v_accvgpr_read_b32 v88, a196
  v_accvgpr_read_b32 v89, a197
  v_accvgpr_read_b32 v90, a198
  v_accvgpr_read_b32 v91, a199
  v_accvgpr_read_b32 v92, a228
  v_accvgpr_read_b32 v93, a229
  v_accvgpr_read_b32 v94, a230
  v_accvgpr_read_b32 v95, a231
  v_cvt_pk_bf16_f32 v212, v88, v89
  v_cvt_pk_bf16_f32 v213, v90, v91
  v_cvt_pk_bf16_f32 v214, v92, v93
  v_cvt_pk_bf16_f32 v215, v94, v95
  v_accvgpr_read_b32 v52, a72
  v_accvgpr_read_b32 v53, a73
  v_accvgpr_read_b32 v54, a74
  v_accvgpr_read_b32 v55, a75
  v_accvgpr_read_b32 v56, a104
  v_accvgpr_read_b32 v57, a105
  v_accvgpr_read_b32 v58, a106
  v_accvgpr_read_b32 v59, a107
  v_cvt_pk_bf16_f32 v48, v52, v53
  v_cvt_pk_bf16_f32 v49, v54, v55
  v_cvt_pk_bf16_f32 v50, v56, v57
  v_cvt_pk_bf16_f32 v51, v58, v59
  buffer_store_dwordx4 v[48:51], v172, s[4:7], s92 offen offset:2048 sc1
  v_accvgpr_read_b32 v64, a200
  v_accvgpr_read_b32 v65, a201
  v_accvgpr_read_b32 v66, a202
  v_accvgpr_read_b32 v67, a203
  v_accvgpr_read_b32 v68, a232
  v_accvgpr_read_b32 v69, a233
  v_accvgpr_read_b32 v70, a234
  v_accvgpr_read_b32 v71, a235
  v_cvt_pk_bf16_f32 v216, v64, v65
  v_cvt_pk_bf16_f32 v217, v66, v67
  v_cvt_pk_bf16_f32 v218, v68, v69
  v_cvt_pk_bf16_f32 v219, v70, v71
  v_accvgpr_read_b32 v76, a76
  v_accvgpr_read_b32 v77, a77
  v_accvgpr_read_b32 v78, a78
  v_accvgpr_read_b32 v79, a79
  v_accvgpr_read_b32 v80, a108
  v_accvgpr_read_b32 v81, a109
  v_accvgpr_read_b32 v82, a110
  v_accvgpr_read_b32 v83, a111
  v_cvt_pk_bf16_f32 v72, v76, v77
  v_cvt_pk_bf16_f32 v73, v78, v79
  v_cvt_pk_bf16_f32 v74, v80, v81
  v_cvt_pk_bf16_f32 v75, v82, v83
  buffer_store_dwordx4 v[72:75], v172, s[4:7], s92 offen offset:3072 sc1
  v_accvgpr_read_b32 v88, a204
  v_accvgpr_read_b32 v89, a205
  v_accvgpr_read_b32 v90, a206
  v_accvgpr_read_b32 v91, a207
  v_accvgpr_read_b32 v92, a236
  v_accvgpr_read_b32 v93, a237
  v_accvgpr_read_b32 v94, a238
  v_accvgpr_read_b32 v95, a239
  v_cvt_pk_bf16_f32 v220, v88, v89
  v_cvt_pk_bf16_f32 v221, v90, v91
  v_cvt_pk_bf16_f32 v222, v92, v93
  v_cvt_pk_bf16_f32 v223, v94, v95
  v_accvgpr_read_b32 v52, a80
  v_accvgpr_read_b32 v53, a81
  v_accvgpr_read_b32 v54, a82
  v_accvgpr_read_b32 v55, a83
  v_accvgpr_read_b32 v56, a112
  v_accvgpr_read_b32 v57, a113
  v_accvgpr_read_b32 v58, a114
  v_accvgpr_read_b32 v59, a115
  v_cvt_pk_bf16_f32 v48, v52, v53
  v_cvt_pk_bf16_f32 v49, v54, v55
  v_cvt_pk_bf16_f32 v50, v56, v57
  v_cvt_pk_bf16_f32 v51, v58, v59
  buffer_store_dwordx4 v[48:51], v173, s[4:7], s92 offen offset:0 sc1
  v_accvgpr_read_b32 v64, a208
  v_accvgpr_read_b32 v65, a209
  v_accvgpr_read_b32 v66, a210
  v_accvgpr_read_b32 v67, a211
  v_accvgpr_read_b32 v68, a240
  v_accvgpr_read_b32 v69, a241
  v_accvgpr_read_b32 v70, a242
  v_accvgpr_read_b32 v71, a243
  v_cvt_pk_bf16_f32 v224, v64, v65
  v_cvt_pk_bf16_f32 v225, v66, v67
  v_cvt_pk_bf16_f32 v226, v68, v69
  v_cvt_pk_bf16_f32 v227, v70, v71
  v_accvgpr_read_b32 v76, a84
  v_accvgpr_read_b32 v77, a85
  v_accvgpr_read_b32 v78, a86
  v_accvgpr_read_b32 v79, a87
  v_accvgpr_read_b32 v80, a116
  v_accvgpr_read_b32 v81, a117
  v_accvgpr_read_b32 v82, a118
  v_accvgpr_read_b32 v83, a119
  v_cvt_pk_bf16_f32 v72, v76, v77
  v_cvt_pk_bf16_f32 v73, v78, v79
  v_cvt_pk_bf16_f32 v74, v80, v81
  v_cvt_pk_bf16_f32 v75, v82, v83
  buffer_store_dwordx4 v[72:75], v173, s[4:7], s92 offen offset:1024 sc1
  v_accvgpr_read_b32 v88, a212
  v_accvgpr_read_b32 v89, a213
  v_accvgpr_read_b32 v90, a214
  v_accvgpr_read_b32 v91, a215
  v_accvgpr_read_b32 v92, a244
  v_accvgpr_read_b32 v93, a245
  v_accvgpr_read_b32 v94, a246
  v_accvgpr_read_b32 v95, a247
  v_cvt_pk_bf16_f32 v228, v88, v89
  v_cvt_pk_bf16_f32 v229, v90, v91
  v_cvt_pk_bf16_f32 v230, v92, v93
  v_cvt_pk_bf16_f32 v231, v94, v95
  v_accvgpr_read_b32 v52, a88
  v_accvgpr_read_b32 v53, a89
  v_accvgpr_read_b32 v54, a90
  v_accvgpr_read_b32 v55, a91
  v_accvgpr_read_b32 v56, a120
  v_accvgpr_read_b32 v57, a121
  v_accvgpr_read_b32 v58, a122
  v_accvgpr_read_b32 v59, a123
  v_cvt_pk_bf16_f32 v48, v52, v53
  v_cvt_pk_bf16_f32 v49, v54, v55
  v_cvt_pk_bf16_f32 v50, v56, v57
  v_cvt_pk_bf16_f32 v51, v58, v59
  buffer_store_dwordx4 v[48:51], v173, s[4:7], s92 offen offset:2048 sc1
  v_accvgpr_read_b32 v64, a216
  v_accvgpr_read_b32 v65, a217
  v_accvgpr_read_b32 v66, a218
  v_accvgpr_read_b32 v67, a219
  v_accvgpr_read_b32 v68, a248
  v_accvgpr_read_b32 v69, a249
  v_accvgpr_read_b32 v70, a250
  v_accvgpr_read_b32 v71, a251
  v_cvt_pk_bf16_f32 v232, v64, v65
  v_cvt_pk_bf16_f32 v233, v66, v67
  v_cvt_pk_bf16_f32 v234, v68, v69
  v_cvt_pk_bf16_f32 v235, v70, v71
  v_accvgpr_read_b32 v76, a92
  v_accvgpr_read_b32 v77, a93
  v_accvgpr_read_b32 v78, a94
  v_accvgpr_read_b32 v79, a95
  v_accvgpr_read_b32 v80, a124
  v_accvgpr_read_b32 v81, a125
  v_accvgpr_read_b32 v82, a126
  v_accvgpr_read_b32 v83, a127
  v_cvt_pk_bf16_f32 v72, v76, v77
  v_cvt_pk_bf16_f32 v73, v78, v79
  v_cvt_pk_bf16_f32 v74, v80, v81
  v_cvt_pk_bf16_f32 v75, v82, v83
  buffer_store_dwordx4 v[72:75], v173, s[4:7], s92 offen offset:3072 sc1
  v_accvgpr_read_b32 v88, a220
  v_accvgpr_read_b32 v89, a221
  v_accvgpr_read_b32 v90, a222
  v_accvgpr_read_b32 v91, a223
  v_accvgpr_read_b32 v92, a252
  v_accvgpr_read_b32 v93, a253
  v_accvgpr_read_b32 v94, a254
  v_accvgpr_read_b32 v95, a255
  v_cvt_pk_bf16_f32 v236, v88, v89
  v_cvt_pk_bf16_f32 v237, v90, v91
  v_cvt_pk_bf16_f32 v238, v92, v93
  v_cvt_pk_bf16_f32 v239, v94, v95
  s_add_u32 s92, s92, s61
  s_mov_b32 s46, s92
  s_add_u32 s47, s92, s61
  s_branch L_edef
L_e1:
  s_cmp_lg_u32 s59, 3
  s_cbranch_scc1 L_e2
  s_lshr_b32 s90, s27, 1
  s_and_b32 s91, s27, 1
  v_mov_b32 v178, 0x0
  v_bfe_u32 v177, v1, 0, 6
  v_lshl_add_u32 v178, v177, 4, v178
  v_add_u32 v176, 4096, v178
  s_mul_i32 s92, s90, 2
  s_mul_i32 s92, s92, s61
  s_add_u32 s92, s92, s60
  s_mul_i32 s93, s91, 2048
  s_add_u32 s92, s92, s93
  v_accvgpr_read_b32 v184, a0
  v_accvgpr_read_b32 v185, a4
  v_accvgpr_read_b32 v186, a1
  v_accvgpr_read_b32 v187, a5
  v_accvgpr_read_b32 v188, a2
  v_accvgpr_read_b32 v189, a6
  v_accvgpr_read_b32 v190, a3
  v_accvgpr_read_b32 v191, a7
  v_cvt_pk_bf16_f32 v180, v184, v185
  v_cvt_pk_bf16_f32 v181, v186, v187
  v_cvt_pk_bf16_f32 v182, v188, v189
  v_cvt_pk_bf16_f32 v183, v190, v191
  buffer_store_dwordx4 v[180:183], v178, s[4:7], s92 offen offset:0 sc1
  v_accvgpr_read_b32 v196, a8
  v_accvgpr_read_b32 v197, a12
  v_accvgpr_read_b32 v198, a9
  v_accvgpr_read_b32 v199, a13
  v_accvgpr_read_b32 v200, a10
  v_accvgpr_read_b32 v201, a14
  v_accvgpr_read_b32 v202, a11
  v_accvgpr_read_b32 v203, a15
  v_cvt_pk_bf16_f32 v192, v196, v197
  v_cvt_pk_bf16_f32 v193, v198, v199
  v_cvt_pk_bf16_f32 v194, v200, v201
  v_cvt_pk_bf16_f32 v195, v202, v203
  buffer_store_dwordx4 v[192:195], v178, s[4:7], s92 offen offset:1024 sc1
  v_accvgpr_read_b32 v208, a16
  v_accvgpr_read_b32 v209, a20
  v_accvgpr_read_b32 v210, a17
  v_accvgpr_read_b32 v211, a21
  v_accvgpr_read_b32 v212, a18
  v_accvgpr_read_b32 v213, a22
  v_accvgpr_read_b32 v214, a19
  v_accvgpr_read_b32 v215, a23
  v_cvt_pk_bf16_f32 v204, v208, v209
  v_cvt_pk_bf16_f32 v205, v210, v211
  v_cvt_pk_bf16_f32 v206, v212, v213
  v_cvt_pk_bf16_f32 v207, v214, v215
  buffer_store_dwordx4 v[204:207], v176, s[4:7], s92 offen offset:0 sc1
  v_accvgpr_read_b32 v220, a24
  v_accvgpr_read_b32 v221, a28
  v_accvgpr_read_b32 v222, a25
  v_accvgpr_read_b32 v223, a29
  v_accvgpr_read_b32 v224, a26
  v_accvgpr_read_b32 v225, a30
  v_accvgpr_read_b32 v226, a27
  v_accvgpr_read_b32 v227, a31
  v_cvt_pk_bf16_f32 v216, v220, v221
  v_cvt_pk_bf16_f32 v217, v222, v223
  v_cvt_pk_bf16_f32 v218, v224, v225
  v_cvt_pk_bf16_f32 v219, v226, v227
  buffer_store_dwordx4 v[216:219], v176, s[4:7], s92 offen offset:1024 sc1
  s_add_u32 s92, s92, s61
  v_accvgpr_read_b32 v184, a32
  v_accvgpr_read_b32 v185, a36
  v_accvgpr_read_b32 v186, a33
  v_accvgpr_read_b32 v187, a37
  v_accvgpr_read_b32 v188, a34
  v_accvgpr_read_b32 v189, a38
  v_accvgpr_read_b32 v190, a35
  v_accvgpr_read_b32 v191, a39
  v_cvt_pk_bf16_f32 v180, v184, v185
  v_cvt_pk_bf16_f32 v181, v186, v187
  v_cvt_pk_bf16_f32 v182, v188, v189
  v_cvt_pk_bf16_f32 v183, v190, v191
  buffer_store_dwordx4 v[180:183], v178, s[4:7], s92 offen offset:0 sc1
  v_accvgpr_read_b32 v196, a40
  v_accvgpr_read_b32 v197, a44
  v_accvgpr_read_b32 v198, a41
  v_accvgpr_read_b32 v199, a45
  v_accvgpr_read_b32 v200, a42
  v_accvgpr_read_b32 v201, a46
  v_accvgpr_read_b32 v202, a43
  v_accvgpr_read_b32 v203, a47
  v_cvt_pk_bf16_f32 v192, v196, v197
  v_cvt_pk_bf16_f32 v193, v198, v199
  v_cvt_pk_bf16_f32 v194, v200, v201
  v_cvt_pk_bf16_f32 v195, v202, v203
  buffer_store_dwordx4 v[192:195], v178, s[4:7], s92 offen offset:1024 sc1
  v_accvgpr_read_b32 v208, a48
  v_accvgpr_read_b32 v209, a52
  v_accvgpr_read_b32 v210, a49
  v_accvgpr_read_b32 v211, a53
  v_accvgpr_read_b32 v212, a50
  v_accvgpr_read_b32 v213, a54
  v_accvgpr_read_b32 v214, a51
  v_accvgpr_read_b32 v215, a55
  v_cvt_pk_bf16_f32 v204, v208, v209
  v_cvt_pk_bf16_f32 v205, v210, v211
  v_cvt_pk_bf16_f32 v206, v212, v213
  v_cvt_pk_bf16_f32 v207, v214, v215
  buffer_store_dwordx4 v[204:207], v176, s[4:7], s92 offen offset:0 sc1
  v_accvgpr_read_b32 v220, a56
  v_accvgpr_read_b32 v221, a60
  v_accvgpr_read_b32 v222, a57
  v_accvgpr_read_b32 v223, a61
  v_accvgpr_read_b32 v224, a58
  v_accvgpr_read_b32 v225, a62
  v_accvgpr_read_b32 v226, a59
  v_accvgpr_read_b32 v227, a63
  v_cvt_pk_bf16_f32 v216, v220, v221
  v_cvt_pk_bf16_f32 v217, v222, v223
  v_cvt_pk_bf16_f32 v218, v224, v225
  v_cvt_pk_bf16_f32 v219, v226, v227
  buffer_store_dwordx4 v[216:219], v176, s[4:7], s92 offen offset:1024 sc1
  s_add_u32 s92, s92, s61
  s_branch L_esig
L_e2:
  s_cmp_lg_u32 s59, 4
  s_cbranch_scc1 L_e3
  s_lshr_b32 s90, s27, 1
  s_and_b32 s91, s27, 1
  v_mov_b32 v178, 0x0
  v_bfe_u32 v177, v1, 0, 6
  v_lshl_add_u32 v178, v177, 4, v178
  v_add_u32 v176, 4096, v178
  s_mul_i32 s92, s90, 2
  s_mul_i32 s92, s92, s61
  s_add_u32 s92, s92, s60
  s_mul_i32 s93, s91, 4096
  s_add_u32 s92, s92, s93
  v_accvgpr_read_b32 v184, a0
  v_accvgpr_read_b32 v185, a1
  v_accvgpr_read_b32 v186, a2
  v_accvgpr_read_b32 v187, a3
  v_accvgpr_read_b32 v188, a16
  v_accvgpr_read_b32 v189, a17
  v_accvgpr_read_b32 v190, a18
  v_accvgpr_read_b32 v191, a19
  v_cvt_pk_bf16_f32 v180, v184, v185
  v_cvt_pk_bf16_f32 v181, v186, v187
  v_cvt_pk_bf16_f32 v182, v188, v189
  v_cvt_pk_bf16_f32 v183, v190, v191
  buffer_store_dwordx4 v[180:183], v178, s[4:7], s92 offen offset:0 sc1
  v_accvgpr_read_b32 v196, a4
  v_accvgpr_read_b32 v197, a5
  v_accvgpr_read_b32 v198, a6
  v_accvgpr_read_b32 v199, a7
  v_accvgpr_read_b32 v200, a20
  v_accvgpr_read_b32 v201, a21
  v_accvgpr_read_b32 v202, a22
  v_accvgpr_read_b32 v203, a23
  v_cvt_pk_bf16_f32 v192, v196, v197
  v_cvt_pk_bf16_f32 v193, v198, v199
  v_cvt_pk_bf16_f32 v194, v200, v201
  v_cvt_pk_bf16_f32 v195, v202, v203
  buffer_store_dwordx4 v[192:195], v178, s[4:7], s92 offen offset:1024 sc1
  v_accvgpr_read_b32 v208, a8
  v_accvgpr_read_b32 v209, a9
  v_accvgpr_read_b32 v210, a10
  v_accvgpr_read_b32 v211, a11
  v_accvgpr_read_b32 v212, a24
  v_accvgpr_read_b32 v213, a25
  v_accvgpr_read_b32 v214, a26
  v_accvgpr_read_b32 v215, a27
  v_cvt_pk_bf16_f32 v204, v208, v209
  v_cvt_pk_bf16_f32 v205, v210, v211
  v_cvt_pk_bf16_f32 v206, v212, v213
  v_cvt_pk_bf16_f32 v207, v214, v215
  buffer_store_dwordx4 v[204:207], v178, s[4:7], s92 offen offset:2048 sc1
  v_accvgpr_read_b32 v220, a12
  v_accvgpr_read_b32 v221, a13
  v_accvgpr_read_b32 v222, a14
  v_accvgpr_read_b32 v223, a15
  v_accvgpr_read_b32 v224, a28
  v_accvgpr_read_b32 v225, a29
  v_accvgpr_read_b32 v226, a30
  v_accvgpr_read_b32 v227, a31
  v_cvt_pk_bf16_f32 v216, v220, v221
  v_cvt_pk_bf16_f32 v217, v222, v223
  v_cvt_pk_bf16_f32 v218, v224, v225
  v_cvt_pk_bf16_f32 v219, v226, v227
  buffer_store_dwordx4 v[216:219], v178, s[4:7], s92 offen offset:3072 sc1
  s_add_u32 s92, s92, s61
  v_accvgpr_read_b32 v184, a32
  v_accvgpr_read_b32 v185, a33
  v_accvgpr_read_b32 v186, a34
  v_accvgpr_read_b32 v187, a35
  v_accvgpr_read_b32 v188, a48
  v_accvgpr_read_b32 v189, a49
  v_accvgpr_read_b32 v190, a50
  v_accvgpr_read_b32 v191, a51
  v_cvt_pk_bf16_f32 v180, v184, v185
  v_cvt_pk_bf16_f32 v181, v186, v187
  v_cvt_pk_bf16_f32 v182, v188, v189
  v_cvt_pk_bf16_f32 v183, v190, v191
  buffer_store_dwordx4 v[180:183], v178, s[4:7], s92 offen offset:0 sc1
  v_accvgpr_read_b32 v196, a36
  v_accvgpr_read_b32 v197, a37
  v_accvgpr_read_b32 v198, a38
  v_accvgpr_read_b32 v199, a39
  v_accvgpr_read_b32 v200, a52
  v_accvgpr_read_b32 v201, a53
  v_accvgpr_read_b32 v202, a54
  v_accvgpr_read_b32 v203, a55
  v_cvt_pk_bf16_f32 v192, v196, v197
  v_cvt_pk_bf16_f32 v193, v198, v199
  v_cvt_pk_bf16_f32 v194, v200, v201
  v_cvt_pk_bf16_f32 v195, v202, v203
  buffer_store_dwordx4 v[192:195], v178, s[4:7], s92 offen offset:1024 sc1
  v_accvgpr_read_b32 v208, a40
  v_accvgpr_read_b32 v209, a41
  v_accvgpr_read_b32 v210, a42
  v_accvgpr_read_b32 v211, a43
  v_accvgpr_read_b32 v212, a56
  v_accvgpr_read_b32 v213, a57
  v_accvgpr_read_b32 v214, a58
  v_accvgpr_read_b32 v215, a59
  v_cvt_pk_bf16_f32 v204, v208, v209
  v_cvt_pk_bf16_f32 v205, v210, v211
  v_cvt_pk_bf16_f32 v206, v212, v213
  v_cvt_pk_bf16_f32 v207, v214, v215
  buffer_store_dwordx4 v[204:207], v178, s[4:7], s92 offen offset:2048 sc1
  v_accvgpr_read_b32 v220, a44
  v_accvgpr_read_b32 v221, a45
  v_accvgpr_read_b32 v222, a46
  v_accvgpr_read_b32 v223, a47
  v_accvgpr_read_b32 v224, a60
  v_accvgpr_read_b32 v225, a61
  v_accvgpr_read_b32 v226, a62
  v_accvgpr_read_b32 v227, a63
  v_cvt_pk_bf16_f32 v216, v220, v221
  v_cvt_pk_bf16_f32 v217, v222, v223
  v_cvt_pk_bf16_f32 v218, v224, v225
  v_cvt_pk_bf16_f32 v219, v226, v227
  buffer_store_dwordx4 v[216:219], v178, s[4:7], s92 offen offset:3072 sc1
  s_add_u32 s92, s92, s61
  s_branch L_esig
L_e3:
  s_cmp_lg_u32 s59, 5
  s_cbranch_scc1 L_e4
  s_lshr_b32 s90, s27, 1
  s_and_b32 s91, s27, 1
  v_and_b32 v176, 15, v1
  v_mul_lo_u32 v176, v176, s61
  v_lshrrev_b32 v177, 4, v1
  v_lshl_add_u32 v178, v177, 4, v176
  s_mul_i32 s92, s90, 64
  s_mul_i32 s92, s92, s61
  s_add_u32 s92, s92, s60
  s_mul_i32 s93, s91, 128
  s_add_u32 s92, s92, s93
  s_lshl_b32 s94, s61, 4
  v_accvgpr_read_b32 v184, a0
  v_accvgpr_read_b32 v185, a1
  v_accvgpr_read_b32 v186, a2
  v_accvgpr_read_b32 v187, a3
  v_accvgpr_read_b32 v188, a4
  v_accvgpr_read_b32 v189, a5
  v_accvgpr_read_b32 v190, a6
  v_accvgpr_read_b32 v191, a7
  v_cvt_pk_bf16_f32 v180, v184, v185
  v_cvt_pk_bf16_f32 v181, v186, v187
  v_cvt_pk_bf16_f32 v182, v188, v189
  v_cvt_pk_bf16_f32 v183, v190, v191
  buffer_store_dwordx4 v[180:183], v178, s[16:19], s92 offen offset:0 sc1
  v_accvgpr_read_b32 v196, a8
  v_accvgpr_read_b32 v197, a9
  v_accvgpr_read_b32 v198, a10
  v_accvgpr_read_b32 v199, a11
  v_accvgpr_read_b32 v200, a12
  v_accvgpr_read_b32 v201, a13
  v_accvgpr_read_b32 v202, a14
  v_accvgpr_read_b32 v203, a15
  v_cvt_pk_bf16_f32 v192, v196, v197
  v_cvt_pk_bf16_f32 v193, v198, v199
  v_cvt_pk_bf16_f32 v194, v200, v201
  v_cvt_pk_bf16_f32 v195, v202, v203
  buffer_store_dwordx4 v[192:195], v178, s[16:19], s92 offen offset:64 sc1
  s_add_u32 s92, s92, s94
  v_accvgpr_read_b32 v208, a16
  v_accvgpr_read_b32 v209, a17
  v_accvgpr_read_b32 v210, a18
  v_accvgpr_read_b32 v211, a19
  v_accvgpr_read_b32 v212, a20
  v_accvgpr_read_b32 v213, a21
  v_accvgpr_read_b32 v214, a22
  v_accvgpr_read_b32 v215, a23
  v_cvt_pk_bf16_f32 v204, v208, v209
  v_cvt_pk_bf16_f32 v205, v210, v211
  v_cvt_pk_bf16_f32 v206, v212, v213
  v_cvt_pk_bf16_f32 v207, v214, v215
  buffer_store_dwordx4 v[204:207], v178, s[16:19], s92 offen offset:0 sc1
  v_accvgpr_read_b32 v220, a24
  v_accvgpr_read_b32 v221, a25
  v_accvgpr_read_b32 v222, a26
  v_accvgpr_read_b32 v223, a27
  v_accvgpr_read_b32 v224, a28
  v_accvgpr_read_b32 v225, a29
  v_accvgpr_read_b32 v226, a30
  v_accvgpr_read_b32 v227, a31
  v_cvt_pk_bf16_f32 v216, v220, v221
  v_cvt_pk_bf16_f32 v217, v222, v223
  v_cvt_pk_bf16_f32 v218, v224, v225
  v_cvt_pk_bf16_f32 v219, v226, v227
  buffer_store_dwordx4 v[216:219], v178, s[16:19], s92 offen offset:64 sc1
  s_add_u32 s92, s92, s94
  v_accvgpr_read_b32 v184, a32
  v_accvgpr_read_b32 v185, a33
  v_accvgpr_read_b32 v186, a34
  v_accvgpr_read_b32 v187, a35
  v_accvgpr_read_b32 v188, a36
  v_accvgpr_read_b32 v189, a37
  v_accvgpr_read_b32 v190, a38
  v_accvgpr_read_b32 v191, a39
  v_cvt_pk_bf16_f32 v180, v184, v185
  v_cvt_pk_bf16_f32 v181, v186, v187
  v_cvt_pk_bf16_f32 v182, v188, v189
  v_cvt_pk_bf16_f32 v183, v190, v191
  buffer_store_dwordx4 v[180:183], v178, s[16:19], s92 offen offset:0 sc1
  v_accvgpr_read_b32 v196, a40
  v_accvgpr_read_b32 v197, a41
  v_accvgpr_read_b32 v198, a42
  v_accvgpr_read_b32 v199, a43
  v_accvgpr_read_b32 v200, a44
  v_accvgpr_read_b32 v201, a45
  v_accvgpr_read_b32 v202, a46
  v_accvgpr_read_b32 v203, a47
  v_cvt_pk_bf16_f32 v192, v196, v197
  v_cvt_pk_bf16_f32 v193, v198, v199
  v_cvt_pk_bf16_f32 v194, v200, v201
  v_cvt_pk_bf16_f32 v195, v202, v203
  buffer_store_dwordx4 v[192:195], v178, s[16:19], s92 offen offset:64 sc1
  s_add_u32 s92, s92, s94
  v_accvgpr_read_b32 v208, a48
  v_accvgpr_read_b32 v209, a49
  v_accvgpr_read_b32 v210, a50
  v_accvgpr_read_b32 v211, a51
  v_accvgpr_read_b32 v212, a52
  v_accvgpr_read_b32 v213, a53
  v_accvgpr_read_b32 v214, a54
  v_accvgpr_read_b32 v215, a55
  v_cvt_pk_bf16_f32 v204, v208, v209
  v_cvt_pk_bf16_f32 v205, v210, v211
  v_cvt_pk_bf16_f32 v206, v212, v213
  v_cvt_pk_bf16_f32 v207, v214, v215
  buffer_store_dwordx4 v[204:207], v178, s[16:19], s92 offen offset:0 sc1
  v_accvgpr_read_b32 v220, a56
  v_accvgpr_read_b32 v221, a57
  v_accvgpr_read_b32 v222, a58
  v_accvgpr_read_b32 v223, a59
  v_accvgpr_read_b32 v224, a60
  v_accvgpr_read_b32 v225, a61
  v_accvgpr_read_b32 v226, a62
  v_accvgpr_read_b32 v227, a63
  v_cvt_pk_bf16_f32 v216, v220, v221
  v_cvt_pk_bf16_f32 v217, v222, v223
  v_cvt_pk_bf16_f32 v218, v224, v225
  v_cvt_pk_bf16_f32 v219, v226, v227
  buffer_store_dwordx4 v[216:219], v178, s[16:19], s92 offen offset:64 sc1
  s_add_u32 s92, s92, s94
  s_branch L_epid
L_e4:
  s_cmp_lg_u32 s59, 6
  s_cbranch_scc1 L_e5
  s_lshr_b32 s90, s27, 1
  s_and_b32 s91, s27, 1
  v_and_b32 v176, 15, v1
  v_mul_lo_u32 v176, v176, s61
  v_lshrrev_b32 v177, 4, v1
  v_lshl_add_u32 v178, v177, 4, v176
  s_mul_i32 s92, s90, 128
  s_mul_i32 s92, s92, s61
  s_add_u32 s92, s92, s60
  s_mul_i32 s93, s91, 128
  s_add_u32 s92, s92, s93
  s_lshl_b32 s94, s61, 4
  v_accvgpr_read_b32 v184, a0
  v_accvgpr_read_b32 v185, a1
  v_accvgpr_read_b32 v186, a2
  v_accvgpr_read_b32 v187, a3
  v_accvgpr_read_b32 v188, a4
  v_accvgpr_read_b32 v189, a5
  v_accvgpr_read_b32 v190, a6
  v_accvgpr_read_b32 v191, a7
  v_cvt_pk_bf16_f32 v180, v184, v185
  v_cvt_pk_bf16_f32 v181, v186, v187
  v_cvt_pk_bf16_f32 v182, v188, v189
  v_cvt_pk_bf16_f32 v183, v190, v191
  buffer_store_dwordx4 v[180:183], v178, s[16:19], s92 offen offset:0 sc1
  v_accvgpr_read_b32 v196, a8
  v_accvgpr_read_b32 v197, a9
  v_accvgpr_read_b32 v198, a10
  v_accvgpr_read_b32 v199, a11
  v_accvgpr_read_b32 v200, a12
  v_accvgpr_read_b32 v201, a13
  v_accvgpr_read_b32 v202, a14
  v_accvgpr_read_b32 v203, a15
  v_cvt_pk_bf16_f32 v192, v196, v197
  v_cvt_pk_bf16_f32 v193, v198, v199
  v_cvt_pk_bf16_f32 v194, v200, v201
  v_cvt_pk_bf16_f32 v195, v202, v203
  buffer_store_dwordx4 v[192:195], v178, s[16:19], s92 offen offset:64 sc1
  s_add_u32 s92, s92, s94
  v_accvgpr_read_b32 v208, a16
  v_accvgpr_read_b32 v209, a17
  v_accvgpr_read_b32 v210, a18
  v_accvgpr_read_b32 v211, a19
  v_accvgpr_read_b32 v212, a20
  v_accvgpr_read_b32 v213, a21
  v_accvgpr_read_b32 v214, a22
  v_accvgpr_read_b32 v215, a23
  v_cvt_pk_bf16_f32 v204, v208, v209
  v_cvt_pk_bf16_f32 v205, v210, v211
  v_cvt_pk_bf16_f32 v206, v212, v213
  v_cvt_pk_bf16_f32 v207, v214, v215
  buffer_store_dwordx4 v[204:207], v178, s[16:19], s92 offen offset:0 sc1
  v_accvgpr_read_b32 v220, a24
  v_accvgpr_read_b32 v221, a25
  v_accvgpr_read_b32 v222, a26
  v_accvgpr_read_b32 v223, a27
  v_accvgpr_read_b32 v224, a28
  v_accvgpr_read_b32 v225, a29
  v_accvgpr_read_b32 v226, a30
  v_accvgpr_read_b32 v227, a31
  v_cvt_pk_bf16_f32 v216, v220, v221
  v_cvt_pk_bf16_f32 v217, v222, v223
  v_cvt_pk_bf16_f32 v218, v224, v225
  v_cvt_pk_bf16_f32 v219, v226, v227
  buffer_store_dwordx4 v[216:219], v178, s[16:19], s92 offen offset:64 sc1
  s_add_u32 s92, s92, s94
  v_accvgpr_read_b32 v184, a32
  v_accvgpr_read_b32 v185, a33
  v_accvgpr_read_b32 v186, a34
  v_accvgpr_read_b32 v187, a35
  v_accvgpr_read_b32 v188, a36
  v_accvgpr_read_b32 v189, a37
  v_accvgpr_read_b32 v190, a38
  v_accvgpr_read_b32 v191, a39
  v_cvt_pk_bf16_f32 v180, v184, v185
  v_cvt_pk_bf16_f32 v181, v186, v187
  v_cvt_pk_bf16_f32 v182, v188, v189
  v_cvt_pk_bf16_f32 v183, v190, v191
  buffer_store_dwordx4 v[180:183], v178, s[16:19], s92 offen offset:0 sc1
  v_accvgpr_read_b32 v196, a40
  v_accvgpr_read_b32 v197, a41
  v_accvgpr_read_b32 v198, a42
  v_accvgpr_read_b32 v199, a43
  v_accvgpr_read_b32 v200, a44
  v_accvgpr_read_b32 v201, a45
  v_accvgpr_read_b32 v202, a46
  v_accvgpr_read_b32 v203, a47
  v_cvt_pk_bf16_f32 v192, v196, v197
  v_cvt_pk_bf16_f32 v193, v198, v199
  v_cvt_pk_bf16_f32 v194, v200, v201
  v_cvt_pk_bf16_f32 v195, v202, v203
  buffer_store_dwordx4 v[192:195], v178, s[16:19], s92 offen offset:64 sc1
  s_add_u32 s92, s92, s94
  v_accvgpr_read_b32 v208, a48
  v_accvgpr_read_b32 v209, a49
  v_accvgpr_read_b32 v210, a50
  v_accvgpr_read_b32 v211, a51
  v_accvgpr_read_b32 v212, a52
  v_accvgpr_read_b32 v213, a53
  v_accvgpr_read_b32 v214, a54
  v_accvgpr_read_b32 v215, a55
  v_cvt_pk_bf16_f32 v204, v208, v209
  v_cvt_pk_bf16_f32 v205, v210, v211
  v_cvt_pk_bf16_f32 v206, v212, v213
  v_cvt_pk_bf16_f32 v207, v214, v215
  buffer_store_dwordx4 v[204:207], v178, s[16:19], s92 offen offset:0 sc1
  v_accvgpr_read_b32 v220, a56
  v_accvgpr_read_b32 v221, a57
  v_accvgpr_read_b32 v222, a58
  v_accvgpr_read_b32 v223, a59
  v_accvgpr_read_b32 v224, a60
  v_accvgpr_read_b32 v225, a61
  v_accvgpr_read_b32 v226, a62
  v_accvgpr_read_b32 v227, a63
  v_cvt_pk_bf16_f32 v216, v220, v221
  v_cvt_pk_bf16_f32 v217, v222, v223
  v_cvt_pk_bf16_f32 v218, v224, v225
  v_cvt_pk_bf16_f32 v219, v226, v227
  buffer_store_dwordx4 v[216:219], v178, s[16:19], s92 offen offset:64 sc1
  s_add_u32 s92, s92, s94
  v_accvgpr_read_b32 v184, a64
  v_accvgpr_read_b32 v185, a65
  v_accvgpr_read_b32 v186, a66
  v_accvgpr_read_b32 v187, a67
  v_accvgpr_read_b32 v188, a68
  v_accvgpr_read_b32 v189, a69
  v_accvgpr_read_b32 v190, a70
  v_accvgpr_read_b32 v191, a71
  v_cvt_pk_bf16_f32 v180, v184, v185
  v_cvt_pk_bf16_f32 v181, v186, v187
  v_cvt_pk_bf16_f32 v182, v188, v189
  v_cvt_pk_bf16_f32 v183, v190, v191
  buffer_store_dwordx4 v[180:183], v178, s[16:19], s92 offen offset:0 sc1
  v_accvgpr_read_b32 v196, a72
  v_accvgpr_read_b32 v197, a73
  v_accvgpr_read_b32 v198, a74
  v_accvgpr_read_b32 v199, a75
  v_accvgpr_read_b32 v200, a76
  v_accvgpr_read_b32 v201, a77
  v_accvgpr_read_b32 v202, a78
  v_accvgpr_read_b32 v203, a79
  v_cvt_pk_bf16_f32 v192, v196, v197
  v_cvt_pk_bf16_f32 v193, v198, v199
  v_cvt_pk_bf16_f32 v194, v200, v201
  v_cvt_pk_bf16_f32 v195, v202, v203
  buffer_store_dwordx4 v[192:195], v178, s[16:19], s92 offen offset:64 sc1
  s_add_u32 s92, s92, s94
  v_accvgpr_read_b32 v208, a80
  v_accvgpr_read_b32 v209, a81
  v_accvgpr_read_b32 v210, a82
  v_accvgpr_read_b32 v211, a83
  v_accvgpr_read_b32 v212, a84
  v_accvgpr_read_b32 v213, a85
  v_accvgpr_read_b32 v214, a86
  v_accvgpr_read_b32 v215, a87
  v_cvt_pk_bf16_f32 v204, v208, v209
  v_cvt_pk_bf16_f32 v205, v210, v211
  v_cvt_pk_bf16_f32 v206, v212, v213
  v_cvt_pk_bf16_f32 v207, v214, v215
  buffer_store_dwordx4 v[204:207], v178, s[16:19], s92 offen offset:0 sc1
  v_accvgpr_read_b32 v220, a88
  v_accvgpr_read_b32 v221, a89
  v_accvgpr_read_b32 v222, a90
  v_accvgpr_read_b32 v223, a91
  v_accvgpr_read_b32 v224, a92
  v_accvgpr_read_b32 v225, a93
  v_accvgpr_read_b32 v226, a94
  v_accvgpr_read_b32 v227, a95
  v_cvt_pk_bf16_f32 v216, v220, v221
  v_cvt_pk_bf16_f32 v217, v222, v223
  v_cvt_pk_bf16_f32 v218, v224, v225
  v_cvt_pk_bf16_f32 v219, v226, v227
  buffer_store_dwordx4 v[216:219], v178, s[16:19], s92 offen offset:64 sc1
  s_add_u32 s92, s92, s94
  v_accvgpr_read_b32 v184, a96
  v_accvgpr_read_b32 v185, a97
  v_accvgpr_read_b32 v186, a98
  v_accvgpr_read_b32 v187, a99
  v_accvgpr_read_b32 v188, a100
  v_accvgpr_read_b32 v189, a101
  v_accvgpr_read_b32 v190, a102
  v_accvgpr_read_b32 v191, a103
  v_cvt_pk_bf16_f32 v180, v184, v185
  v_cvt_pk_bf16_f32 v181, v186, v187
  v_cvt_pk_bf16_f32 v182, v188, v189
  v_cvt_pk_bf16_f32 v183, v190, v191
  buffer_store_dwordx4 v[180:183], v178, s[16:19], s92 offen offset:0 sc1
  v_accvgpr_read_b32 v196, a104
  v_accvgpr_read_b32 v197, a105
  v_accvgpr_read_b32 v198, a106
  v_accvgpr_read_b32 v199, a107
  v_accvgpr_read_b32 v200, a108
  v_accvgpr_read_b32 v201, a109
  v_accvgpr_read_b32 v202, a110
  v_accvgpr_read_b32 v203, a111
  v_cvt_pk_bf16_f32 v192, v196, v197
  v_cvt_pk_bf16_f32 v193, v198, v199
  v_cvt_pk_bf16_f32 v194, v200, v201
  v_cvt_pk_bf16_f32 v195, v202, v203
  buffer_store_dwordx4 v[192:195], v178, s[16:19], s92 offen offset:64 sc1
  s_add_u32 s92, s92, s94
  v_accvgpr_read_b32 v208, a112
  v_accvgpr_read_b32 v209, a113
  v_accvgpr_read_b32 v210, a114
  v_accvgpr_read_b32 v211, a115
  v_accvgpr_read_b32 v212, a116
  v_accvgpr_read_b32 v213, a117
  v_accvgpr_read_b32 v214, a118
  v_accvgpr_read_b32 v215, a119
  v_cvt_pk_bf16_f32 v204, v208, v209
  v_cvt_pk_bf16_f32 v205, v210, v211
  v_cvt_pk_bf16_f32 v206, v212, v213
  v_cvt_pk_bf16_f32 v207, v214, v215
  buffer_store_dwordx4 v[204:207], v178, s[16:19], s92 offen offset:0 sc1
  v_accvgpr_read_b32 v220, a120
  v_accvgpr_read_b32 v221, a121
  v_accvgpr_read_b32 v222, a122
  v_accvgpr_read_b32 v223, a123
  v_accvgpr_read_b32 v224, a124
  v_accvgpr_read_b32 v225, a125
  v_accvgpr_read_b32 v226, a126
  v_accvgpr_read_b32 v227, a127
  v_cvt_pk_bf16_f32 v216, v220, v221
  v_cvt_pk_bf16_f32 v217, v222, v223
  v_cvt_pk_bf16_f32 v218, v224, v225
  v_cvt_pk_bf16_f32 v219, v226, v227
  buffer_store_dwordx4 v[216:219], v178, s[16:19], s92 offen offset:64 sc1
  s_add_u32 s92, s92, s94
  s_branch L_epid
L_e5:
L_edef:
  s_mov_b32 s49, 1
  s_cmp_eq_u32 s58, 1
  s_cbranch_scc1 L_epid
  s_mov_b32 s49, 0
  buffer_store_dwordx4 v[176:179], v172, s[4:7], s46 offen offset:0 sc1
  buffer_store_dwordx4 v[180:183], v172, s[4:7], s46 offen offset:1024 sc1
  buffer_store_dwordx4 v[184:187], v172, s[4:7], s46 offen offset:2048 sc1
  buffer_store_dwordx4 v[188:191], v172, s[4:7], s46 offen offset:3072 sc1
  buffer_store_dwordx4 v[192:195], v173, s[4:7], s46 offen offset:0 sc1
  buffer_store_dwordx4 v[196:199], v173, s[4:7], s46 offen offset:1024 sc1
  buffer_store_dwordx4 v[200:203], v173, s[4:7], s46 offen offset:2048 sc1
  buffer_store_dwordx4 v[204:207], v173, s[4:7], s46 offen offset:3072 sc1
  buffer_store_dwordx4 v[208:211], v172, s[4:7], s47 offen offset:0 sc1
  buffer_store_dwordx4 v[212:215], v172, s[4:7], s47 offen offset:1024 sc1
  buffer_store_dwordx4 v[216:219], v172, s[4:7], s47 offen offset:2048 sc1
  buffer_store_dwordx4 v[220:223], v172, s[4:7], s47 offen offset:3072 sc1
  buffer_store_dwordx4 v[224:227], v173, s[4:7], s47 offen offset:0 sc1
  buffer_store_dwordx4 v[228:231], v173, s[4:7], s47 offen offset:1024 sc1
  buffer_store_dwordx4 v[232:235], v173, s[4:7], s47 offen offset:2048 sc1
  buffer_store_dwordx4 v[236:239], v173, s[4:7], s47 offen offset:3072 sc1
  s_mov_b32 s46, 0x40000000
  s_mov_b32 s47, 0x40000000
L_esig:
  s_waitcnt vmcnt(0)
  s_cmp_lg_u32 s39, 0
  s_cbranch_scc1 L_vok
  v_mbcnt_lo_u32_b32 v250, -1, 0
  v_mbcnt_hi_u32_b32 v250, -1, v250
  s_lshl_b32 s90, s32, 9
  s_add_u32 s90, s90, 147520
  v_lshl_add_u32 v251, v250, 3, s90
  ds_write_b64 v251, v[248:249]
  s_waitcnt lgkmcnt(0)
  s_cmp_lg_u32 s32, 0
  s_cbranch_scc1 L_vd_4
  v_lshlrev_b32 v250, 2, v250
  s_cmp_lg_u32 s100, 0
  s_cbranch_scc1 L_vw_3
  v_readfirstlane_b32 s90, v247
  s_and_b32 s90, s90, s101
  s_cbranch_scc0 L_vw_3
  v_mov_b32 v251, 1
  s_mov_b64 exec, 1
  buffer_store_dword v251, v250, s[28:31], 0 offen offset:32 sc1
  s_mov_b64 exec, -1
L_vw_3:
  buffer_load_dword v251, v250, s[28:31], 0 offen sc1
  s_waitcnt vmcnt(0)
  v_cmp_eq_u32 vcc, -1, v251
  v_readlane_b32 s91, v251, 8
  v_readlane_b32 s92, v251, 32
  v_readlane_b32 s93, v251, 33
  v_readlane_b32 s90, v251, 34
  s_cmp_lg_u32 s100, 0
  s_cselect_b32 s93, s90, s93
  s_cselect_b32 s91, 0, s91
  s_cselect_b32 s92, 1, s92
  s_cselect_b32 s90, 0xff, vcc_lo
  s_cmp_lg_u32 s91, 0
  s_cselect_b32 s92, 3, s92
  s_cbranch_scc1 L_vk_5
  s_add_u32 s3, s3, 1
  s_cmp_ge_u32 s3, 131072
  s_cselect_b32 s92, 4, s92
  s_cbranch_scc1 L_vk_5
  s_sleep 8
  s_and_b32 s90, s90, 0xff
  s_cmp_lg_u32 s90, 0xff
  s_cbranch_scc1 L_vw_3
  s_cmp_lt_u32 s93, 128
  s_cbranch_scc1 L_vw_3
L_vk_5:
  v_mov_b32 v251, s92
  v_mov_b32 v250, 147456
  ds_write_b32 v250, v251
  s_waitcnt lgkmcnt(0)
L_vd_4:
  s_barrier
  v_mov_b32 v250, 147456
  ds_read_b32 v251, v250
  s_waitcnt lgkmcnt(0)
  v_readfirstlane_b32 s92, v251
  s_barrier
  s_cmp_eq_u32 s92, 3
  s_cbranch_scc1 L_fallback
  s_cmp_eq_u32 s92, 4
  s_cbranch_scc1 L_exit
  s_mov_b32 s39, 1
L_vok:
  s_barrier
  s_cmp_lg_u32 s32, 0
  s_cbranch_scc1 L_sig_6
  v_mov_b32 v254, s63
  v_mov_b32 v255, 0
  v_and_b32 v254, 3, v254
  v_mbcnt_lo_u32_b32 v255, -1, 0
  v_lshlrev_b32 v255, 9, v255
  s_cmp_ge_u32 s63, 2
  s_cselect_b64 exec, 3, 1
  buffer_atomic_add v254, v255, s[4:7], s62 offen offset:0 sc1
  s_mov_b64 exec, -1
L_sig_6:
L_epid:
  s_mov_b32 s59, 0
  s_cmp_eq_u32 s58, 1
  s_cbranch_scc1 L_r1
  s_cmp_eq_u32 s58, 2
  s_cbranch_scc1 L_r2
  s_cmp_eq_u32 s58, 3
  s_cbranch_scc1 L_next
  s_cmp_eq_u32 s35, 4
  s_cbranch_scc1 L_atb
  s_cmp_eq_u32 s35, 5
  s_cbranch_scc1 L_bo
  s_cmp_eq_u32 s35, 6
  s_cbranch_scc1 L_ata
  s_cmp_eq_u32 s35, 11
  s_cbranch_scc1 L_ata4
  s_cmp_eq_u32 s35, 7
  s_cbranch_scc1 L_ao
  s_cmp_eq_u32 s35, 8
  s_cbranch_scc1 L_aos
  s_cmp_eq_u32 s35, 12
  s_cbranch_scc1 L_swp
  s_cmp_eq_u32 s35, 14
  s_cbranch_scc1 L_ao4
  s_cmp_eq_u32 s35, 16
  s_cbranch_scc1 L_ao
  s_cmp_eq_u32 s35, 17
  s_cbranch_scc1 L_bo
  s_branch L_exit
L_aqkv:
  s_mov_b32 s8, s64
  s_and_b32 s9, s65, 0xffff
  s_mov_b32 s10, 0x400000
  s_mov_b32 s11, 0x20000
  s_cmp_eq_u32 s35, 0
  s_cselect_b64 s[88:89], s[68:69], s[70:71]
  s_cmp_eq_u32 s35, 2
  s_cselect_b64 s[88:89], s[72:73], s[88:89]
  s_mov_b32 s12, s88
  s_and_b32 s13, s89, 0xffff
  s_mov_b32 s14, 0x800000
  s_mov_b32 s15, 0x20000
  s_lshl_b32 s91, s33, 2
  s_add_u32 s91, s91, s37
  s_mov_b32 s24, 8192
  s_mov_b32 s26, 262144
  s_lshl_b32 s20, s36, 19
  s_lshl_b32 s21, s91, 9
  s_lshl_b32 s22, s35, 24
  s_lshl_b32 s90, s36, 21
  s_add_u32 s22, s22, s90
  s_lshl_b32 s90, s91, 14
  s_add_u32 s22, s22, s90
  s_lshl_b32 s38, s36, 9
  s_add_u32 s38, s38, 28672
  s_cmp_eq_u32 s35, 0
  s_cselect_b32 s38, 8192, s38
  s_cselect_b32 s98, 1, 2
  s_mov_b32 s48, s35
  s_branch L_g1
L_bqkv:
  s_mov_b32 s8, s78
  s_and_b32 s9, s79, 0xffff
  s_mov_b32 s10, 0x400000
  s_mov_b32 s11, 0x20000
  s_mov_b32 s12, s80
  s_and_b32 s13, s81, 0xffff
  s_mov_b32 s14, 0x600000
  s_mov_b32 s15, 0x20000
  s_lshl_b32 s91, s37, 2
  s_add_u32 s91, s91, s33
  s_mov_b32 s24, 6144
  s_mov_b32 s26, 65536
  s_lshl_b32 s20, s36, 19
  s_lshl_b32 s21, s91, 9
  s_lshl_b32 s22, s37, 22
  s_lshl_b32 s90, s36, 19
  s_add_u32 s22, s22, s90
  s_lshl_b32 s90, s33, 14
  s_add_u32 s22, s22, s90
  s_add_u32 s22, s22, 0x4000000
  s_mov_b32 s38, 12288
  s_mov_b32 s48, s37
  s_mov_b32 s98, 1
L_g1:
  s_lshl_b32 s90, s36, 9
  s_add_u32 s38, s38, s90
  s_lshl_b32 s90, s33, 7
  s_add_u32 s38, s38, s90
  s_mov_b32 s23, 2048
  s_mov_b32 s25, 8
  v_and_b32 v1, 63, v0
  v_lshrrev_b32 v38, 6, v0
  s_nop 0
  v_readfirstlane_b32 s27, v38
  s_mul_i32 s90, s27, 64
  v_lshrrev_b32 v38, 3, v1
  v_add_u32 v38, s90, v38
  v_mul_lo_u32 v38, v38, s23
  v_lshrrev_b32 v39, 4, v1
  v_xor_b32 v39, v39, v1
  v_and_b32 v39, 7, v39
  v_lshl_add_u32 v2, v39, 4, v38
  s_mul_i32 s91, s23, 8
  v_add_u32 v3, s91, v2
  v_xor_b32 v3, 64, v3
  v_add_u32 v4, s91, v3
  v_xor_b32 v4, 64, v4
  v_add_u32 v5, s91, v4
  v_xor_b32 v5, 64, v5
  v_add_u32 v6, s91, v5
  v_xor_b32 v6, 64, v6
  v_add_u32 v7, s91, v6
  v_xor_b32 v7, 64, v7
  v_add_u32 v8, s91, v7
  v_xor_b32 v8, 64, v8
  v_add_u32 v9, s91, v8
  v_xor_b32 v9, 64, v9
  s_mul_i32 s90, s27, 16
  v_lshrrev_b32 v38, 5, v1
  v_add_u32 v38, 0, v38
  v_add_u32 v38, s90, v38
  v_mov_b32 v174, v38
  v_and_b32 v39, 3, v38
  v_lshlrev_b32 v39, 1, v39
  v_and_b32 v40, 8, v38
  v_or_b32 v39, v39, v40
  v_xor_b32 v39, v39, v1
  v_and_b32 v39, 31, v39
  v_mul_lo_u32 v38, v38, s24
  v_lshl_add_u32 v10, v39, 4, v38
  v_lshrrev_b32 v38, 5, v1
  v_add_u32 v38, 2, v38
  v_add_u32 v38, s90, v38
  v_and_b32 v39, 3, v38
  v_lshlrev_b32 v39, 1, v39
  v_and_b32 v40, 8, v38
  v_or_b32 v39, v39, v40
  v_xor_b32 v39, v39, v1
  v_and_b32 v39, 31, v39
  v_mul_lo_u32 v38, v38, s24
  v_lshl_add_u32 v11, v39, 4, v38
  v_lshrrev_b32 v38, 5, v1
  v_add_u32 v38, 4, v38
  v_add_u32 v38, s90, v38
  v_and_b32 v39, 3, v38
  v_lshlrev_b32 v39, 1, v39
  v_and_b32 v40, 8, v38
  v_or_b32 v39, v39, v40
  v_xor_b32 v39, v39, v1
  v_and_b32 v39, 31, v39
  v_mul_lo_u32 v38, v38, s24
  v_lshl_add_u32 v12, v39, 4, v38
  v_lshrrev_b32 v38, 5, v1
  v_add_u32 v38, 6, v38
  v_add_u32 v38, s90, v38
  v_and_b32 v39, 3, v38
  v_lshlrev_b32 v39, 1, v39
  v_and_b32 v40, 8, v38
  v_or_b32 v39, v39, v40
  v_xor_b32 v39, v39, v1
  v_and_b32 v39, 31, v39
  v_mul_lo_u32 v38, v38, s24
  v_lshl_add_u32 v13, v39, 4, v38
  v_lshrrev_b32 v38, 5, v1
  v_add_u32 v38, 8, v38
  v_add_u32 v38, s90, v38
  v_and_b32 v39, 3, v38
  v_lshlrev_b32 v39, 1, v39
  v_and_b32 v40, 8, v38
  v_or_b32 v39, v39, v40
  v_xor_b32 v39, v39, v1
  v_and_b32 v39, 31, v39
  v_mul_lo_u32 v38, v38, s24
  v_lshl_add_u32 v14, v39, 4, v38
  v_lshrrev_b32 v38, 5, v1
  v_add_u32 v38, 10, v38
  v_add_u32 v38, s90, v38
  v_and_b32 v39, 3, v38
  v_lshlrev_b32 v39, 1, v39
  v_and_b32 v40, 8, v38
  v_or_b32 v39, v39, v40
  v_xor_b32 v39, v39, v1
  v_and_b32 v39, 31, v39
  v_mul_lo_u32 v38, v38, s24
  v_lshl_add_u32 v15, v39, 4, v38
  v_lshrrev_b32 v38, 5, v1
  v_add_u32 v38, 12, v38
  v_add_u32 v38, s90, v38
  v_and_b32 v39, 3, v38
  v_lshlrev_b32 v39, 1, v39
  v_and_b32 v40, 8, v38
  v_or_b32 v39, v39, v40
  v_xor_b32 v39, v39, v1
  v_and_b32 v39, 31, v39
  v_mul_lo_u32 v38, v38, s24
  v_lshl_add_u32 v16, v39, 4, v38
  v_lshrrev_b32 v38, 5, v1
  v_add_u32 v38, 14, v38
  v_add_u32 v38, s90, v38
  v_and_b32 v39, 3, v38
  v_lshlrev_b32 v39, 1, v39
  v_and_b32 v40, 8, v38
  v_or_b32 v39, v39, v40
  v_xor_b32 v39, v39, v1
  v_and_b32 v39, 31, v39
  v_mul_lo_u32 v38, v38, s24
  v_lshl_add_u32 v17, v39, 4, v38
  s_mul_i32 s51, s24, 64
  s_mul_i32 s52, s27, 8192
  s_mul_i32 s53, s27, 8192
  s_add_u32 s53, s53, 32768
  s_add_u32 m0, s52, 0
  s_nop 0
  buffer_load_dwordx4 v2, s[8:11], s20 offen  lds
  s_add_u32 m0, s53, 0
  s_nop 0
  buffer_load_dwordx4 v10, s[12:15], s21 offen  lds
  s_add_u32 m0, s52, 1024
  s_nop 0
  buffer_load_dwordx4 v3, s[8:11], s20 offen  lds
  s_add_u32 m0, s53, 1024
  s_nop 0
  buffer_load_dwordx4 v11, s[12:15], s21 offen  lds
  s_add_u32 m0, s52, 2048
  s_nop 0
  buffer_load_dwordx4 v4, s[8:11], s20 offen  lds
  s_add_u32 m0, s53, 2048
  s_nop 0
  buffer_load_dwordx4 v12, s[12:15], s21 offen  lds
  s_add_u32 m0, s52, 3072
  s_nop 0
  buffer_load_dwordx4 v5, s[8:11], s20 offen  lds
  s_add_u32 m0, s53, 3072
  s_nop 0
  buffer_load_dwordx4 v13, s[12:15], s21 offen  lds
  s_add_u32 m0, s52, 4096
  s_nop 0
  buffer_load_dwordx4 v6, s[8:11], s20 offen  lds
  s_add_u32 m0, s53, 4096
  s_nop 0
  buffer_load_dwordx4 v14, s[12:15], s21 offen  lds
  s_add_u32 m0, s52, 5120
  s_nop 0
  buffer_load_dwordx4 v7, s[8:11], s20 offen  lds
  s_add_u32 m0, s53, 5120
  s_nop 0
  buffer_load_dwordx4 v15, s[12:15], s21 offen  lds
  s_add_u32 m0, s52, 6144
  s_nop 0
  buffer_load_dwordx4 v8, s[8:11], s20 offen  lds
  s_add_u32 m0, s53, 6144
  s_nop 0
  buffer_load_dwordx4 v16, s[12:15], s21 offen  lds
  s_add_u32 m0, s52, 7168
  s_nop 0
  buffer_load_dwordx4 v9, s[8:11], s20 offen  lds
  s_add_u32 m0, s53, 7168
  s_nop 0
  buffer_load_dwordx4 v17, s[12:15], s21 offen  lds
  s_add_u32 s20, s20, 128
  s_add_u32 s21, s21, s51
  s_add_u32 m0, s52, 65536
  s_nop 0
  buffer_load_dwordx4 v2, s[8:11], s20 offen  lds
  s_add_u32 m0, s53, 65536
  s_nop 0
  buffer_load_dwordx4 v10, s[12:15], s21 offen  lds
  s_add_u32 m0, s52, 66560
  s_nop 0
  buffer_load_dwordx4 v3, s[8:11], s20 offen  lds
  s_add_u32 m0, s53, 66560
  s_nop 0
  buffer_load_dwordx4 v11, s[12:15], s21 offen  lds
  s_add_u32 m0, s52, 67584
  s_nop 0
  buffer_load_dwordx4 v4, s[8:11], s20 offen  lds
  s_add_u32 m0, s53, 67584
  s_nop 0
  buffer_load_dwordx4 v12, s[12:15], s21 offen  lds
  s_add_u32 m0, s52, 68608
  s_nop 0
  buffer_load_dwordx4 v5, s[8:11], s20 offen  lds
  s_add_u32 m0, s53, 68608
  s_nop 0
  buffer_load_dwordx4 v13, s[12:15], s21 offen  lds
  s_add_u32 m0, s52, 69632
  s_nop 0
  buffer_load_dwordx4 v6, s[8:11], s20 offen  lds
  s_add_u32 m0, s53, 69632
  s_nop 0
  buffer_load_dwordx4 v14, s[12:15], s21 offen  lds
  s_add_u32 m0, s52, 70656
  s_nop 0
  buffer_load_dwordx4 v7, s[8:11], s20 offen  lds
  s_add_u32 m0, s53, 70656
  s_nop 0
  buffer_load_dwordx4 v15, s[12:15], s21 offen  lds
  s_add_u32 m0, s52, 71680
  s_nop 0
  buffer_load_dwordx4 v8, s[8:11], s20 offen  lds
  s_add_u32 m0, s53, 71680
  s_nop 0
  buffer_load_dwordx4 v16, s[12:15], s21 offen  lds
  s_add_u32 m0, s52, 72704
  s_nop 0
  buffer_load_dwordx4 v9, s[8:11], s20 offen  lds
  s_add_u32 m0, s53, 72704
  s_nop 0
  buffer_load_dwordx4 v17, s[12:15], s21 offen  lds
  s_add_u32 s20, s20, 128
  s_add_u32 s21, s21, s51
  s_lshr_b32 s90, s27, 1
  s_and_b32 s91, s27, 1
  s_mul_i32 s92, s90, 16384
  v_mov_b32 v38, 0x0
  v_bfe_u32 v39, v1, 0, 4
  v_lshl_add_u32 v38, v39, 7, v38
  v_add_u32 v38, s92, v38
  v_lshrrev_b32 v39, 1, v1
  v_and_b32 v39, 7, v39
  v_lshrrev_b32 v40, 4, v1
  v_xor_b32 v39, v39, v40
  v_lshl_add_u32 v18, v39, 4, v38
  v_xor_b32 v19, 64, v18
  v_add_u32 v20, 65536, v18
  v_add_u32 v21, 65536, v19
  v_mov_b32 v38, 0x0
  v_bfe_u32 v39, v1, 2, 2
  v_lshl_add_u32 v38, v39, 9, v38
  v_bfe_u32 v39, v1, 4, 2
  v_lshl_add_u32 v38, v39, 12, v38
  v_bfe_u32 v39, v1, 0, 2
  v_lshl_add_u32 v38, v39, 3, v38
  v_bfe_u32 v40, v1, 2, 3
  s_mul_i32 s92, s91, 8
  s_add_u32 s93, s92, 0
  v_xor_b32 v39, s93, v40
  v_lshl_add_u32 v22, v39, 5, v38
  v_add_u32 v30, 65536, v22
  s_add_u32 s93, s92, 1
  v_xor_b32 v39, s93, v40
  v_lshl_add_u32 v23, v39, 5, v38
  v_add_u32 v31, 65536, v23
  s_add_u32 s93, s92, 2
  v_xor_b32 v39, s93, v40
  v_lshl_add_u32 v24, v39, 5, v38
  v_add_u32 v32, 65536, v24
  s_add_u32 s93, s92, 3
  v_xor_b32 v39, s93, v40
  v_lshl_add_u32 v25, v39, 5, v38
  v_add_u32 v33, 65536, v25
  s_add_u32 s93, s92, 4
  v_xor_b32 v39, s93, v40
  v_lshl_add_u32 v26, v39, 5, v38
  v_add_u32 v34, 65536, v26
  s_add_u32 s93, s92, 5
  v_xor_b32 v39, s93, v40
  v_lshl_add_u32 v27, v39, 5, v38
  v_add_u32 v35, 65536, v27
  s_add_u32 s93, s92, 6
  v_xor_b32 v39, s93, v40
  v_lshl_add_u32 v28, v39, 5, v38
  v_add_u32 v36, 65536, v28
  s_add_u32 s93, s92, 7
  v_xor_b32 v39, s93, v40
  v_lshl_add_u32 v29, v39, 5, v38
  v_add_u32 v37, 65536, v29
  v_mov_b32 v241, 147456
  v_lshrrev_b32 v175, 4, v0
  v_add_u32 v175, v175, v241
  s_mov_b32 s58, 1
  s_branch L_epi
L_r1:
  s_cmp_eq_u32 s49, 1
  s_cbranch_scc1 L_r1c
  s_waitcnt vmcnt(16)
L_r1c:
  s_cmp_eq_u32 s48, 2
  s_cbranch_scc1 L_g2
  s_waitcnt vmcnt(16)
  s_barrier
  ds_read_b128 v[44:47], v18 offset:0
  ds_read_b64_tr_b16 v[108:109], v22 offset:32768
  ds_read_b64_tr_b16 v[110:111], v22 offset:34816
  ds_read_b128 v[48:51], v18 offset:2048
  ds_read_b64_tr_b16 v[112:113], v23 offset:32768
  ds_read_b64_tr_b16 v[114:115], v23 offset:34816
  ds_read_b128 v[52:55], v18 offset:4096
  ds_read_b64_tr_b16 v[116:117], v24 offset:32768
  ds_read_b64_tr_b16 v[118:119], v24 offset:34816
  ds_read_b128 v[56:59], v18 offset:6144
  ds_read_b64_tr_b16 v[120:121], v25 offset:32768
  ds_read_b64_tr_b16 v[122:123], v25 offset:34816
  ds_read_b128 v[60:63], v18 offset:8192
  ds_read_b64_tr_b16 v[124:125], v26 offset:32768
  ds_read_b64_tr_b16 v[126:127], v26 offset:34816
  ds_read_b128 v[64:67], v18 offset:10240
  ds_read_b64_tr_b16 v[128:129], v27 offset:32768
  ds_read_b64_tr_b16 v[130:131], v27 offset:34816
  ds_read_b128 v[68:71], v18 offset:12288
  ds_read_b64_tr_b16 v[132:133], v28 offset:32768
  ds_read_b64_tr_b16 v[134:135], v28 offset:34816
  ds_read_b128 v[72:75], v18 offset:14336
  ds_read_b64_tr_b16 v[136:137], v29 offset:32768
  ds_read_b64_tr_b16 v[138:139], v29 offset:34816
  s_sub_u32 s25, s25, 1
  s_waitcnt lgkmcnt(0)
  s_nop 0
  v_mfma_f32_16x16x32_bf16 a[0:3], v[108:111], v[44:47], 0
  buffer_store_dwordx4 v[176:179], v172, s[4:7], s46 offen offset:0 sc1
  ds_read_b128 v[76:79], v19 offset:0
  v_mfma_f32_16x16x32_bf16 a[4:7], v[112:115], v[44:47], 0
  v_mfma_f32_16x16x32_bf16 a[8:11], v[116:119], v[44:47], 0
  ds_read_b64_tr_b16 v[140:141], v22 offset:49152
  v_mfma_f32_16x16x32_bf16 a[12:15], v[120:123], v[44:47], 0
  s_nop 0
  v_mfma_f32_16x16x32_bf16 a[16:19], v[124:127], v[44:47], 0
  buffer_store_dwordx4 v[180:183], v172, s[4:7], s46 offen offset:1024 sc1
  ds_read_b64_tr_b16 v[142:143], v22 offset:51200
  v_mfma_f32_16x16x32_bf16 a[20:23], v[128:131], v[44:47], 0
  v_mfma_f32_16x16x32_bf16 a[24:27], v[132:135], v[44:47], 0
  ds_read_b128 v[80:83], v19 offset:2048
  v_mfma_f32_16x16x32_bf16 a[28:31], v[136:139], v[44:47], 0
  s_nop 0
  v_mfma_f32_16x16x32_bf16 a[32:35], v[108:111], v[48:51], 0
  buffer_store_dwordx4 v[184:187], v172, s[4:7], s46 offen offset:2048 sc1
  ds_read_b64_tr_b16 v[144:145], v23 offset:49152
  v_mfma_f32_16x16x32_bf16 a[36:39], v[112:115], v[48:51], 0
  v_mfma_f32_16x16x32_bf16 a[40:43], v[116:119], v[48:51], 0
  ds_read_b64_tr_b16 v[146:147], v23 offset:51200
  v_mfma_f32_16x16x32_bf16 a[44:47], v[120:123], v[48:51], 0
  s_nop 0
  v_mfma_f32_16x16x32_bf16 a[48:51], v[124:127], v[48:51], 0
  buffer_store_dwordx4 v[188:191], v172, s[4:7], s46 offen offset:3072 sc1
  ds_read_b128 v[84:87], v19 offset:4096
  v_mfma_f32_16x16x32_bf16 a[52:55], v[128:131], v[48:51], 0
  v_mfma_f32_16x16x32_bf16 a[56:59], v[132:135], v[48:51], 0
  ds_read_b64_tr_b16 v[148:149], v24 offset:49152
  v_mfma_f32_16x16x32_bf16 a[60:63], v[136:139], v[48:51], 0
  s_nop 0
  v_mfma_f32_16x16x32_bf16 a[64:67], v[108:111], v[52:55], 0
  buffer_store_dwordx4 v[192:195], v173, s[4:7], s46 offen offset:0 sc1
  ds_read_b64_tr_b16 v[150:151], v24 offset:51200
  v_mfma_f32_16x16x32_bf16 a[68:71], v[112:115], v[52:55], 0
  v_mfma_f32_16x16x32_bf16 a[72:75], v[116:119], v[52:55], 0
  ds_read_b128 v[88:91], v19 offset:6144
  v_mfma_f32_16x16x32_bf16 a[76:79], v[120:123], v[52:55], 0
  s_nop 0
  v_mfma_f32_16x16x32_bf16 a[80:83], v[124:127], v[52:55], 0
  buffer_store_dwordx4 v[196:199], v173, s[4:7], s46 offen offset:1024 sc1
  ds_read_b64_tr_b16 v[152:153], v25 offset:49152
  v_mfma_f32_16x16x32_bf16 a[84:87], v[128:131], v[52:55], 0
  v_mfma_f32_16x16x32_bf16 a[88:91], v[132:135], v[52:55], 0
  ds_read_b64_tr_b16 v[154:155], v25 offset:51200
  v_mfma_f32_16x16x32_bf16 a[92:95], v[136:139], v[52:55], 0
  s_nop 0
  v_mfma_f32_16x16x32_bf16 a[96:99], v[108:111], v[56:59], 0
  buffer_store_dwordx4 v[200:203], v173, s[4:7], s46 offen offset:2048 sc1
  ds_read_b128 v[92:95], v19 offset:8192
  v_mfma_f32_16x16x32_bf16 a[100:103], v[112:115], v[56:59], 0
  v_mfma_f32_16x16x32_bf16 a[104:107], v[116:119], v[56:59], 0
  ds_read_b64_tr_b16 v[156:157], v26 offset:49152
  v_mfma_f32_16x16x32_bf16 a[108:111], v[120:123], v[56:59], 0
  s_nop 0
  v_mfma_f32_16x16x32_bf16 a[112:115], v[124:127], v[56:59], 0
  buffer_store_dwordx4 v[204:207], v173, s[4:7], s46 offen offset:3072 sc1
  ds_read_b64_tr_b16 v[158:159], v26 offset:51200
  v_mfma_f32_16x16x32_bf16 a[116:119], v[128:131], v[56:59], 0
  v_mfma_f32_16x16x32_bf16 a[120:123], v[132:135], v[56:59], 0
  ds_read_b128 v[96:99], v19 offset:10240
  v_mfma_f32_16x16x32_bf16 a[124:127], v[136:139], v[56:59], 0
  s_nop 0
  v_mfma_f32_16x16x32_bf16 a[128:131], v[108:111], v[60:63], 0
  buffer_store_dwordx4 v[208:211], v172, s[4:7], s47 offen offset:0 sc1
  ds_read_b64_tr_b16 v[160:161], v27 offset:49152
  v_mfma_f32_16x16x32_bf16 a[132:135], v[112:115], v[60:63], 0
  v_mfma_f32_16x16x32_bf16 a[136:139], v[116:119], v[60:63], 0
  ds_read_b64_tr_b16 v[162:163], v27 offset:51200
  v_mfma_f32_16x16x32_bf16 a[140:143], v[120:123], v[60:63], 0
  s_nop 0
  v_mfma_f32_16x16x32_bf16 a[144:147], v[124:127], v[60:63], 0
  buffer_store_dwordx4 v[212:215], v172, s[4:7], s47 offen offset:1024 sc1
  ds_read_b128 v[100:103], v19 offset:12288
  v_mfma_f32_16x16x32_bf16 a[148:151], v[128:131], v[60:63], 0
  v_mfma_f32_16x16x32_bf16 a[152:155], v[132:135], v[60:63], 0
  ds_read_b64_tr_b16 v[164:165], v28 offset:49152
  v_mfma_f32_16x16x32_bf16 a[156:159], v[136:139], v[60:63], 0
  s_nop 0
  v_mfma_f32_16x16x32_bf16 a[160:163], v[108:111], v[64:67], 0
  buffer_store_dwordx4 v[216:219], v172, s[4:7], s47 offen offset:2048 sc1
  ds_read_b64_tr_b16 v[166:167], v28 offset:51200
  v_mfma_f32_16x16x32_bf16 a[164:167], v[112:115], v[64:67], 0
  v_mfma_f32_16x16x32_bf16 a[168:171], v[116:119], v[64:67], 0
  ds_read_b128 v[104:107], v19 offset:14336
  v_mfma_f32_16x16x32_bf16 a[172:175], v[120:123], v[64:67], 0
  s_nop 0
  v_mfma_f32_16x16x32_bf16 a[176:179], v[124:127], v[64:67], 0
  buffer_store_dwordx4 v[220:223], v172, s[4:7], s47 offen offset:3072 sc1
  ds_read_b64_tr_b16 v[168:169], v29 offset:49152
  v_mfma_f32_16x16x32_bf16 a[180:183], v[128:131], v[64:67], 0
  v_mfma_f32_16x16x32_bf16 a[184:187], v[132:135], v[64:67], 0
  ds_read_b64_tr_b16 v[170:171], v29 offset:51200
  v_mfma_f32_16x16x32_bf16 a[188:191], v[136:139], v[64:67], 0
  s_nop 0
  v_mfma_f32_16x16x32_bf16 a[192:195], v[108:111], v[68:71], 0
  buffer_store_dwordx4 v[224:227], v173, s[4:7], s47 offen offset:0 sc1
  v_mfma_f32_16x16x32_bf16 a[196:199], v[112:115], v[68:71], 0
  v_mfma_f32_16x16x32_bf16 a[200:203], v[116:119], v[68:71], 0
  v_mfma_f32_16x16x32_bf16 a[204:207], v[120:123], v[68:71], 0
  s_nop 0
  v_mfma_f32_16x16x32_bf16 a[208:211], v[124:127], v[68:71], 0
  buffer_store_dwordx4 v[228:231], v173, s[4:7], s47 offen offset:1024 sc1
  v_mfma_f32_16x16x32_bf16 a[212:215], v[128:131], v[68:71], 0
  v_mfma_f32_16x16x32_bf16 a[216:219], v[132:135], v[68:71], 0
  v_mfma_f32_16x16x32_bf16 a[220:223], v[136:139], v[68:71], 0
  s_nop 0
  v_mfma_f32_16x16x32_bf16 a[224:227], v[108:111], v[72:75], 0
  buffer_store_dwordx4 v[232:235], v173, s[4:7], s47 offen offset:2048 sc1
  v_mfma_f32_16x16x32_bf16 a[228:231], v[112:115], v[72:75], 0
  v_mfma_f32_16x16x32_bf16 a[232:235], v[116:119], v[72:75], 0
  v_mfma_f32_16x16x32_bf16 a[236:239], v[120:123], v[72:75], 0
  s_nop 0
  v_mfma_f32_16x16x32_bf16 a[240:243], v[124:127], v[72:75], 0
  buffer_store_dwordx4 v[236:239], v173, s[4:7], s47 offen offset:3072 sc1
  v_mfma_f32_16x16x32_bf16 a[244:247], v[128:131], v[72:75], 0
  v_mfma_f32_16x16x32_bf16 a[248:251], v[132:135], v[72:75], 0
  v_mfma_f32_16x16x32_bf16 a[252:255], v[136:139], v[72:75], 0
  s_waitcnt lgkmcnt(0)
  v_mfma_f32_16x16x32_bf16 a[0:3], v[140:143], v[76:79], a[0:3]
  s_waitcnt vmcnt(16)
  s_barrier
  s_add_u32 m0, s52, 0
  v_mfma_f32_16x16x32_bf16 a[4:7], v[144:147], v[76:79], a[4:7]
  buffer_load_dwordx4 v2, s[8:11], s20 offen  lds
  ds_read_b128 v[44:47], v20 offset:0
  v_mfma_f32_16x16x32_bf16 a[8:11], v[148:151], v[76:79], a[8:11]
  v_mfma_f32_16x16x32_bf16 a[12:15], v[152:155], v[76:79], a[12:15]
  ds_read_b64_tr_b16 v[108:109], v30 offset:32768
  s_add_u32 m0, s53, 0
  v_mfma_f32_16x16x32_bf16 a[16:19], v[156:159], v[76:79], a[16:19]
  buffer_load_dwordx4 v10, s[12:15], s21 offen  lds
  v_mfma_f32_16x16x32_bf16 a[20:23], v[160:163], v[76:79], a[20:23]
  ds_read_b64_tr_b16 v[110:111], v30 offset:34816
  v_mfma_f32_16x16x32_bf16 a[24:27], v[164:167], v[76:79], a[24:27]
  v_mfma_f32_16x16x32_bf16 a[28:31], v[168:171], v[76:79], a[28:31]
  ds_read_b128 v[48:51], v20 offset:2048
  s_add_u32 m0, s52, 1024
  v_mfma_f32_16x16x32_bf16 a[32:35], v[140:143], v[80:83], a[32:35]
  buffer_load_dwordx4 v3, s[8:11], s20 offen  lds
  v_mfma_f32_16x16x32_bf16 a[36:39], v[144:147], v[80:83], a[36:39]
  ds_read_b64_tr_b16 v[112:113], v31 offset:32768
  v_mfma_f32_16x16x32_bf16 a[40:43], v[148:151], v[80:83], a[40:43]
  v_mfma_f32_16x16x32_bf16 a[44:47], v[152:155], v[80:83], a[44:47]
  ds_read_b64_tr_b16 v[114:115], v31 offset:34816
  s_add_u32 m0, s53, 1024
  v_mfma_f32_16x16x32_bf16 a[48:51], v[156:159], v[80:83], a[48:51]
  buffer_load_dwordx4 v11, s[12:15], s21 offen  lds
  v_mfma_f32_16x16x32_bf16 a[52:55], v[160:163], v[80:83], a[52:55]
  ds_read_b128 v[52:55], v20 offset:4096
  v_mfma_f32_16x16x32_bf16 a[56:59], v[164:167], v[80:83], a[56:59]
  s_add_u32 m0, s52, 2048
  v_mfma_f32_16x16x32_bf16 a[60:63], v[168:171], v[80:83], a[60:63]
  buffer_load_dwordx4 v4, s[8:11], s20 offen  lds
  ds_read_b64_tr_b16 v[116:117], v32 offset:32768
  v_mfma_f32_16x16x32_bf16 a[64:67], v[140:143], v[84:87], a[64:67]
  v_mfma_f32_16x16x32_bf16 a[68:71], v[144:147], v[84:87], a[68:71]
  ds_read_b64_tr_b16 v[118:119], v32 offset:34816
  v_mfma_f32_16x16x32_bf16 a[72:75], v[148:151], v[84:87], a[72:75]
  s_add_u32 m0, s53, 2048
  v_mfma_f32_16x16x32_bf16 a[76:79], v[152:155], v[84:87], a[76:79]
  buffer_load_dwordx4 v12, s[12:15], s21 offen  lds
  ds_read_b128 v[56:59], v20 offset:6144
  v_mfma_f32_16x16x32_bf16 a[80:83], v[156:159], v[84:87], a[80:83]
  v_mfma_f32_16x16x32_bf16 a[84:87], v[160:163], v[84:87], a[84:87]
  ds_read_b64_tr_b16 v[120:121], v33 offset:32768
  v_mfma_f32_16x16x32_bf16 a[88:91], v[164:167], v[84:87], a[88:91]
  s_add_u32 m0, s52, 3072
  v_mfma_f32_16x16x32_bf16 a[92:95], v[168:171], v[84:87], a[92:95]
  buffer_load_dwordx4 v5, s[8:11], s20 offen  lds
  ds_read_b64_tr_b16 v[122:123], v33 offset:34816
  v_mfma_f32_16x16x32_bf16 a[96:99], v[140:143], v[88:91], a[96:99]
  v_mfma_f32_16x16x32_bf16 a[100:103], v[144:147], v[88:91], a[100:103]
  ds_read_b128 v[60:63], v20 offset:8192
  s_add_u32 m0, s53, 3072
  v_mfma_f32_16x16x32_bf16 a[104:107], v[148:151], v[88:91], a[104:107]
  buffer_load_dwordx4 v13, s[12:15], s21 offen  lds
  v_mfma_f32_16x16x32_bf16 a[108:111], v[152:155], v[88:91], a[108:111]
  ds_read_b64_tr_b16 v[124:125], v34 offset:32768
  v_mfma_f32_16x16x32_bf16 a[112:115], v[156:159], v[88:91], a[112:115]
  v_mfma_f32_16x16x32_bf16 a[116:119], v[160:163], v[88:91], a[116:119]
  ds_read_b64_tr_b16 v[126:127], v34 offset:34816
  s_add_u32 m0, s52, 4096
  v_mfma_f32_16x16x32_bf16 a[120:123], v[164:167], v[88:91], a[120:123]
  buffer_load_dwordx4 v6, s[8:11], s20 offen  lds
  v_mfma_f32_16x16x32_bf16 a[124:127], v[168:171], v[88:91], a[124:127]
  ds_read_b128 v[64:67], v20 offset:10240
  v_mfma_f32_16x16x32_bf16 a[128:131], v[140:143], v[92:95], a[128:131]
  v_mfma_f32_16x16x32_bf16 a[132:135], v[144:147], v[92:95], a[132:135]
  ds_read_b64_tr_b16 v[128:129], v35 offset:32768
  s_add_u32 m0, s53, 4096
  v_mfma_f32_16x16x32_bf16 a[136:139], v[148:151], v[92:95], a[136:139]
  buffer_load_dwordx4 v14, s[12:15], s21 offen  lds
  v_mfma_f32_16x16x32_bf16 a[140:143], v[152:155], v[92:95], a[140:143]
  ds_read_b64_tr_b16 v[130:131], v35 offset:34816
  v_mfma_f32_16x16x32_bf16 a[144:147], v[156:159], v[92:95], a[144:147]
  v_mfma_f32_16x16x32_bf16 a[148:151], v[160:163], v[92:95], a[148:151]
  ds_read_b128 v[68:71], v20 offset:12288
  s_add_u32 m0, s52, 5120
  v_mfma_f32_16x16x32_bf16 a[152:155], v[164:167], v[92:95], a[152:155]
  buffer_load_dwordx4 v7, s[8:11], s20 offen  lds
  v_mfma_f32_16x16x32_bf16 a[156:159], v[168:171], v[92:95], a[156:159]
  ds_read_b64_tr_b16 v[132:133], v36 offset:32768
  v_mfma_f32_16x16x32_bf16 a[160:163], v[140:143], v[96:99], a[160:163]
  s_add_u32 m0, s53, 5120
  v_mfma_f32_16x16x32_bf16 a[164:167], v[144:147], v[96:99], a[164:167]
  buffer_load_dwordx4 v15, s[12:15], s21 offen  lds
  ds_read_b64_tr_b16 v[134:135], v36 offset:34816
  v_mfma_f32_16x16x32_bf16 a[168:171], v[148:151], v[96:99], a[168:171]
  v_mfma_f32_16x16x32_bf16 a[172:175], v[152:155], v[96:99], a[172:175]
  ds_read_b128 v[72:75], v20 offset:14336
  v_mfma_f32_16x16x32_bf16 a[176:179], v[156:159], v[96:99], a[176:179]
  s_add_u32 m0, s52, 6144
  v_mfma_f32_16x16x32_bf16 a[180:183], v[160:163], v[96:99], a[180:183]
  buffer_load_dwordx4 v8, s[8:11], s20 offen  lds
  ds_read_b64_tr_b16 v[136:137], v37 offset:32768
  v_mfma_f32_16x16x32_bf16 a[184:187], v[164:167], v[96:99], a[184:187]
  v_mfma_f32_16x16x32_bf16 a[188:191], v[168:171], v[96:99], a[188:191]
  ds_read_b64_tr_b16 v[138:139], v37 offset:34816
  v_mfma_f32_16x16x32_bf16 a[192:195], v[140:143], v[100:103], a[192:195]
  s_add_u32 m0, s53, 6144
  v_mfma_f32_16x16x32_bf16 a[196:199], v[144:147], v[100:103], a[196:199]
  buffer_load_dwordx4 v16, s[12:15], s21 offen  lds
  v_mfma_f32_16x16x32_bf16 a[200:203], v[148:151], v[100:103], a[200:203]
  v_mfma_f32_16x16x32_bf16 a[204:207], v[152:155], v[100:103], a[204:207]
  s_add_u32 m0, s52, 7168
  v_mfma_f32_16x16x32_bf16 a[208:211], v[156:159], v[100:103], a[208:211]
  buffer_load_dwordx4 v9, s[8:11], s20 offen  lds
  v_mfma_f32_16x16x32_bf16 a[212:215], v[160:163], v[100:103], a[212:215]
  v_mfma_f32_16x16x32_bf16 a[216:219], v[164:167], v[100:103], a[216:219]
  v_mfma_f32_16x16x32_bf16 a[220:223], v[168:171], v[100:103], a[220:223]
  s_add_u32 m0, s53, 7168
  v_mfma_f32_16x16x32_bf16 a[224:227], v[140:143], v[104:107], a[224:227]
  buffer_load_dwordx4 v17, s[12:15], s21 offen  lds
  v_mfma_f32_16x16x32_bf16 a[228:231], v[144:147], v[104:107], a[228:231]
  v_mfma_f32_16x16x32_bf16 a[232:235], v[148:151], v[104:107], a[232:235]
  v_mfma_f32_16x16x32_bf16 a[236:239], v[152:155], v[104:107], a[236:239]
  s_add_u32 s20, s20, 128
  v_mfma_f32_16x16x32_bf16 a[240:243], v[156:159], v[104:107], a[240:243]
  s_add_u32 s21, s21, s51
  v_mfma_f32_16x16x32_bf16 a[244:247], v[160:163], v[104:107], a[244:247]
  v_mfma_f32_16x16x32_bf16 a[248:251], v[164:167], v[104:107], a[248:251]
  v_mfma_f32_16x16x32_bf16 a[252:255], v[168:171], v[104:107], a[252:255]
  s_waitcnt lgkmcnt(0)
  v_mfma_f32_16x16x32_bf16 a[0:3], v[108:111], v[44:47], a[0:3]
  ds_read_b128 v[76:79], v21 offset:0
  v_mfma_f32_16x16x32_bf16 a[4:7], v[112:115], v[44:47], a[4:7]
  v_mfma_f32_16x16x32_bf16 a[8:11], v[116:119], v[44:47], a[8:11]
  ds_read_b64_tr_b16 v[140:141], v30 offset:49152
  v_mfma_f32_16x16x32_bf16 a[12:15], v[120:123], v[44:47], a[12:15]
  v_mfma_f32_16x16x32_bf16 a[16:19], v[124:127], v[44:47], a[16:19]
  ds_read_b64_tr_b16 v[142:143], v30 offset:51200
  v_mfma_f32_16x16x32_bf16 a[20:23], v[128:131], v[44:47], a[20:23]
  v_mfma_f32_16x16x32_bf16 a[24:27], v[132:135], v[44:47], a[24:27]
  ds_read_b128 v[80:83], v21 offset:2048
  v_mfma_f32_16x16x32_bf16 a[28:31], v[136:139], v[44:47], a[28:31]
  v_mfma_f32_16x16x32_bf16 a[32:35], v[108:111], v[48:51], a[32:35]
  ds_read_b64_tr_b16 v[144:145], v31 offset:49152
  v_mfma_f32_16x16x32_bf16 a[36:39], v[112:115], v[48:51], a[36:39]
  v_mfma_f32_16x16x32_bf16 a[40:43], v[116:119], v[48:51], a[40:43]
  ds_read_b64_tr_b16 v[146:147], v31 offset:51200
  v_mfma_f32_16x16x32_bf16 a[44:47], v[120:123], v[48:51], a[44:47]
  v_mfma_f32_16x16x32_bf16 a[48:51], v[124:127], v[48:51], a[48:51]
  ds_read_b128 v[84:87], v21 offset:4096
  v_mfma_f32_16x16x32_bf16 a[52:55], v[128:131], v[48:51], a[52:55]
  v_mfma_f32_16x16x32_bf16 a[56:59], v[132:135], v[48:51], a[56:59]
  ds_read_b64_tr_b16 v[148:149], v32 offset:49152
  v_mfma_f32_16x16x32_bf16 a[60:63], v[136:139], v[48:51], a[60:63]
  v_mfma_f32_16x16x32_bf16 a[64:67], v[108:111], v[52:55], a[64:67]
  ds_read_b64_tr_b16 v[150:151], v32 offset:51200
  v_mfma_f32_16x16x32_bf16 a[68:71], v[112:115], v[52:55], a[68:71]
  v_mfma_f32_16x16x32_bf16 a[72:75], v[116:119], v[52:55], a[72:75]
  ds_read_b128 v[88:91], v21 offset:6144
  v_mfma_f32_16x16x32_bf16 a[76:79], v[120:123], v[52:55], a[76:79]
  v_mfma_f32_16x16x32_bf16 a[80:83], v[124:127], v[52:55], a[80:83]
  ds_read_b64_tr_b16 v[152:153], v33 offset:49152
  v_mfma_f32_16x16x32_bf16 a[84:87], v[128:131], v[52:55], a[84:87]
  v_mfma_f32_16x16x32_bf16 a[88:91], v[132:135], v[52:55], a[88:91]
  ds_read_b64_tr_b16 v[154:155], v33 offset:51200
  v_mfma_f32_16x16x32_bf16 a[92:95], v[136:139], v[52:55], a[92:95]
  v_mfma_f32_16x16x32_bf16 a[96:99], v[108:111], v[56:59], a[96:99]
  ds_read_b128 v[92:95], v21 offset:8192
  v_mfma_f32_16x16x32_bf16 a[100:103], v[112:115], v[56:59], a[100:103]
  v_mfma_f32_16x16x32_bf16 a[104:107], v[116:119], v[56:59], a[104:107]
  ds_read_b64_tr_b16 v[156:157], v34 offset:49152
  v_mfma_f32_16x16x32_bf16 a[108:111], v[120:123], v[56:59], a[108:111]
  v_mfma_f32_16x16x32_bf16 a[112:115], v[124:127], v[56:59], a[112:115]
  ds_read_b64_tr_b16 v[158:159], v34 offset:51200
  v_mfma_f32_16x16x32_bf16 a[116:119], v[128:131], v[56:59], a[116:119]
  v_mfma_f32_16x16x32_bf16 a[120:123], v[132:135], v[56:59], a[120:123]
  ds_read_b128 v[96:99], v21 offset:10240
  v_mfma_f32_16x16x32_bf16 a[124:127], v[136:139], v[56:59], a[124:127]
  v_mfma_f32_16x16x32_bf16 a[128:131], v[108:111], v[60:63], a[128:131]
  ds_read_b64_tr_b16 v[160:161], v35 offset:49152
  v_mfma_f32_16x16x32_bf16 a[132:135], v[112:115], v[60:63], a[132:135]
  v_mfma_f32_16x16x32_bf16 a[136:139], v[116:119], v[60:63], a[136:139]
  ds_read_b64_tr_b16 v[162:163], v35 offset:51200
  v_mfma_f32_16x16x32_bf16 a[140:143], v[120:123], v[60:63], a[140:143]
  v_mfma_f32_16x16x32_bf16 a[144:147], v[124:127], v[60:63], a[144:147]
  ds_read_b128 v[100:103], v21 offset:12288
  v_mfma_f32_16x16x32_bf16 a[148:151], v[128:131], v[60:63], a[148:151]
  v_mfma_f32_16x16x32_bf16 a[152:155], v[132:135], v[60:63], a[152:155]
  ds_read_b64_tr_b16 v[164:165], v36 offset:49152
  v_mfma_f32_16x16x32_bf16 a[156:159], v[136:139], v[60:63], a[156:159]
  v_mfma_f32_16x16x32_bf16 a[160:163], v[108:111], v[64:67], a[160:163]
  ds_read_b64_tr_b16 v[166:167], v36 offset:51200
  v_mfma_f32_16x16x32_bf16 a[164:167], v[112:115], v[64:67], a[164:167]
  v_mfma_f32_16x16x32_bf16 a[168:171], v[116:119], v[64:67], a[168:171]
  ds_read_b128 v[104:107], v21 offset:14336
  v_mfma_f32_16x16x32_bf16 a[172:175], v[120:123], v[64:67], a[172:175]
  v_mfma_f32_16x16x32_bf16 a[176:179], v[124:127], v[64:67], a[176:179]
  ds_read_b64_tr_b16 v[168:169], v37 offset:49152
  v_mfma_f32_16x16x32_bf16 a[180:183], v[128:131], v[64:67], a[180:183]
  v_mfma_f32_16x16x32_bf16 a[184:187], v[132:135], v[64:67], a[184:187]
  ds_read_b64_tr_b16 v[170:171], v37 offset:51200
  v_mfma_f32_16x16x32_bf16 a[188:191], v[136:139], v[64:67], a[188:191]
  v_mfma_f32_16x16x32_bf16 a[192:195], v[108:111], v[68:71], a[192:195]
  v_mfma_f32_16x16x32_bf16 a[196:199], v[112:115], v[68:71], a[196:199]
  v_mfma_f32_16x16x32_bf16 a[200:203], v[116:119], v[68:71], a[200:203]
  v_mfma_f32_16x16x32_bf16 a[204:207], v[120:123], v[68:71], a[204:207]
  v_mfma_f32_16x16x32_bf16 a[208:211], v[124:127], v[68:71], a[208:211]
  v_mfma_f32_16x16x32_bf16 a[212:215], v[128:131], v[68:71], a[212:215]
  v_mfma_f32_16x16x32_bf16 a[216:219], v[132:135], v[68:71], a[216:219]
  v_mfma_f32_16x16x32_bf16 a[220:223], v[136:139], v[68:71], a[220:223]
  v_mfma_f32_16x16x32_bf16 a[224:227], v[108:111], v[72:75], a[224:227]
  v_mfma_f32_16x16x32_bf16 a[228:231], v[112:115], v[72:75], a[228:231]
  v_mfma_f32_16x16x32_bf16 a[232:235], v[116:119], v[72:75], a[232:235]
  v_mfma_f32_16x16x32_bf16 a[236:239], v[120:123], v[72:75], a[236:239]
  v_mfma_f32_16x16x32_bf16 a[240:243], v[124:127], v[72:75], a[240:243]
  v_mfma_f32_16x16x32_bf16 a[244:247], v[128:131], v[72:75], a[244:247]
  v_mfma_f32_16x16x32_bf16 a[248:251], v[132:135], v[72:75], a[248:251]
  v_mfma_f32_16x16x32_bf16 a[252:255], v[136:139], v[72:75], a[252:255]
  s_waitcnt lgkmcnt(0)
  v_mfma_f32_16x16x32_bf16 a[0:3], v[140:143], v[76:79], a[0:3]
  s_waitcnt vmcnt(0)
  s_barrier
  s_cmp_eq_u32 s49, 0
  s_cbranch_scc1 L_hs_7
  s_cmp_lg_u32 s32, 0
  s_cbranch_scc1 L_sig_8
  v_mov_b32 v254, s63
  v_mov_b32 v255, 0
  v_and_b32 v254, 3, v254
  v_mbcnt_lo_u32_b32 v255, -1, 0
  v_lshlrev_b32 v255, 9, v255
  s_cmp_ge_u32 s63, 2
  s_cselect_b64 exec, 3, 1
  buffer_atomic_add v254, v255, s[4:7], s62 offen offset:0 sc1
  s_mov_b64 exec, -1
L_sig_8:
L_hs_7:
  s_add_u32 m0, s52, 65536
  v_mfma_f32_16x16x32_bf16 a[4:7], v[144:147], v[76:79], a[4:7]
  buffer_load_dwordx4 v2, s[8:11], s20 offen  lds
  ds_read_b128 v[44:47], v18 offset:0
  v_mfma_f32_16x16x32_bf16 a[8:11], v[148:151], v[76:79], a[8:11]
  v_mfma_f32_16x16x32_bf16 a[12:15], v[152:155], v[76:79], a[12:15]
  ds_read_b64_tr_b16 v[108:109], v22 offset:32768
  s_add_u32 m0, s53, 65536
  v_mfma_f32_16x16x32_bf16 a[16:19], v[156:159], v[76:79], a[16:19]
  buffer_load_dwordx4 v10, s[12:15], s21 offen  lds
  v_mfma_f32_16x16x32_bf16 a[20:23], v[160:163], v[76:79], a[20:23]
  ds_read_b64_tr_b16 v[110:111], v22 offset:34816
  v_mfma_f32_16x16x32_bf16 a[24:27], v[164:167], v[76:79], a[24:27]
  v_mfma_f32_16x16x32_bf16 a[28:31], v[168:171], v[76:79], a[28:31]
  ds_read_b128 v[48:51], v18 offset:2048
  s_add_u32 m0, s52, 66560
  v_mfma_f32_16x16x32_bf16 a[32:35], v[140:143], v[80:83], a[32:35]
  buffer_load_dwordx4 v3, s[8:11], s20 offen  lds
  v_mfma_f32_16x16x32_bf16 a[36:39], v[144:147], v[80:83], a[36:39]
  ds_read_b64_tr_b16 v[112:113], v23 offset:32768
  v_mfma_f32_16x16x32_bf16 a[40:43], v[148:151], v[80:83], a[40:43]
  v_mfma_f32_16x16x32_bf16 a[44:47], v[152:155], v[80:83], a[44:47]
  ds_read_b64_tr_b16 v[114:115], v23 offset:34816
  s_add_u32 m0, s53, 66560
  v_mfma_f32_16x16x32_bf16 a[48:51], v[156:159], v[80:83], a[48:51]
  buffer_load_dwordx4 v11, s[12:15], s21 offen  lds
  v_mfma_f32_16x16x32_bf16 a[52:55], v[160:163], v[80:83], a[52:55]
  ds_read_b128 v[52:55], v18 offset:4096
  v_mfma_f32_16x16x32_bf16 a[56:59], v[164:167], v[80:83], a[56:59]
  s_add_u32 m0, s52, 67584
  v_mfma_f32_16x16x32_bf16 a[60:63], v[168:171], v[80:83], a[60:63]
  buffer_load_dwordx4 v4, s[8:11], s20 offen  lds
  ds_read_b64_tr_b16 v[116:117], v24 offset:32768
  v_mfma_f32_16x16x32_bf16 a[64:67], v[140:143], v[84:87], a[64:67]
  v_mfma_f32_16x16x32_bf16 a[68:71], v[144:147], v[84:87], a[68:71]
  ds_read_b64_tr_b16 v[118:119], v24 offset:34816
  v_mfma_f32_16x16x32_bf16 a[72:75], v[148:151], v[84:87], a[72:75]
  s_add_u32 m0, s53, 67584
  v_mfma_f32_16x16x32_bf16 a[76:79], v[152:155], v[84:87], a[76:79]
  buffer_load_dwordx4 v12, s[12:15], s21 offen  lds
  ds_read_b128 v[56:59], v18 offset:6144
  v_mfma_f32_16x16x32_bf16 a[80:83], v[156:159], v[84:87], a[80:83]
  v_mfma_f32_16x16x32_bf16 a[84:87], v[160:163], v[84:87], a[84:87]
  ds_read_b64_tr_b16 v[120:121], v25 offset:32768
  v_mfma_f32_16x16x32_bf16 a[88:91], v[164:167], v[84:87], a[88:91]
  s_add_u32 m0, s52, 68608
  v_mfma_f32_16x16x32_bf16 a[92:95], v[168:171], v[84:87], a[92:95]
  buffer_load_dwordx4 v5, s[8:11], s20 offen  lds
  ds_read_b64_tr_b16 v[122:123], v25 offset:34816
  v_mfma_f32_16x16x32_bf16 a[96:99], v[140:143], v[88:91], a[96:99]
  v_mfma_f32_16x16x32_bf16 a[100:103], v[144:147], v[88:91], a[100:103]
  ds_read_b128 v[60:63], v18 offset:8192
  s_add_u32 m0, s53, 68608
  v_mfma_f32_16x16x32_bf16 a[104:107], v[148:151], v[88:91], a[104:107]
  buffer_load_dwordx4 v13, s[12:15], s21 offen  lds
  v_mfma_f32_16x16x32_bf16 a[108:111], v[152:155], v[88:91], a[108:111]
  ds_read_b64_tr_b16 v[124:125], v26 offset:32768
  v_mfma_f32_16x16x32_bf16 a[112:115], v[156:159], v[88:91], a[112:115]
  v_mfma_f32_16x16x32_bf16 a[116:119], v[160:163], v[88:91], a[116:119]
  ds_read_b64_tr_b16 v[126:127], v26 offset:34816
  s_add_u32 m0, s52, 69632
  v_mfma_f32_16x16x32_bf16 a[120:123], v[164:167], v[88:91], a[120:123]
  buffer_load_dwordx4 v6, s[8:11], s20 offen  lds
  v_mfma_f32_16x16x32_bf16 a[124:127], v[168:171], v[88:91], a[124:127]
  ds_read_b128 v[64:67], v18 offset:10240
  v_mfma_f32_16x16x32_bf16 a[128:131], v[140:143], v[92:95], a[128:131]
  v_mfma_f32_16x16x32_bf16 a[132:135], v[144:147], v[92:95], a[132:135]
  ds_read_b64_tr_b16 v[128:129], v27 offset:32768
  s_add_u32 m0, s53, 69632
  v_mfma_f32_16x16x32_bf16 a[136:139], v[148:151], v[92:95], a[136:139]
  buffer_load_dwordx4 v14, s[12:15], s21 offen  lds
  v_mfma_f32_16x16x32_bf16 a[140:143], v[152:155], v[92:95], a[140:143]
  ds_read_b64_tr_b16 v[130:131], v27 offset:34816
  v_mfma_f32_16x16x32_bf16 a[144:147], v[156:159], v[92:95], a[144:147]
  v_mfma_f32_16x16x32_bf16 a[148:151], v[160:163], v[92:95], a[148:151]
  ds_read_b128 v[68:71], v18 offset:12288
  s_add_u32 m0, s52, 70656
  v_mfma_f32_16x16x32_bf16 a[152:155], v[164:167], v[92:95], a[152:155]
  buffer_load_dwordx4 v7, s[8:11], s20 offen  lds
  v_mfma_f32_16x16x32_bf16 a[156:159], v[168:171], v[92:95], a[156:159]
  ds_read_b64_tr_b16 v[132:133], v28 offset:32768
  v_mfma_f32_16x16x32_bf16 a[160:163], v[140:143], v[96:99], a[160:163]
  s_add_u32 m0, s53, 70656
  v_mfma_f32_16x16x32_bf16 a[164:167], v[144:147], v[96:99], a[164:167]
  buffer_load_dwordx4 v15, s[12:15], s21 offen  lds
  ds_read_b64_tr_b16 v[134:135], v28 offset:34816
  v_mfma_f32_16x16x32_bf16 a[168:171], v[148:151], v[96:99], a[168:171]
  v_mfma_f32_16x16x32_bf16 a[172:175], v[152:155], v[96:99], a[172:175]
  ds_read_b128 v[72:75], v18 offset:14336
  v_mfma_f32_16x16x32_bf16 a[176:179], v[156:159], v[96:99], a[176:179]
  s_add_u32 m0, s52, 71680
  v_mfma_f32_16x16x32_bf16 a[180:183], v[160:163], v[96:99], a[180:183]
  buffer_load_dwordx4 v8, s[8:11], s20 offen  lds
  ds_read_b64_tr_b16 v[136:137], v29 offset:32768
  v_mfma_f32_16x16x32_bf16 a[184:187], v[164:167], v[96:99], a[184:187]
  v_mfma_f32_16x16x32_bf16 a[188:191], v[168:171], v[96:99], a[188:191]
  ds_read_b64_tr_b16 v[138:139], v29 offset:34816
  v_mfma_f32_16x16x32_bf16 a[192:195], v[140:143], v[100:103], a[192:195]
  s_add_u32 m0, s53, 71680
  v_mfma_f32_16x16x32_bf16 a[196:199], v[144:147], v[100:103], a[196:199]
  buffer_load_dwordx4 v16, s[12:15], s21 offen  lds
  v_mfma_f32_16x16x32_bf16 a[200:203], v[148:151], v[100:103], a[200:203]
  v_mfma_f32_16x16x32_bf16 a[204:207], v[152:155], v[100:103], a[204:207]
  s_add_u32 m0, s52, 72704
  v_mfma_f32_16x16x32_bf16 a[208:211], v[156:159], v[100:103], a[208:211]
  buffer_load_dwordx4 v9, s[8:11], s20 offen  lds
  v_mfma_f32_16x16x32_bf16 a[212:215], v[160:163], v[100:103], a[212:215]
  v_mfma_f32_16x16x32_bf16 a[216:219], v[164:167], v[100:103], a[216:219]
  v_mfma_f32_16x16x32_bf16 a[220:223], v[168:171], v[100:103], a[220:223]
  s_add_u32 m0, s53, 72704
  v_mfma_f32_16x16x32_bf16 a[224:227], v[140:143], v[104:107], a[224:227]
  buffer_load_dwordx4 v17, s[12:15], s21 offen  lds
  v_mfma_f32_16x16x32_bf16 a[228:231], v[144:147], v[104:107], a[228:231]
  v_mfma_f32_16x16x32_bf16 a[232:235], v[148:151], v[104:107], a[232:235]
  v_mfma_f32_16x16x32_bf16 a[236:239], v[152:155], v[104:107], a[236:239]
  s_add_u32 s20, s20, 128
  v_mfma_f32_16x16x32_bf16 a[240:243], v[156:159], v[104:107], a[240:243]
  s_add_u32 s21, s21, s51
  v_mfma_f32_16x16x32_bf16 a[244:247], v[160:163], v[104:107], a[244:247]
  v_mfma_f32_16x16x32_bf16 a[248:251], v[164:167], v[104:107], a[248:251]
  v_mfma_f32_16x16x32_bf16 a[252:255], v[168:171], v[104:107], a[252:255]
L_g1_loop:
  s_sub_u32 s25, s25, 1
  s_cmp_eq_u32 s25, 0
  s_cbranch_scc1 L_g1_fin
  s_waitcnt lgkmcnt(0)
  v_mfma_f32_16x16x32_bf16 a[0:3], v[108:111], v[44:47], a[0:3]
  ds_read_b128 v[76:79], v19 offset:0
  v_mfma_f32_16x16x32_bf16 a[4:7], v[112:115], v[44:47], a[4:7]
  v_mfma_f32_16x16x32_bf16 a[8:11], v[116:119], v[44:47], a[8:11]
  ds_read_b64_tr_b16 v[140:141], v22 offset:49152
  v_mfma_f32_16x16x32_bf16 a[12:15], v[120:123], v[44:47], a[12:15]
  v_mfma_f32_16x16x32_bf16 a[16:19], v[124:127], v[44:47], a[16:19]
  ds_read_b64_tr_b16 v[142:143], v22 offset:51200
  v_mfma_f32_16x16x32_bf16 a[20:23], v[128:131], v[44:47], a[20:23]
  v_mfma_f32_16x16x32_bf16 a[24:27], v[132:135], v[44:47], a[24:27]
  ds_read_b128 v[80:83], v19 offset:2048
  v_mfma_f32_16x16x32_bf16 a[28:31], v[136:139], v[44:47], a[28:31]
  v_mfma_f32_16x16x32_bf16 a[32:35], v[108:111], v[48:51], a[32:35]
  ds_read_b64_tr_b16 v[144:145], v23 offset:49152
  v_mfma_f32_16x16x32_bf16 a[36:39], v[112:115], v[48:51], a[36:39]
  v_mfma_f32_16x16x32_bf16 a[40:43], v[116:119], v[48:51], a[40:43]
  ds_read_b64_tr_b16 v[146:147], v23 offset:51200
  v_mfma_f32_16x16x32_bf16 a[44:47], v[120:123], v[48:51], a[44:47]
  v_mfma_f32_16x16x32_bf16 a[48:51], v[124:127], v[48:51], a[48:51]
  ds_read_b128 v[84:87], v19 offset:4096
  v_mfma_f32_16x16x32_bf16 a[52:55], v[128:131], v[48:51], a[52:55]
  v_mfma_f32_16x16x32_bf16 a[56:59], v[132:135], v[48:51], a[56:59]
  ds_read_b64_tr_b16 v[148:149], v24 offset:49152
  v_mfma_f32_16x16x32_bf16 a[60:63], v[136:139], v[48:51], a[60:63]
  v_mfma_f32_16x16x32_bf16 a[64:67], v[108:111], v[52:55], a[64:67]
  ds_read_b64_tr_b16 v[150:151], v24 offset:51200
  v_mfma_f32_16x16x32_bf16 a[68:71], v[112:115], v[52:55], a[68:71]
  v_mfma_f32_16x16x32_bf16 a[72:75], v[116:119], v[52:55], a[72:75]
  ds_read_b128 v[88:91], v19 offset:6144
  v_mfma_f32_16x16x32_bf16 a[76:79], v[120:123], v[52:55], a[76:79]
  v_mfma_f32_16x16x32_bf16 a[80:83], v[124:127], v[52:55], a[80:83]
  ds_read_b64_tr_b16 v[152:153], v25 offset:49152
  v_mfma_f32_16x16x32_bf16 a[84:87], v[128:131], v[52:55], a[84:87]
  v_mfma_f32_16x16x32_bf16 a[88:91], v[132:135], v[52:55], a[88:91]
  ds_read_b64_tr_b16 v[154:155], v25 offset:51200
  v_mfma_f32_16x16x32_bf16 a[92:95], v[136:139], v[52:55], a[92:95]
  v_mfma_f32_16x16x32_bf16 a[96:99], v[108:111], v[56:59], a[96:99]
  ds_read_b128 v[92:95], v19 offset:8192
  v_mfma_f32_16x16x32_bf16 a[100:103], v[112:115], v[56:59], a[100:103]
  v_mfma_f32_16x16x32_bf16 a[104:107], v[116:119], v[56:59], a[104:107]
  ds_read_b64_tr_b16 v[156:157], v26 offset:49152
  v_mfma_f32_16x16x32_bf16 a[108:111], v[120:123], v[56:59], a[108:111]
  v_mfma_f32_16x16x32_bf16 a[112:115], v[124:127], v[56:59], a[112:115]
  ds_read_b64_tr_b16 v[158:159], v26 offset:51200
  v_mfma_f32_16x16x32_bf16 a[116:119], v[128:131], v[56:59], a[116:119]
  v_mfma_f32_16x16x32_bf16 a[120:123], v[132:135], v[56:59], a[120:123]
  ds_read_b128 v[96:99], v19 offset:10240
  v_mfma_f32_16x16x32_bf16 a[124:127], v[136:139], v[56:59], a[124:127]
  v_mfma_f32_16x16x32_bf16 a[128:131], v[108:111], v[60:63], a[128:131]
  ds_read_b64_tr_b16 v[160:161], v27 offset:49152
  v_mfma_f32_16x16x32_bf16 a[132:135], v[112:115], v[60:63], a[132:135]
  v_mfma_f32_16x16x32_bf16 a[136:139], v[116:119], v[60:63], a[136:139]
  ds_read_b64_tr_b16 v[162:163], v27 offset:51200
  v_mfma_f32_16x16x32_bf16 a[140:143], v[120:123], v[60:63], a[140:143]
  v_mfma_f32_16x16x32_bf16 a[144:147], v[124:127], v[60:63], a[144:147]
  ds_read_b128 v[100:103], v19 offset:12288
  v_mfma_f32_16x16x32_bf16 a[148:151], v[128:131], v[60:63], a[148:151]
  v_mfma_f32_16x16x32_bf16 a[152:155], v[132:135], v[60:63], a[152:155]
  ds_read_b64_tr_b16 v[164:165], v28 offset:49152
  v_mfma_f32_16x16x32_bf16 a[156:159], v[136:139], v[60:63], a[156:159]
  v_mfma_f32_16x16x32_bf16 a[160:163], v[108:111], v[64:67], a[160:163]
  ds_read_b64_tr_b16 v[166:167], v28 offset:51200
  v_mfma_f32_16x16x32_bf16 a[164:167], v[112:115], v[64:67], a[164:167]
  v_mfma_f32_16x16x32_bf16 a[168:171], v[116:119], v[64:67], a[168:171]
  ds_read_b128 v[104:107], v19 offset:14336
  v_mfma_f32_16x16x32_bf16 a[172:175], v[120:123], v[64:67], a[172:175]
  v_mfma_f32_16x16x32_bf16 a[176:179], v[124:127], v[64:67], a[176:179]
  ds_read_b64_tr_b16 v[168:169], v29 offset:49152
  v_mfma_f32_16x16x32_bf16 a[180:183], v[128:131], v[64:67], a[180:183]
  v_mfma_f32_16x16x32_bf16 a[184:187], v[132:135], v[64:67], a[184:187]
  ds_read_b64_tr_b16 v[170:171], v29 offset:51200
  v_mfma_f32_16x16x32_bf16 a[188:191], v[136:139], v[64:67], a[188:191]
  v_mfma_f32_16x16x32_bf16 a[192:195], v[108:111], v[68:71], a[192:195]
  v_mfma_f32_16x16x32_bf16 a[196:199], v[112:115], v[68:71], a[196:199]
  v_mfma_f32_16x16x32_bf16 a[200:203], v[116:119], v[68:71], a[200:203]
  v_mfma_f32_16x16x32_bf16 a[204:207], v[120:123], v[68:71], a[204:207]
  v_mfma_f32_16x16x32_bf16 a[208:211], v[124:127], v[68:71], a[208:211]
  v_mfma_f32_16x16x32_bf16 a[212:215], v[128:131], v[68:71], a[212:215]
  v_mfma_f32_16x16x32_bf16 a[216:219], v[132:135], v[68:71], a[216:219]
  v_mfma_f32_16x16x32_bf16 a[220:223], v[136:139], v[68:71], a[220:223]
  v_mfma_f32_16x16x32_bf16 a[224:227], v[108:111], v[72:75], a[224:227]
  v_mfma_f32_16x16x32_bf16 a[228:231], v[112:115], v[72:75], a[228:231]
  v_mfma_f32_16x16x32_bf16 a[232:235], v[116:119], v[72:75], a[232:235]
  v_mfma_f32_16x16x32_bf16 a[236:239], v[120:123], v[72:75], a[236:239]
  v_mfma_f32_16x16x32_bf16 a[240:243], v[124:127], v[72:75], a[240:243]
  v_mfma_f32_16x16x32_bf16 a[244:247], v[128:131], v[72:75], a[244:247]
  v_mfma_f32_16x16x32_bf16 a[248:251], v[132:135], v[72:75], a[248:251]
  v_mfma_f32_16x16x32_bf16 a[252:255], v[136:139], v[72:75], a[252:255]
  s_waitcnt lgkmcnt(0)
  v_mfma_f32_16x16x32_bf16 a[0:3], v[140:143], v[76:79], a[0:3]
  s_waitcnt vmcnt(0)
  s_barrier
  s_add_u32 m0, s52, 0
  v_mfma_f32_16x16x32_bf16 a[4:7], v[144:147], v[76:79], a[4:7]
  buffer_load_dwordx4 v2, s[8:11], s20 offen  lds
  ds_read_b128 v[44:47], v20 offset:0
  v_mfma_f32_16x16x32_bf16 a[8:11], v[148:151], v[76:79], a[8:11]
  v_mfma_f32_16x16x32_bf16 a[12:15], v[152:155], v[76:79], a[12:15]
  ds_read_b64_tr_b16 v[108:109], v30 offset:32768
  s_add_u32 m0, s53, 0
  v_mfma_f32_16x16x32_bf16 a[16:19], v[156:159], v[76:79], a[16:19]
  buffer_load_dwordx4 v10, s[12:15], s21 offen  lds
  v_mfma_f32_16x16x32_bf16 a[20:23], v[160:163], v[76:79], a[20:23]
  ds_read_b64_tr_b16 v[110:111], v30 offset:34816
  v_mfma_f32_16x16x32_bf16 a[24:27], v[164:167], v[76:79], a[24:27]
  v_mfma_f32_16x16x32_bf16 a[28:31], v[168:171], v[76:79], a[28:31]
  ds_read_b128 v[48:51], v20 offset:2048
  s_add_u32 m0, s52, 1024
  v_mfma_f32_16x16x32_bf16 a[32:35], v[140:143], v[80:83], a[32:35]
  buffer_load_dwordx4 v3, s[8:11], s20 offen  lds
  v_mfma_f32_16x16x32_bf16 a[36:39], v[144:147], v[80:83], a[36:39]
  ds_read_b64_tr_b16 v[112:113], v31 offset:32768
  v_mfma_f32_16x16x32_bf16 a[40:43], v[148:151], v[80:83], a[40:43]
  v_mfma_f32_16x16x32_bf16 a[44:47], v[152:155], v[80:83], a[44:47]
  ds_read_b64_tr_b16 v[114:115], v31 offset:34816
  s_add_u32 m0, s53, 1024
  v_mfma_f32_16x16x32_bf16 a[48:51], v[156:159], v[80:83], a[48:51]
  buffer_load_dwordx4 v11, s[12:15], s21 offen  lds
  v_mfma_f32_16x16x32_bf16 a[52:55], v[160:163], v[80:83], a[52:55]
  ds_read_b128 v[52:55], v20 offset:4096
  v_mfma_f32_16x16x32_bf16 a[56:59], v[164:167], v[80:83], a[56:59]
  s_add_u32 m0, s52, 2048
  v_mfma_f32_16x16x32_bf16 a[60:63], v[168:171], v[80:83], a[60:63]
  buffer_load_dwordx4 v4, s[8:11], s20 offen  lds
  ds_read_b64_tr_b16 v[116:117], v32 offset:32768
  v_mfma_f32_16x16x32_bf16 a[64:67], v[140:143], v[84:87], a[64:67]
  v_mfma_f32_16x16x32_bf16 a[68:71], v[144:147], v[84:87], a[68:71]
  ds_read_b64_tr_b16 v[118:119], v32 offset:34816
  v_mfma_f32_16x16x32_bf16 a[72:75], v[148:151], v[84:87], a[72:75]
  s_add_u32 m0, s53, 2048
  v_mfma_f32_16x16x32_bf16 a[76:79], v[152:155], v[84:87], a[76:79]
  buffer_load_dwordx4 v12, s[12:15], s21 offen  lds
  ds_read_b128 v[56:59], v20 offset:6144
  v_mfma_f32_16x16x32_bf16 a[80:83], v[156:159], v[84:87], a[80:83]
  v_mfma_f32_16x16x32_bf16 a[84:87], v[160:163], v[84:87], a[84:87]
  ds_read_b64_tr_b16 v[120:121], v33 offset:32768
  v_mfma_f32_16x16x32_bf16 a[88:91], v[164:167], v[84:87], a[88:91]
  s_add_u32 m0, s52, 3072
  v_mfma_f32_16x16x32_bf16 a[92:95], v[168:171], v[84:87], a[92:95]
  buffer_load_dwordx4 v5, s[8:11], s20 offen  lds
  ds_read_b64_tr_b16 v[122:123], v33 offset:34816
  v_mfma_f32_16x16x32_bf16 a[96:99], v[140:143], v[88:91], a[96:99]
  v_mfma_f32_16x16x32_bf16 a[100:103], v[144:147], v[88:91], a[100:103]
  ds_read_b128 v[60:63], v20 offset:8192
  s_add_u32 m0, s53, 3072
  v_mfma_f32_16x16x32_bf16 a[104:107], v[148:151], v[88:91], a[104:107]
  buffer_load_dwordx4 v13, s[12:15], s21 offen  lds
  v_mfma_f32_16x16x32_bf16 a[108:111], v[152:155], v[88:91], a[108:111]
  ds_read_b64_tr_b16 v[124:125], v34 offset:32768
  v_mfma_f32_16x16x32_bf16 a[112:115], v[156:159], v[88:91], a[112:115]
  v_mfma_f32_16x16x32_bf16 a[116:119], v[160:163], v[88:91], a[116:119]
  ds_read_b64_tr_b16 v[126:127], v34 offset:34816
  s_add_u32 m0, s52, 4096
  v_mfma_f32_16x16x32_bf16 a[120:123], v[164:167], v[88:91], a[120:123]
  buffer_load_dwordx4 v6, s[8:11], s20 offen  lds
  v_mfma_f32_16x16x32_bf16 a[124:127], v[168:171], v[88:91], a[124:127]
  ds_read_b128 v[64:67], v20 offset:10240
  v_mfma_f32_16x16x32_bf16 a[128:131], v[140:143], v[92:95], a[128:131]
  v_mfma_f32_16x16x32_bf16 a[132:135], v[144:147], v[92:95], a[132:135]
  ds_read_b64_tr_b16 v[128:129], v35 offset:32768
  s_add_u32 m0, s53, 4096
  v_mfma_f32_16x16x32_bf16 a[136:139], v[148:151], v[92:95], a[136:139]
  buffer_load_dwordx4 v14, s[12:15], s21 offen  lds
  v_mfma_f32_16x16x32_bf16 a[140:143], v[152:155], v[92:95], a[140:143]
  ds_read_b64_tr_b16 v[130:131], v35 offset:34816
  v_mfma_f32_16x16x32_bf16 a[144:147], v[156:159], v[92:95], a[144:147]
  v_mfma_f32_16x16x32_bf16 a[148:151], v[160:163], v[92:95], a[148:151]
  ds_read_b128 v[68:71], v20 offset:12288
  s_add_u32 m0, s52, 5120
  v_mfma_f32_16x16x32_bf16 a[152:155], v[164:167], v[92:95], a[152:155]
  buffer_load_dwordx4 v7, s[8:11], s20 offen  lds
  v_mfma_f32_16x16x32_bf16 a[156:159], v[168:171], v[92:95], a[156:159]
  ds_read_b64_tr_b16 v[132:133], v36 offset:32768
  v_mfma_f32_16x16x32_bf16 a[160:163], v[140:143], v[96:99], a[160:163]
  s_add_u32 m0, s53, 5120
  v_mfma_f32_16x16x32_bf16 a[164:167], v[144:147], v[96:99], a[164:167]
  buffer_load_dwordx4 v15, s[12:15], s21 offen  lds
  ds_read_b64_tr_b16 v[134:135], v36 offset:34816
  v_mfma_f32_16x16x32_bf16 a[168:171], v[148:151], v[96:99], a[168:171]
  v_mfma_f32_16x16x32_bf16 a[172:175], v[152:155], v[96:99], a[172:175]
  ds_read_b128 v[72:75], v20 offset:14336
  v_mfma_f32_16x16x32_bf16 a[176:179], v[156:159], v[96:99], a[176:179]
  s_add_u32 m0, s52, 6144
  v_mfma_f32_16x16x32_bf16 a[180:183], v[160:163], v[96:99], a[180:183]
  buffer_load_dwordx4 v8, s[8:11], s20 offen  lds
  ds_read_b64_tr_b16 v[136:137], v37 offset:32768
  v_mfma_f32_16x16x32_bf16 a[184:187], v[164:167], v[96:99], a[184:187]
  v_mfma_f32_16x16x32_bf16 a[188:191], v[168:171], v[96:99], a[188:191]
  ds_read_b64_tr_b16 v[138:139], v37 offset:34816
  v_mfma_f32_16x16x32_bf16 a[192:195], v[140:143], v[100:103], a[192:195]
  s_add_u32 m0, s53, 6144
  v_mfma_f32_16x16x32_bf16 a[196:199], v[144:147], v[100:103], a[196:199]
  buffer_load_dwordx4 v16, s[12:15], s21 offen  lds
  v_mfma_f32_16x16x32_bf16 a[200:203], v[148:151], v[100:103], a[200:203]
  v_mfma_f32_16x16x32_bf16 a[204:207], v[152:155], v[100:103], a[204:207]
  s_add_u32 m0, s52, 7168
  v_mfma_f32_16x16x32_bf16 a[208:211], v[156:159], v[100:103], a[208:211]
  buffer_load_dwordx4 v9, s[8:11], s20 offen  lds
  v_mfma_f32_16x16x32_bf16 a[212:215], v[160:163], v[100:103], a[212:215]
  v_mfma_f32_16x16x32_bf16 a[216:219], v[164:167], v[100:103], a[216:219]
  v_mfma_f32_16x16x32_bf16 a[220:223], v[168:171], v[100:103], a[220:223]
  s_add_u32 m0, s53, 7168
  v_mfma_f32_16x16x32_bf16 a[224:227], v[140:143], v[104:107], a[224:227]
  buffer_load_dwordx4 v17, s[12:15], s21 offen  lds
  v_mfma_f32_16x16x32_bf16 a[228:231], v[144:147], v[104:107], a[228:231]
  v_mfma_f32_16x16x32_bf16 a[232:235], v[148:151], v[104:107], a[232:235]
  v_mfma_f32_16x16x32_bf16 a[236:239], v[152:155], v[104:107], a[236:239]
  s_add_u32 s20, s20, 128
  v_mfma_f32_16x16x32_bf16 a[240:243], v[156:159], v[104:107], a[240:243]
  s_add_u32 s21, s21, s51
  v_mfma_f32_16x16x32_bf16 a[244:247], v[160:163], v[104:107], a[244:247]
  v_mfma_f32_16x16x32_bf16 a[248:251], v[164:167], v[104:107], a[248:251]
  v_mfma_f32_16x16x32_bf16 a[252:255], v[168:171], v[104:107], a[252:255]
  s_waitcnt lgkmcnt(0)
  s_cmp_eq_u32 s25, 1
  s_cbranch_scc1 L_g1_cw
L_g1_cwb:
  v_mfma_f32_16x16x32_bf16 a[0:3], v[108:111], v[44:47], a[0:3]
  ds_read_b128 v[76:79], v21 offset:0
  v_mfma_f32_16x16x32_bf16 a[4:7], v[112:115], v[44:47], a[4:7]
  v_mfma_f32_16x16x32_bf16 a[8:11], v[116:119], v[44:47], a[8:11]
  ds_read_b64_tr_b16 v[140:141], v30 offset:49152
  v_mfma_f32_16x16x32_bf16 a[12:15], v[120:123], v[44:47], a[12:15]
  v_mfma_f32_16x16x32_bf16 a[16:19], v[124:127], v[44:47], a[16:19]
  ds_read_b64_tr_b16 v[142:143], v30 offset:51200
  v_mfma_f32_16x16x32_bf16 a[20:23], v[128:131], v[44:47], a[20:23]
  v_mfma_f32_16x16x32_bf16 a[24:27], v[132:135], v[44:47], a[24:27]
  ds_read_b128 v[80:83], v21 offset:2048
  v_mfma_f32_16x16x32_bf16 a[28:31], v[136:139], v[44:47], a[28:31]
  v_mfma_f32_16x16x32_bf16 a[32:35], v[108:111], v[48:51], a[32:35]
  ds_read_b64_tr_b16 v[144:145], v31 offset:49152
  v_mfma_f32_16x16x32_bf16 a[36:39], v[112:115], v[48:51], a[36:39]
  v_mfma_f32_16x16x32_bf16 a[40:43], v[116:119], v[48:51], a[40:43]
  ds_read_b64_tr_b16 v[146:147], v31 offset:51200
  v_mfma_f32_16x16x32_bf16 a[44:47], v[120:123], v[48:51], a[44:47]
  v_mfma_f32_16x16x32_bf16 a[48:51], v[124:127], v[48:51], a[48:51]
  ds_read_b128 v[84:87], v21 offset:4096
  v_mfma_f32_16x16x32_bf16 a[52:55], v[128:131], v[48:51], a[52:55]
  v_mfma_f32_16x16x32_bf16 a[56:59], v[132:135], v[48:51], a[56:59]
  ds_read_b64_tr_b16 v[148:149], v32 offset:49152
  v_mfma_f32_16x16x32_bf16 a[60:63], v[136:139], v[48:51], a[60:63]
  v_mfma_f32_16x16x32_bf16 a[64:67], v[108:111], v[52:55], a[64:67]
  ds_read_b64_tr_b16 v[150:151], v32 offset:51200
  v_mfma_f32_16x16x32_bf16 a[68:71], v[112:115], v[52:55], a[68:71]
  v_mfma_f32_16x16x32_bf16 a[72:75], v[116:119], v[52:55], a[72:75]
  ds_read_b128 v[88:91], v21 offset:6144
  v_mfma_f32_16x16x32_bf16 a[76:79], v[120:123], v[52:55], a[76:79]
  v_mfma_f32_16x16x32_bf16 a[80:83], v[124:127], v[52:55], a[80:83]
  ds_read_b64_tr_b16 v[152:153], v33 offset:49152
  v_mfma_f32_16x16x32_bf16 a[84:87], v[128:131], v[52:55], a[84:87]
  v_mfma_f32_16x16x32_bf16 a[88:91], v[132:135], v[52:55], a[88:91]
  ds_read_b64_tr_b16 v[154:155], v33 offset:51200
  v_mfma_f32_16x16x32_bf16 a[92:95], v[136:139], v[52:55], a[92:95]
  v_mfma_f32_16x16x32_bf16 a[96:99], v[108:111], v[56:59], a[96:99]
  ds_read_b128 v[92:95], v21 offset:8192
  v_mfma_f32_16x16x32_bf16 a[100:103], v[112:115], v[56:59], a[100:103]
  v_mfma_f32_16x16x32_bf16 a[104:107], v[116:119], v[56:59], a[104:107]
  ds_read_b64_tr_b16 v[156:157], v34 offset:49152
  v_mfma_f32_16x16x32_bf16 a[108:111], v[120:123], v[56:59], a[108:111]
  v_mfma_f32_16x16x32_bf16 a[112:115], v[124:127], v[56:59], a[112:115]
  ds_read_b64_tr_b16 v[158:159], v34 offset:51200
  v_mfma_f32_16x16x32_bf16 a[116:119], v[128:131], v[56:59], a[116:119]
  v_mfma_f32_16x16x32_bf16 a[120:123], v[132:135], v[56:59], a[120:123]
  ds_read_b128 v[96:99], v21 offset:10240
  v_mfma_f32_16x16x32_bf16 a[124:127], v[136:139], v[56:59], a[124:127]
  v_mfma_f32_16x16x32_bf16 a[128:131], v[108:111], v[60:63], a[128:131]
  ds_read_b64_tr_b16 v[160:161], v35 offset:49152
  v_mfma_f32_16x16x32_bf16 a[132:135], v[112:115], v[60:63], a[132:135]
  v_mfma_f32_16x16x32_bf16 a[136:139], v[116:119], v[60:63], a[136:139]
  ds_read_b64_tr_b16 v[162:163], v35 offset:51200
  v_mfma_f32_16x16x32_bf16 a[140:143], v[120:123], v[60:63], a[140:143]
  v_mfma_f32_16x16x32_bf16 a[144:147], v[124:127], v[60:63], a[144:147]
  ds_read_b128 v[100:103], v21 offset:12288
  v_mfma_f32_16x16x32_bf16 a[148:151], v[128:131], v[60:63], a[148:151]
  v_mfma_f32_16x16x32_bf16 a[152:155], v[132:135], v[60:63], a[152:155]
  ds_read_b64_tr_b16 v[164:165], v36 offset:49152
  v_mfma_f32_16x16x32_bf16 a[156:159], v[136:139], v[60:63], a[156:159]
  v_mfma_f32_16x16x32_bf16 a[160:163], v[108:111], v[64:67], a[160:163]
  ds_read_b64_tr_b16 v[166:167], v36 offset:51200
  v_mfma_f32_16x16x32_bf16 a[164:167], v[112:115], v[64:67], a[164:167]
  v_mfma_f32_16x16x32_bf16 a[168:171], v[116:119], v[64:67], a[168:171]
  ds_read_b128 v[104:107], v21 offset:14336
  v_mfma_f32_16x16x32_bf16 a[172:175], v[120:123], v[64:67], a[172:175]
  v_mfma_f32_16x16x32_bf16 a[176:179], v[124:127], v[64:67], a[176:179]
  ds_read_b64_tr_b16 v[168:169], v37 offset:49152
  v_mfma_f32_16x16x32_bf16 a[180:183], v[128:131], v[64:67], a[180:183]
  v_mfma_f32_16x16x32_bf16 a[184:187], v[132:135], v[64:67], a[184:187]
  ds_read_b64_tr_b16 v[170:171], v37 offset:51200
  v_mfma_f32_16x16x32_bf16 a[188:191], v[136:139], v[64:67], a[188:191]
  v_mfma_f32_16x16x32_bf16 a[192:195], v[108:111], v[68:71], a[192:195]
  v_mfma_f32_16x16x32_bf16 a[196:199], v[112:115], v[68:71], a[196:199]
  v_mfma_f32_16x16x32_bf16 a[200:203], v[116:119], v[68:71], a[200:203]
  v_mfma_f32_16x16x32_bf16 a[204:207], v[120:123], v[68:71], a[204:207]
  v_mfma_f32_16x16x32_bf16 a[208:211], v[124:127], v[68:71], a[208:211]
  v_mfma_f32_16x16x32_bf16 a[212:215], v[128:131], v[68:71], a[212:215]
  v_mfma_f32_16x16x32_bf16 a[216:219], v[132:135], v[68:71], a[216:219]
  v_mfma_f32_16x16x32_bf16 a[220:223], v[136:139], v[68:71], a[220:223]
  v_mfma_f32_16x16x32_bf16 a[224:227], v[108:111], v[72:75], a[224:227]
  v_mfma_f32_16x16x32_bf16 a[228:231], v[112:115], v[72:75], a[228:231]
  v_mfma_f32_16x16x32_bf16 a[232:235], v[116:119], v[72:75], a[232:235]
  v_mfma_f32_16x16x32_bf16 a[236:239], v[120:123], v[72:75], a[236:239]
  v_mfma_f32_16x16x32_bf16 a[240:243], v[124:127], v[72:75], a[240:243]
  v_mfma_f32_16x16x32_bf16 a[244:247], v[128:131], v[72:75], a[244:247]
  v_mfma_f32_16x16x32_bf16 a[248:251], v[132:135], v[72:75], a[248:251]
  v_mfma_f32_16x16x32_bf16 a[252:255], v[136:139], v[72:75], a[252:255]
  s_waitcnt lgkmcnt(0)
  v_mfma_f32_16x16x32_bf16 a[0:3], v[140:143], v[76:79], a[0:3]
  s_waitcnt vmcnt(0)
  s_barrier
  s_cmp_le_u32 s25, 2
  s_cbranch_scc1 L_g1_cr
L_g1_crb:
  s_add_u32 m0, s52, 65536
  v_mfma_f32_16x16x32_bf16 a[4:7], v[144:147], v[76:79], a[4:7]
  buffer_load_dwordx4 v2, s[8:11], s20 offen  lds
  ds_read_b128 v[44:47], v18 offset:0
  v_mfma_f32_16x16x32_bf16 a[8:11], v[148:151], v[76:79], a[8:11]
  v_mfma_f32_16x16x32_bf16 a[12:15], v[152:155], v[76:79], a[12:15]
  ds_read_b64_tr_b16 v[108:109], v22 offset:32768
  s_add_u32 m0, s53, 65536
  v_mfma_f32_16x16x32_bf16 a[16:19], v[156:159], v[76:79], a[16:19]
  buffer_load_dwordx4 v10, s[12:15], s21 offen  lds
  v_mfma_f32_16x16x32_bf16 a[20:23], v[160:163], v[76:79], a[20:23]
  ds_read_b64_tr_b16 v[110:111], v22 offset:34816
  v_mfma_f32_16x16x32_bf16 a[24:27], v[164:167], v[76:79], a[24:27]
  v_mfma_f32_16x16x32_bf16 a[28:31], v[168:171], v[76:79], a[28:31]
  ds_read_b128 v[48:51], v18 offset:2048
  s_add_u32 m0, s52, 66560
  v_mfma_f32_16x16x32_bf16 a[32:35], v[140:143], v[80:83], a[32:35]
  buffer_load_dwordx4 v3, s[8:11], s20 offen  lds
  v_mfma_f32_16x16x32_bf16 a[36:39], v[144:147], v[80:83], a[36:39]
  ds_read_b64_tr_b16 v[112:113], v23 offset:32768
  v_mfma_f32_16x16x32_bf16 a[40:43], v[148:151], v[80:83], a[40:43]
  v_mfma_f32_16x16x32_bf16 a[44:47], v[152:155], v[80:83], a[44:47]
  ds_read_b64_tr_b16 v[114:115], v23 offset:34816
  s_add_u32 m0, s53, 66560
  v_mfma_f32_16x16x32_bf16 a[48:51], v[156:159], v[80:83], a[48:51]
  buffer_load_dwordx4 v11, s[12:15], s21 offen  lds
  v_mfma_f32_16x16x32_bf16 a[52:55], v[160:163], v[80:83], a[52:55]
  ds_read_b128 v[52:55], v18 offset:4096
  v_mfma_f32_16x16x32_bf16 a[56:59], v[164:167], v[80:83], a[56:59]
  s_add_u32 m0, s52, 67584
  v_mfma_f32_16x16x32_bf16 a[60:63], v[168:171], v[80:83], a[60:63]
  buffer_load_dwordx4 v4, s[8:11], s20 offen  lds
  ds_read_b64_tr_b16 v[116:117], v24 offset:32768
  v_mfma_f32_16x16x32_bf16 a[64:67], v[140:143], v[84:87], a[64:67]
  v_mfma_f32_16x16x32_bf16 a[68:71], v[144:147], v[84:87], a[68:71]
  ds_read_b64_tr_b16 v[118:119], v24 offset:34816
  v_mfma_f32_16x16x32_bf16 a[72:75], v[148:151], v[84:87], a[72:75]
  s_add_u32 m0, s53, 67584
  v_mfma_f32_16x16x32_bf16 a[76:79], v[152:155], v[84:87], a[76:79]
  buffer_load_dwordx4 v12, s[12:15], s21 offen  lds
  ds_read_b128 v[56:59], v18 offset:6144
  v_mfma_f32_16x16x32_bf16 a[80:83], v[156:159], v[84:87], a[80:83]
  v_mfma_f32_16x16x32_bf16 a[84:87], v[160:163], v[84:87], a[84:87]
  ds_read_b64_tr_b16 v[120:121], v25 offset:32768
  v_mfma_f32_16x16x32_bf16 a[88:91], v[164:167], v[84:87], a[88:91]
  s_add_u32 m0, s52, 68608
  v_mfma_f32_16x16x32_bf16 a[92:95], v[168:171], v[84:87], a[92:95]
  buffer_load_dwordx4 v5, s[8:11], s20 offen  lds
  ds_read_b64_tr_b16 v[122:123], v25 offset:34816
  v_mfma_f32_16x16x32_bf16 a[96:99], v[140:143], v[88:91], a[96:99]
  v_mfma_f32_16x16x32_bf16 a[100:103], v[144:147], v[88:91], a[100:103]
  ds_read_b128 v[60:63], v18 offset:8192
  s_add_u32 m0, s53, 68608
  v_mfma_f32_16x16x32_bf16 a[104:107], v[148:151], v[88:91], a[104:107]
  buffer_load_dwordx4 v13, s[12:15], s21 offen  lds
  v_mfma_f32_16x16x32_bf16 a[108:111], v[152:155], v[88:91], a[108:111]
  ds_read_b64_tr_b16 v[124:125], v26 offset:32768
  v_mfma_f32_16x16x32_bf16 a[112:115], v[156:159], v[88:91], a[112:115]
  v_mfma_f32_16x16x32_bf16 a[116:119], v[160:163], v[88:91], a[116:119]
  ds_read_b64_tr_b16 v[126:127], v26 offset:34816
  s_add_u32 m0, s52, 69632
  v_mfma_f32_16x16x32_bf16 a[120:123], v[164:167], v[88:91], a[120:123]
  buffer_load_dwordx4 v6, s[8:11], s20 offen  lds
  v_mfma_f32_16x16x32_bf16 a[124:127], v[168:171], v[88:91], a[124:127]
  ds_read_b128 v[64:67], v18 offset:10240
  v_mfma_f32_16x16x32_bf16 a[128:131], v[140:143], v[92:95], a[128:131]
  v_mfma_f32_16x16x32_bf16 a[132:135], v[144:147], v[92:95], a[132:135]
  ds_read_b64_tr_b16 v[128:129], v27 offset:32768
  s_add_u32 m0, s53, 69632
  v_mfma_f32_16x16x32_bf16 a[136:139], v[148:151], v[92:95], a[136:139]
  buffer_load_dwordx4 v14, s[12:15], s21 offen  lds
  v_mfma_f32_16x16x32_bf16 a[140:143], v[152:155], v[92:95], a[140:143]
  ds_read_b64_tr_b16 v[130:131], v27 offset:34816
  v_mfma_f32_16x16x32_bf16 a[144:147], v[156:159], v[92:95], a[144:147]
  v_mfma_f32_16x16x32_bf16 a[148:151], v[160:163], v[92:95], a[148:151]
  ds_read_b128 v[68:71], v18 offset:12288
  s_add_u32 m0, s52, 70656
  v_mfma_f32_16x16x32_bf16 a[152:155], v[164:167], v[92:95], a[152:155]
  buffer_load_dwordx4 v7, s[8:11], s20 offen  lds
  v_mfma_f32_16x16x32_bf16 a[156:159], v[168:171], v[92:95], a[156:159]
  ds_read_b64_tr_b16 v[132:133], v28 offset:32768
  v_mfma_f32_16x16x32_bf16 a[160:163], v[140:143], v[96:99], a[160:163]
  s_add_u32 m0, s53, 70656
  v_mfma_f32_16x16x32_bf16 a[164:167], v[144:147], v[96:99], a[164:167]
  buffer_load_dwordx4 v15, s[12:15], s21 offen  lds
  ds_read_b64_tr_b16 v[134:135], v28 offset:34816
  v_mfma_f32_16x16x32_bf16 a[168:171], v[148:151], v[96:99], a[168:171]
  v_mfma_f32_16x16x32_bf16 a[172:175], v[152:155], v[96:99], a[172:175]
  ds_read_b128 v[72:75], v18 offset:14336
  v_mfma_f32_16x16x32_bf16 a[176:179], v[156:159], v[96:99], a[176:179]
  s_add_u32 m0, s52, 71680
  v_mfma_f32_16x16x32_bf16 a[180:183], v[160:163], v[96:99], a[180:183]
  buffer_load_dwordx4 v8, s[8:11], s20 offen  lds
  ds_read_b64_tr_b16 v[136:137], v29 offset:32768
  v_mfma_f32_16x16x32_bf16 a[184:187], v[164:167], v[96:99], a[184:187]
  v_mfma_f32_16x16x32_bf16 a[188:191], v[168:171], v[96:99], a[188:191]
  ds_read_b64_tr_b16 v[138:139], v29 offset:34816
  v_mfma_f32_16x16x32_bf16 a[192:195], v[140:143], v[100:103], a[192:195]
  s_add_u32 m0, s53, 71680
  v_mfma_f32_16x16x32_bf16 a[196:199], v[144:147], v[100:103], a[196:199]
  buffer_load_dwordx4 v16, s[12:15], s21 offen  lds
  v_mfma_f32_16x16x32_bf16 a[200:203], v[148:151], v[100:103], a[200:203]
  v_mfma_f32_16x16x32_bf16 a[204:207], v[152:155], v[100:103], a[204:207]
  s_add_u32 m0, s52, 72704
  v_mfma_f32_16x16x32_bf16 a[208:211], v[156:159], v[100:103], a[208:211]
  buffer_load_dwordx4 v9, s[8:11], s20 offen  lds
  v_mfma_f32_16x16x32_bf16 a[212:215], v[160:163], v[100:103], a[212:215]
  v_mfma_f32_16x16x32_bf16 a[216:219], v[164:167], v[100:103], a[216:219]
  v_mfma_f32_16x16x32_bf16 a[220:223], v[168:171], v[100:103], a[220:223]
  s_add_u32 m0, s53, 72704
  v_mfma_f32_16x16x32_bf16 a[224:227], v[140:143], v[104:107], a[224:227]
  buffer_load_dwordx4 v17, s[12:15], s21 offen  lds
  v_mfma_f32_16x16x32_bf16 a[228:231], v[144:147], v[104:107], a[228:231]
  v_mfma_f32_16x16x32_bf16 a[232:235], v[148:151], v[104:107], a[232:235]
  v_mfma_f32_16x16x32_bf16 a[236:239], v[152:155], v[104:107], a[236:239]
  s_add_u32 s20, s20, 128
  v_mfma_f32_16x16x32_bf16 a[240:243], v[156:159], v[104:107], a[240:243]
  s_add_u32 s21, s21, s51
  v_mfma_f32_16x16x32_bf16 a[244:247], v[160:163], v[104:107], a[244:247]
  v_mfma_f32_16x16x32_bf16 a[248:251], v[164:167], v[104:107], a[248:251]
  v_mfma_f32_16x16x32_bf16 a[252:255], v[168:171], v[104:107], a[252:255]
  s_branch L_g1_loop
L_g1_fin:
  s_mov_b32 s59, 1
  s_mov_b32 s60, s22
  s_mov_b32 s61, s26
  s_add_u32 s62, s38, 0x3d00000
  s_mov_b32 s63, s98
  s_waitcnt lgkmcnt(0)
  v_min_u32 v245, 270, v246
  v_lshlrev_b32 v245, 2, v245
  v_add_u32 v245, 147648, v245
  ds_read_b32 v245, v245
  v_readfirstlane_b32 s34, v246
  s_add_u32 s34, s34, 32
  v_mfma_f32_16x16x32_bf16 a[0:3], v[108:111], v[44:47], a[0:3]
  ds_read_b128 v[76:79], v19 offset:0
  v_mfma_f32_16x16x32_bf16 a[4:7], v[112:115], v[44:47], a[4:7]
  v_mfma_f32_16x16x32_bf16 a[8:11], v[116:119], v[44:47], a[8:11]
  ds_read_b64_tr_b16 v[140:141], v22 offset:49152
  v_mfma_f32_16x16x32_bf16 a[12:15], v[120:123], v[44:47], a[12:15]
  v_mfma_f32_16x16x32_bf16 a[16:19], v[124:127], v[44:47], a[16:19]
  ds_read_b64_tr_b16 v[142:143], v22 offset:51200
  v_mfma_f32_16x16x32_bf16 a[20:23], v[128:131], v[44:47], a[20:23]
  v_mfma_f32_16x16x32_bf16 a[24:27], v[132:135], v[44:47], a[24:27]
  ds_read_b128 v[80:83], v19 offset:2048
  v_mfma_f32_16x16x32_bf16 a[28:31], v[136:139], v[44:47], a[28:31]
  v_mfma_f32_16x16x32_bf16 a[32:35], v[108:111], v[48:51], a[32:35]
  ds_read_b64_tr_b16 v[144:145], v23 offset:49152
  v_mfma_f32_16x16x32_bf16 a[36:39], v[112:115], v[48:51], a[36:39]
  v_mfma_f32_16x16x32_bf16 a[40:43], v[116:119], v[48:51], a[40:43]
  ds_read_b64_tr_b16 v[146:147], v23 offset:51200
  v_mfma_f32_16x16x32_bf16 a[44:47], v[120:123], v[48:51], a[44:47]
  v_mfma_f32_16x16x32_bf16 a[48:51], v[124:127], v[48:51], a[48:51]
  ds_read_b128 v[84:87], v19 offset:4096
  v_mfma_f32_16x16x32_bf16 a[52:55], v[128:131], v[48:51], a[52:55]
  v_mfma_f32_16x16x32_bf16 a[56:59], v[132:135], v[48:51], a[56:59]
  ds_read_b64_tr_b16 v[148:149], v24 offset:49152
  v_mfma_f32_16x16x32_bf16 a[60:63], v[136:139], v[48:51], a[60:63]
  v_mfma_f32_16x16x32_bf16 a[64:67], v[108:111], v[52:55], a[64:67]
  ds_read_b64_tr_b16 v[150:151], v24 offset:51200
  v_mfma_f32_16x16x32_bf16 a[68:71], v[112:115], v[52:55], a[68:71]
  v_mfma_f32_16x16x32_bf16 a[72:75], v[116:119], v[52:55], a[72:75]
  ds_read_b128 v[88:91], v19 offset:6144
  v_mfma_f32_16x16x32_bf16 a[76:79], v[120:123], v[52:55], a[76:79]
  v_mfma_f32_16x16x32_bf16 a[80:83], v[124:127], v[52:55], a[80:83]
  ds_read_b64_tr_b16 v[152:153], v25 offset:49152
  v_mfma_f32_16x16x32_bf16 a[84:87], v[128:131], v[52:55], a[84:87]
  v_mfma_f32_16x16x32_bf16 a[88:91], v[132:135], v[52:55], a[88:91]
  ds_read_b64_tr_b16 v[154:155], v25 offset:51200
  v_mfma_f32_16x16x32_bf16 a[92:95], v[136:139], v[52:55], a[92:95]
  v_mfma_f32_16x16x32_bf16 a[96:99], v[108:111], v[56:59], a[96:99]
  ds_read_b128 v[92:95], v19 offset:8192
  v_mfma_f32_16x16x32_bf16 a[100:103], v[112:115], v[56:59], a[100:103]
  v_mfma_f32_16x16x32_bf16 a[104:107], v[116:119], v[56:59], a[104:107]
  ds_read_b64_tr_b16 v[156:157], v26 offset:49152
  v_mfma_f32_16x16x32_bf16 a[108:111], v[120:123], v[56:59], a[108:111]
  v_mfma_f32_16x16x32_bf16 a[112:115], v[124:127], v[56:59], a[112:115]
  ds_read_b64_tr_b16 v[158:159], v26 offset:51200
  v_mfma_f32_16x16x32_bf16 a[116:119], v[128:131], v[56:59], a[116:119]
  v_mfma_f32_16x16x32_bf16 a[120:123], v[132:135], v[56:59], a[120:123]
  ds_read_b128 v[96:99], v19 offset:10240
  v_mfma_f32_16x16x32_bf16 a[124:127], v[136:139], v[56:59], a[124:127]
  v_mfma_f32_16x16x32_bf16 a[128:131], v[108:111], v[60:63], a[128:131]
  ds_read_b64_tr_b16 v[160:161], v27 offset:49152
  v_mfma_f32_16x16x32_bf16 a[132:135], v[112:115], v[60:63], a[132:135]
  v_mfma_f32_16x16x32_bf16 a[136:139], v[116:119], v[60:63], a[136:139]
  ds_read_b64_tr_b16 v[162:163], v27 offset:51200
  v_mfma_f32_16x16x32_bf16 a[140:143], v[120:123], v[60:63], a[140:143]
  v_mfma_f32_16x16x32_bf16 a[144:147], v[124:127], v[60:63], a[144:147]
  ds_read_b128 v[100:103], v19 offset:12288
  v_mfma_f32_16x16x32_bf16 a[148:151], v[128:131], v[60:63], a[148:151]
  v_mfma_f32_16x16x32_bf16 a[152:155], v[132:135], v[60:63], a[152:155]
  ds_read_b64_tr_b16 v[164:165], v28 offset:49152
  v_mfma_f32_16x16x32_bf16 a[156:159], v[136:139], v[60:63], a[156:159]
  v_mfma_f32_16x16x32_bf16 a[160:163], v[108:111], v[64:67], a[160:163]
  ds_read_b64_tr_b16 v[166:167], v28 offset:51200
  v_mfma_f32_16x16x32_bf16 a[164:167], v[112:115], v[64:67], a[164:167]
  v_mfma_f32_16x16x32_bf16 a[168:171], v[116:119], v[64:67], a[168:171]
  ds_read_b128 v[104:107], v19 offset:14336
  v_mfma_f32_16x16x32_bf16 a[172:175], v[120:123], v[64:67], a[172:175]
  v_mfma_f32_16x16x32_bf16 a[176:179], v[124:127], v[64:67], a[176:179]
  ds_read_b64_tr_b16 v[168:169], v29 offset:49152
  v_mfma_f32_16x16x32_bf16 a[180:183], v[128:131], v[64:67], a[180:183]
  v_mfma_f32_16x16x32_bf16 a[184:187], v[132:135], v[64:67], a[184:187]
  ds_read_b64_tr_b16 v[170:171], v29 offset:51200
  v_mfma_f32_16x16x32_bf16 a[188:191], v[136:139], v[64:67], a[188:191]
  v_mfma_f32_16x16x32_bf16 a[192:195], v[108:111], v[68:71], a[192:195]
  v_mfma_f32_16x16x32_bf16 a[196:199], v[112:115], v[68:71], a[196:199]
  v_mfma_f32_16x16x32_bf16 a[200:203], v[116:119], v[68:71], a[200:203]
  v_mfma_f32_16x16x32_bf16 a[204:207], v[120:123], v[68:71], a[204:207]
  v_mfma_f32_16x16x32_bf16 a[208:211], v[124:127], v[68:71], a[208:211]
  v_mfma_f32_16x16x32_bf16 a[212:215], v[128:131], v[68:71], a[212:215]
  v_mfma_f32_16x16x32_bf16 a[216:219], v[132:135], v[68:71], a[216:219]
  v_mfma_f32_16x16x32_bf16 a[220:223], v[136:139], v[68:71], a[220:223]
  v_mfma_f32_16x16x32_bf16 a[224:227], v[108:111], v[72:75], a[224:227]
  v_mfma_f32_16x16x32_bf16 a[228:231], v[112:115], v[72:75], a[228:231]
  v_mfma_f32_16x16x32_bf16 a[232:235], v[116:119], v[72:75], a[232:235]
  v_mfma_f32_16x16x32_bf16 a[236:239], v[120:123], v[72:75], a[236:239]
  v_mfma_f32_16x16x32_bf16 a[240:243], v[124:127], v[72:75], a[240:243]
  v_mfma_f32_16x16x32_bf16 a[244:247], v[128:131], v[72:75], a[244:247]
  v_mfma_f32_16x16x32_bf16 a[248:251], v[132:135], v[72:75], a[248:251]
  v_mfma_f32_16x16x32_bf16 a[252:255], v[136:139], v[72:75], a[252:255]
  s_waitcnt lgkmcnt(0)
  v_mfma_f32_16x16x32_bf16 a[0:3], v[140:143], v[76:79], a[0:3]
  s_waitcnt vmcnt(0)
  s_barrier
  v_readfirstlane_b32 s91, v245
  s_and_b32 s35, s91, 255
  s_lshr_b32 s36, s91, 8
  s_and_b32 s36, s36, 255
  s_lshr_b32 s37, s91, 16
  s_mov_b32 s92, s24
  s_cmp_gt_u32 s35, 3
  s_cbranch_scc1 L_cd_11
  s_cmp_eq_u32 s35, 3
  s_cbranch_scc1 L_cd_9
  s_mov_b32 s8, s64
  s_and_b32 s9, s65, 0xffff
  s_mov_b32 s10, 0x400000
  s_mov_b32 s11, 0x20000
  s_cmp_eq_u32 s35, 0
  s_cselect_b64 s[88:89], s[68:69], s[70:71]
  s_cmp_eq_u32 s35, 2
  s_cselect_b64 s[88:89], s[72:73], s[88:89]
  s_mov_b32 s12, s88
  s_and_b32 s13, s89, 0xffff
  s_mov_b32 s14, 0x800000
  s_mov_b32 s15, 0x20000
  s_lshl_b32 s91, s33, 2
  s_add_u32 s91, s91, s37
  s_mov_b32 s24, 8192
  s_mov_b32 s26, 262144
  s_lshl_b32 s20, s36, 19
  s_lshl_b32 s21, s91, 9
  s_lshl_b32 s22, s35, 24
  s_lshl_b32 s90, s36, 21
  s_add_u32 s22, s22, s90
  s_lshl_b32 s90, s91, 14
  s_add_u32 s22, s22, s90
  s_lshl_b32 s38, s36, 9
  s_add_u32 s38, s38, 28672
  s_cmp_eq_u32 s35, 0
  s_cselect_b32 s38, 8192, s38
  s_cselect_b32 s98, 1, 2
  s_mov_b32 s48, s35
  s_branch L_cd_10
L_cd_11:
  s_mov_b64 vcc, 0
  s_mov_b32 s58, 0
  s_branch L_cd_12
L_cd_9:
  s_mov_b32 s8, s78
  s_and_b32 s9, s79, 0xffff
  s_mov_b32 s10, 0x400000
  s_mov_b32 s11, 0x20000
  s_mov_b32 s12, s80
  s_and_b32 s13, s81, 0xffff
  s_mov_b32 s14, 0x600000
  s_mov_b32 s15, 0x20000
  s_lshl_b32 s91, s37, 2
  s_add_u32 s91, s91, s33
  s_mov_b32 s24, 6144
  s_mov_b32 s26, 65536
  s_lshl_b32 s20, s36, 19
  s_lshl_b32 s21, s91, 9
  s_lshl_b32 s22, s37, 22
  s_lshl_b32 s90, s36, 19
  s_add_u32 s22, s22, s90
  s_lshl_b32 s90, s33, 14
  s_add_u32 s22, s22, s90
  s_add_u32 s22, s22, 0x4000000
  s_mov_b32 s38, 12288
  s_mov_b32 s48, s37
  s_mov_b32 s98, 1
L_cd_10:
  s_lshl_b32 s90, s36, 9
  s_add_u32 s38, s38, s90
  s_lshl_b32 s90, s33, 7
  s_add_u32 s38, s38, s90
  s_mov_b32 s23, 2048
  s_mov_b32 s25, 8
  s_mov_b64 vcc, -1
  s_sub_i32 s92, s24, s92
  s_lshl_b32 s51, s24, 6
  v_mul_i32_i24 v38, s92, v174
  s_mul_i32 s92, s92, 2
  s_mov_b32 s93, 0
  v_add3_u32 v10, v10, v38, s93
  s_add_u32 s93, s93, s92
  v_add3_u32 v11, v11, v38, s93
  s_add_u32 s93, s93, s92
  v_add3_u32 v12, v12, v38, s93
  s_add_u32 s93, s93, s92
  v_add3_u32 v13, v13, v38, s93
  s_add_u32 s93, s93, s92
  v_add3_u32 v14, v14, v38, s93
  s_add_u32 s93, s93, s92
  v_add3_u32 v15, v15, v38, s93
  s_add_u32 s93, s93, s92
  v_add3_u32 v16, v16, v38, s93
  s_add_u32 s93, s93, s92
  v_add3_u32 v17, v17, v38, s93
  s_add_u32 s93, s93, s92
L_cd_12:
  s_add_u32 m0, s52, 0
  v_mfma_f32_16x16x32_bf16 a[4:7], v[144:147], v[76:79], a[4:7]
  s_cbranch_vccz L_gd_13
  buffer_load_dwordx4 v2, s[8:11], s20 offen  lds
L_gd_13:
  ds_read_b128 v[44:47], v20 offset:0
  v_mfma_f32_16x16x32_bf16 a[8:11], v[148:151], v[76:79], a[8:11]
  v_mfma_f32_16x16x32_bf16 a[12:15], v[152:155], v[76:79], a[12:15]
  ds_read_b64_tr_b16 v[108:109], v30 offset:32768
  s_add_u32 m0, s53, 0
  v_mfma_f32_16x16x32_bf16 a[16:19], v[156:159], v[76:79], a[16:19]
  s_cbranch_vccz L_gd_14
  buffer_load_dwordx4 v10, s[12:15], s21 offen  lds
L_gd_14:
  v_mfma_f32_16x16x32_bf16 a[20:23], v[160:163], v[76:79], a[20:23]
  ds_read_b64_tr_b16 v[110:111], v30 offset:34816
  v_mfma_f32_16x16x32_bf16 a[24:27], v[164:167], v[76:79], a[24:27]
  v_mfma_f32_16x16x32_bf16 a[28:31], v[168:171], v[76:79], a[28:31]
  ds_read_b128 v[48:51], v20 offset:2048
  s_add_u32 m0, s52, 1024
  v_mfma_f32_16x16x32_bf16 a[32:35], v[140:143], v[80:83], a[32:35]
  s_cbranch_vccz L_gd_15
  buffer_load_dwordx4 v3, s[8:11], s20 offen  lds
L_gd_15:
  v_mfma_f32_16x16x32_bf16 a[36:39], v[144:147], v[80:83], a[36:39]
  ds_read_b64_tr_b16 v[112:113], v31 offset:32768
  v_mfma_f32_16x16x32_bf16 a[40:43], v[148:151], v[80:83], a[40:43]
  v_mfma_f32_16x16x32_bf16 a[44:47], v[152:155], v[80:83], a[44:47]
  ds_read_b64_tr_b16 v[114:115], v31 offset:34816
  s_add_u32 m0, s53, 1024
  v_mfma_f32_16x16x32_bf16 a[48:51], v[156:159], v[80:83], a[48:51]
  s_cbranch_vccz L_gd_16
  buffer_load_dwordx4 v11, s[12:15], s21 offen  lds
L_gd_16:
  v_mfma_f32_16x16x32_bf16 a[52:55], v[160:163], v[80:83], a[52:55]
  ds_read_b128 v[52:55], v20 offset:4096
  v_mfma_f32_16x16x32_bf16 a[56:59], v[164:167], v[80:83], a[56:59]
  v_mfma_f32_16x16x32_bf16 a[60:63], v[168:171], v[80:83], a[60:63]
  ds_read_b64_tr_b16 v[116:117], v32 offset:32768
  s_add_u32 m0, s52, 2048
  v_mfma_f32_16x16x32_bf16 a[64:67], v[140:143], v[84:87], a[64:67]
  s_cbranch_vccz L_gd_17
  buffer_load_dwordx4 v4, s[8:11], s20 offen  lds
L_gd_17:
  v_mfma_f32_16x16x32_bf16 a[68:71], v[144:147], v[84:87], a[68:71]
  ds_read_b64_tr_b16 v[118:119], v32 offset:34816
  v_mfma_f32_16x16x32_bf16 a[72:75], v[148:151], v[84:87], a[72:75]
  v_mfma_f32_16x16x32_bf16 a[76:79], v[152:155], v[84:87], a[76:79]
  ds_read_b128 v[56:59], v20 offset:6144
  s_add_u32 m0, s53, 2048
  v_mfma_f32_16x16x32_bf16 a[80:83], v[156:159], v[84:87], a[80:83]
  s_cbranch_vccz L_gd_18
  buffer_load_dwordx4 v12, s[12:15], s21 offen  lds
L_gd_18:
  v_mfma_f32_16x16x32_bf16 a[84:87], v[160:163], v[84:87], a[84:87]
  ds_read_b64_tr_b16 v[120:121], v33 offset:32768
  v_mfma_f32_16x16x32_bf16 a[88:91], v[164:167], v[84:87], a[88:91]
  v_mfma_f32_16x16x32_bf16 a[92:95], v[168:171], v[84:87], a[92:95]
  ds_read_b64_tr_b16 v[122:123], v33 offset:34816
  s_add_u32 m0, s52, 3072
  v_mfma_f32_16x16x32_bf16 a[96:99], v[140:143], v[88:91], a[96:99]
  s_cbranch_vccz L_gd_19
  buffer_load_dwordx4 v5, s[8:11], s20 offen  lds
L_gd_19:
  v_mfma_f32_16x16x32_bf16 a[100:103], v[144:147], v[88:91], a[100:103]
  ds_read_b128 v[60:63], v20 offset:8192
  v_mfma_f32_16x16x32_bf16 a[104:107], v[148:151], v[88:91], a[104:107]
  v_mfma_f32_16x16x32_bf16 a[108:111], v[152:155], v[88:91], a[108:111]
  ds_read_b64_tr_b16 v[124:125], v34 offset:32768
  s_add_u32 m0, s53, 3072
  v_mfma_f32_16x16x32_bf16 a[112:115], v[156:159], v[88:91], a[112:115]
  s_cbranch_vccz L_gd_20
  buffer_load_dwordx4 v13, s[12:15], s21 offen  lds
L_gd_20:
  v_mfma_f32_16x16x32_bf16 a[116:119], v[160:163], v[88:91], a[116:119]
  ds_read_b64_tr_b16 v[126:127], v34 offset:34816
  v_mfma_f32_16x16x32_bf16 a[120:123], v[164:167], v[88:91], a[120:123]
  v_mfma_f32_16x16x32_bf16 a[124:127], v[168:171], v[88:91], a[124:127]
  ds_read_b128 v[64:67], v20 offset:10240
  s_add_u32 m0, s52, 4096
  v_mfma_f32_16x16x32_bf16 a[128:131], v[140:143], v[92:95], a[128:131]
  s_cbranch_vccz L_gd_21
  buffer_load_dwordx4 v6, s[8:11], s20 offen  lds
L_gd_21:
  v_mfma_f32_16x16x32_bf16 a[132:135], v[144:147], v[92:95], a[132:135]
  ds_read_b64_tr_b16 v[128:129], v35 offset:32768
  v_mfma_f32_16x16x32_bf16 a[136:139], v[148:151], v[92:95], a[136:139]
  v_mfma_f32_16x16x32_bf16 a[140:143], v[152:155], v[92:95], a[140:143]
  ds_read_b64_tr_b16 v[130:131], v35 offset:34816
  s_add_u32 m0, s53, 4096
  v_mfma_f32_16x16x32_bf16 a[144:147], v[156:159], v[92:95], a[144:147]
  s_cbranch_vccz L_gd_22
  buffer_load_dwordx4 v14, s[12:15], s21 offen  lds
L_gd_22:
  v_mfma_f32_16x16x32_bf16 a[148:151], v[160:163], v[92:95], a[148:151]
  ds_read_b128 v[68:71], v20 offset:12288
  v_mfma_f32_16x16x32_bf16 a[152:155], v[164:167], v[92:95], a[152:155]
  v_mfma_f32_16x16x32_bf16 a[156:159], v[168:171], v[92:95], a[156:159]
  ds_read_b64_tr_b16 v[132:133], v36 offset:32768
  s_add_u32 m0, s52, 5120
  v_mfma_f32_16x16x32_bf16 a[160:163], v[140:143], v[96:99], a[160:163]
  s_cbranch_vccz L_gd_23
  buffer_load_dwordx4 v7, s[8:11], s20 offen  lds
L_gd_23:
  v_mfma_f32_16x16x32_bf16 a[164:167], v[144:147], v[96:99], a[164:167]
  ds_read_b64_tr_b16 v[134:135], v36 offset:34816
  v_mfma_f32_16x16x32_bf16 a[168:171], v[148:151], v[96:99], a[168:171]
  v_mfma_f32_16x16x32_bf16 a[172:175], v[152:155], v[96:99], a[172:175]
  ds_read_b128 v[72:75], v20 offset:14336
  s_add_u32 m0, s53, 5120
  v_mfma_f32_16x16x32_bf16 a[176:179], v[156:159], v[96:99], a[176:179]
  s_cbranch_vccz L_gd_24
  buffer_load_dwordx4 v15, s[12:15], s21 offen  lds
L_gd_24:
  v_mfma_f32_16x16x32_bf16 a[180:183], v[160:163], v[96:99], a[180:183]
  ds_read_b64_tr_b16 v[136:137], v37 offset:32768
  v_mfma_f32_16x16x32_bf16 a[184:187], v[164:167], v[96:99], a[184:187]
  v_mfma_f32_16x16x32_bf16 a[188:191], v[168:171], v[96:99], a[188:191]
  ds_read_b64_tr_b16 v[138:139], v37 offset:34816
  s_add_u32 m0, s52, 6144
  v_mfma_f32_16x16x32_bf16 a[192:195], v[140:143], v[100:103], a[192:195]
  s_cbranch_vccz L_gd_25
  buffer_load_dwordx4 v8, s[8:11], s20 offen  lds
L_gd_25:
  v_mfma_f32_16x16x32_bf16 a[196:199], v[144:147], v[100:103], a[196:199]
  v_mfma_f32_16x16x32_bf16 a[200:203], v[148:151], v[100:103], a[200:203]
  v_mfma_f32_16x16x32_bf16 a[204:207], v[152:155], v[100:103], a[204:207]
  s_add_u32 m0, s53, 6144
  v_mfma_f32_16x16x32_bf16 a[208:211], v[156:159], v[100:103], a[208:211]
  s_cbranch_vccz L_gd_26
  buffer_load_dwordx4 v16, s[12:15], s21 offen  lds
L_gd_26:
  v_mfma_f32_16x16x32_bf16 a[212:215], v[160:163], v[100:103], a[212:215]
  v_mfma_f32_16x16x32_bf16 a[216:219], v[164:167], v[100:103], a[216:219]
  v_mfma_f32_16x16x32_bf16 a[220:223], v[168:171], v[100:103], a[220:223]
  s_add_u32 m0, s52, 7168
  v_mfma_f32_16x16x32_bf16 a[224:227], v[140:143], v[104:107], a[224:227]
  s_cbranch_vccz L_gd_27
  buffer_load_dwordx4 v9, s[8:11], s20 offen  lds
L_gd_27:
  v_mfma_f32_16x16x32_bf16 a[228:231], v[144:147], v[104:107], a[228:231]
  v_mfma_f32_16x16x32_bf16 a[232:235], v[148:151], v[104:107], a[232:235]
  v_mfma_f32_16x16x32_bf16 a[236:239], v[152:155], v[104:107], a[236:239]
  s_add_u32 m0, s53, 7168
  v_mfma_f32_16x16x32_bf16 a[240:243], v[156:159], v[104:107], a[240:243]
  s_cbranch_vccz L_gd_28
  buffer_load_dwordx4 v17, s[12:15], s21 offen  lds
  s_add_u32 s20, s20, 128
  s_add_u32 s21, s21, s51
L_gd_28:
  v_mfma_f32_16x16x32_bf16 a[244:247], v[160:163], v[104:107], a[244:247]
  v_mfma_f32_16x16x32_bf16 a[248:251], v[164:167], v[104:107], a[248:251]
  v_mfma_f32_16x16x32_bf16 a[252:255], v[168:171], v[104:107], a[252:255]
  s_waitcnt lgkmcnt(0)
  v_mfma_f32_16x16x32_bf16 a[0:3], v[108:111], v[44:47], a[0:3]
  ds_read_b128 v[76:79], v21 offset:0
  v_mfma_f32_16x16x32_bf16 a[4:7], v[112:115], v[44:47], a[4:7]
  v_mfma_f32_16x16x32_bf16 a[8:11], v[116:119], v[44:47], a[8:11]
  ds_read_b64_tr_b16 v[140:141], v30 offset:49152
  v_mfma_f32_16x16x32_bf16 a[12:15], v[120:123], v[44:47], a[12:15]
  v_mfma_f32_16x16x32_bf16 a[16:19], v[124:127], v[44:47], a[16:19]
  ds_read_b64_tr_b16 v[142:143], v30 offset:51200
  v_mfma_f32_16x16x32_bf16 a[20:23], v[128:131], v[44:47], a[20:23]
  v_mfma_f32_16x16x32_bf16 a[24:27], v[132:135], v[44:47], a[24:27]
  ds_read_b128 v[80:83], v21 offset:2048
  v_mfma_f32_16x16x32_bf16 a[28:31], v[136:139], v[44:47], a[28:31]
  v_mfma_f32_16x16x32_bf16 a[32:35], v[108:111], v[48:51], a[32:35]
  ds_read_b64_tr_b16 v[144:145], v31 offset:49152
  v_mfma_f32_16x16x32_bf16 a[36:39], v[112:115], v[48:51], a[36:39]
  v_mfma_f32_16x16x32_bf16 a[40:43], v[116:119], v[48:51], a[40:43]
  ds_read_b64_tr_b16 v[146:147], v31 offset:51200
  v_mfma_f32_16x16x32_bf16 a[44:47], v[120:123], v[48:51], a[44:47]
  v_mfma_f32_16x16x32_bf16 a[48:51], v[124:127], v[48:51], a[48:51]
  ds_read_b128 v[84:87], v21 offset:4096
  v_mfma_f32_16x16x32_bf16 a[52:55], v[128:131], v[48:51], a[52:55]
  v_mfma_f32_16x16x32_bf16 a[56:59], v[132:135], v[48:51], a[56:59]
  ds_read_b64_tr_b16 v[148:149], v32 offset:49152
  v_mfma_f32_16x16x32_bf16 a[60:63], v[136:139], v[48:51], a[60:63]
  v_mfma_f32_16x16x32_bf16 a[64:67], v[108:111], v[52:55], a[64:67]
  ds_read_b64_tr_b16 v[150:151], v32 offset:51200
  v_mfma_f32_16x16x32_bf16 a[68:71], v[112:115], v[52:55], a[68:71]
  v_mfma_f32_16x16x32_bf16 a[72:75], v[116:119], v[52:55], a[72:75]
  ds_read_b128 v[88:91], v21 offset:6144
  v_mfma_f32_16x16x32_bf16 a[76:79], v[120:123], v[52:55], a[76:79]
  v_mfma_f32_16x16x32_bf16 a[80:83], v[124:127], v[52:55], a[80:83]
  ds_read_b64_tr_b16 v[152:153], v33 offset:49152
  v_mfma_f32_16x16x32_bf16 a[84:87], v[128:131], v[52:55], a[84:87]
  v_mfma_f32_16x16x32_bf16 a[88:91], v[132:135], v[52:55], a[88:91]
  ds_read_b64_tr_b16 v[154:155], v33 offset:51200
  v_mfma_f32_16x16x32_bf16 a[92:95], v[136:139], v[52:55], a[92:95]
  v_mfma_f32_16x16x32_bf16 a[96:99], v[108:111], v[56:59], a[96:99]
  ds_read_b128 v[92:95], v21 offset:8192
  v_mfma_f32_16x16x32_bf16 a[100:103], v[112:115], v[56:59], a[100:103]
  v_mfma_f32_16x16x32_bf16 a[104:107], v[116:119], v[56:59], a[104:107]
  ds_read_b64_tr_b16 v[156:157], v34 offset:49152
  v_mfma_f32_16x16x32_bf16 a[108:111], v[120:123], v[56:59], a[108:111]
  v_mfma_f32_16x16x32_bf16 a[112:115], v[124:127], v[56:59], a[112:115]
  ds_read_b64_tr_b16 v[158:159], v34 offset:51200
  v_mfma_f32_16x16x32_bf16 a[116:119], v[128:131], v[56:59], a[116:119]
  v_mfma_f32_16x16x32_bf16 a[120:123], v[132:135], v[56:59], a[120:123]
  ds_read_b128 v[96:99], v21 offset:10240
  v_mfma_f32_16x16x32_bf16 a[124:127], v[136:139], v[56:59], a[124:127]
  v_mfma_f32_16x16x32_bf16 a[128:131], v[108:111], v[60:63], a[128:131]
  ds_read_b64_tr_b16 v[160:161], v35 offset:49152
  v_mfma_f32_16x16x32_bf16 a[132:135], v[112:115], v[60:63], a[132:135]
  v_mfma_f32_16x16x32_bf16 a[136:139], v[116:119], v[60:63], a[136:139]
  ds_read_b64_tr_b16 v[162:163], v35 offset:51200
  v_mfma_f32_16x16x32_bf16 a[140:143], v[120:123], v[60:63], a[140:143]
  v_mfma_f32_16x16x32_bf16 a[144:147], v[124:127], v[60:63], a[144:147]
  ds_read_b128 v[100:103], v21 offset:12288
  v_mfma_f32_16x16x32_bf16 a[148:151], v[128:131], v[60:63], a[148:151]
  v_mfma_f32_16x16x32_bf16 a[152:155], v[132:135], v[60:63], a[152:155]
  ds_read_b64_tr_b16 v[164:165], v36 offset:49152
  v_mfma_f32_16x16x32_bf16 a[156:159], v[136:139], v[60:63], a[156:159]
  v_mfma_f32_16x16x32_bf16 a[160:163], v[108:111], v[64:67], a[160:163]
  ds_read_b64_tr_b16 v[166:167], v36 offset:51200
  v_mfma_f32_16x16x32_bf16 a[164:167], v[112:115], v[64:67], a[164:167]
  v_mfma_f32_16x16x32_bf16 a[168:171], v[116:119], v[64:67], a[168:171]
  ds_read_b128 v[104:107], v21 offset:14336
  v_mfma_f32_16x16x32_bf16 a[172:175], v[120:123], v[64:67], a[172:175]
  v_mfma_f32_16x16x32_bf16 a[176:179], v[124:127], v[64:67], a[176:179]
  ds_read_b64_tr_b16 v[168:169], v37 offset:49152
  v_mfma_f32_16x16x32_bf16 a[180:183], v[128:131], v[64:67], a[180:183]
  v_mfma_f32_16x16x32_bf16 a[184:187], v[132:135], v[64:67], a[184:187]
  ds_read_b64_tr_b16 v[170:171], v37 offset:51200
  v_mfma_f32_16x16x32_bf16 a[188:191], v[136:139], v[64:67], a[188:191]
  v_mfma_f32_16x16x32_bf16 a[192:195], v[108:111], v[68:71], a[192:195]
  v_mfma_f32_16x16x32_bf16 a[196:199], v[112:115], v[68:71], a[196:199]
  v_mfma_f32_16x16x32_bf16 a[200:203], v[116:119], v[68:71], a[200:203]
  v_mfma_f32_16x16x32_bf16 a[204:207], v[120:123], v[68:71], a[204:207]
  v_mfma_f32_16x16x32_bf16 a[208:211], v[124:127], v[68:71], a[208:211]
  v_mfma_f32_16x16x32_bf16 a[212:215], v[128:131], v[68:71], a[212:215]
  v_mfma_f32_16x16x32_bf16 a[216:219], v[132:135], v[68:71], a[216:219]
  v_mfma_f32_16x16x32_bf16 a[220:223], v[136:139], v[68:71], a[220:223]
  v_mfma_f32_16x16x32_bf16 a[224:227], v[108:111], v[72:75], a[224:227]
  v_mfma_f32_16x16x32_bf16 a[228:231], v[112:115], v[72:75], a[228:231]
  v_mfma_f32_16x16x32_bf16 a[232:235], v[116:119], v[72:75], a[232:235]
  v_mfma_f32_16x16x32_bf16 a[236:239], v[120:123], v[72:75], a[236:239]
  v_mfma_f32_16x16x32_bf16 a[240:243], v[124:127], v[72:75], a[240:243]
  v_mfma_f32_16x16x32_bf16 a[244:247], v[128:131], v[72:75], a[244:247]
  v_mfma_f32_16x16x32_bf16 a[248:251], v[132:135], v[72:75], a[248:251]
  v_mfma_f32_16x16x32_bf16 a[252:255], v[136:139], v[72:75], a[252:255]
  s_waitcnt lgkmcnt(0)
  v_mfma_f32_16x16x32_bf16 a[0:3], v[140:143], v[76:79], a[0:3]
  s_barrier
  s_add_u32 m0, s52, 65536
  v_mfma_f32_16x16x32_bf16 a[4:7], v[144:147], v[76:79], a[4:7]
  s_cbranch_vccz L_gd_29
  buffer_load_dwordx4 v2, s[8:11], s20 offen  lds
L_gd_29:
  v_mfma_f32_16x16x32_bf16 a[8:11], v[148:151], v[76:79], a[8:11]
  v_mfma_f32_16x16x32_bf16 a[12:15], v[152:155], v[76:79], a[12:15]
  s_add_u32 m0, s53, 65536
  v_mfma_f32_16x16x32_bf16 a[16:19], v[156:159], v[76:79], a[16:19]
  s_cbranch_vccz L_gd_30
  buffer_load_dwordx4 v10, s[12:15], s21 offen  lds
L_gd_30:
  v_mfma_f32_16x16x32_bf16 a[20:23], v[160:163], v[76:79], a[20:23]
  v_mfma_f32_16x16x32_bf16 a[24:27], v[164:167], v[76:79], a[24:27]
  v_mfma_f32_16x16x32_bf16 a[28:31], v[168:171], v[76:79], a[28:31]
  s_add_u32 m0, s52, 66560
  v_mfma_f32_16x16x32_bf16 a[32:35], v[140:143], v[80:83], a[32:35]
  s_cbranch_vccz L_gd_31
  buffer_load_dwordx4 v3, s[8:11], s20 offen  lds
L_gd_31:
  v_mfma_f32_16x16x32_bf16 a[36:39], v[144:147], v[80:83], a[36:39]
  v_mfma_f32_16x16x32_bf16 a[40:43], v[148:151], v[80:83], a[40:43]
  v_mfma_f32_16x16x32_bf16 a[44:47], v[152:155], v[80:83], a[44:47]
  s_add_u32 m0, s53, 66560
  v_mfma_f32_16x16x32_bf16 a[48:51], v[156:159], v[80:83], a[48:51]
  s_cbranch_vccz L_gd_32
  buffer_load_dwordx4 v11, s[12:15], s21 offen  lds
L_gd_32:
  v_mfma_f32_16x16x32_bf16 a[52:55], v[160:163], v[80:83], a[52:55]
  v_mfma_f32_16x16x32_bf16 a[56:59], v[164:167], v[80:83], a[56:59]
  v_mfma_f32_16x16x32_bf16 a[60:63], v[168:171], v[80:83], a[60:63]
  s_add_u32 m0, s52, 67584
  v_mfma_f32_16x16x32_bf16 a[64:67], v[140:143], v[84:87], a[64:67]
  s_cbranch_vccz L_gd_33
  buffer_load_dwordx4 v4, s[8:11], s20 offen  lds
L_gd_33:
  v_mfma_f32_16x16x32_bf16 a[68:71], v[144:147], v[84:87], a[68:71]
  v_mfma_f32_16x16x32_bf16 a[72:75], v[148:151], v[84:87], a[72:75]
  v_mfma_f32_16x16x32_bf16 a[76:79], v[152:155], v[84:87], a[76:79]
  s_add_u32 m0, s53, 67584
  v_mfma_f32_16x16x32_bf16 a[80:83], v[156:159], v[84:87], a[80:83]
  s_cbranch_vccz L_gd_34
  buffer_load_dwordx4 v12, s[12:15], s21 offen  lds
L_gd_34:
  v_mfma_f32_16x16x32_bf16 a[84:87], v[160:163], v[84:87], a[84:87]
  v_mfma_f32_16x16x32_bf16 a[88:91], v[164:167], v[84:87], a[88:91]
  v_mfma_f32_16x16x32_bf16 a[92:95], v[168:171], v[84:87], a[92:95]
  s_add_u32 m0, s52, 68608
  v_mfma_f32_16x16x32_bf16 a[96:99], v[140:143], v[88:91], a[96:99]
  s_cbranch_vccz L_gd_35
  buffer_load_dwordx4 v5, s[8:11], s20 offen  lds
L_gd_35:
  v_mfma_f32_16x16x32_bf16 a[100:103], v[144:147], v[88:91], a[100:103]
  v_mfma_f32_16x16x32_bf16 a[104:107], v[148:151], v[88:91], a[104:107]
  v_mfma_f32_16x16x32_bf16 a[108:111], v[152:155], v[88:91], a[108:111]
  s_add_u32 m0, s53, 68608
  v_mfma_f32_16x16x32_bf16 a[112:115], v[156:159], v[88:91], a[112:115]
  s_cbranch_vccz L_gd_36
  buffer_load_dwordx4 v13, s[12:15], s21 offen  lds
L_gd_36:
  v_mfma_f32_16x16x32_bf16 a[116:119], v[160:163], v[88:91], a[116:119]
  v_mfma_f32_16x16x32_bf16 a[120:123], v[164:167], v[88:91], a[120:123]
  v_mfma_f32_16x16x32_bf16 a[124:127], v[168:171], v[88:91], a[124:127]
  s_add_u32 m0, s52, 69632
  v_mfma_f32_16x16x32_bf16 a[128:131], v[140:143], v[92:95], a[128:131]
  s_cbranch_vccz L_gd_37
  buffer_load_dwordx4 v6, s[8:11], s20 offen  lds
L_gd_37:
  v_mfma_f32_16x16x32_bf16 a[132:135], v[144:147], v[92:95], a[132:135]
  v_mfma_f32_16x16x32_bf16 a[136:139], v[148:151], v[92:95], a[136:139]
  v_mfma_f32_16x16x32_bf16 a[140:143], v[152:155], v[92:95], a[140:143]
  s_add_u32 m0, s53, 69632
  v_mfma_f32_16x16x32_bf16 a[144:147], v[156:159], v[92:95], a[144:147]
  s_cbranch_vccz L_gd_38
  buffer_load_dwordx4 v14, s[12:15], s21 offen  lds
L_gd_38:
  v_mfma_f32_16x16x32_bf16 a[148:151], v[160:163], v[92:95], a[148:151]
  v_mfma_f32_16x16x32_bf16 a[152:155], v[164:167], v[92:95], a[152:155]
  v_mfma_f32_16x16x32_bf16 a[156:159], v[168:171], v[92:95], a[156:159]
  s_add_u32 m0, s52, 70656
  v_mfma_f32_16x16x32_bf16 a[160:163], v[140:143], v[96:99], a[160:163]
  s_cbranch_vccz L_gd_39
  buffer_load_dwordx4 v7, s[8:11], s20 offen  lds
L_gd_39:
  v_mfma_f32_16x16x32_bf16 a[164:167], v[144:147], v[96:99], a[164:167]
  v_mfma_f32_16x16x32_bf16 a[168:171], v[148:151], v[96:99], a[168:171]
  v_mfma_f32_16x16x32_bf16 a[172:175], v[152:155], v[96:99], a[172:175]
  s_add_u32 m0, s53, 70656
  v_mfma_f32_16x16x32_bf16 a[176:179], v[156:159], v[96:99], a[176:179]
  s_cbranch_vccz L_gd_40
  buffer_load_dwordx4 v15, s[12:15], s21 offen  lds
L_gd_40:
  v_mfma_f32_16x16x32_bf16 a[180:183], v[160:163], v[96:99], a[180:183]
  v_mfma_f32_16x16x32_bf16 a[184:187], v[164:167], v[96:99], a[184:187]
  v_mfma_f32_16x16x32_bf16 a[188:191], v[168:171], v[96:99], a[188:191]
  s_add_u32 m0, s52, 71680
  v_mfma_f32_16x16x32_bf16 a[192:195], v[140:143], v[100:103], a[192:195]
  s_cbranch_vccz L_gd_41
  buffer_load_dwordx4 v8, s[8:11], s20 offen  lds
L_gd_41:
  v_mfma_f32_16x16x32_bf16 a[196:199], v[144:147], v[100:103], a[196:199]
  v_mfma_f32_16x16x32_bf16 a[200:203], v[148:151], v[100:103], a[200:203]
  v_mfma_f32_16x16x32_bf16 a[204:207], v[152:155], v[100:103], a[204:207]
  s_add_u32 m0, s53, 71680
  v_mfma_f32_16x16x32_bf16 a[208:211], v[156:159], v[100:103], a[208:211]
  s_cbranch_vccz L_gd_42
  buffer_load_dwordx4 v16, s[12:15], s21 offen  lds
L_gd_42:
  v_mfma_f32_16x16x32_bf16 a[212:215], v[160:163], v[100:103], a[212:215]
  v_mfma_f32_16x16x32_bf16 a[216:219], v[164:167], v[100:103], a[216:219]
  v_mfma_f32_16x16x32_bf16 a[220:223], v[168:171], v[100:103], a[220:223]
  s_add_u32 m0, s52, 72704
  v_mfma_f32_16x16x32_bf16 a[224:227], v[140:143], v[104:107], a[224:227]
  s_cbranch_vccz L_gd_43
  buffer_load_dwordx4 v9, s[8:11], s20 offen  lds
L_gd_43:
  v_mfma_f32_16x16x32_bf16 a[228:231], v[144:147], v[104:107], a[228:231]
  v_mfma_f32_16x16x32_bf16 a[232:235], v[148:151], v[104:107], a[232:235]
  v_mfma_f32_16x16x32_bf16 a[236:239], v[152:155], v[104:107], a[236:239]
  s_add_u32 m0, s53, 72704
  v_mfma_f32_16x16x32_bf16 a[240:243], v[156:159], v[104:107], a[240:243]
  s_cbranch_vccz L_gd_44
  buffer_load_dwordx4 v17, s[12:15], s21 offen  lds
  s_add_u32 s20, s20, 128
  s_add_u32 s21, s21, s51
L_gd_44:
  v_mfma_f32_16x16x32_bf16 a[244:247], v[160:163], v[104:107], a[244:247]
  v_mfma_f32_16x16x32_bf16 a[248:251], v[164:167], v[104:107], a[248:251]
  v_mfma_f32_16x16x32_bf16 a[252:255], v[168:171], v[104:107], a[252:255]
  s_cmp_eq_u32 s58, 1
  s_cbranch_scc1 L_epi
  s_branch L_have1
L_g1_cw:
  s_mov_b64 exec, 1
  ds_write_b32 v175, v244
  s_mov_b64 exec, -1
  s_branch L_g1_cwb
L_g1_cr:
  ds_read_b32 v246, v241
  s_cmp_eq_u32 s25, 1
  s_cbranch_scc1 L_g1_crb
  s_cmp_lg_u32 s32, 0
  s_cbranch_scc1 L_rq_45
  s_cmp_eq_u32 s39, 0
  s_cbranch_scc1 L_rq_45
  s_lshl_b32 s99, s33, 7
  s_add_u32 s99, s99, 0x3d00200
  v_mov_b32 v244, 1
  v_mov_b32 v245, 0
  s_mov_b64 exec, 1
  buffer_atomic_add v244, v245, s[4:7], s99 offen sc0 sc1
  s_mov_b64 exec, -1
L_rq_45:
  s_branch L_g1_crb
L_g2:
  s_waitcnt vmcnt(16)
  s_barrier
  ds_read_b128 v[44:47], v18 offset:0
  ds_read_b64_tr_b16 v[108:109], v22 offset:32768
  ds_read_b64_tr_b16 v[110:111], v22 offset:34816
  ds_read_b128 v[48:51], v18 offset:2048
  ds_read_b64_tr_b16 v[112:113], v23 offset:32768
  ds_read_b64_tr_b16 v[114:115], v23 offset:34816
  ds_read_b128 v[52:55], v18 offset:4096
  ds_read_b64_tr_b16 v[116:117], v24 offset:32768
  ds_read_b64_tr_b16 v[118:119], v24 offset:34816
  ds_read_b128 v[56:59], v18 offset:6144
  ds_read_b64_tr_b16 v[120:121], v25 offset:32768
  ds_read_b64_tr_b16 v[122:123], v25 offset:34816
  ds_read_b128 v[60:63], v18 offset:8192
  ds_read_b64_tr_b16 v[124:125], v26 offset:32768
  ds_read_b64_tr_b16 v[126:127], v26 offset:34816
  ds_read_b128 v[64:67], v18 offset:10240
  ds_read_b64_tr_b16 v[128:129], v27 offset:32768
  ds_read_b64_tr_b16 v[130:131], v27 offset:34816
  ds_read_b128 v[68:71], v18 offset:12288
  ds_read_b64_tr_b16 v[132:133], v28 offset:32768
  ds_read_b64_tr_b16 v[134:135], v28 offset:34816
  ds_read_b128 v[72:75], v18 offset:14336
  ds_read_b64_tr_b16 v[136:137], v29 offset:32768
  ds_read_b64_tr_b16 v[138:139], v29 offset:34816
  s_sub_u32 s25, s25, 1
  s_waitcnt lgkmcnt(0)
  s_nop 0
  v_mfma_f32_16x16x32_bf16 a[0:3], v[44:47], v[108:111], 0
  buffer_store_dwordx4 v[176:179], v172, s[4:7], s46 offen offset:0 sc1
  ds_read_b128 v[76:79], v19 offset:0
  v_mfma_f32_16x16x32_bf16 a[4:7], v[44:47], v[112:115], 0
  v_mfma_f32_16x16x32_bf16 a[8:11], v[44:47], v[116:119], 0
  ds_read_b64_tr_b16 v[140:141], v22 offset:49152
  v_mfma_f32_16x16x32_bf16 a[12:15], v[44:47], v[120:123], 0
  s_nop 0
  v_mfma_f32_16x16x32_bf16 a[16:19], v[44:47], v[124:127], 0
  buffer_store_dwordx4 v[180:183], v172, s[4:7], s46 offen offset:1024 sc1
  ds_read_b64_tr_b16 v[142:143], v22 offset:51200
  v_mfma_f32_16x16x32_bf16 a[20:23], v[44:47], v[128:131], 0
  v_mfma_f32_16x16x32_bf16 a[24:27], v[44:47], v[132:135], 0
  ds_read_b128 v[80:83], v19 offset:2048
  v_mfma_f32_16x16x32_bf16 a[28:31], v[44:47], v[136:139], 0
  s_nop 0
  v_mfma_f32_16x16x32_bf16 a[32:35], v[48:51], v[108:111], 0
  buffer_store_dwordx4 v[184:187], v172, s[4:7], s46 offen offset:2048 sc1
  ds_read_b64_tr_b16 v[144:145], v23 offset:49152
  v_mfma_f32_16x16x32_bf16 a[36:39], v[48:51], v[112:115], 0
  v_mfma_f32_16x16x32_bf16 a[40:43], v[48:51], v[116:119], 0
  ds_read_b64_tr_b16 v[146:147], v23 offset:51200
  v_mfma_f32_16x16x32_bf16 a[44:47], v[48:51], v[120:123], 0
  s_nop 0
  v_mfma_f32_16x16x32_bf16 a[48:51], v[48:51], v[124:127], 0
  buffer_store_dwordx4 v[188:191], v172, s[4:7], s46 offen offset:3072 sc1
  ds_read_b128 v[84:87], v19 offset:4096
  v_mfma_f32_16x16x32_bf16 a[52:55], v[48:51], v[128:131], 0
  v_mfma_f32_16x16x32_bf16 a[56:59], v[48:51], v[132:135], 0
  ds_read_b64_tr_b16 v[148:149], v24 offset:49152
  v_mfma_f32_16x16x32_bf16 a[60:63], v[48:51], v[136:139], 0
  s_nop 0
  v_mfma_f32_16x16x32_bf16 a[64:67], v[52:55], v[108:111], 0
  buffer_store_dwordx4 v[192:195], v173, s[4:7], s46 offen offset:0 sc1
  ds_read_b64_tr_b16 v[150:151], v24 offset:51200
  v_mfma_f32_16x16x32_bf16 a[68:71], v[52:55], v[112:115], 0
  v_mfma_f32_16x16x32_bf16 a[72:75], v[52:55], v[116:119], 0
  ds_read_b128 v[88:91], v19 offset:6144
  v_mfma_f32_16x16x32_bf16 a[76:79], v[52:55], v[120:123], 0
  s_nop 0
  v_mfma_f32_16x16x32_bf16 a[80:83], v[52:55], v[124:127], 0
  buffer_store_dwordx4 v[196:199], v173, s[4:7], s46 offen offset:1024 sc1
  ds_read_b64_tr_b16 v[152:153], v25 offset:49152
  v_mfma_f32_16x16x32_bf16 a[84:87], v[52:55], v[128:131], 0
  v_mfma_f32_16x16x32_bf16 a[88:91], v[52:55], v[132:135], 0
  ds_read_b64_tr_b16 v[154:155], v25 offset:51200
  v_mfma_f32_16x16x32_bf16 a[92:95], v[52:55], v[136:139], 0
  s_nop 0
  v_mfma_f32_16x16x32_bf16 a[96:99], v[56:59], v[108:111], 0
  buffer_store_dwordx4 v[200:203], v173, s[4:7], s46 offen offset:2048 sc1
  ds_read_b128 v[92:95], v19 offset:8192
  v_mfma_f32_16x16x32_bf16 a[100:103], v[56:59], v[112:115], 0
  v_mfma_f32_16x16x32_bf16 a[104:107], v[56:59], v[116:119], 0
  ds_read_b64_tr_b16 v[156:157], v26 offset:49152
  v_mfma_f32_16x16x32_bf16 a[108:111], v[56:59], v[120:123], 0
  s_nop 0
  v_mfma_f32_16x16x32_bf16 a[112:115], v[56:59], v[124:127], 0
  buffer_store_dwordx4 v[204:207], v173, s[4:7], s46 offen offset:3072 sc1
  ds_read_b64_tr_b16 v[158:159], v26 offset:51200
  v_mfma_f32_16x16x32_bf16 a[116:119], v[56:59], v[128:131], 0
  v_mfma_f32_16x16x32_bf16 a[120:123], v[56:59], v[132:135], 0
  ds_read_b128 v[96:99], v19 offset:10240
  v_mfma_f32_16x16x32_bf16 a[124:127], v[56:59], v[136:139], 0
  s_nop 0
  v_mfma_f32_16x16x32_bf16 a[128:131], v[60:63], v[108:111], 0
  buffer_store_dwordx4 v[208:211], v172, s[4:7], s47 offen offset:0 sc1
  ds_read_b64_tr_b16 v[160:161], v27 offset:49152
  v_mfma_f32_16x16x32_bf16 a[132:135], v[60:63], v[112:115], 0
  v_mfma_f32_16x16x32_bf16 a[136:139], v[60:63], v[116:119], 0
  ds_read_b64_tr_b16 v[162:163], v27 offset:51200
  v_mfma_f32_16x16x32_bf16 a[140:143], v[60:63], v[120:123], 0
  s_nop 0
  v_mfma_f32_16x16x32_bf16 a[144:147], v[60:63], v[124:127], 0
  buffer_store_dwordx4 v[212:215], v172, s[4:7], s47 offen offset:1024 sc1
  ds_read_b128 v[100:103], v19 offset:12288
  v_mfma_f32_16x16x32_bf16 a[148:151], v[60:63], v[128:131], 0
  v_mfma_f32_16x16x32_bf16 a[152:155], v[60:63], v[132:135], 0
  ds_read_b64_tr_b16 v[164:165], v28 offset:49152
  v_mfma_f32_16x16x32_bf16 a[156:159], v[60:63], v[136:139], 0
  s_nop 0
  v_mfma_f32_16x16x32_bf16 a[160:163], v[64:67], v[108:111], 0
  buffer_store_dwordx4 v[216:219], v172, s[4:7], s47 offen offset:2048 sc1
  ds_read_b64_tr_b16 v[166:167], v28 offset:51200
  v_mfma_f32_16x16x32_bf16 a[164:167], v[64:67], v[112:115], 0
  v_mfma_f32_16x16x32_bf16 a[168:171], v[64:67], v[116:119], 0
  ds_read_b128 v[104:107], v19 offset:14336
  v_mfma_f32_16x16x32_bf16 a[172:175], v[64:67], v[120:123], 0
  s_nop 0
  v_mfma_f32_16x16x32_bf16 a[176:179], v[64:67], v[124:127], 0
  buffer_store_dwordx4 v[220:223], v172, s[4:7], s47 offen offset:3072 sc1
  ds_read_b64_tr_b16 v[168:169], v29 offset:49152
  v_mfma_f32_16x16x32_bf16 a[180:183], v[64:67], v[128:131], 0
  v_mfma_f32_16x16x32_bf16 a[184:187], v[64:67], v[132:135], 0
  ds_read_b64_tr_b16 v[170:171], v29 offset:51200
  v_mfma_f32_16x16x32_bf16 a[188:191], v[64:67], v[136:139], 0
  s_nop 0
  v_mfma_f32_16x16x32_bf16 a[192:195], v[68:71], v[108:111], 0
  buffer_store_dwordx4 v[224:227], v173, s[4:7], s47 offen offset:0 sc1
  v_mfma_f32_16x16x32_bf16 a[196:199], v[68:71], v[112:115], 0
  v_mfma_f32_16x16x32_bf16 a[200:203], v[68:71], v[116:119], 0
  v_mfma_f32_16x16x32_bf16 a[204:207], v[68:71], v[120:123], 0
  s_nop 0
  v_mfma_f32_16x16x32_bf16 a[208:211], v[68:71], v[124:127], 0
  buffer_store_dwordx4 v[228:231], v173, s[4:7], s47 offen offset:1024 sc1
  v_mfma_f32_16x16x32_bf16 a[212:215], v[68:71], v[128:131], 0
  v_mfma_f32_16x16x32_bf16 a[216:219], v[68:71], v[132:135], 0
  v_mfma_f32_16x16x32_bf16 a[220:223], v[68:71], v[136:139], 0
  s_nop 0
  v_mfma_f32_16x16x32_bf16 a[224:227], v[72:75], v[108:111], 0
  buffer_store_dwordx4 v[232:235], v173, s[4:7], s47 offen offset:2048 sc1
  v_mfma_f32_16x16x32_bf16 a[228:231], v[72:75], v[112:115], 0
  v_mfma_f32_16x16x32_bf16 a[232:235], v[72:75], v[116:119], 0
  v_mfma_f32_16x16x32_bf16 a[236:239], v[72:75], v[120:123], 0
  s_nop 0
  v_mfma_f32_16x16x32_bf16 a[240:243], v[72:75], v[124:127], 0
  buffer_store_dwordx4 v[236:239], v173, s[4:7], s47 offen offset:3072 sc1
  v_mfma_f32_16x16x32_bf16 a[244:247], v[72:75], v[128:131], 0
  v_mfma_f32_16x16x32_bf16 a[248:251], v[72:75], v[132:135], 0
  v_mfma_f32_16x16x32_bf16 a[252:255], v[72:75], v[136:139], 0
  s_waitcnt lgkmcnt(0)
  v_mfma_f32_16x16x32_bf16 a[0:3], v[76:79], v[140:143], a[0:3]
  s_waitcnt vmcnt(16)
  s_barrier
  s_add_u32 m0, s52, 0
  v_mfma_f32_16x16x32_bf16 a[4:7], v[76:79], v[144:147], a[4:7]
  buffer_load_dwordx4 v2, s[8:11], s20 offen  lds
  ds_read_b128 v[44:47], v20 offset:0
  v_mfma_f32_16x16x32_bf16 a[8:11], v[76:79], v[148:151], a[8:11]
  v_mfma_f32_16x16x32_bf16 a[12:15], v[76:79], v[152:155], a[12:15]
  ds_read_b64_tr_b16 v[108:109], v30 offset:32768
  s_add_u32 m0, s53, 0
  v_mfma_f32_16x16x32_bf16 a[16:19], v[76:79], v[156:159], a[16:19]
  buffer_load_dwordx4 v10, s[12:15], s21 offen  lds
  v_mfma_f32_16x16x32_bf16 a[20:23], v[76:79], v[160:163], a[20:23]
  ds_read_b64_tr_b16 v[110:111], v30 offset:34816
  v_mfma_f32_16x16x32_bf16 a[24:27], v[76:79], v[164:167], a[24:27]
  v_mfma_f32_16x16x32_bf16 a[28:31], v[76:79], v[168:171], a[28:31]
  ds_read_b128 v[48:51], v20 offset:2048
  s_add_u32 m0, s52, 1024
  v_mfma_f32_16x16x32_bf16 a[32:35], v[80:83], v[140:143], a[32:35]
  buffer_load_dwordx4 v3, s[8:11], s20 offen  lds
  v_mfma_f32_16x16x32_bf16 a[36:39], v[80:83], v[144:147], a[36:39]
  ds_read_b64_tr_b16 v[112:113], v31 offset:32768
  v_mfma_f32_16x16x32_bf16 a[40:43], v[80:83], v[148:151], a[40:43]
  v_mfma_f32_16x16x32_bf16 a[44:47], v[80:83], v[152:155], a[44:47]
  ds_read_b64_tr_b16 v[114:115], v31 offset:34816
  s_add_u32 m0, s53, 1024
  v_mfma_f32_16x16x32_bf16 a[48:51], v[80:83], v[156:159], a[48:51]
  buffer_load_dwordx4 v11, s[12:15], s21 offen  lds
  v_mfma_f32_16x16x32_bf16 a[52:55], v[80:83], v[160:163], a[52:55]
  ds_read_b128 v[52:55], v20 offset:4096
  v_mfma_f32_16x16x32_bf16 a[56:59], v[80:83], v[164:167], a[56:59]
  s_add_u32 m0, s52, 2048
  v_mfma_f32_16x16x32_bf16 a[60:63], v[80:83], v[168:171], a[60:63]
  buffer_load_dwordx4 v4, s[8:11], s20 offen  lds
  ds_read_b64_tr_b16 v[116:117], v32 offset:32768
  v_mfma_f32_16x16x32_bf16 a[64:67], v[84:87], v[140:143], a[64:67]
  v_mfma_f32_16x16x32_bf16 a[68:71], v[84:87], v[144:147], a[68:71]
  ds_read_b64_tr_b16 v[118:119], v32 offset:34816
  v_mfma_f32_16x16x32_bf16 a[72:75], v[84:87], v[148:151], a[72:75]
  s_add_u32 m0, s53, 2048
  v_mfma_f32_16x16x32_bf16 a[76:79], v[84:87], v[152:155], a[76:79]
  buffer_load_dwordx4 v12, s[12:15], s21 offen  lds
  ds_read_b128 v[56:59], v20 offset:6144
  v_mfma_f32_16x16x32_bf16 a[80:83], v[84:87], v[156:159], a[80:83]
  v_mfma_f32_16x16x32_bf16 a[84:87], v[84:87], v[160:163], a[84:87]
  ds_read_b64_tr_b16 v[120:121], v33 offset:32768
  v_mfma_f32_16x16x32_bf16 a[88:91], v[84:87], v[164:167], a[88:91]
  s_add_u32 m0, s52, 3072
  v_mfma_f32_16x16x32_bf16 a[92:95], v[84:87], v[168:171], a[92:95]
  buffer_load_dwordx4 v5, s[8:11], s20 offen  lds
  ds_read_b64_tr_b16 v[122:123], v33 offset:34816
  v_mfma_f32_16x16x32_bf16 a[96:99], v[88:91], v[140:143], a[96:99]
  v_mfma_f32_16x16x32_bf16 a[100:103], v[88:91], v[144:147], a[100:103]
  ds_read_b128 v[60:63], v20 offset:8192
  s_add_u32 m0, s53, 3072
  v_mfma_f32_16x16x32_bf16 a[104:107], v[88:91], v[148:151], a[104:107]
  buffer_load_dwordx4 v13, s[12:15], s21 offen  lds
  v_mfma_f32_16x16x32_bf16 a[108:111], v[88:91], v[152:155], a[108:111]
  ds_read_b64_tr_b16 v[124:125], v34 offset:32768
  v_mfma_f32_16x16x32_bf16 a[112:115], v[88:91], v[156:159], a[112:115]
  v_mfma_f32_16x16x32_bf16 a[116:119], v[88:91], v[160:163], a[116:119]
  ds_read_b64_tr_b16 v[126:127], v34 offset:34816
  s_add_u32 m0, s52, 4096
  v_mfma_f32_16x16x32_bf16 a[120:123], v[88:91], v[164:167], a[120:123]
  buffer_load_dwordx4 v6, s[8:11], s20 offen  lds
  v_mfma_f32_16x16x32_bf16 a[124:127], v[88:91], v[168:171], a[124:127]
  ds_read_b128 v[64:67], v20 offset:10240
  v_mfma_f32_16x16x32_bf16 a[128:131], v[92:95], v[140:143], a[128:131]
  v_mfma_f32_16x16x32_bf16 a[132:135], v[92:95], v[144:147], a[132:135]
  ds_read_b64_tr_b16 v[128:129], v35 offset:32768
  s_add_u32 m0, s53, 4096
  v_mfma_f32_16x16x32_bf16 a[136:139], v[92:95], v[148:151], a[136:139]
  buffer_load_dwordx4 v14, s[12:15], s21 offen  lds
  v_mfma_f32_16x16x32_bf16 a[140:143], v[92:95], v[152:155], a[140:143]
  ds_read_b64_tr_b16 v[130:131], v35 offset:34816
  v_mfma_f32_16x16x32_bf16 a[144:147], v[92:95], v[156:159], a[144:147]
  v_mfma_f32_16x16x32_bf16 a[148:151], v[92:95], v[160:163], a[148:151]
  ds_read_b128 v[68:71], v20 offset:12288
  s_add_u32 m0, s52, 5120
  v_mfma_f32_16x16x32_bf16 a[152:155], v[92:95], v[164:167], a[152:155]
  buffer_load_dwordx4 v7, s[8:11], s20 offen  lds
  v_mfma_f32_16x16x32_bf16 a[156:159], v[92:95], v[168:171], a[156:159]
  ds_read_b64_tr_b16 v[132:133], v36 offset:32768
  v_mfma_f32_16x16x32_bf16 a[160:163], v[96:99], v[140:143], a[160:163]
  s_add_u32 m0, s53, 5120
  v_mfma_f32_16x16x32_bf16 a[164:167], v[96:99], v[144:147], a[164:167]
  buffer_load_dwordx4 v15, s[12:15], s21 offen  lds
  ds_read_b64_tr_b16 v[134:135], v36 offset:34816
  v_mfma_f32_16x16x32_bf16 a[168:171], v[96:99], v[148:151], a[168:171]
  v_mfma_f32_16x16x32_bf16 a[172:175], v[96:99], v[152:155], a[172:175]
  ds_read_b128 v[72:75], v20 offset:14336
  v_mfma_f32_16x16x32_bf16 a[176:179], v[96:99], v[156:159], a[176:179]
  s_add_u32 m0, s52, 6144
  v_mfma_f32_16x16x32_bf16 a[180:183], v[96:99], v[160:163], a[180:183]
  buffer_load_dwordx4 v8, s[8:11], s20 offen  lds
  ds_read_b64_tr_b16 v[136:137], v37 offset:32768
  v_mfma_f32_16x16x32_bf16 a[184:187], v[96:99], v[164:167], a[184:187]
  v_mfma_f32_16x16x32_bf16 a[188:191], v[96:99], v[168:171], a[188:191]
  ds_read_b64_tr_b16 v[138:139], v37 offset:34816
  v_mfma_f32_16x16x32_bf16 a[192:195], v[100:103], v[140:143], a[192:195]
  s_add_u32 m0, s53, 6144
  v_mfma_f32_16x16x32_bf16 a[196:199], v[100:103], v[144:147], a[196:199]
  buffer_load_dwordx4 v16, s[12:15], s21 offen  lds
  v_mfma_f32_16x16x32_bf16 a[200:203], v[100:103], v[148:151], a[200:203]
  v_mfma_f32_16x16x32_bf16 a[204:207], v[100:103], v[152:155], a[204:207]
  s_add_u32 m0, s52, 7168
  v_mfma_f32_16x16x32_bf16 a[208:211], v[100:103], v[156:159], a[208:211]
  buffer_load_dwordx4 v9, s[8:11], s20 offen  lds
  v_mfma_f32_16x16x32_bf16 a[212:215], v[100:103], v[160:163], a[212:215]
  v_mfma_f32_16x16x32_bf16 a[216:219], v[100:103], v[164:167], a[216:219]
  v_mfma_f32_16x16x32_bf16 a[220:223], v[100:103], v[168:171], a[220:223]
  s_add_u32 m0, s53, 7168
  v_mfma_f32_16x16x32_bf16 a[224:227], v[104:107], v[140:143], a[224:227]
  buffer_load_dwordx4 v17, s[12:15], s21 offen  lds
  v_mfma_f32_16x16x32_bf16 a[228:231], v[104:107], v[144:147], a[228:231]
  v_mfma_f32_16x16x32_bf16 a[232:235], v[104:107], v[148:151], a[232:235]
  v_mfma_f32_16x16x32_bf16 a[236:239], v[104:107], v[152:155], a[236:239]
  s_add_u32 s20, s20, 128
  v_mfma_f32_16x16x32_bf16 a[240:243], v[104:107], v[156:159], a[240:243]
  s_add_u32 s21, s21, s51
  v_mfma_f32_16x16x32_bf16 a[244:247], v[104:107], v[160:163], a[244:247]
  v_mfma_f32_16x16x32_bf16 a[248:251], v[104:107], v[164:167], a[248:251]
  v_mfma_f32_16x16x32_bf16 a[252:255], v[104:107], v[168:171], a[252:255]
  s_waitcnt lgkmcnt(0)
  v_mfma_f32_16x16x32_bf16 a[0:3], v[44:47], v[108:111], a[0:3]
  ds_read_b128 v[76:79], v21 offset:0
  v_mfma_f32_16x16x32_bf16 a[4:7], v[44:47], v[112:115], a[4:7]
  v_mfma_f32_16x16x32_bf16 a[8:11], v[44:47], v[116:119], a[8:11]
  ds_read_b64_tr_b16 v[140:141], v30 offset:49152
  v_mfma_f32_16x16x32_bf16 a[12:15], v[44:47], v[120:123], a[12:15]
  v_mfma_f32_16x16x32_bf16 a[16:19], v[44:47], v[124:127], a[16:19]
  ds_read_b64_tr_b16 v[142:143], v30 offset:51200
  v_mfma_f32_16x16x32_bf16 a[20:23], v[44:47], v[128:131], a[20:23]
  v_mfma_f32_16x16x32_bf16 a[24:27], v[44:47], v[132:135], a[24:27]
  ds_read_b128 v[80:83], v21 offset:2048
  v_mfma_f32_16x16x32_bf16 a[28:31], v[44:47], v[136:139], a[28:31]
  v_mfma_f32_16x16x32_bf16 a[32:35], v[48:51], v[108:111], a[32:35]
  ds_read_b64_tr_b16 v[144:145], v31 offset:49152
  v_mfma_f32_16x16x32_bf16 a[36:39], v[48:51], v[112:115], a[36:39]
  v_mfma_f32_16x16x32_bf16 a[40:43], v[48:51], v[116:119], a[40:43]
  ds_read_b64_tr_b16 v[146:147], v31 offset:51200
  v_mfma_f32_16x16x32_bf16 a[44:47], v[48:51], v[120:123], a[44:47]
  v_mfma_f32_16x16x32_bf16 a[48:51], v[48:51], v[124:127], a[48:51]
  ds_read_b128 v[84:87], v21 offset:4096
  v_mfma_f32_16x16x32_bf16 a[52:55], v[48:51], v[128:131], a[52:55]
  v_mfma_f32_16x16x32_bf16 a[56:59], v[48:51], v[132:135], a[56:59]
  ds_read_b64_tr_b16 v[148:149], v32 offset:49152
  v_mfma_f32_16x16x32_bf16 a[60:63], v[48:51], v[136:139], a[60:63]
  v_mfma_f32_16x16x32_bf16 a[64:67], v[52:55], v[108:111], a[64:67]
  ds_read_b64_tr_b16 v[150:151], v32 offset:51200
  v_mfma_f32_16x16x32_bf16 a[68:71], v[52:55], v[112:115], a[68:71]
  v_mfma_f32_16x16x32_bf16 a[72:75], v[52:55], v[116:119], a[72:75]
  ds_read_b128 v[88:91], v21 offset:6144
  v_mfma_f32_16x16x32_bf16 a[76:79], v[52:55], v[120:123], a[76:79]
  v_mfma_f32_16x16x32_bf16 a[80:83], v[52:55], v[124:127], a[80:83]
  ds_read_b64_tr_b16 v[152:153], v33 offset:49152
  v_mfma_f32_16x16x32_bf16 a[84:87], v[52:55], v[128:131], a[84:87]
  v_mfma_f32_16x16x32_bf16 a[88:91], v[52:55], v[132:135], a[88:91]
  ds_read_b64_tr_b16 v[154:155], v33 offset:51200
  v_mfma_f32_16x16x32_bf16 a[92:95], v[52:55], v[136:139], a[92:95]
  v_mfma_f32_16x16x32_bf16 a[96:99], v[56:59], v[108:111], a[96:99]
  ds_read_b128 v[92:95], v21 offset:8192
  v_mfma_f32_16x16x32_bf16 a[100:103], v[56:59], v[112:115], a[100:103]
  v_mfma_f32_16x16x32_bf16 a[104:107], v[56:59], v[116:119], a[104:107]
  ds_read_b64_tr_b16 v[156:157], v34 offset:49152
  v_mfma_f32_16x16x32_bf16 a[108:111], v[56:59], v[120:123], a[108:111]
  v_mfma_f32_16x16x32_bf16 a[112:115], v[56:59], v[124:127], a[112:115]
  ds_read_b64_tr_b16 v[158:159], v34 offset:51200
  v_mfma_f32_16x16x32_bf16 a[116:119], v[56:59], v[128:131], a[116:119]
  v_mfma_f32_16x16x32_bf16 a[120:123], v[56:59], v[132:135], a[120:123]
  ds_read_b128 v[96:99], v21 offset:10240
  v_mfma_f32_16x16x32_bf16 a[124:127], v[56:59], v[136:139], a[124:127]
  v_mfma_f32_16x16x32_bf16 a[128:131], v[60:63], v[108:111], a[128:131]
  ds_read_b64_tr_b16 v[160:161], v35 offset:49152
  v_mfma_f32_16x16x32_bf16 a[132:135], v[60:63], v[112:115], a[132:135]
  v_mfma_f32_16x16x32_bf16 a[136:139], v[60:63], v[116:119], a[136:139]
  ds_read_b64_tr_b16 v[162:163], v35 offset:51200
  v_mfma_f32_16x16x32_bf16 a[140:143], v[60:63], v[120:123], a[140:143]
  v_mfma_f32_16x16x32_bf16 a[144:147], v[60:63], v[124:127], a[144:147]
  ds_read_b128 v[100:103], v21 offset:12288
  v_mfma_f32_16x16x32_bf16 a[148:151], v[60:63], v[128:131], a[148:151]
  v_mfma_f32_16x16x32_bf16 a[152:155], v[60:63], v[132:135], a[152:155]
  ds_read_b64_tr_b16 v[164:165], v36 offset:49152
  v_mfma_f32_16x16x32_bf16 a[156:159], v[60:63], v[136:139], a[156:159]
  v_mfma_f32_16x16x32_bf16 a[160:163], v[64:67], v[108:111], a[160:163]
  ds_read_b64_tr_b16 v[166:167], v36 offset:51200
  v_mfma_f32_16x16x32_bf16 a[164:167], v[64:67], v[112:115], a[164:167]
  v_mfma_f32_16x16x32_bf16 a[168:171], v[64:67], v[116:119], a[168:171]
  ds_read_b128 v[104:107], v21 offset:14336
  v_mfma_f32_16x16x32_bf16 a[172:175], v[64:67], v[120:123], a[172:175]
  v_mfma_f32_16x16x32_bf16 a[176:179], v[64:67], v[124:127], a[176:179]
  ds_read_b64_tr_b16 v[168:169], v37 offset:49152
  v_mfma_f32_16x16x32_bf16 a[180:183], v[64:67], v[128:131], a[180:183]
  v_mfma_f32_16x16x32_bf16 a[184:187], v[64:67], v[132:135], a[184:187]
  ds_read_b64_tr_b16 v[170:171], v37 offset:51200
  v_mfma_f32_16x16x32_bf16 a[188:191], v[64:67], v[136:139], a[188:191]
  v_mfma_f32_16x16x32_bf16 a[192:195], v[68:71], v[108:111], a[192:195]
  v_mfma_f32_16x16x32_bf16 a[196:199], v[68:71], v[112:115], a[196:199]
  v_mfma_f32_16x16x32_bf16 a[200:203], v[68:71], v[116:119], a[200:203]
  v_mfma_f32_16x16x32_bf16 a[204:207], v[68:71], v[120:123], a[204:207]
  v_mfma_f32_16x16x32_bf16 a[208:211], v[68:71], v[124:127], a[208:211]
  v_mfma_f32_16x16x32_bf16 a[212:215], v[68:71], v[128:131], a[212:215]
  v_mfma_f32_16x16x32_bf16 a[216:219], v[68:71], v[132:135], a[216:219]
  v_mfma_f32_16x16x32_bf16 a[220:223], v[68:71], v[136:139], a[220:223]
  v_mfma_f32_16x16x32_bf16 a[224:227], v[72:75], v[108:111], a[224:227]
  v_mfma_f32_16x16x32_bf16 a[228:231], v[72:75], v[112:115], a[228:231]
  v_mfma_f32_16x16x32_bf16 a[232:235], v[72:75], v[116:119], a[232:235]
  v_mfma_f32_16x16x32_bf16 a[236:239], v[72:75], v[120:123], a[236:239]
  v_mfma_f32_16x16x32_bf16 a[240:243], v[72:75], v[124:127], a[240:243]
  v_mfma_f32_16x16x32_bf16 a[244:247], v[72:75], v[128:131], a[244:247]
  v_mfma_f32_16x16x32_bf16 a[248:251], v[72:75], v[132:135], a[248:251]
  v_mfma_f32_16x16x32_bf16 a[252:255], v[72:75], v[136:139], a[252:255]
  s_waitcnt lgkmcnt(0)
  v_mfma_f32_16x16x32_bf16 a[0:3], v[76:79], v[140:143], a[0:3]
  s_waitcnt vmcnt(0)
  s_barrier
  s_cmp_eq_u32 s49, 0
  s_cbranch_scc1 L_hs_46
  s_cmp_lg_u32 s32, 0
  s_cbranch_scc1 L_sig_47
  v_mov_b32 v254, s63
  v_mov_b32 v255, 0
  v_and_b32 v254, 3, v254
  v_mbcnt_lo_u32_b32 v255, -1, 0
  v_lshlrev_b32 v255, 9, v255
  s_cmp_ge_u32 s63, 2
  s_cselect_b64 exec, 3, 1
  buffer_atomic_add v254, v255, s[4:7], s62 offen offset:0 sc1
  s_mov_b64 exec, -1
L_sig_47:
L_hs_46:
  s_add_u32 m0, s52, 65536
  v_mfma_f32_16x16x32_bf16 a[4:7], v[76:79], v[144:147], a[4:7]
  buffer_load_dwordx4 v2, s[8:11], s20 offen  lds
  ds_read_b128 v[44:47], v18 offset:0
  v_mfma_f32_16x16x32_bf16 a[8:11], v[76:79], v[148:151], a[8:11]
  v_mfma_f32_16x16x32_bf16 a[12:15], v[76:79], v[152:155], a[12:15]
  ds_read_b64_tr_b16 v[108:109], v22 offset:32768
  s_add_u32 m0, s53, 65536
  v_mfma_f32_16x16x32_bf16 a[16:19], v[76:79], v[156:159], a[16:19]
  buffer_load_dwordx4 v10, s[12:15], s21 offen  lds
  v_mfma_f32_16x16x32_bf16 a[20:23], v[76:79], v[160:163], a[20:23]
  ds_read_b64_tr_b16 v[110:111], v22 offset:34816
  v_mfma_f32_16x16x32_bf16 a[24:27], v[76:79], v[164:167], a[24:27]
  v_mfma_f32_16x16x32_bf16 a[28:31], v[76:79], v[168:171], a[28:31]
  ds_read_b128 v[48:51], v18 offset:2048
  s_add_u32 m0, s52, 66560
  v_mfma_f32_16x16x32_bf16 a[32:35], v[80:83], v[140:143], a[32:35]
  buffer_load_dwordx4 v3, s[8:11], s20 offen  lds
  v_mfma_f32_16x16x32_bf16 a[36:39], v[80:83], v[144:147], a[36:39]
  ds_read_b64_tr_b16 v[112:113], v23 offset:32768
  v_mfma_f32_16x16x32_bf16 a[40:43], v[80:83], v[148:151], a[40:43]
  v_mfma_f32_16x16x32_bf16 a[44:47], v[80:83], v[152:155], a[44:47]
  ds_read_b64_tr_b16 v[114:115], v23 offset:34816
  s_add_u32 m0, s53, 66560
  v_mfma_f32_16x16x32_bf16 a[48:51], v[80:83], v[156:159], a[48:51]
  buffer_load_dwordx4 v11, s[12:15], s21 offen  lds
  v_mfma_f32_16x16x32_bf16 a[52:55], v[80:83], v[160:163], a[52:55]
  ds_read_b128 v[52:55], v18 offset:4096
  v_mfma_f32_16x16x32_bf16 a[56:59], v[80:83], v[164:167], a[56:59]
  s_add_u32 m0, s52, 67584
  v_mfma_f32_16x16x32_bf16 a[60:63], v[80:83], v[168:171], a[60:63]
  buffer_load_dwordx4 v4, s[8:11], s20 offen  lds
  ds_read_b64_tr_b16 v[116:117], v24 offset:32768
  v_mfma_f32_16x16x32_bf16 a[64:67], v[84:87], v[140:143], a[64:67]
  v_mfma_f32_16x16x32_bf16 a[68:71], v[84:87], v[144:147], a[68:71]
  ds_read_b64_tr_b16 v[118:119], v24 offset:34816
  v_mfma_f32_16x16x32_bf16 a[72:75], v[84:87], v[148:151], a[72:75]
  s_add_u32 m0, s53, 67584
  v_mfma_f32_16x16x32_bf16 a[76:79], v[84:87], v[152:155], a[76:79]
  buffer_load_dwordx4 v12, s[12:15], s21 offen  lds
  ds_read_b128 v[56:59], v18 offset:6144
  v_mfma_f32_16x16x32_bf16 a[80:83], v[84:87], v[156:159], a[80:83]
  v_mfma_f32_16x16x32_bf16 a[84:87], v[84:87], v[160:163], a[84:87]
  ds_read_b64_tr_b16 v[120:121], v25 offset:32768
  v_mfma_f32_16x16x32_bf16 a[88:91], v[84:87], v[164:167], a[88:91]
  s_add_u32 m0, s52, 68608
  v_mfma_f32_16x16x32_bf16 a[92:95], v[84:87], v[168:171], a[92:95]
  buffer_load_dwordx4 v5, s[8:11], s20 offen  lds
  ds_read_b64_tr_b16 v[122:123], v25 offset:34816
  v_mfma_f32_16x16x32_bf16 a[96:99], v[88:91], v[140:143], a[96:99]
  v_mfma_f32_16x16x32_bf16 a[100:103], v[88:91], v[144:147], a[100:103]
  ds_read_b128 v[60:63], v18 offset:8192
  s_add_u32 m0, s53, 68608
  v_mfma_f32_16x16x32_bf16 a[104:107], v[88:91], v[148:151], a[104:107]
  buffer_load_dwordx4 v13, s[12:15], s21 offen  lds
  v_mfma_f32_16x16x32_bf16 a[108:111], v[88:91], v[152:155], a[108:111]
  ds_read_b64_tr_b16 v[124:125], v26 offset:32768
  v_mfma_f32_16x16x32_bf16 a[112:115], v[88:91], v[156:159], a[112:115]
  v_mfma_f32_16x16x32_bf16 a[116:119], v[88:91], v[160:163], a[116:119]
  ds_read_b64_tr_b16 v[126:127], v26 offset:34816
  s_add_u32 m0, s52, 69632
  v_mfma_f32_16x16x32_bf16 a[120:123], v[88:91], v[164:167], a[120:123]
  buffer_load_dwordx4 v6, s[8:11], s20 offen  lds
  v_mfma_f32_16x16x32_bf16 a[124:127], v[88:91], v[168:171], a[124:127]
  ds_read_b128 v[64:67], v18 offset:10240
  v_mfma_f32_16x16x32_bf16 a[128:131], v[92:95], v[140:143], a[128:131]
  v_mfma_f32_16x16x32_bf16 a[132:135], v[92:95], v[144:147], a[132:135]
  ds_read_b64_tr_b16 v[128:129], v27 offset:32768
  s_add_u32 m0, s53, 69632
  v_mfma_f32_16x16x32_bf16 a[136:139], v[92:95], v[148:151], a[136:139]
  buffer_load_dwordx4 v14, s[12:15], s21 offen  lds
  v_mfma_f32_16x16x32_bf16 a[140:143], v[92:95], v[152:155], a[140:143]
  ds_read_b64_tr_b16 v[130:131], v27 offset:34816
  v_mfma_f32_16x16x32_bf16 a[144:147], v[92:95], v[156:159], a[144:147]
  v_mfma_f32_16x16x32_bf16 a[148:151], v[92:95], v[160:163], a[148:151]
  ds_read_b128 v[68:71], v18 offset:12288
  s_add_u32 m0, s52, 70656
  v_mfma_f32_16x16x32_bf16 a[152:155], v[92:95], v[164:167], a[152:155]
  buffer_load_dwordx4 v7, s[8:11], s20 offen  lds
  v_mfma_f32_16x16x32_bf16 a[156:159], v[92:95], v[168:171], a[156:159]
  ds_read_b64_tr_b16 v[132:133], v28 offset:32768
  v_mfma_f32_16x16x32_bf16 a[160:163], v[96:99], v[140:143], a[160:163]
  s_add_u32 m0, s53, 70656
  v_mfma_f32_16x16x32_bf16 a[164:167], v[96:99], v[144:147], a[164:167]
  buffer_load_dwordx4 v15, s[12:15], s21 offen  lds
  ds_read_b64_tr_b16 v[134:135], v28 offset:34816
  v_mfma_f32_16x16x32_bf16 a[168:171], v[96:99], v[148:151], a[168:171]
  v_mfma_f32_16x16x32_bf16 a[172:175], v[96:99], v[152:155], a[172:175]
  ds_read_b128 v[72:75], v18 offset:14336
  v_mfma_f32_16x16x32_bf16 a[176:179], v[96:99], v[156:159], a[176:179]
  s_add_u32 m0, s52, 71680
  v_mfma_f32_16x16x32_bf16 a[180:183], v[96:99], v[160:163], a[180:183]
  buffer_load_dwordx4 v8, s[8:11], s20 offen  lds
  ds_read_b64_tr_b16 v[136:137], v29 offset:32768
  v_mfma_f32_16x16x32_bf16 a[184:187], v[96:99], v[164:167], a[184:187]
  v_mfma_f32_16x16x32_bf16 a[188:191], v[96:99], v[168:171], a[188:191]
  ds_read_b64_tr_b16 v[138:139], v29 offset:34816
  v_mfma_f32_16x16x32_bf16 a[192:195], v[100:103], v[140:143], a[192:195]
  s_add_u32 m0, s53, 71680
  v_mfma_f32_16x16x32_bf16 a[196:199], v[100:103], v[144:147], a[196:199]
  buffer_load_dwordx4 v16, s[12:15], s21 offen  lds
  v_mfma_f32_16x16x32_bf16 a[200:203], v[100:103], v[148:151], a[200:203]
  v_mfma_f32_16x16x32_bf16 a[204:207], v[100:103], v[152:155], a[204:207]
  s_add_u32 m0, s52, 72704
  v_mfma_f32_16x16x32_bf16 a[208:211], v[100:103], v[156:159], a[208:211]
  buffer_load_dwordx4 v9, s[8:11], s20 offen  lds
  v_mfma_f32_16x16x32_bf16 a[212:215], v[100:103], v[160:163], a[212:215]
  v_mfma_f32_16x16x32_bf16 a[216:219], v[100:103], v[164:167], a[216:219]
  v_mfma_f32_16x16x32_bf16 a[220:223], v[100:103], v[168:171], a[220:223]
  s_add_u32 m0, s53, 72704
  v_mfma_f32_16x16x32_bf16 a[224:227], v[104:107], v[140:143], a[224:227]
  buffer_load_dwordx4 v17, s[12:15], s21 offen  lds
  v_mfma_f32_16x16x32_bf16 a[228:231], v[104:107], v[144:147], a[228:231]
  v_mfma_f32_16x16x32_bf16 a[232:235], v[104:107], v[148:151], a[232:235]
  v_mfma_f32_16x16x32_bf16 a[236:239], v[104:107], v[152:155], a[236:239]
  s_add_u32 s20, s20, 128
  v_mfma_f32_16x16x32_bf16 a[240:243], v[104:107], v[156:159], a[240:243]
  s_add_u32 s21, s21, s51
  v_mfma_f32_16x16x32_bf16 a[244:247], v[104:107], v[160:163], a[244:247]
  v_mfma_f32_16x16x32_bf16 a[248:251], v[104:107], v[164:167], a[248:251]
  v_mfma_f32_16x16x32_bf16 a[252:255], v[104:107], v[168:171], a[252:255]
L_g2_loop:
  s_sub_u32 s25, s25, 1
  s_cmp_eq_u32 s25, 0
  s_cbranch_scc1 L_g2_fin
  s_waitcnt lgkmcnt(0)
  v_mfma_f32_16x16x32_bf16 a[0:3], v[44:47], v[108:111], a[0:3]
  ds_read_b128 v[76:79], v19 offset:0
  v_mfma_f32_16x16x32_bf16 a[4:7], v[44:47], v[112:115], a[4:7]
  v_mfma_f32_16x16x32_bf16 a[8:11], v[44:47], v[116:119], a[8:11]
  ds_read_b64_tr_b16 v[140:141], v22 offset:49152
  v_mfma_f32_16x16x32_bf16 a[12:15], v[44:47], v[120:123], a[12:15]
  v_mfma_f32_16x16x32_bf16 a[16:19], v[44:47], v[124:127], a[16:19]
  ds_read_b64_tr_b16 v[142:143], v22 offset:51200
  v_mfma_f32_16x16x32_bf16 a[20:23], v[44:47], v[128:131], a[20:23]
  v_mfma_f32_16x16x32_bf16 a[24:27], v[44:47], v[132:135], a[24:27]
  ds_read_b128 v[80:83], v19 offset:2048
  v_mfma_f32_16x16x32_bf16 a[28:31], v[44:47], v[136:139], a[28:31]
  v_mfma_f32_16x16x32_bf16 a[32:35], v[48:51], v[108:111], a[32:35]
  ds_read_b64_tr_b16 v[144:145], v23 offset:49152
  v_mfma_f32_16x16x32_bf16 a[36:39], v[48:51], v[112:115], a[36:39]
  v_mfma_f32_16x16x32_bf16 a[40:43], v[48:51], v[116:119], a[40:43]
  ds_read_b64_tr_b16 v[146:147], v23 offset:51200
  v_mfma_f32_16x16x32_bf16 a[44:47], v[48:51], v[120:123], a[44:47]
  v_mfma_f32_16x16x32_bf16 a[48:51], v[48:51], v[124:127], a[48:51]
  ds_read_b128 v[84:87], v19 offset:4096
  v_mfma_f32_16x16x32_bf16 a[52:55], v[48:51], v[128:131], a[52:55]
  v_mfma_f32_16x16x32_bf16 a[56:59], v[48:51], v[132:135], a[56:59]
  ds_read_b64_tr_b16 v[148:149], v24 offset:49152
  v_mfma_f32_16x16x32_bf16 a[60:63], v[48:51], v[136:139], a[60:63]
  v_mfma_f32_16x16x32_bf16 a[64:67], v[52:55], v[108:111], a[64:67]
  ds_read_b64_tr_b16 v[150:151], v24 offset:51200
  v_mfma_f32_16x16x32_bf16 a[68:71], v[52:55], v[112:115], a[68:71]
  v_mfma_f32_16x16x32_bf16 a[72:75], v[52:55], v[116:119], a[72:75]
  ds_read_b128 v[88:91], v19 offset:6144
  v_mfma_f32_16x16x32_bf16 a[76:79], v[52:55], v[120:123], a[76:79]
  v_mfma_f32_16x16x32_bf16 a[80:83], v[52:55], v[124:127], a[80:83]
  ds_read_b64_tr_b16 v[152:153], v25 offset:49152
  v_mfma_f32_16x16x32_bf16 a[84:87], v[52:55], v[128:131], a[84:87]
  v_mfma_f32_16x16x32_bf16 a[88:91], v[52:55], v[132:135], a[88:91]
  ds_read_b64_tr_b16 v[154:155], v25 offset:51200
  v_mfma_f32_16x16x32_bf16 a[92:95], v[52:55], v[136:139], a[92:95]
  v_mfma_f32_16x16x32_bf16 a[96:99], v[56:59], v[108:111], a[96:99]
  ds_read_b128 v[92:95], v19 offset:8192
  v_mfma_f32_16x16x32_bf16 a[100:103], v[56:59], v[112:115], a[100:103]
  v_mfma_f32_16x16x32_bf16 a[104:107], v[56:59], v[116:119], a[104:107]
  ds_read_b64_tr_b16 v[156:157], v26 offset:49152
  v_mfma_f32_16x16x32_bf16 a[108:111], v[56:59], v[120:123], a[108:111]
  v_mfma_f32_16x16x32_bf16 a[112:115], v[56:59], v[124:127], a[112:115]
  ds_read_b64_tr_b16 v[158:159], v26 offset:51200
  v_mfma_f32_16x16x32_bf16 a[116:119], v[56:59], v[128:131], a[116:119]
  v_mfma_f32_16x16x32_bf16 a[120:123], v[56:59], v[132:135], a[120:123]
  ds_read_b128 v[96:99], v19 offset:10240
  v_mfma_f32_16x16x32_bf16 a[124:127], v[56:59], v[136:139], a[124:127]
  v_mfma_f32_16x16x32_bf16 a[128:131], v[60:63], v[108:111], a[128:131]
  ds_read_b64_tr_b16 v[160:161], v27 offset:49152
  v_mfma_f32_16x16x32_bf16 a[132:135], v[60:63], v[112:115], a[132:135]
  v_mfma_f32_16x16x32_bf16 a[136:139], v[60:63], v[116:119], a[136:139]
  ds_read_b64_tr_b16 v[162:163], v27 offset:51200
  v_mfma_f32_16x16x32_bf16 a[140:143], v[60:63], v[120:123], a[140:143]
  v_mfma_f32_16x16x32_bf16 a[144:147], v[60:63], v[124:127], a[144:147]
  ds_read_b128 v[100:103], v19 offset:12288
  v_mfma_f32_16x16x32_bf16 a[148:151], v[60:63], v[128:131], a[148:151]
  v_mfma_f32_16x16x32_bf16 a[152:155], v[60:63], v[132:135], a[152:155]
  ds_read_b64_tr_b16 v[164:165], v28 offset:49152
  v_mfma_f32_16x16x32_bf16 a[156:159], v[60:63], v[136:139], a[156:159]
  v_mfma_f32_16x16x32_bf16 a[160:163], v[64:67], v[108:111], a[160:163]
  ds_read_b64_tr_b16 v[166:167], v28 offset:51200
  v_mfma_f32_16x16x32_bf16 a[164:167], v[64:67], v[112:115], a[164:167]
  v_mfma_f32_16x16x32_bf16 a[168:171], v[64:67], v[116:119], a[168:171]
  ds_read_b128 v[104:107], v19 offset:14336
  v_mfma_f32_16x16x32_bf16 a[172:175], v[64:67], v[120:123], a[172:175]
  v_mfma_f32_16x16x32_bf16 a[176:179], v[64:67], v[124:127], a[176:179]
  ds_read_b64_tr_b16 v[168:169], v29 offset:49152
  v_mfma_f32_16x16x32_bf16 a[180:183], v[64:67], v[128:131], a[180:183]
  v_mfma_f32_16x16x32_bf16 a[184:187], v[64:67], v[132:135], a[184:187]
  ds_read_b64_tr_b16 v[170:171], v29 offset:51200
  v_mfma_f32_16x16x32_bf16 a[188:191], v[64:67], v[136:139], a[188:191]
  v_mfma_f32_16x16x32_bf16 a[192:195], v[68:71], v[108:111], a[192:195]
  v_mfma_f32_16x16x32_bf16 a[196:199], v[68:71], v[112:115], a[196:199]
  v_mfma_f32_16x16x32_bf16 a[200:203], v[68:71], v[116:119], a[200:203]
  v_mfma_f32_16x16x32_bf16 a[204:207], v[68:71], v[120:123], a[204:207]
  v_mfma_f32_16x16x32_bf16 a[208:211], v[68:71], v[124:127], a[208:211]
  v_mfma_f32_16x16x32_bf16 a[212:215], v[68:71], v[128:131], a[212:215]
  v_mfma_f32_16x16x32_bf16 a[216:219], v[68:71], v[132:135], a[216:219]
  v_mfma_f32_16x16x32_bf16 a[220:223], v[68:71], v[136:139], a[220:223]
  v_mfma_f32_16x16x32_bf16 a[224:227], v[72:75], v[108:111], a[224:227]
  v_mfma_f32_16x16x32_bf16 a[228:231], v[72:75], v[112:115], a[228:231]
  v_mfma_f32_16x16x32_bf16 a[232:235], v[72:75], v[116:119], a[232:235]
  v_mfma_f32_16x16x32_bf16 a[236:239], v[72:75], v[120:123], a[236:239]
  v_mfma_f32_16x16x32_bf16 a[240:243], v[72:75], v[124:127], a[240:243]
  v_mfma_f32_16x16x32_bf16 a[244:247], v[72:75], v[128:131], a[244:247]
  v_mfma_f32_16x16x32_bf16 a[248:251], v[72:75], v[132:135], a[248:251]
  v_mfma_f32_16x16x32_bf16 a[252:255], v[72:75], v[136:139], a[252:255]
  s_waitcnt lgkmcnt(0)
  v_mfma_f32_16x16x32_bf16 a[0:3], v[76:79], v[140:143], a[0:3]
  s_waitcnt vmcnt(0)
  s_barrier
  s_add_u32 m0, s52, 0
  v_mfma_f32_16x16x32_bf16 a[4:7], v[76:79], v[144:147], a[4:7]
  buffer_load_dwordx4 v2, s[8:11], s20 offen  lds
  ds_read_b128 v[44:47], v20 offset:0
  v_mfma_f32_16x16x32_bf16 a[8:11], v[76:79], v[148:151], a[8:11]
  v_mfma_f32_16x16x32_bf16 a[12:15], v[76:79], v[152:155], a[12:15]
  ds_read_b64_tr_b16 v[108:109], v30 offset:32768
  s_add_u32 m0, s53, 0
  v_mfma_f32_16x16x32_bf16 a[16:19], v[76:79], v[156:159], a[16:19]
  buffer_load_dwordx4 v10, s[12:15], s21 offen  lds
  v_mfma_f32_16x16x32_bf16 a[20:23], v[76:79], v[160:163], a[20:23]
  ds_read_b64_tr_b16 v[110:111], v30 offset:34816
  v_mfma_f32_16x16x32_bf16 a[24:27], v[76:79], v[164:167], a[24:27]
  v_mfma_f32_16x16x32_bf16 a[28:31], v[76:79], v[168:171], a[28:31]
  ds_read_b128 v[48:51], v20 offset:2048
  s_add_u32 m0, s52, 1024
  v_mfma_f32_16x16x32_bf16 a[32:35], v[80:83], v[140:143], a[32:35]
  buffer_load_dwordx4 v3, s[8:11], s20 offen  lds
  v_mfma_f32_16x16x32_bf16 a[36:39], v[80:83], v[144:147], a[36:39]
  ds_read_b64_tr_b16 v[112:113], v31 offset:32768
  v_mfma_f32_16x16x32_bf16 a[40:43], v[80:83], v[148:151], a[40:43]
  v_mfma_f32_16x16x32_bf16 a[44:47], v[80:83], v[152:155], a[44:47]
  ds_read_b64_tr_b16 v[114:115], v31 offset:34816
  s_add_u32 m0, s53, 1024
  v_mfma_f32_16x16x32_bf16 a[48:51], v[80:83], v[156:159], a[48:51]
  buffer_load_dwordx4 v11, s[12:15], s21 offen  lds
  v_mfma_f32_16x16x32_bf16 a[52:55], v[80:83], v[160:163], a[52:55]
  ds_read_b128 v[52:55], v20 offset:4096
  v_mfma_f32_16x16x32_bf16 a[56:59], v[80:83], v[164:167], a[56:59]
  s_add_u32 m0, s52, 2048
  v_mfma_f32_16x16x32_bf16 a[60:63], v[80:83], v[168:171], a[60:63]
  buffer_load_dwordx4 v4, s[8:11], s20 offen  lds
  ds_read_b64_tr_b16 v[116:117], v32 offset:32768
  v_mfma_f32_16x16x32_bf16 a[64:67], v[84:87], v[140:143], a[64:67]
  v_mfma_f32_16x16x32_bf16 a[68:71], v[84:87], v[144:147], a[68:71]
  ds_read_b64_tr_b16 v[118:119], v32 offset:34816
  v_mfma_f32_16x16x32_bf16 a[72:75], v[84:87], v[148:151], a[72:75]
  s_add_u32 m0, s53, 2048
  v_mfma_f32_16x16x32_bf16 a[76:79], v[84:87], v[152:155], a[76:79]
  buffer_load_dwordx4 v12, s[12:15], s21 offen  lds
  ds_read_b128 v[56:59], v20 offset:6144
  v_mfma_f32_16x16x32_bf16 a[80:83], v[84:87], v[156:159], a[80:83]
  v_mfma_f32_16x16x32_bf16 a[84:87], v[84:87], v[160:163], a[84:87]
  ds_read_b64_tr_b16 v[120:121], v33 offset:32768
  v_mfma_f32_16x16x32_bf16 a[88:91], v[84:87], v[164:167], a[88:91]
  s_add_u32 m0, s52, 3072
  v_mfma_f32_16x16x32_bf16 a[92:95], v[84:87], v[168:171], a[92:95]
  buffer_load_dwordx4 v5, s[8:11], s20 offen  lds
  ds_read_b64_tr_b16 v[122:123], v33 offset:34816
  v_mfma_f32_16x16x32_bf16 a[96:99], v[88:91], v[140:143], a[96:99]
  v_mfma_f32_16x16x32_bf16 a[100:103], v[88:91], v[144:147], a[100:103]
  ds_read_b128 v[60:63], v20 offset:8192
  s_add_u32 m0, s53, 3072
  v_mfma_f32_16x16x32_bf16 a[104:107], v[88:91], v[148:151], a[104:107]
  buffer_load_dwordx4 v13, s[12:15], s21 offen  lds
  v_mfma_f32_16x16x32_bf16 a[108:111], v[88:91], v[152:155], a[108:111]
  ds_read_b64_tr_b16 v[124:125], v34 offset:32768
  v_mfma_f32_16x16x32_bf16 a[112:115], v[88:91], v[156:159], a[112:115]
  v_mfma_f32_16x16x32_bf16 a[116:119], v[88:91], v[160:163], a[116:119]
  ds_read_b64_tr_b16 v[126:127], v34 offset:34816
  s_add_u32 m0, s52, 4096
  v_mfma_f32_16x16x32_bf16 a[120:123], v[88:91], v[164:167], a[120:123]
  buffer_load_dwordx4 v6, s[8:11], s20 offen  lds
  v_mfma_f32_16x16x32_bf16 a[124:127], v[88:91], v[168:171], a[124:127]
  ds_read_b128 v[64:67], v20 offset:10240
  v_mfma_f32_16x16x32_bf16 a[128:131], v[92:95], v[140:143], a[128:131]
  v_mfma_f32_16x16x32_bf16 a[132:135], v[92:95], v[144:147], a[132:135]
  ds_read_b64_tr_b16 v[128:129], v35 offset:32768
  s_add_u32 m0, s53, 4096
  v_mfma_f32_16x16x32_bf16 a[136:139], v[92:95], v[148:151], a[136:139]
  buffer_load_dwordx4 v14, s[12:15], s21 offen  lds
  v_mfma_f32_16x16x32_bf16 a[140:143], v[92:95], v[152:155], a[140:143]
  ds_read_b64_tr_b16 v[130:131], v35 offset:34816
  v_mfma_f32_16x16x32_bf16 a[144:147], v[92:95], v[156:159], a[144:147]
  v_mfma_f32_16x16x32_bf16 a[148:151], v[92:95], v[160:163], a[148:151]
  ds_read_b128 v[68:71], v20 offset:12288
  s_add_u32 m0, s52, 5120
  v_mfma_f32_16x16x32_bf16 a[152:155], v[92:95], v[164:167], a[152:155]
  buffer_load_dwordx4 v7, s[8:11], s20 offen  lds
  v_mfma_f32_16x16x32_bf16 a[156:159], v[92:95], v[168:171], a[156:159]
  ds_read_b64_tr_b16 v[132:133], v36 offset:32768
  v_mfma_f32_16x16x32_bf16 a[160:163], v[96:99], v[140:143], a[160:163]
  s_add_u32 m0, s53, 5120
  v_mfma_f32_16x16x32_bf16 a[164:167], v[96:99], v[144:147], a[164:167]
  buffer_load_dwordx4 v15, s[12:15], s21 offen  lds
  ds_read_b64_tr_b16 v[134:135], v36 offset:34816
  v_mfma_f32_16x16x32_bf16 a[168:171], v[96:99], v[148:151], a[168:171]
  v_mfma_f32_16x16x32_bf16 a[172:175], v[96:99], v[152:155], a[172:175]
  ds_read_b128 v[72:75], v20 offset:14336
  v_mfma_f32_16x16x32_bf16 a[176:179], v[96:99], v[156:159], a[176:179]
  s_add_u32 m0, s52, 6144
  v_mfma_f32_16x16x32_bf16 a[180:183], v[96:99], v[160:163], a[180:183]
  buffer_load_dwordx4 v8, s[8:11], s20 offen  lds
  ds_read_b64_tr_b16 v[136:137], v37 offset:32768
  v_mfma_f32_16x16x32_bf16 a[184:187], v[96:99], v[164:167], a[184:187]
  v_mfma_f32_16x16x32_bf16 a[188:191], v[96:99], v[168:171], a[188:191]
  ds_read_b64_tr_b16 v[138:139], v37 offset:34816
  v_mfma_f32_16x16x32_bf16 a[192:195], v[100:103], v[140:143], a[192:195]
  s_add_u32 m0, s53, 6144
  v_mfma_f32_16x16x32_bf16 a[196:199], v[100:103], v[144:147], a[196:199]
  buffer_load_dwordx4 v16, s[12:15], s21 offen  lds
  v_mfma_f32_16x16x32_bf16 a[200:203], v[100:103], v[148:151], a[200:203]
  v_mfma_f32_16x16x32_bf16 a[204:207], v[100:103], v[152:155], a[204:207]
  s_add_u32 m0, s52, 7168
  v_mfma_f32_16x16x32_bf16 a[208:211], v[100:103], v[156:159], a[208:211]
  buffer_load_dwordx4 v9, s[8:11], s20 offen  lds
  v_mfma_f32_16x16x32_bf16 a[212:215], v[100:103], v[160:163], a[212:215]
  v_mfma_f32_16x16x32_bf16 a[216:219], v[100:103], v[164:167], a[216:219]
  v_mfma_f32_16x16x32_bf16 a[220:223], v[100:103], v[168:171], a[220:223]
  s_add_u32 m0, s53, 7168
  v_mfma_f32_16x16x32_bf16 a[224:227], v[104:107], v[140:143], a[224:227]
  buffer_load_dwordx4 v17, s[12:15], s21 offen  lds
  v_mfma_f32_16x16x32_bf16 a[228:231], v[104:107], v[144:147], a[228:231]
  v_mfma_f32_16x16x32_bf16 a[232:235], v[104:107], v[148:151], a[232:235]
  v_mfma_f32_16x16x32_bf16 a[236:239], v[104:107], v[152:155], a[236:239]
  s_add_u32 s20, s20, 128
  v_mfma_f32_16x16x32_bf16 a[240:243], v[104:107], v[156:159], a[240:243]
  s_add_u32 s21, s21, s51
  v_mfma_f32_16x16x32_bf16 a[244:247], v[104:107], v[160:163], a[244:247]
  v_mfma_f32_16x16x32_bf16 a[248:251], v[104:107], v[164:167], a[248:251]
  v_mfma_f32_16x16x32_bf16 a[252:255], v[104:107], v[168:171], a[252:255]
  s_waitcnt lgkmcnt(0)
  s_cmp_eq_u32 s25, 1
  s_cbranch_scc1 L_g2_cw
L_g2_cwb:
  v_mfma_f32_16x16x32_bf16 a[0:3], v[44:47], v[108:111], a[0:3]
  ds_read_b128 v[76:79], v21 offset:0
  v_mfma_f32_16x16x32_bf16 a[4:7], v[44:47], v[112:115], a[4:7]
  v_mfma_f32_16x16x32_bf16 a[8:11], v[44:47], v[116:119], a[8:11]
  ds_read_b64_tr_b16 v[140:141], v30 offset:49152
  v_mfma_f32_16x16x32_bf16 a[12:15], v[44:47], v[120:123], a[12:15]
  v_mfma_f32_16x16x32_bf16 a[16:19], v[44:47], v[124:127], a[16:19]
  ds_read_b64_tr_b16 v[142:143], v30 offset:51200
  v_mfma_f32_16x16x32_bf16 a[20:23], v[44:47], v[128:131], a[20:23]
  v_mfma_f32_16x16x32_bf16 a[24:27], v[44:47], v[132:135], a[24:27]
  ds_read_b128 v[80:83], v21 offset:2048
  v_mfma_f32_16x16x32_bf16 a[28:31], v[44:47], v[136:139], a[28:31]
  v_mfma_f32_16x16x32_bf16 a[32:35], v[48:51], v[108:111], a[32:35]
  ds_read_b64_tr_b16 v[144:145], v31 offset:49152
  v_mfma_f32_16x16x32_bf16 a[36:39], v[48:51], v[112:115], a[36:39]
  v_mfma_f32_16x16x32_bf16 a[40:43], v[48:51], v[116:119], a[40:43]
  ds_read_b64_tr_b16 v[146:147], v31 offset:51200
  v_mfma_f32_16x16x32_bf16 a[44:47], v[48:51], v[120:123], a[44:47]
  v_mfma_f32_16x16x32_bf16 a[48:51], v[48:51], v[124:127], a[48:51]
  ds_read_b128 v[84:87], v21 offset:4096
  v_mfma_f32_16x16x32_bf16 a[52:55], v[48:51], v[128:131], a[52:55]
  v_mfma_f32_16x16x32_bf16 a[56:59], v[48:51], v[132:135], a[56:59]
  ds_read_b64_tr_b16 v[148:149], v32 offset:49152
  v_mfma_f32_16x16x32_bf16 a[60:63], v[48:51], v[136:139], a[60:63]
  v_mfma_f32_16x16x32_bf16 a[64:67], v[52:55], v[108:111], a[64:67]
  ds_read_b64_tr_b16 v[150:151], v32 offset:51200
  v_mfma_f32_16x16x32_bf16 a[68:71], v[52:55], v[112:115], a[68:71]
  v_mfma_f32_16x16x32_bf16 a[72:75], v[52:55], v[116:119], a[72:75]
  ds_read_b128 v[88:91], v21 offset:6144
  v_mfma_f32_16x16x32_bf16 a[76:79], v[52:55], v[120:123], a[76:79]
  v_mfma_f32_16x16x32_bf16 a[80:83], v[52:55], v[124:127], a[80:83]
  ds_read_b64_tr_b16 v[152:153], v33 offset:49152
  v_mfma_f32_16x16x32_bf16 a[84:87], v[52:55], v[128:131], a[84:87]
  v_mfma_f32_16x16x32_bf16 a[88:91], v[52:55], v[132:135], a[88:91]
  ds_read_b64_tr_b16 v[154:155], v33 offset:51200
  v_mfma_f32_16x16x32_bf16 a[92:95], v[52:55], v[136:139], a[92:95]
  v_mfma_f32_16x16x32_bf16 a[96:99], v[56:59], v[108:111], a[96:99]
  ds_read_b128 v[92:95], v21 offset:8192
  v_mfma_f32_16x16x32_bf16 a[100:103], v[56:59], v[112:115], a[100:103]
  v_mfma_f32_16x16x32_bf16 a[104:107], v[56:59], v[116:119], a[104:107]
  ds_read_b64_tr_b16 v[156:157], v34 offset:49152
  v_mfma_f32_16x16x32_bf16 a[108:111], v[56:59], v[120:123], a[108:111]
  v_mfma_f32_16x16x32_bf16 a[112:115], v[56:59], v[124:127], a[112:115]
  ds_read_b64_tr_b16 v[158:159], v34 offset:51200
  v_mfma_f32_16x16x32_bf16 a[116:119], v[56:59], v[128:131], a[116:119]
  v_mfma_f32_16x16x32_bf16 a[120:123], v[56:59], v[132:135], a[120:123]
  ds_read_b128 v[96:99], v21 offset:10240
  v_mfma_f32_16x16x32_bf16 a[124:127], v[56:59], v[136:139], a[124:127]
  v_mfma_f32_16x16x32_bf16 a[128:131], v[60:63], v[108:111], a[128:131]
  ds_read_b64_tr_b16 v[160:161], v35 offset:49152
  v_mfma_f32_16x16x32_bf16 a[132:135], v[60:63], v[112:115], a[132:135]
  v_mfma_f32_16x16x32_bf16 a[136:139], v[60:63], v[116:119], a[136:139]
  ds_read_b64_tr_b16 v[162:163], v35 offset:51200
  v_mfma_f32_16x16x32_bf16 a[140:143], v[60:63], v[120:123], a[140:143]
  v_mfma_f32_16x16x32_bf16 a[144:147], v[60:63], v[124:127], a[144:147]
  ds_read_b128 v[100:103], v21 offset:12288
  v_mfma_f32_16x16x32_bf16 a[148:151], v[60:63], v[128:131], a[148:151]
  v_mfma_f32_16x16x32_bf16 a[152:155], v[60:63], v[132:135], a[152:155]
  ds_read_b64_tr_b16 v[164:165], v36 offset:49152
  v_mfma_f32_16x16x32_bf16 a[156:159], v[60:63], v[136:139], a[156:159]
  v_mfma_f32_16x16x32_bf16 a[160:163], v[64:67], v[108:111], a[160:163]
  ds_read_b64_tr_b16 v[166:167], v36 offset:51200
  v_mfma_f32_16x16x32_bf16 a[164:167], v[64:67], v[112:115], a[164:167]
  v_mfma_f32_16x16x32_bf16 a[168:171], v[64:67], v[116:119], a[168:171]
  ds_read_b128 v[104:107], v21 offset:14336
  v_mfma_f32_16x16x32_bf16 a[172:175], v[64:67], v[120:123], a[172:175]
  v_mfma_f32_16x16x32_bf16 a[176:179], v[64:67], v[124:127], a[176:179]
  ds_read_b64_tr_b16 v[168:169], v37 offset:49152
  v_mfma_f32_16x16x32_bf16 a[180:183], v[64:67], v[128:131], a[180:183]
  v_mfma_f32_16x16x32_bf16 a[184:187], v[64:67], v[132:135], a[184:187]
  ds_read_b64_tr_b16 v[170:171], v37 offset:51200
  v_mfma_f32_16x16x32_bf16 a[188:191], v[64:67], v[136:139], a[188:191]
  v_mfma_f32_16x16x32_bf16 a[192:195], v[68:71], v[108:111], a[192:195]
  v_mfma_f32_16x16x32_bf16 a[196:199], v[68:71], v[112:115], a[196:199]
  v_mfma_f32_16x16x32_bf16 a[200:203], v[68:71], v[116:119], a[200:203]
  v_mfma_f32_16x16x32_bf16 a[204:207], v[68:71], v[120:123], a[204:207]
  v_mfma_f32_16x16x32_bf16 a[208:211], v[68:71], v[124:127], a[208:211]
  v_mfma_f32_16x16x32_bf16 a[212:215], v[68:71], v[128:131], a[212:215]
  v_mfma_f32_16x16x32_bf16 a[216:219], v[68:71], v[132:135], a[216:219]
  v_mfma_f32_16x16x32_bf16 a[220:223], v[68:71], v[136:139], a[220:223]
  v_mfma_f32_16x16x32_bf16 a[224:227], v[72:75], v[108:111], a[224:227]
  v_mfma_f32_16x16x32_bf16 a[228:231], v[72:75], v[112:115], a[228:231]
  v_mfma_f32_16x16x32_bf16 a[232:235], v[72:75], v[116:119], a[232:235]
  v_mfma_f32_16x16x32_bf16 a[236:239], v[72:75], v[120:123], a[236:239]
  v_mfma_f32_16x16x32_bf16 a[240:243], v[72:75], v[124:127], a[240:243]
  v_mfma_f32_16x16x32_bf16 a[244:247], v[72:75], v[128:131], a[244:247]
  v_mfma_f32_16x16x32_bf16 a[248:251], v[72:75], v[132:135], a[248:251]
  v_mfma_f32_16x16x32_bf16 a[252:255], v[72:75], v[136:139], a[252:255]
  s_waitcnt lgkmcnt(0)
  v_mfma_f32_16x16x32_bf16 a[0:3], v[76:79], v[140:143], a[0:3]
  s_waitcnt vmcnt(0)
  s_barrier
  s_cmp_le_u32 s25, 2
  s_cbranch_scc1 L_g2_cr
L_g2_crb:
  s_add_u32 m0, s52, 65536
  v_mfma_f32_16x16x32_bf16 a[4:7], v[76:79], v[144:147], a[4:7]
  buffer_load_dwordx4 v2, s[8:11], s20 offen  lds
  ds_read_b128 v[44:47], v18 offset:0
  v_mfma_f32_16x16x32_bf16 a[8:11], v[76:79], v[148:151], a[8:11]
  v_mfma_f32_16x16x32_bf16 a[12:15], v[76:79], v[152:155], a[12:15]
  ds_read_b64_tr_b16 v[108:109], v22 offset:32768
  s_add_u32 m0, s53, 65536
  v_mfma_f32_16x16x32_bf16 a[16:19], v[76:79], v[156:159], a[16:19]
  buffer_load_dwordx4 v10, s[12:15], s21 offen  lds
  v_mfma_f32_16x16x32_bf16 a[20:23], v[76:79], v[160:163], a[20:23]
  ds_read_b64_tr_b16 v[110:111], v22 offset:34816
  v_mfma_f32_16x16x32_bf16 a[24:27], v[76:79], v[164:167], a[24:27]
  v_mfma_f32_16x16x32_bf16 a[28:31], v[76:79], v[168:171], a[28:31]
  ds_read_b128 v[48:51], v18 offset:2048
  s_add_u32 m0, s52, 66560
  v_mfma_f32_16x16x32_bf16 a[32:35], v[80:83], v[140:143], a[32:35]
  buffer_load_dwordx4 v3, s[8:11], s20 offen  lds
  v_mfma_f32_16x16x32_bf16 a[36:39], v[80:83], v[144:147], a[36:39]
  ds_read_b64_tr_b16 v[112:113], v23 offset:32768
  v_mfma_f32_16x16x32_bf16 a[40:43], v[80:83], v[148:151], a[40:43]
  v_mfma_f32_16x16x32_bf16 a[44:47], v[80:83], v[152:155], a[44:47]
  ds_read_b64_tr_b16 v[114:115], v23 offset:34816
  s_add_u32 m0, s53, 66560
  v_mfma_f32_16x16x32_bf16 a[48:51], v[80:83], v[156:159], a[48:51]
  buffer_load_dwordx4 v11, s[12:15], s21 offen  lds
  v_mfma_f32_16x16x32_bf16 a[52:55], v[80:83], v[160:163], a[52:55]
  ds_read_b128 v[52:55], v18 offset:4096
  v_mfma_f32_16x16x32_bf16 a[56:59], v[80:83], v[164:167], a[56:59]
  s_add_u32 m0, s52, 67584
  v_mfma_f32_16x16x32_bf16 a[60:63], v[80:83], v[168:171], a[60:63]
  buffer_load_dwordx4 v4, s[8:11], s20 offen  lds
  ds_read_b64_tr_b16 v[116:117], v24 offset:32768
  v_mfma_f32_16x16x32_bf16 a[64:67], v[84:87], v[140:143], a[64:67]
  v_mfma_f32_16x16x32_bf16 a[68:71], v[84:87], v[144:147], a[68:71]
  ds_read_b64_tr_b16 v[118:119], v24 offset:34816
  v_mfma_f32_16x16x32_bf16 a[72:75], v[84:87], v[148:151], a[72:75]
  s_add_u32 m0, s53, 67584
  v_mfma_f32_16x16x32_bf16 a[76:79], v[84:87], v[152:155], a[76:79]
  buffer_load_dwordx4 v12, s[12:15], s21 offen  lds
  ds_read_b128 v[56:59], v18 offset:6144
  v_mfma_f32_16x16x32_bf16 a[80:83], v[84:87], v[156:159], a[80:83]
  v_mfma_f32_16x16x32_bf16 a[84:87], v[84:87], v[160:163], a[84:87]
  ds_read_b64_tr_b16 v[120:121], v25 offset:32768
  v_mfma_f32_16x16x32_bf16 a[88:91], v[84:87], v[164:167], a[88:91]
  s_add_u32 m0, s52, 68608
  v_mfma_f32_16x16x32_bf16 a[92:95], v[84:87], v[168:171], a[92:95]
  buffer_load_dwordx4 v5, s[8:11], s20 offen  lds
  ds_read_b64_tr_b16 v[122:123], v25 offset:34816
  v_mfma_f32_16x16x32_bf16 a[96:99], v[88:91], v[140:143], a[96:99]
  v_mfma_f32_16x16x32_bf16 a[100:103], v[88:91], v[144:147], a[100:103]
  ds_read_b128 v[60:63], v18 offset:8192
  s_add_u32 m0, s53, 68608
  v_mfma_f32_16x16x32_bf16 a[104:107], v[88:91], v[148:151], a[104:107]
  buffer_load_dwordx4 v13, s[12:15], s21 offen  lds
  v_mfma_f32_16x16x32_bf16 a[108:111], v[88:91], v[152:155], a[108:111]
  ds_read_b64_tr_b16 v[124:125], v26 offset:32768
  v_mfma_f32_16x16x32_bf16 a[112:115], v[88:91], v[156:159], a[112:115]
  v_mfma_f32_16x16x32_bf16 a[116:119], v[88:91], v[160:163], a[116:119]
  ds_read_b64_tr_b16 v[126:127], v26 offset:34816
  s_add_u32 m0, s52, 69632
  v_mfma_f32_16x16x32_bf16 a[120:123], v[88:91], v[164:167], a[120:123]
  buffer_load_dwordx4 v6, s[8:11], s20 offen  lds
  v_mfma_f32_16x16x32_bf16 a[124:127], v[88:91], v[168:171], a[124:127]
  ds_read_b128 v[64:67], v18 offset:10240
  v_mfma_f32_16x16x32_bf16 a[128:131], v[92:95], v[140:143], a[128:131]
  v_mfma_f32_16x16x32_bf16 a[132:135], v[92:95], v[144:147], a[132:135]
  ds_read_b64_tr_b16 v[128:129], v27 offset:32768
  s_add_u32 m0, s53, 69632
  v_mfma_f32_16x16x32_bf16 a[136:139], v[92:95], v[148:151], a[136:139]
  buffer_load_dwordx4 v14, s[12:15], s21 offen  lds
  v_mfma_f32_16x16x32_bf16 a[140:143], v[92:95], v[152:155], a[140:143]
  ds_read_b64_tr_b16 v[130:131], v27 offset:34816
  v_mfma_f32_16x16x32_bf16 a[144:147], v[92:95], v[156:159], a[144:147]
  v_mfma_f32_16x16x32_bf16 a[148:151], v[92:95], v[160:163], a[148:151]
  ds_read_b128 v[68:71], v18 offset:12288
  s_add_u32 m0, s52, 70656
  v_mfma_f32_16x16x32_bf16 a[152:155], v[92:95], v[164:167], a[152:155]
  buffer_load_dwordx4 v7, s[8:11], s20 offen  lds
  v_mfma_f32_16x16x32_bf16 a[156:159], v[92:95], v[168:171], a[156:159]
  ds_read_b64_tr_b16 v[132:133], v28 offset:32768
  v_mfma_f32_16x16x32_bf16 a[160:163], v[96:99], v[140:143], a[160:163]
  s_add_u32 m0, s53, 70656
  v_mfma_f32_16x16x32_bf16 a[164:167], v[96:99], v[144:147], a[164:167]
  buffer_load_dwordx4 v15, s[12:15], s21 offen  lds
  ds_read_b64_tr_b16 v[134:135], v28 offset:34816
  v_mfma_f32_16x16x32_bf16 a[168:171], v[96:99], v[148:151], a[168:171]
  v_mfma_f32_16x16x32_bf16 a[172:175], v[96:99], v[152:155], a[172:175]
  ds_read_b128 v[72:75], v18 offset:14336
  v_mfma_f32_16x16x32_bf16 a[176:179], v[96:99], v[156:159], a[176:179]
  s_add_u32 m0, s52, 71680
  v_mfma_f32_16x16x32_bf16 a[180:183], v[96:99], v[160:163], a[180:183]
  buffer_load_dwordx4 v8, s[8:11], s20 offen  lds
  ds_read_b64_tr_b16 v[136:137], v29 offset:32768
  v_mfma_f32_16x16x32_bf16 a[184:187], v[96:99], v[164:167], a[184:187]
  v_mfma_f32_16x16x32_bf16 a[188:191], v[96:99], v[168:171], a[188:191]
  ds_read_b64_tr_b16 v[138:139], v29 offset:34816
  v_mfma_f32_16x16x32_bf16 a[192:195], v[100:103], v[140:143], a[192:195]
  s_add_u32 m0, s53, 71680
  v_mfma_f32_16x16x32_bf16 a[196:199], v[100:103], v[144:147], a[196:199]
  buffer_load_dwordx4 v16, s[12:15], s21 offen  lds
  v_mfma_f32_16x16x32_bf16 a[200:203], v[100:103], v[148:151], a[200:203]
  v_mfma_f32_16x16x32_bf16 a[204:207], v[100:103], v[152:155], a[204:207]
  s_add_u32 m0, s52, 72704
  v_mfma_f32_16x16x32_bf16 a[208:211], v[100:103], v[156:159], a[208:211]
  buffer_load_dwordx4 v9, s[8:11], s20 offen  lds
  v_mfma_f32_16x16x32_bf16 a[212:215], v[100:103], v[160:163], a[212:215]
  v_mfma_f32_16x16x32_bf16 a[216:219], v[100:103], v[164:167], a[216:219]
  v_mfma_f32_16x16x32_bf16 a[220:223], v[100:103], v[168:171], a[220:223]
  s_add_u32 m0, s53, 72704
  v_mfma_f32_16x16x32_bf16 a[224:227], v[104:107], v[140:143], a[224:227]
  buffer_load_dwordx4 v17, s[12:15], s21 offen  lds
  v_mfma_f32_16x16x32_bf16 a[228:231], v[104:107], v[144:147], a[228:231]
  v_mfma_f32_16x16x32_bf16 a[232:235], v[104:107], v[148:151], a[232:235]
  v_mfma_f32_16x16x32_bf16 a[236:239], v[104:107], v[152:155], a[236:239]
  s_add_u32 s20, s20, 128
  v_mfma_f32_16x16x32_bf16 a[240:243], v[104:107], v[156:159], a[240:243]
  s_add_u32 s21, s21, s51
  v_mfma_f32_16x16x32_bf16 a[244:247], v[104:107], v[160:163], a[244:247]
  v_mfma_f32_16x16x32_bf16 a[248:251], v[104:107], v[164:167], a[248:251]
  v_mfma_f32_16x16x32_bf16 a[252:255], v[104:107], v[168:171], a[252:255]
  s_branch L_g2_loop
L_g2_fin:
  s_mov_b32 s59, 2
  s_mov_b32 s60, s22
  s_mov_b32 s61, s26
  s_add_u32 s62, s38, 0x3d00000
  s_mov_b32 s63, s98
  s_waitcnt lgkmcnt(0)
  v_min_u32 v245, 270, v246
  v_lshlrev_b32 v245, 2, v245
  v_add_u32 v245, 147648, v245
  ds_read_b32 v245, v245
  v_readfirstlane_b32 s34, v246
  s_add_u32 s34, s34, 32
  v_mfma_f32_16x16x32_bf16 a[0:3], v[44:47], v[108:111], a[0:3]
  ds_read_b128 v[76:79], v19 offset:0
  v_mfma_f32_16x16x32_bf16 a[4:7], v[44:47], v[112:115], a[4:7]
  v_mfma_f32_16x16x32_bf16 a[8:11], v[44:47], v[116:119], a[8:11]
  ds_read_b64_tr_b16 v[140:141], v22 offset:49152
  v_mfma_f32_16x16x32_bf16 a[12:15], v[44:47], v[120:123], a[12:15]
  v_mfma_f32_16x16x32_bf16 a[16:19], v[44:47], v[124:127], a[16:19]
  ds_read_b64_tr_b16 v[142:143], v22 offset:51200
  v_mfma_f32_16x16x32_bf16 a[20:23], v[44:47], v[128:131], a[20:23]
  v_mfma_f32_16x16x32_bf16 a[24:27], v[44:47], v[132:135], a[24:27]
  ds_read_b128 v[80:83], v19 offset:2048
  v_mfma_f32_16x16x32_bf16 a[28:31], v[44:47], v[136:139], a[28:31]
  v_mfma_f32_16x16x32_bf16 a[32:35], v[48:51], v[108:111], a[32:35]
  ds_read_b64_tr_b16 v[144:145], v23 offset:49152
  v_mfma_f32_16x16x32_bf16 a[36:39], v[48:51], v[112:115], a[36:39]
  v_mfma_f32_16x16x32_bf16 a[40:43], v[48:51], v[116:119], a[40:43]
  ds_read_b64_tr_b16 v[146:147], v23 offset:51200
  v_mfma_f32_16x16x32_bf16 a[44:47], v[48:51], v[120:123], a[44:47]
  v_mfma_f32_16x16x32_bf16 a[48:51], v[48:51], v[124:127], a[48:51]
  ds_read_b128 v[84:87], v19 offset:4096
  v_mfma_f32_16x16x32_bf16 a[52:55], v[48:51], v[128:131], a[52:55]
  v_mfma_f32_16x16x32_bf16 a[56:59], v[48:51], v[132:135], a[56:59]
  ds_read_b64_tr_b16 v[148:149], v24 offset:49152
  v_mfma_f32_16x16x32_bf16 a[60:63], v[48:51], v[136:139], a[60:63]
  v_mfma_f32_16x16x32_bf16 a[64:67], v[52:55], v[108:111], a[64:67]
  ds_read_b64_tr_b16 v[150:151], v24 offset:51200
  v_mfma_f32_16x16x32_bf16 a[68:71], v[52:55], v[112:115], a[68:71]
  v_mfma_f32_16x16x32_bf16 a[72:75], v[52:55], v[116:119], a[72:75]
  ds_read_b128 v[88:91], v19 offset:6144
  v_mfma_f32_16x16x32_bf16 a[76:79], v[52:55], v[120:123], a[76:79]
  v_mfma_f32_16x16x32_bf16 a[80:83], v[52:55], v[124:127], a[80:83]
  ds_read_b64_tr_b16 v[152:153], v25 offset:49152
  v_mfma_f32_16x16x32_bf16 a[84:87], v[52:55], v[128:131], a[84:87]
  v_mfma_f32_16x16x32_bf16 a[88:91], v[52:55], v[132:135], a[88:91]
  ds_read_b64_tr_b16 v[154:155], v25 offset:51200
  v_mfma_f32_16x16x32_bf16 a[92:95], v[52:55], v[136:139], a[92:95]
  v_mfma_f32_16x16x32_bf16 a[96:99], v[56:59], v[108:111], a[96:99]
  ds_read_b128 v[92:95], v19 offset:8192
  v_mfma_f32_16x16x32_bf16 a[100:103], v[56:59], v[112:115], a[100:103]
  v_mfma_f32_16x16x32_bf16 a[104:107], v[56:59], v[116:119], a[104:107]
  ds_read_b64_tr_b16 v[156:157], v26 offset:49152
  v_mfma_f32_16x16x32_bf16 a[108:111], v[56:59], v[120:123], a[108:111]
  v_mfma_f32_16x16x32_bf16 a[112:115], v[56:59], v[124:127], a[112:115]
  ds_read_b64_tr_b16 v[158:159], v26 offset:51200
  v_mfma_f32_16x16x32_bf16 a[116:119], v[56:59], v[128:131], a[116:119]
  v_mfma_f32_16x16x32_bf16 a[120:123], v[56:59], v[132:135], a[120:123]
  ds_read_b128 v[96:99], v19 offset:10240
  v_mfma_f32_16x16x32_bf16 a[124:127], v[56:59], v[136:139], a[124:127]
  v_mfma_f32_16x16x32_bf16 a[128:131], v[60:63], v[108:111], a[128:131]
  ds_read_b64_tr_b16 v[160:161], v27 offset:49152
  v_mfma_f32_16x16x32_bf16 a[132:135], v[60:63], v[112:115], a[132:135]
  v_mfma_f32_16x16x32_bf16 a[136:139], v[60:63], v[116:119], a[136:139]
  ds_read_b64_tr_b16 v[162:163], v27 offset:51200
  v_mfma_f32_16x16x32_bf16 a[140:143], v[60:63], v[120:123], a[140:143]
  v_mfma_f32_16x16x32_bf16 a[144:147], v[60:63], v[124:127], a[144:147]
  ds_read_b128 v[100:103], v19 offset:12288
  v_mfma_f32_16x16x32_bf16 a[148:151], v[60:63], v[128:131], a[148:151]
  v_mfma_f32_16x16x32_bf16 a[152:155], v[60:63], v[132:135], a[152:155]
  ds_read_b64_tr_b16 v[164:165], v28 offset:49152
  v_mfma_f32_16x16x32_bf16 a[156:159], v[60:63], v[136:139], a[156:159]
  v_mfma_f32_16x16x32_bf16 a[160:163], v[64:67], v[108:111], a[160:163]
  ds_read_b64_tr_b16 v[166:167], v28 offset:51200
  v_mfma_f32_16x16x32_bf16 a[164:167], v[64:67], v[112:115], a[164:167]
  v_mfma_f32_16x16x32_bf16 a[168:171], v[64:67], v[116:119], a[168:171]
  ds_read_b128 v[104:107], v19 offset:14336
  v_mfma_f32_16x16x32_bf16 a[172:175], v[64:67], v[120:123], a[172:175]
  v_mfma_f32_16x16x32_bf16 a[176:179], v[64:67], v[124:127], a[176:179]
  ds_read_b64_tr_b16 v[168:169], v29 offset:49152
  v_mfma_f32_16x16x32_bf16 a[180:183], v[64:67], v[128:131], a[180:183]
  v_mfma_f32_16x16x32_bf16 a[184:187], v[64:67], v[132:135], a[184:187]
  ds_read_b64_tr_b16 v[170:171], v29 offset:51200
  v_mfma_f32_16x16x32_bf16 a[188:191], v[64:67], v[136:139], a[188:191]
  v_mfma_f32_16x16x32_bf16 a[192:195], v[68:71], v[108:111], a[192:195]
  v_mfma_f32_16x16x32_bf16 a[196:199], v[68:71], v[112:115], a[196:199]
  v_mfma_f32_16x16x32_bf16 a[200:203], v[68:71], v[116:119], a[200:203]
  v_mfma_f32_16x16x32_bf16 a[204:207], v[68:71], v[120:123], a[204:207]
  v_mfma_f32_16x16x32_bf16 a[208:211], v[68:71], v[124:127], a[208:211]
  v_mfma_f32_16x16x32_bf16 a[212:215], v[68:71], v[128:131], a[212:215]
  v_mfma_f32_16x16x32_bf16 a[216:219], v[68:71], v[132:135], a[216:219]
  v_mfma_f32_16x16x32_bf16 a[220:223], v[68:71], v[136:139], a[220:223]
  v_mfma_f32_16x16x32_bf16 a[224:227], v[72:75], v[108:111], a[224:227]
  v_mfma_f32_16x16x32_bf16 a[228:231], v[72:75], v[112:115], a[228:231]
  v_mfma_f32_16x16x32_bf16 a[232:235], v[72:75], v[116:119], a[232:235]
  v_mfma_f32_16x16x32_bf16 a[236:239], v[72:75], v[120:123], a[236:239]
  v_mfma_f32_16x16x32_bf16 a[240:243], v[72:75], v[124:127], a[240:243]
  v_mfma_f32_16x16x32_bf16 a[244:247], v[72:75], v[128:131], a[244:247]
  v_mfma_f32_16x16x32_bf16 a[248:251], v[72:75], v[132:135], a[248:251]
  v_mfma_f32_16x16x32_bf16 a[252:255], v[72:75], v[136:139], a[252:255]
  s_waitcnt lgkmcnt(0)
  v_mfma_f32_16x16x32_bf16 a[0:3], v[76:79], v[140:143], a[0:3]
  s_waitcnt vmcnt(0)
  s_barrier
  v_readfirstlane_b32 s91, v245
  s_and_b32 s35, s91, 255
  s_lshr_b32 s36, s91, 8
  s_and_b32 s36, s36, 255
  s_lshr_b32 s37, s91, 16
  s_mov_b32 s92, s24
  s_cmp_gt_u32 s35, 3
  s_cbranch_scc1 L_cd_50
  s_cmp_eq_u32 s35, 3
  s_cbranch_scc1 L_cd_48
  s_mov_b32 s8, s64
  s_and_b32 s9, s65, 0xffff
  s_mov_b32 s10, 0x400000
  s_mov_b32 s11, 0x20000
  s_cmp_eq_u32 s35, 0
  s_cselect_b64 s[88:89], s[68:69], s[70:71]
  s_cmp_eq_u32 s35, 2
  s_cselect_b64 s[88:89], s[72:73], s[88:89]
  s_mov_b32 s12, s88
  s_and_b32 s13, s89, 0xffff
  s_mov_b32 s14, 0x800000
  s_mov_b32 s15, 0x20000
  s_lshl_b32 s91, s33, 2
  s_add_u32 s91, s91, s37
  s_mov_b32 s24, 8192
  s_mov_b32 s26, 262144
  s_lshl_b32 s20, s36, 19
  s_lshl_b32 s21, s91, 9
  s_lshl_b32 s22, s35, 24
  s_lshl_b32 s90, s36, 21
  s_add_u32 s22, s22, s90
  s_lshl_b32 s90, s91, 14
  s_add_u32 s22, s22, s90
  s_lshl_b32 s38, s36, 9
  s_add_u32 s38, s38, 28672
  s_cmp_eq_u32 s35, 0
  s_cselect_b32 s38, 8192, s38
  s_cselect_b32 s98, 1, 2
  s_mov_b32 s48, s35
  s_branch L_cd_49
L_cd_50:
  s_mov_b64 vcc, 0
  s_mov_b32 s58, 0
  s_branch L_cd_51
L_cd_48:
  s_mov_b32 s8, s78
  s_and_b32 s9, s79, 0xffff
  s_mov_b32 s10, 0x400000
  s_mov_b32 s11, 0x20000
  s_mov_b32 s12, s80
  s_and_b32 s13, s81, 0xffff
  s_mov_b32 s14, 0x600000
  s_mov_b32 s15, 0x20000
  s_lshl_b32 s91, s37, 2
  s_add_u32 s91, s91, s33
  s_mov_b32 s24, 6144
  s_mov_b32 s26, 65536
  s_lshl_b32 s20, s36, 19
  s_lshl_b32 s21, s91, 9
  s_lshl_b32 s22, s37, 22
  s_lshl_b32 s90, s36, 19
  s_add_u32 s22, s22, s90
  s_lshl_b32 s90, s33, 14
  s_add_u32 s22, s22, s90
  s_add_u32 s22, s22, 0x4000000
  s_mov_b32 s38, 12288
  s_mov_b32 s48, s37
  s_mov_b32 s98, 1
L_cd_49:
  s_lshl_b32 s90, s36, 9
  s_add_u32 s38, s38, s90
  s_lshl_b32 s90, s33, 7
  s_add_u32 s38, s38, s90
  s_mov_b32 s23, 2048
  s_mov_b32 s25, 8
  s_mov_b64 vcc, -1
  s_sub_i32 s92, s24, s92
  s_lshl_b32 s51, s24, 6
  v_mul_i32_i24 v38, s92, v174
  s_mul_i32 s92, s92, 2
  s_mov_b32 s93, 0
  v_add3_u32 v10, v10, v38, s93
  s_add_u32 s93, s93, s92
  v_add3_u32 v11, v11, v38, s93
  s_add_u32 s93, s93, s92
  v_add3_u32 v12, v12, v38, s93
  s_add_u32 s93, s93, s92
  v_add3_u32 v13, v13, v38, s93
  s_add_u32 s93, s93, s92
  v_add3_u32 v14, v14, v38, s93
  s_add_u32 s93, s93, s92
  v_add3_u32 v15, v15, v38, s93
  s_add_u32 s93, s93, s92
  v_add3_u32 v16, v16, v38, s93
  s_add_u32 s93, s93, s92
  v_add3_u32 v17, v17, v38, s93
  s_add_u32 s93, s93, s92
L_cd_51:
  s_add_u32 m0, s52, 0
  v_mfma_f32_16x16x32_bf16 a[4:7], v[76:79], v[144:147], a[4:7]
  s_cbranch_vccz L_gd_52
  buffer_load_dwordx4 v2, s[8:11], s20 offen  lds
L_gd_52:
  ds_read_b128 v[44:47], v20 offset:0
  v_mfma_f32_16x16x32_bf16 a[8:11], v[76:79], v[148:151], a[8:11]
  v_mfma_f32_16x16x32_bf16 a[12:15], v[76:79], v[152:155], a[12:15]
  ds_read_b64_tr_b16 v[108:109], v30 offset:32768
  s_add_u32 m0, s53, 0
  v_mfma_f32_16x16x32_bf16 a[16:19], v[76:79], v[156:159], a[16:19]
  s_cbranch_vccz L_gd_53
  buffer_load_dwordx4 v10, s[12:15], s21 offen  lds
L_gd_53:
  v_mfma_f32_16x16x32_bf16 a[20:23], v[76:79], v[160:163], a[20:23]
  ds_read_b64_tr_b16 v[110:111], v30 offset:34816
  v_mfma_f32_16x16x32_bf16 a[24:27], v[76:79], v[164:167], a[24:27]
  v_mfma_f32_16x16x32_bf16 a[28:31], v[76:79], v[168:171], a[28:31]
  ds_read_b128 v[48:51], v20 offset:2048
  s_add_u32 m0, s52, 1024
  v_mfma_f32_16x16x32_bf16 a[32:35], v[80:83], v[140:143], a[32:35]
  s_cbranch_vccz L_gd_54
  buffer_load_dwordx4 v3, s[8:11], s20 offen  lds
L_gd_54:
  v_mfma_f32_16x16x32_bf16 a[36:39], v[80:83], v[144:147], a[36:39]
  ds_read_b64_tr_b16 v[112:113], v31 offset:32768
  v_mfma_f32_16x16x32_bf16 a[40:43], v[80:83], v[148:151], a[40:43]
  v_mfma_f32_16x16x32_bf16 a[44:47], v[80:83], v[152:155], a[44:47]
  ds_read_b64_tr_b16 v[114:115], v31 offset:34816
  s_add_u32 m0, s53, 1024
  v_mfma_f32_16x16x32_bf16 a[48:51], v[80:83], v[156:159], a[48:51]
  s_cbranch_vccz L_gd_55
  buffer_load_dwordx4 v11, s[12:15], s21 offen  lds
L_gd_55:
  v_mfma_f32_16x16x32_bf16 a[52:55], v[80:83], v[160:163], a[52:55]
  ds_read_b128 v[52:55], v20 offset:4096
  v_mfma_f32_16x16x32_bf16 a[56:59], v[80:83], v[164:167], a[56:59]
  v_mfma_f32_16x16x32_bf16 a[60:63], v[80:83], v[168:171], a[60:63]
  ds_read_b64_tr_b16 v[116:117], v32 offset:32768
  s_add_u32 m0, s52, 2048
  v_mfma_f32_16x16x32_bf16 a[64:67], v[84:87], v[140:143], a[64:67]
  s_cbranch_vccz L_gd_56
  buffer_load_dwordx4 v4, s[8:11], s20 offen  lds
L_gd_56:
  v_mfma_f32_16x16x32_bf16 a[68:71], v[84:87], v[144:147], a[68:71]
  ds_read_b64_tr_b16 v[118:119], v32 offset:34816
  v_mfma_f32_16x16x32_bf16 a[72:75], v[84:87], v[148:151], a[72:75]
  v_mfma_f32_16x16x32_bf16 a[76:79], v[84:87], v[152:155], a[76:79]
  ds_read_b128 v[56:59], v20 offset:6144
  s_add_u32 m0, s53, 2048
  v_mfma_f32_16x16x32_bf16 a[80:83], v[84:87], v[156:159], a[80:83]
  s_cbranch_vccz L_gd_57
  buffer_load_dwordx4 v12, s[12:15], s21 offen  lds
L_gd_57:
  v_mfma_f32_16x16x32_bf16 a[84:87], v[84:87], v[160:163], a[84:87]
  ds_read_b64_tr_b16 v[120:121], v33 offset:32768
  v_mfma_f32_16x16x32_bf16 a[88:91], v[84:87], v[164:167], a[88:91]
  v_mfma_f32_16x16x32_bf16 a[92:95], v[84:87], v[168:171], a[92:95]
  ds_read_b64_tr_b16 v[122:123], v33 offset:34816
  s_add_u32 m0, s52, 3072
  v_mfma_f32_16x16x32_bf16 a[96:99], v[88:91], v[140:143], a[96:99]
  s_cbranch_vccz L_gd_58
  buffer_load_dwordx4 v5, s[8:11], s20 offen  lds
L_gd_58:
  v_mfma_f32_16x16x32_bf16 a[100:103], v[88:91], v[144:147], a[100:103]
  ds_read_b128 v[60:63], v20 offset:8192
  v_mfma_f32_16x16x32_bf16 a[104:107], v[88:91], v[148:151], a[104:107]
  v_mfma_f32_16x16x32_bf16 a[108:111], v[88:91], v[152:155], a[108:111]
  ds_read_b64_tr_b16 v[124:125], v34 offset:32768
  s_add_u32 m0, s53, 3072
  v_mfma_f32_16x16x32_bf16 a[112:115], v[88:91], v[156:159], a[112:115]
  s_cbranch_vccz L_gd_59
  buffer_load_dwordx4 v13, s[12:15], s21 offen  lds
L_gd_59:
  v_mfma_f32_16x16x32_bf16 a[116:119], v[88:91], v[160:163], a[116:119]
  ds_read_b64_tr_b16 v[126:127], v34 offset:34816
  v_mfma_f32_16x16x32_bf16 a[120:123], v[88:91], v[164:167], a[120:123]
  v_mfma_f32_16x16x32_bf16 a[124:127], v[88:91], v[168:171], a[124:127]
  ds_read_b128 v[64:67], v20 offset:10240
  s_add_u32 m0, s52, 4096
  v_mfma_f32_16x16x32_bf16 a[128:131], v[92:95], v[140:143], a[128:131]
  s_cbranch_vccz L_gd_60
  buffer_load_dwordx4 v6, s[8:11], s20 offen  lds
L_gd_60:
  v_mfma_f32_16x16x32_bf16 a[132:135], v[92:95], v[144:147], a[132:135]
  ds_read_b64_tr_b16 v[128:129], v35 offset:32768
  v_mfma_f32_16x16x32_bf16 a[136:139], v[92:95], v[148:151], a[136:139]
  v_mfma_f32_16x16x32_bf16 a[140:143], v[92:95], v[152:155], a[140:143]
  ds_read_b64_tr_b16 v[130:131], v35 offset:34816
  s_add_u32 m0, s53, 4096
  v_mfma_f32_16x16x32_bf16 a[144:147], v[92:95], v[156:159], a[144:147]
  s_cbranch_vccz L_gd_61
  buffer_load_dwordx4 v14, s[12:15], s21 offen  lds
L_gd_61:
  v_mfma_f32_16x16x32_bf16 a[148:151], v[92:95], v[160:163], a[148:151]
  ds_read_b128 v[68:71], v20 offset:12288
  v_mfma_f32_16x16x32_bf16 a[152:155], v[92:95], v[164:167], a[152:155]
  v_mfma_f32_16x16x32_bf16 a[156:159], v[92:95], v[168:171], a[156:159]
  ds_read_b64_tr_b16 v[132:133], v36 offset:32768
  s_add_u32 m0, s52, 5120
  v_mfma_f32_16x16x32_bf16 a[160:163], v[96:99], v[140:143], a[160:163]
  s_cbranch_vccz L_gd_62
  buffer_load_dwordx4 v7, s[8:11], s20 offen  lds
L_gd_62:
  v_mfma_f32_16x16x32_bf16 a[164:167], v[96:99], v[144:147], a[164:167]
  ds_read_b64_tr_b16 v[134:135], v36 offset:34816
  v_mfma_f32_16x16x32_bf16 a[168:171], v[96:99], v[148:151], a[168:171]
  v_mfma_f32_16x16x32_bf16 a[172:175], v[96:99], v[152:155], a[172:175]
  ds_read_b128 v[72:75], v20 offset:14336
  s_add_u32 m0, s53, 5120
  v_mfma_f32_16x16x32_bf16 a[176:179], v[96:99], v[156:159], a[176:179]
  s_cbranch_vccz L_gd_63
  buffer_load_dwordx4 v15, s[12:15], s21 offen  lds
L_gd_63:
  v_mfma_f32_16x16x32_bf16 a[180:183], v[96:99], v[160:163], a[180:183]
  ds_read_b64_tr_b16 v[136:137], v37 offset:32768
  v_mfma_f32_16x16x32_bf16 a[184:187], v[96:99], v[164:167], a[184:187]
  v_mfma_f32_16x16x32_bf16 a[188:191], v[96:99], v[168:171], a[188:191]
  ds_read_b64_tr_b16 v[138:139], v37 offset:34816
  s_add_u32 m0, s52, 6144
  v_mfma_f32_16x16x32_bf16 a[192:195], v[100:103], v[140:143], a[192:195]
  s_cbranch_vccz L_gd_64
  buffer_load_dwordx4 v8, s[8:11], s20 offen  lds
L_gd_64:
  v_mfma_f32_16x16x32_bf16 a[196:199], v[100:103], v[144:147], a[196:199]
  v_mfma_f32_16x16x32_bf16 a[200:203], v[100:103], v[148:151], a[200:203]
  v_mfma_f32_16x16x32_bf16 a[204:207], v[100:103], v[152:155], a[204:207]
  s_add_u32 m0, s53, 6144
  v_mfma_f32_16x16x32_bf16 a[208:211], v[100:103], v[156:159], a[208:211]
  s_cbranch_vccz L_gd_65
  buffer_load_dwordx4 v16, s[12:15], s21 offen  lds
L_gd_65:
  v_mfma_f32_16x16x32_bf16 a[212:215], v[100:103], v[160:163], a[212:215]
  v_mfma_f32_16x16x32_bf16 a[216:219], v[100:103], v[164:167], a[216:219]
  v_mfma_f32_16x16x32_bf16 a[220:223], v[100:103], v[168:171], a[220:223]
  s_add_u32 m0, s52, 7168
  v_mfma_f32_16x16x32_bf16 a[224:227], v[104:107], v[140:143], a[224:227]
  s_cbranch_vccz L_gd_66
  buffer_load_dwordx4 v9, s[8:11], s20 offen  lds
L_gd_66:
  v_mfma_f32_16x16x32_bf16 a[228:231], v[104:107], v[144:147], a[228:231]
  v_mfma_f32_16x16x32_bf16 a[232:235], v[104:107], v[148:151], a[232:235]
  v_mfma_f32_16x16x32_bf16 a[236:239], v[104:107], v[152:155], a[236:239]
  s_add_u32 m0, s53, 7168
  v_mfma_f32_16x16x32_bf16 a[240:243], v[104:107], v[156:159], a[240:243]
  s_cbranch_vccz L_gd_67
  buffer_load_dwordx4 v17, s[12:15], s21 offen  lds
  s_add_u32 s20, s20, 128
  s_add_u32 s21, s21, s51
L_gd_67:
  v_mfma_f32_16x16x32_bf16 a[244:247], v[104:107], v[160:163], a[244:247]
  v_mfma_f32_16x16x32_bf16 a[248:251], v[104:107], v[164:167], a[248:251]
  v_mfma_f32_16x16x32_bf16 a[252:255], v[104:107], v[168:171], a[252:255]
  s_waitcnt lgkmcnt(0)
  v_mfma_f32_16x16x32_bf16 a[0:3], v[44:47], v[108:111], a[0:3]
  ds_read_b128 v[76:79], v21 offset:0
  v_mfma_f32_16x16x32_bf16 a[4:7], v[44:47], v[112:115], a[4:7]
  v_mfma_f32_16x16x32_bf16 a[8:11], v[44:47], v[116:119], a[8:11]
  ds_read_b64_tr_b16 v[140:141], v30 offset:49152
  v_mfma_f32_16x16x32_bf16 a[12:15], v[44:47], v[120:123], a[12:15]
  v_mfma_f32_16x16x32_bf16 a[16:19], v[44:47], v[124:127], a[16:19]
  ds_read_b64_tr_b16 v[142:143], v30 offset:51200
  v_mfma_f32_16x16x32_bf16 a[20:23], v[44:47], v[128:131], a[20:23]
  v_mfma_f32_16x16x32_bf16 a[24:27], v[44:47], v[132:135], a[24:27]
  ds_read_b128 v[80:83], v21 offset:2048
  v_mfma_f32_16x16x32_bf16 a[28:31], v[44:47], v[136:139], a[28:31]
  v_mfma_f32_16x16x32_bf16 a[32:35], v[48:51], v[108:111], a[32:35]
  ds_read_b64_tr_b16 v[144:145], v31 offset:49152
  v_mfma_f32_16x16x32_bf16 a[36:39], v[48:51], v[112:115], a[36:39]
  v_mfma_f32_16x16x32_bf16 a[40:43], v[48:51], v[116:119], a[40:43]
  ds_read_b64_tr_b16 v[146:147], v31 offset:51200
  v_mfma_f32_16x16x32_bf16 a[44:47], v[48:51], v[120:123], a[44:47]
  v_mfma_f32_16x16x32_bf16 a[48:51], v[48:51], v[124:127], a[48:51]
  ds_read_b128 v[84:87], v21 offset:4096
  v_mfma_f32_16x16x32_bf16 a[52:55], v[48:51], v[128:131], a[52:55]
  v_mfma_f32_16x16x32_bf16 a[56:59], v[48:51], v[132:135], a[56:59]
  ds_read_b64_tr_b16 v[148:149], v32 offset:49152
  v_mfma_f32_16x16x32_bf16 a[60:63], v[48:51], v[136:139], a[60:63]
  v_mfma_f32_16x16x32_bf16 a[64:67], v[52:55], v[108:111], a[64:67]
  ds_read_b64_tr_b16 v[150:151], v32 offset:51200
  v_mfma_f32_16x16x32_bf16 a[68:71], v[52:55], v[112:115], a[68:71]
  v_mfma_f32_16x16x32_bf16 a[72:75], v[52:55], v[116:119], a[72:75]
  ds_read_b128 v[88:91], v21 offset:6144
  v_mfma_f32_16x16x32_bf16 a[76:79], v[52:55], v[120:123], a[76:79]
  v_mfma_f32_16x16x32_bf16 a[80:83], v[52:55], v[124:127], a[80:83]
  ds_read_b64_tr_b16 v[152:153], v33 offset:49152
  v_mfma_f32_16x16x32_bf16 a[84:87], v[52:55], v[128:131], a[84:87]
  v_mfma_f32_16x16x32_bf16 a[88:91], v[52:55], v[132:135], a[88:91]
  ds_read_b64_tr_b16 v[154:155], v33 offset:51200
  v_mfma_f32_16x16x32_bf16 a[92:95], v[52:55], v[136:139], a[92:95]
  v_mfma_f32_16x16x32_bf16 a[96:99], v[56:59], v[108:111], a[96:99]
  ds_read_b128 v[92:95], v21 offset:8192
  v_mfma_f32_16x16x32_bf16 a[100:103], v[56:59], v[112:115], a[100:103]
  v_mfma_f32_16x16x32_bf16 a[104:107], v[56:59], v[116:119], a[104:107]
  ds_read_b64_tr_b16 v[156:157], v34 offset:49152
  v_mfma_f32_16x16x32_bf16 a[108:111], v[56:59], v[120:123], a[108:111]
  v_mfma_f32_16x16x32_bf16 a[112:115], v[56:59], v[124:127], a[112:115]
  ds_read_b64_tr_b16 v[158:159], v34 offset:51200
  v_mfma_f32_16x16x32_bf16 a[116:119], v[56:59], v[128:131], a[116:119]
  v_mfma_f32_16x16x32_bf16 a[120:123], v[56:59], v[132:135], a[120:123]
  ds_read_b128 v[96:99], v21 offset:10240
  v_mfma_f32_16x16x32_bf16 a[124:127], v[56:59], v[136:139], a[124:127]
  v_mfma_f32_16x16x32_bf16 a[128:131], v[60:63], v[108:111], a[128:131]
  ds_read_b64_tr_b16 v[160:161], v35 offset:49152
  v_mfma_f32_16x16x32_bf16 a[132:135], v[60:63], v[112:115], a[132:135]
  v_mfma_f32_16x16x32_bf16 a[136:139], v[60:63], v[116:119], a[136:139]
  ds_read_b64_tr_b16 v[162:163], v35 offset:51200
  v_mfma_f32_16x16x32_bf16 a[140:143], v[60:63], v[120:123], a[140:143]
  v_mfma_f32_16x16x32_bf16 a[144:147], v[60:63], v[124:127], a[144:147]
  ds_read_b128 v[100:103], v21 offset:12288
  v_mfma_f32_16x16x32_bf16 a[148:151], v[60:63], v[128:131], a[148:151]
  v_mfma_f32_16x16x32_bf16 a[152:155], v[60:63], v[132:135], a[152:155]
  ds_read_b64_tr_b16 v[164:165], v36 offset:49152
  v_mfma_f32_16x16x32_bf16 a[156:159], v[60:63], v[136:139], a[156:159]
  v_mfma_f32_16x16x32_bf16 a[160:163], v[64:67], v[108:111], a[160:163]
  ds_read_b64_tr_b16 v[166:167], v36 offset:51200
  v_mfma_f32_16x16x32_bf16 a[164:167], v[64:67], v[112:115], a[164:167]
  v_mfma_f32_16x16x32_bf16 a[168:171], v[64:67], v[116:119], a[168:171]
  ds_read_b128 v[104:107], v21 offset:14336
  v_mfma_f32_16x16x32_bf16 a[172:175], v[64:67], v[120:123], a[172:175]
  v_mfma_f32_16x16x32_bf16 a[176:179], v[64:67], v[124:127], a[176:179]
  ds_read_b64_tr_b16 v[168:169], v37 offset:49152
  v_mfma_f32_16x16x32_bf16 a[180:183], v[64:67], v[128:131], a[180:183]
  v_mfma_f32_16x16x32_bf16 a[184:187], v[64:67], v[132:135], a[184:187]
  ds_read_b64_tr_b16 v[170:171], v37 offset:51200
  v_mfma_f32_16x16x32_bf16 a[188:191], v[64:67], v[136:139], a[188:191]
  v_mfma_f32_16x16x32_bf16 a[192:195], v[68:71], v[108:111], a[192:195]
  v_mfma_f32_16x16x32_bf16 a[196:199], v[68:71], v[112:115], a[196:199]
  v_mfma_f32_16x16x32_bf16 a[200:203], v[68:71], v[116:119], a[200:203]
  v_mfma_f32_16x16x32_bf16 a[204:207], v[68:71], v[120:123], a[204:207]
  v_mfma_f32_16x16x32_bf16 a[208:211], v[68:71], v[124:127], a[208:211]
  v_mfma_f32_16x16x32_bf16 a[212:215], v[68:71], v[128:131], a[212:215]
  v_mfma_f32_16x16x32_bf16 a[216:219], v[68:71], v[132:135], a[216:219]
  v_mfma_f32_16x16x32_bf16 a[220:223], v[68:71], v[136:139], a[220:223]
  v_mfma_f32_16x16x32_bf16 a[224:227], v[72:75], v[108:111], a[224:227]
  v_mfma_f32_16x16x32_bf16 a[228:231], v[72:75], v[112:115], a[228:231]
  v_mfma_f32_16x16x32_bf16 a[232:235], v[72:75], v[116:119], a[232:235]
  v_mfma_f32_16x16x32_bf16 a[236:239], v[72:75], v[120:123], a[236:239]
  v_mfma_f32_16x16x32_bf16 a[240:243], v[72:75], v[124:127], a[240:243]
  v_mfma_f32_16x16x32_bf16 a[244:247], v[72:75], v[128:131], a[244:247]
  v_mfma_f32_16x16x32_bf16 a[248:251], v[72:75], v[132:135], a[248:251]
  v_mfma_f32_16x16x32_bf16 a[252:255], v[72:75], v[136:139], a[252:255]
  s_waitcnt lgkmcnt(0)
  v_mfma_f32_16x16x32_bf16 a[0:3], v[76:79], v[140:143], a[0:3]
  s_barrier
  s_add_u32 m0, s52, 65536
  v_mfma_f32_16x16x32_bf16 a[4:7], v[76:79], v[144:147], a[4:7]
  s_cbranch_vccz L_gd_68
  buffer_load_dwordx4 v2, s[8:11], s20 offen  lds
L_gd_68:
  v_mfma_f32_16x16x32_bf16 a[8:11], v[76:79], v[148:151], a[8:11]
  v_mfma_f32_16x16x32_bf16 a[12:15], v[76:79], v[152:155], a[12:15]
  s_add_u32 m0, s53, 65536
  v_mfma_f32_16x16x32_bf16 a[16:19], v[76:79], v[156:159], a[16:19]
  s_cbranch_vccz L_gd_69
  buffer_load_dwordx4 v10, s[12:15], s21 offen  lds
L_gd_69:
  v_mfma_f32_16x16x32_bf16 a[20:23], v[76:79], v[160:163], a[20:23]
  v_mfma_f32_16x16x32_bf16 a[24:27], v[76:79], v[164:167], a[24:27]
  v_mfma_f32_16x16x32_bf16 a[28:31], v[76:79], v[168:171], a[28:31]
  s_add_u32 m0, s52, 66560
  v_mfma_f32_16x16x32_bf16 a[32:35], v[80:83], v[140:143], a[32:35]
  s_cbranch_vccz L_gd_70
  buffer_load_dwordx4 v3, s[8:11], s20 offen  lds
L_gd_70:
  v_mfma_f32_16x16x32_bf16 a[36:39], v[80:83], v[144:147], a[36:39]
  v_mfma_f32_16x16x32_bf16 a[40:43], v[80:83], v[148:151], a[40:43]
  v_mfma_f32_16x16x32_bf16 a[44:47], v[80:83], v[152:155], a[44:47]
  s_add_u32 m0, s53, 66560
  v_mfma_f32_16x16x32_bf16 a[48:51], v[80:83], v[156:159], a[48:51]
  s_cbranch_vccz L_gd_71
  buffer_load_dwordx4 v11, s[12:15], s21 offen  lds
L_gd_71:
  v_mfma_f32_16x16x32_bf16 a[52:55], v[80:83], v[160:163], a[52:55]
  v_mfma_f32_16x16x32_bf16 a[56:59], v[80:83], v[164:167], a[56:59]
  v_mfma_f32_16x16x32_bf16 a[60:63], v[80:83], v[168:171], a[60:63]
  s_add_u32 m0, s52, 67584
  v_mfma_f32_16x16x32_bf16 a[64:67], v[84:87], v[140:143], a[64:67]
  s_cbranch_vccz L_gd_72
  buffer_load_dwordx4 v4, s[8:11], s20 offen  lds
L_gd_72:
  v_mfma_f32_16x16x32_bf16 a[68:71], v[84:87], v[144:147], a[68:71]
  v_mfma_f32_16x16x32_bf16 a[72:75], v[84:87], v[148:151], a[72:75]
  v_mfma_f32_16x16x32_bf16 a[76:79], v[84:87], v[152:155], a[76:79]
  s_add_u32 m0, s53, 67584
  v_mfma_f32_16x16x32_bf16 a[80:83], v[84:87], v[156:159], a[80:83]
  s_cbranch_vccz L_gd_73
  buffer_load_dwordx4 v12, s[12:15], s21 offen  lds
L_gd_73:
  v_mfma_f32_16x16x32_bf16 a[84:87], v[84:87], v[160:163], a[84:87]
  v_mfma_f32_16x16x32_bf16 a[88:91], v[84:87], v[164:167], a[88:91]
  v_mfma_f32_16x16x32_bf16 a[92:95], v[84:87], v[168:171], a[92:95]
  s_add_u32 m0, s52, 68608
  v_mfma_f32_16x16x32_bf16 a[96:99], v[88:91], v[140:143], a[96:99]
  s_cbranch_vccz L_gd_74
  buffer_load_dwordx4 v5, s[8:11], s20 offen  lds
L_gd_74:
  v_mfma_f32_16x16x32_bf16 a[100:103], v[88:91], v[144:147], a[100:103]
  v_mfma_f32_16x16x32_bf16 a[104:107], v[88:91], v[148:151], a[104:107]
  v_mfma_f32_16x16x32_bf16 a[108:111], v[88:91], v[152:155], a[108:111]
  s_add_u32 m0, s53, 68608
  v_mfma_f32_16x16x32_bf16 a[112:115], v[88:91], v[156:159], a[112:115]
  s_cbranch_vccz L_gd_75
  buffer_load_dwordx4 v13, s[12:15], s21 offen  lds
L_gd_75:
  v_mfma_f32_16x16x32_bf16 a[116:119], v[88:91], v[160:163], a[116:119]
  v_mfma_f32_16x16x32_bf16 a[120:123], v[88:91], v[164:167], a[120:123]
  v_mfma_f32_16x16x32_bf16 a[124:127], v[88:91], v[168:171], a[124:127]
  s_add_u32 m0, s52, 69632
  v_mfma_f32_16x16x32_bf16 a[128:131], v[92:95], v[140:143], a[128:131]
  s_cbranch_vccz L_gd_76
  buffer_load_dwordx4 v6, s[8:11], s20 offen  lds
L_gd_76:
  v_mfma_f32_16x16x32_bf16 a[132:135], v[92:95], v[144:147], a[132:135]
  v_mfma_f32_16x16x32_bf16 a[136:139], v[92:95], v[148:151], a[136:139]
  v_mfma_f32_16x16x32_bf16 a[140:143], v[92:95], v[152:155], a[140:143]
  s_add_u32 m0, s53, 69632
  v_mfma_f32_16x16x32_bf16 a[144:147], v[92:95], v[156:159], a[144:147]
  s_cbranch_vccz L_gd_77
  buffer_load_dwordx4 v14, s[12:15], s21 offen  lds
L_gd_77:
  v_mfma_f32_16x16x32_bf16 a[148:151], v[92:95], v[160:163], a[148:151]
  v_mfma_f32_16x16x32_bf16 a[152:155], v[92:95], v[164:167], a[152:155]
  v_mfma_f32_16x16x32_bf16 a[156:159], v[92:95], v[168:171], a[156:159]
  s_add_u32 m0, s52, 70656
  v_mfma_f32_16x16x32_bf16 a[160:163], v[96:99], v[140:143], a[160:163]
  s_cbranch_vccz L_gd_78
  buffer_load_dwordx4 v7, s[8:11], s20 offen  lds
L_gd_78:
  v_mfma_f32_16x16x32_bf16 a[164:167], v[96:99], v[144:147], a[164:167]
  v_mfma_f32_16x16x32_bf16 a[168:171], v[96:99], v[148:151], a[168:171]
  v_mfma_f32_16x16x32_bf16 a[172:175], v[96:99], v[152:155], a[172:175]
  s_add_u32 m0, s53, 70656
  v_mfma_f32_16x16x32_bf16 a[176:179], v[96:99], v[156:159], a[176:179]
  s_cbranch_vccz L_gd_79
  buffer_load_dwordx4 v15, s[12:15], s21 offen  lds
L_gd_79:
  v_mfma_f32_16x16x32_bf16 a[180:183], v[96:99], v[160:163], a[180:183]
  v_mfma_f32_16x16x32_bf16 a[184:187], v[96:99], v[164:167], a[184:187]
  v_mfma_f32_16x16x32_bf16 a[188:191], v[96:99], v[168:171], a[188:191]
  s_add_u32 m0, s52, 71680
  v_mfma_f32_16x16x32_bf16 a[192:195], v[100:103], v[140:143], a[192:195]
  s_cbranch_vccz L_gd_80
  buffer_load_dwordx4 v8, s[8:11], s20 offen  lds
L_gd_80:
  v_mfma_f32_16x16x32_bf16 a[196:199], v[100:103], v[144:147], a[196:199]
  v_mfma_f32_16x16x32_bf16 a[200:203], v[100:103], v[148:151], a[200:203]
  v_mfma_f32_16x16x32_bf16 a[204:207], v[100:103], v[152:155], a[204:207]
  s_add_u32 m0, s53, 71680
  v_mfma_f32_16x16x32_bf16 a[208:211], v[100:103], v[156:159], a[208:211]
  s_cbranch_vccz L_gd_81
  buffer_load_dwordx4 v16, s[12:15], s21 offen  lds
L_gd_81:
  v_mfma_f32_16x16x32_bf16 a[212:215], v[100:103], v[160:163], a[212:215]
  v_mfma_f32_16x16x32_bf16 a[216:219], v[100:103], v[164:167], a[216:219]
  v_mfma_f32_16x16x32_bf16 a[220:223], v[100:103], v[168:171], a[220:223]
  s_add_u32 m0, s52, 72704
  v_mfma_f32_16x16x32_bf16 a[224:227], v[104:107], v[140:143], a[224:227]
  s_cbranch_vccz L_gd_82
  buffer_load_dwordx4 v9, s[8:11], s20 offen  lds
L_gd_82:
  v_mfma_f32_16x16x32_bf16 a[228:231], v[104:107], v[144:147], a[228:231]
  v_mfma_f32_16x16x32_bf16 a[232:235], v[104:107], v[148:151], a[232:235]
  v_mfma_f32_16x16x32_bf16 a[236:239], v[104:107], v[152:155], a[236:239]
  s_add_u32 m0, s53, 72704
  v_mfma_f32_16x16x32_bf16 a[240:243], v[104:107], v[156:159], a[240:243]
  s_cbranch_vccz L_gd_83
  buffer_load_dwordx4 v17, s[12:15], s21 offen  lds
  s_add_u32 s20, s20, 128
  s_add_u32 s21, s21, s51
L_gd_83:
  v_mfma_f32_16x16x32_bf16 a[244:247], v[104:107], v[160:163], a[244:247]
  v_mfma_f32_16x16x32_bf16 a[248:251], v[104:107], v[164:167], a[248:251]
  v_mfma_f32_16x16x32_bf16 a[252:255], v[104:107], v[168:171], a[252:255]
  s_cmp_eq_u32 s58, 1
  s_cbranch_scc1 L_epi
  s_branch L_have1
L_g2_cw:
  s_mov_b64 exec, 1
  ds_write_b32 v175, v244
  s_mov_b64 exec, -1
  s_branch L_g2_cwb
L_g2_cr:
  ds_read_b32 v246, v241
  s_cmp_eq_u32 s25, 1
  s_cbranch_scc1 L_g2_crb
  s_cmp_lg_u32 s32, 0
  s_cbranch_scc1 L_rq_84
  s_cmp_eq_u32 s39, 0
  s_cbranch_scc1 L_rq_84
  s_lshl_b32 s99, s33, 7
  s_add_u32 s99, s99, 0x3d00200
  v_mov_b32 v244, 1
  v_mov_b32 v245, 0
  s_mov_b64 exec, 1
  buffer_atomic_add v244, v245, s[4:7], s99 offen sc0 sc1
  s_mov_b64 exec, -1
L_rq_84:
  s_branch L_g2_crb
L_small:
  s_mov_b32 s8, s64
  s_and_b32 s9, s65, 0xffff
  s_mov_b32 s10, 0x400000
  s_mov_b32 s11, 0x20000
  s_cmp_eq_u32 s35, 9
  s_cselect_b64 s[88:89], s[70:71], s[72:73]
  s_mov_b32 s12, s88
  s_and_b32 s13, s89, 0xffff
  s_mov_b32 s14, 0x800000
  s_mov_b32 s15, 0x20000
  s_lshl_b32 s91, s33, 3
  s_add_u32 s91, s91, s37
  s_mov_b32 s24, 8192
  s_mov_b32 s26, 262144
  s_mov_b32 s23, 2048
  s_mov_b32 s25, 4
  s_lshl_b32 s20, s36, 18
  s_lshl_b32 s21, s91, 8
  s_sub_u32 s22, s35, 8
  s_lshl_b32 s22, s22, 24
  s_lshl_b32 s90, s36, 20
  s_add_u32 s22, s22, s90
  s_lshl_b32 s90, s91, 13
  s_add_u32 s22, s22, s90
  s_lshl_b32 s38, s36, 9
  s_add_u32 s38, s38, 28672
  s_lshl_b32 s90, s33, 7
  s_add_u32 s38, s38, s90
  v_and_b32 v1, 63, v0
  v_lshrrev_b32 v22, 6, v0
  s_nop 0
  v_readfirstlane_b32 s27, v22
  s_mul_i32 s90, s27, 32
  v_lshrrev_b32 v22, 3, v1
  v_add_u32 v22, s90, v22
  v_mul_lo_u32 v22, v22, s23
  v_lshrrev_b32 v23, 4, v1
  v_xor_b32 v23, v23, v1
  v_and_b32 v23, 7, v23
  v_lshl_add_u32 v2, v23, 4, v22
  s_mul_i32 s91, s23, 8
  v_add_u32 v3, s91, v2
  v_xor_b32 v3, 64, v3
  v_add_u32 v4, s91, v3
  v_xor_b32 v4, 64, v4
  v_add_u32 v5, s91, v4
  v_xor_b32 v5, 64, v5
  s_mul_i32 s90, s27, 16
  v_lshrrev_b32 v22, 4, v1
  v_add_u32 v22, 0, v22
  v_add_u32 v22, s90, v22
  v_and_b32 v23, 3, v22
  v_lshlrev_b32 v23, 1, v23
  v_and_b32 v24, 8, v22
  v_or_b32 v23, v23, v24
  v_xor_b32 v23, v23, v1
  v_and_b32 v23, 15, v23
  v_mul_lo_u32 v22, v22, s24
  v_lshl_add_u32 v6, v23, 4, v22
  v_lshrrev_b32 v22, 4, v1
  v_add_u32 v22, 4, v22
  v_add_u32 v22, s90, v22
  v_and_b32 v23, 3, v22
  v_lshlrev_b32 v23, 1, v23
  v_and_b32 v24, 8, v22
  v_or_b32 v23, v23, v24
  v_xor_b32 v23, v23, v1
  v_and_b32 v23, 15, v23
  v_mul_lo_u32 v22, v22, s24
  v_lshl_add_u32 v7, v23, 4, v22
  v_lshrrev_b32 v22, 4, v1
  v_add_u32 v22, 8, v22
  v_add_u32 v22, s90, v22
  v_and_b32 v23, 3, v22
  v_lshlrev_b32 v23, 1, v23
  v_and_b32 v24, 8, v22
  v_or_b32 v23, v23, v24
  v_xor_b32 v23, v23, v1
  v_and_b32 v23, 15, v23
  v_mul_lo_u32 v22, v22, s24
  v_lshl_add_u32 v8, v23, 4, v22
  v_lshrrev_b32 v22, 4, v1
  v_add_u32 v22, 12, v22
  v_add_u32 v22, s90, v22
  v_and_b32 v23, 3, v22
  v_lshlrev_b32 v23, 1, v23
  v_and_b32 v24, 8, v22
  v_or_b32 v23, v23, v24
  v_xor_b32 v23, v23, v1
  v_and_b32 v23, 15, v23
  v_mul_lo_u32 v22, v22, s24
  v_lshl_add_u32 v9, v23, 4, v22
  s_mul_i32 s51, s24, 64
  s_mul_i32 s52, s27, 4096
  s_mul_i32 s53, s27, 4096
  s_add_u32 s53, s53, 16384
  s_add_u32 m0, s52, 0
  s_nop 0
  buffer_load_dwordx4 v2, s[8:11], s20 offen  lds
  s_add_u32 m0, s53, 0
  s_nop 0
  buffer_load_dwordx4 v6, s[12:15], s21 offen  lds
  s_add_u32 m0, s52, 1024
  s_nop 0
  buffer_load_dwordx4 v3, s[8:11], s20 offen  lds
  s_add_u32 m0, s53, 1024
  s_nop 0
  buffer_load_dwordx4 v7, s[12:15], s21 offen  lds
  s_add_u32 m0, s52, 2048
  s_nop 0
  buffer_load_dwordx4 v4, s[8:11], s20 offen  lds
  s_add_u32 m0, s53, 2048
  s_nop 0
  buffer_load_dwordx4 v8, s[12:15], s21 offen  lds
  s_add_u32 m0, s52, 3072
  s_nop 0
  buffer_load_dwordx4 v5, s[8:11], s20 offen  lds
  s_add_u32 m0, s53, 3072
  s_nop 0
  buffer_load_dwordx4 v9, s[12:15], s21 offen  lds
  s_add_u32 s20, s20, 128
  s_add_u32 s21, s21, s51
  s_add_u32 m0, s52, 32768
  s_nop 0
  buffer_load_dwordx4 v2, s[8:11], s20 offen  lds
  s_add_u32 m0, s53, 32768
  s_nop 0
  buffer_load_dwordx4 v6, s[12:15], s21 offen  lds
  s_add_u32 m0, s52, 33792
  s_nop 0
  buffer_load_dwordx4 v3, s[8:11], s20 offen  lds
  s_add_u32 m0, s53, 33792
  s_nop 0
  buffer_load_dwordx4 v7, s[12:15], s21 offen  lds
  s_add_u32 m0, s52, 34816
  s_nop 0
  buffer_load_dwordx4 v4, s[8:11], s20 offen  lds
  s_add_u32 m0, s53, 34816
  s_nop 0
  buffer_load_dwordx4 v8, s[12:15], s21 offen  lds
  s_add_u32 m0, s52, 35840
  s_nop 0
  buffer_load_dwordx4 v5, s[8:11], s20 offen  lds
  s_add_u32 m0, s53, 35840
  s_nop 0
  buffer_load_dwordx4 v9, s[12:15], s21 offen  lds
  s_add_u32 s20, s20, 128
  s_add_u32 s21, s21, s51
  s_add_u32 m0, s52, 65536
  s_nop 0
  buffer_load_dwordx4 v2, s[8:11], s20 offen  lds
  s_add_u32 m0, s53, 65536
  s_nop 0
  buffer_load_dwordx4 v6, s[12:15], s21 offen  lds
  s_add_u32 m0, s52, 66560
  s_nop 0
  buffer_load_dwordx4 v3, s[8:11], s20 offen  lds
  s_add_u32 m0, s53, 66560
  s_nop 0
  buffer_load_dwordx4 v7, s[12:15], s21 offen  lds
  s_add_u32 m0, s52, 67584
  s_nop 0
  buffer_load_dwordx4 v4, s[8:11], s20 offen  lds
  s_add_u32 m0, s53, 67584
  s_nop 0
  buffer_load_dwordx4 v8, s[12:15], s21 offen  lds
  s_add_u32 m0, s52, 68608
  s_nop 0
  buffer_load_dwordx4 v5, s[8:11], s20 offen  lds
  s_add_u32 m0, s53, 68608
  s_nop 0
  buffer_load_dwordx4 v9, s[12:15], s21 offen  lds
  s_add_u32 s20, s20, 128
  s_add_u32 s21, s21, s51
  s_add_u32 m0, s52, 98304
  s_nop 0
  buffer_load_dwordx4 v2, s[8:11], s20 offen  lds
  s_add_u32 m0, s53, 98304
  s_nop 0
  buffer_load_dwordx4 v6, s[12:15], s21 offen  lds
  s_add_u32 m0, s52, 99328
  s_nop 0
  buffer_load_dwordx4 v3, s[8:11], s20 offen  lds
  s_add_u32 m0, s53, 99328
  s_nop 0
  buffer_load_dwordx4 v7, s[12:15], s21 offen  lds
  s_add_u32 m0, s52, 100352
  s_nop 0
  buffer_load_dwordx4 v4, s[8:11], s20 offen  lds
  s_add_u32 m0, s53, 100352
  s_nop 0
  buffer_load_dwordx4 v8, s[12:15], s21 offen  lds
  s_add_u32 m0, s52, 101376
  s_nop 0
  buffer_load_dwordx4 v5, s[8:11], s20 offen  lds
  s_add_u32 m0, s53, 101376
  s_nop 0
  buffer_load_dwordx4 v9, s[12:15], s21 offen  lds
  s_add_u32 s20, s20, 128
  s_add_u32 s21, s21, s51
  s_lshr_b32 s90, s27, 1
  s_and_b32 s91, s27, 1
  s_mul_i32 s92, s90, 8192
  v_mov_b32 v22, 0x0
  v_bfe_u32 v23, v1, 0, 4
  v_lshl_add_u32 v22, v23, 7, v22
  v_add_u32 v22, s92, v22
  v_lshrrev_b32 v23, 1, v1
  v_and_b32 v23, 7, v23
  v_lshrrev_b32 v24, 4, v1
  v_xor_b32 v23, v23, v24
  v_lshl_add_u32 v10, v23, 4, v22
  v_xor_b32 v11, 64, v10
  v_add_u32 v12, 65536, v10
  v_add_u32 v13, 65536, v11
  v_mov_b32 v22, 0x0
  v_bfe_u32 v23, v1, 2, 2
  v_lshl_add_u32 v22, v23, 8, v22
  v_bfe_u32 v23, v1, 4, 2
  v_lshl_add_u32 v22, v23, 11, v22
  v_bfe_u32 v23, v1, 0, 2
  v_lshl_add_u32 v22, v23, 3, v22
  v_bfe_u32 v24, v1, 2, 3
  s_mul_i32 s92, s91, 4
  s_add_u32 s93, s92, 0
  v_xor_b32 v23, s93, v24
  v_lshl_add_u32 v14, v23, 5, v22
  v_add_u32 v18, 65536, v14
  s_add_u32 s93, s92, 1
  v_xor_b32 v23, s93, v24
  v_lshl_add_u32 v15, v23, 5, v22
  v_add_u32 v19, 65536, v15
  s_add_u32 s93, s92, 2
  v_xor_b32 v23, s93, v24
  v_lshl_add_u32 v16, v23, 5, v22
  v_add_u32 v20, 65536, v16
  s_add_u32 s93, s92, 3
  v_xor_b32 v23, s93, v24
  v_lshl_add_u32 v17, v23, 5, v22
  v_add_u32 v21, 65536, v17
  s_mov_b32 s58, 2
  s_branch L_epi
L_r2:
  v_lshlrev_b32 v174, 7, v1
  s_sub_u32 s42, s34, 32
  s_lshl_b32 s40, s42, 2
  s_add_u32 s40, s40, s33
  s_lshl_b32 s40, s40, 2
  s_add_u32 s40, s40, s32
  s_lshl_b32 s40, s40, 13
  s_cmp_ge_u32 s42, 16
  s_cselect_b32 s40, 0x40000000, s40
  s_add_u32 s41, s40, 2097152
  s_mov_b32 s44, s64
  s_and_b32 s45, s65, 0xffff
  s_mov_b32 s46, 0x400000
  s_mov_b32 s47, 0x20000
  buffer_load_dword v175, v174, s[44:47], s40 offen
  s_mov_b32 s44, s64
  s_and_b32 s45, s65, 0xffff
  s_mov_b32 s46, 0x400000
  s_mov_b32 s47, 0x20000
  buffer_load_dword v175, v174, s[44:47], s41 offen
  s_cmp_eq_u32 s35, 10
  s_cbranch_scc1 L_g5
  s_waitcnt vmcnt(26)
  s_barrier
  ds_read_b128 v[28:31], v10 offset:0
  ds_read_b64_tr_b16 v[60:61], v14 offset:16384
  ds_read_b64_tr_b16 v[62:63], v14 offset:17408
  ds_read_b128 v[32:35], v10 offset:2048
  ds_read_b64_tr_b16 v[64:65], v15 offset:16384
  ds_read_b64_tr_b16 v[66:67], v15 offset:17408
  ds_read_b128 v[36:39], v10 offset:4096
  ds_read_b64_tr_b16 v[68:69], v16 offset:16384
  ds_read_b64_tr_b16 v[70:71], v16 offset:17408
  ds_read_b128 v[40:43], v10 offset:6144
  ds_read_b64_tr_b16 v[72:73], v17 offset:16384
  ds_read_b64_tr_b16 v[74:75], v17 offset:17408
  s_sub_u32 s25, s25, 1
  s_waitcnt lgkmcnt(0)
  v_mfma_f32_16x16x32_bf16 a[0:3], v[60:63], v[28:31], 0
  ds_read_b128 v[44:47], v11 offset:0
  v_mfma_f32_16x16x32_bf16 a[4:7], v[64:67], v[28:31], 0
  ds_read_b64_tr_b16 v[76:77], v14 offset:24576
  v_mfma_f32_16x16x32_bf16 a[8:11], v[68:71], v[28:31], 0
  ds_read_b64_tr_b16 v[78:79], v14 offset:25600
  v_mfma_f32_16x16x32_bf16 a[12:15], v[72:75], v[28:31], 0
  ds_read_b128 v[48:51], v11 offset:2048
  v_mfma_f32_16x16x32_bf16 a[16:19], v[60:63], v[32:35], 0
  ds_read_b64_tr_b16 v[80:81], v15 offset:24576
  v_mfma_f32_16x16x32_bf16 a[20:23], v[64:67], v[32:35], 0
  ds_read_b64_tr_b16 v[82:83], v15 offset:25600
  v_mfma_f32_16x16x32_bf16 a[24:27], v[68:71], v[32:35], 0
  ds_read_b128 v[52:55], v11 offset:4096
  v_mfma_f32_16x16x32_bf16 a[28:31], v[72:75], v[32:35], 0
  ds_read_b64_tr_b16 v[84:85], v16 offset:24576
  v_mfma_f32_16x16x32_bf16 a[32:35], v[60:63], v[36:39], 0
  ds_read_b64_tr_b16 v[86:87], v16 offset:25600
  v_mfma_f32_16x16x32_bf16 a[36:39], v[64:67], v[36:39], 0
  ds_read_b128 v[56:59], v11 offset:6144
  v_mfma_f32_16x16x32_bf16 a[40:43], v[68:71], v[36:39], 0
  ds_read_b64_tr_b16 v[88:89], v17 offset:24576
  v_mfma_f32_16x16x32_bf16 a[44:47], v[72:75], v[36:39], 0
  ds_read_b64_tr_b16 v[90:91], v17 offset:25600
  v_mfma_f32_16x16x32_bf16 a[48:51], v[60:63], v[40:43], 0
  v_mfma_f32_16x16x32_bf16 a[52:55], v[64:67], v[40:43], 0
  v_mfma_f32_16x16x32_bf16 a[56:59], v[68:71], v[40:43], 0
  v_mfma_f32_16x16x32_bf16 a[60:63], v[72:75], v[40:43], 0
  s_waitcnt lgkmcnt(0)
  v_mfma_f32_16x16x32_bf16 a[0:3], v[76:79], v[44:47], a[0:3]
  s_waitcnt vmcnt(18)
  s_barrier
  s_add_u32 m0, s52, 0
  v_mfma_f32_16x16x32_bf16 a[4:7], v[80:83], v[44:47], a[4:7]
  buffer_load_dwordx4 v2, s[8:11], s20 offen  lds
  ds_read_b128 v[28:31], v10 offset:32768
  v_mfma_f32_16x16x32_bf16 a[8:11], v[84:87], v[44:47], a[8:11]
  ds_read_b64_tr_b16 v[60:61], v14 offset:49152
  v_mfma_f32_16x16x32_bf16 a[12:15], v[88:91], v[44:47], a[12:15]
  ds_read_b64_tr_b16 v[62:63], v14 offset:50176
  s_add_u32 m0, s53, 0
  v_mfma_f32_16x16x32_bf16 a[16:19], v[76:79], v[48:51], a[16:19]
  buffer_load_dwordx4 v6, s[12:15], s21 offen  lds
  ds_read_b128 v[32:35], v10 offset:34816
  v_mfma_f32_16x16x32_bf16 a[20:23], v[80:83], v[48:51], a[20:23]
  ds_read_b64_tr_b16 v[64:65], v15 offset:49152
  v_mfma_f32_16x16x32_bf16 a[24:27], v[84:87], v[48:51], a[24:27]
  ds_read_b64_tr_b16 v[66:67], v15 offset:50176
  s_add_u32 m0, s52, 1024
  v_mfma_f32_16x16x32_bf16 a[28:31], v[88:91], v[48:51], a[28:31]
  buffer_load_dwordx4 v3, s[8:11], s20 offen  lds
  ds_read_b128 v[36:39], v10 offset:36864
  v_mfma_f32_16x16x32_bf16 a[32:35], v[76:79], v[52:55], a[32:35]
  ds_read_b64_tr_b16 v[68:69], v16 offset:49152
  v_mfma_f32_16x16x32_bf16 a[36:39], v[80:83], v[52:55], a[36:39]
  ds_read_b64_tr_b16 v[70:71], v16 offset:50176
  s_add_u32 m0, s53, 1024
  v_mfma_f32_16x16x32_bf16 a[40:43], v[84:87], v[52:55], a[40:43]
  buffer_load_dwordx4 v7, s[12:15], s21 offen  lds
  ds_read_b128 v[40:43], v10 offset:38912
  v_mfma_f32_16x16x32_bf16 a[44:47], v[88:91], v[52:55], a[44:47]
  ds_read_b64_tr_b16 v[72:73], v17 offset:49152
  v_mfma_f32_16x16x32_bf16 a[48:51], v[76:79], v[56:59], a[48:51]
  ds_read_b64_tr_b16 v[74:75], v17 offset:50176
  s_add_u32 m0, s52, 2048
  v_mfma_f32_16x16x32_bf16 a[52:55], v[80:83], v[56:59], a[52:55]
  buffer_load_dwordx4 v4, s[8:11], s20 offen  lds
  v_mfma_f32_16x16x32_bf16 a[56:59], v[84:87], v[56:59], a[56:59]
  v_mfma_f32_16x16x32_bf16 a[60:63], v[88:91], v[56:59], a[60:63]
  s_waitcnt lgkmcnt(0)
  s_add_u32 m0, s53, 2048
  v_mfma_f32_16x16x32_bf16 a[0:3], v[60:63], v[28:31], a[0:3]
  buffer_load_dwordx4 v8, s[12:15], s21 offen  lds
  ds_read_b128 v[44:47], v11 offset:32768
  v_mfma_f32_16x16x32_bf16 a[4:7], v[64:67], v[28:31], a[4:7]
  ds_read_b64_tr_b16 v[76:77], v14 offset:57344
  v_mfma_f32_16x16x32_bf16 a[8:11], v[68:71], v[28:31], a[8:11]
  ds_read_b64_tr_b16 v[78:79], v14 offset:58368
  v_mfma_f32_16x16x32_bf16 a[12:15], v[72:75], v[28:31], a[12:15]
  ds_read_b128 v[48:51], v11 offset:34816
  s_add_u32 m0, s52, 3072
  v_mfma_f32_16x16x32_bf16 a[16:19], v[60:63], v[32:35], a[16:19]
  buffer_load_dwordx4 v5, s[8:11], s20 offen  lds
  ds_read_b64_tr_b16 v[80:81], v15 offset:57344
  v_mfma_f32_16x16x32_bf16 a[20:23], v[64:67], v[32:35], a[20:23]
  ds_read_b64_tr_b16 v[82:83], v15 offset:58368
  v_mfma_f32_16x16x32_bf16 a[24:27], v[68:71], v[32:35], a[24:27]
  ds_read_b128 v[52:55], v11 offset:36864
  v_mfma_f32_16x16x32_bf16 a[28:31], v[72:75], v[32:35], a[28:31]
  ds_read_b64_tr_b16 v[84:85], v16 offset:57344
  s_add_u32 m0, s53, 3072
  v_mfma_f32_16x16x32_bf16 a[32:35], v[60:63], v[36:39], a[32:35]
  buffer_load_dwordx4 v9, s[12:15], s21 offen  lds
  ds_read_b64_tr_b16 v[86:87], v16 offset:58368
  v_mfma_f32_16x16x32_bf16 a[36:39], v[64:67], v[36:39], a[36:39]
  ds_read_b128 v[56:59], v11 offset:38912
  v_mfma_f32_16x16x32_bf16 a[40:43], v[68:71], v[36:39], a[40:43]
  ds_read_b64_tr_b16 v[88:89], v17 offset:57344
  v_mfma_f32_16x16x32_bf16 a[44:47], v[72:75], v[36:39], a[44:47]
  ds_read_b64_tr_b16 v[90:91], v17 offset:58368
  s_add_u32 s20, s20, 128
  v_mfma_f32_16x16x32_bf16 a[48:51], v[60:63], v[40:43], a[48:51]
  s_add_u32 s21, s21, s51
  v_mfma_f32_16x16x32_bf16 a[52:55], v[64:67], v[40:43], a[52:55]
  v_mfma_f32_16x16x32_bf16 a[56:59], v[68:71], v[40:43], a[56:59]
  v_mfma_f32_16x16x32_bf16 a[60:63], v[72:75], v[40:43], a[60:63]
  s_waitcnt lgkmcnt(0)
  v_mfma_f32_16x16x32_bf16 a[0:3], v[76:79], v[44:47], a[0:3]
  s_waitcnt vmcnt(18)
  s_barrier
  s_add_u32 m0, s52, 32768
  v_mfma_f32_16x16x32_bf16 a[4:7], v[80:83], v[44:47], a[4:7]
  buffer_load_dwordx4 v2, s[8:11], s20 offen  lds
  ds_read_b128 v[28:31], v12 offset:0
  v_mfma_f32_16x16x32_bf16 a[8:11], v[84:87], v[44:47], a[8:11]
  ds_read_b64_tr_b16 v[60:61], v18 offset:16384
  v_mfma_f32_16x16x32_bf16 a[12:15], v[88:91], v[44:47], a[12:15]
  ds_read_b64_tr_b16 v[62:63], v18 offset:17408
  s_add_u32 m0, s53, 32768
  v_mfma_f32_16x16x32_bf16 a[16:19], v[76:79], v[48:51], a[16:19]
  buffer_load_dwordx4 v6, s[12:15], s21 offen  lds
  ds_read_b128 v[32:35], v12 offset:2048
  v_mfma_f32_16x16x32_bf16 a[20:23], v[80:83], v[48:51], a[20:23]
  ds_read_b64_tr_b16 v[64:65], v19 offset:16384
  v_mfma_f32_16x16x32_bf16 a[24:27], v[84:87], v[48:51], a[24:27]
  ds_read_b64_tr_b16 v[66:67], v19 offset:17408
  s_add_u32 m0, s52, 33792
  v_mfma_f32_16x16x32_bf16 a[28:31], v[88:91], v[48:51], a[28:31]
  buffer_load_dwordx4 v3, s[8:11], s20 offen  lds
  ds_read_b128 v[36:39], v12 offset:4096
  v_mfma_f32_16x16x32_bf16 a[32:35], v[76:79], v[52:55], a[32:35]
  ds_read_b64_tr_b16 v[68:69], v20 offset:16384
  v_mfma_f32_16x16x32_bf16 a[36:39], v[80:83], v[52:55], a[36:39]
  ds_read_b64_tr_b16 v[70:71], v20 offset:17408
  s_add_u32 m0, s53, 33792
  v_mfma_f32_16x16x32_bf16 a[40:43], v[84:87], v[52:55], a[40:43]
  buffer_load_dwordx4 v7, s[12:15], s21 offen  lds
  ds_read_b128 v[40:43], v12 offset:6144
  v_mfma_f32_16x16x32_bf16 a[44:47], v[88:91], v[52:55], a[44:47]
  ds_read_b64_tr_b16 v[72:73], v21 offset:16384
  v_mfma_f32_16x16x32_bf16 a[48:51], v[76:79], v[56:59], a[48:51]
  ds_read_b64_tr_b16 v[74:75], v21 offset:17408
  s_add_u32 m0, s52, 34816
  v_mfma_f32_16x16x32_bf16 a[52:55], v[80:83], v[56:59], a[52:55]
  buffer_load_dwordx4 v4, s[8:11], s20 offen  lds
  v_mfma_f32_16x16x32_bf16 a[56:59], v[84:87], v[56:59], a[56:59]
  v_mfma_f32_16x16x32_bf16 a[60:63], v[88:91], v[56:59], a[60:63]
  s_waitcnt lgkmcnt(0)
  s_add_u32 m0, s53, 34816
  v_mfma_f32_16x16x32_bf16 a[0:3], v[60:63], v[28:31], a[0:3]
  buffer_load_dwordx4 v8, s[12:15], s21 offen  lds
  ds_read_b128 v[44:47], v13 offset:0
  v_mfma_f32_16x16x32_bf16 a[4:7], v[64:67], v[28:31], a[4:7]
  ds_read_b64_tr_b16 v[76:77], v18 offset:24576
  v_mfma_f32_16x16x32_bf16 a[8:11], v[68:71], v[28:31], a[8:11]
  ds_read_b64_tr_b16 v[78:79], v18 offset:25600
  v_mfma_f32_16x16x32_bf16 a[12:15], v[72:75], v[28:31], a[12:15]
  ds_read_b128 v[48:51], v13 offset:2048
  s_add_u32 m0, s52, 35840
  v_mfma_f32_16x16x32_bf16 a[16:19], v[60:63], v[32:35], a[16:19]
  buffer_load_dwordx4 v5, s[8:11], s20 offen  lds
  ds_read_b64_tr_b16 v[80:81], v19 offset:24576
  v_mfma_f32_16x16x32_bf16 a[20:23], v[64:67], v[32:35], a[20:23]
  ds_read_b64_tr_b16 v[82:83], v19 offset:25600
  v_mfma_f32_16x16x32_bf16 a[24:27], v[68:71], v[32:35], a[24:27]
  ds_read_b128 v[52:55], v13 offset:4096
  v_mfma_f32_16x16x32_bf16 a[28:31], v[72:75], v[32:35], a[28:31]
  ds_read_b64_tr_b16 v[84:85], v20 offset:24576
  s_add_u32 m0, s53, 35840
  v_mfma_f32_16x16x32_bf16 a[32:35], v[60:63], v[36:39], a[32:35]
  buffer_load_dwordx4 v9, s[12:15], s21 offen  lds
  ds_read_b64_tr_b16 v[86:87], v20 offset:25600
  v_mfma_f32_16x16x32_bf16 a[36:39], v[64:67], v[36:39], a[36:39]
  ds_read_b128 v[56:59], v13 offset:6144
  v_mfma_f32_16x16x32_bf16 a[40:43], v[68:71], v[36:39], a[40:43]
  ds_read_b64_tr_b16 v[88:89], v21 offset:24576
  v_mfma_f32_16x16x32_bf16 a[44:47], v[72:75], v[36:39], a[44:47]
  ds_read_b64_tr_b16 v[90:91], v21 offset:25600
  s_add_u32 s20, s20, 128
  v_mfma_f32_16x16x32_bf16 a[48:51], v[60:63], v[40:43], a[48:51]
  s_add_u32 s21, s21, s51
  v_mfma_f32_16x16x32_bf16 a[52:55], v[64:67], v[40:43], a[52:55]
  v_mfma_f32_16x16x32_bf16 a[56:59], v[68:71], v[40:43], a[56:59]
  v_mfma_f32_16x16x32_bf16 a[60:63], v[72:75], v[40:43], a[60:63]
  s_waitcnt lgkmcnt(0)
  v_mfma_f32_16x16x32_bf16 a[0:3], v[76:79], v[44:47], a[0:3]
  s_waitcnt vmcnt(18)
  s_barrier
  s_add_u32 m0, s52, 65536
  v_mfma_f32_16x16x32_bf16 a[4:7], v[80:83], v[44:47], a[4:7]
  buffer_load_dwordx4 v2, s[8:11], s20 offen  lds
  ds_read_b128 v[28:31], v12 offset:32768
  v_mfma_f32_16x16x32_bf16 a[8:11], v[84:87], v[44:47], a[8:11]
  ds_read_b64_tr_b16 v[60:61], v18 offset:49152
  v_mfma_f32_16x16x32_bf16 a[12:15], v[88:91], v[44:47], a[12:15]
  ds_read_b64_tr_b16 v[62:63], v18 offset:50176
  s_add_u32 m0, s53, 65536
  v_mfma_f32_16x16x32_bf16 a[16:19], v[76:79], v[48:51], a[16:19]
  buffer_load_dwordx4 v6, s[12:15], s21 offen  lds
  ds_read_b128 v[32:35], v12 offset:34816
  v_mfma_f32_16x16x32_bf16 a[20:23], v[80:83], v[48:51], a[20:23]
  ds_read_b64_tr_b16 v[64:65], v19 offset:49152
  v_mfma_f32_16x16x32_bf16 a[24:27], v[84:87], v[48:51], a[24:27]
  ds_read_b64_tr_b16 v[66:67], v19 offset:50176
  s_add_u32 m0, s52, 66560
  v_mfma_f32_16x16x32_bf16 a[28:31], v[88:91], v[48:51], a[28:31]
  buffer_load_dwordx4 v3, s[8:11], s20 offen  lds
  ds_read_b128 v[36:39], v12 offset:36864
  v_mfma_f32_16x16x32_bf16 a[32:35], v[76:79], v[52:55], a[32:35]
  ds_read_b64_tr_b16 v[68:69], v20 offset:49152
  v_mfma_f32_16x16x32_bf16 a[36:39], v[80:83], v[52:55], a[36:39]
  ds_read_b64_tr_b16 v[70:71], v20 offset:50176
  s_add_u32 m0, s53, 66560
  v_mfma_f32_16x16x32_bf16 a[40:43], v[84:87], v[52:55], a[40:43]
  buffer_load_dwordx4 v7, s[12:15], s21 offen  lds
  ds_read_b128 v[40:43], v12 offset:38912
  v_mfma_f32_16x16x32_bf16 a[44:47], v[88:91], v[52:55], a[44:47]
  ds_read_b64_tr_b16 v[72:73], v21 offset:49152
  v_mfma_f32_16x16x32_bf16 a[48:51], v[76:79], v[56:59], a[48:51]
  ds_read_b64_tr_b16 v[74:75], v21 offset:50176
  s_add_u32 m0, s52, 67584
  v_mfma_f32_16x16x32_bf16 a[52:55], v[80:83], v[56:59], a[52:55]
  buffer_load_dwordx4 v4, s[8:11], s20 offen  lds
  v_mfma_f32_16x16x32_bf16 a[56:59], v[84:87], v[56:59], a[56:59]
  v_mfma_f32_16x16x32_bf16 a[60:63], v[88:91], v[56:59], a[60:63]
  s_waitcnt lgkmcnt(0)
  s_add_u32 m0, s53, 67584
  v_mfma_f32_16x16x32_bf16 a[0:3], v[60:63], v[28:31], a[0:3]
  buffer_load_dwordx4 v8, s[12:15], s21 offen  lds
  ds_read_b128 v[44:47], v13 offset:32768
  v_mfma_f32_16x16x32_bf16 a[4:7], v[64:67], v[28:31], a[4:7]
  ds_read_b64_tr_b16 v[76:77], v18 offset:57344
  v_mfma_f32_16x16x32_bf16 a[8:11], v[68:71], v[28:31], a[8:11]
  ds_read_b64_tr_b16 v[78:79], v18 offset:58368
  v_mfma_f32_16x16x32_bf16 a[12:15], v[72:75], v[28:31], a[12:15]
  ds_read_b128 v[48:51], v13 offset:34816
  s_add_u32 m0, s52, 68608
  v_mfma_f32_16x16x32_bf16 a[16:19], v[60:63], v[32:35], a[16:19]
  buffer_load_dwordx4 v5, s[8:11], s20 offen  lds
  ds_read_b64_tr_b16 v[80:81], v19 offset:57344
  v_mfma_f32_16x16x32_bf16 a[20:23], v[64:67], v[32:35], a[20:23]
  ds_read_b64_tr_b16 v[82:83], v19 offset:58368
  v_mfma_f32_16x16x32_bf16 a[24:27], v[68:71], v[32:35], a[24:27]
  ds_read_b128 v[52:55], v13 offset:36864
  v_mfma_f32_16x16x32_bf16 a[28:31], v[72:75], v[32:35], a[28:31]
  ds_read_b64_tr_b16 v[84:85], v20 offset:57344
  s_add_u32 m0, s53, 68608
  v_mfma_f32_16x16x32_bf16 a[32:35], v[60:63], v[36:39], a[32:35]
  buffer_load_dwordx4 v9, s[12:15], s21 offen  lds
  ds_read_b64_tr_b16 v[86:87], v20 offset:58368
  v_mfma_f32_16x16x32_bf16 a[36:39], v[64:67], v[36:39], a[36:39]
  ds_read_b128 v[56:59], v13 offset:38912
  v_mfma_f32_16x16x32_bf16 a[40:43], v[68:71], v[36:39], a[40:43]
  ds_read_b64_tr_b16 v[88:89], v21 offset:57344
  v_mfma_f32_16x16x32_bf16 a[44:47], v[72:75], v[36:39], a[44:47]
  ds_read_b64_tr_b16 v[90:91], v21 offset:58368
  s_add_u32 s20, s20, 128
  v_mfma_f32_16x16x32_bf16 a[48:51], v[60:63], v[40:43], a[48:51]
  s_add_u32 s21, s21, s51
  v_mfma_f32_16x16x32_bf16 a[52:55], v[64:67], v[40:43], a[52:55]
  v_mfma_f32_16x16x32_bf16 a[56:59], v[68:71], v[40:43], a[56:59]
  v_mfma_f32_16x16x32_bf16 a[60:63], v[72:75], v[40:43], a[60:63]
  s_waitcnt lgkmcnt(0)
  v_mfma_f32_16x16x32_bf16 a[0:3], v[76:79], v[44:47], a[0:3]
  s_waitcnt vmcnt(16)
  s_barrier
  s_add_u32 m0, s52, 98304
  v_mfma_f32_16x16x32_bf16 a[4:7], v[80:83], v[44:47], a[4:7]
  buffer_load_dwordx4 v2, s[8:11], s20 offen  lds
  ds_read_b128 v[28:31], v10 offset:0
  v_mfma_f32_16x16x32_bf16 a[8:11], v[84:87], v[44:47], a[8:11]
  ds_read_b64_tr_b16 v[60:61], v14 offset:16384
  v_mfma_f32_16x16x32_bf16 a[12:15], v[88:91], v[44:47], a[12:15]
  ds_read_b64_tr_b16 v[62:63], v14 offset:17408
  s_add_u32 m0, s53, 98304
  v_mfma_f32_16x16x32_bf16 a[16:19], v[76:79], v[48:51], a[16:19]
  buffer_load_dwordx4 v6, s[12:15], s21 offen  lds
  ds_read_b128 v[32:35], v10 offset:2048
  v_mfma_f32_16x16x32_bf16 a[20:23], v[80:83], v[48:51], a[20:23]
  ds_read_b64_tr_b16 v[64:65], v15 offset:16384
  v_mfma_f32_16x16x32_bf16 a[24:27], v[84:87], v[48:51], a[24:27]
  ds_read_b64_tr_b16 v[66:67], v15 offset:17408
  s_add_u32 m0, s52, 99328
  v_mfma_f32_16x16x32_bf16 a[28:31], v[88:91], v[48:51], a[28:31]
  buffer_load_dwordx4 v3, s[8:11], s20 offen  lds
  ds_read_b128 v[36:39], v10 offset:4096
  v_mfma_f32_16x16x32_bf16 a[32:35], v[76:79], v[52:55], a[32:35]
  ds_read_b64_tr_b16 v[68:69], v16 offset:16384
  v_mfma_f32_16x16x32_bf16 a[36:39], v[80:83], v[52:55], a[36:39]
  ds_read_b64_tr_b16 v[70:71], v16 offset:17408
  s_add_u32 m0, s53, 99328
  v_mfma_f32_16x16x32_bf16 a[40:43], v[84:87], v[52:55], a[40:43]
  buffer_load_dwordx4 v7, s[12:15], s21 offen  lds
  ds_read_b128 v[40:43], v10 offset:6144
  v_mfma_f32_16x16x32_bf16 a[44:47], v[88:91], v[52:55], a[44:47]
  ds_read_b64_tr_b16 v[72:73], v17 offset:16384
  v_mfma_f32_16x16x32_bf16 a[48:51], v[76:79], v[56:59], a[48:51]
  ds_read_b64_tr_b16 v[74:75], v17 offset:17408
  s_add_u32 m0, s52, 100352
  v_mfma_f32_16x16x32_bf16 a[52:55], v[80:83], v[56:59], a[52:55]
  buffer_load_dwordx4 v4, s[8:11], s20 offen  lds
  v_mfma_f32_16x16x32_bf16 a[56:59], v[84:87], v[56:59], a[56:59]
  v_mfma_f32_16x16x32_bf16 a[60:63], v[88:91], v[56:59], a[60:63]
L_g4_loop:
  s_sub_u32 s25, s25, 1
  s_cmp_eq_u32 s25, 0
  s_cbranch_scc1 L_g4_fin
  s_waitcnt lgkmcnt(0)
  s_add_u32 m0, s53, 100352
  v_mfma_f32_16x16x32_bf16 a[0:3], v[60:63], v[28:31], a[0:3]
  buffer_load_dwordx4 v8, s[12:15], s21 offen  lds
  ds_read_b128 v[44:47], v11 offset:0
  v_mfma_f32_16x16x32_bf16 a[4:7], v[64:67], v[28:31], a[4:7]
  ds_read_b64_tr_b16 v[76:77], v14 offset:24576
  v_mfma_f32_16x16x32_bf16 a[8:11], v[68:71], v[28:31], a[8:11]
  ds_read_b64_tr_b16 v[78:79], v14 offset:25600
  v_mfma_f32_16x16x32_bf16 a[12:15], v[72:75], v[28:31], a[12:15]
  ds_read_b128 v[48:51], v11 offset:2048
  s_add_u32 m0, s52, 101376
  v_mfma_f32_16x16x32_bf16 a[16:19], v[60:63], v[32:35], a[16:19]
  buffer_load_dwordx4 v5, s[8:11], s20 offen  lds
  ds_read_b64_tr_b16 v[80:81], v15 offset:24576
  v_mfma_f32_16x16x32_bf16 a[20:23], v[64:67], v[32:35], a[20:23]
  ds_read_b64_tr_b16 v[82:83], v15 offset:25600
  v_mfma_f32_16x16x32_bf16 a[24:27], v[68:71], v[32:35], a[24:27]
  ds_read_b128 v[52:55], v11 offset:4096
  v_mfma_f32_16x16x32_bf16 a[28:31], v[72:75], v[32:35], a[28:31]
  ds_read_b64_tr_b16 v[84:85], v16 offset:24576
  s_add_u32 m0, s53, 101376
  v_mfma_f32_16x16x32_bf16 a[32:35], v[60:63], v[36:39], a[32:35]
  buffer_load_dwordx4 v9, s[12:15], s21 offen  lds
  ds_read_b64_tr_b16 v[86:87], v16 offset:25600
  v_mfma_f32_16x16x32_bf16 a[36:39], v[64:67], v[36:39], a[36:39]
  ds_read_b128 v[56:59], v11 offset:6144
  v_mfma_f32_16x16x32_bf16 a[40:43], v[68:71], v[36:39], a[40:43]
  ds_read_b64_tr_b16 v[88:89], v17 offset:24576
  v_mfma_f32_16x16x32_bf16 a[44:47], v[72:75], v[36:39], a[44:47]
  ds_read_b64_tr_b16 v[90:91], v17 offset:25600
  s_add_u32 s20, s20, 128
  v_mfma_f32_16x16x32_bf16 a[48:51], v[60:63], v[40:43], a[48:51]
  s_add_u32 s21, s21, s51
  v_mfma_f32_16x16x32_bf16 a[52:55], v[64:67], v[40:43], a[52:55]
  v_mfma_f32_16x16x32_bf16 a[56:59], v[68:71], v[40:43], a[56:59]
  v_mfma_f32_16x16x32_bf16 a[60:63], v[72:75], v[40:43], a[60:63]
  s_waitcnt lgkmcnt(0)
  v_mfma_f32_16x16x32_bf16 a[0:3], v[76:79], v[44:47], a[0:3]
  s_waitcnt vmcnt(16)
  s_barrier
  s_add_u32 m0, s52, 0
  v_mfma_f32_16x16x32_bf16 a[4:7], v[80:83], v[44:47], a[4:7]
  buffer_load_dwordx4 v2, s[8:11], s20 offen  lds
  ds_read_b128 v[28:31], v10 offset:32768
  v_mfma_f32_16x16x32_bf16 a[8:11], v[84:87], v[44:47], a[8:11]
  ds_read_b64_tr_b16 v[60:61], v14 offset:49152
  v_mfma_f32_16x16x32_bf16 a[12:15], v[88:91], v[44:47], a[12:15]
  ds_read_b64_tr_b16 v[62:63], v14 offset:50176
  s_add_u32 m0, s53, 0
  v_mfma_f32_16x16x32_bf16 a[16:19], v[76:79], v[48:51], a[16:19]
  buffer_load_dwordx4 v6, s[12:15], s21 offen  lds
  ds_read_b128 v[32:35], v10 offset:34816
  v_mfma_f32_16x16x32_bf16 a[20:23], v[80:83], v[48:51], a[20:23]
  ds_read_b64_tr_b16 v[64:65], v15 offset:49152
  v_mfma_f32_16x16x32_bf16 a[24:27], v[84:87], v[48:51], a[24:27]
  ds_read_b64_tr_b16 v[66:67], v15 offset:50176
  s_add_u32 m0, s52, 1024
  v_mfma_f32_16x16x32_bf16 a[28:31], v[88:91], v[48:51], a[28:31]
  buffer_load_dwordx4 v3, s[8:11], s20 offen  lds
  ds_read_b128 v[36:39], v10 offset:36864
  v_mfma_f32_16x16x32_bf16 a[32:35], v[76:79], v[52:55], a[32:35]
  ds_read_b64_tr_b16 v[68:69], v16 offset:49152
  v_mfma_f32_16x16x32_bf16 a[36:39], v[80:83], v[52:55], a[36:39]
  ds_read_b64_tr_b16 v[70:71], v16 offset:50176
  s_add_u32 m0, s53, 1024
  v_mfma_f32_16x16x32_bf16 a[40:43], v[84:87], v[52:55], a[40:43]
  buffer_load_dwordx4 v7, s[12:15], s21 offen  lds
  ds_read_b128 v[40:43], v10 offset:38912
  v_mfma_f32_16x16x32_bf16 a[44:47], v[88:91], v[52:55], a[44:47]
  ds_read_b64_tr_b16 v[72:73], v17 offset:49152
  v_mfma_f32_16x16x32_bf16 a[48:51], v[76:79], v[56:59], a[48:51]
  ds_read_b64_tr_b16 v[74:75], v17 offset:50176
  s_add_u32 m0, s52, 2048
  v_mfma_f32_16x16x32_bf16 a[52:55], v[80:83], v[56:59], a[52:55]
  buffer_load_dwordx4 v4, s[8:11], s20 offen  lds
  v_mfma_f32_16x16x32_bf16 a[56:59], v[84:87], v[56:59], a[56:59]
  v_mfma_f32_16x16x32_bf16 a[60:63], v[88:91], v[56:59], a[60:63]
  s_waitcnt lgkmcnt(0)
  s_add_u32 m0, s53, 2048
  v_mfma_f32_16x16x32_bf16 a[0:3], v[60:63], v[28:31], a[0:3]
  buffer_load_dwordx4 v8, s[12:15], s21 offen  lds
  ds_read_b128 v[44:47], v11 offset:32768
  v_mfma_f32_16x16x32_bf16 a[4:7], v[64:67], v[28:31], a[4:7]
  ds_read_b64_tr_b16 v[76:77], v14 offset:57344
  v_mfma_f32_16x16x32_bf16 a[8:11], v[68:71], v[28:31], a[8:11]
  ds_read_b64_tr_b16 v[78:79], v14 offset:58368
  v_mfma_f32_16x16x32_bf16 a[12:15], v[72:75], v[28:31], a[12:15]
  ds_read_b128 v[48:51], v11 offset:34816
  s_add_u32 m0, s52, 3072
  v_mfma_f32_16x16x32_bf16 a[16:19], v[60:63], v[32:35], a[16:19]
  buffer_load_dwordx4 v5, s[8:11], s20 offen  lds
  ds_read_b64_tr_b16 v[80:81], v15 offset:57344
  v_mfma_f32_16x16x32_bf16 a[20:23], v[64:67], v[32:35], a[20:23]
  ds_read_b64_tr_b16 v[82:83], v15 offset:58368
  v_mfma_f32_16x16x32_bf16 a[24:27], v[68:71], v[32:35], a[24:27]
  ds_read_b128 v[52:55], v11 offset:36864
  v_mfma_f32_16x16x32_bf16 a[28:31], v[72:75], v[32:35], a[28:31]
  ds_read_b64_tr_b16 v[84:85], v16 offset:57344
  s_add_u32 m0, s53, 3072
  v_mfma_f32_16x16x32_bf16 a[32:35], v[60:63], v[36:39], a[32:35]
  buffer_load_dwordx4 v9, s[12:15], s21 offen  lds
  ds_read_b64_tr_b16 v[86:87], v16 offset:58368
  v_mfma_f32_16x16x32_bf16 a[36:39], v[64:67], v[36:39], a[36:39]
  ds_read_b128 v[56:59], v11 offset:38912
  v_mfma_f32_16x16x32_bf16 a[40:43], v[68:71], v[36:39], a[40:43]
  ds_read_b64_tr_b16 v[88:89], v17 offset:57344
  v_mfma_f32_16x16x32_bf16 a[44:47], v[72:75], v[36:39], a[44:47]
  ds_read_b64_tr_b16 v[90:91], v17 offset:58368
  s_add_u32 s20, s20, 128
  v_mfma_f32_16x16x32_bf16 a[48:51], v[60:63], v[40:43], a[48:51]
  s_add_u32 s21, s21, s51
  v_mfma_f32_16x16x32_bf16 a[52:55], v[64:67], v[40:43], a[52:55]
  v_mfma_f32_16x16x32_bf16 a[56:59], v[68:71], v[40:43], a[56:59]
  v_mfma_f32_16x16x32_bf16 a[60:63], v[72:75], v[40:43], a[60:63]
  s_waitcnt lgkmcnt(0)
  v_mfma_f32_16x16x32_bf16 a[0:3], v[76:79], v[44:47], a[0:3]
  s_waitcnt vmcnt(16)
  s_barrier
  s_add_u32 m0, s52, 32768
  v_mfma_f32_16x16x32_bf16 a[4:7], v[80:83], v[44:47], a[4:7]
  buffer_load_dwordx4 v2, s[8:11], s20 offen  lds
  ds_read_b128 v[28:31], v12 offset:0
  v_mfma_f32_16x16x32_bf16 a[8:11], v[84:87], v[44:47], a[8:11]
  ds_read_b64_tr_b16 v[60:61], v18 offset:16384
  v_mfma_f32_16x16x32_bf16 a[12:15], v[88:91], v[44:47], a[12:15]
  ds_read_b64_tr_b16 v[62:63], v18 offset:17408
  s_add_u32 m0, s53, 32768
  v_mfma_f32_16x16x32_bf16 a[16:19], v[76:79], v[48:51], a[16:19]
  buffer_load_dwordx4 v6, s[12:15], s21 offen  lds
  ds_read_b128 v[32:35], v12 offset:2048
  v_mfma_f32_16x16x32_bf16 a[20:23], v[80:83], v[48:51], a[20:23]
  ds_read_b64_tr_b16 v[64:65], v19 offset:16384
  v_mfma_f32_16x16x32_bf16 a[24:27], v[84:87], v[48:51], a[24:27]
  ds_read_b64_tr_b16 v[66:67], v19 offset:17408
  s_add_u32 m0, s52, 33792
  v_mfma_f32_16x16x32_bf16 a[28:31], v[88:91], v[48:51], a[28:31]
  buffer_load_dwordx4 v3, s[8:11], s20 offen  lds
  ds_read_b128 v[36:39], v12 offset:4096
  v_mfma_f32_16x16x32_bf16 a[32:35], v[76:79], v[52:55], a[32:35]
  ds_read_b64_tr_b16 v[68:69], v20 offset:16384
  v_mfma_f32_16x16x32_bf16 a[36:39], v[80:83], v[52:55], a[36:39]
  ds_read_b64_tr_b16 v[70:71], v20 offset:17408
  s_add_u32 m0, s53, 33792
  v_mfma_f32_16x16x32_bf16 a[40:43], v[84:87], v[52:55], a[40:43]
  buffer_load_dwordx4 v7, s[12:15], s21 offen  lds
  ds_read_b128 v[40:43], v12 offset:6144
  v_mfma_f32_16x16x32_bf16 a[44:47], v[88:91], v[52:55], a[44:47]
  ds_read_b64_tr_b16 v[72:73], v21 offset:16384
  v_mfma_f32_16x16x32_bf16 a[48:51], v[76:79], v[56:59], a[48:51]
  ds_read_b64_tr_b16 v[74:75], v21 offset:17408
  s_add_u32 m0, s52, 34816
  v_mfma_f32_16x16x32_bf16 a[52:55], v[80:83], v[56:59], a[52:55]
  buffer_load_dwordx4 v4, s[8:11], s20 offen  lds
  v_mfma_f32_16x16x32_bf16 a[56:59], v[84:87], v[56:59], a[56:59]
  v_mfma_f32_16x16x32_bf16 a[60:63], v[88:91], v[56:59], a[60:63]
  s_waitcnt lgkmcnt(0)
  s_add_u32 m0, s53, 34816
  v_mfma_f32_16x16x32_bf16 a[0:3], v[60:63], v[28:31], a[0:3]
  buffer_load_dwordx4 v8, s[12:15], s21 offen  lds
  ds_read_b128 v[44:47], v13 offset:0
  v_mfma_f32_16x16x32_bf16 a[4:7], v[64:67], v[28:31], a[4:7]
  ds_read_b64_tr_b16 v[76:77], v18 offset:24576
  v_mfma_f32_16x16x32_bf16 a[8:11], v[68:71], v[28:31], a[8:11]
  ds_read_b64_tr_b16 v[78:79], v18 offset:25600
  v_mfma_f32_16x16x32_bf16 a[12:15], v[72:75], v[28:31], a[12:15]
  ds_read_b128 v[48:51], v13 offset:2048
  s_add_u32 m0, s52, 35840
  v_mfma_f32_16x16x32_bf16 a[16:19], v[60:63], v[32:35], a[16:19]
  buffer_load_dwordx4 v5, s[8:11], s20 offen  lds
  ds_read_b64_tr_b16 v[80:81], v19 offset:24576
  v_mfma_f32_16x16x32_bf16 a[20:23], v[64:67], v[32:35], a[20:23]
  ds_read_b64_tr_b16 v[82:83], v19 offset:25600
  v_mfma_f32_16x16x32_bf16 a[24:27], v[68:71], v[32:35], a[24:27]
  ds_read_b128 v[52:55], v13 offset:4096
  v_mfma_f32_16x16x32_bf16 a[28:31], v[72:75], v[32:35], a[28:31]
  ds_read_b64_tr_b16 v[84:85], v20 offset:24576
  s_add_u32 m0, s53, 35840
  v_mfma_f32_16x16x32_bf16 a[32:35], v[60:63], v[36:39], a[32:35]
  buffer_load_dwordx4 v9, s[12:15], s21 offen  lds
  ds_read_b64_tr_b16 v[86:87], v20 offset:25600
  v_mfma_f32_16x16x32_bf16 a[36:39], v[64:67], v[36:39], a[36:39]
  ds_read_b128 v[56:59], v13 offset:6144
  v_mfma_f32_16x16x32_bf16 a[40:43], v[68:71], v[36:39], a[40:43]
  ds_read_b64_tr_b16 v[88:89], v21 offset:24576
  v_mfma_f32_16x16x32_bf16 a[44:47], v[72:75], v[36:39], a[44:47]
  ds_read_b64_tr_b16 v[90:91], v21 offset:25600
  s_add_u32 s20, s20, 128
  v_mfma_f32_16x16x32_bf16 a[48:51], v[60:63], v[40:43], a[48:51]
  s_add_u32 s21, s21, s51
  v_mfma_f32_16x16x32_bf16 a[52:55], v[64:67], v[40:43], a[52:55]
  v_mfma_f32_16x16x32_bf16 a[56:59], v[68:71], v[40:43], a[56:59]
  v_mfma_f32_16x16x32_bf16 a[60:63], v[72:75], v[40:43], a[60:63]
  s_waitcnt lgkmcnt(0)
  v_mfma_f32_16x16x32_bf16 a[0:3], v[76:79], v[44:47], a[0:3]
  s_waitcnt vmcnt(16)
  s_barrier
  s_add_u32 m0, s52, 65536
  v_mfma_f32_16x16x32_bf16 a[4:7], v[80:83], v[44:47], a[4:7]
  buffer_load_dwordx4 v2, s[8:11], s20 offen  lds
  ds_read_b128 v[28:31], v12 offset:32768
  v_mfma_f32_16x16x32_bf16 a[8:11], v[84:87], v[44:47], a[8:11]
  ds_read_b64_tr_b16 v[60:61], v18 offset:49152
  v_mfma_f32_16x16x32_bf16 a[12:15], v[88:91], v[44:47], a[12:15]
  ds_read_b64_tr_b16 v[62:63], v18 offset:50176
  s_add_u32 m0, s53, 65536
  v_mfma_f32_16x16x32_bf16 a[16:19], v[76:79], v[48:51], a[16:19]
  buffer_load_dwordx4 v6, s[12:15], s21 offen  lds
  ds_read_b128 v[32:35], v12 offset:34816
  v_mfma_f32_16x16x32_bf16 a[20:23], v[80:83], v[48:51], a[20:23]
  ds_read_b64_tr_b16 v[64:65], v19 offset:49152
  v_mfma_f32_16x16x32_bf16 a[24:27], v[84:87], v[48:51], a[24:27]
  ds_read_b64_tr_b16 v[66:67], v19 offset:50176
  s_add_u32 m0, s52, 66560
  v_mfma_f32_16x16x32_bf16 a[28:31], v[88:91], v[48:51], a[28:31]
  buffer_load_dwordx4 v3, s[8:11], s20 offen  lds
  ds_read_b128 v[36:39], v12 offset:36864
  v_mfma_f32_16x16x32_bf16 a[32:35], v[76:79], v[52:55], a[32:35]
  ds_read_b64_tr_b16 v[68:69], v20 offset:49152
  v_mfma_f32_16x16x32_bf16 a[36:39], v[80:83], v[52:55], a[36:39]
  ds_read_b64_tr_b16 v[70:71], v20 offset:50176
  s_add_u32 m0, s53, 66560
  v_mfma_f32_16x16x32_bf16 a[40:43], v[84:87], v[52:55], a[40:43]
  buffer_load_dwordx4 v7, s[12:15], s21 offen  lds
  ds_read_b128 v[40:43], v12 offset:38912
  v_mfma_f32_16x16x32_bf16 a[44:47], v[88:91], v[52:55], a[44:47]
  ds_read_b64_tr_b16 v[72:73], v21 offset:49152
  v_mfma_f32_16x16x32_bf16 a[48:51], v[76:79], v[56:59], a[48:51]
  ds_read_b64_tr_b16 v[74:75], v21 offset:50176
  s_add_u32 m0, s52, 67584
  v_mfma_f32_16x16x32_bf16 a[52:55], v[80:83], v[56:59], a[52:55]
  buffer_load_dwordx4 v4, s[8:11], s20 offen  lds
  v_mfma_f32_16x16x32_bf16 a[56:59], v[84:87], v[56:59], a[56:59]
  v_mfma_f32_16x16x32_bf16 a[60:63], v[88:91], v[56:59], a[60:63]
  s_waitcnt lgkmcnt(0)
  s_add_u32 m0, s53, 67584
  v_mfma_f32_16x16x32_bf16 a[0:3], v[60:63], v[28:31], a[0:3]
  buffer_load_dwordx4 v8, s[12:15], s21 offen  lds
  ds_read_b128 v[44:47], v13 offset:32768
  v_mfma_f32_16x16x32_bf16 a[4:7], v[64:67], v[28:31], a[4:7]
  ds_read_b64_tr_b16 v[76:77], v18 offset:57344
  v_mfma_f32_16x16x32_bf16 a[8:11], v[68:71], v[28:31], a[8:11]
  ds_read_b64_tr_b16 v[78:79], v18 offset:58368
  v_mfma_f32_16x16x32_bf16 a[12:15], v[72:75], v[28:31], a[12:15]
  ds_read_b128 v[48:51], v13 offset:34816
  s_add_u32 m0, s52, 68608
  v_mfma_f32_16x16x32_bf16 a[16:19], v[60:63], v[32:35], a[16:19]
  buffer_load_dwordx4 v5, s[8:11], s20 offen  lds
  ds_read_b64_tr_b16 v[80:81], v19 offset:57344
  v_mfma_f32_16x16x32_bf16 a[20:23], v[64:67], v[32:35], a[20:23]
  ds_read_b64_tr_b16 v[82:83], v19 offset:58368
  v_mfma_f32_16x16x32_bf16 a[24:27], v[68:71], v[32:35], a[24:27]
  ds_read_b128 v[52:55], v13 offset:36864
  v_mfma_f32_16x16x32_bf16 a[28:31], v[72:75], v[32:35], a[28:31]
  ds_read_b64_tr_b16 v[84:85], v20 offset:57344
  s_add_u32 m0, s53, 68608
  v_mfma_f32_16x16x32_bf16 a[32:35], v[60:63], v[36:39], a[32:35]
  buffer_load_dwordx4 v9, s[12:15], s21 offen  lds
  ds_read_b64_tr_b16 v[86:87], v20 offset:58368
  v_mfma_f32_16x16x32_bf16 a[36:39], v[64:67], v[36:39], a[36:39]
  ds_read_b128 v[56:59], v13 offset:38912
  v_mfma_f32_16x16x32_bf16 a[40:43], v[68:71], v[36:39], a[40:43]
  ds_read_b64_tr_b16 v[88:89], v21 offset:57344
  v_mfma_f32_16x16x32_bf16 a[44:47], v[72:75], v[36:39], a[44:47]
  ds_read_b64_tr_b16 v[90:91], v21 offset:58368
  s_add_u32 s20, s20, 128
  v_mfma_f32_16x16x32_bf16 a[48:51], v[60:63], v[40:43], a[48:51]
  s_add_u32 s21, s21, s51
  v_mfma_f32_16x16x32_bf16 a[52:55], v[64:67], v[40:43], a[52:55]
  v_mfma_f32_16x16x32_bf16 a[56:59], v[68:71], v[40:43], a[56:59]
  v_mfma_f32_16x16x32_bf16 a[60:63], v[72:75], v[40:43], a[60:63]
  s_waitcnt lgkmcnt(0)
  v_mfma_f32_16x16x32_bf16 a[0:3], v[76:79], v[44:47], a[0:3]
  s_waitcnt vmcnt(16)
  s_barrier
  s_add_u32 m0, s52, 98304
  v_mfma_f32_16x16x32_bf16 a[4:7], v[80:83], v[44:47], a[4:7]
  buffer_load_dwordx4 v2, s[8:11], s20 offen  lds
  ds_read_b128 v[28:31], v10 offset:0
  v_mfma_f32_16x16x32_bf16 a[8:11], v[84:87], v[44:47], a[8:11]
  ds_read_b64_tr_b16 v[60:61], v14 offset:16384
  v_mfma_f32_16x16x32_bf16 a[12:15], v[88:91], v[44:47], a[12:15]
  ds_read_b64_tr_b16 v[62:63], v14 offset:17408
  s_add_u32 m0, s53, 98304
  v_mfma_f32_16x16x32_bf16 a[16:19], v[76:79], v[48:51], a[16:19]
  buffer_load_dwordx4 v6, s[12:15], s21 offen  lds
  ds_read_b128 v[32:35], v10 offset:2048
  v_mfma_f32_16x16x32_bf16 a[20:23], v[80:83], v[48:51], a[20:23]
  ds_read_b64_tr_b16 v[64:65], v15 offset:16384
  v_mfma_f32_16x16x32_bf16 a[24:27], v[84:87], v[48:51], a[24:27]
  ds_read_b64_tr_b16 v[66:67], v15 offset:17408
  s_add_u32 m0, s52, 99328
  v_mfma_f32_16x16x32_bf16 a[28:31], v[88:91], v[48:51], a[28:31]
  buffer_load_dwordx4 v3, s[8:11], s20 offen  lds
  ds_read_b128 v[36:39], v10 offset:4096
  v_mfma_f32_16x16x32_bf16 a[32:35], v[76:79], v[52:55], a[32:35]
  ds_read_b64_tr_b16 v[68:69], v16 offset:16384
  v_mfma_f32_16x16x32_bf16 a[36:39], v[80:83], v[52:55], a[36:39]
  ds_read_b64_tr_b16 v[70:71], v16 offset:17408
  s_add_u32 m0, s53, 99328
  v_mfma_f32_16x16x32_bf16 a[40:43], v[84:87], v[52:55], a[40:43]
  buffer_load_dwordx4 v7, s[12:15], s21 offen  lds
  ds_read_b128 v[40:43], v10 offset:6144
  v_mfma_f32_16x16x32_bf16 a[44:47], v[88:91], v[52:55], a[44:47]
  ds_read_b64_tr_b16 v[72:73], v17 offset:16384
  v_mfma_f32_16x16x32_bf16 a[48:51], v[76:79], v[56:59], a[48:51]
  ds_read_b64_tr_b16 v[74:75], v17 offset:17408
  s_add_u32 m0, s52, 100352
  v_mfma_f32_16x16x32_bf16 a[52:55], v[80:83], v[56:59], a[52:55]
  buffer_load_dwordx4 v4, s[8:11], s20 offen  lds
  v_mfma_f32_16x16x32_bf16 a[56:59], v[84:87], v[56:59], a[56:59]
  v_mfma_f32_16x16x32_bf16 a[60:63], v[88:91], v[56:59], a[60:63]
  s_branch L_g4_loop
L_g4_fin:
  s_cmp_lg_u32 s32, 0
  s_cbranch_scc1 L_rq_85
  s_cmp_eq_u32 s39, 0
  s_cbranch_scc1 L_rq_85
  s_lshl_b32 s99, s33, 7
  s_add_u32 s99, s99, 0x3d00200
  v_mov_b32 v244, 1
  v_mov_b32 v245, 0
  s_mov_b64 exec, 1
  buffer_atomic_add v244, v245, s[4:7], s99 offen sc0 sc1
  s_mov_b64 exec, -1
L_rq_85:
  s_waitcnt lgkmcnt(0)
  s_add_u32 m0, s53, 100352
  v_mfma_f32_16x16x32_bf16 a[0:3], v[60:63], v[28:31], a[0:3]
  buffer_load_dwordx4 v8, s[12:15], s21 offen  lds
  ds_read_b128 v[44:47], v11 offset:0
  v_mfma_f32_16x16x32_bf16 a[4:7], v[64:67], v[28:31], a[4:7]
  ds_read_b64_tr_b16 v[76:77], v14 offset:24576
  v_mfma_f32_16x16x32_bf16 a[8:11], v[68:71], v[28:31], a[8:11]
  ds_read_b64_tr_b16 v[78:79], v14 offset:25600
  v_mfma_f32_16x16x32_bf16 a[12:15], v[72:75], v[28:31], a[12:15]
  ds_read_b128 v[48:51], v11 offset:2048
  s_add_u32 m0, s52, 101376
  v_mfma_f32_16x16x32_bf16 a[16:19], v[60:63], v[32:35], a[16:19]
  buffer_load_dwordx4 v5, s[8:11], s20 offen  lds
  ds_read_b64_tr_b16 v[80:81], v15 offset:24576
  v_mfma_f32_16x16x32_bf16 a[20:23], v[64:67], v[32:35], a[20:23]
  ds_read_b64_tr_b16 v[82:83], v15 offset:25600
  v_mfma_f32_16x16x32_bf16 a[24:27], v[68:71], v[32:35], a[24:27]
  ds_read_b128 v[52:55], v11 offset:4096
  v_mfma_f32_16x16x32_bf16 a[28:31], v[72:75], v[32:35], a[28:31]
  ds_read_b64_tr_b16 v[84:85], v16 offset:24576
  s_add_u32 m0, s53, 101376
  v_mfma_f32_16x16x32_bf16 a[32:35], v[60:63], v[36:39], a[32:35]
  buffer_load_dwordx4 v9, s[12:15], s21 offen  lds
  ds_read_b64_tr_b16 v[86:87], v16 offset:25600
  v_mfma_f32_16x16x32_bf16 a[36:39], v[64:67], v[36:39], a[36:39]
  ds_read_b128 v[56:59], v11 offset:6144
  v_mfma_f32_16x16x32_bf16 a[40:43], v[68:71], v[36:39], a[40:43]
  ds_read_b64_tr_b16 v[88:89], v17 offset:24576
  v_mfma_f32_16x16x32_bf16 a[44:47], v[72:75], v[36:39], a[44:47]
  ds_read_b64_tr_b16 v[90:91], v17 offset:25600
  s_add_u32 s20, s20, 128
  v_mfma_f32_16x16x32_bf16 a[48:51], v[60:63], v[40:43], a[48:51]
  s_add_u32 s21, s21, s51
  v_mfma_f32_16x16x32_bf16 a[52:55], v[64:67], v[40:43], a[52:55]
  v_mfma_f32_16x16x32_bf16 a[56:59], v[68:71], v[40:43], a[56:59]
  v_mfma_f32_16x16x32_bf16 a[60:63], v[72:75], v[40:43], a[60:63]
  s_waitcnt lgkmcnt(0)
  v_mfma_f32_16x16x32_bf16 a[0:3], v[76:79], v[44:47], a[0:3]
  s_waitcnt vmcnt(16)
  s_barrier
  v_mfma_f32_16x16x32_bf16 a[4:7], v[80:83], v[44:47], a[4:7]
  ds_read_b128 v[28:31], v10 offset:32768
  v_mfma_f32_16x16x32_bf16 a[8:11], v[84:87], v[44:47], a[8:11]
  ds_read_b64_tr_b16 v[60:61], v14 offset:49152
  v_mfma_f32_16x16x32_bf16 a[12:15], v[88:91], v[44:47], a[12:15]
  ds_read_b64_tr_b16 v[62:63], v14 offset:50176
  v_mfma_f32_16x16x32_bf16 a[16:19], v[76:79], v[48:51], a[16:19]
  ds_read_b128 v[32:35], v10 offset:34816
  v_mfma_f32_16x16x32_bf16 a[20:23], v[80:83], v[48:51], a[20:23]
  ds_read_b64_tr_b16 v[64:65], v15 offset:49152
  v_mfma_f32_16x16x32_bf16 a[24:27], v[84:87], v[48:51], a[24:27]
  ds_read_b64_tr_b16 v[66:67], v15 offset:50176
  v_mfma_f32_16x16x32_bf16 a[28:31], v[88:91], v[48:51], a[28:31]
  ds_read_b128 v[36:39], v10 offset:36864
  v_mfma_f32_16x16x32_bf16 a[32:35], v[76:79], v[52:55], a[32:35]
  ds_read_b64_tr_b16 v[68:69], v16 offset:49152
  v_mfma_f32_16x16x32_bf16 a[36:39], v[80:83], v[52:55], a[36:39]
  ds_read_b64_tr_b16 v[70:71], v16 offset:50176
  v_mfma_f32_16x16x32_bf16 a[40:43], v[84:87], v[52:55], a[40:43]
  ds_read_b128 v[40:43], v10 offset:38912
  v_mfma_f32_16x16x32_bf16 a[44:47], v[88:91], v[52:55], a[44:47]
  ds_read_b64_tr_b16 v[72:73], v17 offset:49152
  v_mfma_f32_16x16x32_bf16 a[48:51], v[76:79], v[56:59], a[48:51]
  ds_read_b64_tr_b16 v[74:75], v17 offset:50176
  v_mfma_f32_16x16x32_bf16 a[52:55], v[80:83], v[56:59], a[52:55]
  v_mfma_f32_16x16x32_bf16 a[56:59], v[84:87], v[56:59], a[56:59]
  v_mfma_f32_16x16x32_bf16 a[60:63], v[88:91], v[56:59], a[60:63]
  s_waitcnt lgkmcnt(0)
  v_mfma_f32_16x16x32_bf16 a[0:3], v[60:63], v[28:31], a[0:3]
  ds_read_b128 v[44:47], v11 offset:32768
  v_mfma_f32_16x16x32_bf16 a[4:7], v[64:67], v[28:31], a[4:7]
  ds_read_b64_tr_b16 v[76:77], v14 offset:57344
  v_mfma_f32_16x16x32_bf16 a[8:11], v[68:71], v[28:31], a[8:11]
  ds_read_b64_tr_b16 v[78:79], v14 offset:58368
  v_mfma_f32_16x16x32_bf16 a[12:15], v[72:75], v[28:31], a[12:15]
  ds_read_b128 v[48:51], v11 offset:34816
  v_mfma_f32_16x16x32_bf16 a[16:19], v[60:63], v[32:35], a[16:19]
  ds_read_b64_tr_b16 v[80:81], v15 offset:57344
  v_mfma_f32_16x16x32_bf16 a[20:23], v[64:67], v[32:35], a[20:23]
  ds_read_b64_tr_b16 v[82:83], v15 offset:58368
  v_mfma_f32_16x16x32_bf16 a[24:27], v[68:71], v[32:35], a[24:27]
  ds_read_b128 v[52:55], v11 offset:36864
  v_mfma_f32_16x16x32_bf16 a[28:31], v[72:75], v[32:35], a[28:31]
  ds_read_b64_tr_b16 v[84:85], v16 offset:57344
  v_mfma_f32_16x16x32_bf16 a[32:35], v[60:63], v[36:39], a[32:35]
  ds_read_b64_tr_b16 v[86:87], v16 offset:58368
  v_mfma_f32_16x16x32_bf16 a[36:39], v[64:67], v[36:39], a[36:39]
  ds_read_b128 v[56:59], v11 offset:38912
  v_mfma_f32_16x16x32_bf16 a[40:43], v[68:71], v[36:39], a[40:43]
  ds_read_b64_tr_b16 v[88:89], v17 offset:57344
  v_mfma_f32_16x16x32_bf16 a[44:47], v[72:75], v[36:39], a[44:47]
  ds_read_b64_tr_b16 v[90:91], v17 offset:58368
  v_mfma_f32_16x16x32_bf16 a[48:51], v[60:63], v[40:43], a[48:51]
  v_mfma_f32_16x16x32_bf16 a[52:55], v[64:67], v[40:43], a[52:55]
  v_mfma_f32_16x16x32_bf16 a[56:59], v[68:71], v[40:43], a[56:59]
  v_mfma_f32_16x16x32_bf16 a[60:63], v[72:75], v[40:43], a[60:63]
  s_waitcnt lgkmcnt(0)
  v_mfma_f32_16x16x32_bf16 a[0:3], v[76:79], v[44:47], a[0:3]
  s_waitcnt vmcnt(8)
  s_barrier
  v_mfma_f32_16x16x32_bf16 a[4:7], v[80:83], v[44:47], a[4:7]
  ds_read_b128 v[28:31], v12 offset:0
  v_mfma_f32_16x16x32_bf16 a[8:11], v[84:87], v[44:47], a[8:11]
  ds_read_b64_tr_b16 v[60:61], v18 offset:16384
  v_mfma_f32_16x16x32_bf16 a[12:15], v[88:91], v[44:47], a[12:15]
  ds_read_b64_tr_b16 v[62:63], v18 offset:17408
  v_mfma_f32_16x16x32_bf16 a[16:19], v[76:79], v[48:51], a[16:19]
  ds_read_b128 v[32:35], v12 offset:2048
  v_mfma_f32_16x16x32_bf16 a[20:23], v[80:83], v[48:51], a[20:23]
  ds_read_b64_tr_b16 v[64:65], v19 offset:16384
  v_mfma_f32_16x16x32_bf16 a[24:27], v[84:87], v[48:51], a[24:27]
  ds_read_b64_tr_b16 v[66:67], v19 offset:17408
  v_mfma_f32_16x16x32_bf16 a[28:31], v[88:91], v[48:51], a[28:31]
  ds_read_b128 v[36:39], v12 offset:4096
  v_mfma_f32_16x16x32_bf16 a[32:35], v[76:79], v[52:55], a[32:35]
  ds_read_b64_tr_b16 v[68:69], v20 offset:16384
  v_mfma_f32_16x16x32_bf16 a[36:39], v[80:83], v[52:55], a[36:39]
  ds_read_b64_tr_b16 v[70:71], v20 offset:17408
  v_mfma_f32_16x16x32_bf16 a[40:43], v[84:87], v[52:55], a[40:43]
  ds_read_b128 v[40:43], v12 offset:6144
  v_mfma_f32_16x16x32_bf16 a[44:47], v[88:91], v[52:55], a[44:47]
  ds_read_b64_tr_b16 v[72:73], v21 offset:16384
  v_mfma_f32_16x16x32_bf16 a[48:51], v[76:79], v[56:59], a[48:51]
  ds_read_b64_tr_b16 v[74:75], v21 offset:17408
  v_mfma_f32_16x16x32_bf16 a[52:55], v[80:83], v[56:59], a[52:55]
  v_mfma_f32_16x16x32_bf16 a[56:59], v[84:87], v[56:59], a[56:59]
  v_mfma_f32_16x16x32_bf16 a[60:63], v[88:91], v[56:59], a[60:63]
  s_waitcnt lgkmcnt(0)
  v_mfma_f32_16x16x32_bf16 a[0:3], v[60:63], v[28:31], a[0:3]
  ds_read_b128 v[44:47], v13 offset:0
  v_mfma_f32_16x16x32_bf16 a[4:7], v[64:67], v[28:31], a[4:7]
  ds_read_b64_tr_b16 v[76:77], v18 offset:24576
  v_mfma_f32_16x16x32_bf16 a[8:11], v[68:71], v[28:31], a[8:11]
  ds_read_b64_tr_b16 v[78:79], v18 offset:25600
  v_mfma_f32_16x16x32_bf16 a[12:15], v[72:75], v[28:31], a[12:15]
  ds_read_b128 v[48:51], v13 offset:2048
  v_mfma_f32_16x16x32_bf16 a[16:19], v[60:63], v[32:35], a[16:19]
  ds_read_b64_tr_b16 v[80:81], v19 offset:24576
  v_mfma_f32_16x16x32_bf16 a[20:23], v[64:67], v[32:35], a[20:23]
  ds_read_b64_tr_b16 v[82:83], v19 offset:25600
  v_mfma_f32_16x16x32_bf16 a[24:27], v[68:71], v[32:35], a[24:27]
  ds_read_b128 v[52:55], v13 offset:4096
  v_mfma_f32_16x16x32_bf16 a[28:31], v[72:75], v[32:35], a[28:31]
  ds_read_b64_tr_b16 v[84:85], v20 offset:24576
  v_mfma_f32_16x16x32_bf16 a[32:35], v[60:63], v[36:39], a[32:35]
  ds_read_b64_tr_b16 v[86:87], v20 offset:25600
  v_mfma_f32_16x16x32_bf16 a[36:39], v[64:67], v[36:39], a[36:39]
  ds_read_b128 v[56:59], v13 offset:6144
  v_mfma_f32_16x16x32_bf16 a[40:43], v[68:71], v[36:39], a[40:43]
  ds_read_b64_tr_b16 v[88:89], v21 offset:24576
  v_mfma_f32_16x16x32_bf16 a[44:47], v[72:75], v[36:39], a[44:47]
  ds_read_b64_tr_b16 v[90:91], v21 offset:25600
  v_mfma_f32_16x16x32_bf16 a[48:51], v[60:63], v[40:43], a[48:51]
  v_mfma_f32_16x16x32_bf16 a[52:55], v[64:67], v[40:43], a[52:55]
  v_mfma_f32_16x16x32_bf16 a[56:59], v[68:71], v[40:43], a[56:59]
  v_mfma_f32_16x16x32_bf16 a[60:63], v[72:75], v[40:43], a[60:63]
  s_waitcnt lgkmcnt(0)
  v_mfma_f32_16x16x32_bf16 a[0:3], v[76:79], v[44:47], a[0:3]
  s_waitcnt vmcnt(0)
  s_barrier
  v_mfma_f32_16x16x32_bf16 a[4:7], v[80:83], v[44:47], a[4:7]
  ds_read_b128 v[28:31], v12 offset:32768
  v_mfma_f32_16x16x32_bf16 a[8:11], v[84:87], v[44:47], a[8:11]
  ds_read_b64_tr_b16 v[60:61], v18 offset:49152
  v_mfma_f32_16x16x32_bf16 a[12:15], v[88:91], v[44:47], a[12:15]
  ds_read_b64_tr_b16 v[62:63], v18 offset:50176
  v_mfma_f32_16x16x32_bf16 a[16:19], v[76:79], v[48:51], a[16:19]
  ds_read_b128 v[32:35], v12 offset:34816
  v_mfma_f32_16x16x32_bf16 a[20:23], v[80:83], v[48:51], a[20:23]
  ds_read_b64_tr_b16 v[64:65], v19 offset:49152
  v_mfma_f32_16x16x32_bf16 a[24:27], v[84:87], v[48:51], a[24:27]
  ds_read_b64_tr_b16 v[66:67], v19 offset:50176
  v_mfma_f32_16x16x32_bf16 a[28:31], v[88:91], v[48:51], a[28:31]
  ds_read_b128 v[36:39], v12 offset:36864
  v_mfma_f32_16x16x32_bf16 a[32:35], v[76:79], v[52:55], a[32:35]
  ds_read_b64_tr_b16 v[68:69], v20 offset:49152
  v_mfma_f32_16x16x32_bf16 a[36:39], v[80:83], v[52:55], a[36:39]
  ds_read_b64_tr_b16 v[70:71], v20 offset:50176
  v_mfma_f32_16x16x32_bf16 a[40:43], v[84:87], v[52:55], a[40:43]
  ds_read_b128 v[40:43], v12 offset:38912
  v_mfma_f32_16x16x32_bf16 a[44:47], v[88:91], v[52:55], a[44:47]
  ds_read_b64_tr_b16 v[72:73], v21 offset:49152
  v_mfma_f32_16x16x32_bf16 a[48:51], v[76:79], v[56:59], a[48:51]
  ds_read_b64_tr_b16 v[74:75], v21 offset:50176
  v_mfma_f32_16x16x32_bf16 a[52:55], v[80:83], v[56:59], a[52:55]
  v_mfma_f32_16x16x32_bf16 a[56:59], v[84:87], v[56:59], a[56:59]
  v_mfma_f32_16x16x32_bf16 a[60:63], v[88:91], v[56:59], a[60:63]
  s_waitcnt lgkmcnt(0)
  v_mfma_f32_16x16x32_bf16 a[0:3], v[60:63], v[28:31], a[0:3]
  ds_read_b128 v[44:47], v13 offset:32768
  v_mfma_f32_16x16x32_bf16 a[4:7], v[64:67], v[28:31], a[4:7]
  ds_read_b64_tr_b16 v[76:77], v18 offset:57344
  v_mfma_f32_16x16x32_bf16 a[8:11], v[68:71], v[28:31], a[8:11]
  ds_read_b64_tr_b16 v[78:79], v18 offset:58368
  v_mfma_f32_16x16x32_bf16 a[12:15], v[72:75], v[28:31], a[12:15]
  ds_read_b128 v[48:51], v13 offset:34816
  v_mfma_f32_16x16x32_bf16 a[16:19], v[60:63], v[32:35], a[16:19]
  ds_read_b64_tr_b16 v[80:81], v19 offset:57344
  v_mfma_f32_16x16x32_bf16 a[20:23], v[64:67], v[32:35], a[20:23]
  ds_read_b64_tr_b16 v[82:83], v19 offset:58368
  v_mfma_f32_16x16x32_bf16 a[24:27], v[68:71], v[32:35], a[24:27]
  ds_read_b128 v[52:55], v13 offset:36864
  v_mfma_f32_16x16x32_bf16 a[28:31], v[72:75], v[32:35], a[28:31]
  ds_read_b64_tr_b16 v[84:85], v20 offset:57344
  v_mfma_f32_16x16x32_bf16 a[32:35], v[60:63], v[36:39], a[32:35]
  ds_read_b64_tr_b16 v[86:87], v20 offset:58368
  v_mfma_f32_16x16x32_bf16 a[36:39], v[64:67], v[36:39], a[36:39]
  ds_read_b128 v[56:59], v13 offset:38912
  v_mfma_f32_16x16x32_bf16 a[40:43], v[68:71], v[36:39], a[40:43]
  ds_read_b64_tr_b16 v[88:89], v21 offset:57344
  v_mfma_f32_16x16x32_bf16 a[44:47], v[72:75], v[36:39], a[44:47]
  ds_read_b64_tr_b16 v[90:91], v21 offset:58368
  v_mfma_f32_16x16x32_bf16 a[48:51], v[60:63], v[40:43], a[48:51]
  v_mfma_f32_16x16x32_bf16 a[52:55], v[64:67], v[40:43], a[52:55]
  v_mfma_f32_16x16x32_bf16 a[56:59], v[68:71], v[40:43], a[56:59]
  v_mfma_f32_16x16x32_bf16 a[60:63], v[72:75], v[40:43], a[60:63]
  s_waitcnt lgkmcnt(0)
  v_mfma_f32_16x16x32_bf16 a[0:3], v[76:79], v[44:47], a[0:3]
  v_mfma_f32_16x16x32_bf16 a[4:7], v[80:83], v[44:47], a[4:7]
  v_mfma_f32_16x16x32_bf16 a[8:11], v[84:87], v[44:47], a[8:11]
  v_mfma_f32_16x16x32_bf16 a[12:15], v[88:91], v[44:47], a[12:15]
  v_mfma_f32_16x16x32_bf16 a[16:19], v[76:79], v[48:51], a[16:19]
  v_mfma_f32_16x16x32_bf16 a[20:23], v[80:83], v[48:51], a[20:23]
  v_mfma_f32_16x16x32_bf16 a[24:27], v[84:87], v[48:51], a[24:27]
  v_mfma_f32_16x16x32_bf16 a[28:31], v[88:91], v[48:51], a[28:31]
  v_mfma_f32_16x16x32_bf16 a[32:35], v[76:79], v[52:55], a[32:35]
  v_mfma_f32_16x16x32_bf16 a[36:39], v[80:83], v[52:55], a[36:39]
  v_mfma_f32_16x16x32_bf16 a[40:43], v[84:87], v[52:55], a[40:43]
  v_mfma_f32_16x16x32_bf16 a[44:47], v[88:91], v[52:55], a[44:47]
  v_mfma_f32_16x16x32_bf16 a[48:51], v[76:79], v[56:59], a[48:51]
  v_mfma_f32_16x16x32_bf16 a[52:55], v[80:83], v[56:59], a[52:55]
  v_mfma_f32_16x16x32_bf16 a[56:59], v[84:87], v[56:59], a[56:59]
  v_mfma_f32_16x16x32_bf16 a[60:63], v[88:91], v[56:59], a[60:63]
  s_mov_b32 s59, 3
  s_mov_b32 s60, s22
  s_mov_b32 s61, s26
  s_add_u32 s62, s38, 0x3d00000
  s_mov_b32 s63, s98
  s_cmp_lg_u32 s39, 0
  s_cbranch_scc1 L_got
  s_mov_b32 s58, 3
  s_branch L_epi
L_g5:
  s_waitcnt vmcnt(26)
  s_barrier
  ds_read_b128 v[28:31], v10 offset:0
  ds_read_b64_tr_b16 v[60:61], v14 offset:16384
  ds_read_b64_tr_b16 v[62:63], v14 offset:17408
  ds_read_b128 v[32:35], v10 offset:2048
  ds_read_b64_tr_b16 v[64:65], v15 offset:16384
  ds_read_b64_tr_b16 v[66:67], v15 offset:17408
  ds_read_b128 v[36:39], v10 offset:4096
  ds_read_b64_tr_b16 v[68:69], v16 offset:16384
  ds_read_b64_tr_b16 v[70:71], v16 offset:17408
  ds_read_b128 v[40:43], v10 offset:6144
  ds_read_b64_tr_b16 v[72:73], v17 offset:16384
  ds_read_b64_tr_b16 v[74:75], v17 offset:17408
  s_sub_u32 s25, s25, 1
  s_waitcnt lgkmcnt(0)
  v_mfma_f32_16x16x32_bf16 a[0:3], v[28:31], v[60:63], 0
  ds_read_b128 v[44:47], v11 offset:0
  v_mfma_f32_16x16x32_bf16 a[4:7], v[28:31], v[64:67], 0
  ds_read_b64_tr_b16 v[76:77], v14 offset:24576
  v_mfma_f32_16x16x32_bf16 a[8:11], v[28:31], v[68:71], 0
  ds_read_b64_tr_b16 v[78:79], v14 offset:25600
  v_mfma_f32_16x16x32_bf16 a[12:15], v[28:31], v[72:75], 0
  ds_read_b128 v[48:51], v11 offset:2048
  v_mfma_f32_16x16x32_bf16 a[16:19], v[32:35], v[60:63], 0
  ds_read_b64_tr_b16 v[80:81], v15 offset:24576
  v_mfma_f32_16x16x32_bf16 a[20:23], v[32:35], v[64:67], 0
  ds_read_b64_tr_b16 v[82:83], v15 offset:25600
  v_mfma_f32_16x16x32_bf16 a[24:27], v[32:35], v[68:71], 0
  ds_read_b128 v[52:55], v11 offset:4096
  v_mfma_f32_16x16x32_bf16 a[28:31], v[32:35], v[72:75], 0
  ds_read_b64_tr_b16 v[84:85], v16 offset:24576
  v_mfma_f32_16x16x32_bf16 a[32:35], v[36:39], v[60:63], 0
  ds_read_b64_tr_b16 v[86:87], v16 offset:25600
  v_mfma_f32_16x16x32_bf16 a[36:39], v[36:39], v[64:67], 0
  ds_read_b128 v[56:59], v11 offset:6144
  v_mfma_f32_16x16x32_bf16 a[40:43], v[36:39], v[68:71], 0
  ds_read_b64_tr_b16 v[88:89], v17 offset:24576
  v_mfma_f32_16x16x32_bf16 a[44:47], v[36:39], v[72:75], 0
  ds_read_b64_tr_b16 v[90:91], v17 offset:25600
  v_mfma_f32_16x16x32_bf16 a[48:51], v[40:43], v[60:63], 0
  v_mfma_f32_16x16x32_bf16 a[52:55], v[40:43], v[64:67], 0
  v_mfma_f32_16x16x32_bf16 a[56:59], v[40:43], v[68:71], 0
  v_mfma_f32_16x16x32_bf16 a[60:63], v[40:43], v[72:75], 0
  s_waitcnt lgkmcnt(0)
  v_mfma_f32_16x16x32_bf16 a[0:3], v[44:47], v[76:79], a[0:3]
  s_waitcnt vmcnt(18)
  s_barrier
  s_add_u32 m0, s52, 0
  v_mfma_f32_16x16x32_bf16 a[4:7], v[44:47], v[80:83], a[4:7]
  buffer_load_dwordx4 v2, s[8:11], s20 offen  lds
  ds_read_b128 v[28:31], v10 offset:32768
  v_mfma_f32_16x16x32_bf16 a[8:11], v[44:47], v[84:87], a[8:11]
  ds_read_b64_tr_b16 v[60:61], v14 offset:49152
  v_mfma_f32_16x16x32_bf16 a[12:15], v[44:47], v[88:91], a[12:15]
  ds_read_b64_tr_b16 v[62:63], v14 offset:50176
  s_add_u32 m0, s53, 0
  v_mfma_f32_16x16x32_bf16 a[16:19], v[48:51], v[76:79], a[16:19]
  buffer_load_dwordx4 v6, s[12:15], s21 offen  lds
  ds_read_b128 v[32:35], v10 offset:34816
  v_mfma_f32_16x16x32_bf16 a[20:23], v[48:51], v[80:83], a[20:23]
  ds_read_b64_tr_b16 v[64:65], v15 offset:49152
  v_mfma_f32_16x16x32_bf16 a[24:27], v[48:51], v[84:87], a[24:27]
  ds_read_b64_tr_b16 v[66:67], v15 offset:50176
  s_add_u32 m0, s52, 1024
  v_mfma_f32_16x16x32_bf16 a[28:31], v[48:51], v[88:91], a[28:31]
  buffer_load_dwordx4 v3, s[8:11], s20 offen  lds
  ds_read_b128 v[36:39], v10 offset:36864
  v_mfma_f32_16x16x32_bf16 a[32:35], v[52:55], v[76:79], a[32:35]
  ds_read_b64_tr_b16 v[68:69], v16 offset:49152
  v_mfma_f32_16x16x32_bf16 a[36:39], v[52:55], v[80:83], a[36:39]
  ds_read_b64_tr_b16 v[70:71], v16 offset:50176
  s_add_u32 m0, s53, 1024
  v_mfma_f32_16x16x32_bf16 a[40:43], v[52:55], v[84:87], a[40:43]
  buffer_load_dwordx4 v7, s[12:15], s21 offen  lds
  ds_read_b128 v[40:43], v10 offset:38912
  v_mfma_f32_16x16x32_bf16 a[44:47], v[52:55], v[88:91], a[44:47]
  ds_read_b64_tr_b16 v[72:73], v17 offset:49152
  v_mfma_f32_16x16x32_bf16 a[48:51], v[56:59], v[76:79], a[48:51]
  ds_read_b64_tr_b16 v[74:75], v17 offset:50176
  s_add_u32 m0, s52, 2048
  v_mfma_f32_16x16x32_bf16 a[52:55], v[56:59], v[80:83], a[52:55]
  buffer_load_dwordx4 v4, s[8:11], s20 offen  lds
  v_mfma_f32_16x16x32_bf16 a[56:59], v[56:59], v[84:87], a[56:59]
  v_mfma_f32_16x16x32_bf16 a[60:63], v[56:59], v[88:91], a[60:63]
  s_waitcnt lgkmcnt(0)
  s_add_u32 m0, s53, 2048
  v_mfma_f32_16x16x32_bf16 a[0:3], v[28:31], v[60:63], a[0:3]
  buffer_load_dwordx4 v8, s[12:15], s21 offen  lds
  ds_read_b128 v[44:47], v11 offset:32768
  v_mfma_f32_16x16x32_bf16 a[4:7], v[28:31], v[64:67], a[4:7]
  ds_read_b64_tr_b16 v[76:77], v14 offset:57344
  v_mfma_f32_16x16x32_bf16 a[8:11], v[28:31], v[68:71], a[8:11]
  ds_read_b64_tr_b16 v[78:79], v14 offset:58368
  v_mfma_f32_16x16x32_bf16 a[12:15], v[28:31], v[72:75], a[12:15]
  ds_read_b128 v[48:51], v11 offset:34816
  s_add_u32 m0, s52, 3072
  v_mfma_f32_16x16x32_bf16 a[16:19], v[32:35], v[60:63], a[16:19]
  buffer_load_dwordx4 v5, s[8:11], s20 offen  lds
  ds_read_b64_tr_b16 v[80:81], v15 offset:57344
  v_mfma_f32_16x16x32_bf16 a[20:23], v[32:35], v[64:67], a[20:23]
  ds_read_b64_tr_b16 v[82:83], v15 offset:58368
  v_mfma_f32_16x16x32_bf16 a[24:27], v[32:35], v[68:71], a[24:27]
  ds_read_b128 v[52:55], v11 offset:36864
  v_mfma_f32_16x16x32_bf16 a[28:31], v[32:35], v[72:75], a[28:31]
  ds_read_b64_tr_b16 v[84:85], v16 offset:57344
  s_add_u32 m0, s53, 3072
  v_mfma_f32_16x16x32_bf16 a[32:35], v[36:39], v[60:63], a[32:35]
  buffer_load_dwordx4 v9, s[12:15], s21 offen  lds
  ds_read_b64_tr_b16 v[86:87], v16 offset:58368
  v_mfma_f32_16x16x32_bf16 a[36:39], v[36:39], v[64:67], a[36:39]
  ds_read_b128 v[56:59], v11 offset:38912
  v_mfma_f32_16x16x32_bf16 a[40:43], v[36:39], v[68:71], a[40:43]
  ds_read_b64_tr_b16 v[88:89], v17 offset:57344
  v_mfma_f32_16x16x32_bf16 a[44:47], v[36:39], v[72:75], a[44:47]
  ds_read_b64_tr_b16 v[90:91], v17 offset:58368
  s_add_u32 s20, s20, 128
  v_mfma_f32_16x16x32_bf16 a[48:51], v[40:43], v[60:63], a[48:51]
  s_add_u32 s21, s21, s51
  v_mfma_f32_16x16x32_bf16 a[52:55], v[40:43], v[64:67], a[52:55]
  v_mfma_f32_16x16x32_bf16 a[56:59], v[40:43], v[68:71], a[56:59]
  v_mfma_f32_16x16x32_bf16 a[60:63], v[40:43], v[72:75], a[60:63]
  s_waitcnt lgkmcnt(0)
  v_mfma_f32_16x16x32_bf16 a[0:3], v[44:47], v[76:79], a[0:3]
  s_waitcnt vmcnt(18)
  s_barrier
  s_add_u32 m0, s52, 32768
  v_mfma_f32_16x16x32_bf16 a[4:7], v[44:47], v[80:83], a[4:7]
  buffer_load_dwordx4 v2, s[8:11], s20 offen  lds
  ds_read_b128 v[28:31], v12 offset:0
  v_mfma_f32_16x16x32_bf16 a[8:11], v[44:47], v[84:87], a[8:11]
  ds_read_b64_tr_b16 v[60:61], v18 offset:16384
  v_mfma_f32_16x16x32_bf16 a[12:15], v[44:47], v[88:91], a[12:15]
  ds_read_b64_tr_b16 v[62:63], v18 offset:17408
  s_add_u32 m0, s53, 32768
  v_mfma_f32_16x16x32_bf16 a[16:19], v[48:51], v[76:79], a[16:19]
  buffer_load_dwordx4 v6, s[12:15], s21 offen  lds
  ds_read_b128 v[32:35], v12 offset:2048
  v_mfma_f32_16x16x32_bf16 a[20:23], v[48:51], v[80:83], a[20:23]
  ds_read_b64_tr_b16 v[64:65], v19 offset:16384
  v_mfma_f32_16x16x32_bf16 a[24:27], v[48:51], v[84:87], a[24:27]
  ds_read_b64_tr_b16 v[66:67], v19 offset:17408
  s_add_u32 m0, s52, 33792
  v_mfma_f32_16x16x32_bf16 a[28:31], v[48:51], v[88:91], a[28:31]
  buffer_load_dwordx4 v3, s[8:11], s20 offen  lds
  ds_read_b128 v[36:39], v12 offset:4096
  v_mfma_f32_16x16x32_bf16 a[32:35], v[52:55], v[76:79], a[32:35]
  ds_read_b64_tr_b16 v[68:69], v20 offset:16384
  v_mfma_f32_16x16x32_bf16 a[36:39], v[52:55], v[80:83], a[36:39]
  ds_read_b64_tr_b16 v[70:71], v20 offset:17408
  s_add_u32 m0, s53, 33792
  v_mfma_f32_16x16x32_bf16 a[40:43], v[52:55], v[84:87], a[40:43]
  buffer_load_dwordx4 v7, s[12:15], s21 offen  lds
  ds_read_b128 v[40:43], v12 offset:6144
  v_mfma_f32_16x16x32_bf16 a[44:47], v[52:55], v[88:91], a[44:47]
  ds_read_b64_tr_b16 v[72:73], v21 offset:16384
  v_mfma_f32_16x16x32_bf16 a[48:51], v[56:59], v[76:79], a[48:51]
  ds_read_b64_tr_b16 v[74:75], v21 offset:17408
  s_add_u32 m0, s52, 34816
  v_mfma_f32_16x16x32_bf16 a[52:55], v[56:59], v[80:83], a[52:55]
  buffer_load_dwordx4 v4, s[8:11], s20 offen  lds
  v_mfma_f32_16x16x32_bf16 a[56:59], v[56:59], v[84:87], a[56:59]
  v_mfma_f32_16x16x32_bf16 a[60:63], v[56:59], v[88:91], a[60:63]
  s_waitcnt lgkmcnt(0)
  s_add_u32 m0, s53, 34816
  v_mfma_f32_16x16x32_bf16 a[0:3], v[28:31], v[60:63], a[0:3]
  buffer_load_dwordx4 v8, s[12:15], s21 offen  lds
  ds_read_b128 v[44:47], v13 offset:0
  v_mfma_f32_16x16x32_bf16 a[4:7], v[28:31], v[64:67], a[4:7]
  ds_read_b64_tr_b16 v[76:77], v18 offset:24576
  v_mfma_f32_16x16x32_bf16 a[8:11], v[28:31], v[68:71], a[8:11]
  ds_read_b64_tr_b16 v[78:79], v18 offset:25600
  v_mfma_f32_16x16x32_bf16 a[12:15], v[28:31], v[72:75], a[12:15]
  ds_read_b128 v[48:51], v13 offset:2048
  s_add_u32 m0, s52, 35840
  v_mfma_f32_16x16x32_bf16 a[16:19], v[32:35], v[60:63], a[16:19]
  buffer_load_dwordx4 v5, s[8:11], s20 offen  lds
  ds_read_b64_tr_b16 v[80:81], v19 offset:24576
  v_mfma_f32_16x16x32_bf16 a[20:23], v[32:35], v[64:67], a[20:23]
  ds_read_b64_tr_b16 v[82:83], v19 offset:25600
  v_mfma_f32_16x16x32_bf16 a[24:27], v[32:35], v[68:71], a[24:27]
  ds_read_b128 v[52:55], v13 offset:4096
  v_mfma_f32_16x16x32_bf16 a[28:31], v[32:35], v[72:75], a[28:31]
  ds_read_b64_tr_b16 v[84:85], v20 offset:24576
  s_add_u32 m0, s53, 35840
  v_mfma_f32_16x16x32_bf16 a[32:35], v[36:39], v[60:63], a[32:35]
  buffer_load_dwordx4 v9, s[12:15], s21 offen  lds
  ds_read_b64_tr_b16 v[86:87], v20 offset:25600
  v_mfma_f32_16x16x32_bf16 a[36:39], v[36:39], v[64:67], a[36:39]
  ds_read_b128 v[56:59], v13 offset:6144
  v_mfma_f32_16x16x32_bf16 a[40:43], v[36:39], v[68:71], a[40:43]
  ds_read_b64_tr_b16 v[88:89], v21 offset:24576
  v_mfma_f32_16x16x32_bf16 a[44:47], v[36:39], v[72:75], a[44:47]
  ds_read_b64_tr_b16 v[90:91], v21 offset:25600
  s_add_u32 s20, s20, 128
  v_mfma_f32_16x16x32_bf16 a[48:51], v[40:43], v[60:63], a[48:51]
  s_add_u32 s21, s21, s51
  v_mfma_f32_16x16x32_bf16 a[52:55], v[40:43], v[64:67], a[52:55]
  v_mfma_f32_16x16x32_bf16 a[56:59], v[40:43], v[68:71], a[56:59]
  v_mfma_f32_16x16x32_bf16 a[60:63], v[40:43], v[72:75], a[60:63]
  s_waitcnt lgkmcnt(0)
  v_mfma_f32_16x16x32_bf16 a[0:3], v[44:47], v[76:79], a[0:3]
  s_waitcnt vmcnt(18)
  s_barrier
  s_add_u32 m0, s52, 65536
  v_mfma_f32_16x16x32_bf16 a[4:7], v[44:47], v[80:83], a[4:7]
  buffer_load_dwordx4 v2, s[8:11], s20 offen  lds
  ds_read_b128 v[28:31], v12 offset:32768
  v_mfma_f32_16x16x32_bf16 a[8:11], v[44:47], v[84:87], a[8:11]
  ds_read_b64_tr_b16 v[60:61], v18 offset:49152
  v_mfma_f32_16x16x32_bf16 a[12:15], v[44:47], v[88:91], a[12:15]
  ds_read_b64_tr_b16 v[62:63], v18 offset:50176
  s_add_u32 m0, s53, 65536
  v_mfma_f32_16x16x32_bf16 a[16:19], v[48:51], v[76:79], a[16:19]
  buffer_load_dwordx4 v6, s[12:15], s21 offen  lds
  ds_read_b128 v[32:35], v12 offset:34816
  v_mfma_f32_16x16x32_bf16 a[20:23], v[48:51], v[80:83], a[20:23]
  ds_read_b64_tr_b16 v[64:65], v19 offset:49152
  v_mfma_f32_16x16x32_bf16 a[24:27], v[48:51], v[84:87], a[24:27]
  ds_read_b64_tr_b16 v[66:67], v19 offset:50176
  s_add_u32 m0, s52, 66560
  v_mfma_f32_16x16x32_bf16 a[28:31], v[48:51], v[88:91], a[28:31]
  buffer_load_dwordx4 v3, s[8:11], s20 offen  lds
  ds_read_b128 v[36:39], v12 offset:36864
  v_mfma_f32_16x16x32_bf16 a[32:35], v[52:55], v[76:79], a[32:35]
  ds_read_b64_tr_b16 v[68:69], v20 offset:49152
  v_mfma_f32_16x16x32_bf16 a[36:39], v[52:55], v[80:83], a[36:39]
  ds_read_b64_tr_b16 v[70:71], v20 offset:50176
  s_add_u32 m0, s53, 66560
  v_mfma_f32_16x16x32_bf16 a[40:43], v[52:55], v[84:87], a[40:43]
  buffer_load_dwordx4 v7, s[12:15], s21 offen  lds
  ds_read_b128 v[40:43], v12 offset:38912
  v_mfma_f32_16x16x32_bf16 a[44:47], v[52:55], v[88:91], a[44:47]
  ds_read_b64_tr_b16 v[72:73], v21 offset:49152
  v_mfma_f32_16x16x32_bf16 a[48:51], v[56:59], v[76:79], a[48:51]
  ds_read_b64_tr_b16 v[74:75], v21 offset:50176
  s_add_u32 m0, s52, 67584
  v_mfma_f32_16x16x32_bf16 a[52:55], v[56:59], v[80:83], a[52:55]
  buffer_load_dwordx4 v4, s[8:11], s20 offen  lds
  v_mfma_f32_16x16x32_bf16 a[56:59], v[56:59], v[84:87], a[56:59]
  v_mfma_f32_16x16x32_bf16 a[60:63], v[56:59], v[88:91], a[60:63]
  s_waitcnt lgkmcnt(0)
  s_add_u32 m0, s53, 67584
  v_mfma_f32_16x16x32_bf16 a[0:3], v[28:31], v[60:63], a[0:3]
  buffer_load_dwordx4 v8, s[12:15], s21 offen  lds
  ds_read_b128 v[44:47], v13 offset:32768
  v_mfma_f32_16x16x32_bf16 a[4:7], v[28:31], v[64:67], a[4:7]
  ds_read_b64_tr_b16 v[76:77], v18 offset:57344
  v_mfma_f32_16x16x32_bf16 a[8:11], v[28:31], v[68:71], a[8:11]
  ds_read_b64_tr_b16 v[78:79], v18 offset:58368
  v_mfma_f32_16x16x32_bf16 a[12:15], v[28:31], v[72:75], a[12:15]
  ds_read_b128 v[48:51], v13 offset:34816
  s_add_u32 m0, s52, 68608
  v_mfma_f32_16x16x32_bf16 a[16:19], v[32:35], v[60:63], a[16:19]
  buffer_load_dwordx4 v5, s[8:11], s20 offen  lds
  ds_read_b64_tr_b16 v[80:81], v19 offset:57344
  v_mfma_f32_16x16x32_bf16 a[20:23], v[32:35], v[64:67], a[20:23]
  ds_read_b64_tr_b16 v[82:83], v19 offset:58368
  v_mfma_f32_16x16x32_bf16 a[24:27], v[32:35], v[68:71], a[24:27]
  ds_read_b128 v[52:55], v13 offset:36864
  v_mfma_f32_16x16x32_bf16 a[28:31], v[32:35], v[72:75], a[28:31]
  ds_read_b64_tr_b16 v[84:85], v20 offset:57344
  s_add_u32 m0, s53, 68608
  v_mfma_f32_16x16x32_bf16 a[32:35], v[36:39], v[60:63], a[32:35]
  buffer_load_dwordx4 v9, s[12:15], s21 offen  lds
  ds_read_b64_tr_b16 v[86:87], v20 offset:58368
  v_mfma_f32_16x16x32_bf16 a[36:39], v[36:39], v[64:67], a[36:39]
  ds_read_b128 v[56:59], v13 offset:38912
  v_mfma_f32_16x16x32_bf16 a[40:43], v[36:39], v[68:71], a[40:43]
  ds_read_b64_tr_b16 v[88:89], v21 offset:57344
  v_mfma_f32_16x16x32_bf16 a[44:47], v[36:39], v[72:75], a[44:47]
  ds_read_b64_tr_b16 v[90:91], v21 offset:58368
  s_add_u32 s20, s20, 128
  v_mfma_f32_16x16x32_bf16 a[48:51], v[40:43], v[60:63], a[48:51]
  s_add_u32 s21, s21, s51
  v_mfma_f32_16x16x32_bf16 a[52:55], v[40:43], v[64:67], a[52:55]
  v_mfma_f32_16x16x32_bf16 a[56:59], v[40:43], v[68:71], a[56:59]
  v_mfma_f32_16x16x32_bf16 a[60:63], v[40:43], v[72:75], a[60:63]
  s_waitcnt lgkmcnt(0)
  v_mfma_f32_16x16x32_bf16 a[0:3], v[44:47], v[76:79], a[0:3]
  s_waitcnt vmcnt(16)
  s_barrier
  s_add_u32 m0, s52, 98304
  v_mfma_f32_16x16x32_bf16 a[4:7], v[44:47], v[80:83], a[4:7]
  buffer_load_dwordx4 v2, s[8:11], s20 offen  lds
  ds_read_b128 v[28:31], v10 offset:0
  v_mfma_f32_16x16x32_bf16 a[8:11], v[44:47], v[84:87], a[8:11]
  ds_read_b64_tr_b16 v[60:61], v14 offset:16384
  v_mfma_f32_16x16x32_bf16 a[12:15], v[44:47], v[88:91], a[12:15]
  ds_read_b64_tr_b16 v[62:63], v14 offset:17408
  s_add_u32 m0, s53, 98304
  v_mfma_f32_16x16x32_bf16 a[16:19], v[48:51], v[76:79], a[16:19]
  buffer_load_dwordx4 v6, s[12:15], s21 offen  lds
  ds_read_b128 v[32:35], v10 offset:2048
  v_mfma_f32_16x16x32_bf16 a[20:23], v[48:51], v[80:83], a[20:23]
  ds_read_b64_tr_b16 v[64:65], v15 offset:16384
  v_mfma_f32_16x16x32_bf16 a[24:27], v[48:51], v[84:87], a[24:27]
  ds_read_b64_tr_b16 v[66:67], v15 offset:17408
  s_add_u32 m0, s52, 99328
  v_mfma_f32_16x16x32_bf16 a[28:31], v[48:51], v[88:91], a[28:31]
  buffer_load_dwordx4 v3, s[8:11], s20 offen  lds
  ds_read_b128 v[36:39], v10 offset:4096
  v_mfma_f32_16x16x32_bf16 a[32:35], v[52:55], v[76:79], a[32:35]
  ds_read_b64_tr_b16 v[68:69], v16 offset:16384
  v_mfma_f32_16x16x32_bf16 a[36:39], v[52:55], v[80:83], a[36:39]
  ds_read_b64_tr_b16 v[70:71], v16 offset:17408
  s_add_u32 m0, s53, 99328
  v_mfma_f32_16x16x32_bf16 a[40:43], v[52:55], v[84:87], a[40:43]
  buffer_load_dwordx4 v7, s[12:15], s21 offen  lds
  ds_read_b128 v[40:43], v10 offset:6144
  v_mfma_f32_16x16x32_bf16 a[44:47], v[52:55], v[88:91], a[44:47]
  ds_read_b64_tr_b16 v[72:73], v17 offset:16384
  v_mfma_f32_16x16x32_bf16 a[48:51], v[56:59], v[76:79], a[48:51]
  ds_read_b64_tr_b16 v[74:75], v17 offset:17408
  s_add_u32 m0, s52, 100352
  v_mfma_f32_16x16x32_bf16 a[52:55], v[56:59], v[80:83], a[52:55]
  buffer_load_dwordx4 v4, s[8:11], s20 offen  lds
  v_mfma_f32_16x16x32_bf16 a[56:59], v[56:59], v[84:87], a[56:59]
  v_mfma_f32_16x16x32_bf16 a[60:63], v[56:59], v[88:91], a[60:63]
L_g5_loop:
  s_sub_u32 s25, s25, 1
  s_cmp_eq_u32 s25, 0
  s_cbranch_scc1 L_g5_fin
  s_waitcnt lgkmcnt(0)
  s_add_u32 m0, s53, 100352
  v_mfma_f32_16x16x32_bf16 a[0:3], v[28:31], v[60:63], a[0:3]
  buffer_load_dwordx4 v8, s[12:15], s21 offen  lds
  ds_read_b128 v[44:47], v11 offset:0
  v_mfma_f32_16x16x32_bf16 a[4:7], v[28:31], v[64:67], a[4:7]
  ds_read_b64_tr_b16 v[76:77], v14 offset:24576
  v_mfma_f32_16x16x32_bf16 a[8:11], v[28:31], v[68:71], a[8:11]
  ds_read_b64_tr_b16 v[78:79], v14 offset:25600
  v_mfma_f32_16x16x32_bf16 a[12:15], v[28:31], v[72:75], a[12:15]
  ds_read_b128 v[48:51], v11 offset:2048
  s_add_u32 m0, s52, 101376
  v_mfma_f32_16x16x32_bf16 a[16:19], v[32:35], v[60:63], a[16:19]
  buffer_load_dwordx4 v5, s[8:11], s20 offen  lds
  ds_read_b64_tr_b16 v[80:81], v15 offset:24576
  v_mfma_f32_16x16x32_bf16 a[20:23], v[32:35], v[64:67], a[20:23]
  ds_read_b64_tr_b16 v[82:83], v15 offset:25600
  v_mfma_f32_16x16x32_bf16 a[24:27], v[32:35], v[68:71], a[24:27]
  ds_read_b128 v[52:55], v11 offset:4096
  v_mfma_f32_16x16x32_bf16 a[28:31], v[32:35], v[72:75], a[28:31]
  ds_read_b64_tr_b16 v[84:85], v16 offset:24576
  s_add_u32 m0, s53, 101376
  v_mfma_f32_16x16x32_bf16 a[32:35], v[36:39], v[60:63], a[32:35]
  buffer_load_dwordx4 v9, s[12:15], s21 offen  lds
  ds_read_b64_tr_b16 v[86:87], v16 offset:25600
  v_mfma_f32_16x16x32_bf16 a[36:39], v[36:39], v[64:67], a[36:39]
  ds_read_b128 v[56:59], v11 offset:6144
  v_mfma_f32_16x16x32_bf16 a[40:43], v[36:39], v[68:71], a[40:43]
  ds_read_b64_tr_b16 v[88:89], v17 offset:24576
  v_mfma_f32_16x16x32_bf16 a[44:47], v[36:39], v[72:75], a[44:47]
  ds_read_b64_tr_b16 v[90:91], v17 offset:25600
  s_add_u32 s20, s20, 128
  v_mfma_f32_16x16x32_bf16 a[48:51], v[40:43], v[60:63], a[48:51]
  s_add_u32 s21, s21, s51
  v_mfma_f32_16x16x32_bf16 a[52:55], v[40:43], v[64:67], a[52:55]
  v_mfma_f32_16x16x32_bf16 a[56:59], v[40:43], v[68:71], a[56:59]
  v_mfma_f32_16x16x32_bf16 a[60:63], v[40:43], v[72:75], a[60:63]
  s_waitcnt lgkmcnt(0)
  v_mfma_f32_16x16x32_bf16 a[0:3], v[44:47], v[76:79], a[0:3]
  s_waitcnt vmcnt(16)
  s_barrier
  s_add_u32 m0, s52, 0
  v_mfma_f32_16x16x32_bf16 a[4:7], v[44:47], v[80:83], a[4:7]
  buffer_load_dwordx4 v2, s[8:11], s20 offen  lds
  ds_read_b128 v[28:31], v10 offset:32768
  v_mfma_f32_16x16x32_bf16 a[8:11], v[44:47], v[84:87], a[8:11]
  ds_read_b64_tr_b16 v[60:61], v14 offset:49152
  v_mfma_f32_16x16x32_bf16 a[12:15], v[44:47], v[88:91], a[12:15]
  ds_read_b64_tr_b16 v[62:63], v14 offset:50176
  s_add_u32 m0, s53, 0
  v_mfma_f32_16x16x32_bf16 a[16:19], v[48:51], v[76:79], a[16:19]
  buffer_load_dwordx4 v6, s[12:15], s21 offen  lds
  ds_read_b128 v[32:35], v10 offset:34816
  v_mfma_f32_16x16x32_bf16 a[20:23], v[48:51], v[80:83], a[20:23]
  ds_read_b64_tr_b16 v[64:65], v15 offset:49152
  v_mfma_f32_16x16x32_bf16 a[24:27], v[48:51], v[84:87], a[24:27]
  ds_read_b64_tr_b16 v[66:67], v15 offset:50176
  s_add_u32 m0, s52, 1024
  v_mfma_f32_16x16x32_bf16 a[28:31], v[48:51], v[88:91], a[28:31]
  buffer_load_dwordx4 v3, s[8:11], s20 offen  lds
  ds_read_b128 v[36:39], v10 offset:36864
  v_mfma_f32_16x16x32_bf16 a[32:35], v[52:55], v[76:79], a[32:35]
  ds_read_b64_tr_b16 v[68:69], v16 offset:49152
  v_mfma_f32_16x16x32_bf16 a[36:39], v[52:55], v[80:83], a[36:39]
  ds_read_b64_tr_b16 v[70:71], v16 offset:50176
  s_add_u32 m0, s53, 1024
  v_mfma_f32_16x16x32_bf16 a[40:43], v[52:55], v[84:87], a[40:43]
  buffer_load_dwordx4 v7, s[12:15], s21 offen  lds
  ds_read_b128 v[40:43], v10 offset:38912
  v_mfma_f32_16x16x32_bf16 a[44:47], v[52:55], v[88:91], a[44:47]
  ds_read_b64_tr_b16 v[72:73], v17 offset:49152
  v_mfma_f32_16x16x32_bf16 a[48:51], v[56:59], v[76:79], a[48:51]
  ds_read_b64_tr_b16 v[74:75], v17 offset:50176
  s_add_u32 m0, s52, 2048
  v_mfma_f32_16x16x32_bf16 a[52:55], v[56:59], v[80:83], a[52:55]
  buffer_load_dwordx4 v4, s[8:11], s20 offen  lds
  v_mfma_f32_16x16x32_bf16 a[56:59], v[56:59], v[84:87], a[56:59]
  v_mfma_f32_16x16x32_bf16 a[60:63], v[56:59], v[88:91], a[60:63]
  s_waitcnt lgkmcnt(0)
  s_add_u32 m0, s53, 2048
  v_mfma_f32_16x16x32_bf16 a[0:3], v[28:31], v[60:63], a[0:3]
  buffer_load_dwordx4 v8, s[12:15], s21 offen  lds
  ds_read_b128 v[44:47], v11 offset:32768
  v_mfma_f32_16x16x32_bf16 a[4:7], v[28:31], v[64:67], a[4:7]
  ds_read_b64_tr_b16 v[76:77], v14 offset:57344
  v_mfma_f32_16x16x32_bf16 a[8:11], v[28:31], v[68:71], a[8:11]
  ds_read_b64_tr_b16 v[78:79], v14 offset:58368
  v_mfma_f32_16x16x32_bf16 a[12:15], v[28:31], v[72:75], a[12:15]
  ds_read_b128 v[48:51], v11 offset:34816
  s_add_u32 m0, s52, 3072
  v_mfma_f32_16x16x32_bf16 a[16:19], v[32:35], v[60:63], a[16:19]
  buffer_load_dwordx4 v5, s[8:11], s20 offen  lds
  ds_read_b64_tr_b16 v[80:81], v15 offset:57344
  v_mfma_f32_16x16x32_bf16 a[20:23], v[32:35], v[64:67], a[20:23]
  ds_read_b64_tr_b16 v[82:83], v15 offset:58368
  v_mfma_f32_16x16x32_bf16 a[24:27], v[32:35], v[68:71], a[24:27]
  ds_read_b128 v[52:55], v11 offset:36864
  v_mfma_f32_16x16x32_bf16 a[28:31], v[32:35], v[72:75], a[28:31]
  ds_read_b64_tr_b16 v[84:85], v16 offset:57344
  s_add_u32 m0, s53, 3072
  v_mfma_f32_16x16x32_bf16 a[32:35], v[36:39], v[60:63], a[32:35]
  buffer_load_dwordx4 v9, s[12:15], s21 offen  lds
  ds_read_b64_tr_b16 v[86:87], v16 offset:58368
  v_mfma_f32_16x16x32_bf16 a[36:39], v[36:39], v[64:67], a[36:39]
  ds_read_b128 v[56:59], v11 offset:38912
  v_mfma_f32_16x16x32_bf16 a[40:43], v[36:39], v[68:71], a[40:43]
  ds_read_b64_tr_b16 v[88:89], v17 offset:57344
  v_mfma_f32_16x16x32_bf16 a[44:47], v[36:39], v[72:75], a[44:47]
  ds_read_b64_tr_b16 v[90:91], v17 offset:58368
  s_add_u32 s20, s20, 128
  v_mfma_f32_16x16x32_bf16 a[48:51], v[40:43], v[60:63], a[48:51]
  s_add_u32 s21, s21, s51
  v_mfma_f32_16x16x32_bf16 a[52:55], v[40:43], v[64:67], a[52:55]
  v_mfma_f32_16x16x32_bf16 a[56:59], v[40:43], v[68:71], a[56:59]
  v_mfma_f32_16x16x32_bf16 a[60:63], v[40:43], v[72:75], a[60:63]
  s_waitcnt lgkmcnt(0)
  v_mfma_f32_16x16x32_bf16 a[0:3], v[44:47], v[76:79], a[0:3]
  s_waitcnt vmcnt(16)
  s_barrier
  s_add_u32 m0, s52, 32768
  v_mfma_f32_16x16x32_bf16 a[4:7], v[44:47], v[80:83], a[4:7]
  buffer_load_dwordx4 v2, s[8:11], s20 offen  lds
  ds_read_b128 v[28:31], v12 offset:0
  v_mfma_f32_16x16x32_bf16 a[8:11], v[44:47], v[84:87], a[8:11]
  ds_read_b64_tr_b16 v[60:61], v18 offset:16384
  v_mfma_f32_16x16x32_bf16 a[12:15], v[44:47], v[88:91], a[12:15]
  ds_read_b64_tr_b16 v[62:63], v18 offset:17408
  s_add_u32 m0, s53, 32768
  v_mfma_f32_16x16x32_bf16 a[16:19], v[48:51], v[76:79], a[16:19]
  buffer_load_dwordx4 v6, s[12:15], s21 offen  lds
  ds_read_b128 v[32:35], v12 offset:2048
  v_mfma_f32_16x16x32_bf16 a[20:23], v[48:51], v[80:83], a[20:23]
  ds_read_b64_tr_b16 v[64:65], v19 offset:16384
  v_mfma_f32_16x16x32_bf16 a[24:27], v[48:51], v[84:87], a[24:27]
  ds_read_b64_tr_b16 v[66:67], v19 offset:17408
  s_add_u32 m0, s52, 33792
  v_mfma_f32_16x16x32_bf16 a[28:31], v[48:51], v[88:91], a[28:31]
  buffer_load_dwordx4 v3, s[8:11], s20 offen  lds
  ds_read_b128 v[36:39], v12 offset:4096
  v_mfma_f32_16x16x32_bf16 a[32:35], v[52:55], v[76:79], a[32:35]
  ds_read_b64_tr_b16 v[68:69], v20 offset:16384
  v_mfma_f32_16x16x32_bf16 a[36:39], v[52:55], v[80:83], a[36:39]
  ds_read_b64_tr_b16 v[70:71], v20 offset:17408
  s_add_u32 m0, s53, 33792
  v_mfma_f32_16x16x32_bf16 a[40:43], v[52:55], v[84:87], a[40:43]
  buffer_load_dwordx4 v7, s[12:15], s21 offen  lds
  ds_read_b128 v[40:43], v12 offset:6144
  v_mfma_f32_16x16x32_bf16 a[44:47], v[52:55], v[88:91], a[44:47]
  ds_read_b64_tr_b16 v[72:73], v21 offset:16384
  v_mfma_f32_16x16x32_bf16 a[48:51], v[56:59], v[76:79], a[48:51]
  ds_read_b64_tr_b16 v[74:75], v21 offset:17408
  s_add_u32 m0, s52, 34816
  v_mfma_f32_16x16x32_bf16 a[52:55], v[56:59], v[80:83], a[52:55]
  buffer_load_dwordx4 v4, s[8:11], s20 offen  lds
  v_mfma_f32_16x16x32_bf16 a[56:59], v[56:59], v[84:87], a[56:59]
  v_mfma_f32_16x16x32_bf16 a[60:63], v[56:59], v[88:91], a[60:63]
  s_waitcnt lgkmcnt(0)
  s_add_u32 m0, s53, 34816
  v_mfma_f32_16x16x32_bf16 a[0:3], v[28:31], v[60:63], a[0:3]
  buffer_load_dwordx4 v8, s[12:15], s21 offen  lds
  ds_read_b128 v[44:47], v13 offset:0
  v_mfma_f32_16x16x32_bf16 a[4:7], v[28:31], v[64:67], a[4:7]
  ds_read_b64_tr_b16 v[76:77], v18 offset:24576
  v_mfma_f32_16x16x32_bf16 a[8:11], v[28:31], v[68:71], a[8:11]
  ds_read_b64_tr_b16 v[78:79], v18 offset:25600
  v_mfma_f32_16x16x32_bf16 a[12:15], v[28:31], v[72:75], a[12:15]
  ds_read_b128 v[48:51], v13 offset:2048
  s_add_u32 m0, s52, 35840
  v_mfma_f32_16x16x32_bf16 a[16:19], v[32:35], v[60:63], a[16:19]
  buffer_load_dwordx4 v5, s[8:11], s20 offen  lds
  ds_read_b64_tr_b16 v[80:81], v19 offset:24576
  v_mfma_f32_16x16x32_bf16 a[20:23], v[32:35], v[64:67], a[20:23]
  ds_read_b64_tr_b16 v[82:83], v19 offset:25600
  v_mfma_f32_16x16x32_bf16 a[24:27], v[32:35], v[68:71], a[24:27]
  ds_read_b128 v[52:55], v13 offset:4096
  v_mfma_f32_16x16x32_bf16 a[28:31], v[32:35], v[72:75], a[28:31]
  ds_read_b64_tr_b16 v[84:85], v20 offset:24576
  s_add_u32 m0, s53, 35840
  v_mfma_f32_16x16x32_bf16 a[32:35], v[36:39], v[60:63], a[32:35]
  buffer_load_dwordx4 v9, s[12:15], s21 offen  lds
  ds_read_b64_tr_b16 v[86:87], v20 offset:25600
  v_mfma_f32_16x16x32_bf16 a[36:39], v[36:39], v[64:67], a[36:39]
  ds_read_b128 v[56:59], v13 offset:6144
  v_mfma_f32_16x16x32_bf16 a[40:43], v[36:39], v[68:71], a[40:43]
  ds_read_b64_tr_b16 v[88:89], v21 offset:24576
  v_mfma_f32_16x16x32_bf16 a[44:47], v[36:39], v[72:75], a[44:47]
  ds_read_b64_tr_b16 v[90:91], v21 offset:25600
  s_add_u32 s20, s20, 128
  v_mfma_f32_16x16x32_bf16 a[48:51], v[40:43], v[60:63], a[48:51]
  s_add_u32 s21, s21, s51
  v_mfma_f32_16x16x32_bf16 a[52:55], v[40:43], v[64:67], a[52:55]
  v_mfma_f32_16x16x32_bf16 a[56:59], v[40:43], v[68:71], a[56:59]
  v_mfma_f32_16x16x32_bf16 a[60:63], v[40:43], v[72:75], a[60:63]
  s_waitcnt lgkmcnt(0)
  v_mfma_f32_16x16x32_bf16 a[0:3], v[44:47], v[76:79], a[0:3]
  s_waitcnt vmcnt(16)
  s_barrier
  s_add_u32 m0, s52, 65536
  v_mfma_f32_16x16x32_bf16 a[4:7], v[44:47], v[80:83], a[4:7]
  buffer_load_dwordx4 v2, s[8:11], s20 offen  lds
  ds_read_b128 v[28:31], v12 offset:32768
  v_mfma_f32_16x16x32_bf16 a[8:11], v[44:47], v[84:87], a[8:11]
  ds_read_b64_tr_b16 v[60:61], v18 offset:49152
  v_mfma_f32_16x16x32_bf16 a[12:15], v[44:47], v[88:91], a[12:15]
  ds_read_b64_tr_b16 v[62:63], v18 offset:50176
  s_add_u32 m0, s53, 65536
  v_mfma_f32_16x16x32_bf16 a[16:19], v[48:51], v[76:79], a[16:19]
  buffer_load_dwordx4 v6, s[12:15], s21 offen  lds
  ds_read_b128 v[32:35], v12 offset:34816
  v_mfma_f32_16x16x32_bf16 a[20:23], v[48:51], v[80:83], a[20:23]
  ds_read_b64_tr_b16 v[64:65], v19 offset:49152
  v_mfma_f32_16x16x32_bf16 a[24:27], v[48:51], v[84:87], a[24:27]
  ds_read_b64_tr_b16 v[66:67], v19 offset:50176
  s_add_u32 m0, s52, 66560
  v_mfma_f32_16x16x32_bf16 a[28:31], v[48:51], v[88:91], a[28:31]
  buffer_load_dwordx4 v3, s[8:11], s20 offen  lds
  ds_read_b128 v[36:39], v12 offset:36864
  v_mfma_f32_16x16x32_bf16 a[32:35], v[52:55], v[76:79], a[32:35]
  ds_read_b64_tr_b16 v[68:69], v20 offset:49152
  v_mfma_f32_16x16x32_bf16 a[36:39], v[52:55], v[80:83], a[36:39]
  ds_read_b64_tr_b16 v[70:71], v20 offset:50176
  s_add_u32 m0, s53, 66560
  v_mfma_f32_16x16x32_bf16 a[40:43], v[52:55], v[84:87], a[40:43]
  buffer_load_dwordx4 v7, s[12:15], s21 offen  lds
  ds_read_b128 v[40:43], v12 offset:38912
  v_mfma_f32_16x16x32_bf16 a[44:47], v[52:55], v[88:91], a[44:47]
  ds_read_b64_tr_b16 v[72:73], v21 offset:49152
  v_mfma_f32_16x16x32_bf16 a[48:51], v[56:59], v[76:79], a[48:51]
  ds_read_b64_tr_b16 v[74:75], v21 offset:50176
  s_add_u32 m0, s52, 67584
  v_mfma_f32_16x16x32_bf16 a[52:55], v[56:59], v[80:83], a[52:55]
  buffer_load_dwordx4 v4, s[8:11], s20 offen  lds
  v_mfma_f32_16x16x32_bf16 a[56:59], v[56:59], v[84:87], a[56:59]
  v_mfma_f32_16x16x32_bf16 a[60:63], v[56:59], v[88:91], a[60:63]
  s_waitcnt lgkmcnt(0)
  s_add_u32 m0, s53, 67584
  v_mfma_f32_16x16x32_bf16 a[0:3], v[28:31], v[60:63], a[0:3]
  buffer_load_dwordx4 v8, s[12:15], s21 offen  lds
  ds_read_b128 v[44:47], v13 offset:32768
  v_mfma_f32_16x16x32_bf16 a[4:7], v[28:31], v[64:67], a[4:7]
  ds_read_b64_tr_b16 v[76:77], v18 offset:57344
  v_mfma_f32_16x16x32_bf16 a[8:11], v[28:31], v[68:71], a[8:11]
  ds_read_b64_tr_b16 v[78:79], v18 offset:58368
  v_mfma_f32_16x16x32_bf16 a[12:15], v[28:31], v[72:75], a[12:15]
  ds_read_b128 v[48:51], v13 offset:34816
  s_add_u32 m0, s52, 68608
  v_mfma_f32_16x16x32_bf16 a[16:19], v[32:35], v[60:63], a[16:19]
  buffer_load_dwordx4 v5, s[8:11], s20 offen  lds
  ds_read_b64_tr_b16 v[80:81], v19 offset:57344
  v_mfma_f32_16x16x32_bf16 a[20:23], v[32:35], v[64:67], a[20:23]
  ds_read_b64_tr_b16 v[82:83], v19 offset:58368
  v_mfma_f32_16x16x32_bf16 a[24:27], v[32:35], v[68:71], a[24:27]
  ds_read_b128 v[52:55], v13 offset:36864
  v_mfma_f32_16x16x32_bf16 a[28:31], v[32:35], v[72:75], a[28:31]
  ds_read_b64_tr_b16 v[84:85], v20 offset:57344
  s_add_u32 m0, s53, 68608
  v_mfma_f32_16x16x32_bf16 a[32:35], v[36:39], v[60:63], a[32:35]
  buffer_load_dwordx4 v9, s[12:15], s21 offen  lds
  ds_read_b64_tr_b16 v[86:87], v20 offset:58368
  v_mfma_f32_16x16x32_bf16 a[36:39], v[36:39], v[64:67], a[36:39]
  ds_read_b128 v[56:59], v13 offset:38912
  v_mfma_f32_16x16x32_bf16 a[40:43], v[36:39], v[68:71], a[40:43]
  ds_read_b64_tr_b16 v[88:89], v21 offset:57344
  v_mfma_f32_16x16x32_bf16 a[44:47], v[36:39], v[72:75], a[44:47]
  ds_read_b64_tr_b16 v[90:91], v21 offset:58368
  s_add_u32 s20, s20, 128
  v_mfma_f32_16x16x32_bf16 a[48:51], v[40:43], v[60:63], a[48:51]
  s_add_u32 s21, s21, s51
  v_mfma_f32_16x16x32_bf16 a[52:55], v[40:43], v[64:67], a[52:55]
  v_mfma_f32_16x16x32_bf16 a[56:59], v[40:43], v[68:71], a[56:59]
  v_mfma_f32_16x16x32_bf16 a[60:63], v[40:43], v[72:75], a[60:63]
  s_waitcnt lgkmcnt(0)
  v_mfma_f32_16x16x32_bf16 a[0:3], v[44:47], v[76:79], a[0:3]
  s_waitcnt vmcnt(16)
  s_barrier
  s_add_u32 m0, s52, 98304
  v_mfma_f32_16x16x32_bf16 a[4:7], v[44:47], v[80:83], a[4:7]
  buffer_load_dwordx4 v2, s[8:11], s20 offen  lds
  ds_read_b128 v[28:31], v10 offset:0
  v_mfma_f32_16x16x32_bf16 a[8:11], v[44:47], v[84:87], a[8:11]
  ds_read_b64_tr_b16 v[60:61], v14 offset:16384
  v_mfma_f32_16x16x32_bf16 a[12:15], v[44:47], v[88:91], a[12:15]
  ds_read_b64_tr_b16 v[62:63], v14 offset:17408
  s_add_u32 m0, s53, 98304
  v_mfma_f32_16x16x32_bf16 a[16:19], v[48:51], v[76:79], a[16:19]
  buffer_load_dwordx4 v6, s[12:15], s21 offen  lds
  ds_read_b128 v[32:35], v10 offset:2048
  v_mfma_f32_16x16x32_bf16 a[20:23], v[48:51], v[80:83], a[20:23]
  ds_read_b64_tr_b16 v[64:65], v15 offset:16384
  v_mfma_f32_16x16x32_bf16 a[24:27], v[48:51], v[84:87], a[24:27]
  ds_read_b64_tr_b16 v[66:67], v15 offset:17408
  s_add_u32 m0, s52, 99328
  v_mfma_f32_16x16x32_bf16 a[28:31], v[48:51], v[88:91], a[28:31]
  buffer_load_dwordx4 v3, s[8:11], s20 offen  lds
  ds_read_b128 v[36:39], v10 offset:4096
  v_mfma_f32_16x16x32_bf16 a[32:35], v[52:55], v[76:79], a[32:35]
  ds_read_b64_tr_b16 v[68:69], v16 offset:16384
  v_mfma_f32_16x16x32_bf16 a[36:39], v[52:55], v[80:83], a[36:39]
  ds_read_b64_tr_b16 v[70:71], v16 offset:17408
  s_add_u32 m0, s53, 99328
  v_mfma_f32_16x16x32_bf16 a[40:43], v[52:55], v[84:87], a[40:43]
  buffer_load_dwordx4 v7, s[12:15], s21 offen  lds
  ds_read_b128 v[40:43], v10 offset:6144
  v_mfma_f32_16x16x32_bf16 a[44:47], v[52:55], v[88:91], a[44:47]
  ds_read_b64_tr_b16 v[72:73], v17 offset:16384
  v_mfma_f32_16x16x32_bf16 a[48:51], v[56:59], v[76:79], a[48:51]
  ds_read_b64_tr_b16 v[74:75], v17 offset:17408
  s_add_u32 m0, s52, 100352
  v_mfma_f32_16x16x32_bf16 a[52:55], v[56:59], v[80:83], a[52:55]
  buffer_load_dwordx4 v4, s[8:11], s20 offen  lds
  v_mfma_f32_16x16x32_bf16 a[56:59], v[56:59], v[84:87], a[56:59]
  v_mfma_f32_16x16x32_bf16 a[60:63], v[56:59], v[88:91], a[60:63]
  s_branch L_g5_loop
L_g5_fin:
  s_cmp_lg_u32 s32, 0
  s_cbranch_scc1 L_rq_86
  s_cmp_eq_u32 s39, 0
  s_cbranch_scc1 L_rq_86
  s_lshl_b32 s99, s33, 7
  s_add_u32 s99, s99, 0x3d00200
  v_mov_b32 v244, 1
  v_mov_b32 v245, 0
  s_mov_b64 exec, 1
  buffer_atomic_add v244, v245, s[4:7], s99 offen sc0 sc1
  s_mov_b64 exec, -1
L_rq_86:
  s_waitcnt lgkmcnt(0)
  s_add_u32 m0, s53, 100352
  v_mfma_f32_16x16x32_bf16 a[0:3], v[28:31], v[60:63], a[0:3]
  buffer_load_dwordx4 v8, s[12:15], s21 offen  lds
  ds_read_b128 v[44:47], v11 offset:0
  v_mfma_f32_16x16x32_bf16 a[4:7], v[28:31], v[64:67], a[4:7]
  ds_read_b64_tr_b16 v[76:77], v14 offset:24576
  v_mfma_f32_16x16x32_bf16 a[8:11], v[28:31], v[68:71], a[8:11]
  ds_read_b64_tr_b16 v[78:79], v14 offset:25600
  v_mfma_f32_16x16x32_bf16 a[12:15], v[28:31], v[72:75], a[12:15]
  ds_read_b128 v[48:51], v11 offset:2048
  s_add_u32 m0, s52, 101376
  v_mfma_f32_16x16x32_bf16 a[16:19], v[32:35], v[60:63], a[16:19]
  buffer_load_dwordx4 v5, s[8:11], s20 offen  lds
  ds_read_b64_tr_b16 v[80:81], v15 offset:24576
  v_mfma_f32_16x16x32_bf16 a[20:23], v[32:35], v[64:67], a[20:23]
  ds_read_b64_tr_b16 v[82:83], v15 offset:25600
  v_mfma_f32_16x16x32_bf16 a[24:27], v[32:35], v[68:71], a[24:27]
  ds_read_b128 v[52:55], v11 offset:4096
  v_mfma_f32_16x16x32_bf16 a[28:31], v[32:35], v[72:75], a[28:31]
  ds_read_b64_tr_b16 v[84:85], v16 offset:24576
  s_add_u32 m0, s53, 101376
  v_mfma_f32_16x16x32_bf16 a[32:35], v[36:39], v[60:63], a[32:35]
  buffer_load_dwordx4 v9, s[12:15], s21 offen  lds
  ds_read_b64_tr_b16 v[86:87], v16 offset:25600
  v_mfma_f32_16x16x32_bf16 a[36:39], v[36:39], v[64:67], a[36:39]
  ds_read_b128 v[56:59], v11 offset:6144
  v_mfma_f32_16x16x32_bf16 a[40:43], v[36:39], v[68:71], a[40:43]
  ds_read_b64_tr_b16 v[88:89], v17 offset:24576
  v_mfma_f32_16x16x32_bf16 a[44:47], v[36:39], v[72:75], a[44:47]
  ds_read_b64_tr_b16 v[90:91], v17 offset:25600
  s_add_u32 s20, s20, 128
  v_mfma_f32_16x16x32_bf16 a[48:51], v[40:43], v[60:63], a[48:51]
  s_add_u32 s21, s21, s51
  v_mfma_f32_16x16x32_bf16 a[52:55], v[40:43], v[64:67], a[52:55]
  v_mfma_f32_16x16x32_bf16 a[56:59], v[40:43], v[68:71], a[56:59]
  v_mfma_f32_16x16x32_bf16 a[60:63], v[40:43], v[72:75], a[60:63]
  s_waitcnt lgkmcnt(0)
  v_mfma_f32_16x16x32_bf16 a[0:3], v[44:47], v[76:79], a[0:3]
  s_waitcnt vmcnt(16)
  s_barrier
  v_mfma_f32_16x16x32_bf16 a[4:7], v[44:47], v[80:83], a[4:7]
  ds_read_b128 v[28:31], v10 offset:32768
  v_mfma_f32_16x16x32_bf16 a[8:11], v[44:47], v[84:87], a[8:11]
  ds_read_b64_tr_b16 v[60:61], v14 offset:49152
  v_mfma_f32_16x16x32_bf16 a[12:15], v[44:47], v[88:91], a[12:15]
  ds_read_b64_tr_b16 v[62:63], v14 offset:50176
  v_mfma_f32_16x16x32_bf16 a[16:19], v[48:51], v[76:79], a[16:19]
  ds_read_b128 v[32:35], v10 offset:34816
  v_mfma_f32_16x16x32_bf16 a[20:23], v[48:51], v[80:83], a[20:23]
  ds_read_b64_tr_b16 v[64:65], v15 offset:49152
  v_mfma_f32_16x16x32_bf16 a[24:27], v[48:51], v[84:87], a[24:27]
  ds_read_b64_tr_b16 v[66:67], v15 offset:50176
  v_mfma_f32_16x16x32_bf16 a[28:31], v[48:51], v[88:91], a[28:31]
  ds_read_b128 v[36:39], v10 offset:36864
  v_mfma_f32_16x16x32_bf16 a[32:35], v[52:55], v[76:79], a[32:35]
  ds_read_b64_tr_b16 v[68:69], v16 offset:49152
  v_mfma_f32_16x16x32_bf16 a[36:39], v[52:55], v[80:83], a[36:39]
  ds_read_b64_tr_b16 v[70:71], v16 offset:50176
  v_mfma_f32_16x16x32_bf16 a[40:43], v[52:55], v[84:87], a[40:43]
  ds_read_b128 v[40:43], v10 offset:38912
  v_mfma_f32_16x16x32_bf16 a[44:47], v[52:55], v[88:91], a[44:47]
  ds_read_b64_tr_b16 v[72:73], v17 offset:49152
  v_mfma_f32_16x16x32_bf16 a[48:51], v[56:59], v[76:79], a[48:51]
  ds_read_b64_tr_b16 v[74:75], v17 offset:50176
  v_mfma_f32_16x16x32_bf16 a[52:55], v[56:59], v[80:83], a[52:55]
  v_mfma_f32_16x16x32_bf16 a[56:59], v[56:59], v[84:87], a[56:59]
  v_mfma_f32_16x16x32_bf16 a[60:63], v[56:59], v[88:91], a[60:63]
  s_waitcnt lgkmcnt(0)
  v_mfma_f32_16x16x32_bf16 a[0:3], v[28:31], v[60:63], a[0:3]
  ds_read_b128 v[44:47], v11 offset:32768
  v_mfma_f32_16x16x32_bf16 a[4:7], v[28:31], v[64:67], a[4:7]
  ds_read_b64_tr_b16 v[76:77], v14 offset:57344
  v_mfma_f32_16x16x32_bf16 a[8:11], v[28:31], v[68:71], a[8:11]
  ds_read_b64_tr_b16 v[78:79], v14 offset:58368
  v_mfma_f32_16x16x32_bf16 a[12:15], v[28:31], v[72:75], a[12:15]
  ds_read_b128 v[48:51], v11 offset:34816
  v_mfma_f32_16x16x32_bf16 a[16:19], v[32:35], v[60:63], a[16:19]
  ds_read_b64_tr_b16 v[80:81], v15 offset:57344
  v_mfma_f32_16x16x32_bf16 a[20:23], v[32:35], v[64:67], a[20:23]
  ds_read_b64_tr_b16 v[82:83], v15 offset:58368
  v_mfma_f32_16x16x32_bf16 a[24:27], v[32:35], v[68:71], a[24:27]
  ds_read_b128 v[52:55], v11 offset:36864
  v_mfma_f32_16x16x32_bf16 a[28:31], v[32:35], v[72:75], a[28:31]
  ds_read_b64_tr_b16 v[84:85], v16 offset:57344
  v_mfma_f32_16x16x32_bf16 a[32:35], v[36:39], v[60:63], a[32:35]
  ds_read_b64_tr_b16 v[86:87], v16 offset:58368
  v_mfma_f32_16x16x32_bf16 a[36:39], v[36:39], v[64:67], a[36:39]
  ds_read_b128 v[56:59], v11 offset:38912
  v_mfma_f32_16x16x32_bf16 a[40:43], v[36:39], v[68:71], a[40:43]
  ds_read_b64_tr_b16 v[88:89], v17 offset:57344
  v_mfma_f32_16x16x32_bf16 a[44:47], v[36:39], v[72:75], a[44:47]
  ds_read_b64_tr_b16 v[90:91], v17 offset:58368
  v_mfma_f32_16x16x32_bf16 a[48:51], v[40:43], v[60:63], a[48:51]
  v_mfma_f32_16x16x32_bf16 a[52:55], v[40:43], v[64:67], a[52:55]
  v_mfma_f32_16x16x32_bf16 a[56:59], v[40:43], v[68:71], a[56:59]
  v_mfma_f32_16x16x32_bf16 a[60:63], v[40:43], v[72:75], a[60:63]
  s_waitcnt lgkmcnt(0)
  v_mfma_f32_16x16x32_bf16 a[0:3], v[44:47], v[76:79], a[0:3]
  s_waitcnt vmcnt(8)
  s_barrier
  v_mfma_f32_16x16x32_bf16 a[4:7], v[44:47], v[80:83], a[4:7]
  ds_read_b128 v[28:31], v12 offset:0
  v_mfma_f32_16x16x32_bf16 a[8:11], v[44:47], v[84:87], a[8:11]
  ds_read_b64_tr_b16 v[60:61], v18 offset:16384
  v_mfma_f32_16x16x32_bf16 a[12:15], v[44:47], v[88:91], a[12:15]
  ds_read_b64_tr_b16 v[62:63], v18 offset:17408
  v_mfma_f32_16x16x32_bf16 a[16:19], v[48:51], v[76:79], a[16:19]
  ds_read_b128 v[32:35], v12 offset:2048
  v_mfma_f32_16x16x32_bf16 a[20:23], v[48:51], v[80:83], a[20:23]
  ds_read_b64_tr_b16 v[64:65], v19 offset:16384
  v_mfma_f32_16x16x32_bf16 a[24:27], v[48:51], v[84:87], a[24:27]
  ds_read_b64_tr_b16 v[66:67], v19 offset:17408
  v_mfma_f32_16x16x32_bf16 a[28:31], v[48:51], v[88:91], a[28:31]
  ds_read_b128 v[36:39], v12 offset:4096
  v_mfma_f32_16x16x32_bf16 a[32:35], v[52:55], v[76:79], a[32:35]
  ds_read_b64_tr_b16 v[68:69], v20 offset:16384
  v_mfma_f32_16x16x32_bf16 a[36:39], v[52:55], v[80:83], a[36:39]
  ds_read_b64_tr_b16 v[70:71], v20 offset:17408
  v_mfma_f32_16x16x32_bf16 a[40:43], v[52:55], v[84:87], a[40:43]
  ds_read_b128 v[40:43], v12 offset:6144
  v_mfma_f32_16x16x32_bf16 a[44:47], v[52:55], v[88:91], a[44:47]
  ds_read_b64_tr_b16 v[72:73], v21 offset:16384
  v_mfma_f32_16x16x32_bf16 a[48:51], v[56:59], v[76:79], a[48:51]
  ds_read_b64_tr_b16 v[74:75], v21 offset:17408
  v_mfma_f32_16x16x32_bf16 a[52:55], v[56:59], v[80:83], a[52:55]
  v_mfma_f32_16x16x32_bf16 a[56:59], v[56:59], v[84:87], a[56:59]
  v_mfma_f32_16x16x32_bf16 a[60:63], v[56:59], v[88:91], a[60:63]
  s_waitcnt lgkmcnt(0)
  v_mfma_f32_16x16x32_bf16 a[0:3], v[28:31], v[60:63], a[0:3]
  ds_read_b128 v[44:47], v13 offset:0
  v_mfma_f32_16x16x32_bf16 a[4:7], v[28:31], v[64:67], a[4:7]
  ds_read_b64_tr_b16 v[76:77], v18 offset:24576
  v_mfma_f32_16x16x32_bf16 a[8:11], v[28:31], v[68:71], a[8:11]
  ds_read_b64_tr_b16 v[78:79], v18 offset:25600
  v_mfma_f32_16x16x32_bf16 a[12:15], v[28:31], v[72:75], a[12:15]
  ds_read_b128 v[48:51], v13 offset:2048
  v_mfma_f32_16x16x32_bf16 a[16:19], v[32:35], v[60:63], a[16:19]
  ds_read_b64_tr_b16 v[80:81], v19 offset:24576
  v_mfma_f32_16x16x32_bf16 a[20:23], v[32:35], v[64:67], a[20:23]
  ds_read_b64_tr_b16 v[82:83], v19 offset:25600
  v_mfma_f32_16x16x32_bf16 a[24:27], v[32:35], v[68:71], a[24:27]
  ds_read_b128 v[52:55], v13 offset:4096
  v_mfma_f32_16x16x32_bf16 a[28:31], v[32:35], v[72:75], a[28:31]
  ds_read_b64_tr_b16 v[84:85], v20 offset:24576
  v_mfma_f32_16x16x32_bf16 a[32:35], v[36:39], v[60:63], a[32:35]
  ds_read_b64_tr_b16 v[86:87], v20 offset:25600
  v_mfma_f32_16x16x32_bf16 a[36:39], v[36:39], v[64:67], a[36:39]
  ds_read_b128 v[56:59], v13 offset:6144
  v_mfma_f32_16x16x32_bf16 a[40:43], v[36:39], v[68:71], a[40:43]
  ds_read_b64_tr_b16 v[88:89], v21 offset:24576
  v_mfma_f32_16x16x32_bf16 a[44:47], v[36:39], v[72:75], a[44:47]
  ds_read_b64_tr_b16 v[90:91], v21 offset:25600
  v_mfma_f32_16x16x32_bf16 a[48:51], v[40:43], v[60:63], a[48:51]
  v_mfma_f32_16x16x32_bf16 a[52:55], v[40:43], v[64:67], a[52:55]
  v_mfma_f32_16x16x32_bf16 a[56:59], v[40:43], v[68:71], a[56:59]
  v_mfma_f32_16x16x32_bf16 a[60:63], v[40:43], v[72:75], a[60:63]
  s_waitcnt lgkmcnt(0)
  v_mfma_f32_16x16x32_bf16 a[0:3], v[44:47], v[76:79], a[0:3]
  s_waitcnt vmcnt(0)
  s_barrier
  v_mfma_f32_16x16x32_bf16 a[4:7], v[44:47], v[80:83], a[4:7]
  ds_read_b128 v[28:31], v12 offset:32768
  v_mfma_f32_16x16x32_bf16 a[8:11], v[44:47], v[84:87], a[8:11]
  ds_read_b64_tr_b16 v[60:61], v18 offset:49152
  v_mfma_f32_16x16x32_bf16 a[12:15], v[44:47], v[88:91], a[12:15]
  ds_read_b64_tr_b16 v[62:63], v18 offset:50176
  v_mfma_f32_16x16x32_bf16 a[16:19], v[48:51], v[76:79], a[16:19]
  ds_read_b128 v[32:35], v12 offset:34816
  v_mfma_f32_16x16x32_bf16 a[20:23], v[48:51], v[80:83], a[20:23]
  ds_read_b64_tr_b16 v[64:65], v19 offset:49152
  v_mfma_f32_16x16x32_bf16 a[24:27], v[48:51], v[84:87], a[24:27]
  ds_read_b64_tr_b16 v[66:67], v19 offset:50176
  v_mfma_f32_16x16x32_bf16 a[28:31], v[48:51], v[88:91], a[28:31]
  ds_read_b128 v[36:39], v12 offset:36864
  v_mfma_f32_16x16x32_bf16 a[32:35], v[52:55], v[76:79], a[32:35]
  ds_read_b64_tr_b16 v[68:69], v20 offset:49152
  v_mfma_f32_16x16x32_bf16 a[36:39], v[52:55], v[80:83], a[36:39]
  ds_read_b64_tr_b16 v[70:71], v20 offset:50176
  v_mfma_f32_16x16x32_bf16 a[40:43], v[52:55], v[84:87], a[40:43]
  ds_read_b128 v[40:43], v12 offset:38912
  v_mfma_f32_16x16x32_bf16 a[44:47], v[52:55], v[88:91], a[44:47]
  ds_read_b64_tr_b16 v[72:73], v21 offset:49152
  v_mfma_f32_16x16x32_bf16 a[48:51], v[56:59], v[76:79], a[48:51]
  ds_read_b64_tr_b16 v[74:75], v21 offset:50176
  v_mfma_f32_16x16x32_bf16 a[52:55], v[56:59], v[80:83], a[52:55]
  v_mfma_f32_16x16x32_bf16 a[56:59], v[56:59], v[84:87], a[56:59]
  v_mfma_f32_16x16x32_bf16 a[60:63], v[56:59], v[88:91], a[60:63]
  s_waitcnt lgkmcnt(0)
  v_mfma_f32_16x16x32_bf16 a[0:3], v[28:31], v[60:63], a[0:3]
  ds_read_b128 v[44:47], v13 offset:32768
  v_mfma_f32_16x16x32_bf16 a[4:7], v[28:31], v[64:67], a[4:7]
  ds_read_b64_tr_b16 v[76:77], v18 offset:57344
  v_mfma_f32_16x16x32_bf16 a[8:11], v[28:31], v[68:71], a[8:11]
  ds_read_b64_tr_b16 v[78:79], v18 offset:58368
  v_mfma_f32_16x16x32_bf16 a[12:15], v[28:31], v[72:75], a[12:15]
  ds_read_b128 v[48:51], v13 offset:34816
  v_mfma_f32_16x16x32_bf16 a[16:19], v[32:35], v[60:63], a[16:19]
  ds_read_b64_tr_b16 v[80:81], v19 offset:57344
  v_mfma_f32_16x16x32_bf16 a[20:23], v[32:35], v[64:67], a[20:23]
  ds_read_b64_tr_b16 v[82:83], v19 offset:58368
  v_mfma_f32_16x16x32_bf16 a[24:27], v[32:35], v[68:71], a[24:27]
  ds_read_b128 v[52:55], v13 offset:36864
  v_mfma_f32_16x16x32_bf16 a[28:31], v[32:35], v[72:75], a[28:31]
  ds_read_b64_tr_b16 v[84:85], v20 offset:57344
  v_mfma_f32_16x16x32_bf16 a[32:35], v[36:39], v[60:63], a[32:35]
  ds_read_b64_tr_b16 v[86:87], v20 offset:58368
  v_mfma_f32_16x16x32_bf16 a[36:39], v[36:39], v[64:67], a[36:39]
  ds_read_b128 v[56:59], v13 offset:38912
  v_mfma_f32_16x16x32_bf16 a[40:43], v[36:39], v[68:71], a[40:43]
  ds_read_b64_tr_b16 v[88:89], v21 offset:57344
  v_mfma_f32_16x16x32_bf16 a[44:47], v[36:39], v[72:75], a[44:47]
  ds_read_b64_tr_b16 v[90:91], v21 offset:58368
  v_mfma_f32_16x16x32_bf16 a[48:51], v[40:43], v[60:63], a[48:51]
  v_mfma_f32_16x16x32_bf16 a[52:55], v[40:43], v[64:67], a[52:55]
  v_mfma_f32_16x16x32_bf16 a[56:59], v[40:43], v[68:71], a[56:59]
  v_mfma_f32_16x16x32_bf16 a[60:63], v[40:43], v[72:75], a[60:63]
  s_waitcnt lgkmcnt(0)
  v_mfma_f32_16x16x32_bf16 a[0:3], v[44:47], v[76:79], a[0:3]
  v_mfma_f32_16x16x32_bf16 a[4:7], v[44:47], v[80:83], a[4:7]
  v_mfma_f32_16x16x32_bf16 a[8:11], v[44:47], v[84:87], a[8:11]
  v_mfma_f32_16x16x32_bf16 a[12:15], v[44:47], v[88:91], a[12:15]
  v_mfma_f32_16x16x32_bf16 a[16:19], v[48:51], v[76:79], a[16:19]
  v_mfma_f32_16x16x32_bf16 a[20:23], v[48:51], v[80:83], a[20:23]
  v_mfma_f32_16x16x32_bf16 a[24:27], v[48:51], v[84:87], a[24:27]
  v_mfma_f32_16x16x32_bf16 a[28:31], v[48:51], v[88:91], a[28:31]
  v_mfma_f32_16x16x32_bf16 a[32:35], v[52:55], v[76:79], a[32:35]
  v_mfma_f32_16x16x32_bf16 a[36:39], v[52:55], v[80:83], a[36:39]
  v_mfma_f32_16x16x32_bf16 a[40:43], v[52:55], v[84:87], a[40:43]
  v_mfma_f32_16x16x32_bf16 a[44:47], v[52:55], v[88:91], a[44:47]
  v_mfma_f32_16x16x32_bf16 a[48:51], v[56:59], v[76:79], a[48:51]
  v_mfma_f32_16x16x32_bf16 a[52:55], v[56:59], v[80:83], a[52:55]
  v_mfma_f32_16x16x32_bf16 a[56:59], v[56:59], v[84:87], a[56:59]
  v_mfma_f32_16x16x32_bf16 a[60:63], v[56:59], v[88:91], a[60:63]
  s_mov_b32 s59, 4
  s_mov_b32 s60, s22
  s_mov_b32 s61, s26
  s_add_u32 s62, s38, 0x3d00000
  s_mov_b32 s63, s98
  s_cmp_lg_u32 s39, 0
  s_cbranch_scc1 L_got
  s_mov_b32 s58, 3
  s_branch L_epi
L_swp:
  s_barrier
  v_and_b32 v1, 63, v0
  v_lshlrev_b32 v2, 7, v1
  s_lshl_b32 s40, s36, 2
  s_add_u32 s40, s40, s33
  s_lshl_b32 s40, s40, 2
  s_add_u32 s40, s40, s32
  s_lshl_b32 s40, s40, 13
  s_mov_b32 s44, s78
  s_and_b32 s45, s79, 0xffff
  s_mov_b32 s46, 0x400000
  s_mov_b32 s47, 0x20000
  s_mov_b32 s41, s40
  buffer_load_dword v4, v2, s[44:47], s41 offen
  s_add_u32 s41, s41, 524288
  buffer_load_dword v5, v2, s[44:47], s41 offen
  s_add_u32 s41, s41, 524288
  buffer_load_dword v6, v2, s[44:47], s41 offen
  s_add_u32 s41, s41, 524288
  buffer_load_dword v7, v2, s[44:47], s41 offen
  s_add_u32 s41, s41, 524288
  buffer_load_dword v8, v2, s[44:47], s41 offen
  s_add_u32 s41, s41, 524288
  buffer_load_dword v9, v2, s[44:47], s41 offen
  s_add_u32 s41, s41, 524288
  buffer_load_dword v10, v2, s[44:47], s41 offen
  s_add_u32 s41, s41, 524288
  buffer_load_dword v11, v2, s[44:47], s41 offen
  s_add_u32 s41, s41, 524288
  s_mov_b32 s44, s80
  s_and_b32 s45, s81, 0xffff
  s_mov_b32 s46, 0x600000
  s_mov_b32 s47, 0x20000
  s_mov_b32 s41, s40
  buffer_load_dword v4, v2, s[44:47], s41 offen
  s_add_u32 s41, s41, 524288
  buffer_load_dword v5, v2, s[44:47], s41 offen
  s_add_u32 s41, s41, 524288
  buffer_load_dword v6, v2, s[44:47], s41 offen
  s_add_u32 s41, s41, 524288
  buffer_load_dword v7, v2, s[44:47], s41 offen
  s_add_u32 s41, s41, 524288
  buffer_load_dword v8, v2, s[44:47], s41 offen
  s_add_u32 s41, s41, 524288
  buffer_load_dword v9, v2, s[44:47], s41 offen
  s_add_u32 s41, s41, 524288
  buffer_load_dword v10, v2, s[44:47], s41 offen
  s_add_u32 s41, s41, 524288
  buffer_load_dword v11, v2, s[44:47], s41 offen
  s_add_u32 s41, s41, 524288
  buffer_load_dword v12, v2, s[44:47], s41 offen
  s_add_u32 s41, s41, 524288
  buffer_load_dword v13, v2, s[44:47], s41 offen
  s_add_u32 s41, s41, 524288
  buffer_load_dword v14, v2, s[44:47], s41 offen
  s_add_u32 s41, s41, 524288
  buffer_load_dword v15, v2, s[44:47], s41 offen
  s_add_u32 s41, s41, 524288
  s_mov_b32 s44, s82
  s_and_b32 s45, s83, 0xffff
  s_mov_b32 s46, 0x200000
  s_mov_b32 s47, 0x20000
  s_mov_b32 s41, s40
  buffer_load_dword v4, v2, s[44:47], s41 offen
  s_add_u32 s41, s41, 524288
  buffer_load_dword v5, v2, s[44:47], s41 offen
  s_add_u32 s41, s41, 524288
  buffer_load_dword v6, v2, s[44:47], s41 offen
  s_add_u32 s41, s41, 524288
  buffer_load_dword v7, v2, s[44:47], s41 offen
  s_add_u32 s41, s41, 524288
  s_branch L_next
L_atb:
  s_lshl_b32 s90, s33, 7
  s_lshl_b32 s40, s36, 9
  s_add_u32 s40, s40, s90
  s_max_u32 s41, s36, 1
  s_sub_u32 s41, s41, 1
  s_lshl_b32 s41, s41, 9
  s_add_u32 s41, s41, s90
  s_cmp_lg_u32 s32, 0
  s_cbranch_scc1 L_dd_88
  v_mov_b32 v228, 0x3d00000
  v_mov_b32 v231, 0x3d03000
L_dw_87:
  buffer_load_dword v234, v231, s[4:7], s40 offen offset:0 sc1
  buffer_load_dword v235, v231, s[4:7], s41 offen offset:0 sc1
  s_waitcnt vmcnt(0)
  s_mov_b32 s44, 1
  v_readfirstlane_b32 s45, v234
  s_cmp_ge_u32 s45, 3
  s_cselect_b32 s44, s44, 0
  v_readfirstlane_b32 s45, v235
  s_cmp_ge_u32 s45, 3
  s_cselect_b32 s44, s44, 0
  s_cmp_eq_u32 s44, 1
  s_cbranch_scc1 L_dd_88
  s_sleep 6
  s_add_u32 s3, s3, 1
  s_cmp_lt_u32 s3, 131072
  s_cbranch_scc1 L_dw_87
L_dd_88:
  s_barrier
  s_lshl_b32 s38, s36, 7
  s_add_u32 s38, s38, 1024
  s_lshl_b32 s46, s36, 3
  s_lshl_b32 s90, s37, 1
  s_add_u32 s99, s46, s90
  s_lshr_b32 s90, s32, 1
  s_add_u32 s99, s99, s90
  s_lshl_b32 s99, s99, 3
  s_lshl_b32 s90, s33, 1
  s_add_u32 s99, s99, s90
  s_and_b32 s90, s32, 1
  s_add_u32 s20, s99, s90
  v_and_b32 v1, 63, v0
  s_lshl_b32 s90, s20, 13
  s_sub_u32 s91, s90, 65536
  s_cmp_lt_u32 s20, 8
  s_cselect_b32 s91, s90, s91
  v_mov_b32 v2, 0x0
  v_bfe_u32 v7, v1, 0, 6
  v_lshl_add_u32 v2, v7, 4, v2
  v_add_u32 v3, 4096, v2
  s_add_u32 s92, s90, 67108864
  s_add_u32 s93, s90, 71303168
  s_add_u32 s94, s91, 71303168
  s_add_u32 s95, s90, 75497472
  s_add_u32 s96, s91, 75497472
  s_add_u32 s97, s90, 100663296
  buffer_load_dwordx4 v[8:11], v2, s[4:7], s92 offen offset:0 sc1
  buffer_load_dwordx4 v[12:15], v2, s[4:7], s92 offen offset:1024 sc1
  buffer_load_dwordx4 v[16:19], v2, s[4:7], s92 offen offset:2048 sc1
  buffer_load_dwordx4 v[20:23], v2, s[4:7], s92 offen offset:3072 sc1
  buffer_load_dwordx4 v[24:27], v3, s[4:7], s92 offen offset:0 sc1
  buffer_load_dwordx4 v[28:31], v3, s[4:7], s92 offen offset:1024 sc1
  buffer_load_dwordx4 v[32:35], v3, s[4:7], s92 offen offset:2048 sc1
  buffer_load_dwordx4 v[36:39], v3, s[4:7], s92 offen offset:3072 sc1
  buffer_load_dwordx4 v[40:43], v3, s[4:7], s94 offen offset:0 sc1
  buffer_load_dwordx4 v[44:47], v3, s[4:7], s94 offen offset:1024 sc1
  buffer_load_dwordx4 v[48:51], v3, s[4:7], s94 offen offset:2048 sc1
  buffer_load_dwordx4 v[52:55], v3, s[4:7], s94 offen offset:3072 sc1
  buffer_load_dwordx4 v[56:59], v2, s[4:7], s93 offen offset:0 sc1
  buffer_load_dwordx4 v[60:63], v2, s[4:7], s93 offen offset:1024 sc1
  buffer_load_dwordx4 v[64:67], v2, s[4:7], s93 offen offset:2048 sc1
  buffer_load_dwordx4 v[68:71], v2, s[4:7], s93 offen offset:3072 sc1
  buffer_load_dwordx4 v[72:75], v3, s[4:7], s93 offen offset:0 sc1
  buffer_load_dwordx4 v[76:79], v3, s[4:7], s93 offen offset:1024 sc1
  buffer_load_dwordx4 v[80:83], v3, s[4:7], s93 offen offset:2048 sc1
  buffer_load_dwordx4 v[84:87], v3, s[4:7], s93 offen offset:3072 sc1
  buffer_load_dwordx2 v[88:89], v2, s[4:7], s96 offen offset:8 sc1
  buffer_load_dwordx2 v[94:95], v2, s[4:7], s96 offen offset:1032 sc1
  buffer_load_dwordx2 v[100:101], v2, s[4:7], s96 offen offset:2056 sc1
  buffer_load_dwordx2 v[106:107], v2, s[4:7], s96 offen offset:3080 sc1
  buffer_load_dwordx2 v[112:113], v3, s[4:7], s96 offen offset:8 sc1
  buffer_load_dwordx2 v[118:119], v3, s[4:7], s96 offen offset:1032 sc1
  buffer_load_dwordx2 v[124:125], v3, s[4:7], s96 offen offset:2056 sc1
  buffer_load_dwordx2 v[130:131], v3, s[4:7], s96 offen offset:3080 sc1
  buffer_load_dwordx4 v[90:93], v2, s[4:7], s95 offen offset:0 sc1
  buffer_load_dwordx4 v[96:99], v2, s[4:7], s95 offen offset:1024 sc1
  buffer_load_dwordx4 v[102:105], v2, s[4:7], s95 offen offset:2048 sc1
  buffer_load_dwordx4 v[108:111], v2, s[4:7], s95 offen offset:3072 sc1
  buffer_load_dwordx4 v[114:117], v3, s[4:7], s95 offen offset:0 sc1
  buffer_load_dwordx4 v[120:123], v3, s[4:7], s95 offen offset:1024 sc1
  buffer_load_dwordx4 v[126:129], v3, s[4:7], s95 offen offset:2048 sc1
  buffer_load_dwordx4 v[132:135], v3, s[4:7], s95 offen offset:3072 sc1
  s_mov_b32 s40, 0x50000
  s_mov_b32 s41, 0x5550055
  s_mov_b32 s42, 0xa0000
  s_mov_b32 s43, 0xaaa00aa
  s_mov_b32 s44, 0x150001
  s_mov_b32 s45, 0x15550155
  s_mov_b32 s46, 0x2a0002
  s_mov_b32 s47, 0x2aaa02aa
  s_mov_b32 s48, 0x55505555
  s_mov_b32 s49, 0x50005500
  s_mov_b32 s50, 0xaaa0aaaa
  s_mov_b32 s51, 0xa000aa00
  s_mov_b32 s52, 0x55405554
  s_mov_b32 s53, 0x40005400
  s_mov_b32 s54, 0xaa80aaa8
  s_mov_b32 s55, 0x8000a800
  s_cmp_lt_u32 s20, 8
  s_cselect_b64 s[56:57], 0, s[40:41]
  s_cselect_b64 s[58:59], 0, s[42:43]
  s_cselect_b64 s[60:61], 0, s[44:45]
  s_cselect_b64 s[62:63], 0, s[46:47]
  s_mov_b32 s21, 0x3e8293ee
  v_mov_b32 v6, 0xcfa8965f
  s_waitcnt vmcnt(16)
  v_mfma_f32_16x16x32_bf16 v[136:139], v[40:43], v[8:11], 0
  v_mfma_f32_16x16x32_bf16 v[140:143], v[56:59], v[8:11], 0
  v_mfma_f32_16x16x32_bf16 v[144:147], v[44:47], v[12:15], 0
  v_mfma_f32_16x16x32_bf16 v[148:151], v[60:63], v[12:15], 0
  v_mfma_f32_16x16x32_bf16 v[152:155], v[48:51], v[16:19], 0
  v_mfma_f32_16x16x32_bf16 v[156:159], v[64:67], v[16:19], 0
  v_mfma_f32_16x16x32_bf16 v[160:163], v[52:55], v[20:23], 0
  v_mfma_f32_16x16x32_bf16 v[164:167], v[68:71], v[20:23], 0
  v_mfma_f32_16x16x32_bf16 v[168:171], v[56:59], v[24:27], 0
  v_mfma_f32_16x16x32_bf16 v[172:175], v[72:75], v[24:27], 0
  v_mfma_f32_16x16x32_bf16 v[176:179], v[60:63], v[28:31], 0
  v_mfma_f32_16x16x32_bf16 v[180:183], v[76:79], v[28:31], 0
  v_mfma_f32_16x16x32_bf16 v[184:187], v[64:67], v[32:35], 0
  v_mfma_f32_16x16x32_bf16 v[188:191], v[80:83], v[32:35], 0
  v_mfma_f32_16x16x32_bf16 v[192:195], v[68:71], v[36:39], 0
  v_mfma_f32_16x16x32_bf16 v[196:199], v[84:87], v[36:39], 0
  v_cndmask_b32 v136, v6, v136, s[56:57]
  v_cndmask_b32 v137, v6, v137, s[58:59]
  v_cndmask_b32 v138, v6, v138, s[60:61]
  v_cndmask_b32 v139, v6, v139, s[62:63]
  v_cndmask_b32 v140, v6, v140, s[48:49]
  v_cndmask_b32 v141, v6, v141, s[50:51]
  v_cndmask_b32 v142, v6, v142, s[52:53]
  v_cndmask_b32 v143, v6, v143, s[54:55]
  v_max3_f32 v4, v136, v137, v138
  v_max3_f32 v4, v4, v139, v140
  v_max3_f32 v4, v4, v141, v142
  v_max_f32 v4, v4, v143
  v_mov_b32 v5, v4
  s_nop 1
  v_permlane32_swap_b32 v4, v5
  v_max_f32 v4, v4, v5
  v_mov_b32 v5, v4
  s_nop 1
  v_permlane16_swap_b32 v4, v5
  v_max_f32 v4, v4, v5
  v_mul_f32 v4, s21, v4
  v_fma_f32 v136, v136, s21, -v4
  v_fma_f32 v137, v137, s21, -v4
  v_fma_f32 v138, v138, s21, -v4
  v_fma_f32 v139, v139, s21, -v4
  v_fma_f32 v140, v140, s21, -v4
  v_fma_f32 v141, v141, s21, -v4
  v_fma_f32 v142, v142, s21, -v4
  v_fma_f32 v143, v143, s21, -v4
  v_exp_f32 v136, v136
  v_exp_f32 v137, v137
  v_exp_f32 v138, v138
  v_exp_f32 v139, v139
  v_exp_f32 v140, v140
  v_exp_f32 v141, v141
  v_exp_f32 v142, v142
  v_exp_f32 v143, v143
  v_add_f32 v4, v136, v137
  v_add_f32 v4, v4, v138
  v_add_f32 v4, v4, v139
  v_add_f32 v4, v4, v140
  v_add_f32 v4, v4, v141
  v_add_f32 v4, v4, v142
  v_add_f32 v4, v4, v143
  v_mov_b32 v5, v4
  s_nop 1
  v_permlane32_swap_b32 v4, v5
  v_add_f32 v4, v4, v5
  v_mov_b32 v5, v4
  s_nop 1
  v_permlane16_swap_b32 v4, v5
  v_add_f32 v4, v4, v5
  v_rcp_f32 v4, v4
  s_nop 0
  v_mul_f32 v136, v136, v4
  v_mul_f32 v137, v137, v4
  v_mul_f32 v138, v138, v4
  v_mul_f32 v139, v139, v4
  v_mul_f32 v140, v140, v4
  v_mul_f32 v141, v141, v4
  v_mul_f32 v142, v142, v4
  v_mul_f32 v143, v143, v4
  v_cvt_pk_bf16_f32 v8, v136, v137
  v_cvt_pk_bf16_f32 v9, v138, v139
  v_cvt_pk_bf16_f32 v10, v140, v141
  v_cvt_pk_bf16_f32 v11, v142, v143
  v_cndmask_b32 v144, v6, v144, s[56:57]
  v_cndmask_b32 v145, v6, v145, s[58:59]
  v_cndmask_b32 v146, v6, v146, s[60:61]
  v_cndmask_b32 v147, v6, v147, s[62:63]
  v_cndmask_b32 v148, v6, v148, s[48:49]
  v_cndmask_b32 v149, v6, v149, s[50:51]
  v_cndmask_b32 v150, v6, v150, s[52:53]
  v_cndmask_b32 v151, v6, v151, s[54:55]
  v_max3_f32 v4, v144, v145, v146
  v_max3_f32 v4, v4, v147, v148
  v_max3_f32 v4, v4, v149, v150
  v_max_f32 v4, v4, v151
  v_mov_b32 v5, v4
  s_nop 1
  v_permlane32_swap_b32 v4, v5
  v_max_f32 v4, v4, v5
  v_mov_b32 v5, v4
  s_nop 1
  v_permlane16_swap_b32 v4, v5
  v_max_f32 v4, v4, v5
  v_mul_f32 v4, s21, v4
  v_fma_f32 v144, v144, s21, -v4
  v_fma_f32 v145, v145, s21, -v4
  v_fma_f32 v146, v146, s21, -v4
  v_fma_f32 v147, v147, s21, -v4
  v_fma_f32 v148, v148, s21, -v4
  v_fma_f32 v149, v149, s21, -v4
  v_fma_f32 v150, v150, s21, -v4
  v_fma_f32 v151, v151, s21, -v4
  v_exp_f32 v144, v144
  v_exp_f32 v145, v145
  v_exp_f32 v146, v146
  v_exp_f32 v147, v147
  v_exp_f32 v148, v148
  v_exp_f32 v149, v149
  v_exp_f32 v150, v150
  v_exp_f32 v151, v151
  v_add_f32 v4, v144, v145
  v_add_f32 v4, v4, v146
  v_add_f32 v4, v4, v147
  v_add_f32 v4, v4, v148
  v_add_f32 v4, v4, v149
  v_add_f32 v4, v4, v150
  v_add_f32 v4, v4, v151
  v_mov_b32 v5, v4
  s_nop 1
  v_permlane32_swap_b32 v4, v5
  v_add_f32 v4, v4, v5
  v_mov_b32 v5, v4
  s_nop 1
  v_permlane16_swap_b32 v4, v5
  v_add_f32 v4, v4, v5
  v_rcp_f32 v4, v4
  s_nop 0
  v_mul_f32 v144, v144, v4
  v_mul_f32 v145, v145, v4
  v_mul_f32 v146, v146, v4
  v_mul_f32 v147, v147, v4
  v_mul_f32 v148, v148, v4
  v_mul_f32 v149, v149, v4
  v_mul_f32 v150, v150, v4
  v_mul_f32 v151, v151, v4
  v_cvt_pk_bf16_f32 v12, v144, v145
  v_cvt_pk_bf16_f32 v13, v146, v147
  v_cvt_pk_bf16_f32 v14, v148, v149
  v_cvt_pk_bf16_f32 v15, v150, v151
  v_cndmask_b32 v152, v6, v152, s[56:57]
  v_cndmask_b32 v153, v6, v153, s[58:59]
  v_cndmask_b32 v154, v6, v154, s[60:61]
  v_cndmask_b32 v155, v6, v155, s[62:63]
  v_cndmask_b32 v156, v6, v156, s[48:49]
  v_cndmask_b32 v157, v6, v157, s[50:51]
  v_cndmask_b32 v158, v6, v158, s[52:53]
  v_cndmask_b32 v159, v6, v159, s[54:55]
  v_max3_f32 v4, v152, v153, v154
  v_max3_f32 v4, v4, v155, v156
  v_max3_f32 v4, v4, v157, v158
  v_max_f32 v4, v4, v159
  v_mov_b32 v5, v4
  s_nop 1
  v_permlane32_swap_b32 v4, v5
  v_max_f32 v4, v4, v5
  v_mov_b32 v5, v4
  s_nop 1
  v_permlane16_swap_b32 v4, v5
  v_max_f32 v4, v4, v5
  v_mul_f32 v4, s21, v4
  v_fma_f32 v152, v152, s21, -v4
  v_fma_f32 v153, v153, s21, -v4
  v_fma_f32 v154, v154, s21, -v4
  v_fma_f32 v155, v155, s21, -v4
  v_fma_f32 v156, v156, s21, -v4
  v_fma_f32 v157, v157, s21, -v4
  v_fma_f32 v158, v158, s21, -v4
  v_fma_f32 v159, v159, s21, -v4
  v_exp_f32 v152, v152
  v_exp_f32 v153, v153
  v_exp_f32 v154, v154
  v_exp_f32 v155, v155
  v_exp_f32 v156, v156
  v_exp_f32 v157, v157
  v_exp_f32 v158, v158
  v_exp_f32 v159, v159
  v_add_f32 v4, v152, v153
  v_add_f32 v4, v4, v154
  v_add_f32 v4, v4, v155
  v_add_f32 v4, v4, v156
  v_add_f32 v4, v4, v157
  v_add_f32 v4, v4, v158
  v_add_f32 v4, v4, v159
  v_mov_b32 v5, v4
  s_nop 1
  v_permlane32_swap_b32 v4, v5
  v_add_f32 v4, v4, v5
  v_mov_b32 v5, v4
  s_nop 1
  v_permlane16_swap_b32 v4, v5
  v_add_f32 v4, v4, v5
  v_rcp_f32 v4, v4
  s_nop 0
  v_mul_f32 v152, v152, v4
  v_mul_f32 v153, v153, v4
  v_mul_f32 v154, v154, v4
  v_mul_f32 v155, v155, v4
  v_mul_f32 v156, v156, v4
  v_mul_f32 v157, v157, v4
  v_mul_f32 v158, v158, v4
  v_mul_f32 v159, v159, v4
  v_cvt_pk_bf16_f32 v16, v152, v153
  v_cvt_pk_bf16_f32 v17, v154, v155
  v_cvt_pk_bf16_f32 v18, v156, v157
  v_cvt_pk_bf16_f32 v19, v158, v159
  v_cndmask_b32 v160, v6, v160, s[56:57]
  v_cndmask_b32 v161, v6, v161, s[58:59]
  v_cndmask_b32 v162, v6, v162, s[60:61]
  v_cndmask_b32 v163, v6, v163, s[62:63]
  v_cndmask_b32 v164, v6, v164, s[48:49]
  v_cndmask_b32 v165, v6, v165, s[50:51]
  v_cndmask_b32 v166, v6, v166, s[52:53]
  v_cndmask_b32 v167, v6, v167, s[54:55]
  v_max3_f32 v4, v160, v161, v162
  v_max3_f32 v4, v4, v163, v164
  v_max3_f32 v4, v4, v165, v166
  v_max_f32 v4, v4, v167
  v_mov_b32 v5, v4
  s_nop 1
  v_permlane32_swap_b32 v4, v5
  v_max_f32 v4, v4, v5
  v_mov_b32 v5, v4
  s_nop 1
  v_permlane16_swap_b32 v4, v5
  v_max_f32 v4, v4, v5
  v_mul_f32 v4, s21, v4
  v_fma_f32 v160, v160, s21, -v4
  v_fma_f32 v161, v161, s21, -v4
  v_fma_f32 v162, v162, s21, -v4
  v_fma_f32 v163, v163, s21, -v4
  v_fma_f32 v164, v164, s21, -v4
  v_fma_f32 v165, v165, s21, -v4
  v_fma_f32 v166, v166, s21, -v4
  v_fma_f32 v167, v167, s21, -v4
  v_exp_f32 v160, v160
  v_exp_f32 v161, v161
  v_exp_f32 v162, v162
  v_exp_f32 v163, v163
  v_exp_f32 v164, v164
  v_exp_f32 v165, v165
  v_exp_f32 v166, v166
  v_exp_f32 v167, v167
  v_add_f32 v4, v160, v161
  v_add_f32 v4, v4, v162
  v_add_f32 v4, v4, v163
  v_add_f32 v4, v4, v164
  v_add_f32 v4, v4, v165
  v_add_f32 v4, v4, v166
  v_add_f32 v4, v4, v167
  v_mov_b32 v5, v4
  s_nop 1
  v_permlane32_swap_b32 v4, v5
  v_add_f32 v4, v4, v5
  v_mov_b32 v5, v4
  s_nop 1
  v_permlane16_swap_b32 v4, v5
  v_add_f32 v4, v4, v5
  v_rcp_f32 v4, v4
  s_nop 0
  v_mul_f32 v160, v160, v4
  v_mul_f32 v161, v161, v4
  v_mul_f32 v162, v162, v4
  v_mul_f32 v163, v163, v4
  v_mul_f32 v164, v164, v4
  v_mul_f32 v165, v165, v4
  v_mul_f32 v166, v166, v4
  v_mul_f32 v167, v167, v4
  v_cvt_pk_bf16_f32 v20, v160, v161
  v_cvt_pk_bf16_f32 v21, v162, v163
  v_cvt_pk_bf16_f32 v22, v164, v165
  v_cvt_pk_bf16_f32 v23, v166, v167
  v_cndmask_b32 v168, v6, v168, s[40:41]
  v_cndmask_b32 v169, v6, v169, s[42:43]
  v_cndmask_b32 v170, v6, v170, s[44:45]
  v_cndmask_b32 v171, v6, v171, s[46:47]
  v_cndmask_b32 v172, v6, v172, s[48:49]
  v_cndmask_b32 v173, v6, v173, s[50:51]
  v_cndmask_b32 v174, v6, v174, s[52:53]
  v_cndmask_b32 v175, v6, v175, s[54:55]
  v_max3_f32 v4, v168, v169, v170
  v_max3_f32 v4, v4, v171, v172
  v_max3_f32 v4, v4, v173, v174
  v_max_f32 v4, v4, v175
  v_mov_b32 v5, v4
  s_nop 1
  v_permlane32_swap_b32 v4, v5
  v_max_f32 v4, v4, v5
  v_mov_b32 v5, v4
  s_nop 1
  v_permlane16_swap_b32 v4, v5
  v_max_f32 v4, v4, v5
  v_mul_f32 v4, s21, v4
  v_fma_f32 v168, v168, s21, -v4
  v_fma_f32 v169, v169, s21, -v4
  v_fma_f32 v170, v170, s21, -v4
  v_fma_f32 v171, v171, s21, -v4
  v_fma_f32 v172, v172, s21, -v4
  v_fma_f32 v173, v173, s21, -v4
  v_fma_f32 v174, v174, s21, -v4
  v_fma_f32 v175, v175, s21, -v4
  v_exp_f32 v168, v168
  v_exp_f32 v169, v169
  v_exp_f32 v170, v170
  v_exp_f32 v171, v171
  v_exp_f32 v172, v172
  v_exp_f32 v173, v173
  v_exp_f32 v174, v174
  v_exp_f32 v175, v175
  v_add_f32 v4, v168, v169
  v_add_f32 v4, v4, v170
  v_add_f32 v4, v4, v171
  v_add_f32 v4, v4, v172
  v_add_f32 v4, v4, v173
  v_add_f32 v4, v4, v174
  v_add_f32 v4, v4, v175
  v_mov_b32 v5, v4
  s_nop 1
  v_permlane32_swap_b32 v4, v5
  v_add_f32 v4, v4, v5
  v_mov_b32 v5, v4
  s_nop 1
  v_permlane16_swap_b32 v4, v5
  v_add_f32 v4, v4, v5
  v_rcp_f32 v4, v4
  s_nop 0
  v_mul_f32 v168, v168, v4
  v_mul_f32 v169, v169, v4
  v_mul_f32 v170, v170, v4
  v_mul_f32 v171, v171, v4
  v_mul_f32 v172, v172, v4
  v_mul_f32 v173, v173, v4
  v_mul_f32 v174, v174, v4
  v_mul_f32 v175, v175, v4
  v_cvt_pk_bf16_f32 v24, v168, v169
  v_cvt_pk_bf16_f32 v25, v170, v171
  v_cvt_pk_bf16_f32 v26, v172, v173
  v_cvt_pk_bf16_f32 v27, v174, v175
  v_cndmask_b32 v176, v6, v176, s[40:41]
  v_cndmask_b32 v177, v6, v177, s[42:43]
  v_cndmask_b32 v178, v6, v178, s[44:45]
  v_cndmask_b32 v179, v6, v179, s[46:47]
  v_cndmask_b32 v180, v6, v180, s[48:49]
  v_cndmask_b32 v181, v6, v181, s[50:51]
  v_cndmask_b32 v182, v6, v182, s[52:53]
  v_cndmask_b32 v183, v6, v183, s[54:55]
  v_max3_f32 v4, v176, v177, v178
  v_max3_f32 v4, v4, v179, v180
  v_max3_f32 v4, v4, v181, v182
  v_max_f32 v4, v4, v183
  v_mov_b32 v5, v4
  s_nop 1
  v_permlane32_swap_b32 v4, v5
  v_max_f32 v4, v4, v5
  v_mov_b32 v5, v4
  s_nop 1
  v_permlane16_swap_b32 v4, v5
  v_max_f32 v4, v4, v5
  v_mul_f32 v4, s21, v4
  v_fma_f32 v176, v176, s21, -v4
  v_fma_f32 v177, v177, s21, -v4
  v_fma_f32 v178, v178, s21, -v4
  v_fma_f32 v179, v179, s21, -v4
  v_fma_f32 v180, v180, s21, -v4
  v_fma_f32 v181, v181, s21, -v4
  v_fma_f32 v182, v182, s21, -v4
  v_fma_f32 v183, v183, s21, -v4
  v_exp_f32 v176, v176
  v_exp_f32 v177, v177
  v_exp_f32 v178, v178
  v_exp_f32 v179, v179
  v_exp_f32 v180, v180
  v_exp_f32 v181, v181
  v_exp_f32 v182, v182
  v_exp_f32 v183, v183
  v_add_f32 v4, v176, v177
  v_add_f32 v4, v4, v178
  v_add_f32 v4, v4, v179
  v_add_f32 v4, v4, v180
  v_add_f32 v4, v4, v181
  v_add_f32 v4, v4, v182
  v_add_f32 v4, v4, v183
  v_mov_b32 v5, v4
  s_nop 1
  v_permlane32_swap_b32 v4, v5
  v_add_f32 v4, v4, v5
  v_mov_b32 v5, v4
  s_nop 1
  v_permlane16_swap_b32 v4, v5
  v_add_f32 v4, v4, v5
  v_rcp_f32 v4, v4
  s_nop 0
  v_mul_f32 v176, v176, v4
  v_mul_f32 v177, v177, v4
  v_mul_f32 v178, v178, v4
  v_mul_f32 v179, v179, v4
  v_mul_f32 v180, v180, v4
  v_mul_f32 v181, v181, v4
  v_mul_f32 v182, v182, v4
  v_mul_f32 v183, v183, v4
  v_cvt_pk_bf16_f32 v28, v176, v177
  v_cvt_pk_bf16_f32 v29, v178, v179
  v_cvt_pk_bf16_f32 v30, v180, v181
  v_cvt_pk_bf16_f32 v31, v182, v183
  v_cndmask_b32 v184, v6, v184, s[40:41]
  v_cndmask_b32 v185, v6, v185, s[42:43]
  v_cndmask_b32 v186, v6, v186, s[44:45]
  v_cndmask_b32 v187, v6, v187, s[46:47]
  v_cndmask_b32 v188, v6, v188, s[48:49]
  v_cndmask_b32 v189, v6, v189, s[50:51]
  v_cndmask_b32 v190, v6, v190, s[52:53]
  v_cndmask_b32 v191, v6, v191, s[54:55]
  v_max3_f32 v4, v184, v185, v186
  v_max3_f32 v4, v4, v187, v188
  v_max3_f32 v4, v4, v189, v190
  v_max_f32 v4, v4, v191
  v_mov_b32 v5, v4
  s_nop 1
  v_permlane32_swap_b32 v4, v5
  v_max_f32 v4, v4, v5
  v_mov_b32 v5, v4
  s_nop 1
  v_permlane16_swap_b32 v4, v5
  v_max_f32 v4, v4, v5
  v_mul_f32 v4, s21, v4
  v_fma_f32 v184, v184, s21, -v4
  v_fma_f32 v185, v185, s21, -v4
  v_fma_f32 v186, v186, s21, -v4
  v_fma_f32 v187, v187, s21, -v4
  v_fma_f32 v188, v188, s21, -v4
  v_fma_f32 v189, v189, s21, -v4
  v_fma_f32 v190, v190, s21, -v4
  v_fma_f32 v191, v191, s21, -v4
  v_exp_f32 v184, v184
  v_exp_f32 v185, v185
  v_exp_f32 v186, v186
  v_exp_f32 v187, v187
  v_exp_f32 v188, v188
  v_exp_f32 v189, v189
  v_exp_f32 v190, v190
  v_exp_f32 v191, v191
  v_add_f32 v4, v184, v185
  v_add_f32 v4, v4, v186
  v_add_f32 v4, v4, v187
  v_add_f32 v4, v4, v188
  v_add_f32 v4, v4, v189
  v_add_f32 v4, v4, v190
  v_add_f32 v4, v4, v191
  v_mov_b32 v5, v4
  s_nop 1
  v_permlane32_swap_b32 v4, v5
  v_add_f32 v4, v4, v5
  v_mov_b32 v5, v4
  s_nop 1
  v_permlane16_swap_b32 v4, v5
  v_add_f32 v4, v4, v5
  v_rcp_f32 v4, v4
  s_nop 0
  v_mul_f32 v184, v184, v4
  v_mul_f32 v185, v185, v4
  v_mul_f32 v186, v186, v4
  v_mul_f32 v187, v187, v4
  v_mul_f32 v188, v188, v4
  v_mul_f32 v189, v189, v4
  v_mul_f32 v190, v190, v4
  v_mul_f32 v191, v191, v4
  v_cvt_pk_bf16_f32 v32, v184, v185
  v_cvt_pk_bf16_f32 v33, v186, v187
  v_cvt_pk_bf16_f32 v34, v188, v189
  v_cvt_pk_bf16_f32 v35, v190, v191
  v_cndmask_b32 v192, v6, v192, s[40:41]
  v_cndmask_b32 v193, v6, v193, s[42:43]
  v_cndmask_b32 v194, v6, v194, s[44:45]
  v_cndmask_b32 v195, v6, v195, s[46:47]
  v_cndmask_b32 v196, v6, v196, s[48:49]
  v_cndmask_b32 v197, v6, v197, s[50:51]
  v_cndmask_b32 v198, v6, v198, s[52:53]
  v_cndmask_b32 v199, v6, v199, s[54:55]
  v_max3_f32 v4, v192, v193, v194
  v_max3_f32 v4, v4, v195, v196
  v_max3_f32 v4, v4, v197, v198
  v_max_f32 v4, v4, v199
  v_mov_b32 v5, v4
  s_nop 1
  v_permlane32_swap_b32 v4, v5
  v_max_f32 v4, v4, v5
  v_mov_b32 v5, v4
  s_nop 1
  v_permlane16_swap_b32 v4, v5
  v_max_f32 v4, v4, v5
  v_mul_f32 v4, s21, v4
  v_fma_f32 v192, v192, s21, -v4
  v_fma_f32 v193, v193, s21, -v4
  v_fma_f32 v194, v194, s21, -v4
  v_fma_f32 v195, v195, s21, -v4
  v_fma_f32 v196, v196, s21, -v4
  v_fma_f32 v197, v197, s21, -v4
  v_fma_f32 v198, v198, s21, -v4
  v_fma_f32 v199, v199, s21, -v4
  v_exp_f32 v192, v192
  v_exp_f32 v193, v193
  v_exp_f32 v194, v194
  v_exp_f32 v195, v195
  v_exp_f32 v196, v196
  v_exp_f32 v197, v197
  v_exp_f32 v198, v198
  v_exp_f32 v199, v199
  v_add_f32 v4, v192, v193
  v_add_f32 v4, v4, v194
  v_add_f32 v4, v4, v195
  v_add_f32 v4, v4, v196
  v_add_f32 v4, v4, v197
  v_add_f32 v4, v4, v198
  v_add_f32 v4, v4, v199
  v_mov_b32 v5, v4
  s_nop 1
  v_permlane32_swap_b32 v4, v5
  v_add_f32 v4, v4, v5
  v_mov_b32 v5, v4
  s_nop 1
  v_permlane16_swap_b32 v4, v5
  v_add_f32 v4, v4, v5
  v_rcp_f32 v4, v4
  s_nop 0
  v_mul_f32 v192, v192, v4
  v_mul_f32 v193, v193, v4
  v_mul_f32 v194, v194, v4
  v_mul_f32 v195, v195, v4
  v_mul_f32 v196, v196, v4
  v_mul_f32 v197, v197, v4
  v_mul_f32 v198, v198, v4
  v_mul_f32 v199, v199, v4
  v_cvt_pk_bf16_f32 v36, v192, v193
  v_cvt_pk_bf16_f32 v37, v194, v195
  v_cvt_pk_bf16_f32 v38, v196, v197
  v_cvt_pk_bf16_f32 v39, v198, v199
  s_waitcnt vmcnt(0)
  s_cmp_lg_u32 s32, 0
  s_cbranch_scc1 L_rq_89
  s_cmp_eq_u32 s39, 0
  s_cbranch_scc1 L_rq_89
  s_lshl_b32 s99, s33, 7
  s_add_u32 s99, s99, 0x3d00200
  v_mov_b32 v244, 1
  v_mov_b32 v245, 0
  s_mov_b64 exec, 1
  buffer_atomic_add v244, v245, s[4:7], s99 offen sc0 sc1
  s_mov_b64 exec, -1
L_rq_89:
  v_mfma_f32_16x16x32_bf16 v[136:139], v[88:91], v[8:11], 0
  v_mfma_f32_16x16x32_bf16 v[140:143], v[94:97], v[8:11], 0
  v_mfma_f32_16x16x32_bf16 v[144:147], v[100:103], v[12:15], 0
  v_mfma_f32_16x16x32_bf16 v[148:151], v[106:109], v[12:15], 0
  v_mfma_f32_16x16x32_bf16 v[152:155], v[112:115], v[16:19], 0
  v_mfma_f32_16x16x32_bf16 v[156:159], v[118:121], v[16:19], 0
  v_mfma_f32_16x16x32_bf16 v[160:163], v[124:127], v[20:23], 0
  v_mfma_f32_16x16x32_bf16 v[164:167], v[130:133], v[20:23], 0
  v_mfma_f32_16x16x32_bf16 v[168:171], v[90:93], v[24:27], 0
  v_mfma_f32_16x16x32_bf16 v[172:175], v[96:99], v[24:27], 0
  v_mfma_f32_16x16x32_bf16 v[176:179], v[102:105], v[28:31], 0
  v_mfma_f32_16x16x32_bf16 v[180:183], v[108:111], v[28:31], 0
  v_mfma_f32_16x16x32_bf16 v[184:187], v[114:117], v[32:35], 0
  v_mfma_f32_16x16x32_bf16 v[188:191], v[120:123], v[32:35], 0
  v_mfma_f32_16x16x32_bf16 v[192:195], v[126:129], v[36:39], 0
  v_mfma_f32_16x16x32_bf16 v[196:199], v[132:135], v[36:39], 0
  v_cvt_pk_bf16_f32 v40, v136, v137
  v_cvt_pk_bf16_f32 v41, v138, v139
  v_cvt_pk_bf16_f32 v42, v140, v141
  v_cvt_pk_bf16_f32 v43, v142, v143
  buffer_store_dwordx4 v[40:43], v2, s[4:7], s97 offen offset:0 sc1
  v_cvt_pk_bf16_f32 v44, v144, v145
  v_cvt_pk_bf16_f32 v45, v146, v147
  v_cvt_pk_bf16_f32 v46, v148, v149
  v_cvt_pk_bf16_f32 v47, v150, v151
  buffer_store_dwordx4 v[44:47], v2, s[4:7], s97 offen offset:1024 sc1
  v_cvt_pk_bf16_f32 v48, v152, v153
  v_cvt_pk_bf16_f32 v49, v154, v155
  v_cvt_pk_bf16_f32 v50, v156, v157
  v_cvt_pk_bf16_f32 v51, v158, v159
  buffer_store_dwordx4 v[48:51], v2, s[4:7], s97 offen offset:2048 sc1
  v_cvt_pk_bf16_f32 v52, v160, v161
  v_cvt_pk_bf16_f32 v53, v162, v163
  v_cvt_pk_bf16_f32 v54, v164, v165
  v_cvt_pk_bf16_f32 v55, v166, v167
  buffer_store_dwordx4 v[52:55], v2, s[4:7], s97 offen offset:3072 sc1
  v_cvt_pk_bf16_f32 v56, v168, v169
  v_cvt_pk_bf16_f32 v57, v170, v171
  v_cvt_pk_bf16_f32 v58, v172, v173
  v_cvt_pk_bf16_f32 v59, v174, v175
  buffer_store_dwordx4 v[56:59], v3, s[4:7], s97 offen offset:0 sc1
  v_cvt_pk_bf16_f32 v60, v176, v177
  v_cvt_pk_bf16_f32 v61, v178, v179
  v_cvt_pk_bf16_f32 v62, v180, v181
  v_cvt_pk_bf16_f32 v63, v182, v183
  buffer_store_dwordx4 v[60:63], v3, s[4:7], s97 offen offset:1024 sc1
  v_cvt_pk_bf16_f32 v64, v184, v185
  v_cvt_pk_bf16_f32 v65, v186, v187
  v_cvt_pk_bf16_f32 v66, v188, v189
  v_cvt_pk_bf16_f32 v67, v190, v191
  buffer_store_dwordx4 v[64:67], v3, s[4:7], s97 offen offset:2048 sc1
  v_cvt_pk_bf16_f32 v68, v192, v193
  v_cvt_pk_bf16_f32 v69, v194, v195
  v_cvt_pk_bf16_f32 v70, v196, v197
  v_cvt_pk_bf16_f32 v71, v198, v199
  buffer_store_dwordx4 v[68:71], v3, s[4:7], s97 offen offset:3072 sc1
  s_branch L_done
L_ata:
  s_mov_b32 s50, 0
L_ata_c:
  s_lshr_b32 s40, s36, 3
  s_lshl_b32 s40, s40, 9
  s_lshl_b32 s90, s33, 7
  s_add_u32 s40, s40, s90
  s_add_u32 s41, s36, 1
  s_min_u32 s41, s41, 62
  s_lshr_b32 s43, s36, 2
  s_lshl_b32 s43, s43, 9
  s_add_u32 s43, s43, s90
  s_add_u32 s43, s43, 28672
  s_lshl_b32 s42, s33, 1
  s_add_u32 s42, s42, s37
  s_lshl_b32 s42, s42, 7
  s_add_u32 s42, s42, 4096
  s_cmp_ge_u32 s50, 2
  s_cbranch_scc1 L_ata_s
  s_cmp_lg_u32 s32, 0
  s_cbranch_scc1 L_dd_91
  v_mov_b32 v228, 0x3d00000
  v_mov_b32 v230, 0x3d02000
L_dw_90:
  buffer_load_dword v234, v230, s[4:7], s40 offen offset:0 sc1
  buffer_load_dword v235, v228, s[4:7], s43 offen offset:0 sc1
  s_waitcnt vmcnt(0)
  s_mov_b32 s44, 1
  v_readfirstlane_b32 s45, v234
  s_cmp_ge_u32 s45, 4
  s_cselect_b32 s44, s44, 0
  v_readfirstlane_b32 s45, v235
  s_cmp_ge_u32 s45, 16
  s_cselect_b32 s44, s44, 0
  s_cmp_eq_u32 s44, 1
  s_cbranch_scc1 L_dd_91
  s_sleep 6
  s_add_u32 s3, s3, 1
  s_cmp_lt_u32 s3, 131072
  s_cbranch_scc1 L_dw_90
L_dd_91:
  s_barrier
L_ata_s:
  s_mov_b32 s98, 1
  s_lshr_b32 s38, s36, 2
  s_lshl_b32 s38, s38, 7
  s_add_u32 s38, s38, 2048
  s_lshr_b32 s90, s36, 1
  s_sub_u32 s90, s90, 24
  s_lshl_b32 s90, s90, 2
  s_add_u32 s90, s90, s33
  s_lshl_b32 s90, s90, 1
  s_add_u32 s90, s90, s37
  s_lshl_b32 s90, s90, 7
  s_add_u32 s90, s90, 20480
  s_cmp_ge_u32 s36, 60
  s_cselect_b32 s38, s90, s38
  s_lshl_b32 s20, s36, 5
  s_lshl_b32 s90, s33, 3
  s_add_u32 s20, s20, s90
  s_lshl_b32 s90, s37, 2
  s_add_u32 s20, s20, s90
  s_add_u32 s20, s20, s32
  v_and_b32 v1, 63, v0
  s_lshl_b32 s90, s20, 13
  s_lshl_b32 s91, s20, 11
  v_mov_b32 v2, 0x0
  v_bfe_u32 v7, v1, 0, 6
  v_lshl_add_u32 v2, v7, 4, v2
  v_add_u32 v3, 4096, v2
  v_mov_b32 v4, 0x3000000
  v_bfe_u32 v7, v1, 0, 1
  v_lshl_add_u32 v4, v7, 4, v4
  v_bfe_u32 v7, v1, 2, 2
  v_lshl_add_u32 v4, v7, 5, v4
  v_bfe_u32 v7, v1, 4, 2
  v_lshl_add_u32 v4, v7, 7, v4
  v_add_u32 v5, 0x3400000, v2
  v_mov_b32 v8, 0x0
  v_bfe_u32 v7, v1, 0, 3
  v_lshl_add_u32 v8, v7, 4, v8
  v_bfe_u32 v7, v1, 3, 1
  v_lshl_add_u32 v8, v7, 11, v8
  v_bfe_u32 v7, v1, 4, 2
  v_lshl_add_u32 v8, v7, 8, v8
  v_add_u32 v9, 4096, v8
  v_mov_b32 v10, 0x0
  v_bfe_u32 v7, v1, 0, 4
  v_lshl_add_u32 v10, v7, 4, v10
  v_bfe_u32 v7, v1, 4, 1
  v_lshl_add_u32 v10, v7, 8, v10
  v_bfe_u32 v7, v1, 5, 1
  v_lshl_add_u32 v10, v7, 10, v10
  v_add_u32 v11, 4096, v10
  s_add_u32 s92, s90, 16777216
  s_add_u32 s93, s90, 33554432
  s_add_u32 s94, s90, 0
  s_add_u32 s95, s90, 83886080
  buffer_load_dwordx4 v[16:19], v2, s[4:7], s94 offen offset:0 sc1
  buffer_load_dwordx4 v[20:23], v2, s[4:7], s94 offen offset:1024 sc1
  buffer_load_dwordx4 v[24:27], v2, s[4:7], s94 offen offset:2048 sc1
  buffer_load_dwordx4 v[28:31], v2, s[4:7], s94 offen offset:3072 sc1
  buffer_load_dwordx4 v[32:35], v3, s[4:7], s94 offen offset:0 sc1
  buffer_load_dwordx4 v[36:39], v3, s[4:7], s94 offen offset:1024 sc1
  buffer_load_dwordx4 v[40:43], v3, s[4:7], s94 offen offset:2048 sc1
  buffer_load_dwordx4 v[44:47], v3, s[4:7], s94 offen offset:3072 sc1
  buffer_load_dwordx4 v[48:51], v2, s[4:7], s92 offen offset:0 sc1
  buffer_load_dwordx4 v[52:55], v2, s[4:7], s92 offen offset:1024 sc1
  buffer_load_dwordx4 v[56:59], v2, s[4:7], s92 offen offset:2048 sc1
  buffer_load_dwordx4 v[60:63], v2, s[4:7], s92 offen offset:3072 sc1
  buffer_load_dwordx4 v[64:67], v3, s[4:7], s92 offen offset:0 sc1
  buffer_load_dwordx4 v[68:71], v3, s[4:7], s92 offen offset:1024 sc1
  buffer_load_dwordx4 v[72:75], v3, s[4:7], s92 offen offset:2048 sc1
  buffer_load_dwordx4 v[76:79], v3, s[4:7], s92 offen offset:3072 sc1
  buffer_load_dwordx4 v[80:83], v8, s[4:7], s93 offen offset:0 sc1
  buffer_load_dwordx4 v[84:87], v8, s[4:7], s93 offen offset:128 sc1
  buffer_load_dwordx4 v[88:91], v8, s[4:7], s93 offen offset:1024 sc1
  buffer_load_dwordx4 v[92:95], v8, s[4:7], s93 offen offset:1152 sc1
  buffer_load_dwordx4 v[96:99], v9, s[4:7], s93 offen offset:0 sc1
  buffer_load_dwordx4 v[100:103], v9, s[4:7], s93 offen offset:128 sc1
  buffer_load_dwordx4 v[104:107], v9, s[4:7], s93 offen offset:1024 sc1
  buffer_load_dwordx4 v[108:111], v9, s[4:7], s93 offen offset:1152 sc1
  s_cmp_lg_u32 s32, 0
  s_cbranch_scc1 L_dd_93
  v_mov_b32 v228, 0x3d00000
L_dw_92:
  s_lshl_b32 s45, s33, 7
  buffer_load_dword v238, v228, s[4:7], s45 offen offset:0 sc1
  buffer_load_dword v239, v228, s[4:7], s42 offen sc1
  s_waitcnt vmcnt(0)
  s_mov_b32 s44, 1
  v_readfirstlane_b32 s45, v238
  v_readfirstlane_b32 s47, v239
  s_cmp_ge_u32 s47, 16
  s_cselect_b32 s45, 64, s45
  s_cmp_ge_u32 s45, s41
  s_cselect_b32 s44, s44, 0
  s_cmp_eq_u32 s44, 1
  s_cbranch_scc1 L_dd_93
  s_sleep 3
  s_add_u32 s3, s3, 1
  s_cmp_lt_u32 s3, 131072
  s_cbranch_scc1 L_dw_92
L_dd_93:
  s_barrier
  buffer_load_dwordx4 v[112:115], v4, s[4:7], s91 offen offset:0 sc1
  buffer_load_dwordx4 v[116:119], v4, s[4:7], s91 offen offset:512 sc1
  buffer_load_dwordx4 v[120:123], v4, s[4:7], s91 offen offset:1024 sc1
  buffer_load_dwordx4 v[124:127], v4, s[4:7], s91 offen offset:1536 sc1
  buffer_load_dwordx4 v[128:131], v5, s[4:7], s91 offen offset:0 sc1
  buffer_load_dwordx4 v[132:135], v5, s[4:7], s91 offen offset:1024 sc1
  s_mov_b32 s40, 0xfff0ffff
  s_mov_b32 s41, 0xf000ff00
  s_mov_b32 s42, 0xffe0fffe
  s_mov_b32 s43, 0xe000fe00
  s_mov_b32 s44, 0xffc0fffc
  s_mov_b32 s45, 0xc000fc00
  s_mov_b32 s46, 0xff80fff8
  s_mov_b32 s47, 0x8000f800
  s_mov_b32 s50, 0x3e0293ee
  v_mov_b32 v6, 0xd028965f
  s_waitcnt vmcnt(6)
  v_mfma_f32_16x16x32_bf16 v[140:143], v[48:51], v[16:19], 0
  v_mfma_f32_16x16x32_bf16 v[148:151], v[48:51], v[32:35], 0
  v_mfma_f32_16x16x32_bf16 v[152:155], v[64:67], v[32:35], 0
  v_mfma_f32_16x16x32_bf16 v[140:143], v[52:55], v[20:23], v[140:143]
  v_mfma_f32_16x16x32_bf16 v[148:151], v[52:55], v[36:39], v[148:151]
  v_mfma_f32_16x16x32_bf16 v[152:155], v[68:71], v[36:39], v[152:155]
  v_mfma_f32_16x16x32_bf16 v[140:143], v[56:59], v[24:27], v[140:143]
  v_mfma_f32_16x16x32_bf16 v[148:151], v[56:59], v[40:43], v[148:151]
  v_mfma_f32_16x16x32_bf16 v[152:155], v[72:75], v[40:43], v[152:155]
  v_mfma_f32_16x16x32_bf16 v[140:143], v[60:63], v[28:31], v[140:143]
  v_mfma_f32_16x16x32_bf16 v[148:151], v[60:63], v[44:47], v[148:151]
  v_mfma_f32_16x16x32_bf16 v[152:155], v[76:79], v[44:47], v[152:155]
L_av:
  s_waitcnt vmcnt(0)
  v_max3_u32 v12, v112, v113, v114
  v_max3_u32 v12, v12, v115, v116
  v_max3_u32 v12, v12, v117, v118
  v_max3_u32 v12, v12, v119, v120
  v_max3_u32 v12, v12, v121, v122
  v_max3_u32 v12, v12, v123, v124
  v_max3_u32 v12, v12, v125, v126
  v_max3_u32 v12, v12, v127, v128
  v_max3_u32 v12, v12, v129, v130
  v_max3_u32 v12, v12, v131, v132
  v_max3_u32 v12, v12, v133, v134
  v_max_u32 v12, v12, v135
  v_cmp_eq_u32 vcc, -1, v12
  s_cbranch_vccz L_avd
  s_add_u32 s3, s3, 1
  s_cmp_ge_u32 s3, 131072
  s_cbranch_scc1 L_avd
  buffer_load_dwordx4 v[112:115], v4, s[4:7], s91 offen offset:0 sc1
  buffer_load_dwordx4 v[116:119], v4, s[4:7], s91 offen offset:512 sc1
  buffer_load_dwordx4 v[120:123], v4, s[4:7], s91 offen offset:1024 sc1
  buffer_load_dwordx4 v[124:127], v4, s[4:7], s91 offen offset:1536 sc1
  buffer_load_dwordx4 v[128:131], v5, s[4:7], s91 offen offset:0 sc1
  buffer_load_dwordx4 v[132:135], v5, s[4:7], s91 offen offset:1024 sc1
  s_branch L_av
L_avd:
  s_waitcnt vmcnt(0)
  s_cmp_lt_u32 s36, 60
  s_cbranch_scc1 L_rf_94
  s_cmp_lg_u32 s32, 0
  s_cbranch_scc1 L_rq_95
  s_cmp_eq_u32 s39, 0
  s_cbranch_scc1 L_rq_95
  s_lshl_b32 s99, s33, 7
  s_add_u32 s99, s99, 0x3d00200
  v_mov_b32 v244, 1
  v_mov_b32 v245, 0
  s_mov_b64 exec, 1
  buffer_atomic_add v244, v245, s[4:7], s99 offen sc0 sc1
  s_mov_b64 exec, -1
L_rq_95:
L_rf_94:
  v_mfma_f32_16x16x32_bf16 v[136:139], v[112:115], v[16:19], 0
  v_mfma_f32_16x16x32_bf16 v[144:147], v[112:115], v[32:35], 0
  v_mfma_f32_16x16x32_bf16 v[136:139], v[116:119], v[20:23], v[136:139]
  v_mfma_f32_16x16x32_bf16 v[144:147], v[116:119], v[36:39], v[144:147]
  v_mfma_f32_16x16x32_bf16 v[136:139], v[120:123], v[24:27], v[136:139]
  v_mfma_f32_16x16x32_bf16 v[144:147], v[120:123], v[40:43], v[144:147]
  v_mfma_f32_16x16x32_bf16 v[136:139], v[124:127], v[28:31], v[136:139]
  v_mfma_f32_16x16x32_bf16 v[144:147], v[124:127], v[44:47], v[144:147]
  v_cndmask_b32 v140, v6, v140, s[40:41]
  v_cndmask_b32 v141, v6, v141, s[42:43]
  v_cndmask_b32 v142, v6, v142, s[44:45]
  v_cndmask_b32 v143, v6, v143, s[46:47]
  s_nop 2
  v_max3_f32 v12, v136, v137, v140
  v_max3_f32 v12, v12, v141, v142
  v_max_f32 v12, v12, v143
  v_mov_b32 v13, v12
  s_nop 1
  v_permlane32_swap_b32 v12, v13
  v_max_f32 v12, v12, v13
  v_mov_b32 v13, v12
  s_nop 1
  v_permlane16_swap_b32 v12, v13
  v_max_f32 v12, v12, v13
  v_mul_f32 v12, s50, v12
  v_fma_f32 v136, v136, s50, -v12
  v_fma_f32 v137, v137, s50, -v12
  v_fma_f32 v140, v140, s50, -v12
  v_fma_f32 v141, v141, s50, -v12
  v_fma_f32 v142, v142, s50, -v12
  v_fma_f32 v143, v143, s50, -v12
  v_exp_f32 v136, v136
  v_exp_f32 v137, v137
  v_exp_f32 v140, v140
  v_exp_f32 v141, v141
  v_exp_f32 v142, v142
  v_exp_f32 v143, v143
  v_add_f32 v12, v136, v137
  v_add_f32 v12, v12, v140
  v_add_f32 v12, v12, v141
  v_add_f32 v12, v12, v142
  v_add_f32 v12, v12, v143
  v_mov_b32 v13, v12
  s_nop 1
  v_permlane32_swap_b32 v12, v13
  v_add_f32 v12, v12, v13
  v_mov_b32 v13, v12
  s_nop 1
  v_permlane16_swap_b32 v12, v13
  v_add_f32 v12, v12, v13
  v_rcp_f32 v12, v12
  s_nop 0
  v_mul_f32 v136, v136, v12
  v_mul_f32 v137, v137, v12
  v_mul_f32 v140, v140, v12
  v_mul_f32 v141, v141, v12
  v_mul_f32 v142, v142, v12
  v_mul_f32 v143, v143, v12
  v_cvt_pk_bf16_f32 v160, v136, v137
  v_mov_b32 v161, 0
  v_mov_b32 v162, 0
  v_mov_b32 v163, v160
  v_cvt_pk_bf16_f32 v156, v140, v141
  v_cvt_pk_bf16_f32 v157, v142, v143
  v_mov_b32 v158, 0
  v_mov_b32 v159, 0
  v_cndmask_b32 v152, v6, v152, s[40:41]
  v_cndmask_b32 v153, v6, v153, s[42:43]
  v_cndmask_b32 v154, v6, v154, s[44:45]
  v_cndmask_b32 v155, v6, v155, s[46:47]
  v_max3_f32 v12, v144, v145, v148
  v_max3_f32 v12, v12, v149, v150
  v_max3_f32 v12, v12, v151, v152
  v_max3_f32 v12, v12, v153, v154
  v_max_f32 v12, v12, v155
  v_mov_b32 v13, v12
  s_nop 1
  v_permlane32_swap_b32 v12, v13
  v_max_f32 v12, v12, v13
  v_mov_b32 v13, v12
  s_nop 1
  v_permlane16_swap_b32 v12, v13
  v_max_f32 v12, v12, v13
  v_mul_f32 v12, s50, v12
  v_fma_f32 v144, v144, s50, -v12
  v_fma_f32 v145, v145, s50, -v12
  v_fma_f32 v148, v148, s50, -v12
  v_fma_f32 v149, v149, s50, -v12
  v_fma_f32 v150, v150, s50, -v12
  v_fma_f32 v151, v151, s50, -v12
  v_fma_f32 v152, v152, s50, -v12
  v_fma_f32 v153, v153, s50, -v12
  v_fma_f32 v154, v154, s50, -v12
  v_fma_f32 v155, v155, s50, -v12
  v_exp_f32 v144, v144
  v_exp_f32 v145, v145
  v_exp_f32 v148, v148
  v_exp_f32 v149, v149
  v_exp_f32 v150, v150
  v_exp_f32 v151, v151
  v_exp_f32 v152, v152
  v_exp_f32 v153, v153
  v_exp_f32 v154, v154
  v_exp_f32 v155, v155
  v_add_f32 v12, v144, v145
  v_add_f32 v12, v12, v148
  v_add_f32 v12, v12, v149
  v_add_f32 v12, v12, v150
  v_add_f32 v12, v12, v151
  v_add_f32 v12, v12, v152
  v_add_f32 v12, v12, v153
  v_add_f32 v12, v12, v154
  v_add_f32 v12, v12, v155
  v_mov_b32 v13, v12
  s_nop 1
  v_permlane32_swap_b32 v12, v13
  v_add_f32 v12, v12, v13
  v_mov_b32 v13, v12
  s_nop 1
  v_permlane16_swap_b32 v12, v13
  v_add_f32 v12, v12, v13
  v_rcp_f32 v12, v12
  s_nop 0
  v_mul_f32 v144, v144, v12
  v_mul_f32 v145, v145, v12
  v_mul_f32 v148, v148, v12
  v_mul_f32 v149, v149, v12
  v_mul_f32 v150, v150, v12
  v_mul_f32 v151, v151, v12
  v_mul_f32 v152, v152, v12
  v_mul_f32 v153, v153, v12
  v_mul_f32 v154, v154, v12
  v_mul_f32 v155, v155, v12
  v_cvt_pk_bf16_f32 v168, v144, v145
  v_mov_b32 v169, 0
  v_mov_b32 v170, 0
  v_mov_b32 v171, v168
  v_cvt_pk_bf16_f32 v164, v148, v149
  v_cvt_pk_bf16_f32 v165, v150, v151
  v_cvt_pk_bf16_f32 v166, v152, v153
  v_cvt_pk_bf16_f32 v167, v154, v155
  v_mfma_f32_16x16x32_bf16 v[176:179], v[80:83], v[156:159], 0
  v_mfma_f32_16x16x32_bf16 v[180:183], v[84:87], v[156:159], 0
  v_mfma_f32_16x16x32_bf16 v[184:187], v[88:91], v[156:159], 0
  v_mfma_f32_16x16x32_bf16 v[188:191], v[92:95], v[156:159], 0
  v_mfma_f32_16x16x32_bf16 v[192:195], v[96:99], v[156:159], 0
  v_mfma_f32_16x16x32_bf16 v[196:199], v[100:103], v[156:159], 0
  v_mfma_f32_16x16x32_bf16 v[200:203], v[104:107], v[156:159], 0
  v_mfma_f32_16x16x32_bf16 v[204:207], v[108:111], v[156:159], 0
  v_mfma_f32_16x16x16_bf16 v[176:179], v[128:129], v[160:161], v[176:179]
  v_mfma_f32_16x16x16_bf16 v[180:183], v[128:129], v[162:163], v[180:183]
  v_mfma_f32_16x16x16_bf16 v[184:187], v[130:131], v[160:161], v[184:187]
  v_mfma_f32_16x16x16_bf16 v[188:191], v[130:131], v[162:163], v[188:191]
  v_mfma_f32_16x16x16_bf16 v[192:195], v[132:133], v[160:161], v[192:195]
  v_mfma_f32_16x16x16_bf16 v[196:199], v[132:133], v[162:163], v[196:199]
  v_mfma_f32_16x16x16_bf16 v[200:203], v[134:135], v[160:161], v[200:203]
  v_mfma_f32_16x16x16_bf16 v[204:207], v[134:135], v[162:163], v[204:207]
  v_mfma_f32_16x16x32_bf16 v[208:211], v[80:83], v[164:167], 0
  v_mfma_f32_16x16x32_bf16 v[212:215], v[84:87], v[164:167], 0
  v_mfma_f32_16x16x32_bf16 v[216:219], v[88:91], v[164:167], 0
  v_mfma_f32_16x16x32_bf16 v[220:223], v[92:95], v[164:167], 0
  v_mfma_f32_16x16x32_bf16 v[224:227], v[96:99], v[164:167], 0
  v_mfma_f32_16x16x32_bf16 v[228:231], v[100:103], v[164:167], 0
  v_mfma_f32_16x16x32_bf16 v[232:235], v[104:107], v[164:167], 0
  v_mfma_f32_16x16x32_bf16 v[236:239], v[108:111], v[164:167], 0
  v_mfma_f32_16x16x16_bf16 v[208:211], v[128:129], v[168:169], v[208:211]
  v_mfma_f32_16x16x16_bf16 v[212:215], v[128:129], v[170:171], v[212:215]
  v_mfma_f32_16x16x16_bf16 v[216:219], v[130:131], v[168:169], v[216:219]
  v_mfma_f32_16x16x16_bf16 v[220:223], v[130:131], v[170:171], v[220:223]
  v_mfma_f32_16x16x16_bf16 v[224:227], v[132:133], v[168:169], v[224:227]
  v_mfma_f32_16x16x16_bf16 v[228:231], v[132:133], v[170:171], v[228:231]
  v_mfma_f32_16x16x16_bf16 v[232:235], v[134:135], v[168:169], v[232:235]
  v_mfma_f32_16x16x16_bf16 v[236:239], v[134:135], v[170:171], v[236:239]
  v_cvt_pk_bf16_f32 v136, v176, v177
  v_cvt_pk_bf16_f32 v137, v178, v179
  v_cvt_pk_bf16_f32 v138, v184, v185
  v_cvt_pk_bf16_f32 v139, v186, v187
  buffer_store_dwordx4 v[136:139], v10, s[4:7], s95 offen offset:0 sc1
  v_cvt_pk_bf16_f32 v140, v180, v181
  v_cvt_pk_bf16_f32 v141, v182, v183
  v_cvt_pk_bf16_f32 v142, v188, v189
  v_cvt_pk_bf16_f32 v143, v190, v191
  buffer_store_dwordx4 v[140:143], v10, s[4:7], s95 offen offset:512 sc1
  v_cvt_pk_bf16_f32 v144, v192, v193
  v_cvt_pk_bf16_f32 v145, v194, v195
  v_cvt_pk_bf16_f32 v146, v200, v201
  v_cvt_pk_bf16_f32 v147, v202, v203
  buffer_store_dwordx4 v[144:147], v10, s[4:7], s95 offen offset:2048 sc1
  v_cvt_pk_bf16_f32 v148, v196, v197
  v_cvt_pk_bf16_f32 v149, v198, v199
  v_cvt_pk_bf16_f32 v150, v204, v205
  v_cvt_pk_bf16_f32 v151, v206, v207
  buffer_store_dwordx4 v[148:151], v10, s[4:7], s95 offen offset:2560 sc1
  v_cvt_pk_bf16_f32 v136, v208, v209
  v_cvt_pk_bf16_f32 v137, v210, v211
  v_cvt_pk_bf16_f32 v138, v216, v217
  v_cvt_pk_bf16_f32 v139, v218, v219
  buffer_store_dwordx4 v[136:139], v11, s[4:7], s95 offen offset:0 sc1
  v_cvt_pk_bf16_f32 v140, v212, v213
  v_cvt_pk_bf16_f32 v141, v214, v215
  v_cvt_pk_bf16_f32 v142, v220, v221
  v_cvt_pk_bf16_f32 v143, v222, v223
  buffer_store_dwordx4 v[140:143], v11, s[4:7], s95 offen offset:512 sc1
  v_cvt_pk_bf16_f32 v144, v224, v225
  v_cvt_pk_bf16_f32 v145, v226, v227
  v_cvt_pk_bf16_f32 v146, v232, v233
  v_cvt_pk_bf16_f32 v147, v234, v235
  buffer_store_dwordx4 v[144:147], v11, s[4:7], s95 offen offset:2048 sc1
  v_cvt_pk_bf16_f32 v148, v228, v229
  v_cvt_pk_bf16_f32 v149, v230, v231
  v_cvt_pk_bf16_f32 v150, v236, v237
  v_cvt_pk_bf16_f32 v151, v238, v239
  buffer_store_dwordx4 v[148:151], v11, s[4:7], s95 offen offset:2560 sc1
  s_add_u32 s95, s95, 262144
  s_branch L_done
L_ata4:
  s_lshr_b32 s40, s36, 3
  s_lshl_b32 s40, s40, 9
  s_lshl_b32 s90, s33, 7
  s_add_u32 s40, s40, s90
  s_add_u32 s41, s36, 4
  s_lshr_b32 s43, s36, 2
  s_lshl_b32 s43, s43, 9
  s_add_u32 s43, s43, s90
  s_add_u32 s43, s43, 28672
  s_lshl_b32 s42, s33, 1
  s_add_u32 s42, s42, s37
  s_lshl_b32 s42, s42, 7
  s_add_u32 s42, s42, 4096
  s_cmp_lg_u32 s32, 0
  s_cbranch_scc1 L_dd_97
  v_mov_b32 v228, 0x3d00000
  v_mov_b32 v230, 0x3d02000
L_dw_96:
  buffer_load_dword v234, v230, s[4:7], s40 offen offset:0 sc1
  buffer_load_dword v235, v228, s[4:7], s43 offen offset:0 sc1
  s_lshl_b32 s45, s33, 7
  buffer_load_dword v238, v228, s[4:7], s45 offen offset:0 sc1
  buffer_load_dword v239, v228, s[4:7], s42 offen sc1
  s_waitcnt vmcnt(0)
  s_mov_b32 s44, 1
  v_readfirstlane_b32 s45, v234
  s_cmp_ge_u32 s45, 4
  s_cselect_b32 s44, s44, 0
  v_readfirstlane_b32 s45, v235
  s_cmp_ge_u32 s45, 16
  s_cselect_b32 s44, s44, 0
  v_readfirstlane_b32 s45, v238
  v_readfirstlane_b32 s47, v239
  s_cmp_ge_u32 s47, 16
  s_cselect_b32 s45, 64, s45
  s_cmp_ge_u32 s45, s41
  s_cselect_b32 s44, s44, 0
  s_cmp_eq_u32 s44, 1
  s_cbranch_scc1 L_dd_97
  s_sleep 6
  s_add_u32 s3, s3, 1
  s_cmp_lt_u32 s3, 131072
  s_cbranch_scc1 L_dw_96
L_dd_97:
  s_barrier
  s_mov_b32 s98, 4
  s_lshr_b32 s38, s36, 2
  s_lshl_b32 s38, s38, 7
  s_add_u32 s38, s38, 2048
  s_lshl_b32 s20, s36, 5
  s_lshl_b32 s90, s33, 3
  s_add_u32 s20, s20, s90
  s_lshl_b32 s90, s37, 2
  s_add_u32 s20, s20, s90
  s_add_u32 s20, s20, s32
  v_and_b32 v1, 63, v0
  s_lshl_b32 s90, s20, 13
  s_lshl_b32 s91, s20, 11
  v_mov_b32 v2, 0x0
  v_bfe_u32 v7, v1, 0, 6
  v_lshl_add_u32 v2, v7, 4, v2
  v_add_u32 v3, 4096, v2
  v_mov_b32 v4, 0x3000000
  v_bfe_u32 v7, v1, 0, 1
  v_lshl_add_u32 v4, v7, 4, v4
  v_bfe_u32 v7, v1, 2, 2
  v_lshl_add_u32 v4, v7, 5, v4
  v_bfe_u32 v7, v1, 4, 2
  v_lshl_add_u32 v4, v7, 7, v4
  v_add_u32 v5, 0x3400000, v2
  v_mov_b32 v8, 0x0
  v_bfe_u32 v7, v1, 0, 3
  v_lshl_add_u32 v8, v7, 4, v8
  v_bfe_u32 v7, v1, 3, 1
  v_lshl_add_u32 v8, v7, 11, v8
  v_bfe_u32 v7, v1, 4, 2
  v_lshl_add_u32 v8, v7, 8, v8
  v_add_u32 v9, 4096, v8
  v_mov_b32 v10, 0x0
  v_bfe_u32 v7, v1, 0, 4
  v_lshl_add_u32 v10, v7, 4, v10
  v_bfe_u32 v7, v1, 4, 1
  v_lshl_add_u32 v10, v7, 8, v10
  v_bfe_u32 v7, v1, 5, 1
  v_lshl_add_u32 v10, v7, 10, v10
  v_add_u32 v11, 4096, v10
  s_add_u32 s92, s90, 16777216
  s_add_u32 s93, s90, 33554432
  s_add_u32 s94, s90, 0
  s_add_u32 s95, s90, 83886080
  buffer_load_dwordx4 v[16:19], v2, s[4:7], s94 offen offset:0 sc1
  buffer_load_dwordx4 v[20:23], v2, s[4:7], s94 offen offset:1024 sc1
  buffer_load_dwordx4 v[24:27], v2, s[4:7], s94 offen offset:2048 sc1
  buffer_load_dwordx4 v[28:31], v2, s[4:7], s94 offen offset:3072 sc1
  buffer_load_dwordx4 v[32:35], v3, s[4:7], s94 offen offset:0 sc1
  buffer_load_dwordx4 v[36:39], v3, s[4:7], s94 offen offset:1024 sc1
  buffer_load_dwordx4 v[40:43], v3, s[4:7], s94 offen offset:2048 sc1
  buffer_load_dwordx4 v[44:47], v3, s[4:7], s94 offen offset:3072 sc1
  buffer_load_dwordx4 v[48:51], v2, s[4:7], s92 offen offset:0 sc1
  buffer_load_dwordx4 v[52:55], v2, s[4:7], s92 offen offset:1024 sc1
  buffer_load_dwordx4 v[56:59], v2, s[4:7], s92 offen offset:2048 sc1
  buffer_load_dwordx4 v[60:63], v2, s[4:7], s92 offen offset:3072 sc1
  buffer_load_dwordx4 v[64:67], v3, s[4:7], s92 offen offset:0 sc1
  buffer_load_dwordx4 v[68:71], v3, s[4:7], s92 offen offset:1024 sc1
  buffer_load_dwordx4 v[72:75], v3, s[4:7], s92 offen offset:2048 sc1
  buffer_load_dwordx4 v[76:79], v3, s[4:7], s92 offen offset:3072 sc1
  buffer_load_dwordx4 v[80:83], v8, s[4:7], s93 offen offset:0 sc1
  buffer_load_dwordx4 v[84:87], v8, s[4:7], s93 offen offset:128 sc1
  buffer_load_dwordx4 v[88:91], v8, s[4:7], s93 offen offset:1024 sc1
  buffer_load_dwordx4 v[92:95], v8, s[4:7], s93 offen offset:1152 sc1
  buffer_load_dwordx4 v[96:99], v9, s[4:7], s93 offen offset:0 sc1
  buffer_load_dwordx4 v[100:103], v9, s[4:7], s93 offen offset:128 sc1
  buffer_load_dwordx4 v[104:107], v9, s[4:7], s93 offen offset:1024 sc1
  buffer_load_dwordx4 v[108:111], v9, s[4:7], s93 offen offset:1152 sc1
  buffer_load_dwordx4 v[112:115], v4, s[4:7], s91 offen offset:0 sc1
  buffer_load_dwordx4 v[116:119], v4, s[4:7], s91 offen offset:512 sc1
  buffer_load_dwordx4 v[120:123], v4, s[4:7], s91 offen offset:1024 sc1
  buffer_load_dwordx4 v[124:127], v4, s[4:7], s91 offen offset:1536 sc1
  buffer_load_dwordx4 v[128:131], v5, s[4:7], s91 offen offset:0 sc1
  buffer_load_dwordx4 v[132:135], v5, s[4:7], s91 offen offset:1024 sc1
  s_add_u32 s92, s92, 262144
  s_add_u32 s93, s93, 262144
  s_add_u32 s94, s94, 262144
  s_add_u32 s91, s91, 65536
  buffer_load_dwordx4 a[0:3], v2, s[4:7], s94 offen offset:0 sc1
  buffer_load_dwordx4 a[4:7], v2, s[4:7], s94 offen offset:1024 sc1
  buffer_load_dwordx4 a[8:11], v2, s[4:7], s94 offen offset:2048 sc1
  buffer_load_dwordx4 a[12:15], v2, s[4:7], s94 offen offset:3072 sc1
  buffer_load_dwordx4 a[16:19], v3, s[4:7], s94 offen offset:0 sc1
  buffer_load_dwordx4 a[20:23], v3, s[4:7], s94 offen offset:1024 sc1
  buffer_load_dwordx4 a[24:27], v3, s[4:7], s94 offen offset:2048 sc1
  buffer_load_dwordx4 a[28:31], v3, s[4:7], s94 offen offset:3072 sc1
  buffer_load_dwordx4 a[32:35], v2, s[4:7], s92 offen offset:0 sc1
  buffer_load_dwordx4 a[36:39], v2, s[4:7], s92 offen offset:1024 sc1
  buffer_load_dwordx4 a[40:43], v2, s[4:7], s92 offen offset:2048 sc1
  buffer_load_dwordx4 a[44:47], v2, s[4:7], s92 offen offset:3072 sc1
  buffer_load_dwordx4 a[48:51], v3, s[4:7], s92 offen offset:0 sc1
  buffer_load_dwordx4 a[52:55], v3, s[4:7], s92 offen offset:1024 sc1
  buffer_load_dwordx4 a[56:59], v3, s[4:7], s92 offen offset:2048 sc1
  buffer_load_dwordx4 a[60:63], v3, s[4:7], s92 offen offset:3072 sc1
  buffer_load_dwordx4 a[64:67], v8, s[4:7], s93 offen offset:0 sc1
  buffer_load_dwordx4 a[68:71], v8, s[4:7], s93 offen offset:128 sc1
  buffer_load_dwordx4 a[72:75], v8, s[4:7], s93 offen offset:1024 sc1
  buffer_load_dwordx4 a[76:79], v8, s[4:7], s93 offen offset:1152 sc1
  buffer_load_dwordx4 a[80:83], v9, s[4:7], s93 offen offset:0 sc1
  buffer_load_dwordx4 a[84:87], v9, s[4:7], s93 offen offset:128 sc1
  buffer_load_dwordx4 a[88:91], v9, s[4:7], s93 offen offset:1024 sc1
  buffer_load_dwordx4 a[92:95], v9, s[4:7], s93 offen offset:1152 sc1
  buffer_load_dwordx4 a[96:99], v4, s[4:7], s91 offen offset:0 sc1
  buffer_load_dwordx4 a[100:103], v4, s[4:7], s91 offen offset:512 sc1
  buffer_load_dwordx4 a[104:107], v4, s[4:7], s91 offen offset:1024 sc1
  buffer_load_dwordx4 a[108:111], v4, s[4:7], s91 offen offset:1536 sc1
  buffer_load_dwordx4 a[112:115], v5, s[4:7], s91 offen offset:0 sc1
  buffer_load_dwordx4 a[116:119], v5, s[4:7], s91 offen offset:1024 sc1
  s_add_u32 s92, s92, 262144
  s_add_u32 s93, s93, 262144
  s_add_u32 s94, s94, 262144
  s_add_u32 s91, s91, 65536
  s_mov_b32 s40, 0xfff0ffff
  s_mov_b32 s41, 0xf000ff00
  s_mov_b32 s42, 0xffe0fffe
  s_mov_b32 s43, 0xe000fe00
  s_mov_b32 s44, 0xffc0fffc
  s_mov_b32 s45, 0xc000fc00
  s_mov_b32 s46, 0xff80fff8
  s_mov_b32 s47, 0x8000f800
  s_mov_b32 s50, 0x3e0293ee
  v_mov_b32 v6, 0xd028965f
  s_waitcnt vmcnt(30)
  v_mfma_f32_16x16x32_bf16 v[136:139], v[112:115], v[16:19], 0
  v_mfma_f32_16x16x32_bf16 v[140:143], v[48:51], v[16:19], 0
  v_mfma_f32_16x16x32_bf16 v[144:147], v[112:115], v[32:35], 0
  v_mfma_f32_16x16x32_bf16 v[148:151], v[48:51], v[32:35], 0
  v_mfma_f32_16x16x32_bf16 v[152:155], v[64:67], v[32:35], 0
  v_mfma_f32_16x16x32_bf16 v[136:139], v[116:119], v[20:23], v[136:139]
  v_mfma_f32_16x16x32_bf16 v[140:143], v[52:55], v[20:23], v[140:143]
  v_mfma_f32_16x16x32_bf16 v[144:147], v[116:119], v[36:39], v[144:147]
  v_mfma_f32_16x16x32_bf16 v[148:151], v[52:55], v[36:39], v[148:151]
  v_mfma_f32_16x16x32_bf16 v[152:155], v[68:71], v[36:39], v[152:155]
  v_mfma_f32_16x16x32_bf16 v[136:139], v[120:123], v[24:27], v[136:139]
  v_mfma_f32_16x16x32_bf16 v[140:143], v[56:59], v[24:27], v[140:143]
  v_mfma_f32_16x16x32_bf16 v[144:147], v[120:123], v[40:43], v[144:147]
  v_mfma_f32_16x16x32_bf16 v[148:151], v[56:59], v[40:43], v[148:151]
  v_mfma_f32_16x16x32_bf16 v[152:155], v[72:75], v[40:43], v[152:155]
  v_mfma_f32_16x16x32_bf16 v[136:139], v[124:127], v[28:31], v[136:139]
  v_mfma_f32_16x16x32_bf16 v[140:143], v[60:63], v[28:31], v[140:143]
  v_mfma_f32_16x16x32_bf16 v[144:147], v[124:127], v[44:47], v[144:147]
  v_mfma_f32_16x16x32_bf16 v[148:151], v[60:63], v[44:47], v[148:151]
  v_mfma_f32_16x16x32_bf16 v[152:155], v[76:79], v[44:47], v[152:155]
  s_nop 4
  v_cndmask_b32 v140, v6, v140, s[40:41]
  v_cndmask_b32 v141, v6, v141, s[42:43]
  v_cndmask_b32 v142, v6, v142, s[44:45]
  v_cndmask_b32 v143, v6, v143, s[46:47]
  v_max3_f32 v12, v136, v137, v140
  v_max3_f32 v12, v12, v141, v142
  v_max_f32 v12, v12, v143
  v_mov_b32 v13, v12
  s_nop 1
  v_permlane32_swap_b32 v12, v13
  v_max_f32 v12, v12, v13
  v_mov_b32 v13, v12
  s_nop 1
  v_permlane16_swap_b32 v12, v13
  v_max_f32 v12, v12, v13
  v_mul_f32 v12, s50, v12
  v_fma_f32 v136, v136, s50, -v12
  v_fma_f32 v137, v137, s50, -v12
  v_fma_f32 v140, v140, s50, -v12
  v_fma_f32 v141, v141, s50, -v12
  v_fma_f32 v142, v142, s50, -v12
  v_fma_f32 v143, v143, s50, -v12
  v_exp_f32 v136, v136
  v_exp_f32 v137, v137
  v_exp_f32 v140, v140
  v_exp_f32 v141, v141
  v_exp_f32 v142, v142
  v_exp_f32 v143, v143
  v_add_f32 v12, v136, v137
  v_add_f32 v12, v12, v140
  v_add_f32 v12, v12, v141
  v_add_f32 v12, v12, v142
  v_add_f32 v12, v12, v143
  v_mov_b32 v13, v12
  s_nop 1
  v_permlane32_swap_b32 v12, v13
  v_add_f32 v12, v12, v13
  v_mov_b32 v13, v12
  s_nop 1
  v_permlane16_swap_b32 v12, v13
  v_add_f32 v12, v12, v13
  v_rcp_f32 v12, v12
  s_nop 0
  v_mul_f32 v136, v136, v12
  v_mul_f32 v137, v137, v12
  v_mul_f32 v140, v140, v12
  v_mul_f32 v141, v141, v12
  v_mul_f32 v142, v142, v12
  v_mul_f32 v143, v143, v12
  v_cvt_pk_bf16_f32 v160, v136, v137
  v_mov_b32 v161, 0
  v_mov_b32 v162, 0
  v_mov_b32 v163, v160
  v_cvt_pk_bf16_f32 v156, v140, v141
  v_cvt_pk_bf16_f32 v157, v142, v143
  v_mov_b32 v158, 0
  v_mov_b32 v159, 0
  v_cndmask_b32 v152, v6, v152, s[40:41]
  v_cndmask_b32 v153, v6, v153, s[42:43]
  v_cndmask_b32 v154, v6, v154, s[44:45]
  v_cndmask_b32 v155, v6, v155, s[46:47]
  v_max3_f32 v12, v144, v145, v148
  v_max3_f32 v12, v12, v149, v150
  v_max3_f32 v12, v12, v151, v152
  v_max3_f32 v12, v12, v153, v154
  v_max_f32 v12, v12, v155
  v_mov_b32 v13, v12
  s_nop 1
  v_permlane32_swap_b32 v12, v13
  v_max_f32 v12, v12, v13
  v_mov_b32 v13, v12
  s_nop 1
  v_permlane16_swap_b32 v12, v13
  v_max_f32 v12, v12, v13
  v_mul_f32 v12, s50, v12
  v_fma_f32 v144, v144, s50, -v12
  v_fma_f32 v145, v145, s50, -v12
  v_fma_f32 v148, v148, s50, -v12
  v_fma_f32 v149, v149, s50, -v12
  v_fma_f32 v150, v150, s50, -v12
  v_fma_f32 v151, v151, s50, -v12
  v_fma_f32 v152, v152, s50, -v12
  v_fma_f32 v153, v153, s50, -v12
  v_fma_f32 v154, v154, s50, -v12
  v_fma_f32 v155, v155, s50, -v12
  v_exp_f32 v144, v144
  v_exp_f32 v145, v145
  v_exp_f32 v148, v148
  v_exp_f32 v149, v149
  v_exp_f32 v150, v150
  v_exp_f32 v151, v151
  v_exp_f32 v152, v152
  v_exp_f32 v153, v153
  v_exp_f32 v154, v154
  v_exp_f32 v155, v155
  v_add_f32 v12, v144, v145
  v_add_f32 v12, v12, v148
  v_add_f32 v12, v12, v149
  v_add_f32 v12, v12, v150
  v_add_f32 v12, v12, v151
  v_add_f32 v12, v12, v152
  v_add_f32 v12, v12, v153
  v_add_f32 v12, v12, v154
  v_add_f32 v12, v12, v155
  v_mov_b32 v13, v12
  s_nop 1
  v_permlane32_swap_b32 v12, v13
  v_add_f32 v12, v12, v13
  v_mov_b32 v13, v12
  s_nop 1
  v_permlane16_swap_b32 v12, v13
  v_add_f32 v12, v12, v13
  v_rcp_f32 v12, v12
  s_nop 0
  v_mul_f32 v144, v144, v12
  v_mul_f32 v145, v145, v12
  v_mul_f32 v148, v148, v12
  v_mul_f32 v149, v149, v12
  v_mul_f32 v150, v150, v12
  v_mul_f32 v151, v151, v12
  v_mul_f32 v152, v152, v12
  v_mul_f32 v153, v153, v12
  v_mul_f32 v154, v154, v12
  v_mul_f32 v155, v155, v12
  v_cvt_pk_bf16_f32 v168, v144, v145
  v_mov_b32 v169, 0
  v_mov_b32 v170, 0
  v_mov_b32 v171, v168
  v_cvt_pk_bf16_f32 v164, v148, v149
  v_cvt_pk_bf16_f32 v165, v150, v151
  v_cvt_pk_bf16_f32 v166, v152, v153
  v_cvt_pk_bf16_f32 v167, v154, v155
  v_mfma_f32_16x16x32_bf16 v[176:179], v[80:83], v[156:159], 0
  v_mfma_f32_16x16x32_bf16 v[180:183], v[84:87], v[156:159], 0
  v_mfma_f32_16x16x32_bf16 v[184:187], v[88:91], v[156:159], 0
  v_mfma_f32_16x16x32_bf16 v[188:191], v[92:95], v[156:159], 0
  v_mfma_f32_16x16x32_bf16 v[192:195], v[96:99], v[156:159], 0
  v_mfma_f32_16x16x32_bf16 v[196:199], v[100:103], v[156:159], 0
  v_mfma_f32_16x16x32_bf16 v[200:203], v[104:107], v[156:159], 0
  v_mfma_f32_16x16x32_bf16 v[204:207], v[108:111], v[156:159], 0
  v_mfma_f32_16x16x16_bf16 v[176:179], v[128:129], v[160:161], v[176:179]
  v_mfma_f32_16x16x16_bf16 v[180:183], v[128:129], v[162:163], v[180:183]
  v_mfma_f32_16x16x16_bf16 v[184:187], v[130:131], v[160:161], v[184:187]
  v_mfma_f32_16x16x16_bf16 v[188:191], v[130:131], v[162:163], v[188:191]
  v_mfma_f32_16x16x16_bf16 v[192:195], v[132:133], v[160:161], v[192:195]
  v_mfma_f32_16x16x16_bf16 v[196:199], v[132:133], v[162:163], v[196:199]
  v_mfma_f32_16x16x16_bf16 v[200:203], v[134:135], v[160:161], v[200:203]
  v_mfma_f32_16x16x16_bf16 v[204:207], v[134:135], v[162:163], v[204:207]
  v_mfma_f32_16x16x32_bf16 v[208:211], v[80:83], v[164:167], 0
  v_mfma_f32_16x16x32_bf16 v[212:215], v[84:87], v[164:167], 0
  v_mfma_f32_16x16x32_bf16 v[216:219], v[88:91], v[164:167], 0
  v_mfma_f32_16x16x32_bf16 v[220:223], v[92:95], v[164:167], 0
  v_mfma_f32_16x16x32_bf16 v[224:227], v[96:99], v[164:167], 0
  v_mfma_f32_16x16x32_bf16 v[228:231], v[100:103], v[164:167], 0
  v_mfma_f32_16x16x32_bf16 v[232:235], v[104:107], v[164:167], 0
  v_mfma_f32_16x16x32_bf16 v[236:239], v[108:111], v[164:167], 0
  v_mfma_f32_16x16x16_bf16 v[208:211], v[128:129], v[168:169], v[208:211]
  v_mfma_f32_16x16x16_bf16 v[212:215], v[128:129], v[170:171], v[212:215]
  v_mfma_f32_16x16x16_bf16 v[216:219], v[130:131], v[168:169], v[216:219]
  v_mfma_f32_16x16x16_bf16 v[220:223], v[130:131], v[170:171], v[220:223]
  v_mfma_f32_16x16x16_bf16 v[224:227], v[132:133], v[168:169], v[224:227]
  v_mfma_f32_16x16x16_bf16 v[228:231], v[132:133], v[170:171], v[228:231]
  v_mfma_f32_16x16x16_bf16 v[232:235], v[134:135], v[168:169], v[232:235]
  v_mfma_f32_16x16x16_bf16 v[236:239], v[134:135], v[170:171], v[236:239]
  buffer_load_dwordx4 v[16:19], v2, s[4:7], s94 offen offset:0 sc1
  buffer_load_dwordx4 v[20:23], v2, s[4:7], s94 offen offset:1024 sc1
  buffer_load_dwordx4 v[24:27], v2, s[4:7], s94 offen offset:2048 sc1
  buffer_load_dwordx4 v[28:31], v2, s[4:7], s94 offen offset:3072 sc1
  buffer_load_dwordx4 v[32:35], v3, s[4:7], s94 offen offset:0 sc1
  buffer_load_dwordx4 v[36:39], v3, s[4:7], s94 offen offset:1024 sc1
  buffer_load_dwordx4 v[40:43], v3, s[4:7], s94 offen offset:2048 sc1
  buffer_load_dwordx4 v[44:47], v3, s[4:7], s94 offen offset:3072 sc1
  buffer_load_dwordx4 v[48:51], v2, s[4:7], s92 offen offset:0 sc1
  buffer_load_dwordx4 v[52:55], v2, s[4:7], s92 offen offset:1024 sc1
  buffer_load_dwordx4 v[56:59], v2, s[4:7], s92 offen offset:2048 sc1
  buffer_load_dwordx4 v[60:63], v2, s[4:7], s92 offen offset:3072 sc1
  buffer_load_dwordx4 v[64:67], v3, s[4:7], s92 offen offset:0 sc1
  buffer_load_dwordx4 v[68:71], v3, s[4:7], s92 offen offset:1024 sc1
  buffer_load_dwordx4 v[72:75], v3, s[4:7], s92 offen offset:2048 sc1
  buffer_load_dwordx4 v[76:79], v3, s[4:7], s92 offen offset:3072 sc1
  buffer_load_dwordx4 v[80:83], v8, s[4:7], s93 offen offset:0 sc1
  buffer_load_dwordx4 v[84:87], v8, s[4:7], s93 offen offset:128 sc1
  buffer_load_dwordx4 v[88:91], v8, s[4:7], s93 offen offset:1024 sc1
  buffer_load_dwordx4 v[92:95], v8, s[4:7], s93 offen offset:1152 sc1
  buffer_load_dwordx4 v[96:99], v9, s[4:7], s93 offen offset:0 sc1
  buffer_load_dwordx4 v[100:103], v9, s[4:7], s93 offen offset:128 sc1
  buffer_load_dwordx4 v[104:107], v9, s[4:7], s93 offen offset:1024 sc1
  buffer_load_dwordx4 v[108:111], v9, s[4:7], s93 offen offset:1152 sc1
  buffer_load_dwordx4 v[112:115], v4, s[4:7], s91 offen offset:0 sc1
  buffer_load_dwordx4 v[116:119], v4, s[4:7], s91 offen offset:512 sc1
  buffer_load_dwordx4 v[120:123], v4, s[4:7], s91 offen offset:1024 sc1
  buffer_load_dwordx4 v[124:127], v4, s[4:7], s91 offen offset:1536 sc1
  buffer_load_dwordx4 v[128:131], v5, s[4:7], s91 offen offset:0 sc1
  buffer_load_dwordx4 v[132:135], v5, s[4:7], s91 offen offset:1024 sc1
  s_add_u32 s92, s92, 262144
  s_add_u32 s93, s93, 262144
  s_add_u32 s94, s94, 262144
  s_add_u32 s91, s91, 65536
  v_cvt_pk_bf16_f32 v136, v176, v177
  v_cvt_pk_bf16_f32 v137, v178, v179
  v_cvt_pk_bf16_f32 v138, v184, v185
  v_cvt_pk_bf16_f32 v139, v186, v187
  buffer_store_dwordx4 v[136:139], v10, s[4:7], s95 offen offset:0 sc1
  v_cvt_pk_bf16_f32 v140, v180, v181
  v_cvt_pk_bf16_f32 v141, v182, v183
  v_cvt_pk_bf16_f32 v142, v188, v189
  v_cvt_pk_bf16_f32 v143, v190, v191
  buffer_store_dwordx4 v[140:143], v10, s[4:7], s95 offen offset:512 sc1
  v_cvt_pk_bf16_f32 v144, v192, v193
  v_cvt_pk_bf16_f32 v145, v194, v195
  v_cvt_pk_bf16_f32 v146, v200, v201
  v_cvt_pk_bf16_f32 v147, v202, v203
  buffer_store_dwordx4 v[144:147], v10, s[4:7], s95 offen offset:2048 sc1
  v_cvt_pk_bf16_f32 v148, v196, v197
  v_cvt_pk_bf16_f32 v149, v198, v199
  v_cvt_pk_bf16_f32 v150, v204, v205
  v_cvt_pk_bf16_f32 v151, v206, v207
  buffer_store_dwordx4 v[148:151], v10, s[4:7], s95 offen offset:2560 sc1
  v_cvt_pk_bf16_f32 v136, v208, v209
  v_cvt_pk_bf16_f32 v137, v210, v211
  v_cvt_pk_bf16_f32 v138, v216, v217
  v_cvt_pk_bf16_f32 v139, v218, v219
  buffer_store_dwordx4 v[136:139], v11, s[4:7], s95 offen offset:0 sc1
  v_cvt_pk_bf16_f32 v140, v212, v213
  v_cvt_pk_bf16_f32 v141, v214, v215
  v_cvt_pk_bf16_f32 v142, v220, v221
  v_cvt_pk_bf16_f32 v143, v222, v223
  buffer_store_dwordx4 v[140:143], v11, s[4:7], s95 offen offset:512 sc1
  v_cvt_pk_bf16_f32 v144, v224, v225
  v_cvt_pk_bf16_f32 v145, v226, v227
  v_cvt_pk_bf16_f32 v146, v232, v233
  v_cvt_pk_bf16_f32 v147, v234, v235
  buffer_store_dwordx4 v[144:147], v11, s[4:7], s95 offen offset:2048 sc1
  v_cvt_pk_bf16_f32 v148, v228, v229
  v_cvt_pk_bf16_f32 v149, v230, v231
  v_cvt_pk_bf16_f32 v150, v236, v237
  v_cvt_pk_bf16_f32 v151, v238, v239
  buffer_store_dwordx4 v[148:151], v11, s[4:7], s95 offen offset:2560 sc1
  s_add_u32 s95, s95, 262144
  s_waitcnt vmcnt(38)
  v_mfma_f32_16x16x32_bf16 v[136:139], a[96:99], a[0:3], 0
  v_mfma_f32_16x16x32_bf16 v[140:143], a[32:35], a[0:3], 0
  v_mfma_f32_16x16x32_bf16 v[144:147], a[96:99], a[16:19], 0
  v_mfma_f32_16x16x32_bf16 v[148:151], a[32:35], a[16:19], 0
  v_mfma_f32_16x16x32_bf16 v[152:155], a[48:51], a[16:19], 0
  v_mfma_f32_16x16x32_bf16 v[136:139], a[100:103], a[4:7], v[136:139]
  v_mfma_f32_16x16x32_bf16 v[140:143], a[36:39], a[4:7], v[140:143]
  v_mfma_f32_16x16x32_bf16 v[144:147], a[100:103], a[20:23], v[144:147]
  v_mfma_f32_16x16x32_bf16 v[148:151], a[36:39], a[20:23], v[148:151]
  v_mfma_f32_16x16x32_bf16 v[152:155], a[52:55], a[20:23], v[152:155]
  v_mfma_f32_16x16x32_bf16 v[136:139], a[104:107], a[8:11], v[136:139]
  v_mfma_f32_16x16x32_bf16 v[140:143], a[40:43], a[8:11], v[140:143]
  v_mfma_f32_16x16x32_bf16 v[144:147], a[104:107], a[24:27], v[144:147]
  v_mfma_f32_16x16x32_bf16 v[148:151], a[40:43], a[24:27], v[148:151]
  v_mfma_f32_16x16x32_bf16 v[152:155], a[56:59], a[24:27], v[152:155]
  v_mfma_f32_16x16x32_bf16 v[136:139], a[108:111], a[12:15], v[136:139]
  v_mfma_f32_16x16x32_bf16 v[140:143], a[44:47], a[12:15], v[140:143]
  v_mfma_f32_16x16x32_bf16 v[144:147], a[108:111], a[28:31], v[144:147]
  v_mfma_f32_16x16x32_bf16 v[148:151], a[44:47], a[28:31], v[148:151]
  v_mfma_f32_16x16x32_bf16 v[152:155], a[60:63], a[28:31], v[152:155]
  s_nop 4
  v_cndmask_b32 v140, v6, v140, s[40:41]
  v_cndmask_b32 v141, v6, v141, s[42:43]
  v_cndmask_b32 v142, v6, v142, s[44:45]
  v_cndmask_b32 v143, v6, v143, s[46:47]
  v_max3_f32 v12, v136, v137, v140
  v_max3_f32 v12, v12, v141, v142
  v_max_f32 v12, v12, v143
  v_mov_b32 v13, v12
  s_nop 1
  v_permlane32_swap_b32 v12, v13
  v_max_f32 v12, v12, v13
  v_mov_b32 v13, v12
  s_nop 1
  v_permlane16_swap_b32 v12, v13
  v_max_f32 v12, v12, v13
  v_mul_f32 v12, s50, v12
  v_fma_f32 v136, v136, s50, -v12
  v_fma_f32 v137, v137, s50, -v12
  v_fma_f32 v140, v140, s50, -v12
  v_fma_f32 v141, v141, s50, -v12
  v_fma_f32 v142, v142, s50, -v12
  v_fma_f32 v143, v143, s50, -v12
  v_exp_f32 v136, v136
  v_exp_f32 v137, v137
  v_exp_f32 v140, v140
  v_exp_f32 v141, v141
  v_exp_f32 v142, v142
  v_exp_f32 v143, v143
  v_add_f32 v12, v136, v137
  v_add_f32 v12, v12, v140
  v_add_f32 v12, v12, v141
  v_add_f32 v12, v12, v142
  v_add_f32 v12, v12, v143
  v_mov_b32 v13, v12
  s_nop 1
  v_permlane32_swap_b32 v12, v13
  v_add_f32 v12, v12, v13
  v_mov_b32 v13, v12
  s_nop 1
  v_permlane16_swap_b32 v12, v13
  v_add_f32 v12, v12, v13
  v_rcp_f32 v12, v12
  s_nop 0
  v_mul_f32 v136, v136, v12
  v_mul_f32 v137, v137, v12
  v_mul_f32 v140, v140, v12
  v_mul_f32 v141, v141, v12
  v_mul_f32 v142, v142, v12
  v_mul_f32 v143, v143, v12
  v_cvt_pk_bf16_f32 v160, v136, v137
  v_mov_b32 v161, 0
  v_mov_b32 v162, 0
  v_mov_b32 v163, v160
  v_cvt_pk_bf16_f32 v156, v140, v141
  v_cvt_pk_bf16_f32 v157, v142, v143
  v_mov_b32 v158, 0
  v_mov_b32 v159, 0
  v_cndmask_b32 v152, v6, v152, s[40:41]
  v_cndmask_b32 v153, v6, v153, s[42:43]
  v_cndmask_b32 v154, v6, v154, s[44:45]
  v_cndmask_b32 v155, v6, v155, s[46:47]
  v_max3_f32 v12, v144, v145, v148
  v_max3_f32 v12, v12, v149, v150
  v_max3_f32 v12, v12, v151, v152
  v_max3_f32 v12, v12, v153, v154
  v_max_f32 v12, v12, v155
  v_mov_b32 v13, v12
  s_nop 1
  v_permlane32_swap_b32 v12, v13
  v_max_f32 v12, v12, v13
  v_mov_b32 v13, v12
  s_nop 1
  v_permlane16_swap_b32 v12, v13
  v_max_f32 v12, v12, v13
  v_mul_f32 v12, s50, v12
  v_fma_f32 v144, v144, s50, -v12
  v_fma_f32 v145, v145, s50, -v12
  v_fma_f32 v148, v148, s50, -v12
  v_fma_f32 v149, v149, s50, -v12
  v_fma_f32 v150, v150, s50, -v12
  v_fma_f32 v151, v151, s50, -v12
  v_fma_f32 v152, v152, s50, -v12
  v_fma_f32 v153, v153, s50, -v12
  v_fma_f32 v154, v154, s50, -v12
  v_fma_f32 v155, v155, s50, -v12
  v_exp_f32 v144, v144
  v_exp_f32 v145, v145
  v_exp_f32 v148, v148
  v_exp_f32 v149, v149
  v_exp_f32 v150, v150
  v_exp_f32 v151, v151
  v_exp_f32 v152, v152
  v_exp_f32 v153, v153
  v_exp_f32 v154, v154
  v_exp_f32 v155, v155
  v_add_f32 v12, v144, v145
  v_add_f32 v12, v12, v148
  v_add_f32 v12, v12, v149
  v_add_f32 v12, v12, v150
  v_add_f32 v12, v12, v151
  v_add_f32 v12, v12, v152
  v_add_f32 v12, v12, v153
  v_add_f32 v12, v12, v154
  v_add_f32 v12, v12, v155
  v_mov_b32 v13, v12
  s_nop 1
  v_permlane32_swap_b32 v12, v13
  v_add_f32 v12, v12, v13
  v_mov_b32 v13, v12
  s_nop 1
  v_permlane16_swap_b32 v12, v13
  v_add_f32 v12, v12, v13
  v_rcp_f32 v12, v12
  s_nop 0
  v_mul_f32 v144, v144, v12
  v_mul_f32 v145, v145, v12
  v_mul_f32 v148, v148, v12
  v_mul_f32 v149, v149, v12
  v_mul_f32 v150, v150, v12
  v_mul_f32 v151, v151, v12
  v_mul_f32 v152, v152, v12
  v_mul_f32 v153, v153, v12
  v_mul_f32 v154, v154, v12
  v_mul_f32 v155, v155, v12
  v_cvt_pk_bf16_f32 v168, v144, v145
  v_mov_b32 v169, 0
  v_mov_b32 v170, 0
  v_mov_b32 v171, v168
  v_cvt_pk_bf16_f32 v164, v148, v149
  v_cvt_pk_bf16_f32 v165, v150, v151
  v_cvt_pk_bf16_f32 v166, v152, v153
  v_cvt_pk_bf16_f32 v167, v154, v155
  v_mfma_f32_16x16x32_bf16 v[176:179], a[64:67], v[156:159], 0
  v_mfma_f32_16x16x32_bf16 v[180:183], a[68:71], v[156:159], 0
  v_mfma_f32_16x16x32_bf16 v[184:187], a[72:75], v[156:159], 0
  v_mfma_f32_16x16x32_bf16 v[188:191], a[76:79], v[156:159], 0
  v_mfma_f32_16x16x32_bf16 v[192:195], a[80:83], v[156:159], 0
  v_mfma_f32_16x16x32_bf16 v[196:199], a[84:87], v[156:159], 0
  v_mfma_f32_16x16x32_bf16 v[200:203], a[88:91], v[156:159], 0
  v_mfma_f32_16x16x32_bf16 v[204:207], a[92:95], v[156:159], 0
  v_mfma_f32_16x16x16_bf16 v[176:179], a[112:113], v[160:161], v[176:179]
  v_mfma_f32_16x16x16_bf16 v[180:183], a[112:113], v[162:163], v[180:183]
  v_mfma_f32_16x16x16_bf16 v[184:187], a[114:115], v[160:161], v[184:187]
  v_mfma_f32_16x16x16_bf16 v[188:191], a[114:115], v[162:163], v[188:191]
  v_mfma_f32_16x16x16_bf16 v[192:195], a[116:117], v[160:161], v[192:195]
  v_mfma_f32_16x16x16_bf16 v[196:199], a[116:117], v[162:163], v[196:199]
  v_mfma_f32_16x16x16_bf16 v[200:203], a[118:119], v[160:161], v[200:203]
  v_mfma_f32_16x16x16_bf16 v[204:207], a[118:119], v[162:163], v[204:207]
  v_mfma_f32_16x16x32_bf16 v[208:211], a[64:67], v[164:167], 0
  v_mfma_f32_16x16x32_bf16 v[212:215], a[68:71], v[164:167], 0
  v_mfma_f32_16x16x32_bf16 v[216:219], a[72:75], v[164:167], 0
  v_mfma_f32_16x16x32_bf16 v[220:223], a[76:79], v[164:167], 0
  v_mfma_f32_16x16x32_bf16 v[224:227], a[80:83], v[164:167], 0
  v_mfma_f32_16x16x32_bf16 v[228:231], a[84:87], v[164:167], 0
  v_mfma_f32_16x16x32_bf16 v[232:235], a[88:91], v[164:167], 0
  v_mfma_f32_16x16x32_bf16 v[236:239], a[92:95], v[164:167], 0
  v_mfma_f32_16x16x16_bf16 v[208:211], a[112:113], v[168:169], v[208:211]
  v_mfma_f32_16x16x16_bf16 v[212:215], a[112:113], v[170:171], v[212:215]
  v_mfma_f32_16x16x16_bf16 v[216:219], a[114:115], v[168:169], v[216:219]
  v_mfma_f32_16x16x16_bf16 v[220:223], a[114:115], v[170:171], v[220:223]
  v_mfma_f32_16x16x16_bf16 v[224:227], a[116:117], v[168:169], v[224:227]
  v_mfma_f32_16x16x16_bf16 v[228:231], a[116:117], v[170:171], v[228:231]
  v_mfma_f32_16x16x16_bf16 v[232:235], a[118:119], v[168:169], v[232:235]
  v_mfma_f32_16x16x16_bf16 v[236:239], a[118:119], v[170:171], v[236:239]
  buffer_load_dwordx4 a[0:3], v2, s[4:7], s94 offen offset:0 sc1
  buffer_load_dwordx4 a[4:7], v2, s[4:7], s94 offen offset:1024 sc1
  buffer_load_dwordx4 a[8:11], v2, s[4:7], s94 offen offset:2048 sc1
  buffer_load_dwordx4 a[12:15], v2, s[4:7], s94 offen offset:3072 sc1
  buffer_load_dwordx4 a[16:19], v3, s[4:7], s94 offen offset:0 sc1
  buffer_load_dwordx4 a[20:23], v3, s[4:7], s94 offen offset:1024 sc1
  buffer_load_dwordx4 a[24:27], v3, s[4:7], s94 offen offset:2048 sc1
  buffer_load_dwordx4 a[28:31], v3, s[4:7], s94 offen offset:3072 sc1
  buffer_load_dwordx4 a[32:35], v2, s[4:7], s92 offen offset:0 sc1
  buffer_load_dwordx4 a[36:39], v2, s[4:7], s92 offen offset:1024 sc1
  buffer_load_dwordx4 a[40:43], v2, s[4:7], s92 offen offset:2048 sc1
  buffer_load_dwordx4 a[44:47], v2, s[4:7], s92 offen offset:3072 sc1
  buffer_load_dwordx4 a[48:51], v3, s[4:7], s92 offen offset:0 sc1
  buffer_load_dwordx4 a[52:55], v3, s[4:7], s92 offen offset:1024 sc1
  buffer_load_dwordx4 a[56:59], v3, s[4:7], s92 offen offset:2048 sc1
  buffer_load_dwordx4 a[60:63], v3, s[4:7], s92 offen offset:3072 sc1
  buffer_load_dwordx4 a[64:67], v8, s[4:7], s93 offen offset:0 sc1
  buffer_load_dwordx4 a[68:71], v8, s[4:7], s93 offen offset:128 sc1
  buffer_load_dwordx4 a[72:75], v8, s[4:7], s93 offen offset:1024 sc1
  buffer_load_dwordx4 a[76:79], v8, s[4:7], s93 offen offset:1152 sc1
  buffer_load_dwordx4 a[80:83], v9, s[4:7], s93 offen offset:0 sc1
  buffer_load_dwordx4 a[84:87], v9, s[4:7], s93 offen offset:128 sc1
  buffer_load_dwordx4 a[88:91], v9, s[4:7], s93 offen offset:1024 sc1
  buffer_load_dwordx4 a[92:95], v9, s[4:7], s93 offen offset:1152 sc1
  buffer_load_dwordx4 a[96:99], v4, s[4:7], s91 offen offset:0 sc1
  buffer_load_dwordx4 a[100:103], v4, s[4:7], s91 offen offset:512 sc1
  buffer_load_dwordx4 a[104:107], v4, s[4:7], s91 offen offset:1024 sc1
  buffer_load_dwordx4 a[108:111], v4, s[4:7], s91 offen offset:1536 sc1
  buffer_load_dwordx4 a[112:115], v5, s[4:7], s91 offen offset:0 sc1
  buffer_load_dwordx4 a[116:119], v5, s[4:7], s91 offen offset:1024 sc1
  s_add_u32 s92, s92, 262144
  s_add_u32 s93, s93, 262144
  s_add_u32 s94, s94, 262144
  s_add_u32 s91, s91, 65536
  v_cvt_pk_bf16_f32 v136, v176, v177
  v_cvt_pk_bf16_f32 v137, v178, v179
  v_cvt_pk_bf16_f32 v138, v184, v185
  v_cvt_pk_bf16_f32 v139, v186, v187
  buffer_store_dwordx4 v[136:139], v10, s[4:7], s95 offen offset:0 sc1
  v_cvt_pk_bf16_f32 v140, v180, v181
  v_cvt_pk_bf16_f32 v141, v182, v183
  v_cvt_pk_bf16_f32 v142, v188, v189
  v_cvt_pk_bf16_f32 v143, v190, v191
  buffer_store_dwordx4 v[140:143], v10, s[4:7], s95 offen offset:512 sc1
  v_cvt_pk_bf16_f32 v144, v192, v193
  v_cvt_pk_bf16_f32 v145, v194, v195
  v_cvt_pk_bf16_f32 v146, v200, v201
  v_cvt_pk_bf16_f32 v147, v202, v203
  buffer_store_dwordx4 v[144:147], v10, s[4:7], s95 offen offset:2048 sc1
  v_cvt_pk_bf16_f32 v148, v196, v197
  v_cvt_pk_bf16_f32 v149, v198, v199
  v_cvt_pk_bf16_f32 v150, v204, v205
  v_cvt_pk_bf16_f32 v151, v206, v207
  buffer_store_dwordx4 v[148:151], v10, s[4:7], s95 offen offset:2560 sc1
  v_cvt_pk_bf16_f32 v136, v208, v209
  v_cvt_pk_bf16_f32 v137, v210, v211
  v_cvt_pk_bf16_f32 v138, v216, v217
  v_cvt_pk_bf16_f32 v139, v218, v219
  buffer_store_dwordx4 v[136:139], v11, s[4:7], s95 offen offset:0 sc1
  v_cvt_pk_bf16_f32 v140, v212, v213
  v_cvt_pk_bf16_f32 v141, v214, v215
  v_cvt_pk_bf16_f32 v142, v220, v221
  v_cvt_pk_bf16_f32 v143, v222, v223
  buffer_store_dwordx4 v[140:143], v11, s[4:7], s95 offen offset:512 sc1
  v_cvt_pk_bf16_f32 v144, v224, v225
  v_cvt_pk_bf16_f32 v145, v226, v227
  v_cvt_pk_bf16_f32 v146, v232, v233
  v_cvt_pk_bf16_f32 v147, v234, v235
  buffer_store_dwordx4 v[144:147], v11, s[4:7], s95 offen offset:2048 sc1
  v_cvt_pk_bf16_f32 v148, v228, v229
  v_cvt_pk_bf16_f32 v149, v230, v231
  v_cvt_pk_bf16_f32 v150, v236, v237
  v_cvt_pk_bf16_f32 v151, v238, v239
  buffer_store_dwordx4 v[148:151], v11, s[4:7], s95 offen offset:2560 sc1
  s_add_u32 s95, s95, 262144
  s_waitcnt vmcnt(46)
  v_mfma_f32_16x16x32_bf16 v[136:139], v[112:115], v[16:19], 0
  v_mfma_f32_16x16x32_bf16 v[140:143], v[48:51], v[16:19], 0
  v_mfma_f32_16x16x32_bf16 v[144:147], v[112:115], v[32:35], 0
  v_mfma_f32_16x16x32_bf16 v[148:151], v[48:51], v[32:35], 0
  v_mfma_f32_16x16x32_bf16 v[152:155], v[64:67], v[32:35], 0
  v_mfma_f32_16x16x32_bf16 v[136:139], v[116:119], v[20:23], v[136:139]
  v_mfma_f32_16x16x32_bf16 v[140:143], v[52:55], v[20:23], v[140:143]
  v_mfma_f32_16x16x32_bf16 v[144:147], v[116:119], v[36:39], v[144:147]
  v_mfma_f32_16x16x32_bf16 v[148:151], v[52:55], v[36:39], v[148:151]
  v_mfma_f32_16x16x32_bf16 v[152:155], v[68:71], v[36:39], v[152:155]
  v_mfma_f32_16x16x32_bf16 v[136:139], v[120:123], v[24:27], v[136:139]
  v_mfma_f32_16x16x32_bf16 v[140:143], v[56:59], v[24:27], v[140:143]
  v_mfma_f32_16x16x32_bf16 v[144:147], v[120:123], v[40:43], v[144:147]
  v_mfma_f32_16x16x32_bf16 v[148:151], v[56:59], v[40:43], v[148:151]
  v_mfma_f32_16x16x32_bf16 v[152:155], v[72:75], v[40:43], v[152:155]
  v_mfma_f32_16x16x32_bf16 v[136:139], v[124:127], v[28:31], v[136:139]
  v_mfma_f32_16x16x32_bf16 v[140:143], v[60:63], v[28:31], v[140:143]
  v_mfma_f32_16x16x32_bf16 v[144:147], v[124:127], v[44:47], v[144:147]
  v_mfma_f32_16x16x32_bf16 v[148:151], v[60:63], v[44:47], v[148:151]
  v_mfma_f32_16x16x32_bf16 v[152:155], v[76:79], v[44:47], v[152:155]
  s_nop 4
  v_cndmask_b32 v140, v6, v140, s[40:41]
  v_cndmask_b32 v141, v6, v141, s[42:43]
  v_cndmask_b32 v142, v6, v142, s[44:45]
  v_cndmask_b32 v143, v6, v143, s[46:47]
  v_max3_f32 v12, v136, v137, v140
  v_max3_f32 v12, v12, v141, v142
  v_max_f32 v12, v12, v143
  v_mov_b32 v13, v12
  s_nop 1
  v_permlane32_swap_b32 v12, v13
  v_max_f32 v12, v12, v13
  v_mov_b32 v13, v12
  s_nop 1
  v_permlane16_swap_b32 v12, v13
  v_max_f32 v12, v12, v13
  v_mul_f32 v12, s50, v12
  v_fma_f32 v136, v136, s50, -v12
  v_fma_f32 v137, v137, s50, -v12
  v_fma_f32 v140, v140, s50, -v12
  v_fma_f32 v141, v141, s50, -v12
  v_fma_f32 v142, v142, s50, -v12
  v_fma_f32 v143, v143, s50, -v12
  v_exp_f32 v136, v136
  v_exp_f32 v137, v137
  v_exp_f32 v140, v140
  v_exp_f32 v141, v141
  v_exp_f32 v142, v142
  v_exp_f32 v143, v143
  v_add_f32 v12, v136, v137
  v_add_f32 v12, v12, v140
  v_add_f32 v12, v12, v141
  v_add_f32 v12, v12, v142
  v_add_f32 v12, v12, v143
  v_mov_b32 v13, v12
  s_nop 1
  v_permlane32_swap_b32 v12, v13
  v_add_f32 v12, v12, v13
  v_mov_b32 v13, v12
  s_nop 1
  v_permlane16_swap_b32 v12, v13
  v_add_f32 v12, v12, v13
  v_rcp_f32 v12, v12
  s_nop 0
  v_mul_f32 v136, v136, v12
  v_mul_f32 v137, v137, v12
  v_mul_f32 v140, v140, v12
  v_mul_f32 v141, v141, v12
  v_mul_f32 v142, v142, v12
  v_mul_f32 v143, v143, v12
  v_cvt_pk_bf16_f32 v160, v136, v137
  v_mov_b32 v161, 0
  v_mov_b32 v162, 0
  v_mov_b32 v163, v160
  v_cvt_pk_bf16_f32 v156, v140, v141
  v_cvt_pk_bf16_f32 v157, v142, v143
  v_mov_b32 v158, 0
  v_mov_b32 v159, 0
  v_cndmask_b32 v152, v6, v152, s[40:41]
  v_cndmask_b32 v153, v6, v153, s[42:43]
  v_cndmask_b32 v154, v6, v154, s[44:45]
  v_cndmask_b32 v155, v6, v155, s[46:47]
  v_max3_f32 v12, v144, v145, v148
  v_max3_f32 v12, v12, v149, v150
  v_max3_f32 v12, v12, v151, v152
  v_max3_f32 v12, v12, v153, v154
  v_max_f32 v12, v12, v155
  v_mov_b32 v13, v12
  s_nop 1
  v_permlane32_swap_b32 v12, v13
  v_max_f32 v12, v12, v13
  v_mov_b32 v13, v12
  s_nop 1
  v_permlane16_swap_b32 v12, v13
  v_max_f32 v12, v12, v13
  v_mul_f32 v12, s50, v12
  v_fma_f32 v144, v144, s50, -v12
  v_fma_f32 v145, v145, s50, -v12
  v_fma_f32 v148, v148, s50, -v12
  v_fma_f32 v149, v149, s50, -v12
  v_fma_f32 v150, v150, s50, -v12
  v_fma_f32 v151, v151, s50, -v12
  v_fma_f32 v152, v152, s50, -v12
  v_fma_f32 v153, v153, s50, -v12
  v_fma_f32 v154, v154, s50, -v12
  v_fma_f32 v155, v155, s50, -v12
  v_exp_f32 v144, v144
  v_exp_f32 v145, v145
  v_exp_f32 v148, v148
  v_exp_f32 v149, v149
  v_exp_f32 v150, v150
  v_exp_f32 v151, v151
  v_exp_f32 v152, v152
  v_exp_f32 v153, v153
  v_exp_f32 v154, v154
  v_exp_f32 v155, v155
  v_add_f32 v12, v144, v145
  v_add_f32 v12, v12, v148
  v_add_f32 v12, v12, v149
  v_add_f32 v12, v12, v150
  v_add_f32 v12, v12, v151
  v_add_f32 v12, v12, v152
  v_add_f32 v12, v12, v153
  v_add_f32 v12, v12, v154
  v_add_f32 v12, v12, v155
  v_mov_b32 v13, v12
  s_nop 1
  v_permlane32_swap_b32 v12, v13
  v_add_f32 v12, v12, v13
  v_mov_b32 v13, v12
  s_nop 1
  v_permlane16_swap_b32 v12, v13
  v_add_f32 v12, v12, v13
  v_rcp_f32 v12, v12
  s_nop 0
  v_mul_f32 v144, v144, v12
  v_mul_f32 v145, v145, v12
  v_mul_f32 v148, v148, v12
  v_mul_f32 v149, v149, v12
  v_mul_f32 v150, v150, v12
  v_mul_f32 v151, v151, v12
  v_mul_f32 v152, v152, v12
  v_mul_f32 v153, v153, v12
  v_mul_f32 v154, v154, v12
  v_mul_f32 v155, v155, v12
  v_cvt_pk_bf16_f32 v168, v144, v145
  v_mov_b32 v169, 0
  v_mov_b32 v170, 0
  v_mov_b32 v171, v168
  v_cvt_pk_bf16_f32 v164, v148, v149
  v_cvt_pk_bf16_f32 v165, v150, v151
  v_cvt_pk_bf16_f32 v166, v152, v153
  v_cvt_pk_bf16_f32 v167, v154, v155
  v_mfma_f32_16x16x32_bf16 v[176:179], v[80:83], v[156:159], 0
  v_mfma_f32_16x16x32_bf16 v[180:183], v[84:87], v[156:159], 0
  v_mfma_f32_16x16x32_bf16 v[184:187], v[88:91], v[156:159], 0
  v_mfma_f32_16x16x32_bf16 v[188:191], v[92:95], v[156:159], 0
  v_mfma_f32_16x16x32_bf16 v[192:195], v[96:99], v[156:159], 0
  v_mfma_f32_16x16x32_bf16 v[196:199], v[100:103], v[156:159], 0
  v_mfma_f32_16x16x32_bf16 v[200:203], v[104:107], v[156:159], 0
  v_mfma_f32_16x16x32_bf16 v[204:207], v[108:111], v[156:159], 0
  v_mfma_f32_16x16x16_bf16 v[176:179], v[128:129], v[160:161], v[176:179]
  v_mfma_f32_16x16x16_bf16 v[180:183], v[128:129], v[162:163], v[180:183]
  v_mfma_f32_16x16x16_bf16 v[184:187], v[130:131], v[160:161], v[184:187]
  v_mfma_f32_16x16x16_bf16 v[188:191], v[130:131], v[162:163], v[188:191]
  v_mfma_f32_16x16x16_bf16 v[192:195], v[132:133], v[160:161], v[192:195]
  v_mfma_f32_16x16x16_bf16 v[196:199], v[132:133], v[162:163], v[196:199]
  v_mfma_f32_16x16x16_bf16 v[200:203], v[134:135], v[160:161], v[200:203]
  v_mfma_f32_16x16x16_bf16 v[204:207], v[134:135], v[162:163], v[204:207]
  v_mfma_f32_16x16x32_bf16 v[208:211], v[80:83], v[164:167], 0
  v_mfma_f32_16x16x32_bf16 v[212:215], v[84:87], v[164:167], 0
  v_mfma_f32_16x16x32_bf16 v[216:219], v[88:91], v[164:167], 0
  v_mfma_f32_16x16x32_bf16 v[220:223], v[92:95], v[164:167], 0
  v_mfma_f32_16x16x32_bf16 v[224:227], v[96:99], v[164:167], 0
  v_mfma_f32_16x16x32_bf16 v[228:231], v[100:103], v[164:167], 0
  v_mfma_f32_16x16x32_bf16 v[232:235], v[104:107], v[164:167], 0
  v_mfma_f32_16x16x32_bf16 v[236:239], v[108:111], v[164:167], 0
  v_mfma_f32_16x16x16_bf16 v[208:211], v[128:129], v[168:169], v[208:211]
  v_mfma_f32_16x16x16_bf16 v[212:215], v[128:129], v[170:171], v[212:215]
  v_mfma_f32_16x16x16_bf16 v[216:219], v[130:131], v[168:169], v[216:219]
  v_mfma_f32_16x16x16_bf16 v[220:223], v[130:131], v[170:171], v[220:223]
  v_mfma_f32_16x16x16_bf16 v[224:227], v[132:133], v[168:169], v[224:227]
  v_mfma_f32_16x16x16_bf16 v[228:231], v[132:133], v[170:171], v[228:231]
  v_mfma_f32_16x16x16_bf16 v[232:235], v[134:135], v[168:169], v[232:235]
  v_mfma_f32_16x16x16_bf16 v[236:239], v[134:135], v[170:171], v[236:239]
  v_cvt_pk_bf16_f32 v136, v176, v177
  v_cvt_pk_bf16_f32 v137, v178, v179
  v_cvt_pk_bf16_f32 v138, v184, v185
  v_cvt_pk_bf16_f32 v139, v186, v187
  buffer_store_dwordx4 v[136:139], v10, s[4:7], s95 offen offset:0 sc1
  v_cvt_pk_bf16_f32 v140, v180, v181
  v_cvt_pk_bf16_f32 v141, v182, v183
  v_cvt_pk_bf16_f32 v142, v188, v189
  v_cvt_pk_bf16_f32 v143, v190, v191
  buffer_store_dwordx4 v[140:143], v10, s[4:7], s95 offen offset:512 sc1
  v_cvt_pk_bf16_f32 v144, v192, v193
  v_cvt_pk_bf16_f32 v145, v194, v195
  v_cvt_pk_bf16_f32 v146, v200, v201
  v_cvt_pk_bf16_f32 v147, v202, v203
  buffer_store_dwordx4 v[144:147], v10, s[4:7], s95 offen offset:2048 sc1
  v_cvt_pk_bf16_f32 v148, v196, v197
  v_cvt_pk_bf16_f32 v149, v198, v199
  v_cvt_pk_bf16_f32 v150, v204, v205
  v_cvt_pk_bf16_f32 v151, v206, v207
  buffer_store_dwordx4 v[148:151], v10, s[4:7], s95 offen offset:2560 sc1
  v_cvt_pk_bf16_f32 v136, v208, v209
  v_cvt_pk_bf16_f32 v137, v210, v211
  v_cvt_pk_bf16_f32 v138, v216, v217
  v_cvt_pk_bf16_f32 v139, v218, v219
  buffer_store_dwordx4 v[136:139], v11, s[4:7], s95 offen offset:0 sc1
  v_cvt_pk_bf16_f32 v140, v212, v213
  v_cvt_pk_bf16_f32 v141, v214, v215
  v_cvt_pk_bf16_f32 v142, v220, v221
  v_cvt_pk_bf16_f32 v143, v222, v223
  buffer_store_dwordx4 v[140:143], v11, s[4:7], s95 offen offset:512 sc1
  v_cvt_pk_bf16_f32 v144, v224, v225
  v_cvt_pk_bf16_f32 v145, v226, v227
  v_cvt_pk_bf16_f32 v146, v232, v233
  v_cvt_pk_bf16_f32 v147, v234, v235
  buffer_store_dwordx4 v[144:147], v11, s[4:7], s95 offen offset:2048 sc1
  v_cvt_pk_bf16_f32 v148, v228, v229
  v_cvt_pk_bf16_f32 v149, v230, v231
  v_cvt_pk_bf16_f32 v150, v236, v237
  v_cvt_pk_bf16_f32 v151, v238, v239
  buffer_store_dwordx4 v[148:151], v11, s[4:7], s95 offen offset:2560 sc1
  s_add_u32 s95, s95, 262144
  s_waitcnt vmcnt(16)
  s_cmp_lg_u32 s32, 0
  s_cbranch_scc1 L_rq_98
  s_cmp_eq_u32 s39, 0
  s_cbranch_scc1 L_rq_98
  s_lshl_b32 s99, s33, 7
  s_add_u32 s99, s99, 0x3d00200
  v_mov_b32 v244, 1
  v_mov_b32 v245, 0
  s_mov_b64 exec, 1
  buffer_atomic_add v244, v245, s[4:7], s99 offen sc0 sc1
  s_mov_b64 exec, -1
L_rq_98:
  v_mfma_f32_16x16x32_bf16 v[136:139], a[96:99], a[0:3], 0
  v_mfma_f32_16x16x32_bf16 v[140:143], a[32:35], a[0:3], 0
  v_mfma_f32_16x16x32_bf16 v[144:147], a[96:99], a[16:19], 0
  v_mfma_f32_16x16x32_bf16 v[148:151], a[32:35], a[16:19], 0
  v_mfma_f32_16x16x32_bf16 v[152:155], a[48:51], a[16:19], 0
  v_mfma_f32_16x16x32_bf16 v[136:139], a[100:103], a[4:7], v[136:139]
  v_mfma_f32_16x16x32_bf16 v[140:143], a[36:39], a[4:7], v[140:143]
  v_mfma_f32_16x16x32_bf16 v[144:147], a[100:103], a[20:23], v[144:147]
  v_mfma_f32_16x16x32_bf16 v[148:151], a[36:39], a[20:23], v[148:151]
  v_mfma_f32_16x16x32_bf16 v[152:155], a[52:55], a[20:23], v[152:155]
  v_mfma_f32_16x16x32_bf16 v[136:139], a[104:107], a[8:11], v[136:139]
  v_mfma_f32_16x16x32_bf16 v[140:143], a[40:43], a[8:11], v[140:143]
  v_mfma_f32_16x16x32_bf16 v[144:147], a[104:107], a[24:27], v[144:147]
  v_mfma_f32_16x16x32_bf16 v[148:151], a[40:43], a[24:27], v[148:151]
  v_mfma_f32_16x16x32_bf16 v[152:155], a[56:59], a[24:27], v[152:155]
  v_mfma_f32_16x16x32_bf16 v[136:139], a[108:111], a[12:15], v[136:139]
  v_mfma_f32_16x16x32_bf16 v[140:143], a[44:47], a[12:15], v[140:143]
  v_mfma_f32_16x16x32_bf16 v[144:147], a[108:111], a[28:31], v[144:147]
  v_mfma_f32_16x16x32_bf16 v[148:151], a[44:47], a[28:31], v[148:151]
  v_mfma_f32_16x16x32_bf16 v[152:155], a[60:63], a[28:31], v[152:155]
  s_nop 4
  v_cndmask_b32 v140, v6, v140, s[40:41]
  v_cndmask_b32 v141, v6, v141, s[42:43]
  v_cndmask_b32 v142, v6, v142, s[44:45]
  v_cndmask_b32 v143, v6, v143, s[46:47]
  v_max3_f32 v12, v136, v137, v140
  v_max3_f32 v12, v12, v141, v142
  v_max_f32 v12, v12, v143
  v_mov_b32 v13, v12
  s_nop 1
  v_permlane32_swap_b32 v12, v13
  v_max_f32 v12, v12, v13
  v_mov_b32 v13, v12
  s_nop 1
  v_permlane16_swap_b32 v12, v13
  v_max_f32 v12, v12, v13
  v_mul_f32 v12, s50, v12
  v_fma_f32 v136, v136, s50, -v12
  v_fma_f32 v137, v137, s50, -v12
  v_fma_f32 v140, v140, s50, -v12
  v_fma_f32 v141, v141, s50, -v12
  v_fma_f32 v142, v142, s50, -v12
  v_fma_f32 v143, v143, s50, -v12
  v_exp_f32 v136, v136
  v_exp_f32 v137, v137
  v_exp_f32 v140, v140
  v_exp_f32 v141, v141
  v_exp_f32 v142, v142
  v_exp_f32 v143, v143
  v_add_f32 v12, v136, v137
  v_add_f32 v12, v12, v140
  v_add_f32 v12, v12, v141
  v_add_f32 v12, v12, v142
  v_add_f32 v12, v12, v143
  v_mov_b32 v13, v12
  s_nop 1
  v_permlane32_swap_b32 v12, v13
  v_add_f32 v12, v12, v13
  v_mov_b32 v13, v12
  s_nop 1
  v_permlane16_swap_b32 v12, v13
  v_add_f32 v12, v12, v13
  v_rcp_f32 v12, v12
  s_nop 0
  v_mul_f32 v136, v136, v12
  v_mul_f32 v137, v137, v12
  v_mul_f32 v140, v140, v12
  v_mul_f32 v141, v141, v12
  v_mul_f32 v142, v142, v12
  v_mul_f32 v143, v143, v12
  v_cvt_pk_bf16_f32 v160, v136, v137
  v_mov_b32 v161, 0
  v_mov_b32 v162, 0
  v_mov_b32 v163, v160
  v_cvt_pk_bf16_f32 v156, v140, v141
  v_cvt_pk_bf16_f32 v157, v142, v143
  v_mov_b32 v158, 0
  v_mov_b32 v159, 0
  v_cndmask_b32 v152, v6, v152, s[40:41]
  v_cndmask_b32 v153, v6, v153, s[42:43]
  v_cndmask_b32 v154, v6, v154, s[44:45]
  v_cndmask_b32 v155, v6, v155, s[46:47]
  v_max3_f32 v12, v144, v145, v148
  v_max3_f32 v12, v12, v149, v150
  v_max3_f32 v12, v12, v151, v152
  v_max3_f32 v12, v12, v153, v154
  v_max_f32 v12, v12, v155
  v_mov_b32 v13, v12
  s_nop 1
  v_permlane32_swap_b32 v12, v13
  v_max_f32 v12, v12, v13
  v_mov_b32 v13, v12
  s_nop 1
  v_permlane16_swap_b32 v12, v13
  v_max_f32 v12, v12, v13
  v_mul_f32 v12, s50, v12
  v_fma_f32 v144, v144, s50, -v12
  v_fma_f32 v145, v145, s50, -v12
  v_fma_f32 v148, v148, s50, -v12
  v_fma_f32 v149, v149, s50, -v12
  v_fma_f32 v150, v150, s50, -v12
  v_fma_f32 v151, v151, s50, -v12
  v_fma_f32 v152, v152, s50, -v12
  v_fma_f32 v153, v153, s50, -v12
  v_fma_f32 v154, v154, s50, -v12
  v_fma_f32 v155, v155, s50, -v12
  v_exp_f32 v144, v144
  v_exp_f32 v145, v145
  v_exp_f32 v148, v148
  v_exp_f32 v149, v149
  v_exp_f32 v150, v150
  v_exp_f32 v151, v151
  v_exp_f32 v152, v152
  v_exp_f32 v153, v153
  v_exp_f32 v154, v154
  v_exp_f32 v155, v155
  v_add_f32 v12, v144, v145
  v_add_f32 v12, v12, v148
  v_add_f32 v12, v12, v149
  v_add_f32 v12, v12, v150
  v_add_f32 v12, v12, v151
  v_add_f32 v12, v12, v152
  v_add_f32 v12, v12, v153
  v_add_f32 v12, v12, v154
  v_add_f32 v12, v12, v155
  v_mov_b32 v13, v12
  s_nop 1
  v_permlane32_swap_b32 v12, v13
  v_add_f32 v12, v12, v13
  v_mov_b32 v13, v12
  s_nop 1
  v_permlane16_swap_b32 v12, v13
  v_add_f32 v12, v12, v13
  v_rcp_f32 v12, v12
  s_nop 0
  v_mul_f32 v144, v144, v12
  v_mul_f32 v145, v145, v12
  v_mul_f32 v148, v148, v12
  v_mul_f32 v149, v149, v12
  v_mul_f32 v150, v150, v12
  v_mul_f32 v151, v151, v12
  v_mul_f32 v152, v152, v12
  v_mul_f32 v153, v153, v12
  v_mul_f32 v154, v154, v12
  v_mul_f32 v155, v155, v12
  v_cvt_pk_bf16_f32 v168, v144, v145
  v_mov_b32 v169, 0
  v_mov_b32 v170, 0
  v_mov_b32 v171, v168
  v_cvt_pk_bf16_f32 v164, v148, v149
  v_cvt_pk_bf16_f32 v165, v150, v151
  v_cvt_pk_bf16_f32 v166, v152, v153
  v_cvt_pk_bf16_f32 v167, v154, v155
  v_mfma_f32_16x16x32_bf16 v[176:179], a[64:67], v[156:159], 0
  v_mfma_f32_16x16x32_bf16 v[180:183], a[68:71], v[156:159], 0
  v_mfma_f32_16x16x32_bf16 v[184:187], a[72:75], v[156:159], 0
  v_mfma_f32_16x16x32_bf16 v[188:191], a[76:79], v[156:159], 0
  v_mfma_f32_16x16x32_bf16 v[192:195], a[80:83], v[156:159], 0
  v_mfma_f32_16x16x32_bf16 v[196:199], a[84:87], v[156:159], 0
  v_mfma_f32_16x16x32_bf16 v[200:203], a[88:91], v[156:159], 0
  v_mfma_f32_16x16x32_bf16 v[204:207], a[92:95], v[156:159], 0
  v_mfma_f32_16x16x16_bf16 v[176:179], a[112:113], v[160:161], v[176:179]
  v_mfma_f32_16x16x16_bf16 v[180:183], a[112:113], v[162:163], v[180:183]
  v_mfma_f32_16x16x16_bf16 v[184:187], a[114:115], v[160:161], v[184:187]
  v_mfma_f32_16x16x16_bf16 v[188:191], a[114:115], v[162:163], v[188:191]
  v_mfma_f32_16x16x16_bf16 v[192:195], a[116:117], v[160:161], v[192:195]
  v_mfma_f32_16x16x16_bf16 v[196:199], a[116:117], v[162:163], v[196:199]
  v_mfma_f32_16x16x16_bf16 v[200:203], a[118:119], v[160:161], v[200:203]
  v_mfma_f32_16x16x16_bf16 v[204:207], a[118:119], v[162:163], v[204:207]
  v_mfma_f32_16x16x32_bf16 v[208:211], a[64:67], v[164:167], 0
  v_mfma_f32_16x16x32_bf16 v[212:215], a[68:71], v[164:167], 0
  v_mfma_f32_16x16x32_bf16 v[216:219], a[72:75], v[164:167], 0
  v_mfma_f32_16x16x32_bf16 v[220:223], a[76:79], v[164:167], 0
  v_mfma_f32_16x16x32_bf16 v[224:227], a[80:83], v[164:167], 0
  v_mfma_f32_16x16x32_bf16 v[228:231], a[84:87], v[164:167], 0
  v_mfma_f32_16x16x32_bf16 v[232:235], a[88:91], v[164:167], 0
  v_mfma_f32_16x16x32_bf16 v[236:239], a[92:95], v[164:167], 0
  v_mfma_f32_16x16x16_bf16 v[208:211], a[112:113], v[168:169], v[208:211]
  v_mfma_f32_16x16x16_bf16 v[212:215], a[112:113], v[170:171], v[212:215]
  v_mfma_f32_16x16x16_bf16 v[216:219], a[114:115], v[168:169], v[216:219]
  v_mfma_f32_16x16x16_bf16 v[220:223], a[114:115], v[170:171], v[220:223]
  v_mfma_f32_16x16x16_bf16 v[224:227], a[116:117], v[168:169], v[224:227]
  v_mfma_f32_16x16x16_bf16 v[228:231], a[116:117], v[170:171], v[228:231]
  v_mfma_f32_16x16x16_bf16 v[232:235], a[118:119], v[168:169], v[232:235]
  v_mfma_f32_16x16x16_bf16 v[236:239], a[118:119], v[170:171], v[236:239]
  v_cvt_pk_bf16_f32 v136, v176, v177
  v_cvt_pk_bf16_f32 v137, v178, v179
  v_cvt_pk_bf16_f32 v138, v184, v185
  v_cvt_pk_bf16_f32 v139, v186, v187
  buffer_store_dwordx4 v[136:139], v10, s[4:7], s95 offen offset:0 sc1
  v_cvt_pk_bf16_f32 v140, v180, v181
  v_cvt_pk_bf16_f32 v141, v182, v183
  v_cvt_pk_bf16_f32 v142, v188, v189
  v_cvt_pk_bf16_f32 v143, v190, v191
  buffer_store_dwordx4 v[140:143], v10, s[4:7], s95 offen offset:512 sc1
  v_cvt_pk_bf16_f32 v144, v192, v193
  v_cvt_pk_bf16_f32 v145, v194, v195
  v_cvt_pk_bf16_f32 v146, v200, v201
  v_cvt_pk_bf16_f32 v147, v202, v203
  buffer_store_dwordx4 v[144:147], v10, s[4:7], s95 offen offset:2048 sc1
  v_cvt_pk_bf16_f32 v148, v196, v197
  v_cvt_pk_bf16_f32 v149, v198, v199
  v_cvt_pk_bf16_f32 v150, v204, v205
  v_cvt_pk_bf16_f32 v151, v206, v207
  buffer_store_dwordx4 v[148:151], v10, s[4:7], s95 offen offset:2560 sc1
  v_cvt_pk_bf16_f32 v136, v208, v209
  v_cvt_pk_bf16_f32 v137, v210, v211
  v_cvt_pk_bf16_f32 v138, v216, v217
  v_cvt_pk_bf16_f32 v139, v218, v219
  buffer_store_dwordx4 v[136:139], v11, s[4:7], s95 offen offset:0 sc1
  v_cvt_pk_bf16_f32 v140, v212, v213
  v_cvt_pk_bf16_f32 v141, v214, v215
  v_cvt_pk_bf16_f32 v142, v220, v221
  v_cvt_pk_bf16_f32 v143, v222, v223
  buffer_store_dwordx4 v[140:143], v11, s[4:7], s95 offen offset:512 sc1
  v_cvt_pk_bf16_f32 v144, v224, v225
  v_cvt_pk_bf16_f32 v145, v226, v227
  v_cvt_pk_bf16_f32 v146, v232, v233
  v_cvt_pk_bf16_f32 v147, v234, v235
  buffer_store_dwordx4 v[144:147], v11, s[4:7], s95 offen offset:2048 sc1
  v_cvt_pk_bf16_f32 v148, v228, v229
  v_cvt_pk_bf16_f32 v149, v230, v231
  v_cvt_pk_bf16_f32 v150, v236, v237
  v_cvt_pk_bf16_f32 v151, v238, v239
  buffer_store_dwordx4 v[148:151], v11, s[4:7], s95 offen offset:2560 sc1
  s_add_u32 s95, s95, 262144
  s_branch L_done
L_bo:
  s_lshr_b32 s40, s36, 1
  s_lshl_b32 s40, s40, 7
  s_add_u32 s40, s40, 1024
  s_mov_b32 s41, 16
  s_mov_b32 s12, s82
  s_and_b32 s13, s83, 0xffff
  s_mov_b32 s14, 0x200000
  s_mov_b32 s15, 0x20000
  s_mov_b32 s23, 65536
  s_mov_b32 s25, 4
  s_lshl_b32 s20, s36, 18
  s_add_u32 s20, s20, 0x6000000
  s_mov_b32 s22, 2048
  s_branch L_g3
L_aos:
  s_mov_b32 s12, s74
  s_and_b32 s13, s75, 0xffff
  s_mov_b32 s14, 0x800000
  s_mov_b32 s15, 0x20000
  s_and_b32 s48, s37, 7
  s_lshr_b32 s37, s37, 3
  s_sub_u32 s40, s36, 12
  s_lshl_b32 s40, s40, 4
  s_add_u32 s40, s40, s48
  s_lshl_b32 s40, s40, 7
  s_add_u32 s40, s40, 20480
  s_mov_b32 s41, 2
  s_add_u32 s42, s40, 1024
  s_mov_b32 s23, 262144
  s_mov_b32 s25, 2
  s_lshl_b32 s20, s36, 20
  s_add_u32 s20, s20, 0x5000000
  s_lshl_b32 s90, s48, 15
  s_add_u32 s20, s20, s90
  s_mov_b32 s22, 0
  s_lshl_b32 s49, s48, 20
  s_branch L_g3b
L_ao4:
  s_lshl_b32 s40, s36, 7
  s_add_u32 s40, s40, 2048
  s_mov_b32 s41, 32
  s_mov_b32 s42, s40
  s_mov_b32 s12, s74
  s_and_b32 s13, s75, 0xffff
  s_mov_b32 s14, 0x800000
  s_mov_b32 s15, 0x20000
  s_and_b32 s48, s37, 3
  s_lshr_b32 s37, s37, 2
  s_mov_b32 s23, 262144
  s_mov_b32 s25, 4
  s_lshl_b32 s20, s36, 20
  s_add_u32 s20, s20, 0x5000000
  s_lshl_b32 s90, s48, 16
  s_add_u32 s20, s20, s90
  s_mov_b32 s22, 0
  s_lshl_b32 s49, s48, 21
  s_branch L_g3b
L_ao:
  s_lshl_b32 s40, s36, 7
  s_add_u32 s40, s40, 2048
  s_mov_b32 s41, 32
  s_mov_b32 s12, s74
  s_and_b32 s13, s75, 0xffff
  s_mov_b32 s14, 0x800000
  s_mov_b32 s15, 0x20000
  s_mov_b32 s23, 262144
  s_mov_b32 s25, 16
  s_lshl_b32 s20, s36, 20
  s_add_u32 s20, s20, 0x5000000
  s_mov_b32 s22, 0
L_g3:
  s_mov_b32 s49, 0
  s_cmp_eq_u32 s35, 16
  s_cselect_b32 s42, 128, 0
  s_add_u32 s42, s42, s40
L_g3b:
  s_mov_b32 s8, s4
  s_and_b32 s9, s5, 0xffff
  s_mov_b32 s10, 0x10000000
  s_mov_b32 s11, 0x20000
  s_lshl_b32 s91, s33, 1
  s_add_u32 s91, s91, s37
  s_mov_b32 s24, 2048
  s_mov_b32 s26, 4096
  s_lshl_b32 s21, s91, 8
  s_add_u32 s22, s22, s21
  s_lshl_b32 s90, s36, 19
  s_add_u32 s22, s22, s90
  s_add_u32 s21, s21, s49
  s_mov_b32 s50, s91
  s_cmp_lt_u32 s35, 16
  s_cbranch_scc1 L_g3c
  s_cmp_eq_u32 s35, 16
  s_cselect_b32 s25, 21, 5
  s_mov_b32 s48, 2048
  v_and_b32 v1, 63, v0
  v_lshrrev_b32 v23, 6, v0
  s_nop 0
  v_readfirstlane_b32 s27, v23
  s_mul_i32 s90, s27, 2
  s_mul_i32 s90, s90, s23
  v_mov_b32 v2, 0x0
  v_bfe_u32 v24, v1, 0, 6
  v_lshl_add_u32 v2, v24, 4, v2
  v_add_u32 v2, s90, v2
  v_mov_b32 v3, 0x400
  v_bfe_u32 v24, v1, 0, 6
  v_lshl_add_u32 v3, v24, 4, v3
  v_add_u32 v3, s90, v3
  v_mov_b32 v4, 0x1000
  v_bfe_u32 v24, v1, 0, 6
  v_lshl_add_u32 v4, v24, 4, v4
  v_add_u32 v4, s90, v4
  v_mov_b32 v5, 0x1400
  v_bfe_u32 v24, v1, 0, 6
  v_lshl_add_u32 v5, v24, 4, v5
  v_add_u32 v5, s90, v5
  s_add_u32 s90, s90, s23
  v_mov_b32 v6, 0x0
  v_bfe_u32 v24, v1, 0, 6
  v_lshl_add_u32 v6, v24, 4, v6
  v_add_u32 v6, s90, v6
  v_mov_b32 v7, 0x400
  v_bfe_u32 v24, v1, 0, 6
  v_lshl_add_u32 v7, v24, 4, v7
  v_add_u32 v7, s90, v7
  v_mov_b32 v8, 0x1000
  v_bfe_u32 v24, v1, 0, 6
  v_lshl_add_u32 v8, v24, 4, v8
  v_add_u32 v8, s90, v8
  v_mov_b32 v9, 0x1400
  v_bfe_u32 v24, v1, 0, 6
  v_lshl_add_u32 v9, v24, 4, v9
  v_add_u32 v9, s90, v9
  s_mul_i32 s90, s27, 16
  v_lshrrev_b32 v23, 4, v1
  v_add_u32 v23, 0, v23
  v_add_u32 v23, s90, v23
  v_and_b32 v24, 7, v23
  v_lshlrev_b32 v24, 1, v24
  v_xor_b32 v24, v24, v1
  v_and_b32 v24, 15, v24
  v_mul_lo_u32 v23, v23, s24
  v_lshl_add_u32 v10, v24, 4, v23
  v_lshrrev_b32 v23, 4, v1
  v_add_u32 v23, 4, v23
  v_add_u32 v23, s90, v23
  v_and_b32 v24, 7, v23
  v_lshlrev_b32 v24, 1, v24
  v_xor_b32 v24, v24, v1
  v_and_b32 v24, 15, v24
  v_mul_lo_u32 v23, v23, s24
  v_lshl_add_u32 v11, v24, 4, v23
  v_lshrrev_b32 v23, 4, v1
  v_add_u32 v23, 8, v23
  v_add_u32 v23, s90, v23
  v_and_b32 v24, 7, v23
  v_lshlrev_b32 v24, 1, v24
  v_xor_b32 v24, v24, v1
  v_and_b32 v24, 15, v24
  v_mul_lo_u32 v23, v23, s24
  v_lshl_add_u32 v12, v24, 4, v23
  v_lshrrev_b32 v23, 4, v1
  v_add_u32 v23, 12, v23
  v_add_u32 v23, s90, v23
  v_and_b32 v24, 7, v23
  v_lshlrev_b32 v24, 1, v24
  v_xor_b32 v24, v24, v1
  v_and_b32 v24, 15, v24
  v_mul_lo_u32 v23, v23, s24
  v_lshl_add_u32 v13, v24, 4, v23
  s_mul_i32 s51, s24, 64
  s_mul_i32 s52, s27, 8192
  s_mul_i32 s53, s27, 4096
  s_add_u32 s53, s53, 32768
  s_add_u32 m0, s53, 0
  s_nop 0
  buffer_load_dwordx4 v10, s[12:15], s21 offen  lds
  s_add_u32 m0, s53, 1024
  s_nop 0
  buffer_load_dwordx4 v11, s[12:15], s21 offen  lds
  s_add_u32 m0, s53, 2048
  s_nop 0
  buffer_load_dwordx4 v12, s[12:15], s21 offen  lds
  s_add_u32 m0, s53, 3072
  s_nop 0
  buffer_load_dwordx4 v13, s[12:15], s21 offen  lds
  s_add_u32 s21, s21, s51
  s_add_u32 m0, s53, 49152
  s_nop 0
  buffer_load_dwordx4 v10, s[12:15], s21 offen  lds
  s_add_u32 m0, s53, 50176
  s_nop 0
  buffer_load_dwordx4 v11, s[12:15], s21 offen  lds
  s_add_u32 m0, s53, 51200
  s_nop 0
  buffer_load_dwordx4 v12, s[12:15], s21 offen  lds
  s_add_u32 m0, s53, 52224
  s_nop 0
  buffer_load_dwordx4 v13, s[12:15], s21 offen  lds
  s_add_u32 s21, s21, s51
  s_add_u32 m0, s53, 98304
  s_nop 0
  buffer_load_dwordx4 v10, s[12:15], s21 offen  lds
  s_add_u32 m0, s53, 99328
  s_nop 0
  buffer_load_dwordx4 v11, s[12:15], s21 offen  lds
  s_add_u32 m0, s53, 100352
  s_nop 0
  buffer_load_dwordx4 v12, s[12:15], s21 offen  lds
  s_add_u32 m0, s53, 101376
  s_nop 0
  buffer_load_dwordx4 v13, s[12:15], s21 offen  lds
  s_add_u32 s21, s21, s51
  s_cmp_lg_u32 s32, 0
  s_cbranch_scc1 L_dd_100
  v_mov_b32 v228, 0x3d00000
L_dw_99:
  buffer_load_dword v234, v228, s[4:7], s40 offen offset:0 sc1
  buffer_load_dword v235, v228, s[4:7], s42 offen offset:0 sc1
  s_waitcnt vmcnt(0)
  s_mov_b32 s44, 1
  v_readfirstlane_b32 s45, v234
  s_cmp_ge_u32 s45, s41
  s_cselect_b32 s44, s44, 0
  v_readfirstlane_b32 s45, v235
  s_cmp_ge_u32 s45, s41
  s_cselect_b32 s44, s44, 0
  s_cmp_eq_u32 s44, 1
  s_cbranch_scc1 L_dd_100
  s_sleep 3
  s_add_u32 s3, s3, 1
  s_cmp_lt_u32 s3, 131072
  s_cbranch_scc1 L_dw_99
L_dd_100:
  s_barrier
  s_add_u32 m0, s52, 0
  s_nop 0
  buffer_load_dwordx4 v2, s[8:11], s20 offen sc1 lds
  s_add_u32 m0, s52, 1024
  s_nop 0
  buffer_load_dwordx4 v3, s[8:11], s20 offen sc1 lds
  s_add_u32 m0, s52, 2048
  s_nop 0
  buffer_load_dwordx4 v4, s[8:11], s20 offen sc1 lds
  s_add_u32 m0, s52, 3072
  s_nop 0
  buffer_load_dwordx4 v5, s[8:11], s20 offen sc1 lds
  s_add_u32 m0, s52, 4096
  s_nop 0
  buffer_load_dwordx4 v6, s[8:11], s20 offen sc1 lds
  s_add_u32 m0, s52, 5120
  s_nop 0
  buffer_load_dwordx4 v7, s[8:11], s20 offen sc1 lds
  s_add_u32 m0, s52, 6144
  s_nop 0
  buffer_load_dwordx4 v8, s[8:11], s20 offen sc1 lds
  s_add_u32 m0, s52, 7168
  s_nop 0
  buffer_load_dwordx4 v9, s[8:11], s20 offen sc1 lds
  s_add_u32 s20, s20, s48
  s_xor_b32 s48, s48, 4096
  s_add_u32 m0, s52, 49152
  s_nop 0
  buffer_load_dwordx4 v2, s[8:11], s20 offen sc1 lds
  s_add_u32 m0, s52, 50176
  s_nop 0
  buffer_load_dwordx4 v3, s[8:11], s20 offen sc1 lds
  s_add_u32 m0, s52, 51200
  s_nop 0
  buffer_load_dwordx4 v4, s[8:11], s20 offen sc1 lds
  s_add_u32 m0, s52, 52224
  s_nop 0
  buffer_load_dwordx4 v5, s[8:11], s20 offen sc1 lds
  s_add_u32 m0, s52, 53248
  s_nop 0
  buffer_load_dwordx4 v6, s[8:11], s20 offen sc1 lds
  s_add_u32 m0, s52, 54272
  s_nop 0
  buffer_load_dwordx4 v7, s[8:11], s20 offen sc1 lds
  s_add_u32 m0, s52, 55296
  s_nop 0
  buffer_load_dwordx4 v8, s[8:11], s20 offen sc1 lds
  s_add_u32 m0, s52, 56320
  s_nop 0
  buffer_load_dwordx4 v9, s[8:11], s20 offen sc1 lds
  s_add_u32 s20, s20, s48
  s_xor_b32 s48, s48, 4096
  s_add_u32 m0, s52, 98304
  s_nop 0
  buffer_load_dwordx4 v2, s[8:11], s20 offen sc1 lds
  s_add_u32 m0, s52, 99328
  s_nop 0
  buffer_load_dwordx4 v3, s[8:11], s20 offen sc1 lds
  s_add_u32 m0, s52, 100352
  s_nop 0
  buffer_load_dwordx4 v4, s[8:11], s20 offen sc1 lds
  s_add_u32 m0, s52, 101376
  s_nop 0
  buffer_load_dwordx4 v5, s[8:11], s20 offen sc1 lds
  s_add_u32 m0, s52, 102400
  s_nop 0
  buffer_load_dwordx4 v6, s[8:11], s20 offen sc1 lds
  s_add_u32 m0, s52, 103424
  s_nop 0
  buffer_load_dwordx4 v7, s[8:11], s20 offen sc1 lds
  s_add_u32 m0, s52, 104448
  s_nop 0
  buffer_load_dwordx4 v8, s[8:11], s20 offen sc1 lds
  s_add_u32 m0, s52, 105472
  s_nop 0
  buffer_load_dwordx4 v9, s[8:11], s20 offen sc1 lds
  s_add_u32 s20, s20, s48
  s_xor_b32 s48, s48, 4096
  s_lshr_b32 s90, s27, 1
  s_and_b32 s91, s27, 1
  s_mul_i32 s92, s90, 16384
  v_mov_b32 v14, 0x0
  v_bfe_u32 v24, v1, 0, 6
  v_lshl_add_u32 v14, v24, 4, v14
  v_add_u32 v14, s92, v14
  v_add_u32 v15, 65536, v14
  v_add_u32 v16, 131072, v14
  v_mov_b32 v23, 0x0
  v_bfe_u32 v24, v1, 2, 2
  v_lshl_add_u32 v23, v24, 8, v23
  v_bfe_u32 v24, v1, 4, 2
  v_lshl_add_u32 v23, v24, 10, v23
  v_bfe_u32 v24, v1, 0, 1
  v_lshl_add_u32 v23, v24, 4, v23
  v_bfe_u32 v25, v1, 2, 3
  v_bfe_u32 v24, v1, 1, 1
  v_xor_b32 v25, v25, v24
  s_mul_i32 s92, s91, 4
  s_add_u32 s93, s92, 0
  v_xor_b32 v24, s93, v25
  v_lshl_add_u32 v17, v24, 5, v23
  v_add_u32 v19, 65536, v17
  v_add_u32 v21, 131072, v17
  s_add_u32 s93, s92, 2
  v_xor_b32 v24, s93, v25
  v_lshl_add_u32 v18, v24, 5, v23
  v_add_u32 v20, 65536, v18
  v_add_u32 v22, 131072, v18
  s_waitcnt vmcnt(16)
  s_barrier
  ds_read_b128 v[28:31], v14 offset:0
  ds_read_b64_tr_b16 v[92:93], v17 offset:32768
  ds_read_b64_tr_b16 v[94:95], v17 offset:36864
  ds_read_b128 v[32:35], v14 offset:2048
  ds_read_b64_tr_b16 v[96:97], v17 offset:32776
  ds_read_b64_tr_b16 v[98:99], v17 offset:36872
  ds_read_b128 v[36:39], v14 offset:4096
  ds_read_b64_tr_b16 v[100:101], v18 offset:32768
  ds_read_b64_tr_b16 v[102:103], v18 offset:36864
  ds_read_b128 v[40:43], v14 offset:6144
  ds_read_b64_tr_b16 v[104:105], v18 offset:32776
  ds_read_b64_tr_b16 v[106:107], v18 offset:36872
  ds_read_b128 v[44:47], v14 offset:8192
  ds_read_b128 v[48:51], v14 offset:10240
  ds_read_b128 v[52:55], v14 offset:12288
  ds_read_b128 v[56:59], v14 offset:14336
  s_sub_u32 s25, s25, 1
  s_waitcnt lgkmcnt(0)
  v_mfma_f32_16x16x32_bf16 a[0:3], v[92:95], v[28:31], 0
  ds_read_b128 v[60:63], v14 offset:1024
  v_mfma_f32_16x16x32_bf16 a[4:7], v[96:99], v[28:31], 0
  ds_read_b64_tr_b16 v[108:109], v17 offset:40960
  v_mfma_f32_16x16x32_bf16 a[8:11], v[100:103], v[28:31], 0
  ds_read_b64_tr_b16 v[110:111], v17 offset:45056
  v_mfma_f32_16x16x32_bf16 a[12:15], v[104:107], v[28:31], 0
  ds_read_b128 v[64:67], v14 offset:3072
  v_mfma_f32_16x16x32_bf16 a[16:19], v[92:95], v[32:35], 0
  ds_read_b64_tr_b16 v[112:113], v17 offset:40968
  v_mfma_f32_16x16x32_bf16 a[20:23], v[96:99], v[32:35], 0
  ds_read_b64_tr_b16 v[114:115], v17 offset:45064
  v_mfma_f32_16x16x32_bf16 a[24:27], v[100:103], v[32:35], 0
  ds_read_b128 v[68:71], v14 offset:5120
  v_mfma_f32_16x16x32_bf16 a[28:31], v[104:107], v[32:35], 0
  ds_read_b64_tr_b16 v[116:117], v18 offset:40960
  v_mfma_f32_16x16x32_bf16 a[32:35], v[92:95], v[36:39], 0
  ds_read_b64_tr_b16 v[118:119], v18 offset:45056
  v_mfma_f32_16x16x32_bf16 a[36:39], v[96:99], v[36:39], 0
  ds_read_b128 v[72:75], v14 offset:7168
  v_mfma_f32_16x16x32_bf16 a[40:43], v[100:103], v[36:39], 0
  ds_read_b64_tr_b16 v[120:121], v18 offset:40968
  v_mfma_f32_16x16x32_bf16 a[44:47], v[104:107], v[36:39], 0
  ds_read_b64_tr_b16 v[122:123], v18 offset:45064
  v_mfma_f32_16x16x32_bf16 a[48:51], v[92:95], v[40:43], 0
  ds_read_b128 v[76:79], v14 offset:9216
  v_mfma_f32_16x16x32_bf16 a[52:55], v[96:99], v[40:43], 0
  ds_read_b128 v[80:83], v14 offset:11264
  v_mfma_f32_16x16x32_bf16 a[56:59], v[100:103], v[40:43], 0
  ds_read_b128 v[84:87], v14 offset:13312
  v_mfma_f32_16x16x32_bf16 a[60:63], v[104:107], v[40:43], 0
  ds_read_b128 v[88:91], v14 offset:15360
  v_mfma_f32_16x16x32_bf16 a[64:67], v[92:95], v[44:47], 0
  v_mfma_f32_16x16x32_bf16 a[68:71], v[96:99], v[44:47], 0
  v_mfma_f32_16x16x32_bf16 a[72:75], v[100:103], v[44:47], 0
  v_mfma_f32_16x16x32_bf16 a[76:79], v[104:107], v[44:47], 0
  v_mfma_f32_16x16x32_bf16 a[80:83], v[92:95], v[48:51], 0
  v_mfma_f32_16x16x32_bf16 a[84:87], v[96:99], v[48:51], 0
  v_mfma_f32_16x16x32_bf16 a[88:91], v[100:103], v[48:51], 0
  v_mfma_f32_16x16x32_bf16 a[92:95], v[104:107], v[48:51], 0
  v_mfma_f32_16x16x32_bf16 a[96:99], v[92:95], v[52:55], 0
  v_mfma_f32_16x16x32_bf16 a[100:103], v[96:99], v[52:55], 0
  v_mfma_f32_16x16x32_bf16 a[104:107], v[100:103], v[52:55], 0
  v_mfma_f32_16x16x32_bf16 a[108:111], v[104:107], v[52:55], 0
  v_mfma_f32_16x16x32_bf16 a[112:115], v[92:95], v[56:59], 0
  v_mfma_f32_16x16x32_bf16 a[116:119], v[96:99], v[56:59], 0
  v_mfma_f32_16x16x32_bf16 a[120:123], v[100:103], v[56:59], 0
  v_mfma_f32_16x16x32_bf16 a[124:127], v[104:107], v[56:59], 0
  s_waitcnt lgkmcnt(0)
  v_mfma_f32_16x16x32_bf16 a[0:3], v[108:111], v[60:63], a[0:3]
  s_waitcnt vmcnt(8)
  s_barrier
  s_add_u32 m0, s52, 0
  v_mfma_f32_16x16x32_bf16 a[4:7], v[112:115], v[60:63], a[4:7]
  buffer_load_dwordx4 v2, s[8:11], s20 offen sc1 lds
  ds_read_b128 v[28:31], v14 offset:49152
  v_mfma_f32_16x16x32_bf16 a[8:11], v[116:119], v[60:63], a[8:11]
  ds_read_b64_tr_b16 v[92:93], v19 offset:16384
  v_mfma_f32_16x16x32_bf16 a[12:15], v[120:123], v[60:63], a[12:15]
  ds_read_b64_tr_b16 v[94:95], v19 offset:20480
  v_mfma_f32_16x16x32_bf16 a[16:19], v[108:111], v[64:67], a[16:19]
  ds_read_b128 v[32:35], v14 offset:51200
  s_add_u32 m0, s53, 0
  v_mfma_f32_16x16x32_bf16 a[20:23], v[112:115], v[64:67], a[20:23]
  buffer_load_dwordx4 v10, s[12:15], s21 offen  lds
  ds_read_b64_tr_b16 v[96:97], v19 offset:16392
  v_mfma_f32_16x16x32_bf16 a[24:27], v[116:119], v[64:67], a[24:27]
  ds_read_b64_tr_b16 v[98:99], v19 offset:20488
  v_mfma_f32_16x16x32_bf16 a[28:31], v[120:123], v[64:67], a[28:31]
  ds_read_b128 v[36:39], v14 offset:53248
  v_mfma_f32_16x16x32_bf16 a[32:35], v[108:111], v[68:71], a[32:35]
  ds_read_b64_tr_b16 v[100:101], v20 offset:16384
  s_add_u32 m0, s52, 1024
  v_mfma_f32_16x16x32_bf16 a[36:39], v[112:115], v[68:71], a[36:39]
  buffer_load_dwordx4 v3, s[8:11], s20 offen sc1 lds
  ds_read_b64_tr_b16 v[102:103], v20 offset:20480
  v_mfma_f32_16x16x32_bf16 a[40:43], v[116:119], v[68:71], a[40:43]
  ds_read_b128 v[40:43], v14 offset:55296
  v_mfma_f32_16x16x32_bf16 a[44:47], v[120:123], v[68:71], a[44:47]
  ds_read_b64_tr_b16 v[104:105], v20 offset:16392
  v_mfma_f32_16x16x32_bf16 a[48:51], v[108:111], v[72:75], a[48:51]
  ds_read_b64_tr_b16 v[106:107], v20 offset:20488
  v_mfma_f32_16x16x32_bf16 a[52:55], v[112:115], v[72:75], a[52:55]
  ds_read_b128 v[44:47], v14 offset:57344
  s_add_u32 m0, s53, 1024
  v_mfma_f32_16x16x32_bf16 a[56:59], v[116:119], v[72:75], a[56:59]
  buffer_load_dwordx4 v11, s[12:15], s21 offen  lds
  ds_read_b128 v[48:51], v14 offset:59392
  v_mfma_f32_16x16x32_bf16 a[60:63], v[120:123], v[72:75], a[60:63]
  ds_read_b128 v[52:55], v14 offset:61440
  v_mfma_f32_16x16x32_bf16 a[64:67], v[108:111], v[76:79], a[64:67]
  ds_read_b128 v[56:59], v14 offset:63488
  v_mfma_f32_16x16x32_bf16 a[68:71], v[112:115], v[76:79], a[68:71]
  s_add_u32 m0, s52, 2048
  v_mfma_f32_16x16x32_bf16 a[72:75], v[116:119], v[76:79], a[72:75]
  buffer_load_dwordx4 v4, s[8:11], s20 offen sc1 lds
  v_mfma_f32_16x16x32_bf16 a[76:79], v[120:123], v[76:79], a[76:79]
  v_mfma_f32_16x16x32_bf16 a[80:83], v[108:111], v[80:83], a[80:83]
  v_mfma_f32_16x16x32_bf16 a[84:87], v[112:115], v[80:83], a[84:87]
  v_mfma_f32_16x16x32_bf16 a[88:91], v[116:119], v[80:83], a[88:91]
  s_add_u32 m0, s53, 2048
  v_mfma_f32_16x16x32_bf16 a[92:95], v[120:123], v[80:83], a[92:95]
  buffer_load_dwordx4 v12, s[12:15], s21 offen  lds
  v_mfma_f32_16x16x32_bf16 a[96:99], v[108:111], v[84:87], a[96:99]
  v_mfma_f32_16x16x32_bf16 a[100:103], v[112:115], v[84:87], a[100:103]
  v_mfma_f32_16x16x32_bf16 a[104:107], v[116:119], v[84:87], a[104:107]
  s_add_u32 m0, s52, 3072
  v_mfma_f32_16x16x32_bf16 a[108:111], v[120:123], v[84:87], a[108:111]
  buffer_load_dwordx4 v5, s[8:11], s20 offen sc1 lds
  v_mfma_f32_16x16x32_bf16 a[112:115], v[108:111], v[88:91], a[112:115]
  v_mfma_f32_16x16x32_bf16 a[116:119], v[112:115], v[88:91], a[116:119]
  v_mfma_f32_16x16x32_bf16 a[120:123], v[116:119], v[88:91], a[120:123]
  v_mfma_f32_16x16x32_bf16 a[124:127], v[120:123], v[88:91], a[124:127]
  s_waitcnt lgkmcnt(0)
  s_add_u32 m0, s53, 3072
  v_mfma_f32_16x16x32_bf16 a[0:3], v[92:95], v[28:31], a[0:3]
  buffer_load_dwordx4 v13, s[12:15], s21 offen  lds
  ds_read_b128 v[60:63], v14 offset:50176
  v_mfma_f32_16x16x32_bf16 a[4:7], v[96:99], v[28:31], a[4:7]
  ds_read_b64_tr_b16 v[108:109], v19 offset:24576
  v_mfma_f32_16x16x32_bf16 a[8:11], v[100:103], v[28:31], a[8:11]
  ds_read_b64_tr_b16 v[110:111], v19 offset:28672
  v_mfma_f32_16x16x32_bf16 a[12:15], v[104:107], v[28:31], a[12:15]
  ds_read_b128 v[64:67], v14 offset:52224
  v_mfma_f32_16x16x32_bf16 a[16:19], v[92:95], v[32:35], a[16:19]
  ds_read_b64_tr_b16 v[112:113], v19 offset:24584
  s_add_u32 m0, s52, 4096
  v_mfma_f32_16x16x32_bf16 a[20:23], v[96:99], v[32:35], a[20:23]
  buffer_load_dwordx4 v6, s[8:11], s20 offen sc1 lds
  ds_read_b64_tr_b16 v[114:115], v19 offset:28680
  v_mfma_f32_16x16x32_bf16 a[24:27], v[100:103], v[32:35], a[24:27]
  ds_read_b128 v[68:71], v14 offset:54272
  v_mfma_f32_16x16x32_bf16 a[28:31], v[104:107], v[32:35], a[28:31]
  ds_read_b64_tr_b16 v[116:117], v20 offset:24576
  v_mfma_f32_16x16x32_bf16 a[32:35], v[92:95], v[36:39], a[32:35]
  ds_read_b64_tr_b16 v[118:119], v20 offset:28672
  v_mfma_f32_16x16x32_bf16 a[36:39], v[96:99], v[36:39], a[36:39]
  ds_read_b128 v[72:75], v14 offset:56320
  s_add_u32 m0, s52, 5120
  v_mfma_f32_16x16x32_bf16 a[40:43], v[100:103], v[36:39], a[40:43]
  buffer_load_dwordx4 v7, s[8:11], s20 offen sc1 lds
  ds_read_b64_tr_b16 v[120:121], v20 offset:24584
  v_mfma_f32_16x16x32_bf16 a[44:47], v[104:107], v[36:39], a[44:47]
  ds_read_b64_tr_b16 v[122:123], v20 offset:28680
  v_mfma_f32_16x16x32_bf16 a[48:51], v[92:95], v[40:43], a[48:51]
  ds_read_b128 v[76:79], v14 offset:58368
  v_mfma_f32_16x16x32_bf16 a[52:55], v[96:99], v[40:43], a[52:55]
  ds_read_b128 v[80:83], v14 offset:60416
  v_mfma_f32_16x16x32_bf16 a[56:59], v[100:103], v[40:43], a[56:59]
  ds_read_b128 v[84:87], v14 offset:62464
  v_mfma_f32_16x16x32_bf16 a[60:63], v[104:107], v[40:43], a[60:63]
  ds_read_b128 v[88:91], v14 offset:64512
  s_add_u32 m0, s52, 6144
  v_mfma_f32_16x16x32_bf16 a[64:67], v[92:95], v[44:47], a[64:67]
  buffer_load_dwordx4 v8, s[8:11], s20 offen sc1 lds
  v_mfma_f32_16x16x32_bf16 a[68:71], v[96:99], v[44:47], a[68:71]
  v_mfma_f32_16x16x32_bf16 a[72:75], v[100:103], v[44:47], a[72:75]
  v_mfma_f32_16x16x32_bf16 a[76:79], v[104:107], v[44:47], a[76:79]
  v_mfma_f32_16x16x32_bf16 a[80:83], v[92:95], v[48:51], a[80:83]
  s_add_u32 m0, s52, 7168
  v_mfma_f32_16x16x32_bf16 a[84:87], v[96:99], v[48:51], a[84:87]
  buffer_load_dwordx4 v9, s[8:11], s20 offen sc1 lds
  v_mfma_f32_16x16x32_bf16 a[88:91], v[100:103], v[48:51], a[88:91]
  v_mfma_f32_16x16x32_bf16 a[92:95], v[104:107], v[48:51], a[92:95]
  v_mfma_f32_16x16x32_bf16 a[96:99], v[92:95], v[52:55], a[96:99]
  v_mfma_f32_16x16x32_bf16 a[100:103], v[96:99], v[52:55], a[100:103]
  s_add_u32 s20, s20, s48
  s_xor_b32 s48, s48, 4096
  v_mfma_f32_16x16x32_bf16 a[104:107], v[100:103], v[52:55], a[104:107]
  s_add_u32 s21, s21, s51
  v_mfma_f32_16x16x32_bf16 a[108:111], v[104:107], v[52:55], a[108:111]
  v_mfma_f32_16x16x32_bf16 a[112:115], v[92:95], v[56:59], a[112:115]
  v_mfma_f32_16x16x32_bf16 a[116:119], v[96:99], v[56:59], a[116:119]
  v_mfma_f32_16x16x32_bf16 a[120:123], v[100:103], v[56:59], a[120:123]
  v_mfma_f32_16x16x32_bf16 a[124:127], v[104:107], v[56:59], a[124:127]
  s_waitcnt lgkmcnt(0)
  v_mfma_f32_16x16x32_bf16 a[0:3], v[108:111], v[60:63], a[0:3]
  s_waitcnt vmcnt(12)
  s_barrier
  s_add_u32 m0, s52, 49152
  v_mfma_f32_16x16x32_bf16 a[4:7], v[112:115], v[60:63], a[4:7]
  buffer_load_dwordx4 v2, s[8:11], s20 offen sc1 lds
  ds_read_b128 v[28:31], v15 offset:32768
  v_mfma_f32_16x16x32_bf16 a[8:11], v[116:119], v[60:63], a[8:11]
  ds_read_b64_tr_b16 v[92:93], v21 offset:0
  v_mfma_f32_16x16x32_bf16 a[12:15], v[120:123], v[60:63], a[12:15]
  ds_read_b64_tr_b16 v[94:95], v21 offset:4096
  v_mfma_f32_16x16x32_bf16 a[16:19], v[108:111], v[64:67], a[16:19]
  ds_read_b128 v[32:35], v15 offset:34816
  s_add_u32 m0, s53, 49152
  v_mfma_f32_16x16x32_bf16 a[20:23], v[112:115], v[64:67], a[20:23]
  buffer_load_dwordx4 v10, s[12:15], s21 offen  lds
  ds_read_b64_tr_b16 v[96:97], v21 offset:8
  v_mfma_f32_16x16x32_bf16 a[24:27], v[116:119], v[64:67], a[24:27]
  ds_read_b64_tr_b16 v[98:99], v21 offset:4104
  v_mfma_f32_16x16x32_bf16 a[28:31], v[120:123], v[64:67], a[28:31]
  ds_read_b128 v[36:39], v15 offset:36864
  v_mfma_f32_16x16x32_bf16 a[32:35], v[108:111], v[68:71], a[32:35]
  ds_read_b64_tr_b16 v[100:101], v22 offset:0
  s_add_u32 m0, s52, 50176
  v_mfma_f32_16x16x32_bf16 a[36:39], v[112:115], v[68:71], a[36:39]
  buffer_load_dwordx4 v3, s[8:11], s20 offen sc1 lds
  ds_read_b64_tr_b16 v[102:103], v22 offset:4096
  v_mfma_f32_16x16x32_bf16 a[40:43], v[116:119], v[68:71], a[40:43]
  ds_read_b128 v[40:43], v15 offset:38912
  v_mfma_f32_16x16x32_bf16 a[44:47], v[120:123], v[68:71], a[44:47]
  ds_read_b64_tr_b16 v[104:105], v22 offset:8
  v_mfma_f32_16x16x32_bf16 a[48:51], v[108:111], v[72:75], a[48:51]
  ds_read_b64_tr_b16 v[106:107], v22 offset:4104
  v_mfma_f32_16x16x32_bf16 a[52:55], v[112:115], v[72:75], a[52:55]
  ds_read_b128 v[44:47], v15 offset:40960
  s_add_u32 m0, s53, 50176
  v_mfma_f32_16x16x32_bf16 a[56:59], v[116:119], v[72:75], a[56:59]
  buffer_load_dwordx4 v11, s[12:15], s21 offen  lds
  ds_read_b128 v[48:51], v15 offset:43008
  v_mfma_f32_16x16x32_bf16 a[60:63], v[120:123], v[72:75], a[60:63]
  ds_read_b128 v[52:55], v15 offset:45056
  v_mfma_f32_16x16x32_bf16 a[64:67], v[108:111], v[76:79], a[64:67]
  ds_read_b128 v[56:59], v15 offset:47104
  v_mfma_f32_16x16x32_bf16 a[68:71], v[112:115], v[76:79], a[68:71]
  s_add_u32 m0, s52, 51200
  v_mfma_f32_16x16x32_bf16 a[72:75], v[116:119], v[76:79], a[72:75]
  buffer_load_dwordx4 v4, s[8:11], s20 offen sc1 lds
  v_mfma_f32_16x16x32_bf16 a[76:79], v[120:123], v[76:79], a[76:79]
  v_mfma_f32_16x16x32_bf16 a[80:83], v[108:111], v[80:83], a[80:83]
  v_mfma_f32_16x16x32_bf16 a[84:87], v[112:115], v[80:83], a[84:87]
  v_mfma_f32_16x16x32_bf16 a[88:91], v[116:119], v[80:83], a[88:91]
  s_add_u32 m0, s53, 51200
  v_mfma_f32_16x16x32_bf16 a[92:95], v[120:123], v[80:83], a[92:95]
  buffer_load_dwordx4 v12, s[12:15], s21 offen  lds
  v_mfma_f32_16x16x32_bf16 a[96:99], v[108:111], v[84:87], a[96:99]
  v_mfma_f32_16x16x32_bf16 a[100:103], v[112:115], v[84:87], a[100:103]
  v_mfma_f32_16x16x32_bf16 a[104:107], v[116:119], v[84:87], a[104:107]
  s_add_u32 m0, s52, 52224
  v_mfma_f32_16x16x32_bf16 a[108:111], v[120:123], v[84:87], a[108:111]
  buffer_load_dwordx4 v5, s[8:11], s20 offen sc1 lds
  v_mfma_f32_16x16x32_bf16 a[112:115], v[108:111], v[88:91], a[112:115]
  v_mfma_f32_16x16x32_bf16 a[116:119], v[112:115], v[88:91], a[116:119]
  v_mfma_f32_16x16x32_bf16 a[120:123], v[116:119], v[88:91], a[120:123]
  v_mfma_f32_16x16x32_bf16 a[124:127], v[120:123], v[88:91], a[124:127]
  s_waitcnt lgkmcnt(0)
  s_add_u32 m0, s53, 52224
  v_mfma_f32_16x16x32_bf16 a[0:3], v[92:95], v[28:31], a[0:3]
  buffer_load_dwordx4 v13, s[12:15], s21 offen  lds
  ds_read_b128 v[60:63], v15 offset:33792
  v_mfma_f32_16x16x32_bf16 a[4:7], v[96:99], v[28:31], a[4:7]
  ds_read_b64_tr_b16 v[108:109], v21 offset:8192
  v_mfma_f32_16x16x32_bf16 a[8:11], v[100:103], v[28:31], a[8:11]
  ds_read_b64_tr_b16 v[110:111], v21 offset:12288
  v_mfma_f32_16x16x32_bf16 a[12:15], v[104:107], v[28:31], a[12:15]
  ds_read_b128 v[64:67], v15 offset:35840
  v_mfma_f32_16x16x32_bf16 a[16:19], v[92:95], v[32:35], a[16:19]
  ds_read_b64_tr_b16 v[112:113], v21 offset:8200
  s_add_u32 m0, s52, 53248
  v_mfma_f32_16x16x32_bf16 a[20:23], v[96:99], v[32:35], a[20:23]
  buffer_load_dwordx4 v6, s[8:11], s20 offen sc1 lds
  ds_read_b64_tr_b16 v[114:115], v21 offset:12296
  v_mfma_f32_16x16x32_bf16 a[24:27], v[100:103], v[32:35], a[24:27]
  ds_read_b128 v[68:71], v15 offset:37888
  v_mfma_f32_16x16x32_bf16 a[28:31], v[104:107], v[32:35], a[28:31]
  ds_read_b64_tr_b16 v[116:117], v22 offset:8192
  v_mfma_f32_16x16x32_bf16 a[32:35], v[92:95], v[36:39], a[32:35]
  ds_read_b64_tr_b16 v[118:119], v22 offset:12288
  v_mfma_f32_16x16x32_bf16 a[36:39], v[96:99], v[36:39], a[36:39]
  ds_read_b128 v[72:75], v15 offset:39936
  s_add_u32 m0, s52, 54272
  v_mfma_f32_16x16x32_bf16 a[40:43], v[100:103], v[36:39], a[40:43]
  buffer_load_dwordx4 v7, s[8:11], s20 offen sc1 lds
  ds_read_b64_tr_b16 v[120:121], v22 offset:8200
  v_mfma_f32_16x16x32_bf16 a[44:47], v[104:107], v[36:39], a[44:47]
  ds_read_b64_tr_b16 v[122:123], v22 offset:12296
  v_mfma_f32_16x16x32_bf16 a[48:51], v[92:95], v[40:43], a[48:51]
  ds_read_b128 v[76:79], v15 offset:41984
  v_mfma_f32_16x16x32_bf16 a[52:55], v[96:99], v[40:43], a[52:55]
  ds_read_b128 v[80:83], v15 offset:44032
  v_mfma_f32_16x16x32_bf16 a[56:59], v[100:103], v[40:43], a[56:59]
  ds_read_b128 v[84:87], v15 offset:46080
  v_mfma_f32_16x16x32_bf16 a[60:63], v[104:107], v[40:43], a[60:63]
  ds_read_b128 v[88:91], v15 offset:48128
  s_add_u32 m0, s52, 55296
  v_mfma_f32_16x16x32_bf16 a[64:67], v[92:95], v[44:47], a[64:67]
  buffer_load_dwordx4 v8, s[8:11], s20 offen sc1 lds
  v_mfma_f32_16x16x32_bf16 a[68:71], v[96:99], v[44:47], a[68:71]
  v_mfma_f32_16x16x32_bf16 a[72:75], v[100:103], v[44:47], a[72:75]
  v_mfma_f32_16x16x32_bf16 a[76:79], v[104:107], v[44:47], a[76:79]
  v_mfma_f32_16x16x32_bf16 a[80:83], v[92:95], v[48:51], a[80:83]
  s_add_u32 m0, s52, 56320
  v_mfma_f32_16x16x32_bf16 a[84:87], v[96:99], v[48:51], a[84:87]
  buffer_load_dwordx4 v9, s[8:11], s20 offen sc1 lds
  v_mfma_f32_16x16x32_bf16 a[88:91], v[100:103], v[48:51], a[88:91]
  v_mfma_f32_16x16x32_bf16 a[92:95], v[104:107], v[48:51], a[92:95]
  v_mfma_f32_16x16x32_bf16 a[96:99], v[92:95], v[52:55], a[96:99]
  v_mfma_f32_16x16x32_bf16 a[100:103], v[96:99], v[52:55], a[100:103]
  s_add_u32 s20, s20, s48
  s_xor_b32 s48, s48, 4096
  v_mfma_f32_16x16x32_bf16 a[104:107], v[100:103], v[52:55], a[104:107]
  s_add_u32 s21, s21, s51
  v_mfma_f32_16x16x32_bf16 a[108:111], v[104:107], v[52:55], a[108:111]
  v_mfma_f32_16x16x32_bf16 a[112:115], v[92:95], v[56:59], a[112:115]
  v_mfma_f32_16x16x32_bf16 a[116:119], v[96:99], v[56:59], a[116:119]
  v_mfma_f32_16x16x32_bf16 a[120:123], v[100:103], v[56:59], a[120:123]
  v_mfma_f32_16x16x32_bf16 a[124:127], v[104:107], v[56:59], a[124:127]
  s_waitcnt lgkmcnt(0)
  v_mfma_f32_16x16x32_bf16 a[0:3], v[108:111], v[60:63], a[0:3]
  s_waitcnt vmcnt(12)
  s_barrier
  s_add_u32 m0, s52, 98304
  v_mfma_f32_16x16x32_bf16 a[4:7], v[112:115], v[60:63], a[4:7]
  buffer_load_dwordx4 v2, s[8:11], s20 offen sc1 lds
  ds_read_b128 v[28:31], v14 offset:0
  v_mfma_f32_16x16x32_bf16 a[8:11], v[116:119], v[60:63], a[8:11]
  ds_read_b64_tr_b16 v[92:93], v17 offset:32768
  v_mfma_f32_16x16x32_bf16 a[12:15], v[120:123], v[60:63], a[12:15]
  ds_read_b64_tr_b16 v[94:95], v17 offset:36864
  v_mfma_f32_16x16x32_bf16 a[16:19], v[108:111], v[64:67], a[16:19]
  ds_read_b128 v[32:35], v14 offset:2048
  s_add_u32 m0, s53, 98304
  v_mfma_f32_16x16x32_bf16 a[20:23], v[112:115], v[64:67], a[20:23]
  buffer_load_dwordx4 v10, s[12:15], s21 offen  lds
  ds_read_b64_tr_b16 v[96:97], v17 offset:32776
  v_mfma_f32_16x16x32_bf16 a[24:27], v[116:119], v[64:67], a[24:27]
  ds_read_b64_tr_b16 v[98:99], v17 offset:36872
  v_mfma_f32_16x16x32_bf16 a[28:31], v[120:123], v[64:67], a[28:31]
  ds_read_b128 v[36:39], v14 offset:4096
  v_mfma_f32_16x16x32_bf16 a[32:35], v[108:111], v[68:71], a[32:35]
  ds_read_b64_tr_b16 v[100:101], v18 offset:32768
  s_add_u32 m0, s52, 99328
  v_mfma_f32_16x16x32_bf16 a[36:39], v[112:115], v[68:71], a[36:39]
  buffer_load_dwordx4 v3, s[8:11], s20 offen sc1 lds
  ds_read_b64_tr_b16 v[102:103], v18 offset:36864
  v_mfma_f32_16x16x32_bf16 a[40:43], v[116:119], v[68:71], a[40:43]
  ds_read_b128 v[40:43], v14 offset:6144
  v_mfma_f32_16x16x32_bf16 a[44:47], v[120:123], v[68:71], a[44:47]
  ds_read_b64_tr_b16 v[104:105], v18 offset:32776
  v_mfma_f32_16x16x32_bf16 a[48:51], v[108:111], v[72:75], a[48:51]
  ds_read_b64_tr_b16 v[106:107], v18 offset:36872
  v_mfma_f32_16x16x32_bf16 a[52:55], v[112:115], v[72:75], a[52:55]
  ds_read_b128 v[44:47], v14 offset:8192
  s_add_u32 m0, s53, 99328
  v_mfma_f32_16x16x32_bf16 a[56:59], v[116:119], v[72:75], a[56:59]
  buffer_load_dwordx4 v11, s[12:15], s21 offen  lds
  ds_read_b128 v[48:51], v14 offset:10240
  v_mfma_f32_16x16x32_bf16 a[60:63], v[120:123], v[72:75], a[60:63]
  ds_read_b128 v[52:55], v14 offset:12288
  v_mfma_f32_16x16x32_bf16 a[64:67], v[108:111], v[76:79], a[64:67]
  ds_read_b128 v[56:59], v14 offset:14336
  v_mfma_f32_16x16x32_bf16 a[68:71], v[112:115], v[76:79], a[68:71]
  s_add_u32 m0, s52, 100352
  v_mfma_f32_16x16x32_bf16 a[72:75], v[116:119], v[76:79], a[72:75]
  buffer_load_dwordx4 v4, s[8:11], s20 offen sc1 lds
  v_mfma_f32_16x16x32_bf16 a[76:79], v[120:123], v[76:79], a[76:79]
  v_mfma_f32_16x16x32_bf16 a[80:83], v[108:111], v[80:83], a[80:83]
  v_mfma_f32_16x16x32_bf16 a[84:87], v[112:115], v[80:83], a[84:87]
  v_mfma_f32_16x16x32_bf16 a[88:91], v[116:119], v[80:83], a[88:91]
  s_add_u32 m0, s53, 100352
  v_mfma_f32_16x16x32_bf16 a[92:95], v[120:123], v[80:83], a[92:95]
  buffer_load_dwordx4 v12, s[12:15], s21 offen  lds
  v_mfma_f32_16x16x32_bf16 a[96:99], v[108:111], v[84:87], a[96:99]
  v_mfma_f32_16x16x32_bf16 a[100:103], v[112:115], v[84:87], a[100:103]
  v_mfma_f32_16x16x32_bf16 a[104:107], v[116:119], v[84:87], a[104:107]
  s_add_u32 m0, s52, 101376
  v_mfma_f32_16x16x32_bf16 a[108:111], v[120:123], v[84:87], a[108:111]
  buffer_load_dwordx4 v5, s[8:11], s20 offen sc1 lds
  v_mfma_f32_16x16x32_bf16 a[112:115], v[108:111], v[88:91], a[112:115]
  v_mfma_f32_16x16x32_bf16 a[116:119], v[112:115], v[88:91], a[116:119]
  v_mfma_f32_16x16x32_bf16 a[120:123], v[116:119], v[88:91], a[120:123]
  v_mfma_f32_16x16x32_bf16 a[124:127], v[120:123], v[88:91], a[124:127]
L_g6_loop:
  s_sub_u32 s25, s25, 1
  s_cmp_eq_u32 s25, 0
  s_cbranch_scc1 L_g6_fin
  s_waitcnt lgkmcnt(0)
  s_add_u32 m0, s53, 101376
  v_mfma_f32_16x16x32_bf16 a[0:3], v[92:95], v[28:31], a[0:3]
  buffer_load_dwordx4 v13, s[12:15], s21 offen  lds
  ds_read_b128 v[60:63], v14 offset:1024
  v_mfma_f32_16x16x32_bf16 a[4:7], v[96:99], v[28:31], a[4:7]
  ds_read_b64_tr_b16 v[108:109], v17 offset:40960
  v_mfma_f32_16x16x32_bf16 a[8:11], v[100:103], v[28:31], a[8:11]
  ds_read_b64_tr_b16 v[110:111], v17 offset:45056
  v_mfma_f32_16x16x32_bf16 a[12:15], v[104:107], v[28:31], a[12:15]
  ds_read_b128 v[64:67], v14 offset:3072
  v_mfma_f32_16x16x32_bf16 a[16:19], v[92:95], v[32:35], a[16:19]
  ds_read_b64_tr_b16 v[112:113], v17 offset:40968
  s_add_u32 m0, s52, 102400
  v_mfma_f32_16x16x32_bf16 a[20:23], v[96:99], v[32:35], a[20:23]
  buffer_load_dwordx4 v6, s[8:11], s20 offen sc1 lds
  ds_read_b64_tr_b16 v[114:115], v17 offset:45064
  v_mfma_f32_16x16x32_bf16 a[24:27], v[100:103], v[32:35], a[24:27]
  ds_read_b128 v[68:71], v14 offset:5120
  v_mfma_f32_16x16x32_bf16 a[28:31], v[104:107], v[32:35], a[28:31]
  ds_read_b64_tr_b16 v[116:117], v18 offset:40960
  v_mfma_f32_16x16x32_bf16 a[32:35], v[92:95], v[36:39], a[32:35]
  ds_read_b64_tr_b16 v[118:119], v18 offset:45056
  v_mfma_f32_16x16x32_bf16 a[36:39], v[96:99], v[36:39], a[36:39]
  ds_read_b128 v[72:75], v14 offset:7168
  s_add_u32 m0, s52, 103424
  v_mfma_f32_16x16x32_bf16 a[40:43], v[100:103], v[36:39], a[40:43]
  buffer_load_dwordx4 v7, s[8:11], s20 offen sc1 lds
  ds_read_b64_tr_b16 v[120:121], v18 offset:40968
  v_mfma_f32_16x16x32_bf16 a[44:47], v[104:107], v[36:39], a[44:47]
  ds_read_b64_tr_b16 v[122:123], v18 offset:45064
  v_mfma_f32_16x16x32_bf16 a[48:51], v[92:95], v[40:43], a[48:51]
  ds_read_b128 v[76:79], v14 offset:9216
  v_mfma_f32_16x16x32_bf16 a[52:55], v[96:99], v[40:43], a[52:55]
  ds_read_b128 v[80:83], v14 offset:11264
  v_mfma_f32_16x16x32_bf16 a[56:59], v[100:103], v[40:43], a[56:59]
  ds_read_b128 v[84:87], v14 offset:13312
  v_mfma_f32_16x16x32_bf16 a[60:63], v[104:107], v[40:43], a[60:63]
  ds_read_b128 v[88:91], v14 offset:15360
  s_add_u32 m0, s52, 104448
  v_mfma_f32_16x16x32_bf16 a[64:67], v[92:95], v[44:47], a[64:67]
  buffer_load_dwordx4 v8, s[8:11], s20 offen sc1 lds
  v_mfma_f32_16x16x32_bf16 a[68:71], v[96:99], v[44:47], a[68:71]
  v_mfma_f32_16x16x32_bf16 a[72:75], v[100:103], v[44:47], a[72:75]
  v_mfma_f32_16x16x32_bf16 a[76:79], v[104:107], v[44:47], a[76:79]
  v_mfma_f32_16x16x32_bf16 a[80:83], v[92:95], v[48:51], a[80:83]
  s_add_u32 m0, s52, 105472
  v_mfma_f32_16x16x32_bf16 a[84:87], v[96:99], v[48:51], a[84:87]
  buffer_load_dwordx4 v9, s[8:11], s20 offen sc1 lds
  v_mfma_f32_16x16x32_bf16 a[88:91], v[100:103], v[48:51], a[88:91]
  v_mfma_f32_16x16x32_bf16 a[92:95], v[104:107], v[48:51], a[92:95]
  v_mfma_f32_16x16x32_bf16 a[96:99], v[92:95], v[52:55], a[96:99]
  v_mfma_f32_16x16x32_bf16 a[100:103], v[96:99], v[52:55], a[100:103]
  s_add_u32 s20, s20, s48
  s_xor_b32 s48, s48, 4096
  v_mfma_f32_16x16x32_bf16 a[104:107], v[100:103], v[52:55], a[104:107]
  s_add_u32 s21, s21, s51
  v_mfma_f32_16x16x32_bf16 a[108:111], v[104:107], v[52:55], a[108:111]
  v_mfma_f32_16x16x32_bf16 a[112:115], v[92:95], v[56:59], a[112:115]
  v_mfma_f32_16x16x32_bf16 a[116:119], v[96:99], v[56:59], a[116:119]
  v_mfma_f32_16x16x32_bf16 a[120:123], v[100:103], v[56:59], a[120:123]
  v_mfma_f32_16x16x32_bf16 a[124:127], v[104:107], v[56:59], a[124:127]
  s_waitcnt lgkmcnt(0)
  v_mfma_f32_16x16x32_bf16 a[0:3], v[108:111], v[60:63], a[0:3]
  s_waitcnt vmcnt(12)
  s_barrier
  s_add_u32 m0, s52, 0
  v_mfma_f32_16x16x32_bf16 a[4:7], v[112:115], v[60:63], a[4:7]
  buffer_load_dwordx4 v2, s[8:11], s20 offen sc1 lds
  ds_read_b128 v[28:31], v14 offset:49152
  v_mfma_f32_16x16x32_bf16 a[8:11], v[116:119], v[60:63], a[8:11]
  ds_read_b64_tr_b16 v[92:93], v19 offset:16384
  v_mfma_f32_16x16x32_bf16 a[12:15], v[120:123], v[60:63], a[12:15]
  ds_read_b64_tr_b16 v[94:95], v19 offset:20480
  v_mfma_f32_16x16x32_bf16 a[16:19], v[108:111], v[64:67], a[16:19]
  ds_read_b128 v[32:35], v14 offset:51200
  s_add_u32 m0, s53, 0
  v_mfma_f32_16x16x32_bf16 a[20:23], v[112:115], v[64:67], a[20:23]
  buffer_load_dwordx4 v10, s[12:15], s21 offen  lds
  ds_read_b64_tr_b16 v[96:97], v19 offset:16392
  v_mfma_f32_16x16x32_bf16 a[24:27], v[116:119], v[64:67], a[24:27]
  ds_read_b64_tr_b16 v[98:99], v19 offset:20488
  v_mfma_f32_16x16x32_bf16 a[28:31], v[120:123], v[64:67], a[28:31]
  ds_read_b128 v[36:39], v14 offset:53248
  v_mfma_f32_16x16x32_bf16 a[32:35], v[108:111], v[68:71], a[32:35]
  ds_read_b64_tr_b16 v[100:101], v20 offset:16384
  s_add_u32 m0, s52, 1024
  v_mfma_f32_16x16x32_bf16 a[36:39], v[112:115], v[68:71], a[36:39]
  buffer_load_dwordx4 v3, s[8:11], s20 offen sc1 lds
  ds_read_b64_tr_b16 v[102:103], v20 offset:20480
  v_mfma_f32_16x16x32_bf16 a[40:43], v[116:119], v[68:71], a[40:43]
  ds_read_b128 v[40:43], v14 offset:55296
  v_mfma_f32_16x16x32_bf16 a[44:47], v[120:123], v[68:71], a[44:47]
  ds_read_b64_tr_b16 v[104:105], v20 offset:16392
  v_mfma_f32_16x16x32_bf16 a[48:51], v[108:111], v[72:75], a[48:51]
  ds_read_b64_tr_b16 v[106:107], v20 offset:20488
  v_mfma_f32_16x16x32_bf16 a[52:55], v[112:115], v[72:75], a[52:55]
  ds_read_b128 v[44:47], v14 offset:57344
  s_add_u32 m0, s53, 1024
  v_mfma_f32_16x16x32_bf16 a[56:59], v[116:119], v[72:75], a[56:59]
  buffer_load_dwordx4 v11, s[12:15], s21 offen  lds
  ds_read_b128 v[48:51], v14 offset:59392
  v_mfma_f32_16x16x32_bf16 a[60:63], v[120:123], v[72:75], a[60:63]
  ds_read_b128 v[52:55], v14 offset:61440
  v_mfma_f32_16x16x32_bf16 a[64:67], v[108:111], v[76:79], a[64:67]
  ds_read_b128 v[56:59], v14 offset:63488
  v_mfma_f32_16x16x32_bf16 a[68:71], v[112:115], v[76:79], a[68:71]
  s_add_u32 m0, s52, 2048
  v_mfma_f32_16x16x32_bf16 a[72:75], v[116:119], v[76:79], a[72:75]
  buffer_load_dwordx4 v4, s[8:11], s20 offen sc1 lds
  v_mfma_f32_16x16x32_bf16 a[76:79], v[120:123], v[76:79], a[76:79]
  v_mfma_f32_16x16x32_bf16 a[80:83], v[108:111], v[80:83], a[80:83]
  v_mfma_f32_16x16x32_bf16 a[84:87], v[112:115], v[80:83], a[84:87]
  v_mfma_f32_16x16x32_bf16 a[88:91], v[116:119], v[80:83], a[88:91]
  s_add_u32 m0, s53, 2048
  v_mfma_f32_16x16x32_bf16 a[92:95], v[120:123], v[80:83], a[92:95]
  buffer_load_dwordx4 v12, s[12:15], s21 offen  lds
  v_mfma_f32_16x16x32_bf16 a[96:99], v[108:111], v[84:87], a[96:99]
  v_mfma_f32_16x16x32_bf16 a[100:103], v[112:115], v[84:87], a[100:103]
  v_mfma_f32_16x16x32_bf16 a[104:107], v[116:119], v[84:87], a[104:107]
  s_add_u32 m0, s52, 3072
  v_mfma_f32_16x16x32_bf16 a[108:111], v[120:123], v[84:87], a[108:111]
  buffer_load_dwordx4 v5, s[8:11], s20 offen sc1 lds
  v_mfma_f32_16x16x32_bf16 a[112:115], v[108:111], v[88:91], a[112:115]
  v_mfma_f32_16x16x32_bf16 a[116:119], v[112:115], v[88:91], a[116:119]
  v_mfma_f32_16x16x32_bf16 a[120:123], v[116:119], v[88:91], a[120:123]
  v_mfma_f32_16x16x32_bf16 a[124:127], v[120:123], v[88:91], a[124:127]
  s_waitcnt lgkmcnt(0)
  s_add_u32 m0, s53, 3072
  v_mfma_f32_16x16x32_bf16 a[0:3], v[92:95], v[28:31], a[0:3]
  buffer_load_dwordx4 v13, s[12:15], s21 offen  lds
  ds_read_b128 v[60:63], v14 offset:50176
  v_mfma_f32_16x16x32_bf16 a[4:7], v[96:99], v[28:31], a[4:7]
  ds_read_b64_tr_b16 v[108:109], v19 offset:24576
  v_mfma_f32_16x16x32_bf16 a[8:11], v[100:103], v[28:31], a[8:11]
  ds_read_b64_tr_b16 v[110:111], v19 offset:28672
  v_mfma_f32_16x16x32_bf16 a[12:15], v[104:107], v[28:31], a[12:15]
  ds_read_b128 v[64:67], v14 offset:52224
  v_mfma_f32_16x16x32_bf16 a[16:19], v[92:95], v[32:35], a[16:19]
  ds_read_b64_tr_b16 v[112:113], v19 offset:24584
  s_add_u32 m0, s52, 4096
  v_mfma_f32_16x16x32_bf16 a[20:23], v[96:99], v[32:35], a[20:23]
  buffer_load_dwordx4 v6, s[8:11], s20 offen sc1 lds
  ds_read_b64_tr_b16 v[114:115], v19 offset:28680
  v_mfma_f32_16x16x32_bf16 a[24:27], v[100:103], v[32:35], a[24:27]
  ds_read_b128 v[68:71], v14 offset:54272
  v_mfma_f32_16x16x32_bf16 a[28:31], v[104:107], v[32:35], a[28:31]
  ds_read_b64_tr_b16 v[116:117], v20 offset:24576
  v_mfma_f32_16x16x32_bf16 a[32:35], v[92:95], v[36:39], a[32:35]
  ds_read_b64_tr_b16 v[118:119], v20 offset:28672
  v_mfma_f32_16x16x32_bf16 a[36:39], v[96:99], v[36:39], a[36:39]
  ds_read_b128 v[72:75], v14 offset:56320
  s_add_u32 m0, s52, 5120
  v_mfma_f32_16x16x32_bf16 a[40:43], v[100:103], v[36:39], a[40:43]
  buffer_load_dwordx4 v7, s[8:11], s20 offen sc1 lds
  ds_read_b64_tr_b16 v[120:121], v20 offset:24584
  v_mfma_f32_16x16x32_bf16 a[44:47], v[104:107], v[36:39], a[44:47]
  ds_read_b64_tr_b16 v[122:123], v20 offset:28680
  v_mfma_f32_16x16x32_bf16 a[48:51], v[92:95], v[40:43], a[48:51]
  ds_read_b128 v[76:79], v14 offset:58368
  v_mfma_f32_16x16x32_bf16 a[52:55], v[96:99], v[40:43], a[52:55]
  ds_read_b128 v[80:83], v14 offset:60416
  v_mfma_f32_16x16x32_bf16 a[56:59], v[100:103], v[40:43], a[56:59]
  ds_read_b128 v[84:87], v14 offset:62464
  v_mfma_f32_16x16x32_bf16 a[60:63], v[104:107], v[40:43], a[60:63]
  ds_read_b128 v[88:91], v14 offset:64512
  s_add_u32 m0, s52, 6144
  v_mfma_f32_16x16x32_bf16 a[64:67], v[92:95], v[44:47], a[64:67]
  buffer_load_dwordx4 v8, s[8:11], s20 offen sc1 lds
  v_mfma_f32_16x16x32_bf16 a[68:71], v[96:99], v[44:47], a[68:71]
  v_mfma_f32_16x16x32_bf16 a[72:75], v[100:103], v[44:47], a[72:75]
  v_mfma_f32_16x16x32_bf16 a[76:79], v[104:107], v[44:47], a[76:79]
  v_mfma_f32_16x16x32_bf16 a[80:83], v[92:95], v[48:51], a[80:83]
  s_add_u32 m0, s52, 7168
  v_mfma_f32_16x16x32_bf16 a[84:87], v[96:99], v[48:51], a[84:87]
  buffer_load_dwordx4 v9, s[8:11], s20 offen sc1 lds
  v_mfma_f32_16x16x32_bf16 a[88:91], v[100:103], v[48:51], a[88:91]
  v_mfma_f32_16x16x32_bf16 a[92:95], v[104:107], v[48:51], a[92:95]
  v_mfma_f32_16x16x32_bf16 a[96:99], v[92:95], v[52:55], a[96:99]
  v_mfma_f32_16x16x32_bf16 a[100:103], v[96:99], v[52:55], a[100:103]
  s_add_u32 s20, s20, s48
  s_xor_b32 s48, s48, 4096
  v_mfma_f32_16x16x32_bf16 a[104:107], v[100:103], v[52:55], a[104:107]
  s_add_u32 s21, s21, s51
  v_mfma_f32_16x16x32_bf16 a[108:111], v[104:107], v[52:55], a[108:111]
  v_mfma_f32_16x16x32_bf16 a[112:115], v[92:95], v[56:59], a[112:115]
  v_mfma_f32_16x16x32_bf16 a[116:119], v[96:99], v[56:59], a[116:119]
  v_mfma_f32_16x16x32_bf16 a[120:123], v[100:103], v[56:59], a[120:123]
  v_mfma_f32_16x16x32_bf16 a[124:127], v[104:107], v[56:59], a[124:127]
  s_waitcnt lgkmcnt(0)
  v_mfma_f32_16x16x32_bf16 a[0:3], v[108:111], v[60:63], a[0:3]
  s_waitcnt vmcnt(12)
  s_barrier
  s_add_u32 m0, s52, 49152
  v_mfma_f32_16x16x32_bf16 a[4:7], v[112:115], v[60:63], a[4:7]
  buffer_load_dwordx4 v2, s[8:11], s20 offen sc1 lds
  ds_read_b128 v[28:31], v15 offset:32768
  v_mfma_f32_16x16x32_bf16 a[8:11], v[116:119], v[60:63], a[8:11]
  ds_read_b64_tr_b16 v[92:93], v21 offset:0
  v_mfma_f32_16x16x32_bf16 a[12:15], v[120:123], v[60:63], a[12:15]
  ds_read_b64_tr_b16 v[94:95], v21 offset:4096
  v_mfma_f32_16x16x32_bf16 a[16:19], v[108:111], v[64:67], a[16:19]
  ds_read_b128 v[32:35], v15 offset:34816
  s_add_u32 m0, s53, 49152
  v_mfma_f32_16x16x32_bf16 a[20:23], v[112:115], v[64:67], a[20:23]
  buffer_load_dwordx4 v10, s[12:15], s21 offen  lds
  ds_read_b64_tr_b16 v[96:97], v21 offset:8
  v_mfma_f32_16x16x32_bf16 a[24:27], v[116:119], v[64:67], a[24:27]
  ds_read_b64_tr_b16 v[98:99], v21 offset:4104
  v_mfma_f32_16x16x32_bf16 a[28:31], v[120:123], v[64:67], a[28:31]
  ds_read_b128 v[36:39], v15 offset:36864
  v_mfma_f32_16x16x32_bf16 a[32:35], v[108:111], v[68:71], a[32:35]
  ds_read_b64_tr_b16 v[100:101], v22 offset:0
  s_add_u32 m0, s52, 50176
  v_mfma_f32_16x16x32_bf16 a[36:39], v[112:115], v[68:71], a[36:39]
  buffer_load_dwordx4 v3, s[8:11], s20 offen sc1 lds
  ds_read_b64_tr_b16 v[102:103], v22 offset:4096
  v_mfma_f32_16x16x32_bf16 a[40:43], v[116:119], v[68:71], a[40:43]
  ds_read_b128 v[40:43], v15 offset:38912
  v_mfma_f32_16x16x32_bf16 a[44:47], v[120:123], v[68:71], a[44:47]
  ds_read_b64_tr_b16 v[104:105], v22 offset:8
  v_mfma_f32_16x16x32_bf16 a[48:51], v[108:111], v[72:75], a[48:51]
  ds_read_b64_tr_b16 v[106:107], v22 offset:4104
  v_mfma_f32_16x16x32_bf16 a[52:55], v[112:115], v[72:75], a[52:55]
  ds_read_b128 v[44:47], v15 offset:40960
  s_add_u32 m0, s53, 50176
  v_mfma_f32_16x16x32_bf16 a[56:59], v[116:119], v[72:75], a[56:59]
  buffer_load_dwordx4 v11, s[12:15], s21 offen  lds
  ds_read_b128 v[48:51], v15 offset:43008
  v_mfma_f32_16x16x32_bf16 a[60:63], v[120:123], v[72:75], a[60:63]
  ds_read_b128 v[52:55], v15 offset:45056
  v_mfma_f32_16x16x32_bf16 a[64:67], v[108:111], v[76:79], a[64:67]
  ds_read_b128 v[56:59], v15 offset:47104
  v_mfma_f32_16x16x32_bf16 a[68:71], v[112:115], v[76:79], a[68:71]
  s_add_u32 m0, s52, 51200
  v_mfma_f32_16x16x32_bf16 a[72:75], v[116:119], v[76:79], a[72:75]
  buffer_load_dwordx4 v4, s[8:11], s20 offen sc1 lds
  v_mfma_f32_16x16x32_bf16 a[76:79], v[120:123], v[76:79], a[76:79]
  v_mfma_f32_16x16x32_bf16 a[80:83], v[108:111], v[80:83], a[80:83]
  v_mfma_f32_16x16x32_bf16 a[84:87], v[112:115], v[80:83], a[84:87]
  v_mfma_f32_16x16x32_bf16 a[88:91], v[116:119], v[80:83], a[88:91]
  s_add_u32 m0, s53, 51200
  v_mfma_f32_16x16x32_bf16 a[92:95], v[120:123], v[80:83], a[92:95]
  buffer_load_dwordx4 v12, s[12:15], s21 offen  lds
  v_mfma_f32_16x16x32_bf16 a[96:99], v[108:111], v[84:87], a[96:99]
  v_mfma_f32_16x16x32_bf16 a[100:103], v[112:115], v[84:87], a[100:103]
  v_mfma_f32_16x16x32_bf16 a[104:107], v[116:119], v[84:87], a[104:107]
  s_add_u32 m0, s52, 52224
  v_mfma_f32_16x16x32_bf16 a[108:111], v[120:123], v[84:87], a[108:111]
  buffer_load_dwordx4 v5, s[8:11], s20 offen sc1 lds
  v_mfma_f32_16x16x32_bf16 a[112:115], v[108:111], v[88:91], a[112:115]
  v_mfma_f32_16x16x32_bf16 a[116:119], v[112:115], v[88:91], a[116:119]
  v_mfma_f32_16x16x32_bf16 a[120:123], v[116:119], v[88:91], a[120:123]
  v_mfma_f32_16x16x32_bf16 a[124:127], v[120:123], v[88:91], a[124:127]
  s_waitcnt lgkmcnt(0)
  s_add_u32 m0, s53, 52224
  v_mfma_f32_16x16x32_bf16 a[0:3], v[92:95], v[28:31], a[0:3]
  buffer_load_dwordx4 v13, s[12:15], s21 offen  lds
  ds_read_b128 v[60:63], v15 offset:33792
  v_mfma_f32_16x16x32_bf16 a[4:7], v[96:99], v[28:31], a[4:7]
  ds_read_b64_tr_b16 v[108:109], v21 offset:8192
  v_mfma_f32_16x16x32_bf16 a[8:11], v[100:103], v[28:31], a[8:11]
  ds_read_b64_tr_b16 v[110:111], v21 offset:12288
  v_mfma_f32_16x16x32_bf16 a[12:15], v[104:107], v[28:31], a[12:15]
  ds_read_b128 v[64:67], v15 offset:35840
  v_mfma_f32_16x16x32_bf16 a[16:19], v[92:95], v[32:35], a[16:19]
  ds_read_b64_tr_b16 v[112:113], v21 offset:8200
  s_add_u32 m0, s52, 53248
  v_mfma_f32_16x16x32_bf16 a[20:23], v[96:99], v[32:35], a[20:23]
  buffer_load_dwordx4 v6, s[8:11], s20 offen sc1 lds
  ds_read_b64_tr_b16 v[114:115], v21 offset:12296
  v_mfma_f32_16x16x32_bf16 a[24:27], v[100:103], v[32:35], a[24:27]
  ds_read_b128 v[68:71], v15 offset:37888
  v_mfma_f32_16x16x32_bf16 a[28:31], v[104:107], v[32:35], a[28:31]
  ds_read_b64_tr_b16 v[116:117], v22 offset:8192
  v_mfma_f32_16x16x32_bf16 a[32:35], v[92:95], v[36:39], a[32:35]
  ds_read_b64_tr_b16 v[118:119], v22 offset:12288
  v_mfma_f32_16x16x32_bf16 a[36:39], v[96:99], v[36:39], a[36:39]
  ds_read_b128 v[72:75], v15 offset:39936
  s_add_u32 m0, s52, 54272
  v_mfma_f32_16x16x32_bf16 a[40:43], v[100:103], v[36:39], a[40:43]
  buffer_load_dwordx4 v7, s[8:11], s20 offen sc1 lds
  ds_read_b64_tr_b16 v[120:121], v22 offset:8200
  v_mfma_f32_16x16x32_bf16 a[44:47], v[104:107], v[36:39], a[44:47]
  ds_read_b64_tr_b16 v[122:123], v22 offset:12296
  v_mfma_f32_16x16x32_bf16 a[48:51], v[92:95], v[40:43], a[48:51]
  ds_read_b128 v[76:79], v15 offset:41984
  v_mfma_f32_16x16x32_bf16 a[52:55], v[96:99], v[40:43], a[52:55]
  ds_read_b128 v[80:83], v15 offset:44032
  v_mfma_f32_16x16x32_bf16 a[56:59], v[100:103], v[40:43], a[56:59]
  ds_read_b128 v[84:87], v15 offset:46080
  v_mfma_f32_16x16x32_bf16 a[60:63], v[104:107], v[40:43], a[60:63]
  ds_read_b128 v[88:91], v15 offset:48128
  s_add_u32 m0, s52, 55296
  v_mfma_f32_16x16x32_bf16 a[64:67], v[92:95], v[44:47], a[64:67]
  buffer_load_dwordx4 v8, s[8:11], s20 offen sc1 lds
  v_mfma_f32_16x16x32_bf16 a[68:71], v[96:99], v[44:47], a[68:71]
  v_mfma_f32_16x16x32_bf16 a[72:75], v[100:103], v[44:47], a[72:75]
  v_mfma_f32_16x16x32_bf16 a[76:79], v[104:107], v[44:47], a[76:79]
  v_mfma_f32_16x16x32_bf16 a[80:83], v[92:95], v[48:51], a[80:83]
  s_add_u32 m0, s52, 56320
  v_mfma_f32_16x16x32_bf16 a[84:87], v[96:99], v[48:51], a[84:87]
  buffer_load_dwordx4 v9, s[8:11], s20 offen sc1 lds
  v_mfma_f32_16x16x32_bf16 a[88:91], v[100:103], v[48:51], a[88:91]
  v_mfma_f32_16x16x32_bf16 a[92:95], v[104:107], v[48:51], a[92:95]
  v_mfma_f32_16x16x32_bf16 a[96:99], v[92:95], v[52:55], a[96:99]
  v_mfma_f32_16x16x32_bf16 a[100:103], v[96:99], v[52:55], a[100:103]
  s_add_u32 s20, s20, s48
  s_xor_b32 s48, s48, 4096
  v_mfma_f32_16x16x32_bf16 a[104:107], v[100:103], v[52:55], a[104:107]
  s_add_u32 s21, s21, s51
  v_mfma_f32_16x16x32_bf16 a[108:111], v[104:107], v[52:55], a[108:111]
  v_mfma_f32_16x16x32_bf16 a[112:115], v[92:95], v[56:59], a[112:115]
  v_mfma_f32_16x16x32_bf16 a[116:119], v[96:99], v[56:59], a[116:119]
  v_mfma_f32_16x16x32_bf16 a[120:123], v[100:103], v[56:59], a[120:123]
  v_mfma_f32_16x16x32_bf16 a[124:127], v[104:107], v[56:59], a[124:127]
  s_waitcnt lgkmcnt(0)
  v_mfma_f32_16x16x32_bf16 a[0:3], v[108:111], v[60:63], a[0:3]
  s_waitcnt vmcnt(12)
  s_barrier
  s_add_u32 m0, s52, 98304
  v_mfma_f32_16x16x32_bf16 a[4:7], v[112:115], v[60:63], a[4:7]
  buffer_load_dwordx4 v2, s[8:11], s20 offen sc1 lds
  ds_read_b128 v[28:31], v14 offset:0
  v_mfma_f32_16x16x32_bf16 a[8:11], v[116:119], v[60:63], a[8:11]
  ds_read_b64_tr_b16 v[92:93], v17 offset:32768
  v_mfma_f32_16x16x32_bf16 a[12:15], v[120:123], v[60:63], a[12:15]
  ds_read_b64_tr_b16 v[94:95], v17 offset:36864
  v_mfma_f32_16x16x32_bf16 a[16:19], v[108:111], v[64:67], a[16:19]
  ds_read_b128 v[32:35], v14 offset:2048
  s_add_u32 m0, s53, 98304
  v_mfma_f32_16x16x32_bf16 a[20:23], v[112:115], v[64:67], a[20:23]
  buffer_load_dwordx4 v10, s[12:15], s21 offen  lds
  ds_read_b64_tr_b16 v[96:97], v17 offset:32776
  v_mfma_f32_16x16x32_bf16 a[24:27], v[116:119], v[64:67], a[24:27]
  ds_read_b64_tr_b16 v[98:99], v17 offset:36872
  v_mfma_f32_16x16x32_bf16 a[28:31], v[120:123], v[64:67], a[28:31]
  ds_read_b128 v[36:39], v14 offset:4096
  v_mfma_f32_16x16x32_bf16 a[32:35], v[108:111], v[68:71], a[32:35]
  ds_read_b64_tr_b16 v[100:101], v18 offset:32768
  s_add_u32 m0, s52, 99328
  v_mfma_f32_16x16x32_bf16 a[36:39], v[112:115], v[68:71], a[36:39]
  buffer_load_dwordx4 v3, s[8:11], s20 offen sc1 lds
  ds_read_b64_tr_b16 v[102:103], v18 offset:36864
  v_mfma_f32_16x16x32_bf16 a[40:43], v[116:119], v[68:71], a[40:43]
  ds_read_b128 v[40:43], v14 offset:6144
  v_mfma_f32_16x16x32_bf16 a[44:47], v[120:123], v[68:71], a[44:47]
  ds_read_b64_tr_b16 v[104:105], v18 offset:32776
  v_mfma_f32_16x16x32_bf16 a[48:51], v[108:111], v[72:75], a[48:51]
  ds_read_b64_tr_b16 v[106:107], v18 offset:36872
  v_mfma_f32_16x16x32_bf16 a[52:55], v[112:115], v[72:75], a[52:55]
  ds_read_b128 v[44:47], v14 offset:8192
  s_add_u32 m0, s53, 99328
  v_mfma_f32_16x16x32_bf16 a[56:59], v[116:119], v[72:75], a[56:59]
  buffer_load_dwordx4 v11, s[12:15], s21 offen  lds
  ds_read_b128 v[48:51], v14 offset:10240
  v_mfma_f32_16x16x32_bf16 a[60:63], v[120:123], v[72:75], a[60:63]
  ds_read_b128 v[52:55], v14 offset:12288
  v_mfma_f32_16x16x32_bf16 a[64:67], v[108:111], v[76:79], a[64:67]
  ds_read_b128 v[56:59], v14 offset:14336
  v_mfma_f32_16x16x32_bf16 a[68:71], v[112:115], v[76:79], a[68:71]
  s_add_u32 m0, s52, 100352
  v_mfma_f32_16x16x32_bf16 a[72:75], v[116:119], v[76:79], a[72:75]
  buffer_load_dwordx4 v4, s[8:11], s20 offen sc1 lds
  v_mfma_f32_16x16x32_bf16 a[76:79], v[120:123], v[76:79], a[76:79]
  v_mfma_f32_16x16x32_bf16 a[80:83], v[108:111], v[80:83], a[80:83]
  v_mfma_f32_16x16x32_bf16 a[84:87], v[112:115], v[80:83], a[84:87]
  v_mfma_f32_16x16x32_bf16 a[88:91], v[116:119], v[80:83], a[88:91]
  s_add_u32 m0, s53, 100352
  v_mfma_f32_16x16x32_bf16 a[92:95], v[120:123], v[80:83], a[92:95]
  buffer_load_dwordx4 v12, s[12:15], s21 offen  lds
  v_mfma_f32_16x16x32_bf16 a[96:99], v[108:111], v[84:87], a[96:99]
  v_mfma_f32_16x16x32_bf16 a[100:103], v[112:115], v[84:87], a[100:103]
  v_mfma_f32_16x16x32_bf16 a[104:107], v[116:119], v[84:87], a[104:107]
  s_add_u32 m0, s52, 101376
  v_mfma_f32_16x16x32_bf16 a[108:111], v[120:123], v[84:87], a[108:111]
  buffer_load_dwordx4 v5, s[8:11], s20 offen sc1 lds
  v_mfma_f32_16x16x32_bf16 a[112:115], v[108:111], v[88:91], a[112:115]
  v_mfma_f32_16x16x32_bf16 a[116:119], v[112:115], v[88:91], a[116:119]
  v_mfma_f32_16x16x32_bf16 a[120:123], v[116:119], v[88:91], a[120:123]
  v_mfma_f32_16x16x32_bf16 a[124:127], v[120:123], v[88:91], a[124:127]
  s_branch L_g6_loop
L_g6_fin:
  s_cmp_eq_u32 s35, 16
  s_cselect_b32 s90, 999, s34
  s_cmp_lt_u32 s90, 242
  s_cbranch_scc0 L_re_101
  s_cmp_lg_u32 s32, 0
  s_cbranch_scc1 L_rq_102
  s_cmp_eq_u32 s39, 0
  s_cbranch_scc1 L_rq_102
  s_lshl_b32 s99, s33, 7
  s_add_u32 s99, s99, 0x3d00200
  v_mov_b32 v244, 1
  v_mov_b32 v245, 0
  s_mov_b64 exec, 1
  buffer_atomic_add v244, v245, s[4:7], s99 offen sc0 sc1
  s_mov_b64 exec, -1
L_rq_102:
L_re_101:
  s_waitcnt lgkmcnt(0)
  s_add_u32 m0, s53, 101376
  v_mfma_f32_16x16x32_bf16 a[0:3], v[92:95], v[28:31], a[0:3]
  buffer_load_dwordx4 v13, s[12:15], s21 offen  lds
  ds_read_b128 v[60:63], v14 offset:1024
  v_mfma_f32_16x16x32_bf16 a[4:7], v[96:99], v[28:31], a[4:7]
  ds_read_b64_tr_b16 v[108:109], v17 offset:40960
  v_mfma_f32_16x16x32_bf16 a[8:11], v[100:103], v[28:31], a[8:11]
  ds_read_b64_tr_b16 v[110:111], v17 offset:45056
  v_mfma_f32_16x16x32_bf16 a[12:15], v[104:107], v[28:31], a[12:15]
  ds_read_b128 v[64:67], v14 offset:3072
  v_mfma_f32_16x16x32_bf16 a[16:19], v[92:95], v[32:35], a[16:19]
  ds_read_b64_tr_b16 v[112:113], v17 offset:40968
  s_add_u32 m0, s52, 102400
  v_mfma_f32_16x16x32_bf16 a[20:23], v[96:99], v[32:35], a[20:23]
  buffer_load_dwordx4 v6, s[8:11], s20 offen sc1 lds
  ds_read_b64_tr_b16 v[114:115], v17 offset:45064
  v_mfma_f32_16x16x32_bf16 a[24:27], v[100:103], v[32:35], a[24:27]
  ds_read_b128 v[68:71], v14 offset:5120
  v_mfma_f32_16x16x32_bf16 a[28:31], v[104:107], v[32:35], a[28:31]
  ds_read_b64_tr_b16 v[116:117], v18 offset:40960
  v_mfma_f32_16x16x32_bf16 a[32:35], v[92:95], v[36:39], a[32:35]
  ds_read_b64_tr_b16 v[118:119], v18 offset:45056
  v_mfma_f32_16x16x32_bf16 a[36:39], v[96:99], v[36:39], a[36:39]
  ds_read_b128 v[72:75], v14 offset:7168
  s_add_u32 m0, s52, 103424
  v_mfma_f32_16x16x32_bf16 a[40:43], v[100:103], v[36:39], a[40:43]
  buffer_load_dwordx4 v7, s[8:11], s20 offen sc1 lds
  ds_read_b64_tr_b16 v[120:121], v18 offset:40968
  v_mfma_f32_16x16x32_bf16 a[44:47], v[104:107], v[36:39], a[44:47]
  ds_read_b64_tr_b16 v[122:123], v18 offset:45064
  v_mfma_f32_16x16x32_bf16 a[48:51], v[92:95], v[40:43], a[48:51]
  ds_read_b128 v[76:79], v14 offset:9216
  v_mfma_f32_16x16x32_bf16 a[52:55], v[96:99], v[40:43], a[52:55]
  ds_read_b128 v[80:83], v14 offset:11264
  v_mfma_f32_16x16x32_bf16 a[56:59], v[100:103], v[40:43], a[56:59]
  ds_read_b128 v[84:87], v14 offset:13312
  v_mfma_f32_16x16x32_bf16 a[60:63], v[104:107], v[40:43], a[60:63]
  ds_read_b128 v[88:91], v14 offset:15360
  s_add_u32 m0, s52, 104448
  v_mfma_f32_16x16x32_bf16 a[64:67], v[92:95], v[44:47], a[64:67]
  buffer_load_dwordx4 v8, s[8:11], s20 offen sc1 lds
  v_mfma_f32_16x16x32_bf16 a[68:71], v[96:99], v[44:47], a[68:71]
  v_mfma_f32_16x16x32_bf16 a[72:75], v[100:103], v[44:47], a[72:75]
  v_mfma_f32_16x16x32_bf16 a[76:79], v[104:107], v[44:47], a[76:79]
  v_mfma_f32_16x16x32_bf16 a[80:83], v[92:95], v[48:51], a[80:83]
  s_add_u32 m0, s52, 105472
  v_mfma_f32_16x16x32_bf16 a[84:87], v[96:99], v[48:51], a[84:87]
  buffer_load_dwordx4 v9, s[8:11], s20 offen sc1 lds
  v_mfma_f32_16x16x32_bf16 a[88:91], v[100:103], v[48:51], a[88:91]
  v_mfma_f32_16x16x32_bf16 a[92:95], v[104:107], v[48:51], a[92:95]
  v_mfma_f32_16x16x32_bf16 a[96:99], v[92:95], v[52:55], a[96:99]
  v_mfma_f32_16x16x32_bf16 a[100:103], v[96:99], v[52:55], a[100:103]
  s_add_u32 s20, s20, s48
  s_xor_b32 s48, s48, 4096
  v_mfma_f32_16x16x32_bf16 a[104:107], v[100:103], v[52:55], a[104:107]
  s_add_u32 s21, s21, s51
  v_mfma_f32_16x16x32_bf16 a[108:111], v[104:107], v[52:55], a[108:111]
  v_mfma_f32_16x16x32_bf16 a[112:115], v[92:95], v[56:59], a[112:115]
  v_mfma_f32_16x16x32_bf16 a[116:119], v[96:99], v[56:59], a[116:119]
  v_mfma_f32_16x16x32_bf16 a[120:123], v[100:103], v[56:59], a[120:123]
  v_mfma_f32_16x16x32_bf16 a[124:127], v[104:107], v[56:59], a[124:127]
  s_waitcnt lgkmcnt(0)
  v_mfma_f32_16x16x32_bf16 a[0:3], v[108:111], v[60:63], a[0:3]
  s_waitcnt vmcnt(12)
  s_barrier
  s_add_u32 m0, s52, 0
  v_mfma_f32_16x16x32_bf16 a[4:7], v[112:115], v[60:63], a[4:7]
  buffer_load_dwordx4 v2, s[8:11], s20 offen sc1 lds
  ds_read_b128 v[28:31], v14 offset:49152
  v_mfma_f32_16x16x32_bf16 a[8:11], v[116:119], v[60:63], a[8:11]
  ds_read_b64_tr_b16 v[92:93], v19 offset:16384
  v_mfma_f32_16x16x32_bf16 a[12:15], v[120:123], v[60:63], a[12:15]
  ds_read_b64_tr_b16 v[94:95], v19 offset:20480
  v_mfma_f32_16x16x32_bf16 a[16:19], v[108:111], v[64:67], a[16:19]
  ds_read_b128 v[32:35], v14 offset:51200
  s_add_u32 m0, s53, 0
  v_mfma_f32_16x16x32_bf16 a[20:23], v[112:115], v[64:67], a[20:23]
  buffer_load_dwordx4 v10, s[12:15], s21 offen  lds
  ds_read_b64_tr_b16 v[96:97], v19 offset:16392
  v_mfma_f32_16x16x32_bf16 a[24:27], v[116:119], v[64:67], a[24:27]
  ds_read_b64_tr_b16 v[98:99], v19 offset:20488
  v_mfma_f32_16x16x32_bf16 a[28:31], v[120:123], v[64:67], a[28:31]
  ds_read_b128 v[36:39], v14 offset:53248
  v_mfma_f32_16x16x32_bf16 a[32:35], v[108:111], v[68:71], a[32:35]
  ds_read_b64_tr_b16 v[100:101], v20 offset:16384
  s_add_u32 m0, s52, 1024
  v_mfma_f32_16x16x32_bf16 a[36:39], v[112:115], v[68:71], a[36:39]
  buffer_load_dwordx4 v3, s[8:11], s20 offen sc1 lds
  ds_read_b64_tr_b16 v[102:103], v20 offset:20480
  v_mfma_f32_16x16x32_bf16 a[40:43], v[116:119], v[68:71], a[40:43]
  ds_read_b128 v[40:43], v14 offset:55296
  v_mfma_f32_16x16x32_bf16 a[44:47], v[120:123], v[68:71], a[44:47]
  ds_read_b64_tr_b16 v[104:105], v20 offset:16392
  v_mfma_f32_16x16x32_bf16 a[48:51], v[108:111], v[72:75], a[48:51]
  ds_read_b64_tr_b16 v[106:107], v20 offset:20488
  v_mfma_f32_16x16x32_bf16 a[52:55], v[112:115], v[72:75], a[52:55]
  ds_read_b128 v[44:47], v14 offset:57344
  s_add_u32 m0, s53, 1024
  v_mfma_f32_16x16x32_bf16 a[56:59], v[116:119], v[72:75], a[56:59]
  buffer_load_dwordx4 v11, s[12:15], s21 offen  lds
  ds_read_b128 v[48:51], v14 offset:59392
  v_mfma_f32_16x16x32_bf16 a[60:63], v[120:123], v[72:75], a[60:63]
  ds_read_b128 v[52:55], v14 offset:61440
  v_mfma_f32_16x16x32_bf16 a[64:67], v[108:111], v[76:79], a[64:67]
  ds_read_b128 v[56:59], v14 offset:63488
  v_mfma_f32_16x16x32_bf16 a[68:71], v[112:115], v[76:79], a[68:71]
  s_add_u32 m0, s52, 2048
  v_mfma_f32_16x16x32_bf16 a[72:75], v[116:119], v[76:79], a[72:75]
  buffer_load_dwordx4 v4, s[8:11], s20 offen sc1 lds
  v_mfma_f32_16x16x32_bf16 a[76:79], v[120:123], v[76:79], a[76:79]
  v_mfma_f32_16x16x32_bf16 a[80:83], v[108:111], v[80:83], a[80:83]
  v_mfma_f32_16x16x32_bf16 a[84:87], v[112:115], v[80:83], a[84:87]
  v_mfma_f32_16x16x32_bf16 a[88:91], v[116:119], v[80:83], a[88:91]
  s_add_u32 m0, s53, 2048
  v_mfma_f32_16x16x32_bf16 a[92:95], v[120:123], v[80:83], a[92:95]
  buffer_load_dwordx4 v12, s[12:15], s21 offen  lds
  v_mfma_f32_16x16x32_bf16 a[96:99], v[108:111], v[84:87], a[96:99]
  v_mfma_f32_16x16x32_bf16 a[100:103], v[112:115], v[84:87], a[100:103]
  v_mfma_f32_16x16x32_bf16 a[104:107], v[116:119], v[84:87], a[104:107]
  s_add_u32 m0, s52, 3072
  v_mfma_f32_16x16x32_bf16 a[108:111], v[120:123], v[84:87], a[108:111]
  buffer_load_dwordx4 v5, s[8:11], s20 offen sc1 lds
  v_mfma_f32_16x16x32_bf16 a[112:115], v[108:111], v[88:91], a[112:115]
  v_mfma_f32_16x16x32_bf16 a[116:119], v[112:115], v[88:91], a[116:119]
  v_mfma_f32_16x16x32_bf16 a[120:123], v[116:119], v[88:91], a[120:123]
  v_mfma_f32_16x16x32_bf16 a[124:127], v[120:123], v[88:91], a[124:127]
  s_waitcnt lgkmcnt(0)
  s_add_u32 m0, s53, 3072
  v_mfma_f32_16x16x32_bf16 a[0:3], v[92:95], v[28:31], a[0:3]
  buffer_load_dwordx4 v13, s[12:15], s21 offen  lds
  ds_read_b128 v[60:63], v14 offset:50176
  v_mfma_f32_16x16x32_bf16 a[4:7], v[96:99], v[28:31], a[4:7]
  ds_read_b64_tr_b16 v[108:109], v19 offset:24576
  v_mfma_f32_16x16x32_bf16 a[8:11], v[100:103], v[28:31], a[8:11]
  ds_read_b64_tr_b16 v[110:111], v19 offset:28672
  v_mfma_f32_16x16x32_bf16 a[12:15], v[104:107], v[28:31], a[12:15]
  ds_read_b128 v[64:67], v14 offset:52224
  v_mfma_f32_16x16x32_bf16 a[16:19], v[92:95], v[32:35], a[16:19]
  ds_read_b64_tr_b16 v[112:113], v19 offset:24584
  s_add_u32 m0, s52, 4096
  v_mfma_f32_16x16x32_bf16 a[20:23], v[96:99], v[32:35], a[20:23]
  buffer_load_dwordx4 v6, s[8:11], s20 offen sc1 lds
  ds_read_b64_tr_b16 v[114:115], v19 offset:28680
  v_mfma_f32_16x16x32_bf16 a[24:27], v[100:103], v[32:35], a[24:27]
  ds_read_b128 v[68:71], v14 offset:54272
  v_mfma_f32_16x16x32_bf16 a[28:31], v[104:107], v[32:35], a[28:31]
  ds_read_b64_tr_b16 v[116:117], v20 offset:24576
  v_mfma_f32_16x16x32_bf16 a[32:35], v[92:95], v[36:39], a[32:35]
  ds_read_b64_tr_b16 v[118:119], v20 offset:28672
  v_mfma_f32_16x16x32_bf16 a[36:39], v[96:99], v[36:39], a[36:39]
  ds_read_b128 v[72:75], v14 offset:56320
  s_add_u32 m0, s52, 5120
  v_mfma_f32_16x16x32_bf16 a[40:43], v[100:103], v[36:39], a[40:43]
  buffer_load_dwordx4 v7, s[8:11], s20 offen sc1 lds
  ds_read_b64_tr_b16 v[120:121], v20 offset:24584
  v_mfma_f32_16x16x32_bf16 a[44:47], v[104:107], v[36:39], a[44:47]
  ds_read_b64_tr_b16 v[122:123], v20 offset:28680
  v_mfma_f32_16x16x32_bf16 a[48:51], v[92:95], v[40:43], a[48:51]
  ds_read_b128 v[76:79], v14 offset:58368
  v_mfma_f32_16x16x32_bf16 a[52:55], v[96:99], v[40:43], a[52:55]
  ds_read_b128 v[80:83], v14 offset:60416
  v_mfma_f32_16x16x32_bf16 a[56:59], v[100:103], v[40:43], a[56:59]
  ds_read_b128 v[84:87], v14 offset:62464
  v_mfma_f32_16x16x32_bf16 a[60:63], v[104:107], v[40:43], a[60:63]
  ds_read_b128 v[88:91], v14 offset:64512
  s_add_u32 m0, s52, 6144
  v_mfma_f32_16x16x32_bf16 a[64:67], v[92:95], v[44:47], a[64:67]
  buffer_load_dwordx4 v8, s[8:11], s20 offen sc1 lds
  v_mfma_f32_16x16x32_bf16 a[68:71], v[96:99], v[44:47], a[68:71]
  v_mfma_f32_16x16x32_bf16 a[72:75], v[100:103], v[44:47], a[72:75]
  v_mfma_f32_16x16x32_bf16 a[76:79], v[104:107], v[44:47], a[76:79]
  v_mfma_f32_16x16x32_bf16 a[80:83], v[92:95], v[48:51], a[80:83]
  s_add_u32 m0, s52, 7168
  v_mfma_f32_16x16x32_bf16 a[84:87], v[96:99], v[48:51], a[84:87]
  buffer_load_dwordx4 v9, s[8:11], s20 offen sc1 lds
  v_mfma_f32_16x16x32_bf16 a[88:91], v[100:103], v[48:51], a[88:91]
  v_mfma_f32_16x16x32_bf16 a[92:95], v[104:107], v[48:51], a[92:95]
  v_mfma_f32_16x16x32_bf16 a[96:99], v[92:95], v[52:55], a[96:99]
  v_mfma_f32_16x16x32_bf16 a[100:103], v[96:99], v[52:55], a[100:103]
  s_add_u32 s20, s20, s48
  s_xor_b32 s48, s48, 4096
  v_mfma_f32_16x16x32_bf16 a[104:107], v[100:103], v[52:55], a[104:107]
  s_add_u32 s21, s21, s51
  v_mfma_f32_16x16x32_bf16 a[108:111], v[104:107], v[52:55], a[108:111]
  v_mfma_f32_16x16x32_bf16 a[112:115], v[92:95], v[56:59], a[112:115]
  v_mfma_f32_16x16x32_bf16 a[116:119], v[96:99], v[56:59], a[116:119]
  v_mfma_f32_16x16x32_bf16 a[120:123], v[100:103], v[56:59], a[120:123]
  v_mfma_f32_16x16x32_bf16 a[124:127], v[104:107], v[56:59], a[124:127]
  s_waitcnt lgkmcnt(0)
  v_mfma_f32_16x16x32_bf16 a[0:3], v[108:111], v[60:63], a[0:3]
  s_waitcnt vmcnt(12)
  s_barrier
  v_mfma_f32_16x16x32_bf16 a[4:7], v[112:115], v[60:63], a[4:7]
  ds_read_b128 v[28:31], v15 offset:32768
  v_mfma_f32_16x16x32_bf16 a[8:11], v[116:119], v[60:63], a[8:11]
  ds_read_b64_tr_b16 v[92:93], v21 offset:0
  v_mfma_f32_16x16x32_bf16 a[12:15], v[120:123], v[60:63], a[12:15]
  ds_read_b64_tr_b16 v[94:95], v21 offset:4096
  v_mfma_f32_16x16x32_bf16 a[16:19], v[108:111], v[64:67], a[16:19]
  ds_read_b128 v[32:35], v15 offset:34816
  v_mfma_f32_16x16x32_bf16 a[20:23], v[112:115], v[64:67], a[20:23]
  ds_read_b64_tr_b16 v[96:97], v21 offset:8
  v_mfma_f32_16x16x32_bf16 a[24:27], v[116:119], v[64:67], a[24:27]
  ds_read_b64_tr_b16 v[98:99], v21 offset:4104
  v_mfma_f32_16x16x32_bf16 a[28:31], v[120:123], v[64:67], a[28:31]
  ds_read_b128 v[36:39], v15 offset:36864
  v_mfma_f32_16x16x32_bf16 a[32:35], v[108:111], v[68:71], a[32:35]
  ds_read_b64_tr_b16 v[100:101], v22 offset:0
  v_mfma_f32_16x16x32_bf16 a[36:39], v[112:115], v[68:71], a[36:39]
  ds_read_b64_tr_b16 v[102:103], v22 offset:4096
  v_mfma_f32_16x16x32_bf16 a[40:43], v[116:119], v[68:71], a[40:43]
  ds_read_b128 v[40:43], v15 offset:38912
  v_mfma_f32_16x16x32_bf16 a[44:47], v[120:123], v[68:71], a[44:47]
  ds_read_b64_tr_b16 v[104:105], v22 offset:8
  v_mfma_f32_16x16x32_bf16 a[48:51], v[108:111], v[72:75], a[48:51]
  ds_read_b64_tr_b16 v[106:107], v22 offset:4104
  v_mfma_f32_16x16x32_bf16 a[52:55], v[112:115], v[72:75], a[52:55]
  ds_read_b128 v[44:47], v15 offset:40960
  v_mfma_f32_16x16x32_bf16 a[56:59], v[116:119], v[72:75], a[56:59]
  ds_read_b128 v[48:51], v15 offset:43008
  v_mfma_f32_16x16x32_bf16 a[60:63], v[120:123], v[72:75], a[60:63]
  ds_read_b128 v[52:55], v15 offset:45056
  v_mfma_f32_16x16x32_bf16 a[64:67], v[108:111], v[76:79], a[64:67]
  ds_read_b128 v[56:59], v15 offset:47104
  v_mfma_f32_16x16x32_bf16 a[68:71], v[112:115], v[76:79], a[68:71]
  v_mfma_f32_16x16x32_bf16 a[72:75], v[116:119], v[76:79], a[72:75]
  v_mfma_f32_16x16x32_bf16 a[76:79], v[120:123], v[76:79], a[76:79]
  v_mfma_f32_16x16x32_bf16 a[80:83], v[108:111], v[80:83], a[80:83]
  v_mfma_f32_16x16x32_bf16 a[84:87], v[112:115], v[80:83], a[84:87]
  v_mfma_f32_16x16x32_bf16 a[88:91], v[116:119], v[80:83], a[88:91]
  v_mfma_f32_16x16x32_bf16 a[92:95], v[120:123], v[80:83], a[92:95]
  v_mfma_f32_16x16x32_bf16 a[96:99], v[108:111], v[84:87], a[96:99]
  v_mfma_f32_16x16x32_bf16 a[100:103], v[112:115], v[84:87], a[100:103]
  v_mfma_f32_16x16x32_bf16 a[104:107], v[116:119], v[84:87], a[104:107]
  v_mfma_f32_16x16x32_bf16 a[108:111], v[120:123], v[84:87], a[108:111]
  v_mfma_f32_16x16x32_bf16 a[112:115], v[108:111], v[88:91], a[112:115]
  v_mfma_f32_16x16x32_bf16 a[116:119], v[112:115], v[88:91], a[116:119]
  v_mfma_f32_16x16x32_bf16 a[120:123], v[116:119], v[88:91], a[120:123]
  v_mfma_f32_16x16x32_bf16 a[124:127], v[120:123], v[88:91], a[124:127]
  s_waitcnt lgkmcnt(0)
  v_mfma_f32_16x16x32_bf16 a[0:3], v[92:95], v[28:31], a[0:3]
  ds_read_b128 v[60:63], v15 offset:33792
  v_mfma_f32_16x16x32_bf16 a[4:7], v[96:99], v[28:31], a[4:7]
  ds_read_b64_tr_b16 v[108:109], v21 offset:8192
  v_mfma_f32_16x16x32_bf16 a[8:11], v[100:103], v[28:31], a[8:11]
  ds_read_b64_tr_b16 v[110:111], v21 offset:12288
  v_mfma_f32_16x16x32_bf16 a[12:15], v[104:107], v[28:31], a[12:15]
  ds_read_b128 v[64:67], v15 offset:35840
  v_mfma_f32_16x16x32_bf16 a[16:19], v[92:95], v[32:35], a[16:19]
  ds_read_b64_tr_b16 v[112:113], v21 offset:8200
  v_mfma_f32_16x16x32_bf16 a[20:23], v[96:99], v[32:35], a[20:23]
  ds_read_b64_tr_b16 v[114:115], v21 offset:12296
  v_mfma_f32_16x16x32_bf16 a[24:27], v[100:103], v[32:35], a[24:27]
  ds_read_b128 v[68:71], v15 offset:37888
  v_mfma_f32_16x16x32_bf16 a[28:31], v[104:107], v[32:35], a[28:31]
  ds_read_b64_tr_b16 v[116:117], v22 offset:8192
  v_mfma_f32_16x16x32_bf16 a[32:35], v[92:95], v[36:39], a[32:35]
  ds_read_b64_tr_b16 v[118:119], v22 offset:12288
  v_mfma_f32_16x16x32_bf16 a[36:39], v[96:99], v[36:39], a[36:39]
  ds_read_b128 v[72:75], v15 offset:39936
  v_mfma_f32_16x16x32_bf16 a[40:43], v[100:103], v[36:39], a[40:43]
  ds_read_b64_tr_b16 v[120:121], v22 offset:8200
  v_mfma_f32_16x16x32_bf16 a[44:47], v[104:107], v[36:39], a[44:47]
  ds_read_b64_tr_b16 v[122:123], v22 offset:12296
  v_mfma_f32_16x16x32_bf16 a[48:51], v[92:95], v[40:43], a[48:51]
  ds_read_b128 v[76:79], v15 offset:41984
  v_mfma_f32_16x16x32_bf16 a[52:55], v[96:99], v[40:43], a[52:55]
  ds_read_b128 v[80:83], v15 offset:44032
  v_mfma_f32_16x16x32_bf16 a[56:59], v[100:103], v[40:43], a[56:59]
  ds_read_b128 v[84:87], v15 offset:46080
  v_mfma_f32_16x16x32_bf16 a[60:63], v[104:107], v[40:43], a[60:63]
  ds_read_b128 v[88:91], v15 offset:48128
  v_mfma_f32_16x16x32_bf16 a[64:67], v[92:95], v[44:47], a[64:67]
  v_mfma_f32_16x16x32_bf16 a[68:71], v[96:99], v[44:47], a[68:71]
  v_mfma_f32_16x16x32_bf16 a[72:75], v[100:103], v[44:47], a[72:75]
  v_mfma_f32_16x16x32_bf16 a[76:79], v[104:107], v[44:47], a[76:79]
  v_mfma_f32_16x16x32_bf16 a[80:83], v[92:95], v[48:51], a[80:83]
  v_mfma_f32_16x16x32_bf16 a[84:87], v[96:99], v[48:51], a[84:87]
  v_mfma_f32_16x16x32_bf16 a[88:91], v[100:103], v[48:51], a[88:91]
  v_mfma_f32_16x16x32_bf16 a[92:95], v[104:107], v[48:51], a[92:95]
  v_mfma_f32_16x16x32_bf16 a[96:99], v[92:95], v[52:55], a[96:99]
  v_mfma_f32_16x16x32_bf16 a[100:103], v[96:99], v[52:55], a[100:103]
  v_mfma_f32_16x16x32_bf16 a[104:107], v[100:103], v[52:55], a[104:107]
  v_mfma_f32_16x16x32_bf16 a[108:111], v[104:107], v[52:55], a[108:111]
  v_mfma_f32_16x16x32_bf16 a[112:115], v[92:95], v[56:59], a[112:115]
  v_mfma_f32_16x16x32_bf16 a[116:119], v[96:99], v[56:59], a[116:119]
  v_mfma_f32_16x16x32_bf16 a[120:123], v[100:103], v[56:59], a[120:123]
  v_mfma_f32_16x16x32_bf16 a[124:127], v[104:107], v[56:59], a[124:127]
  s_waitcnt lgkmcnt(0)
  v_mfma_f32_16x16x32_bf16 a[0:3], v[108:111], v[60:63], a[0:3]
  s_waitcnt vmcnt(0)
  s_barrier
  v_mfma_f32_16x16x32_bf16 a[4:7], v[112:115], v[60:63], a[4:7]
  ds_read_b128 v[28:31], v14 offset:0
  v_mfma_f32_16x16x32_bf16 a[8:11], v[116:119], v[60:63], a[8:11]
  ds_read_b64_tr_b16 v[92:93], v17 offset:32768
  v_mfma_f32_16x16x32_bf16 a[12:15], v[120:123], v[60:63], a[12:15]
  ds_read_b64_tr_b16 v[94:95], v17 offset:36864
  v_mfma_f32_16x16x32_bf16 a[16:19], v[108:111], v[64:67], a[16:19]
  ds_read_b128 v[32:35], v14 offset:2048
  v_mfma_f32_16x16x32_bf16 a[20:23], v[112:115], v[64:67], a[20:23]
  ds_read_b64_tr_b16 v[96:97], v17 offset:32776
  v_mfma_f32_16x16x32_bf16 a[24:27], v[116:119], v[64:67], a[24:27]
  ds_read_b64_tr_b16 v[98:99], v17 offset:36872
  v_mfma_f32_16x16x32_bf16 a[28:31], v[120:123], v[64:67], a[28:31]
  ds_read_b128 v[36:39], v14 offset:4096
  v_mfma_f32_16x16x32_bf16 a[32:35], v[108:111], v[68:71], a[32:35]
  ds_read_b64_tr_b16 v[100:101], v18 offset:32768
  v_mfma_f32_16x16x32_bf16 a[36:39], v[112:115], v[68:71], a[36:39]
  ds_read_b64_tr_b16 v[102:103], v18 offset:36864
  v_mfma_f32_16x16x32_bf16 a[40:43], v[116:119], v[68:71], a[40:43]
  ds_read_b128 v[40:43], v14 offset:6144
  v_mfma_f32_16x16x32_bf16 a[44:47], v[120:123], v[68:71], a[44:47]
  ds_read_b64_tr_b16 v[104:105], v18 offset:32776
  v_mfma_f32_16x16x32_bf16 a[48:51], v[108:111], v[72:75], a[48:51]
  ds_read_b64_tr_b16 v[106:107], v18 offset:36872
  v_mfma_f32_16x16x32_bf16 a[52:55], v[112:115], v[72:75], a[52:55]
  ds_read_b128 v[44:47], v14 offset:8192
  v_mfma_f32_16x16x32_bf16 a[56:59], v[116:119], v[72:75], a[56:59]
  ds_read_b128 v[48:51], v14 offset:10240
  v_mfma_f32_16x16x32_bf16 a[60:63], v[120:123], v[72:75], a[60:63]
  ds_read_b128 v[52:55], v14 offset:12288
  v_mfma_f32_16x16x32_bf16 a[64:67], v[108:111], v[76:79], a[64:67]
  ds_read_b128 v[56:59], v14 offset:14336
  v_mfma_f32_16x16x32_bf16 a[68:71], v[112:115], v[76:79], a[68:71]
  v_mfma_f32_16x16x32_bf16 a[72:75], v[116:119], v[76:79], a[72:75]
  v_mfma_f32_16x16x32_bf16 a[76:79], v[120:123], v[76:79], a[76:79]
  v_mfma_f32_16x16x32_bf16 a[80:83], v[108:111], v[80:83], a[80:83]
  v_mfma_f32_16x16x32_bf16 a[84:87], v[112:115], v[80:83], a[84:87]
  v_mfma_f32_16x16x32_bf16 a[88:91], v[116:119], v[80:83], a[88:91]
  v_mfma_f32_16x16x32_bf16 a[92:95], v[120:123], v[80:83], a[92:95]
  v_mfma_f32_16x16x32_bf16 a[96:99], v[108:111], v[84:87], a[96:99]
  v_mfma_f32_16x16x32_bf16 a[100:103], v[112:115], v[84:87], a[100:103]
  v_mfma_f32_16x16x32_bf16 a[104:107], v[116:119], v[84:87], a[104:107]
  v_mfma_f32_16x16x32_bf16 a[108:111], v[120:123], v[84:87], a[108:111]
  v_mfma_f32_16x16x32_bf16 a[112:115], v[108:111], v[88:91], a[112:115]
  v_mfma_f32_16x16x32_bf16 a[116:119], v[112:115], v[88:91], a[116:119]
  v_mfma_f32_16x16x32_bf16 a[120:123], v[116:119], v[88:91], a[120:123]
  v_mfma_f32_16x16x32_bf16 a[124:127], v[120:123], v[88:91], a[124:127]
  s_waitcnt lgkmcnt(0)
  v_mfma_f32_16x16x32_bf16 a[0:3], v[92:95], v[28:31], a[0:3]
  ds_read_b128 v[60:63], v14 offset:1024
  v_mfma_f32_16x16x32_bf16 a[4:7], v[96:99], v[28:31], a[4:7]
  ds_read_b64_tr_b16 v[108:109], v17 offset:40960
  v_mfma_f32_16x16x32_bf16 a[8:11], v[100:103], v[28:31], a[8:11]
  ds_read_b64_tr_b16 v[110:111], v17 offset:45056
  v_mfma_f32_16x16x32_bf16 a[12:15], v[104:107], v[28:31], a[12:15]
  ds_read_b128 v[64:67], v14 offset:3072
  v_mfma_f32_16x16x32_bf16 a[16:19], v[92:95], v[32:35], a[16:19]
  ds_read_b64_tr_b16 v[112:113], v17 offset:40968
  v_mfma_f32_16x16x32_bf16 a[20:23], v[96:99], v[32:35], a[20:23]
  ds_read_b64_tr_b16 v[114:115], v17 offset:45064
  v_mfma_f32_16x16x32_bf16 a[24:27], v[100:103], v[32:35], a[24:27]
  ds_read_b128 v[68:71], v14 offset:5120
  v_mfma_f32_16x16x32_bf16 a[28:31], v[104:107], v[32:35], a[28:31]
  ds_read_b64_tr_b16 v[116:117], v18 offset:40960
  v_mfma_f32_16x16x32_bf16 a[32:35], v[92:95], v[36:39], a[32:35]
  ds_read_b64_tr_b16 v[118:119], v18 offset:45056
  v_mfma_f32_16x16x32_bf16 a[36:39], v[96:99], v[36:39], a[36:39]
  ds_read_b128 v[72:75], v14 offset:7168
  v_mfma_f32_16x16x32_bf16 a[40:43], v[100:103], v[36:39], a[40:43]
  ds_read_b64_tr_b16 v[120:121], v18 offset:40968
  v_mfma_f32_16x16x32_bf16 a[44:47], v[104:107], v[36:39], a[44:47]
  ds_read_b64_tr_b16 v[122:123], v18 offset:45064
  v_mfma_f32_16x16x32_bf16 a[48:51], v[92:95], v[40:43], a[48:51]
  ds_read_b128 v[76:79], v14 offset:9216
  v_mfma_f32_16x16x32_bf16 a[52:55], v[96:99], v[40:43], a[52:55]
  ds_read_b128 v[80:83], v14 offset:11264
  v_mfma_f32_16x16x32_bf16 a[56:59], v[100:103], v[40:43], a[56:59]
  ds_read_b128 v[84:87], v14 offset:13312
  v_mfma_f32_16x16x32_bf16 a[60:63], v[104:107], v[40:43], a[60:63]
  ds_read_b128 v[88:91], v14 offset:15360
  v_mfma_f32_16x16x32_bf16 a[64:67], v[92:95], v[44:47], a[64:67]
  v_mfma_f32_16x16x32_bf16 a[68:71], v[96:99], v[44:47], a[68:71]
  v_mfma_f32_16x16x32_bf16 a[72:75], v[100:103], v[44:47], a[72:75]
  v_mfma_f32_16x16x32_bf16 a[76:79], v[104:107], v[44:47], a[76:79]
  v_mfma_f32_16x16x32_bf16 a[80:83], v[92:95], v[48:51], a[80:83]
  v_mfma_f32_16x16x32_bf16 a[84:87], v[96:99], v[48:51], a[84:87]
  v_mfma_f32_16x16x32_bf16 a[88:91], v[100:103], v[48:51], a[88:91]
  v_mfma_f32_16x16x32_bf16 a[92:95], v[104:107], v[48:51], a[92:95]
  v_mfma_f32_16x16x32_bf16 a[96:99], v[92:95], v[52:55], a[96:99]
  v_mfma_f32_16x16x32_bf16 a[100:103], v[96:99], v[52:55], a[100:103]
  v_mfma_f32_16x16x32_bf16 a[104:107], v[100:103], v[52:55], a[104:107]
  v_mfma_f32_16x16x32_bf16 a[108:111], v[104:107], v[52:55], a[108:111]
  v_mfma_f32_16x16x32_bf16 a[112:115], v[92:95], v[56:59], a[112:115]
  v_mfma_f32_16x16x32_bf16 a[116:119], v[96:99], v[56:59], a[116:119]
  v_mfma_f32_16x16x32_bf16 a[120:123], v[100:103], v[56:59], a[120:123]
  v_mfma_f32_16x16x32_bf16 a[124:127], v[104:107], v[56:59], a[124:127]
  s_waitcnt lgkmcnt(0)
  v_mfma_f32_16x16x32_bf16 a[0:3], v[108:111], v[60:63], a[0:3]
  v_mfma_f32_16x16x32_bf16 a[4:7], v[112:115], v[60:63], a[4:7]
  v_mfma_f32_16x16x32_bf16 a[8:11], v[116:119], v[60:63], a[8:11]
  v_mfma_f32_16x16x32_bf16 a[12:15], v[120:123], v[60:63], a[12:15]
  v_mfma_f32_16x16x32_bf16 a[16:19], v[108:111], v[64:67], a[16:19]
  v_mfma_f32_16x16x32_bf16 a[20:23], v[112:115], v[64:67], a[20:23]
  v_mfma_f32_16x16x32_bf16 a[24:27], v[116:119], v[64:67], a[24:27]
  v_mfma_f32_16x16x32_bf16 a[28:31], v[120:123], v[64:67], a[28:31]
  v_mfma_f32_16x16x32_bf16 a[32:35], v[108:111], v[68:71], a[32:35]
  v_mfma_f32_16x16x32_bf16 a[36:39], v[112:115], v[68:71], a[36:39]
  v_mfma_f32_16x16x32_bf16 a[40:43], v[116:119], v[68:71], a[40:43]
  v_mfma_f32_16x16x32_bf16 a[44:47], v[120:123], v[68:71], a[44:47]
  v_mfma_f32_16x16x32_bf16 a[48:51], v[108:111], v[72:75], a[48:51]
  v_mfma_f32_16x16x32_bf16 a[52:55], v[112:115], v[72:75], a[52:55]
  v_mfma_f32_16x16x32_bf16 a[56:59], v[116:119], v[72:75], a[56:59]
  v_mfma_f32_16x16x32_bf16 a[60:63], v[120:123], v[72:75], a[60:63]
  v_mfma_f32_16x16x32_bf16 a[64:67], v[108:111], v[76:79], a[64:67]
  v_mfma_f32_16x16x32_bf16 a[68:71], v[112:115], v[76:79], a[68:71]
  v_mfma_f32_16x16x32_bf16 a[72:75], v[116:119], v[76:79], a[72:75]
  v_mfma_f32_16x16x32_bf16 a[76:79], v[120:123], v[76:79], a[76:79]
  v_mfma_f32_16x16x32_bf16 a[80:83], v[108:111], v[80:83], a[80:83]
  v_mfma_f32_16x16x32_bf16 a[84:87], v[112:115], v[80:83], a[84:87]
  v_mfma_f32_16x16x32_bf16 a[88:91], v[116:119], v[80:83], a[88:91]
  v_mfma_f32_16x16x32_bf16 a[92:95], v[120:123], v[80:83], a[92:95]
  v_mfma_f32_16x16x32_bf16 a[96:99], v[108:111], v[84:87], a[96:99]
  v_mfma_f32_16x16x32_bf16 a[100:103], v[112:115], v[84:87], a[100:103]
  v_mfma_f32_16x16x32_bf16 a[104:107], v[116:119], v[84:87], a[104:107]
  v_mfma_f32_16x16x32_bf16 a[108:111], v[120:123], v[84:87], a[108:111]
  v_mfma_f32_16x16x32_bf16 a[112:115], v[108:111], v[88:91], a[112:115]
  v_mfma_f32_16x16x32_bf16 a[116:119], v[112:115], v[88:91], a[116:119]
  v_mfma_f32_16x16x32_bf16 a[120:123], v[116:119], v[88:91], a[120:123]
  v_mfma_f32_16x16x32_bf16 a[124:127], v[120:123], v[88:91], a[124:127]
  s_mov_b32 s59, 6
  s_mov_b32 s60, s22
  s_mov_b32 s61, s26
  s_add_u32 s62, s38, 0x3d00000
  s_mov_b32 s63, s98
  s_cmp_eq_u32 s35, 16
  s_cselect_b32 s90, 999, s34
  s_cmp_lt_u32 s90, 242
  s_cbranch_scc1 L_got
  s_mov_b32 s58, 3
  s_branch L_epi
L_g3c:
  v_and_b32 v1, 63, v0
  v_lshrrev_b32 v16, 6, v0
  s_nop 0
  v_readfirstlane_b32 s27, v16
  s_mul_i32 s90, s27, 1
  s_mul_i32 s90, s90, s23
  v_mov_b32 v2, 0x0
  v_bfe_u32 v17, v1, 0, 6
  v_lshl_add_u32 v2, v17, 4, v2
  v_add_u32 v2, s90, v2
  v_mov_b32 v3, 0x400
  v_bfe_u32 v17, v1, 0, 6
  v_lshl_add_u32 v3, v17, 4, v3
  v_add_u32 v3, s90, v3
  v_mov_b32 v4, 0x1000
  v_bfe_u32 v17, v1, 0, 6
  v_lshl_add_u32 v4, v17, 4, v4
  v_add_u32 v4, s90, v4
  v_mov_b32 v5, 0x1400
  v_bfe_u32 v17, v1, 0, 6
  v_lshl_add_u32 v5, v17, 4, v5
  v_add_u32 v5, s90, v5
  s_mul_i32 s90, s27, 16
  v_lshrrev_b32 v16, 4, v1
  v_add_u32 v16, 0, v16
  v_add_u32 v16, s90, v16
  v_and_b32 v17, 7, v16
  v_lshlrev_b32 v17, 1, v17
  v_xor_b32 v17, v17, v1
  v_and_b32 v17, 15, v17
  v_mul_lo_u32 v16, v16, s24
  v_lshl_add_u32 v6, v17, 4, v16
  v_lshrrev_b32 v16, 4, v1
  v_add_u32 v16, 4, v16
  v_add_u32 v16, s90, v16
  v_and_b32 v17, 7, v16
  v_lshlrev_b32 v17, 1, v17
  v_xor_b32 v17, v17, v1
  v_and_b32 v17, 15, v17
  v_mul_lo_u32 v16, v16, s24
  v_lshl_add_u32 v7, v17, 4, v16
  v_lshrrev_b32 v16, 4, v1
  v_add_u32 v16, 8, v16
  v_add_u32 v16, s90, v16
  v_and_b32 v17, 7, v16
  v_lshlrev_b32 v17, 1, v17
  v_xor_b32 v17, v17, v1
  v_and_b32 v17, 15, v17
  v_mul_lo_u32 v16, v16, s24
  v_lshl_add_u32 v8, v17, 4, v16
  v_lshrrev_b32 v16, 4, v1
  v_add_u32 v16, 12, v16
  v_add_u32 v16, s90, v16
  v_and_b32 v17, 7, v16
  v_lshlrev_b32 v17, 1, v17
  v_xor_b32 v17, v17, v1
  v_and_b32 v17, 15, v17
  v_mul_lo_u32 v16, v16, s24
  v_lshl_add_u32 v9, v17, 4, v16
  s_mul_i32 s51, s24, 64
  s_mul_i32 s52, s27, 4096
  s_mul_i32 s53, s27, 4096
  s_add_u32 s53, s53, 16384
  s_add_u32 m0, s53, 0
  s_nop 0
  buffer_load_dwordx4 v6, s[12:15], s21 offen  lds
  s_add_u32 m0, s53, 1024
  s_nop 0
  buffer_load_dwordx4 v7, s[12:15], s21 offen  lds
  s_add_u32 m0, s53, 2048
  s_nop 0
  buffer_load_dwordx4 v8, s[12:15], s21 offen  lds
  s_add_u32 m0, s53, 3072
  s_nop 0
  buffer_load_dwordx4 v9, s[12:15], s21 offen  lds
  s_add_u32 s21, s21, s51
  s_add_u32 m0, s53, 32768
  s_nop 0
  buffer_load_dwordx4 v6, s[12:15], s21 offen  lds
  s_add_u32 m0, s53, 33792
  s_nop 0
  buffer_load_dwordx4 v7, s[12:15], s21 offen  lds
  s_add_u32 m0, s53, 34816
  s_nop 0
  buffer_load_dwordx4 v8, s[12:15], s21 offen  lds
  s_add_u32 m0, s53, 35840
  s_nop 0
  buffer_load_dwordx4 v9, s[12:15], s21 offen  lds
  s_add_u32 s21, s21, s51
  s_add_u32 m0, s53, 65536
  s_nop 0
  buffer_load_dwordx4 v6, s[12:15], s21 offen  lds
  s_add_u32 m0, s53, 66560
  s_nop 0
  buffer_load_dwordx4 v7, s[12:15], s21 offen  lds
  s_add_u32 m0, s53, 67584
  s_nop 0
  buffer_load_dwordx4 v8, s[12:15], s21 offen  lds
  s_add_u32 m0, s53, 68608
  s_nop 0
  buffer_load_dwordx4 v9, s[12:15], s21 offen  lds
  s_add_u32 s21, s21, s51
  s_add_u32 m0, s53, 98304
  s_nop 0
  buffer_load_dwordx4 v6, s[12:15], s21 offen  lds
  s_add_u32 m0, s53, 99328
  s_nop 0
  buffer_load_dwordx4 v7, s[12:15], s21 offen  lds
  s_add_u32 m0, s53, 100352
  s_nop 0
  buffer_load_dwordx4 v8, s[12:15], s21 offen  lds
  s_add_u32 m0, s53, 101376
  s_nop 0
  buffer_load_dwordx4 v9, s[12:15], s21 offen  lds
  s_add_u32 s21, s21, s51
  s_cmp_lg_u32 s32, 0
  s_cbranch_scc1 L_dd_104
  v_mov_b32 v228, 0x3d00000
L_dw_103:
  buffer_load_dword v234, v228, s[4:7], s40 offen offset:0 sc1
  buffer_load_dword v235, v228, s[4:7], s42 offen offset:0 sc1
  s_waitcnt vmcnt(0)
  s_mov_b32 s44, 1
  v_readfirstlane_b32 s45, v234
  s_cmp_ge_u32 s45, s41
  s_cselect_b32 s44, s44, 0
  v_readfirstlane_b32 s45, v235
  s_cmp_ge_u32 s45, s41
  s_cselect_b32 s44, s44, 0
  s_cmp_eq_u32 s44, 1
  s_cbranch_scc1 L_dd_104
  s_sleep 3
  s_add_u32 s3, s3, 1
  s_cmp_lt_u32 s3, 131072
  s_cbranch_scc1 L_dw_103
L_dd_104:
  s_barrier
  s_add_u32 m0, s52, 0
  s_nop 0
  buffer_load_dwordx4 v2, s[8:11], s20 offen sc1 lds
  s_add_u32 m0, s52, 1024
  s_nop 0
  buffer_load_dwordx4 v3, s[8:11], s20 offen sc1 lds
  s_add_u32 m0, s52, 2048
  s_nop 0
  buffer_load_dwordx4 v4, s[8:11], s20 offen sc1 lds
  s_add_u32 m0, s52, 3072
  s_nop 0
  buffer_load_dwordx4 v5, s[8:11], s20 offen sc1 lds
  s_add_u32 s20, s20, 2048
  s_add_u32 m0, s52, 32768
  s_nop 0
  buffer_load_dwordx4 v2, s[8:11], s20 offen sc1 lds
  s_add_u32 m0, s52, 33792
  s_nop 0
  buffer_load_dwordx4 v3, s[8:11], s20 offen sc1 lds
  s_add_u32 m0, s52, 34816
  s_nop 0
  buffer_load_dwordx4 v4, s[8:11], s20 offen sc1 lds
  s_add_u32 m0, s52, 35840
  s_nop 0
  buffer_load_dwordx4 v5, s[8:11], s20 offen sc1 lds
  s_add_u32 s20, s20, 6144
  s_add_u32 m0, s52, 65536
  s_nop 0
  buffer_load_dwordx4 v2, s[8:11], s20 offen sc1 lds
  s_add_u32 m0, s52, 66560
  s_nop 0
  buffer_load_dwordx4 v3, s[8:11], s20 offen sc1 lds
  s_add_u32 m0, s52, 67584
  s_nop 0
  buffer_load_dwordx4 v4, s[8:11], s20 offen sc1 lds
  s_add_u32 m0, s52, 68608
  s_nop 0
  buffer_load_dwordx4 v5, s[8:11], s20 offen sc1 lds
  s_add_u32 s20, s20, 2048
  s_add_u32 m0, s52, 98304
  s_nop 0
  buffer_load_dwordx4 v2, s[8:11], s20 offen sc1 lds
  s_add_u32 m0, s52, 99328
  s_nop 0
  buffer_load_dwordx4 v3, s[8:11], s20 offen sc1 lds
  s_add_u32 m0, s52, 100352
  s_nop 0
  buffer_load_dwordx4 v4, s[8:11], s20 offen sc1 lds
  s_add_u32 m0, s52, 101376
  s_nop 0
  buffer_load_dwordx4 v5, s[8:11], s20 offen sc1 lds
  s_add_u32 s20, s20, 6144
  s_lshr_b32 s90, s27, 1
  s_and_b32 s91, s27, 1
  s_mul_i32 s92, s90, 8192
  v_mov_b32 v10, 0x0
  v_bfe_u32 v17, v1, 0, 6
  v_lshl_add_u32 v10, v17, 4, v10
  v_add_u32 v10, s92, v10
  v_add_u32 v11, 65536, v10
  v_mov_b32 v16, 0x0
  v_bfe_u32 v17, v1, 2, 2
  v_lshl_add_u32 v16, v17, 8, v16
  v_bfe_u32 v17, v1, 4, 2
  v_lshl_add_u32 v16, v17, 10, v16
  v_bfe_u32 v17, v1, 0, 1
  v_lshl_add_u32 v16, v17, 4, v16
  v_bfe_u32 v18, v1, 2, 3
  v_bfe_u32 v17, v1, 1, 1
  v_xor_b32 v18, v18, v17
  s_mul_i32 s92, s91, 4
  s_add_u32 s93, s92, 0
  v_xor_b32 v17, s93, v18
  v_lshl_add_u32 v12, v17, 5, v16
  v_add_u32 v14, 65536, v12
  s_add_u32 s93, s92, 2
  v_xor_b32 v17, s93, v18
  v_lshl_add_u32 v13, v17, 5, v16
  v_add_u32 v15, 65536, v13
  s_waitcnt vmcnt(12)
  s_barrier
  ds_read_b128 v[20:23], v10 offset:0
  ds_read_b64_tr_b16 v[52:53], v12 offset:16384
  ds_read_b64_tr_b16 v[54:55], v12 offset:20480
  ds_read_b128 v[24:27], v10 offset:2048
  ds_read_b64_tr_b16 v[56:57], v12 offset:16392
  ds_read_b64_tr_b16 v[58:59], v12 offset:20488
  ds_read_b128 v[28:31], v10 offset:4096
  ds_read_b64_tr_b16 v[60:61], v13 offset:16384
  ds_read_b64_tr_b16 v[62:63], v13 offset:20480
  ds_read_b128 v[32:35], v10 offset:6144
  ds_read_b64_tr_b16 v[64:65], v13 offset:16392
  ds_read_b64_tr_b16 v[66:67], v13 offset:20488
  s_sub_u32 s25, s25, 1
  s_waitcnt lgkmcnt(0)
  v_mfma_f32_16x16x32_bf16 a[0:3], v[52:55], v[20:23], 0
  ds_read_b128 v[36:39], v10 offset:1024
  v_mfma_f32_16x16x32_bf16 a[4:7], v[56:59], v[20:23], 0
  ds_read_b64_tr_b16 v[68:69], v12 offset:24576
  v_mfma_f32_16x16x32_bf16 a[8:11], v[60:63], v[20:23], 0
  ds_read_b64_tr_b16 v[70:71], v12 offset:28672
  v_mfma_f32_16x16x32_bf16 a[12:15], v[64:67], v[20:23], 0
  ds_read_b128 v[40:43], v10 offset:3072
  v_mfma_f32_16x16x32_bf16 a[16:19], v[52:55], v[24:27], 0
  ds_read_b64_tr_b16 v[72:73], v12 offset:24584
  v_mfma_f32_16x16x32_bf16 a[20:23], v[56:59], v[24:27], 0
  ds_read_b64_tr_b16 v[74:75], v12 offset:28680
  v_mfma_f32_16x16x32_bf16 a[24:27], v[60:63], v[24:27], 0
  ds_read_b128 v[44:47], v10 offset:5120
  v_mfma_f32_16x16x32_bf16 a[28:31], v[64:67], v[24:27], 0
  ds_read_b64_tr_b16 v[76:77], v13 offset:24576
  v_mfma_f32_16x16x32_bf16 a[32:35], v[52:55], v[28:31], 0
  ds_read_b64_tr_b16 v[78:79], v13 offset:28672
  v_mfma_f32_16x16x32_bf16 a[36:39], v[56:59], v[28:31], 0
  ds_read_b128 v[48:51], v10 offset:7168
  v_mfma_f32_16x16x32_bf16 a[40:43], v[60:63], v[28:31], 0
  ds_read_b64_tr_b16 v[80:81], v13 offset:24584
  v_mfma_f32_16x16x32_bf16 a[44:47], v[64:67], v[28:31], 0
  ds_read_b64_tr_b16 v[82:83], v13 offset:28680
  v_mfma_f32_16x16x32_bf16 a[48:51], v[52:55], v[32:35], 0
  v_mfma_f32_16x16x32_bf16 a[52:55], v[56:59], v[32:35], 0
  v_mfma_f32_16x16x32_bf16 a[56:59], v[60:63], v[32:35], 0
  v_mfma_f32_16x16x32_bf16 a[60:63], v[64:67], v[32:35], 0
  s_waitcnt lgkmcnt(0)
  v_mfma_f32_16x16x32_bf16 a[0:3], v[68:71], v[36:39], a[0:3]
  s_waitcnt vmcnt(8)
  s_barrier
  s_add_u32 m0, s52, 0
  v_mfma_f32_16x16x32_bf16 a[4:7], v[72:75], v[36:39], a[4:7]
  buffer_load_dwordx4 v2, s[8:11], s20 offen sc1 lds
  ds_read_b128 v[20:23], v10 offset:32768
  v_mfma_f32_16x16x32_bf16 a[8:11], v[76:79], v[36:39], a[8:11]
  ds_read_b64_tr_b16 v[52:53], v12 offset:49152
  v_mfma_f32_16x16x32_bf16 a[12:15], v[80:83], v[36:39], a[12:15]
  ds_read_b64_tr_b16 v[54:55], v12 offset:53248
  s_add_u32 m0, s53, 0
  v_mfma_f32_16x16x32_bf16 a[16:19], v[68:71], v[40:43], a[16:19]
  buffer_load_dwordx4 v6, s[12:15], s21 offen  lds
  ds_read_b128 v[24:27], v10 offset:34816
  v_mfma_f32_16x16x32_bf16 a[20:23], v[72:75], v[40:43], a[20:23]
  ds_read_b64_tr_b16 v[56:57], v12 offset:49160
  v_mfma_f32_16x16x32_bf16 a[24:27], v[76:79], v[40:43], a[24:27]
  ds_read_b64_tr_b16 v[58:59], v12 offset:53256
  s_add_u32 m0, s52, 1024
  v_mfma_f32_16x16x32_bf16 a[28:31], v[80:83], v[40:43], a[28:31]
  buffer_load_dwordx4 v3, s[8:11], s20 offen sc1 lds
  ds_read_b128 v[28:31], v10 offset:36864
  v_mfma_f32_16x16x32_bf16 a[32:35], v[68:71], v[44:47], a[32:35]
  ds_read_b64_tr_b16 v[60:61], v13 offset:49152
  v_mfma_f32_16x16x32_bf16 a[36:39], v[72:75], v[44:47], a[36:39]
  ds_read_b64_tr_b16 v[62:63], v13 offset:53248
  s_add_u32 m0, s53, 1024
  v_mfma_f32_16x16x32_bf16 a[40:43], v[76:79], v[44:47], a[40:43]
  buffer_load_dwordx4 v7, s[12:15], s21 offen  lds
  ds_read_b128 v[32:35], v10 offset:38912
  v_mfma_f32_16x16x32_bf16 a[44:47], v[80:83], v[44:47], a[44:47]
  ds_read_b64_tr_b16 v[64:65], v13 offset:49160
  v_mfma_f32_16x16x32_bf16 a[48:51], v[68:71], v[48:51], a[48:51]
  ds_read_b64_tr_b16 v[66:67], v13 offset:53256
  s_add_u32 m0, s52, 2048
  v_mfma_f32_16x16x32_bf16 a[52:55], v[72:75], v[48:51], a[52:55]
  buffer_load_dwordx4 v4, s[8:11], s20 offen sc1 lds
  v_mfma_f32_16x16x32_bf16 a[56:59], v[76:79], v[48:51], a[56:59]
  v_mfma_f32_16x16x32_bf16 a[60:63], v[80:83], v[48:51], a[60:63]
  s_waitcnt lgkmcnt(0)
  s_add_u32 m0, s53, 2048
  v_mfma_f32_16x16x32_bf16 a[0:3], v[52:55], v[20:23], a[0:3]
  buffer_load_dwordx4 v8, s[12:15], s21 offen  lds
  ds_read_b128 v[36:39], v10 offset:33792
  v_mfma_f32_16x16x32_bf16 a[4:7], v[56:59], v[20:23], a[4:7]
  ds_read_b64_tr_b16 v[68:69], v12 offset:57344
  v_mfma_f32_16x16x32_bf16 a[8:11], v[60:63], v[20:23], a[8:11]
  ds_read_b64_tr_b16 v[70:71], v12 offset:61440
  v_mfma_f32_16x16x32_bf16 a[12:15], v[64:67], v[20:23], a[12:15]
  ds_read_b128 v[40:43], v10 offset:35840
  s_add_u32 m0, s52, 3072
  v_mfma_f32_16x16x32_bf16 a[16:19], v[52:55], v[24:27], a[16:19]
  buffer_load_dwordx4 v5, s[8:11], s20 offen sc1 lds
  ds_read_b64_tr_b16 v[72:73], v12 offset:57352
  v_mfma_f32_16x16x32_bf16 a[20:23], v[56:59], v[24:27], a[20:23]
  ds_read_b64_tr_b16 v[74:75], v12 offset:61448
  v_mfma_f32_16x16x32_bf16 a[24:27], v[60:63], v[24:27], a[24:27]
  ds_read_b128 v[44:47], v10 offset:37888
  v_mfma_f32_16x16x32_bf16 a[28:31], v[64:67], v[24:27], a[28:31]
  ds_read_b64_tr_b16 v[76:77], v13 offset:57344
  s_add_u32 m0, s53, 3072
  v_mfma_f32_16x16x32_bf16 a[32:35], v[52:55], v[28:31], a[32:35]
  buffer_load_dwordx4 v9, s[12:15], s21 offen  lds
  ds_read_b64_tr_b16 v[78:79], v13 offset:61440
  v_mfma_f32_16x16x32_bf16 a[36:39], v[56:59], v[28:31], a[36:39]
  ds_read_b128 v[48:51], v10 offset:39936
  v_mfma_f32_16x16x32_bf16 a[40:43], v[60:63], v[28:31], a[40:43]
  ds_read_b64_tr_b16 v[80:81], v13 offset:57352
  v_mfma_f32_16x16x32_bf16 a[44:47], v[64:67], v[28:31], a[44:47]
  ds_read_b64_tr_b16 v[82:83], v13 offset:61448
  s_add_u32 s20, s20, 2048
  v_mfma_f32_16x16x32_bf16 a[48:51], v[52:55], v[32:35], a[48:51]
  s_add_u32 s21, s21, s51
  v_mfma_f32_16x16x32_bf16 a[52:55], v[56:59], v[32:35], a[52:55]
  v_mfma_f32_16x16x32_bf16 a[56:59], v[60:63], v[32:35], a[56:59]
  v_mfma_f32_16x16x32_bf16 a[60:63], v[64:67], v[32:35], a[60:63]
  s_waitcnt lgkmcnt(0)
  v_mfma_f32_16x16x32_bf16 a[0:3], v[68:71], v[36:39], a[0:3]
  s_waitcnt vmcnt(12)
  s_barrier
  s_add_u32 m0, s52, 32768
  v_mfma_f32_16x16x32_bf16 a[4:7], v[72:75], v[36:39], a[4:7]
  buffer_load_dwordx4 v2, s[8:11], s20 offen sc1 lds
  ds_read_b128 v[20:23], v11 offset:0
  v_mfma_f32_16x16x32_bf16 a[8:11], v[76:79], v[36:39], a[8:11]
  ds_read_b64_tr_b16 v[52:53], v14 offset:16384
  v_mfma_f32_16x16x32_bf16 a[12:15], v[80:83], v[36:39], a[12:15]
  ds_read_b64_tr_b16 v[54:55], v14 offset:20480
  s_add_u32 m0, s53, 32768
  v_mfma_f32_16x16x32_bf16 a[16:19], v[68:71], v[40:43], a[16:19]
  buffer_load_dwordx4 v6, s[12:15], s21 offen  lds
  ds_read_b128 v[24:27], v11 offset:2048
  v_mfma_f32_16x16x32_bf16 a[20:23], v[72:75], v[40:43], a[20:23]
  ds_read_b64_tr_b16 v[56:57], v14 offset:16392
  v_mfma_f32_16x16x32_bf16 a[24:27], v[76:79], v[40:43], a[24:27]
  ds_read_b64_tr_b16 v[58:59], v14 offset:20488
  s_add_u32 m0, s52, 33792
  v_mfma_f32_16x16x32_bf16 a[28:31], v[80:83], v[40:43], a[28:31]
  buffer_load_dwordx4 v3, s[8:11], s20 offen sc1 lds
  ds_read_b128 v[28:31], v11 offset:4096
  v_mfma_f32_16x16x32_bf16 a[32:35], v[68:71], v[44:47], a[32:35]
  ds_read_b64_tr_b16 v[60:61], v15 offset:16384
  v_mfma_f32_16x16x32_bf16 a[36:39], v[72:75], v[44:47], a[36:39]
  ds_read_b64_tr_b16 v[62:63], v15 offset:20480
  s_add_u32 m0, s53, 33792
  v_mfma_f32_16x16x32_bf16 a[40:43], v[76:79], v[44:47], a[40:43]
  buffer_load_dwordx4 v7, s[12:15], s21 offen  lds
  ds_read_b128 v[32:35], v11 offset:6144
  v_mfma_f32_16x16x32_bf16 a[44:47], v[80:83], v[44:47], a[44:47]
  ds_read_b64_tr_b16 v[64:65], v15 offset:16392
  v_mfma_f32_16x16x32_bf16 a[48:51], v[68:71], v[48:51], a[48:51]
  ds_read_b64_tr_b16 v[66:67], v15 offset:20488
  s_add_u32 m0, s52, 34816
  v_mfma_f32_16x16x32_bf16 a[52:55], v[72:75], v[48:51], a[52:55]
  buffer_load_dwordx4 v4, s[8:11], s20 offen sc1 lds
  v_mfma_f32_16x16x32_bf16 a[56:59], v[76:79], v[48:51], a[56:59]
  v_mfma_f32_16x16x32_bf16 a[60:63], v[80:83], v[48:51], a[60:63]
  s_waitcnt lgkmcnt(0)
  s_add_u32 m0, s53, 34816
  v_mfma_f32_16x16x32_bf16 a[0:3], v[52:55], v[20:23], a[0:3]
  buffer_load_dwordx4 v8, s[12:15], s21 offen  lds
  ds_read_b128 v[36:39], v11 offset:1024
  v_mfma_f32_16x16x32_bf16 a[4:7], v[56:59], v[20:23], a[4:7]
  ds_read_b64_tr_b16 v[68:69], v14 offset:24576
  v_mfma_f32_16x16x32_bf16 a[8:11], v[60:63], v[20:23], a[8:11]
  ds_read_b64_tr_b16 v[70:71], v14 offset:28672
  v_mfma_f32_16x16x32_bf16 a[12:15], v[64:67], v[20:23], a[12:15]
  ds_read_b128 v[40:43], v11 offset:3072
  s_add_u32 m0, s52, 35840
  v_mfma_f32_16x16x32_bf16 a[16:19], v[52:55], v[24:27], a[16:19]
  buffer_load_dwordx4 v5, s[8:11], s20 offen sc1 lds
  ds_read_b64_tr_b16 v[72:73], v14 offset:24584
  v_mfma_f32_16x16x32_bf16 a[20:23], v[56:59], v[24:27], a[20:23]
  ds_read_b64_tr_b16 v[74:75], v14 offset:28680
  v_mfma_f32_16x16x32_bf16 a[24:27], v[60:63], v[24:27], a[24:27]
  ds_read_b128 v[44:47], v11 offset:5120
  v_mfma_f32_16x16x32_bf16 a[28:31], v[64:67], v[24:27], a[28:31]
  ds_read_b64_tr_b16 v[76:77], v15 offset:24576
  s_add_u32 m0, s53, 35840
  v_mfma_f32_16x16x32_bf16 a[32:35], v[52:55], v[28:31], a[32:35]
  buffer_load_dwordx4 v9, s[12:15], s21 offen  lds
  ds_read_b64_tr_b16 v[78:79], v15 offset:28672
  v_mfma_f32_16x16x32_bf16 a[36:39], v[56:59], v[28:31], a[36:39]
  ds_read_b128 v[48:51], v11 offset:7168
  v_mfma_f32_16x16x32_bf16 a[40:43], v[60:63], v[28:31], a[40:43]
  ds_read_b64_tr_b16 v[80:81], v15 offset:24584
  v_mfma_f32_16x16x32_bf16 a[44:47], v[64:67], v[28:31], a[44:47]
  ds_read_b64_tr_b16 v[82:83], v15 offset:28680
  s_add_u32 s20, s20, 6144
  v_mfma_f32_16x16x32_bf16 a[48:51], v[52:55], v[32:35], a[48:51]
  s_add_u32 s21, s21, s51
  v_mfma_f32_16x16x32_bf16 a[52:55], v[56:59], v[32:35], a[52:55]
  v_mfma_f32_16x16x32_bf16 a[56:59], v[60:63], v[32:35], a[56:59]
  v_mfma_f32_16x16x32_bf16 a[60:63], v[64:67], v[32:35], a[60:63]
  s_waitcnt lgkmcnt(0)
  v_mfma_f32_16x16x32_bf16 a[0:3], v[68:71], v[36:39], a[0:3]
  s_waitcnt vmcnt(16)
  s_barrier
  s_add_u32 m0, s52, 65536
  v_mfma_f32_16x16x32_bf16 a[4:7], v[72:75], v[36:39], a[4:7]
  buffer_load_dwordx4 v2, s[8:11], s20 offen sc1 lds
  ds_read_b128 v[20:23], v11 offset:32768
  v_mfma_f32_16x16x32_bf16 a[8:11], v[76:79], v[36:39], a[8:11]
  ds_read_b64_tr_b16 v[52:53], v14 offset:49152
  v_mfma_f32_16x16x32_bf16 a[12:15], v[80:83], v[36:39], a[12:15]
  ds_read_b64_tr_b16 v[54:55], v14 offset:53248
  s_add_u32 m0, s53, 65536
  v_mfma_f32_16x16x32_bf16 a[16:19], v[68:71], v[40:43], a[16:19]
  buffer_load_dwordx4 v6, s[12:15], s21 offen  lds
  ds_read_b128 v[24:27], v11 offset:34816
  v_mfma_f32_16x16x32_bf16 a[20:23], v[72:75], v[40:43], a[20:23]
  ds_read_b64_tr_b16 v[56:57], v14 offset:49160
  v_mfma_f32_16x16x32_bf16 a[24:27], v[76:79], v[40:43], a[24:27]
  ds_read_b64_tr_b16 v[58:59], v14 offset:53256
  s_add_u32 m0, s52, 66560
  v_mfma_f32_16x16x32_bf16 a[28:31], v[80:83], v[40:43], a[28:31]
  buffer_load_dwordx4 v3, s[8:11], s20 offen sc1 lds
  ds_read_b128 v[28:31], v11 offset:36864
  v_mfma_f32_16x16x32_bf16 a[32:35], v[68:71], v[44:47], a[32:35]
  ds_read_b64_tr_b16 v[60:61], v15 offset:49152
  v_mfma_f32_16x16x32_bf16 a[36:39], v[72:75], v[44:47], a[36:39]
  ds_read_b64_tr_b16 v[62:63], v15 offset:53248
  s_add_u32 m0, s53, 66560
  v_mfma_f32_16x16x32_bf16 a[40:43], v[76:79], v[44:47], a[40:43]
  buffer_load_dwordx4 v7, s[12:15], s21 offen  lds
  ds_read_b128 v[32:35], v11 offset:38912
  v_mfma_f32_16x16x32_bf16 a[44:47], v[80:83], v[44:47], a[44:47]
  ds_read_b64_tr_b16 v[64:65], v15 offset:49160
  v_mfma_f32_16x16x32_bf16 a[48:51], v[68:71], v[48:51], a[48:51]
  ds_read_b64_tr_b16 v[66:67], v15 offset:53256
  s_add_u32 m0, s52, 67584
  v_mfma_f32_16x16x32_bf16 a[52:55], v[72:75], v[48:51], a[52:55]
  buffer_load_dwordx4 v4, s[8:11], s20 offen sc1 lds
  v_mfma_f32_16x16x32_bf16 a[56:59], v[76:79], v[48:51], a[56:59]
  v_mfma_f32_16x16x32_bf16 a[60:63], v[80:83], v[48:51], a[60:63]
  s_waitcnt lgkmcnt(0)
  s_add_u32 m0, s53, 67584
  v_mfma_f32_16x16x32_bf16 a[0:3], v[52:55], v[20:23], a[0:3]
  buffer_load_dwordx4 v8, s[12:15], s21 offen  lds
  ds_read_b128 v[36:39], v11 offset:33792
  v_mfma_f32_16x16x32_bf16 a[4:7], v[56:59], v[20:23], a[4:7]
  ds_read_b64_tr_b16 v[68:69], v14 offset:57344
  v_mfma_f32_16x16x32_bf16 a[8:11], v[60:63], v[20:23], a[8:11]
  ds_read_b64_tr_b16 v[70:71], v14 offset:61440
  v_mfma_f32_16x16x32_bf16 a[12:15], v[64:67], v[20:23], a[12:15]
  ds_read_b128 v[40:43], v11 offset:35840
  s_add_u32 m0, s52, 68608
  v_mfma_f32_16x16x32_bf16 a[16:19], v[52:55], v[24:27], a[16:19]
  buffer_load_dwordx4 v5, s[8:11], s20 offen sc1 lds
  ds_read_b64_tr_b16 v[72:73], v14 offset:57352
  v_mfma_f32_16x16x32_bf16 a[20:23], v[56:59], v[24:27], a[20:23]
  ds_read_b64_tr_b16 v[74:75], v14 offset:61448
  v_mfma_f32_16x16x32_bf16 a[24:27], v[60:63], v[24:27], a[24:27]
  ds_read_b128 v[44:47], v11 offset:37888
  v_mfma_f32_16x16x32_bf16 a[28:31], v[64:67], v[24:27], a[28:31]
  ds_read_b64_tr_b16 v[76:77], v15 offset:57344
  s_add_u32 m0, s53, 68608
  v_mfma_f32_16x16x32_bf16 a[32:35], v[52:55], v[28:31], a[32:35]
  buffer_load_dwordx4 v9, s[12:15], s21 offen  lds
  ds_read_b64_tr_b16 v[78:79], v15 offset:61440
  v_mfma_f32_16x16x32_bf16 a[36:39], v[56:59], v[28:31], a[36:39]
  ds_read_b128 v[48:51], v11 offset:39936
  v_mfma_f32_16x16x32_bf16 a[40:43], v[60:63], v[28:31], a[40:43]
  ds_read_b64_tr_b16 v[80:81], v15 offset:57352
  v_mfma_f32_16x16x32_bf16 a[44:47], v[64:67], v[28:31], a[44:47]
  ds_read_b64_tr_b16 v[82:83], v15 offset:61448
  s_add_u32 s20, s20, 2048
  v_mfma_f32_16x16x32_bf16 a[48:51], v[52:55], v[32:35], a[48:51]
  s_add_u32 s21, s21, s51
  v_mfma_f32_16x16x32_bf16 a[52:55], v[56:59], v[32:35], a[52:55]
  v_mfma_f32_16x16x32_bf16 a[56:59], v[60:63], v[32:35], a[56:59]
  v_mfma_f32_16x16x32_bf16 a[60:63], v[64:67], v[32:35], a[60:63]
  s_waitcnt lgkmcnt(0)
  v_mfma_f32_16x16x32_bf16 a[0:3], v[68:71], v[36:39], a[0:3]
  s_waitcnt vmcnt(16)
  s_barrier
  s_add_u32 m0, s52, 98304
  v_mfma_f32_16x16x32_bf16 a[4:7], v[72:75], v[36:39], a[4:7]
  buffer_load_dwordx4 v2, s[8:11], s20 offen sc1 lds
  ds_read_b128 v[20:23], v10 offset:0
  v_mfma_f32_16x16x32_bf16 a[8:11], v[76:79], v[36:39], a[8:11]
  ds_read_b64_tr_b16 v[52:53], v12 offset:16384
  v_mfma_f32_16x16x32_bf16 a[12:15], v[80:83], v[36:39], a[12:15]
  ds_read_b64_tr_b16 v[54:55], v12 offset:20480
  s_add_u32 m0, s53, 98304
  v_mfma_f32_16x16x32_bf16 a[16:19], v[68:71], v[40:43], a[16:19]
  buffer_load_dwordx4 v6, s[12:15], s21 offen  lds
  ds_read_b128 v[24:27], v10 offset:2048
  v_mfma_f32_16x16x32_bf16 a[20:23], v[72:75], v[40:43], a[20:23]
  ds_read_b64_tr_b16 v[56:57], v12 offset:16392
  v_mfma_f32_16x16x32_bf16 a[24:27], v[76:79], v[40:43], a[24:27]
  ds_read_b64_tr_b16 v[58:59], v12 offset:20488
  s_add_u32 m0, s52, 99328
  v_mfma_f32_16x16x32_bf16 a[28:31], v[80:83], v[40:43], a[28:31]
  buffer_load_dwordx4 v3, s[8:11], s20 offen sc1 lds
  ds_read_b128 v[28:31], v10 offset:4096
  v_mfma_f32_16x16x32_bf16 a[32:35], v[68:71], v[44:47], a[32:35]
  ds_read_b64_tr_b16 v[60:61], v13 offset:16384
  v_mfma_f32_16x16x32_bf16 a[36:39], v[72:75], v[44:47], a[36:39]
  ds_read_b64_tr_b16 v[62:63], v13 offset:20480
  s_add_u32 m0, s53, 99328
  v_mfma_f32_16x16x32_bf16 a[40:43], v[76:79], v[44:47], a[40:43]
  buffer_load_dwordx4 v7, s[12:15], s21 offen  lds
  ds_read_b128 v[32:35], v10 offset:6144
  v_mfma_f32_16x16x32_bf16 a[44:47], v[80:83], v[44:47], a[44:47]
  ds_read_b64_tr_b16 v[64:65], v13 offset:16392
  v_mfma_f32_16x16x32_bf16 a[48:51], v[68:71], v[48:51], a[48:51]
  ds_read_b64_tr_b16 v[66:67], v13 offset:20488
  s_add_u32 m0, s52, 100352
  v_mfma_f32_16x16x32_bf16 a[52:55], v[72:75], v[48:51], a[52:55]
  buffer_load_dwordx4 v4, s[8:11], s20 offen sc1 lds
  v_mfma_f32_16x16x32_bf16 a[56:59], v[76:79], v[48:51], a[56:59]
  v_mfma_f32_16x16x32_bf16 a[60:63], v[80:83], v[48:51], a[60:63]
L_g3_loop:
  s_sub_u32 s25, s25, 1
  s_cmp_eq_u32 s25, 0
  s_cbranch_scc1 L_g3_fin
  s_waitcnt lgkmcnt(0)
  s_add_u32 m0, s53, 100352
  v_mfma_f32_16x16x32_bf16 a[0:3], v[52:55], v[20:23], a[0:3]
  buffer_load_dwordx4 v8, s[12:15], s21 offen  lds
  ds_read_b128 v[36:39], v10 offset:1024
  v_mfma_f32_16x16x32_bf16 a[4:7], v[56:59], v[20:23], a[4:7]
  ds_read_b64_tr_b16 v[68:69], v12 offset:24576
  v_mfma_f32_16x16x32_bf16 a[8:11], v[60:63], v[20:23], a[8:11]
  ds_read_b64_tr_b16 v[70:71], v12 offset:28672
  v_mfma_f32_16x16x32_bf16 a[12:15], v[64:67], v[20:23], a[12:15]
  ds_read_b128 v[40:43], v10 offset:3072
  s_add_u32 m0, s52, 101376
  v_mfma_f32_16x16x32_bf16 a[16:19], v[52:55], v[24:27], a[16:19]
  buffer_load_dwordx4 v5, s[8:11], s20 offen sc1 lds
  ds_read_b64_tr_b16 v[72:73], v12 offset:24584
  v_mfma_f32_16x16x32_bf16 a[20:23], v[56:59], v[24:27], a[20:23]
  ds_read_b64_tr_b16 v[74:75], v12 offset:28680
  v_mfma_f32_16x16x32_bf16 a[24:27], v[60:63], v[24:27], a[24:27]
  ds_read_b128 v[44:47], v10 offset:5120
  v_mfma_f32_16x16x32_bf16 a[28:31], v[64:67], v[24:27], a[28:31]
  ds_read_b64_tr_b16 v[76:77], v13 offset:24576
  s_add_u32 m0, s53, 101376
  v_mfma_f32_16x16x32_bf16 a[32:35], v[52:55], v[28:31], a[32:35]
  buffer_load_dwordx4 v9, s[12:15], s21 offen  lds
  ds_read_b64_tr_b16 v[78:79], v13 offset:28672
  v_mfma_f32_16x16x32_bf16 a[36:39], v[56:59], v[28:31], a[36:39]
  ds_read_b128 v[48:51], v10 offset:7168
  v_mfma_f32_16x16x32_bf16 a[40:43], v[60:63], v[28:31], a[40:43]
  ds_read_b64_tr_b16 v[80:81], v13 offset:24584
  v_mfma_f32_16x16x32_bf16 a[44:47], v[64:67], v[28:31], a[44:47]
  ds_read_b64_tr_b16 v[82:83], v13 offset:28680
  s_add_u32 s20, s20, 6144
  v_mfma_f32_16x16x32_bf16 a[48:51], v[52:55], v[32:35], a[48:51]
  s_add_u32 s21, s21, s51
  v_mfma_f32_16x16x32_bf16 a[52:55], v[56:59], v[32:35], a[52:55]
  v_mfma_f32_16x16x32_bf16 a[56:59], v[60:63], v[32:35], a[56:59]
  v_mfma_f32_16x16x32_bf16 a[60:63], v[64:67], v[32:35], a[60:63]
  s_waitcnt lgkmcnt(0)
  v_mfma_f32_16x16x32_bf16 a[0:3], v[68:71], v[36:39], a[0:3]
  s_waitcnt vmcnt(16)
  s_barrier
  s_add_u32 m0, s52, 0
  v_mfma_f32_16x16x32_bf16 a[4:7], v[72:75], v[36:39], a[4:7]
  buffer_load_dwordx4 v2, s[8:11], s20 offen sc1 lds
  ds_read_b128 v[20:23], v10 offset:32768
  v_mfma_f32_16x16x32_bf16 a[8:11], v[76:79], v[36:39], a[8:11]
  ds_read_b64_tr_b16 v[52:53], v12 offset:49152
  v_mfma_f32_16x16x32_bf16 a[12:15], v[80:83], v[36:39], a[12:15]
  ds_read_b64_tr_b16 v[54:55], v12 offset:53248
  s_add_u32 m0, s53, 0
  v_mfma_f32_16x16x32_bf16 a[16:19], v[68:71], v[40:43], a[16:19]
  buffer_load_dwordx4 v6, s[12:15], s21 offen  lds
  ds_read_b128 v[24:27], v10 offset:34816
  v_mfma_f32_16x16x32_bf16 a[20:23], v[72:75], v[40:43], a[20:23]
  ds_read_b64_tr_b16 v[56:57], v12 offset:49160
  v_mfma_f32_16x16x32_bf16 a[24:27], v[76:79], v[40:43], a[24:27]
  ds_read_b64_tr_b16 v[58:59], v12 offset:53256
  s_add_u32 m0, s52, 1024
  v_mfma_f32_16x16x32_bf16 a[28:31], v[80:83], v[40:43], a[28:31]
  buffer_load_dwordx4 v3, s[8:11], s20 offen sc1 lds
  ds_read_b128 v[28:31], v10 offset:36864
  v_mfma_f32_16x16x32_bf16 a[32:35], v[68:71], v[44:47], a[32:35]
  ds_read_b64_tr_b16 v[60:61], v13 offset:49152
  v_mfma_f32_16x16x32_bf16 a[36:39], v[72:75], v[44:47], a[36:39]
  ds_read_b64_tr_b16 v[62:63], v13 offset:53248
  s_add_u32 m0, s53, 1024
  v_mfma_f32_16x16x32_bf16 a[40:43], v[76:79], v[44:47], a[40:43]
  buffer_load_dwordx4 v7, s[12:15], s21 offen  lds
  ds_read_b128 v[32:35], v10 offset:38912
  v_mfma_f32_16x16x32_bf16 a[44:47], v[80:83], v[44:47], a[44:47]
  ds_read_b64_tr_b16 v[64:65], v13 offset:49160
  v_mfma_f32_16x16x32_bf16 a[48:51], v[68:71], v[48:51], a[48:51]
  ds_read_b64_tr_b16 v[66:67], v13 offset:53256
  s_add_u32 m0, s52, 2048
  v_mfma_f32_16x16x32_bf16 a[52:55], v[72:75], v[48:51], a[52:55]
  buffer_load_dwordx4 v4, s[8:11], s20 offen sc1 lds
  v_mfma_f32_16x16x32_bf16 a[56:59], v[76:79], v[48:51], a[56:59]
  v_mfma_f32_16x16x32_bf16 a[60:63], v[80:83], v[48:51], a[60:63]
  s_waitcnt lgkmcnt(0)
  s_add_u32 m0, s53, 2048
  v_mfma_f32_16x16x32_bf16 a[0:3], v[52:55], v[20:23], a[0:3]
  buffer_load_dwordx4 v8, s[12:15], s21 offen  lds
  ds_read_b128 v[36:39], v10 offset:33792
  v_mfma_f32_16x16x32_bf16 a[4:7], v[56:59], v[20:23], a[4:7]
  ds_read_b64_tr_b16 v[68:69], v12 offset:57344
  v_mfma_f32_16x16x32_bf16 a[8:11], v[60:63], v[20:23], a[8:11]
  ds_read_b64_tr_b16 v[70:71], v12 offset:61440
  v_mfma_f32_16x16x32_bf16 a[12:15], v[64:67], v[20:23], a[12:15]
  ds_read_b128 v[40:43], v10 offset:35840
  s_add_u32 m0, s52, 3072
  v_mfma_f32_16x16x32_bf16 a[16:19], v[52:55], v[24:27], a[16:19]
  buffer_load_dwordx4 v5, s[8:11], s20 offen sc1 lds
  ds_read_b64_tr_b16 v[72:73], v12 offset:57352
  v_mfma_f32_16x16x32_bf16 a[20:23], v[56:59], v[24:27], a[20:23]
  ds_read_b64_tr_b16 v[74:75], v12 offset:61448
  v_mfma_f32_16x16x32_bf16 a[24:27], v[60:63], v[24:27], a[24:27]
  ds_read_b128 v[44:47], v10 offset:37888
  v_mfma_f32_16x16x32_bf16 a[28:31], v[64:67], v[24:27], a[28:31]
  ds_read_b64_tr_b16 v[76:77], v13 offset:57344
  s_add_u32 m0, s53, 3072
  v_mfma_f32_16x16x32_bf16 a[32:35], v[52:55], v[28:31], a[32:35]
  buffer_load_dwordx4 v9, s[12:15], s21 offen  lds
  ds_read_b64_tr_b16 v[78:79], v13 offset:61440
  v_mfma_f32_16x16x32_bf16 a[36:39], v[56:59], v[28:31], a[36:39]
  ds_read_b128 v[48:51], v10 offset:39936
  v_mfma_f32_16x16x32_bf16 a[40:43], v[60:63], v[28:31], a[40:43]
  ds_read_b64_tr_b16 v[80:81], v13 offset:57352
  v_mfma_f32_16x16x32_bf16 a[44:47], v[64:67], v[28:31], a[44:47]
  ds_read_b64_tr_b16 v[82:83], v13 offset:61448
  s_add_u32 s20, s20, 2048
  v_mfma_f32_16x16x32_bf16 a[48:51], v[52:55], v[32:35], a[48:51]
  s_add_u32 s21, s21, s51
  v_mfma_f32_16x16x32_bf16 a[52:55], v[56:59], v[32:35], a[52:55]
  v_mfma_f32_16x16x32_bf16 a[56:59], v[60:63], v[32:35], a[56:59]
  v_mfma_f32_16x16x32_bf16 a[60:63], v[64:67], v[32:35], a[60:63]
  s_waitcnt lgkmcnt(0)
  v_mfma_f32_16x16x32_bf16 a[0:3], v[68:71], v[36:39], a[0:3]
  s_waitcnt vmcnt(16)
  s_barrier
  s_add_u32 m0, s52, 32768
  v_mfma_f32_16x16x32_bf16 a[4:7], v[72:75], v[36:39], a[4:7]
  buffer_load_dwordx4 v2, s[8:11], s20 offen sc1 lds
  ds_read_b128 v[20:23], v11 offset:0
  v_mfma_f32_16x16x32_bf16 a[8:11], v[76:79], v[36:39], a[8:11]
  ds_read_b64_tr_b16 v[52:53], v14 offset:16384
  v_mfma_f32_16x16x32_bf16 a[12:15], v[80:83], v[36:39], a[12:15]
  ds_read_b64_tr_b16 v[54:55], v14 offset:20480
  s_add_u32 m0, s53, 32768
  v_mfma_f32_16x16x32_bf16 a[16:19], v[68:71], v[40:43], a[16:19]
  buffer_load_dwordx4 v6, s[12:15], s21 offen  lds
  ds_read_b128 v[24:27], v11 offset:2048
  v_mfma_f32_16x16x32_bf16 a[20:23], v[72:75], v[40:43], a[20:23]
  ds_read_b64_tr_b16 v[56:57], v14 offset:16392
  v_mfma_f32_16x16x32_bf16 a[24:27], v[76:79], v[40:43], a[24:27]
  ds_read_b64_tr_b16 v[58:59], v14 offset:20488
  s_add_u32 m0, s52, 33792
  v_mfma_f32_16x16x32_bf16 a[28:31], v[80:83], v[40:43], a[28:31]
  buffer_load_dwordx4 v3, s[8:11], s20 offen sc1 lds
  ds_read_b128 v[28:31], v11 offset:4096
  v_mfma_f32_16x16x32_bf16 a[32:35], v[68:71], v[44:47], a[32:35]
  ds_read_b64_tr_b16 v[60:61], v15 offset:16384
  v_mfma_f32_16x16x32_bf16 a[36:39], v[72:75], v[44:47], a[36:39]
  ds_read_b64_tr_b16 v[62:63], v15 offset:20480
  s_add_u32 m0, s53, 33792
  v_mfma_f32_16x16x32_bf16 a[40:43], v[76:79], v[44:47], a[40:43]
  buffer_load_dwordx4 v7, s[12:15], s21 offen  lds
  ds_read_b128 v[32:35], v11 offset:6144
  v_mfma_f32_16x16x32_bf16 a[44:47], v[80:83], v[44:47], a[44:47]
  ds_read_b64_tr_b16 v[64:65], v15 offset:16392
  v_mfma_f32_16x16x32_bf16 a[48:51], v[68:71], v[48:51], a[48:51]
  ds_read_b64_tr_b16 v[66:67], v15 offset:20488
  s_add_u32 m0, s52, 34816
  v_mfma_f32_16x16x32_bf16 a[52:55], v[72:75], v[48:51], a[52:55]
  buffer_load_dwordx4 v4, s[8:11], s20 offen sc1 lds
  v_mfma_f32_16x16x32_bf16 a[56:59], v[76:79], v[48:51], a[56:59]
  v_mfma_f32_16x16x32_bf16 a[60:63], v[80:83], v[48:51], a[60:63]
  s_waitcnt lgkmcnt(0)
  s_add_u32 m0, s53, 34816
  v_mfma_f32_16x16x32_bf16 a[0:3], v[52:55], v[20:23], a[0:3]
  buffer_load_dwordx4 v8, s[12:15], s21 offen  lds
  ds_read_b128 v[36:39], v11 offset:1024
  v_mfma_f32_16x16x32_bf16 a[4:7], v[56:59], v[20:23], a[4:7]
  ds_read_b64_tr_b16 v[68:69], v14 offset:24576
  v_mfma_f32_16x16x32_bf16 a[8:11], v[60:63], v[20:23], a[8:11]
  ds_read_b64_tr_b16 v[70:71], v14 offset:28672
  v_mfma_f32_16x16x32_bf16 a[12:15], v[64:67], v[20:23], a[12:15]
  ds_read_b128 v[40:43], v11 offset:3072
  s_add_u32 m0, s52, 35840
  v_mfma_f32_16x16x32_bf16 a[16:19], v[52:55], v[24:27], a[16:19]
  buffer_load_dwordx4 v5, s[8:11], s20 offen sc1 lds
  ds_read_b64_tr_b16 v[72:73], v14 offset:24584
  v_mfma_f32_16x16x32_bf16 a[20:23], v[56:59], v[24:27], a[20:23]
  ds_read_b64_tr_b16 v[74:75], v14 offset:28680
  v_mfma_f32_16x16x32_bf16 a[24:27], v[60:63], v[24:27], a[24:27]
  ds_read_b128 v[44:47], v11 offset:5120
  v_mfma_f32_16x16x32_bf16 a[28:31], v[64:67], v[24:27], a[28:31]
  ds_read_b64_tr_b16 v[76:77], v15 offset:24576
  s_add_u32 m0, s53, 35840
  v_mfma_f32_16x16x32_bf16 a[32:35], v[52:55], v[28:31], a[32:35]
  buffer_load_dwordx4 v9, s[12:15], s21 offen  lds
  ds_read_b64_tr_b16 v[78:79], v15 offset:28672
  v_mfma_f32_16x16x32_bf16 a[36:39], v[56:59], v[28:31], a[36:39]
  ds_read_b128 v[48:51], v11 offset:7168
  v_mfma_f32_16x16x32_bf16 a[40:43], v[60:63], v[28:31], a[40:43]
  ds_read_b64_tr_b16 v[80:81], v15 offset:24584
  v_mfma_f32_16x16x32_bf16 a[44:47], v[64:67], v[28:31], a[44:47]
  ds_read_b64_tr_b16 v[82:83], v15 offset:28680
  s_add_u32 s20, s20, 6144
  v_mfma_f32_16x16x32_bf16 a[48:51], v[52:55], v[32:35], a[48:51]
  s_add_u32 s21, s21, s51
  v_mfma_f32_16x16x32_bf16 a[52:55], v[56:59], v[32:35], a[52:55]
  v_mfma_f32_16x16x32_bf16 a[56:59], v[60:63], v[32:35], a[56:59]
  v_mfma_f32_16x16x32_bf16 a[60:63], v[64:67], v[32:35], a[60:63]
  s_waitcnt lgkmcnt(0)
  v_mfma_f32_16x16x32_bf16 a[0:3], v[68:71], v[36:39], a[0:3]
  s_waitcnt vmcnt(16)
  s_barrier
  s_add_u32 m0, s52, 65536
  v_mfma_f32_16x16x32_bf16 a[4:7], v[72:75], v[36:39], a[4:7]
  buffer_load_dwordx4 v2, s[8:11], s20 offen sc1 lds
  ds_read_b128 v[20:23], v11 offset:32768
  v_mfma_f32_16x16x32_bf16 a[8:11], v[76:79], v[36:39], a[8:11]
  ds_read_b64_tr_b16 v[52:53], v14 offset:49152
  v_mfma_f32_16x16x32_bf16 a[12:15], v[80:83], v[36:39], a[12:15]
  ds_read_b64_tr_b16 v[54:55], v14 offset:53248
  s_add_u32 m0, s53, 65536
  v_mfma_f32_16x16x32_bf16 a[16:19], v[68:71], v[40:43], a[16:19]
  buffer_load_dwordx4 v6, s[12:15], s21 offen  lds
  ds_read_b128 v[24:27], v11 offset:34816
  v_mfma_f32_16x16x32_bf16 a[20:23], v[72:75], v[40:43], a[20:23]
  ds_read_b64_tr_b16 v[56:57], v14 offset:49160
  v_mfma_f32_16x16x32_bf16 a[24:27], v[76:79], v[40:43], a[24:27]
  ds_read_b64_tr_b16 v[58:59], v14 offset:53256
  s_add_u32 m0, s52, 66560
  v_mfma_f32_16x16x32_bf16 a[28:31], v[80:83], v[40:43], a[28:31]
  buffer_load_dwordx4 v3, s[8:11], s20 offen sc1 lds
  ds_read_b128 v[28:31], v11 offset:36864
  v_mfma_f32_16x16x32_bf16 a[32:35], v[68:71], v[44:47], a[32:35]
  ds_read_b64_tr_b16 v[60:61], v15 offset:49152
  v_mfma_f32_16x16x32_bf16 a[36:39], v[72:75], v[44:47], a[36:39]
  ds_read_b64_tr_b16 v[62:63], v15 offset:53248
  s_add_u32 m0, s53, 66560
  v_mfma_f32_16x16x32_bf16 a[40:43], v[76:79], v[44:47], a[40:43]
  buffer_load_dwordx4 v7, s[12:15], s21 offen  lds
  ds_read_b128 v[32:35], v11 offset:38912
  v_mfma_f32_16x16x32_bf16 a[44:47], v[80:83], v[44:47], a[44:47]
  ds_read_b64_tr_b16 v[64:65], v15 offset:49160
  v_mfma_f32_16x16x32_bf16 a[48:51], v[68:71], v[48:51], a[48:51]
  ds_read_b64_tr_b16 v[66:67], v15 offset:53256
  s_add_u32 m0, s52, 67584
  v_mfma_f32_16x16x32_bf16 a[52:55], v[72:75], v[48:51], a[52:55]
  buffer_load_dwordx4 v4, s[8:11], s20 offen sc1 lds
  v_mfma_f32_16x16x32_bf16 a[56:59], v[76:79], v[48:51], a[56:59]
  v_mfma_f32_16x16x32_bf16 a[60:63], v[80:83], v[48:51], a[60:63]
  s_waitcnt lgkmcnt(0)
  s_add_u32 m0, s53, 67584
  v_mfma_f32_16x16x32_bf16 a[0:3], v[52:55], v[20:23], a[0:3]
  buffer_load_dwordx4 v8, s[12:15], s21 offen  lds
  ds_read_b128 v[36:39], v11 offset:33792
  v_mfma_f32_16x16x32_bf16 a[4:7], v[56:59], v[20:23], a[4:7]
  ds_read_b64_tr_b16 v[68:69], v14 offset:57344
  v_mfma_f32_16x16x32_bf16 a[8:11], v[60:63], v[20:23], a[8:11]
  ds_read_b64_tr_b16 v[70:71], v14 offset:61440
  v_mfma_f32_16x16x32_bf16 a[12:15], v[64:67], v[20:23], a[12:15]
  ds_read_b128 v[40:43], v11 offset:35840
  s_add_u32 m0, s52, 68608
  v_mfma_f32_16x16x32_bf16 a[16:19], v[52:55], v[24:27], a[16:19]
  buffer_load_dwordx4 v5, s[8:11], s20 offen sc1 lds
  ds_read_b64_tr_b16 v[72:73], v14 offset:57352
  v_mfma_f32_16x16x32_bf16 a[20:23], v[56:59], v[24:27], a[20:23]
  ds_read_b64_tr_b16 v[74:75], v14 offset:61448
  v_mfma_f32_16x16x32_bf16 a[24:27], v[60:63], v[24:27], a[24:27]
  ds_read_b128 v[44:47], v11 offset:37888
  v_mfma_f32_16x16x32_bf16 a[28:31], v[64:67], v[24:27], a[28:31]
  ds_read_b64_tr_b16 v[76:77], v15 offset:57344
  s_add_u32 m0, s53, 68608
  v_mfma_f32_16x16x32_bf16 a[32:35], v[52:55], v[28:31], a[32:35]
  buffer_load_dwordx4 v9, s[12:15], s21 offen  lds
  ds_read_b64_tr_b16 v[78:79], v15 offset:61440
  v_mfma_f32_16x16x32_bf16 a[36:39], v[56:59], v[28:31], a[36:39]
  ds_read_b128 v[48:51], v11 offset:39936
  v_mfma_f32_16x16x32_bf16 a[40:43], v[60:63], v[28:31], a[40:43]
  ds_read_b64_tr_b16 v[80:81], v15 offset:57352
  v_mfma_f32_16x16x32_bf16 a[44:47], v[64:67], v[28:31], a[44:47]
  ds_read_b64_tr_b16 v[82:83], v15 offset:61448
  s_add_u32 s20, s20, 2048
  v_mfma_f32_16x16x32_bf16 a[48:51], v[52:55], v[32:35], a[48:51]
  s_add_u32 s21, s21, s51
  v_mfma_f32_16x16x32_bf16 a[52:55], v[56:59], v[32:35], a[52:55]
  v_mfma_f32_16x16x32_bf16 a[56:59], v[60:63], v[32:35], a[56:59]
  v_mfma_f32_16x16x32_bf16 a[60:63], v[64:67], v[32:35], a[60:63]
  s_waitcnt lgkmcnt(0)
  v_mfma_f32_16x16x32_bf16 a[0:3], v[68:71], v[36:39], a[0:3]
  s_waitcnt vmcnt(16)
  s_barrier
  s_add_u32 m0, s52, 98304
  v_mfma_f32_16x16x32_bf16 a[4:7], v[72:75], v[36:39], a[4:7]
  buffer_load_dwordx4 v2, s[8:11], s20 offen sc1 lds
  ds_read_b128 v[20:23], v10 offset:0
  v_mfma_f32_16x16x32_bf16 a[8:11], v[76:79], v[36:39], a[8:11]
  ds_read_b64_tr_b16 v[52:53], v12 offset:16384
  v_mfma_f32_16x16x32_bf16 a[12:15], v[80:83], v[36:39], a[12:15]
  ds_read_b64_tr_b16 v[54:55], v12 offset:20480
  s_add_u32 m0, s53, 98304
  v_mfma_f32_16x16x32_bf16 a[16:19], v[68:71], v[40:43], a[16:19]
  buffer_load_dwordx4 v6, s[12:15], s21 offen  lds
  ds_read_b128 v[24:27], v10 offset:2048
  v_mfma_f32_16x16x32_bf16 a[20:23], v[72:75], v[40:43], a[20:23]
  ds_read_b64_tr_b16 v[56:57], v12 offset:16392
  v_mfma_f32_16x16x32_bf16 a[24:27], v[76:79], v[40:43], a[24:27]
  ds_read_b64_tr_b16 v[58:59], v12 offset:20488
  s_add_u32 m0, s52, 99328
  v_mfma_f32_16x16x32_bf16 a[28:31], v[80:83], v[40:43], a[28:31]
  buffer_load_dwordx4 v3, s[8:11], s20 offen sc1 lds
  ds_read_b128 v[28:31], v10 offset:4096
  v_mfma_f32_16x16x32_bf16 a[32:35], v[68:71], v[44:47], a[32:35]
  ds_read_b64_tr_b16 v[60:61], v13 offset:16384
  v_mfma_f32_16x16x32_bf16 a[36:39], v[72:75], v[44:47], a[36:39]
  ds_read_b64_tr_b16 v[62:63], v13 offset:20480
  s_add_u32 m0, s53, 99328
  v_mfma_f32_16x16x32_bf16 a[40:43], v[76:79], v[44:47], a[40:43]
  buffer_load_dwordx4 v7, s[12:15], s21 offen  lds
  ds_read_b128 v[32:35], v10 offset:6144
  v_mfma_f32_16x16x32_bf16 a[44:47], v[80:83], v[44:47], a[44:47]
  ds_read_b64_tr_b16 v[64:65], v13 offset:16392
  v_mfma_f32_16x16x32_bf16 a[48:51], v[68:71], v[48:51], a[48:51]
  ds_read_b64_tr_b16 v[66:67], v13 offset:20488
  s_add_u32 m0, s52, 100352
  v_mfma_f32_16x16x32_bf16 a[52:55], v[72:75], v[48:51], a[52:55]
  buffer_load_dwordx4 v4, s[8:11], s20 offen sc1 lds
  v_mfma_f32_16x16x32_bf16 a[56:59], v[76:79], v[48:51], a[56:59]
  v_mfma_f32_16x16x32_bf16 a[60:63], v[80:83], v[48:51], a[60:63]
  s_branch L_g3_loop
L_g3_fin:
  s_cmp_ge_u32 s35, 8
  s_cbranch_scc1 L_r3_105
  s_cmp_eq_u32 s35, 16
  s_cselect_b32 s90, 999, s34
  s_cmp_lt_u32 s90, 242
  s_cbranch_scc0 L_re_106
  s_cmp_lg_u32 s32, 0
  s_cbranch_scc1 L_rq_107
  s_cmp_eq_u32 s39, 0
  s_cbranch_scc1 L_rq_107
  s_lshl_b32 s99, s33, 7
  s_add_u32 s99, s99, 0x3d00200
  v_mov_b32 v244, 1
  v_mov_b32 v245, 0
  s_mov_b64 exec, 1
  buffer_atomic_add v244, v245, s[4:7], s99 offen sc0 sc1
  s_mov_b64 exec, -1
L_rq_107:
L_re_106:
L_r3_105:
  s_waitcnt lgkmcnt(0)
  s_add_u32 m0, s53, 100352
  v_mfma_f32_16x16x32_bf16 a[0:3], v[52:55], v[20:23], a[0:3]
  buffer_load_dwordx4 v8, s[12:15], s21 offen  lds
  ds_read_b128 v[36:39], v10 offset:1024
  v_mfma_f32_16x16x32_bf16 a[4:7], v[56:59], v[20:23], a[4:7]
  ds_read_b64_tr_b16 v[68:69], v12 offset:24576
  v_mfma_f32_16x16x32_bf16 a[8:11], v[60:63], v[20:23], a[8:11]
  ds_read_b64_tr_b16 v[70:71], v12 offset:28672
  v_mfma_f32_16x16x32_bf16 a[12:15], v[64:67], v[20:23], a[12:15]
  ds_read_b128 v[40:43], v10 offset:3072
  s_add_u32 m0, s52, 101376
  v_mfma_f32_16x16x32_bf16 a[16:19], v[52:55], v[24:27], a[16:19]
  buffer_load_dwordx4 v5, s[8:11], s20 offen sc1 lds
  ds_read_b64_tr_b16 v[72:73], v12 offset:24584
  v_mfma_f32_16x16x32_bf16 a[20:23], v[56:59], v[24:27], a[20:23]
  ds_read_b64_tr_b16 v[74:75], v12 offset:28680
  v_mfma_f32_16x16x32_bf16 a[24:27], v[60:63], v[24:27], a[24:27]
  ds_read_b128 v[44:47], v10 offset:5120
  v_mfma_f32_16x16x32_bf16 a[28:31], v[64:67], v[24:27], a[28:31]
  ds_read_b64_tr_b16 v[76:77], v13 offset:24576
  s_add_u32 m0, s53, 101376
  v_mfma_f32_16x16x32_bf16 a[32:35], v[52:55], v[28:31], a[32:35]
  buffer_load_dwordx4 v9, s[12:15], s21 offen  lds
  ds_read_b64_tr_b16 v[78:79], v13 offset:28672
  v_mfma_f32_16x16x32_bf16 a[36:39], v[56:59], v[28:31], a[36:39]
  ds_read_b128 v[48:51], v10 offset:7168
  v_mfma_f32_16x16x32_bf16 a[40:43], v[60:63], v[28:31], a[40:43]
  ds_read_b64_tr_b16 v[80:81], v13 offset:24584
  v_mfma_f32_16x16x32_bf16 a[44:47], v[64:67], v[28:31], a[44:47]
  ds_read_b64_tr_b16 v[82:83], v13 offset:28680
  s_add_u32 s20, s20, 6144
  v_mfma_f32_16x16x32_bf16 a[48:51], v[52:55], v[32:35], a[48:51]
  s_add_u32 s21, s21, s51
  v_mfma_f32_16x16x32_bf16 a[52:55], v[56:59], v[32:35], a[52:55]
  v_mfma_f32_16x16x32_bf16 a[56:59], v[60:63], v[32:35], a[56:59]
  v_mfma_f32_16x16x32_bf16 a[60:63], v[64:67], v[32:35], a[60:63]
  s_waitcnt lgkmcnt(0)
  v_mfma_f32_16x16x32_bf16 a[0:3], v[68:71], v[36:39], a[0:3]
  s_waitcnt vmcnt(16)
  s_barrier
  v_mfma_f32_16x16x32_bf16 a[4:7], v[72:75], v[36:39], a[4:7]
  ds_read_b128 v[20:23], v10 offset:32768
  v_mfma_f32_16x16x32_bf16 a[8:11], v[76:79], v[36:39], a[8:11]
  ds_read_b64_tr_b16 v[52:53], v12 offset:49152
  v_mfma_f32_16x16x32_bf16 a[12:15], v[80:83], v[36:39], a[12:15]
  ds_read_b64_tr_b16 v[54:55], v12 offset:53248
  v_mfma_f32_16x16x32_bf16 a[16:19], v[68:71], v[40:43], a[16:19]
  ds_read_b128 v[24:27], v10 offset:34816
  v_mfma_f32_16x16x32_bf16 a[20:23], v[72:75], v[40:43], a[20:23]
  ds_read_b64_tr_b16 v[56:57], v12 offset:49160
  v_mfma_f32_16x16x32_bf16 a[24:27], v[76:79], v[40:43], a[24:27]
  ds_read_b64_tr_b16 v[58:59], v12 offset:53256
  v_mfma_f32_16x16x32_bf16 a[28:31], v[80:83], v[40:43], a[28:31]
  ds_read_b128 v[28:31], v10 offset:36864
  v_mfma_f32_16x16x32_bf16 a[32:35], v[68:71], v[44:47], a[32:35]
  ds_read_b64_tr_b16 v[60:61], v13 offset:49152
  v_mfma_f32_16x16x32_bf16 a[36:39], v[72:75], v[44:47], a[36:39]
  ds_read_b64_tr_b16 v[62:63], v13 offset:53248
  v_mfma_f32_16x16x32_bf16 a[40:43], v[76:79], v[44:47], a[40:43]
  ds_read_b128 v[32:35], v10 offset:38912
  v_mfma_f32_16x16x32_bf16 a[44:47], v[80:83], v[44:47], a[44:47]
  ds_read_b64_tr_b16 v[64:65], v13 offset:49160
  v_mfma_f32_16x16x32_bf16 a[48:51], v[68:71], v[48:51], a[48:51]
  ds_read_b64_tr_b16 v[66:67], v13 offset:53256
  v_mfma_f32_16x16x32_bf16 a[52:55], v[72:75], v[48:51], a[52:55]
  v_mfma_f32_16x16x32_bf16 a[56:59], v[76:79], v[48:51], a[56:59]
  v_mfma_f32_16x16x32_bf16 a[60:63], v[80:83], v[48:51], a[60:63]
  s_waitcnt lgkmcnt(0)
  v_mfma_f32_16x16x32_bf16 a[0:3], v[52:55], v[20:23], a[0:3]
  ds_read_b128 v[36:39], v10 offset:33792
  v_mfma_f32_16x16x32_bf16 a[4:7], v[56:59], v[20:23], a[4:7]
  ds_read_b64_tr_b16 v[68:69], v12 offset:57344
  v_mfma_f32_16x16x32_bf16 a[8:11], v[60:63], v[20:23], a[8:11]
  ds_read_b64_tr_b16 v[70:71], v12 offset:61440
  v_mfma_f32_16x16x32_bf16 a[12:15], v[64:67], v[20:23], a[12:15]
  ds_read_b128 v[40:43], v10 offset:35840
  v_mfma_f32_16x16x32_bf16 a[16:19], v[52:55], v[24:27], a[16:19]
  ds_read_b64_tr_b16 v[72:73], v12 offset:57352
  v_mfma_f32_16x16x32_bf16 a[20:23], v[56:59], v[24:27], a[20:23]
  ds_read_b64_tr_b16 v[74:75], v12 offset:61448
  v_mfma_f32_16x16x32_bf16 a[24:27], v[60:63], v[24:27], a[24:27]
  ds_read_b128 v[44:47], v10 offset:37888
  v_mfma_f32_16x16x32_bf16 a[28:31], v[64:67], v[24:27], a[28:31]
  ds_read_b64_tr_b16 v[76:77], v13 offset:57344
  v_mfma_f32_16x16x32_bf16 a[32:35], v[52:55], v[28:31], a[32:35]
  ds_read_b64_tr_b16 v[78:79], v13 offset:61440
  v_mfma_f32_16x16x32_bf16 a[36:39], v[56:59], v[28:31], a[36:39]
  ds_read_b128 v[48:51], v10 offset:39936
  v_mfma_f32_16x16x32_bf16 a[40:43], v[60:63], v[28:31], a[40:43]
  ds_read_b64_tr_b16 v[80:81], v13 offset:57352
  v_mfma_f32_16x16x32_bf16 a[44:47], v[64:67], v[28:31], a[44:47]
  ds_read_b64_tr_b16 v[82:83], v13 offset:61448
  v_mfma_f32_16x16x32_bf16 a[48:51], v[52:55], v[32:35], a[48:51]
  v_mfma_f32_16x16x32_bf16 a[52:55], v[56:59], v[32:35], a[52:55]
  v_mfma_f32_16x16x32_bf16 a[56:59], v[60:63], v[32:35], a[56:59]
  v_mfma_f32_16x16x32_bf16 a[60:63], v[64:67], v[32:35], a[60:63]
  s_waitcnt lgkmcnt(0)
  v_mfma_f32_16x16x32_bf16 a[0:3], v[68:71], v[36:39], a[0:3]
  s_waitcnt vmcnt(8)
  s_barrier
  v_mfma_f32_16x16x32_bf16 a[4:7], v[72:75], v[36:39], a[4:7]
  ds_read_b128 v[20:23], v11 offset:0
  v_mfma_f32_16x16x32_bf16 a[8:11], v[76:79], v[36:39], a[8:11]
  ds_read_b64_tr_b16 v[52:53], v14 offset:16384
  v_mfma_f32_16x16x32_bf16 a[12:15], v[80:83], v[36:39], a[12:15]
  ds_read_b64_tr_b16 v[54:55], v14 offset:20480
  v_mfma_f32_16x16x32_bf16 a[16:19], v[68:71], v[40:43], a[16:19]
  ds_read_b128 v[24:27], v11 offset:2048
  v_mfma_f32_16x16x32_bf16 a[20:23], v[72:75], v[40:43], a[20:23]
  ds_read_b64_tr_b16 v[56:57], v14 offset:16392
  v_mfma_f32_16x16x32_bf16 a[24:27], v[76:79], v[40:43], a[24:27]
  ds_read_b64_tr_b16 v[58:59], v14 offset:20488
  v_mfma_f32_16x16x32_bf16 a[28:31], v[80:83], v[40:43], a[28:31]
  ds_read_b128 v[28:31], v11 offset:4096
  v_mfma_f32_16x16x32_bf16 a[32:35], v[68:71], v[44:47], a[32:35]
  ds_read_b64_tr_b16 v[60:61], v15 offset:16384
  v_mfma_f32_16x16x32_bf16 a[36:39], v[72:75], v[44:47], a[36:39]
  ds_read_b64_tr_b16 v[62:63], v15 offset:20480
  v_mfma_f32_16x16x32_bf16 a[40:43], v[76:79], v[44:47], a[40:43]
  ds_read_b128 v[32:35], v11 offset:6144
  v_mfma_f32_16x16x32_bf16 a[44:47], v[80:83], v[44:47], a[44:47]
  ds_read_b64_tr_b16 v[64:65], v15 offset:16392
  v_mfma_f32_16x16x32_bf16 a[48:51], v[68:71], v[48:51], a[48:51]
  ds_read_b64_tr_b16 v[66:67], v15 offset:20488
  v_mfma_f32_16x16x32_bf16 a[52:55], v[72:75], v[48:51], a[52:55]
  v_mfma_f32_16x16x32_bf16 a[56:59], v[76:79], v[48:51], a[56:59]
  v_mfma_f32_16x16x32_bf16 a[60:63], v[80:83], v[48:51], a[60:63]
  s_waitcnt lgkmcnt(0)
  v_mfma_f32_16x16x32_bf16 a[0:3], v[52:55], v[20:23], a[0:3]
  ds_read_b128 v[36:39], v11 offset:1024
  v_mfma_f32_16x16x32_bf16 a[4:7], v[56:59], v[20:23], a[4:7]
  ds_read_b64_tr_b16 v[68:69], v14 offset:24576
  v_mfma_f32_16x16x32_bf16 a[8:11], v[60:63], v[20:23], a[8:11]
  ds_read_b64_tr_b16 v[70:71], v14 offset:28672
  v_mfma_f32_16x16x32_bf16 a[12:15], v[64:67], v[20:23], a[12:15]
  ds_read_b128 v[40:43], v11 offset:3072
  v_mfma_f32_16x16x32_bf16 a[16:19], v[52:55], v[24:27], a[16:19]
  ds_read_b64_tr_b16 v[72:73], v14 offset:24584
  v_mfma_f32_16x16x32_bf16 a[20:23], v[56:59], v[24:27], a[20:23]
  ds_read_b64_tr_b16 v[74:75], v14 offset:28680
  v_mfma_f32_16x16x32_bf16 a[24:27], v[60:63], v[24:27], a[24:27]
  ds_read_b128 v[44:47], v11 offset:5120
  v_mfma_f32_16x16x32_bf16 a[28:31], v[64:67], v[24:27], a[28:31]
  ds_read_b64_tr_b16 v[76:77], v15 offset:24576
  v_mfma_f32_16x16x32_bf16 a[32:35], v[52:55], v[28:31], a[32:35]
  ds_read_b64_tr_b16 v[78:79], v15 offset:28672
  v_mfma_f32_16x16x32_bf16 a[36:39], v[56:59], v[28:31], a[36:39]
  ds_read_b128 v[48:51], v11 offset:7168
  v_mfma_f32_16x16x32_bf16 a[40:43], v[60:63], v[28:31], a[40:43]
  ds_read_b64_tr_b16 v[80:81], v15 offset:24584
  v_mfma_f32_16x16x32_bf16 a[44:47], v[64:67], v[28:31], a[44:47]
  ds_read_b64_tr_b16 v[82:83], v15 offset:28680
  v_mfma_f32_16x16x32_bf16 a[48:51], v[52:55], v[32:35], a[48:51]
  v_mfma_f32_16x16x32_bf16 a[52:55], v[56:59], v[32:35], a[52:55]
  v_mfma_f32_16x16x32_bf16 a[56:59], v[60:63], v[32:35], a[56:59]
  v_mfma_f32_16x16x32_bf16 a[60:63], v[64:67], v[32:35], a[60:63]
  s_waitcnt lgkmcnt(0)
  v_mfma_f32_16x16x32_bf16 a[0:3], v[68:71], v[36:39], a[0:3]
  s_waitcnt vmcnt(0)
  s_barrier
  v_mfma_f32_16x16x32_bf16 a[4:7], v[72:75], v[36:39], a[4:7]
  ds_read_b128 v[20:23], v11 offset:32768
  v_mfma_f32_16x16x32_bf16 a[8:11], v[76:79], v[36:39], a[8:11]
  ds_read_b64_tr_b16 v[52:53], v14 offset:49152
  v_mfma_f32_16x16x32_bf16 a[12:15], v[80:83], v[36:39], a[12:15]
  ds_read_b64_tr_b16 v[54:55], v14 offset:53248
  v_mfma_f32_16x16x32_bf16 a[16:19], v[68:71], v[40:43], a[16:19]
  ds_read_b128 v[24:27], v11 offset:34816
  v_mfma_f32_16x16x32_bf16 a[20:23], v[72:75], v[40:43], a[20:23]
  ds_read_b64_tr_b16 v[56:57], v14 offset:49160
  v_mfma_f32_16x16x32_bf16 a[24:27], v[76:79], v[40:43], a[24:27]
  ds_read_b64_tr_b16 v[58:59], v14 offset:53256
  v_mfma_f32_16x16x32_bf16 a[28:31], v[80:83], v[40:43], a[28:31]
  ds_read_b128 v[28:31], v11 offset:36864
  v_mfma_f32_16x16x32_bf16 a[32:35], v[68:71], v[44:47], a[32:35]
  ds_read_b64_tr_b16 v[60:61], v15 offset:49152
  v_mfma_f32_16x16x32_bf16 a[36:39], v[72:75], v[44:47], a[36:39]
  ds_read_b64_tr_b16 v[62:63], v15 offset:53248
  v_mfma_f32_16x16x32_bf16 a[40:43], v[76:79], v[44:47], a[40:43]
  ds_read_b128 v[32:35], v11 offset:38912
  v_mfma_f32_16x16x32_bf16 a[44:47], v[80:83], v[44:47], a[44:47]
  ds_read_b64_tr_b16 v[64:65], v15 offset:49160
  v_mfma_f32_16x16x32_bf16 a[48:51], v[68:71], v[48:51], a[48:51]
  ds_read_b64_tr_b16 v[66:67], v15 offset:53256
  v_mfma_f32_16x16x32_bf16 a[52:55], v[72:75], v[48:51], a[52:55]
  v_mfma_f32_16x16x32_bf16 a[56:59], v[76:79], v[48:51], a[56:59]
  v_mfma_f32_16x16x32_bf16 a[60:63], v[80:83], v[48:51], a[60:63]
  s_waitcnt lgkmcnt(0)
  v_mfma_f32_16x16x32_bf16 a[0:3], v[52:55], v[20:23], a[0:3]
  ds_read_b128 v[36:39], v11 offset:33792
  v_mfma_f32_16x16x32_bf16 a[4:7], v[56:59], v[20:23], a[4:7]
  ds_read_b64_tr_b16 v[68:69], v14 offset:57344
  v_mfma_f32_16x16x32_bf16 a[8:11], v[60:63], v[20:23], a[8:11]
  ds_read_b64_tr_b16 v[70:71], v14 offset:61440
  v_mfma_f32_16x16x32_bf16 a[12:15], v[64:67], v[20:23], a[12:15]
  ds_read_b128 v[40:43], v11 offset:35840
  v_mfma_f32_16x16x32_bf16 a[16:19], v[52:55], v[24:27], a[16:19]
  ds_read_b64_tr_b16 v[72:73], v14 offset:57352
  v_mfma_f32_16x16x32_bf16 a[20:23], v[56:59], v[24:27], a[20:23]
  ds_read_b64_tr_b16 v[74:75], v14 offset:61448
  v_mfma_f32_16x16x32_bf16 a[24:27], v[60:63], v[24:27], a[24:27]
  ds_read_b128 v[44:47], v11 offset:37888
  v_mfma_f32_16x16x32_bf16 a[28:31], v[64:67], v[24:27], a[28:31]
  ds_read_b64_tr_b16 v[76:77], v15 offset:57344
  v_mfma_f32_16x16x32_bf16 a[32:35], v[52:55], v[28:31], a[32:35]
  ds_read_b64_tr_b16 v[78:79], v15 offset:61440
  v_mfma_f32_16x16x32_bf16 a[36:39], v[56:59], v[28:31], a[36:39]
  ds_read_b128 v[48:51], v11 offset:39936
  v_mfma_f32_16x16x32_bf16 a[40:43], v[60:63], v[28:31], a[40:43]
  ds_read_b64_tr_b16 v[80:81], v15 offset:57352
  v_mfma_f32_16x16x32_bf16 a[44:47], v[64:67], v[28:31], a[44:47]
  ds_read_b64_tr_b16 v[82:83], v15 offset:61448
  v_mfma_f32_16x16x32_bf16 a[48:51], v[52:55], v[32:35], a[48:51]
  v_mfma_f32_16x16x32_bf16 a[52:55], v[56:59], v[32:35], a[52:55]
  v_mfma_f32_16x16x32_bf16 a[56:59], v[60:63], v[32:35], a[56:59]
  v_mfma_f32_16x16x32_bf16 a[60:63], v[64:67], v[32:35], a[60:63]
  s_waitcnt lgkmcnt(0)
  v_mfma_f32_16x16x32_bf16 a[0:3], v[68:71], v[36:39], a[0:3]
  v_mfma_f32_16x16x32_bf16 a[4:7], v[72:75], v[36:39], a[4:7]
  v_mfma_f32_16x16x32_bf16 a[8:11], v[76:79], v[36:39], a[8:11]
  v_mfma_f32_16x16x32_bf16 a[12:15], v[80:83], v[36:39], a[12:15]
  v_mfma_f32_16x16x32_bf16 a[16:19], v[68:71], v[40:43], a[16:19]
  v_mfma_f32_16x16x32_bf16 a[20:23], v[72:75], v[40:43], a[20:23]
  v_mfma_f32_16x16x32_bf16 a[24:27], v[76:79], v[40:43], a[24:27]
  v_mfma_f32_16x16x32_bf16 a[28:31], v[80:83], v[40:43], a[28:31]
  v_mfma_f32_16x16x32_bf16 a[32:35], v[68:71], v[44:47], a[32:35]
  v_mfma_f32_16x16x32_bf16 a[36:39], v[72:75], v[44:47], a[36:39]
  v_mfma_f32_16x16x32_bf16 a[40:43], v[76:79], v[44:47], a[40:43]
  v_mfma_f32_16x16x32_bf16 a[44:47], v[80:83], v[44:47], a[44:47]
  v_mfma_f32_16x16x32_bf16 a[48:51], v[68:71], v[48:51], a[48:51]
  v_mfma_f32_16x16x32_bf16 a[52:55], v[72:75], v[48:51], a[52:55]
  v_mfma_f32_16x16x32_bf16 a[56:59], v[76:79], v[48:51], a[56:59]
  v_mfma_f32_16x16x32_bf16 a[60:63], v[80:83], v[48:51], a[60:63]
  s_cmp_ge_u32 s35, 8
  s_cbranch_scc1 L_part
  s_mov_b32 s59, 5
  s_mov_b32 s60, s22
  s_mov_b32 s61, s26
  s_add_u32 s62, s38, 0x3d00000
  s_mov_b32 s63, s98
  s_cmp_eq_u32 s35, 16
  s_cselect_b32 s90, 999, s34
  s_cmp_lt_u32 s90, 242
  s_cbranch_scc1 L_got
  s_mov_b32 s58, 3
  s_branch L_epi
L_part:
  s_sub_u32 s40, s36, 12
  s_lshl_b32 s40, s40, 3
  s_add_u32 s40, s40, s50
  s_lshl_b32 s41, s40, 19
  s_add_u32 s41, s41, 0x6400000
  s_lshl_b32 s90, s32, 14
  s_add_u32 s41, s41, s90
  s_lshl_b32 s90, s48, 16
  s_add_u32 s42, s41, s90
  v_lshlrev_b32 v2, 4, v1
  buffer_store_dwordx4 a[0:3], v2, s[4:7], s42 offen offset:0 sc1
  buffer_store_dwordx4 a[4:7], v2, s[4:7], s42 offen offset:1024 sc1
  buffer_store_dwordx4 a[8:11], v2, s[4:7], s42 offen offset:2048 sc1
  buffer_store_dwordx4 a[12:15], v2, s[4:7], s42 offen offset:3072 sc1
  s_add_u32 s42, s42, 4096
  buffer_store_dwordx4 a[16:19], v2, s[4:7], s42 offen offset:0 sc1
  buffer_store_dwordx4 a[20:23], v2, s[4:7], s42 offen offset:1024 sc1
  buffer_store_dwordx4 a[24:27], v2, s[4:7], s42 offen offset:2048 sc1
  buffer_store_dwordx4 a[28:31], v2, s[4:7], s42 offen offset:3072 sc1
  s_add_u32 s42, s42, 4096
  buffer_store_dwordx4 a[32:35], v2, s[4:7], s42 offen offset:0 sc1
  buffer_store_dwordx4 a[36:39], v2, s[4:7], s42 offen offset:1024 sc1
  buffer_store_dwordx4 a[40:43], v2, s[4:7], s42 offen offset:2048 sc1
  buffer_store_dwordx4 a[44:47], v2, s[4:7], s42 offen offset:3072 sc1
  s_add_u32 s42, s42, 4096
  buffer_store_dwordx4 a[48:51], v2, s[4:7], s42 offen offset:0 sc1
  buffer_store_dwordx4 a[52:55], v2, s[4:7], s42 offen offset:1024 sc1
  buffer_store_dwordx4 a[56:59], v2, s[4:7], s42 offen offset:2048 sc1
  buffer_store_dwordx4 a[60:63], v2, s[4:7], s42 offen offset:3072 sc1
  s_lshl_b32 s40, s40, 7
  s_add_u32 s43, s40, 0x3d04000
  s_waitcnt vmcnt(0)
  s_barrier
  s_cmp_lg_u32 s32, 0
  s_cbranch_scc1 L_sig_108
  v_mov_b32 v254, 1
  v_mov_b32 v255, 0
  s_mov_b64 exec, 1
  buffer_atomic_add v254, v255, s[4:7], s43 offen offset:0 sc1
  s_mov_b64 exec, -1
L_sig_108:
  s_cmp_eq_u32 s35, 8
  s_cselect_b32 s43, 8, 4
  s_cmp_lg_u32 s32, 0
  s_cbranch_scc1 L_dd_110
  v_mov_b32 v228, 0x3d00000
  v_mov_b32 v232, 0x3d04000
L_dw_109:
  buffer_load_dword v234, v232, s[4:7], s40 offen offset:0 sc1
  s_waitcnt vmcnt(0)
  s_mov_b32 s44, 1
  v_readfirstlane_b32 s45, v234
  s_cmp_ge_u32 s45, s43
  s_cselect_b32 s44, s44, 0
  s_cmp_eq_u32 s44, 1
  s_cbranch_scc1 L_dd_110
  s_sleep 1
  s_add_u32 s3, s3, 1
  s_cmp_lt_u32 s3, 131072
  s_cbranch_scc1 L_dw_109
L_dd_110:
  s_barrier
  s_cmp_lg_u32 s32, 0
  s_cbranch_scc1 L_rq_111
  s_cmp_eq_u32 s39, 0
  s_cbranch_scc1 L_rq_111
  s_lshl_b32 s99, s33, 7
  s_add_u32 s99, s99, 0x3d00200
  v_mov_b32 v244, 1
  v_mov_b32 v245, 0
  s_mov_b64 exec, 1
  buffer_atomic_add v244, v245, s[4:7], s99 offen sc0 sc1
  s_mov_b64 exec, -1
L_rq_111:
  s_cmp_eq_u32 s35, 14
  s_cbranch_scc1 L_part4
  s_lshl_b32 s90, s48, 11
  s_add_u32 s41, s41, s90
  buffer_load_dwordx4 v[16:19], v2, s[4:7], s41 offen offset:0 sc1
  buffer_load_dwordx4 v[20:23], v2, s[4:7], s41 offen offset:1024 sc1
  s_add_u32 s41, s41, 0x10000
  buffer_load_dwordx4 v[24:27], v2, s[4:7], s41 offen offset:0 sc1
  buffer_load_dwordx4 v[28:31], v2, s[4:7], s41 offen offset:1024 sc1
  s_add_u32 s41, s41, 0x10000
  buffer_load_dwordx4 v[32:35], v2, s[4:7], s41 offen offset:0 sc1
  buffer_load_dwordx4 v[36:39], v2, s[4:7], s41 offen offset:1024 sc1
  s_add_u32 s41, s41, 0x10000
  buffer_load_dwordx4 v[40:43], v2, s[4:7], s41 offen offset:0 sc1
  buffer_load_dwordx4 v[44:47], v2, s[4:7], s41 offen offset:1024 sc1
  s_add_u32 s41, s41, 0x10000
  buffer_load_dwordx4 v[48:51], v2, s[4:7], s41 offen offset:0 sc1
  buffer_load_dwordx4 v[52:55], v2, s[4:7], s41 offen offset:1024 sc1
  s_add_u32 s41, s41, 0x10000
  buffer_load_dwordx4 v[56:59], v2, s[4:7], s41 offen offset:0 sc1
  buffer_load_dwordx4 v[60:63], v2, s[4:7], s41 offen offset:1024 sc1
  s_add_u32 s41, s41, 0x10000
  buffer_load_dwordx4 v[64:67], v2, s[4:7], s41 offen offset:0 sc1
  buffer_load_dwordx4 v[68:71], v2, s[4:7], s41 offen offset:1024 sc1
  s_add_u32 s41, s41, 0x10000
  buffer_load_dwordx4 v[72:75], v2, s[4:7], s41 offen offset:0 sc1
  buffer_load_dwordx4 v[76:79], v2, s[4:7], s41 offen offset:1024 sc1
  s_add_u32 s41, s41, 0x10000
  v_mov_b32 v3, 0x0
  v_bfe_u32 v4, v1, 0, 4
  v_lshl_add_u32 v3, v4, 12, v3
  v_bfe_u32 v4, v1, 4, 2
  v_lshl_add_u32 v3, v4, 4, v3
  s_lshr_b32 s90, s32, 1
  s_lshl_b32 s90, s90, 18
  s_add_u32 s22, s22, s90
  s_and_b32 s90, s32, 1
  s_lshl_b32 s90, s90, 7
  s_add_u32 s22, s22, s90
  s_lshr_b32 s90, s48, 1
  s_lshl_b32 s90, s90, 16
  s_add_u32 s22, s22, s90
  s_and_b32 s90, s48, 1
  s_lshl_b32 s90, s90, 6
  s_add_u32 s22, s22, s90
  s_waitcnt vmcnt(12)
  v_pk_add_f32 v[16:17], v[16:17], v[24:25]
  v_pk_add_f32 v[18:19], v[18:19], v[26:27]
  v_pk_add_f32 v[20:21], v[20:21], v[28:29]
  v_pk_add_f32 v[22:23], v[22:23], v[30:31]
  s_waitcnt vmcnt(10)
  v_pk_add_f32 v[16:17], v[16:17], v[32:33]
  v_pk_add_f32 v[18:19], v[18:19], v[34:35]
  v_pk_add_f32 v[20:21], v[20:21], v[36:37]
  v_pk_add_f32 v[22:23], v[22:23], v[38:39]
  s_waitcnt vmcnt(8)
  v_pk_add_f32 v[16:17], v[16:17], v[40:41]
  v_pk_add_f32 v[18:19], v[18:19], v[42:43]
  v_pk_add_f32 v[20:21], v[20:21], v[44:45]
  v_pk_add_f32 v[22:23], v[22:23], v[46:47]
  s_waitcnt vmcnt(6)
  v_pk_add_f32 v[16:17], v[16:17], v[48:49]
  v_pk_add_f32 v[18:19], v[18:19], v[50:51]
  v_pk_add_f32 v[20:21], v[20:21], v[52:53]
  v_pk_add_f32 v[22:23], v[22:23], v[54:55]
  s_waitcnt vmcnt(4)
  v_pk_add_f32 v[16:17], v[16:17], v[56:57]
  v_pk_add_f32 v[18:19], v[18:19], v[58:59]
  v_pk_add_f32 v[20:21], v[20:21], v[60:61]
  v_pk_add_f32 v[22:23], v[22:23], v[62:63]
  s_waitcnt vmcnt(2)
  v_pk_add_f32 v[16:17], v[16:17], v[64:65]
  v_pk_add_f32 v[18:19], v[18:19], v[66:67]
  v_pk_add_f32 v[20:21], v[20:21], v[68:69]
  v_pk_add_f32 v[22:23], v[22:23], v[70:71]
  s_waitcnt vmcnt(0)
  v_pk_add_f32 v[16:17], v[16:17], v[72:73]
  v_pk_add_f32 v[18:19], v[18:19], v[74:75]
  v_pk_add_f32 v[20:21], v[20:21], v[76:77]
  v_pk_add_f32 v[22:23], v[22:23], v[78:79]
  v_cvt_pk_bf16_f32 v8, v16, v17
  v_cvt_pk_bf16_f32 v9, v18, v19
  v_cvt_pk_bf16_f32 v10, v20, v21
  v_cvt_pk_bf16_f32 v11, v22, v23
  buffer_store_dwordx4 v[8:11], v3, s[16:19], s22 offen sc1
  s_branch L_got
L_part4:
  s_lshl_b32 s90, s48, 12
  s_add_u32 s41, s41, s90
  buffer_load_dwordx4 v[16:19], v2, s[4:7], s41 offen offset:0 sc1
  buffer_load_dwordx4 v[20:23], v2, s[4:7], s41 offen offset:1024 sc1
  buffer_load_dwordx4 v[24:27], v2, s[4:7], s41 offen offset:2048 sc1
  buffer_load_dwordx4 v[28:31], v2, s[4:7], s41 offen offset:3072 sc1
  s_add_u32 s41, s41, 0x10000
  buffer_load_dwordx4 v[32:35], v2, s[4:7], s41 offen offset:0 sc1
  buffer_load_dwordx4 v[36:39], v2, s[4:7], s41 offen offset:1024 sc1
  buffer_load_dwordx4 v[40:43], v2, s[4:7], s41 offen offset:2048 sc1
  buffer_load_dwordx4 v[44:47], v2, s[4:7], s41 offen offset:3072 sc1
  s_add_u32 s41, s41, 0x10000
  buffer_load_dwordx4 v[48:51], v2, s[4:7], s41 offen offset:0 sc1
  buffer_load_dwordx4 v[52:55], v2, s[4:7], s41 offen offset:1024 sc1
  buffer_load_dwordx4 v[56:59], v2, s[4:7], s41 offen offset:2048 sc1
  buffer_load_dwordx4 v[60:63], v2, s[4:7], s41 offen offset:3072 sc1
  s_add_u32 s41, s41, 0x10000
  buffer_load_dwordx4 v[64:67], v2, s[4:7], s41 offen offset:0 sc1
  buffer_load_dwordx4 v[68:71], v2, s[4:7], s41 offen offset:1024 sc1
  buffer_load_dwordx4 v[72:75], v2, s[4:7], s41 offen offset:2048 sc1
  buffer_load_dwordx4 v[76:79], v2, s[4:7], s41 offen offset:3072 sc1
  s_add_u32 s41, s41, 0x10000
  v_mov_b32 v3, 0x0
  v_bfe_u32 v4, v1, 0, 4
  v_lshl_add_u32 v3, v4, 12, v3
  v_bfe_u32 v4, v1, 4, 2
  v_lshl_add_u32 v3, v4, 4, v3
  s_lshr_b32 s90, s32, 1
  s_lshl_b32 s90, s90, 18
  s_add_u32 s22, s22, s90
  s_and_b32 s90, s32, 1
  s_lshl_b32 s90, s90, 7
  s_add_u32 s22, s22, s90
  s_lshl_b32 s90, s48, 16
  s_add_u32 s22, s22, s90
  s_waitcnt vmcnt(8)
  v_pk_add_f32 v[16:17], v[16:17], v[32:33]
  v_pk_add_f32 v[18:19], v[18:19], v[34:35]
  v_pk_add_f32 v[20:21], v[20:21], v[36:37]
  v_pk_add_f32 v[22:23], v[22:23], v[38:39]
  v_pk_add_f32 v[24:25], v[24:25], v[40:41]
  v_pk_add_f32 v[26:27], v[26:27], v[42:43]
  v_pk_add_f32 v[28:29], v[28:29], v[44:45]
  v_pk_add_f32 v[30:31], v[30:31], v[46:47]
  s_waitcnt vmcnt(4)
  v_pk_add_f32 v[16:17], v[16:17], v[48:49]
  v_pk_add_f32 v[18:19], v[18:19], v[50:51]
  v_pk_add_f32 v[20:21], v[20:21], v[52:53]
  v_pk_add_f32 v[22:23], v[22:23], v[54:55]
  v_pk_add_f32 v[24:25], v[24:25], v[56:57]
  v_pk_add_f32 v[26:27], v[26:27], v[58:59]
  v_pk_add_f32 v[28:29], v[28:29], v[60:61]
  v_pk_add_f32 v[30:31], v[30:31], v[62:63]
  s_waitcnt vmcnt(0)
  v_pk_add_f32 v[16:17], v[16:17], v[64:65]
  v_pk_add_f32 v[18:19], v[18:19], v[66:67]
  v_pk_add_f32 v[20:21], v[20:21], v[68:69]
  v_pk_add_f32 v[22:23], v[22:23], v[70:71]
  v_pk_add_f32 v[24:25], v[24:25], v[72:73]
  v_pk_add_f32 v[26:27], v[26:27], v[74:75]
  v_pk_add_f32 v[28:29], v[28:29], v[76:77]
  v_pk_add_f32 v[30:31], v[30:31], v[78:79]
  v_cvt_pk_bf16_f32 v8, v16, v17
  v_cvt_pk_bf16_f32 v9, v18, v19
  v_cvt_pk_bf16_f32 v10, v20, v21
  v_cvt_pk_bf16_f32 v11, v22, v23
  v_cvt_pk_bf16_f32 v12, v24, v25
  v_cvt_pk_bf16_f32 v13, v26, v27
  v_cvt_pk_bf16_f32 v14, v28, v29
  v_cvt_pk_bf16_f32 v15, v30, v31
  buffer_store_dwordx4 v[8:11], v3, s[16:19], s22 offen offset:0 sc1
  buffer_store_dwordx4 v[12:15], v3, s[16:19], s22 offen offset:64 sc1
  s_branch L_got
L_done:
  s_waitcnt vmcnt(0)
  s_barrier
  s_add_u32 s38, s38, 0x3d00000
  s_cmp_lg_u32 s32, 0
  s_cbranch_scc1 L_sig_112
  v_mov_b32 v254, s98
  v_mov_b32 v255, 0
  s_mov_b64 exec, 1
  buffer_atomic_add v254, v255, s[4:7], s38 offen offset:0 sc1
  s_mov_b64 exec, -1
L_sig_112:
  s_mov_b32 s59, 0
  s_cmp_lg_u32 s35, 6
  s_cbranch_scc1 L_got
  s_add_u32 s36, s36, 2
  s_and_b32 s50, s36, 7
  s_cmp_lt_u32 s36, 62
  s_cbranch_scc1 L_ata_c
  s_branch L_got
L_exit:
  s_endpgm
.p2align 3
L_table:
.long 0x9
.long 0xa
.long 0x10009
.long 0x1000a
.long 0x20009
.long 0x2000a
.long 0x30009
.long 0x3000a
.long 0x40009
.long 0x4000a
.long 0x50009
.long 0x5000a
.long 0x60009
.long 0x6000a
.long 0x70009
.long 0x7000a
.long 0x109
.long 0x10a
.long 0x10109
.long 0x1010a
.long 0x20109
.long 0x2010a
.long 0x30109
.long 0x3010a
.long 0x40109
.long 0x4010a
.long 0x50109
.long 0x5010a
.long 0x60109
.long 0x6010a
.long 0x70109
.long 0x7010a
.long 0x209
.long 0x20a
.long 0x10209
.long 0x1020a
.long 0x20209
.long 0x2020a
.long 0x30209
.long 0x3020a
.long 0x40209
.long 0x4020a
.long 0x50209
.long 0x5020a
.long 0x60209
.long 0x6020a
.long 0x70209
.long 0x7020a
.long 0x201
.long 0x202
.long 0x10201
.long 0x10202
.long 0x20201
.long 0x20202
.long 0x30201
.long 0x30202
.long 0x301
.long 0x302
.long 0x10301
.long 0x10302
.long 0x20301
.long 0x20302
.long 0x30301
.long 0x30302
.long 0x309
.long 0x30a
.long 0x10309
.long 0x1030a
.long 0x20309
.long 0x2030a
.long 0x30309
.long 0x3030a
.long 0x40309
.long 0x4030a
.long 0x50309
.long 0x5030a
.long 0x60309
.long 0x6030a
.long 0x70309
.long 0x7030a
.long 0xc
.long 0x10c
.long 0x20c
.long 0x30c
.long 0x0
.long 0x10000
.long 0x20000
.long 0x30000
.long 0x100
.long 0x10100
.long 0x20100
.long 0x30100
.long 0x200
.long 0x10200
.long 0x20200
.long 0x30200
.long 0x401
.long 0x402
.long 0x10401
.long 0x10402
.long 0x20401
.long 0x20402
.long 0x30401
.long 0x30402
.long 0x501
.long 0x502
.long 0x10501
.long 0x10502
.long 0x20501
.long 0x20502
.long 0x30501
.long 0x30502
.long 0x300
.long 0x10300
.long 0x20300
.long 0x30300
.long 0x3
.long 0x10003
.long 0x20003
.long 0x103
.long 0x10103
.long 0x20103
.long 0x203
.long 0x10203
.long 0x20203
.long 0x303
.long 0x10303
.long 0x20303
.long 0x400
.long 0x10400
.long 0x20400
.long 0x30400
.long 0x500
.long 0x10500
.long 0x20500
.long 0x30500
.long 0x600
.long 0x10600
.long 0x20600
.long 0x30600
.long 0x700
.long 0x10700
.long 0x20700
.long 0x30700
.long 0xb
.long 0x1000b
.long 0x40b
.long 0x1040b
.long 0x80b
.long 0x1080b
.long 0xc0b
.long 0x10c0b
.long 0x403
.long 0x10403
.long 0x20403
.long 0x503
.long 0x10503
.long 0x20503
.long 0x603
.long 0x10603
.long 0x601
.long 0x602
.long 0x10601
.long 0x10602
.long 0x20601
.long 0x20602
.long 0x30601
.long 0x30602
.long 0x701
.long 0x702
.long 0x10701
.long 0x10702
.long 0x20701
.long 0x20702
.long 0x30701
.long 0x30702
.long 0x100b
.long 0x1100b
.long 0x140b
.long 0x1140b
.long 0x180b
.long 0x1180b
.long 0x1c0b
.long 0x11c0b
.long 0x20603
.long 0x703
.long 0x10703
.long 0x20703
.long 0x200b
.long 0x1200b
.long 0x240b
.long 0x1240b
.long 0x10
.long 0x10010
.long 0x210
.long 0x10210
.long 0x410
.long 0x10410
.long 0x610
.long 0x10610
.long 0x404
.long 0x10404
.long 0x20404
.long 0x30404
.long 0x304
.long 0x10304
.long 0x20304
.long 0x30304
.long 0x2806
.long 0x12806
.long 0x2906
.long 0x12906
.long 0x4
.long 0x10004
.long 0x20004
.long 0x30004
.long 0x104
.long 0x10104
.long 0x20104
.long 0x30104
.long 0x204
.long 0x10204
.long 0x20204
.long 0x30204
.long 0x11
.long 0x10011
.long 0x211
.long 0x10211
.long 0x504
.long 0x10504
.long 0x20504
.long 0x30504
.long 0x411
.long 0x10411
.long 0x611
.long 0x10611
.long 0x807
.long 0x10807
.long 0x907
.long 0x10907
.long 0xa07
.long 0x10a07
.long 0x811
.long 0x10811
.long 0xb07
.long 0x10b07
.long 0xa11
.long 0x10a11
.long 0xc07
.long 0x10c07
.long 0x604
.long 0x10604
.long 0x20604
.long 0x30604
.long 0x704
.long 0x10704
.long 0x20704
.long 0x30704
.long 0xc05
.long 0x10c05
.long 0xd05
.long 0x10d05
.long 0xe05
.long 0x10e05
.long 0xf05
.long 0x10f05
.long 0xd0e
.long 0x10d0e
.long 0x20d0e
.long 0x30d0e
.long 0x40d0e
.long 0x50d0e
.long 0x60d0e
.long 0x70d0e
.long 0x3e06
.long 0x13e06
.long 0x3f06
.long 0x13f06
.long 0xe0e
.long 0x10e0e
.long 0x20e0e
.long 0x30e0e
.long 0x40e0e
.long 0x50e0e
.long 0x60e0e
.long 0x70e0e
.long 0xf08
.long 0x10f08
.long 0x20f08
.long 0x30f08
.long 0x40f08
.long 0x50f08
.long 0x60f08
.long 0x70f08
.long 0x80f08
.long 0x90f08
.long 0xa0f08
.long 0xb0f08
.long 0xc0f08
.long 0xd0f08
.long 0xe0f08
.long 0xf0f08
.long 0xf
.long 0x0
.long 0x0
.long 0x0
.fill 206, 4, 0
.section .rodata,"a"
.p2align 6
.amdhsa_kernel concat_heads__memory_aug_recurrent_mem_tr__sliding_local_dilated__prompt_kernel
  .amdhsa_next_free_vgpr 512
  .amdhsa_next_free_sgpr 102
  .amdhsa_accum_offset 256
  .amdhsa_group_segment_fixed_size 0
  .amdhsa_kernarg_size 104
  .amdhsa_user_sgpr_count 2
  .amdhsa_user_sgpr_kernarg_segment_ptr 1
  .amdhsa_system_sgpr_workgroup_id_x 1
  .amdhsa_float_denorm_mode_32 3
  .amdhsa_float_denorm_mode_16_64 3
.end_amdhsa_kernel
```

```asm
; @launch grid=(256,1,1) block=(256,1,1) lds=149568
.amdgcn_target "amdgcn-amd-amdhsa--gfx950"
.text
.globl concat_heads__memory_aug_recurrent_mem_tr__sliding_local_dilated__prompt_kernel
.p2align 8
.type concat_heads__memory_aug_recurrent_mem_tr__sliding_local_dilated__prompt_kernel,@function
concat_heads__memory_aug_recurrent_mem_tr__sliding_local_dilated__prompt_kernel:
  s_cmp_ge_u32 s2, 256
  s_cbranch_scc1 L_exit
  s_load_dwordx4 s[92:95], s[0:1], 88
  s_load_dwordx16 s[64:79], s[0:1], 0
  s_getreg_b32 s39, hwreg(HW_REG_XCC_ID, 0, 3)
  v_lshrrev_b32 v2, 6, v0
  s_nop 0
  v_readfirstlane_b32 s32, v2
  s_mov_b32 s3, 0
  s_getpc_b64 s[86:87]
L_pc0:
  s_lshr_b32 s90, s2, 3
  s_lshl_b32 s90, s90, 2
  s_add_u32 s90, s90, s32
  s_and_b32 s90, s90, 31
  s_lshl_b32 s90, s90, 12
  v_and_b32 v1, 63, v0
  v_lshlrev_b32 v1, 6, v1
  v_add_u32 v1, s90, v1
  v_min_u32 v1, L_table-L_pc0, v1
  global_load_dword v199, v1, s[86:87]
  v_lshlrev_b32 v1, 3, v0
  v_add_u32 v1, L_table-L_pc0, v1
  global_load_dwordx2 v[248:249], v1, s[86:87]
  s_waitcnt lgkmcnt(0)
  s_mov_b32 s4, s94
  s_and_b32 s5, s95, 0xffff
  s_mov_b32 s6, 0x10000000
  s_mov_b32 s7, 0x20000
  s_mov_b32 s28, s92
  s_and_b32 s29, s93, 0xffff
  s_mov_b32 s30, 0x100
  s_mov_b32 s31, 0x20000
  s_mov_b32 s100, 0
  s_lshr_b32 s41, s2, 3
  s_lshl_b32 s101, 1, s41
  s_cmp_lg_u32 s32, 0
  s_cbranch_scc1 L_sweep
  s_lshl_b32 s90, s39, 2
  v_mov_b32 v247, s101
  v_mov_b32 v2, 0
  s_mov_b64 exec, 1
  buffer_atomic_or v247, v2, s[28:31], s90 offen offset:0 sc0 sc1
  s_mov_b64 exec, -1
L_sweep:
  s_lshl_b32 s40, s39, 5
  s_add_u32 s40, s40, s41
  s_mov_b32 s43, 1
  s_branch L_role
L_fallback:
  s_load_dwordx4 s[92:95], s[0:1], 88
  s_load_dwordx16 s[64:79], s[0:1], 0
  s_getreg_b32 s39, hwreg(HW_REG_XCC_ID, 0, 3)
  s_mov_b32 s100, 4
  v_mbcnt_lo_u32_b32 v0, -1, 0
  v_mbcnt_hi_u32_b32 v0, -1, v0
  s_lshl_b32 s90, s32, 6
  v_add_u32 v0, s90, v0
  s_waitcnt vmcnt(0) lgkmcnt(0)
  s_barrier
  s_cmp_lg_u32 s32, 0
  s_cbranch_scc1 L_tkd
  s_lshl_b32 s90, s39, 2
  v_mov_b32 v1, 1
  v_mov_b32 v2, 0
  v_lshlrev_b32 v3, 2, v0
  s_mov_b64 exec, 1
  buffer_atomic_add v1, v2, s[28:31], s90 offen offset:192 sc0 sc1
  s_mov_b64 exec, 0xff
L_tkw:
  buffer_load_dword v4, v3, s[28:31], 0 offen offset:192 sc1
  s_waitcnt vmcnt(0)
  v_readfirstlane_b32 s40, v1
  s_mov_b32 s41, 0
  s_mov_b32 s42, 0
  s_mov_b32 s43, 1
  v_readlane_b32 s44, v4, 0
  s_add_u32 s41, s41, s44
  s_cmp_gt_u32 s39, 0
  s_cselect_b32 s45, s44, 0
  s_add_u32 s42, s42, s45
  s_cmp_eq_u32 s44, 32
  s_cselect_b32 s43, s43, 0
  v_readlane_b32 s44, v4, 1
  s_add_u32 s41, s41, s44
  s_cmp_gt_u32 s39, 1
  s_cselect_b32 s45, s44, 0
  s_add_u32 s42, s42, s45
  s_cmp_eq_u32 s44, 32
  s_cselect_b32 s43, s43, 0
  v_readlane_b32 s44, v4, 2
  s_add_u32 s41, s41, s44
  s_cmp_gt_u32 s39, 2
  s_cselect_b32 s45, s44, 0
  s_add_u32 s42, s42, s45
  s_cmp_eq_u32 s44, 32
  s_cselect_b32 s43, s43, 0
  v_readlane_b32 s44, v4, 3
  s_add_u32 s41, s41, s44
  s_cmp_gt_u32 s39, 3
  s_cselect_b32 s45, s44, 0
  s_add_u32 s42, s42, s45
  s_cmp_eq_u32 s44, 32
  s_cselect_b32 s43, s43, 0
  v_readlane_b32 s44, v4, 4
  s_add_u32 s41, s41, s44
  s_cmp_gt_u32 s39, 4
  s_cselect_b32 s45, s44, 0
  s_add_u32 s42, s42, s45
  v_readlane_b32 s44, v4, 5
  s_add_u32 s41, s41, s44
  s_cmp_gt_u32 s39, 5
  s_cselect_b32 s45, s44, 0
  s_add_u32 s42, s42, s45
  v_readlane_b32 s44, v4, 6
  s_add_u32 s41, s41, s44
  s_cmp_gt_u32 s39, 6
  s_cselect_b32 s45, s44, 0
  s_add_u32 s42, s42, s45
  v_readlane_b32 s44, v4, 7
  s_add_u32 s41, s41, s44
  s_cmp_gt_u32 s39, 7
  s_cselect_b32 s45, s44, 0
  s_add_u32 s42, s42, s45
  s_add_u32 s3, s3, 1
  s_cmp_ge_u32 s3, 131072
  s_cbranch_scc1 L_tkbad
  s_sleep 4
  s_cmp_lt_u32 s41, 256
  s_cbranch_scc1 L_tkw
  s_add_u32 s40, s40, s42
  s_lshl_b32 s43, s43, 16
  s_or_b32 s40, s40, s43
  s_branch L_tkok
L_tkbad:
  s_mov_b32 s40, 0xffff
L_tkok:
  s_mov_b64 exec, -1
  v_mov_b32 v1, s40
  v_mov_b32 v2, 147456
  ds_write_b32 v2, v1
  s_waitcnt lgkmcnt(0)
L_tkd:
  s_barrier
  v_mov_b32 v2, 147456
  ds_read_b32 v1, v2
  s_waitcnt lgkmcnt(0)
  v_readfirstlane_b32 s40, v1
  s_barrier
  s_lshr_b32 s43, s40, 16
  s_and_b32 s40, s40, 0xffff
  s_cmp_ge_u32 s40, 256
  s_cbranch_scc1 L_exit
L_role:
  s_cmp_ge_u32 s40, 128
  s_cbranch_scc1 L_worker
  s_lshr_b32 s33, s40, 5
  s_and_b32 s34, s40, 31
  s_cmp_eq_u32 s43, 0
  s_cbranch_scc1 L_recslow
  s_load_dwordx4 s[80:83], s[0:1], 8
  s_load_dwordx4 s[84:87], s[0:1], 24
  s_load_dwordx2 s[88:89], s[0:1], 40
  v_lshrrev_b32 v31, 6, v0
  s_nop 0
  v_readfirstlane_b32 s32, v31
  v_and_b32 v0, 63, v0
  s_lshr_b32 s35, s34, 4
  s_lshl_b32 s90, s33, 1
  s_add_u32 s35, s35, s90
  s_and_b32 s36, s34, 15
  s_lshr_b32 s37, s36, 2
  s_lshl_b32 s90, s35, 2
  s_add_u32 s37, s37, s90
  s_and_b32 s38, s36, 3
  s_waitcnt lgkmcnt(0)
  s_mov_b32 s24, s80
  s_and_b32 s25, s81, 0xffff
  s_mov_b32 s26, 0x4000
  s_mov_b32 s27, 0x20000
  s_mov_b32 s8, s82
  s_and_b32 s9, s83, 0xffff
  s_mov_b32 s10, 0x800000
  s_mov_b32 s11, 0x20000
  s_mov_b32 s12, s84
  s_and_b32 s13, s85, 0xffff
  s_mov_b32 s14, 0x800000
  s_mov_b32 s15, 0x20000
  s_mov_b32 s16, s86
  s_and_b32 s17, s87, 0xffff
  s_mov_b32 s18, 0x800000
  s_mov_b32 s19, 0x20000
  s_mov_b32 s20, s88
  s_and_b32 s21, s89, 0xffff
  s_mov_b32 s22, 0x800000
  s_mov_b32 s23, 0x20000
  s_lshl_b32 s90, s32, 21
  s_lshl_b32 s91, s37, 8
  s_add_u32 s90, s90, s91
  s_lshr_b32 s91, s38, 1
  s_lshl_b32 s91, s91, 7
  s_add_u32 s90, s90, s91
  v_mov_b32 v180, 0x0
  v_bfe_u32 v31, v0, 3, 3
  v_lshl_add_u32 v180, v31, 13, v180
  v_bfe_u32 v31, v0, 0, 3
  v_lshl_add_u32 v180, v31, 4, v180
  v_add_u32 v180, s90, v180
  v_xor_b32 v185, 128, v180
  s_lshl_b32 s90, s35, 2
  s_add_u32 s90, s90, s32
  s_lshl_b32 s90, s90, 18
  s_lshl_b32 s91, s36, 7
  s_add_u32 s90, s90, s91
  v_mov_b32 v181, 0x0
  v_bfe_u32 v31, v0, 3, 3
  v_lshl_add_u32 v181, v31, 11, v181
  v_bfe_u32 v31, v0, 0, 3
  v_lshl_add_u32 v181, v31, 4, v181
  v_add_u32 v181, s90, v181
  s_lshl_b32 s96, s32, 15
  s_and_b32 s91, s38, 1
  s_lshl_b32 s91, s91, 6
  s_add_u32 s91, s91, s96
  v_mov_b32 v182, 0x0
  v_bfe_u32 v31, v0, 5, 1
  v_lshl_add_u32 v182, v31, 11, v182
  v_bfe_u32 v31, v0, 4, 1
  v_lshl_add_u32 v182, v31, 10, v182
  v_bfe_u32 v31, v0, 2, 2
  v_lshl_add_u32 v182, v31, 7, v182
  v_bfe_u32 v31, v0, 0, 2
  v_lshl_add_u32 v182, v31, 3, v182
  v_add_u32 v182, s91, v182
  s_lshl_b32 s91, s32, 5
  v_mov_b32 v183, 0x0
  v_bfe_u32 v31, v0, 4, 1
  v_lshl_add_u32 v183, v31, 13, v183
  v_bfe_u32 v31, v0, 5, 1
  v_lshl_add_u32 v183, v31, 8, v183
  v_bfe_u32 v31, v0, 2, 1
  v_lshl_add_u32 v183, v31, 10, v183
  v_bfe_u32 v31, v0, 3, 1
  v_lshl_add_u32 v183, v31, 7, v183
  v_bfe_u32 v31, v0, 0, 2
  v_lshl_add_u32 v183, v31, 3, v183
  v_add_u32 v183, s91, v183
  v_add_u32 v184, 0x10000, v183
  s_lshl_b32 s97, s34, 2
  s_add_u32 s97, s97, s32
  s_lshl_b32 s98, s97, 14
  s_lshl_b32 s91, s33, 21
  s_add_u32 s98, s98, s91
  s_lshl_b32 s97, s97, 16
  s_lshl_b32 s91, s33, 11
  s_add_u32 s97, s97, s91
  v_mov_b32 v16, 0x0
  v_bfe_u32 v31, v0, 0, 4
  v_lshl_add_u32 v16, v31, 7, v16
  v_bfe_u32 v31, v0, 4, 2
  v_lshl_add_u32 v16, v31, 13, v16
  v_add_u32 v17, 0x8000, v16
  v_lshlrev_b32 v18, 7, v0
  v_add_u32 v19, 0x2000, v18
  s_lshl_b32 s97, s34, 2
  s_add_u32 s97, s97, s32
  s_lshl_b32 s98, s97, 14
  s_lshl_b32 s91, s33, 21
  s_add_u32 s98, s98, s91
  s_lshl_b32 s97, s97, 16
  s_lshl_b32 s91, s33, 11
  s_add_u32 s97, s97, s91
  v_mov_b32 v16, 0x180
  v_bfe_u32 v31, v0, 0, 1
  v_lshl_add_u32 v16, v31, 10, v16
  v_bfe_u32 v31, v0, 1, 3
  v_lshl_add_u32 v16, v31, 13, v16
  v_mov_b32 v17, 0x180
  v_bfe_u32 v31, v0, 0, 4
  v_lshl_add_u32 v17, v31, 10, v17
  s_mov_b64 exec, 0xffff
  buffer_load_dword v201, v16, s[12:15], s97 offen
  buffer_load_dword v202, v16, s[16:19], s97 offen
  buffer_load_dword v200, v16, s[8:11], s97 offen
  buffer_load_dword v203, v17, s[20:23], s98 offen
  s_mov_b64 exec, -1
  s_lshl_b32 s58, s33, 5
  s_add_u32 s58, s58, s34
  s_lshl_b32 s59, s32, 19
  s_add_u32 s59, s59, 0x3800000
  s_lshl_b32 s90, s58, 11
  s_add_u32 s90, s90, s59
  s_mul_i32 s91, s58, 3072
  s_add_u32 s91, s91, s59
  s_add_u32 s91, s91, 0x200000
  v_lshlrev_b32 v6, 4, v0
  v_mov_b32 v8, -1
  v_mov_b32 v12, 0
  v_mov_b32 v9, -1
  v_mov_b32 v13, 0
  v_mov_b32 v10, -1
  v_mov_b32 v14, 0
  v_mov_b32 v11, -1
  v_mov_b32 v15, 0
  buffer_store_dwordx4 v[8:11], v6, s[4:7], s90 offen offset:0 sc1
  buffer_store_dwordx4 v[8:11], v6, s[4:7], s90 offen offset:1024 sc1
  buffer_store_dwordx4 v[8:11], v6, s[4:7], s91 offen offset:0 sc1
  buffer_store_dwordx4 v[8:11], v6, s[4:7], s91 offen offset:1024 sc1
  buffer_store_dwordx4 v[8:11], v6, s[4:7], s91 offen offset:2048 sc1
  s_lshl_b32 s58, s58, 2
  s_add_u32 s58, s58, s32
  s_cmp_ge_u32 s58, 36
  s_cbranch_scc1 FL_nz_1
  s_lshl_b32 s90, s58, 10
  s_add_u32 s90, s90, 0x3d00000
  buffer_store_dwordx4 v[12:15], v6, s[4:7], s90 offen sc1
FL_nz_1:
  s_cmp_lg_u32 s58, 3
  s_cbranch_scc1 FL_np_2
  v_mov_b32 v6, 0x3840000
  v_bfe_u32 v31, v0, 0, 1
  v_lshl_add_u32 v6, v31, 13, v6
  v_bfe_u32 v31, v0, 1, 1
  s_mov_b32 s99, 4352
  v_mad_u32_u24 v6, v31, s99, v6
  v_bfe_u32 v31, v0, 2, 2
  s_mov_b32 s99, 82432
  v_mad_u32_u24 v6, v31, s99, v6
  v_mov_b32 v7, -1
  s_mov_b64 exec, 0xffff
  buffer_store_dword v7, v6, s[4:7], 0 offen sc1
  s_mov_b64 exec, -1
  s_waitcnt vmcnt(0)
FL_np_2:
  s_add_u32 m0, s96, 0
  s_mov_b32 s90, 0x0
  buffer_load_dwordx4 v180, s[12:15], s90 offen  lds
  s_add_u32 m0, s96, 1024
  s_mov_b32 s90, 0x10000
  buffer_load_dwordx4 v180, s[12:15], s90 offen  lds
  s_add_u32 m0, s96, 2048
  s_mov_b32 s90, 0x20000
  buffer_load_dwordx4 v180, s[12:15], s90 offen  lds
  s_add_u32 m0, s96, 3072
  s_mov_b32 s90, 0x30000
  buffer_load_dwordx4 v180, s[12:15], s90 offen  lds
  s_add_u32 m0, s96, 4096
  s_mov_b32 s90, 0x0
  buffer_load_dwordx4 v185, s[16:19], s90 offen  lds
  s_add_u32 m0, s96, 5120
  s_mov_b32 s90, 0x10000
  buffer_load_dwordx4 v185, s[16:19], s90 offen  lds
  s_add_u32 m0, s96, 6144
  s_mov_b32 s90, 0x20000
  buffer_load_dwordx4 v185, s[16:19], s90 offen  lds
  s_add_u32 m0, s96, 7168
  s_mov_b32 s90, 0x30000
  buffer_load_dwordx4 v185, s[16:19], s90 offen  lds
  s_add_u32 m0, s96, 8192
  s_mov_b32 s90, 0x40000
  buffer_load_dwordx4 v180, s[12:15], s90 offen  lds
  s_add_u32 m0, s96, 9216
  s_mov_b32 s90, 0x50000
  buffer_load_dwordx4 v180, s[12:15], s90 offen  lds
  s_add_u32 m0, s96, 10240
  s_mov_b32 s90, 0x60000
  buffer_load_dwordx4 v180, s[12:15], s90 offen  lds
  s_add_u32 m0, s96, 11264
  s_mov_b32 s90, 0x70000
  buffer_load_dwordx4 v180, s[12:15], s90 offen  lds
  s_add_u32 m0, s96, 12288
  s_mov_b32 s90, 0x40000
  buffer_load_dwordx4 v185, s[16:19], s90 offen  lds
  s_add_u32 m0, s96, 13312
  s_mov_b32 s90, 0x50000
  buffer_load_dwordx4 v185, s[16:19], s90 offen  lds
  s_add_u32 m0, s96, 14336
  s_mov_b32 s90, 0x60000
  buffer_load_dwordx4 v185, s[16:19], s90 offen  lds
  s_add_u32 m0, s96, 15360
  s_mov_b32 s90, 0x70000
  buffer_load_dwordx4 v185, s[16:19], s90 offen  lds
  s_add_u32 m0, s96, 16384
  s_mov_b32 s90, 0x80000
  buffer_load_dwordx4 v180, s[12:15], s90 offen  lds
  s_add_u32 m0, s96, 17408
  s_mov_b32 s90, 0x90000
  buffer_load_dwordx4 v180, s[12:15], s90 offen  lds
  s_add_u32 m0, s96, 18432
  s_mov_b32 s90, 0xa0000
  buffer_load_dwordx4 v180, s[12:15], s90 offen  lds
  s_add_u32 m0, s96, 19456
  s_mov_b32 s90, 0xb0000
  buffer_load_dwordx4 v180, s[12:15], s90 offen  lds
  s_add_u32 m0, s96, 20480
  s_mov_b32 s90, 0x80000
  buffer_load_dwordx4 v185, s[16:19], s90 offen  lds
  s_add_u32 m0, s96, 21504
  s_mov_b32 s90, 0x90000
  buffer_load_dwordx4 v185, s[16:19], s90 offen  lds
  s_add_u32 m0, s96, 22528
  s_mov_b32 s90, 0xa0000
  buffer_load_dwordx4 v185, s[16:19], s90 offen  lds
  s_add_u32 m0, s96, 23552
  s_mov_b32 s90, 0xb0000
  buffer_load_dwordx4 v185, s[16:19], s90 offen  lds
  s_add_u32 m0, s96, 24576
  s_mov_b32 s90, 0xc0000
  buffer_load_dwordx4 v180, s[12:15], s90 offen  lds
  s_add_u32 m0, s96, 25600
  s_mov_b32 s90, 0xd0000
  buffer_load_dwordx4 v180, s[12:15], s90 offen  lds
  s_add_u32 m0, s96, 26624
  s_mov_b32 s90, 0xe0000
  buffer_load_dwordx4 v180, s[12:15], s90 offen  lds
  s_add_u32 m0, s96, 27648
  s_mov_b32 s90, 0xf0000
  buffer_load_dwordx4 v180, s[12:15], s90 offen  lds
  s_add_u32 m0, s96, 28672
  s_mov_b32 s90, 0xc0000
  buffer_load_dwordx4 v185, s[16:19], s90 offen  lds
  s_add_u32 m0, s96, 29696
  s_mov_b32 s90, 0xd0000
  buffer_load_dwordx4 v185, s[16:19], s90 offen  lds
  s_add_u32 m0, s96, 30720
  s_mov_b32 s90, 0xe0000
  buffer_load_dwordx4 v185, s[16:19], s90 offen  lds
  s_add_u32 m0, s96, 31744
  s_mov_b32 s90, 0xf0000
  buffer_load_dwordx4 v185, s[16:19], s90 offen  lds
  s_cmp_lg_u32 s58, 3
  s_cbranch_scc1 FL_np_3
  s_add_u32 s92, s94, 0x3840000
  s_addc_u32 s93, s95, 0
  s_mov_b32 s62, -1
  s_mov_b32 s63, -1
  s_memtime s[56:57]
  s_waitcnt lgkmcnt(0)
  s_load_dword s60, s[92:93], 0x0
  s_waitcnt lgkmcnt(0)
  s_memtime s[58:59]
  s_waitcnt lgkmcnt(0)
  s_sub_u32 s58, s58, s56
  s_min_u32 s62, s62, s58
  s_memtime s[56:57]
  s_waitcnt lgkmcnt(0)
  s_load_dword s60, s[92:93], 0x2000
  s_waitcnt lgkmcnt(0)
  s_memtime s[58:59]
  s_waitcnt lgkmcnt(0)
  s_sub_u32 s58, s58, s56
  s_min_u32 s63, s63, s58
  s_memtime s[56:57]
  s_waitcnt lgkmcnt(0)
  s_load_dword s60, s[92:93], 0x1100
  s_waitcnt lgkmcnt(0)
  s_memtime s[58:59]
  s_waitcnt lgkmcnt(0)
  s_sub_u32 s58, s58, s56
  s_min_u32 s62, s62, s58
  s_memtime s[56:57]
  s_waitcnt lgkmcnt(0)
  s_load_dword s60, s[92:93], 0x3100
  s_waitcnt lgkmcnt(0)
  s_memtime s[58:59]
  s_waitcnt lgkmcnt(0)
  s_sub_u32 s58, s58, s56
  s_min_u32 s63, s63, s58
  s_memtime s[56:57]
  s_waitcnt lgkmcnt(0)
  s_load_dword s60, s[92:93], 0x14200
  s_waitcnt lgkmcnt(0)
  s_memtime s[58:59]
  s_waitcnt lgkmcnt(0)
  s_sub_u32 s58, s58, s56
  s_min_u32 s62, s62, s58
  s_memtime s[56:57]
  s_waitcnt lgkmcnt(0)
  s_load_dword s60, s[92:93], 0x16200
  s_waitcnt lgkmcnt(0)
  s_memtime s[58:59]
  s_waitcnt lgkmcnt(0)
  s_sub_u32 s58, s58, s56
  s_min_u32 s63, s63, s58
  s_memtime s[56:57]
  s_waitcnt lgkmcnt(0)
  s_load_dword s60, s[92:93], 0x15300
  s_waitcnt lgkmcnt(0)
  s_memtime s[58:59]
  s_waitcnt lgkmcnt(0)
  s_sub_u32 s58, s58, s56
  s_min_u32 s62, s62, s58
  s_memtime s[56:57]
  s_waitcnt lgkmcnt(0)
  s_load_dword s60, s[92:93], 0x17300
  s_waitcnt lgkmcnt(0)
  s_memtime s[58:59]
  s_waitcnt lgkmcnt(0)
  s_sub_u32 s58, s58, s56
  s_min_u32 s63, s63, s58
  s_cmp_lt_u32 s63, s62
  s_cselect_b32 s60, 2, 1
  v_mov_b32 v6, s60
  v_mov_b32 v7, s62
  v_mov_b32 v8, s63
  v_mov_b32 v9, 0
  s_mov_b64 exec, 1
  buffer_store_dword v6, v9, s[28:31], 0 offen offset:128 sc1
  s_mov_b64 exec, -1
FL_np_3:
  s_lshl_b32 s90, s34, 2
  s_add_u32 s90, s90, s32
  s_lshr_b32 s91, s90, 3
  s_lshl_b32 s91, s91, 14
  s_and_b32 s92, s90, 7
  s_lshl_b32 s92, s92, 10
  s_add_u32 s91, s91, s92
  v_mov_b32 v1, 0x0
  v_bfe_u32 v31, v0, 0, 6
  v_lshl_add_u32 v1, v31, 4, v1
  v_add_u32 v1, s91, v1
  v_lshrrev_b32 v30, 4, v0
  v_cmp_eq_u32 vcc, s33, v30
  v_xor_b32 v29, 0x2000, v1
  s_nop 0
  v_cndmask_b32 v1, v1, v29, vcc
  s_lshl_b32 s91, s33, 14
  s_lshl_b32 s92, s90, 7
  s_add_u32 s91, s91, s92
  v_mov_b32 v2, 0x200000
  v_bfe_u32 v31, v0, 0, 2
  v_lshl_add_u32 v2, v31, 2, v2
  v_bfe_u32 v31, v0, 2, 1
  v_lshl_add_u32 v2, v31, 6, v2
  v_bfe_u32 v31, v0, 4, 1
  v_lshl_add_u32 v2, v31, 4, v2
  v_bfe_u32 v31, v0, 5, 1
  v_lshl_add_u32 v2, v31, 5, v2
  v_bfe_u32 v31, v0, 3, 1
  v_lshl_add_u32 v2, v31, 31, v2
  v_add_u32 v2, s91, v2
  s_lshr_b32 s92, s90, 1
  s_lshl_b32 s92, s92, 5
  s_and_b32 s91, s90, 1
  s_lshl_b32 s91, s91, 13
  s_add_u32 s92, s92, s91
  v_mov_b32 v30, 0x0
  v_bfe_u32 v31, v0, 2, 1
  v_lshl_add_u32 v30, v31, 12, v30
  v_bfe_u32 v31, v0, 4, 1
  v_lshl_add_u32 v30, v31, 11, v30
  v_bfe_u32 v31, v0, 0, 2
  v_lshl_add_u32 v30, v31, 3, v30
  v_bfe_u32 v31, v0, 5, 1
  v_lshl_add_u32 v30, v31, 2, v30
  v_add_u32 v30, s92, v30
  buffer_load_dword v44, v30, s[24:27], 0 offen
  s_lshl_b32 s91, s33, 14
  s_lshl_b32 s92, s32, 12
  s_add_u32 s91, s91, s92
  v_mov_b32 v3, 0x200000
  v_bfe_u32 v31, v0, 0, 6
  v_lshl_add_u32 v3, v31, 4, v3
  v_add_u32 v3, s91, v3
  s_mul_i32 s91, s32, 3264
  v_mov_b32 v4, 0x0
  v_bfe_u32 v31, v0, 0, 6
  v_lshl_add_u32 v4, v31, 4, v4
  v_add_u32 v4, s91, v4
  s_lshl_b32 s91, s32, 6
  v_mov_b32 v6, 0x0
  v_bfe_u32 v31, v0, 0, 2
  v_lshl_add_u32 v6, v31, 4, v6
  v_bfe_u32 v31, v0, 2, 1
  v_lshl_add_u32 v6, v31, 2, v6
  v_bfe_u32 v31, v0, 3, 1
  s_mov_b32 s99, 1088
  v_mad_u32_u24 v6, v31, s99, v6
  v_bfe_u32 v31, v0, 4, 2
  v_lshl_add_u32 v6, v31, 8, v6
  v_add_u32 v6, s91, v6
  v_add_u32 v240, 3264, v6
  v_add_u32 v241, 6528, v6
  v_add_u32 v242, 9792, v6
  s_lshl_b32 s93, s37, 13
  s_lshl_b32 s91, s38, 10
  s_add_u32 s91, s91, s93
  s_lshl_b32 s92, s32, 8
  s_add_u32 s91, s91, s92
  v_mov_b32 v7, 0x210000
  v_bfe_u32 v31, v0, 0, 6
  v_lshl_add_u32 v7, v31, 2, v7
  v_add_u32 v7, s91, v7
  s_lshl_b32 s91, s37, 11
  s_lshl_b32 s92, s38, 9
  s_add_u32 s59, s91, s92
  s_lshl_b32 s92, s32, 7
  s_add_u32 s91, s59, s92
  v_mov_b32 v19, 0x83000000
  v_bfe_u32 v31, v0, 0, 3
  v_lshl_add_u32 v19, v31, 2, v19
  v_bfe_u32 v31, v0, 4, 2
  v_lshl_add_u32 v19, v31, 5, v19
  v_bfe_u32 v31, v0, 3, 1
  v_lshl_add_u32 v19, v31, 31, v19
  v_add_u32 v19, s91, v19
  s_lshl_b32 s91, s32, 8
  v_mov_b32 v5, 0x880
  v_bfe_u32 v31, v0, 0, 1
  v_lshl_add_u32 v5, v31, 7, v5
  v_bfe_u32 v31, v0, 1, 1
  v_lshl_add_u32 v5, v31, 3, v5
  v_bfe_u32 v31, v0, 2, 3
  v_lshl_add_u32 v5, v31, 4, v5
  v_add_u32 v5, s91, v5
  s_lshr_b32 s92, s38, 1
  s_xor_b32 s92, s92, 1
  s_lshl_b32 s92, s92, 10
  s_add_u32 s91, s91, s92
  s_add_u32 s91, s91, s93
  s_and_b32 s92, s38, 1
  s_lshl_b32 s92, s92, 7
  s_add_u32 s91, s91, s92
  v_mov_b32 v8, 0x211000
  v_bfe_u32 v31, v0, 0, 5
  v_lshl_add_u32 v8, v31, 2, v8
  v_bfe_u32 v31, v0, 5, 1
  v_lshl_add_u32 v8, v31, 31, v8
  v_add_u32 v8, s91, v8
  s_sub_u32 s91, s91, s93
  s_lshl_b32 s92, s37, 11
  s_add_u32 s91, s91, s92
  v_mov_b32 v20, 0x3400000
  v_bfe_u32 v31, v0, 0, 5
  v_lshl_add_u32 v20, v31, 2, v20
  v_bfe_u32 v31, v0, 5, 1
  v_lshl_add_u32 v20, v31, 31, v20
  v_add_u32 v20, s91, v20
  s_lshl_b32 s97, s35, 2
  s_add_u32 s97, s97, s32
  s_lshl_b32 s97, s97, 13
  v_mov_b32 v9, 0x210000
  v_bfe_u32 v31, v0, 0, 6
  v_lshl_add_u32 v9, v31, 4, v9
  v_add_u32 v9, s97, v9
  v_add_u32 v10, 4096, v9
  v_mov_b32 v11, 0x1000000
  v_bfe_u32 v31, v0, 0, 2
  v_lshl_add_u32 v11, v31, 4, v11
  v_bfe_u32 v31, v0, 2, 1
  v_lshl_add_u32 v11, v31, 7, v11
  v_bfe_u32 v31, v0, 3, 1
  v_lshl_add_u32 v11, v31, 12, v11
  v_bfe_u32 v31, v0, 4, 2
  v_lshl_add_u32 v11, v31, 8, v11
  v_add_u32 v11, s97, v11
  v_mov_b32 v12, 0x2000000
  v_bfe_u32 v31, v0, 0, 3
  v_lshl_add_u32 v12, v31, 4, v12
  v_bfe_u32 v31, v0, 3, 1
  v_lshl_add_u32 v12, v31, 11, v12
  v_bfe_u32 v31, v0, 4, 2
  v_lshl_add_u32 v12, v31, 8, v12
  v_add_u32 v12, s97, v12
  v_add_u32 v13, 4096, v12
  s_lshl_b32 s91, s36, 9
  s_add_u32 s91, s91, s97
  s_add_u32 s63, s91, 0x1000000
  v_mov_b32 v21, 0x1000000
  v_bfe_u32 v31, v0, 0, 2
  v_lshl_add_u32 v21, v31, 7, v21
  v_bfe_u32 v31, v0, 2, 1
  v_lshl_add_u32 v21, v31, 24, v21
  v_add_u32 v21, s91, v21
  v_cmp_gt_u32 vcc, 8, v0
  v_mov_b32 v30, 0x80000000
  s_nop 0
  v_cndmask_b32 v21, v30, v21, vcc
  s_lshl_b32 s91, s32, 11
  v_mov_b32 v30, 0x0
  v_bfe_u32 v31, v0, 2, 1
  v_lshl_add_u32 v30, v31, 6, v30
  v_bfe_u32 v31, v0, 0, 1
  v_lshl_add_u32 v30, v31, 5, v30
  v_bfe_u32 v31, v0, 1, 1
  v_lshl_add_u32 v30, v31, 4, v30
  v_mov_b32 v29, 0x0
  v_bfe_u32 v31, v0, 4, 2
  v_lshl_add_u32 v29, v31, 5, v29
  v_xor_b32 v30, v30, v29
  v_mov_b32 v14, 0x3400
  v_bfe_u32 v31, v0, 0, 4
  v_lshl_add_u32 v14, v31, 7, v14
  v_add_u32 v14, s91, v14
  v_add_u32 v14, v14, v30
  v_xor_b32 v15, 16, v14
  v_mov_b32 v30, 0x0
  v_bfe_u32 v31, v0, 5, 1
  v_lshl_add_u32 v30, v31, 6, v30
  v_bfe_u32 v31, v0, 1, 1
  v_lshl_add_u32 v30, v31, 5, v30
  v_bfe_u32 v31, v0, 4, 1
  v_lshl_add_u32 v30, v31, 4, v30
  v_mov_b32 v29, 0x0
  v_bfe_u32 v31, v0, 2, 2
  v_lshl_add_u32 v29, v31, 5, v29
  v_bfe_u32 v31, v0, 0, 1
  v_lshl_add_u32 v29, v31, 4, v29
  v_xor_b32 v30, v30, v29
  v_mov_b32 v16, 0x3400
  v_bfe_u32 v31, v0, 4, 2
  v_lshl_add_u32 v16, v31, 8, v16
  v_bfe_u32 v31, v0, 1, 1
  v_lshl_add_u32 v16, v31, 7, v16
  v_add_u32 v16, v16, v30
  s_lshl_b32 s98, s36, 14
  s_lshl_b32 s92, s35, 7
  s_add_u32 s98, s98, s92
  s_lshl_b32 s92, s32, 11
  s_add_u32 s91, s98, s92
  v_mov_b32 v17, 0x0
  v_bfe_u32 v31, v0, 0, 5
  v_lshl_add_u32 v17, v31, 2, v17
  v_bfe_u32 v31, v0, 5, 1
  v_lshl_add_u32 v17, v31, 10, v17
  v_add_u32 v17, s91, v17
  v_xor_b32 v18, 0x2000, v17
  s_mov_b32 s48, 0x33333333
  s_mov_b32 s49, 0x33333333
  s_mov_b32 s50, 0xffff0000
  s_mov_b32 s51, 0xffff0000
  s_mov_b32 s52, 0x0000ffff
  s_mov_b32 s53, 0x0000ffff
  s_mov_b32 s54, 0xfffffffe
  s_mov_b32 s47, 0x3e0293ee
  v_mov_b32 v30, 0x4444
  v_mov_b32 v31, 0xeeee
  v_cndmask_b32 v23, v31, v30, s[48:49]
  v_mov_b32 v22, -1
  v_mov_b32 v232, 0
  v_mov_b32 v233, 0
  v_mov_b32 v234, 0
  v_mov_b32 v235, 0
  v_mov_b32 v112, 0
  v_mov_b32 v113, 0
  s_mov_b32 s56, 0xf0f0f0f0
  s_mov_b32 s57, 0xf0f0f0f0
  v_mov_b32 v30, 0x3f80
  v_mov_b32 v31, 1.0
  v_cndmask_b32 v30, v30, v31, s[56:57]
  s_mov_b32 s56, 0x110011
  s_mov_b32 s57, 0x110011
  v_cndmask_b32 v24, 0, v30, s[56:57]
  s_mov_b32 s56, 0x220022
  s_mov_b32 s57, 0x220022
  v_cndmask_b32 v25, 0, v30, s[56:57]
  s_mov_b32 s56, 0x11001100
  s_mov_b32 s57, 0x11001100
  v_cndmask_b32 v26, 0, v30, s[56:57]
  s_mov_b32 s56, 0x22002200
  s_mov_b32 s57, 0x22002200
  v_cndmask_b32 v27, 0, v30, s[56:57]
  s_mov_b32 s40, 0
  s_mov_b32 s41, 0x3800000
  s_mov_b32 s43, 0x3900000
  s_mov_b32 s44, 0
  s_mov_b32 s55, 0x40000
  s_mov_b32 s45, 0
  s_waitcnt vmcnt(33)
  s_barrier
  s_cmp_lg_u32 s32, 0
  s_cbranch_scc1 FL_sig_4
  v_mov_b32 v254, 1
  v_mov_b32 v255, 0
  s_mov_b64 exec, 1
  buffer_atomic_add v254, v255, s[28:31], s100 offen offset:132 sc1
  s_mov_b64 exec, -1
FL_sig_4:
  s_mov_b32 s90, 0x3e0000
  buffer_store_dword v22, v19, s[4:7], s90 offen sc1
  buffer_store_dword v22, v20, s[4:7], s90 offen sc1
  s_mov_b32 s90, 0x3f0000
  buffer_store_dword v22, v19, s[4:7], s90 offen sc1
  buffer_store_dword v22, v20, s[4:7], s90 offen sc1
  s_waitcnt vmcnt(28)
  ds_read_b64_tr_b16 a[16:17], v182 offset:0
  ds_read_b64_tr_b16 a[18:19], v182 offset:512
  ds_read_b64_tr_b16 a[24:25], v182 offset:32
  ds_read_b64_tr_b16 a[26:27], v182 offset:544
  s_waitcnt lgkmcnt(0)
  s_add_u32 m0, s96, 0
  s_mov_b32 s90, 0x100000
  buffer_load_dwordx4 v180, s[12:15], s90 offen  lds
  s_add_u32 m0, s96, 1024
  s_mov_b32 s90, 0x110000
  buffer_load_dwordx4 v180, s[12:15], s90 offen  lds
  s_add_u32 m0, s96, 2048
  s_mov_b32 s90, 0x120000
  buffer_load_dwordx4 v180, s[12:15], s90 offen  lds
  s_add_u32 m0, s96, 3072
  s_mov_b32 s90, 0x130000
  buffer_load_dwordx4 v180, s[12:15], s90 offen  lds
  s_waitcnt vmcnt(28)
  ds_read_b64_tr_b16 a[32:33], v182 offset:4096
  ds_read_b64_tr_b16 a[34:35], v182 offset:4608
  ds_read_b64_tr_b16 a[40:41], v182 offset:4128
  ds_read_b64_tr_b16 a[42:43], v182 offset:4640
  s_waitcnt lgkmcnt(0)
  s_add_u32 m0, s96, 4096
  s_mov_b32 s90, 0x100000
  buffer_load_dwordx4 v185, s[16:19], s90 offen  lds
  s_add_u32 m0, s96, 5120
  s_mov_b32 s90, 0x110000
  buffer_load_dwordx4 v185, s[16:19], s90 offen  lds
  s_add_u32 m0, s96, 6144
  s_mov_b32 s90, 0x120000
  buffer_load_dwordx4 v185, s[16:19], s90 offen  lds
  s_add_u32 m0, s96, 7168
  s_mov_b32 s90, 0x130000
  buffer_load_dwordx4 v185, s[16:19], s90 offen  lds
  s_waitcnt vmcnt(28)
  ds_read_b64_tr_b16 a[20:21], v182 offset:8192
  ds_read_b64_tr_b16 a[22:23], v182 offset:8704
  ds_read_b64_tr_b16 a[28:29], v182 offset:8224
  ds_read_b64_tr_b16 a[30:31], v182 offset:8736
  s_waitcnt lgkmcnt(0)
  s_add_u32 m0, s96, 8192
  s_mov_b32 s90, 0x140000
  buffer_load_dwordx4 v180, s[12:15], s90 offen  lds
  s_add_u32 m0, s96, 9216
  s_mov_b32 s90, 0x150000
  buffer_load_dwordx4 v180, s[12:15], s90 offen  lds
  s_add_u32 m0, s96, 10240
  s_mov_b32 s90, 0x160000
  buffer_load_dwordx4 v180, s[12:15], s90 offen  lds
  s_add_u32 m0, s96, 11264
  s_mov_b32 s90, 0x170000
  buffer_load_dwordx4 v180, s[12:15], s90 offen  lds
  s_waitcnt vmcnt(28)
  ds_read_b64_tr_b16 a[36:37], v182 offset:12288
  ds_read_b64_tr_b16 a[38:39], v182 offset:12800
  ds_read_b64_tr_b16 a[44:45], v182 offset:12320
  ds_read_b64_tr_b16 a[46:47], v182 offset:12832
  s_waitcnt lgkmcnt(0)
  s_add_u32 m0, s96, 12288
  s_mov_b32 s90, 0x140000
  buffer_load_dwordx4 v185, s[16:19], s90 offen  lds
  s_add_u32 m0, s96, 13312
  s_mov_b32 s90, 0x150000
  buffer_load_dwordx4 v185, s[16:19], s90 offen  lds
  s_add_u32 m0, s96, 14336
  s_mov_b32 s90, 0x160000
  buffer_load_dwordx4 v185, s[16:19], s90 offen  lds
  s_add_u32 m0, s96, 15360
  s_mov_b32 s90, 0x170000
  buffer_load_dwordx4 v185, s[16:19], s90 offen  lds
  s_waitcnt vmcnt(28)
  ds_read_b64_tr_b16 a[64:65], v182 offset:16384
  ds_read_b64_tr_b16 a[66:67], v182 offset:16896
  ds_read_b64_tr_b16 a[72:73], v182 offset:16416
  ds_read_b64_tr_b16 a[74:75], v182 offset:16928
  s_waitcnt lgkmcnt(0)
  s_add_u32 m0, s96, 16384
  s_mov_b32 s90, 0x180000
  buffer_load_dwordx4 v180, s[12:15], s90 offen  lds
  s_add_u32 m0, s96, 17408
  s_mov_b32 s90, 0x190000
  buffer_load_dwordx4 v180, s[12:15], s90 offen  lds
  s_add_u32 m0, s96, 18432
  s_mov_b32 s90, 0x1a0000
  buffer_load_dwordx4 v180, s[12:15], s90 offen  lds
  s_add_u32 m0, s96, 19456
  s_mov_b32 s90, 0x1b0000
  buffer_load_dwordx4 v180, s[12:15], s90 offen  lds
  s_waitcnt vmcnt(28)
  ds_read_b64_tr_b16 a[80:81], v182 offset:20480
  ds_read_b64_tr_b16 a[82:83], v182 offset:20992
  ds_read_b64_tr_b16 a[88:89], v182 offset:20512
  ds_read_b64_tr_b16 a[90:91], v182 offset:21024
  s_waitcnt lgkmcnt(0)
  s_add_u32 m0, s96, 20480
  s_mov_b32 s90, 0x180000
  buffer_load_dwordx4 v185, s[16:19], s90 offen  lds
  s_add_u32 m0, s96, 21504
  s_mov_b32 s90, 0x190000
  buffer_load_dwordx4 v185, s[16:19], s90 offen  lds
  s_add_u32 m0, s96, 22528
  s_mov_b32 s90, 0x1a0000
  buffer_load_dwordx4 v185, s[16:19], s90 offen  lds
  s_add_u32 m0, s96, 23552
  s_mov_b32 s90, 0x1b0000
  buffer_load_dwordx4 v185, s[16:19], s90 offen  lds
  s_waitcnt vmcnt(28)
  ds_read_b64_tr_b16 a[68:69], v182 offset:24576
  ds_read_b64_tr_b16 a[70:71], v182 offset:25088
  ds_read_b64_tr_b16 a[76:77], v182 offset:24608
  ds_read_b64_tr_b16 a[78:79], v182 offset:25120
  s_waitcnt lgkmcnt(0)
  s_add_u32 m0, s96, 24576
  s_mov_b32 s90, 0x1c0000
  buffer_load_dwordx4 v180, s[12:15], s90 offen  lds
  s_add_u32 m0, s96, 25600
  s_mov_b32 s90, 0x1d0000
  buffer_load_dwordx4 v180, s[12:15], s90 offen  lds
  s_add_u32 m0, s96, 26624
  s_mov_b32 s90, 0x1e0000
  buffer_load_dwordx4 v180, s[12:15], s90 offen  lds
  s_add_u32 m0, s96, 27648
  s_mov_b32 s90, 0x1f0000
  buffer_load_dwordx4 v180, s[12:15], s90 offen  lds
  s_waitcnt vmcnt(28)
  ds_read_b64_tr_b16 a[84:85], v182 offset:28672
  ds_read_b64_tr_b16 a[86:87], v182 offset:29184
  ds_read_b64_tr_b16 a[92:93], v182 offset:28704
  ds_read_b64_tr_b16 a[94:95], v182 offset:29216
  s_waitcnt lgkmcnt(0)
  s_add_u32 m0, s96, 28672
  s_mov_b32 s90, 0x1c0000
  buffer_load_dwordx4 v185, s[16:19], s90 offen  lds
  s_add_u32 m0, s96, 29696
  s_mov_b32 s90, 0x1d0000
  buffer_load_dwordx4 v185, s[16:19], s90 offen  lds
  s_add_u32 m0, s96, 30720
  s_mov_b32 s90, 0x1e0000
  buffer_load_dwordx4 v185, s[16:19], s90 offen  lds
  s_add_u32 m0, s96, 31744
  s_mov_b32 s90, 0x1f0000
  buffer_load_dwordx4 v185, s[16:19], s90 offen  lds
  s_waitcnt vmcnt(28)
  ds_read_b64_tr_b16 a[112:113], v182 offset:0
  ds_read_b64_tr_b16 a[114:115], v182 offset:512
  ds_read_b64_tr_b16 a[120:121], v182 offset:32
  ds_read_b64_tr_b16 a[122:123], v182 offset:544
  s_waitcnt lgkmcnt(0)
  s_add_u32 m0, s96, 0
  s_mov_b32 s90, 0x0
  buffer_load_dwordx4 v180, s[8:11], s90 offen  lds
  s_add_u32 m0, s96, 1024
  s_mov_b32 s90, 0x10000
  buffer_load_dwordx4 v180, s[8:11], s90 offen  lds
  s_add_u32 m0, s96, 2048
  s_mov_b32 s90, 0x20000
  buffer_load_dwordx4 v180, s[8:11], s90 offen  lds
  s_add_u32 m0, s96, 3072
  s_mov_b32 s90, 0x30000
  buffer_load_dwordx4 v180, s[8:11], s90 offen  lds
  s_waitcnt vmcnt(28)
  ds_read_b64_tr_b16 a[128:129], v182 offset:4096
  ds_read_b64_tr_b16 a[130:131], v182 offset:4608
  ds_read_b64_tr_b16 a[136:137], v182 offset:4128
  ds_read_b64_tr_b16 a[138:139], v182 offset:4640
  s_waitcnt lgkmcnt(0)
  s_add_u32 m0, s96, 4096
  s_mov_b32 s90, 0x40000
  buffer_load_dwordx4 v180, s[8:11], s90 offen  lds
  s_add_u32 m0, s96, 5120
  s_mov_b32 s90, 0x50000
  buffer_load_dwordx4 v180, s[8:11], s90 offen  lds
  s_add_u32 m0, s96, 6144
  s_mov_b32 s90, 0x60000
  buffer_load_dwordx4 v180, s[8:11], s90 offen  lds
  s_add_u32 m0, s96, 7168
  s_mov_b32 s90, 0x70000
  buffer_load_dwordx4 v180, s[8:11], s90 offen  lds
  s_waitcnt vmcnt(28)
  ds_read_b64_tr_b16 a[116:117], v182 offset:8192
  ds_read_b64_tr_b16 a[118:119], v182 offset:8704
  ds_read_b64_tr_b16 a[124:125], v182 offset:8224
  ds_read_b64_tr_b16 a[126:127], v182 offset:8736
  s_waitcnt lgkmcnt(0)
  s_add_u32 m0, s96, 8192
  s_mov_b32 s90, 0x80000
  buffer_load_dwordx4 v180, s[8:11], s90 offen  lds
  s_add_u32 m0, s96, 9216
  s_mov_b32 s90, 0x90000
  buffer_load_dwordx4 v180, s[8:11], s90 offen  lds
  s_add_u32 m0, s96, 10240
  s_mov_b32 s90, 0xa0000
  buffer_load_dwordx4 v180, s[8:11], s90 offen  lds
  s_add_u32 m0, s96, 11264
  s_mov_b32 s90, 0xb0000
  buffer_load_dwordx4 v180, s[8:11], s90 offen  lds
  s_waitcnt vmcnt(28)
  ds_read_b64_tr_b16 a[132:133], v182 offset:12288
  ds_read_b64_tr_b16 a[134:135], v182 offset:12800
  ds_read_b64_tr_b16 a[140:141], v182 offset:12320
  ds_read_b64_tr_b16 a[142:143], v182 offset:12832
  s_waitcnt lgkmcnt(0)
  s_add_u32 m0, s96, 12288
  s_mov_b32 s90, 0xc0000
  buffer_load_dwordx4 v180, s[8:11], s90 offen  lds
  s_add_u32 m0, s96, 13312
  s_mov_b32 s90, 0xd0000
  buffer_load_dwordx4 v180, s[8:11], s90 offen  lds
  s_add_u32 m0, s96, 14336
  s_mov_b32 s90, 0xe0000
  buffer_load_dwordx4 v180, s[8:11], s90 offen  lds
  s_add_u32 m0, s96, 15360
  s_mov_b32 s90, 0xf0000
  buffer_load_dwordx4 v180, s[8:11], s90 offen  lds
  s_waitcnt vmcnt(28)
  ds_read_b64_tr_b16 a[160:161], v182 offset:16384
  ds_read_b64_tr_b16 a[162:163], v182 offset:16896
  ds_read_b64_tr_b16 a[168:169], v182 offset:16416
  ds_read_b64_tr_b16 a[170:171], v182 offset:16928
  s_waitcnt lgkmcnt(0)
  s_add_u32 m0, s96, 16384
  s_mov_b32 s90, 0x100000
  buffer_load_dwordx4 v180, s[8:11], s90 offen  lds
  s_add_u32 m0, s96, 17408
  s_mov_b32 s90, 0x110000
  buffer_load_dwordx4 v180, s[8:11], s90 offen  lds
  s_add_u32 m0, s96, 18432
  s_mov_b32 s90, 0x120000
  buffer_load_dwordx4 v180, s[8:11], s90 offen  lds
  s_add_u32 m0, s96, 19456
  s_mov_b32 s90, 0x130000
  buffer_load_dwordx4 v180, s[8:11], s90 offen  lds
  s_waitcnt vmcnt(28)
  ds_read_b64_tr_b16 a[176:177], v182 offset:20480
  ds_read_b64_tr_b16 a[178:179], v182 offset:20992
  ds_read_b64_tr_b16 a[184:185], v182 offset:20512
  ds_read_b64_tr_b16 a[186:187], v182 offset:21024
  s_waitcnt lgkmcnt(0)
  s_add_u32 m0, s96, 20480
  s_mov_b32 s90, 0x140000
  buffer_load_dwordx4 v180, s[8:11], s90 offen  lds
  s_add_u32 m0, s96, 21504
  s_mov_b32 s90, 0x150000
  buffer_load_dwordx4 v180, s[8:11], s90 offen  lds
  s_add_u32 m0, s96, 22528
  s_mov_b32 s90, 0x160000
  buffer_load_dwordx4 v180, s[8:11], s90 offen  lds
  s_add_u32 m0, s96, 23552
  s_mov_b32 s90, 0x170000
  buffer_load_dwordx4 v180, s[8:11], s90 offen  lds
  s_waitcnt vmcnt(28)
  ds_read_b64_tr_b16 a[164:165], v182 offset:24576
  ds_read_b64_tr_b16 a[166:167], v182 offset:25088
  ds_read_b64_tr_b16 a[172:173], v182 offset:24608
  ds_read_b64_tr_b16 a[174:175], v182 offset:25120
  s_waitcnt lgkmcnt(0)
  s_add_u32 m0, s96, 24576
  s_mov_b32 s90, 0x180000
  buffer_load_dwordx4 v180, s[8:11], s90 offen  lds
  s_add_u32 m0, s96, 25600
  s_mov_b32 s90, 0x190000
  buffer_load_dwordx4 v180, s[8:11], s90 offen  lds
  s_add_u32 m0, s96, 26624
  s_mov_b32 s90, 0x1a0000
  buffer_load_dwordx4 v180, s[8:11], s90 offen  lds
  s_add_u32 m0, s96, 27648
  s_mov_b32 s90, 0x1b0000
  buffer_load_dwordx4 v180, s[8:11], s90 offen  lds
  s_waitcnt vmcnt(28)
  ds_read_b64_tr_b16 a[180:181], v182 offset:28672
  ds_read_b64_tr_b16 a[182:183], v182 offset:29184
  ds_read_b64_tr_b16 a[188:189], v182 offset:28704
  ds_read_b64_tr_b16 a[190:191], v182 offset:29216
  s_waitcnt lgkmcnt(0)
  s_add_u32 m0, s96, 28672
  s_mov_b32 s90, 0x1c0000
  buffer_load_dwordx4 v180, s[8:11], s90 offen  lds
  s_add_u32 m0, s96, 29696
  s_mov_b32 s90, 0x1d0000
  buffer_load_dwordx4 v180, s[8:11], s90 offen  lds
  s_add_u32 m0, s96, 30720
  s_mov_b32 s90, 0x1e0000
  buffer_load_dwordx4 v180, s[8:11], s90 offen  lds
  s_add_u32 m0, s96, 31744
  s_mov_b32 s90, 0x1f0000
  buffer_load_dwordx4 v180, s[8:11], s90 offen  lds
  s_waitcnt vmcnt(28)
  ds_read_b64_tr_b16 a[0:1], v182 offset:0
  ds_read_b64_tr_b16 a[2:3], v182 offset:512
  ds_read_b64_tr_b16 a[8:9], v182 offset:32
  ds_read_b64_tr_b16 a[10:11], v182 offset:544
  s_waitcnt lgkmcnt(0)
  s_add_u32 m0, s96, 0
  s_mov_b32 s90, 0x0
  buffer_load_dwordx4 v181, s[20:23], s90 offen  lds
  s_add_u32 m0, s96, 1024
  s_mov_b32 s90, 0x4000
  buffer_load_dwordx4 v181, s[20:23], s90 offen  lds
  s_add_u32 m0, s96, 2048
  s_mov_b32 s90, 0x8000
  buffer_load_dwordx4 v181, s[20:23], s90 offen  lds
  s_add_u32 m0, s96, 3072
  s_mov_b32 s90, 0xc000
  buffer_load_dwordx4 v181, s[20:23], s90 offen  lds
  s_waitcnt vmcnt(28)
  ds_read_b64_tr_b16 a[4:5], v182 offset:4096
  ds_read_b64_tr_b16 a[6:7], v182 offset:4608
  ds_read_b64_tr_b16 a[12:13], v182 offset:4128
  ds_read_b64_tr_b16 a[14:15], v182 offset:4640
  s_waitcnt lgkmcnt(0)
  s_add_u32 m0, s96, 4096
  s_mov_b32 s90, 0x10000
  buffer_load_dwordx4 v181, s[20:23], s90 offen  lds
  s_add_u32 m0, s96, 5120
  s_mov_b32 s90, 0x14000
  buffer_load_dwordx4 v181, s[20:23], s90 offen  lds
  s_add_u32 m0, s96, 6144
  s_mov_b32 s90, 0x18000
  buffer_load_dwordx4 v181, s[20:23], s90 offen  lds
  s_add_u32 m0, s96, 7168
  s_mov_b32 s90, 0x1c000
  buffer_load_dwordx4 v181, s[20:23], s90 offen  lds
  s_waitcnt vmcnt(28)
  ds_read_b64_tr_b16 a[48:49], v182 offset:8192
  ds_read_b64_tr_b16 a[50:51], v182 offset:8704
  ds_read_b64_tr_b16 a[56:57], v182 offset:8224
  ds_read_b64_tr_b16 a[58:59], v182 offset:8736
  s_waitcnt lgkmcnt(0)
  s_add_u32 m0, s96, 8192
  s_mov_b32 s90, 0x20000
  buffer_load_dwordx4 v181, s[20:23], s90 offen  lds
  s_add_u32 m0, s96, 9216
  s_mov_b32 s90, 0x24000
  buffer_load_dwordx4 v181, s[20:23], s90 offen  lds
  s_add_u32 m0, s96, 10240
  s_mov_b32 s90, 0x28000
  buffer_load_dwordx4 v181, s[20:23], s90 offen  lds
  s_add_u32 m0, s96, 11264
  s_mov_b32 s90, 0x2c000
  buffer_load_dwordx4 v181, s[20:23], s90 offen  lds
  s_waitcnt vmcnt(28)
  ds_read_b64_tr_b16 a[52:53], v182 offset:12288
  ds_read_b64_tr_b16 a[54:55], v182 offset:12800
  ds_read_b64_tr_b16 a[60:61], v182 offset:12320
  ds_read_b64_tr_b16 a[62:63], v182 offset:12832
  s_waitcnt lgkmcnt(0)
  s_add_u32 m0, s96, 12288
  s_mov_b32 s90, 0x30000
  buffer_load_dwordx4 v181, s[20:23], s90 offen  lds
  s_add_u32 m0, s96, 13312
  s_mov_b32 s90, 0x34000
  buffer_load_dwordx4 v181, s[20:23], s90 offen  lds
  s_add_u32 m0, s96, 14336
  s_mov_b32 s90, 0x38000
  buffer_load_dwordx4 v181, s[20:23], s90 offen  lds
  s_add_u32 m0, s96, 15360
  s_mov_b32 s90, 0x3c000
  buffer_load_dwordx4 v181, s[20:23], s90 offen  lds
  s_mov_b32 s90, 0x3800000
  buffer_load_dword v204, v2, s[4:7], s90 offen sc1
  buffer_load_dword v204, v7, s[4:7], s90 offen sc1
  buffer_load_dword v204, v8, s[4:7], s90 offen sc1
  s_mov_b32 s90, 0x3880000
  buffer_load_dword v204, v2, s[4:7], s90 offen sc1
  buffer_load_dword v204, v7, s[4:7], s90 offen sc1
  buffer_load_dword v204, v8, s[4:7], s90 offen sc1
  s_mov_b32 s90, 0x3900000
  buffer_load_dword v204, v2, s[4:7], s90 offen sc1
  buffer_load_dword v204, v7, s[4:7], s90 offen sc1
  buffer_load_dword v204, v8, s[4:7], s90 offen sc1
  s_mov_b32 s90, 0x3980000
  buffer_load_dword v204, v2, s[4:7], s90 offen sc1
  buffer_load_dword v204, v7, s[4:7], s90 offen sc1
  buffer_load_dword v204, v8, s[4:7], s90 offen sc1
  s_waitcnt vmcnt(28)
  ds_read_b64_tr_b16 a[96:97], v182 offset:16384
  ds_read_b64_tr_b16 a[98:99], v182 offset:16896
  ds_read_b64_tr_b16 a[104:105], v182 offset:16416
  ds_read_b64_tr_b16 a[106:107], v182 offset:16928
  s_waitcnt vmcnt(24)
  ds_read_b64_tr_b16 a[100:101], v182 offset:20480
  ds_read_b64_tr_b16 a[102:103], v182 offset:20992
  ds_read_b64_tr_b16 a[108:109], v182 offset:20512
  ds_read_b64_tr_b16 a[110:111], v182 offset:21024
  s_waitcnt vmcnt(20)
  ds_read_b64_tr_b16 a[144:145], v182 offset:24576
  ds_read_b64_tr_b16 a[146:147], v182 offset:25088
  ds_read_b64_tr_b16 a[152:153], v182 offset:24608
  ds_read_b64_tr_b16 a[154:155], v182 offset:25120
  s_waitcnt vmcnt(16)
  ds_read_b64_tr_b16 a[148:149], v182 offset:28672
  ds_read_b64_tr_b16 a[150:151], v182 offset:29184
  ds_read_b64_tr_b16 a[156:157], v182 offset:28704
  ds_read_b64_tr_b16 a[158:159], v182 offset:29216
  v_mbcnt_lo_u32_b32 v250, -1, 0
  v_mbcnt_hi_u32_b32 v250, -1, v250
  s_lshl_b32 s90, s32, 9
  s_add_u32 s90, s90, 147520
  v_lshl_add_u32 v251, v250, 3, s90
  ds_write_b64 v251, v[248:249]
  s_waitcnt lgkmcnt(0)
  s_cmp_lg_u32 s32, 0
  s_cbranch_scc1 FL_vd_6
  v_lshlrev_b32 v250, 2, v250
  s_cmp_lg_u32 s100, 0
  s_cbranch_scc1 FL_vw_5
  v_readfirstlane_b32 s90, v247
  s_and_b32 s90, s90, s101
  s_cbranch_scc0 FL_vw_5
  v_mov_b32 v251, 1
  s_mov_b64 exec, 1
  buffer_store_dword v251, v250, s[28:31], 0 offen offset:32 sc1
  s_mov_b64 exec, -1
FL_vw_5:
  buffer_load_dword v251, v250, s[28:31], 0 offen sc1
  s_waitcnt vmcnt(0)
  v_cmp_eq_u32 vcc, -1, v251
  v_readlane_b32 s91, v251, 8
  v_readlane_b32 s92, v251, 32
  v_readlane_b32 s93, v251, 33
  v_readlane_b32 s90, v251, 34
  s_cmp_lg_u32 s100, 0
  s_cselect_b32 s93, s90, s93
  s_cselect_b32 s91, 0, s91
  s_cselect_b32 s92, 1, s92
  s_cselect_b32 s90, 0xff, vcc_lo
  s_cmp_lg_u32 s91, 0
  s_cselect_b32 s92, 3, s92
  s_cbranch_scc1 FL_vk_7
  s_add_u32 s3, s3, 1
  s_cmp_ge_u32 s3, 131072
  s_cselect_b32 s92, 4, s92
  s_cbranch_scc1 FL_vk_7
  s_sleep 8
  s_and_b32 s90, s90, 0xff
  s_cmp_lg_u32 s90, 0xff
  s_cbranch_scc1 FL_vw_5
  s_cmp_lt_u32 s93, 128
  s_cbranch_scc1 FL_vw_5
  s_cmp_eq_u32 s92, 0
  s_cbranch_scc1 FL_vw_5
FL_vk_7:
  v_mov_b32 v251, s92
  v_mov_b32 v250, 147456
  ds_write_b32 v250, v251
  s_waitcnt lgkmcnt(0)
FL_vd_6:
  s_barrier
  v_mov_b32 v250, 147456
  ds_read_b32 v251, v250
  s_waitcnt lgkmcnt(0)
  v_readfirstlane_b32 s92, v251
  s_barrier
  s_cmp_eq_u32 s92, 3
  s_cbranch_scc1 L_fallback
  s_cmp_eq_u32 s92, 4
  s_cbranch_scc1 L_exit
  s_sub_u32 s39, s92, 1
  s_and_b32 s39, s39, 1
  s_lshl_b32 s39, s39, 13
  s_waitcnt vmcnt(0)
  s_barrier
  ds_read_b64_tr_b16 a[192:193], v183 offset:0
  ds_read_b64_tr_b16 a[194:195], v183 offset:2048
  ds_read_b64_tr_b16 a[196:197], v183 offset:512
  ds_read_b64_tr_b16 a[198:199], v183 offset:2560
  ds_read_b64_tr_b16 a[200:201], v183 offset:4096
  ds_read_b64_tr_b16 a[202:203], v183 offset:6144
  ds_read_b64_tr_b16 a[204:205], v183 offset:4608
  ds_read_b64_tr_b16 a[206:207], v183 offset:6656
  s_waitcnt lgkmcnt(0)
  ds_read_b64_tr_b16 a[208:209], v183 offset:32768
  ds_read_b64_tr_b16 a[210:211], v183 offset:34816
  ds_read_b64_tr_b16 a[212:213], v183 offset:33280
  ds_read_b64_tr_b16 a[214:215], v183 offset:35328
  ds_read_b64_tr_b16 a[216:217], v183 offset:36864
  ds_read_b64_tr_b16 a[218:219], v183 offset:38912
  ds_read_b64_tr_b16 a[220:221], v183 offset:37376
  ds_read_b64_tr_b16 a[222:223], v183 offset:39424
  s_waitcnt lgkmcnt(0)
  ds_read_b64_tr_b16 a[224:225], v184 offset:0
  ds_read_b64_tr_b16 a[226:227], v184 offset:2048
  ds_read_b64_tr_b16 a[228:229], v184 offset:512
  ds_read_b64_tr_b16 a[230:231], v184 offset:2560
  ds_read_b64_tr_b16 a[232:233], v184 offset:4096
  ds_read_b64_tr_b16 a[234:235], v184 offset:6144
  ds_read_b64_tr_b16 a[236:237], v184 offset:4608
  ds_read_b64_tr_b16 a[238:239], v184 offset:6656
  s_waitcnt lgkmcnt(0)
  ds_read_b64_tr_b16 a[240:241], v184 offset:32768
  ds_read_b64_tr_b16 a[242:243], v184 offset:34816
  ds_read_b64_tr_b16 a[244:245], v184 offset:33280
  ds_read_b64_tr_b16 a[246:247], v184 offset:35328
  ds_read_b64_tr_b16 a[248:249], v184 offset:36864
  ds_read_b64_tr_b16 a[250:251], v184 offset:38912
  ds_read_b64_tr_b16 a[252:253], v184 offset:37376
  ds_read_b64_tr_b16 a[254:255], v184 offset:39424
  s_waitcnt lgkmcnt(0)
  s_barrier
  s_mov_b32 s46, 0
  v_xor_b32 v1, s39, v1
  v_xor_b32 v17, s39, v17
  v_xor_b32 v18, s39, v18
  s_mov_b32 s12, s63
  s_mov_b32 s90, 0x3800000
  s_mov_b32 s90, 0x3880000
  s_mov_b32 s90, 0x3900000
  s_mov_b32 s90, 0x3980000
  v_mov_b32 v248, 0x3f803f80
  v_mov_b32 v249, 0x3f803f80
  v_mov_b32 v250, 0x3f803f80
  v_mov_b32 v251, 0x3f803f80
  v_mov_b32 v252, 0x3f803f80
  v_mov_b32 v253, 0x3f803f80
  v_mov_b32 v254, 0x3f803f80
  v_mov_b32 v255, 0x3f803f80
  s_cmp_lg_u32 s32, 0
  s_cbranch_scc1 FL_kv0d
  s_lshl_b32 s90, s33, 7
  s_add_u32 s90, s90, 0x3d07000
  v_mov_b32 v30, s90
FL_kv0:
  buffer_load_dword v31, v30, s[4:7], 0 offen sc1
  s_waitcnt vmcnt(0)
  v_readfirstlane_b32 s90, v31
  s_add_u32 s46, s46, 1
  s_cmp_ge_u32 s46, 131072
  s_cbranch_scc1 FL_rec_abort
  s_sleep 2
  s_cmp_lt_u32 s90, 16
  s_cbranch_scc1 FL_kv0
FL_kv0d:
  s_barrier
  buffer_load_dwordx4 v[180:183], v12, s[4:7], s44 offen offset:0
  buffer_load_dwordx4 v[184:187], v12, s[4:7], s44 offen offset:128
  buffer_load_dwordx4 v[188:191], v12, s[4:7], s44 offen offset:1024
  buffer_load_dwordx4 v[192:195], v12, s[4:7], s44 offen offset:1152
  buffer_load_dwordx4 v[196:199], v13, s[4:7], s44 offen offset:0
  buffer_load_dwordx4 v[200:203], v13, s[4:7], s44 offen offset:128
  buffer_load_dwordx4 v[204:207], v13, s[4:7], s44 offen offset:1024
  buffer_load_dwordx4 v[208:211], v13, s[4:7], s44 offen offset:1152
  buffer_load_dwordx4 v[116:119], v11, s[4:7], s44 offen offset:0
  buffer_load_dwordx4 v[132:135], v11, s[4:7], s44 offen offset:64
  buffer_load_dwordx4 v[120:123], v11, s[4:7], s44 offen offset:1024
  buffer_load_dwordx4 v[136:139], v11, s[4:7], s44 offen offset:1088
  buffer_load_dwordx4 v[124:127], v11, s[4:7], s44 offen offset:2048
  buffer_load_dwordx4 v[140:143], v11, s[4:7], s44 offen offset:2112
  buffer_load_dwordx4 v[128:131], v11, s[4:7], s44 offen offset:3072
  buffer_load_dwordx4 v[144:147], v11, s[4:7], s44 offen offset:3136
  s_add_u32 s44, s44, 0x40000
  v_mov_b64 v[64:65], 0
  v_mov_b64 v[66:67], 0
  v_mov_b64 v[68:69], 0
  v_mov_b64 v[70:71], 0
  v_mov_b64 v[72:73], 0
  v_mov_b64 v[74:75], 0
  v_mov_b64 v[76:77], 0
  v_mov_b64 v[78:79], 0
  v_mov_b64 v[80:81], 0
  v_mov_b64 v[82:83], 0
  v_mov_b64 v[84:85], 0
  v_mov_b64 v[86:87], 0
  v_mov_b64 v[32:33], 0
  v_mov_b64 v[34:35], 0
  v_mov_b64 v[212:213], 0
  v_mov_b64 v[214:215], 0
  v_mov_b64 v[216:217], 0
  v_mov_b64 v[218:219], 0
  v_mov_b64 v[220:221], 0
  v_mov_b64 v[222:223], 0
  v_mov_b64 v[224:225], 0
  v_mov_b64 v[226:227], 0
  v_mov_b64 v[228:229], 0
  v_mov_b64 v[230:231], 0
  s_waitcnt vmcnt(0)
  v_min_u32 v44, s54, v44
  s_lshl_b32 s90, s33, 7
  s_add_u32 s90, s90, 0x3d07000
  v_mov_b32 v244, s90
  s_lshl_b32 s90, s34, 2
  s_add_u32 s90, s90, s32
  s_lshl_b32 s91, s33, 7
  s_add_u32 s91, s91, 0x3d00000
  v_mbcnt_lo_u32_b32 v30, -1, 0
  v_mbcnt_hi_u32_b32 v30, -1, v30
  v_add_u32 v30, s90, v30
  v_cmp_eq_u32 vcc, 0, v30
  v_mov_b32 v30, 0x80000000
  v_mov_b32 v31, s91
  v_cndmask_b32 v245, v30, v31, vcc
  s_mov_b64 s[8:9], s[94:95]
  s_mov_b64 s[10:11], s[94:95]
  s_branch FL_pubmem
FL_step:
  s_load_dword s16, s[8:9], 256
  s_load_dword s17, s[10:11], 256
  s_load_dword s18, s[8:9], 320
  s_load_dword s19, s[10:11], 320
  s_load_dword s20, s[8:9], 384
  s_load_dword s21, s[10:11], 384
  s_load_dword s22, s[8:9], 448
  s_load_dword s23, s[10:11], 448
  buffer_load_dwordx4 v[200:203], v13, s[4:7], s44 offen offset:128
  buffer_load_dwordx4 v[204:207], v13, s[4:7], s44 offen offset:1024
  buffer_load_dwordx4 v[208:211], v13, s[4:7], s44 offen offset:1152
  buffer_load_dwordx4 v[128:131], v11, s[4:7], s44 offen offset:3072
  buffer_load_dwordx4 v[144:147], v11, s[4:7], s44 offen offset:3136
  v_mov_b64 v[64:65], 0
  v_mov_b64 v[66:67], 0
  v_mov_b64 v[68:69], 0
  v_mov_b64 v[70:71], 0
  v_mov_b64 v[72:73], 0
  v_mov_b64 v[74:75], 0
  v_mov_b64 v[76:77], 0
  v_mov_b64 v[78:79], 0
  v_mov_b64 v[80:81], 0
  v_mov_b64 v[82:83], 0
  v_mov_b64 v[84:85], 0
  v_mov_b64 v[86:87], 0
  v_mov_b64 v[32:33], 0
  v_mov_b64 v[34:35], 0
  buffer_load_dwordx4 v[36:39], v1, s[4:7], s42 offen sc1
  buffer_store_dword v22, v18, s[4:7], s13 offen
  buffer_store_dword v22, v2, s[4:7], s13 offen
  buffer_store_dword v22, v7, s[4:7], s13 offen
  buffer_store_dword v22, v8, s[4:7], s13 offen
  s_add_u32 s44, s44, 0x40000
  s_min_u32 s44, s44, 0xfc0000
  s_add_u32 s45, s45, 0x10000
  s_waitcnt vmcnt(12)
FL_kv_chk:
  v_readfirstlane_b32 s90, v243
  s_cmp_lt_u32 s90, 16
  s_cbranch_scc1 FL_kv_f
  s_waitcnt vmcnt(4)
FL_g_chk:
  v_max3_u32 v31, v36, v37, v38
  v_max_u32 v31, v31, v39
  v_cmp_eq_u32 vcc, -1, v31
  v_mfma_f32_16x16x32_bf16 v[40:43], v[24:27], v[36:39], 0
  s_cbranch_vccnz FL_g_f
  s_nop 6
  v_add_f32_dpp v45, v40, v40 row_ror:8 row_mask:0xf bank_mask:0xf
  v_add_f32_dpp v46, v41, v41 row_ror:8 row_mask:0xf bank_mask:0xf
  v_cvt_pk_bf16_f32 v44, v45, v46
  v_min_u32 v44, s54, v44
FL_pubmem:
  buffer_store_dword v44, v2, s[4:7], s41 offen
  v_mov_b32 v148, v180
  v_mov_b32 v150, v181
  v_mov_b32 v152, v182
  v_mov_b32 v154, v183
  v_mov_b32 v149, v184
  v_mov_b32 v151, v185
  v_mov_b32 v153, v186
  v_mov_b32 v155, v187
  v_mov_b32 v156, v188
  v_mov_b32 v158, v189
  v_mov_b32 v160, v190
  v_mov_b32 v162, v191
  v_mov_b32 v157, v192
  v_mov_b32 v159, v193
  v_mov_b32 v161, v194
  v_mov_b32 v163, v195
  v_mov_b32 v164, v196
  v_mov_b32 v166, v197
  v_mov_b32 v168, v198
  v_mov_b32 v170, v199
  v_mov_b32 v165, v200
  v_mov_b32 v167, v201
  v_mov_b32 v169, v202
  v_mov_b32 v171, v203
  buffer_load_dwordx4 v[48:51], v3, s[4:7], s41 offen offset:0 sc1
  v_mov_b32 v172, v204
  v_mov_b32 v174, v205
  buffer_load_dwordx4 v[52:55], v3, s[4:7], s41 offen offset:1024 sc1
  v_mov_b32 v176, v206
  v_mov_b32 v178, v207
  buffer_load_dwordx4 v[56:59], v3, s[4:7], s41 offen offset:2048 sc1
  v_mov_b32 v173, v208
  v_mov_b32 v175, v209
  buffer_load_dwordx4 v[60:63], v3, s[4:7], s41 offen offset:3072 sc1
  v_mov_b32 v177, v210
  v_mov_b32 v179, v211
  s_waitcnt vmcnt(3)
  v_max3_u32 v31, v48, v49, v50
  v_max_u32 v31, v31, v51
  v_cmp_eq_u32 vcc, -1, v31
  s_cbranch_vccnz FL_m_f0
  v_smfmac_f32_16x16x64_bf16 v[64:67], v[48:51], a[0:7], v23
  s_waitcnt vmcnt(2)
  v_max3_u32 v31, v52, v53, v54
  v_max_u32 v31, v31, v55
  v_cmp_eq_u32 vcc, -1, v31
  v_smfmac_f32_16x16x64_bf16 v[68:71], v[48:51], a[8:15], v23
  v_smfmac_f32_16x16x64_bf16 v[72:75], v[48:51], a[16:23], v23
  v_smfmac_f32_16x16x64_bf16 v[76:79], v[48:51], a[24:31], v23
  s_cbranch_vccnz FL_m_f1
  v_smfmac_f32_16x16x64_bf16 v[64:67], v[52:55], a[48:55], v23
  s_waitcnt vmcnt(1)
  v_max3_u32 v31, v56, v57, v58
  v_max_u32 v31, v31, v59
  v_cmp_eq_u32 vcc, -1, v31
  v_smfmac_f32_16x16x64_bf16 v[68:71], v[52:55], a[56:63], v23
  v_smfmac_f32_16x16x64_bf16 v[72:75], v[52:55], a[64:71], v23
  v_smfmac_f32_16x16x64_bf16 v[76:79], v[52:55], a[72:79], v23
  s_cbranch_vccnz FL_m_f2
  v_smfmac_f32_16x16x64_bf16 v[64:67], v[56:59], a[96:103], v23
  s_waitcnt vmcnt(0)
  v_max3_u32 v31, v60, v61, v62
  v_max_u32 v31, v31, v63
  v_cmp_eq_u32 vcc, -1, v31
  v_smfmac_f32_16x16x64_bf16 v[68:71], v[56:59], a[104:111], v23
  v_smfmac_f32_16x16x64_bf16 v[72:75], v[56:59], a[112:119], v23
  v_smfmac_f32_16x16x64_bf16 v[76:79], v[56:59], a[120:127], v23
  s_cbranch_vccnz FL_m_f3
  v_smfmac_f32_16x16x64_bf16 v[64:67], v[60:63], a[144:151], v23
  v_smfmac_f32_16x16x64_bf16 v[68:71], v[60:63], a[152:159], v23
  v_smfmac_f32_16x16x64_bf16 v[72:75], v[60:63], a[160:167], v23
  v_smfmac_f32_16x16x64_bf16 v[76:79], v[60:63], a[168:175], v23
FL_m_done:
  s_nop 4
  v_pk_add_f32 v[88:89], v[64:65], v[66:67]
  v_pk_add_f32 v[90:91], v[68:69], v[70:71]
  ds_write_b128 v4, v[88:91] offset:0
  v_pk_add_f32 v[92:93], v[72:73], v[74:75]
  v_pk_add_f32 v[94:95], v[76:77], v[78:79]
  ds_write_b128 v4, v[92:95] offset:1088
  v_smfmac_f32_16x16x64_bf16 v[80:83], v[48:51], a[32:39], v23
  buffer_load_dwordx4 v[180:183], v12, s[4:7], s44 offen offset:0
  v_mov_b32 v36, 0
  v_smfmac_f32_16x16x64_bf16 v[84:87], v[48:51], a[40:47], v23
  buffer_load_dwordx4 v[184:187], v12, s[4:7], s44 offen offset:128
  v_mov_b32 v37, 0
  v_smfmac_f32_16x16x64_bf16 v[80:83], v[52:55], a[80:87], v23
  buffer_load_dwordx4 v[188:191], v12, s[4:7], s44 offen offset:1024
  v_mov_b32 v38, 0
  v_smfmac_f32_16x16x64_bf16 v[84:87], v[52:55], a[88:95], v23
  buffer_load_dwordx4 v[192:195], v12, s[4:7], s44 offen offset:1152
  v_mov_b32 v39, 0
  v_smfmac_f32_16x16x64_bf16 v[80:83], v[56:59], a[128:135], v23
  buffer_load_dwordx4 v[196:199], v13, s[4:7], s44 offen offset:0
  v_mov_b32 v40, 0
  s_waitcnt lgkmcnt(0)
  s_barrier
  ds_read2_b32 v[100:101], v6 offset0:0 offset1:2
  ds_read2_b32 v[102:103], v240 offset0:0 offset1:2
  ds_read2_b32 v[104:105], v241 offset0:0 offset1:2
  ds_read2_b32 v[106:107], v242 offset0:0 offset1:2
  v_smfmac_f32_16x16x64_bf16 v[84:87], v[56:59], a[136:143], v23
  v_mov_b32 v41, 0
  v_smfmac_f32_16x16x64_bf16 v[80:83], v[60:63], a[176:183], v23
  v_mov_b32 v42, 0
  v_smfmac_f32_16x16x64_bf16 v[84:87], v[60:63], a[184:191], v23
  v_mov_b32 v43, 0
  v_mov_b32 v44, 0
  v_mov_b32 v45, 0
  v_mov_b32 v46, 0
  v_mov_b32 v47, 0
  s_waitcnt lgkmcnt(2)
  v_pk_add_f32 v[100:101], v[100:101], v[102:103]
  s_waitcnt lgkmcnt(0)
  v_pk_add_f32 v[104:105], v[104:105], v[106:107]
  v_pk_add_f32 v[100:101], v[100:101], v[104:105]
  v_cvt_pk_bf16_f32 v112, v100, v101
  v_min_u32 v112, s54, v112
  buffer_store_dword v112, v7, s[4:7], s41 offen
  v_pk_add_f32 v[96:97], v[80:81], v[82:83]
  v_pk_add_f32 v[98:99], v[84:85], v[86:87]
  ds_write_b128 v4, v[96:99] offset:2176
  v_mov_b64 v[212:213], 0
  v_mov_b64 v[214:215], 0
  v_mov_b64 v[216:217], 0
  v_mov_b64 v[218:219], 0
  v_mov_b64 v[220:221], 0
  v_mov_b64 v[222:223], 0
  v_mov_b64 v[224:225], 0
  v_mov_b64 v[226:227], 0
  v_mov_b64 v[228:229], 0
  v_mov_b64 v[230:231], 0
  s_waitcnt lgkmcnt(0)
  s_barrier
  ds_read_b64 v[88:89], v5 offset:0
  buffer_load_dwordx4 v[64:67], v9, s[4:7], s41 offen offset:0 sc1
  s_mov_b32 s42, s41
  s_add_u32 s90, s40, 1
  ds_read_b64 v[90:91], v5 offset:3264
  buffer_load_dwordx4 v[68:71], v9, s[4:7], s41 offen offset:1024 sc1
  s_and_b32 s90, s90, 3
  s_lshl_b32 s90, s90, 19
  ds_read_b64 v[92:93], v5 offset:6528
  buffer_load_dwordx4 v[72:75], v9, s[4:7], s41 offen offset:2048 sc1
  s_add_u32 s91, s90, 0x3800000
  s_add_u32 s55, s55, 0x40000
  ds_read_b64 v[94:95], v5 offset:9792
  buffer_load_dwordx4 v[76:79], v9, s[4:7], s41 offen offset:3072 sc1
  s_min_u32 s55, s55, 0xfc0000
  s_nop 0
  s_waitcnt lgkmcnt(2)
  v_pk_add_f32 v[88:89], v[88:89], v[90:91]
  s_waitcnt lgkmcnt(0)
  v_pk_add_f32 v[92:93], v[92:93], v[94:95]
  v_pk_add_f32 v[88:89], v[88:89], v[92:93]
  v_cvt_pk_bf16_f32 v113, v88, v89
  v_min_u32 v113, s54, v113
  buffer_store_dword v113, v8, s[4:7], s41 offen
  s_add_u32 s8, s94, s55
  s_addc_u32 s9, s95, 0
  s_add_u32 s8, s8, s12
  s_addc_u32 s9, s9, 0
  s_add_u32 s10, s8, 0x1000000
  s_addc_u32 s11, s9, 0
  s_load_dword s16, s[8:9], 0
  s_load_dword s17, s[10:11], 0
  s_load_dword s18, s[8:9], 64
  s_load_dword s19, s[10:11], 64
  s_load_dword s20, s[8:9], 128
  s_load_dword s21, s[10:11], 128
  s_load_dword s22, s[8:9], 192
  s_load_dword s23, s[10:11], 192
  s_cmp_eq_u32 s40, 63
  s_cbranch_scc1 FL_last
  s_waitcnt vmcnt(4)
  v_max3_u32 v31, v64, v65, v66
  v_max_u32 v31, v31, v67
  v_cmp_eq_u32 vcc, -1, v31
  s_cbranch_vccnz FL_x_f0
  v_mfma_f32_16x16x32_bf16 v[44:47], v[64:67], v[64:67], v[44:47]
  s_waitcnt vmcnt(3)
  v_max3_u32 v31, v68, v69, v70
  v_max_u32 v31, v31, v71
  v_cmp_eq_u32 vcc, -1, v31
  v_mfma_f32_16x16x32_bf16 v[36:39], v[116:119], v[64:67], v[36:39]
  v_mfma_f32_16x16x32_bf16 v[40:43], v[132:135], v[64:67], v[40:43]
  s_cbranch_vccnz FL_x_f1
  v_mfma_f32_16x16x32_bf16 v[44:47], v[68:71], v[68:71], v[44:47]
  s_waitcnt vmcnt(2)
  v_max3_u32 v31, v72, v73, v74
  v_max_u32 v31, v31, v75
  v_cmp_eq_u32 vcc, -1, v31
  v_mfma_f32_16x16x32_bf16 v[36:39], v[120:123], v[68:71], v[36:39]
  v_mfma_f32_16x16x32_bf16 v[40:43], v[136:139], v[68:71], v[40:43]
  s_cbranch_vccnz FL_x_f2
  v_mfma_f32_16x16x32_bf16 v[44:47], v[72:75], v[72:75], v[44:47]
  s_waitcnt vmcnt(1)
  v_max3_u32 v31, v76, v77, v78
  v_max_u32 v31, v31, v79
  v_cmp_eq_u32 vcc, -1, v31
  v_mfma_f32_16x16x32_bf16 v[36:39], v[124:127], v[72:75], v[36:39]
  v_mfma_f32_16x16x32_bf16 v[40:43], v[140:143], v[72:75], v[40:43]
  s_cbranch_vccnz FL_x_f3
  v_mfma_f32_16x16x32_bf16 v[44:47], v[76:79], v[76:79], v[44:47]
  v_mfma_f32_16x16x32_bf16 v[36:39], v[128:131], v[76:79], v[36:39]
  v_mfma_f32_16x16x32_bf16 v[40:43], v[144:147], v[76:79], v[40:43]
FL_x_done:
  buffer_load_dwordx4 v[88:91], v10, s[4:7], s41 offen offset:0 sc1
  buffer_load_dwordx4 v[92:95], v10, s[4:7], s41 offen offset:1024 sc1
  s_mov_b64 vcc, s[48:49]
  s_nop 2
  v_max_f32 v30, v46, v47
  s_nop 0
  v_cndmask_b32_dpp v96, v40, v36, vcc quad_perm:[0,1,0,1] row_mask:0xf bank_mask:0xf
  v_cndmask_b32_dpp v97, v41, v37, vcc quad_perm:[0,1,0,1] row_mask:0xf bank_mask:0xf
  v_cndmask_b32_dpp v98, v42, v38, vcc quad_perm:[0,1,0,1] row_mask:0xf bank_mask:0xf
  v_cndmask_b32_dpp v99, v43, v39, vcc quad_perm:[0,1,0,1] row_mask:0xf bank_mask:0xf
  v_max3_f32 v29, v96, v97, v98
  s_nop 0
  v_max_f32_dpp v28, v30, v99 quad_perm:[0,1,0,1] row_mask:0xf bank_mask:0xf
  v_max_f32 v29, v29, v28
  s_nop 1
  v_max_f32_dpp v28, v29, v29 quad_perm:[2,3,0,1] row_mask:0xf bank_mask:0xf
  v_mov_b32 v29, v28
  s_nop 1
  v_permlane32_swap_b32 v28, v29
  v_max_f32 v28, v28, v29
  v_mov_b32 v29, v28
  s_nop 1
  v_permlane16_swap_b32 v28, v29
  v_max_f32 v28, v28, v29
  v_mul_f32 v28, s47, v28
  v_fma_f32 v96, v96, s47, -v28
  v_fma_f32 v97, v97, s47, -v28
  v_fma_f32 v98, v98, s47, -v28
  v_fma_f32 v99, v99, s47, -v28
  v_fma_f32 v46, v46, s47, -v28
  v_fma_f32 v47, v47, s47, -v28
  v_exp_f32 v96, v96
  v_exp_f32 v97, v97
  v_exp_f32 v98, v98
  v_exp_f32 v99, v99
  v_cvt_pk_bf16_f32 v236, v96, v97
  v_cvt_pk_bf16_f32 v237, v98, v99
  v_exp_f32 v46, v46
  v_mov_b32_dpp v100, v236 quad_perm:[0,1,0,1] row_mask:0xf bank_mask:0xf
  v_mov_b32_dpp v102, v236 quad_perm:[2,3,2,3] row_mask:0xf bank_mask:0xf
  v_mov_b32_dpp v101, v237 quad_perm:[0,1,0,1] row_mask:0xf bank_mask:0xf
  v_mov_b32_dpp v103, v237 quad_perm:[2,3,2,3] row_mask:0xf bank_mask:0xf
  v_exp_f32 v47, v47
  s_nop 0
  v_smfmac_f32_16x16x64_bf16 v[228:231], v[100:103], v[248:255], v23
  v_cvt_pk_bf16_f32 v238, v46, v47
  buffer_load_dwordx4 v[116:119], v11, s[4:7], s44 offen offset:0
  v_smfmac_f32_16x16x64_bf16 v[212:215], v[100:103], v[148:155], v23
  buffer_load_dwordx4 v[132:135], v11, s[4:7], s44 offen offset:64
  v_mov_b32_dpp v232, v238 quad_perm:[0,1,0,1] row_mask:0xf bank_mask:0xf
  v_smfmac_f32_16x16x64_bf16 v[216:219], v[100:103], v[156:163], v23
  buffer_load_dwordx4 v[120:123], v11, s[4:7], s44 offen offset:1024
  v_mov_b32_dpp v235, v238 quad_perm:[0,1,0,1] row_mask:0xf bank_mask:0xf
  v_smfmac_f32_16x16x64_bf16 v[220:223], v[100:103], v[164:171], v23
  buffer_load_dwordx4 v[136:139], v11, s[4:7], s44 offen offset:1088
  s_waitcnt vmcnt(4)
  v_max3_u32 v31, v88, v89, v90
  v_max3_u32 v31, v31, v91, v92
  v_smfmac_f32_16x16x32_bf16 v[228:231], v[232:233], v[248:251], v23
  v_max3_u32 v31, v31, v93, v94
  v_max_u32 v31, v31, v95
  v_cmp_eq_u32 vcc, -1, v31
  v_smfmac_f32_16x16x64_bf16 v[224:227], v[100:103], v[172:179], v23
  s_cbranch_vccnz FL_v_f
FL_v_ok:
  v_smfmac_f32_16x16x32_bf16 v[212:215], v[232:233], v[88:91], v23
  buffer_load_dwordx4 v[124:127], v11, s[4:7], s44 offen offset:2048
  buffer_load_dwordx4 v[140:143], v11, s[4:7], s44 offen offset:2112
  v_smfmac_f32_16x16x32_bf16 v[216:219], v[234:235], v[88:91], v23
  v_rcp_f32 v28, v228
  v_smfmac_f32_16x16x32_bf16 v[220:223], v[232:233], v[92:95], v23
  v_rcp_f32 v29, v229
  v_smfmac_f32_16x16x32_bf16 v[224:227], v[234:235], v[92:95], v23
  s_nop 0
  v_pk_mul_f32 v[212:213], v[212:213], v[28:29]
  v_pk_mul_f32 v[214:215], v[214:215], v[28:29]
  v_cvt_pk_bf16_f32 v104, v212, v214
  v_cvt_pk_bf16_f32 v108, v213, v215
  v_pk_mul_f32 v[216:217], v[216:217], v[28:29]
  v_pk_mul_f32 v[218:219], v[218:219], v[28:29]
  v_cvt_pk_bf16_f32 v105, v216, v218
  v_cvt_pk_bf16_f32 v109, v217, v219
  v_pk_mul_f32 v[220:221], v[220:221], v[28:29]
  v_pk_mul_f32 v[222:223], v[222:223], v[28:29]
  v_cvt_pk_bf16_f32 v106, v220, v222
  v_cvt_pk_bf16_f32 v110, v221, v223
  v_pk_mul_f32 v[224:225], v[224:225], v[28:29]
  v_pk_mul_f32 v[226:227], v[226:227], v[28:29]
  v_cvt_pk_bf16_f32 v107, v224, v226
  v_cvt_pk_bf16_f32 v111, v225, v227
  ds_write_b128 v14, v[104:107]
  ds_write_b128 v15, v[108:111]
  s_add_u32 s92, s40, 3
  s_min_u32 s92, s92, 63
  s_lshr_b32 s92, s92, 2
  s_lshl_b32 s92, s92, 9
  v_mov_b32 v246, s40
  s_waitcnt lgkmcnt(0)
  s_barrier
  ds_read_b128 v[48:51], v16 offset:0
  ds_read_b128 v[52:55], v16 offset:1024
  ds_read_b128 v[56:59], v16 offset:2048
  ds_read_b128 v[60:63], v16 offset:3072
  ds_read_b128 v[64:67], v16 offset:4096
  buffer_store_dword v22, v17, s[4:7], s43 offen sc1
  buffer_store_dword v112, v19, s[4:7], s45 offen sc1
  s_waitcnt lgkmcnt(4)
  v_smfmac_f32_16x16x64_bf16 v[32:35], v[48:51], a[192:199], v23
  ds_read_b128 v[68:71], v16 offset:5120
  buffer_store_dword v113, v20, s[4:7], s45 offen sc1
  s_waitcnt lgkmcnt(4)
  v_smfmac_f32_16x16x64_bf16 v[32:35], v[52:55], a[200:207], v23
  ds_read_b128 v[72:75], v16 offset:6144
  buffer_store_dword v246, v245, s[4:7], 0 offen sc1
  s_waitcnt lgkmcnt(4)
  v_smfmac_f32_16x16x64_bf16 v[32:35], v[56:59], a[208:215], v23
  ds_read_b128 v[76:79], v16 offset:7168
  buffer_load_dword v243, v244, s[4:7], s92 offen sc1
  s_waitcnt lgkmcnt(4)
  v_smfmac_f32_16x16x64_bf16 v[32:35], v[60:63], a[216:223], v23
  s_mov_b32 s13, s43
  s_waitcnt lgkmcnt(3)
  v_smfmac_f32_16x16x64_bf16 v[32:35], v[64:67], a[224:231], v23
  s_add_u32 s40, s40, 1
  s_waitcnt lgkmcnt(2)
  v_smfmac_f32_16x16x64_bf16 v[32:35], v[68:71], a[232:239], v23
  s_mov_b32 s41, s91
  s_waitcnt lgkmcnt(1)
  v_smfmac_f32_16x16x64_bf16 v[32:35], v[72:75], a[240:247], v23
  s_xor_b32 s43, s91, 0x100000
  s_waitcnt lgkmcnt(0)
  v_smfmac_f32_16x16x64_bf16 v[32:35], v[76:79], a[248:255], v23
  s_nop 7
  v_pk_add_f32 v[28:29], v[32:33], v[34:35]
  v_cvt_pk_bf16_f32 v28, v28, v29
  v_min_u32 v28, s54, v28
  buffer_store_dword v28, v17, s[4:7], s42 offen sc1
  buffer_store_dword v28, v18, s[4:7], s42 offen
  s_branch FL_step
FL_last:
  buffer_store_dword v112, v19, s[4:7], s45 offen sc1
  buffer_store_dword v113, v20, s[4:7], s45 offen sc1
  s_branch L_join
FL_kv_f:
  s_sleep 8
  buffer_load_dword v243, v244, s[4:7], s92 offen sc1
  s_add_u32 s46, s46, 1
  s_cmp_ge_u32 s46, 131072
  s_cbranch_scc1 FL_rec_abort
  s_waitcnt vmcnt(0)
  s_branch FL_kv_chk
FL_g_f:
  s_mov_b64 exec, vcc
  buffer_load_dwordx4 v[36:39], v1, s[4:7], s42 offen sc1
  s_mov_b64 exec, -1
  s_add_u32 s46, s46, 1
  s_cmp_ge_u32 s46, 131072
  s_cbranch_scc1 FL_rec_abort
  s_waitcnt vmcnt(0)
  s_branch FL_g_chk
FL_m_f0:
  s_mov_b64 exec, vcc
  buffer_load_dwordx4 v[48:51], v3, s[4:7], s41 offen offset:0 sc1
  s_mov_b64 exec, -1
  s_waitcnt vmcnt(1)
  s_branch FL_m_0123_c1
FL_m_f1:
  s_mov_b64 exec, vcc
  buffer_load_dwordx4 v[52:55], v3, s[4:7], s41 offen offset:1024 sc1
  s_mov_b64 exec, -1
  s_waitcnt vmcnt(1)
  s_branch FL_m_123_c2
FL_m_f2:
  s_mov_b64 exec, vcc
  buffer_load_dwordx4 v[56:59], v3, s[4:7], s41 offen offset:2048 sc1
  s_mov_b64 exec, -1
  s_waitcnt vmcnt(1)
  s_branch FL_m_23_c3
FL_m_f3:
  s_mov_b64 exec, vcc
  buffer_load_dwordx4 v[60:63], v3, s[4:7], s41 offen offset:3072 sc1
  s_mov_b64 exec, -1
  s_nop 7
  s_branch FL_m_3_c3
FL_m_0_c0:
  v_max3_u32 v31, v48, v49, v50
  v_max_u32 v31, v31, v51
  v_cmp_eq_u32 vcc, -1, v31
  s_cbranch_vccz FL_m_0_ok0
FL_m_0_x0:
  s_mov_b64 exec, vcc
  buffer_load_dwordx4 v[48:51], v3, s[4:7], s41 offen offset:0 sc1
  s_mov_b64 exec, -1
  s_add_u32 s46, s46, 1
  s_cmp_ge_u32 s46, 131072
  s_cbranch_scc1 FL_rec_abort
  s_waitcnt vmcnt(2)
  s_branch FL_m_0_c0
FL_m_0_ok0:
  v_smfmac_f32_16x16x64_bf16 v[64:67], v[48:51], a[0:7], v23
  v_smfmac_f32_16x16x64_bf16 v[68:71], v[48:51], a[8:15], v23
  v_smfmac_f32_16x16x64_bf16 v[72:75], v[48:51], a[16:23], v23
  v_smfmac_f32_16x16x64_bf16 v[76:79], v[48:51], a[24:31], v23
  s_branch FL_m_done
FL_m_1_c1:
  v_max3_u32 v31, v52, v53, v54
  v_max_u32 v31, v31, v55
  v_cmp_eq_u32 vcc, -1, v31
  s_cbranch_vccz FL_m_1_ok1
FL_m_1_x1:
  s_mov_b64 exec, vcc
  buffer_load_dwordx4 v[52:55], v3, s[4:7], s41 offen offset:1024 sc1
  s_mov_b64 exec, -1
  s_add_u32 s46, s46, 1
  s_cmp_ge_u32 s46, 131072
  s_cbranch_scc1 FL_rec_abort
  s_waitcnt vmcnt(2)
  s_branch FL_m_1_c1
FL_m_1_ok1:
  v_smfmac_f32_16x16x64_bf16 v[64:67], v[52:55], a[48:55], v23
  v_smfmac_f32_16x16x64_bf16 v[68:71], v[52:55], a[56:63], v23
  v_smfmac_f32_16x16x64_bf16 v[72:75], v[52:55], a[64:71], v23
  v_smfmac_f32_16x16x64_bf16 v[76:79], v[52:55], a[72:79], v23
  s_branch FL_m_done
FL_m_2_c2:
  v_max3_u32 v31, v56, v57, v58
  v_max_u32 v31, v31, v59
  v_cmp_eq_u32 vcc, -1, v31
  s_cbranch_vccz FL_m_2_ok2
FL_m_2_x2:
  s_mov_b64 exec, vcc
  buffer_load_dwordx4 v[56:59], v3, s[4:7], s41 offen offset:2048 sc1
  s_mov_b64 exec, -1
  s_add_u32 s46, s46, 1
  s_cmp_ge_u32 s46, 131072
  s_cbranch_scc1 FL_rec_abort
  s_waitcnt vmcnt(2)
  s_branch FL_m_2_c2
FL_m_2_ok2:
  v_smfmac_f32_16x16x64_bf16 v[64:67], v[56:59], a[96:103], v23
  v_smfmac_f32_16x16x64_bf16 v[68:71], v[56:59], a[104:111], v23
  v_smfmac_f32_16x16x64_bf16 v[72:75], v[56:59], a[112:119], v23
  v_smfmac_f32_16x16x64_bf16 v[76:79], v[56:59], a[120:127], v23
  s_branch FL_m_done
FL_m_3_c3:
  v_max3_u32 v31, v60, v61, v62
  v_max_u32 v31, v31, v63
  v_cmp_eq_u32 vcc, -1, v31
  s_cbranch_vccz FL_m_3_ok3
FL_m_3_x3:
  s_mov_b64 exec, vcc
  buffer_load_dwordx4 v[60:63], v3, s[4:7], s41 offen offset:3072 sc1
  s_mov_b64 exec, -1
  s_add_u32 s46, s46, 1
  s_cmp_ge_u32 s46, 131072
  s_cbranch_scc1 FL_rec_abort
  s_waitcnt vmcnt(2)
  s_branch FL_m_3_c3
FL_m_3_ok3:
  v_smfmac_f32_16x16x64_bf16 v[64:67], v[60:63], a[144:151], v23
  v_smfmac_f32_16x16x64_bf16 v[68:71], v[60:63], a[152:159], v23
  v_smfmac_f32_16x16x64_bf16 v[72:75], v[60:63], a[160:167], v23
  v_smfmac_f32_16x16x64_bf16 v[76:79], v[60:63], a[168:175], v23
  s_branch FL_m_done
FL_m_01_c0:
  v_max3_u32 v31, v48, v49, v50
  v_max_u32 v31, v31, v51
  v_cmp_eq_u32 vcc, -1, v31
  s_cbranch_vccz FL_m_01_ok0
FL_m_01_x0:
  s_mov_b64 exec, vcc
  buffer_load_dwordx4 v[48:51], v3, s[4:7], s41 offen offset:0 sc1
  s_mov_b64 exec, -1
FL_m_01_c1:
  v_max3_u32 v31, v52, v53, v54
  v_max_u32 v31, v31, v55
  v_cmp_eq_u32 vcc, -1, v31
  s_cbranch_vccz FL_m_01_ok1
FL_m_01_x1:
  s_mov_b64 exec, vcc
  buffer_load_dwordx4 v[52:55], v3, s[4:7], s41 offen offset:1024 sc1
  s_mov_b64 exec, -1
  s_add_u32 s46, s46, 1
  s_cmp_ge_u32 s46, 131072
  s_cbranch_scc1 FL_rec_abort
  s_waitcnt vmcnt(4)
  s_branch FL_m_01_c0
FL_m_01_ok0:
  v_smfmac_f32_16x16x64_bf16 v[64:67], v[48:51], a[0:7], v23
  v_max3_u32 v31, v52, v53, v54
  v_max_u32 v31, v31, v55
  v_cmp_eq_u32 vcc, -1, v31
  v_smfmac_f32_16x16x64_bf16 v[68:71], v[48:51], a[8:15], v23
  v_smfmac_f32_16x16x64_bf16 v[72:75], v[48:51], a[16:23], v23
  v_smfmac_f32_16x16x64_bf16 v[76:79], v[48:51], a[24:31], v23
  s_cbranch_vccz FL_m_1_ok1
  s_branch FL_m_1_x1
FL_m_01_ok1:
  v_smfmac_f32_16x16x64_bf16 v[64:67], v[52:55], a[48:55], v23
  v_max3_u32 v31, v48, v49, v50
  v_max_u32 v31, v31, v51
  v_cmp_eq_u32 vcc, -1, v31
  v_smfmac_f32_16x16x64_bf16 v[68:71], v[52:55], a[56:63], v23
  v_smfmac_f32_16x16x64_bf16 v[72:75], v[52:55], a[64:71], v23
  v_smfmac_f32_16x16x64_bf16 v[76:79], v[52:55], a[72:79], v23
  s_cbranch_vccz FL_m_0_ok0
  s_branch FL_m_0_x0
FL_m_02_c0:
  v_max3_u32 v31, v48, v49, v50
  v_max_u32 v31, v31, v51
  v_cmp_eq_u32 vcc, -1, v31
  s_cbranch_vccz FL_m_02_ok0
FL_m_02_x0:
  s_mov_b64 exec, vcc
  buffer_load_dwordx4 v[48:51], v3, s[4:7], s41 offen offset:0 sc1
  s_mov_b64 exec, -1
FL_m_02_c2:
  v_max3_u32 v31, v56, v57, v58
  v_max_u32 v31, v31, v59
  v_cmp_eq_u32 vcc, -1, v31
  s_cbranch_vccz FL_m_02_ok2
FL_m_02_x2:
  s_mov_b64 exec, vcc
  buffer_load_dwordx4 v[56:59], v3, s[4:7], s41 offen offset:2048 sc1
  s_mov_b64 exec, -1
  s_add_u32 s46, s46, 1
  s_cmp_ge_u32 s46, 131072
  s_cbranch_scc1 FL_rec_abort
  s_waitcnt vmcnt(4)
  s_branch FL_m_02_c0
FL_m_02_ok0:
  v_smfmac_f32_16x16x64_bf16 v[64:67], v[48:51], a[0:7], v23
  v_max3_u32 v31, v56, v57, v58
  v_max_u32 v31, v31, v59
  v_cmp_eq_u32 vcc, -1, v31
  v_smfmac_f32_16x16x64_bf16 v[68:71], v[48:51], a[8:15], v23
  v_smfmac_f32_16x16x64_bf16 v[72:75], v[48:51], a[16:23], v23
  v_smfmac_f32_16x16x64_bf16 v[76:79], v[48:51], a[24:31], v23
  s_cbranch_vccz FL_m_2_ok2
  s_branch FL_m_2_x2
FL_m_02_ok2:
  v_smfmac_f32_16x16x64_bf16 v[64:67], v[56:59], a[96:103], v23
  v_max3_u32 v31, v48, v49, v50
  v_max_u32 v31, v31, v51
  v_cmp_eq_u32 vcc, -1, v31
  v_smfmac_f32_16x16x64_bf16 v[68:71], v[56:59], a[104:111], v23
  v_smfmac_f32_16x16x64_bf16 v[72:75], v[56:59], a[112:119], v23
  v_smfmac_f32_16x16x64_bf16 v[76:79], v[56:59], a[120:127], v23
  s_cbranch_vccz FL_m_0_ok0
  s_branch FL_m_0_x0
FL_m_03_c0:
  v_max3_u32 v31, v48, v49, v50
  v_max_u32 v31, v31, v51
  v_cmp_eq_u32 vcc, -1, v31
  s_cbranch_vccz FL_m_03_ok0
FL_m_03_x0:
  s_mov_b64 exec, vcc
  buffer_load_dwordx4 v[48:51], v3, s[4:7], s41 offen offset:0 sc1
  s_mov_b64 exec, -1
FL_m_03_c3:
  v_max3_u32 v31, v60, v61, v62
  v_max_u32 v31, v31, v63
  v_cmp_eq_u32 vcc, -1, v31
  s_cbranch_vccz FL_m_03_ok3
FL_m_03_x3:
  s_mov_b64 exec, vcc
  buffer_load_dwordx4 v[60:63], v3, s[4:7], s41 offen offset:3072 sc1
  s_mov_b64 exec, -1
  s_add_u32 s46, s46, 1
  s_cmp_ge_u32 s46, 131072
  s_cbranch_scc1 FL_rec_abort
  s_waitcnt vmcnt(4)
  s_branch FL_m_03_c0
FL_m_03_ok0:
  v_smfmac_f32_16x16x64_bf16 v[64:67], v[48:51], a[0:7], v23
  v_max3_u32 v31, v60, v61, v62
  v_max_u32 v31, v31, v63
  v_cmp_eq_u32 vcc, -1, v31
  v_smfmac_f32_16x16x64_bf16 v[68:71], v[48:51], a[8:15], v23
  v_smfmac_f32_16x16x64_bf16 v[72:75], v[48:51], a[16:23], v23
  v_smfmac_f32_16x16x64_bf16 v[76:79], v[48:51], a[24:31], v23
  s_cbranch_vccz FL_m_3_ok3
  s_branch FL_m_3_x3
FL_m_03_ok3:
  v_smfmac_f32_16x16x64_bf16 v[64:67], v[60:63], a[144:151], v23
  v_max3_u32 v31, v48, v49, v50
  v_max_u32 v31, v31, v51
  v_cmp_eq_u32 vcc, -1, v31
  v_smfmac_f32_16x16x64_bf16 v[68:71], v[60:63], a[152:159], v23
  v_smfmac_f32_16x16x64_bf16 v[72:75], v[60:63], a[160:167], v23
  v_smfmac_f32_16x16x64_bf16 v[76:79], v[60:63], a[168:175], v23
  s_cbranch_vccz FL_m_0_ok0
  s_branch FL_m_0_x0
FL_m_12_c1:
  v_max3_u32 v31, v52, v53, v54
  v_max_u32 v31, v31, v55
  v_cmp_eq_u32 vcc, -1, v31
  s_cbranch_vccz FL_m_12_ok1
FL_m_12_x1:
  s_mov_b64 exec, vcc
  buffer_load_dwordx4 v[52:55], v3, s[4:7], s41 offen offset:1024 sc1
  s_mov_b64 exec, -1
FL_m_12_c2:
  v_max3_u32 v31, v56, v57, v58
  v_max_u32 v31, v31, v59
  v_cmp_eq_u32 vcc, -1, v31
  s_cbranch_vccz FL_m_12_ok2
FL_m_12_x2:
  s_mov_b64 exec, vcc
  buffer_load_dwordx4 v[56:59], v3, s[4:7], s41 offen offset:2048 sc1
  s_mov_b64 exec, -1
  s_add_u32 s46, s46, 1
  s_cmp_ge_u32 s46, 131072
  s_cbranch_scc1 FL_rec_abort
  s_waitcnt vmcnt(4)
  s_branch FL_m_12_c1
FL_m_12_ok1:
  v_smfmac_f32_16x16x64_bf16 v[64:67], v[52:55], a[48:55], v23
  v_max3_u32 v31, v56, v57, v58
  v_max_u32 v31, v31, v59
  v_cmp_eq_u32 vcc, -1, v31
  v_smfmac_f32_16x16x64_bf16 v[68:71], v[52:55], a[56:63], v23
  v_smfmac_f32_16x16x64_bf16 v[72:75], v[52:55], a[64:71], v23
  v_smfmac_f32_16x16x64_bf16 v[76:79], v[52:55], a[72:79], v23
  s_cbranch_vccz FL_m_2_ok2
  s_branch FL_m_2_x2
FL_m_12_ok2:
  v_smfmac_f32_16x16x64_bf16 v[64:67], v[56:59], a[96:103], v23
  v_max3_u32 v31, v52, v53, v54
  v_max_u32 v31, v31, v55
  v_cmp_eq_u32 vcc, -1, v31
  v_smfmac_f32_16x16x64_bf16 v[68:71], v[56:59], a[104:111], v23
  v_smfmac_f32_16x16x64_bf16 v[72:75], v[56:59], a[112:119], v23
  v_smfmac_f32_16x16x64_bf16 v[76:79], v[56:59], a[120:127], v23
  s_cbranch_vccz FL_m_1_ok1
  s_branch FL_m_1_x1
FL_m_13_c1:
  v_max3_u32 v31, v52, v53, v54
  v_max_u32 v31, v31, v55
  v_cmp_eq_u32 vcc, -1, v31
  s_cbranch_vccz FL_m_13_ok1
FL_m_13_x1:
  s_mov_b64 exec, vcc
  buffer_load_dwordx4 v[52:55], v3, s[4:7], s41 offen offset:1024 sc1
  s_mov_b64 exec, -1
FL_m_13_c3:
  v_max3_u32 v31, v60, v61, v62
  v_max_u32 v31, v31, v63
  v_cmp_eq_u32 vcc, -1, v31
  s_cbranch_vccz FL_m_13_ok3
FL_m_13_x3:
  s_mov_b64 exec, vcc
  buffer_load_dwordx4 v[60:63], v3, s[4:7], s41 offen offset:3072 sc1
  s_mov_b64 exec, -1
  s_add_u32 s46, s46, 1
  s_cmp_ge_u32 s46, 131072
  s_cbranch_scc1 FL_rec_abort
  s_waitcnt vmcnt(4)
  s_branch FL_m_13_c1
FL_m_13_ok1:
  v_smfmac_f32_16x16x64_bf16 v[64:67], v[52:55], a[48:55], v23
  v_max3_u32 v31, v60, v61, v62
  v_max_u32 v31, v31, v63
  v_cmp_eq_u32 vcc, -1, v31
  v_smfmac_f32_16x16x64_bf16 v[68:71], v[52:55], a[56:63], v23
  v_smfmac_f32_16x16x64_bf16 v[72:75], v[52:55], a[64:71], v23
  v_smfmac_f32_16x16x64_bf16 v[76:79], v[52:55], a[72:79], v23
  s_cbranch_vccz FL_m_3_ok3
  s_branch FL_m_3_x3
FL_m_13_ok3:
  v_smfmac_f32_16x16x64_bf16 v[64:67], v[60:63], a[144:151], v23
  v_max3_u32 v31, v52, v53, v54
  v_max_u32 v31, v31, v55
  v_cmp_eq_u32 vcc, -1, v31
  v_smfmac_f32_16x16x64_bf16 v[68:71], v[60:63], a[152:159], v23
  v_smfmac_f32_16x16x64_bf16 v[72:75], v[60:63], a[160:167], v23
  v_smfmac_f32_16x16x64_bf16 v[76:79], v[60:63], a[168:175], v23
  s_cbranch_vccz FL_m_1_ok1
  s_branch FL_m_1_x1
FL_m_23_c2:
  v_max3_u32 v31, v56, v57, v58
  v_max_u32 v31, v31, v59
  v_cmp_eq_u32 vcc, -1, v31
  s_cbranch_vccz FL_m_23_ok2
FL_m_23_x2:
  s_mov_b64 exec, vcc
  buffer_load_dwordx4 v[56:59], v3, s[4:7], s41 offen offset:2048 sc1
  s_mov_b64 exec, -1
FL_m_23_c3:
  v_max3_u32 v31, v60, v61, v62
  v_max_u32 v31, v31, v63
  v_cmp_eq_u32 vcc, -1, v31
  s_cbranch_vccz FL_m_23_ok3
FL_m_23_x3:
  s_mov_b64 exec, vcc
  buffer_load_dwordx4 v[60:63], v3, s[4:7], s41 offen offset:3072 sc1
  s_mov_b64 exec, -1
  s_add_u32 s46, s46, 1
  s_cmp_ge_u32 s46, 131072
  s_cbranch_scc1 FL_rec_abort
  s_waitcnt vmcnt(4)
  s_branch FL_m_23_c2
FL_m_23_ok2:
  v_smfmac_f32_16x16x64_bf16 v[64:67], v[56:59], a[96:103], v23
  v_max3_u32 v31, v60, v61, v62
  v_max_u32 v31, v31, v63
  v_cmp_eq_u32 vcc, -1, v31
  v_smfmac_f32_16x16x64_bf16 v[68:71], v[56:59], a[104:111], v23
  v_smfmac_f32_16x16x64_bf16 v[72:75], v[56:59], a[112:119], v23
  v_smfmac_f32_16x16x64_bf16 v[76:79], v[56:59], a[120:127], v23
  s_cbranch_vccz FL_m_3_ok3
  s_branch FL_m_3_x3
FL_m_23_ok3:
  v_smfmac_f32_16x16x64_bf16 v[64:67], v[60:63], a[144:151], v23
  v_max3_u32 v31, v56, v57, v58
  v_max_u32 v31, v31, v59
  v_cmp_eq_u32 vcc, -1, v31
  v_smfmac_f32_16x16x64_bf16 v[68:71], v[60:63], a[152:159], v23
  v_smfmac_f32_16x16x64_bf16 v[72:75], v[60:63], a[160:167], v23
  v_smfmac_f32_16x16x64_bf16 v[76:79], v[60:63], a[168:175], v23
  s_cbranch_vccz FL_m_2_ok2
  s_branch FL_m_2_x2
FL_m_012_c0:
  v_max3_u32 v31, v48, v49, v50
  v_max_u32 v31, v31, v51
  v_cmp_eq_u32 vcc, -1, v31
  s_cbranch_vccz FL_m_012_ok0
FL_m_012_x0:
  s_mov_b64 exec, vcc
  buffer_load_dwordx4 v[48:51], v3, s[4:7], s41 offen offset:0 sc1
  s_mov_b64 exec, -1
FL_m_012_c1:
  v_max3_u32 v31, v52, v53, v54
  v_max_u32 v31, v31, v55
  v_cmp_eq_u32 vcc, -1, v31
  s_cbranch_vccz FL_m_012_ok1
FL_m_012_x1:
  s_mov_b64 exec, vcc
  buffer_load_dwordx4 v[52:55], v3, s[4:7], s41 offen offset:1024 sc1
  s_mov_b64 exec, -1
FL_m_012_c2:
  v_max3_u32 v31, v56, v57, v58
  v_max_u32 v31, v31, v59
  v_cmp_eq_u32 vcc, -1, v31
  s_cbranch_vccz FL_m_012_ok2
FL_m_012_x2:
  s_mov_b64 exec, vcc
  buffer_load_dwordx4 v[56:59], v3, s[4:7], s41 offen offset:2048 sc1
  s_mov_b64 exec, -1
  s_add_u32 s46, s46, 1
  s_cmp_ge_u32 s46, 131072
  s_cbranch_scc1 FL_rec_abort
  s_waitcnt vmcnt(4)
  s_branch FL_m_012_c0
FL_m_012_ok0:
  v_smfmac_f32_16x16x64_bf16 v[64:67], v[48:51], a[0:7], v23
  v_max3_u32 v31, v52, v53, v54
  v_max_u32 v31, v31, v55
  v_cmp_eq_u32 vcc, -1, v31
  v_smfmac_f32_16x16x64_bf16 v[68:71], v[48:51], a[8:15], v23
  v_smfmac_f32_16x16x64_bf16 v[72:75], v[48:51], a[16:23], v23
  v_smfmac_f32_16x16x64_bf16 v[76:79], v[48:51], a[24:31], v23
  s_cbranch_vccz FL_m_12_ok1
  s_branch FL_m_12_x1
FL_m_012_ok1:
  v_smfmac_f32_16x16x64_bf16 v[64:67], v[52:55], a[48:55], v23
  v_max3_u32 v31, v56, v57, v58
  v_max_u32 v31, v31, v59
  v_cmp_eq_u32 vcc, -1, v31
  v_smfmac_f32_16x16x64_bf16 v[68:71], v[52:55], a[56:63], v23
  v_smfmac_f32_16x16x64_bf16 v[72:75], v[52:55], a[64:71], v23
  v_smfmac_f32_16x16x64_bf16 v[76:79], v[52:55], a[72:79], v23
  s_cbranch_vccz FL_m_02_ok2
  s_branch FL_m_02_x2
FL_m_012_ok2:
  v_smfmac_f32_16x16x64_bf16 v[64:67], v[56:59], a[96:103], v23
  v_max3_u32 v31, v48, v49, v50
  v_max_u32 v31, v31, v51
  v_cmp_eq_u32 vcc, -1, v31
  v_smfmac_f32_16x16x64_bf16 v[68:71], v[56:59], a[104:111], v23
  v_smfmac_f32_16x16x64_bf16 v[72:75], v[56:59], a[112:119], v23
  v_smfmac_f32_16x16x64_bf16 v[76:79], v[56:59], a[120:127], v23
  s_cbranch_vccz FL_m_01_ok0
  s_branch FL_m_01_x0
FL_m_013_c0:
  v_max3_u32 v31, v48, v49, v50
  v_max_u32 v31, v31, v51
  v_cmp_eq_u32 vcc, -1, v31
  s_cbranch_vccz FL_m_013_ok0
FL_m_013_x0:
  s_mov_b64 exec, vcc
  buffer_load_dwordx4 v[48:51], v3, s[4:7], s41 offen offset:0 sc1
  s_mov_b64 exec, -1
FL_m_013_c1:
  v_max3_u32 v31, v52, v53, v54
  v_max_u32 v31, v31, v55
  v_cmp_eq_u32 vcc, -1, v31
  s_cbranch_vccz FL_m_013_ok1
FL_m_013_x1:
  s_mov_b64 exec, vcc
  buffer_load_dwordx4 v[52:55], v3, s[4:7], s41 offen offset:1024 sc1
  s_mov_b64 exec, -1
FL_m_013_c3:
  v_max3_u32 v31, v60, v61, v62
  v_max_u32 v31, v31, v63
  v_cmp_eq_u32 vcc, -1, v31
  s_cbranch_vccz FL_m_013_ok3
FL_m_013_x3:
  s_mov_b64 exec, vcc
  buffer_load_dwordx4 v[60:63], v3, s[4:7], s41 offen offset:3072 sc1
  s_mov_b64 exec, -1
  s_add_u32 s46, s46, 1
  s_cmp_ge_u32 s46, 131072
  s_cbranch_scc1 FL_rec_abort
  s_waitcnt vmcnt(4)
  s_branch FL_m_013_c0
FL_m_013_ok0:
  v_smfmac_f32_16x16x64_bf16 v[64:67], v[48:51], a[0:7], v23
  v_max3_u32 v31, v52, v53, v54
  v_max_u32 v31, v31, v55
  v_cmp_eq_u32 vcc, -1, v31
  v_smfmac_f32_16x16x64_bf16 v[68:71], v[48:51], a[8:15], v23
  v_smfmac_f32_16x16x64_bf16 v[72:75], v[48:51], a[16:23], v23
  v_smfmac_f32_16x16x64_bf16 v[76:79], v[48:51], a[24:31], v23
  s_cbranch_vccz FL_m_13_ok1
  s_branch FL_m_13_x1
FL_m_013_ok1:
  v_smfmac_f32_16x16x64_bf16 v[64:67], v[52:55], a[48:55], v23
  v_max3_u32 v31, v60, v61, v62
  v_max_u32 v31, v31, v63
  v_cmp_eq_u32 vcc, -1, v31
  v_smfmac_f32_16x16x64_bf16 v[68:71], v[52:55], a[56:63], v23
  v_smfmac_f32_16x16x64_bf16 v[72:75], v[52:55], a[64:71], v23
  v_smfmac_f32_16x16x64_bf16 v[76:79], v[52:55], a[72:79], v23
  s_cbranch_vccz FL_m_03_ok3
  s_branch FL_m_03_x3
FL_m_013_ok3:
  v_smfmac_f32_16x16x64_bf16 v[64:67], v[60:63], a[144:151], v23
  v_max3_u32 v31, v48, v49, v50
  v_max_u32 v31, v31, v51
  v_cmp_eq_u32 vcc, -1, v31
  v_smfmac_f32_16x16x64_bf16 v[68:71], v[60:63], a[152:159], v23
  v_smfmac_f32_16x16x64_bf16 v[72:75], v[60:63], a[160:167], v23
  v_smfmac_f32_16x16x64_bf16 v[76:79], v[60:63], a[168:175], v23
  s_cbranch_vccz FL_m_01_ok0
  s_branch FL_m_01_x0
FL_m_023_c0:
  v_max3_u32 v31, v48, v49, v50
  v_max_u32 v31, v31, v51
  v_cmp_eq_u32 vcc, -1, v31
  s_cbranch_vccz FL_m_023_ok0
FL_m_023_x0:
  s_mov_b64 exec, vcc
  buffer_load_dwordx4 v[48:51], v3, s[4:7], s41 offen offset:0 sc1
  s_mov_b64 exec, -1
FL_m_023_c2:
  v_max3_u32 v31, v56, v57, v58
  v_max_u32 v31, v31, v59
  v_cmp_eq_u32 vcc, -1, v31
  s_cbranch_vccz FL_m_023_ok2
FL_m_023_x2:
  s_mov_b64 exec, vcc
  buffer_load_dwordx4 v[56:59], v3, s[4:7], s41 offen offset:2048 sc1
  s_mov_b64 exec, -1
FL_m_023_c3:
  v_max3_u32 v31, v60, v61, v62
  v_max_u32 v31, v31, v63
  v_cmp_eq_u32 vcc, -1, v31
  s_cbranch_vccz FL_m_023_ok3
FL_m_023_x3:
  s_mov_b64 exec, vcc
  buffer_load_dwordx4 v[60:63], v3, s[4:7], s41 offen offset:3072 sc1
  s_mov_b64 exec, -1
  s_add_u32 s46, s46, 1
  s_cmp_ge_u32 s46, 131072
  s_cbranch_scc1 FL_rec_abort
  s_waitcnt vmcnt(4)
  s_branch FL_m_023_c0
FL_m_023_ok0:
  v_smfmac_f32_16x16x64_bf16 v[64:67], v[48:51], a[0:7], v23
  v_max3_u32 v31, v56, v57, v58
  v_max_u32 v31, v31, v59
  v_cmp_eq_u32 vcc, -1, v31
  v_smfmac_f32_16x16x64_bf16 v[68:71], v[48:51], a[8:15], v23
  v_smfmac_f32_16x16x64_bf16 v[72:75], v[48:51], a[16:23], v23
  v_smfmac_f32_16x16x64_bf16 v[76:79], v[48:51], a[24:31], v23
  s_cbranch_vccz FL_m_23_ok2
  s_branch FL_m_23_x2
FL_m_023_ok2:
  v_smfmac_f32_16x16x64_bf16 v[64:67], v[56:59], a[96:103], v23
  v_max3_u32 v31, v60, v61, v62
  v_max_u32 v31, v31, v63
  v_cmp_eq_u32 vcc, -1, v31
  v_smfmac_f32_16x16x64_bf16 v[68:71], v[56:59], a[104:111], v23
  v_smfmac_f32_16x16x64_bf16 v[72:75], v[56:59], a[112:119], v23
  v_smfmac_f32_16x16x64_bf16 v[76:79], v[56:59], a[120:127], v23
  s_cbranch_vccz FL_m_03_ok3
  s_branch FL_m_03_x3
FL_m_023_ok3:
  v_smfmac_f32_16x16x64_bf16 v[64:67], v[60:63], a[144:151], v23
  v_max3_u32 v31, v48, v49, v50
  v_max_u32 v31, v31, v51
  v_cmp_eq_u32 vcc, -1, v31
  v_smfmac_f32_16x16x64_bf16 v[68:71], v[60:63], a[152:159], v23
  v_smfmac_f32_16x16x64_bf16 v[72:75], v[60:63], a[160:167], v23
  v_smfmac_f32_16x16x64_bf16 v[76:79], v[60:63], a[168:175], v23
  s_cbranch_vccz FL_m_02_ok0
  s_branch FL_m_02_x0
FL_m_123_c1:
  v_max3_u32 v31, v52, v53, v54
  v_max_u32 v31, v31, v55
  v_cmp_eq_u32 vcc, -1, v31
  s_cbranch_vccz FL_m_123_ok1
FL_m_123_x1:
  s_mov_b64 exec, vcc
  buffer_load_dwordx4 v[52:55], v3, s[4:7], s41 offen offset:1024 sc1
  s_mov_b64 exec, -1
FL_m_123_c2:
  v_max3_u32 v31, v56, v57, v58
  v_max_u32 v31, v31, v59
  v_cmp_eq_u32 vcc, -1, v31
  s_cbranch_vccz FL_m_123_ok2
FL_m_123_x2:
  s_mov_b64 exec, vcc
  buffer_load_dwordx4 v[56:59], v3, s[4:7], s41 offen offset:2048 sc1
  s_mov_b64 exec, -1
FL_m_123_c3:
  v_max3_u32 v31, v60, v61, v62
  v_max_u32 v31, v31, v63
  v_cmp_eq_u32 vcc, -1, v31
  s_cbranch_vccz FL_m_123_ok3
FL_m_123_x3:
  s_mov_b64 exec, vcc
  buffer_load_dwordx4 v[60:63], v3, s[4:7], s41 offen offset:3072 sc1
  s_mov_b64 exec, -1
  s_add_u32 s46, s46, 1
  s_cmp_ge_u32 s46, 131072
  s_cbranch_scc1 FL_rec_abort
  s_waitcnt vmcnt(4)
  s_branch FL_m_123_c1
FL_m_123_ok1:
  v_smfmac_f32_16x16x64_bf16 v[64:67], v[52:55], a[48:55], v23
  v_max3_u32 v31, v56, v57, v58
  v_max_u32 v31, v31, v59
  v_cmp_eq_u32 vcc, -1, v31
  v_smfmac_f32_16x16x64_bf16 v[68:71], v[52:55], a[56:63], v23
  v_smfmac_f32_16x16x64_bf16 v[72:75], v[52:55], a[64:71], v23
  v_smfmac_f32_16x16x64_bf16 v[76:79], v[52:55], a[72:79], v23
  s_cbranch_vccz FL_m_23_ok2
  s_branch FL_m_23_x2
FL_m_123_ok2:
  v_smfmac_f32_16x16x64_bf16 v[64:67], v[56:59], a[96:103], v23
  v_max3_u32 v31, v60, v61, v62
  v_max_u32 v31, v31, v63
  v_cmp_eq_u32 vcc, -1, v31
  v_smfmac_f32_16x16x64_bf16 v[68:71], v[56:59], a[104:111], v23
  v_smfmac_f32_16x16x64_bf16 v[72:75], v[56:59], a[112:119], v23
  v_smfmac_f32_16x16x64_bf16 v[76:79], v[56:59], a[120:127], v23
  s_cbranch_vccz FL_m_13_ok3
  s_branch FL_m_13_x3
FL_m_123_ok3:
  v_smfmac_f32_16x16x64_bf16 v[64:67], v[60:63], a[144:151], v23
  v_max3_u32 v31, v52, v53, v54
  v_max_u32 v31, v31, v55
  v_cmp_eq_u32 vcc, -1, v31
  v_smfmac_f32_16x16x64_bf16 v[68:71], v[60:63], a[152:159], v23
  v_smfmac_f32_16x16x64_bf16 v[72:75], v[60:63], a[160:167], v23
  v_smfmac_f32_16x16x64_bf16 v[76:79], v[60:63], a[168:175], v23
  s_cbranch_vccz FL_m_12_ok1
  s_branch FL_m_12_x1
FL_m_0123_c0:
  v_max3_u32 v31, v48, v49, v50
  v_max_u32 v31, v31, v51
  v_cmp_eq_u32 vcc, -1, v31
  s_cbranch_vccz FL_m_0123_ok0
FL_m_0123_x0:
  s_mov_b64 exec, vcc
  buffer_load_dwordx4 v[48:51], v3, s[4:7], s41 offen offset:0 sc1
  s_mov_b64 exec, -1
FL_m_0123_c1:
  v_max3_u32 v31, v52, v53, v54
  v_max_u32 v31, v31, v55
  v_cmp_eq_u32 vcc, -1, v31
  s_cbranch_vccz FL_m_0123_ok1
FL_m_0123_x1:
  s_mov_b64 exec, vcc
  buffer_load_dwordx4 v[52:55], v3, s[4:7], s41 offen offset:1024 sc1
  s_mov_b64 exec, -1
FL_m_0123_c2:
  v_max3_u32 v31, v56, v57, v58
  v_max_u32 v31, v31, v59
  v_cmp_eq_u32 vcc, -1, v31
  s_cbranch_vccz FL_m_0123_ok2
FL_m_0123_x2:
  s_mov_b64 exec, vcc
  buffer_load_dwordx4 v[56:59], v3, s[4:7], s41 offen offset:2048 sc1
  s_mov_b64 exec, -1
FL_m_0123_c3:
  v_max3_u32 v31, v60, v61, v62
  v_max_u32 v31, v31, v63
  v_cmp_eq_u32 vcc, -1, v31
  s_cbranch_vccz FL_m_0123_ok3
FL_m_0123_x3:
  s_mov_b64 exec, vcc
  buffer_load_dwordx4 v[60:63], v3, s[4:7], s41 offen offset:3072 sc1
  s_mov_b64 exec, -1
  s_add_u32 s46, s46, 1
  s_cmp_ge_u32 s46, 131072
  s_cbranch_scc1 FL_rec_abort
  s_waitcnt vmcnt(4)
  s_branch FL_m_0123_c0
FL_m_0123_ok0:
  v_smfmac_f32_16x16x64_bf16 v[64:67], v[48:51], a[0:7], v23
  v_max3_u32 v31, v52, v53, v54
  v_max_u32 v31, v31, v55
  v_cmp_eq_u32 vcc, -1, v31
  v_smfmac_f32_16x16x64_bf16 v[68:71], v[48:51], a[8:15], v23
  v_smfmac_f32_16x16x64_bf16 v[72:75], v[48:51], a[16:23], v23
  v_smfmac_f32_16x16x64_bf16 v[76:79], v[48:51], a[24:31], v23
  s_cbranch_vccz FL_m_123_ok1
  s_branch FL_m_123_x1
FL_m_0123_ok1:
  v_smfmac_f32_16x16x64_bf16 v[64:67], v[52:55], a[48:55], v23
  v_max3_u32 v31, v56, v57, v58
  v_max_u32 v31, v31, v59
  v_cmp_eq_u32 vcc, -1, v31
  v_smfmac_f32_16x16x64_bf16 v[68:71], v[52:55], a[56:63], v23
  v_smfmac_f32_16x16x64_bf16 v[72:75], v[52:55], a[64:71], v23
  v_smfmac_f32_16x16x64_bf16 v[76:79], v[52:55], a[72:79], v23
  s_cbranch_vccz FL_m_023_ok2
  s_branch FL_m_023_x2
FL_m_0123_ok2:
  v_smfmac_f32_16x16x64_bf16 v[64:67], v[56:59], a[96:103], v23
  v_max3_u32 v31, v60, v61, v62
  v_max_u32 v31, v31, v63
  v_cmp_eq_u32 vcc, -1, v31
  v_smfmac_f32_16x16x64_bf16 v[68:71], v[56:59], a[104:111], v23
  v_smfmac_f32_16x16x64_bf16 v[72:75], v[56:59], a[112:119], v23
  v_smfmac_f32_16x16x64_bf16 v[76:79], v[56:59], a[120:127], v23
  s_cbranch_vccz FL_m_013_ok3
  s_branch FL_m_013_x3
FL_m_0123_ok3:
  v_smfmac_f32_16x16x64_bf16 v[64:67], v[60:63], a[144:151], v23
  v_max3_u32 v31, v48, v49, v50
  v_max_u32 v31, v31, v51
  v_cmp_eq_u32 vcc, -1, v31
  v_smfmac_f32_16x16x64_bf16 v[68:71], v[60:63], a[152:159], v23
  v_smfmac_f32_16x16x64_bf16 v[72:75], v[60:63], a[160:167], v23
  v_smfmac_f32_16x16x64_bf16 v[76:79], v[60:63], a[168:175], v23
  s_cbranch_vccz FL_m_012_ok0
  s_branch FL_m_012_x0
FL_x_f0:
  s_mov_b64 exec, vcc
  buffer_load_dwordx4 v[64:67], v9, s[4:7], s41 offen offset:0 sc1
  s_mov_b64 exec, -1
  s_waitcnt vmcnt(2)
  s_branch FL_x_0123_c1
FL_x_f1:
  s_mov_b64 exec, vcc
  buffer_load_dwordx4 v[68:71], v9, s[4:7], s41 offen offset:1024 sc1
  s_mov_b64 exec, -1
  s_waitcnt vmcnt(2)
  s_branch FL_x_123_c2
FL_x_f2:
  s_mov_b64 exec, vcc
  buffer_load_dwordx4 v[72:75], v9, s[4:7], s41 offen offset:2048 sc1
  s_mov_b64 exec, -1
  s_waitcnt vmcnt(2)
  s_branch FL_x_23_c3
FL_x_f3:
  s_mov_b64 exec, vcc
  buffer_load_dwordx4 v[76:79], v9, s[4:7], s41 offen offset:3072 sc1
  s_mov_b64 exec, -1
  s_nop 7
  s_branch FL_x_3_c3
FL_x_0_c0:
  v_max3_u32 v31, v64, v65, v66
  v_max_u32 v31, v31, v67
  v_cmp_eq_u32 vcc, -1, v31
  s_cbranch_vccz FL_x_0_ok0
FL_x_0_x0:
  s_mov_b64 exec, vcc
  buffer_load_dwordx4 v[64:67], v9, s[4:7], s41 offen offset:0 sc1
  s_mov_b64 exec, -1
  s_add_u32 s46, s46, 1
  s_cmp_ge_u32 s46, 131072
  s_cbranch_scc1 FL_rec_abort
  s_waitcnt vmcnt(2)
  s_branch FL_x_0_c0
FL_x_0_ok0:
  v_mfma_f32_16x16x32_bf16 v[44:47], v[64:67], v[64:67], v[44:47]
  v_mfma_f32_16x16x32_bf16 v[36:39], v[116:119], v[64:67], v[36:39]
  v_mfma_f32_16x16x32_bf16 v[40:43], v[132:135], v[64:67], v[40:43]
  s_branch FL_x_done
FL_x_1_c1:
  v_max3_u32 v31, v68, v69, v70
  v_max_u32 v31, v31, v71
  v_cmp_eq_u32 vcc, -1, v31
  s_cbranch_vccz FL_x_1_ok1
FL_x_1_x1:
  s_mov_b64 exec, vcc
  buffer_load_dwordx4 v[68:71], v9, s[4:7], s41 offen offset:1024 sc1
  s_mov_b64 exec, -1
  s_add_u32 s46, s46, 1
  s_cmp_ge_u32 s46, 131072
  s_cbranch_scc1 FL_rec_abort
  s_waitcnt vmcnt(2)
  s_branch FL_x_1_c1
FL_x_1_ok1:
  v_mfma_f32_16x16x32_bf16 v[44:47], v[68:71], v[68:71], v[44:47]
  v_mfma_f32_16x16x32_bf16 v[36:39], v[120:123], v[68:71], v[36:39]
  v_mfma_f32_16x16x32_bf16 v[40:43], v[136:139], v[68:71], v[40:43]
  s_branch FL_x_done
FL_x_2_c2:
  v_max3_u32 v31, v72, v73, v74
  v_max_u32 v31, v31, v75
  v_cmp_eq_u32 vcc, -1, v31
  s_cbranch_vccz FL_x_2_ok2
FL_x_2_x2:
  s_mov_b64 exec, vcc
  buffer_load_dwordx4 v[72:75], v9, s[4:7], s41 offen offset:2048 sc1
  s_mov_b64 exec, -1
  s_add_u32 s46, s46, 1
  s_cmp_ge_u32 s46, 131072
  s_cbranch_scc1 FL_rec_abort
  s_waitcnt vmcnt(2)
  s_branch FL_x_2_c2
FL_x_2_ok2:
  v_mfma_f32_16x16x32_bf16 v[44:47], v[72:75], v[72:75], v[44:47]
  v_mfma_f32_16x16x32_bf16 v[36:39], v[124:127], v[72:75], v[36:39]
  v_mfma_f32_16x16x32_bf16 v[40:43], v[140:143], v[72:75], v[40:43]
  s_branch FL_x_done
FL_x_3_c3:
  v_max3_u32 v31, v76, v77, v78
  v_max_u32 v31, v31, v79
  v_cmp_eq_u32 vcc, -1, v31
  s_cbranch_vccz FL_x_3_ok3
FL_x_3_x3:
  s_mov_b64 exec, vcc
  buffer_load_dwordx4 v[76:79], v9, s[4:7], s41 offen offset:3072 sc1
  s_mov_b64 exec, -1
  s_add_u32 s46, s46, 1
  s_cmp_ge_u32 s46, 131072
  s_cbranch_scc1 FL_rec_abort
  s_waitcnt vmcnt(2)
  s_branch FL_x_3_c3
FL_x_3_ok3:
  v_mfma_f32_16x16x32_bf16 v[44:47], v[76:79], v[76:79], v[44:47]
  v_mfma_f32_16x16x32_bf16 v[36:39], v[128:131], v[76:79], v[36:39]
  v_mfma_f32_16x16x32_bf16 v[40:43], v[144:147], v[76:79], v[40:43]
  s_branch FL_x_done
FL_x_01_c0:
  v_max3_u32 v31, v64, v65, v66
  v_max_u32 v31, v31, v67
  v_cmp_eq_u32 vcc, -1, v31
  s_cbranch_vccz FL_x_01_ok0
FL_x_01_x0:
  s_mov_b64 exec, vcc
  buffer_load_dwordx4 v[64:67], v9, s[4:7], s41 offen offset:0 sc1
  s_mov_b64 exec, -1
FL_x_01_c1:
  v_max3_u32 v31, v68, v69, v70
  v_max_u32 v31, v31, v71
  v_cmp_eq_u32 vcc, -1, v31
  s_cbranch_vccz FL_x_01_ok1
FL_x_01_x1:
  s_mov_b64 exec, vcc
  buffer_load_dwordx4 v[68:71], v9, s[4:7], s41 offen offset:1024 sc1
  s_mov_b64 exec, -1
  s_add_u32 s46, s46, 1
  s_cmp_ge_u32 s46, 131072
  s_cbranch_scc1 FL_rec_abort
  s_waitcnt vmcnt(4)
  s_branch FL_x_01_c0
FL_x_01_ok0:
  v_mfma_f32_16x16x32_bf16 v[44:47], v[64:67], v[64:67], v[44:47]
  v_max3_u32 v31, v68, v69, v70
  v_max_u32 v31, v31, v71
  v_cmp_eq_u32 vcc, -1, v31
  v_mfma_f32_16x16x32_bf16 v[36:39], v[116:119], v[64:67], v[36:39]
  v_mfma_f32_16x16x32_bf16 v[40:43], v[132:135], v[64:67], v[40:43]
  s_cbranch_vccz FL_x_1_ok1
  s_branch FL_x_1_x1
FL_x_01_ok1:
  v_mfma_f32_16x16x32_bf16 v[44:47], v[68:71], v[68:71], v[44:47]
  v_max3_u32 v31, v64, v65, v66
  v_max_u32 v31, v31, v67
  v_cmp_eq_u32 vcc, -1, v31
  v_mfma_f32_16x16x32_bf16 v[36:39], v[120:123], v[68:71], v[36:39]
  v_mfma_f32_16x16x32_bf16 v[40:43], v[136:139], v[68:71], v[40:43]
  s_cbranch_vccz FL_x_0_ok0
  s_branch FL_x_0_x0
FL_x_02_c0:
  v_max3_u32 v31, v64, v65, v66
  v_max_u32 v31, v31, v67
  v_cmp_eq_u32 vcc, -1, v31
  s_cbranch_vccz FL_x_02_ok0
FL_x_02_x0:
  s_mov_b64 exec, vcc
  buffer_load_dwordx4 v[64:67], v9, s[4:7], s41 offen offset:0 sc1
  s_mov_b64 exec, -1
FL_x_02_c2:
  v_max3_u32 v31, v72, v73, v74
  v_max_u32 v31, v31, v75
  v_cmp_eq_u32 vcc, -1, v31
  s_cbranch_vccz FL_x_02_ok2
FL_x_02_x2:
  s_mov_b64 exec, vcc
  buffer_load_dwordx4 v[72:75], v9, s[4:7], s41 offen offset:2048 sc1
  s_mov_b64 exec, -1
  s_add_u32 s46, s46, 1
  s_cmp_ge_u32 s46, 131072
  s_cbranch_scc1 FL_rec_abort
  s_waitcnt vmcnt(4)
  s_branch FL_x_02_c0
FL_x_02_ok0:
  v_mfma_f32_16x16x32_bf16 v[44:47], v[64:67], v[64:67], v[44:47]
  v_max3_u32 v31, v72, v73, v74
  v_max_u32 v31, v31, v75
  v_cmp_eq_u32 vcc, -1, v31
  v_mfma_f32_16x16x32_bf16 v[36:39], v[116:119], v[64:67], v[36:39]
  v_mfma_f32_16x16x32_bf16 v[40:43], v[132:135], v[64:67], v[40:43]
  s_cbranch_vccz FL_x_2_ok2
  s_branch FL_x_2_x2
FL_x_02_ok2:
  v_mfma_f32_16x16x32_bf16 v[44:47], v[72:75], v[72:75], v[44:47]
  v_max3_u32 v31, v64, v65, v66
  v_max_u32 v31, v31, v67
  v_cmp_eq_u32 vcc, -1, v31
  v_mfma_f32_16x16x32_bf16 v[36:39], v[124:127], v[72:75], v[36:39]
  v_mfma_f32_16x16x32_bf16 v[40:43], v[140:143], v[72:75], v[40:43]
  s_cbranch_vccz FL_x_0_ok0
  s_branch FL_x_0_x0
FL_x_03_c0:
  v_max3_u32 v31, v64, v65, v66
  v_max_u32 v31, v31, v67
  v_cmp_eq_u32 vcc, -1, v31
  s_cbranch_vccz FL_x_03_ok0
FL_x_03_x0:
  s_mov_b64 exec, vcc
  buffer_load_dwordx4 v[64:67], v9, s[4:7], s41 offen offset:0 sc1
  s_mov_b64 exec, -1
FL_x_03_c3:
  v_max3_u32 v31, v76, v77, v78
  v_max_u32 v31, v31, v79
  v_cmp_eq_u32 vcc, -1, v31
  s_cbranch_vccz FL_x_03_ok3
FL_x_03_x3:
  s_mov_b64 exec, vcc
  buffer_load_dwordx4 v[76:79], v9, s[4:7], s41 offen offset:3072 sc1
  s_mov_b64 exec, -1
  s_add_u32 s46, s46, 1
  s_cmp_ge_u32 s46, 131072
  s_cbranch_scc1 FL_rec_abort
  s_waitcnt vmcnt(4)
  s_branch FL_x_03_c0
FL_x_03_ok0:
  v_mfma_f32_16x16x32_bf16 v[44:47], v[64:67], v[64:67], v[44:47]
  v_max3_u32 v31, v76, v77, v78
  v_max_u32 v31, v31, v79
  v_cmp_eq_u32 vcc, -1, v31
  v_mfma_f32_16x16x32_bf16 v[36:39], v[116:119], v[64:67], v[36:39]
  v_mfma_f32_16x16x32_bf16 v[40:43], v[132:135], v[64:67], v[40:43]
  s_cbranch_vccz FL_x_3_ok3
  s_branch FL_x_3_x3
FL_x_03_ok3:
  v_mfma_f32_16x16x32_bf16 v[44:47], v[76:79], v[76:79], v[44:47]
  v_max3_u32 v31, v64, v65, v66
  v_max_u32 v31, v31, v67
  v_cmp_eq_u32 vcc, -1, v31
  v_mfma_f32_16x16x32_bf16 v[36:39], v[128:131], v[76:79], v[36:39]
  v_mfma_f32_16x16x32_bf16 v[40:43], v[144:147], v[76:79], v[40:43]
  s_cbranch_vccz FL_x_0_ok0
  s_branch FL_x_0_x0
FL_x_12_c1:
  v_max3_u32 v31, v68, v69, v70
  v_max_u32 v31, v31, v71
  v_cmp_eq_u32 vcc, -1, v31
  s_cbranch_vccz FL_x_12_ok1
FL_x_12_x1:
  s_mov_b64 exec, vcc
  buffer_load_dwordx4 v[68:71], v9, s[4:7], s41 offen offset:1024 sc1
  s_mov_b64 exec, -1
FL_x_12_c2:
  v_max3_u32 v31, v72, v73, v74
  v_max_u32 v31, v31, v75
  v_cmp_eq_u32 vcc, -1, v31
  s_cbranch_vccz FL_x_12_ok2
FL_x_12_x2:
  s_mov_b64 exec, vcc
  buffer_load_dwordx4 v[72:75], v9, s[4:7], s41 offen offset:2048 sc1
  s_mov_b64 exec, -1
  s_add_u32 s46, s46, 1
  s_cmp_ge_u32 s46, 131072
  s_cbranch_scc1 FL_rec_abort
  s_waitcnt vmcnt(4)
  s_branch FL_x_12_c1
FL_x_12_ok1:
  v_mfma_f32_16x16x32_bf16 v[44:47], v[68:71], v[68:71], v[44:47]
  v_max3_u32 v31, v72, v73, v74
  v_max_u32 v31, v31, v75
  v_cmp_eq_u32 vcc, -1, v31
  v_mfma_f32_16x16x32_bf16 v[36:39], v[120:123], v[68:71], v[36:39]
  v_mfma_f32_16x16x32_bf16 v[40:43], v[136:139], v[68:71], v[40:43]
  s_cbranch_vccz FL_x_2_ok2
  s_branch FL_x_2_x2
FL_x_12_ok2:
  v_mfma_f32_16x16x32_bf16 v[44:47], v[72:75], v[72:75], v[44:47]
  v_max3_u32 v31, v68, v69, v70
  v_max_u32 v31, v31, v71
  v_cmp_eq_u32 vcc, -1, v31
  v_mfma_f32_16x16x32_bf16 v[36:39], v[124:127], v[72:75], v[36:39]
  v_mfma_f32_16x16x32_bf16 v[40:43], v[140:143], v[72:75], v[40:43]
  s_cbranch_vccz FL_x_1_ok1
  s_branch FL_x_1_x1
FL_x_13_c1:
  v_max3_u32 v31, v68, v69, v70
  v_max_u32 v31, v31, v71
  v_cmp_eq_u32 vcc, -1, v31
  s_cbranch_vccz FL_x_13_ok1
FL_x_13_x1:
  s_mov_b64 exec, vcc
  buffer_load_dwordx4 v[68:71], v9, s[4:7], s41 offen offset:1024 sc1
  s_mov_b64 exec, -1
FL_x_13_c3:
  v_max3_u32 v31, v76, v77, v78
  v_max_u32 v31, v31, v79
  v_cmp_eq_u32 vcc, -1, v31
  s_cbranch_vccz FL_x_13_ok3
FL_x_13_x3:
  s_mov_b64 exec, vcc
  buffer_load_dwordx4 v[76:79], v9, s[4:7], s41 offen offset:3072 sc1
  s_mov_b64 exec, -1
  s_add_u32 s46, s46, 1
  s_cmp_ge_u32 s46, 131072
  s_cbranch_scc1 FL_rec_abort
  s_waitcnt vmcnt(4)
  s_branch FL_x_13_c1
FL_x_13_ok1:
  v_mfma_f32_16x16x32_bf16 v[44:47], v[68:71], v[68:71], v[44:47]
  v_max3_u32 v31, v76, v77, v78
  v_max_u32 v31, v31, v79
  v_cmp_eq_u32 vcc, -1, v31
  v_mfma_f32_16x16x32_bf16 v[36:39], v[120:123], v[68:71], v[36:39]
  v_mfma_f32_16x16x32_bf16 v[40:43], v[136:139], v[68:71], v[40:43]
  s_cbranch_vccz FL_x_3_ok3
  s_branch FL_x_3_x3
FL_x_13_ok3:
  v_mfma_f32_16x16x32_bf16 v[44:47], v[76:79], v[76:79], v[44:47]
  v_max3_u32 v31, v68, v69, v70
  v_max_u32 v31, v31, v71
  v_cmp_eq_u32 vcc, -1, v31
  v_mfma_f32_16x16x32_bf16 v[36:39], v[128:131], v[76:79], v[36:39]
  v_mfma_f32_16x16x32_bf16 v[40:43], v[144:147], v[76:79], v[40:43]
  s_cbranch_vccz FL_x_1_ok1
  s_branch FL_x_1_x1
FL_x_23_c2:
  v_max3_u32 v31, v72, v73, v74
  v_max_u32 v31, v31, v75
  v_cmp_eq_u32 vcc, -1, v31
  s_cbranch_vccz FL_x_23_ok2
FL_x_23_x2:
  s_mov_b64 exec, vcc
  buffer_load_dwordx4 v[72:75], v9, s[4:7], s41 offen offset:2048 sc1
  s_mov_b64 exec, -1
FL_x_23_c3:
  v_max3_u32 v31, v76, v77, v78
  v_max_u32 v31, v31, v79
  v_cmp_eq_u32 vcc, -1, v31
  s_cbranch_vccz FL_x_23_ok3
FL_x_23_x3:
  s_mov_b64 exec, vcc
  buffer_load_dwordx4 v[76:79], v9, s[4:7], s41 offen offset:3072 sc1
  s_mov_b64 exec, -1
  s_add_u32 s46, s46, 1
  s_cmp_ge_u32 s46, 131072
  s_cbranch_scc1 FL_rec_abort
  s_waitcnt vmcnt(4)
  s_branch FL_x_23_c2
FL_x_23_ok2:
  v_mfma_f32_16x16x32_bf16 v[44:47], v[72:75], v[72:75], v[44:47]
  v_max3_u32 v31, v76, v77, v78
  v_max_u32 v31, v31, v79
  v_cmp_eq_u32 vcc, -1, v31
  v_mfma_f32_16x16x32_bf16 v[36:39], v[124:127], v[72:75], v[36:39]
  v_mfma_f32_16x16x32_bf16 v[40:43], v[140:143], v[72:75], v[40:43]
  s_cbranch_vccz FL_x_3_ok3
  s_branch FL_x_3_x3
FL_x_23_ok3:
  v_mfma_f32_16x16x32_bf16 v[44:47], v[76:79], v[76:79], v[44:47]
  v_max3_u32 v31, v72, v73, v74
  v_max_u32 v31, v31, v75
  v_cmp_eq_u32 vcc, -1, v31
  v_mfma_f32_16x16x32_bf16 v[36:39], v[128:131], v[76:79], v[36:39]
  v_mfma_f32_16x16x32_bf16 v[40:43], v[144:147], v[76:79], v[40:43]
  s_cbranch_vccz FL_x_2_ok2
  s_branch FL_x_2_x2
FL_x_012_c0:
  v_max3_u32 v31, v64, v65, v66
  v_max_u32 v31, v31, v67
  v_cmp_eq_u32 vcc, -1, v31
  s_cbranch_vccz FL_x_012_ok0
FL_x_012_x0:
  s_mov_b64 exec, vcc
  buffer_load_dwordx4 v[64:67], v9, s[4:7], s41 offen offset:0 sc1
  s_mov_b64 exec, -1
FL_x_012_c1:
  v_max3_u32 v31, v68, v69, v70
  v_max_u32 v31, v31, v71
  v_cmp_eq_u32 vcc, -1, v31
  s_cbranch_vccz FL_x_012_ok1
FL_x_012_x1:
  s_mov_b64 exec, vcc
  buffer_load_dwordx4 v[68:71], v9, s[4:7], s41 offen offset:1024 sc1
  s_mov_b64 exec, -1
FL_x_012_c2:
  v_max3_u32 v31, v72, v73, v74
  v_max_u32 v31, v31, v75
  v_cmp_eq_u32 vcc, -1, v31
  s_cbranch_vccz FL_x_012_ok2
FL_x_012_x2:
  s_mov_b64 exec, vcc
  buffer_load_dwordx4 v[72:75], v9, s[4:7], s41 offen offset:2048 sc1
  s_mov_b64 exec, -1
  s_add_u32 s46, s46, 1
  s_cmp_ge_u32 s46, 131072
  s_cbranch_scc1 FL_rec_abort
  s_waitcnt vmcnt(4)
  s_branch FL_x_012_c0
FL_x_012_ok0:
  v_mfma_f32_16x16x32_bf16 v[44:47], v[64:67], v[64:67], v[44:47]
  v_max3_u32 v31, v68, v69, v70
  v_max_u32 v31, v31, v71
  v_cmp_eq_u32 vcc, -1, v31
  v_mfma_f32_16x16x32_bf16 v[36:39], v[116:119], v[64:67], v[36:39]
  v_mfma_f32_16x16x32_bf16 v[40:43], v[132:135], v[64:67], v[40:43]
  s_cbranch_vccz FL_x_12_ok1
  s_branch FL_x_12_x1
FL_x_012_ok1:
  v_mfma_f32_16x16x32_bf16 v[44:47], v[68:71], v[68:71], v[44:47]
  v_max3_u32 v31, v72, v73, v74
  v_max_u32 v31, v31, v75
  v_cmp_eq_u32 vcc, -1, v31
  v_mfma_f32_16x16x32_bf16 v[36:39], v[120:123], v[68:71], v[36:39]
  v_mfma_f32_16x16x32_bf16 v[40:43], v[136:139], v[68:71], v[40:43]
  s_cbranch_vccz FL_x_02_ok2
  s_branch FL_x_02_x2
FL_x_012_ok2:
  v_mfma_f32_16x16x32_bf16 v[44:47], v[72:75], v[72:75], v[44:47]
  v_max3_u32 v31, v64, v65, v66
  v_max_u32 v31, v31, v67
  v_cmp_eq_u32 vcc, -1, v31
  v_mfma_f32_16x16x32_bf16 v[36:39], v[124:127], v[72:75], v[36:39]
  v_mfma_f32_16x16x32_bf16 v[40:43], v[140:143], v[72:75], v[40:43]
  s_cbranch_vccz FL_x_01_ok0
  s_branch FL_x_01_x0
FL_x_013_c0:
  v_max3_u32 v31, v64, v65, v66
  v_max_u32 v31, v31, v67
  v_cmp_eq_u32 vcc, -1, v31
  s_cbranch_vccz FL_x_013_ok0
FL_x_013_x0:
  s_mov_b64 exec, vcc
  buffer_load_dwordx4 v[64:67], v9, s[4:7], s41 offen offset:0 sc1
  s_mov_b64 exec, -1
FL_x_013_c1:
  v_max3_u32 v31, v68, v69, v70
  v_max_u32 v31, v31, v71
  v_cmp_eq_u32 vcc, -1, v31
  s_cbranch_vccz FL_x_013_ok1
FL_x_013_x1:
  s_mov_b64 exec, vcc
  buffer_load_dwordx4 v[68:71], v9, s[4:7], s41 offen offset:1024 sc1
  s_mov_b64 exec, -1
FL_x_013_c3:
  v_max3_u32 v31, v76, v77, v78
  v_max_u32 v31, v31, v79
  v_cmp_eq_u32 vcc, -1, v31
  s_cbranch_vccz FL_x_013_ok3
FL_x_013_x3:
  s_mov_b64 exec, vcc
  buffer_load_dwordx4 v[76:79], v9, s[4:7], s41 offen offset:3072 sc1
  s_mov_b64 exec, -1
  s_add_u32 s46, s46, 1
  s_cmp_ge_u32 s46, 131072
  s_cbranch_scc1 FL_rec_abort
  s_waitcnt vmcnt(4)
  s_branch FL_x_013_c0
FL_x_013_ok0:
  v_mfma_f32_16x16x32_bf16 v[44:47], v[64:67], v[64:67], v[44:47]
  v_max3_u32 v31, v68, v69, v70
  v_max_u32 v31, v31, v71
  v_cmp_eq_u32 vcc, -1, v31
  v_mfma_f32_16x16x32_bf16 v[36:39], v[116:119], v[64:67], v[36:39]
  v_mfma_f32_16x16x32_bf16 v[40:43], v[132:135], v[64:67], v[40:43]
  s_cbranch_vccz FL_x_13_ok1
  s_branch FL_x_13_x1
FL_x_013_ok1:
  v_mfma_f32_16x16x32_bf16 v[44:47], v[68:71], v[68:71], v[44:47]
  v_max3_u32 v31, v76, v77, v78
  v_max_u32 v31, v31, v79
  v_cmp_eq_u32 vcc, -1, v31
  v_mfma_f32_16x16x32_bf16 v[36:39], v[120:123], v[68:71], v[36:39]
  v_mfma_f32_16x16x32_bf16 v[40:43], v[136:139], v[68:71], v[40:43]
  s_cbranch_vccz FL_x_03_ok3
  s_branch FL_x_03_x3
FL_x_013_ok3:
  v_mfma_f32_16x16x32_bf16 v[44:47], v[76:79], v[76:79], v[44:47]
  v_max3_u32 v31, v64, v65, v66
  v_max_u32 v31, v31, v67
  v_cmp_eq_u32 vcc, -1, v31
  v_mfma_f32_16x16x32_bf16 v[36:39], v[128:131], v[76:79], v[36:39]
  v_mfma_f32_16x16x32_bf16 v[40:43], v[144:147], v[76:79], v[40:43]
  s_cbranch_vccz FL_x_01_ok0
  s_branch FL_x_01_x0
FL_x_023_c0:
  v_max3_u32 v31, v64, v65, v66
  v_max_u32 v31, v31, v67
  v_cmp_eq_u32 vcc, -1, v31
  s_cbranch_vccz FL_x_023_ok0
FL_x_023_x0:
  s_mov_b64 exec, vcc
  buffer_load_dwordx4 v[64:67], v9, s[4:7], s41 offen offset:0 sc1
  s_mov_b64 exec, -1
FL_x_023_c2:
  v_max3_u32 v31, v72, v73, v74
  v_max_u32 v31, v31, v75
  v_cmp_eq_u32 vcc, -1, v31
  s_cbranch_vccz FL_x_023_ok2
FL_x_023_x2:
  s_mov_b64 exec, vcc
  buffer_load_dwordx4 v[72:75], v9, s[4:7], s41 offen offset:2048 sc1
  s_mov_b64 exec, -1
FL_x_023_c3:
  v_max3_u32 v31, v76, v77, v78
  v_max_u32 v31, v31, v79
  v_cmp_eq_u32 vcc, -1, v31
  s_cbranch_vccz FL_x_023_ok3
FL_x_023_x3:
  s_mov_b64 exec, vcc
  buffer_load_dwordx4 v[76:79], v9, s[4:7], s41 offen offset:3072 sc1
  s_mov_b64 exec, -1
  s_add_u32 s46, s46, 1
  s_cmp_ge_u32 s46, 131072
  s_cbranch_scc1 FL_rec_abort
  s_waitcnt vmcnt(4)
  s_branch FL_x_023_c0
FL_x_023_ok0:
  v_mfma_f32_16x16x32_bf16 v[44:47], v[64:67], v[64:67], v[44:47]
  v_max3_u32 v31, v72, v73, v74
  v_max_u32 v31, v31, v75
  v_cmp_eq_u32 vcc, -1, v31
  v_mfma_f32_16x16x32_bf16 v[36:39], v[116:119], v[64:67], v[36:39]
  v_mfma_f32_16x16x32_bf16 v[40:43], v[132:135], v[64:67], v[40:43]
  s_cbranch_vccz FL_x_23_ok2
  s_branch FL_x_23_x2
FL_x_023_ok2:
  v_mfma_f32_16x16x32_bf16 v[44:47], v[72:75], v[72:75], v[44:47]
  v_max3_u32 v31, v76, v77, v78
  v_max_u32 v31, v31, v79
  v_cmp_eq_u32 vcc, -1, v31
  v_mfma_f32_16x16x32_bf16 v[36:39], v[124:127], v[72:75], v[36:39]
  v_mfma_f32_16x16x32_bf16 v[40:43], v[140:143], v[72:75], v[40:43]
  s_cbranch_vccz FL_x_03_ok3
  s_branch FL_x_03_x3
FL_x_023_ok3:
  v_mfma_f32_16x16x32_bf16 v[44:47], v[76:79], v[76:79], v[44:47]
  v_max3_u32 v31, v64, v65, v66
  v_max_u32 v31, v31, v67
  v_cmp_eq_u32 vcc, -1, v31
  v_mfma_f32_16x16x32_bf16 v[36:39], v[128:131], v[76:79], v[36:39]
  v_mfma_f32_16x16x32_bf16 v[40:43], v[144:147], v[76:79], v[40:43]
  s_cbranch_vccz FL_x_02_ok0
  s_branch FL_x_02_x0
FL_x_123_c1:
  v_max3_u32 v31, v68, v69, v70
  v_max_u32 v31, v31, v71
  v_cmp_eq_u32 vcc, -1, v31
  s_cbranch_vccz FL_x_123_ok1
FL_x_123_x1:
  s_mov_b64 exec, vcc
  buffer_load_dwordx4 v[68:71], v9, s[4:7], s41 offen offset:1024 sc1
  s_mov_b64 exec, -1
FL_x_123_c2:
  v_max3_u32 v31, v72, v73, v74
  v_max_u32 v31, v31, v75
  v_cmp_eq_u32 vcc, -1, v31
  s_cbranch_vccz FL_x_123_ok2
FL_x_123_x2:
  s_mov_b64 exec, vcc
  buffer_load_dwordx4 v[72:75], v9, s[4:7], s41 offen offset:2048 sc1
  s_mov_b64 exec, -1
FL_x_123_c3:
  v_max3_u32 v31, v76, v77, v78
  v_max_u32 v31, v31, v79
  v_cmp_eq_u32 vcc, -1, v31
  s_cbranch_vccz FL_x_123_ok3
FL_x_123_x3:
  s_mov_b64 exec, vcc
  buffer_load_dwordx4 v[76:79], v9, s[4:7], s41 offen offset:3072 sc1
  s_mov_b64 exec, -1
  s_add_u32 s46, s46, 1
  s_cmp_ge_u32 s46, 131072
  s_cbranch_scc1 FL_rec_abort
  s_waitcnt vmcnt(4)
  s_branch FL_x_123_c1
FL_x_123_ok1:
  v_mfma_f32_16x16x32_bf16 v[44:47], v[68:71], v[68:71], v[44:47]
  v_max3_u32 v31, v72, v73, v74
  v_max_u32 v31, v31, v75
  v_cmp_eq_u32 vcc, -1, v31
  v_mfma_f32_16x16x32_bf16 v[36:39], v[120:123], v[68:71], v[36:39]
  v_mfma_f32_16x16x32_bf16 v[40:43], v[136:139], v[68:71], v[40:43]
  s_cbranch_vccz FL_x_23_ok2
  s_branch FL_x_23_x2
FL_x_123_ok2:
  v_mfma_f32_16x16x32_bf16 v[44:47], v[72:75], v[72:75], v[44:47]
  v_max3_u32 v31, v76, v77, v78
  v_max_u32 v31, v31, v79
  v_cmp_eq_u32 vcc, -1, v31
  v_mfma_f32_16x16x32_bf16 v[36:39], v[124:127], v[72:75], v[36:39]
  v_mfma_f32_16x16x32_bf16 v[40:43], v[140:143], v[72:75], v[40:43]
  s_cbranch_vccz FL_x_13_ok3
  s_branch FL_x_13_x3
FL_x_123_ok3:
  v_mfma_f32_16x16x32_bf16 v[44:47], v[76:79], v[76:79], v[44:47]
  v_max3_u32 v31, v68, v69, v70
  v_max_u32 v31, v31, v71
  v_cmp_eq_u32 vcc, -1, v31
  v_mfma_f32_16x16x32_bf16 v[36:39], v[128:131], v[76:79], v[36:39]
  v_mfma_f32_16x16x32_bf16 v[40:43], v[144:147], v[76:79], v[40:43]
  s_cbranch_vccz FL_x_12_ok1
  s_branch FL_x_12_x1
FL_x_0123_c0:
  v_max3_u32 v31, v64, v65, v66
  v_max_u32 v31, v31, v67
  v_cmp_eq_u32 vcc, -1, v31
  s_cbranch_vccz FL_x_0123_ok0
FL_x_0123_x0:
  s_mov_b64 exec, vcc
  buffer_load_dwordx4 v[64:67], v9, s[4:7], s41 offen offset:0 sc1
  s_mov_b64 exec, -1
FL_x_0123_c1:
  v_max3_u32 v31, v68, v69, v70
  v_max_u32 v31, v31, v71
  v_cmp_eq_u32 vcc, -1, v31
  s_cbranch_vccz FL_x_0123_ok1
FL_x_0123_x1:
  s_mov_b64 exec, vcc
  buffer_load_dwordx4 v[68:71], v9, s[4:7], s41 offen offset:1024 sc1
  s_mov_b64 exec, -1
FL_x_0123_c2:
  v_max3_u32 v31, v72, v73, v74
  v_max_u32 v31, v31, v75
  v_cmp_eq_u32 vcc, -1, v31
  s_cbranch_vccz FL_x_0123_ok2
FL_x_0123_x2:
  s_mov_b64 exec, vcc
  buffer_load_dwordx4 v[72:75], v9, s[4:7], s41 offen offset:2048 sc1
  s_mov_b64 exec, -1
FL_x_0123_c3:
  v_max3_u32 v31, v76, v77, v78
  v_max_u32 v31, v31, v79
  v_cmp_eq_u32 vcc, -1, v31
  s_cbranch_vccz FL_x_0123_ok3
FL_x_0123_x3:
  s_mov_b64 exec, vcc
  buffer_load_dwordx4 v[76:79], v9, s[4:7], s41 offen offset:3072 sc1
  s_mov_b64 exec, -1
  s_add_u32 s46, s46, 1
  s_cmp_ge_u32 s46, 131072
  s_cbranch_scc1 FL_rec_abort
  s_waitcnt vmcnt(4)
  s_branch FL_x_0123_c0
FL_x_0123_ok0:
  v_mfma_f32_16x16x32_bf16 v[44:47], v[64:67], v[64:67], v[44:47]
  v_max3_u32 v31, v68, v69, v70
  v_max_u32 v31, v31, v71
  v_cmp_eq_u32 vcc, -1, v31
  v_mfma_f32_16x16x32_bf16 v[36:39], v[116:119], v[64:67], v[36:39]
  v_mfma_f32_16x16x32_bf16 v[40:43], v[132:135], v[64:67], v[40:43]
  s_cbranch_vccz FL_x_123_ok1
  s_branch FL_x_123_x1
FL_x_0123_ok1:
  v_mfma_f32_16x16x32_bf16 v[44:47], v[68:71], v[68:71], v[44:47]
  v_max3_u32 v31, v72, v73, v74
  v_max_u32 v31, v31, v75
  v_cmp_eq_u32 vcc, -1, v31
  v_mfma_f32_16x16x32_bf16 v[36:39], v[120:123], v[68:71], v[36:39]
  v_mfma_f32_16x16x32_bf16 v[40:43], v[136:139], v[68:71], v[40:43]
  s_cbranch_vccz FL_x_023_ok2
  s_branch FL_x_023_x2
FL_x_0123_ok2:
  v_mfma_f32_16x16x32_bf16 v[44:47], v[72:75], v[72:75], v[44:47]
  v_max3_u32 v31, v76, v77, v78
  v_max_u32 v31, v31, v79
  v_cmp_eq_u32 vcc, -1, v31
  v_mfma_f32_16x16x32_bf16 v[36:39], v[124:127], v[72:75], v[36:39]
  v_mfma_f32_16x16x32_bf16 v[40:43], v[140:143], v[72:75], v[40:43]
  s_cbranch_vccz FL_x_013_ok3
  s_branch FL_x_013_x3
FL_x_0123_ok3:
  v_mfma_f32_16x16x32_bf16 v[44:47], v[76:79], v[76:79], v[44:47]
  v_max3_u32 v31, v64, v65, v66
  v_max_u32 v31, v31, v67
  v_cmp_eq_u32 vcc, -1, v31
  v_mfma_f32_16x16x32_bf16 v[36:39], v[128:131], v[76:79], v[36:39]
  v_mfma_f32_16x16x32_bf16 v[40:43], v[144:147], v[76:79], v[40:43]
  s_cbranch_vccz FL_x_012_ok0
  s_branch FL_x_012_x0
FL_v_f:
  buffer_load_dwordx4 v[88:91], v10, s[4:7], s41 offen offset:0 sc1
  buffer_load_dwordx4 v[92:95], v10, s[4:7], s41 offen offset:1024 sc1
  s_add_u32 s46, s46, 1
  s_cmp_ge_u32 s46, 131072
  s_cbranch_scc1 FL_rec_abort
  s_waitcnt vmcnt(0)
  v_max3_u32 v31, v88, v89, v90
  v_max3_u32 v31, v31, v91, v92
  v_max3_u32 v31, v31, v93, v94
  v_max_u32 v31, v31, v95
  v_cmp_eq_u32 vcc, -1, v31
  s_cbranch_vccnz FL_v_f
  s_branch FL_v_ok
FL_rec_abort:
  s_waitcnt vmcnt(0)
  s_endpgm
L_recslow:
  s_load_dwordx4 s[80:83], s[0:1], 8
  s_load_dwordx4 s[84:87], s[0:1], 24
  s_load_dwordx2 s[88:89], s[0:1], 40
  v_lshrrev_b32 v31, 6, v0
  s_nop 0
  v_readfirstlane_b32 s32, v31
  v_and_b32 v0, 63, v0
  s_lshr_b32 s35, s34, 4
  s_lshl_b32 s90, s33, 1
  s_add_u32 s35, s35, s90
  s_and_b32 s36, s34, 15
  s_lshr_b32 s37, s36, 2
  s_lshl_b32 s90, s35, 2
  s_add_u32 s37, s37, s90
  s_and_b32 s38, s36, 3
  s_waitcnt lgkmcnt(0)
  s_mov_b32 s24, s80
  s_and_b32 s25, s81, 0xffff
  s_mov_b32 s26, 0x4000
  s_mov_b32 s27, 0x20000
  s_mov_b32 s8, s82
  s_and_b32 s9, s83, 0xffff
  s_mov_b32 s10, 0x800000
  s_mov_b32 s11, 0x20000
  s_mov_b32 s12, s84
  s_and_b32 s13, s85, 0xffff
  s_mov_b32 s14, 0x800000
  s_mov_b32 s15, 0x20000
  s_mov_b32 s16, s86
  s_and_b32 s17, s87, 0xffff
  s_mov_b32 s18, 0x800000
  s_mov_b32 s19, 0x20000
  s_mov_b32 s20, s88
  s_and_b32 s21, s89, 0xffff
  s_mov_b32 s22, 0x800000
  s_mov_b32 s23, 0x20000
  s_lshl_b32 s90, s32, 21
  s_lshl_b32 s91, s37, 8
  s_add_u32 s90, s90, s91
  s_lshr_b32 s91, s38, 1
  s_lshl_b32 s91, s91, 7
  s_add_u32 s90, s90, s91
  v_mov_b32 v180, 0x0
  v_bfe_u32 v31, v0, 3, 3
  v_lshl_add_u32 v180, v31, 13, v180
  v_bfe_u32 v31, v0, 0, 3
  v_lshl_add_u32 v180, v31, 4, v180
  v_add_u32 v180, s90, v180
  v_xor_b32 v185, 128, v180
  s_lshl_b32 s90, s35, 2
  s_add_u32 s90, s90, s32
  s_lshl_b32 s90, s90, 18
  s_lshl_b32 s91, s36, 7
  s_add_u32 s90, s90, s91
  v_mov_b32 v181, 0x0
  v_bfe_u32 v31, v0, 3, 3
  v_lshl_add_u32 v181, v31, 11, v181
  v_bfe_u32 v31, v0, 0, 3
  v_lshl_add_u32 v181, v31, 4, v181
  v_add_u32 v181, s90, v181
  s_lshl_b32 s96, s32, 15
  s_and_b32 s91, s38, 1
  s_lshl_b32 s91, s91, 6
  s_add_u32 s91, s91, s96
  v_mov_b32 v182, 0x0
  v_bfe_u32 v31, v0, 5, 1
  v_lshl_add_u32 v182, v31, 11, v182
  v_bfe_u32 v31, v0, 4, 1
  v_lshl_add_u32 v182, v31, 10, v182
  v_bfe_u32 v31, v0, 2, 2
  v_lshl_add_u32 v182, v31, 7, v182
  v_bfe_u32 v31, v0, 0, 2
  v_lshl_add_u32 v182, v31, 3, v182
  v_add_u32 v182, s91, v182
  s_lshl_b32 s91, s32, 5
  v_mov_b32 v183, 0x0
  v_bfe_u32 v31, v0, 4, 1
  v_lshl_add_u32 v183, v31, 13, v183
  v_bfe_u32 v31, v0, 5, 1
  v_lshl_add_u32 v183, v31, 8, v183
  v_bfe_u32 v31, v0, 2, 1
  v_lshl_add_u32 v183, v31, 10, v183
  v_bfe_u32 v31, v0, 3, 1
  v_lshl_add_u32 v183, v31, 7, v183
  v_bfe_u32 v31, v0, 0, 2
  v_lshl_add_u32 v183, v31, 3, v183
  v_add_u32 v183, s91, v183
  v_add_u32 v184, 0x10000, v183
  s_lshl_b32 s97, s34, 2
  s_add_u32 s97, s97, s32
  s_lshl_b32 s98, s97, 14
  s_lshl_b32 s91, s33, 21
  s_add_u32 s98, s98, s91
  s_lshl_b32 s97, s97, 16
  s_lshl_b32 s91, s33, 11
  s_add_u32 s97, s97, s91
  v_mov_b32 v16, 0x0
  v_bfe_u32 v31, v0, 0, 4
  v_lshl_add_u32 v16, v31, 7, v16
  v_bfe_u32 v31, v0, 4, 2
  v_lshl_add_u32 v16, v31, 13, v16
  v_add_u32 v17, 0x8000, v16
  v_lshlrev_b32 v18, 7, v0
  v_add_u32 v19, 0x2000, v18
  s_lshl_b32 s97, s34, 2
  s_add_u32 s97, s97, s32
  s_lshl_b32 s98, s97, 14
  s_lshl_b32 s91, s33, 21
  s_add_u32 s98, s98, s91
  s_lshl_b32 s97, s97, 16
  s_lshl_b32 s91, s33, 11
  s_add_u32 s97, s97, s91
  v_mov_b32 v16, 0x180
  v_bfe_u32 v31, v0, 0, 1
  v_lshl_add_u32 v16, v31, 10, v16
  v_bfe_u32 v31, v0, 1, 3
  v_lshl_add_u32 v16, v31, 13, v16
  v_mov_b32 v17, 0x180
  v_bfe_u32 v31, v0, 0, 4
  v_lshl_add_u32 v17, v31, 10, v17
  s_mov_b64 exec, 0xffff
  buffer_load_dword v201, v16, s[12:15], s97 offen
  buffer_load_dword v202, v16, s[16:19], s97 offen
  buffer_load_dword v200, v16, s[8:11], s97 offen
  buffer_load_dword v203, v17, s[20:23], s98 offen
  s_mov_b64 exec, -1
  s_lshl_b32 s58, s33, 5
  s_add_u32 s58, s58, s34
  s_lshl_b32 s59, s32, 19
  s_add_u32 s59, s59, 0x3800000
  s_lshl_b32 s90, s58, 11
  s_add_u32 s90, s90, s59
  s_mul_i32 s91, s58, 3072
  s_add_u32 s91, s91, s59
  s_add_u32 s91, s91, 0x200000
  v_lshlrev_b32 v6, 4, v0
  v_mov_b32 v8, -1
  v_mov_b32 v12, 0
  v_mov_b32 v9, -1
  v_mov_b32 v13, 0
  v_mov_b32 v10, -1
  v_mov_b32 v14, 0
  v_mov_b32 v11, -1
  v_mov_b32 v15, 0
  buffer_store_dwordx4 v[8:11], v6, s[4:7], s90 offen offset:0 sc1
  buffer_store_dwordx4 v[8:11], v6, s[4:7], s90 offen offset:1024 sc1
  buffer_store_dwordx4 v[8:11], v6, s[4:7], s91 offen offset:0 sc1
  buffer_store_dwordx4 v[8:11], v6, s[4:7], s91 offen offset:1024 sc1
  buffer_store_dwordx4 v[8:11], v6, s[4:7], s91 offen offset:2048 sc1
  s_lshl_b32 s58, s58, 2
  s_add_u32 s58, s58, s32
  s_cmp_ge_u32 s58, 36
  s_cbranch_scc1 SL_nz_1
  s_lshl_b32 s90, s58, 10
  s_add_u32 s90, s90, 0x3d00000
  buffer_store_dwordx4 v[12:15], v6, s[4:7], s90 offen sc1
SL_nz_1:
  s_add_u32 m0, s96, 0
  s_mov_b32 s90, 0x0
  buffer_load_dwordx4 v180, s[12:15], s90 offen  lds
  s_add_u32 m0, s96, 1024
  s_mov_b32 s90, 0x10000
  buffer_load_dwordx4 v180, s[12:15], s90 offen  lds
  s_add_u32 m0, s96, 2048
  s_mov_b32 s90, 0x20000
  buffer_load_dwordx4 v180, s[12:15], s90 offen  lds
  s_add_u32 m0, s96, 3072
  s_mov_b32 s90, 0x30000
  buffer_load_dwordx4 v180, s[12:15], s90 offen  lds
  s_add_u32 m0, s96, 4096
  s_mov_b32 s90, 0x0
  buffer_load_dwordx4 v185, s[16:19], s90 offen  lds
  s_add_u32 m0, s96, 5120
  s_mov_b32 s90, 0x10000
  buffer_load_dwordx4 v185, s[16:19], s90 offen  lds
  s_add_u32 m0, s96, 6144
  s_mov_b32 s90, 0x20000
  buffer_load_dwordx4 v185, s[16:19], s90 offen  lds
  s_add_u32 m0, s96, 7168
  s_mov_b32 s90, 0x30000
  buffer_load_dwordx4 v185, s[16:19], s90 offen  lds
  s_add_u32 m0, s96, 8192
  s_mov_b32 s90, 0x40000
  buffer_load_dwordx4 v180, s[12:15], s90 offen  lds
  s_add_u32 m0, s96, 9216
  s_mov_b32 s90, 0x50000
  buffer_load_dwordx4 v180, s[12:15], s90 offen  lds
  s_add_u32 m0, s96, 10240
  s_mov_b32 s90, 0x60000
  buffer_load_dwordx4 v180, s[12:15], s90 offen  lds
  s_add_u32 m0, s96, 11264
  s_mov_b32 s90, 0x70000
  buffer_load_dwordx4 v180, s[12:15], s90 offen  lds
  s_add_u32 m0, s96, 12288
  s_mov_b32 s90, 0x40000
  buffer_load_dwordx4 v185, s[16:19], s90 offen  lds
  s_add_u32 m0, s96, 13312
  s_mov_b32 s90, 0x50000
  buffer_load_dwordx4 v185, s[16:19], s90 offen  lds
  s_add_u32 m0, s96, 14336
  s_mov_b32 s90, 0x60000
  buffer_load_dwordx4 v185, s[16:19], s90 offen  lds
  s_add_u32 m0, s96, 15360
  s_mov_b32 s90, 0x70000
  buffer_load_dwordx4 v185, s[16:19], s90 offen  lds
  s_add_u32 m0, s96, 16384
  s_mov_b32 s90, 0x80000
  buffer_load_dwordx4 v180, s[12:15], s90 offen  lds
  s_add_u32 m0, s96, 17408
  s_mov_b32 s90, 0x90000
  buffer_load_dwordx4 v180, s[12:15], s90 offen  lds
  s_add_u32 m0, s96, 18432
  s_mov_b32 s90, 0xa0000
  buffer_load_dwordx4 v180, s[12:15], s90 offen  lds
  s_add_u32 m0, s96, 19456
  s_mov_b32 s90, 0xb0000
  buffer_load_dwordx4 v180, s[12:15], s90 offen  lds
  s_add_u32 m0, s96, 20480
  s_mov_b32 s90, 0x80000
  buffer_load_dwordx4 v185, s[16:19], s90 offen  lds
  s_add_u32 m0, s96, 21504
  s_mov_b32 s90, 0x90000
  buffer_load_dwordx4 v185, s[16:19], s90 offen  lds
  s_add_u32 m0, s96, 22528
  s_mov_b32 s90, 0xa0000
  buffer_load_dwordx4 v185, s[16:19], s90 offen  lds
  s_add_u32 m0, s96, 23552
  s_mov_b32 s90, 0xb0000
  buffer_load_dwordx4 v185, s[16:19], s90 offen  lds
  s_add_u32 m0, s96, 24576
  s_mov_b32 s90, 0xc0000
  buffer_load_dwordx4 v180, s[12:15], s90 offen  lds
  s_add_u32 m0, s96, 25600
  s_mov_b32 s90, 0xd0000
  buffer_load_dwordx4 v180, s[12:15], s90 offen  lds
  s_add_u32 m0, s96, 26624
  s_mov_b32 s90, 0xe0000
  buffer_load_dwordx4 v180, s[12:15], s90 offen  lds
  s_add_u32 m0, s96, 27648
  s_mov_b32 s90, 0xf0000
  buffer_load_dwordx4 v180, s[12:15], s90 offen  lds
  s_add_u32 m0, s96, 28672
  s_mov_b32 s90, 0xc0000
  buffer_load_dwordx4 v185, s[16:19], s90 offen  lds
  s_add_u32 m0, s96, 29696
  s_mov_b32 s90, 0xd0000
  buffer_load_dwordx4 v185, s[16:19], s90 offen  lds
  s_add_u32 m0, s96, 30720
  s_mov_b32 s90, 0xe0000
  buffer_load_dwordx4 v185, s[16:19], s90 offen  lds
  s_add_u32 m0, s96, 31744
  s_mov_b32 s90, 0xf0000
  buffer_load_dwordx4 v185, s[16:19], s90 offen  lds
  s_lshl_b32 s90, s34, 2
  s_add_u32 s90, s90, s32
  s_lshr_b32 s91, s90, 3
  s_lshl_b32 s91, s91, 14
  s_and_b32 s92, s90, 7
  s_lshl_b32 s92, s92, 10
  s_add_u32 s91, s91, s92
  v_mov_b32 v1, 0x0
  v_bfe_u32 v31, v0, 0, 6
  v_lshl_add_u32 v1, v31, 4, v1
  v_add_u32 v1, s91, v1
  v_lshrrev_b32 v30, 4, v0
  v_cmp_eq_u32 vcc, s33, v30
  v_xor_b32 v29, 0x2000, v1
  s_nop 0
  v_cndmask_b32 v1, v1, v29, vcc
  s_lshl_b32 s91, s33, 14
  s_lshl_b32 s92, s90, 7
  s_add_u32 s91, s91, s92
  v_mov_b32 v2, 0x200000
  v_bfe_u32 v31, v0, 0, 2
  v_lshl_add_u32 v2, v31, 2, v2
  v_bfe_u32 v31, v0, 2, 1
  v_lshl_add_u32 v2, v31, 6, v2
  v_bfe_u32 v31, v0, 4, 1
  v_lshl_add_u32 v2, v31, 4, v2
  v_bfe_u32 v31, v0, 5, 1
  v_lshl_add_u32 v2, v31, 5, v2
  v_bfe_u32 v31, v0, 3, 1
  v_lshl_add_u32 v2, v31, 31, v2
  v_add_u32 v2, s91, v2
  s_lshr_b32 s92, s90, 1
  s_lshl_b32 s92, s92, 5
  s_and_b32 s91, s90, 1
  s_lshl_b32 s91, s91, 13
  s_add_u32 s92, s92, s91
  v_mov_b32 v30, 0x0
  v_bfe_u32 v31, v0, 2, 1
  v_lshl_add_u32 v30, v31, 12, v30
  v_bfe_u32 v31, v0, 4, 1
  v_lshl_add_u32 v30, v31, 11, v30
  v_bfe_u32 v31, v0, 0, 2
  v_lshl_add_u32 v30, v31, 3, v30
  v_bfe_u32 v31, v0, 5, 1
  v_lshl_add_u32 v30, v31, 2, v30
  v_add_u32 v30, s92, v30
  buffer_load_dword v44, v30, s[24:27], 0 offen
  s_lshl_b32 s91, s33, 14
  s_lshl_b32 s92, s32, 12
  s_add_u32 s91, s91, s92
  v_mov_b32 v3, 0x200000
  v_bfe_u32 v31, v0, 0, 6
  v_lshl_add_u32 v3, v31, 4, v3
  v_add_u32 v3, s91, v3
  s_mul_i32 s91, s32, 3264
  v_mov_b32 v4, 0x0
  v_bfe_u32 v31, v0, 0, 6
  v_lshl_add_u32 v4, v31, 4, v4
  v_add_u32 v4, s91, v4
  s_lshl_b32 s91, s32, 6
  v_mov_b32 v6, 0x0
  v_bfe_u32 v31, v0, 0, 2
  v_lshl_add_u32 v6, v31, 4, v6
  v_bfe_u32 v31, v0, 2, 1
  v_lshl_add_u32 v6, v31, 2, v6
  v_bfe_u32 v31, v0, 3, 1
  s_mov_b32 s99, 1088
  v_mad_u32_u24 v6, v31, s99, v6
  v_bfe_u32 v31, v0, 4, 2
  v_lshl_add_u32 v6, v31, 8, v6
  v_add_u32 v6, s91, v6
  v_add_u32 v240, 3264, v6
  v_add_u32 v241, 6528, v6
  v_add_u32 v242, 9792, v6
  s_lshl_b32 s93, s37, 13
  s_lshl_b32 s91, s38, 10
  s_add_u32 s91, s91, s93
  s_lshl_b32 s92, s32, 8
  s_add_u32 s91, s91, s92
  v_mov_b32 v7, 0x210000
  v_bfe_u32 v31, v0, 0, 6
  v_lshl_add_u32 v7, v31, 2, v7
  v_add_u32 v7, s91, v7
  s_lshl_b32 s91, s37, 11
  s_lshl_b32 s92, s38, 9
  s_add_u32 s59, s91, s92
  s_lshl_b32 s92, s32, 7
  s_add_u32 s91, s59, s92
  v_mov_b32 v19, 0x83000000
  v_bfe_u32 v31, v0, 0, 3
  v_lshl_add_u32 v19, v31, 2, v19
  v_bfe_u32 v31, v0, 4, 2
  v_lshl_add_u32 v19, v31, 5, v19
  v_bfe_u32 v31, v0, 3, 1
  v_lshl_add_u32 v19, v31, 31, v19
  v_add_u32 v19, s91, v19
  s_lshl_b32 s91, s32, 8
  v_mov_b32 v5, 0x880
  v_bfe_u32 v31, v0, 0, 1
  v_lshl_add_u32 v5, v31, 7, v5
  v_bfe_u32 v31, v0, 1, 1
  v_lshl_add_u32 v5, v31, 3, v5
  v_bfe_u32 v31, v0, 2, 3
  v_lshl_add_u32 v5, v31, 4, v5
  v_add_u32 v5, s91, v5
  s_lshr_b32 s92, s38, 1
  s_xor_b32 s92, s92, 1
  s_lshl_b32 s92, s92, 10
  s_add_u32 s91, s91, s92
  s_add_u32 s91, s91, s93
  s_and_b32 s92, s38, 1
  s_lshl_b32 s92, s92, 7
  s_add_u32 s91, s91, s92
  v_mov_b32 v8, 0x211000
  v_bfe_u32 v31, v0, 0, 5
  v_lshl_add_u32 v8, v31, 2, v8
  v_bfe_u32 v31, v0, 5, 1
  v_lshl_add_u32 v8, v31, 31, v8
  v_add_u32 v8, s91, v8
  s_sub_u32 s91, s91, s93
  s_lshl_b32 s92, s37, 11
  s_add_u32 s91, s91, s92
  v_mov_b32 v20, 0x3400000
  v_bfe_u32 v31, v0, 0, 5
  v_lshl_add_u32 v20, v31, 2, v20
  v_bfe_u32 v31, v0, 5, 1
  v_lshl_add_u32 v20, v31, 31, v20
  v_add_u32 v20, s91, v20
  s_lshl_b32 s97, s35, 2
  s_add_u32 s97, s97, s32
  s_lshl_b32 s97, s97, 13
  v_mov_b32 v9, 0x210000
  v_bfe_u32 v31, v0, 0, 6
  v_lshl_add_u32 v9, v31, 4, v9
  v_add_u32 v9, s97, v9
  v_add_u32 v10, 4096, v9
  v_mov_b32 v11, 0x1000000
  v_bfe_u32 v31, v0, 0, 2
  v_lshl_add_u32 v11, v31, 4, v11
  v_bfe_u32 v31, v0, 2, 1
  v_lshl_add_u32 v11, v31, 7, v11
  v_bfe_u32 v31, v0, 3, 1
  v_lshl_add_u32 v11, v31, 12, v11
  v_bfe_u32 v31, v0, 4, 2
  v_lshl_add_u32 v11, v31, 8, v11
  v_add_u32 v11, s97, v11
  v_mov_b32 v12, 0x2000000
  v_bfe_u32 v31, v0, 0, 3
  v_lshl_add_u32 v12, v31, 4, v12
  v_bfe_u32 v31, v0, 3, 1
  v_lshl_add_u32 v12, v31, 11, v12
  v_bfe_u32 v31, v0, 4, 2
  v_lshl_add_u32 v12, v31, 8, v12
  v_add_u32 v12, s97, v12
  v_add_u32 v13, 4096, v12
  s_lshl_b32 s91, s36, 9
  s_add_u32 s91, s91, s97
  s_add_u32 s63, s91, 0x1000000
  v_mov_b32 v21, 0x1000000
  v_bfe_u32 v31, v0, 0, 2
  v_lshl_add_u32 v21, v31, 7, v21
  v_bfe_u32 v31, v0, 2, 1
  v_lshl_add_u32 v21, v31, 24, v21
  v_add_u32 v21, s91, v21
  v_cmp_gt_u32 vcc, 8, v0
  v_mov_b32 v30, 0x80000000
  s_nop 0
  v_cndmask_b32 v21, v30, v21, vcc
  s_lshl_b32 s91, s32, 11
  v_mov_b32 v30, 0x0
  v_bfe_u32 v31, v0, 2, 1
  v_lshl_add_u32 v30, v31, 6, v30
  v_bfe_u32 v31, v0, 0, 1
  v_lshl_add_u32 v30, v31, 5, v30
  v_bfe_u32 v31, v0, 1, 1
  v_lshl_add_u32 v30, v31, 4, v30
  v_mov_b32 v29, 0x0
  v_bfe_u32 v31, v0, 4, 2
  v_lshl_add_u32 v29, v31, 5, v29
  v_xor_b32 v30, v30, v29
  v_mov_b32 v14, 0x3400
  v_bfe_u32 v31, v0, 0, 4
  v_lshl_add_u32 v14, v31, 7, v14
  v_add_u32 v14, s91, v14
  v_add_u32 v14, v14, v30
  v_xor_b32 v15, 16, v14
  v_mov_b32 v30, 0x0
  v_bfe_u32 v31, v0, 5, 1
  v_lshl_add_u32 v30, v31, 6, v30
  v_bfe_u32 v31, v0, 1, 1
  v_lshl_add_u32 v30, v31, 5, v30
  v_bfe_u32 v31, v0, 4, 1
  v_lshl_add_u32 v30, v31, 4, v30
  v_mov_b32 v29, 0x0
  v_bfe_u32 v31, v0, 2, 2
  v_lshl_add_u32 v29, v31, 5, v29
  v_bfe_u32 v31, v0, 0, 1
  v_lshl_add_u32 v29, v31, 4, v29
  v_xor_b32 v30, v30, v29
  v_mov_b32 v16, 0x3400
  v_bfe_u32 v31, v0, 4, 2
  v_lshl_add_u32 v16, v31, 8, v16
  v_bfe_u32 v31, v0, 1, 1
  v_lshl_add_u32 v16, v31, 7, v16
  v_add_u32 v16, v16, v30
  s_lshl_b32 s98, s36, 14
  s_lshl_b32 s92, s35, 7
  s_add_u32 s98, s98, s92
  s_lshl_b32 s92, s32, 11
  s_add_u32 s91, s98, s92
  v_mov_b32 v17, 0x0
  v_bfe_u32 v31, v0, 0, 5
  v_lshl_add_u32 v17, v31, 2, v17
  v_bfe_u32 v31, v0, 5, 1
  v_lshl_add_u32 v17, v31, 10, v17
  v_add_u32 v17, s91, v17
  v_xor_b32 v18, 0x2000, v17
  s_mov_b32 s48, 0x33333333
  s_mov_b32 s49, 0x33333333
  s_mov_b32 s50, 0xffff0000
  s_mov_b32 s51, 0xffff0000
  s_mov_b32 s52, 0x0000ffff
  s_mov_b32 s53, 0x0000ffff
  s_mov_b32 s54, 0xfffffffe
  s_mov_b32 s47, 0x3e0293ee
  v_mov_b32 v30, 0x4444
  v_mov_b32 v31, 0xeeee
  v_cndmask_b32 v23, v31, v30, s[48:49]
  v_mov_b32 v22, -1
  v_mov_b32 v232, 0
  v_mov_b32 v233, 0
  v_mov_b32 v234, 0
  v_mov_b32 v235, 0
  v_mov_b32 v112, 0
  v_mov_b32 v113, 0
  s_mov_b32 s56, 0xf0f0f0f0
  s_mov_b32 s57, 0xf0f0f0f0
  v_mov_b32 v30, 0x3f80
  v_mov_b32 v31, 1.0
  v_cndmask_b32 v30, v30, v31, s[56:57]
  s_mov_b32 s56, 0x110011
  s_mov_b32 s57, 0x110011
  v_cndmask_b32 v24, 0, v30, s[56:57]
  s_mov_b32 s56, 0x220022
  s_mov_b32 s57, 0x220022
  v_cndmask_b32 v25, 0, v30, s[56:57]
  s_mov_b32 s56, 0x11001100
  s_mov_b32 s57, 0x11001100
  v_cndmask_b32 v26, 0, v30, s[56:57]
  s_mov_b32 s56, 0x22002200
  s_mov_b32 s57, 0x22002200
  v_cndmask_b32 v27, 0, v30, s[56:57]
  s_mov_b32 s40, 0
  s_mov_b32 s41, 0x3800000
  s_mov_b32 s43, 0x3900000
  s_mov_b32 s44, 0
  s_mov_b32 s55, 0x40000
  s_mov_b32 s45, 0
  s_waitcnt vmcnt(33)
  s_barrier
  s_cmp_lg_u32 s32, 0
  s_cbranch_scc1 SL_sig_2
  v_mov_b32 v254, 1
  v_mov_b32 v255, 0
  s_mov_b64 exec, 1
  buffer_atomic_add v254, v255, s[28:31], s100 offen offset:132 sc1
  s_mov_b64 exec, -1
SL_sig_2:
  s_mov_b32 s90, 0x3e0000
  buffer_store_dword v22, v19, s[4:7], s90 offen sc1
  buffer_store_dword v22, v20, s[4:7], s90 offen sc1
  s_mov_b32 s90, 0x3f0000
  buffer_store_dword v22, v19, s[4:7], s90 offen sc1
  buffer_store_dword v22, v20, s[4:7], s90 offen sc1
  s_waitcnt vmcnt(28)
  ds_read_b64_tr_b16 a[16:17], v182 offset:0
  ds_read_b64_tr_b16 a[18:19], v182 offset:512
  ds_read_b64_tr_b16 a[24:25], v182 offset:32
  ds_read_b64_tr_b16 a[26:27], v182 offset:544
  s_waitcnt lgkmcnt(0)
  s_add_u32 m0, s96, 0
  s_mov_b32 s90, 0x100000
  buffer_load_dwordx4 v180, s[12:15], s90 offen  lds
  s_add_u32 m0, s96, 1024
  s_mov_b32 s90, 0x110000
  buffer_load_dwordx4 v180, s[12:15], s90 offen  lds
  s_add_u32 m0, s96, 2048
  s_mov_b32 s90, 0x120000
  buffer_load_dwordx4 v180, s[12:15], s90 offen  lds
  s_add_u32 m0, s96, 3072
  s_mov_b32 s90, 0x130000
  buffer_load_dwordx4 v180, s[12:15], s90 offen  lds
  s_waitcnt vmcnt(28)
  ds_read_b64_tr_b16 a[32:33], v182 offset:4096
  ds_read_b64_tr_b16 a[34:35], v182 offset:4608
  ds_read_b64_tr_b16 a[40:41], v182 offset:4128
  ds_read_b64_tr_b16 a[42:43], v182 offset:4640
  s_waitcnt lgkmcnt(0)
  s_add_u32 m0, s96, 4096
  s_mov_b32 s90, 0x100000
  buffer_load_dwordx4 v185, s[16:19], s90 offen  lds
  s_add_u32 m0, s96, 5120
  s_mov_b32 s90, 0x110000
  buffer_load_dwordx4 v185, s[16:19], s90 offen  lds
  s_add_u32 m0, s96, 6144
  s_mov_b32 s90, 0x120000
  buffer_load_dwordx4 v185, s[16:19], s90 offen  lds
  s_add_u32 m0, s96, 7168
  s_mov_b32 s90, 0x130000
  buffer_load_dwordx4 v185, s[16:19], s90 offen  lds
  s_waitcnt vmcnt(28)
  ds_read_b64_tr_b16 a[20:21], v182 offset:8192
  ds_read_b64_tr_b16 a[22:23], v182 offset:8704
  ds_read_b64_tr_b16 a[28:29], v182 offset:8224
  ds_read_b64_tr_b16 a[30:31], v182 offset:8736
  s_waitcnt lgkmcnt(0)
  s_add_u32 m0, s96, 8192
  s_mov_b32 s90, 0x140000
  buffer_load_dwordx4 v180, s[12:15], s90 offen  lds
  s_add_u32 m0, s96, 9216
  s_mov_b32 s90, 0x150000
  buffer_load_dwordx4 v180, s[12:15], s90 offen  lds
  s_add_u32 m0, s96, 10240
  s_mov_b32 s90, 0x160000
  buffer_load_dwordx4 v180, s[12:15], s90 offen  lds
  s_add_u32 m0, s96, 11264
  s_mov_b32 s90, 0x170000
  buffer_load_dwordx4 v180, s[12:15], s90 offen  lds
  s_waitcnt vmcnt(28)
  ds_read_b64_tr_b16 a[36:37], v182 offset:12288
  ds_read_b64_tr_b16 a[38:39], v182 offset:12800
  ds_read_b64_tr_b16 a[44:45], v182 offset:12320
  ds_read_b64_tr_b16 a[46:47], v182 offset:12832
  s_waitcnt lgkmcnt(0)
  s_add_u32 m0, s96, 12288
  s_mov_b32 s90, 0x140000
  buffer_load_dwordx4 v185, s[16:19], s90 offen  lds
  s_add_u32 m0, s96, 13312
  s_mov_b32 s90, 0x150000
  buffer_load_dwordx4 v185, s[16:19], s90 offen  lds
  s_add_u32 m0, s96, 14336
  s_mov_b32 s90, 0x160000
  buffer_load_dwordx4 v185, s[16:19], s90 offen  lds
  s_add_u32 m0, s96, 15360
  s_mov_b32 s90, 0x170000
  buffer_load_dwordx4 v185, s[16:19], s90 offen  lds
  s_waitcnt vmcnt(28)
  ds_read_b64_tr_b16 a[64:65], v182 offset:16384
  ds_read_b64_tr_b16 a[66:67], v182 offset:16896
  ds_read_b64_tr_b16 a[72:73], v182 offset:16416
  ds_read_b64_tr_b16 a[74:75], v182 offset:16928
  s_waitcnt lgkmcnt(0)
  s_add_u32 m0, s96, 16384
  s_mov_b32 s90, 0x180000
  buffer_load_dwordx4 v180, s[12:15], s90 offen  lds
  s_add_u32 m0, s96, 17408
  s_mov_b32 s90, 0x190000
  buffer_load_dwordx4 v180, s[12:15], s90 offen  lds
  s_add_u32 m0, s96, 18432
  s_mov_b32 s90, 0x1a0000
  buffer_load_dwordx4 v180, s[12:15], s90 offen  lds
  s_add_u32 m0, s96, 19456
  s_mov_b32 s90, 0x1b0000
  buffer_load_dwordx4 v180, s[12:15], s90 offen  lds
  s_waitcnt vmcnt(28)
  ds_read_b64_tr_b16 a[80:81], v182 offset:20480
  ds_read_b64_tr_b16 a[82:83], v182 offset:20992
  ds_read_b64_tr_b16 a[88:89], v182 offset:20512
  ds_read_b64_tr_b16 a[90:91], v182 offset:21024
  s_waitcnt lgkmcnt(0)
  s_add_u32 m0, s96, 20480
  s_mov_b32 s90, 0x180000
  buffer_load_dwordx4 v185, s[16:19], s90 offen  lds
  s_add_u32 m0, s96, 21504
  s_mov_b32 s90, 0x190000
  buffer_load_dwordx4 v185, s[16:19], s90 offen  lds
  s_add_u32 m0, s96, 22528
  s_mov_b32 s90, 0x1a0000
  buffer_load_dwordx4 v185, s[16:19], s90 offen  lds
  s_add_u32 m0, s96, 23552
  s_mov_b32 s90, 0x1b0000
  buffer_load_dwordx4 v185, s[16:19], s90 offen  lds
  s_waitcnt vmcnt(28)
  ds_read_b64_tr_b16 a[68:69], v182 offset:24576
  ds_read_b64_tr_b16 a[70:71], v182 offset:25088
  ds_read_b64_tr_b16 a[76:77], v182 offset:24608
  ds_read_b64_tr_b16 a[78:79], v182 offset:25120
  s_waitcnt lgkmcnt(0)
  s_add_u32 m0, s96, 24576
  s_mov_b32 s90, 0x1c0000
  buffer_load_dwordx4 v180, s[12:15], s90 offen  lds
  s_add_u32 m0, s96, 25600
  s_mov_b32 s90, 0x1d0000
  buffer_load_dwordx4 v180, s[12:15], s90 offen  lds
  s_add_u32 m0, s96, 26624
  s_mov_b32 s90, 0x1e0000
  buffer_load_dwordx4 v180, s[12:15], s90 offen  lds
  s_add_u32 m0, s96, 27648
  s_mov_b32 s90, 0x1f0000
  buffer_load_dwordx4 v180, s[12:15], s90 offen  lds
  s_waitcnt vmcnt(28)
  ds_read_b64_tr_b16 a[84:85], v182 offset:28672
  ds_read_b64_tr_b16 a[86:87], v182 offset:29184
  ds_read_b64_tr_b16 a[92:93], v182 offset:28704
  ds_read_b64_tr_b16 a[94:95], v182 offset:29216
  s_waitcnt lgkmcnt(0)
  s_add_u32 m0, s96, 28672
  s_mov_b32 s90, 0x1c0000
  buffer_load_dwordx4 v185, s[16:19], s90 offen  lds
  s_add_u32 m0, s96, 29696
  s_mov_b32 s90, 0x1d0000
  buffer_load_dwordx4 v185, s[16:19], s90 offen  lds
  s_add_u32 m0, s96, 30720
  s_mov_b32 s90, 0x1e0000
  buffer_load_dwordx4 v185, s[16:19], s90 offen  lds
  s_add_u32 m0, s96, 31744
  s_mov_b32 s90, 0x1f0000
  buffer_load_dwordx4 v185, s[16:19], s90 offen  lds
  s_waitcnt vmcnt(28)
  ds_read_b64_tr_b16 a[112:113], v182 offset:0
  ds_read_b64_tr_b16 a[114:115], v182 offset:512
  ds_read_b64_tr_b16 a[120:121], v182 offset:32
  ds_read_b64_tr_b16 a[122:123], v182 offset:544
  s_waitcnt lgkmcnt(0)
  s_add_u32 m0, s96, 0
  s_mov_b32 s90, 0x0
  buffer_load_dwordx4 v180, s[8:11], s90 offen  lds
  s_add_u32 m0, s96, 1024
  s_mov_b32 s90, 0x10000
  buffer_load_dwordx4 v180, s[8:11], s90 offen  lds
  s_add_u32 m0, s96, 2048
  s_mov_b32 s90, 0x20000
  buffer_load_dwordx4 v180, s[8:11], s90 offen  lds
  s_add_u32 m0, s96, 3072
  s_mov_b32 s90, 0x30000
  buffer_load_dwordx4 v180, s[8:11], s90 offen  lds
  s_waitcnt vmcnt(28)
  ds_read_b64_tr_b16 a[128:129], v182 offset:4096
  ds_read_b64_tr_b16 a[130:131], v182 offset:4608
  ds_read_b64_tr_b16 a[136:137], v182 offset:4128
  ds_read_b64_tr_b16 a[138:139], v182 offset:4640
  s_waitcnt lgkmcnt(0)
  s_add_u32 m0, s96, 4096
  s_mov_b32 s90, 0x40000
  buffer_load_dwordx4 v180, s[8:11], s90 offen  lds
  s_add_u32 m0, s96, 5120
  s_mov_b32 s90, 0x50000
  buffer_load_dwordx4 v180, s[8:11], s90 offen  lds
  s_add_u32 m0, s96, 6144
  s_mov_b32 s90, 0x60000
  buffer_load_dwordx4 v180, s[8:11], s90 offen  lds
  s_add_u32 m0, s96, 7168
  s_mov_b32 s90, 0x70000
  buffer_load_dwordx4 v180, s[8:11], s90 offen  lds
  s_waitcnt vmcnt(28)
  ds_read_b64_tr_b16 a[116:117], v182 offset:8192
  ds_read_b64_tr_b16 a[118:119], v182 offset:8704
  ds_read_b64_tr_b16 a[124:125], v182 offset:8224
  ds_read_b64_tr_b16 a[126:127], v182 offset:8736
  s_waitcnt lgkmcnt(0)
  s_add_u32 m0, s96, 8192
  s_mov_b32 s90, 0x80000
  buffer_load_dwordx4 v180, s[8:11], s90 offen  lds
  s_add_u32 m0, s96, 9216
  s_mov_b32 s90, 0x90000
  buffer_load_dwordx4 v180, s[8:11], s90 offen  lds
  s_add_u32 m0, s96, 10240
  s_mov_b32 s90, 0xa0000
  buffer_load_dwordx4 v180, s[8:11], s90 offen  lds
  s_add_u32 m0, s96, 11264
  s_mov_b32 s90, 0xb0000
  buffer_load_dwordx4 v180, s[8:11], s90 offen  lds
  s_waitcnt vmcnt(28)
  ds_read_b64_tr_b16 a[132:133], v182 offset:12288
  ds_read_b64_tr_b16 a[134:135], v182 offset:12800
  ds_read_b64_tr_b16 a[140:141], v182 offset:12320
  ds_read_b64_tr_b16 a[142:143], v182 offset:12832
  s_waitcnt lgkmcnt(0)
  s_add_u32 m0, s96, 12288
  s_mov_b32 s90, 0xc0000
  buffer_load_dwordx4 v180, s[8:11], s90 offen  lds
  s_add_u32 m0, s96, 13312
  s_mov_b32 s90, 0xd0000
  buffer_load_dwordx4 v180, s[8:11], s90 offen  lds
  s_add_u32 m0, s96, 14336
  s_mov_b32 s90, 0xe0000
  buffer_load_dwordx4 v180, s[8:11], s90 offen  lds
  s_add_u32 m0, s96, 15360
  s_mov_b32 s90, 0xf0000
  buffer_load_dwordx4 v180, s[8:11], s90 offen  lds
  s_waitcnt vmcnt(28)
  ds_read_b64_tr_b16 a[160:161], v182 offset:16384
  ds_read_b64_tr_b16 a[162:163], v182 offset:16896
  ds_read_b64_tr_b16 a[168:169], v182 offset:16416
  ds_read_b64_tr_b16 a[170:171], v182 offset:16928
  s_waitcnt lgkmcnt(0)
  s_add_u32 m0, s96, 16384
  s_mov_b32 s90, 0x100000
  buffer_load_dwordx4 v180, s[8:11], s90 offen  lds
  s_add_u32 m0, s96, 17408
  s_mov_b32 s90, 0x110000
  buffer_load_dwordx4 v180, s[8:11], s90 offen  lds
  s_add_u32 m0, s96, 18432
  s_mov_b32 s90, 0x120000
  buffer_load_dwordx4 v180, s[8:11], s90 offen  lds
  s_add_u32 m0, s96, 19456
  s_mov_b32 s90, 0x130000
  buffer_load_dwordx4 v180, s[8:11], s90 offen  lds
  s_waitcnt vmcnt(28)
  ds_read_b64_tr_b16 a[176:177], v182 offset:20480
  ds_read_b64_tr_b16 a[178:179], v182 offset:20992
  ds_read_b64_tr_b16 a[184:185], v182 offset:20512
  ds_read_b64_tr_b16 a[186:187], v182 offset:21024
  s_waitcnt lgkmcnt(0)
  s_add_u32 m0, s96, 20480
  s_mov_b32 s90, 0x140000
  buffer_load_dwordx4 v180, s[8:11], s90 offen  lds
  s_add_u32 m0, s96, 21504
  s_mov_b32 s90, 0x150000
  buffer_load_dwordx4 v180, s[8:11], s90 offen  lds
  s_add_u32 m0, s96, 22528
  s_mov_b32 s90, 0x160000
  buffer_load_dwordx4 v180, s[8:11], s90 offen  lds
  s_add_u32 m0, s96, 23552
  s_mov_b32 s90, 0x170000
  buffer_load_dwordx4 v180, s[8:11], s90 offen  lds
  s_waitcnt vmcnt(28)
  ds_read_b64_tr_b16 a[164:165], v182 offset:24576
  ds_read_b64_tr_b16 a[166:167], v182 offset:25088
  ds_read_b64_tr_b16 a[172:173], v182 offset:24608
  ds_read_b64_tr_b16 a[174:175], v182 offset:25120
  s_waitcnt lgkmcnt(0)
  s_add_u32 m0, s96, 24576
  s_mov_b32 s90, 0x180000
  buffer_load_dwordx4 v180, s[8:11], s90 offen  lds
  s_add_u32 m0, s96, 25600
  s_mov_b32 s90, 0x190000
  buffer_load_dwordx4 v180, s[8:11], s90 offen  lds
  s_add_u32 m0, s96, 26624
  s_mov_b32 s90, 0x1a0000
  buffer_load_dwordx4 v180, s[8:11], s90 offen  lds
  s_add_u32 m0, s96, 27648
  s_mov_b32 s90, 0x1b0000
  buffer_load_dwordx4 v180, s[8:11], s90 offen  lds
  s_waitcnt vmcnt(28)
  ds_read_b64_tr_b16 a[180:181], v182 offset:28672
  ds_read_b64_tr_b16 a[182:183], v182 offset:29184
  ds_read_b64_tr_b16 a[188:189], v182 offset:28704
  ds_read_b64_tr_b16 a[190:191], v182 offset:29216
  s_waitcnt lgkmcnt(0)
  s_add_u32 m0, s96, 28672
  s_mov_b32 s90, 0x1c0000
  buffer_load_dwordx4 v180, s[8:11], s90 offen  lds
  s_add_u32 m0, s96, 29696
  s_mov_b32 s90, 0x1d0000
  buffer_load_dwordx4 v180, s[8:11], s90 offen  lds
  s_add_u32 m0, s96, 30720
  s_mov_b32 s90, 0x1e0000
  buffer_load_dwordx4 v180, s[8:11], s90 offen  lds
  s_add_u32 m0, s96, 31744
  s_mov_b32 s90, 0x1f0000
  buffer_load_dwordx4 v180, s[8:11], s90 offen  lds
  s_waitcnt vmcnt(28)
  ds_read_b64_tr_b16 a[0:1], v182 offset:0
  ds_read_b64_tr_b16 a[2:3], v182 offset:512
  ds_read_b64_tr_b16 a[8:9], v182 offset:32
  ds_read_b64_tr_b16 a[10:11], v182 offset:544
  s_waitcnt lgkmcnt(0)
  s_add_u32 m0, s96, 0
  s_mov_b32 s90, 0x0
  buffer_load_dwordx4 v181, s[20:23], s90 offen  lds
  s_add_u32 m0, s96, 1024
  s_mov_b32 s90, 0x4000
  buffer_load_dwordx4 v181, s[20:23], s90 offen  lds
  s_add_u32 m0, s96, 2048
  s_mov_b32 s90, 0x8000
  buffer_load_dwordx4 v181, s[20:23], s90 offen  lds
  s_add_u32 m0, s96, 3072
  s_mov_b32 s90, 0xc000
  buffer_load_dwordx4 v181, s[20:23], s90 offen  lds
  s_waitcnt vmcnt(28)
  ds_read_b64_tr_b16 a[4:5], v182 offset:4096
  ds_read_b64_tr_b16 a[6:7], v182 offset:4608
  ds_read_b64_tr_b16 a[12:13], v182 offset:4128
  ds_read_b64_tr_b16 a[14:15], v182 offset:4640
  s_waitcnt lgkmcnt(0)
  s_add_u32 m0, s96, 4096
  s_mov_b32 s90, 0x10000
  buffer_load_dwordx4 v181, s[20:23], s90 offen  lds
  s_add_u32 m0, s96, 5120
  s_mov_b32 s90, 0x14000
  buffer_load_dwordx4 v181, s[20:23], s90 offen  lds
  s_add_u32 m0, s96, 6144
  s_mov_b32 s90, 0x18000
  buffer_load_dwordx4 v181, s[20:23], s90 offen  lds
  s_add_u32 m0, s96, 7168
  s_mov_b32 s90, 0x1c000
  buffer_load_dwordx4 v181, s[20:23], s90 offen  lds
  s_waitcnt vmcnt(28)
  ds_read_b64_tr_b16 a[48:49], v182 offset:8192
  ds_read_b64_tr_b16 a[50:51], v182 offset:8704
  ds_read_b64_tr_b16 a[56:57], v182 offset:8224
  ds_read_b64_tr_b16 a[58:59], v182 offset:8736
  s_waitcnt lgkmcnt(0)
  s_add_u32 m0, s96, 8192
  s_mov_b32 s90, 0x20000
  buffer_load_dwordx4 v181, s[20:23], s90 offen  lds
  s_add_u32 m0, s96, 9216
  s_mov_b32 s90, 0x24000
  buffer_load_dwordx4 v181, s[20:23], s90 offen  lds
  s_add_u32 m0, s96, 10240
  s_mov_b32 s90, 0x28000
  buffer_load_dwordx4 v181, s[20:23], s90 offen  lds
  s_add_u32 m0, s96, 11264
  s_mov_b32 s90, 0x2c000
  buffer_load_dwordx4 v181, s[20:23], s90 offen  lds
  s_waitcnt vmcnt(28)
  ds_read_b64_tr_b16 a[52:53], v182 offset:12288
  ds_read_b64_tr_b16 a[54:55], v182 offset:12800
  ds_read_b64_tr_b16 a[60:61], v182 offset:12320
  ds_read_b64_tr_b16 a[62:63], v182 offset:12832
  s_waitcnt lgkmcnt(0)
  s_add_u32 m0, s96, 12288
  s_mov_b32 s90, 0x30000
  buffer_load_dwordx4 v181, s[20:23], s90 offen  lds
  s_add_u32 m0, s96, 13312
  s_mov_b32 s90, 0x34000
  buffer_load_dwordx4 v181, s[20:23], s90 offen  lds
  s_add_u32 m0, s96, 14336
  s_mov_b32 s90, 0x38000
  buffer_load_dwordx4 v181, s[20:23], s90 offen  lds
  s_add_u32 m0, s96, 15360
  s_mov_b32 s90, 0x3c000
  buffer_load_dwordx4 v181, s[20:23], s90 offen  lds
  s_mov_b32 s90, 0x3800000
  buffer_load_dword v204, v2, s[4:7], s90 offen sc1
  buffer_load_dword v204, v7, s[4:7], s90 offen sc1
  buffer_load_dword v204, v8, s[4:7], s90 offen sc1
  s_mov_b32 s90, 0x3880000
  buffer_load_dword v204, v2, s[4:7], s90 offen sc1
  buffer_load_dword v204, v7, s[4:7], s90 offen sc1
  buffer_load_dword v204, v8, s[4:7], s90 offen sc1
  s_mov_b32 s90, 0x3900000
  buffer_load_dword v204, v2, s[4:7], s90 offen sc1
  buffer_load_dword v204, v7, s[4:7], s90 offen sc1
  buffer_load_dword v204, v8, s[4:7], s90 offen sc1
  s_mov_b32 s90, 0x3980000
  buffer_load_dword v204, v2, s[4:7], s90 offen sc1
  buffer_load_dword v204, v7, s[4:7], s90 offen sc1
  buffer_load_dword v204, v8, s[4:7], s90 offen sc1
  s_waitcnt vmcnt(28)
  ds_read_b64_tr_b16 a[96:97], v182 offset:16384
  ds_read_b64_tr_b16 a[98:99], v182 offset:16896
  ds_read_b64_tr_b16 a[104:105], v182 offset:16416
  ds_read_b64_tr_b16 a[106:107], v182 offset:16928
  s_waitcnt vmcnt(24)
  ds_read_b64_tr_b16 a[100:101], v182 offset:20480
  ds_read_b64_tr_b16 a[102:103], v182 offset:20992
  ds_read_b64_tr_b16 a[108:109], v182 offset:20512
  ds_read_b64_tr_b16 a[110:111], v182 offset:21024
  s_waitcnt vmcnt(20)
  ds_read_b64_tr_b16 a[144:145], v182 offset:24576
  ds_read_b64_tr_b16 a[146:147], v182 offset:25088
  ds_read_b64_tr_b16 a[152:153], v182 offset:24608
  ds_read_b64_tr_b16 a[154:155], v182 offset:25120
  s_waitcnt vmcnt(16)
  ds_read_b64_tr_b16 a[148:149], v182 offset:28672
  ds_read_b64_tr_b16 a[150:151], v182 offset:29184
  ds_read_b64_tr_b16 a[156:157], v182 offset:28704
  ds_read_b64_tr_b16 a[158:159], v182 offset:29216
  v_mbcnt_lo_u32_b32 v250, -1, 0
  v_mbcnt_hi_u32_b32 v250, -1, v250
  s_lshl_b32 s90, s32, 9
  s_add_u32 s90, s90, 147520
  v_lshl_add_u32 v251, v250, 3, s90
  ds_write_b64 v251, v[248:249]
  s_waitcnt lgkmcnt(0)
  s_cmp_lg_u32 s32, 0
  s_cbranch_scc1 SL_vd_4
  v_lshlrev_b32 v250, 2, v250
  s_cmp_lg_u32 s100, 0
  s_cbranch_scc1 SL_vw_3
  v_readfirstlane_b32 s90, v247
  s_and_b32 s90, s90, s101
  s_cbranch_scc0 SL_vw_3
  v_mov_b32 v251, 1
  s_mov_b64 exec, 1
  buffer_store_dword v251, v250, s[28:31], 0 offen offset:32 sc1
  s_mov_b64 exec, -1
SL_vw_3:
  buffer_load_dword v251, v250, s[28:31], 0 offen sc1
  s_waitcnt vmcnt(0)
  v_cmp_eq_u32 vcc, -1, v251
  v_readlane_b32 s91, v251, 8
  v_readlane_b32 s92, v251, 32
  v_readlane_b32 s93, v251, 33
  v_readlane_b32 s90, v251, 34
  s_cmp_lg_u32 s100, 0
  s_cselect_b32 s93, s90, s93
  s_cselect_b32 s91, 0, s91
  s_cselect_b32 s92, 1, s92
  s_cselect_b32 s90, 0xff, vcc_lo
  s_cmp_lg_u32 s91, 0
  s_cselect_b32 s92, 3, s92
  s_cbranch_scc1 SL_vk_5
  s_add_u32 s3, s3, 1
  s_cmp_ge_u32 s3, 131072
  s_cselect_b32 s92, 4, s92
  s_cbranch_scc1 SL_vk_5
  s_sleep 8
  s_and_b32 s90, s90, 0xff
  s_cmp_lg_u32 s90, 0xff
  s_cbranch_scc1 SL_vw_3
  s_cmp_lt_u32 s93, 128
  s_cbranch_scc1 SL_vw_3
SL_vk_5:
  v_mov_b32 v251, s92
  v_mov_b32 v250, 147456
  ds_write_b32 v250, v251
  s_waitcnt lgkmcnt(0)
SL_vd_4:
  s_barrier
  v_mov_b32 v250, 147456
  ds_read_b32 v251, v250
  s_waitcnt lgkmcnt(0)
  v_readfirstlane_b32 s92, v251
  s_barrier
  s_cmp_eq_u32 s92, 3
  s_cbranch_scc1 L_fallback
  s_cmp_eq_u32 s92, 4
  s_cbranch_scc1 L_exit
  s_waitcnt vmcnt(0)
  s_barrier
  ds_read_b64_tr_b16 a[192:193], v183 offset:0
  ds_read_b64_tr_b16 a[194:195], v183 offset:2048
  ds_read_b64_tr_b16 a[196:197], v183 offset:512
  ds_read_b64_tr_b16 a[198:199], v183 offset:2560
  ds_read_b64_tr_b16 a[200:201], v183 offset:4096
  ds_read_b64_tr_b16 a[202:203], v183 offset:6144
  ds_read_b64_tr_b16 a[204:205], v183 offset:4608
  ds_read_b64_tr_b16 a[206:207], v183 offset:6656
  s_waitcnt lgkmcnt(0)
  ds_read_b64_tr_b16 a[208:209], v183 offset:32768
  ds_read_b64_tr_b16 a[210:211], v183 offset:34816
  ds_read_b64_tr_b16 a[212:213], v183 offset:33280
  ds_read_b64_tr_b16 a[214:215], v183 offset:35328
  ds_read_b64_tr_b16 a[216:217], v183 offset:36864
  ds_read_b64_tr_b16 a[218:219], v183 offset:38912
  ds_read_b64_tr_b16 a[220:221], v183 offset:37376
  ds_read_b64_tr_b16 a[222:223], v183 offset:39424
  s_waitcnt lgkmcnt(0)
  ds_read_b64_tr_b16 a[224:225], v184 offset:0
  ds_read_b64_tr_b16 a[226:227], v184 offset:2048
  ds_read_b64_tr_b16 a[228:229], v184 offset:512
  ds_read_b64_tr_b16 a[230:231], v184 offset:2560
  ds_read_b64_tr_b16 a[232:233], v184 offset:4096
  ds_read_b64_tr_b16 a[234:235], v184 offset:6144
  ds_read_b64_tr_b16 a[236:237], v184 offset:4608
  ds_read_b64_tr_b16 a[238:239], v184 offset:6656
  s_waitcnt lgkmcnt(0)
  ds_read_b64_tr_b16 a[240:241], v184 offset:32768
  ds_read_b64_tr_b16 a[242:243], v184 offset:34816
  ds_read_b64_tr_b16 a[244:245], v184 offset:33280
  ds_read_b64_tr_b16 a[246:247], v184 offset:35328
  ds_read_b64_tr_b16 a[248:249], v184 offset:36864
  ds_read_b64_tr_b16 a[250:251], v184 offset:38912
  ds_read_b64_tr_b16 a[252:253], v184 offset:37376
  ds_read_b64_tr_b16 a[254:255], v184 offset:39424
  s_waitcnt lgkmcnt(0)
  s_barrier
  s_mov_b32 s46, 0
  s_mov_b32 s39, 0
  v_xor_b32 v1, s39, v1
  v_xor_b32 v17, s39, v17
  v_xor_b32 v18, s39, v18
  s_mov_b32 s12, s63
  s_mov_b32 s90, 0x3800000
  s_mov_b32 s90, 0x3880000
  s_mov_b32 s90, 0x3900000
  s_mov_b32 s90, 0x3980000
  v_mov_b32 v248, 0x3f803f80
  v_mov_b32 v249, 0x3f803f80
  v_mov_b32 v250, 0x3f803f80
  v_mov_b32 v251, 0x3f803f80
  v_mov_b32 v252, 0x3f803f80
  v_mov_b32 v253, 0x3f803f80
  v_mov_b32 v254, 0x3f803f80
  v_mov_b32 v255, 0x3f803f80
  s_cmp_lg_u32 s32, 0
  s_cbranch_scc1 SL_kv0d
  s_lshl_b32 s90, s33, 7
  s_add_u32 s90, s90, 0x3d07000
  v_mov_b32 v30, s90
SL_kv0:
  buffer_load_dword v31, v30, s[4:7], 0 offen sc1
  s_waitcnt vmcnt(0)
  v_readfirstlane_b32 s90, v31
  s_add_u32 s46, s46, 1
  s_cmp_ge_u32 s46, 131072
  s_cbranch_scc1 SL_rec_abort
  s_sleep 2
  s_cmp_lt_u32 s90, 16
  s_cbranch_scc1 SL_kv0
SL_kv0d:
  s_barrier
  buffer_load_dwordx4 v[180:183], v12, s[4:7], s44 offen offset:0
  buffer_load_dwordx4 v[184:187], v12, s[4:7], s44 offen offset:128
  buffer_load_dwordx4 v[188:191], v12, s[4:7], s44 offen offset:1024
  buffer_load_dwordx4 v[192:195], v12, s[4:7], s44 offen offset:1152
  buffer_load_dwordx4 v[196:199], v13, s[4:7], s44 offen offset:0
  buffer_load_dwordx4 v[200:203], v13, s[4:7], s44 offen offset:128
  buffer_load_dwordx4 v[204:207], v13, s[4:7], s44 offen offset:1024
  buffer_load_dwordx4 v[208:211], v13, s[4:7], s44 offen offset:1152
  buffer_load_dwordx4 v[116:119], v11, s[4:7], s44 offen offset:0
  buffer_load_dwordx4 v[132:135], v11, s[4:7], s44 offen offset:64
  buffer_load_dwordx4 v[120:123], v11, s[4:7], s44 offen offset:1024
  buffer_load_dwordx4 v[136:139], v11, s[4:7], s44 offen offset:1088
  buffer_load_dwordx4 v[124:127], v11, s[4:7], s44 offen offset:2048
  buffer_load_dwordx4 v[140:143], v11, s[4:7], s44 offen offset:2112
  buffer_load_dwordx4 v[128:131], v11, s[4:7], s44 offen offset:3072
  buffer_load_dwordx4 v[144:147], v11, s[4:7], s44 offen offset:3136
  s_add_u32 s44, s44, 0x40000
  v_mov_b64 v[64:65], 0
  v_mov_b64 v[66:67], 0
  v_mov_b64 v[68:69], 0
  v_mov_b64 v[70:71], 0
  v_mov_b64 v[72:73], 0
  v_mov_b64 v[74:75], 0
  v_mov_b64 v[76:77], 0
  v_mov_b64 v[78:79], 0
  v_mov_b64 v[80:81], 0
  v_mov_b64 v[82:83], 0
  v_mov_b64 v[84:85], 0
  v_mov_b64 v[86:87], 0
  v_mov_b64 v[32:33], 0
  v_mov_b64 v[34:35], 0
  v_mov_b64 v[212:213], 0
  v_mov_b64 v[214:215], 0
  v_mov_b64 v[216:217], 0
  v_mov_b64 v[218:219], 0
  v_mov_b64 v[220:221], 0
  v_mov_b64 v[222:223], 0
  v_mov_b64 v[224:225], 0
  v_mov_b64 v[226:227], 0
  v_mov_b64 v[228:229], 0
  v_mov_b64 v[230:231], 0
  s_waitcnt vmcnt(0)
  v_min_u32 v44, s54, v44
  s_lshl_b32 s90, s33, 7
  s_add_u32 s90, s90, 0x3d07000
  v_mov_b32 v244, s90
  s_lshl_b32 s90, s34, 2
  s_add_u32 s90, s90, s32
  s_lshl_b32 s91, s33, 7
  s_add_u32 s91, s91, 0x3d00000
  v_mbcnt_lo_u32_b32 v30, -1, 0
  v_mbcnt_hi_u32_b32 v30, -1, v30
  v_add_u32 v30, s90, v30
  v_cmp_eq_u32 vcc, 0, v30
  v_mov_b32 v30, 0x80000000
  v_mov_b32 v31, s91
  v_cndmask_b32 v245, v30, v31, vcc
  s_mov_b64 s[8:9], s[94:95]
  s_mov_b64 s[10:11], s[94:95]
  s_branch SL_pubmem
SL_step:
  s_load_dword s16, s[8:9], 256
  s_load_dword s17, s[10:11], 256
  s_load_dword s18, s[8:9], 320
  s_load_dword s19, s[10:11], 320
  s_load_dword s20, s[8:9], 384
  s_load_dword s21, s[10:11], 384
  s_load_dword s22, s[8:9], 448
  s_load_dword s23, s[10:11], 448
  buffer_load_dwordx4 v[200:203], v13, s[4:7], s44 offen offset:128
  buffer_load_dwordx4 v[204:207], v13, s[4:7], s44 offen offset:1024
  buffer_load_dwordx4 v[208:211], v13, s[4:7], s44 offen offset:1152
  buffer_load_dwordx4 v[128:131], v11, s[4:7], s44 offen offset:3072
  buffer_load_dwordx4 v[144:147], v11, s[4:7], s44 offen offset:3136
  v_mov_b64 v[64:65], 0
  v_mov_b64 v[66:67], 0
  v_mov_b64 v[68:69], 0
  v_mov_b64 v[70:71], 0
  v_mov_b64 v[72:73], 0
  v_mov_b64 v[74:75], 0
  v_mov_b64 v[76:77], 0
  v_mov_b64 v[78:79], 0
  v_mov_b64 v[80:81], 0
  v_mov_b64 v[82:83], 0
  v_mov_b64 v[84:85], 0
  v_mov_b64 v[86:87], 0
  v_mov_b64 v[32:33], 0
  v_mov_b64 v[34:35], 0
  buffer_load_dwordx4 v[36:39], v1, s[4:7], s42 offen sc1
  buffer_store_dword v22, v18, s[4:7], s13 offen sc1
  buffer_store_dword v22, v2, s[4:7], s13 offen sc1
  buffer_store_dword v22, v7, s[4:7], s13 offen sc1
  buffer_store_dword v22, v8, s[4:7], s13 offen sc1
  s_add_u32 s44, s44, 0x40000
  s_min_u32 s44, s44, 0xfc0000
  s_add_u32 s45, s45, 0x10000
  s_waitcnt vmcnt(12)
SL_kv_chk:
  v_readfirstlane_b32 s90, v243
  s_cmp_lt_u32 s90, 16
  s_cbranch_scc1 SL_kv_f
  s_waitcnt vmcnt(4)
SL_g_chk:
  v_max3_u32 v31, v36, v37, v38
  v_max_u32 v31, v31, v39
  v_cmp_eq_u32 vcc, -1, v31
  v_mfma_f32_16x16x32_bf16 v[40:43], v[24:27], v[36:39], 0
  s_cbranch_vccnz SL_g_f
  s_nop 6
  v_add_f32_dpp v45, v40, v40 row_ror:8 row_mask:0xf bank_mask:0xf
  v_add_f32_dpp v46, v41, v41 row_ror:8 row_mask:0xf bank_mask:0xf
  v_cvt_pk_bf16_f32 v44, v45, v46
  v_min_u32 v44, s54, v44
SL_pubmem:
  buffer_store_dword v44, v2, s[4:7], s41 offen sc1
  v_mov_b32 v148, v180
  v_mov_b32 v150, v181
  v_mov_b32 v152, v182
  v_mov_b32 v154, v183
  v_mov_b32 v149, v184
  v_mov_b32 v151, v185
  v_mov_b32 v153, v186
  v_mov_b32 v155, v187
  v_mov_b32 v156, v188
  v_mov_b32 v158, v189
  v_mov_b32 v160, v190
  v_mov_b32 v162, v191
  v_mov_b32 v157, v192
  v_mov_b32 v159, v193
  v_mov_b32 v161, v194
  v_mov_b32 v163, v195
  v_mov_b32 v164, v196
  v_mov_b32 v166, v197
  v_mov_b32 v168, v198
  v_mov_b32 v170, v199
  v_mov_b32 v165, v200
  v_mov_b32 v167, v201
  v_mov_b32 v169, v202
  v_mov_b32 v171, v203
  buffer_load_dwordx4 v[48:51], v3, s[4:7], s41 offen offset:0 sc1
  v_mov_b32 v172, v204
  v_mov_b32 v174, v205
  buffer_load_dwordx4 v[52:55], v3, s[4:7], s41 offen offset:1024 sc1
  v_mov_b32 v176, v206
  v_mov_b32 v178, v207
  buffer_load_dwordx4 v[56:59], v3, s[4:7], s41 offen offset:2048 sc1
  v_mov_b32 v173, v208
  v_mov_b32 v175, v209
  buffer_load_dwordx4 v[60:63], v3, s[4:7], s41 offen offset:3072 sc1
  v_mov_b32 v177, v210
  v_mov_b32 v179, v211
  s_waitcnt vmcnt(3)
  v_max3_u32 v31, v48, v49, v50
  v_max_u32 v31, v31, v51
  v_cmp_eq_u32 vcc, -1, v31
  s_cbranch_vccnz SL_m_f0
  v_smfmac_f32_16x16x64_bf16 v[64:67], v[48:51], a[0:7], v23
  s_waitcnt vmcnt(2)
  v_max3_u32 v31, v52, v53, v54
  v_max_u32 v31, v31, v55
  v_cmp_eq_u32 vcc, -1, v31
  v_smfmac_f32_16x16x64_bf16 v[68:71], v[48:51], a[8:15], v23
  v_smfmac_f32_16x16x64_bf16 v[72:75], v[48:51], a[16:23], v23
  v_smfmac_f32_16x16x64_bf16 v[76:79], v[48:51], a[24:31], v23
  s_cbranch_vccnz SL_m_f1
  v_smfmac_f32_16x16x64_bf16 v[64:67], v[52:55], a[48:55], v23
  s_waitcnt vmcnt(1)
  v_max3_u32 v31, v56, v57, v58
  v_max_u32 v31, v31, v59
  v_cmp_eq_u32 vcc, -1, v31
  v_smfmac_f32_16x16x64_bf16 v[68:71], v[52:55], a[56:63], v23
  v_smfmac_f32_16x16x64_bf16 v[72:75], v[52:55], a[64:71], v23
  v_smfmac_f32_16x16x64_bf16 v[76:79], v[52:55], a[72:79], v23
  s_cbranch_vccnz SL_m_f2
  v_smfmac_f32_16x16x64_bf16 v[64:67], v[56:59], a[96:103], v23
  s_waitcnt vmcnt(0)
  v_max3_u32 v31, v60, v61, v62
  v_max_u32 v31, v31, v63
  v_cmp_eq_u32 vcc, -1, v31
  v_smfmac_f32_16x16x64_bf16 v[68:71], v[56:59], a[104:111], v23
  v_smfmac_f32_16x16x64_bf16 v[72:75], v[56:59], a[112:119], v23
  v_smfmac_f32_16x16x64_bf16 v[76:79], v[56:59], a[120:127], v23
  s_cbranch_vccnz SL_m_f3
  v_smfmac_f32_16x16x64_bf16 v[64:67], v[60:63], a[144:151], v23
  v_smfmac_f32_16x16x64_bf16 v[68:71], v[60:63], a[152:159], v23
  v_smfmac_f32_16x16x64_bf16 v[72:75], v[60:63], a[160:167], v23
  v_smfmac_f32_16x16x64_bf16 v[76:79], v[60:63], a[168:175], v23
SL_m_done:
  s_nop 4
  v_pk_add_f32 v[88:89], v[64:65], v[66:67]
  v_pk_add_f32 v[90:91], v[68:69], v[70:71]
  ds_write_b128 v4, v[88:91] offset:0
  v_pk_add_f32 v[92:93], v[72:73], v[74:75]
  v_pk_add_f32 v[94:95], v[76:77], v[78:79]
  ds_write_b128 v4, v[92:95] offset:1088
  v_smfmac_f32_16x16x64_bf16 v[80:83], v[48:51], a[32:39], v23
  buffer_load_dwordx4 v[180:183], v12, s[4:7], s44 offen offset:0
  v_mov_b32 v36, 0
  v_smfmac_f32_16x16x64_bf16 v[84:87], v[48:51], a[40:47], v23
  buffer_load_dwordx4 v[184:187], v12, s[4:7], s44 offen offset:128
  v_mov_b32 v37, 0
  v_smfmac_f32_16x16x64_bf16 v[80:83], v[52:55], a[80:87], v23
  buffer_load_dwordx4 v[188:191], v12, s[4:7], s44 offen offset:1024
  v_mov_b32 v38, 0
  v_smfmac_f32_16x16x64_bf16 v[84:87], v[52:55], a[88:95], v23
  buffer_load_dwordx4 v[192:195], v12, s[4:7], s44 offen offset:1152
  v_mov_b32 v39, 0
  v_smfmac_f32_16x16x64_bf16 v[80:83], v[56:59], a[128:135], v23
  buffer_load_dwordx4 v[196:199], v13, s[4:7], s44 offen offset:0
  v_mov_b32 v40, 0
  s_waitcnt lgkmcnt(0)
  s_barrier
  ds_read2_b32 v[100:101], v6 offset0:0 offset1:2
  ds_read2_b32 v[102:103], v240 offset0:0 offset1:2
  ds_read2_b32 v[104:105], v241 offset0:0 offset1:2
  ds_read2_b32 v[106:107], v242 offset0:0 offset1:2
  v_smfmac_f32_16x16x64_bf16 v[84:87], v[56:59], a[136:143], v23
  v_mov_b32 v41, 0
  v_smfmac_f32_16x16x64_bf16 v[80:83], v[60:63], a[176:183], v23
  v_mov_b32 v42, 0
  v_smfmac_f32_16x16x64_bf16 v[84:87], v[60:63], a[184:191], v23
  v_mov_b32 v43, 0
  v_mov_b32 v44, 0
  v_mov_b32 v45, 0
  v_mov_b32 v46, 0
  v_mov_b32 v47, 0
  s_waitcnt lgkmcnt(2)
  v_pk_add_f32 v[100:101], v[100:101], v[102:103]
  s_waitcnt lgkmcnt(0)
  v_pk_add_f32 v[104:105], v[104:105], v[106:107]
  v_pk_add_f32 v[100:101], v[100:101], v[104:105]
  v_cvt_pk_bf16_f32 v112, v100, v101
  v_min_u32 v112, s54, v112
  buffer_store_dword v112, v7, s[4:7], s41 offen sc1
  v_pk_add_f32 v[96:97], v[80:81], v[82:83]
  v_pk_add_f32 v[98:99], v[84:85], v[86:87]
  ds_write_b128 v4, v[96:99] offset:2176
  v_mov_b64 v[212:213], 0
  v_mov_b64 v[214:215], 0
  v_mov_b64 v[216:217], 0
  v_mov_b64 v[218:219], 0
  v_mov_b64 v[220:221], 0
  v_mov_b64 v[222:223], 0
  v_mov_b64 v[224:225], 0
  v_mov_b64 v[226:227], 0
  v_mov_b64 v[228:229], 0
  v_mov_b64 v[230:231], 0
  s_waitcnt lgkmcnt(0)
  s_barrier
  ds_read_b64 v[88:89], v5 offset:0
  buffer_load_dwordx4 v[64:67], v9, s[4:7], s41 offen offset:0 sc1
  s_mov_b32 s42, s41
  s_add_u32 s90, s40, 1
  ds_read_b64 v[90:91], v5 offset:3264
  buffer_load_dwordx4 v[68:71], v9, s[4:7], s41 offen offset:1024 sc1
  s_and_b32 s90, s90, 3
  s_lshl_b32 s90, s90, 19
  ds_read_b64 v[92:93], v5 offset:6528
  buffer_load_dwordx4 v[72:75], v9, s[4:7], s41 offen offset:2048 sc1
  s_add_u32 s91, s90, 0x3800000
  s_add_u32 s55, s55, 0x40000
  ds_read_b64 v[94:95], v5 offset:9792
  buffer_load_dwordx4 v[76:79], v9, s[4:7], s41 offen offset:3072 sc1
  s_min_u32 s55, s55, 0xfc0000
  s_nop 0
  s_waitcnt lgkmcnt(2)
  v_pk_add_f32 v[88:89], v[88:89], v[90:91]
  s_waitcnt lgkmcnt(0)
  v_pk_add_f32 v[92:93], v[92:93], v[94:95]
  v_pk_add_f32 v[88:89], v[88:89], v[92:93]
  v_cvt_pk_bf16_f32 v113, v88, v89
  v_min_u32 v113, s54, v113
  buffer_store_dword v113, v8, s[4:7], s41 offen sc1
  s_add_u32 s8, s94, s55
  s_addc_u32 s9, s95, 0
  s_add_u32 s8, s8, s12
  s_addc_u32 s9, s9, 0
  s_add_u32 s10, s8, 0x1000000
  s_addc_u32 s11, s9, 0
  s_load_dword s16, s[8:9], 0
  s_load_dword s17, s[10:11], 0
  s_load_dword s18, s[8:9], 64
  s_load_dword s19, s[10:11], 64
  s_load_dword s20, s[8:9], 128
  s_load_dword s21, s[10:11], 128
  s_load_dword s22, s[8:9], 192
  s_load_dword s23, s[10:11], 192
  s_cmp_eq_u32 s40, 63
  s_cbranch_scc1 SL_last
  s_waitcnt vmcnt(4)
  v_max3_u32 v31, v64, v65, v66
  v_max_u32 v31, v31, v67
  v_cmp_eq_u32 vcc, -1, v31
  s_cbranch_vccnz SL_x_f0
  v_mfma_f32_16x16x32_bf16 v[44:47], v[64:67], v[64:67], v[44:47]
  s_waitcnt vmcnt(3)
  v_max3_u32 v31, v68, v69, v70
  v_max_u32 v31, v31, v71
  v_cmp_eq_u32 vcc, -1, v31
  v_mfma_f32_16x16x32_bf16 v[36:39], v[116:119], v[64:67], v[36:39]
  v_mfma_f32_16x16x32_bf16 v[40:43], v[132:135], v[64:67], v[40:43]
  s_cbranch_vccnz SL_x_f1
  v_mfma_f32_16x16x32_bf16 v[44:47], v[68:71], v[68:71], v[44:47]
  s_waitcnt vmcnt(2)
  v_max3_u32 v31, v72, v73, v74
  v_max_u32 v31, v31, v75
  v_cmp_eq_u32 vcc, -1, v31
  v_mfma_f32_16x16x32_bf16 v[36:39], v[120:123], v[68:71], v[36:39]
  v_mfma_f32_16x16x32_bf16 v[40:43], v[136:139], v[68:71], v[40:43]
  s_cbranch_vccnz SL_x_f2
  v_mfma_f32_16x16x32_bf16 v[44:47], v[72:75], v[72:75], v[44:47]
  s_waitcnt vmcnt(1)
  v_max3_u32 v31, v76, v77, v78
  v_max_u32 v31, v31, v79
  v_cmp_eq_u32 vcc, -1, v31
  v_mfma_f32_16x16x32_bf16 v[36:39], v[124:127], v[72:75], v[36:39]
  v_mfma_f32_16x16x32_bf16 v[40:43], v[140:143], v[72:75], v[40:43]
  s_cbranch_vccnz SL_x_f3
  v_mfma_f32_16x16x32_bf16 v[44:47], v[76:79], v[76:79], v[44:47]
  v_mfma_f32_16x16x32_bf16 v[36:39], v[128:131], v[76:79], v[36:39]
  v_mfma_f32_16x16x32_bf16 v[40:43], v[144:147], v[76:79], v[40:43]
SL_x_done:
  buffer_load_dwordx4 v[88:91], v10, s[4:7], s41 offen offset:0 sc1
  buffer_load_dwordx4 v[92:95], v10, s[4:7], s41 offen offset:1024 sc1
  s_mov_b64 vcc, s[48:49]
  s_nop 2
  v_max_f32 v30, v46, v47
  s_nop 0
  v_cndmask_b32_dpp v96, v40, v36, vcc quad_perm:[0,1,0,1] row_mask:0xf bank_mask:0xf
  v_cndmask_b32_dpp v97, v41, v37, vcc quad_perm:[0,1,0,1] row_mask:0xf bank_mask:0xf
  v_cndmask_b32_dpp v98, v42, v38, vcc quad_perm:[0,1,0,1] row_mask:0xf bank_mask:0xf
  v_cndmask_b32_dpp v99, v43, v39, vcc quad_perm:[0,1,0,1] row_mask:0xf bank_mask:0xf
  v_max3_f32 v29, v96, v97, v98
  s_nop 0
  v_max_f32_dpp v28, v30, v99 quad_perm:[0,1,0,1] row_mask:0xf bank_mask:0xf
  v_max_f32 v29, v29, v28
  s_nop 1
  v_max_f32_dpp v28, v29, v29 quad_perm:[2,3,0,1] row_mask:0xf bank_mask:0xf
  v_mov_b32 v29, v28
  s_nop 1
  v_permlane32_swap_b32 v28, v29
  v_max_f32 v28, v28, v29
  v_mov_b32 v29, v28
  s_nop 1
  v_permlane16_swap_b32 v28, v29
  v_max_f32 v28, v28, v29
  v_mul_f32 v28, s47, v28
  v_fma_f32 v96, v96, s47, -v28
  v_fma_f32 v97, v97, s47, -v28
  v_fma_f32 v98, v98, s47, -v28
  v_fma_f32 v99, v99, s47, -v28
  v_fma_f32 v46, v46, s47, -v28
  v_fma_f32 v47, v47, s47, -v28
  v_exp_f32 v96, v96
  v_exp_f32 v97, v97
  v_exp_f32 v98, v98
  v_exp_f32 v99, v99
  v_cvt_pk_bf16_f32 v236, v96, v97
  v_cvt_pk_bf16_f32 v237, v98, v99
  v_exp_f32 v46, v46
  v_mov_b32_dpp v100, v236 quad_perm:[0,1,0,1] row_mask:0xf bank_mask:0xf
  v_mov_b32_dpp v102, v236 quad_perm:[2,3,2,3] row_mask:0xf bank_mask:0xf
  v_mov_b32_dpp v101, v237 quad_perm:[0,1,0,1] row_mask:0xf bank_mask:0xf
  v_mov_b32_dpp v103, v237 quad_perm:[2,3,2,3] row_mask:0xf bank_mask:0xf
  v_exp_f32 v47, v47
  s_nop 0
  v_smfmac_f32_16x16x64_bf16 v[228:231], v[100:103], v[248:255], v23
  v_cvt_pk_bf16_f32 v238, v46, v47
  buffer_load_dwordx4 v[116:119], v11, s[4:7], s44 offen offset:0
  v_smfmac_f32_16x16x64_bf16 v[212:215], v[100:103], v[148:155], v23
  buffer_load_dwordx4 v[132:135], v11, s[4:7], s44 offen offset:64
  v_mov_b32_dpp v232, v238 quad_perm:[0,1,0,1] row_mask:0xf bank_mask:0xf
  v_smfmac_f32_16x16x64_bf16 v[216:219], v[100:103], v[156:163], v23
  buffer_load_dwordx4 v[120:123], v11, s[4:7], s44 offen offset:1024
  v_mov_b32_dpp v235, v238 quad_perm:[0,1,0,1] row_mask:0xf bank_mask:0xf
  v_smfmac_f32_16x16x64_bf16 v[220:223], v[100:103], v[164:171], v23
  buffer_load_dwordx4 v[136:139], v11, s[4:7], s44 offen offset:1088
  s_waitcnt vmcnt(4)
  v_max3_u32 v31, v88, v89, v90
  v_max3_u32 v31, v31, v91, v92
  v_smfmac_f32_16x16x32_bf16 v[228:231], v[232:233], v[248:251], v23
  v_max3_u32 v31, v31, v93, v94
  v_max_u32 v31, v31, v95
  v_cmp_eq_u32 vcc, -1, v31
  v_smfmac_f32_16x16x64_bf16 v[224:227], v[100:103], v[172:179], v23
  s_cbranch_vccnz SL_v_f
SL_v_ok:
  v_smfmac_f32_16x16x32_bf16 v[212:215], v[232:233], v[88:91], v23
  buffer_load_dwordx4 v[124:127], v11, s[4:7], s44 offen offset:2048
  buffer_load_dwordx4 v[140:143], v11, s[4:7], s44 offen offset:2112
  v_smfmac_f32_16x16x32_bf16 v[216:219], v[234:235], v[88:91], v23
  v_rcp_f32 v28, v228
  v_smfmac_f32_16x16x32_bf16 v[220:223], v[232:233], v[92:95], v23
  v_rcp_f32 v29, v229
  v_smfmac_f32_16x16x32_bf16 v[224:227], v[234:235], v[92:95], v23
  s_nop 0
  v_pk_mul_f32 v[212:213], v[212:213], v[28:29]
  v_pk_mul_f32 v[214:215], v[214:215], v[28:29]
  v_cvt_pk_bf16_f32 v104, v212, v214
  v_cvt_pk_bf16_f32 v108, v213, v215
  v_pk_mul_f32 v[216:217], v[216:217], v[28:29]
  v_pk_mul_f32 v[218:219], v[218:219], v[28:29]
  v_cvt_pk_bf16_f32 v105, v216, v218
  v_cvt_pk_bf16_f32 v109, v217, v219
  v_pk_mul_f32 v[220:221], v[220:221], v[28:29]
  v_pk_mul_f32 v[222:223], v[222:223], v[28:29]
  v_cvt_pk_bf16_f32 v106, v220, v222
  v_cvt_pk_bf16_f32 v110, v221, v223
  v_pk_mul_f32 v[224:225], v[224:225], v[28:29]
  v_pk_mul_f32 v[226:227], v[226:227], v[28:29]
  v_cvt_pk_bf16_f32 v107, v224, v226
  v_cvt_pk_bf16_f32 v111, v225, v227
  ds_write_b128 v14, v[104:107]
  ds_write_b128 v15, v[108:111]
  s_add_u32 s92, s40, 3
  s_min_u32 s92, s92, 63
  s_lshr_b32 s92, s92, 2
  s_lshl_b32 s92, s92, 9
  v_mov_b32 v246, s40
  s_waitcnt lgkmcnt(0)
  s_barrier
  ds_read_b128 v[48:51], v16 offset:0
  ds_read_b128 v[52:55], v16 offset:1024
  ds_read_b128 v[56:59], v16 offset:2048
  ds_read_b128 v[60:63], v16 offset:3072
  ds_read_b128 v[64:67], v16 offset:4096
  buffer_store_dword v22, v17, s[4:7], s43 offen sc1
  buffer_store_dword v112, v19, s[4:7], s45 offen sc1
  s_waitcnt lgkmcnt(4)
  v_smfmac_f32_16x16x64_bf16 v[32:35], v[48:51], a[192:199], v23
  ds_read_b128 v[68:71], v16 offset:5120
  buffer_store_dword v113, v20, s[4:7], s45 offen sc1
  s_waitcnt lgkmcnt(4)
  v_smfmac_f32_16x16x64_bf16 v[32:35], v[52:55], a[200:207], v23
  ds_read_b128 v[72:75], v16 offset:6144
  buffer_store_dword v246, v245, s[4:7], 0 offen sc1
  s_waitcnt lgkmcnt(4)
  v_smfmac_f32_16x16x64_bf16 v[32:35], v[56:59], a[208:215], v23
  ds_read_b128 v[76:79], v16 offset:7168
  buffer_load_dword v243, v244, s[4:7], s92 offen sc1
  s_waitcnt lgkmcnt(4)
  v_smfmac_f32_16x16x64_bf16 v[32:35], v[60:63], a[216:223], v23
  s_mov_b32 s13, s43
  s_waitcnt lgkmcnt(3)
  v_smfmac_f32_16x16x64_bf16 v[32:35], v[64:67], a[224:231], v23
  s_add_u32 s40, s40, 1
  s_waitcnt lgkmcnt(2)
  v_smfmac_f32_16x16x64_bf16 v[32:35], v[68:71], a[232:239], v23
  s_mov_b32 s41, s91
  s_waitcnt lgkmcnt(1)
  v_smfmac_f32_16x16x64_bf16 v[32:35], v[72:75], a[240:247], v23
  s_xor_b32 s43, s91, 0x100000
  s_waitcnt lgkmcnt(0)
  v_smfmac_f32_16x16x64_bf16 v[32:35], v[76:79], a[248:255], v23
  s_nop 7
  v_pk_add_f32 v[28:29], v[32:33], v[34:35]
  v_cvt_pk_bf16_f32 v28, v28, v29
  v_min_u32 v28, s54, v28
  buffer_store_dword v28, v17, s[4:7], s42 offen sc1
  buffer_store_dword v28, v18, s[4:7], s42 offen sc1
  s_branch SL_step
SL_last:
  buffer_store_dword v112, v19, s[4:7], s45 offen sc1
  buffer_store_dword v113, v20, s[4:7], s45 offen sc1
  s_branch L_join
SL_kv_f:
  s_sleep 8
  buffer_load_dword v243, v244, s[4:7], s92 offen sc1
  s_add_u32 s46, s46, 1
  s_cmp_ge_u32 s46, 131072
  s_cbranch_scc1 SL_rec_abort
  s_waitcnt vmcnt(0)
  s_branch SL_kv_chk
SL_g_f:
  s_mov_b64 exec, vcc
  buffer_load_dwordx4 v[36:39], v1, s[4:7], s42 offen sc1
  s_mov_b64 exec, -1
  s_add_u32 s46, s46, 1
  s_cmp_ge_u32 s46, 131072
  s_cbranch_scc1 SL_rec_abort
  s_waitcnt vmcnt(0)
  s_branch SL_g_chk
SL_m_f0:
  s_mov_b64 exec, vcc
  buffer_load_dwordx4 v[48:51], v3, s[4:7], s41 offen offset:0 sc1
  s_mov_b64 exec, -1
  s_waitcnt vmcnt(1)
  s_branch SL_m_0123_c1
SL_m_f1:
  s_mov_b64 exec, vcc
  buffer_load_dwordx4 v[52:55], v3, s[4:7], s41 offen offset:1024 sc1
  s_mov_b64 exec, -1
  s_waitcnt vmcnt(1)
  s_branch SL_m_123_c2
SL_m_f2:
  s_mov_b64 exec, vcc
  buffer_load_dwordx4 v[56:59], v3, s[4:7], s41 offen offset:2048 sc1
  s_mov_b64 exec, -1
  s_waitcnt vmcnt(1)
  s_branch SL_m_23_c3
SL_m_f3:
  s_mov_b64 exec, vcc
  buffer_load_dwordx4 v[60:63], v3, s[4:7], s41 offen offset:3072 sc1
  s_mov_b64 exec, -1
  s_nop 7
  s_branch SL_m_3_c3
SL_m_0_c0:
  v_max3_u32 v31, v48, v49, v50
  v_max_u32 v31, v31, v51
  v_cmp_eq_u32 vcc, -1, v31
  s_cbranch_vccz SL_m_0_ok0
SL_m_0_x0:
  s_mov_b64 exec, vcc
  buffer_load_dwordx4 v[48:51], v3, s[4:7], s41 offen offset:0 sc1
  s_mov_b64 exec, -1
  s_add_u32 s46, s46, 1
  s_cmp_ge_u32 s46, 131072
  s_cbranch_scc1 SL_rec_abort
  s_waitcnt vmcnt(2)
  s_branch SL_m_0_c0
SL_m_0_ok0:
  v_smfmac_f32_16x16x64_bf16 v[64:67], v[48:51], a[0:7], v23
  v_smfmac_f32_16x16x64_bf16 v[68:71], v[48:51], a[8:15], v23
  v_smfmac_f32_16x16x64_bf16 v[72:75], v[48:51], a[16:23], v23
  v_smfmac_f32_16x16x64_bf16 v[76:79], v[48:51], a[24:31], v23
  s_branch SL_m_done
SL_m_1_c1:
  v_max3_u32 v31, v52, v53, v54
  v_max_u32 v31, v31, v55
  v_cmp_eq_u32 vcc, -1, v31
  s_cbranch_vccz SL_m_1_ok1
SL_m_1_x1:
  s_mov_b64 exec, vcc
  buffer_load_dwordx4 v[52:55], v3, s[4:7], s41 offen offset:1024 sc1
  s_mov_b64 exec, -1
  s_add_u32 s46, s46, 1
  s_cmp_ge_u32 s46, 131072
  s_cbranch_scc1 SL_rec_abort
  s_waitcnt vmcnt(2)
  s_branch SL_m_1_c1
SL_m_1_ok1:
  v_smfmac_f32_16x16x64_bf16 v[64:67], v[52:55], a[48:55], v23
  v_smfmac_f32_16x16x64_bf16 v[68:71], v[52:55], a[56:63], v23
  v_smfmac_f32_16x16x64_bf16 v[72:75], v[52:55], a[64:71], v23
  v_smfmac_f32_16x16x64_bf16 v[76:79], v[52:55], a[72:79], v23
  s_branch SL_m_done
SL_m_2_c2:
  v_max3_u32 v31, v56, v57, v58
  v_max_u32 v31, v31, v59
  v_cmp_eq_u32 vcc, -1, v31
  s_cbranch_vccz SL_m_2_ok2
SL_m_2_x2:
  s_mov_b64 exec, vcc
  buffer_load_dwordx4 v[56:59], v3, s[4:7], s41 offen offset:2048 sc1
  s_mov_b64 exec, -1
  s_add_u32 s46, s46, 1
  s_cmp_ge_u32 s46, 131072
  s_cbranch_scc1 SL_rec_abort
  s_waitcnt vmcnt(2)
  s_branch SL_m_2_c2
SL_m_2_ok2:
  v_smfmac_f32_16x16x64_bf16 v[64:67], v[56:59], a[96:103], v23
  v_smfmac_f32_16x16x64_bf16 v[68:71], v[56:59], a[104:111], v23
  v_smfmac_f32_16x16x64_bf16 v[72:75], v[56:59], a[112:119], v23
  v_smfmac_f32_16x16x64_bf16 v[76:79], v[56:59], a[120:127], v23
  s_branch SL_m_done
SL_m_3_c3:
  v_max3_u32 v31, v60, v61, v62
  v_max_u32 v31, v31, v63
  v_cmp_eq_u32 vcc, -1, v31
  s_cbranch_vccz SL_m_3_ok3
SL_m_3_x3:
  s_mov_b64 exec, vcc
  buffer_load_dwordx4 v[60:63], v3, s[4:7], s41 offen offset:3072 sc1
  s_mov_b64 exec, -1
  s_add_u32 s46, s46, 1
  s_cmp_ge_u32 s46, 131072
  s_cbranch_scc1 SL_rec_abort
  s_waitcnt vmcnt(2)
  s_branch SL_m_3_c3
SL_m_3_ok3:
  v_smfmac_f32_16x16x64_bf16 v[64:67], v[60:63], a[144:151], v23
  v_smfmac_f32_16x16x64_bf16 v[68:71], v[60:63], a[152:159], v23
  v_smfmac_f32_16x16x64_bf16 v[72:75], v[60:63], a[160:167], v23
  v_smfmac_f32_16x16x64_bf16 v[76:79], v[60:63], a[168:175], v23
  s_branch SL_m_done
SL_m_01_c0:
  v_max3_u32 v31, v48, v49, v50
  v_max_u32 v31, v31, v51
  v_cmp_eq_u32 vcc, -1, v31
  s_cbranch_vccz SL_m_01_ok0
SL_m_01_x0:
  s_mov_b64 exec, vcc
  buffer_load_dwordx4 v[48:51], v3, s[4:7], s41 offen offset:0 sc1
  s_mov_b64 exec, -1
SL_m_01_c1:
  v_max3_u32 v31, v52, v53, v54
  v_max_u32 v31, v31, v55
  v_cmp_eq_u32 vcc, -1, v31
  s_cbranch_vccz SL_m_01_ok1
SL_m_01_x1:
  s_mov_b64 exec, vcc
  buffer_load_dwordx4 v[52:55], v3, s[4:7], s41 offen offset:1024 sc1
  s_mov_b64 exec, -1
  s_add_u32 s46, s46, 1
  s_cmp_ge_u32 s46, 131072
  s_cbranch_scc1 SL_rec_abort
  s_waitcnt vmcnt(4)
  s_branch SL_m_01_c0
SL_m_01_ok0:
  v_smfmac_f32_16x16x64_bf16 v[64:67], v[48:51], a[0:7], v23
  v_max3_u32 v31, v52, v53, v54
  v_max_u32 v31, v31, v55
  v_cmp_eq_u32 vcc, -1, v31
  v_smfmac_f32_16x16x64_bf16 v[68:71], v[48:51], a[8:15], v23
  v_smfmac_f32_16x16x64_bf16 v[72:75], v[48:51], a[16:23], v23
  v_smfmac_f32_16x16x64_bf16 v[76:79], v[48:51], a[24:31], v23
  s_cbranch_vccz SL_m_1_ok1
  s_branch SL_m_1_x1
SL_m_01_ok1:
  v_smfmac_f32_16x16x64_bf16 v[64:67], v[52:55], a[48:55], v23
  v_max3_u32 v31, v48, v49, v50
  v_max_u32 v31, v31, v51
  v_cmp_eq_u32 vcc, -1, v31
  v_smfmac_f32_16x16x64_bf16 v[68:71], v[52:55], a[56:63], v23
  v_smfmac_f32_16x16x64_bf16 v[72:75], v[52:55], a[64:71], v23
  v_smfmac_f32_16x16x64_bf16 v[76:79], v[52:55], a[72:79], v23
  s_cbranch_vccz SL_m_0_ok0
  s_branch SL_m_0_x0
SL_m_02_c0:
  v_max3_u32 v31, v48, v49, v50
  v_max_u32 v31, v31, v51
  v_cmp_eq_u32 vcc, -1, v31
  s_cbranch_vccz SL_m_02_ok0
SL_m_02_x0:
  s_mov_b64 exec, vcc
  buffer_load_dwordx4 v[48:51], v3, s[4:7], s41 offen offset:0 sc1
  s_mov_b64 exec, -1
SL_m_02_c2:
  v_max3_u32 v31, v56, v57, v58
  v_max_u32 v31, v31, v59
  v_cmp_eq_u32 vcc, -1, v31
  s_cbranch_vccz SL_m_02_ok2
SL_m_02_x2:
  s_mov_b64 exec, vcc
  buffer_load_dwordx4 v[56:59], v3, s[4:7], s41 offen offset:2048 sc1
  s_mov_b64 exec, -1
  s_add_u32 s46, s46, 1
  s_cmp_ge_u32 s46, 131072
  s_cbranch_scc1 SL_rec_abort
  s_waitcnt vmcnt(4)
  s_branch SL_m_02_c0
SL_m_02_ok0:
  v_smfmac_f32_16x16x64_bf16 v[64:67], v[48:51], a[0:7], v23
  v_max3_u32 v31, v56, v57, v58
  v_max_u32 v31, v31, v59
  v_cmp_eq_u32 vcc, -1, v31
  v_smfmac_f32_16x16x64_bf16 v[68:71], v[48:51], a[8:15], v23
  v_smfmac_f32_16x16x64_bf16 v[72:75], v[48:51], a[16:23], v23
  v_smfmac_f32_16x16x64_bf16 v[76:79], v[48:51], a[24:31], v23
  s_cbranch_vccz SL_m_2_ok2
  s_branch SL_m_2_x2
SL_m_02_ok2:
  v_smfmac_f32_16x16x64_bf16 v[64:67], v[56:59], a[96:103], v23
  v_max3_u32 v31, v48, v49, v50
  v_max_u32 v31, v31, v51
  v_cmp_eq_u32 vcc, -1, v31
  v_smfmac_f32_16x16x64_bf16 v[68:71], v[56:59], a[104:111], v23
  v_smfmac_f32_16x16x64_bf16 v[72:75], v[56:59], a[112:119], v23
  v_smfmac_f32_16x16x64_bf16 v[76:79], v[56:59], a[120:127], v23
  s_cbranch_vccz SL_m_0_ok0
  s_branch SL_m_0_x0
SL_m_03_c0:
  v_max3_u32 v31, v48, v49, v50
  v_max_u32 v31, v31, v51
  v_cmp_eq_u32 vcc, -1, v31
  s_cbranch_vccz SL_m_03_ok0
SL_m_03_x0:
  s_mov_b64 exec, vcc
  buffer_load_dwordx4 v[48:51], v3, s[4:7], s41 offen offset:0 sc1
  s_mov_b64 exec, -1
SL_m_03_c3:
  v_max3_u32 v31, v60, v61, v62
  v_max_u32 v31, v31, v63
  v_cmp_eq_u32 vcc, -1, v31
  s_cbranch_vccz SL_m_03_ok3
SL_m_03_x3:
  s_mov_b64 exec, vcc
  buffer_load_dwordx4 v[60:63], v3, s[4:7], s41 offen offset:3072 sc1
  s_mov_b64 exec, -1
  s_add_u32 s46, s46, 1
  s_cmp_ge_u32 s46, 131072
  s_cbranch_scc1 SL_rec_abort
  s_waitcnt vmcnt(4)
  s_branch SL_m_03_c0
SL_m_03_ok0:
  v_smfmac_f32_16x16x64_bf16 v[64:67], v[48:51], a[0:7], v23
  v_max3_u32 v31, v60, v61, v62
  v_max_u32 v31, v31, v63
  v_cmp_eq_u32 vcc, -1, v31
  v_smfmac_f32_16x16x64_bf16 v[68:71], v[48:51], a[8:15], v23
  v_smfmac_f32_16x16x64_bf16 v[72:75], v[48:51], a[16:23], v23
  v_smfmac_f32_16x16x64_bf16 v[76:79], v[48:51], a[24:31], v23
  s_cbranch_vccz SL_m_3_ok3
  s_branch SL_m_3_x3
SL_m_03_ok3:
  v_smfmac_f32_16x16x64_bf16 v[64:67], v[60:63], a[144:151], v23
  v_max3_u32 v31, v48, v49, v50
  v_max_u32 v31, v31, v51
  v_cmp_eq_u32 vcc, -1, v31
  v_smfmac_f32_16x16x64_bf16 v[68:71], v[60:63], a[152:159], v23
  v_smfmac_f32_16x16x64_bf16 v[72:75], v[60:63], a[160:167], v23
  v_smfmac_f32_16x16x64_bf16 v[76:79], v[60:63], a[168:175], v23
  s_cbranch_vccz SL_m_0_ok0
  s_branch SL_m_0_x0
SL_m_12_c1:
  v_max3_u32 v31, v52, v53, v54
  v_max_u32 v31, v31, v55
  v_cmp_eq_u32 vcc, -1, v31
  s_cbranch_vccz SL_m_12_ok1
SL_m_12_x1:
  s_mov_b64 exec, vcc
  buffer_load_dwordx4 v[52:55], v3, s[4:7], s41 offen offset:1024 sc1
  s_mov_b64 exec, -1
SL_m_12_c2:
  v_max3_u32 v31, v56, v57, v58
  v_max_u32 v31, v31, v59
  v_cmp_eq_u32 vcc, -1, v31
  s_cbranch_vccz SL_m_12_ok2
SL_m_12_x2:
  s_mov_b64 exec, vcc
  buffer_load_dwordx4 v[56:59], v3, s[4:7], s41 offen offset:2048 sc1
  s_mov_b64 exec, -1
  s_add_u32 s46, s46, 1
  s_cmp_ge_u32 s46, 131072
  s_cbranch_scc1 SL_rec_abort
  s_waitcnt vmcnt(4)
  s_branch SL_m_12_c1
SL_m_12_ok1:
  v_smfmac_f32_16x16x64_bf16 v[64:67], v[52:55], a[48:55], v23
  v_max3_u32 v31, v56, v57, v58
  v_max_u32 v31, v31, v59
  v_cmp_eq_u32 vcc, -1, v31
  v_smfmac_f32_16x16x64_bf16 v[68:71], v[52:55], a[56:63], v23
  v_smfmac_f32_16x16x64_bf16 v[72:75], v[52:55], a[64:71], v23
  v_smfmac_f32_16x16x64_bf16 v[76:79], v[52:55], a[72:79], v23
  s_cbranch_vccz SL_m_2_ok2
  s_branch SL_m_2_x2
SL_m_12_ok2:
  v_smfmac_f32_16x16x64_bf16 v[64:67], v[56:59], a[96:103], v23
  v_max3_u32 v31, v52, v53, v54
  v_max_u32 v31, v31, v55
  v_cmp_eq_u32 vcc, -1, v31
  v_smfmac_f32_16x16x64_bf16 v[68:71], v[56:59], a[104:111], v23
  v_smfmac_f32_16x16x64_bf16 v[72:75], v[56:59], a[112:119], v23
  v_smfmac_f32_16x16x64_bf16 v[76:79], v[56:59], a[120:127], v23
  s_cbranch_vccz SL_m_1_ok1
  s_branch SL_m_1_x1
SL_m_13_c1:
  v_max3_u32 v31, v52, v53, v54
  v_max_u32 v31, v31, v55
  v_cmp_eq_u32 vcc, -1, v31
  s_cbranch_vccz SL_m_13_ok1
SL_m_13_x1:
  s_mov_b64 exec, vcc
  buffer_load_dwordx4 v[52:55], v3, s[4:7], s41 offen offset:1024 sc1
  s_mov_b64 exec, -1
SL_m_13_c3:
  v_max3_u32 v31, v60, v61, v62
  v_max_u32 v31, v31, v63
  v_cmp_eq_u32 vcc, -1, v31
  s_cbranch_vccz SL_m_13_ok3
SL_m_13_x3:
  s_mov_b64 exec, vcc
  buffer_load_dwordx4 v[60:63], v3, s[4:7], s41 offen offset:3072 sc1
  s_mov_b64 exec, -1
  s_add_u32 s46, s46, 1
  s_cmp_ge_u32 s46, 131072
  s_cbranch_scc1 SL_rec_abort
  s_waitcnt vmcnt(4)
  s_branch SL_m_13_c1
SL_m_13_ok1:
  v_smfmac_f32_16x16x64_bf16 v[64:67], v[52:55], a[48:55], v23
  v_max3_u32 v31, v60, v61, v62
  v_max_u32 v31, v31, v63
  v_cmp_eq_u32 vcc, -1, v31
  v_smfmac_f32_16x16x64_bf16 v[68:71], v[52:55], a[56:63], v23
  v_smfmac_f32_16x16x64_bf16 v[72:75], v[52:55], a[64:71], v23
  v_smfmac_f32_16x16x64_bf16 v[76:79], v[52:55], a[72:79], v23
  s_cbranch_vccz SL_m_3_ok3
  s_branch SL_m_3_x3
SL_m_13_ok3:
  v_smfmac_f32_16x16x64_bf16 v[64:67], v[60:63], a[144:151], v23
  v_max3_u32 v31, v52, v53, v54
  v_max_u32 v31, v31, v55
  v_cmp_eq_u32 vcc, -1, v31
  v_smfmac_f32_16x16x64_bf16 v[68:71], v[60:63], a[152:159], v23
  v_smfmac_f32_16x16x64_bf16 v[72:75], v[60:63], a[160:167], v23
  v_smfmac_f32_16x16x64_bf16 v[76:79], v[60:63], a[168:175], v23
  s_cbranch_vccz SL_m_1_ok1
  s_branch SL_m_1_x1
SL_m_23_c2:
  v_max3_u32 v31, v56, v57, v58
  v_max_u32 v31, v31, v59
  v_cmp_eq_u32 vcc, -1, v31
  s_cbranch_vccz SL_m_23_ok2
SL_m_23_x2:
  s_mov_b64 exec, vcc
  buffer_load_dwordx4 v[56:59], v3, s[4:7], s41 offen offset:2048 sc1
  s_mov_b64 exec, -1
SL_m_23_c3:
  v_max3_u32 v31, v60, v61, v62
  v_max_u32 v31, v31, v63
  v_cmp_eq_u32 vcc, -1, v31
  s_cbranch_vccz SL_m_23_ok3
SL_m_23_x3:
  s_mov_b64 exec, vcc
  buffer_load_dwordx4 v[60:63], v3, s[4:7], s41 offen offset:3072 sc1
  s_mov_b64 exec, -1
  s_add_u32 s46, s46, 1
  s_cmp_ge_u32 s46, 131072
  s_cbranch_scc1 SL_rec_abort
  s_waitcnt vmcnt(4)
  s_branch SL_m_23_c2
SL_m_23_ok2:
  v_smfmac_f32_16x16x64_bf16 v[64:67], v[56:59], a[96:103], v23
  v_max3_u32 v31, v60, v61, v62
  v_max_u32 v31, v31, v63
  v_cmp_eq_u32 vcc, -1, v31
  v_smfmac_f32_16x16x64_bf16 v[68:71], v[56:59], a[104:111], v23
  v_smfmac_f32_16x16x64_bf16 v[72:75], v[56:59], a[112:119], v23
  v_smfmac_f32_16x16x64_bf16 v[76:79], v[56:59], a[120:127], v23
  s_cbranch_vccz SL_m_3_ok3
  s_branch SL_m_3_x3
SL_m_23_ok3:
  v_smfmac_f32_16x16x64_bf16 v[64:67], v[60:63], a[144:151], v23
  v_max3_u32 v31, v56, v57, v58
  v_max_u32 v31, v31, v59
  v_cmp_eq_u32 vcc, -1, v31
  v_smfmac_f32_16x16x64_bf16 v[68:71], v[60:63], a[152:159], v23
  v_smfmac_f32_16x16x64_bf16 v[72:75], v[60:63], a[160:167], v23
  v_smfmac_f32_16x16x64_bf16 v[76:79], v[60:63], a[168:175], v23
  s_cbranch_vccz SL_m_2_ok2
  s_branch SL_m_2_x2
SL_m_012_c0:
  v_max3_u32 v31, v48, v49, v50
  v_max_u32 v31, v31, v51
  v_cmp_eq_u32 vcc, -1, v31
  s_cbranch_vccz SL_m_012_ok0
SL_m_012_x0:
  s_mov_b64 exec, vcc
  buffer_load_dwordx4 v[48:51], v3, s[4:7], s41 offen offset:0 sc1
  s_mov_b64 exec, -1
SL_m_012_c1:
  v_max3_u32 v31, v52, v53, v54
  v_max_u32 v31, v31, v55
  v_cmp_eq_u32 vcc, -1, v31
  s_cbranch_vccz SL_m_012_ok1
SL_m_012_x1:
  s_mov_b64 exec, vcc
  buffer_load_dwordx4 v[52:55], v3, s[4:7], s41 offen offset:1024 sc1
  s_mov_b64 exec, -1
SL_m_012_c2:
  v_max3_u32 v31, v56, v57, v58
  v_max_u32 v31, v31, v59
  v_cmp_eq_u32 vcc, -1, v31
  s_cbranch_vccz SL_m_012_ok2
SL_m_012_x2:
  s_mov_b64 exec, vcc
  buffer_load_dwordx4 v[56:59], v3, s[4:7], s41 offen offset:2048 sc1
  s_mov_b64 exec, -1
  s_add_u32 s46, s46, 1
  s_cmp_ge_u32 s46, 131072
  s_cbranch_scc1 SL_rec_abort
  s_waitcnt vmcnt(4)
  s_branch SL_m_012_c0
SL_m_012_ok0:
  v_smfmac_f32_16x16x64_bf16 v[64:67], v[48:51], a[0:7], v23
  v_max3_u32 v31, v52, v53, v54
  v_max_u32 v31, v31, v55
  v_cmp_eq_u32 vcc, -1, v31
  v_smfmac_f32_16x16x64_bf16 v[68:71], v[48:51], a[8:15], v23
  v_smfmac_f32_16x16x64_bf16 v[72:75], v[48:51], a[16:23], v23
  v_smfmac_f32_16x16x64_bf16 v[76:79], v[48:51], a[24:31], v23
  s_cbranch_vccz SL_m_12_ok1
  s_branch SL_m_12_x1
SL_m_012_ok1:
  v_smfmac_f32_16x16x64_bf16 v[64:67], v[52:55], a[48:55], v23
  v_max3_u32 v31, v56, v57, v58
  v_max_u32 v31, v31, v59
  v_cmp_eq_u32 vcc, -1, v31
  v_smfmac_f32_16x16x64_bf16 v[68:71], v[52:55], a[56:63], v23
  v_smfmac_f32_16x16x64_bf16 v[72:75], v[52:55], a[64:71], v23
  v_smfmac_f32_16x16x64_bf16 v[76:79], v[52:55], a[72:79], v23
  s_cbranch_vccz SL_m_02_ok2
  s_branch SL_m_02_x2
SL_m_012_ok2:
  v_smfmac_f32_16x16x64_bf16 v[64:67], v[56:59], a[96:103], v23
  v_max3_u32 v31, v48, v49, v50
  v_max_u32 v31, v31, v51
  v_cmp_eq_u32 vcc, -1, v31
  v_smfmac_f32_16x16x64_bf16 v[68:71], v[56:59], a[104:111], v23
  v_smfmac_f32_16x16x64_bf16 v[72:75], v[56:59], a[112:119], v23
  v_smfmac_f32_16x16x64_bf16 v[76:79], v[56:59], a[120:127], v23
  s_cbranch_vccz SL_m_01_ok0
  s_branch SL_m_01_x0
SL_m_013_c0:
  v_max3_u32 v31, v48, v49, v50
  v_max_u32 v31, v31, v51
  v_cmp_eq_u32 vcc, -1, v31
  s_cbranch_vccz SL_m_013_ok0
SL_m_013_x0:
  s_mov_b64 exec, vcc
  buffer_load_dwordx4 v[48:51], v3, s[4:7], s41 offen offset:0 sc1
  s_mov_b64 exec, -1
SL_m_013_c1:
  v_max3_u32 v31, v52, v53, v54
  v_max_u32 v31, v31, v55
  v_cmp_eq_u32 vcc, -1, v31
  s_cbranch_vccz SL_m_013_ok1
SL_m_013_x1:
  s_mov_b64 exec, vcc
  buffer_load_dwordx4 v[52:55], v3, s[4:7], s41 offen offset:1024 sc1
  s_mov_b64 exec, -1
SL_m_013_c3:
  v_max3_u32 v31, v60, v61, v62
  v_max_u32 v31, v31, v63
  v_cmp_eq_u32 vcc, -1, v31
  s_cbranch_vccz SL_m_013_ok3
SL_m_013_x3:
  s_mov_b64 exec, vcc
  buffer_load_dwordx4 v[60:63], v3, s[4:7], s41 offen offset:3072 sc1
  s_mov_b64 exec, -1
  s_add_u32 s46, s46, 1
  s_cmp_ge_u32 s46, 131072
  s_cbranch_scc1 SL_rec_abort
  s_waitcnt vmcnt(4)
  s_branch SL_m_013_c0
SL_m_013_ok0:
  v_smfmac_f32_16x16x64_bf16 v[64:67], v[48:51], a[0:7], v23
  v_max3_u32 v31, v52, v53, v54
  v_max_u32 v31, v31, v55
  v_cmp_eq_u32 vcc, -1, v31
  v_smfmac_f32_16x16x64_bf16 v[68:71], v[48:51], a[8:15], v23
  v_smfmac_f32_16x16x64_bf16 v[72:75], v[48:51], a[16:23], v23
  v_smfmac_f32_16x16x64_bf16 v[76:79], v[48:51], a[24:31], v23
  s_cbranch_vccz SL_m_13_ok1
  s_branch SL_m_13_x1
SL_m_013_ok1:
  v_smfmac_f32_16x16x64_bf16 v[64:67], v[52:55], a[48:55], v23
  v_max3_u32 v31, v60, v61, v62
  v_max_u32 v31, v31, v63
  v_cmp_eq_u32 vcc, -1, v31
  v_smfmac_f32_16x16x64_bf16 v[68:71], v[52:55], a[56:63], v23
  v_smfmac_f32_16x16x64_bf16 v[72:75], v[52:55], a[64:71], v23
  v_smfmac_f32_16x16x64_bf16 v[76:79], v[52:55], a[72:79], v23
  s_cbranch_vccz SL_m_03_ok3
  s_branch SL_m_03_x3
SL_m_013_ok3:
  v_smfmac_f32_16x16x64_bf16 v[64:67], v[60:63], a[144:151], v23
  v_max3_u32 v31, v48, v49, v50
  v_max_u32 v31, v31, v51
  v_cmp_eq_u32 vcc, -1, v31
  v_smfmac_f32_16x16x64_bf16 v[68:71], v[60:63], a[152:159], v23
  v_smfmac_f32_16x16x64_bf16 v[72:75], v[60:63], a[160:167], v23
  v_smfmac_f32_16x16x64_bf16 v[76:79], v[60:63], a[168:175], v23
  s_cbranch_vccz SL_m_01_ok0
  s_branch SL_m_01_x0
SL_m_023_c0:
  v_max3_u32 v31, v48, v49, v50
  v_max_u32 v31, v31, v51
  v_cmp_eq_u32 vcc, -1, v31
  s_cbranch_vccz SL_m_023_ok0
SL_m_023_x0:
  s_mov_b64 exec, vcc
  buffer_load_dwordx4 v[48:51], v3, s[4:7], s41 offen offset:0 sc1
  s_mov_b64 exec, -1
SL_m_023_c2:
  v_max3_u32 v31, v56, v57, v58
  v_max_u32 v31, v31, v59
  v_cmp_eq_u32 vcc, -1, v31
  s_cbranch_vccz SL_m_023_ok2
SL_m_023_x2:
  s_mov_b64 exec, vcc
  buffer_load_dwordx4 v[56:59], v3, s[4:7], s41 offen offset:2048 sc1
  s_mov_b64 exec, -1
SL_m_023_c3:
  v_max3_u32 v31, v60, v61, v62
  v_max_u32 v31, v31, v63
  v_cmp_eq_u32 vcc, -1, v31
  s_cbranch_vccz SL_m_023_ok3
SL_m_023_x3:
  s_mov_b64 exec, vcc
  buffer_load_dwordx4 v[60:63], v3, s[4:7], s41 offen offset:3072 sc1
  s_mov_b64 exec, -1
  s_add_u32 s46, s46, 1
  s_cmp_ge_u32 s46, 131072
  s_cbranch_scc1 SL_rec_abort
  s_waitcnt vmcnt(4)
  s_branch SL_m_023_c0
SL_m_023_ok0:
  v_smfmac_f32_16x16x64_bf16 v[64:67], v[48:51], a[0:7], v23
  v_max3_u32 v31, v56, v57, v58
  v_max_u32 v31, v31, v59
  v_cmp_eq_u32 vcc, -1, v31
  v_smfmac_f32_16x16x64_bf16 v[68:71], v[48:51], a[8:15], v23
  v_smfmac_f32_16x16x64_bf16 v[72:75], v[48:51], a[16:23], v23
  v_smfmac_f32_16x16x64_bf16 v[76:79], v[48:51], a[24:31], v23
  s_cbranch_vccz SL_m_23_ok2
  s_branch SL_m_23_x2
SL_m_023_ok2:
  v_smfmac_f32_16x16x64_bf16 v[64:67], v[56:59], a[96:103], v23
  v_max3_u32 v31, v60, v61, v62
  v_max_u32 v31, v31, v63
  v_cmp_eq_u32 vcc, -1, v31
  v_smfmac_f32_16x16x64_bf16 v[68:71], v[56:59], a[104:111], v23
  v_smfmac_f32_16x16x64_bf16 v[72:75], v[56:59], a[112:119], v23
  v_smfmac_f32_16x16x64_bf16 v[76:79], v[56:59], a[120:127], v23
  s_cbranch_vccz SL_m_03_ok3
  s_branch SL_m_03_x3
SL_m_023_ok3:
  v_smfmac_f32_16x16x64_bf16 v[64:67], v[60:63], a[144:151], v23
  v_max3_u32 v31, v48, v49, v50
  v_max_u32 v31, v31, v51
  v_cmp_eq_u32 vcc, -1, v31
  v_smfmac_f32_16x16x64_bf16 v[68:71], v[60:63], a[152:159], v23
  v_smfmac_f32_16x16x64_bf16 v[72:75], v[60:63], a[160:167], v23
  v_smfmac_f32_16x16x64_bf16 v[76:79], v[60:63], a[168:175], v23
  s_cbranch_vccz SL_m_02_ok0
  s_branch SL_m_02_x0
SL_m_123_c1:
  v_max3_u32 v31, v52, v53, v54
  v_max_u32 v31, v31, v55
  v_cmp_eq_u32 vcc, -1, v31
  s_cbranch_vccz SL_m_123_ok1
SL_m_123_x1:
  s_mov_b64 exec, vcc
  buffer_load_dwordx4 v[52:55], v3, s[4:7], s41 offen offset:1024 sc1
  s_mov_b64 exec, -1
SL_m_123_c2:
  v_max3_u32 v31, v56, v57, v58
  v_max_u32 v31, v31, v59
  v_cmp_eq_u32 vcc, -1, v31
  s_cbranch_vccz SL_m_123_ok2
SL_m_123_x2:
  s_mov_b64 exec, vcc
  buffer_load_dwordx4 v[56:59], v3, s[4:7], s41 offen offset:2048 sc1
  s_mov_b64 exec, -1
SL_m_123_c3:
  v_max3_u32 v31, v60, v61, v62
  v_max_u32 v31, v31, v63
  v_cmp_eq_u32 vcc, -1, v31
  s_cbranch_vccz SL_m_123_ok3
SL_m_123_x3:
  s_mov_b64 exec, vcc
  buffer_load_dwordx4 v[60:63], v3, s[4:7], s41 offen offset:3072 sc1
  s_mov_b64 exec, -1
  s_add_u32 s46, s46, 1
  s_cmp_ge_u32 s46, 131072
  s_cbranch_scc1 SL_rec_abort
  s_waitcnt vmcnt(4)
  s_branch SL_m_123_c1
SL_m_123_ok1:
  v_smfmac_f32_16x16x64_bf16 v[64:67], v[52:55], a[48:55], v23
  v_max3_u32 v31, v56, v57, v58
  v_max_u32 v31, v31, v59
  v_cmp_eq_u32 vcc, -1, v31
  v_smfmac_f32_16x16x64_bf16 v[68:71], v[52:55], a[56:63], v23
  v_smfmac_f32_16x16x64_bf16 v[72:75], v[52:55], a[64:71], v23
  v_smfmac_f32_16x16x64_bf16 v[76:79], v[52:55], a[72:79], v23
  s_cbranch_vccz SL_m_23_ok2
  s_branch SL_m_23_x2
SL_m_123_ok2:
  v_smfmac_f32_16x16x64_bf16 v[64:67], v[56:59], a[96:103], v23
  v_max3_u32 v31, v60, v61, v62
  v_max_u32 v31, v31, v63
  v_cmp_eq_u32 vcc, -1, v31
  v_smfmac_f32_16x16x64_bf16 v[68:71], v[56:59], a[104:111], v23
  v_smfmac_f32_16x16x64_bf16 v[72:75], v[56:59], a[112:119], v23
  v_smfmac_f32_16x16x64_bf16 v[76:79], v[56:59], a[120:127], v23
  s_cbranch_vccz SL_m_13_ok3
  s_branch SL_m_13_x3
SL_m_123_ok3:
  v_smfmac_f32_16x16x64_bf16 v[64:67], v[60:63], a[144:151], v23
  v_max3_u32 v31, v52, v53, v54
  v_max_u32 v31, v31, v55
  v_cmp_eq_u32 vcc, -1, v31
  v_smfmac_f32_16x16x64_bf16 v[68:71], v[60:63], a[152:159], v23
  v_smfmac_f32_16x16x64_bf16 v[72:75], v[60:63], a[160:167], v23
  v_smfmac_f32_16x16x64_bf16 v[76:79], v[60:63], a[168:175], v23
  s_cbranch_vccz SL_m_12_ok1
  s_branch SL_m_12_x1
SL_m_0123_c0:
  v_max3_u32 v31, v48, v49, v50
  v_max_u32 v31, v31, v51
  v_cmp_eq_u32 vcc, -1, v31
  s_cbranch_vccz SL_m_0123_ok0
SL_m_0123_x0:
  s_mov_b64 exec, vcc
  buffer_load_dwordx4 v[48:51], v3, s[4:7], s41 offen offset:0 sc1
  s_mov_b64 exec, -1
SL_m_0123_c1:
  v_max3_u32 v31, v52, v53, v54
  v_max_u32 v31, v31, v55
  v_cmp_eq_u32 vcc, -1, v31
  s_cbranch_vccz SL_m_0123_ok1
SL_m_0123_x1:
  s_mov_b64 exec, vcc
  buffer_load_dwordx4 v[52:55], v3, s[4:7], s41 offen offset:1024 sc1
  s_mov_b64 exec, -1
SL_m_0123_c2:
  v_max3_u32 v31, v56, v57, v58
  v_max_u32 v31, v31, v59
  v_cmp_eq_u32 vcc, -1, v31
  s_cbranch_vccz SL_m_0123_ok2
SL_m_0123_x2:
  s_mov_b64 exec, vcc
  buffer_load_dwordx4 v[56:59], v3, s[4:7], s41 offen offset:2048 sc1
  s_mov_b64 exec, -1
SL_m_0123_c3:
  v_max3_u32 v31, v60, v61, v62
  v_max_u32 v31, v31, v63
  v_cmp_eq_u32 vcc, -1, v31
  s_cbranch_vccz SL_m_0123_ok3
SL_m_0123_x3:
  s_mov_b64 exec, vcc
  buffer_load_dwordx4 v[60:63], v3, s[4:7], s41 offen offset:3072 sc1
  s_mov_b64 exec, -1
  s_add_u32 s46, s46, 1
  s_cmp_ge_u32 s46, 131072
  s_cbranch_scc1 SL_rec_abort
  s_waitcnt vmcnt(4)
  s_branch SL_m_0123_c0
SL_m_0123_ok0:
  v_smfmac_f32_16x16x64_bf16 v[64:67], v[48:51], a[0:7], v23
  v_max3_u32 v31, v52, v53, v54
  v_max_u32 v31, v31, v55
  v_cmp_eq_u32 vcc, -1, v31
  v_smfmac_f32_16x16x64_bf16 v[68:71], v[48:51], a[8:15], v23
  v_smfmac_f32_16x16x64_bf16 v[72:75], v[48:51], a[16:23], v23
  v_smfmac_f32_16x16x64_bf16 v[76:79], v[48:51], a[24:31], v23
  s_cbranch_vccz SL_m_123_ok1
  s_branch SL_m_123_x1
SL_m_0123_ok1:
  v_smfmac_f32_16x16x64_bf16 v[64:67], v[52:55], a[48:55], v23
  v_max3_u32 v31, v56, v57, v58
  v_max_u32 v31, v31, v59
  v_cmp_eq_u32 vcc, -1, v31
  v_smfmac_f32_16x16x64_bf16 v[68:71], v[52:55], a[56:63], v23
  v_smfmac_f32_16x16x64_bf16 v[72:75], v[52:55], a[64:71], v23
  v_smfmac_f32_16x16x64_bf16 v[76:79], v[52:55], a[72:79], v23
  s_cbranch_vccz SL_m_023_ok2
  s_branch SL_m_023_x2
SL_m_0123_ok2:
  v_smfmac_f32_16x16x64_bf16 v[64:67], v[56:59], a[96:103], v23
  v_max3_u32 v31, v60, v61, v62
  v_max_u32 v31, v31, v63
  v_cmp_eq_u32 vcc, -1, v31
  v_smfmac_f32_16x16x64_bf16 v[68:71], v[56:59], a[104:111], v23
  v_smfmac_f32_16x16x64_bf16 v[72:75], v[56:59], a[112:119], v23
  v_smfmac_f32_16x16x64_bf16 v[76:79], v[56:59], a[120:127], v23
  s_cbranch_vccz SL_m_013_ok3
  s_branch SL_m_013_x3
SL_m_0123_ok3:
  v_smfmac_f32_16x16x64_bf16 v[64:67], v[60:63], a[144:151], v23
  v_max3_u32 v31, v48, v49, v50
  v_max_u32 v31, v31, v51
  v_cmp_eq_u32 vcc, -1, v31
  v_smfmac_f32_16x16x64_bf16 v[68:71], v[60:63], a[152:159], v23
  v_smfmac_f32_16x16x64_bf16 v[72:75], v[60:63], a[160:167], v23
  v_smfmac_f32_16x16x64_bf16 v[76:79], v[60:63], a[168:175], v23
  s_cbranch_vccz SL_m_012_ok0
  s_branch SL_m_012_x0
SL_x_f0:
  s_mov_b64 exec, vcc
  buffer_load_dwordx4 v[64:67], v9, s[4:7], s41 offen offset:0 sc1
  s_mov_b64 exec, -1
  s_waitcnt vmcnt(2)
  s_branch SL_x_0123_c1
SL_x_f1:
  s_mov_b64 exec, vcc
  buffer_load_dwordx4 v[68:71], v9, s[4:7], s41 offen offset:1024 sc1
  s_mov_b64 exec, -1
  s_waitcnt vmcnt(2)
  s_branch SL_x_123_c2
SL_x_f2:
  s_mov_b64 exec, vcc
  buffer_load_dwordx4 v[72:75], v9, s[4:7], s41 offen offset:2048 sc1
  s_mov_b64 exec, -1
  s_waitcnt vmcnt(2)
  s_branch SL_x_23_c3
SL_x_f3:
  s_mov_b64 exec, vcc
  buffer_load_dwordx4 v[76:79], v9, s[4:7], s41 offen offset:3072 sc1
  s_mov_b64 exec, -1
  s_nop 7
  s_branch SL_x_3_c3
SL_x_0_c0:
  v_max3_u32 v31, v64, v65, v66
  v_max_u32 v31, v31, v67
  v_cmp_eq_u32 vcc, -1, v31
  s_cbranch_vccz SL_x_0_ok0
SL_x_0_x0:
  s_mov_b64 exec, vcc
  buffer_load_dwordx4 v[64:67], v9, s[4:7], s41 offen offset:0 sc1
  s_mov_b64 exec, -1
  s_add_u32 s46, s46, 1
  s_cmp_ge_u32 s46, 131072
  s_cbranch_scc1 SL_rec_abort
  s_waitcnt vmcnt(2)
  s_branch SL_x_0_c0
SL_x_0_ok0:
  v_mfma_f32_16x16x32_bf16 v[44:47], v[64:67], v[64:67], v[44:47]
  v_mfma_f32_16x16x32_bf16 v[36:39], v[116:119], v[64:67], v[36:39]
  v_mfma_f32_16x16x32_bf16 v[40:43], v[132:135], v[64:67], v[40:43]
  s_branch SL_x_done
SL_x_1_c1:
  v_max3_u32 v31, v68, v69, v70
  v_max_u32 v31, v31, v71
  v_cmp_eq_u32 vcc, -1, v31
  s_cbranch_vccz SL_x_1_ok1
SL_x_1_x1:
  s_mov_b64 exec, vcc
  buffer_load_dwordx4 v[68:71], v9, s[4:7], s41 offen offset:1024 sc1
  s_mov_b64 exec, -1
  s_add_u32 s46, s46, 1
  s_cmp_ge_u32 s46, 131072
  s_cbranch_scc1 SL_rec_abort
  s_waitcnt vmcnt(2)
  s_branch SL_x_1_c1
SL_x_1_ok1:
  v_mfma_f32_16x16x32_bf16 v[44:47], v[68:71], v[68:71], v[44:47]
  v_mfma_f32_16x16x32_bf16 v[36:39], v[120:123], v[68:71], v[36:39]
  v_mfma_f32_16x16x32_bf16 v[40:43], v[136:139], v[68:71], v[40:43]
  s_branch SL_x_done
SL_x_2_c2:
  v_max3_u32 v31, v72, v73, v74
  v_max_u32 v31, v31, v75
  v_cmp_eq_u32 vcc, -1, v31
  s_cbranch_vccz SL_x_2_ok2
SL_x_2_x2:
  s_mov_b64 exec, vcc
  buffer_load_dwordx4 v[72:75], v9, s[4:7], s41 offen offset:2048 sc1
  s_mov_b64 exec, -1
  s_add_u32 s46, s46, 1
  s_cmp_ge_u32 s46, 131072
  s_cbranch_scc1 SL_rec_abort
  s_waitcnt vmcnt(2)
  s_branch SL_x_2_c2
SL_x_2_ok2:
  v_mfma_f32_16x16x32_bf16 v[44:47], v[72:75], v[72:75], v[44:47]
  v_mfma_f32_16x16x32_bf16 v[36:39], v[124:127], v[72:75], v[36:39]
  v_mfma_f32_16x16x32_bf16 v[40:43], v[140:143], v[72:75], v[40:43]
  s_branch SL_x_done
SL_x_3_c3:
  v_max3_u32 v31, v76, v77, v78
  v_max_u32 v31, v31, v79
  v_cmp_eq_u32 vcc, -1, v31
  s_cbranch_vccz SL_x_3_ok3
SL_x_3_x3:
  s_mov_b64 exec, vcc
  buffer_load_dwordx4 v[76:79], v9, s[4:7], s41 offen offset:3072 sc1
  s_mov_b64 exec, -1
  s_add_u32 s46, s46, 1
  s_cmp_ge_u32 s46, 131072
  s_cbranch_scc1 SL_rec_abort
  s_waitcnt vmcnt(2)
  s_branch SL_x_3_c3
SL_x_3_ok3:
  v_mfma_f32_16x16x32_bf16 v[44:47], v[76:79], v[76:79], v[44:47]
  v_mfma_f32_16x16x32_bf16 v[36:39], v[128:131], v[76:79], v[36:39]
  v_mfma_f32_16x16x32_bf16 v[40:43], v[144:147], v[76:79], v[40:43]
  s_branch SL_x_done
SL_x_01_c0:
  v_max3_u32 v31, v64, v65, v66
  v_max_u32 v31, v31, v67
  v_cmp_eq_u32 vcc, -1, v31
  s_cbranch_vccz SL_x_01_ok0
SL_x_01_x0:
  s_mov_b64 exec, vcc
  buffer_load_dwordx4 v[64:67], v9, s[4:7], s41 offen offset:0 sc1
  s_mov_b64 exec, -1
SL_x_01_c1:
  v_max3_u32 v31, v68, v69, v70
  v_max_u32 v31, v31, v71
  v_cmp_eq_u32 vcc, -1, v31
  s_cbranch_vccz SL_x_01_ok1
SL_x_01_x1:
  s_mov_b64 exec, vcc
  buffer_load_dwordx4 v[68:71], v9, s[4:7], s41 offen offset:1024 sc1
  s_mov_b64 exec, -1
  s_add_u32 s46, s46, 1
  s_cmp_ge_u32 s46, 131072
  s_cbranch_scc1 SL_rec_abort
  s_waitcnt vmcnt(4)
  s_branch SL_x_01_c0
SL_x_01_ok0:
  v_mfma_f32_16x16x32_bf16 v[44:47], v[64:67], v[64:67], v[44:47]
  v_max3_u32 v31, v68, v69, v70
  v_max_u32 v31, v31, v71
  v_cmp_eq_u32 vcc, -1, v31
  v_mfma_f32_16x16x32_bf16 v[36:39], v[116:119], v[64:67], v[36:39]
  v_mfma_f32_16x16x32_bf16 v[40:43], v[132:135], v[64:67], v[40:43]
  s_cbranch_vccz SL_x_1_ok1
  s_branch SL_x_1_x1
SL_x_01_ok1:
  v_mfma_f32_16x16x32_bf16 v[44:47], v[68:71], v[68:71], v[44:47]
  v_max3_u32 v31, v64, v65, v66
  v_max_u32 v31, v31, v67
  v_cmp_eq_u32 vcc, -1, v31
  v_mfma_f32_16x16x32_bf16 v[36:39], v[120:123], v[68:71], v[36:39]
  v_mfma_f32_16x16x32_bf16 v[40:43], v[136:139], v[68:71], v[40:43]
  s_cbranch_vccz SL_x_0_ok0
  s_branch SL_x_0_x0
SL_x_02_c0:
  v_max3_u32 v31, v64, v65, v66
  v_max_u32 v31, v31, v67
  v_cmp_eq_u32 vcc, -1, v31
  s_cbranch_vccz SL_x_02_ok0
SL_x_02_x0:
  s_mov_b64 exec, vcc
  buffer_load_dwordx4 v[64:67], v9, s[4:7], s41 offen offset:0 sc1
  s_mov_b64 exec, -1
SL_x_02_c2:
  v_max3_u32 v31, v72, v73, v74
  v_max_u32 v31, v31, v75
  v_cmp_eq_u32 vcc, -1, v31
  s_cbranch_vccz SL_x_02_ok2
SL_x_02_x2:
  s_mov_b64 exec, vcc
  buffer_load_dwordx4 v[72:75], v9, s[4:7], s41 offen offset:2048 sc1
  s_mov_b64 exec, -1
  s_add_u32 s46, s46, 1
  s_cmp_ge_u32 s46, 131072
  s_cbranch_scc1 SL_rec_abort
  s_waitcnt vmcnt(4)
  s_branch SL_x_02_c0
SL_x_02_ok0:
  v_mfma_f32_16x16x32_bf16 v[44:47], v[64:67], v[64:67], v[44:47]
  v_max3_u32 v31, v72, v73, v74
  v_max_u32 v31, v31, v75
  v_cmp_eq_u32 vcc, -1, v31
  v_mfma_f32_16x16x32_bf16 v[36:39], v[116:119], v[64:67], v[36:39]
  v_mfma_f32_16x16x32_bf16 v[40:43], v[132:135], v[64:67], v[40:43]
  s_cbranch_vccz SL_x_2_ok2
  s_branch SL_x_2_x2
SL_x_02_ok2:
  v_mfma_f32_16x16x32_bf16 v[44:47], v[72:75], v[72:75], v[44:47]
  v_max3_u32 v31, v64, v65, v66
  v_max_u32 v31, v31, v67
  v_cmp_eq_u32 vcc, -1, v31
  v_mfma_f32_16x16x32_bf16 v[36:39], v[124:127], v[72:75], v[36:39]
  v_mfma_f32_16x16x32_bf16 v[40:43], v[140:143], v[72:75], v[40:43]
  s_cbranch_vccz SL_x_0_ok0
  s_branch SL_x_0_x0
SL_x_03_c0:
  v_max3_u32 v31, v64, v65, v66
  v_max_u32 v31, v31, v67
  v_cmp_eq_u32 vcc, -1, v31
  s_cbranch_vccz SL_x_03_ok0
SL_x_03_x0:
  s_mov_b64 exec, vcc
  buffer_load_dwordx4 v[64:67], v9, s[4:7], s41 offen offset:0 sc1
  s_mov_b64 exec, -1
SL_x_03_c3:
  v_max3_u32 v31, v76, v77, v78
  v_max_u32 v31, v31, v79
  v_cmp_eq_u32 vcc, -1, v31
  s_cbranch_vccz SL_x_03_ok3
SL_x_03_x3:
  s_mov_b64 exec, vcc
  buffer_load_dwordx4 v[76:79], v9, s[4:7], s41 offen offset:3072 sc1
  s_mov_b64 exec, -1
  s_add_u32 s46, s46, 1
  s_cmp_ge_u32 s46, 131072
  s_cbranch_scc1 SL_rec_abort
  s_waitcnt vmcnt(4)
  s_branch SL_x_03_c0
SL_x_03_ok0:
  v_mfma_f32_16x16x32_bf16 v[44:47], v[64:67], v[64:67], v[44:47]
  v_max3_u32 v31, v76, v77, v78
  v_max_u32 v31, v31, v79
  v_cmp_eq_u32 vcc, -1, v31
  v_mfma_f32_16x16x32_bf16 v[36:39], v[116:119], v[64:67], v[36:39]
  v_mfma_f32_16x16x32_bf16 v[40:43], v[132:135], v[64:67], v[40:43]
  s_cbranch_vccz SL_x_3_ok3
  s_branch SL_x_3_x3
SL_x_03_ok3:
  v_mfma_f32_16x16x32_bf16 v[44:47], v[76:79], v[76:79], v[44:47]
  v_max3_u32 v31, v64, v65, v66
  v_max_u32 v31, v31, v67
  v_cmp_eq_u32 vcc, -1, v31
  v_mfma_f32_16x16x32_bf16 v[36:39], v[128:131], v[76:79], v[36:39]
  v_mfma_f32_16x16x32_bf16 v[40:43], v[144:147], v[76:79], v[40:43]
  s_cbranch_vccz SL_x_0_ok0
  s_branch SL_x_0_x0
SL_x_12_c1:
  v_max3_u32 v31, v68, v69, v70
  v_max_u32 v31, v31, v71
  v_cmp_eq_u32 vcc, -1, v31
  s_cbranch_vccz SL_x_12_ok1
SL_x_12_x1:
  s_mov_b64 exec, vcc
  buffer_load_dwordx4 v[68:71], v9, s[4:7], s41 offen offset:1024 sc1
  s_mov_b64 exec, -1
SL_x_12_c2:
  v_max3_u32 v31, v72, v73, v74
  v_max_u32 v31, v31, v75
  v_cmp_eq_u32 vcc, -1, v31
  s_cbranch_vccz SL_x_12_ok2
SL_x_12_x2:
  s_mov_b64 exec, vcc
  buffer_load_dwordx4 v[72:75], v9, s[4:7], s41 offen offset:2048 sc1
  s_mov_b64 exec, -1
  s_add_u32 s46, s46, 1
  s_cmp_ge_u32 s46, 131072
  s_cbranch_scc1 SL_rec_abort
  s_waitcnt vmcnt(4)
  s_branch SL_x_12_c1
SL_x_12_ok1:
  v_mfma_f32_16x16x32_bf16 v[44:47], v[68:71], v[68:71], v[44:47]
  v_max3_u32 v31, v72, v73, v74
  v_max_u32 v31, v31, v75
  v_cmp_eq_u32 vcc, -1, v31
  v_mfma_f32_16x16x32_bf16 v[36:39], v[120:123], v[68:71], v[36:39]
  v_mfma_f32_16x16x32_bf16 v[40:43], v[136:139], v[68:71], v[40:43]
  s_cbranch_vccz SL_x_2_ok2
  s_branch SL_x_2_x2
SL_x_12_ok2:
  v_mfma_f32_16x16x32_bf16 v[44:47], v[72:75], v[72:75], v[44:47]
  v_max3_u32 v31, v68, v69, v70
  v_max_u32 v31, v31, v71
  v_cmp_eq_u32 vcc, -1, v31
  v_mfma_f32_16x16x32_bf16 v[36:39], v[124:127], v[72:75], v[36:39]
  v_mfma_f32_16x16x32_bf16 v[40:43], v[140:143], v[72:75], v[40:43]
  s_cbranch_vccz SL_x_1_ok1
  s_branch SL_x_1_x1
SL_x_13_c1:
  v_max3_u32 v31, v68, v69, v70
  v_max_u32 v31, v31, v71
  v_cmp_eq_u32 vcc, -1, v31
  s_cbranch_vccz SL_x_13_ok1
SL_x_13_x1:
  s_mov_b64 exec, vcc
  buffer_load_dwordx4 v[68:71], v9, s[4:7], s41 offen offset:1024 sc1
  s_mov_b64 exec, -1
SL_x_13_c3:
  v_max3_u32 v31, v76, v77, v78
  v_max_u32 v31, v31, v79
  v_cmp_eq_u32 vcc, -1, v31
  s_cbranch_vccz SL_x_13_ok3
SL_x_13_x3:
  s_mov_b64 exec, vcc
  buffer_load_dwordx4 v[76:79], v9, s[4:7], s41 offen offset:3072 sc1
  s_mov_b64 exec, -1
  s_add_u32 s46, s46, 1
  s_cmp_ge_u32 s46, 131072
  s_cbranch_scc1 SL_rec_abort
  s_waitcnt vmcnt(4)
  s_branch SL_x_13_c1
SL_x_13_ok1:
  v_mfma_f32_16x16x32_bf16 v[44:47], v[68:71], v[68:71], v[44:47]
  v_max3_u32 v31, v76, v77, v78
  v_max_u32 v31, v31, v79
  v_cmp_eq_u32 vcc, -1, v31
  v_mfma_f32_16x16x32_bf16 v[36:39], v[120:123], v[68:71], v[36:39]
  v_mfma_f32_16x16x32_bf16 v[40:43], v[136:139], v[68:71], v[40:43]
  s_cbranch_vccz SL_x_3_ok3
  s_branch SL_x_3_x3
SL_x_13_ok3:
  v_mfma_f32_16x16x32_bf16 v[44:47], v[76:79], v[76:79], v[44:47]
  v_max3_u32 v31, v68, v69, v70
  v_max_u32 v31, v31, v71
  v_cmp_eq_u32 vcc, -1, v31
  v_mfma_f32_16x16x32_bf16 v[36:39], v[128:131], v[76:79], v[36:39]
  v_mfma_f32_16x16x32_bf16 v[40:43], v[144:147], v[76:79], v[40:43]
  s_cbranch_vccz SL_x_1_ok1
  s_branch SL_x_1_x1
SL_x_23_c2:
  v_max3_u32 v31, v72, v73, v74
  v_max_u32 v31, v31, v75
  v_cmp_eq_u32 vcc, -1, v31
  s_cbranch_vccz SL_x_23_ok2
SL_x_23_x2:
  s_mov_b64 exec, vcc
  buffer_load_dwordx4 v[72:75], v9, s[4:7], s41 offen offset:2048 sc1
  s_mov_b64 exec, -1
SL_x_23_c3:
  v_max3_u32 v31, v76, v77, v78
  v_max_u32 v31, v31, v79
  v_cmp_eq_u32 vcc, -1, v31
  s_cbranch_vccz SL_x_23_ok3
SL_x_23_x3:
  s_mov_b64 exec, vcc
  buffer_load_dwordx4 v[76:79], v9, s[4:7], s41 offen offset:3072 sc1
  s_mov_b64 exec, -1
  s_add_u32 s46, s46, 1
  s_cmp_ge_u32 s46, 131072
  s_cbranch_scc1 SL_rec_abort
  s_waitcnt vmcnt(4)
  s_branch SL_x_23_c2
SL_x_23_ok2:
  v_mfma_f32_16x16x32_bf16 v[44:47], v[72:75], v[72:75], v[44:47]
  v_max3_u32 v31, v76, v77, v78
  v_max_u32 v31, v31, v79
  v_cmp_eq_u32 vcc, -1, v31
  v_mfma_f32_16x16x32_bf16 v[36:39], v[124:127], v[72:75], v[36:39]
  v_mfma_f32_16x16x32_bf16 v[40:43], v[140:143], v[72:75], v[40:43]
  s_cbranch_vccz SL_x_3_ok3
  s_branch SL_x_3_x3
SL_x_23_ok3:
  v_mfma_f32_16x16x32_bf16 v[44:47], v[76:79], v[76:79], v[44:47]
  v_max3_u32 v31, v72, v73, v74
  v_max_u32 v31, v31, v75
  v_cmp_eq_u32 vcc, -1, v31
  v_mfma_f32_16x16x32_bf16 v[36:39], v[128:131], v[76:79], v[36:39]
  v_mfma_f32_16x16x32_bf16 v[40:43], v[144:147], v[76:79], v[40:43]
  s_cbranch_vccz SL_x_2_ok2
  s_branch SL_x_2_x2
SL_x_012_c0:
  v_max3_u32 v31, v64, v65, v66
  v_max_u32 v31, v31, v67
  v_cmp_eq_u32 vcc, -1, v31
  s_cbranch_vccz SL_x_012_ok0
SL_x_012_x0:
  s_mov_b64 exec, vcc
  buffer_load_dwordx4 v[64:67], v9, s[4:7], s41 offen offset:0 sc1
  s_mov_b64 exec, -1
SL_x_012_c1:
  v_max3_u32 v31, v68, v69, v70
  v_max_u32 v31, v31, v71
  v_cmp_eq_u32 vcc, -1, v31
  s_cbranch_vccz SL_x_012_ok1
SL_x_012_x1:
  s_mov_b64 exec, vcc
  buffer_load_dwordx4 v[68:71], v9, s[4:7], s41 offen offset:1024 sc1
  s_mov_b64 exec, -1
SL_x_012_c2:
  v_max3_u32 v31, v72, v73, v74
  v_max_u32 v31, v31, v75
  v_cmp_eq_u32 vcc, -1, v31
  s_cbranch_vccz SL_x_012_ok2
SL_x_012_x2:
  s_mov_b64 exec, vcc
  buffer_load_dwordx4 v[72:75], v9, s[4:7], s41 offen offset:2048 sc1
  s_mov_b64 exec, -1
  s_add_u32 s46, s46, 1
  s_cmp_ge_u32 s46, 131072
  s_cbranch_scc1 SL_rec_abort
  s_waitcnt vmcnt(4)
  s_branch SL_x_012_c0
SL_x_012_ok0:
  v_mfma_f32_16x16x32_bf16 v[44:47], v[64:67], v[64:67], v[44:47]
  v_max3_u32 v31, v68, v69, v70
  v_max_u32 v31, v31, v71
  v_cmp_eq_u32 vcc, -1, v31
  v_mfma_f32_16x16x32_bf16 v[36:39], v[116:119], v[64:67], v[36:39]
  v_mfma_f32_16x16x32_bf16 v[40:43], v[132:135], v[64:67], v[40:43]
  s_cbranch_vccz SL_x_12_ok1
  s_branch SL_x_12_x1
SL_x_012_ok1:
  v_mfma_f32_16x16x32_bf16 v[44:47], v[68:71], v[68:71], v[44:47]
  v_max3_u32 v31, v72, v73, v74
  v_max_u32 v31, v31, v75
  v_cmp_eq_u32 vcc, -1, v31
  v_mfma_f32_16x16x32_bf16 v[36:39], v[120:123], v[68:71], v[36:39]
  v_mfma_f32_16x16x32_bf16 v[40:43], v[136:139], v[68:71], v[40:43]
  s_cbranch_vccz SL_x_02_ok2
  s_branch SL_x_02_x2
SL_x_012_ok2:
  v_mfma_f32_16x16x32_bf16 v[44:47], v[72:75], v[72:75], v[44:47]
  v_max3_u32 v31, v64, v65, v66
  v_max_u32 v31, v31, v67
  v_cmp_eq_u32 vcc, -1, v31
  v_mfma_f32_16x16x32_bf16 v[36:39], v[124:127], v[72:75], v[36:39]
  v_mfma_f32_16x16x32_bf16 v[40:43], v[140:143], v[72:75], v[40:43]
  s_cbranch_vccz SL_x_01_ok0
  s_branch SL_x_01_x0
SL_x_013_c0:
  v_max3_u32 v31, v64, v65, v66
  v_max_u32 v31, v31, v67
  v_cmp_eq_u32 vcc, -1, v31
  s_cbranch_vccz SL_x_013_ok0
SL_x_013_x0:
  s_mov_b64 exec, vcc
  buffer_load_dwordx4 v[64:67], v9, s[4:7], s41 offen offset:0 sc1
  s_mov_b64 exec, -1
SL_x_013_c1:
  v_max3_u32 v31, v68, v69, v70
  v_max_u32 v31, v31, v71
  v_cmp_eq_u32 vcc, -1, v31
  s_cbranch_vccz SL_x_013_ok1
SL_x_013_x1:
  s_mov_b64 exec, vcc
  buffer_load_dwordx4 v[68:71], v9, s[4:7], s41 offen offset:1024 sc1
  s_mov_b64 exec, -1
SL_x_013_c3:
  v_max3_u32 v31, v76, v77, v78
  v_max_u32 v31, v31, v79
  v_cmp_eq_u32 vcc, -1, v31
  s_cbranch_vccz SL_x_013_ok3
SL_x_013_x3:
  s_mov_b64 exec, vcc
  buffer_load_dwordx4 v[76:79], v9, s[4:7], s41 offen offset:3072 sc1
  s_mov_b64 exec, -1
  s_add_u32 s46, s46, 1
  s_cmp_ge_u32 s46, 131072
  s_cbranch_scc1 SL_rec_abort
  s_waitcnt vmcnt(4)
  s_branch SL_x_013_c0
SL_x_013_ok0:
  v_mfma_f32_16x16x32_bf16 v[44:47], v[64:67], v[64:67], v[44:47]
  v_max3_u32 v31, v68, v69, v70
  v_max_u32 v31, v31, v71
  v_cmp_eq_u32 vcc, -1, v31
  v_mfma_f32_16x16x32_bf16 v[36:39], v[116:119], v[64:67], v[36:39]
  v_mfma_f32_16x16x32_bf16 v[40:43], v[132:135], v[64:67], v[40:43]
  s_cbranch_vccz SL_x_13_ok1
  s_branch SL_x_13_x1
SL_x_013_ok1:
  v_mfma_f32_16x16x32_bf16 v[44:47], v[68:71], v[68:71], v[44:47]
  v_max3_u32 v31, v76, v77, v78
  v_max_u32 v31, v31, v79
  v_cmp_eq_u32 vcc, -1, v31
  v_mfma_f32_16x16x32_bf16 v[36:39], v[120:123], v[68:71], v[36:39]
  v_mfma_f32_16x16x32_bf16 v[40:43], v[136:139], v[68:71], v[40:43]
  s_cbranch_vccz SL_x_03_ok3
  s_branch SL_x_03_x3
SL_x_013_ok3:
  v_mfma_f32_16x16x32_bf16 v[44:47], v[76:79], v[76:79], v[44:47]
  v_max3_u32 v31, v64, v65, v66
  v_max_u32 v31, v31, v67
  v_cmp_eq_u32 vcc, -1, v31
  v_mfma_f32_16x16x32_bf16 v[36:39], v[128:131], v[76:79], v[36:39]
  v_mfma_f32_16x16x32_bf16 v[40:43], v[144:147], v[76:79], v[40:43]
  s_cbranch_vccz SL_x_01_ok0
  s_branch SL_x_01_x0
SL_x_023_c0:
  v_max3_u32 v31, v64, v65, v66
  v_max_u32 v31, v31, v67
  v_cmp_eq_u32 vcc, -1, v31
  s_cbranch_vccz SL_x_023_ok0
SL_x_023_x0:
  s_mov_b64 exec, vcc
  buffer_load_dwordx4 v[64:67], v9, s[4:7], s41 offen offset:0 sc1
  s_mov_b64 exec, -1
SL_x_023_c2:
  v_max3_u32 v31, v72, v73, v74
  v_max_u32 v31, v31, v75
  v_cmp_eq_u32 vcc, -1, v31
  s_cbranch_vccz SL_x_023_ok2
SL_x_023_x2:
  s_mov_b64 exec, vcc
  buffer_load_dwordx4 v[72:75], v9, s[4:7], s41 offen offset:2048 sc1
  s_mov_b64 exec, -1
SL_x_023_c3:
  v_max3_u32 v31, v76, v77, v78
  v_max_u32 v31, v31, v79
  v_cmp_eq_u32 vcc, -1, v31
  s_cbranch_vccz SL_x_023_ok3
SL_x_023_x3:
  s_mov_b64 exec, vcc
  buffer_load_dwordx4 v[76:79], v9, s[4:7], s41 offen offset:3072 sc1
  s_mov_b64 exec, -1
  s_add_u32 s46, s46, 1
  s_cmp_ge_u32 s46, 131072
  s_cbranch_scc1 SL_rec_abort
  s_waitcnt vmcnt(4)
  s_branch SL_x_023_c0
SL_x_023_ok0:
  v_mfma_f32_16x16x32_bf16 v[44:47], v[64:67], v[64:67], v[44:47]
  v_max3_u32 v31, v72, v73, v74
  v_max_u32 v31, v31, v75
  v_cmp_eq_u32 vcc, -1, v31
  v_mfma_f32_16x16x32_bf16 v[36:39], v[116:119], v[64:67], v[36:39]
  v_mfma_f32_16x16x32_bf16 v[40:43], v[132:135], v[64:67], v[40:43]
  s_cbranch_vccz SL_x_23_ok2
  s_branch SL_x_23_x2
SL_x_023_ok2:
  v_mfma_f32_16x16x32_bf16 v[44:47], v[72:75], v[72:75], v[44:47]
  v_max3_u32 v31, v76, v77, v78
  v_max_u32 v31, v31, v79
  v_cmp_eq_u32 vcc, -1, v31
  v_mfma_f32_16x16x32_bf16 v[36:39], v[124:127], v[72:75], v[36:39]
  v_mfma_f32_16x16x32_bf16 v[40:43], v[140:143], v[72:75], v[40:43]
  s_cbranch_vccz SL_x_03_ok3
  s_branch SL_x_03_x3
SL_x_023_ok3:
  v_mfma_f32_16x16x32_bf16 v[44:47], v[76:79], v[76:79], v[44:47]
  v_max3_u32 v31, v64, v65, v66
  v_max_u32 v31, v31, v67
  v_cmp_eq_u32 vcc, -1, v31
  v_mfma_f32_16x16x32_bf16 v[36:39], v[128:131], v[76:79], v[36:39]
  v_mfma_f32_16x16x32_bf16 v[40:43], v[144:147], v[76:79], v[40:43]
  s_cbranch_vccz SL_x_02_ok0
  s_branch SL_x_02_x0
SL_x_123_c1:
  v_max3_u32 v31, v68, v69, v70
  v_max_u32 v31, v31, v71
  v_cmp_eq_u32 vcc, -1, v31
  s_cbranch_vccz SL_x_123_ok1
SL_x_123_x1:
  s_mov_b64 exec, vcc
  buffer_load_dwordx4 v[68:71], v9, s[4:7], s41 offen offset:1024 sc1
  s_mov_b64 exec, -1
SL_x_123_c2:
  v_max3_u32 v31, v72, v73, v74
  v_max_u32 v31, v31, v75
  v_cmp_eq_u32 vcc, -1, v31
  s_cbranch_vccz SL_x_123_ok2
SL_x_123_x2:
  s_mov_b64 exec, vcc
  buffer_load_dwordx4 v[72:75], v9, s[4:7], s41 offen offset:2048 sc1
  s_mov_b64 exec, -1
SL_x_123_c3:
  v_max3_u32 v31, v76, v77, v78
  v_max_u32 v31, v31, v79
  v_cmp_eq_u32 vcc, -1, v31
  s_cbranch_vccz SL_x_123_ok3
SL_x_123_x3:
  s_mov_b64 exec, vcc
  buffer_load_dwordx4 v[76:79], v9, s[4:7], s41 offen offset:3072 sc1
  s_mov_b64 exec, -1
  s_add_u32 s46, s46, 1
  s_cmp_ge_u32 s46, 131072
  s_cbranch_scc1 SL_rec_abort
  s_waitcnt vmcnt(4)
  s_branch SL_x_123_c1
SL_x_123_ok1:
  v_mfma_f32_16x16x32_bf16 v[44:47], v[68:71], v[68:71], v[44:47]
  v_max3_u32 v31, v72, v73, v74
  v_max_u32 v31, v31, v75
  v_cmp_eq_u32 vcc, -1, v31
  v_mfma_f32_16x16x32_bf16 v[36:39], v[120:123], v[68:71], v[36:39]
  v_mfma_f32_16x16x32_bf16 v[40:43], v[136:139], v[68:71], v[40:43]
  s_cbranch_vccz SL_x_23_ok2
  s_branch SL_x_23_x2
SL_x_123_ok2:
  v_mfma_f32_16x16x32_bf16 v[44:47], v[72:75], v[72:75], v[44:47]
  v_max3_u32 v31, v76, v77, v78
  v_max_u32 v31, v31, v79
  v_cmp_eq_u32 vcc, -1, v31
  v_mfma_f32_16x16x32_bf16 v[36:39], v[124:127], v[72:75], v[36:39]
  v_mfma_f32_16x16x32_bf16 v[40:43], v[140:143], v[72:75], v[40:43]
  s_cbranch_vccz SL_x_13_ok3
  s_branch SL_x_13_x3
SL_x_123_ok3:
  v_mfma_f32_16x16x32_bf16 v[44:47], v[76:79], v[76:79], v[44:47]
  v_max3_u32 v31, v68, v69, v70
  v_max_u32 v31, v31, v71
  v_cmp_eq_u32 vcc, -1, v31
  v_mfma_f32_16x16x32_bf16 v[36:39], v[128:131], v[76:79], v[36:39]
  v_mfma_f32_16x16x32_bf16 v[40:43], v[144:147], v[76:79], v[40:43]
  s_cbranch_vccz SL_x_12_ok1
  s_branch SL_x_12_x1
SL_x_0123_c0:
  v_max3_u32 v31, v64, v65, v66
  v_max_u32 v31, v31, v67
  v_cmp_eq_u32 vcc, -1, v31
  s_cbranch_vccz SL_x_0123_ok0
SL_x_0123_x0:
  s_mov_b64 exec, vcc
  buffer_load_dwordx4 v[64:67], v9, s[4:7], s41 offen offset:0 sc1
  s_mov_b64 exec, -1
SL_x_0123_c1:
  v_max3_u32 v31, v68, v69, v70
  v_max_u32 v31, v31, v71
  v_cmp_eq_u32 vcc, -1, v31
  s_cbranch_vccz SL_x_0123_ok1
SL_x_0123_x1:
  s_mov_b64 exec, vcc
  buffer_load_dwordx4 v[68:71], v9, s[4:7], s41 offen offset:1024 sc1
  s_mov_b64 exec, -1
SL_x_0123_c2:
  v_max3_u32 v31, v72, v73, v74
  v_max_u32 v31, v31, v75
  v_cmp_eq_u32 vcc, -1, v31
  s_cbranch_vccz SL_x_0123_ok2
SL_x_0123_x2:
  s_mov_b64 exec, vcc
  buffer_load_dwordx4 v[72:75], v9, s[4:7], s41 offen offset:2048 sc1
  s_mov_b64 exec, -1
SL_x_0123_c3:
  v_max3_u32 v31, v76, v77, v78
  v_max_u32 v31, v31, v79
  v_cmp_eq_u32 vcc, -1, v31
  s_cbranch_vccz SL_x_0123_ok3
SL_x_0123_x3:
  s_mov_b64 exec, vcc
  buffer_load_dwordx4 v[76:79], v9, s[4:7], s41 offen offset:3072 sc1
  s_mov_b64 exec, -1
  s_add_u32 s46, s46, 1
  s_cmp_ge_u32 s46, 131072
  s_cbranch_scc1 SL_rec_abort
  s_waitcnt vmcnt(4)
  s_branch SL_x_0123_c0
SL_x_0123_ok0:
  v_mfma_f32_16x16x32_bf16 v[44:47], v[64:67], v[64:67], v[44:47]
  v_max3_u32 v31, v68, v69, v70
  v_max_u32 v31, v31, v71
  v_cmp_eq_u32 vcc, -1, v31
  v_mfma_f32_16x16x32_bf16 v[36:39], v[116:119], v[64:67], v[36:39]
  v_mfma_f32_16x16x32_bf16 v[40:43], v[132:135], v[64:67], v[40:43]
  s_cbranch_vccz SL_x_123_ok1
  s_branch SL_x_123_x1
SL_x_0123_ok1:
  v_mfma_f32_16x16x32_bf16 v[44:47], v[68:71], v[68:71], v[44:47]
  v_max3_u32 v31, v72, v73, v74
  v_max_u32 v31, v31, v75
  v_cmp_eq_u32 vcc, -1, v31
  v_mfma_f32_16x16x32_bf16 v[36:39], v[120:123], v[68:71], v[36:39]
  v_mfma_f32_16x16x32_bf16 v[40:43], v[136:139], v[68:71], v[40:43]
  s_cbranch_vccz SL_x_023_ok2
  s_branch SL_x_023_x2
SL_x_0123_ok2:
  v_mfma_f32_16x16x32_bf16 v[44:47], v[72:75], v[72:75], v[44:47]
  v_max3_u32 v31, v76, v77, v78
  v_max_u32 v31, v31, v79
  v_cmp_eq_u32 vcc, -1, v31
  v_mfma_f32_16x16x32_bf16 v[36:39], v[124:127], v[72:75], v[36:39]
  v_mfma_f32_16x16x32_bf16 v[40:43], v[140:143], v[72:75], v[40:43]
  s_cbranch_vccz SL_x_013_ok3
  s_branch SL_x_013_x3
SL_x_0123_ok3:
  v_mfma_f32_16x16x32_bf16 v[44:47], v[76:79], v[76:79], v[44:47]
  v_max3_u32 v31, v64, v65, v66
  v_max_u32 v31, v31, v67
  v_cmp_eq_u32 vcc, -1, v31
  v_mfma_f32_16x16x32_bf16 v[36:39], v[128:131], v[76:79], v[36:39]
  v_mfma_f32_16x16x32_bf16 v[40:43], v[144:147], v[76:79], v[40:43]
  s_cbranch_vccz SL_x_012_ok0
  s_branch SL_x_012_x0
SL_v_f:
  buffer_load_dwordx4 v[88:91], v10, s[4:7], s41 offen offset:0 sc1
  buffer_load_dwordx4 v[92:95], v10, s[4:7], s41 offen offset:1024 sc1
  s_add_u32 s46, s46, 1
  s_cmp_ge_u32 s46, 131072
  s_cbranch_scc1 SL_rec_abort
  s_waitcnt vmcnt(0)
  v_max3_u32 v31, v88, v89, v90
  v_max3_u32 v31, v31, v91, v92
  v_max3_u32 v31, v31, v93, v94
  v_max_u32 v31, v31, v95
  v_cmp_eq_u32 vcc, -1, v31
  s_cbranch_vccnz SL_v_f
  s_branch SL_v_ok
SL_rec_abort:
  s_waitcnt vmcnt(0)
  s_endpgm
L_join:
  s_load_dwordx16 s[64:79], s[0:1], 0
  s_mov_b32 s39, 1
  s_cmp_lg_u32 s32, 0
  s_cbranch_scc1 L_rq_1
  s_cmp_eq_u32 s39, 0
  s_cbranch_scc1 L_rq_1
  s_lshl_b32 s99, s33, 7
  s_add_u32 s99, s99, 0x3d00200
  v_mov_b32 v244, 1
  v_mov_b32 v245, 0
  s_mov_b64 exec, 1
  buffer_atomic_add v244, v245, s[4:7], s99 offen sc0 sc1
  s_mov_b64 exec, -1
L_rq_1:
  v_mbcnt_lo_u32_b32 v0, -1, 0
  v_mbcnt_hi_u32_b32 v0, -1, v0
  s_lshl_b32 s90, s32, 6
  v_add_u32 v0, s90, v0
  s_lshl_b32 s40, s33, 5
  s_add_u32 s40, s40, 128
  s_mov_b32 s39, 1
  s_barrier
  s_branch L_worker1
L_worker:
  s_mov_b32 s39, 0
L_worker1:
  s_load_dwordx4 s[80:83], s[0:1], 64
  s_load_dwordx2 s[84:85], s[0:1], 80
  s_sub_u32 s33, s40, 128
  s_lshr_b32 s33, s33, 5
  s_and_b32 s34, s40, 31
  s_getpc_b64 s[86:87]
L_pc:
  s_add_u32 s86, s86, L_table-L_pc
  s_addc_u32 s87, s87, 0
  s_waitcnt lgkmcnt(0)
  s_mov_b32 s16, s84
  s_and_b32 s17, s85, 0xffff
  s_mov_b32 s18, 0x800000
  s_mov_b32 s19, 0x20000
  s_mov_b32 s8, s64
  s_and_b32 s9, s65, 0xffff
  s_mov_b32 s10, 0x400000
  s_mov_b32 s11, 0x20000
  s_mov_b32 s12, s70
  s_and_b32 s13, s71, 0xffff
  s_mov_b32 s14, 0x800000
  s_mov_b32 s15, 0x20000
  v_mov_b32 v1, 0
  v_mov_b32 v2, 0
  v_mov_b32 v3, 0
  v_mov_b32 v4, 0
  v_mov_b32 v5, 0
  v_mov_b32 v6, 0
  v_mov_b32 v7, 0
  v_mov_b32 v8, 0
  v_mov_b32 v9, 0
  v_mov_b32 v10, 0
  v_mov_b32 v11, 0
  v_mov_b32 v12, 0
  v_mov_b32 v13, 0
  v_mov_b32 v14, 0
  v_mov_b32 v15, 0
  v_mov_b32 v16, 0
  v_mov_b32 v17, 0
  v_mov_b32 v172, 0
  v_mov_b32 v173, 0
  s_mov_b32 s59, 0
  s_cmp_eq_u32 s39, 0
  s_cbranch_scc1 L_have
  s_branch L_next1
L_next:
  s_cmp_lg_u32 s32, 0
  s_cbranch_scc1 L_rq_2
  s_cmp_eq_u32 s39, 0
  s_cbranch_scc1 L_rq_2
  s_lshl_b32 s99, s33, 7
  s_add_u32 s99, s99, 0x3d00200
  v_mov_b32 v244, 1
  v_mov_b32 v245, 0
  s_mov_b64 exec, 1
  buffer_atomic_add v244, v245, s[4:7], s99 offen sc0 sc1
  s_mov_b64 exec, -1
L_rq_2:
L_next1:
  s_waitcnt vmcnt(0)
L_got:
  s_cmp_lg_u32 s32, 0
  s_cbranch_scc1 L_nx1
  v_mov_b32 v245, 147456
  s_mov_b64 exec, 1
  ds_write_b32 v245, v244
  s_mov_b64 exec, -1
  s_waitcnt lgkmcnt(0)
L_nx1:
  s_barrier
  v_mov_b32 v245, 147456
  ds_read_b32 v246, v245
  s_waitcnt lgkmcnt(0)
  v_min_u32 v245, 270, v246
  v_lshlrev_b32 v245, 2, v245
  v_add_u32 v245, 147648, v245
  ds_read_b32 v245, v245
  v_readfirstlane_b32 s34, v246
  s_add_u32 s34, s34, 32
  s_waitcnt lgkmcnt(0)
  v_readfirstlane_b32 s91, v245
  s_branch L_have1
L_have:
  s_lshl_b32 s90, s34, 2
  s_load_dword s91, s[86:87], s90
  s_waitcnt lgkmcnt(0)
L_have1:
  s_mov_b32 s98, 1
  s_and_b32 s35, s91, 255
  s_lshr_b32 s36, s91, 8
  s_and_b32 s36, s36, 255
  s_lshr_b32 s37, s91, 16
  s_cmp_eq_u32 s35, 0
  s_cbranch_scc1 L_aqkv
  s_cmp_eq_u32 s35, 1
  s_cbranch_scc1 L_aqkv
  s_cmp_eq_u32 s35, 2
  s_cbranch_scc1 L_aqkv
  s_cmp_eq_u32 s35, 3
  s_cbranch_scc1 L_bqkv
  s_cmp_eq_u32 s35, 9
  s_cbranch_scc1 L_small
  s_cmp_eq_u32 s35, 10
  s_cbranch_scc1 L_small
  s_mov_b32 s58, 0
L_epi:
  s_mov_b32 s46, 0x40000000
  s_mov_b32 s47, 0x40000000
  s_mov_b32 s49, 0
  s_cmp_eq_u32 s58, 1
  s_cselect_b64 vcc, -1, 0
  s_cmp_eq_u32 s59, 0
  s_cbranch_scc1 L_epid
  s_cmp_lg_u32 s59, 1
  s_cbranch_scc1 L_e0
  s_lshr_b32 s90, s27, 1
  s_and_b32 s91, s27, 1
  v_mov_b32 v172, 0x0
  v_bfe_u32 v45, v1, 0, 6
  v_lshl_add_u32 v172, v45, 4, v172
  v_add_u32 v173, 4096, v172
  s_mul_i32 s92, s90, 4
  s_mul_i32 s92, s92, s61
  s_add_u32 s92, s92, s60
  s_mul_i32 s93, s91, 8192
  s_add_u32 s92, s92, s93
  v_accvgpr_read_b32 v52, a0
  v_accvgpr_read_b32 v53, a4
  v_accvgpr_read_b32 v54, a1
  v_accvgpr_read_b32 v55, a5
  v_accvgpr_read_b32 v56, a2
  v_accvgpr_read_b32 v57, a6
  v_accvgpr_read_b32 v58, a3
  v_accvgpr_read_b32 v59, a7
  v_cvt_pk_bf16_f32 v48, v52, v53
  v_cvt_pk_bf16_f32 v49, v54, v55
  v_cvt_pk_bf16_f32 v50, v56, v57
  v_cvt_pk_bf16_f32 v51, v58, v59
  buffer_store_dwordx4 v[48:51], v172, s[4:7], s92 offen offset:0 sc1
  v_accvgpr_read_b32 v64, a128
  v_accvgpr_read_b32 v65, a132
  v_accvgpr_read_b32 v66, a129
  v_accvgpr_read_b32 v67, a133
  v_accvgpr_read_b32 v68, a130
  v_accvgpr_read_b32 v69, a134
  v_accvgpr_read_b32 v70, a131
  v_accvgpr_read_b32 v71, a135
  v_cvt_pk_bf16_f32 v176, v64, v65
  v_cvt_pk_bf16_f32 v177, v66, v67
  v_cvt_pk_bf16_f32 v178, v68, v69
  v_cvt_pk_bf16_f32 v179, v70, v71
  v_accvgpr_read_b32 v76, a8
  v_accvgpr_read_b32 v77, a12
  v_accvgpr_read_b32 v78, a9
  v_accvgpr_read_b32 v79, a13
  v_accvgpr_read_b32 v80, a10
  v_accvgpr_read_b32 v81, a14
  v_accvgpr_read_b32 v82, a11
  v_accvgpr_read_b32 v83, a15
  v_cvt_pk_bf16_f32 v72, v76, v77
  v_cvt_pk_bf16_f32 v73, v78, v79
  v_cvt_pk_bf16_f32 v74, v80, v81
  v_cvt_pk_bf16_f32 v75, v82, v83
  buffer_store_dwordx4 v[72:75], v172, s[4:7], s92 offen offset:1024 sc1
  v_accvgpr_read_b32 v88, a136
  v_accvgpr_read_b32 v89, a140
  v_accvgpr_read_b32 v90, a137
  v_accvgpr_read_b32 v91, a141
  v_accvgpr_read_b32 v92, a138
  v_accvgpr_read_b32 v93, a142
  v_accvgpr_read_b32 v94, a139
  v_accvgpr_read_b32 v95, a143
  v_cvt_pk_bf16_f32 v180, v88, v89
  v_cvt_pk_bf16_f32 v181, v90, v91
  v_cvt_pk_bf16_f32 v182, v92, v93
  v_cvt_pk_bf16_f32 v183, v94, v95
  v_accvgpr_read_b32 v52, a16
  v_accvgpr_read_b32 v53, a20
  v_accvgpr_read_b32 v54, a17
  v_accvgpr_read_b32 v55, a21
  v_accvgpr_read_b32 v56, a18
  v_accvgpr_read_b32 v57, a22
  v_accvgpr_read_b32 v58, a19
  v_accvgpr_read_b32 v59, a23
  v_cvt_pk_bf16_f32 v48, v52, v53
  v_cvt_pk_bf16_f32 v49, v54, v55
  v_cvt_pk_bf16_f32 v50, v56, v57
  v_cvt_pk_bf16_f32 v51, v58, v59
  buffer_store_dwordx4 v[48:51], v172, s[4:7], s92 offen offset:2048 sc1
  v_accvgpr_read_b32 v64, a144
  v_accvgpr_read_b32 v65, a148
  v_accvgpr_read_b32 v66, a145
  v_accvgpr_read_b32 v67, a149
  v_accvgpr_read_b32 v68, a146
  v_accvgpr_read_b32 v69, a150
  v_accvgpr_read_b32 v70, a147
  v_accvgpr_read_b32 v71, a151
  v_cvt_pk_bf16_f32 v184, v64, v65
  v_cvt_pk_bf16_f32 v185, v66, v67
  v_cvt_pk_bf16_f32 v186, v68, v69
  v_cvt_pk_bf16_f32 v187, v70, v71
  v_accvgpr_read_b32 v76, a24
  v_accvgpr_read_b32 v77, a28
  v_accvgpr_read_b32 v78, a25
  v_accvgpr_read_b32 v79, a29
  v_accvgpr_read_b32 v80, a26
  v_accvgpr_read_b32 v81, a30
  v_accvgpr_read_b32 v82, a27
  v_accvgpr_read_b32 v83, a31
  v_cvt_pk_bf16_f32 v72, v76, v77
  v_cvt_pk_bf16_f32 v73, v78, v79
  v_cvt_pk_bf16_f32 v74, v80, v81
  v_cvt_pk_bf16_f32 v75, v82, v83
  buffer_store_dwordx4 v[72:75], v172, s[4:7], s92 offen offset:3072 sc1
  v_accvgpr_read_b32 v88, a152
  v_accvgpr_read_b32 v89, a156
  v_accvgpr_read_b32 v90, a153
  v_accvgpr_read_b32 v91, a157
  v_accvgpr_read_b32 v92, a154
  v_accvgpr_read_b32 v93, a158
  v_accvgpr_read_b32 v94, a155
  v_accvgpr_read_b32 v95, a159
  v_cvt_pk_bf16_f32 v188, v88, v89
  v_cvt_pk_bf16_f32 v189, v90, v91
  v_cvt_pk_bf16_f32 v190, v92, v93
  v_cvt_pk_bf16_f32 v191, v94, v95
  v_accvgpr_read_b32 v52, a32
  v_accvgpr_read_b32 v53, a36
  v_accvgpr_read_b32 v54, a33
  v_accvgpr_read_b32 v55, a37
  v_accvgpr_read_b32 v56, a34
  v_accvgpr_read_b32 v57, a38
  v_accvgpr_read_b32 v58, a35
  v_accvgpr_read_b32 v59, a39
  v_cvt_pk_bf16_f32 v48, v52, v53
  v_cvt_pk_bf16_f32 v49, v54, v55
  v_cvt_pk_bf16_f32 v50, v56, v57
  v_cvt_pk_bf16_f32 v51, v58, v59
  buffer_store_dwordx4 v[48:51], v173, s[4:7], s92 offen offset:0 sc1
  v_accvgpr_read_b32 v64, a160
  v_accvgpr_read_b32 v65, a164
  v_accvgpr_read_b32 v66, a161
  v_accvgpr_read_b32 v67, a165
  v_accvgpr_read_b32 v68, a162
  v_accvgpr_read_b32 v69, a166
  v_accvgpr_read_b32 v70, a163
  v_accvgpr_read_b32 v71, a167
  v_cvt_pk_bf16_f32 v192, v64, v65
  v_cvt_pk_bf16_f32 v193, v66, v67
  v_cvt_pk_bf16_f32 v194, v68, v69
  v_cvt_pk_bf16_f32 v195, v70, v71
  v_accvgpr_read_b32 v76, a40
  v_accvgpr_read_b32 v77, a44
  v_accvgpr_read_b32 v78, a41
  v_accvgpr_read_b32 v79, a45
  v_accvgpr_read_b32 v80, a42
  v_accvgpr_read_b32 v81, a46
  v_accvgpr_read_b32 v82, a43
  v_accvgpr_read_b32 v83, a47
  v_cvt_pk_bf16_f32 v72, v76, v77
  v_cvt_pk_bf16_f32 v73, v78, v79
  v_cvt_pk_bf16_f32 v74, v80, v81
  v_cvt_pk_bf16_f32 v75, v82, v83
  buffer_store_dwordx4 v[72:75], v173, s[4:7], s92 offen offset:1024 sc1
  v_accvgpr_read_b32 v88, a168
  v_accvgpr_read_b32 v89, a172
  v_accvgpr_read_b32 v90, a169
  v_accvgpr_read_b32 v91, a173
  v_accvgpr_read_b32 v92, a170
  v_accvgpr_read_b32 v93, a174
  v_accvgpr_read_b32 v94, a171
  v_accvgpr_read_b32 v95, a175
  v_cvt_pk_bf16_f32 v196, v88, v89
  v_cvt_pk_bf16_f32 v197, v90, v91
  v_cvt_pk_bf16_f32 v198, v92, v93
  v_cvt_pk_bf16_f32 v199, v94, v95
  v_accvgpr_read_b32 v52, a48
  v_accvgpr_read_b32 v53, a52
  v_accvgpr_read_b32 v54, a49
  v_accvgpr_read_b32 v55, a53
  v_accvgpr_read_b32 v56, a50
  v_accvgpr_read_b32 v57, a54
  v_accvgpr_read_b32 v58, a51
  v_accvgpr_read_b32 v59, a55
  v_cvt_pk_bf16_f32 v48, v52, v53
  v_cvt_pk_bf16_f32 v49, v54, v55
  v_cvt_pk_bf16_f32 v50, v56, v57
  v_cvt_pk_bf16_f32 v51, v58, v59
  buffer_store_dwordx4 v[48:51], v173, s[4:7], s92 offen offset:2048 sc1
  v_accvgpr_read_b32 v64, a176
  v_accvgpr_read_b32 v65, a180
  v_accvgpr_read_b32 v66, a177
  v_accvgpr_read_b32 v67, a181
  v_accvgpr_read_b32 v68, a178
  v_accvgpr_read_b32 v69, a182
  v_accvgpr_read_b32 v70, a179
  v_accvgpr_read_b32 v71, a183
  v_cvt_pk_bf16_f32 v200, v64, v65
  v_cvt_pk_bf16_f32 v201, v66, v67
  v_cvt_pk_bf16_f32 v202, v68, v69
  v_cvt_pk_bf16_f32 v203, v70, v71
  v_accvgpr_read_b32 v76, a56
  v_accvgpr_read_b32 v77, a60
  v_accvgpr_read_b32 v78, a57
  v_accvgpr_read_b32 v79, a61
  v_accvgpr_read_b32 v80, a58
  v_accvgpr_read_b32 v81, a62
  v_accvgpr_read_b32 v82, a59
  v_accvgpr_read_b32 v83, a63
  v_cvt_pk_bf16_f32 v72, v76, v77
  v_cvt_pk_bf16_f32 v73, v78, v79
  v_cvt_pk_bf16_f32 v74, v80, v81
  v_cvt_pk_bf16_f32 v75, v82, v83
  buffer_store_dwordx4 v[72:75], v173, s[4:7], s92 offen offset:3072 sc1
  v_accvgpr_read_b32 v88, a184
  v_accvgpr_read_b32 v89, a188
  v_accvgpr_read_b32 v90, a185
  v_accvgpr_read_b32 v91, a189
  v_accvgpr_read_b32 v92, a186
  v_accvgpr_read_b32 v93, a190
  v_accvgpr_read_b32 v94, a187
  v_accvgpr_read_b32 v95, a191
  v_cvt_pk_bf16_f32 v204, v88, v89
  v_cvt_pk_bf16_f32 v205, v90, v91
  v_cvt_pk_bf16_f32 v206, v92, v93
  v_cvt_pk_bf16_f32 v207, v94, v95
  s_add_u32 s92, s92, s61
  v_accvgpr_read_b32 v52, a64
  v_accvgpr_read_b32 v53, a68
  v_accvgpr_read_b32 v54, a65
  v_accvgpr_read_b32 v55, a69
  v_accvgpr_read_b32 v56, a66
  v_accvgpr_read_b32 v57, a70
  v_accvgpr_read_b32 v58, a67
  v_accvgpr_read_b32 v59, a71
  v_cvt_pk_bf16_f32 v48, v52, v53
  v_cvt_pk_bf16_f32 v49, v54, v55
  v_cvt_pk_bf16_f32 v50, v56, v57
  v_cvt_pk_bf16_f32 v51, v58, v59
  buffer_store_dwordx4 v[48:51], v172, s[4:7], s92 offen offset:0 sc1
  v_accvgpr_read_b32 v64, a192
  v_accvgpr_read_b32 v65, a196
  v_accvgpr_read_b32 v66, a193
  v_accvgpr_read_b32 v67, a197
  v_accvgpr_read_b32 v68, a194
  v_accvgpr_read_b32 v69, a198
  v_accvgpr_read_b32 v70, a195
  v_accvgpr_read_b32 v71, a199
  v_cvt_pk_bf16_f32 v208, v64, v65
  v_cvt_pk_bf16_f32 v209, v66, v67
  v_cvt_pk_bf16_f32 v210, v68, v69
  v_cvt_pk_bf16_f32 v211, v70, v71
  v_accvgpr_read_b32 v76, a72
  v_accvgpr_read_b32 v77, a76
  v_accvgpr_read_b32 v78, a73
  v_accvgpr_read_b32 v79, a77
  v_accvgpr_read_b32 v80, a74
  v_accvgpr_read_b32 v81, a78
  v_accvgpr_read_b32 v82, a75
  v_accvgpr_read_b32 v83, a79
  v_cvt_pk_bf16_f32 v72, v76, v77
  v_cvt_pk_bf16_f32 v73, v78, v79
  v_cvt_pk_bf16_f32 v74, v80, v81
  v_cvt_pk_bf16_f32 v75, v82, v83
  buffer_store_dwordx4 v[72:75], v172, s[4:7], s92 offen offset:1024 sc1
  v_accvgpr_read_b32 v88, a200
  v_accvgpr_read_b32 v89, a204
  v_accvgpr_read_b32 v90, a201
  v_accvgpr_read_b32 v91, a205
  v_accvgpr_read_b32 v92, a202
  v_accvgpr_read_b32 v93, a206
  v_accvgpr_read_b32 v94, a203
  v_accvgpr_read_b32 v95, a207
  v_cvt_pk_bf16_f32 v212, v88, v89
  v_cvt_pk_bf16_f32 v213, v90, v91
  v_cvt_pk_bf16_f32 v214, v92, v93
  v_cvt_pk_bf16_f32 v215, v94, v95
  v_accvgpr_read_b32 v52, a80
  v_accvgpr_read_b32 v53, a84
  v_accvgpr_read_b32 v54, a81
  v_accvgpr_read_b32 v55, a85
  v_accvgpr_read_b32 v56, a82
  v_accvgpr_read_b32 v57, a86
  v_accvgpr_read_b32 v58, a83
  v_accvgpr_read_b32 v59, a87
  v_cvt_pk_bf16_f32 v48, v52, v53
  v_cvt_pk_bf16_f32 v49, v54, v55
  v_cvt_pk_bf16_f32 v50, v56, v57
  v_cvt_pk_bf16_f32 v51, v58, v59
  buffer_store_dwordx4 v[48:51], v172, s[4:7], s92 offen offset:2048 sc1
  v_accvgpr_read_b32 v64, a208
  v_accvgpr_read_b32 v65, a212
  v_accvgpr_read_b32 v66, a209
  v_accvgpr_read_b32 v67, a213
  v_accvgpr_read_b32 v68, a210
  v_accvgpr_read_b32 v69, a214
  v_accvgpr_read_b32 v70, a211
  v_accvgpr_read_b32 v71, a215
  v_cvt_pk_bf16_f32 v216, v64, v65
  v_cvt_pk_bf16_f32 v217, v66, v67
  v_cvt_pk_bf16_f32 v218, v68, v69
  v_cvt_pk_bf16_f32 v219, v70, v71
  v_accvgpr_read_b32 v76, a88
  v_accvgpr_read_b32 v77, a92
  v_accvgpr_read_b32 v78, a89
  v_accvgpr_read_b32 v79, a93
  v_accvgpr_read_b32 v80, a90
  v_accvgpr_read_b32 v81, a94
  v_accvgpr_read_b32 v82, a91
  v_accvgpr_read_b32 v83, a95
  v_cvt_pk_bf16_f32 v72, v76, v77
  v_cvt_pk_bf16_f32 v73, v78, v79
  v_cvt_pk_bf16_f32 v74, v80, v81
  v_cvt_pk_bf16_f32 v75, v82, v83
  buffer_store_dwordx4 v[72:75], v172, s[4:7], s92 offen offset:3072 sc1
  v_accvgpr_read_b32 v88, a216
  v_accvgpr_read_b32 v89, a220
  v_accvgpr_read_b32 v90, a217
  v_accvgpr_read_b32 v91, a221
  v_accvgpr_read_b32 v92, a218
  v_accvgpr_read_b32 v93, a222
  v_accvgpr_read_b32 v94, a219
  v_accvgpr_read_b32 v95, a223
  v_cvt_pk_bf16_f32 v220, v88, v89
  v_cvt_pk_bf16_f32 v221, v90, v91
  v_cvt_pk_bf16_f32 v222, v92, v93
  v_cvt_pk_bf16_f32 v223, v94, v95
  v_accvgpr_read_b32 v52, a96
  v_accvgpr_read_b32 v53, a100
  v_accvgpr_read_b32 v54, a97
  v_accvgpr_read_b32 v55, a101
  v_accvgpr_read_b32 v56, a98
  v_accvgpr_read_b32 v57, a102
  v_accvgpr_read_b32 v58, a99
  v_accvgpr_read_b32 v59, a103
  v_cvt_pk_bf16_f32 v48, v52, v53
  v_cvt_pk_bf16_f32 v49, v54, v55
  v_cvt_pk_bf16_f32 v50, v56, v57
  v_cvt_pk_bf16_f32 v51, v58, v59
  buffer_store_dwordx4 v[48:51], v173, s[4:7], s92 offen offset:0 sc1
  v_accvgpr_read_b32 v64, a224
  v_accvgpr_read_b32 v65, a228
  v_accvgpr_read_b32 v66, a225
  v_accvgpr_read_b32 v67, a229
  v_accvgpr_read_b32 v68, a226
  v_accvgpr_read_b32 v69, a230
  v_accvgpr_read_b32 v70, a227
  v_accvgpr_read_b32 v71, a231
  v_cvt_pk_bf16_f32 v224, v64, v65
  v_cvt_pk_bf16_f32 v225, v66, v67
  v_cvt_pk_bf16_f32 v226, v68, v69
  v_cvt_pk_bf16_f32 v227, v70, v71
  v_accvgpr_read_b32 v76, a104
  v_accvgpr_read_b32 v77, a108
  v_accvgpr_read_b32 v78, a105
  v_accvgpr_read_b32 v79, a109
  v_accvgpr_read_b32 v80, a106
  v_accvgpr_read_b32 v81, a110
  v_accvgpr_read_b32 v82, a107
  v_accvgpr_read_b32 v83, a111
  v_cvt_pk_bf16_f32 v72, v76, v77
  v_cvt_pk_bf16_f32 v73, v78, v79
  v_cvt_pk_bf16_f32 v74, v80, v81
  v_cvt_pk_bf16_f32 v75, v82, v83
  buffer_store_dwordx4 v[72:75], v173, s[4:7], s92 offen offset:1024 sc1
  v_accvgpr_read_b32 v88, a232
  v_accvgpr_read_b32 v89, a236
  v_accvgpr_read_b32 v90, a233
  v_accvgpr_read_b32 v91, a237
  v_accvgpr_read_b32 v92, a234
  v_accvgpr_read_b32 v93, a238
  v_accvgpr_read_b32 v94, a235
  v_accvgpr_read_b32 v95, a239
  v_cvt_pk_bf16_f32 v228, v88, v89
  v_cvt_pk_bf16_f32 v229, v90, v91
  v_cvt_pk_bf16_f32 v230, v92, v93
  v_cvt_pk_bf16_f32 v231, v94, v95
  v_accvgpr_read_b32 v52, a112
  v_accvgpr_read_b32 v53, a116
  v_accvgpr_read_b32 v54, a113
  v_accvgpr_read_b32 v55, a117
  v_accvgpr_read_b32 v56, a114
  v_accvgpr_read_b32 v57, a118
  v_accvgpr_read_b32 v58, a115
  v_accvgpr_read_b32 v59, a119
  v_cvt_pk_bf16_f32 v48, v52, v53
  v_cvt_pk_bf16_f32 v49, v54, v55
  v_cvt_pk_bf16_f32 v50, v56, v57
  v_cvt_pk_bf16_f32 v51, v58, v59
  buffer_store_dwordx4 v[48:51], v173, s[4:7], s92 offen offset:2048 sc1
  v_accvgpr_read_b32 v64, a240
  v_accvgpr_read_b32 v65, a244
  v_accvgpr_read_b32 v66, a241
  v_accvgpr_read_b32 v67, a245
  v_accvgpr_read_b32 v68, a242
  v_accvgpr_read_b32 v69, a246
  v_accvgpr_read_b32 v70, a243
  v_accvgpr_read_b32 v71, a247
  v_cvt_pk_bf16_f32 v232, v64, v65
  v_cvt_pk_bf16_f32 v233, v66, v67
  v_cvt_pk_bf16_f32 v234, v68, v69
  v_cvt_pk_bf16_f32 v235, v70, v71
  v_accvgpr_read_b32 v76, a120
  v_accvgpr_read_b32 v77, a124
  v_accvgpr_read_b32 v78, a121
  v_accvgpr_read_b32 v79, a125
  v_accvgpr_read_b32 v80, a122
  v_accvgpr_read_b32 v81, a126
  v_accvgpr_read_b32 v82, a123
  v_accvgpr_read_b32 v83, a127
  v_cvt_pk_bf16_f32 v72, v76, v77
  v_cvt_pk_bf16_f32 v73, v78, v79
  v_cvt_pk_bf16_f32 v74, v80, v81
  v_cvt_pk_bf16_f32 v75, v82, v83
  buffer_store_dwordx4 v[72:75], v173, s[4:7], s92 offen offset:3072 sc1
  v_accvgpr_read_b32 v88, a248
  v_accvgpr_read_b32 v89, a252
  v_accvgpr_read_b32 v90, a249
  v_accvgpr_read_b32 v91, a253
  v_accvgpr_read_b32 v92, a250
  v_accvgpr_read_b32 v93, a254
  v_accvgpr_read_b32 v94, a251
  v_accvgpr_read_b32 v95, a255
  v_cvt_pk_bf16_f32 v236, v88, v89
  v_cvt_pk_bf16_f32 v237, v90, v91
  v_cvt_pk_bf16_f32 v238, v92, v93
  v_cvt_pk_bf16_f32 v239, v94, v95
  s_add_u32 s92, s92, s61
  s_mov_b32 s46, s92
  s_add_u32 s47, s92, s61
  s_branch L_edef
L_e0:
  s_cmp_lg_u32 s59, 2
  s_cbranch_scc1 L_e1
  s_lshr_b32 s90, s27, 1
  s_and_b32 s91, s27, 1
  v_mov_b32 v172, 0x0
  v_bfe_u32 v45, v1, 0, 6
  v_lshl_add_u32 v172, v45, 4, v172
  v_add_u32 v173, 4096, v172
  s_mul_i32 s92, s90, 4
  s_mul_i32 s92, s92, s61
  s_add_u32 s92, s92, s60
  s_mul_i32 s93, s91, 8192
  s_add_u32 s92, s92, s93
  v_accvgpr_read_b32 v52, a0
  v_accvgpr_read_b32 v53, a1
  v_accvgpr_read_b32 v54, a2
  v_accvgpr_read_b32 v55, a3
  v_accvgpr_read_b32 v56, a32
  v_accvgpr_read_b32 v57, a33
  v_accvgpr_read_b32 v58, a34
  v_accvgpr_read_b32 v59, a35
  v_cvt_pk_bf16_f32 v48, v52, v53
  v_cvt_pk_bf16_f32 v49, v54, v55
  v_cvt_pk_bf16_f32 v50, v56, v57
  v_cvt_pk_bf16_f32 v51, v58, v59
  buffer_store_dwordx4 v[48:51], v172, s[4:7], s92 offen offset:0 sc1
  v_accvgpr_read_b32 v64, a128
  v_accvgpr_read_b32 v65, a129
  v_accvgpr_read_b32 v66, a130
  v_accvgpr_read_b32 v67, a131
  v_accvgpr_read_b32 v68, a160
  v_accvgpr_read_b32 v69, a161
  v_accvgpr_read_b32 v70, a162
  v_accvgpr_read_b32 v71, a163
  v_cvt_pk_bf16_f32 v176, v64, v65
  v_cvt_pk_bf16_f32 v177, v66, v67
  v_cvt_pk_bf16_f32 v178, v68, v69
  v_cvt_pk_bf16_f32 v179, v70, v71
  v_accvgpr_read_b32 v76, a4
  v_accvgpr_read_b32 v77, a5
  v_accvgpr_read_b32 v78, a6
  v_accvgpr_read_b32 v79, a7
  v_accvgpr_read_b32 v80, a36
  v_accvgpr_read_b32 v81, a37
  v_accvgpr_read_b32 v82, a38
  v_accvgpr_read_b32 v83, a39
  v_cvt_pk_bf16_f32 v72, v76, v77
  v_cvt_pk_bf16_f32 v73, v78, v79
  v_cvt_pk_bf16_f32 v74, v80, v81
  v_cvt_pk_bf16_f32 v75, v82, v83
  buffer_store_dwordx4 v[72:75], v172, s[4:7], s92 offen offset:1024 sc1
  v_accvgpr_read_b32 v88, a132
  v_accvgpr_read_b32 v89, a133
  v_accvgpr_read_b32 v90, a134
  v_accvgpr_read_b32 v91, a135
  v_accvgpr_read_b32 v92, a164
  v_accvgpr_read_b32 v93, a165
  v_accvgpr_read_b32 v94, a166
  v_accvgpr_read_b32 v95, a167
  v_cvt_pk_bf16_f32 v180, v88, v89
  v_cvt_pk_bf16_f32 v181, v90, v91
  v_cvt_pk_bf16_f32 v182, v92, v93
  v_cvt_pk_bf16_f32 v183, v94, v95
  v_accvgpr_read_b32 v52, a8
  v_accvgpr_read_b32 v53, a9
  v_accvgpr_read_b32 v54, a10
  v_accvgpr_read_b32 v55, a11
  v_accvgpr_read_b32 v56, a40
  v_accvgpr_read_b32 v57, a41
  v_accvgpr_read_b32 v58, a42
  v_accvgpr_read_b32 v59, a43
  v_cvt_pk_bf16_f32 v48, v52, v53
  v_cvt_pk_bf16_f32 v49, v54, v55
  v_cvt_pk_bf16_f32 v50, v56, v57
  v_cvt_pk_bf16_f32 v51, v58, v59
  buffer_store_dwordx4 v[48:51], v172, s[4:7], s92 offen offset:2048 sc1
  v_accvgpr_read_b32 v64, a136
  v_accvgpr_read_b32 v65, a137
  v_accvgpr_read_b32 v66, a138
  v_accvgpr_read_b32 v67, a139
  v_accvgpr_read_b32 v68, a168
  v_accvgpr_read_b32 v69, a169
  v_accvgpr_read_b32 v70, a170
  v_accvgpr_read_b32 v71, a171
  v_cvt_pk_bf16_f32 v184, v64, v65
  v_cvt_pk_bf16_f32 v185, v66, v67
  v_cvt_pk_bf16_f32 v186, v68, v69
  v_cvt_pk_bf16_f32 v187, v70, v71
  v_accvgpr_read_b32 v76, a12
  v_accvgpr_read_b32 v77, a13
  v_accvgpr_read_b32 v78, a14
  v_accvgpr_read_b32 v79, a15
  v_accvgpr_read_b32 v80, a44
  v_accvgpr_read_b32 v81, a45
  v_accvgpr_read_b32 v82, a46
  v_accvgpr_read_b32 v83, a47
  v_cvt_pk_bf16_f32 v72, v76, v77
  v_cvt_pk_bf16_f32 v73, v78, v79
  v_cvt_pk_bf16_f32 v74, v80, v81
  v_cvt_pk_bf16_f32 v75, v82, v83
  buffer_store_dwordx4 v[72:75], v172, s[4:7], s92 offen offset:3072 sc1
  v_accvgpr_read_b32 v88, a140
  v_accvgpr_read_b32 v89, a141
  v_accvgpr_read_b32 v90, a142
  v_accvgpr_read_b32 v91, a143
  v_accvgpr_read_b32 v92, a172
  v_accvgpr_read_b32 v93, a173
  v_accvgpr_read_b32 v94, a174
  v_accvgpr_read_b32 v95, a175
  v_cvt_pk_bf16_f32 v188, v88, v89
  v_cvt_pk_bf16_f32 v189, v90, v91
  v_cvt_pk_bf16_f32 v190, v92, v93
  v_cvt_pk_bf16_f32 v191, v94, v95
  v_accvgpr_read_b32 v52, a16
  v_accvgpr_read_b32 v53, a17
  v_accvgpr_read_b32 v54, a18
  v_accvgpr_read_b32 v55, a19
  v_accvgpr_read_b32 v56, a48
  v_accvgpr_read_b32 v57, a49
  v_accvgpr_read_b32 v58, a50
  v_accvgpr_read_b32 v59, a51
  v_cvt_pk_bf16_f32 v48, v52, v53
  v_cvt_pk_bf16_f32 v49, v54, v55
  v_cvt_pk_bf16_f32 v50, v56, v57
  v_cvt_pk_bf16_f32 v51, v58, v59
  buffer_store_dwordx4 v[48:51], v173, s[4:7], s92 offen offset:0 sc1
  v_accvgpr_read_b32 v64, a144
  v_accvgpr_read_b32 v65, a145
  v_accvgpr_read_b32 v66, a146
  v_accvgpr_read_b32 v67, a147
  v_accvgpr_read_b32 v68, a176
  v_accvgpr_read_b32 v69, a177
  v_accvgpr_read_b32 v70, a178
  v_accvgpr_read_b32 v71, a179
  v_cvt_pk_bf16_f32 v192, v64, v65
  v_cvt_pk_bf16_f32 v193, v66, v67
  v_cvt_pk_bf16_f32 v194, v68, v69
  v_cvt_pk_bf16_f32 v195, v70, v71
  v_accvgpr_read_b32 v76, a20
  v_accvgpr_read_b32 v77, a21
  v_accvgpr_read_b32 v78, a22
  v_accvgpr_read_b32 v79, a23
  v_accvgpr_read_b32 v80, a52
  v_accvgpr_read_b32 v81, a53
  v_accvgpr_read_b32 v82, a54
  v_accvgpr_read_b32 v83, a55
  v_cvt_pk_bf16_f32 v72, v76, v77
  v_cvt_pk_bf16_f32 v73, v78, v79
  v_cvt_pk_bf16_f32 v74, v80, v81
  v_cvt_pk_bf16_f32 v75, v82, v83
  buffer_store_dwordx4 v[72:75], v173, s[4:7], s92 offen offset:1024 sc1
  v_accvgpr_read_b32 v88, a148
  v_accvgpr_read_b32 v89, a149
  v_accvgpr_read_b32 v90, a150
  v_accvgpr_read_b32 v91, a151
  v_accvgpr_read_b32 v92, a180
  v_accvgpr_read_b32 v93, a181
  v_accvgpr_read_b32 v94, a182
  v_accvgpr_read_b32 v95, a183
  v_cvt_pk_bf16_f32 v196, v88, v89
  v_cvt_pk_bf16_f32 v197, v90, v91
  v_cvt_pk_bf16_f32 v198, v92, v93
  v_cvt_pk_bf16_f32 v199, v94, v95
  v_accvgpr_read_b32 v52, a24
  v_accvgpr_read_b32 v53, a25
  v_accvgpr_read_b32 v54, a26
  v_accvgpr_read_b32 v55, a27
  v_accvgpr_read_b32 v56, a56
  v_accvgpr_read_b32 v57, a57
  v_accvgpr_read_b32 v58, a58
  v_accvgpr_read_b32 v59, a59
  v_cvt_pk_bf16_f32 v48, v52, v53
  v_cvt_pk_bf16_f32 v49, v54, v55
  v_cvt_pk_bf16_f32 v50, v56, v57
  v_cvt_pk_bf16_f32 v51, v58, v59
  buffer_store_dwordx4 v[48:51], v173, s[4:7], s92 offen offset:2048 sc1
  v_accvgpr_read_b32 v64, a152
  v_accvgpr_read_b32 v65, a153
  v_accvgpr_read_b32 v66, a154
  v_accvgpr_read_b32 v67, a155
  v_accvgpr_read_b32 v68, a184
  v_accvgpr_read_b32 v69, a185
  v_accvgpr_read_b32 v70, a186
  v_accvgpr_read_b32 v71, a187
  v_cvt_pk_bf16_f32 v200, v64, v65
  v_cvt_pk_bf16_f32 v201, v66, v67
  v_cvt_pk_bf16_f32 v202, v68, v69
  v_cvt_pk_bf16_f32 v203, v70, v71
  v_accvgpr_read_b32 v76, a28
  v_accvgpr_read_b32 v77, a29
  v_accvgpr_read_b32 v78, a30
  v_accvgpr_read_b32 v79, a31
  v_accvgpr_read_b32 v80, a60
  v_accvgpr_read_b32 v81, a61
  v_accvgpr_read_b32 v82, a62
  v_accvgpr_read_b32 v83, a63
  v_cvt_pk_bf16_f32 v72, v76, v77
  v_cvt_pk_bf16_f32 v73, v78, v79
  v_cvt_pk_bf16_f32 v74, v80, v81
  v_cvt_pk_bf16_f32 v75, v82, v83
  buffer_store_dwordx4 v[72:75], v173, s[4:7], s92 offen offset:3072 sc1
  v_accvgpr_read_b32 v88, a156
  v_accvgpr_read_b32 v89, a157
  v_accvgpr_read_b32 v90, a158
  v_accvgpr_read_b32 v91, a159
  v_accvgpr_read_b32 v92, a188
  v_accvgpr_read_b32 v93, a189
  v_accvgpr_read_b32 v94, a190
  v_accvgpr_read_b32 v95, a191
  v_cvt_pk_bf16_f32 v204, v88, v89
  v_cvt_pk_bf16_f32 v205, v90, v91
  v_cvt_pk_bf16_f32 v206, v92, v93
  v_cvt_pk_bf16_f32 v207, v94, v95
  s_add_u32 s92, s92, s61
  v_accvgpr_read_b32 v52, a64
  v_accvgpr_read_b32 v53, a65
  v_accvgpr_read_b32 v54, a66
  v_accvgpr_read_b32 v55, a67
  v_accvgpr_read_b32 v56, a96
  v_accvgpr_read_b32 v57, a97
  v_accvgpr_read_b32 v58, a98
  v_accvgpr_read_b32 v59, a99
  v_cvt_pk_bf16_f32 v48, v52, v53
  v_cvt_pk_bf16_f32 v49, v54, v55
  v_cvt_pk_bf16_f32 v50, v56, v57
  v_cvt_pk_bf16_f32 v51, v58, v59
  buffer_store_dwordx4 v[48:51], v172, s[4:7], s92 offen offset:0 sc1
  v_accvgpr_read_b32 v64, a192
  v_accvgpr_read_b32 v65, a193
  v_accvgpr_read_b32 v66, a194
  v_accvgpr_read_b32 v67, a195
  v_accvgpr_read_b32 v68, a224
  v_accvgpr_read_b32 v69, a225
  v_accvgpr_read_b32 v70, a226
  v_accvgpr_read_b32 v71, a227
  v_cvt_pk_bf16_f32 v208, v64, v65
  v_cvt_pk_bf16_f32 v209, v66, v67
  v_cvt_pk_bf16_f32 v210, v68, v69
  v_cvt_pk_bf16_f32 v211, v70, v71
  v_accvgpr_read_b32 v76, a68
  v_accvgpr_read_b32 v77, a69
  v_accvgpr_read_b32 v78, a70
  v_accvgpr_read_b32 v79, a71
  v_accvgpr_read_b32 v80, a100
  v_accvgpr_read_b32 v81, a101
  v_accvgpr_read_b32 v82, a102
  v_accvgpr_read_b32 v83, a103
  v_cvt_pk_bf16_f32 v72, v76, v77
  v_cvt_pk_bf16_f32 v73, v78, v79
  v_cvt_pk_bf16_f32 v74, v80, v81
  v_cvt_pk_bf16_f32 v75, v82, v83
  buffer_store_dwordx4 v[72:75], v172, s[4:7], s92 offen offset:1024 sc1
  v_accvgpr_read_b32 v88, a196
  v_accvgpr_read_b32 v89, a197
  v_accvgpr_read_b32 v90, a198
  v_accvgpr_read_b32 v91, a199
  v_accvgpr_read_b32 v92, a228
  v_accvgpr_read_b32 v93, a229
  v_accvgpr_read_b32 v94, a230
  v_accvgpr_read_b32 v95, a231
  v_cvt_pk_bf16_f32 v212, v88, v89
  v_cvt_pk_bf16_f32 v213, v90, v91
  v_cvt_pk_bf16_f32 v214, v92, v93
  v_cvt_pk_bf16_f32 v215, v94, v95
  v_accvgpr_read_b32 v52, a72
  v_accvgpr_read_b32 v53, a73
  v_accvgpr_read_b32 v54, a74
  v_accvgpr_read_b32 v55, a75
  v_accvgpr_read_b32 v56, a104
  v_accvgpr_read_b32 v57, a105
  v_accvgpr_read_b32 v58, a106
  v_accvgpr_read_b32 v59, a107
  v_cvt_pk_bf16_f32 v48, v52, v53
  v_cvt_pk_bf16_f32 v49, v54, v55
  v_cvt_pk_bf16_f32 v50, v56, v57
  v_cvt_pk_bf16_f32 v51, v58, v59
  buffer_store_dwordx4 v[48:51], v172, s[4:7], s92 offen offset:2048 sc1
  v_accvgpr_read_b32 v64, a200
  v_accvgpr_read_b32 v65, a201
  v_accvgpr_read_b32 v66, a202
  v_accvgpr_read_b32 v67, a203
  v_accvgpr_read_b32 v68, a232
  v_accvgpr_read_b32 v69, a233
  v_accvgpr_read_b32 v70, a234
  v_accvgpr_read_b32 v71, a235
  v_cvt_pk_bf16_f32 v216, v64, v65
  v_cvt_pk_bf16_f32 v217, v66, v67
  v_cvt_pk_bf16_f32 v218, v68, v69
  v_cvt_pk_bf16_f32 v219, v70, v71
  v_accvgpr_read_b32 v76, a76
  v_accvgpr_read_b32 v77, a77
  v_accvgpr_read_b32 v78, a78
  v_accvgpr_read_b32 v79, a79
  v_accvgpr_read_b32 v80, a108
  v_accvgpr_read_b32 v81, a109
  v_accvgpr_read_b32 v82, a110
  v_accvgpr_read_b32 v83, a111
  v_cvt_pk_bf16_f32 v72, v76, v77
  v_cvt_pk_bf16_f32 v73, v78, v79
  v_cvt_pk_bf16_f32 v74, v80, v81
  v_cvt_pk_bf16_f32 v75, v82, v83
  buffer_store_dwordx4 v[72:75], v172, s[4:7], s92 offen offset:3072 sc1
  v_accvgpr_read_b32 v88, a204
  v_accvgpr_read_b32 v89, a205
  v_accvgpr_read_b32 v90, a206
  v_accvgpr_read_b32 v91, a207
  v_accvgpr_read_b32 v92, a236
  v_accvgpr_read_b32 v93, a237
  v_accvgpr_read_b32 v94, a238
  v_accvgpr_read_b32 v95, a239
  v_cvt_pk_bf16_f32 v220, v88, v89
  v_cvt_pk_bf16_f32 v221, v90, v91
  v_cvt_pk_bf16_f32 v222, v92, v93
  v_cvt_pk_bf16_f32 v223, v94, v95
  v_accvgpr_read_b32 v52, a80
  v_accvgpr_read_b32 v53, a81
  v_accvgpr_read_b32 v54, a82
  v_accvgpr_read_b32 v55, a83
  v_accvgpr_read_b32 v56, a112
  v_accvgpr_read_b32 v57, a113
  v_accvgpr_read_b32 v58, a114
  v_accvgpr_read_b32 v59, a115
  v_cvt_pk_bf16_f32 v48, v52, v53
  v_cvt_pk_bf16_f32 v49, v54, v55
  v_cvt_pk_bf16_f32 v50, v56, v57
  v_cvt_pk_bf16_f32 v51, v58, v59
  buffer_store_dwordx4 v[48:51], v173, s[4:7], s92 offen offset:0 sc1
  v_accvgpr_read_b32 v64, a208
  v_accvgpr_read_b32 v65, a209
  v_accvgpr_read_b32 v66, a210
  v_accvgpr_read_b32 v67, a211
  v_accvgpr_read_b32 v68, a240
  v_accvgpr_read_b32 v69, a241
  v_accvgpr_read_b32 v70, a242
  v_accvgpr_read_b32 v71, a243
  v_cvt_pk_bf16_f32 v224, v64, v65
  v_cvt_pk_bf16_f32 v225, v66, v67
  v_cvt_pk_bf16_f32 v226, v68, v69
  v_cvt_pk_bf16_f32 v227, v70, v71
  v_accvgpr_read_b32 v76, a84
  v_accvgpr_read_b32 v77, a85
  v_accvgpr_read_b32 v78, a86
  v_accvgpr_read_b32 v79, a87
  v_accvgpr_read_b32 v80, a116
  v_accvgpr_read_b32 v81, a117
  v_accvgpr_read_b32 v82, a118
  v_accvgpr_read_b32 v83, a119
  v_cvt_pk_bf16_f32 v72, v76, v77
  v_cvt_pk_bf16_f32 v73, v78, v79
  v_cvt_pk_bf16_f32 v74, v80, v81
  v_cvt_pk_bf16_f32 v75, v82, v83
  buffer_store_dwordx4 v[72:75], v173, s[4:7], s92 offen offset:1024 sc1
  v_accvgpr_read_b32 v88, a212
  v_accvgpr_read_b32 v89, a213
  v_accvgpr_read_b32 v90, a214
  v_accvgpr_read_b32 v91, a215
  v_accvgpr_read_b32 v92, a244
  v_accvgpr_read_b32 v93, a245
  v_accvgpr_read_b32 v94, a246
  v_accvgpr_read_b32 v95, a247
  v_cvt_pk_bf16_f32 v228, v88, v89
  v_cvt_pk_bf16_f32 v229, v90, v91
  v_cvt_pk_bf16_f32 v230, v92, v93
  v_cvt_pk_bf16_f32 v231, v94, v95
  v_accvgpr_read_b32 v52, a88
  v_accvgpr_read_b32 v53, a89
  v_accvgpr_read_b32 v54, a90
  v_accvgpr_read_b32 v55, a91
  v_accvgpr_read_b32 v56, a120
  v_accvgpr_read_b32 v57, a121
  v_accvgpr_read_b32 v58, a122
  v_accvgpr_read_b32 v59, a123
  v_cvt_pk_bf16_f32 v48, v52, v53
  v_cvt_pk_bf16_f32 v49, v54, v55
  v_cvt_pk_bf16_f32 v50, v56, v57
  v_cvt_pk_bf16_f32 v51, v58, v59
  buffer_store_dwordx4 v[48:51], v173, s[4:7], s92 offen offset:2048 sc1
  v_accvgpr_read_b32 v64, a216
  v_accvgpr_read_b32 v65, a217
  v_accvgpr_read_b32 v66, a218
  v_accvgpr_read_b32 v67, a219
  v_accvgpr_read_b32 v68, a248
  v_accvgpr_read_b32 v69, a249
  v_accvgpr_read_b32 v70, a250
  v_accvgpr_read_b32 v71, a251
  v_cvt_pk_bf16_f32 v232, v64, v65
  v_cvt_pk_bf16_f32 v233, v66, v67
  v_cvt_pk_bf16_f32 v234, v68, v69
  v_cvt_pk_bf16_f32 v235, v70, v71
  v_accvgpr_read_b32 v76, a92
  v_accvgpr_read_b32 v77, a93
  v_accvgpr_read_b32 v78, a94
  v_accvgpr_read_b32 v79, a95
  v_accvgpr_read_b32 v80, a124
  v_accvgpr_read_b32 v81, a125
  v_accvgpr_read_b32 v82, a126
  v_accvgpr_read_b32 v83, a127
  v_cvt_pk_bf16_f32 v72, v76, v77
  v_cvt_pk_bf16_f32 v73, v78, v79
  v_cvt_pk_bf16_f32 v74, v80, v81
  v_cvt_pk_bf16_f32 v75, v82, v83
  buffer_store_dwordx4 v[72:75], v173, s[4:7], s92 offen offset:3072 sc1
  v_accvgpr_read_b32 v88, a220
  v_accvgpr_read_b32 v89, a221
  v_accvgpr_read_b32 v90, a222
  v_accvgpr_read_b32 v91, a223
  v_accvgpr_read_b32 v92, a252
  v_accvgpr_read_b32 v93, a253
  v_accvgpr_read_b32 v94, a254
  v_accvgpr_read_b32 v95, a255
  v_cvt_pk_bf16_f32 v236, v88, v89
  v_cvt_pk_bf16_f32 v237, v90, v91
  v_cvt_pk_bf16_f32 v238, v92, v93
  v_cvt_pk_bf16_f32 v239, v94, v95
  s_add_u32 s92, s92, s61
  s_mov_b32 s46, s92
  s_add_u32 s47, s92, s61
  s_branch L_edef
L_e1:
  s_cmp_lg_u32 s59, 3
  s_cbranch_scc1 L_e2
  s_lshr_b32 s90, s27, 1
  s_and_b32 s91, s27, 1
  v_mov_b32 v178, 0x0
  v_bfe_u32 v177, v1, 0, 6
  v_lshl_add_u32 v178, v177, 4, v178
  v_add_u32 v176, 4096, v178
  s_mul_i32 s92, s90, 2
  s_mul_i32 s92, s92, s61
  s_add_u32 s92, s92, s60
  s_mul_i32 s93, s91, 2048
  s_add_u32 s92, s92, s93
  v_accvgpr_read_b32 v184, a0
  v_accvgpr_read_b32 v185, a4
  v_accvgpr_read_b32 v186, a1
  v_accvgpr_read_b32 v187, a5
  v_accvgpr_read_b32 v188, a2
  v_accvgpr_read_b32 v189, a6
  v_accvgpr_read_b32 v190, a3
  v_accvgpr_read_b32 v191, a7
  v_cvt_pk_bf16_f32 v180, v184, v185
  v_cvt_pk_bf16_f32 v181, v186, v187
  v_cvt_pk_bf16_f32 v182, v188, v189
  v_cvt_pk_bf16_f32 v183, v190, v191
  buffer_store_dwordx4 v[180:183], v178, s[4:7], s92 offen offset:0 sc1
  v_accvgpr_read_b32 v196, a8
  v_accvgpr_read_b32 v197, a12
  v_accvgpr_read_b32 v198, a9
  v_accvgpr_read_b32 v199, a13
  v_accvgpr_read_b32 v200, a10
  v_accvgpr_read_b32 v201, a14
  v_accvgpr_read_b32 v202, a11
  v_accvgpr_read_b32 v203, a15
  v_cvt_pk_bf16_f32 v192, v196, v197
  v_cvt_pk_bf16_f32 v193, v198, v199
  v_cvt_pk_bf16_f32 v194, v200, v201
  v_cvt_pk_bf16_f32 v195, v202, v203
  buffer_store_dwordx4 v[192:195], v178, s[4:7], s92 offen offset:1024 sc1
  v_accvgpr_read_b32 v208, a16
  v_accvgpr_read_b32 v209, a20
  v_accvgpr_read_b32 v210, a17
  v_accvgpr_read_b32 v211, a21
  v_accvgpr_read_b32 v212, a18
  v_accvgpr_read_b32 v213, a22
  v_accvgpr_read_b32 v214, a19
  v_accvgpr_read_b32 v215, a23
  v_cvt_pk_bf16_f32 v204, v208, v209
  v_cvt_pk_bf16_f32 v205, v210, v211
  v_cvt_pk_bf16_f32 v206, v212, v213
  v_cvt_pk_bf16_f32 v207, v214, v215
  buffer_store_dwordx4 v[204:207], v176, s[4:7], s92 offen offset:0 sc1
  v_accvgpr_read_b32 v220, a24
  v_accvgpr_read_b32 v221, a28
  v_accvgpr_read_b32 v222, a25
  v_accvgpr_read_b32 v223, a29
  v_accvgpr_read_b32 v224, a26
  v_accvgpr_read_b32 v225, a30
  v_accvgpr_read_b32 v226, a27
  v_accvgpr_read_b32 v227, a31
  v_cvt_pk_bf16_f32 v216, v220, v221
  v_cvt_pk_bf16_f32 v217, v222, v223
  v_cvt_pk_bf16_f32 v218, v224, v225
  v_cvt_pk_bf16_f32 v219, v226, v227
  buffer_store_dwordx4 v[216:219], v176, s[4:7], s92 offen offset:1024 sc1
  s_add_u32 s92, s92, s61
  v_accvgpr_read_b32 v184, a32
  v_accvgpr_read_b32 v185, a36
  v_accvgpr_read_b32 v186, a33
  v_accvgpr_read_b32 v187, a37
  v_accvgpr_read_b32 v188, a34
  v_accvgpr_read_b32 v189, a38
  v_accvgpr_read_b32 v190, a35
  v_accvgpr_read_b32 v191, a39
  v_cvt_pk_bf16_f32 v180, v184, v185
  v_cvt_pk_bf16_f32 v181, v186, v187
  v_cvt_pk_bf16_f32 v182, v188, v189
  v_cvt_pk_bf16_f32 v183, v190, v191
  buffer_store_dwordx4 v[180:183], v178, s[4:7], s92 offen offset:0 sc1
  v_accvgpr_read_b32 v196, a40
  v_accvgpr_read_b32 v197, a44
  v_accvgpr_read_b32 v198, a41
  v_accvgpr_read_b32 v199, a45
  v_accvgpr_read_b32 v200, a42
  v_accvgpr_read_b32 v201, a46
  v_accvgpr_read_b32 v202, a43
  v_accvgpr_read_b32 v203, a47
  v_cvt_pk_bf16_f32 v192, v196, v197
  v_cvt_pk_bf16_f32 v193, v198, v199
  v_cvt_pk_bf16_f32 v194, v200, v201
  v_cvt_pk_bf16_f32 v195, v202, v203
  buffer_store_dwordx4 v[192:195], v178, s[4:7], s92 offen offset:1024 sc1
  v_accvgpr_read_b32 v208, a48
  v_accvgpr_read_b32 v209, a52
  v_accvgpr_read_b32 v210, a49
  v_accvgpr_read_b32 v211, a53
  v_accvgpr_read_b32 v212, a50
  v_accvgpr_read_b32 v213, a54
  v_accvgpr_read_b32 v214, a51
  v_accvgpr_read_b32 v215, a55
  v_cvt_pk_bf16_f32 v204, v208, v209
  v_cvt_pk_bf16_f32 v205, v210, v211
  v_cvt_pk_bf16_f32 v206, v212, v213
  v_cvt_pk_bf16_f32 v207, v214, v215
  buffer_store_dwordx4 v[204:207], v176, s[4:7], s92 offen offset:0 sc1
  v_accvgpr_read_b32 v220, a56
  v_accvgpr_read_b32 v221, a60
  v_accvgpr_read_b32 v222, a57
  v_accvgpr_read_b32 v223, a61
  v_accvgpr_read_b32 v224, a58
  v_accvgpr_read_b32 v225, a62
  v_accvgpr_read_b32 v226, a59
  v_accvgpr_read_b32 v227, a63
  v_cvt_pk_bf16_f32 v216, v220, v221
  v_cvt_pk_bf16_f32 v217, v222, v223
  v_cvt_pk_bf16_f32 v218, v224, v225
  v_cvt_pk_bf16_f32 v219, v226, v227
  buffer_store_dwordx4 v[216:219], v176, s[4:7], s92 offen offset:1024 sc1
  s_add_u32 s92, s92, s61
  s_branch L_esig
L_e2:
  s_cmp_lg_u32 s59, 4
  s_cbranch_scc1 L_e3
  s_lshr_b32 s90, s27, 1
  s_and_b32 s91, s27, 1
  v_mov_b32 v178, 0x0
  v_bfe_u32 v177, v1, 0, 6
  v_lshl_add_u32 v178, v177, 4, v178
  v_add_u32 v176, 4096, v178
  s_mul_i32 s92, s90, 2
  s_mul_i32 s92, s92, s61
  s_add_u32 s92, s92, s60
  s_mul_i32 s93, s91, 4096
  s_add_u32 s92, s92, s93
  v_accvgpr_read_b32 v184, a0
  v_accvgpr_read_b32 v185, a1
  v_accvgpr_read_b32 v186, a2
  v_accvgpr_read_b32 v187, a3
  v_accvgpr_read_b32 v188, a16
  v_accvgpr_read_b32 v189, a17
  v_accvgpr_read_b32 v190, a18
  v_accvgpr_read_b32 v191, a19
  v_cvt_pk_bf16_f32 v180, v184, v185
  v_cvt_pk_bf16_f32 v181, v186, v187
  v_cvt_pk_bf16_f32 v182, v188, v189
  v_cvt_pk_bf16_f32 v183, v190, v191
  buffer_store_dwordx4 v[180:183], v178, s[4:7], s92 offen offset:0 sc1
  v_accvgpr_read_b32 v196, a4
  v_accvgpr_read_b32 v197, a5
  v_accvgpr_read_b32 v198, a6
  v_accvgpr_read_b32 v199, a7
  v_accvgpr_read_b32 v200, a20
  v_accvgpr_read_b32 v201, a21
  v_accvgpr_read_b32 v202, a22
  v_accvgpr_read_b32 v203, a23
  v_cvt_pk_bf16_f32 v192, v196, v197
  v_cvt_pk_bf16_f32 v193, v198, v199
  v_cvt_pk_bf16_f32 v194, v200, v201
  v_cvt_pk_bf16_f32 v195, v202, v203
  buffer_store_dwordx4 v[192:195], v178, s[4:7], s92 offen offset:1024 sc1
  v_accvgpr_read_b32 v208, a8
  v_accvgpr_read_b32 v209, a9
  v_accvgpr_read_b32 v210, a10
  v_accvgpr_read_b32 v211, a11
  v_accvgpr_read_b32 v212, a24
  v_accvgpr_read_b32 v213, a25
  v_accvgpr_read_b32 v214, a26
  v_accvgpr_read_b32 v215, a27
  v_cvt_pk_bf16_f32 v204, v208, v209
  v_cvt_pk_bf16_f32 v205, v210, v211
  v_cvt_pk_bf16_f32 v206, v212, v213
  v_cvt_pk_bf16_f32 v207, v214, v215
  buffer_store_dwordx4 v[204:207], v178, s[4:7], s92 offen offset:2048 sc1
  v_accvgpr_read_b32 v220, a12
  v_accvgpr_read_b32 v221, a13
  v_accvgpr_read_b32 v222, a14
  v_accvgpr_read_b32 v223, a15
  v_accvgpr_read_b32 v224, a28
  v_accvgpr_read_b32 v225, a29
  v_accvgpr_read_b32 v226, a30
  v_accvgpr_read_b32 v227, a31
  v_cvt_pk_bf16_f32 v216, v220, v221
  v_cvt_pk_bf16_f32 v217, v222, v223
  v_cvt_pk_bf16_f32 v218, v224, v225
  v_cvt_pk_bf16_f32 v219, v226, v227
  buffer_store_dwordx4 v[216:219], v178, s[4:7], s92 offen offset:3072 sc1
  s_add_u32 s92, s92, s61
  v_accvgpr_read_b32 v184, a32
  v_accvgpr_read_b32 v185, a33
  v_accvgpr_read_b32 v186, a34
  v_accvgpr_read_b32 v187, a35
  v_accvgpr_read_b32 v188, a48
  v_accvgpr_read_b32 v189, a49
  v_accvgpr_read_b32 v190, a50
  v_accvgpr_read_b32 v191, a51
  v_cvt_pk_bf16_f32 v180, v184, v185
  v_cvt_pk_bf16_f32 v181, v186, v187
  v_cvt_pk_bf16_f32 v182, v188, v189
  v_cvt_pk_bf16_f32 v183, v190, v191
  buffer_store_dwordx4 v[180:183], v178, s[4:7], s92 offen offset:0 sc1
  v_accvgpr_read_b32 v196, a36
  v_accvgpr_read_b32 v197, a37
  v_accvgpr_read_b32 v198, a38
  v_accvgpr_read_b32 v199, a39
  v_accvgpr_read_b32 v200, a52
  v_accvgpr_read_b32 v201, a53
  v_accvgpr_read_b32 v202, a54
  v_accvgpr_read_b32 v203, a55
  v_cvt_pk_bf16_f32 v192, v196, v197
  v_cvt_pk_bf16_f32 v193, v198, v199
  v_cvt_pk_bf16_f32 v194, v200, v201
  v_cvt_pk_bf16_f32 v195, v202, v203
  buffer_store_dwordx4 v[192:195], v178, s[4:7], s92 offen offset:1024 sc1
  v_accvgpr_read_b32 v208, a40
  v_accvgpr_read_b32 v209, a41
  v_accvgpr_read_b32 v210, a42
  v_accvgpr_read_b32 v211, a43
  v_accvgpr_read_b32 v212, a56
  v_accvgpr_read_b32 v213, a57
  v_accvgpr_read_b32 v214, a58
  v_accvgpr_read_b32 v215, a59
  v_cvt_pk_bf16_f32 v204, v208, v209
  v_cvt_pk_bf16_f32 v205, v210, v211
  v_cvt_pk_bf16_f32 v206, v212, v213
  v_cvt_pk_bf16_f32 v207, v214, v215
  buffer_store_dwordx4 v[204:207], v178, s[4:7], s92 offen offset:2048 sc1
  v_accvgpr_read_b32 v220, a44
  v_accvgpr_read_b32 v221, a45
  v_accvgpr_read_b32 v222, a46
  v_accvgpr_read_b32 v223, a47
  v_accvgpr_read_b32 v224, a60
  v_accvgpr_read_b32 v225, a61
  v_accvgpr_read_b32 v226, a62
  v_accvgpr_read_b32 v227, a63
  v_cvt_pk_bf16_f32 v216, v220, v221
  v_cvt_pk_bf16_f32 v217, v222, v223
  v_cvt_pk_bf16_f32 v218, v224, v225
  v_cvt_pk_bf16_f32 v219, v226, v227
  buffer_store_dwordx4 v[216:219], v178, s[4:7], s92 offen offset:3072 sc1
  s_add_u32 s92, s92, s61
  s_branch L_esig
L_e3:
  s_cmp_lg_u32 s59, 5
  s_cbranch_scc1 L_e4
  s_lshr_b32 s90, s27, 1
  s_and_b32 s91, s27, 1
  v_and_b32 v176, 15, v1
  v_mul_lo_u32 v176, v176, s61
  v_lshrrev_b32 v177, 4, v1
  v_lshl_add_u32 v178, v177, 4, v176
  s_mul_i32 s92, s90, 64
  s_mul_i32 s92, s92, s61
  s_add_u32 s92, s92, s60
  s_mul_i32 s93, s91, 128
  s_add_u32 s92, s92, s93
  s_lshl_b32 s94, s61, 4
  v_accvgpr_read_b32 v184, a0
  v_accvgpr_read_b32 v185, a1
  v_accvgpr_read_b32 v186, a2
  v_accvgpr_read_b32 v187, a3
  v_accvgpr_read_b32 v188, a4
  v_accvgpr_read_b32 v189, a5
  v_accvgpr_read_b32 v190, a6
  v_accvgpr_read_b32 v191, a7
  v_cvt_pk_bf16_f32 v180, v184, v185
  v_cvt_pk_bf16_f32 v181, v186, v187
  v_cvt_pk_bf16_f32 v182, v188, v189
  v_cvt_pk_bf16_f32 v183, v190, v191
  buffer_store_dwordx4 v[180:183], v178, s[16:19], s92 offen offset:0 sc1
  v_accvgpr_read_b32 v196, a8
  v_accvgpr_read_b32 v197, a9
  v_accvgpr_read_b32 v198, a10
  v_accvgpr_read_b32 v199, a11
  v_accvgpr_read_b32 v200, a12
  v_accvgpr_read_b32 v201, a13
  v_accvgpr_read_b32 v202, a14
  v_accvgpr_read_b32 v203, a15
  v_cvt_pk_bf16_f32 v192, v196, v197
  v_cvt_pk_bf16_f32 v193, v198, v199
  v_cvt_pk_bf16_f32 v194, v200, v201
  v_cvt_pk_bf16_f32 v195, v202, v203
  buffer_store_dwordx4 v[192:195], v178, s[16:19], s92 offen offset:64 sc1
  s_add_u32 s92, s92, s94
  v_accvgpr_read_b32 v208, a16
  v_accvgpr_read_b32 v209, a17
  v_accvgpr_read_b32 v210, a18
  v_accvgpr_read_b32 v211, a19
  v_accvgpr_read_b32 v212, a20
  v_accvgpr_read_b32 v213, a21
  v_accvgpr_read_b32 v214, a22
  v_accvgpr_read_b32 v215, a23
  v_cvt_pk_bf16_f32 v204, v208, v209
  v_cvt_pk_bf16_f32 v205, v210, v211
  v_cvt_pk_bf16_f32 v206, v212, v213
  v_cvt_pk_bf16_f32 v207, v214, v215
  buffer_store_dwordx4 v[204:207], v178, s[16:19], s92 offen offset:0 sc1
  v_accvgpr_read_b32 v220, a24
  v_accvgpr_read_b32 v221, a25
  v_accvgpr_read_b32 v222, a26
  v_accvgpr_read_b32 v223, a27
  v_accvgpr_read_b32 v224, a28
  v_accvgpr_read_b32 v225, a29
  v_accvgpr_read_b32 v226, a30
  v_accvgpr_read_b32 v227, a31
  v_cvt_pk_bf16_f32 v216, v220, v221
  v_cvt_pk_bf16_f32 v217, v222, v223
  v_cvt_pk_bf16_f32 v218, v224, v225
  v_cvt_pk_bf16_f32 v219, v226, v227
  buffer_store_dwordx4 v[216:219], v178, s[16:19], s92 offen offset:64 sc1
  s_add_u32 s92, s92, s94
  v_accvgpr_read_b32 v184, a32
  v_accvgpr_read_b32 v185, a33
  v_accvgpr_read_b32 v186, a34
  v_accvgpr_read_b32 v187, a35
  v_accvgpr_read_b32 v188, a36
  v_accvgpr_read_b32 v189, a37
  v_accvgpr_read_b32 v190, a38
  v_accvgpr_read_b32 v191, a39
  v_cvt_pk_bf16_f32 v180, v184, v185
  v_cvt_pk_bf16_f32 v181, v186, v187
  v_cvt_pk_bf16_f32 v182, v188, v189
  v_cvt_pk_bf16_f32 v183, v190, v191
  buffer_store_dwordx4 v[180:183], v178, s[16:19], s92 offen offset:0 sc1
  v_accvgpr_read_b32 v196, a40
  v_accvgpr_read_b32 v197, a41
  v_accvgpr_read_b32 v198, a42
  v_accvgpr_read_b32 v199, a43
  v_accvgpr_read_b32 v200, a44
  v_accvgpr_read_b32 v201, a45
  v_accvgpr_read_b32 v202, a46
  v_accvgpr_read_b32 v203, a47
  v_cvt_pk_bf16_f32 v192, v196, v197
  v_cvt_pk_bf16_f32 v193, v198, v199
  v_cvt_pk_bf16_f32 v194, v200, v201
  v_cvt_pk_bf16_f32 v195, v202, v203
  buffer_store_dwordx4 v[192:195], v178, s[16:19], s92 offen offset:64 sc1
  s_add_u32 s92, s92, s94
  v_accvgpr_read_b32 v208, a48
  v_accvgpr_read_b32 v209, a49
  v_accvgpr_read_b32 v210, a50
  v_accvgpr_read_b32 v211, a51
  v_accvgpr_read_b32 v212, a52
  v_accvgpr_read_b32 v213, a53
  v_accvgpr_read_b32 v214, a54
  v_accvgpr_read_b32 v215, a55
  v_cvt_pk_bf16_f32 v204, v208, v209
  v_cvt_pk_bf16_f32 v205, v210, v211
  v_cvt_pk_bf16_f32 v206, v212, v213
  v_cvt_pk_bf16_f32 v207, v214, v215
  buffer_store_dwordx4 v[204:207], v178, s[16:19], s92 offen offset:0 sc1
  v_accvgpr_read_b32 v220, a56
  v_accvgpr_read_b32 v221, a57
  v_accvgpr_read_b32 v222, a58
  v_accvgpr_read_b32 v223, a59
  v_accvgpr_read_b32 v224, a60
  v_accvgpr_read_b32 v225, a61
  v_accvgpr_read_b32 v226, a62
  v_accvgpr_read_b32 v227, a63
  v_cvt_pk_bf16_f32 v216, v220, v221
  v_cvt_pk_bf16_f32 v217, v222, v223
  v_cvt_pk_bf16_f32 v218, v224, v225
  v_cvt_pk_bf16_f32 v219, v226, v227
  buffer_store_dwordx4 v[216:219], v178, s[16:19], s92 offen offset:64 sc1
  s_add_u32 s92, s92, s94
  s_branch L_epid
L_e4:
  s_cmp_lg_u32 s59, 6
  s_cbranch_scc1 L_e5
  s_lshr_b32 s90, s27, 1
  s_and_b32 s91, s27, 1
  v_and_b32 v176, 15, v1
  v_mul_lo_u32 v176, v176, s61
  v_lshrrev_b32 v177, 4, v1
  v_lshl_add_u32 v178, v177, 4, v176
  s_mul_i32 s92, s90, 128
  s_mul_i32 s92, s92, s61
  s_add_u32 s92, s92, s60
  s_mul_i32 s93, s91, 128
  s_add_u32 s92, s92, s93
  s_lshl_b32 s94, s61, 4
  v_accvgpr_read_b32 v184, a0
  v_accvgpr_read_b32 v185, a1
  v_accvgpr_read_b32 v186, a2
  v_accvgpr_read_b32 v187, a3
  v_accvgpr_read_b32 v188, a4
  v_accvgpr_read_b32 v189, a5
  v_accvgpr_read_b32 v190, a6
  v_accvgpr_read_b32 v191, a7
  v_cvt_pk_bf16_f32 v180, v184, v185
  v_cvt_pk_bf16_f32 v181, v186, v187
  v_cvt_pk_bf16_f32 v182, v188, v189
  v_cvt_pk_bf16_f32 v183, v190, v191
  buffer_store_dwordx4 v[180:183], v178, s[16:19], s92 offen offset:0 sc1
  v_accvgpr_read_b32 v196, a8
  v_accvgpr_read_b32 v197, a9
  v_accvgpr_read_b32 v198, a10
  v_accvgpr_read_b32 v199, a11
  v_accvgpr_read_b32 v200, a12
  v_accvgpr_read_b32 v201, a13
  v_accvgpr_read_b32 v202, a14
  v_accvgpr_read_b32 v203, a15
  v_cvt_pk_bf16_f32 v192, v196, v197
  v_cvt_pk_bf16_f32 v193, v198, v199
  v_cvt_pk_bf16_f32 v194, v200, v201
  v_cvt_pk_bf16_f32 v195, v202, v203
  buffer_store_dwordx4 v[192:195], v178, s[16:19], s92 offen offset:64 sc1
  s_add_u32 s92, s92, s94
  v_accvgpr_read_b32 v208, a16
  v_accvgpr_read_b32 v209, a17
  v_accvgpr_read_b32 v210, a18
  v_accvgpr_read_b32 v211, a19
  v_accvgpr_read_b32 v212, a20
  v_accvgpr_read_b32 v213, a21
  v_accvgpr_read_b32 v214, a22
  v_accvgpr_read_b32 v215, a23
  v_cvt_pk_bf16_f32 v204, v208, v209
  v_cvt_pk_bf16_f32 v205, v210, v211
  v_cvt_pk_bf16_f32 v206, v212, v213
  v_cvt_pk_bf16_f32 v207, v214, v215
  buffer_store_dwordx4 v[204:207], v178, s[16:19], s92 offen offset:0 sc1
  v_accvgpr_read_b32 v220, a24
  v_accvgpr_read_b32 v221, a25
  v_accvgpr_read_b32 v222, a26
  v_accvgpr_read_b32 v223, a27
  v_accvgpr_read_b32 v224, a28
  v_accvgpr_read_b32 v225, a29
  v_accvgpr_read_b32 v226, a30
  v_accvgpr_read_b32 v227, a31
  v_cvt_pk_bf16_f32 v216, v220, v221
  v_cvt_pk_bf16_f32 v217, v222, v223
  v_cvt_pk_bf16_f32 v218, v224, v225
  v_cvt_pk_bf16_f32 v219, v226, v227
  buffer_store_dwordx4 v[216:219], v178, s[16:19], s92 offen offset:64 sc1
  s_add_u32 s92, s92, s94
  v_accvgpr_read_b32 v184, a32
  v_accvgpr_read_b32 v185, a33
  v_accvgpr_read_b32 v186, a34
  v_accvgpr_read_b32 v187, a35
  v_accvgpr_read_b32 v188, a36
  v_accvgpr_read_b32 v189, a37
  v_accvgpr_read_b32 v190, a38
  v_accvgpr_read_b32 v191, a39
  v_cvt_pk_bf16_f32 v180, v184, v185
  v_cvt_pk_bf16_f32 v181, v186, v187
  v_cvt_pk_bf16_f32 v182, v188, v189
  v_cvt_pk_bf16_f32 v183, v190, v191
  buffer_store_dwordx4 v[180:183], v178, s[16:19], s92 offen offset:0 sc1
  v_accvgpr_read_b32 v196, a40
  v_accvgpr_read_b32 v197, a41
  v_accvgpr_read_b32 v198, a42
  v_accvgpr_read_b32 v199, a43
  v_accvgpr_read_b32 v200, a44
  v_accvgpr_read_b32 v201, a45
  v_accvgpr_read_b32 v202, a46
  v_accvgpr_read_b32 v203, a47
  v_cvt_pk_bf16_f32 v192, v196, v197
  v_cvt_pk_bf16_f32 v193, v198, v199
  v_cvt_pk_bf16_f32 v194, v200, v201
  v_cvt_pk_bf16_f32 v195, v202, v203
  buffer_store_dwordx4 v[192:195], v178, s[16:19], s92 offen offset:64 sc1
  s_add_u32 s92, s92, s94
  v_accvgpr_read_b32 v208, a48
  v_accvgpr_read_b32 v209, a49
  v_accvgpr_read_b32 v210, a50
  v_accvgpr_read_b32 v211, a51
  v_accvgpr_read_b32 v212, a52
  v_accvgpr_read_b32 v213, a53
  v_accvgpr_read_b32 v214, a54
  v_accvgpr_read_b32 v215, a55
  v_cvt_pk_bf16_f32 v204, v208, v209
  v_cvt_pk_bf16_f32 v205, v210, v211
  v_cvt_pk_bf16_f32 v206, v212, v213
  v_cvt_pk_bf16_f32 v207, v214, v215
  buffer_store_dwordx4 v[204:207], v178, s[16:19], s92 offen offset:0 sc1
  v_accvgpr_read_b32 v220, a56
  v_accvgpr_read_b32 v221, a57
  v_accvgpr_read_b32 v222, a58
  v_accvgpr_read_b32 v223, a59
  v_accvgpr_read_b32 v224, a60
  v_accvgpr_read_b32 v225, a61
  v_accvgpr_read_b32 v226, a62
  v_accvgpr_read_b32 v227, a63
  v_cvt_pk_bf16_f32 v216, v220, v221
  v_cvt_pk_bf16_f32 v217, v222, v223
  v_cvt_pk_bf16_f32 v218, v224, v225
  v_cvt_pk_bf16_f32 v219, v226, v227
  buffer_store_dwordx4 v[216:219], v178, s[16:19], s92 offen offset:64 sc1
  s_add_u32 s92, s92, s94
  v_accvgpr_read_b32 v184, a64
  v_accvgpr_read_b32 v185, a65
  v_accvgpr_read_b32 v186, a66
  v_accvgpr_read_b32 v187, a67
  v_accvgpr_read_b32 v188, a68
  v_accvgpr_read_b32 v189, a69
  v_accvgpr_read_b32 v190, a70
  v_accvgpr_read_b32 v191, a71
  v_cvt_pk_bf16_f32 v180, v184, v185
  v_cvt_pk_bf16_f32 v181, v186, v187
  v_cvt_pk_bf16_f32 v182, v188, v189
  v_cvt_pk_bf16_f32 v183, v190, v191
  buffer_store_dwordx4 v[180:183], v178, s[16:19], s92 offen offset:0 sc1
  v_accvgpr_read_b32 v196, a72
  v_accvgpr_read_b32 v197, a73
  v_accvgpr_read_b32 v198, a74
  v_accvgpr_read_b32 v199, a75
  v_accvgpr_read_b32 v200, a76
  v_accvgpr_read_b32 v201, a77
  v_accvgpr_read_b32 v202, a78
  v_accvgpr_read_b32 v203, a79
  v_cvt_pk_bf16_f32 v192, v196, v197
  v_cvt_pk_bf16_f32 v193, v198, v199
  v_cvt_pk_bf16_f32 v194, v200, v201
  v_cvt_pk_bf16_f32 v195, v202, v203
  buffer_store_dwordx4 v[192:195], v178, s[16:19], s92 offen offset:64 sc1
  s_add_u32 s92, s92, s94
  v_accvgpr_read_b32 v208, a80
  v_accvgpr_read_b32 v209, a81
  v_accvgpr_read_b32 v210, a82
  v_accvgpr_read_b32 v211, a83
  v_accvgpr_read_b32 v212, a84
  v_accvgpr_read_b32 v213, a85
  v_accvgpr_read_b32 v214, a86
  v_accvgpr_read_b32 v215, a87
  v_cvt_pk_bf16_f32 v204, v208, v209
  v_cvt_pk_bf16_f32 v205, v210, v211
  v_cvt_pk_bf16_f32 v206, v212, v213
  v_cvt_pk_bf16_f32 v207, v214, v215
  buffer_store_dwordx4 v[204:207], v178, s[16:19], s92 offen offset:0 sc1
  v_accvgpr_read_b32 v220, a88
  v_accvgpr_read_b32 v221, a89
  v_accvgpr_read_b32 v222, a90
  v_accvgpr_read_b32 v223, a91
  v_accvgpr_read_b32 v224, a92
  v_accvgpr_read_b32 v225, a93
  v_accvgpr_read_b32 v226, a94
  v_accvgpr_read_b32 v227, a95
  v_cvt_pk_bf16_f32 v216, v220, v221
  v_cvt_pk_bf16_f32 v217, v222, v223
  v_cvt_pk_bf16_f32 v218, v224, v225
  v_cvt_pk_bf16_f32 v219, v226, v227
  buffer_store_dwordx4 v[216:219], v178, s[16:19], s92 offen offset:64 sc1
  s_add_u32 s92, s92, s94
  v_accvgpr_read_b32 v184, a96
  v_accvgpr_read_b32 v185, a97
  v_accvgpr_read_b32 v186, a98
  v_accvgpr_read_b32 v187, a99
  v_accvgpr_read_b32 v188, a100
  v_accvgpr_read_b32 v189, a101
  v_accvgpr_read_b32 v190, a102
  v_accvgpr_read_b32 v191, a103
  v_cvt_pk_bf16_f32 v180, v184, v185
  v_cvt_pk_bf16_f32 v181, v186, v187
  v_cvt_pk_bf16_f32 v182, v188, v189
  v_cvt_pk_bf16_f32 v183, v190, v191
  buffer_store_dwordx4 v[180:183], v178, s[16:19], s92 offen offset:0 sc1
  v_accvgpr_read_b32 v196, a104
  v_accvgpr_read_b32 v197, a105
  v_accvgpr_read_b32 v198, a106
  v_accvgpr_read_b32 v199, a107
  v_accvgpr_read_b32 v200, a108
  v_accvgpr_read_b32 v201, a109
  v_accvgpr_read_b32 v202, a110
  v_accvgpr_read_b32 v203, a111
  v_cvt_pk_bf16_f32 v192, v196, v197
  v_cvt_pk_bf16_f32 v193, v198, v199
  v_cvt_pk_bf16_f32 v194, v200, v201
  v_cvt_pk_bf16_f32 v195, v202, v203
  buffer_store_dwordx4 v[192:195], v178, s[16:19], s92 offen offset:64 sc1
  s_add_u32 s92, s92, s94
  v_accvgpr_read_b32 v208, a112
  v_accvgpr_read_b32 v209, a113
  v_accvgpr_read_b32 v210, a114
  v_accvgpr_read_b32 v211, a115
  v_accvgpr_read_b32 v212, a116
  v_accvgpr_read_b32 v213, a117
  v_accvgpr_read_b32 v214, a118
  v_accvgpr_read_b32 v215, a119
  v_cvt_pk_bf16_f32 v204, v208, v209
  v_cvt_pk_bf16_f32 v205, v210, v211
  v_cvt_pk_bf16_f32 v206, v212, v213
  v_cvt_pk_bf16_f32 v207, v214, v215
  buffer_store_dwordx4 v[204:207], v178, s[16:19], s92 offen offset:0 sc1
  v_accvgpr_read_b32 v220, a120
  v_accvgpr_read_b32 v221, a121
  v_accvgpr_read_b32 v222, a122
  v_accvgpr_read_b32 v223, a123
  v_accvgpr_read_b32 v224, a124
  v_accvgpr_read_b32 v225, a125
  v_accvgpr_read_b32 v226, a126
  v_accvgpr_read_b32 v227, a127
  v_cvt_pk_bf16_f32 v216, v220, v221
  v_cvt_pk_bf16_f32 v217, v222, v223
  v_cvt_pk_bf16_f32 v218, v224, v225
  v_cvt_pk_bf16_f32 v219, v226, v227
  buffer_store_dwordx4 v[216:219], v178, s[16:19], s92 offen offset:64 sc1
  s_add_u32 s92, s92, s94
  s_branch L_epid
L_e5:
L_edef:
  s_mov_b32 s49, 1
  s_cmp_eq_u32 s58, 1
  s_cbranch_scc1 L_epid
  s_mov_b32 s49, 0
  buffer_store_dwordx4 v[176:179], v172, s[4:7], s46 offen offset:0 sc1
  buffer_store_dwordx4 v[180:183], v172, s[4:7], s46 offen offset:1024 sc1
  buffer_store_dwordx4 v[184:187], v172, s[4:7], s46 offen offset:2048 sc1
  buffer_store_dwordx4 v[188:191], v172, s[4:7], s46 offen offset:3072 sc1
  buffer_store_dwordx4 v[192:195], v173, s[4:7], s46 offen offset:0 sc1
  buffer_store_dwordx4 v[196:199], v173, s[4:7], s46 offen offset:1024 sc1
  buffer_store_dwordx4 v[200:203], v173, s[4:7], s46 offen offset:2048 sc1
  buffer_store_dwordx4 v[204:207], v173, s[4:7], s46 offen offset:3072 sc1
  buffer_store_dwordx4 v[208:211], v172, s[4:7], s47 offen offset:0 sc1
  buffer_store_dwordx4 v[212:215], v172, s[4:7], s47 offen offset:1024 sc1
  buffer_store_dwordx4 v[216:219], v172, s[4:7], s47 offen offset:2048 sc1
  buffer_store_dwordx4 v[220:223], v172, s[4:7], s47 offen offset:3072 sc1
  buffer_store_dwordx4 v[224:227], v173, s[4:7], s47 offen offset:0 sc1
  buffer_store_dwordx4 v[228:231], v173, s[4:7], s47 offen offset:1024 sc1
  buffer_store_dwordx4 v[232:235], v173, s[4:7], s47 offen offset:2048 sc1
  buffer_store_dwordx4 v[236:239], v173, s[4:7], s47 offen offset:3072 sc1
  s_mov_b32 s46, 0x40000000
  s_mov_b32 s47, 0x40000000
L_esig:
  s_waitcnt vmcnt(0)
  s_cmp_lg_u32 s39, 0
  s_cbranch_scc1 L_vok
  v_mbcnt_lo_u32_b32 v250, -1, 0
  v_mbcnt_hi_u32_b32 v250, -1, v250
  s_lshl_b32 s90, s32, 9
  s_add_u32 s90, s90, 147520
  v_lshl_add_u32 v251, v250, 3, s90
  ds_write_b64 v251, v[248:249]
  s_waitcnt lgkmcnt(0)
  s_cmp_lg_u32 s32, 0
  s_cbranch_scc1 L_vd_4
  v_lshlrev_b32 v250, 2, v250
  s_cmp_lg_u32 s100, 0
  s_cbranch_scc1 L_vw_3
  v_readfirstlane_b32 s90, v247
  s_and_b32 s90, s90, s101
  s_cbranch_scc0 L_vw_3
  v_mov_b32 v251, 1
  s_mov_b64 exec, 1
  buffer_store_dword v251, v250, s[28:31], 0 offen offset:32 sc1
  s_mov_b64 exec, -1
L_vw_3:
  buffer_load_dword v251, v250, s[28:31], 0 offen sc1
  s_waitcnt vmcnt(0)
  v_cmp_eq_u32 vcc, -1, v251
  v_readlane_b32 s91, v251, 8
  v_readlane_b32 s92, v251, 32
  v_readlane_b32 s93, v251, 33
  v_readlane_b32 s90, v251, 34
  s_cmp_lg_u32 s100, 0
  s_cselect_b32 s93, s90, s93
  s_cselect_b32 s91, 0, s91
  s_cselect_b32 s92, 1, s92
  s_cselect_b32 s90, 0xff, vcc_lo
  s_cmp_lg_u32 s91, 0
  s_cselect_b32 s92, 3, s92
  s_cbranch_scc1 L_vk_5
  s_add_u32 s3, s3, 1
  s_cmp_ge_u32 s3, 131072
  s_cselect_b32 s92, 4, s92
  s_cbranch_scc1 L_vk_5
  s_sleep 8
  s_and_b32 s90, s90, 0xff
  s_cmp_lg_u32 s90, 0xff
  s_cbranch_scc1 L_vw_3
  s_cmp_lt_u32 s93, 128
  s_cbranch_scc1 L_vw_3
L_vk_5:
  v_mov_b32 v251, s92
  v_mov_b32 v250, 147456
  ds_write_b32 v250, v251
  s_waitcnt lgkmcnt(0)
L_vd_4:
  s_barrier
  v_mov_b32 v250, 147456
  ds_read_b32 v251, v250
  s_waitcnt lgkmcnt(0)
  v_readfirstlane_b32 s92, v251
  s_barrier
  s_cmp_eq_u32 s92, 3
  s_cbranch_scc1 L_fallback
  s_cmp_eq_u32 s92, 4
  s_cbranch_scc1 L_exit
  s_mov_b32 s39, 1
L_vok:
  s_barrier
  s_cmp_lg_u32 s32, 0
  s_cbranch_scc1 L_sig_6
  v_mov_b32 v254, s63
  v_mov_b32 v255, 0
  v_and_b32 v254, 3, v254
  v_mbcnt_lo_u32_b32 v255, -1, 0
  v_lshlrev_b32 v255, 9, v255
  s_cmp_ge_u32 s63, 2
  s_cselect_b64 exec, 3, 1
  buffer_atomic_add v254, v255, s[4:7], s62 offen offset:0 sc1
  s_mov_b64 exec, -1
L_sig_6:
L_epid:
  s_mov_b32 s59, 0
  s_cmp_eq_u32 s58, 1
  s_cbranch_scc1 L_r1
  s_cmp_eq_u32 s58, 2
  s_cbranch_scc1 L_r2
  s_cmp_eq_u32 s58, 3
  s_cbranch_scc1 L_next
  s_cmp_eq_u32 s35, 4
  s_cbranch_scc1 L_atb
  s_cmp_eq_u32 s35, 5
  s_cbranch_scc1 L_bo
  s_cmp_eq_u32 s35, 6
  s_cbranch_scc1 L_ata
  s_cmp_eq_u32 s35, 11
  s_cbranch_scc1 L_ata4
  s_cmp_eq_u32 s35, 7
  s_cbranch_scc1 L_ao
  s_cmp_eq_u32 s35, 8
  s_cbranch_scc1 L_aos
  s_cmp_eq_u32 s35, 12
  s_cbranch_scc1 L_swp
  s_cmp_eq_u32 s35, 14
  s_cbranch_scc1 L_ao4
  s_cmp_eq_u32 s35, 16
  s_cbranch_scc1 L_ao
  s_cmp_eq_u32 s35, 17
  s_cbranch_scc1 L_bo
  s_branch L_exit
L_aqkv:
  s_mov_b32 s8, s64
  s_and_b32 s9, s65, 0xffff
  s_mov_b32 s10, 0x400000
  s_mov_b32 s11, 0x20000
  s_cmp_eq_u32 s35, 0
  s_cselect_b64 s[88:89], s[68:69], s[70:71]
  s_cmp_eq_u32 s35, 2
  s_cselect_b64 s[88:89], s[72:73], s[88:89]
  s_mov_b32 s12, s88
  s_and_b32 s13, s89, 0xffff
  s_mov_b32 s14, 0x800000
  s_mov_b32 s15, 0x20000
  s_lshl_b32 s91, s33, 2
  s_add_u32 s91, s91, s37
  s_mov_b32 s24, 8192
  s_mov_b32 s26, 262144
  s_lshl_b32 s20, s36, 19
  s_lshl_b32 s21, s91, 9
  s_lshl_b32 s22, s35, 24
  s_lshl_b32 s90, s36, 21
  s_add_u32 s22, s22, s90
  s_lshl_b32 s90, s91, 14
  s_add_u32 s22, s22, s90
  s_lshl_b32 s38, s36, 9
  s_add_u32 s38, s38, 28672
  s_cmp_eq_u32 s35, 0
  s_cselect_b32 s38, 8192, s38
  s_cselect_b32 s98, 1, 2
  s_mov_b32 s48, s35
  s_branch L_g1
L_bqkv:
  s_mov_b32 s8, s78
  s_and_b32 s9, s79, 0xffff
  s_mov_b32 s10, 0x400000
  s_mov_b32 s11, 0x20000
  s_mov_b32 s12, s80
  s_and_b32 s13, s81, 0xffff
  s_mov_b32 s14, 0x600000
  s_mov_b32 s15, 0x20000
  s_lshl_b32 s91, s37, 2
  s_add_u32 s91, s91, s33
  s_mov_b32 s24, 6144
  s_mov_b32 s26, 65536
  s_lshl_b32 s20, s36, 19
  s_lshl_b32 s21, s91, 9
  s_lshl_b32 s22, s37, 22
  s_lshl_b32 s90, s36, 19
  s_add_u32 s22, s22, s90
  s_lshl_b32 s90, s33, 14
  s_add_u32 s22, s22, s90
  s_add_u32 s22, s22, 0x4000000
  s_mov_b32 s38, 12288
  s_mov_b32 s48, s37
  s_mov_b32 s98, 1
L_g1:
  s_lshl_b32 s90, s36, 9
  s_add_u32 s38, s38, s90
  s_lshl_b32 s90, s33, 7
  s_add_u32 s38, s38, s90
  s_mov_b32 s23, 2048
  s_mov_b32 s25, 8
  v_and_b32 v1, 63, v0
  v_lshrrev_b32 v38, 6, v0
  s_nop 0
  v_readfirstlane_b32 s27, v38
  s_mul_i32 s90, s27, 64
  v_lshrrev_b32 v38, 3, v1
  v_add_u32 v38, s90, v38
  v_mul_lo_u32 v38, v38, s23
  v_lshrrev_b32 v39, 4, v1
  v_xor_b32 v39, v39, v1
  v_and_b32 v39, 7, v39
  v_lshl_add_u32 v2, v39, 4, v38
  s_mul_i32 s91, s23, 8
  v_add_u32 v3, s91, v2
  v_xor_b32 v3, 64, v3
  v_add_u32 v4, s91, v3
  v_xor_b32 v4, 64, v4
  v_add_u32 v5, s91, v4
  v_xor_b32 v5, 64, v5
  v_add_u32 v6, s91, v5
  v_xor_b32 v6, 64, v6
  v_add_u32 v7, s91, v6
  v_xor_b32 v7, 64, v7
  v_add_u32 v8, s91, v7
  v_xor_b32 v8, 64, v8
  v_add_u32 v9, s91, v8
  v_xor_b32 v9, 64, v9
  s_mul_i32 s90, s27, 16
  v_lshrrev_b32 v38, 5, v1
  v_add_u32 v38, 0, v38
  v_add_u32 v38, s90, v38
  v_mov_b32 v174, v38
  v_and_b32 v39, 3, v38
  v_lshlrev_b32 v39, 1, v39
  v_and_b32 v40, 8, v38
  v_or_b32 v39, v39, v40
  v_xor_b32 v39, v39, v1
  v_and_b32 v39, 31, v39
  v_mul_lo_u32 v38, v38, s24
  v_lshl_add_u32 v10, v39, 4, v38
  v_lshrrev_b32 v38, 5, v1
  v_add_u32 v38, 2, v38
  v_add_u32 v38, s90, v38
  v_and_b32 v39, 3, v38
  v_lshlrev_b32 v39, 1, v39
  v_and_b32 v40, 8, v38
  v_or_b32 v39, v39, v40
  v_xor_b32 v39, v39, v1
  v_and_b32 v39, 31, v39
  v_mul_lo_u32 v38, v38, s24
  v_lshl_add_u32 v11, v39, 4, v38
  v_lshrrev_b32 v38, 5, v1
  v_add_u32 v38, 4, v38
  v_add_u32 v38, s90, v38
  v_and_b32 v39, 3, v38
  v_lshlrev_b32 v39, 1, v39
  v_and_b32 v40, 8, v38
  v_or_b32 v39, v39, v40
  v_xor_b32 v39, v39, v1
  v_and_b32 v39, 31, v39
  v_mul_lo_u32 v38, v38, s24
  v_lshl_add_u32 v12, v39, 4, v38
  v_lshrrev_b32 v38, 5, v1
  v_add_u32 v38, 6, v38
  v_add_u32 v38, s90, v38
  v_and_b32 v39, 3, v38
  v_lshlrev_b32 v39, 1, v39
  v_and_b32 v40, 8, v38
  v_or_b32 v39, v39, v40
  v_xor_b32 v39, v39, v1
  v_and_b32 v39, 31, v39
  v_mul_lo_u32 v38, v38, s24
  v_lshl_add_u32 v13, v39, 4, v38
  v_lshrrev_b32 v38, 5, v1
  v_add_u32 v38, 8, v38
  v_add_u32 v38, s90, v38
  v_and_b32 v39, 3, v38
  v_lshlrev_b32 v39, 1, v39
  v_and_b32 v40, 8, v38
  v_or_b32 v39, v39, v40
  v_xor_b32 v39, v39, v1
  v_and_b32 v39, 31, v39
  v_mul_lo_u32 v38, v38, s24
  v_lshl_add_u32 v14, v39, 4, v38
  v_lshrrev_b32 v38, 5, v1
  v_add_u32 v38, 10, v38
  v_add_u32 v38, s90, v38
  v_and_b32 v39, 3, v38
  v_lshlrev_b32 v39, 1, v39
  v_and_b32 v40, 8, v38
  v_or_b32 v39, v39, v40
  v_xor_b32 v39, v39, v1
  v_and_b32 v39, 31, v39
  v_mul_lo_u32 v38, v38, s24
  v_lshl_add_u32 v15, v39, 4, v38
  v_lshrrev_b32 v38, 5, v1
  v_add_u32 v38, 12, v38
  v_add_u32 v38, s90, v38
  v_and_b32 v39, 3, v38
  v_lshlrev_b32 v39, 1, v39
  v_and_b32 v40, 8, v38
  v_or_b32 v39, v39, v40
  v_xor_b32 v39, v39, v1
  v_and_b32 v39, 31, v39
  v_mul_lo_u32 v38, v38, s24
  v_lshl_add_u32 v16, v39, 4, v38
  v_lshrrev_b32 v38, 5, v1
  v_add_u32 v38, 14, v38
  v_add_u32 v38, s90, v38
  v_and_b32 v39, 3, v38
  v_lshlrev_b32 v39, 1, v39
  v_and_b32 v40, 8, v38
  v_or_b32 v39, v39, v40
  v_xor_b32 v39, v39, v1
  v_and_b32 v39, 31, v39
  v_mul_lo_u32 v38, v38, s24
  v_lshl_add_u32 v17, v39, 4, v38
  s_mul_i32 s51, s24, 64
  s_mul_i32 s52, s27, 8192
  s_mul_i32 s53, s27, 8192
  s_add_u32 s53, s53, 32768
  s_add_u32 m0, s52, 0
  s_nop 0
  buffer_load_dwordx4 v2, s[8:11], s20 offen  lds
  s_add_u32 m0, s53, 0
  s_nop 0
  buffer_load_dwordx4 v10, s[12:15], s21 offen  lds
  s_add_u32 m0, s52, 1024
  s_nop 0
  buffer_load_dwordx4 v3, s[8:11], s20 offen  lds
  s_add_u32 m0, s53, 1024
  s_nop 0
  buffer_load_dwordx4 v11, s[12:15], s21 offen  lds
  s_add_u32 m0, s52, 2048
  s_nop 0
  buffer_load_dwordx4 v4, s[8:11], s20 offen  lds
  s_add_u32 m0, s53, 2048
  s_nop 0
  buffer_load_dwordx4 v12, s[12:15], s21 offen  lds
  s_add_u32 m0, s52, 3072
  s_nop 0
  buffer_load_dwordx4 v5, s[8:11], s20 offen  lds
  s_add_u32 m0, s53, 3072
  s_nop 0
  buffer_load_dwordx4 v13, s[12:15], s21 offen  lds
  s_add_u32 m0, s52, 4096
  s_nop 0
  buffer_load_dwordx4 v6, s[8:11], s20 offen  lds
  s_add_u32 m0, s53, 4096
  s_nop 0
  buffer_load_dwordx4 v14, s[12:15], s21 offen  lds
  s_add_u32 m0, s52, 5120
  s_nop 0
  buffer_load_dwordx4 v7, s[8:11], s20 offen  lds
  s_add_u32 m0, s53, 5120
  s_nop 0
  buffer_load_dwordx4 v15, s[12:15], s21 offen  lds
  s_add_u32 m0, s52, 6144
  s_nop 0
  buffer_load_dwordx4 v8, s[8:11], s20 offen  lds
  s_add_u32 m0, s53, 6144
  s_nop 0
  buffer_load_dwordx4 v16, s[12:15], s21 offen  lds
  s_add_u32 m0, s52, 7168
  s_nop 0
  buffer_load_dwordx4 v9, s[8:11], s20 offen  lds
  s_add_u32 m0, s53, 7168
  s_nop 0
  buffer_load_dwordx4 v17, s[12:15], s21 offen  lds
  s_add_u32 s20, s20, 128
  s_add_u32 s21, s21, s51
  s_add_u32 m0, s52, 65536
  s_nop 0
  buffer_load_dwordx4 v2, s[8:11], s20 offen  lds
  s_add_u32 m0, s53, 65536
  s_nop 0
  buffer_load_dwordx4 v10, s[12:15], s21 offen  lds
  s_add_u32 m0, s52, 66560
  s_nop 0
  buffer_load_dwordx4 v3, s[8:11], s20 offen  lds
  s_add_u32 m0, s53, 66560
  s_nop 0
  buffer_load_dwordx4 v11, s[12:15], s21 offen  lds
  s_add_u32 m0, s52, 67584
  s_nop 0
  buffer_load_dwordx4 v4, s[8:11], s20 offen  lds
  s_add_u32 m0, s53, 67584
  s_nop 0
  buffer_load_dwordx4 v12, s[12:15], s21 offen  lds
  s_add_u32 m0, s52, 68608
  s_nop 0
  buffer_load_dwordx4 v5, s[8:11], s20 offen  lds
  s_add_u32 m0, s53, 68608
  s_nop 0
  buffer_load_dwordx4 v13, s[12:15], s21 offen  lds
  s_add_u32 m0, s52, 69632
  s_nop 0
  buffer_load_dwordx4 v6, s[8:11], s20 offen  lds
  s_add_u32 m0, s53, 69632
  s_nop 0
  buffer_load_dwordx4 v14, s[12:15], s21 offen  lds
  s_add_u32 m0, s52, 70656
  s_nop 0
  buffer_load_dwordx4 v7, s[8:11], s20 offen  lds
  s_add_u32 m0, s53, 70656
  s_nop 0
  buffer_load_dwordx4 v15, s[12:15], s21 offen  lds
  s_add_u32 m0, s52, 71680
  s_nop 0
  buffer_load_dwordx4 v8, s[8:11], s20 offen  lds
  s_add_u32 m0, s53, 71680
  s_nop 0
  buffer_load_dwordx4 v16, s[12:15], s21 offen  lds
  s_add_u32 m0, s52, 72704
  s_nop 0
  buffer_load_dwordx4 v9, s[8:11], s20 offen  lds
  s_add_u32 m0, s53, 72704
  s_nop 0
  buffer_load_dwordx4 v17, s[12:15], s21 offen  lds
  s_add_u32 s20, s20, 128
  s_add_u32 s21, s21, s51
  s_lshr_b32 s90, s27, 1
  s_and_b32 s91, s27, 1
  s_mul_i32 s92, s90, 16384
  v_mov_b32 v38, 0x0
  v_bfe_u32 v39, v1, 0, 4
  v_lshl_add_u32 v38, v39, 7, v38
  v_add_u32 v38, s92, v38
  v_lshrrev_b32 v39, 1, v1
  v_and_b32 v39, 7, v39
  v_lshrrev_b32 v40, 4, v1
  v_xor_b32 v39, v39, v40
  v_lshl_add_u32 v18, v39, 4, v38
  v_xor_b32 v19, 64, v18
  v_add_u32 v20, 65536, v18
  v_add_u32 v21, 65536, v19
  v_mov_b32 v38, 0x0
  v_bfe_u32 v39, v1, 2, 2
  v_lshl_add_u32 v38, v39, 9, v38
  v_bfe_u32 v39, v1, 4, 2
  v_lshl_add_u32 v38, v39, 12, v38
  v_bfe_u32 v39, v1, 0, 2
  v_lshl_add_u32 v38, v39, 3, v38
  v_bfe_u32 v40, v1, 2, 3
  s_mul_i32 s92, s91, 8
  s_add_u32 s93, s92, 0
  v_xor_b32 v39, s93, v40
  v_lshl_add_u32 v22, v39, 5, v38
  v_add_u32 v30, 65536, v22
  s_add_u32 s93, s92, 1
  v_xor_b32 v39, s93, v40
  v_lshl_add_u32 v23, v39, 5, v38
  v_add_u32 v31, 65536, v23
  s_add_u32 s93, s92, 2
  v_xor_b32 v39, s93, v40
  v_lshl_add_u32 v24, v39, 5, v38
  v_add_u32 v32, 65536, v24
  s_add_u32 s93, s92, 3
  v_xor_b32 v39, s93, v40
  v_lshl_add_u32 v25, v39, 5, v38
  v_add_u32 v33, 65536, v25
  s_add_u32 s93, s92, 4
  v_xor_b32 v39, s93, v40
  v_lshl_add_u32 v26, v39, 5, v38
  v_add_u32 v34, 65536, v26
  s_add_u32 s93, s92, 5
  v_xor_b32 v39, s93, v40
  v_lshl_add_u32 v27, v39, 5, v38
  v_add_u32 v35, 65536, v27
  s_add_u32 s93, s92, 6
  v_xor_b32 v39, s93, v40
  v_lshl_add_u32 v28, v39, 5, v38
  v_add_u32 v36, 65536, v28
  s_add_u32 s93, s92, 7
  v_xor_b32 v39, s93, v40
  v_lshl_add_u32 v29, v39, 5, v38
  v_add_u32 v37, 65536, v29
  v_mov_b32 v241, 147456
  v_lshrrev_b32 v175, 4, v0
  v_add_u32 v175, v175, v241
  s_mov_b32 s58, 1
  s_branch L_epi
L_r1:
  s_cmp_eq_u32 s49, 1
  s_cbranch_scc1 L_r1c
  s_waitcnt vmcnt(16)
L_r1c:
  s_cmp_eq_u32 s48, 2
  s_cbranch_scc1 L_g2
  s_waitcnt vmcnt(16)
  s_barrier
  ds_read_b128 v[44:47], v18 offset:0
  ds_read_b64_tr_b16 v[108:109], v22 offset:32768
  ds_read_b64_tr_b16 v[110:111], v22 offset:34816
  ds_read_b128 v[48:51], v18 offset:2048
  ds_read_b64_tr_b16 v[112:113], v23 offset:32768
  ds_read_b64_tr_b16 v[114:115], v23 offset:34816
  ds_read_b128 v[52:55], v18 offset:4096
  ds_read_b64_tr_b16 v[116:117], v24 offset:32768
  ds_read_b64_tr_b16 v[118:119], v24 offset:34816
  ds_read_b128 v[56:59], v18 offset:6144
  ds_read_b64_tr_b16 v[120:121], v25 offset:32768
  ds_read_b64_tr_b16 v[122:123], v25 offset:34816
  ds_read_b128 v[60:63], v18 offset:8192
  ds_read_b64_tr_b16 v[124:125], v26 offset:32768
  ds_read_b64_tr_b16 v[126:127], v26 offset:34816
  ds_read_b128 v[64:67], v18 offset:10240
  ds_read_b64_tr_b16 v[128:129], v27 offset:32768
  ds_read_b64_tr_b16 v[130:131], v27 offset:34816
  ds_read_b128 v[68:71], v18 offset:12288
  ds_read_b64_tr_b16 v[132:133], v28 offset:32768
  ds_read_b64_tr_b16 v[134:135], v28 offset:34816
  ds_read_b128 v[72:75], v18 offset:14336
  ds_read_b64_tr_b16 v[136:137], v29 offset:32768
  ds_read_b64_tr_b16 v[138:139], v29 offset:34816
  s_sub_u32 s25, s25, 1
  s_waitcnt lgkmcnt(0)
  s_nop 0
  v_mfma_f32_16x16x32_bf16 a[0:3], v[108:111], v[44:47], 0
  buffer_store_dwordx4 v[176:179], v172, s[4:7], s46 offen offset:0 sc1
  ds_read_b128 v[76:79], v19 offset:0
  v_mfma_f32_16x16x32_bf16 a[4:7], v[112:115], v[44:47], 0
  v_mfma_f32_16x16x32_bf16 a[8:11], v[116:119], v[44:47], 0
  ds_read_b64_tr_b16 v[140:141], v22 offset:49152
  v_mfma_f32_16x16x32_bf16 a[12:15], v[120:123], v[44:47], 0
  s_nop 0
  v_mfma_f32_16x16x32_bf16 a[16:19], v[124:127], v[44:47], 0
  buffer_store_dwordx4 v[180:183], v172, s[4:7], s46 offen offset:1024 sc1
  ds_read_b64_tr_b16 v[142:143], v22 offset:51200
  v_mfma_f32_16x16x32_bf16 a[20:23], v[128:131], v[44:47], 0
  v_mfma_f32_16x16x32_bf16 a[24:27], v[132:135], v[44:47], 0
  ds_read_b128 v[80:83], v19 offset:2048
  v_mfma_f32_16x16x32_bf16 a[28:31], v[136:139], v[44:47], 0
  s_nop 0
  v_mfma_f32_16x16x32_bf16 a[32:35], v[108:111], v[48:51], 0
  buffer_store_dwordx4 v[184:187], v172, s[4:7], s46 offen offset:2048 sc1
  ds_read_b64_tr_b16 v[144:145], v23 offset:49152
  v_mfma_f32_16x16x32_bf16 a[36:39], v[112:115], v[48:51], 0
  v_mfma_f32_16x16x32_bf16 a[40:43], v[116:119], v[48:51], 0
  ds_read_b64_tr_b16 v[146:147], v23 offset:51200
  v_mfma_f32_16x16x32_bf16 a[44:47], v[120:123], v[48:51], 0
  s_nop 0
  v_mfma_f32_16x16x32_bf16 a[48:51], v[124:127], v[48:51], 0
  buffer_store_dwordx4 v[188:191], v172, s[4:7], s46 offen offset:3072 sc1
  ds_read_b128 v[84:87], v19 offset:4096
  v_mfma_f32_16x16x32_bf16 a[52:55], v[128:131], v[48:51], 0
  v_mfma_f32_16x16x32_bf16 a[56:59], v[132:135], v[48:51], 0
  ds_read_b64_tr_b16 v[148:149], v24 offset:49152
  v_mfma_f32_16x16x32_bf16 a[60:63], v[136:139], v[48:51], 0
  s_nop 0
  v_mfma_f32_16x16x32_bf16 a[64:67], v[108:111], v[52:55], 0
  buffer_store_dwordx4 v[192:195], v173, s[4:7], s46 offen offset:0 sc1
  ds_read_b64_tr_b16 v[150:151], v24 offset:51200
  v_mfma_f32_16x16x32_bf16 a[68:71], v[112:115], v[52:55], 0
  v_mfma_f32_16x16x32_bf16 a[72:75], v[116:119], v[52:55], 0
  ds_read_b128 v[88:91], v19 offset:6144
  v_mfma_f32_16x16x32_bf16 a[76:79], v[120:123], v[52:55], 0
  s_nop 0
  v_mfma_f32_16x16x32_bf16 a[80:83], v[124:127], v[52:55], 0
  buffer_store_dwordx4 v[196:199], v173, s[4:7], s46 offen offset:1024 sc1
  ds_read_b64_tr_b16 v[152:153], v25 offset:49152
  v_mfma_f32_16x16x32_bf16 a[84:87], v[128:131], v[52:55], 0
  v_mfma_f32_16x16x32_bf16 a[88:91], v[132:135], v[52:55], 0
  ds_read_b64_tr_b16 v[154:155], v25 offset:51200
  v_mfma_f32_16x16x32_bf16 a[92:95], v[136:139], v[52:55], 0
  s_nop 0
  v_mfma_f32_16x16x32_bf16 a[96:99], v[108:111], v[56:59], 0
  buffer_store_dwordx4 v[200:203], v173, s[4:7], s46 offen offset:2048 sc1
  ds_read_b128 v[92:95], v19 offset:8192
  v_mfma_f32_16x16x32_bf16 a[100:103], v[112:115], v[56:59], 0
  v_mfma_f32_16x16x32_bf16 a[104:107], v[116:119], v[56:59], 0
  ds_read_b64_tr_b16 v[156:157], v26 offset:49152
  v_mfma_f32_16x16x32_bf16 a[108:111], v[120:123], v[56:59], 0
  s_nop 0
  v_mfma_f32_16x16x32_bf16 a[112:115], v[124:127], v[56:59], 0
  buffer_store_dwordx4 v[204:207], v173, s[4:7], s46 offen offset:3072 sc1
  ds_read_b64_tr_b16 v[158:159], v26 offset:51200
  v_mfma_f32_16x16x32_bf16 a[116:119], v[128:131], v[56:59], 0
  v_mfma_f32_16x16x32_bf16 a[120:123], v[132:135], v[56:59], 0
  ds_read_b128 v[96:99], v19 offset:10240
  v_mfma_f32_16x16x32_bf16 a[124:127], v[136:139], v[56:59], 0
  s_nop 0
  v_mfma_f32_16x16x32_bf16 a[128:131], v[108:111], v[60:63], 0
  buffer_store_dwordx4 v[208:211], v172, s[4:7], s47 offen offset:0 sc1
  ds_read_b64_tr_b16 v[160:161], v27 offset:49152
  v_mfma_f32_16x16x32_bf16 a[132:135], v[112:115], v[60:63], 0
  v_mfma_f32_16x16x32_bf16 a[136:139], v[116:119], v[60:63], 0
  ds_read_b64_tr_b16 v[162:163], v27 offset:51200
  v_mfma_f32_16x16x32_bf16 a[140:143], v[120:123], v[60:63], 0
  s_nop 0
  v_mfma_f32_16x16x32_bf16 a[144:147], v[124:127], v[60:63], 0
  buffer_store_dwordx4 v[212:215], v172, s[4:7], s47 offen offset:1024 sc1
  ds_read_b128 v[100:103], v19 offset:12288
  v_mfma_f32_16x16x32_bf16 a[148:151], v[128:131], v[60:63], 0
  v_mfma_f32_16x16x32_bf16 a[152:155], v[132:135], v[60:63], 0
  ds_read_b64_tr_b16 v[164:165], v28 offset:49152
  v_mfma_f32_16x16x32_bf16 a[156:159], v[136:139], v[60:63], 0
  s_nop 0
  v_mfma_f32_16x16x32_bf16 a[160:163], v[108:111], v[64:67], 0
  buffer_store_dwordx4 v[216:219], v172, s[4:7], s47 offen offset:2048 sc1
  ds_read_b64_tr_b16 v[166:167], v28 offset:51200
  v_mfma_f32_16x16x32_bf16 a[164:167], v[112:115], v[64:67], 0
  v_mfma_f32_16x16x32_bf16 a[168:171], v[116:119], v[64:67], 0
  ds_read_b128 v[104:107], v19 offset:14336
  v_mfma_f32_16x16x32_bf16 a[172:175], v[120:123], v[64:67], 0
  s_nop 0
  v_mfma_f32_16x16x32_bf16 a[176:179], v[124:127], v[64:67], 0
  buffer_store_dwordx4 v[220:223], v172, s[4:7], s47 offen offset:3072 sc1
  ds_read_b64_tr_b16 v[168:169], v29 offset:49152
  v_mfma_f32_16x16x32_bf16 a[180:183], v[128:131], v[64:67], 0
  v_mfma_f32_16x16x32_bf16 a[184:187], v[132:135], v[64:67], 0
  ds_read_b64_tr_b16 v[170:171], v29 offset:51200
  v_mfma_f32_16x16x32_bf16 a[188:191], v[136:139], v[64:67], 0
  s_nop 0
  v_mfma_f32_16x16x32_bf16 a[192:195], v[108:111], v[68:71], 0
  buffer_store_dwordx4 v[224:227], v173, s[4:7], s47 offen offset:0 sc1
  v_mfma_f32_16x16x32_bf16 a[196:199], v[112:115], v[68:71], 0
  v_mfma_f32_16x16x32_bf16 a[200:203], v[116:119], v[68:71], 0
  v_mfma_f32_16x16x32_bf16 a[204:207], v[120:123], v[68:71], 0
  s_nop 0
  v_mfma_f32_16x16x32_bf16 a[208:211], v[124:127], v[68:71], 0
  buffer_store_dwordx4 v[228:231], v173, s[4:7], s47 offen offset:1024 sc1
  v_mfma_f32_16x16x32_bf16 a[212:215], v[128:131], v[68:71], 0
  v_mfma_f32_16x16x32_bf16 a[216:219], v[132:135], v[68:71], 0
  v_mfma_f32_16x16x32_bf16 a[220:223], v[136:139], v[68:71], 0
  s_nop 0
  v_mfma_f32_16x16x32_bf16 a[224:227], v[108:111], v[72:75], 0
  buffer_store_dwordx4 v[232:235], v173, s[4:7], s47 offen offset:2048 sc1
  v_mfma_f32_16x16x32_bf16 a[228:231], v[112:115], v[72:75], 0
  v_mfma_f32_16x16x32_bf16 a[232:235], v[116:119], v[72:75], 0
  v_mfma_f32_16x16x32_bf16 a[236:239], v[120:123], v[72:75], 0
  s_nop 0
  v_mfma_f32_16x16x32_bf16 a[240:243], v[124:127], v[72:75], 0
  buffer_store_dwordx4 v[236:239], v173, s[4:7], s47 offen offset:3072 sc1
  v_mfma_f32_16x16x32_bf16 a[244:247], v[128:131], v[72:75], 0
  v_mfma_f32_16x16x32_bf16 a[248:251], v[132:135], v[72:75], 0
  v_mfma_f32_16x16x32_bf16 a[252:255], v[136:139], v[72:75], 0
  s_waitcnt lgkmcnt(0)
  v_mfma_f32_16x16x32_bf16 a[0:3], v[140:143], v[76:79], a[0:3]
  s_waitcnt vmcnt(16)
  s_barrier
  s_add_u32 m0, s52, 0
  v_mfma_f32_16x16x32_bf16 a[4:7], v[144:147], v[76:79], a[4:7]
  buffer_load_dwordx4 v2, s[8:11], s20 offen  lds
  ds_read_b128 v[44:47], v20 offset:0
  v_mfma_f32_16x16x32_bf16 a[8:11], v[148:151], v[76:79], a[8:11]
  v_mfma_f32_16x16x32_bf16 a[12:15], v[152:155], v[76:79], a[12:15]
  ds_read_b64_tr_b16 v[108:109], v30 offset:32768
  s_add_u32 m0, s53, 0
  v_mfma_f32_16x16x32_bf16 a[16:19], v[156:159], v[76:79], a[16:19]
  buffer_load_dwordx4 v10, s[12:15], s21 offen  lds
  v_mfma_f32_16x16x32_bf16 a[20:23], v[160:163], v[76:79], a[20:23]
  ds_read_b64_tr_b16 v[110:111], v30 offset:34816
  v_mfma_f32_16x16x32_bf16 a[24:27], v[164:167], v[76:79], a[24:27]
  v_mfma_f32_16x16x32_bf16 a[28:31], v[168:171], v[76:79], a[28:31]
  ds_read_b128 v[48:51], v20 offset:2048
  s_add_u32 m0, s52, 1024
  v_mfma_f32_16x16x32_bf16 a[32:35], v[140:143], v[80:83], a[32:35]
  buffer_load_dwordx4 v3, s[8:11], s20 offen  lds
  v_mfma_f32_16x16x32_bf16 a[36:39], v[144:147], v[80:83], a[36:39]
  ds_read_b64_tr_b16 v[112:113], v31 offset:32768
  v_mfma_f32_16x16x32_bf16 a[40:43], v[148:151], v[80:83], a[40:43]
  v_mfma_f32_16x16x32_bf16 a[44:47], v[152:155], v[80:83], a[44:47]
  ds_read_b64_tr_b16 v[114:115], v31 offset:34816
  s_add_u32 m0, s53, 1024
  v_mfma_f32_16x16x32_bf16 a[48:51], v[156:159], v[80:83], a[48:51]
  buffer_load_dwordx4 v11, s[12:15], s21 offen  lds
  v_mfma_f32_16x16x32_bf16 a[52:55], v[160:163], v[80:83], a[52:55]
  ds_read_b128 v[52:55], v20 offset:4096
  v_mfma_f32_16x16x32_bf16 a[56:59], v[164:167], v[80:83], a[56:59]
  s_add_u32 m0, s52, 2048
  v_mfma_f32_16x16x32_bf16 a[60:63], v[168:171], v[80:83], a[60:63]
  buffer_load_dwordx4 v4, s[8:11], s20 offen  lds
  ds_read_b64_tr_b16 v[116:117], v32 offset:32768
  v_mfma_f32_16x16x32_bf16 a[64:67], v[140:143], v[84:87], a[64:67]
  v_mfma_f32_16x16x32_bf16 a[68:71], v[144:147], v[84:87], a[68:71]
  ds_read_b64_tr_b16 v[118:119], v32 offset:34816
  v_mfma_f32_16x16x32_bf16 a[72:75], v[148:151], v[84:87], a[72:75]
  s_add_u32 m0, s53, 2048
  v_mfma_f32_16x16x32_bf16 a[76:79], v[152:155], v[84:87], a[76:79]
  buffer_load_dwordx4 v12, s[12:15], s21 offen  lds
  ds_read_b128 v[56:59], v20 offset:6144
  v_mfma_f32_16x16x32_bf16 a[80:83], v[156:159], v[84:87], a[80:83]
  v_mfma_f32_16x16x32_bf16 a[84:87], v[160:163], v[84:87], a[84:87]
  ds_read_b64_tr_b16 v[120:121], v33 offset:32768
  v_mfma_f32_16x16x32_bf16 a[88:91], v[164:167], v[84:87], a[88:91]
  s_add_u32 m0, s52, 3072
  v_mfma_f32_16x16x32_bf16 a[92:95], v[168:171], v[84:87], a[92:95]
  buffer_load_dwordx4 v5, s[8:11], s20 offen  lds
  ds_read_b64_tr_b16 v[122:123], v33 offset:34816
  v_mfma_f32_16x16x32_bf16 a[96:99], v[140:143], v[88:91], a[96:99]
  v_mfma_f32_16x16x32_bf16 a[100:103], v[144:147], v[88:91], a[100:103]
  ds_read_b128 v[60:63], v20 offset:8192
  s_add_u32 m0, s53, 3072
  v_mfma_f32_16x16x32_bf16 a[104:107], v[148:151], v[88:91], a[104:107]
  buffer_load_dwordx4 v13, s[12:15], s21 offen  lds
  v_mfma_f32_16x16x32_bf16 a[108:111], v[152:155], v[88:91], a[108:111]
  ds_read_b64_tr_b16 v[124:125], v34 offset:32768
  v_mfma_f32_16x16x32_bf16 a[112:115], v[156:159], v[88:91], a[112:115]
  v_mfma_f32_16x16x32_bf16 a[116:119], v[160:163], v[88:91], a[116:119]
  ds_read_b64_tr_b16 v[126:127], v34 offset:34816
  s_add_u32 m0, s52, 4096
  v_mfma_f32_16x16x32_bf16 a[120:123], v[164:167], v[88:91], a[120:123]
  buffer_load_dwordx4 v6, s[8:11], s20 offen  lds
  v_mfma_f32_16x16x32_bf16 a[124:127], v[168:171], v[88:91], a[124:127]
  ds_read_b128 v[64:67], v20 offset:10240
  v_mfma_f32_16x16x32_bf16 a[128:131], v[140:143], v[92:95], a[128:131]
  v_mfma_f32_16x16x32_bf16 a[132:135], v[144:147], v[92:95], a[132:135]
  ds_read_b64_tr_b16 v[128:129], v35 offset:32768
  s_add_u32 m0, s53, 4096
  v_mfma_f32_16x16x32_bf16 a[136:139], v[148:151], v[92:95], a[136:139]
  buffer_load_dwordx4 v14, s[12:15], s21 offen  lds
  v_mfma_f32_16x16x32_bf16 a[140:143], v[152:155], v[92:95], a[140:143]
  ds_read_b64_tr_b16 v[130:131], v35 offset:34816
  v_mfma_f32_16x16x32_bf16 a[144:147], v[156:159], v[92:95], a[144:147]
  v_mfma_f32_16x16x32_bf16 a[148:151], v[160:163], v[92:95], a[148:151]
  ds_read_b128 v[68:71], v20 offset:12288
  s_add_u32 m0, s52, 5120
  v_mfma_f32_16x16x32_bf16 a[152:155], v[164:167], v[92:95], a[152:155]
  buffer_load_dwordx4 v7, s[8:11], s20 offen  lds
  v_mfma_f32_16x16x32_bf16 a[156:159], v[168:171], v[92:95], a[156:159]
  ds_read_b64_tr_b16 v[132:133], v36 offset:32768
  v_mfma_f32_16x16x32_bf16 a[160:163], v[140:143], v[96:99], a[160:163]
  s_add_u32 m0, s53, 5120
  v_mfma_f32_16x16x32_bf16 a[164:167], v[144:147], v[96:99], a[164:167]
  buffer_load_dwordx4 v15, s[12:15], s21 offen  lds
  ds_read_b64_tr_b16 v[134:135], v36 offset:34816
  v_mfma_f32_16x16x32_bf16 a[168:171], v[148:151], v[96:99], a[168:171]
  v_mfma_f32_16x16x32_bf16 a[172:175], v[152:155], v[96:99], a[172:175]
  ds_read_b128 v[72:75], v20 offset:14336
  v_mfma_f32_16x16x32_bf16 a[176:179], v[156:159], v[96:99], a[176:179]
  s_add_u32 m0, s52, 6144
  v_mfma_f32_16x16x32_bf16 a[180:183], v[160:163], v[96:99], a[180:183]
  buffer_load_dwordx4 v8, s[8:11], s20 offen  lds
  ds_read_b64_tr_b16 v[136:137], v37 offset:32768
  v_mfma_f32_16x16x32_bf16 a[184:187], v[164:167], v[96:99], a[184:187]
  v_mfma_f32_16x16x32_bf16 a[188:191], v[168:171], v[96:99], a[188:191]
  ds_read_b64_tr_b16 v[138:139], v37 offset:34816
  v_mfma_f32_16x16x32_bf16 a[192:195], v[140:143], v[100:103], a[192:195]
  s_add_u32 m0, s53, 6144
  v_mfma_f32_16x16x32_bf16 a[196:199], v[144:147], v[100:103], a[196:199]
  buffer_load_dwordx4 v16, s[12:15], s21 offen  lds
  v_mfma_f32_16x16x32_bf16 a[200:203], v[148:151], v[100:103], a[200:203]
  v_mfma_f32_16x16x32_bf16 a[204:207], v[152:155], v[100:103], a[204:207]
  s_add_u32 m0, s52, 7168
  v_mfma_f32_16x16x32_bf16 a[208:211], v[156:159], v[100:103], a[208:211]
  buffer_load_dwordx4 v9, s[8:11], s20 offen  lds
  v_mfma_f32_16x16x32_bf16 a[212:215], v[160:163], v[100:103], a[212:215]
  v_mfma_f32_16x16x32_bf16 a[216:219], v[164:167], v[100:103], a[216:219]
  v_mfma_f32_16x16x32_bf16 a[220:223], v[168:171], v[100:103], a[220:223]
  s_add_u32 m0, s53, 7168
  v_mfma_f32_16x16x32_bf16 a[224:227], v[140:143], v[104:107], a[224:227]
  buffer_load_dwordx4 v17, s[12:15], s21 offen  lds
  v_mfma_f32_16x16x32_bf16 a[228:231], v[144:147], v[104:107], a[228:231]
  v_mfma_f32_16x16x32_bf16 a[232:235], v[148:151], v[104:107], a[232:235]
  v_mfma_f32_16x16x32_bf16 a[236:239], v[152:155], v[104:107], a[236:239]
  s_add_u32 s20, s20, 128
  v_mfma_f32_16x16x32_bf16 a[240:243], v[156:159], v[104:107], a[240:243]
  s_add_u32 s21, s21, s51
  v_mfma_f32_16x16x32_bf16 a[244:247], v[160:163], v[104:107], a[244:247]
  v_mfma_f32_16x16x32_bf16 a[248:251], v[164:167], v[104:107], a[248:251]
  v_mfma_f32_16x16x32_bf16 a[252:255], v[168:171], v[104:107], a[252:255]
  s_waitcnt lgkmcnt(0)
  v_mfma_f32_16x16x32_bf16 a[0:3], v[108:111], v[44:47], a[0:3]
  ds_read_b128 v[76:79], v21 offset:0
  v_mfma_f32_16x16x32_bf16 a[4:7], v[112:115], v[44:47], a[4:7]
  v_mfma_f32_16x16x32_bf16 a[8:11], v[116:119], v[44:47], a[8:11]
  ds_read_b64_tr_b16 v[140:141], v30 offset:49152
  v_mfma_f32_16x16x32_bf16 a[12:15], v[120:123], v[44:47], a[12:15]
  v_mfma_f32_16x16x32_bf16 a[16:19], v[124:127], v[44:47], a[16:19]
  ds_read_b64_tr_b16 v[142:143], v30 offset:51200
  v_mfma_f32_16x16x32_bf16 a[20:23], v[128:131], v[44:47], a[20:23]
  v_mfma_f32_16x16x32_bf16 a[24:27], v[132:135], v[44:47], a[24:27]
  ds_read_b128 v[80:83], v21 offset:2048
  v_mfma_f32_16x16x32_bf16 a[28:31], v[136:139], v[44:47], a[28:31]
  v_mfma_f32_16x16x32_bf16 a[32:35], v[108:111], v[48:51], a[32:35]
  ds_read_b64_tr_b16 v[144:145], v31 offset:49152
  v_mfma_f32_16x16x32_bf16 a[36:39], v[112:115], v[48:51], a[36:39]
  v_mfma_f32_16x16x32_bf16 a[40:43], v[116:119], v[48:51], a[40:43]
  ds_read_b64_tr_b16 v[146:147], v31 offset:51200
  v_mfma_f32_16x16x32_bf16 a[44:47], v[120:123], v[48:51], a[44:47]
  v_mfma_f32_16x16x32_bf16 a[48:51], v[124:127], v[48:51], a[48:51]
  ds_read_b128 v[84:87], v21 offset:4096
  v_mfma_f32_16x16x32_bf16 a[52:55], v[128:131], v[48:51], a[52:55]
  v_mfma_f32_16x16x32_bf16 a[56:59], v[132:135], v[48:51], a[56:59]
  ds_read_b64_tr_b16 v[148:149], v32 offset:49152
  v_mfma_f32_16x16x32_bf16 a[60:63], v[136:139], v[48:51], a[60:63]
  v_mfma_f32_16x16x32_bf16 a[64:67], v[108:111], v[52:55], a[64:67]
  ds_read_b64_tr_b16 v[150:151], v32 offset:51200
  v_mfma_f32_16x16x32_bf16 a[68:71], v[112:115], v[52:55], a[68:71]
  v_mfma_f32_16x16x32_bf16 a[72:75], v[116:119], v[52:55], a[72:75]
  ds_read_b128 v[88:91], v21 offset:6144
  v_mfma_f32_16x16x32_bf16 a[76:79], v[120:123], v[52:55], a[76:79]
  v_mfma_f32_16x16x32_bf16 a[80:83], v[124:127], v[52:55], a[80:83]
  ds_read_b64_tr_b16 v[152:153], v33 offset:49152
  v_mfma_f32_16x16x32_bf16 a[84:87], v[128:131], v[52:55], a[84:87]
  v_mfma_f32_16x16x32_bf16 a[88:91], v[132:135], v[52:55], a[88:91]
  ds_read_b64_tr_b16 v[154:155], v33 offset:51200
  v_mfma_f32_16x16x32_bf16 a[92:95], v[136:139], v[52:55], a[92:95]
  v_mfma_f32_16x16x32_bf16 a[96:99], v[108:111], v[56:59], a[96:99]
  ds_read_b128 v[92:95], v21 offset:8192
  v_mfma_f32_16x16x32_bf16 a[100:103], v[112:115], v[56:59], a[100:103]
  v_mfma_f32_16x16x32_bf16 a[104:107], v[116:119], v[56:59], a[104:107]
  ds_read_b64_tr_b16 v[156:157], v34 offset:49152
  v_mfma_f32_16x16x32_bf16 a[108:111], v[120:123], v[56:59], a[108:111]
  v_mfma_f32_16x16x32_bf16 a[112:115], v[124:127], v[56:59], a[112:115]
  ds_read_b64_tr_b16 v[158:159], v34 offset:51200
  v_mfma_f32_16x16x32_bf16 a[116:119], v[128:131], v[56:59], a[116:119]
  v_mfma_f32_16x16x32_bf16 a[120:123], v[132:135], v[56:59], a[120:123]
  ds_read_b128 v[96:99], v21 offset:10240
  v_mfma_f32_16x16x32_bf16 a[124:127], v[136:139], v[56:59], a[124:127]
  v_mfma_f32_16x16x32_bf16 a[128:131], v[108:111], v[60:63], a[128:131]
  ds_read_b64_tr_b16 v[160:161], v35 offset:49152
  v_mfma_f32_16x16x32_bf16 a[132:135], v[112:115], v[60:63], a[132:135]
  v_mfma_f32_16x16x32_bf16 a[136:139], v[116:119], v[60:63], a[136:139]
  ds_read_b64_tr_b16 v[162:163], v35 offset:51200
  v_mfma_f32_16x16x32_bf16 a[140:143], v[120:123], v[60:63], a[140:143]
  v_mfma_f32_16x16x32_bf16 a[144:147], v[124:127], v[60:63], a[144:147]
  ds_read_b128 v[100:103], v21 offset:12288
  v_mfma_f32_16x16x32_bf16 a[148:151], v[128:131], v[60:63], a[148:151]
  v_mfma_f32_16x16x32_bf16 a[152:155], v[132:135], v[60:63], a[152:155]
  ds_read_b64_tr_b16 v[164:165], v36 offset:49152
  v_mfma_f32_16x16x32_bf16 a[156:159], v[136:139], v[60:63], a[156:159]
  v_mfma_f32_16x16x32_bf16 a[160:163], v[108:111], v[64:67], a[160:163]
  ds_read_b64_tr_b16 v[166:167], v36 offset:51200
  v_mfma_f32_16x16x32_bf16 a[164:167], v[112:115], v[64:67], a[164:167]
  v_mfma_f32_16x16x32_bf16 a[168:171], v[116:119], v[64:67], a[168:171]
  ds_read_b128 v[104:107], v21 offset:14336
  v_mfma_f32_16x16x32_bf16 a[172:175], v[120:123], v[64:67], a[172:175]
  v_mfma_f32_16x16x32_bf16 a[176:179], v[124:127], v[64:67], a[176:179]
  ds_read_b64_tr_b16 v[168:169], v37 offset:49152
  v_mfma_f32_16x16x32_bf16 a[180:183], v[128:131], v[64:67], a[180:183]
  v_mfma_f32_16x16x32_bf16 a[184:187], v[132:135], v[64:67], a[184:187]
  ds_read_b64_tr_b16 v[170:171], v37 offset:51200
  v_mfma_f32_16x16x32_bf16 a[188:191], v[136:139], v[64:67], a[188:191]
  v_mfma_f32_16x16x32_bf16 a[192:195], v[108:111], v[68:71], a[192:195]
  v_mfma_f32_16x16x32_bf16 a[196:199], v[112:115], v[68:71], a[196:199]
  v_mfma_f32_16x16x32_bf16 a[200:203], v[116:119], v[68:71], a[200:203]
  v_mfma_f32_16x16x32_bf16 a[204:207], v[120:123], v[68:71], a[204:207]
  v_mfma_f32_16x16x32_bf16 a[208:211], v[124:127], v[68:71], a[208:211]
  v_mfma_f32_16x16x32_bf16 a[212:215], v[128:131], v[68:71], a[212:215]
  v_mfma_f32_16x16x32_bf16 a[216:219], v[132:135], v[68:71], a[216:219]
  v_mfma_f32_16x16x32_bf16 a[220:223], v[136:139], v[68:71], a[220:223]
  v_mfma_f32_16x16x32_bf16 a[224:227], v[108:111], v[72:75], a[224:227]
  v_mfma_f32_16x16x32_bf16 a[228:231], v[112:115], v[72:75], a[228:231]
  v_mfma_f32_16x16x32_bf16 a[232:235], v[116:119], v[72:75], a[232:235]
  v_mfma_f32_16x16x32_bf16 a[236:239], v[120:123], v[72:75], a[236:239]
  v_mfma_f32_16x16x32_bf16 a[240:243], v[124:127], v[72:75], a[240:243]
  v_mfma_f32_16x16x32_bf16 a[244:247], v[128:131], v[72:75], a[244:247]
  v_mfma_f32_16x16x32_bf16 a[248:251], v[132:135], v[72:75], a[248:251]
  v_mfma_f32_16x16x32_bf16 a[252:255], v[136:139], v[72:75], a[252:255]
  s_waitcnt lgkmcnt(0)
  v_mfma_f32_16x16x32_bf16 a[0:3], v[140:143], v[76:79], a[0:3]
  s_waitcnt vmcnt(0)
  s_barrier
  s_cmp_eq_u32 s49, 0
  s_cbranch_scc1 L_hs_7
  s_cmp_lg_u32 s32, 0
  s_cbranch_scc1 L_sig_8
  v_mov_b32 v254, s63
  v_mov_b32 v255, 0
  v_and_b32 v254, 3, v254
  v_mbcnt_lo_u32_b32 v255, -1, 0
  v_lshlrev_b32 v255, 9, v255
  s_cmp_ge_u32 s63, 2
  s_cselect_b64 exec, 3, 1
  buffer_atomic_add v254, v255, s[4:7], s62 offen offset:0 sc1
  s_mov_b64 exec, -1
L_sig_8:
L_hs_7:
  s_add_u32 m0, s52, 65536
  v_mfma_f32_16x16x32_bf16 a[4:7], v[144:147], v[76:79], a[4:7]
  buffer_load_dwordx4 v2, s[8:11], s20 offen  lds
  ds_read_b128 v[44:47], v18 offset:0
  v_mfma_f32_16x16x32_bf16 a[8:11], v[148:151], v[76:79], a[8:11]
  v_mfma_f32_16x16x32_bf16 a[12:15], v[152:155], v[76:79], a[12:15]
  ds_read_b64_tr_b16 v[108:109], v22 offset:32768
  s_add_u32 m0, s53, 65536
  v_mfma_f32_16x16x32_bf16 a[16:19], v[156:159], v[76:79], a[16:19]
  buffer_load_dwordx4 v10, s[12:15], s21 offen  lds
  v_mfma_f32_16x16x32_bf16 a[20:23], v[160:163], v[76:79], a[20:23]
  ds_read_b64_tr_b16 v[110:111], v22 offset:34816
  v_mfma_f32_16x16x32_bf16 a[24:27], v[164:167], v[76:79], a[24:27]
  v_mfma_f32_16x16x32_bf16 a[28:31], v[168:171], v[76:79], a[28:31]
  ds_read_b128 v[48:51], v18 offset:2048
  s_add_u32 m0, s52, 66560
  v_mfma_f32_16x16x32_bf16 a[32:35], v[140:143], v[80:83], a[32:35]
  buffer_load_dwordx4 v3, s[8:11], s20 offen  lds
  v_mfma_f32_16x16x32_bf16 a[36:39], v[144:147], v[80:83], a[36:39]
  ds_read_b64_tr_b16 v[112:113], v23 offset:32768
  v_mfma_f32_16x16x32_bf16 a[40:43], v[148:151], v[80:83], a[40:43]
  v_mfma_f32_16x16x32_bf16 a[44:47], v[152:155], v[80:83], a[44:47]
  ds_read_b64_tr_b16 v[114:115], v23 offset:34816
  s_add_u32 m0, s53, 66560
  v_mfma_f32_16x16x32_bf16 a[48:51], v[156:159], v[80:83], a[48:51]
  buffer_load_dwordx4 v11, s[12:15], s21 offen  lds
  v_mfma_f32_16x16x32_bf16 a[52:55], v[160:163], v[80:83], a[52:55]
  ds_read_b128 v[52:55], v18 offset:4096
  v_mfma_f32_16x16x32_bf16 a[56:59], v[164:167], v[80:83], a[56:59]
  s_add_u32 m0, s52, 67584
  v_mfma_f32_16x16x32_bf16 a[60:63], v[168:171], v[80:83], a[60:63]
  buffer_load_dwordx4 v4, s[8:11], s20 offen  lds
  ds_read_b64_tr_b16 v[116:117], v24 offset:32768
  v_mfma_f32_16x16x32_bf16 a[64:67], v[140:143], v[84:87], a[64:67]
  v_mfma_f32_16x16x32_bf16 a[68:71], v[144:147], v[84:87], a[68:71]
  ds_read_b64_tr_b16 v[118:119], v24 offset:34816
  v_mfma_f32_16x16x32_bf16 a[72:75], v[148:151], v[84:87], a[72:75]
  s_add_u32 m0, s53, 67584
  v_mfma_f32_16x16x32_bf16 a[76:79], v[152:155], v[84:87], a[76:79]
  buffer_load_dwordx4 v12, s[12:15], s21 offen  lds
  ds_read_b128 v[56:59], v18 offset:6144
  v_mfma_f32_16x16x32_bf16 a[80:83], v[156:159], v[84:87], a[80:83]
  v_mfma_f32_16x16x32_bf16 a[84:87], v[160:163], v[84:87], a[84:87]
  ds_read_b64_tr_b16 v[120:121], v25 offset:32768
  v_mfma_f32_16x16x32_bf16 a[88:91], v[164:167], v[84:87], a[88:91]
  s_add_u32 m0, s52, 68608
  v_mfma_f32_16x16x32_bf16 a[92:95], v[168:171], v[84:87], a[92:95]
  buffer_load_dwordx4 v5, s[8:11], s20 offen  lds
  ds_read_b64_tr_b16 v[122:123], v25 offset:34816
  v_mfma_f32_16x16x32_bf16 a[96:99], v[140:143], v[88:91], a[96:99]
  v_mfma_f32_16x16x32_bf16 a[100:103], v[144:147], v[88:91], a[100:103]
  ds_read_b128 v[60:63], v18 offset:8192
  s_add_u32 m0, s53, 68608
  v_mfma_f32_16x16x32_bf16 a[104:107], v[148:151], v[88:91], a[104:107]
  buffer_load_dwordx4 v13, s[12:15], s21 offen  lds
  v_mfma_f32_16x16x32_bf16 a[108:111], v[152:155], v[88:91], a[108:111]
  ds_read_b64_tr_b16 v[124:125], v26 offset:32768
  v_mfma_f32_16x16x32_bf16 a[112:115], v[156:159], v[88:91], a[112:115]
  v_mfma_f32_16x16x32_bf16 a[116:119], v[160:163], v[88:91], a[116:119]
  ds_read_b64_tr_b16 v[126:127], v26 offset:34816
  s_add_u32 m0, s52, 69632
  v_mfma_f32_16x16x32_bf16 a[120:123], v[164:167], v[88:91], a[120:123]
  buffer_load_dwordx4 v6, s[8:11], s20 offen  lds
  v_mfma_f32_16x16x32_bf16 a[124:127], v[168:171], v[88:91], a[124:127]
  ds_read_b128 v[64:67], v18 offset:10240
  v_mfma_f32_16x16x32_bf16 a[128:131], v[140:143], v[92:95], a[128:131]
  v_mfma_f32_16x16x32_bf16 a[132:135], v[144:147], v[92:95], a[132:135]
  ds_read_b64_tr_b16 v[128:129], v27 offset:32768
  s_add_u32 m0, s53, 69632
  v_mfma_f32_16x16x32_bf16 a[136:139], v[148:151], v[92:95], a[136:139]
  buffer_load_dwordx4 v14, s[12:15], s21 offen  lds
  v_mfma_f32_16x16x32_bf16 a[140:143], v[152:155], v[92:95], a[140:143]
  ds_read_b64_tr_b16 v[130:131], v27 offset:34816
  v_mfma_f32_16x16x32_bf16 a[144:147], v[156:159], v[92:95], a[144:147]
  v_mfma_f32_16x16x32_bf16 a[148:151], v[160:163], v[92:95], a[148:151]
  ds_read_b128 v[68:71], v18 offset:12288
  s_add_u32 m0, s52, 70656
  v_mfma_f32_16x16x32_bf16 a[152:155], v[164:167], v[92:95], a[152:155]
  buffer_load_dwordx4 v7, s[8:11], s20 offen  lds
  v_mfma_f32_16x16x32_bf16 a[156:159], v[168:171], v[92:95], a[156:159]
  ds_read_b64_tr_b16 v[132:133], v28 offset:32768
  v_mfma_f32_16x16x32_bf16 a[160:163], v[140:143], v[96:99], a[160:163]
  s_add_u32 m0, s53, 70656
  v_mfma_f32_16x16x32_bf16 a[164:167], v[144:147], v[96:99], a[164:167]
  buffer_load_dwordx4 v15, s[12:15], s21 offen  lds
  ds_read_b64_tr_b16 v[134:135], v28 offset:34816
  v_mfma_f32_16x16x32_bf16 a[168:171], v[148:151], v[96:99], a[168:171]
  v_mfma_f32_16x16x32_bf16 a[172:175], v[152:155], v[96:99], a[172:175]
  ds_read_b128 v[72:75], v18 offset:14336
  v_mfma_f32_16x16x32_bf16 a[176:179], v[156:159], v[96:99], a[176:179]
  s_add_u32 m0, s52, 71680
  v_mfma_f32_16x16x32_bf16 a[180:183], v[160:163], v[96:99], a[180:183]
  buffer_load_dwordx4 v8, s[8:11], s20 offen  lds
  ds_read_b64_tr_b16 v[136:137], v29 offset:32768
  v_mfma_f32_16x16x32_bf16 a[184:187], v[164:167], v[96:99], a[184:187]
  v_mfma_f32_16x16x32_bf16 a[188:191], v[168:171], v[96:99], a[188:191]
  ds_read_b64_tr_b16 v[138:139], v29 offset:34816
  v_mfma_f32_16x16x32_bf16 a[192:195], v[140:143], v[100:103], a[192:195]
  s_add_u32 m0, s53, 71680
  v_mfma_f32_16x16x32_bf16 a[196:199], v[144:147], v[100:103], a[196:199]
  buffer_load_dwordx4 v16, s[12:15], s21 offen  lds
  v_mfma_f32_16x16x32_bf16 a[200:203], v[148:151], v[100:103], a[200:203]
  v_mfma_f32_16x16x32_bf16 a[204:207], v[152:155], v[100:103], a[204:207]
  s_add_u32 m0, s52, 72704
  v_mfma_f32_16x16x32_bf16 a[208:211], v[156:159], v[100:103], a[208:211]
  buffer_load_dwordx4 v9, s[8:11], s20 offen  lds
  v_mfma_f32_16x16x32_bf16 a[212:215], v[160:163], v[100:103], a[212:215]
  v_mfma_f32_16x16x32_bf16 a[216:219], v[164:167], v[100:103], a[216:219]
  v_mfma_f32_16x16x32_bf16 a[220:223], v[168:171], v[100:103], a[220:223]
  s_add_u32 m0, s53, 72704
  v_mfma_f32_16x16x32_bf16 a[224:227], v[140:143], v[104:107], a[224:227]
  buffer_load_dwordx4 v17, s[12:15], s21 offen  lds
  v_mfma_f32_16x16x32_bf16 a[228:231], v[144:147], v[104:107], a[228:231]
  v_mfma_f32_16x16x32_bf16 a[232:235], v[148:151], v[104:107], a[232:235]
  v_mfma_f32_16x16x32_bf16 a[236:239], v[152:155], v[104:107], a[236:239]
  s_add_u32 s20, s20, 128
  v_mfma_f32_16x16x32_bf16 a[240:243], v[156:159], v[104:107], a[240:243]
  s_add_u32 s21, s21, s51
  v_mfma_f32_16x16x32_bf16 a[244:247], v[160:163], v[104:107], a[244:247]
  v_mfma_f32_16x16x32_bf16 a[248:251], v[164:167], v[104:107], a[248:251]
  v_mfma_f32_16x16x32_bf16 a[252:255], v[168:171], v[104:107], a[252:255]
L_g1_loop:
  s_sub_u32 s25, s25, 1
  s_cmp_eq_u32 s25, 0
  s_cbranch_scc1 L_g1_fin
  s_waitcnt lgkmcnt(0)
  v_mfma_f32_16x16x32_bf16 a[0:3], v[108:111], v[44:47], a[0:3]
  ds_read_b128 v[76:79], v19 offset:0
  v_mfma_f32_16x16x32_bf16 a[4:7], v[112:115], v[44:47], a[4:7]
  v_mfma_f32_16x16x32_bf16 a[8:11], v[116:119], v[44:47], a[8:11]
  ds_read_b64_tr_b16 v[140:141], v22 offset:49152
  v_mfma_f32_16x16x32_bf16 a[12:15], v[120:123], v[44:47], a[12:15]
  v_mfma_f32_16x16x32_bf16 a[16:19], v[124:127], v[44:47], a[16:19]
  ds_read_b64_tr_b16 v[142:143], v22 offset:51200
  v_mfma_f32_16x16x32_bf16 a[20:23], v[128:131], v[44:47], a[20:23]
  v_mfma_f32_16x16x32_bf16 a[24:27], v[132:135], v[44:47], a[24:27]
  ds_read_b128 v[80:83], v19 offset:2048
  v_mfma_f32_16x16x32_bf16 a[28:31], v[136:139], v[44:47], a[28:31]
  v_mfma_f32_16x16x32_bf16 a[32:35], v[108:111], v[48:51], a[32:35]
  ds_read_b64_tr_b16 v[144:145], v23 offset:49152
  v_mfma_f32_16x16x32_bf16 a[36:39], v[112:115], v[48:51], a[36:39]
  v_mfma_f32_16x16x32_bf16 a[40:43], v[116:119], v[48:51], a[40:43]
  ds_read_b64_tr_b16 v[146:147], v23 offset:51200
  v_mfma_f32_16x16x32_bf16 a[44:47], v[120:123], v[48:51], a[44:47]
  v_mfma_f32_16x16x32_bf16 a[48:51], v[124:127], v[48:51], a[48:51]
  ds_read_b128 v[84:87], v19 offset:4096
  v_mfma_f32_16x16x32_bf16 a[52:55], v[128:131], v[48:51], a[52:55]
  v_mfma_f32_16x16x32_bf16 a[56:59], v[132:135], v[48:51], a[56:59]
  ds_read_b64_tr_b16 v[148:149], v24 offset:49152
  v_mfma_f32_16x16x32_bf16 a[60:63], v[136:139], v[48:51], a[60:63]
  v_mfma_f32_16x16x32_bf16 a[64:67], v[108:111], v[52:55], a[64:67]
  ds_read_b64_tr_b16 v[150:151], v24 offset:51200
  v_mfma_f32_16x16x32_bf16 a[68:71], v[112:115], v[52:55], a[68:71]
  v_mfma_f32_16x16x32_bf16 a[72:75], v[116:119], v[52:55], a[72:75]
  ds_read_b128 v[88:91], v19 offset:6144
  v_mfma_f32_16x16x32_bf16 a[76:79], v[120:123], v[52:55], a[76:79]
  v_mfma_f32_16x16x32_bf16 a[80:83], v[124:127], v[52:55], a[80:83]
  ds_read_b64_tr_b16 v[152:153], v25 offset:49152
  v_mfma_f32_16x16x32_bf16 a[84:87], v[128:131], v[52:55], a[84:87]
  v_mfma_f32_16x16x32_bf16 a[88:91], v[132:135], v[52:55], a[88:91]
  ds_read_b64_tr_b16 v[154:155], v25 offset:51200
  v_mfma_f32_16x16x32_bf16 a[92:95], v[136:139], v[52:55], a[92:95]
  v_mfma_f32_16x16x32_bf16 a[96:99], v[108:111], v[56:59], a[96:99]
  ds_read_b128 v[92:95], v19 offset:8192
  v_mfma_f32_16x16x32_bf16 a[100:103], v[112:115], v[56:59], a[100:103]
  v_mfma_f32_16x16x32_bf16 a[104:107], v[116:119], v[56:59], a[104:107]
  ds_read_b64_tr_b16 v[156:157], v26 offset:49152
  v_mfma_f32_16x16x32_bf16 a[108:111], v[120:123], v[56:59], a[108:111]
  v_mfma_f32_16x16x32_bf16 a[112:115], v[124:127], v[56:59], a[112:115]
  ds_read_b64_tr_b16 v[158:159], v26 offset:51200
  v_mfma_f32_16x16x32_bf16 a[116:119], v[128:131], v[56:59], a[116:119]
  v_mfma_f32_16x16x32_bf16 a[120:123], v[132:135], v[56:59], a[120:123]
  ds_read_b128 v[96:99], v19 offset:10240
  v_mfma_f32_16x16x32_bf16 a[124:127], v[136:139], v[56:59], a[124:127]
  v_mfma_f32_16x16x32_bf16 a[128:131], v[108:111], v[60:63], a[128:131]
  ds_read_b64_tr_b16 v[160:161], v27 offset:49152
  v_mfma_f32_16x16x32_bf16 a[132:135], v[112:115], v[60:63], a[132:135]
  v_mfma_f32_16x16x32_bf16 a[136:139], v[116:119], v[60:63], a[136:139]
  ds_read_b64_tr_b16 v[162:163], v27 offset:51200
  v_mfma_f32_16x16x32_bf16 a[140:143], v[120:123], v[60:63], a[140:143]
  v_mfma_f32_16x16x32_bf16 a[144:147], v[124:127], v[60:63], a[144:147]
  ds_read_b128 v[100:103], v19 offset:12288
  v_mfma_f32_16x16x32_bf16 a[148:151], v[128:131], v[60:63], a[148:151]
  v_mfma_f32_16x16x32_bf16 a[152:155], v[132:135], v[60:63], a[152:155]
  ds_read_b64_tr_b16 v[164:165], v28 offset:49152
  v_mfma_f32_16x16x32_bf16 a[156:159], v[136:139], v[60:63], a[156:159]
  v_mfma_f32_16x16x32_bf16 a[160:163], v[108:111], v[64:67], a[160:163]
  ds_read_b64_tr_b16 v[166:167], v28 offset:51200
  v_mfma_f32_16x16x32_bf16 a[164:167], v[112:115], v[64:67], a[164:167]
  v_mfma_f32_16x16x32_bf16 a[168:171], v[116:119], v[64:67], a[168:171]
  ds_read_b128 v[104:107], v19 offset:14336
  v_mfma_f32_16x16x32_bf16 a[172:175], v[120:123], v[64:67], a[172:175]
  v_mfma_f32_16x16x32_bf16 a[176:179], v[124:127], v[64:67], a[176:179]
  ds_read_b64_tr_b16 v[168:169], v29 offset:49152
  v_mfma_f32_16x16x32_bf16 a[180:183], v[128:131], v[64:67], a[180:183]
  v_mfma_f32_16x16x32_bf16 a[184:187], v[132:135], v[64:67], a[184:187]
  ds_read_b64_tr_b16 v[170:171], v29 offset:51200
  v_mfma_f32_16x16x32_bf16 a[188:191], v[136:139], v[64:67], a[188:191]
  v_mfma_f32_16x16x32_bf16 a[192:195], v[108:111], v[68:71], a[192:195]
  v_mfma_f32_16x16x32_bf16 a[196:199], v[112:115], v[68:71], a[196:199]
  v_mfma_f32_16x16x32_bf16 a[200:203], v[116:119], v[68:71], a[200:203]
  v_mfma_f32_16x16x32_bf16 a[204:207], v[120:123], v[68:71], a[204:207]
  v_mfma_f32_16x16x32_bf16 a[208:211], v[124:127], v[68:71], a[208:211]
  v_mfma_f32_16x16x32_bf16 a[212:215], v[128:131], v[68:71], a[212:215]
  v_mfma_f32_16x16x32_bf16 a[216:219], v[132:135], v[68:71], a[216:219]
  v_mfma_f32_16x16x32_bf16 a[220:223], v[136:139], v[68:71], a[220:223]
  v_mfma_f32_16x16x32_bf16 a[224:227], v[108:111], v[72:75], a[224:227]
  v_mfma_f32_16x16x32_bf16 a[228:231], v[112:115], v[72:75], a[228:231]
  v_mfma_f32_16x16x32_bf16 a[232:235], v[116:119], v[72:75], a[232:235]
  v_mfma_f32_16x16x32_bf16 a[236:239], v[120:123], v[72:75], a[236:239]
  v_mfma_f32_16x16x32_bf16 a[240:243], v[124:127], v[72:75], a[240:243]
  v_mfma_f32_16x16x32_bf16 a[244:247], v[128:131], v[72:75], a[244:247]
  v_mfma_f32_16x16x32_bf16 a[248:251], v[132:135], v[72:75], a[248:251]
  v_mfma_f32_16x16x32_bf16 a[252:255], v[136:139], v[72:75], a[252:255]
  s_waitcnt lgkmcnt(0)
  v_mfma_f32_16x16x32_bf16 a[0:3], v[140:143], v[76:79], a[0:3]
  s_waitcnt vmcnt(0)
  s_barrier
  s_add_u32 m0, s52, 0
  v_mfma_f32_16x16x32_bf16 a[4:7], v[144:147], v[76:79], a[4:7]
  buffer_load_dwordx4 v2, s[8:11], s20 offen  lds
  ds_read_b128 v[44:47], v20 offset:0
  v_mfma_f32_16x16x32_bf16 a[8:11], v[148:151], v[76:79], a[8:11]
  v_mfma_f32_16x16x32_bf16 a[12:15], v[152:155], v[76:79], a[12:15]
  ds_read_b64_tr_b16 v[108:109], v30 offset:32768
  s_add_u32 m0, s53, 0
  v_mfma_f32_16x16x32_bf16 a[16:19], v[156:159], v[76:79], a[16:19]
  buffer_load_dwordx4 v10, s[12:15], s21 offen  lds
  v_mfma_f32_16x16x32_bf16 a[20:23], v[160:163], v[76:79], a[20:23]
  ds_read_b64_tr_b16 v[110:111], v30 offset:34816
  v_mfma_f32_16x16x32_bf16 a[24:27], v[164:167], v[76:79], a[24:27]
  v_mfma_f32_16x16x32_bf16 a[28:31], v[168:171], v[76:79], a[28:31]
  ds_read_b128 v[48:51], v20 offset:2048
  s_add_u32 m0, s52, 1024
  v_mfma_f32_16x16x32_bf16 a[32:35], v[140:143], v[80:83], a[32:35]
  buffer_load_dwordx4 v3, s[8:11], s20 offen  lds
  v_mfma_f32_16x16x32_bf16 a[36:39], v[144:147], v[80:83], a[36:39]
  ds_read_b64_tr_b16 v[112:113], v31 offset:32768
  v_mfma_f32_16x16x32_bf16 a[40:43], v[148:151], v[80:83], a[40:43]
  v_mfma_f32_16x16x32_bf16 a[44:47], v[152:155], v[80:83], a[44:47]
  ds_read_b64_tr_b16 v[114:115], v31 offset:34816
  s_add_u32 m0, s53, 1024
  v_mfma_f32_16x16x32_bf16 a[48:51], v[156:159], v[80:83], a[48:51]
  buffer_load_dwordx4 v11, s[12:15], s21 offen  lds
  v_mfma_f32_16x16x32_bf16 a[52:55], v[160:163], v[80:83], a[52:55]
  ds_read_b128 v[52:55], v20 offset:4096
  v_mfma_f32_16x16x32_bf16 a[56:59], v[164:167], v[80:83], a[56:59]
  s_add_u32 m0, s52, 2048
  v_mfma_f32_16x16x32_bf16 a[60:63], v[168:171], v[80:83], a[60:63]
  buffer_load_dwordx4 v4, s[8:11], s20 offen  lds
  ds_read_b64_tr_b16 v[116:117], v32 offset:32768
  v_mfma_f32_16x16x32_bf16 a[64:67], v[140:143], v[84:87], a[64:67]
  v_mfma_f32_16x16x32_bf16 a[68:71], v[144:147], v[84:87], a[68:71]
  ds_read_b64_tr_b16 v[118:119], v32 offset:34816
  v_mfma_f32_16x16x32_bf16 a[72:75], v[148:151], v[84:87], a[72:75]
  s_add_u32 m0, s53, 2048
  v_mfma_f32_16x16x32_bf16 a[76:79], v[152:155], v[84:87], a[76:79]
  buffer_load_dwordx4 v12, s[12:15], s21 offen  lds
  ds_read_b128 v[56:59], v20 offset:6144
  v_mfma_f32_16x16x32_bf16 a[80:83], v[156:159], v[84:87], a[80:83]
  v_mfma_f32_16x16x32_bf16 a[84:87], v[160:163], v[84:87], a[84:87]
  ds_read_b64_tr_b16 v[120:121], v33 offset:32768
  v_mfma_f32_16x16x32_bf16 a[88:91], v[164:167], v[84:87], a[88:91]
  s_add_u32 m0, s52, 3072
  v_mfma_f32_16x16x32_bf16 a[92:95], v[168:171], v[84:87], a[92:95]
  buffer_load_dwordx4 v5, s[8:11], s20 offen  lds
  ds_read_b64_tr_b16 v[122:123], v33 offset:34816
  v_mfma_f32_16x16x32_bf16 a[96:99], v[140:143], v[88:91], a[96:99]
  v_mfma_f32_16x16x32_bf16 a[100:103], v[144:147], v[88:91], a[100:103]
  ds_read_b128 v[60:63], v20 offset:8192
  s_add_u32 m0, s53, 3072
  v_mfma_f32_16x16x32_bf16 a[104:107], v[148:151], v[88:91], a[104:107]
  buffer_load_dwordx4 v13, s[12:15], s21 offen  lds
  v_mfma_f32_16x16x32_bf16 a[108:111], v[152:155], v[88:91], a[108:111]
  ds_read_b64_tr_b16 v[124:125], v34 offset:32768
  v_mfma_f32_16x16x32_bf16 a[112:115], v[156:159], v[88:91], a[112:115]
  v_mfma_f32_16x16x32_bf16 a[116:119], v[160:163], v[88:91], a[116:119]
  ds_read_b64_tr_b16 v[126:127], v34 offset:34816
  s_add_u32 m0, s52, 4096
  v_mfma_f32_16x16x32_bf16 a[120:123], v[164:167], v[88:91], a[120:123]
  buffer_load_dwordx4 v6, s[8:11], s20 offen  lds
  v_mfma_f32_16x16x32_bf16 a[124:127], v[168:171], v[88:91], a[124:127]
  ds_read_b128 v[64:67], v20 offset:10240
  v_mfma_f32_16x16x32_bf16 a[128:131], v[140:143], v[92:95], a[128:131]
  v_mfma_f32_16x16x32_bf16 a[132:135], v[144:147], v[92:95], a[132:135]
  ds_read_b64_tr_b16 v[128:129], v35 offset:32768
  s_add_u32 m0, s53, 4096
  v_mfma_f32_16x16x32_bf16 a[136:139], v[148:151], v[92:95], a[136:139]
  buffer_load_dwordx4 v14, s[12:15], s21 offen  lds
  v_mfma_f32_16x16x32_bf16 a[140:143], v[152:155], v[92:95], a[140:143]
  ds_read_b64_tr_b16 v[130:131], v35 offset:34816
  v_mfma_f32_16x16x32_bf16 a[144:147], v[156:159], v[92:95], a[144:147]
  v_mfma_f32_16x16x32_bf16 a[148:151], v[160:163], v[92:95], a[148:151]
  ds_read_b128 v[68:71], v20 offset:12288
  s_add_u32 m0, s52, 5120
  v_mfma_f32_16x16x32_bf16 a[152:155], v[164:167], v[92:95], a[152:155]
  buffer_load_dwordx4 v7, s[8:11], s20 offen  lds
  v_mfma_f32_16x16x32_bf16 a[156:159], v[168:171], v[92:95], a[156:159]
  ds_read_b64_tr_b16 v[132:133], v36 offset:32768
  v_mfma_f32_16x16x32_bf16 a[160:163], v[140:143], v[96:99], a[160:163]
  s_add_u32 m0, s53, 5120
  v_mfma_f32_16x16x32_bf16 a[164:167], v[144:147], v[96:99], a[164:167]
  buffer_load_dwordx4 v15, s[12:15], s21 offen  lds
  ds_read_b64_tr_b16 v[134:135], v36 offset:34816
  v_mfma_f32_16x16x32_bf16 a[168:171], v[148:151], v[96:99], a[168:171]
  v_mfma_f32_16x16x32_bf16 a[172:175], v[152:155], v[96:99], a[172:175]
  ds_read_b128 v[72:75], v20 offset:14336
  v_mfma_f32_16x16x32_bf16 a[176:179], v[156:159], v[96:99], a[176:179]
  s_add_u32 m0, s52, 6144
  v_mfma_f32_16x16x32_bf16 a[180:183], v[160:163], v[96:99], a[180:183]
  buffer_load_dwordx4 v8, s[8:11], s20 offen  lds
  ds_read_b64_tr_b16 v[136:137], v37 offset:32768
  v_mfma_f32_16x16x32_bf16 a[184:187], v[164:167], v[96:99], a[184:187]
  v_mfma_f32_16x16x32_bf16 a[188:191], v[168:171], v[96:99], a[188:191]
  ds_read_b64_tr_b16 v[138:139], v37 offset:34816
  v_mfma_f32_16x16x32_bf16 a[192:195], v[140:143], v[100:103], a[192:195]
  s_add_u32 m0, s53, 6144
  v_mfma_f32_16x16x32_bf16 a[196:199], v[144:147], v[100:103], a[196:199]
  buffer_load_dwordx4 v16, s[12:15], s21 offen  lds
  v_mfma_f32_16x16x32_bf16 a[200:203], v[148:151], v[100:103], a[200:203]
  v_mfma_f32_16x16x32_bf16 a[204:207], v[152:155], v[100:103], a[204:207]
  s_add_u32 m0, s52, 7168
  v_mfma_f32_16x16x32_bf16 a[208:211], v[156:159], v[100:103], a[208:211]
  buffer_load_dwordx4 v9, s[8:11], s20 offen  lds
  v_mfma_f32_16x16x32_bf16 a[212:215], v[160:163], v[100:103], a[212:215]
  v_mfma_f32_16x16x32_bf16 a[216:219], v[164:167], v[100:103], a[216:219]
  v_mfma_f32_16x16x32_bf16 a[220:223], v[168:171], v[100:103], a[220:223]
  s_add_u32 m0, s53, 7168
  v_mfma_f32_16x16x32_bf16 a[224:227], v[140:143], v[104:107], a[224:227]
  buffer_load_dwordx4 v17, s[12:15], s21 offen  lds
  v_mfma_f32_16x16x32_bf16 a[228:231], v[144:147], v[104:107], a[228:231]
  v_mfma_f32_16x16x32_bf16 a[232:235], v[148:151], v[104:107], a[232:235]
  v_mfma_f32_16x16x32_bf16 a[236:239], v[152:155], v[104:107], a[236:239]
  s_add_u32 s20, s20, 128
  v_mfma_f32_16x16x32_bf16 a[240:243], v[156:159], v[104:107], a[240:243]
  s_add_u32 s21, s21, s51
  v_mfma_f32_16x16x32_bf16 a[244:247], v[160:163], v[104:107], a[244:247]
  v_mfma_f32_16x16x32_bf16 a[248:251], v[164:167], v[104:107], a[248:251]
  v_mfma_f32_16x16x32_bf16 a[252:255], v[168:171], v[104:107], a[252:255]
  s_waitcnt lgkmcnt(0)
  s_cmp_eq_u32 s25, 1
  s_cbranch_scc1 L_g1_cw
L_g1_cwb:
  v_mfma_f32_16x16x32_bf16 a[0:3], v[108:111], v[44:47], a[0:3]
  ds_read_b128 v[76:79], v21 offset:0
  v_mfma_f32_16x16x32_bf16 a[4:7], v[112:115], v[44:47], a[4:7]
  v_mfma_f32_16x16x32_bf16 a[8:11], v[116:119], v[44:47], a[8:11]
  ds_read_b64_tr_b16 v[140:141], v30 offset:49152
  v_mfma_f32_16x16x32_bf16 a[12:15], v[120:123], v[44:47], a[12:15]
  v_mfma_f32_16x16x32_bf16 a[16:19], v[124:127], v[44:47], a[16:19]
  ds_read_b64_tr_b16 v[142:143], v30 offset:51200
  v_mfma_f32_16x16x32_bf16 a[20:23], v[128:131], v[44:47], a[20:23]
  v_mfma_f32_16x16x32_bf16 a[24:27], v[132:135], v[44:47], a[24:27]
  ds_read_b128 v[80:83], v21 offset:2048
  v_mfma_f32_16x16x32_bf16 a[28:31], v[136:139], v[44:47], a[28:31]
  v_mfma_f32_16x16x32_bf16 a[32:35], v[108:111], v[48:51], a[32:35]
  ds_read_b64_tr_b16 v[144:145], v31 offset:49152
  v_mfma_f32_16x16x32_bf16 a[36:39], v[112:115], v[48:51], a[36:39]
  v_mfma_f32_16x16x32_bf16 a[40:43], v[116:119], v[48:51], a[40:43]
  ds_read_b64_tr_b16 v[146:147], v31 offset:51200
  v_mfma_f32_16x16x32_bf16 a[44:47], v[120:123], v[48:51], a[44:47]
  v_mfma_f32_16x16x32_bf16 a[48:51], v[124:127], v[48:51], a[48:51]
  ds_read_b128 v[84:87], v21 offset:4096
  v_mfma_f32_16x16x32_bf16 a[52:55], v[128:131], v[48:51], a[52:55]
  v_mfma_f32_16x16x32_bf16 a[56:59], v[132:135], v[48:51], a[56:59]
  ds_read_b64_tr_b16 v[148:149], v32 offset:49152
  v_mfma_f32_16x16x32_bf16 a[60:63], v[136:139], v[48:51], a[60:63]
  v_mfma_f32_16x16x32_bf16 a[64:67], v[108:111], v[52:55], a[64:67]
  ds_read_b64_tr_b16 v[150:151], v32 offset:51200
  v_mfma_f32_16x16x32_bf16 a[68:71], v[112:115], v[52:55], a[68:71]
  v_mfma_f32_16x16x32_bf16 a[72:75], v[116:119], v[52:55], a[72:75]
  ds_read_b128 v[88:91], v21 offset:6144
  v_mfma_f32_16x16x32_bf16 a[76:79], v[120:123], v[52:55], a[76:79]
  v_mfma_f32_16x16x32_bf16 a[80:83], v[124:127], v[52:55], a[80:83]
  ds_read_b64_tr_b16 v[152:153], v33 offset:49152
  v_mfma_f32_16x16x32_bf16 a[84:87], v[128:131], v[52:55], a[84:87]
  v_mfma_f32_16x16x32_bf16 a[88:91], v[132:135], v[52:55], a[88:91]
  ds_read_b64_tr_b16 v[154:155], v33 offset:51200
  v_mfma_f32_16x16x32_bf16 a[92:95], v[136:139], v[52:55], a[92:95]
  v_mfma_f32_16x16x32_bf16 a[96:99], v[108:111], v[56:59], a[96:99]
  ds_read_b128 v[92:95], v21 offset:8192
  v_mfma_f32_16x16x32_bf16 a[100:103], v[112:115], v[56:59], a[100:103]
  v_mfma_f32_16x16x32_bf16 a[104:107], v[116:119], v[56:59], a[104:107]
  ds_read_b64_tr_b16 v[156:157], v34 offset:49152
  v_mfma_f32_16x16x32_bf16 a[108:111], v[120:123], v[56:59], a[108:111]
  v_mfma_f32_16x16x32_bf16 a[112:115], v[124:127], v[56:59], a[112:115]
  ds_read_b64_tr_b16 v[158:159], v34 offset:51200
  v_mfma_f32_16x16x32_bf16 a[116:119], v[128:131], v[56:59], a[116:119]
  v_mfma_f32_16x16x32_bf16 a[120:123], v[132:135], v[56:59], a[120:123]
  ds_read_b128 v[96:99], v21 offset:10240
  v_mfma_f32_16x16x32_bf16 a[124:127], v[136:139], v[56:59], a[124:127]
  v_mfma_f32_16x16x32_bf16 a[128:131], v[108:111], v[60:63], a[128:131]
  ds_read_b64_tr_b16 v[160:161], v35 offset:49152
  v_mfma_f32_16x16x32_bf16 a[132:135], v[112:115], v[60:63], a[132:135]
  v_mfma_f32_16x16x32_bf16 a[136:139], v[116:119], v[60:63], a[136:139]
  ds_read_b64_tr_b16 v[162:163], v35 offset:51200
  v_mfma_f32_16x16x32_bf16 a[140:143], v[120:123], v[60:63], a[140:143]
  v_mfma_f32_16x16x32_bf16 a[144:147], v[124:127], v[60:63], a[144:147]
  ds_read_b128 v[100:103], v21 offset:12288
  v_mfma_f32_16x16x32_bf16 a[148:151], v[128:131], v[60:63], a[148:151]
  v_mfma_f32_16x16x32_bf16 a[152:155], v[132:135], v[60:63], a[152:155]
  ds_read_b64_tr_b16 v[164:165], v36 offset:49152
  v_mfma_f32_16x16x32_bf16 a[156:159], v[136:139], v[60:63], a[156:159]
  v_mfma_f32_16x16x32_bf16 a[160:163], v[108:111], v[64:67], a[160:163]
  ds_read_b64_tr_b16 v[166:167], v36 offset:51200
  v_mfma_f32_16x16x32_bf16 a[164:167], v[112:115], v[64:67], a[164:167]
  v_mfma_f32_16x16x32_bf16 a[168:171], v[116:119], v[64:67], a[168:171]
  ds_read_b128 v[104:107], v21 offset:14336
  v_mfma_f32_16x16x32_bf16 a[172:175], v[120:123], v[64:67], a[172:175]
  v_mfma_f32_16x16x32_bf16 a[176:179], v[124:127], v[64:67], a[176:179]
  ds_read_b64_tr_b16 v[168:169], v37 offset:49152
  v_mfma_f32_16x16x32_bf16 a[180:183], v[128:131], v[64:67], a[180:183]
  v_mfma_f32_16x16x32_bf16 a[184:187], v[132:135], v[64:67], a[184:187]
  ds_read_b64_tr_b16 v[170:171], v37 offset:51200
  v_mfma_f32_16x16x32_bf16 a[188:191], v[136:139], v[64:67], a[188:191]
  v_mfma_f32_16x16x32_bf16 a[192:195], v[108:111], v[68:71], a[192:195]
  v_mfma_f32_16x16x32_bf16 a[196:199], v[112:115], v[68:71], a[196:199]
  v_mfma_f32_16x16x32_bf16 a[200:203], v[116:119], v[68:71], a[200:203]
  v_mfma_f32_16x16x32_bf16 a[204:207], v[120:123], v[68:71], a[204:207]
  v_mfma_f32_16x16x32_bf16 a[208:211], v[124:127], v[68:71], a[208:211]
  v_mfma_f32_16x16x32_bf16 a[212:215], v[128:131], v[68:71], a[212:215]
  v_mfma_f32_16x16x32_bf16 a[216:219], v[132:135], v[68:71], a[216:219]
  v_mfma_f32_16x16x32_bf16 a[220:223], v[136:139], v[68:71], a[220:223]
  v_mfma_f32_16x16x32_bf16 a[224:227], v[108:111], v[72:75], a[224:227]
  v_mfma_f32_16x16x32_bf16 a[228:231], v[112:115], v[72:75], a[228:231]
  v_mfma_f32_16x16x32_bf16 a[232:235], v[116:119], v[72:75], a[232:235]
  v_mfma_f32_16x16x32_bf16 a[236:239], v[120:123], v[72:75], a[236:239]
  v_mfma_f32_16x16x32_bf16 a[240:243], v[124:127], v[72:75], a[240:243]
  v_mfma_f32_16x16x32_bf16 a[244:247], v[128:131], v[72:75], a[244:247]
  v_mfma_f32_16x16x32_bf16 a[248:251], v[132:135], v[72:75], a[248:251]
  v_mfma_f32_16x16x32_bf16 a[252:255], v[136:139], v[72:75], a[252:255]
  s_waitcnt lgkmcnt(0)
  v_mfma_f32_16x16x32_bf16 a[0:3], v[140:143], v[76:79], a[0:3]
  s_waitcnt vmcnt(0)
  s_barrier
  s_cmp_le_u32 s25, 2
  s_cbranch_scc1 L_g1_cr
L_g1_crb:
  s_add_u32 m0, s52, 65536
  v_mfma_f32_16x16x32_bf16 a[4:7], v[144:147], v[76:79], a[4:7]
  buffer_load_dwordx4 v2, s[8:11], s20 offen  lds
  ds_read_b128 v[44:47], v18 offset:0
  v_mfma_f32_16x16x32_bf16 a[8:11], v[148:151], v[76:79], a[8:11]
  v_mfma_f32_16x16x32_bf16 a[12:15], v[152:155], v[76:79], a[12:15]
  ds_read_b64_tr_b16 v[108:109], v22 offset:32768
  s_add_u32 m0, s53, 65536
  v_mfma_f32_16x16x32_bf16 a[16:19], v[156:159], v[76:79], a[16:19]
  buffer_load_dwordx4 v10, s[12:15], s21 offen  lds
  v_mfma_f32_16x16x32_bf16 a[20:23], v[160:163], v[76:79], a[20:23]
  ds_read_b64_tr_b16 v[110:111], v22 offset:34816
  v_mfma_f32_16x16x32_bf16 a[24:27], v[164:167], v[76:79], a[24:27]
  v_mfma_f32_16x16x32_bf16 a[28:31], v[168:171], v[76:79], a[28:31]
  ds_read_b128 v[48:51], v18 offset:2048
  s_add_u32 m0, s52, 66560
  v_mfma_f32_16x16x32_bf16 a[32:35], v[140:143], v[80:83], a[32:35]
  buffer_load_dwordx4 v3, s[8:11], s20 offen  lds
  v_mfma_f32_16x16x32_bf16 a[36:39], v[144:147], v[80:83], a[36:39]
  ds_read_b64_tr_b16 v[112:113], v23 offset:32768
  v_mfma_f32_16x16x32_bf16 a[40:43], v[148:151], v[80:83], a[40:43]
  v_mfma_f32_16x16x32_bf16 a[44:47], v[152:155], v[80:83], a[44:47]
  ds_read_b64_tr_b16 v[114:115], v23 offset:34816
  s_add_u32 m0, s53, 66560
  v_mfma_f32_16x16x32_bf16 a[48:51], v[156:159], v[80:83], a[48:51]
  buffer_load_dwordx4 v11, s[12:15], s21 offen  lds
  v_mfma_f32_16x16x32_bf16 a[52:55], v[160:163], v[80:83], a[52:55]
  ds_read_b128 v[52:55], v18 offset:4096
  v_mfma_f32_16x16x32_bf16 a[56:59], v[164:167], v[80:83], a[56:59]
  s_add_u32 m0, s52, 67584
  v_mfma_f32_16x16x32_bf16 a[60:63], v[168:171], v[80:83], a[60:63]
  buffer_load_dwordx4 v4, s[8:11], s20 offen  lds
  ds_read_b64_tr_b16 v[116:117], v24 offset:32768
  v_mfma_f32_16x16x32_bf16 a[64:67], v[140:143], v[84:87], a[64:67]
  v_mfma_f32_16x16x32_bf16 a[68:71], v[144:147], v[84:87], a[68:71]
  ds_read_b64_tr_b16 v[118:119], v24 offset:34816
  v_mfma_f32_16x16x32_bf16 a[72:75], v[148:151], v[84:87], a[72:75]
  s_add_u32 m0, s53, 67584
  v_mfma_f32_16x16x32_bf16 a[76:79], v[152:155], v[84:87], a[76:79]
  buffer_load_dwordx4 v12, s[12:15], s21 offen  lds
  ds_read_b128 v[56:59], v18 offset:6144
  v_mfma_f32_16x16x32_bf16 a[80:83], v[156:159], v[84:87], a[80:83]
  v_mfma_f32_16x16x32_bf16 a[84:87], v[160:163], v[84:87], a[84:87]
  ds_read_b64_tr_b16 v[120:121], v25 offset:32768
  v_mfma_f32_16x16x32_bf16 a[88:91], v[164:167], v[84:87], a[88:91]
  s_add_u32 m0, s52, 68608
  v_mfma_f32_16x16x32_bf16 a[92:95], v[168:171], v[84:87], a[92:95]
  buffer_load_dwordx4 v5, s[8:11], s20 offen  lds
  ds_read_b64_tr_b16 v[122:123], v25 offset:34816
  v_mfma_f32_16x16x32_bf16 a[96:99], v[140:143], v[88:91], a[96:99]
  v_mfma_f32_16x16x32_bf16 a[100:103], v[144:147], v[88:91], a[100:103]
  ds_read_b128 v[60:63], v18 offset:8192
  s_add_u32 m0, s53, 68608
  v_mfma_f32_16x16x32_bf16 a[104:107], v[148:151], v[88:91], a[104:107]
  buffer_load_dwordx4 v13, s[12:15], s21 offen  lds
  v_mfma_f32_16x16x32_bf16 a[108:111], v[152:155], v[88:91], a[108:111]
  ds_read_b64_tr_b16 v[124:125], v26 offset:32768
  v_mfma_f32_16x16x32_bf16 a[112:115], v[156:159], v[88:91], a[112:115]
  v_mfma_f32_16x16x32_bf16 a[116:119], v[160:163], v[88:91], a[116:119]
  ds_read_b64_tr_b16 v[126:127], v26 offset:34816
  s_add_u32 m0, s52, 69632
  v_mfma_f32_16x16x32_bf16 a[120:123], v[164:167], v[88:91], a[120:123]
  buffer_load_dwordx4 v6, s[8:11], s20 offen  lds
  v_mfma_f32_16x16x32_bf16 a[124:127], v[168:171], v[88:91], a[124:127]
  ds_read_b128 v[64:67], v18 offset:10240
  v_mfma_f32_16x16x32_bf16 a[128:131], v[140:143], v[92:95], a[128:131]
  v_mfma_f32_16x16x32_bf16 a[132:135], v[144:147], v[92:95], a[132:135]
  ds_read_b64_tr_b16 v[128:129], v27 offset:32768
  s_add_u32 m0, s53, 69632
  v_mfma_f32_16x16x32_bf16 a[136:139], v[148:151], v[92:95], a[136:139]
  buffer_load_dwordx4 v14, s[12:15], s21 offen  lds
  v_mfma_f32_16x16x32_bf16 a[140:143], v[152:155], v[92:95], a[140:143]
  ds_read_b64_tr_b16 v[130:131], v27 offset:34816
  v_mfma_f32_16x16x32_bf16 a[144:147], v[156:159], v[92:95], a[144:147]
  v_mfma_f32_16x16x32_bf16 a[148:151], v[160:163], v[92:95], a[148:151]
  ds_read_b128 v[68:71], v18 offset:12288
  s_add_u32 m0, s52, 70656
  v_mfma_f32_16x16x32_bf16 a[152:155], v[164:167], v[92:95], a[152:155]
  buffer_load_dwordx4 v7, s[8:11], s20 offen  lds
  v_mfma_f32_16x16x32_bf16 a[156:159], v[168:171], v[92:95], a[156:159]
  ds_read_b64_tr_b16 v[132:133], v28 offset:32768
  v_mfma_f32_16x16x32_bf16 a[160:163], v[140:143], v[96:99], a[160:163]
  s_add_u32 m0, s53, 70656
  v_mfma_f32_16x16x32_bf16 a[164:167], v[144:147], v[96:99], a[164:167]
  buffer_load_dwordx4 v15, s[12:15], s21 offen  lds
  ds_read_b64_tr_b16 v[134:135], v28 offset:34816
  v_mfma_f32_16x16x32_bf16 a[168:171], v[148:151], v[96:99], a[168:171]
  v_mfma_f32_16x16x32_bf16 a[172:175], v[152:155], v[96:99], a[172:175]
  ds_read_b128 v[72:75], v18 offset:14336
  v_mfma_f32_16x16x32_bf16 a[176:179], v[156:159], v[96:99], a[176:179]
  s_add_u32 m0, s52, 71680
  v_mfma_f32_16x16x32_bf16 a[180:183], v[160:163], v[96:99], a[180:183]
  buffer_load_dwordx4 v8, s[8:11], s20 offen  lds
  ds_read_b64_tr_b16 v[136:137], v29 offset:32768
  v_mfma_f32_16x16x32_bf16 a[184:187], v[164:167], v[96:99], a[184:187]
  v_mfma_f32_16x16x32_bf16 a[188:191], v[168:171], v[96:99], a[188:191]
  ds_read_b64_tr_b16 v[138:139], v29 offset:34816
  v_mfma_f32_16x16x32_bf16 a[192:195], v[140:143], v[100:103], a[192:195]
  s_add_u32 m0, s53, 71680
  v_mfma_f32_16x16x32_bf16 a[196:199], v[144:147], v[100:103], a[196:199]
  buffer_load_dwordx4 v16, s[12:15], s21 offen  lds
  v_mfma_f32_16x16x32_bf16 a[200:203], v[148:151], v[100:103], a[200:203]
  v_mfma_f32_16x16x32_bf16 a[204:207], v[152:155], v[100:103], a[204:207]
  s_add_u32 m0, s52, 72704
  v_mfma_f32_16x16x32_bf16 a[208:211], v[156:159], v[100:103], a[208:211]
  buffer_load_dwordx4 v9, s[8:11], s20 offen  lds
  v_mfma_f32_16x16x32_bf16 a[212:215], v[160:163], v[100:103], a[212:215]
  v_mfma_f32_16x16x32_bf16 a[216:219], v[164:167], v[100:103], a[216:219]
  v_mfma_f32_16x16x32_bf16 a[220:223], v[168:171], v[100:103], a[220:223]
  s_add_u32 m0, s53, 72704
  v_mfma_f32_16x16x32_bf16 a[224:227], v[140:143], v[104:107], a[224:227]
  buffer_load_dwordx4 v17, s[12:15], s21 offen  lds
  v_mfma_f32_16x16x32_bf16 a[228:231], v[144:147], v[104:107], a[228:231]
  v_mfma_f32_16x16x32_bf16 a[232:235], v[148:151], v[104:107], a[232:235]
  v_mfma_f32_16x16x32_bf16 a[236:239], v[152:155], v[104:107], a[236:239]
  s_add_u32 s20, s20, 128
  v_mfma_f32_16x16x32_bf16 a[240:243], v[156:159], v[104:107], a[240:243]
  s_add_u32 s21, s21, s51
  v_mfma_f32_16x16x32_bf16 a[244:247], v[160:163], v[104:107], a[244:247]
  v_mfma_f32_16x16x32_bf16 a[248:251], v[164:167], v[104:107], a[248:251]
  v_mfma_f32_16x16x32_bf16 a[252:255], v[168:171], v[104:107], a[252:255]
  s_branch L_g1_loop
L_g1_fin:
  s_mov_b32 s59, 1
  s_mov_b32 s60, s22
  s_mov_b32 s61, s26
  s_add_u32 s62, s38, 0x3d00000
  s_mov_b32 s63, s98
  s_waitcnt lgkmcnt(0)
  v_min_u32 v245, 270, v246
  v_lshlrev_b32 v245, 2, v245
  v_add_u32 v245, 147648, v245
  ds_read_b32 v245, v245
  v_readfirstlane_b32 s34, v246
  s_add_u32 s34, s34, 32
  v_mfma_f32_16x16x32_bf16 a[0:3], v[108:111], v[44:47], a[0:3]
  ds_read_b128 v[76:79], v19 offset:0
  v_mfma_f32_16x16x32_bf16 a[4:7], v[112:115], v[44:47], a[4:7]
  v_mfma_f32_16x16x32_bf16 a[8:11], v[116:119], v[44:47], a[8:11]
  ds_read_b64_tr_b16 v[140:141], v22 offset:49152
  v_mfma_f32_16x16x32_bf16 a[12:15], v[120:123], v[44:47], a[12:15]
  v_mfma_f32_16x16x32_bf16 a[16:19], v[124:127], v[44:47], a[16:19]
  ds_read_b64_tr_b16 v[142:143], v22 offset:51200
  v_mfma_f32_16x16x32_bf16 a[20:23], v[128:131], v[44:47], a[20:23]
  v_mfma_f32_16x16x32_bf16 a[24:27], v[132:135], v[44:47], a[24:27]
  ds_read_b128 v[80:83], v19 offset:2048
  v_mfma_f32_16x16x32_bf16 a[28:31], v[136:139], v[44:47], a[28:31]
  v_mfma_f32_16x16x32_bf16 a[32:35], v[108:111], v[48:51], a[32:35]
  ds_read_b64_tr_b16 v[144:145], v23 offset:49152
  v_mfma_f32_16x16x32_bf16 a[36:39], v[112:115], v[48:51], a[36:39]
  v_mfma_f32_16x16x32_bf16 a[40:43], v[116:119], v[48:51], a[40:43]
  ds_read_b64_tr_b16 v[146:147], v23 offset:51200
  v_mfma_f32_16x16x32_bf16 a[44:47], v[120:123], v[48:51], a[44:47]
  v_mfma_f32_16x16x32_bf16 a[48:51], v[124:127], v[48:51], a[48:51]
  ds_read_b128 v[84:87], v19 offset:4096
  v_mfma_f32_16x16x32_bf16 a[52:55], v[128:131], v[48:51], a[52:55]
  v_mfma_f32_16x16x32_bf16 a[56:59], v[132:135], v[48:51], a[56:59]
  ds_read_b64_tr_b16 v[148:149], v24 offset:49152
  v_mfma_f32_16x16x32_bf16 a[60:63], v[136:139], v[48:51], a[60:63]
  v_mfma_f32_16x16x32_bf16 a[64:67], v[108:111], v[52:55], a[64:67]
  ds_read_b64_tr_b16 v[150:151], v24 offset:51200
  v_mfma_f32_16x16x32_bf16 a[68:71], v[112:115], v[52:55], a[68:71]
  v_mfma_f32_16x16x32_bf16 a[72:75], v[116:119], v[52:55], a[72:75]
  ds_read_b128 v[88:91], v19 offset:6144
  v_mfma_f32_16x16x32_bf16 a[76:79], v[120:123], v[52:55], a[76:79]
  v_mfma_f32_16x16x32_bf16 a[80:83], v[124:127], v[52:55], a[80:83]
  ds_read_b64_tr_b16 v[152:153], v25 offset:49152
  v_mfma_f32_16x16x32_bf16 a[84:87], v[128:131], v[52:55], a[84:87]
  v_mfma_f32_16x16x32_bf16 a[88:91], v[132:135], v[52:55], a[88:91]
  ds_read_b64_tr_b16 v[154:155], v25 offset:51200
  v_mfma_f32_16x16x32_bf16 a[92:95], v[136:139], v[52:55], a[92:95]
  v_mfma_f32_16x16x32_bf16 a[96:99], v[108:111], v[56:59], a[96:99]
  ds_read_b128 v[92:95], v19 offset:8192
  v_mfma_f32_16x16x32_bf16 a[100:103], v[112:115], v[56:59], a[100:103]
  v_mfma_f32_16x16x32_bf16 a[104:107], v[116:119], v[56:59], a[104:107]
  ds_read_b64_tr_b16 v[156:157], v26 offset:49152
  v_mfma_f32_16x16x32_bf16 a[108:111], v[120:123], v[56:59], a[108:111]
  v_mfma_f32_16x16x32_bf16 a[112:115], v[124:127], v[56:59], a[112:115]
  ds_read_b64_tr_b16 v[158:159], v26 offset:51200
  v_mfma_f32_16x16x32_bf16 a[116:119], v[128:131], v[56:59], a[116:119]
  v_mfma_f32_16x16x32_bf16 a[120:123], v[132:135], v[56:59], a[120:123]
  ds_read_b128 v[96:99], v19 offset:10240
  v_mfma_f32_16x16x32_bf16 a[124:127], v[136:139], v[56:59], a[124:127]
  v_mfma_f32_16x16x32_bf16 a[128:131], v[108:111], v[60:63], a[128:131]
  ds_read_b64_tr_b16 v[160:161], v27 offset:49152
  v_mfma_f32_16x16x32_bf16 a[132:135], v[112:115], v[60:63], a[132:135]
  v_mfma_f32_16x16x32_bf16 a[136:139], v[116:119], v[60:63], a[136:139]
  ds_read_b64_tr_b16 v[162:163], v27 offset:51200
  v_mfma_f32_16x16x32_bf16 a[140:143], v[120:123], v[60:63], a[140:143]
  v_mfma_f32_16x16x32_bf16 a[144:147], v[124:127], v[60:63], a[144:147]
  ds_read_b128 v[100:103], v19 offset:12288
  v_mfma_f32_16x16x32_bf16 a[148:151], v[128:131], v[60:63], a[148:151]
  v_mfma_f32_16x16x32_bf16 a[152:155], v[132:135], v[60:63], a[152:155]
  ds_read_b64_tr_b16 v[164:165], v28 offset:49152
  v_mfma_f32_16x16x32_bf16 a[156:159], v[136:139], v[60:63], a[156:159]
  v_mfma_f32_16x16x32_bf16 a[160:163], v[108:111], v[64:67], a[160:163]
  ds_read_b64_tr_b16 v[166:167], v28 offset:51200
  v_mfma_f32_16x16x32_bf16 a[164:167], v[112:115], v[64:67], a[164:167]
  v_mfma_f32_16x16x32_bf16 a[168:171], v[116:119], v[64:67], a[168:171]
  ds_read_b128 v[104:107], v19 offset:14336
  v_mfma_f32_16x16x32_bf16 a[172:175], v[120:123], v[64:67], a[172:175]
  v_mfma_f32_16x16x32_bf16 a[176:179], v[124:127], v[64:67], a[176:179]
  ds_read_b64_tr_b16 v[168:169], v29 offset:49152
  v_mfma_f32_16x16x32_bf16 a[180:183], v[128:131], v[64:67], a[180:183]
  v_mfma_f32_16x16x32_bf16 a[184:187], v[132:135], v[64:67], a[184:187]
  ds_read_b64_tr_b16 v[170:171], v29 offset:51200
  v_mfma_f32_16x16x32_bf16 a[188:191], v[136:139], v[64:67], a[188:191]
  v_mfma_f32_16x16x32_bf16 a[192:195], v[108:111], v[68:71], a[192:195]
  v_mfma_f32_16x16x32_bf16 a[196:199], v[112:115], v[68:71], a[196:199]
  v_mfma_f32_16x16x32_bf16 a[200:203], v[116:119], v[68:71], a[200:203]
  v_mfma_f32_16x16x32_bf16 a[204:207], v[120:123], v[68:71], a[204:207]
  v_mfma_f32_16x16x32_bf16 a[208:211], v[124:127], v[68:71], a[208:211]
  v_mfma_f32_16x16x32_bf16 a[212:215], v[128:131], v[68:71], a[212:215]
  v_mfma_f32_16x16x32_bf16 a[216:219], v[132:135], v[68:71], a[216:219]
  v_mfma_f32_16x16x32_bf16 a[220:223], v[136:139], v[68:71], a[220:223]
  v_mfma_f32_16x16x32_bf16 a[224:227], v[108:111], v[72:75], a[224:227]
  v_mfma_f32_16x16x32_bf16 a[228:231], v[112:115], v[72:75], a[228:231]
  v_mfma_f32_16x16x32_bf16 a[232:235], v[116:119], v[72:75], a[232:235]
  v_mfma_f32_16x16x32_bf16 a[236:239], v[120:123], v[72:75], a[236:239]
  v_mfma_f32_16x16x32_bf16 a[240:243], v[124:127], v[72:75], a[240:243]
  v_mfma_f32_16x16x32_bf16 a[244:247], v[128:131], v[72:75], a[244:247]
  v_mfma_f32_16x16x32_bf16 a[248:251], v[132:135], v[72:75], a[248:251]
  v_mfma_f32_16x16x32_bf16 a[252:255], v[136:139], v[72:75], a[252:255]
  s_waitcnt lgkmcnt(0)
  v_mfma_f32_16x16x32_bf16 a[0:3], v[140:143], v[76:79], a[0:3]
  s_waitcnt vmcnt(0)
  s_barrier
  v_readfirstlane_b32 s91, v245
  s_and_b32 s35, s91, 255
  s_lshr_b32 s36, s91, 8
  s_and_b32 s36, s36, 255
  s_lshr_b32 s37, s91, 16
  s_mov_b32 s92, s24
  s_cmp_gt_u32 s35, 3
  s_cbranch_scc1 L_cd_11
  s_cmp_eq_u32 s35, 3
  s_cbranch_scc1 L_cd_9
  s_mov_b32 s8, s64
  s_and_b32 s9, s65, 0xffff
  s_mov_b32 s10, 0x400000
  s_mov_b32 s11, 0x20000
  s_cmp_eq_u32 s35, 0
  s_cselect_b64 s[88:89], s[68:69], s[70:71]
  s_cmp_eq_u32 s35, 2
  s_cselect_b64 s[88:89], s[72:73], s[88:89]
  s_mov_b32 s12, s88
  s_and_b32 s13, s89, 0xffff
  s_mov_b32 s14, 0x800000
  s_mov_b32 s15, 0x20000
  s_lshl_b32 s91, s33, 2
  s_add_u32 s91, s91, s37
  s_mov_b32 s24, 8192
  s_mov_b32 s26, 262144
  s_lshl_b32 s20, s36, 19
  s_lshl_b32 s21, s91, 9
  s_lshl_b32 s22, s35, 24
  s_lshl_b32 s90, s36, 21
  s_add_u32 s22, s22, s90
  s_lshl_b32 s90, s91, 14
  s_add_u32 s22, s22, s90
  s_lshl_b32 s38, s36, 9
  s_add_u32 s38, s38, 28672
  s_cmp_eq_u32 s35, 0
  s_cselect_b32 s38, 8192, s38
  s_cselect_b32 s98, 1, 2
  s_mov_b32 s48, s35
  s_branch L_cd_10
L_cd_11:
  s_mov_b64 vcc, 0
  s_mov_b32 s58, 0
  s_branch L_cd_12
L_cd_9:
  s_mov_b32 s8, s78
  s_and_b32 s9, s79, 0xffff
  s_mov_b32 s10, 0x400000
  s_mov_b32 s11, 0x20000
  s_mov_b32 s12, s80
  s_and_b32 s13, s81, 0xffff
  s_mov_b32 s14, 0x600000
  s_mov_b32 s15, 0x20000
  s_lshl_b32 s91, s37, 2
  s_add_u32 s91, s91, s33
  s_mov_b32 s24, 6144
  s_mov_b32 s26, 65536
  s_lshl_b32 s20, s36, 19
  s_lshl_b32 s21, s91, 9
  s_lshl_b32 s22, s37, 22
  s_lshl_b32 s90, s36, 19
  s_add_u32 s22, s22, s90
  s_lshl_b32 s90, s33, 14
  s_add_u32 s22, s22, s90
  s_add_u32 s22, s22, 0x4000000
  s_mov_b32 s38, 12288
  s_mov_b32 s48, s37
  s_mov_b32 s98, 1
L_cd_10:
  s_lshl_b32 s90, s36, 9
  s_add_u32 s38, s38, s90
  s_lshl_b32 s90, s33, 7
  s_add_u32 s38, s38, s90
  s_mov_b32 s23, 2048
  s_mov_b32 s25, 8
  s_mov_b64 vcc, -1
  s_sub_i32 s92, s24, s92
  s_lshl_b32 s51, s24, 6
  v_mul_i32_i24 v38, s92, v174
  s_mul_i32 s92, s92, 2
  s_mov_b32 s93, 0
  v_add3_u32 v10, v10, v38, s93
  s_add_u32 s93, s93, s92
  v_add3_u32 v11, v11, v38, s93
  s_add_u32 s93, s93, s92
  v_add3_u32 v12, v12, v38, s93
  s_add_u32 s93, s93, s92
  v_add3_u32 v13, v13, v38, s93
  s_add_u32 s93, s93, s92
  v_add3_u32 v14, v14, v38, s93
  s_add_u32 s93, s93, s92
  v_add3_u32 v15, v15, v38, s93
  s_add_u32 s93, s93, s92
  v_add3_u32 v16, v16, v38, s93
  s_add_u32 s93, s93, s92
  v_add3_u32 v17, v17, v38, s93
  s_add_u32 s93, s93, s92
L_cd_12:
  s_add_u32 m0, s52, 0
  v_mfma_f32_16x16x32_bf16 a[4:7], v[144:147], v[76:79], a[4:7]
  s_cbranch_vccz L_gd_13
  buffer_load_dwordx4 v2, s[8:11], s20 offen  lds
L_gd_13:
  ds_read_b128 v[44:47], v20 offset:0
  v_mfma_f32_16x16x32_bf16 a[8:11], v[148:151], v[76:79], a[8:11]
  v_mfma_f32_16x16x32_bf16 a[12:15], v[152:155], v[76:79], a[12:15]
  ds_read_b64_tr_b16 v[108:109], v30 offset:32768
  s_add_u32 m0, s53, 0
  v_mfma_f32_16x16x32_bf16 a[16:19], v[156:159], v[76:79], a[16:19]
  s_cbranch_vccz L_gd_14
  buffer_load_dwordx4 v10, s[12:15], s21 offen  lds
L_gd_14:
  v_mfma_f32_16x16x32_bf16 a[20:23], v[160:163], v[76:79], a[20:23]
  ds_read_b64_tr_b16 v[110:111], v30 offset:34816
  v_mfma_f32_16x16x32_bf16 a[24:27], v[164:167], v[76:79], a[24:27]
  v_mfma_f32_16x16x32_bf16 a[28:31], v[168:171], v[76:79], a[28:31]
  ds_read_b128 v[48:51], v20 offset:2048
  s_add_u32 m0, s52, 1024
  v_mfma_f32_16x16x32_bf16 a[32:35], v[140:143], v[80:83], a[32:35]
  s_cbranch_vccz L_gd_15
  buffer_load_dwordx4 v3, s[8:11], s20 offen  lds
L_gd_15:
  v_mfma_f32_16x16x32_bf16 a[36:39], v[144:147], v[80:83], a[36:39]
  ds_read_b64_tr_b16 v[112:113], v31 offset:32768
  v_mfma_f32_16x16x32_bf16 a[40:43], v[148:151], v[80:83], a[40:43]
  v_mfma_f32_16x16x32_bf16 a[44:47], v[152:155], v[80:83], a[44:47]
  ds_read_b64_tr_b16 v[114:115], v31 offset:34816
  s_add_u32 m0, s53, 1024
  v_mfma_f32_16x16x32_bf16 a[48:51], v[156:159], v[80:83], a[48:51]
  s_cbranch_vccz L_gd_16
  buffer_load_dwordx4 v11, s[12:15], s21 offen  lds
L_gd_16:
  v_mfma_f32_16x16x32_bf16 a[52:55], v[160:163], v[80:83], a[52:55]
  ds_read_b128 v[52:55], v20 offset:4096
  v_mfma_f32_16x16x32_bf16 a[56:59], v[164:167], v[80:83], a[56:59]
  v_mfma_f32_16x16x32_bf16 a[60:63], v[168:171], v[80:83], a[60:63]
  ds_read_b64_tr_b16 v[116:117], v32 offset:32768
  s_add_u32 m0, s52, 2048
  v_mfma_f32_16x16x32_bf16 a[64:67], v[140:143], v[84:87], a[64:67]
  s_cbranch_vccz L_gd_17
  buffer_load_dwordx4 v4, s[8:11], s20 offen  lds
L_gd_17:
  v_mfma_f32_16x16x32_bf16 a[68:71], v[144:147], v[84:87], a[68:71]
  ds_read_b64_tr_b16 v[118:119], v32 offset:34816
  v_mfma_f32_16x16x32_bf16 a[72:75], v[148:151], v[84:87], a[72:75]
  v_mfma_f32_16x16x32_bf16 a[76:79], v[152:155], v[84:87], a[76:79]
  ds_read_b128 v[56:59], v20 offset:6144
  s_add_u32 m0, s53, 2048
  v_mfma_f32_16x16x32_bf16 a[80:83], v[156:159], v[84:87], a[80:83]
  s_cbranch_vccz L_gd_18
  buffer_load_dwordx4 v12, s[12:15], s21 offen  lds
L_gd_18:
  v_mfma_f32_16x16x32_bf16 a[84:87], v[160:163], v[84:87], a[84:87]
  ds_read_b64_tr_b16 v[120:121], v33 offset:32768
  v_mfma_f32_16x16x32_bf16 a[88:91], v[164:167], v[84:87], a[88:91]
  v_mfma_f32_16x16x32_bf16 a[92:95], v[168:171], v[84:87], a[92:95]
  ds_read_b64_tr_b16 v[122:123], v33 offset:34816
  s_add_u32 m0, s52, 3072
  v_mfma_f32_16x16x32_bf16 a[96:99], v[140:143], v[88:91], a[96:99]
  s_cbranch_vccz L_gd_19
  buffer_load_dwordx4 v5, s[8:11], s20 offen  lds
L_gd_19:
  v_mfma_f32_16x16x32_bf16 a[100:103], v[144:147], v[88:91], a[100:103]
  ds_read_b128 v[60:63], v20 offset:8192
  v_mfma_f32_16x16x32_bf16 a[104:107], v[148:151], v[88:91], a[104:107]
  v_mfma_f32_16x16x32_bf16 a[108:111], v[152:155], v[88:91], a[108:111]
  ds_read_b64_tr_b16 v[124:125], v34 offset:32768
  s_add_u32 m0, s53, 3072
  v_mfma_f32_16x16x32_bf16 a[112:115], v[156:159], v[88:91], a[112:115]
  s_cbranch_vccz L_gd_20
  buffer_load_dwordx4 v13, s[12:15], s21 offen  lds
L_gd_20:
  v_mfma_f32_16x16x32_bf16 a[116:119], v[160:163], v[88:91], a[116:119]
  ds_read_b64_tr_b16 v[126:127], v34 offset:34816
  v_mfma_f32_16x16x32_bf16 a[120:123], v[164:167], v[88:91], a[120:123]
  v_mfma_f32_16x16x32_bf16 a[124:127], v[168:171], v[88:91], a[124:127]
  ds_read_b128 v[64:67], v20 offset:10240
  s_add_u32 m0, s52, 4096
  v_mfma_f32_16x16x32_bf16 a[128:131], v[140:143], v[92:95], a[128:131]
  s_cbranch_vccz L_gd_21
  buffer_load_dwordx4 v6, s[8:11], s20 offen  lds
L_gd_21:
  v_mfma_f32_16x16x32_bf16 a[132:135], v[144:147], v[92:95], a[132:135]
  ds_read_b64_tr_b16 v[128:129], v35 offset:32768
  v_mfma_f32_16x16x32_bf16 a[136:139], v[148:151], v[92:95], a[136:139]
  v_mfma_f32_16x16x32_bf16 a[140:143], v[152:155], v[92:95], a[140:143]
  ds_read_b64_tr_b16 v[130:131], v35 offset:34816
  s_add_u32 m0, s53, 4096
  v_mfma_f32_16x16x32_bf16 a[144:147], v[156:159], v[92:95], a[144:147]
  s_cbranch_vccz L_gd_22
  buffer_load_dwordx4 v14, s[12:15], s21 offen  lds
L_gd_22:
  v_mfma_f32_16x16x32_bf16 a[148:151], v[160:163], v[92:95], a[148:151]
  ds_read_b128 v[68:71], v20 offset:12288
  v_mfma_f32_16x16x32_bf16 a[152:155], v[164:167], v[92:95], a[152:155]
  v_mfma_f32_16x16x32_bf16 a[156:159], v[168:171], v[92:95], a[156:159]
  ds_read_b64_tr_b16 v[132:133], v36 offset:32768
  s_add_u32 m0, s52, 5120
  v_mfma_f32_16x16x32_bf16 a[160:163], v[140:143], v[96:99], a[160:163]
  s_cbranch_vccz L_gd_23
  buffer_load_dwordx4 v7, s[8:11], s20 offen  lds
L_gd_23:
  v_mfma_f32_16x16x32_bf16 a[164:167], v[144:147], v[96:99], a[164:167]
  ds_read_b64_tr_b16 v[134:135], v36 offset:34816
  v_mfma_f32_16x16x32_bf16 a[168:171], v[148:151], v[96:99], a[168:171]
  v_mfma_f32_16x16x32_bf16 a[172:175], v[152:155], v[96:99], a[172:175]
  ds_read_b128 v[72:75], v20 offset:14336
  s_add_u32 m0, s53, 5120
  v_mfma_f32_16x16x32_bf16 a[176:179], v[156:159], v[96:99], a[176:179]
  s_cbranch_vccz L_gd_24
  buffer_load_dwordx4 v15, s[12:15], s21 offen  lds
L_gd_24:
  v_mfma_f32_16x16x32_bf16 a[180:183], v[160:163], v[96:99], a[180:183]
  ds_read_b64_tr_b16 v[136:137], v37 offset:32768
  v_mfma_f32_16x16x32_bf16 a[184:187], v[164:167], v[96:99], a[184:187]
  v_mfma_f32_16x16x32_bf16 a[188:191], v[168:171], v[96:99], a[188:191]
  ds_read_b64_tr_b16 v[138:139], v37 offset:34816
  s_add_u32 m0, s52, 6144
  v_mfma_f32_16x16x32_bf16 a[192:195], v[140:143], v[100:103], a[192:195]
  s_cbranch_vccz L_gd_25
  buffer_load_dwordx4 v8, s[8:11], s20 offen  lds
L_gd_25:
  v_mfma_f32_16x16x32_bf16 a[196:199], v[144:147], v[100:103], a[196:199]
  v_mfma_f32_16x16x32_bf16 a[200:203], v[148:151], v[100:103], a[200:203]
  v_mfma_f32_16x16x32_bf16 a[204:207], v[152:155], v[100:103], a[204:207]
  s_add_u32 m0, s53, 6144
  v_mfma_f32_16x16x32_bf16 a[208:211], v[156:159], v[100:103], a[208:211]
  s_cbranch_vccz L_gd_26
  buffer_load_dwordx4 v16, s[12:15], s21 offen  lds
L_gd_26:
  v_mfma_f32_16x16x32_bf16 a[212:215], v[160:163], v[100:103], a[212:215]
  v_mfma_f32_16x16x32_bf16 a[216:219], v[164:167], v[100:103], a[216:219]
  v_mfma_f32_16x16x32_bf16 a[220:223], v[168:171], v[100:103], a[220:223]
  s_add_u32 m0, s52, 7168
  v_mfma_f32_16x16x32_bf16 a[224:227], v[140:143], v[104:107], a[224:227]
  s_cbranch_vccz L_gd_27
  buffer_load_dwordx4 v9, s[8:11], s20 offen  lds
L_gd_27:
  v_mfma_f32_16x16x32_bf16 a[228:231], v[144:147], v[104:107], a[228:231]
  v_mfma_f32_16x16x32_bf16 a[232:235], v[148:151], v[104:107], a[232:235]
  v_mfma_f32_16x16x32_bf16 a[236:239], v[152:155], v[104:107], a[236:239]
  s_add_u32 m0, s53, 7168
  v_mfma_f32_16x16x32_bf16 a[240:243], v[156:159], v[104:107], a[240:243]
  s_cbranch_vccz L_gd_28
  buffer_load_dwordx4 v17, s[12:15], s21 offen  lds
  s_add_u32 s20, s20, 128
  s_add_u32 s21, s21, s51
L_gd_28:
  v_mfma_f32_16x16x32_bf16 a[244:247], v[160:163], v[104:107], a[244:247]
  v_mfma_f32_16x16x32_bf16 a[248:251], v[164:167], v[104:107], a[248:251]
  v_mfma_f32_16x16x32_bf16 a[252:255], v[168:171], v[104:107], a[252:255]
  s_waitcnt lgkmcnt(0)
  v_mfma_f32_16x16x32_bf16 a[0:3], v[108:111], v[44:47], a[0:3]
  ds_read_b128 v[76:79], v21 offset:0
  v_mfma_f32_16x16x32_bf16 a[4:7], v[112:115], v[44:47], a[4:7]
  v_mfma_f32_16x16x32_bf16 a[8:11], v[116:119], v[44:47], a[8:11]
  ds_read_b64_tr_b16 v[140:141], v30 offset:49152
  v_mfma_f32_16x16x32_bf16 a[12:15], v[120:123], v[44:47], a[12:15]
  v_mfma_f32_16x16x32_bf16 a[16:19], v[124:127], v[44:47], a[16:19]
  ds_read_b64_tr_b16 v[142:143], v30 offset:51200
  v_mfma_f32_16x16x32_bf16 a[20:23], v[128:131], v[44:47], a[20:23]
  v_mfma_f32_16x16x32_bf16 a[24:27], v[132:135], v[44:47], a[24:27]
  ds_read_b128 v[80:83], v21 offset:2048
  v_mfma_f32_16x16x32_bf16 a[28:31], v[136:139], v[44:47], a[28:31]
  v_mfma_f32_16x16x32_bf16 a[32:35], v[108:111], v[48:51], a[32:35]
  ds_read_b64_tr_b16 v[144:145], v31 offset:49152
  v_mfma_f32_16x16x32_bf16 a[36:39], v[112:115], v[48:51], a[36:39]
  v_mfma_f32_16x16x32_bf16 a[40:43], v[116:119], v[48:51], a[40:43]
  ds_read_b64_tr_b16 v[146:147], v31 offset:51200
  v_mfma_f32_16x16x32_bf16 a[44:47], v[120:123], v[48:51], a[44:47]
  v_mfma_f32_16x16x32_bf16 a[48:51], v[124:127], v[48:51], a[48:51]
  ds_read_b128 v[84:87], v21 offset:4096
  v_mfma_f32_16x16x32_bf16 a[52:55], v[128:131], v[48:51], a[52:55]
  v_mfma_f32_16x16x32_bf16 a[56:59], v[132:135], v[48:51], a[56:59]
  ds_read_b64_tr_b16 v[148:149], v32 offset:49152
  v_mfma_f32_16x16x32_bf16 a[60:63], v[136:139], v[48:51], a[60:63]
  v_mfma_f32_16x16x32_bf16 a[64:67], v[108:111], v[52:55], a[64:67]
  ds_read_b64_tr_b16 v[150:151], v32 offset:51200
  v_mfma_f32_16x16x32_bf16 a[68:71], v[112:115], v[52:55], a[68:71]
  v_mfma_f32_16x16x32_bf16 a[72:75], v[116:119], v[52:55], a[72:75]
  ds_read_b128 v[88:91], v21 offset:6144
  v_mfma_f32_16x16x32_bf16 a[76:79], v[120:123], v[52:55], a[76:79]
  v_mfma_f32_16x16x32_bf16 a[80:83], v[124:127], v[52:55], a[80:83]
  ds_read_b64_tr_b16 v[152:153], v33 offset:49152
  v_mfma_f32_16x16x32_bf16 a[84:87], v[128:131], v[52:55], a[84:87]
  v_mfma_f32_16x16x32_bf16 a[88:91], v[132:135], v[52:55], a[88:91]
  ds_read_b64_tr_b16 v[154:155], v33 offset:51200
  v_mfma_f32_16x16x32_bf16 a[92:95], v[136:139], v[52:55], a[92:95]
  v_mfma_f32_16x16x32_bf16 a[96:99], v[108:111], v[56:59], a[96:99]
  ds_read_b128 v[92:95], v21 offset:8192
  v_mfma_f32_16x16x32_bf16 a[100:103], v[112:115], v[56:59], a[100:103]
  v_mfma_f32_16x16x32_bf16 a[104:107], v[116:119], v[56:59], a[104:107]
  ds_read_b64_tr_b16 v[156:157], v34 offset:49152
  v_mfma_f32_16x16x32_bf16 a[108:111], v[120:123], v[56:59], a[108:111]
  v_mfma_f32_16x16x32_bf16 a[112:115], v[124:127], v[56:59], a[112:115]
  ds_read_b64_tr_b16 v[158:159], v34 offset:51200
  v_mfma_f32_16x16x32_bf16 a[116:119], v[128:131], v[56:59], a[116:119]
  v_mfma_f32_16x16x32_bf16 a[120:123], v[132:135], v[56:59], a[120:123]
  ds_read_b128 v[96:99], v21 offset:10240
  v_mfma_f32_16x16x32_bf16 a[124:127], v[136:139], v[56:59], a[124:127]
  v_mfma_f32_16x16x32_bf16 a[128:131], v[108:111], v[60:63], a[128:131]
  ds_read_b64_tr_b16 v[160:161], v35 offset:49152
  v_mfma_f32_16x16x32_bf16 a[132:135], v[112:115], v[60:63], a[132:135]
  v_mfma_f32_16x16x32_bf16 a[136:139], v[116:119], v[60:63], a[136:139]
  ds_read_b64_tr_b16 v[162:163], v35 offset:51200
  v_mfma_f32_16x16x32_bf16 a[140:143], v[120:123], v[60:63], a[140:143]
  v_mfma_f32_16x16x32_bf16 a[144:147], v[124:127], v[60:63], a[144:147]
  ds_read_b128 v[100:103], v21 offset:12288
  v_mfma_f32_16x16x32_bf16 a[148:151], v[128:131], v[60:63], a[148:151]
  v_mfma_f32_16x16x32_bf16 a[152:155], v[132:135], v[60:63], a[152:155]
  ds_read_b64_tr_b16 v[164:165], v36 offset:49152
  v_mfma_f32_16x16x32_bf16 a[156:159], v[136:139], v[60:63], a[156:159]
  v_mfma_f32_16x16x32_bf16 a[160:163], v[108:111], v[64:67], a[160:163]
  ds_read_b64_tr_b16 v[166:167], v36 offset:51200
  v_mfma_f32_16x16x32_bf16 a[164:167], v[112:115], v[64:67], a[164:167]
  v_mfma_f32_16x16x32_bf16 a[168:171], v[116:119], v[64:67], a[168:171]
  ds_read_b128 v[104:107], v21 offset:14336
  v_mfma_f32_16x16x32_bf16 a[172:175], v[120:123], v[64:67], a[172:175]
  v_mfma_f32_16x16x32_bf16 a[176:179], v[124:127], v[64:67], a[176:179]
  ds_read_b64_tr_b16 v[168:169], v37 offset:49152
  v_mfma_f32_16x16x32_bf16 a[180:183], v[128:131], v[64:67], a[180:183]
  v_mfma_f32_16x16x32_bf16 a[184:187], v[132:135], v[64:67], a[184:187]
  ds_read_b64_tr_b16 v[170:171], v37 offset:51200
  v_mfma_f32_16x16x32_bf16 a[188:191], v[136:139], v[64:67], a[188:191]
  v_mfma_f32_16x16x32_bf16 a[192:195], v[108:111], v[68:71], a[192:195]
  v_mfma_f32_16x16x32_bf16 a[196:199], v[112:115], v[68:71], a[196:199]
  v_mfma_f32_16x16x32_bf16 a[200:203], v[116:119], v[68:71], a[200:203]
  v_mfma_f32_16x16x32_bf16 a[204:207], v[120:123], v[68:71], a[204:207]
  v_mfma_f32_16x16x32_bf16 a[208:211], v[124:127], v[68:71], a[208:211]
  v_mfma_f32_16x16x32_bf16 a[212:215], v[128:131], v[68:71], a[212:215]
  v_mfma_f32_16x16x32_bf16 a[216:219], v[132:135], v[68:71], a[216:219]
  v_mfma_f32_16x16x32_bf16 a[220:223], v[136:139], v[68:71], a[220:223]
  v_mfma_f32_16x16x32_bf16 a[224:227], v[108:111], v[72:75], a[224:227]
  v_mfma_f32_16x16x32_bf16 a[228:231], v[112:115], v[72:75], a[228:231]
  v_mfma_f32_16x16x32_bf16 a[232:235], v[116:119], v[72:75], a[232:235]
  v_mfma_f32_16x16x32_bf16 a[236:239], v[120:123], v[72:75], a[236:239]
  v_mfma_f32_16x16x32_bf16 a[240:243], v[124:127], v[72:75], a[240:243]
  v_mfma_f32_16x16x32_bf16 a[244:247], v[128:131], v[72:75], a[244:247]
  v_mfma_f32_16x16x32_bf16 a[248:251], v[132:135], v[72:75], a[248:251]
  v_mfma_f32_16x16x32_bf16 a[252:255], v[136:139], v[72:75], a[252:255]
  s_waitcnt lgkmcnt(0)
  v_mfma_f32_16x16x32_bf16 a[0:3], v[140:143], v[76:79], a[0:3]
  s_barrier
  s_add_u32 m0, s52, 65536
  v_mfma_f32_16x16x32_bf16 a[4:7], v[144:147], v[76:79], a[4:7]
  s_cbranch_vccz L_gd_29
  buffer_load_dwordx4 v2, s[8:11], s20 offen  lds
L_gd_29:
  v_mfma_f32_16x16x32_bf16 a[8:11], v[148:151], v[76:79], a[8:11]
  v_mfma_f32_16x16x32_bf16 a[12:15], v[152:155], v[76:79], a[12:15]
  s_add_u32 m0, s53, 65536
  v_mfma_f32_16x16x32_bf16 a[16:19], v[156:159], v[76:79], a[16:19]
  s_cbranch_vccz L_gd_30
  buffer_load_dwordx4 v10, s[12:15], s21 offen  lds
L_gd_30:
  v_mfma_f32_16x16x32_bf16 a[20:23], v[160:163], v[76:79], a[20:23]
  v_mfma_f32_16x16x32_bf16 a[24:27], v[164:167], v[76:79], a[24:27]
  v_mfma_f32_16x16x32_bf16 a[28:31], v[168:171], v[76:79], a[28:31]
  s_add_u32 m0, s52, 66560
  v_mfma_f32_16x16x32_bf16 a[32:35], v[140:143], v[80:83], a[32:35]
  s_cbranch_vccz L_gd_31
  buffer_load_dwordx4 v3, s[8:11], s20 offen  lds
L_gd_31:
  v_mfma_f32_16x16x32_bf16 a[36:39], v[144:147], v[80:83], a[36:39]
  v_mfma_f32_16x16x32_bf16 a[40:43], v[148:151], v[80:83], a[40:43]
  v_mfma_f32_16x16x32_bf16 a[44:47], v[152:155], v[80:83], a[44:47]
  s_add_u32 m0, s53, 66560
  v_mfma_f32_16x16x32_bf16 a[48:51], v[156:159], v[80:83], a[48:51]
  s_cbranch_vccz L_gd_32
  buffer_load_dwordx4 v11, s[12:15], s21 offen  lds
L_gd_32:
  v_mfma_f32_16x16x32_bf16 a[52:55], v[160:163], v[80:83], a[52:55]
  v_mfma_f32_16x16x32_bf16 a[56:59], v[164:167], v[80:83], a[56:59]
  v_mfma_f32_16x16x32_bf16 a[60:63], v[168:171], v[80:83], a[60:63]
  s_add_u32 m0, s52, 67584
  v_mfma_f32_16x16x32_bf16 a[64:67], v[140:143], v[84:87], a[64:67]
  s_cbranch_vccz L_gd_33
  buffer_load_dwordx4 v4, s[8:11], s20 offen  lds
L_gd_33:
  v_mfma_f32_16x16x32_bf16 a[68:71], v[144:147], v[84:87], a[68:71]
  v_mfma_f32_16x16x32_bf16 a[72:75], v[148:151], v[84:87], a[72:75]
  v_mfma_f32_16x16x32_bf16 a[76:79], v[152:155], v[84:87], a[76:79]
  s_add_u32 m0, s53, 67584
  v_mfma_f32_16x16x32_bf16 a[80:83], v[156:159], v[84:87], a[80:83]
  s_cbranch_vccz L_gd_34
  buffer_load_dwordx4 v12, s[12:15], s21 offen  lds
L_gd_34:
  v_mfma_f32_16x16x32_bf16 a[84:87], v[160:163], v[84:87], a[84:87]
  v_mfma_f32_16x16x32_bf16 a[88:91], v[164:167], v[84:87], a[88:91]
  v_mfma_f32_16x16x32_bf16 a[92:95], v[168:171], v[84:87], a[92:95]
  s_add_u32 m0, s52, 68608
  v_mfma_f32_16x16x32_bf16 a[96:99], v[140:143], v[88:91], a[96:99]
  s_cbranch_vccz L_gd_35
  buffer_load_dwordx4 v5, s[8:11], s20 offen  lds
L_gd_35:
  v_mfma_f32_16x16x32_bf16 a[100:103], v[144:147], v[88:91], a[100:103]
  v_mfma_f32_16x16x32_bf16 a[104:107], v[148:151], v[88:91], a[104:107]
  v_mfma_f32_16x16x32_bf16 a[108:111], v[152:155], v[88:91], a[108:111]
  s_add_u32 m0, s53, 68608
  v_mfma_f32_16x16x32_bf16 a[112:115], v[156:159], v[88:91], a[112:115]
  s_cbranch_vccz L_gd_36
  buffer_load_dwordx4 v13, s[12:15], s21 offen  lds
L_gd_36:
  v_mfma_f32_16x16x32_bf16 a[116:119], v[160:163], v[88:91], a[116:119]
  v_mfma_f32_16x16x32_bf16 a[120:123], v[164:167], v[88:91], a[120:123]
  v_mfma_f32_16x16x32_bf16 a[124:127], v[168:171], v[88:91], a[124:127]
  s_add_u32 m0, s52, 69632
  v_mfma_f32_16x16x32_bf16 a[128:131], v[140:143], v[92:95], a[128:131]
  s_cbranch_vccz L_gd_37
  buffer_load_dwordx4 v6, s[8:11], s20 offen  lds
L_gd_37:
  v_mfma_f32_16x16x32_bf16 a[132:135], v[144:147], v[92:95], a[132:135]
  v_mfma_f32_16x16x32_bf16 a[136:139], v[148:151], v[92:95], a[136:139]
  v_mfma_f32_16x16x32_bf16 a[140:143], v[152:155], v[92:95], a[140:143]
  s_add_u32 m0, s53, 69632
  v_mfma_f32_16x16x32_bf16 a[144:147], v[156:159], v[92:95], a[144:147]
  s_cbranch_vccz L_gd_38
  buffer_load_dwordx4 v14, s[12:15], s21 offen  lds
L_gd_38:
  v_mfma_f32_16x16x32_bf16 a[148:151], v[160:163], v[92:95], a[148:151]
  v_mfma_f32_16x16x32_bf16 a[152:155], v[164:167], v[92:95], a[152:155]
  v_mfma_f32_16x16x32_bf16 a[156:159], v[168:171], v[92:95], a[156:159]
  s_add_u32 m0, s52, 70656
  v_mfma_f32_16x16x32_bf16 a[160:163], v[140:143], v[96:99], a[160:163]
  s_cbranch_vccz L_gd_39
  buffer_load_dwordx4 v7, s[8:11], s20 offen  lds
L_gd_39:
  v_mfma_f32_16x16x32_bf16 a[164:167], v[144:147], v[96:99], a[164:167]
  v_mfma_f32_16x16x32_bf16 a[168:171], v[148:151], v[96:99], a[168:171]
  v_mfma_f32_16x16x32_bf16 a[172:175], v[152:155], v[96:99], a[172:175]
  s_add_u32 m0, s53, 70656
  v_mfma_f32_16x16x32_bf16 a[176:179], v[156:159], v[96:99], a[176:179]
  s_cbranch_vccz L_gd_40
  buffer_load_dwordx4 v15, s[12:15], s21 offen  lds
L_gd_40:
  v_mfma_f32_16x16x32_bf16 a[180:183], v[160:163], v[96:99], a[180:183]
  v_mfma_f32_16x16x32_bf16 a[184:187], v[164:167], v[96:99], a[184:187]
  v_mfma_f32_16x16x32_bf16 a[188:191], v[168:171], v[96:99], a[188:191]
  s_add_u32 m0, s52, 71680
  v_mfma_f32_16x16x32_bf16 a[192:195], v[140:143], v[100:103], a[192:195]
  s_cbranch_vccz L_gd_41
  buffer_load_dwordx4 v8, s[8:11], s20 offen  lds
L_gd_41:
  v_mfma_f32_16x16x32_bf16 a[196:199], v[144:147], v[100:103], a[196:199]
  v_mfma_f32_16x16x32_bf16 a[200:203], v[148:151], v[100:103], a[200:203]
  v_mfma_f32_16x16x32_bf16 a[204:207], v[152:155], v[100:103], a[204:207]
  s_add_u32 m0, s53, 71680
  v_mfma_f32_16x16x32_bf16 a[208:211], v[156:159], v[100:103], a[208:211]
  s_cbranch_vccz L_gd_42
  buffer_load_dwordx4 v16, s[12:15], s21 offen  lds
L_gd_42:
  v_mfma_f32_16x16x32_bf16 a[212:215], v[160:163], v[100:103], a[212:215]
  v_mfma_f32_16x16x32_bf16 a[216:219], v[164:167], v[100:103], a[216:219]
  v_mfma_f32_16x16x32_bf16 a[220:223], v[168:171], v[100:103], a[220:223]
  s_add_u32 m0, s52, 72704
  v_mfma_f32_16x16x32_bf16 a[224:227], v[140:143], v[104:107], a[224:227]
  s_cbranch_vccz L_gd_43
  buffer_load_dwordx4 v9, s[8:11], s20 offen  lds
L_gd_43:
  v_mfma_f32_16x16x32_bf16 a[228:231], v[144:147], v[104:107], a[228:231]
  v_mfma_f32_16x16x32_bf16 a[232:235], v[148:151], v[104:107], a[232:235]
  v_mfma_f32_16x16x32_bf16 a[236:239], v[152:155], v[104:107], a[236:239]
  s_add_u32 m0, s53, 72704
  v_mfma_f32_16x16x32_bf16 a[240:243], v[156:159], v[104:107], a[240:243]
  s_cbranch_vccz L_gd_44
  buffer_load_dwordx4 v17, s[12:15], s21 offen  lds
  s_add_u32 s20, s20, 128
  s_add_u32 s21, s21, s51
L_gd_44:
  v_mfma_f32_16x16x32_bf16 a[244:247], v[160:163], v[104:107], a[244:247]
  v_mfma_f32_16x16x32_bf16 a[248:251], v[164:167], v[104:107], a[248:251]
  v_mfma_f32_16x16x32_bf16 a[252:255], v[168:171], v[104:107], a[252:255]
  s_cmp_eq_u32 s58, 1
  s_cbranch_scc1 L_epi
  s_branch L_have1
L_g1_cw:
  s_mov_b64 exec, 1
  ds_write_b32 v175, v244
  s_mov_b64 exec, -1
  s_branch L_g1_cwb
L_g1_cr:
  ds_read_b32 v246, v241
  s_cmp_eq_u32 s25, 1
  s_cbranch_scc1 L_g1_crb
  s_cmp_lg_u32 s32, 0
  s_cbranch_scc1 L_rq_45
  s_cmp_eq_u32 s39, 0
  s_cbranch_scc1 L_rq_45
  s_lshl_b32 s99, s33, 7
  s_add_u32 s99, s99, 0x3d00200
  v_mov_b32 v244, 1
  v_mov_b32 v245, 0
  s_mov_b64 exec, 1
  buffer_atomic_add v244, v245, s[4:7], s99 offen sc0 sc1
  s_mov_b64 exec, -1
L_rq_45:
  s_branch L_g1_crb
L_g2:
  s_waitcnt vmcnt(16)
  s_barrier
  ds_read_b128 v[44:47], v18 offset:0
  ds_read_b64_tr_b16 v[108:109], v22 offset:32768
  ds_read_b64_tr_b16 v[110:111], v22 offset:34816
  ds_read_b128 v[48:51], v18 offset:2048
  ds_read_b64_tr_b16 v[112:113], v23 offset:32768
  ds_read_b64_tr_b16 v[114:115], v23 offset:34816
  ds_read_b128 v[52:55], v18 offset:4096
  ds_read_b64_tr_b16 v[116:117], v24 offset:32768
  ds_read_b64_tr_b16 v[118:119], v24 offset:34816
  ds_read_b128 v[56:59], v18 offset:6144
  ds_read_b64_tr_b16 v[120:121], v25 offset:32768
  ds_read_b64_tr_b16 v[122:123], v25 offset:34816
  ds_read_b128 v[60:63], v18 offset:8192
  ds_read_b64_tr_b16 v[124:125], v26 offset:32768
  ds_read_b64_tr_b16 v[126:127], v26 offset:34816
  ds_read_b128 v[64:67], v18 offset:10240
  ds_read_b64_tr_b16 v[128:129], v27 offset:32768
  ds_read_b64_tr_b16 v[130:131], v27 offset:34816
  ds_read_b128 v[68:71], v18 offset:12288
  ds_read_b64_tr_b16 v[132:133], v28 offset:32768
  ds_read_b64_tr_b16 v[134:135], v28 offset:34816
  ds_read_b128 v[72:75], v18 offset:14336
  ds_read_b64_tr_b16 v[136:137], v29 offset:32768
  ds_read_b64_tr_b16 v[138:139], v29 offset:34816
  s_sub_u32 s25, s25, 1
  s_waitcnt lgkmcnt(0)
  s_nop 0
  v_mfma_f32_16x16x32_bf16 a[0:3], v[44:47], v[108:111], 0
  buffer_store_dwordx4 v[176:179], v172, s[4:7], s46 offen offset:0 sc1
  ds_read_b128 v[76:79], v19 offset:0
  v_mfma_f32_16x16x32_bf16 a[4:7], v[44:47], v[112:115], 0
  v_mfma_f32_16x16x32_bf16 a[8:11], v[44:47], v[116:119], 0
  ds_read_b64_tr_b16 v[140:141], v22 offset:49152
  v_mfma_f32_16x16x32_bf16 a[12:15], v[44:47], v[120:123], 0
  s_nop 0
  v_mfma_f32_16x16x32_bf16 a[16:19], v[44:47], v[124:127], 0
  buffer_store_dwordx4 v[180:183], v172, s[4:7], s46 offen offset:1024 sc1
  ds_read_b64_tr_b16 v[142:143], v22 offset:51200
  v_mfma_f32_16x16x32_bf16 a[20:23], v[44:47], v[128:131], 0
  v_mfma_f32_16x16x32_bf16 a[24:27], v[44:47], v[132:135], 0
  ds_read_b128 v[80:83], v19 offset:2048
  v_mfma_f32_16x16x32_bf16 a[28:31], v[44:47], v[136:139], 0
  s_nop 0
  v_mfma_f32_16x16x32_bf16 a[32:35], v[48:51], v[108:111], 0
  buffer_store_dwordx4 v[184:187], v172, s[4:7], s46 offen offset:2048 sc1
  ds_read_b64_tr_b16 v[144:145], v23 offset:49152
  v_mfma_f32_16x16x32_bf16 a[36:39], v[48:51], v[112:115], 0
  v_mfma_f32_16x16x32_bf16 a[40:43], v[48:51], v[116:119], 0
  ds_read_b64_tr_b16 v[146:147], v23 offset:51200
  v_mfma_f32_16x16x32_bf16 a[44:47], v[48:51], v[120:123], 0
  s_nop 0
  v_mfma_f32_16x16x32_bf16 a[48:51], v[48:51], v[124:127], 0
  buffer_store_dwordx4 v[188:191], v172, s[4:7], s46 offen offset:3072 sc1
  ds_read_b128 v[84:87], v19 offset:4096
  v_mfma_f32_16x16x32_bf16 a[52:55], v[48:51], v[128:131], 0
  v_mfma_f32_16x16x32_bf16 a[56:59], v[48:51], v[132:135], 0
  ds_read_b64_tr_b16 v[148:149], v24 offset:49152
  v_mfma_f32_16x16x32_bf16 a[60:63], v[48:51], v[136:139], 0
  s_nop 0
  v_mfma_f32_16x16x32_bf16 a[64:67], v[52:55], v[108:111], 0
  buffer_store_dwordx4 v[192:195], v173, s[4:7], s46 offen offset:0 sc1
  ds_read_b64_tr_b16 v[150:151], v24 offset:51200
  v_mfma_f32_16x16x32_bf16 a[68:71], v[52:55], v[112:115], 0
  v_mfma_f32_16x16x32_bf16 a[72:75], v[52:55], v[116:119], 0
  ds_read_b128 v[88:91], v19 offset:6144
  v_mfma_f32_16x16x32_bf16 a[76:79], v[52:55], v[120:123], 0
  s_nop 0
  v_mfma_f32_16x16x32_bf16 a[80:83], v[52:55], v[124:127], 0
  buffer_store_dwordx4 v[196:199], v173, s[4:7], s46 offen offset:1024 sc1
  ds_read_b64_tr_b16 v[152:153], v25 offset:49152
  v_mfma_f32_16x16x32_bf16 a[84:87], v[52:55], v[128:131], 0
  v_mfma_f32_16x16x32_bf16 a[88:91], v[52:55], v[132:135], 0
  ds_read_b64_tr_b16 v[154:155], v25 offset:51200
  v_mfma_f32_16x16x32_bf16 a[92:95], v[52:55], v[136:139], 0
  s_nop 0
  v_mfma_f32_16x16x32_bf16 a[96:99], v[56:59], v[108:111], 0
  buffer_store_dwordx4 v[200:203], v173, s[4:7], s46 offen offset:2048 sc1
  ds_read_b128 v[92:95], v19 offset:8192
  v_mfma_f32_16x16x32_bf16 a[100:103], v[56:59], v[112:115], 0
  v_mfma_f32_16x16x32_bf16 a[104:107], v[56:59], v[116:119], 0
  ds_read_b64_tr_b16 v[156:157], v26 offset:49152
  v_mfma_f32_16x16x32_bf16 a[108:111], v[56:59], v[120:123], 0
  s_nop 0
  v_mfma_f32_16x16x32_bf16 a[112:115], v[56:59], v[124:127], 0
  buffer_store_dwordx4 v[204:207], v173, s[4:7], s46 offen offset:3072 sc1
  ds_read_b64_tr_b16 v[158:159], v26 offset:51200
  v_mfma_f32_16x16x32_bf16 a[116:119], v[56:59], v[128:131], 0
  v_mfma_f32_16x16x32_bf16 a[120:123], v[56:59], v[132:135], 0
  ds_read_b128 v[96:99], v19 offset:10240
  v_mfma_f32_16x16x32_bf16 a[124:127], v[56:59], v[136:139], 0
  s_nop 0
  v_mfma_f32_16x16x32_bf16 a[128:131], v[60:63], v[108:111], 0
  buffer_store_dwordx4 v[208:211], v172, s[4:7], s47 offen offset:0 sc1
  ds_read_b64_tr_b16 v[160:161], v27 offset:49152
  v_mfma_f32_16x16x32_bf16 a[132:135], v[60:63], v[112:115], 0
  v_mfma_f32_16x16x32_bf16 a[136:139], v[60:63], v[116:119], 0
  ds_read_b64_tr_b16 v[162:163], v27 offset:51200
  v_mfma_f32_16x16x32_bf16 a[140:143], v[60:63], v[120:123], 0
  s_nop 0
  v_mfma_f32_16x16x32_bf16 a[144:147], v[60:63], v[124:127], 0
  buffer_store_dwordx4 v[212:215], v172, s[4:7], s47 offen offset:1024 sc1
  ds_read_b128 v[100:103], v19 offset:12288
  v_mfma_f32_16x16x32_bf16 a[148:151], v[60:63], v[128:131], 0
  v_mfma_f32_16x16x32_bf16 a[152:155], v[60:63], v[132:135], 0
  ds_read_b64_tr_b16 v[164:165], v28 offset:49152
  v_mfma_f32_16x16x32_bf16 a[156:159], v[60:63], v[136:139], 0
  s_nop 0
  v_mfma_f32_16x16x32_bf16 a[160:163], v[64:67], v[108:111], 0
  buffer_store_dwordx4 v[216:219], v172, s[4:7], s47 offen offset:2048 sc1
  ds_read_b64_tr_b16 v[166:167], v28 offset:51200
  v_mfma_f32_16x16x32_bf16 a[164:167], v[64:67], v[112:115], 0
  v_mfma_f32_16x16x32_bf16 a[168:171], v[64:67], v[116:119], 0
  ds_read_b128 v[104:107], v19 offset:14336
  v_mfma_f32_16x16x32_bf16 a[172:175], v[64:67], v[120:123], 0
  s_nop 0
  v_mfma_f32_16x16x32_bf16 a[176:179], v[64:67], v[124:127], 0
  buffer_store_dwordx4 v[220:223], v172, s[4:7], s47 offen offset:3072 sc1
  ds_read_b64_tr_b16 v[168:169], v29 offset:49152
  v_mfma_f32_16x16x32_bf16 a[180:183], v[64:67], v[128:131], 0
  v_mfma_f32_16x16x32_bf16 a[184:187], v[64:67], v[132:135], 0
  ds_read_b64_tr_b16 v[170:171], v29 offset:51200
  v_mfma_f32_16x16x32_bf16 a[188:191], v[64:67], v[136:139], 0
  s_nop 0
  v_mfma_f32_16x16x32_bf16 a[192:195], v[68:71], v[108:111], 0
  buffer_store_dwordx4 v[224:227], v173, s[4:7], s47 offen offset:0 sc1
  v_mfma_f32_16x16x32_bf16 a[196:199], v[68:71], v[112:115], 0
  v_mfma_f32_16x16x32_bf16 a[200:203], v[68:71], v[116:119], 0
  v_mfma_f32_16x16x32_bf16 a[204:207], v[68:71], v[120:123], 0
  s_nop 0
  v_mfma_f32_16x16x32_bf16 a[208:211], v[68:71], v[124:127], 0
  buffer_store_dwordx4 v[228:231], v173, s[4:7], s47 offen offset:1024 sc1
  v_mfma_f32_16x16x32_bf16 a[212:215], v[68:71], v[128:131], 0
  v_mfma_f32_16x16x32_bf16 a[216:219], v[68:71], v[132:135], 0
  v_mfma_f32_16x16x32_bf16 a[220:223], v[68:71], v[136:139], 0
  s_nop 0
  v_mfma_f32_16x16x32_bf16 a[224:227], v[72:75], v[108:111], 0
  buffer_store_dwordx4 v[232:235], v173, s[4:7], s47 offen offset:2048 sc1
  v_mfma_f32_16x16x32_bf16 a[228:231], v[72:75], v[112:115], 0
  v_mfma_f32_16x16x32_bf16 a[232:235], v[72:75], v[116:119], 0
  v_mfma_f32_16x16x32_bf16 a[236:239], v[72:75], v[120:123], 0
  s_nop 0
  v_mfma_f32_16x16x32_bf16 a[240:243], v[72:75], v[124:127], 0
  buffer_store_dwordx4 v[236:239], v173, s[4:7], s47 offen offset:3072 sc1
  v_mfma_f32_16x16x32_bf16 a[244:247], v[72:75], v[128:131], 0
  v_mfma_f32_16x16x32_bf16 a[248:251], v[72:75], v[132:135], 0
  v_mfma_f32_16x16x32_bf16 a[252:255], v[72:75], v[136:139], 0
  s_waitcnt lgkmcnt(0)
  v_mfma_f32_16x16x32_bf16 a[0:3], v[76:79], v[140:143], a[0:3]
  s_waitcnt vmcnt(16)
  s_barrier
  s_add_u32 m0, s52, 0
  v_mfma_f32_16x16x32_bf16 a[4:7], v[76:79], v[144:147], a[4:7]
  buffer_load_dwordx4 v2, s[8:11], s20 offen  lds
  ds_read_b128 v[44:47], v20 offset:0
  v_mfma_f32_16x16x32_bf16 a[8:11], v[76:79], v[148:151], a[8:11]
  v_mfma_f32_16x16x32_bf16 a[12:15], v[76:79], v[152:155], a[12:15]
  ds_read_b64_tr_b16 v[108:109], v30 offset:32768
  s_add_u32 m0, s53, 0
  v_mfma_f32_16x16x32_bf16 a[16:19], v[76:79], v[156:159], a[16:19]
  buffer_load_dwordx4 v10, s[12:15], s21 offen  lds
  v_mfma_f32_16x16x32_bf16 a[20:23], v[76:79], v[160:163], a[20:23]
  ds_read_b64_tr_b16 v[110:111], v30 offset:34816
  v_mfma_f32_16x16x32_bf16 a[24:27], v[76:79], v[164:167], a[24:27]
  v_mfma_f32_16x16x32_bf16 a[28:31], v[76:79], v[168:171], a[28:31]
  ds_read_b128 v[48:51], v20 offset:2048
  s_add_u32 m0, s52, 1024
  v_mfma_f32_16x16x32_bf16 a[32:35], v[80:83], v[140:143], a[32:35]
  buffer_load_dwordx4 v3, s[8:11], s20 offen  lds
  v_mfma_f32_16x16x32_bf16 a[36:39], v[80:83], v[144:147], a[36:39]
  ds_read_b64_tr_b16 v[112:113], v31 offset:32768
  v_mfma_f32_16x16x32_bf16 a[40:43], v[80:83], v[148:151], a[40:43]
  v_mfma_f32_16x16x32_bf16 a[44:47], v[80:83], v[152:155], a[44:47]
  ds_read_b64_tr_b16 v[114:115], v31 offset:34816
  s_add_u32 m0, s53, 1024
  v_mfma_f32_16x16x32_bf16 a[48:51], v[80:83], v[156:159], a[48:51]
  buffer_load_dwordx4 v11, s[12:15], s21 offen  lds
  v_mfma_f32_16x16x32_bf16 a[52:55], v[80:83], v[160:163], a[52:55]
  ds_read_b128 v[52:55], v20 offset:4096
  v_mfma_f32_16x16x32_bf16 a[56:59], v[80:83], v[164:167], a[56:59]
  s_add_u32 m0, s52, 2048
  v_mfma_f32_16x16x32_bf16 a[60:63], v[80:83], v[168:171], a[60:63]
  buffer_load_dwordx4 v4, s[8:11], s20 offen  lds
  ds_read_b64_tr_b16 v[116:117], v32 offset:32768
  v_mfma_f32_16x16x32_bf16 a[64:67], v[84:87], v[140:143], a[64:67]
  v_mfma_f32_16x16x32_bf16 a[68:71], v[84:87], v[144:147], a[68:71]
  ds_read_b64_tr_b16 v[118:119], v32 offset:34816
  v_mfma_f32_16x16x32_bf16 a[72:75], v[84:87], v[148:151], a[72:75]
  s_add_u32 m0, s53, 2048
  v_mfma_f32_16x16x32_bf16 a[76:79], v[84:87], v[152:155], a[76:79]
  buffer_load_dwordx4 v12, s[12:15], s21 offen  lds
  ds_read_b128 v[56:59], v20 offset:6144
  v_mfma_f32_16x16x32_bf16 a[80:83], v[84:87], v[156:159], a[80:83]
  v_mfma_f32_16x16x32_bf16 a[84:87], v[84:87], v[160:163], a[84:87]
  ds_read_b64_tr_b16 v[120:121], v33 offset:32768
  v_mfma_f32_16x16x32_bf16 a[88:91], v[84:87], v[164:167], a[88:91]
  s_add_u32 m0, s52, 3072
  v_mfma_f32_16x16x32_bf16 a[92:95], v[84:87], v[168:171], a[92:95]
  buffer_load_dwordx4 v5, s[8:11], s20 offen  lds
  ds_read_b64_tr_b16 v[122:123], v33 offset:34816
  v_mfma_f32_16x16x32_bf16 a[96:99], v[88:91], v[140:143], a[96:99]
  v_mfma_f32_16x16x32_bf16 a[100:103], v[88:91], v[144:147], a[100:103]
  ds_read_b128 v[60:63], v20 offset:8192
  s_add_u32 m0, s53, 3072
  v_mfma_f32_16x16x32_bf16 a[104:107], v[88:91], v[148:151], a[104:107]
  buffer_load_dwordx4 v13, s[12:15], s21 offen  lds
  v_mfma_f32_16x16x32_bf16 a[108:111], v[88:91], v[152:155], a[108:111]
  ds_read_b64_tr_b16 v[124:125], v34 offset:32768
  v_mfma_f32_16x16x32_bf16 a[112:115], v[88:91], v[156:159], a[112:115]
  v_mfma_f32_16x16x32_bf16 a[116:119], v[88:91], v[160:163], a[116:119]
  ds_read_b64_tr_b16 v[126:127], v34 offset:34816
  s_add_u32 m0, s52, 4096
  v_mfma_f32_16x16x32_bf16 a[120:123], v[88:91], v[164:167], a[120:123]
  buffer_load_dwordx4 v6, s[8:11], s20 offen  lds
  v_mfma_f32_16x16x32_bf16 a[124:127], v[88:91], v[168:171], a[124:127]
  ds_read_b128 v[64:67], v20 offset:10240
  v_mfma_f32_16x16x32_bf16 a[128:131], v[92:95], v[140:143], a[128:131]
  v_mfma_f32_16x16x32_bf16 a[132:135], v[92:95], v[144:147], a[132:135]
  ds_read_b64_tr_b16 v[128:129], v35 offset:32768
  s_add_u32 m0, s53, 4096
  v_mfma_f32_16x16x32_bf16 a[136:139], v[92:95], v[148:151], a[136:139]
  buffer_load_dwordx4 v14, s[12:15], s21 offen  lds
  v_mfma_f32_16x16x32_bf16 a[140:143], v[92:95], v[152:155], a[140:143]
  ds_read_b64_tr_b16 v[130:131], v35 offset:34816
  v_mfma_f32_16x16x32_bf16 a[144:147], v[92:95], v[156:159], a[144:147]
  v_mfma_f32_16x16x32_bf16 a[148:151], v[92:95], v[160:163], a[148:151]
  ds_read_b128 v[68:71], v20 offset:12288
  s_add_u32 m0, s52, 5120
  v_mfma_f32_16x16x32_bf16 a[152:155], v[92:95], v[164:167], a[152:155]
  buffer_load_dwordx4 v7, s[8:11], s20 offen  lds
  v_mfma_f32_16x16x32_bf16 a[156:159], v[92:95], v[168:171], a[156:159]
  ds_read_b64_tr_b16 v[132:133], v36 offset:32768
  v_mfma_f32_16x16x32_bf16 a[160:163], v[96:99], v[140:143], a[160:163]
  s_add_u32 m0, s53, 5120
  v_mfma_f32_16x16x32_bf16 a[164:167], v[96:99], v[144:147], a[164:167]
  buffer_load_dwordx4 v15, s[12:15], s21 offen  lds
  ds_read_b64_tr_b16 v[134:135], v36 offset:34816
  v_mfma_f32_16x16x32_bf16 a[168:171], v[96:99], v[148:151], a[168:171]
  v_mfma_f32_16x16x32_bf16 a[172:175], v[96:99], v[152:155], a[172:175]
  ds_read_b128 v[72:75], v20 offset:14336
  v_mfma_f32_16x16x32_bf16 a[176:179], v[96:99], v[156:159], a[176:179]
  s_add_u32 m0, s52, 6144
  v_mfma_f32_16x16x32_bf16 a[180:183], v[96:99], v[160:163], a[180:183]
  buffer_load_dwordx4 v8, s[8:11], s20 offen  lds
  ds_read_b64_tr_b16 v[136:137], v37 offset:32768
  v_mfma_f32_16x16x32_bf16 a[184:187], v[96:99], v[164:167], a[184:187]
  v_mfma_f32_16x16x32_bf16 a[188:191], v[96:99], v[168:171], a[188:191]
  ds_read_b64_tr_b16 v[138:139], v37 offset:34816
  v_mfma_f32_16x16x32_bf16 a[192:195], v[100:103], v[140:143], a[192:195]
  s_add_u32 m0, s53, 6144
  v_mfma_f32_16x16x32_bf16 a[196:199], v[100:103], v[144:147], a[196:199]
  buffer_load_dwordx4 v16, s[12:15], s21 offen  lds
  v_mfma_f32_16x16x32_bf16 a[200:203], v[100:103], v[148:151], a[200:203]
  v_mfma_f32_16x16x32_bf16 a[204:207], v[100:103], v[152:155], a[204:207]
  s_add_u32 m0, s52, 7168
  v_mfma_f32_16x16x32_bf16 a[208:211], v[100:103], v[156:159], a[208:211]
  buffer_load_dwordx4 v9, s[8:11], s20 offen  lds
  v_mfma_f32_16x16x32_bf16 a[212:215], v[100:103], v[160:163], a[212:215]
  v_mfma_f32_16x16x32_bf16 a[216:219], v[100:103], v[164:167], a[216:219]
  v_mfma_f32_16x16x32_bf16 a[220:223], v[100:103], v[168:171], a[220:223]
  s_add_u32 m0, s53, 7168
  v_mfma_f32_16x16x32_bf16 a[224:227], v[104:107], v[140:143], a[224:227]
  buffer_load_dwordx4 v17, s[12:15], s21 offen  lds
  v_mfma_f32_16x16x32_bf16 a[228:231], v[104:107], v[144:147], a[228:231]
  v_mfma_f32_16x16x32_bf16 a[232:235], v[104:107], v[148:151], a[232:235]
  v_mfma_f32_16x16x32_bf16 a[236:239], v[104:107], v[152:155], a[236:239]
  s_add_u32 s20, s20, 128
  v_mfma_f32_16x16x32_bf16 a[240:243], v[104:107], v[156:159], a[240:243]
  s_add_u32 s21, s21, s51
  v_mfma_f32_16x16x32_bf16 a[244:247], v[104:107], v[160:163], a[244:247]
  v_mfma_f32_16x16x32_bf16 a[248:251], v[104:107], v[164:167], a[248:251]
  v_mfma_f32_16x16x32_bf16 a[252:255], v[104:107], v[168:171], a[252:255]
  s_waitcnt lgkmcnt(0)
  v_mfma_f32_16x16x32_bf16 a[0:3], v[44:47], v[108:111], a[0:3]
  ds_read_b128 v[76:79], v21 offset:0
  v_mfma_f32_16x16x32_bf16 a[4:7], v[44:47], v[112:115], a[4:7]
  v_mfma_f32_16x16x32_bf16 a[8:11], v[44:47], v[116:119], a[8:11]
  ds_read_b64_tr_b16 v[140:141], v30 offset:49152
  v_mfma_f32_16x16x32_bf16 a[12:15], v[44:47], v[120:123], a[12:15]
  v_mfma_f32_16x16x32_bf16 a[16:19], v[44:47], v[124:127], a[16:19]
  ds_read_b64_tr_b16 v[142:143], v30 offset:51200
  v_mfma_f32_16x16x32_bf16 a[20:23], v[44:47], v[128:131], a[20:23]
  v_mfma_f32_16x16x32_bf16 a[24:27], v[44:47], v[132:135], a[24:27]
  ds_read_b128 v[80:83], v21 offset:2048
  v_mfma_f32_16x16x32_bf16 a[28:31], v[44:47], v[136:139], a[28:31]
  v_mfma_f32_16x16x32_bf16 a[32:35], v[48:51], v[108:111], a[32:35]
  ds_read_b64_tr_b16 v[144:145], v31 offset:49152
  v_mfma_f32_16x16x32_bf16 a[36:39], v[48:51], v[112:115], a[36:39]
  v_mfma_f32_16x16x32_bf16 a[40:43], v[48:51], v[116:119], a[40:43]
  ds_read_b64_tr_b16 v[146:147], v31 offset:51200
  v_mfma_f32_16x16x32_bf16 a[44:47], v[48:51], v[120:123], a[44:47]
  v_mfma_f32_16x16x32_bf16 a[48:51], v[48:51], v[124:127], a[48:51]
  ds_read_b128 v[84:87], v21 offset:4096
  v_mfma_f32_16x16x32_bf16 a[52:55], v[48:51], v[128:131], a[52:55]
  v_mfma_f32_16x16x32_bf16 a[56:59], v[48:51], v[132:135], a[56:59]
  ds_read_b64_tr_b16 v[148:149], v32 offset:49152
  v_mfma_f32_16x16x32_bf16 a[60:63], v[48:51], v[136:139], a[60:63]
  v_mfma_f32_16x16x32_bf16 a[64:67], v[52:55], v[108:111], a[64:67]
  ds_read_b64_tr_b16 v[150:151], v32 offset:51200
  v_mfma_f32_16x16x32_bf16 a[68:71], v[52:55], v[112:115], a[68:71]
  v_mfma_f32_16x16x32_bf16 a[72:75], v[52:55], v[116:119], a[72:75]
  ds_read_b128 v[88:91], v21 offset:6144
  v_mfma_f32_16x16x32_bf16 a[76:79], v[52:55], v[120:123], a[76:79]
  v_mfma_f32_16x16x32_bf16 a[80:83], v[52:55], v[124:127], a[80:83]
  ds_read_b64_tr_b16 v[152:153], v33 offset:49152
  v_mfma_f32_16x16x32_bf16 a[84:87], v[52:55], v[128:131], a[84:87]
  v_mfma_f32_16x16x32_bf16 a[88:91], v[52:55], v[132:135], a[88:91]
  ds_read_b64_tr_b16 v[154:155], v33 offset:51200
  v_mfma_f32_16x16x32_bf16 a[92:95], v[52:55], v[136:139], a[92:95]
  v_mfma_f32_16x16x32_bf16 a[96:99], v[56:59], v[108:111], a[96:99]
  ds_read_b128 v[92:95], v21 offset:8192
  v_mfma_f32_16x16x32_bf16 a[100:103], v[56:59], v[112:115], a[100:103]
  v_mfma_f32_16x16x32_bf16 a[104:107], v[56:59], v[116:119], a[104:107]
  ds_read_b64_tr_b16 v[156:157], v34 offset:49152
  v_mfma_f32_16x16x32_bf16 a[108:111], v[56:59], v[120:123], a[108:111]
  v_mfma_f32_16x16x32_bf16 a[112:115], v[56:59], v[124:127], a[112:115]
  ds_read_b64_tr_b16 v[158:159], v34 offset:51200
  v_mfma_f32_16x16x32_bf16 a[116:119], v[56:59], v[128:131], a[116:119]
  v_mfma_f32_16x16x32_bf16 a[120:123], v[56:59], v[132:135], a[120:123]
  ds_read_b128 v[96:99], v21 offset:10240
  v_mfma_f32_16x16x32_bf16 a[124:127], v[56:59], v[136:139], a[124:127]
  v_mfma_f32_16x16x32_bf16 a[128:131], v[60:63], v[108:111], a[128:131]
  ds_read_b64_tr_b16 v[160:161], v35 offset:49152
  v_mfma_f32_16x16x32_bf16 a[132:135], v[60:63], v[112:115], a[132:135]
  v_mfma_f32_16x16x32_bf16 a[136:139], v[60:63], v[116:119], a[136:139]
  ds_read_b64_tr_b16 v[162:163], v35 offset:51200
  v_mfma_f32_16x16x32_bf16 a[140:143], v[60:63], v[120:123], a[140:143]
  v_mfma_f32_16x16x32_bf16 a[144:147], v[60:63], v[124:127], a[144:147]
  ds_read_b128 v[100:103], v21 offset:12288
  v_mfma_f32_16x16x32_bf16 a[148:151], v[60:63], v[128:131], a[148:151]
  v_mfma_f32_16x16x32_bf16 a[152:155], v[60:63], v[132:135], a[152:155]
  ds_read_b64_tr_b16 v[164:165], v36 offset:49152
  v_mfma_f32_16x16x32_bf16 a[156:159], v[60:63], v[136:139], a[156:159]
  v_mfma_f32_16x16x32_bf16 a[160:163], v[64:67], v[108:111], a[160:163]
  ds_read_b64_tr_b16 v[166:167], v36 offset:51200
  v_mfma_f32_16x16x32_bf16 a[164:167], v[64:67], v[112:115], a[164:167]
  v_mfma_f32_16x16x32_bf16 a[168:171], v[64:67], v[116:119], a[168:171]
  ds_read_b128 v[104:107], v21 offset:14336
  v_mfma_f32_16x16x32_bf16 a[172:175], v[64:67], v[120:123], a[172:175]
  v_mfma_f32_16x16x32_bf16 a[176:179], v[64:67], v[124:127], a[176:179]
  ds_read_b64_tr_b16 v[168:169], v37 offset:49152
  v_mfma_f32_16x16x32_bf16 a[180:183], v[64:67], v[128:131], a[180:183]
  v_mfma_f32_16x16x32_bf16 a[184:187], v[64:67], v[132:135], a[184:187]
  ds_read_b64_tr_b16 v[170:171], v37 offset:51200
  v_mfma_f32_16x16x32_bf16 a[188:191], v[64:67], v[136:139], a[188:191]
  v_mfma_f32_16x16x32_bf16 a[192:195], v[68:71], v[108:111], a[192:195]
  v_mfma_f32_16x16x32_bf16 a[196:199], v[68:71], v[112:115], a[196:199]
  v_mfma_f32_16x16x32_bf16 a[200:203], v[68:71], v[116:119], a[200:203]
  v_mfma_f32_16x16x32_bf16 a[204:207], v[68:71], v[120:123], a[204:207]
  v_mfma_f32_16x16x32_bf16 a[208:211], v[68:71], v[124:127], a[208:211]
  v_mfma_f32_16x16x32_bf16 a[212:215], v[68:71], v[128:131], a[212:215]
  v_mfma_f32_16x16x32_bf16 a[216:219], v[68:71], v[132:135], a[216:219]
  v_mfma_f32_16x16x32_bf16 a[220:223], v[68:71], v[136:139], a[220:223]
  v_mfma_f32_16x16x32_bf16 a[224:227], v[72:75], v[108:111], a[224:227]
  v_mfma_f32_16x16x32_bf16 a[228:231], v[72:75], v[112:115], a[228:231]
  v_mfma_f32_16x16x32_bf16 a[232:235], v[72:75], v[116:119], a[232:235]
  v_mfma_f32_16x16x32_bf16 a[236:239], v[72:75], v[120:123], a[236:239]
  v_mfma_f32_16x16x32_bf16 a[240:243], v[72:75], v[124:127], a[240:243]
  v_mfma_f32_16x16x32_bf16 a[244:247], v[72:75], v[128:131], a[244:247]
  v_mfma_f32_16x16x32_bf16 a[248:251], v[72:75], v[132:135], a[248:251]
  v_mfma_f32_16x16x32_bf16 a[252:255], v[72:75], v[136:139], a[252:255]
  s_waitcnt lgkmcnt(0)
  v_mfma_f32_16x16x32_bf16 a[0:3], v[76:79], v[140:143], a[0:3]
  s_waitcnt vmcnt(0)
  s_barrier
  s_cmp_eq_u32 s49, 0
  s_cbranch_scc1 L_hs_46
  s_cmp_lg_u32 s32, 0
  s_cbranch_scc1 L_sig_47
  v_mov_b32 v254, s63
  v_mov_b32 v255, 0
  v_and_b32 v254, 3, v254
  v_mbcnt_lo_u32_b32 v255, -1, 0
  v_lshlrev_b32 v255, 9, v255
  s_cmp_ge_u32 s63, 2
  s_cselect_b64 exec, 3, 1
  buffer_atomic_add v254, v255, s[4:7], s62 offen offset:0 sc1
  s_mov_b64 exec, -1
L_sig_47:
L_hs_46:
  s_add_u32 m0, s52, 65536
  v_mfma_f32_16x16x32_bf16 a[4:7], v[76:79], v[144:147], a[4:7]
  buffer_load_dwordx4 v2, s[8:11], s20 offen  lds
  ds_read_b128 v[44:47], v18 offset:0
  v_mfma_f32_16x16x32_bf16 a[8:11], v[76:79], v[148:151], a[8:11]
  v_mfma_f32_16x16x32_bf16 a[12:15], v[76:79], v[152:155], a[12:15]
  ds_read_b64_tr_b16 v[108:109], v22 offset:32768
  s_add_u32 m0, s53, 65536
  v_mfma_f32_16x16x32_bf16 a[16:19], v[76:79], v[156:159], a[16:19]
  buffer_load_dwordx4 v10, s[12:15], s21 offen  lds
  v_mfma_f32_16x16x32_bf16 a[20:23], v[76:79], v[160:163], a[20:23]
  ds_read_b64_tr_b16 v[110:111], v22 offset:34816
  v_mfma_f32_16x16x32_bf16 a[24:27], v[76:79], v[164:167], a[24:27]
  v_mfma_f32_16x16x32_bf16 a[28:31], v[76:79], v[168:171], a[28:31]
  ds_read_b128 v[48:51], v18 offset:2048
  s_add_u32 m0, s52, 66560
  v_mfma_f32_16x16x32_bf16 a[32:35], v[80:83], v[140:143], a[32:35]
  buffer_load_dwordx4 v3, s[8:11], s20 offen  lds
  v_mfma_f32_16x16x32_bf16 a[36:39], v[80:83], v[144:147], a[36:39]
  ds_read_b64_tr_b16 v[112:113], v23 offset:32768
  v_mfma_f32_16x16x32_bf16 a[40:43], v[80:83], v[148:151], a[40:43]
  v_mfma_f32_16x16x32_bf16 a[44:47], v[80:83], v[152:155], a[44:47]
  ds_read_b64_tr_b16 v[114:115], v23 offset:34816
  s_add_u32 m0, s53, 66560
  v_mfma_f32_16x16x32_bf16 a[48:51], v[80:83], v[156:159], a[48:51]
  buffer_load_dwordx4 v11, s[12:15], s21 offen  lds
  v_mfma_f32_16x16x32_bf16 a[52:55], v[80:83], v[160:163], a[52:55]
  ds_read_b128 v[52:55], v18 offset:4096
  v_mfma_f32_16x16x32_bf16 a[56:59], v[80:83], v[164:167], a[56:59]
  s_add_u32 m0, s52, 67584
  v_mfma_f32_16x16x32_bf16 a[60:63], v[80:83], v[168:171], a[60:63]
  buffer_load_dwordx4 v4, s[8:11], s20 offen  lds
  ds_read_b64_tr_b16 v[116:117], v24 offset:32768
  v_mfma_f32_16x16x32_bf16 a[64:67], v[84:87], v[140:143], a[64:67]
  v_mfma_f32_16x16x32_bf16 a[68:71], v[84:87], v[144:147], a[68:71]
  ds_read_b64_tr_b16 v[118:119], v24 offset:34816
  v_mfma_f32_16x16x32_bf16 a[72:75], v[84:87], v[148:151], a[72:75]
  s_add_u32 m0, s53, 67584
  v_mfma_f32_16x16x32_bf16 a[76:79], v[84:87], v[152:155], a[76:79]
  buffer_load_dwordx4 v12, s[12:15], s21 offen  lds
  ds_read_b128 v[56:59], v18 offset:6144
  v_mfma_f32_16x16x32_bf16 a[80:83], v[84:87], v[156:159], a[80:83]
  v_mfma_f32_16x16x32_bf16 a[84:87], v[84:87], v[160:163], a[84:87]
  ds_read_b64_tr_b16 v[120:121], v25 offset:32768
  v_mfma_f32_16x16x32_bf16 a[88:91], v[84:87], v[164:167], a[88:91]
  s_add_u32 m0, s52, 68608
  v_mfma_f32_16x16x32_bf16 a[92:95], v[84:87], v[168:171], a[92:95]
  buffer_load_dwordx4 v5, s[8:11], s20 offen  lds
  ds_read_b64_tr_b16 v[122:123], v25 offset:34816
  v_mfma_f32_16x16x32_bf16 a[96:99], v[88:91], v[140:143], a[96:99]
  v_mfma_f32_16x16x32_bf16 a[100:103], v[88:91], v[144:147], a[100:103]
  ds_read_b128 v[60:63], v18 offset:8192
  s_add_u32 m0, s53, 68608
  v_mfma_f32_16x16x32_bf16 a[104:107], v[88:91], v[148:151], a[104:107]
  buffer_load_dwordx4 v13, s[12:15], s21 offen  lds
  v_mfma_f32_16x16x32_bf16 a[108:111], v[88:91], v[152:155], a[108:111]
  ds_read_b64_tr_b16 v[124:125], v26 offset:32768
  v_mfma_f32_16x16x32_bf16 a[112:115], v[88:91], v[156:159], a[112:115]
  v_mfma_f32_16x16x32_bf16 a[116:119], v[88:91], v[160:163], a[116:119]
  ds_read_b64_tr_b16 v[126:127], v26 offset:34816
  s_add_u32 m0, s52, 69632
  v_mfma_f32_16x16x32_bf16 a[120:123], v[88:91], v[164:167], a[120:123]
  buffer_load_dwordx4 v6, s[8:11], s20 offen  lds
  v_mfma_f32_16x16x32_bf16 a[124:127], v[88:91], v[168:171], a[124:127]
  ds_read_b128 v[64:67], v18 offset:10240
  v_mfma_f32_16x16x32_bf16 a[128:131], v[92:95], v[140:143], a[128:131]
  v_mfma_f32_16x16x32_bf16 a[132:135], v[92:95], v[144:147], a[132:135]
  ds_read_b64_tr_b16 v[128:129], v27 offset:32768
  s_add_u32 m0, s53, 69632
  v_mfma_f32_16x16x32_bf16 a[136:139], v[92:95], v[148:151], a[136:139]
  buffer_load_dwordx4 v14, s[12:15], s21 offen  lds
  v_mfma_f32_16x16x32_bf16 a[140:143], v[92:95], v[152:155], a[140:143]
  ds_read_b64_tr_b16 v[130:131], v27 offset:34816
  v_mfma_f32_16x16x32_bf16 a[144:147], v[92:95], v[156:159], a[144:147]
  v_mfma_f32_16x16x32_bf16 a[148:151], v[92:95], v[160:163], a[148:151]
  ds_read_b128 v[68:71], v18 offset:12288
  s_add_u32 m0, s52, 70656
  v_mfma_f32_16x16x32_bf16 a[152:155], v[92:95], v[164:167], a[152:155]
  buffer_load_dwordx4 v7, s[8:11], s20 offen  lds
  v_mfma_f32_16x16x32_bf16 a[156:159], v[92:95], v[168:171], a[156:159]
  ds_read_b64_tr_b16 v[132:133], v28 offset:32768
  v_mfma_f32_16x16x32_bf16 a[160:163], v[96:99], v[140:143], a[160:163]
  s_add_u32 m0, s53, 70656
  v_mfma_f32_16x16x32_bf16 a[164:167], v[96:99], v[144:147], a[164:167]
  buffer_load_dwordx4 v15, s[12:15], s21 offen  lds
  ds_read_b64_tr_b16 v[134:135], v28 offset:34816
  v_mfma_f32_16x16x32_bf16 a[168:171], v[96:99], v[148:151], a[168:171]
  v_mfma_f32_16x16x32_bf16 a[172:175], v[96:99], v[152:155], a[172:175]
  ds_read_b128 v[72:75], v18 offset:14336
  v_mfma_f32_16x16x32_bf16 a[176:179], v[96:99], v[156:159], a[176:179]
  s_add_u32 m0, s52, 71680
  v_mfma_f32_16x16x32_bf16 a[180:183], v[96:99], v[160:163], a[180:183]
  buffer_load_dwordx4 v8, s[8:11], s20 offen  lds
  ds_read_b64_tr_b16 v[136:137], v29 offset:32768
  v_mfma_f32_16x16x32_bf16 a[184:187], v[96:99], v[164:167], a[184:187]
  v_mfma_f32_16x16x32_bf16 a[188:191], v[96:99], v[168:171], a[188:191]
  ds_read_b64_tr_b16 v[138:139], v29 offset:34816
  v_mfma_f32_16x16x32_bf16 a[192:195], v[100:103], v[140:143], a[192:195]
  s_add_u32 m0, s53, 71680
  v_mfma_f32_16x16x32_bf16 a[196:199], v[100:103], v[144:147], a[196:199]
  buffer_load_dwordx4 v16, s[12:15], s21 offen  lds
  v_mfma_f32_16x16x32_bf16 a[200:203], v[100:103], v[148:151], a[200:203]
  v_mfma_f32_16x16x32_bf16 a[204:207], v[100:103], v[152:155], a[204:207]
  s_add_u32 m0, s52, 72704
  v_mfma_f32_16x16x32_bf16 a[208:211], v[100:103], v[156:159], a[208:211]
  buffer_load_dwordx4 v9, s[8:11], s20 offen  lds
  v_mfma_f32_16x16x32_bf16 a[212:215], v[100:103], v[160:163], a[212:215]
  v_mfma_f32_16x16x32_bf16 a[216:219], v[100:103], v[164:167], a[216:219]
  v_mfma_f32_16x16x32_bf16 a[220:223], v[100:103], v[168:171], a[220:223]
  s_add_u32 m0, s53, 72704
  v_mfma_f32_16x16x32_bf16 a[224:227], v[104:107], v[140:143], a[224:227]
  buffer_load_dwordx4 v17, s[12:15], s21 offen  lds
  v_mfma_f32_16x16x32_bf16 a[228:231], v[104:107], v[144:147], a[228:231]
  v_mfma_f32_16x16x32_bf16 a[232:235], v[104:107], v[148:151], a[232:235]
  v_mfma_f32_16x16x32_bf16 a[236:239], v[104:107], v[152:155], a[236:239]
  s_add_u32 s20, s20, 128
  v_mfma_f32_16x16x32_bf16 a[240:243], v[104:107], v[156:159], a[240:243]
  s_add_u32 s21, s21, s51
  v_mfma_f32_16x16x32_bf16 a[244:247], v[104:107], v[160:163], a[244:247]
  v_mfma_f32_16x16x32_bf16 a[248:251], v[104:107], v[164:167], a[248:251]
  v_mfma_f32_16x16x32_bf16 a[252:255], v[104:107], v[168:171], a[252:255]
L_g2_loop:
  s_sub_u32 s25, s25, 1
  s_cmp_eq_u32 s25, 0
  s_cbranch_scc1 L_g2_fin
  s_waitcnt lgkmcnt(0)
  v_mfma_f32_16x16x32_bf16 a[0:3], v[44:47], v[108:111], a[0:3]
  ds_read_b128 v[76:79], v19 offset:0
  v_mfma_f32_16x16x32_bf16 a[4:7], v[44:47], v[112:115], a[4:7]
  v_mfma_f32_16x16x32_bf16 a[8:11], v[44:47], v[116:119], a[8:11]
  ds_read_b64_tr_b16 v[140:141], v22 offset:49152
  v_mfma_f32_16x16x32_bf16 a[12:15], v[44:47], v[120:123], a[12:15]
  v_mfma_f32_16x16x32_bf16 a[16:19], v[44:47], v[124:127], a[16:19]
  ds_read_b64_tr_b16 v[142:143], v22 offset:51200
  v_mfma_f32_16x16x32_bf16 a[20:23], v[44:47], v[128:131], a[20:23]
  v_mfma_f32_16x16x32_bf16 a[24:27], v[44:47], v[132:135], a[24:27]
  ds_read_b128 v[80:83], v19 offset:2048
  v_mfma_f32_16x16x32_bf16 a[28:31], v[44:47], v[136:139], a[28:31]
  v_mfma_f32_16x16x32_bf16 a[32:35], v[48:51], v[108:111], a[32:35]
  ds_read_b64_tr_b16 v[144:145], v23 offset:49152
  v_mfma_f32_16x16x32_bf16 a[36:39], v[48:51], v[112:115], a[36:39]
  v_mfma_f32_16x16x32_bf16 a[40:43], v[48:51], v[116:119], a[40:43]
  ds_read_b64_tr_b16 v[146:147], v23 offset:51200
  v_mfma_f32_16x16x32_bf16 a[44:47], v[48:51], v[120:123], a[44:47]
  v_mfma_f32_16x16x32_bf16 a[48:51], v[48:51], v[124:127], a[48:51]
  ds_read_b128 v[84:87], v19 offset:4096
  v_mfma_f32_16x16x32_bf16 a[52:55], v[48:51], v[128:131], a[52:55]
  v_mfma_f32_16x16x32_bf16 a[56:59], v[48:51], v[132:135], a[56:59]
  ds_read_b64_tr_b16 v[148:149], v24 offset:49152
  v_mfma_f32_16x16x32_bf16 a[60:63], v[48:51], v[136:139], a[60:63]
  v_mfma_f32_16x16x32_bf16 a[64:67], v[52:55], v[108:111], a[64:67]
  ds_read_b64_tr_b16 v[150:151], v24 offset:51200
  v_mfma_f32_16x16x32_bf16 a[68:71], v[52:55], v[112:115], a[68:71]
  v_mfma_f32_16x16x32_bf16 a[72:75], v[52:55], v[116:119], a[72:75]
  ds_read_b128 v[88:91], v19 offset:6144
  v_mfma_f32_16x16x32_bf16 a[76:79], v[52:55], v[120:123], a[76:79]
  v_mfma_f32_16x16x32_bf16 a[80:83], v[52:55], v[124:127], a[80:83]
  ds_read_b64_tr_b16 v[152:153], v25 offset:49152
  v_mfma_f32_16x16x32_bf16 a[84:87], v[52:55], v[128:131], a[84:87]
  v_mfma_f32_16x16x32_bf16 a[88:91], v[52:55], v[132:135], a[88:91]
  ds_read_b64_tr_b16 v[154:155], v25 offset:51200
  v_mfma_f32_16x16x32_bf16 a[92:95], v[52:55], v[136:139], a[92:95]
  v_mfma_f32_16x16x32_bf16 a[96:99], v[56:59], v[108:111], a[96:99]
  ds_read_b128 v[92:95], v19 offset:8192
  v_mfma_f32_16x16x32_bf16 a[100:103], v[56:59], v[112:115], a[100:103]
  v_mfma_f32_16x16x32_bf16 a[104:107], v[56:59], v[116:119], a[104:107]
  ds_read_b64_tr_b16 v[156:157], v26 offset:49152
  v_mfma_f32_16x16x32_bf16 a[108:111], v[56:59], v[120:123], a[108:111]
  v_mfma_f32_16x16x32_bf16 a[112:115], v[56:59], v[124:127], a[112:115]
  ds_read_b64_tr_b16 v[158:159], v26 offset:51200
  v_mfma_f32_16x16x32_bf16 a[116:119], v[56:59], v[128:131], a[116:119]
  v_mfma_f32_16x16x32_bf16 a[120:123], v[56:59], v[132:135], a[120:123]
  ds_read_b128 v[96:99], v19 offset:10240
  v_mfma_f32_16x16x32_bf16 a[124:127], v[56:59], v[136:139], a[124:127]
  v_mfma_f32_16x16x32_bf16 a[128:131], v[60:63], v[108:111], a[128:131]
  ds_read_b64_tr_b16 v[160:161], v27 offset:49152
  v_mfma_f32_16x16x32_bf16 a[132:135], v[60:63], v[112:115], a[132:135]
  v_mfma_f32_16x16x32_bf16 a[136:139], v[60:63], v[116:119], a[136:139]
  ds_read_b64_tr_b16 v[162:163], v27 offset:51200
  v_mfma_f32_16x16x32_bf16 a[140:143], v[60:63], v[120:123], a[140:143]
  v_mfma_f32_16x16x32_bf16 a[144:147], v[60:63], v[124:127], a[144:147]
  ds_read_b128 v[100:103], v19 offset:12288
  v_mfma_f32_16x16x32_bf16 a[148:151], v[60:63], v[128:131], a[148:151]
  v_mfma_f32_16x16x32_bf16 a[152:155], v[60:63], v[132:135], a[152:155]
  ds_read_b64_tr_b16 v[164:165], v28 offset:49152
  v_mfma_f32_16x16x32_bf16 a[156:159], v[60:63], v[136:139], a[156:159]
  v_mfma_f32_16x16x32_bf16 a[160:163], v[64:67], v[108:111], a[160:163]
  ds_read_b64_tr_b16 v[166:167], v28 offset:51200
  v_mfma_f32_16x16x32_bf16 a[164:167], v[64:67], v[112:115], a[164:167]
  v_mfma_f32_16x16x32_bf16 a[168:171], v[64:67], v[116:119], a[168:171]
  ds_read_b128 v[104:107], v19 offset:14336
  v_mfma_f32_16x16x32_bf16 a[172:175], v[64:67], v[120:123], a[172:175]
  v_mfma_f32_16x16x32_bf16 a[176:179], v[64:67], v[124:127], a[176:179]
  ds_read_b64_tr_b16 v[168:169], v29 offset:49152
  v_mfma_f32_16x16x32_bf16 a[180:183], v[64:67], v[128:131], a[180:183]
  v_mfma_f32_16x16x32_bf16 a[184:187], v[64:67], v[132:135], a[184:187]
  ds_read_b64_tr_b16 v[170:171], v29 offset:51200
  v_mfma_f32_16x16x32_bf16 a[188:191], v[64:67], v[136:139], a[188:191]
  v_mfma_f32_16x16x32_bf16 a[192:195], v[68:71], v[108:111], a[192:195]
  v_mfma_f32_16x16x32_bf16 a[196:199], v[68:71], v[112:115], a[196:199]
  v_mfma_f32_16x16x32_bf16 a[200:203], v[68:71], v[116:119], a[200:203]
  v_mfma_f32_16x16x32_bf16 a[204:207], v[68:71], v[120:123], a[204:207]
  v_mfma_f32_16x16x32_bf16 a[208:211], v[68:71], v[124:127], a[208:211]
  v_mfma_f32_16x16x32_bf16 a[212:215], v[68:71], v[128:131], a[212:215]
  v_mfma_f32_16x16x32_bf16 a[216:219], v[68:71], v[132:135], a[216:219]
  v_mfma_f32_16x16x32_bf16 a[220:223], v[68:71], v[136:139], a[220:223]
  v_mfma_f32_16x16x32_bf16 a[224:227], v[72:75], v[108:111], a[224:227]
  v_mfma_f32_16x16x32_bf16 a[228:231], v[72:75], v[112:115], a[228:231]
  v_mfma_f32_16x16x32_bf16 a[232:235], v[72:75], v[116:119], a[232:235]
  v_mfma_f32_16x16x32_bf16 a[236:239], v[72:75], v[120:123], a[236:239]
  v_mfma_f32_16x16x32_bf16 a[240:243], v[72:75], v[124:127], a[240:243]
  v_mfma_f32_16x16x32_bf16 a[244:247], v[72:75], v[128:131], a[244:247]
  v_mfma_f32_16x16x32_bf16 a[248:251], v[72:75], v[132:135], a[248:251]
  v_mfma_f32_16x16x32_bf16 a[252:255], v[72:75], v[136:139], a[252:255]
  s_waitcnt lgkmcnt(0)
  v_mfma_f32_16x16x32_bf16 a[0:3], v[76:79], v[140:143], a[0:3]
  s_waitcnt vmcnt(0)
  s_barrier
  s_add_u32 m0, s52, 0
  v_mfma_f32_16x16x32_bf16 a[4:7], v[76:79], v[144:147], a[4:7]
  buffer_load_dwordx4 v2, s[8:11], s20 offen  lds
  ds_read_b128 v[44:47], v20 offset:0
  v_mfma_f32_16x16x32_bf16 a[8:11], v[76:79], v[148:151], a[8:11]
  v_mfma_f32_16x16x32_bf16 a[12:15], v[76:79], v[152:155], a[12:15]
  ds_read_b64_tr_b16 v[108:109], v30 offset:32768
  s_add_u32 m0, s53, 0
  v_mfma_f32_16x16x32_bf16 a[16:19], v[76:79], v[156:159], a[16:19]
  buffer_load_dwordx4 v10, s[12:15], s21 offen  lds
  v_mfma_f32_16x16x32_bf16 a[20:23], v[76:79], v[160:163], a[20:23]
  ds_read_b64_tr_b16 v[110:111], v30 offset:34816
  v_mfma_f32_16x16x32_bf16 a[24:27], v[76:79], v[164:167], a[24:27]
  v_mfma_f32_16x16x32_bf16 a[28:31], v[76:79], v[168:171], a[28:31]
  ds_read_b128 v[48:51], v20 offset:2048
  s_add_u32 m0, s52, 1024
  v_mfma_f32_16x16x32_bf16 a[32:35], v[80:83], v[140:143], a[32:35]
  buffer_load_dwordx4 v3, s[8:11], s20 offen  lds
  v_mfma_f32_16x16x32_bf16 a[36:39], v[80:83], v[144:147], a[36:39]
  ds_read_b64_tr_b16 v[112:113], v31 offset:32768
  v_mfma_f32_16x16x32_bf16 a[40:43], v[80:83], v[148:151], a[40:43]
  v_mfma_f32_16x16x32_bf16 a[44:47], v[80:83], v[152:155], a[44:47]
  ds_read_b64_tr_b16 v[114:115], v31 offset:34816
  s_add_u32 m0, s53, 1024
  v_mfma_f32_16x16x32_bf16 a[48:51], v[80:83], v[156:159], a[48:51]
  buffer_load_dwordx4 v11, s[12:15], s21 offen  lds
  v_mfma_f32_16x16x32_bf16 a[52:55], v[80:83], v[160:163], a[52:55]
  ds_read_b128 v[52:55], v20 offset:4096
  v_mfma_f32_16x16x32_bf16 a[56:59], v[80:83], v[164:167], a[56:59]
  s_add_u32 m0, s52, 2048
  v_mfma_f32_16x16x32_bf16 a[60:63], v[80:83], v[168:171], a[60:63]
  buffer_load_dwordx4 v4, s[8:11], s20 offen  lds
  ds_read_b64_tr_b16 v[116:117], v32 offset:32768
  v_mfma_f32_16x16x32_bf16 a[64:67], v[84:87], v[140:143], a[64:67]
  v_mfma_f32_16x16x32_bf16 a[68:71], v[84:87], v[144:147], a[68:71]
  ds_read_b64_tr_b16 v[118:119], v32 offset:34816
  v_mfma_f32_16x16x32_bf16 a[72:75], v[84:87], v[148:151], a[72:75]
  s_add_u32 m0, s53, 2048
  v_mfma_f32_16x16x32_bf16 a[76:79], v[84:87], v[152:155], a[76:79]
  buffer_load_dwordx4 v12, s[12:15], s21 offen  lds
  ds_read_b128 v[56:59], v20 offset:6144
  v_mfma_f32_16x16x32_bf16 a[80:83], v[84:87], v[156:159], a[80:83]
  v_mfma_f32_16x16x32_bf16 a[84:87], v[84:87], v[160:163], a[84:87]
  ds_read_b64_tr_b16 v[120:121], v33 offset:32768
  v_mfma_f32_16x16x32_bf16 a[88:91], v[84:87], v[164:167], a[88:91]
  s_add_u32 m0, s52, 3072
  v_mfma_f32_16x16x32_bf16 a[92:95], v[84:87], v[168:171], a[92:95]
  buffer_load_dwordx4 v5, s[8:11], s20 offen  lds
  ds_read_b64_tr_b16 v[122:123], v33 offset:34816
  v_mfma_f32_16x16x32_bf16 a[96:99], v[88:91], v[140:143], a[96:99]
  v_mfma_f32_16x16x32_bf16 a[100:103], v[88:91], v[144:147], a[100:103]
  ds_read_b128 v[60:63], v20 offset:8192
  s_add_u32 m0, s53, 3072
  v_mfma_f32_16x16x32_bf16 a[104:107], v[88:91], v[148:151], a[104:107]
  buffer_load_dwordx4 v13, s[12:15], s21 offen  lds
  v_mfma_f32_16x16x32_bf16 a[108:111], v[88:91], v[152:155], a[108:111]
  ds_read_b64_tr_b16 v[124:125], v34 offset:32768
  v_mfma_f32_16x16x32_bf16 a[112:115], v[88:91], v[156:159], a[112:115]
  v_mfma_f32_16x16x32_bf16 a[116:119], v[88:91], v[160:163], a[116:119]
  ds_read_b64_tr_b16 v[126:127], v34 offset:34816
  s_add_u32 m0, s52, 4096
  v_mfma_f32_16x16x32_bf16 a[120:123], v[88:91], v[164:167], a[120:123]
  buffer_load_dwordx4 v6, s[8:11], s20 offen  lds
  v_mfma_f32_16x16x32_bf16 a[124:127], v[88:91], v[168:171], a[124:127]
  ds_read_b128 v[64:67], v20 offset:10240
  v_mfma_f32_16x16x32_bf16 a[128:131], v[92:95], v[140:143], a[128:131]
  v_mfma_f32_16x16x32_bf16 a[132:135], v[92:95], v[144:147], a[132:135]
  ds_read_b64_tr_b16 v[128:129], v35 offset:32768
  s_add_u32 m0, s53, 4096
  v_mfma_f32_16x16x32_bf16 a[136:139], v[92:95], v[148:151], a[136:139]
  buffer_load_dwordx4 v14, s[12:15], s21 offen  lds
  v_mfma_f32_16x16x32_bf16 a[140:143], v[92:95], v[152:155], a[140:143]
  ds_read_b64_tr_b16 v[130:131], v35 offset:34816
  v_mfma_f32_16x16x32_bf16 a[144:147], v[92:95], v[156:159], a[144:147]
  v_mfma_f32_16x16x32_bf16 a[148:151], v[92:95], v[160:163], a[148:151]
  ds_read_b128 v[68:71], v20 offset:12288
  s_add_u32 m0, s52, 5120
  v_mfma_f32_16x16x32_bf16 a[152:155], v[92:95], v[164:167], a[152:155]
  buffer_load_dwordx4 v7, s[8:11], s20 offen  lds
  v_mfma_f32_16x16x32_bf16 a[156:159], v[92:95], v[168:171], a[156:159]
  ds_read_b64_tr_b16 v[132:133], v36 offset:32768
  v_mfma_f32_16x16x32_bf16 a[160:163], v[96:99], v[140:143], a[160:163]
  s_add_u32 m0, s53, 5120
  v_mfma_f32_16x16x32_bf16 a[164:167], v[96:99], v[144:147], a[164:167]
  buffer_load_dwordx4 v15, s[12:15], s21 offen  lds
  ds_read_b64_tr_b16 v[134:135], v36 offset:34816
  v_mfma_f32_16x16x32_bf16 a[168:171], v[96:99], v[148:151], a[168:171]
  v_mfma_f32_16x16x32_bf16 a[172:175], v[96:99], v[152:155], a[172:175]
  ds_read_b128 v[72:75], v20 offset:14336
  v_mfma_f32_16x16x32_bf16 a[176:179], v[96:99], v[156:159], a[176:179]
  s_add_u32 m0, s52, 6144
  v_mfma_f32_16x16x32_bf16 a[180:183], v[96:99], v[160:163], a[180:183]
  buffer_load_dwordx4 v8, s[8:11], s20 offen  lds
  ds_read_b64_tr_b16 v[136:137], v37 offset:32768
  v_mfma_f32_16x16x32_bf16 a[184:187], v[96:99], v[164:167], a[184:187]
  v_mfma_f32_16x16x32_bf16 a[188:191], v[96:99], v[168:171], a[188:191]
  ds_read_b64_tr_b16 v[138:139], v37 offset:34816
  v_mfma_f32_16x16x32_bf16 a[192:195], v[100:103], v[140:143], a[192:195]
  s_add_u32 m0, s53, 6144
  v_mfma_f32_16x16x32_bf16 a[196:199], v[100:103], v[144:147], a[196:199]
  buffer_load_dwordx4 v16, s[12:15], s21 offen  lds
  v_mfma_f32_16x16x32_bf16 a[200:203], v[100:103], v[148:151], a[200:203]
  v_mfma_f32_16x16x32_bf16 a[204:207], v[100:103], v[152:155], a[204:207]
  s_add_u32 m0, s52, 7168
  v_mfma_f32_16x16x32_bf16 a[208:211], v[100:103], v[156:159], a[208:211]
  buffer_load_dwordx4 v9, s[8:11], s20 offen  lds
  v_mfma_f32_16x16x32_bf16 a[212:215], v[100:103], v[160:163], a[212:215]
  v_mfma_f32_16x16x32_bf16 a[216:219], v[100:103], v[164:167], a[216:219]
  v_mfma_f32_16x16x32_bf16 a[220:223], v[100:103], v[168:171], a[220:223]
  s_add_u32 m0, s53, 7168
  v_mfma_f32_16x16x32_bf16 a[224:227], v[104:107], v[140:143], a[224:227]
  buffer_load_dwordx4 v17, s[12:15], s21 offen  lds
  v_mfma_f32_16x16x32_bf16 a[228:231], v[104:107], v[144:147], a[228:231]
  v_mfma_f32_16x16x32_bf16 a[232:235], v[104:107], v[148:151], a[232:235]
  v_mfma_f32_16x16x32_bf16 a[236:239], v[104:107], v[152:155], a[236:239]
  s_add_u32 s20, s20, 128
  v_mfma_f32_16x16x32_bf16 a[240:243], v[104:107], v[156:159], a[240:243]
  s_add_u32 s21, s21, s51
  v_mfma_f32_16x16x32_bf16 a[244:247], v[104:107], v[160:163], a[244:247]
  v_mfma_f32_16x16x32_bf16 a[248:251], v[104:107], v[164:167], a[248:251]
  v_mfma_f32_16x16x32_bf16 a[252:255], v[104:107], v[168:171], a[252:255]
  s_waitcnt lgkmcnt(0)
  s_cmp_eq_u32 s25, 1
  s_cbranch_scc1 L_g2_cw
L_g2_cwb:
  v_mfma_f32_16x16x32_bf16 a[0:3], v[44:47], v[108:111], a[0:3]
  ds_read_b128 v[76:79], v21 offset:0
  v_mfma_f32_16x16x32_bf16 a[4:7], v[44:47], v[112:115], a[4:7]
  v_mfma_f32_16x16x32_bf16 a[8:11], v[44:47], v[116:119], a[8:11]
  ds_read_b64_tr_b16 v[140:141], v30 offset:49152
  v_mfma_f32_16x16x32_bf16 a[12:15], v[44:47], v[120:123], a[12:15]
  v_mfma_f32_16x16x32_bf16 a[16:19], v[44:47], v[124:127], a[16:19]
  ds_read_b64_tr_b16 v[142:143], v30 offset:51200
  v_mfma_f32_16x16x32_bf16 a[20:23], v[44:47], v[128:131], a[20:23]
  v_mfma_f32_16x16x32_bf16 a[24:27], v[44:47], v[132:135], a[24:27]
  ds_read_b128 v[80:83], v21 offset:2048
  v_mfma_f32_16x16x32_bf16 a[28:31], v[44:47], v[136:139], a[28:31]
  v_mfma_f32_16x16x32_bf16 a[32:35], v[48:51], v[108:111], a[32:35]
  ds_read_b64_tr_b16 v[144:145], v31 offset:49152
  v_mfma_f32_16x16x32_bf16 a[36:39], v[48:51], v[112:115], a[36:39]
  v_mfma_f32_16x16x32_bf16 a[40:43], v[48:51], v[116:119], a[40:43]
  ds_read_b64_tr_b16 v[146:147], v31 offset:51200
  v_mfma_f32_16x16x32_bf16 a[44:47], v[48:51], v[120:123], a[44:47]
  v_mfma_f32_16x16x32_bf16 a[48:51], v[48:51], v[124:127], a[48:51]
  ds_read_b128 v[84:87], v21 offset:4096
  v_mfma_f32_16x16x32_bf16 a[52:55], v[48:51], v[128:131], a[52:55]
  v_mfma_f32_16x16x32_bf16 a[56:59], v[48:51], v[132:135], a[56:59]
  ds_read_b64_tr_b16 v[148:149], v32 offset:49152
  v_mfma_f32_16x16x32_bf16 a[60:63], v[48:51], v[136:139], a[60:63]
  v_mfma_f32_16x16x32_bf16 a[64:67], v[52:55], v[108:111], a[64:67]
  ds_read_b64_tr_b16 v[150:151], v32 offset:51200
  v_mfma_f32_16x16x32_bf16 a[68:71], v[52:55], v[112:115], a[68:71]
  v_mfma_f32_16x16x32_bf16 a[72:75], v[52:55], v[116:119], a[72:75]
  ds_read_b128 v[88:91], v21 offset:6144
  v_mfma_f32_16x16x32_bf16 a[76:79], v[52:55], v[120:123], a[76:79]
  v_mfma_f32_16x16x32_bf16 a[80:83], v[52:55], v[124:127], a[80:83]
  ds_read_b64_tr_b16 v[152:153], v33 offset:49152
  v_mfma_f32_16x16x32_bf16 a[84:87], v[52:55], v[128:131], a[84:87]
  v_mfma_f32_16x16x32_bf16 a[88:91], v[52:55], v[132:135], a[88:91]
  ds_read_b64_tr_b16 v[154:155], v33 offset:51200
  v_mfma_f32_16x16x32_bf16 a[92:95], v[52:55], v[136:139], a[92:95]
  v_mfma_f32_16x16x32_bf16 a[96:99], v[56:59], v[108:111], a[96:99]
  ds_read_b128 v[92:95], v21 offset:8192
  v_mfma_f32_16x16x32_bf16 a[100:103], v[56:59], v[112:115], a[100:103]
  v_mfma_f32_16x16x32_bf16 a[104:107], v[56:59], v[116:119], a[104:107]
  ds_read_b64_tr_b16 v[156:157], v34 offset:49152
  v_mfma_f32_16x16x32_bf16 a[108:111], v[56:59], v[120:123], a[108:111]
  v_mfma_f32_16x16x32_bf16 a[112:115], v[56:59], v[124:127], a[112:115]
  ds_read_b64_tr_b16 v[158:159], v34 offset:51200
  v_mfma_f32_16x16x32_bf16 a[116:119], v[56:59], v[128:131], a[116:119]
  v_mfma_f32_16x16x32_bf16 a[120:123], v[56:59], v[132:135], a[120:123]
  ds_read_b128 v[96:99], v21 offset:10240
  v_mfma_f32_16x16x32_bf16 a[124:127], v[56:59], v[136:139], a[124:127]
  v_mfma_f32_16x16x32_bf16 a[128:131], v[60:63], v[108:111], a[128:131]
  ds_read_b64_tr_b16 v[160:161], v35 offset:49152
  v_mfma_f32_16x16x32_bf16 a[132:135], v[60:63], v[112:115], a[132:135]
  v_mfma_f32_16x16x32_bf16 a[136:139], v[60:63], v[116:119], a[136:139]
  ds_read_b64_tr_b16 v[162:163], v35 offset:51200
  v_mfma_f32_16x16x32_bf16 a[140:143], v[60:63], v[120:123], a[140:143]
  v_mfma_f32_16x16x32_bf16 a[144:147], v[60:63], v[124:127], a[144:147]
  ds_read_b128 v[100:103], v21 offset:12288
  v_mfma_f32_16x16x32_bf16 a[148:151], v[60:63], v[128:131], a[148:151]
  v_mfma_f32_16x16x32_bf16 a[152:155], v[60:63], v[132:135], a[152:155]
  ds_read_b64_tr_b16 v[164:165], v36 offset:49152
  v_mfma_f32_16x16x32_bf16 a[156:159], v[60:63], v[136:139], a[156:159]
  v_mfma_f32_16x16x32_bf16 a[160:163], v[64:67], v[108:111], a[160:163]
  ds_read_b64_tr_b16 v[166:167], v36 offset:51200
  v_mfma_f32_16x16x32_bf16 a[164:167], v[64:67], v[112:115], a[164:167]
  v_mfma_f32_16x16x32_bf16 a[168:171], v[64:67], v[116:119], a[168:171]
  ds_read_b128 v[104:107], v21 offset:14336
  v_mfma_f32_16x16x32_bf16 a[172:175], v[64:67], v[120:123], a[172:175]
  v_mfma_f32_16x16x32_bf16 a[176:179], v[64:67], v[124:127], a[176:179]
  ds_read_b64_tr_b16 v[168:169], v37 offset:49152
  v_mfma_f32_16x16x32_bf16 a[180:183], v[64:67], v[128:131], a[180:183]
  v_mfma_f32_16x16x32_bf16 a[184:187], v[64:67], v[132:135], a[184:187]
  ds_read_b64_tr_b16 v[170:171], v37 offset:51200
  v_mfma_f32_16x16x32_bf16 a[188:191], v[64:67], v[136:139], a[188:191]
  v_mfma_f32_16x16x32_bf16 a[192:195], v[68:71], v[108:111], a[192:195]
  v_mfma_f32_16x16x32_bf16 a[196:199], v[68:71], v[112:115], a[196:199]
  v_mfma_f32_16x16x32_bf16 a[200:203], v[68:71], v[116:119], a[200:203]
  v_mfma_f32_16x16x32_bf16 a[204:207], v[68:71], v[120:123], a[204:207]
  v_mfma_f32_16x16x32_bf16 a[208:211], v[68:71], v[124:127], a[208:211]
  v_mfma_f32_16x16x32_bf16 a[212:215], v[68:71], v[128:131], a[212:215]
  v_mfma_f32_16x16x32_bf16 a[216:219], v[68:71], v[132:135], a[216:219]
  v_mfma_f32_16x16x32_bf16 a[220:223], v[68:71], v[136:139], a[220:223]
  v_mfma_f32_16x16x32_bf16 a[224:227], v[72:75], v[108:111], a[224:227]
  v_mfma_f32_16x16x32_bf16 a[228:231], v[72:75], v[112:115], a[228:231]
  v_mfma_f32_16x16x32_bf16 a[232:235], v[72:75], v[116:119], a[232:235]
  v_mfma_f32_16x16x32_bf16 a[236:239], v[72:75], v[120:123], a[236:239]
  v_mfma_f32_16x16x32_bf16 a[240:243], v[72:75], v[124:127], a[240:243]
  v_mfma_f32_16x16x32_bf16 a[244:247], v[72:75], v[128:131], a[244:247]
  v_mfma_f32_16x16x32_bf16 a[248:251], v[72:75], v[132:135], a[248:251]
  v_mfma_f32_16x16x32_bf16 a[252:255], v[72:75], v[136:139], a[252:255]
  s_waitcnt lgkmcnt(0)
  v_mfma_f32_16x16x32_bf16 a[0:3], v[76:79], v[140:143], a[0:3]
  s_waitcnt vmcnt(0)
  s_barrier
  s_cmp_le_u32 s25, 2
  s_cbranch_scc1 L_g2_cr
L_g2_crb:
  s_add_u32 m0, s52, 65536
  v_mfma_f32_16x16x32_bf16 a[4:7], v[76:79], v[144:147], a[4:7]
  buffer_load_dwordx4 v2, s[8:11], s20 offen  lds
  ds_read_b128 v[44:47], v18 offset:0
  v_mfma_f32_16x16x32_bf16 a[8:11], v[76:79], v[148:151], a[8:11]
  v_mfma_f32_16x16x32_bf16 a[12:15], v[76:79], v[152:155], a[12:15]
  ds_read_b64_tr_b16 v[108:109], v22 offset:32768
  s_add_u32 m0, s53, 65536
  v_mfma_f32_16x16x32_bf16 a[16:19], v[76:79], v[156:159], a[16:19]
  buffer_load_dwordx4 v10, s[12:15], s21 offen  lds
  v_mfma_f32_16x16x32_bf16 a[20:23], v[76:79], v[160:163], a[20:23]
  ds_read_b64_tr_b16 v[110:111], v22 offset:34816
  v_mfma_f32_16x16x32_bf16 a[24:27], v[76:79], v[164:167], a[24:27]
  v_mfma_f32_16x16x32_bf16 a[28:31], v[76:79], v[168:171], a[28:31]
  ds_read_b128 v[48:51], v18 offset:2048
  s_add_u32 m0, s52, 66560
  v_mfma_f32_16x16x32_bf16 a[32:35], v[80:83], v[140:143], a[32:35]
  buffer_load_dwordx4 v3, s[8:11], s20 offen  lds
  v_mfma_f32_16x16x32_bf16 a[36:39], v[80:83], v[144:147], a[36:39]
  ds_read_b64_tr_b16 v[112:113], v23 offset:32768
  v_mfma_f32_16x16x32_bf16 a[40:43], v[80:83], v[148:151], a[40:43]
  v_mfma_f32_16x16x32_bf16 a[44:47], v[80:83], v[152:155], a[44:47]
  ds_read_b64_tr_b16 v[114:115], v23 offset:34816
  s_add_u32 m0, s53, 66560
  v_mfma_f32_16x16x32_bf16 a[48:51], v[80:83], v[156:159], a[48:51]
  buffer_load_dwordx4 v11, s[12:15], s21 offen  lds
  v_mfma_f32_16x16x32_bf16 a[52:55], v[80:83], v[160:163], a[52:55]
  ds_read_b128 v[52:55], v18 offset:4096
  v_mfma_f32_16x16x32_bf16 a[56:59], v[80:83], v[164:167], a[56:59]
  s_add_u32 m0, s52, 67584
  v_mfma_f32_16x16x32_bf16 a[60:63], v[80:83], v[168:171], a[60:63]
  buffer_load_dwordx4 v4, s[8:11], s20 offen  lds
  ds_read_b64_tr_b16 v[116:117], v24 offset:32768
  v_mfma_f32_16x16x32_bf16 a[64:67], v[84:87], v[140:143], a[64:67]
  v_mfma_f32_16x16x32_bf16 a[68:71], v[84:87], v[144:147], a[68:71]
  ds_read_b64_tr_b16 v[118:119], v24 offset:34816
  v_mfma_f32_16x16x32_bf16 a[72:75], v[84:87], v[148:151], a[72:75]
  s_add_u32 m0, s53, 67584
  v_mfma_f32_16x16x32_bf16 a[76:79], v[84:87], v[152:155], a[76:79]
  buffer_load_dwordx4 v12, s[12:15], s21 offen  lds
  ds_read_b128 v[56:59], v18 offset:6144
  v_mfma_f32_16x16x32_bf16 a[80:83], v[84:87], v[156:159], a[80:83]
  v_mfma_f32_16x16x32_bf16 a[84:87], v[84:87], v[160:163], a[84:87]
  ds_read_b64_tr_b16 v[120:121], v25 offset:32768
  v_mfma_f32_16x16x32_bf16 a[88:91], v[84:87], v[164:167], a[88:91]
  s_add_u32 m0, s52, 68608
  v_mfma_f32_16x16x32_bf16 a[92:95], v[84:87], v[168:171], a[92:95]
  buffer_load_dwordx4 v5, s[8:11], s20 offen  lds
  ds_read_b64_tr_b16 v[122:123], v25 offset:34816
  v_mfma_f32_16x16x32_bf16 a[96:99], v[88:91], v[140:143], a[96:99]
  v_mfma_f32_16x16x32_bf16 a[100:103], v[88:91], v[144:147], a[100:103]
  ds_read_b128 v[60:63], v18 offset:8192
  s_add_u32 m0, s53, 68608
  v_mfma_f32_16x16x32_bf16 a[104:107], v[88:91], v[148:151], a[104:107]
  buffer_load_dwordx4 v13, s[12:15], s21 offen  lds
  v_mfma_f32_16x16x32_bf16 a[108:111], v[88:91], v[152:155], a[108:111]
  ds_read_b64_tr_b16 v[124:125], v26 offset:32768
  v_mfma_f32_16x16x32_bf16 a[112:115], v[88:91], v[156:159], a[112:115]
  v_mfma_f32_16x16x32_bf16 a[116:119], v[88:91], v[160:163], a[116:119]
  ds_read_b64_tr_b16 v[126:127], v26 offset:34816
  s_add_u32 m0, s52, 69632
  v_mfma_f32_16x16x32_bf16 a[120:123], v[88:91], v[164:167], a[120:123]
  buffer_load_dwordx4 v6, s[8:11], s20 offen  lds
  v_mfma_f32_16x16x32_bf16 a[124:127], v[88:91], v[168:171], a[124:127]
  ds_read_b128 v[64:67], v18 offset:10240
  v_mfma_f32_16x16x32_bf16 a[128:131], v[92:95], v[140:143], a[128:131]
  v_mfma_f32_16x16x32_bf16 a[132:135], v[92:95], v[144:147], a[132:135]
  ds_read_b64_tr_b16 v[128:129], v27 offset:32768
  s_add_u32 m0, s53, 69632
  v_mfma_f32_16x16x32_bf16 a[136:139], v[92:95], v[148:151], a[136:139]
  buffer_load_dwordx4 v14, s[12:15], s21 offen  lds
  v_mfma_f32_16x16x32_bf16 a[140:143], v[92:95], v[152:155], a[140:143]
  ds_read_b64_tr_b16 v[130:131], v27 offset:34816
  v_mfma_f32_16x16x32_bf16 a[144:147], v[92:95], v[156:159], a[144:147]
  v_mfma_f32_16x16x32_bf16 a[148:151], v[92:95], v[160:163], a[148:151]
  ds_read_b128 v[68:71], v18 offset:12288
  s_add_u32 m0, s52, 70656
  v_mfma_f32_16x16x32_bf16 a[152:155], v[92:95], v[164:167], a[152:155]
  buffer_load_dwordx4 v7, s[8:11], s20 offen  lds
  v_mfma_f32_16x16x32_bf16 a[156:159], v[92:95], v[168:171], a[156:159]
  ds_read_b64_tr_b16 v[132:133], v28 offset:32768
  v_mfma_f32_16x16x32_bf16 a[160:163], v[96:99], v[140:143], a[160:163]
  s_add_u32 m0, s53, 70656
  v_mfma_f32_16x16x32_bf16 a[164:167], v[96:99], v[144:147], a[164:167]
  buffer_load_dwordx4 v15, s[12:15], s21 offen  lds
  ds_read_b64_tr_b16 v[134:135], v28 offset:34816
  v_mfma_f32_16x16x32_bf16 a[168:171], v[96:99], v[148:151], a[168:171]
  v_mfma_f32_16x16x32_bf16 a[172:175], v[96:99], v[152:155], a[172:175]
  ds_read_b128 v[72:75], v18 offset:14336
  v_mfma_f32_16x16x32_bf16 a[176:179], v[96:99], v[156:159], a[176:179]
  s_add_u32 m0, s52, 71680
  v_mfma_f32_16x16x32_bf16 a[180:183], v[96:99], v[160:163], a[180:183]
  buffer_load_dwordx4 v8, s[8:11], s20 offen  lds
  ds_read_b64_tr_b16 v[136:137], v29 offset:32768
  v_mfma_f32_16x16x32_bf16 a[184:187], v[96:99], v[164:167], a[184:187]
  v_mfma_f32_16x16x32_bf16 a[188:191], v[96:99], v[168:171], a[188:191]
  ds_read_b64_tr_b16 v[138:139], v29 offset:34816
  v_mfma_f32_16x16x32_bf16 a[192:195], v[100:103], v[140:143], a[192:195]
  s_add_u32 m0, s53, 71680
  v_mfma_f32_16x16x32_bf16 a[196:199], v[100:103], v[144:147], a[196:199]
  buffer_load_dwordx4 v16, s[12:15], s21 offen  lds
  v_mfma_f32_16x16x32_bf16 a[200:203], v[100:103], v[148:151], a[200:203]
  v_mfma_f32_16x16x32_bf16 a[204:207], v[100:103], v[152:155], a[204:207]
  s_add_u32 m0, s52, 72704
  v_mfma_f32_16x16x32_bf16 a[208:211], v[100:103], v[156:159], a[208:211]
  buffer_load_dwordx4 v9, s[8:11], s20 offen  lds
  v_mfma_f32_16x16x32_bf16 a[212:215], v[100:103], v[160:163], a[212:215]
  v_mfma_f32_16x16x32_bf16 a[216:219], v[100:103], v[164:167], a[216:219]
  v_mfma_f32_16x16x32_bf16 a[220:223], v[100:103], v[168:171], a[220:223]
  s_add_u32 m0, s53, 72704
  v_mfma_f32_16x16x32_bf16 a[224:227], v[104:107], v[140:143], a[224:227]
  buffer_load_dwordx4 v17, s[12:15], s21 offen  lds
  v_mfma_f32_16x16x32_bf16 a[228:231], v[104:107], v[144:147], a[228:231]
  v_mfma_f32_16x16x32_bf16 a[232:235], v[104:107], v[148:151], a[232:235]
  v_mfma_f32_16x16x32_bf16 a[236:239], v[104:107], v[152:155], a[236:239]
  s_add_u32 s20, s20, 128
  v_mfma_f32_16x16x32_bf16 a[240:243], v[104:107], v[156:159], a[240:243]
  s_add_u32 s21, s21, s51
  v_mfma_f32_16x16x32_bf16 a[244:247], v[104:107], v[160:163], a[244:247]
  v_mfma_f32_16x16x32_bf16 a[248:251], v[104:107], v[164:167], a[248:251]
  v_mfma_f32_16x16x32_bf16 a[252:255], v[104:107], v[168:171], a[252:255]
  s_branch L_g2_loop
L_g2_fin:
  s_mov_b32 s59, 2
  s_mov_b32 s60, s22
  s_mov_b32 s61, s26
  s_add_u32 s62, s38, 0x3d00000
  s_mov_b32 s63, s98
  s_waitcnt lgkmcnt(0)
  v_min_u32 v245, 270, v246
  v_lshlrev_b32 v245, 2, v245
  v_add_u32 v245, 147648, v245
  ds_read_b32 v245, v245
  v_readfirstlane_b32 s34, v246
  s_add_u32 s34, s34, 32
  v_mfma_f32_16x16x32_bf16 a[0:3], v[44:47], v[108:111], a[0:3]
  ds_read_b128 v[76:79], v19 offset:0
  v_mfma_f32_16x16x32_bf16 a[4:7], v[44:47], v[112:115], a[4:7]
  v_mfma_f32_16x16x32_bf16 a[8:11], v[44:47], v[116:119], a[8:11]
  ds_read_b64_tr_b16 v[140:141], v22 offset:49152
  v_mfma_f32_16x16x32_bf16 a[12:15], v[44:47], v[120:123], a[12:15]
  v_mfma_f32_16x16x32_bf16 a[16:19], v[44:47], v[124:127], a[16:19]
  ds_read_b64_tr_b16 v[142:143], v22 offset:51200
  v_mfma_f32_16x16x32_bf16 a[20:23], v[44:47], v[128:131], a[20:23]
  v_mfma_f32_16x16x32_bf16 a[24:27], v[44:47], v[132:135], a[24:27]
  ds_read_b128 v[80:83], v19 offset:2048
  v_mfma_f32_16x16x32_bf16 a[28:31], v[44:47], v[136:139], a[28:31]
  v_mfma_f32_16x16x32_bf16 a[32:35], v[48:51], v[108:111], a[32:35]
  ds_read_b64_tr_b16 v[144:145], v23 offset:49152
  v_mfma_f32_16x16x32_bf16 a[36:39], v[48:51], v[112:115], a[36:39]
  v_mfma_f32_16x16x32_bf16 a[40:43], v[48:51], v[116:119], a[40:43]
  ds_read_b64_tr_b16 v[146:147], v23 offset:51200
  v_mfma_f32_16x16x32_bf16 a[44:47], v[48:51], v[120:123], a[44:47]
  v_mfma_f32_16x16x32_bf16 a[48:51], v[48:51], v[124:127], a[48:51]
  ds_read_b128 v[84:87], v19 offset:4096
  v_mfma_f32_16x16x32_bf16 a[52:55], v[48:51], v[128:131], a[52:55]
  v_mfma_f32_16x16x32_bf16 a[56:59], v[48:51], v[132:135], a[56:59]
  ds_read_b64_tr_b16 v[148:149], v24 offset:49152
  v_mfma_f32_16x16x32_bf16 a[60:63], v[48:51], v[136:139], a[60:63]
  v_mfma_f32_16x16x32_bf16 a[64:67], v[52:55], v[108:111], a[64:67]
  ds_read_b64_tr_b16 v[150:151], v24 offset:51200
  v_mfma_f32_16x16x32_bf16 a[68:71], v[52:55], v[112:115], a[68:71]
  v_mfma_f32_16x16x32_bf16 a[72:75], v[52:55], v[116:119], a[72:75]
  ds_read_b128 v[88:91], v19 offset:6144
  v_mfma_f32_16x16x32_bf16 a[76:79], v[52:55], v[120:123], a[76:79]
  v_mfma_f32_16x16x32_bf16 a[80:83], v[52:55], v[124:127], a[80:83]
  ds_read_b64_tr_b16 v[152:153], v25 offset:49152
  v_mfma_f32_16x16x32_bf16 a[84:87], v[52:55], v[128:131], a[84:87]
  v_mfma_f32_16x16x32_bf16 a[88:91], v[52:55], v[132:135], a[88:91]
  ds_read_b64_tr_b16 v[154:155], v25 offset:51200
  v_mfma_f32_16x16x32_bf16 a[92:95], v[52:55], v[136:139], a[92:95]
  v_mfma_f32_16x16x32_bf16 a[96:99], v[56:59], v[108:111], a[96:99]
  ds_read_b128 v[92:95], v19 offset:8192
  v_mfma_f32_16x16x32_bf16 a[100:103], v[56:59], v[112:115], a[100:103]
  v_mfma_f32_16x16x32_bf16 a[104:107], v[56:59], v[116:119], a[104:107]
  ds_read_b64_tr_b16 v[156:157], v26 offset:49152
  v_mfma_f32_16x16x32_bf16 a[108:111], v[56:59], v[120:123], a[108:111]
  v_mfma_f32_16x16x32_bf16 a[112:115], v[56:59], v[124:127], a[112:115]
  ds_read_b64_tr_b16 v[158:159], v26 offset:51200
  v_mfma_f32_16x16x32_bf16 a[116:119], v[56:59], v[128:131], a[116:119]
  v_mfma_f32_16x16x32_bf16 a[120:123], v[56:59], v[132:135], a[120:123]
  ds_read_b128 v[96:99], v19 offset:10240
  v_mfma_f32_16x16x32_bf16 a[124:127], v[56:59], v[136:139], a[124:127]
  v_mfma_f32_16x16x32_bf16 a[128:131], v[60:63], v[108:111], a[128:131]
  ds_read_b64_tr_b16 v[160:161], v27 offset:49152
  v_mfma_f32_16x16x32_bf16 a[132:135], v[60:63], v[112:115], a[132:135]
  v_mfma_f32_16x16x32_bf16 a[136:139], v[60:63], v[116:119], a[136:139]
  ds_read_b64_tr_b16 v[162:163], v27 offset:51200
  v_mfma_f32_16x16x32_bf16 a[140:143], v[60:63], v[120:123], a[140:143]
  v_mfma_f32_16x16x32_bf16 a[144:147], v[60:63], v[124:127], a[144:147]
  ds_read_b128 v[100:103], v19 offset:12288
  v_mfma_f32_16x16x32_bf16 a[148:151], v[60:63], v[128:131], a[148:151]
  v_mfma_f32_16x16x32_bf16 a[152:155], v[60:63], v[132:135], a[152:155]
  ds_read_b64_tr_b16 v[164:165], v28 offset:49152
  v_mfma_f32_16x16x32_bf16 a[156:159], v[60:63], v[136:139], a[156:159]
  v_mfma_f32_16x16x32_bf16 a[160:163], v[64:67], v[108:111], a[160:163]
  ds_read_b64_tr_b16 v[166:167], v28 offset:51200
  v_mfma_f32_16x16x32_bf16 a[164:167], v[64:67], v[112:115], a[164:167]
  v_mfma_f32_16x16x32_bf16 a[168:171], v[64:67], v[116:119], a[168:171]
  ds_read_b128 v[104:107], v19 offset:14336
  v_mfma_f32_16x16x32_bf16 a[172:175], v[64:67], v[120:123], a[172:175]
  v_mfma_f32_16x16x32_bf16 a[176:179], v[64:67], v[124:127], a[176:179]
  ds_read_b64_tr_b16 v[168:169], v29 offset:49152
  v_mfma_f32_16x16x32_bf16 a[180:183], v[64:67], v[128:131], a[180:183]
  v_mfma_f32_16x16x32_bf16 a[184:187], v[64:67], v[132:135], a[184:187]
  ds_read_b64_tr_b16 v[170:171], v29 offset:51200
  v_mfma_f32_16x16x32_bf16 a[188:191], v[64:67], v[136:139], a[188:191]
  v_mfma_f32_16x16x32_bf16 a[192:195], v[68:71], v[108:111], a[192:195]
  v_mfma_f32_16x16x32_bf16 a[196:199], v[68:71], v[112:115], a[196:199]
  v_mfma_f32_16x16x32_bf16 a[200:203], v[68:71], v[116:119], a[200:203]
  v_mfma_f32_16x16x32_bf16 a[204:207], v[68:71], v[120:123], a[204:207]
  v_mfma_f32_16x16x32_bf16 a[208:211], v[68:71], v[124:127], a[208:211]
  v_mfma_f32_16x16x32_bf16 a[212:215], v[68:71], v[128:131], a[212:215]
  v_mfma_f32_16x16x32_bf16 a[216:219], v[68:71], v[132:135], a[216:219]
  v_mfma_f32_16x16x32_bf16 a[220:223], v[68:71], v[136:139], a[220:223]
  v_mfma_f32_16x16x32_bf16 a[224:227], v[72:75], v[108:111], a[224:227]
  v_mfma_f32_16x16x32_bf16 a[228:231], v[72:75], v[112:115], a[228:231]
  v_mfma_f32_16x16x32_bf16 a[232:235], v[72:75], v[116:119], a[232:235]
  v_mfma_f32_16x16x32_bf16 a[236:239], v[72:75], v[120:123], a[236:239]
  v_mfma_f32_16x16x32_bf16 a[240:243], v[72:75], v[124:127], a[240:243]
  v_mfma_f32_16x16x32_bf16 a[244:247], v[72:75], v[128:131], a[244:247]
  v_mfma_f32_16x16x32_bf16 a[248:251], v[72:75], v[132:135], a[248:251]
  v_mfma_f32_16x16x32_bf16 a[252:255], v[72:75], v[136:139], a[252:255]
  s_waitcnt lgkmcnt(0)
  v_mfma_f32_16x16x32_bf16 a[0:3], v[76:79], v[140:143], a[0:3]
  s_waitcnt vmcnt(0)
  s_barrier
  v_readfirstlane_b32 s91, v245
  s_and_b32 s35, s91, 255
  s_lshr_b32 s36, s91, 8
  s_and_b32 s36, s36, 255
  s_lshr_b32 s37, s91, 16
  s_mov_b32 s92, s24
  s_cmp_gt_u32 s35, 3
  s_cbranch_scc1 L_cd_50
  s_cmp_eq_u32 s35, 3
  s_cbranch_scc1 L_cd_48
  s_mov_b32 s8, s64
  s_and_b32 s9, s65, 0xffff
  s_mov_b32 s10, 0x400000
  s_mov_b32 s11, 0x20000
  s_cmp_eq_u32 s35, 0
  s_cselect_b64 s[88:89], s[68:69], s[70:71]
  s_cmp_eq_u32 s35, 2
  s_cselect_b64 s[88:89], s[72:73], s[88:89]
  s_mov_b32 s12, s88
  s_and_b32 s13, s89, 0xffff
  s_mov_b32 s14, 0x800000
  s_mov_b32 s15, 0x20000
  s_lshl_b32 s91, s33, 2
  s_add_u32 s91, s91, s37
  s_mov_b32 s24, 8192
  s_mov_b32 s26, 262144
  s_lshl_b32 s20, s36, 19
  s_lshl_b32 s21, s91, 9
  s_lshl_b32 s22, s35, 24
  s_lshl_b32 s90, s36, 21
  s_add_u32 s22, s22, s90
  s_lshl_b32 s90, s91, 14
  s_add_u32 s22, s22, s90
  s_lshl_b32 s38, s36, 9
  s_add_u32 s38, s38, 28672
  s_cmp_eq_u32 s35, 0
  s_cselect_b32 s38, 8192, s38
  s_cselect_b32 s98, 1, 2
  s_mov_b32 s48, s35
  s_branch L_cd_49
L_cd_50:
  s_mov_b64 vcc, 0
  s_mov_b32 s58, 0
  s_branch L_cd_51
L_cd_48:
  s_mov_b32 s8, s78
  s_and_b32 s9, s79, 0xffff
  s_mov_b32 s10, 0x400000
  s_mov_b32 s11, 0x20000
  s_mov_b32 s12, s80
  s_and_b32 s13, s81, 0xffff
  s_mov_b32 s14, 0x600000
  s_mov_b32 s15, 0x20000
  s_lshl_b32 s91, s37, 2
  s_add_u32 s91, s91, s33
  s_mov_b32 s24, 6144
  s_mov_b32 s26, 65536
  s_lshl_b32 s20, s36, 19
  s_lshl_b32 s21, s91, 9
  s_lshl_b32 s22, s37, 22
  s_lshl_b32 s90, s36, 19
  s_add_u32 s22, s22, s90
  s_lshl_b32 s90, s33, 14
  s_add_u32 s22, s22, s90
  s_add_u32 s22, s22, 0x4000000
  s_mov_b32 s38, 12288
  s_mov_b32 s48, s37
  s_mov_b32 s98, 1
L_cd_49:
  s_lshl_b32 s90, s36, 9
  s_add_u32 s38, s38, s90
  s_lshl_b32 s90, s33, 7
  s_add_u32 s38, s38, s90
  s_mov_b32 s23, 2048
  s_mov_b32 s25, 8
  s_mov_b64 vcc, -1
  s_sub_i32 s92, s24, s92
  s_lshl_b32 s51, s24, 6
  v_mul_i32_i24 v38, s92, v174
  s_mul_i32 s92, s92, 2
  s_mov_b32 s93, 0
  v_add3_u32 v10, v10, v38, s93
  s_add_u32 s93, s93, s92
  v_add3_u32 v11, v11, v38, s93
  s_add_u32 s93, s93, s92
  v_add3_u32 v12, v12, v38, s93
  s_add_u32 s93, s93, s92
  v_add3_u32 v13, v13, v38, s93
  s_add_u32 s93, s93, s92
  v_add3_u32 v14, v14, v38, s93
  s_add_u32 s93, s93, s92
  v_add3_u32 v15, v15, v38, s93
  s_add_u32 s93, s93, s92
  v_add3_u32 v16, v16, v38, s93
  s_add_u32 s93, s93, s92
  v_add3_u32 v17, v17, v38, s93
  s_add_u32 s93, s93, s92
L_cd_51:
  s_add_u32 m0, s52, 0
  v_mfma_f32_16x16x32_bf16 a[4:7], v[76:79], v[144:147], a[4:7]
  s_cbranch_vccz L_gd_52
  buffer_load_dwordx4 v2, s[8:11], s20 offen  lds
L_gd_52:
  ds_read_b128 v[44:47], v20 offset:0
  v_mfma_f32_16x16x32_bf16 a[8:11], v[76:79], v[148:151], a[8:11]
  v_mfma_f32_16x16x32_bf16 a[12:15], v[76:79], v[152:155], a[12:15]
  ds_read_b64_tr_b16 v[108:109], v30 offset:32768
  s_add_u32 m0, s53, 0
  v_mfma_f32_16x16x32_bf16 a[16:19], v[76:79], v[156:159], a[16:19]
  s_cbranch_vccz L_gd_53
  buffer_load_dwordx4 v10, s[12:15], s21 offen  lds
L_gd_53:
  v_mfma_f32_16x16x32_bf16 a[20:23], v[76:79], v[160:163], a[20:23]
  ds_read_b64_tr_b16 v[110:111], v30 offset:34816
  v_mfma_f32_16x16x32_bf16 a[24:27], v[76:79], v[164:167], a[24:27]
  v_mfma_f32_16x16x32_bf16 a[28:31], v[76:79], v[168:171], a[28:31]
  ds_read_b128 v[48:51], v20 offset:2048
  s_add_u32 m0, s52, 1024
  v_mfma_f32_16x16x32_bf16 a[32:35], v[80:83], v[140:143], a[32:35]
  s_cbranch_vccz L_gd_54
  buffer_load_dwordx4 v3, s[8:11], s20 offen  lds
L_gd_54:
  v_mfma_f32_16x16x32_bf16 a[36:39], v[80:83], v[144:147], a[36:39]
  ds_read_b64_tr_b16 v[112:113], v31 offset:32768
  v_mfma_f32_16x16x32_bf16 a[40:43], v[80:83], v[148:151], a[40:43]
  v_mfma_f32_16x16x32_bf16 a[44:47], v[80:83], v[152:155], a[44:47]
  ds_read_b64_tr_b16 v[114:115], v31 offset:34816
  s_add_u32 m0, s53, 1024
  v_mfma_f32_16x16x32_bf16 a[48:51], v[80:83], v[156:159], a[48:51]
  s_cbranch_vccz L_gd_55
  buffer_load_dwordx4 v11, s[12:15], s21 offen  lds
L_gd_55:
  v_mfma_f32_16x16x32_bf16 a[52:55], v[80:83], v[160:163], a[52:55]
  ds_read_b128 v[52:55], v20 offset:4096
  v_mfma_f32_16x16x32_bf16 a[56:59], v[80:83], v[164:167], a[56:59]
  v_mfma_f32_16x16x32_bf16 a[60:63], v[80:83], v[168:171], a[60:63]
  ds_read_b64_tr_b16 v[116:117], v32 offset:32768
  s_add_u32 m0, s52, 2048
  v_mfma_f32_16x16x32_bf16 a[64:67], v[84:87], v[140:143], a[64:67]
  s_cbranch_vccz L_gd_56
  buffer_load_dwordx4 v4, s[8:11], s20 offen  lds
L_gd_56:
  v_mfma_f32_16x16x32_bf16 a[68:71], v[84:87], v[144:147], a[68:71]
  ds_read_b64_tr_b16 v[118:119], v32 offset:34816
  v_mfma_f32_16x16x32_bf16 a[72:75], v[84:87], v[148:151], a[72:75]
  v_mfma_f32_16x16x32_bf16 a[76:79], v[84:87], v[152:155], a[76:79]
  ds_read_b128 v[56:59], v20 offset:6144
  s_add_u32 m0, s53, 2048
  v_mfma_f32_16x16x32_bf16 a[80:83], v[84:87], v[156:159], a[80:83]
  s_cbranch_vccz L_gd_57
  buffer_load_dwordx4 v12, s[12:15], s21 offen  lds
L_gd_57:
  v_mfma_f32_16x16x32_bf16 a[84:87], v[84:87], v[160:163], a[84:87]
  ds_read_b64_tr_b16 v[120:121], v33 offset:32768
  v_mfma_f32_16x16x32_bf16 a[88:91], v[84:87], v[164:167], a[88:91]
  v_mfma_f32_16x16x32_bf16 a[92:95], v[84:87], v[168:171], a[92:95]
  ds_read_b64_tr_b16 v[122:123], v33 offset:34816
  s_add_u32 m0, s52, 3072
  v_mfma_f32_16x16x32_bf16 a[96:99], v[88:91], v[140:143], a[96:99]
  s_cbranch_vccz L_gd_58
  buffer_load_dwordx4 v5, s[8:11], s20 offen  lds
L_gd_58:
  v_mfma_f32_16x16x32_bf16 a[100:103], v[88:91], v[144:147], a[100:103]
  ds_read_b128 v[60:63], v20 offset:8192
  v_mfma_f32_16x16x32_bf16 a[104:107], v[88:91], v[148:151], a[104:107]
  v_mfma_f32_16x16x32_bf16 a[108:111], v[88:91], v[152:155], a[108:111]
  ds_read_b64_tr_b16 v[124:125], v34 offset:32768
  s_add_u32 m0, s53, 3072
  v_mfma_f32_16x16x32_bf16 a[112:115], v[88:91], v[156:159], a[112:115]
  s_cbranch_vccz L_gd_59
  buffer_load_dwordx4 v13, s[12:15], s21 offen  lds
L_gd_59:
  v_mfma_f32_16x16x32_bf16 a[116:119], v[88:91], v[160:163], a[116:119]
  ds_read_b64_tr_b16 v[126:127], v34 offset:34816
  v_mfma_f32_16x16x32_bf16 a[120:123], v[88:91], v[164:167], a[120:123]
  v_mfma_f32_16x16x32_bf16 a[124:127], v[88:91], v[168:171], a[124:127]
  ds_read_b128 v[64:67], v20 offset:10240
  s_add_u32 m0, s52, 4096
  v_mfma_f32_16x16x32_bf16 a[128:131], v[92:95], v[140:143], a[128:131]
  s_cbranch_vccz L_gd_60
  buffer_load_dwordx4 v6, s[8:11], s20 offen  lds
L_gd_60:
  v_mfma_f32_16x16x32_bf16 a[132:135], v[92:95], v[144:147], a[132:135]
  ds_read_b64_tr_b16 v[128:129], v35 offset:32768
  v_mfma_f32_16x16x32_bf16 a[136:139], v[92:95], v[148:151], a[136:139]
  v_mfma_f32_16x16x32_bf16 a[140:143], v[92:95], v[152:155], a[140:143]
  ds_read_b64_tr_b16 v[130:131], v35 offset:34816
  s_add_u32 m0, s53, 4096
  v_mfma_f32_16x16x32_bf16 a[144:147], v[92:95], v[156:159], a[144:147]
  s_cbranch_vccz L_gd_61
  buffer_load_dwordx4 v14, s[12:15], s21 offen  lds
L_gd_61:
  v_mfma_f32_16x16x32_bf16 a[148:151], v[92:95], v[160:163], a[148:151]
  ds_read_b128 v[68:71], v20 offset:12288
  v_mfma_f32_16x16x32_bf16 a[152:155], v[92:95], v[164:167], a[152:155]
  v_mfma_f32_16x16x32_bf16 a[156:159], v[92:95], v[168:171], a[156:159]
  ds_read_b64_tr_b16 v[132:133], v36 offset:32768
  s_add_u32 m0, s52, 5120
  v_mfma_f32_16x16x32_bf16 a[160:163], v[96:99], v[140:143], a[160:163]
  s_cbranch_vccz L_gd_62
  buffer_load_dwordx4 v7, s[8:11], s20 offen  lds
L_gd_62:
  v_mfma_f32_16x16x32_bf16 a[164:167], v[96:99], v[144:147], a[164:167]
  ds_read_b64_tr_b16 v[134:135], v36 offset:34816
  v_mfma_f32_16x16x32_bf16 a[168:171], v[96:99], v[148:151], a[168:171]
  v_mfma_f32_16x16x32_bf16 a[172:175], v[96:99], v[152:155], a[172:175]
  ds_read_b128 v[72:75], v20 offset:14336
  s_add_u32 m0, s53, 5120
  v_mfma_f32_16x16x32_bf16 a[176:179], v[96:99], v[156:159], a[176:179]
  s_cbranch_vccz L_gd_63
  buffer_load_dwordx4 v15, s[12:15], s21 offen  lds
L_gd_63:
  v_mfma_f32_16x16x32_bf16 a[180:183], v[96:99], v[160:163], a[180:183]
  ds_read_b64_tr_b16 v[136:137], v37 offset:32768
  v_mfma_f32_16x16x32_bf16 a[184:187], v[96:99], v[164:167], a[184:187]
  v_mfma_f32_16x16x32_bf16 a[188:191], v[96:99], v[168:171], a[188:191]
  ds_read_b64_tr_b16 v[138:139], v37 offset:34816
  s_add_u32 m0, s52, 6144
  v_mfma_f32_16x16x32_bf16 a[192:195], v[100:103], v[140:143], a[192:195]
  s_cbranch_vccz L_gd_64
  buffer_load_dwordx4 v8, s[8:11], s20 offen  lds
L_gd_64:
  v_mfma_f32_16x16x32_bf16 a[196:199], v[100:103], v[144:147], a[196:199]
  v_mfma_f32_16x16x32_bf16 a[200:203], v[100:103], v[148:151], a[200:203]
  v_mfma_f32_16x16x32_bf16 a[204:207], v[100:103], v[152:155], a[204:207]
  s_add_u32 m0, s53, 6144
  v_mfma_f32_16x16x32_bf16 a[208:211], v[100:103], v[156:159], a[208:211]
  s_cbranch_vccz L_gd_65
  buffer_load_dwordx4 v16, s[12:15], s21 offen  lds
L_gd_65:
  v_mfma_f32_16x16x32_bf16 a[212:215], v[100:103], v[160:163], a[212:215]
  v_mfma_f32_16x16x32_bf16 a[216:219], v[100:103], v[164:167], a[216:219]
  v_mfma_f32_16x16x32_bf16 a[220:223], v[100:103], v[168:171], a[220:223]
  s_add_u32 m0, s52, 7168
  v_mfma_f32_16x16x32_bf16 a[224:227], v[104:107], v[140:143], a[224:227]
  s_cbranch_vccz L_gd_66
  buffer_load_dwordx4 v9, s[8:11], s20 offen  lds
L_gd_66:
  v_mfma_f32_16x16x32_bf16 a[228:231], v[104:107], v[144:147], a[228:231]
  v_mfma_f32_16x16x32_bf16 a[232:235], v[104:107], v[148:151], a[232:235]
  v_mfma_f32_16x16x32_bf16 a[236:239], v[104:107], v[152:155], a[236:239]
  s_add_u32 m0, s53, 7168
  v_mfma_f32_16x16x32_bf16 a[240:243], v[104:107], v[156:159], a[240:243]
  s_cbranch_vccz L_gd_67
  buffer_load_dwordx4 v17, s[12:15], s21 offen  lds
  s_add_u32 s20, s20, 128
  s_add_u32 s21, s21, s51
L_gd_67:
  v_mfma_f32_16x16x32_bf16 a[244:247], v[104:107], v[160:163], a[244:247]
  v_mfma_f32_16x16x32_bf16 a[248:251], v[104:107], v[164:167], a[248:251]
  v_mfma_f32_16x16x32_bf16 a[252:255], v[104:107], v[168:171], a[252:255]
  s_waitcnt lgkmcnt(0)
  v_mfma_f32_16x16x32_bf16 a[0:3], v[44:47], v[108:111], a[0:3]
  ds_read_b128 v[76:79], v21 offset:0
  v_mfma_f32_16x16x32_bf16 a[4:7], v[44:47], v[112:115], a[4:7]
  v_mfma_f32_16x16x32_bf16 a[8:11], v[44:47], v[116:119], a[8:11]
  ds_read_b64_tr_b16 v[140:141], v30 offset:49152
  v_mfma_f32_16x16x32_bf16 a[12:15], v[44:47], v[120:123], a[12:15]
  v_mfma_f32_16x16x32_bf16 a[16:19], v[44:47], v[124:127], a[16:19]
  ds_read_b64_tr_b16 v[142:143], v30 offset:51200
  v_mfma_f32_16x16x32_bf16 a[20:23], v[44:47], v[128:131], a[20:23]
  v_mfma_f32_16x16x32_bf16 a[24:27], v[44:47], v[132:135], a[24:27]
  ds_read_b128 v[80:83], v21 offset:2048
  v_mfma_f32_16x16x32_bf16 a[28:31], v[44:47], v[136:139], a[28:31]
  v_mfma_f32_16x16x32_bf16 a[32:35], v[48:51], v[108:111], a[32:35]
  ds_read_b64_tr_b16 v[144:145], v31 offset:49152
  v_mfma_f32_16x16x32_bf16 a[36:39], v[48:51], v[112:115], a[36:39]
  v_mfma_f32_16x16x32_bf16 a[40:43], v[48:51], v[116:119], a[40:43]
  ds_read_b64_tr_b16 v[146:147], v31 offset:51200
  v_mfma_f32_16x16x32_bf16 a[44:47], v[48:51], v[120:123], a[44:47]
  v_mfma_f32_16x16x32_bf16 a[48:51], v[48:51], v[124:127], a[48:51]
  ds_read_b128 v[84:87], v21 offset:4096
  v_mfma_f32_16x16x32_bf16 a[52:55], v[48:51], v[128:131], a[52:55]
  v_mfma_f32_16x16x32_bf16 a[56:59], v[48:51], v[132:135], a[56:59]
  ds_read_b64_tr_b16 v[148:149], v32 offset:49152
  v_mfma_f32_16x16x32_bf16 a[60:63], v[48:51], v[136:139], a[60:63]
  v_mfma_f32_16x16x32_bf16 a[64:67], v[52:55], v[108:111], a[64:67]
  ds_read_b64_tr_b16 v[150:151], v32 offset:51200
  v_mfma_f32_16x16x32_bf16 a[68:71], v[52:55], v[112:115], a[68:71]
  v_mfma_f32_16x16x32_bf16 a[72:75], v[52:55], v[116:119], a[72:75]
  ds_read_b128 v[88:91], v21 offset:6144
  v_mfma_f32_16x16x32_bf16 a[76:79], v[52:55], v[120:123], a[76:79]
  v_mfma_f32_16x16x32_bf16 a[80:83], v[52:55], v[124:127], a[80:83]
  ds_read_b64_tr_b16 v[152:153], v33 offset:49152
  v_mfma_f32_16x16x32_bf16 a[84:87], v[52:55], v[128:131], a[84:87]
  v_mfma_f32_16x16x32_bf16 a[88:91], v[52:55], v[132:135], a[88:91]
  ds_read_b64_tr_b16 v[154:155], v33 offset:51200
  v_mfma_f32_16x16x32_bf16 a[92:95], v[52:55], v[136:139], a[92:95]
  v_mfma_f32_16x16x32_bf16 a[96:99], v[56:59], v[108:111], a[96:99]
  ds_read_b128 v[92:95], v21 offset:8192
  v_mfma_f32_16x16x32_bf16 a[100:103], v[56:59], v[112:115], a[100:103]
  v_mfma_f32_16x16x32_bf16 a[104:107], v[56:59], v[116:119], a[104:107]
  ds_read_b64_tr_b16 v[156:157], v34 offset:49152
  v_mfma_f32_16x16x32_bf16 a[108:111], v[56:59], v[120:123], a[108:111]
  v_mfma_f32_16x16x32_bf16 a[112:115], v[56:59], v[124:127], a[112:115]
  ds_read_b64_tr_b16 v[158:159], v34 offset:51200
  v_mfma_f32_16x16x32_bf16 a[116:119], v[56:59], v[128:131], a[116:119]
  v_mfma_f32_16x16x32_bf16 a[120:123], v[56:59], v[132:135], a[120:123]
  ds_read_b128 v[96:99], v21 offset:10240
  v_mfma_f32_16x16x32_bf16 a[124:127], v[56:59], v[136:139], a[124:127]
  v_mfma_f32_16x16x32_bf16 a[128:131], v[60:63], v[108:111], a[128:131]
  ds_read_b64_tr_b16 v[160:161], v35 offset:49152
  v_mfma_f32_16x16x32_bf16 a[132:135], v[60:63], v[112:115], a[132:135]
  v_mfma_f32_16x16x32_bf16 a[136:139], v[60:63], v[116:119], a[136:139]
  ds_read_b64_tr_b16 v[162:163], v35 offset:51200
  v_mfma_f32_16x16x32_bf16 a[140:143], v[60:63], v[120:123], a[140:143]
  v_mfma_f32_16x16x32_bf16 a[144:147], v[60:63], v[124:127], a[144:147]
  ds_read_b128 v[100:103], v21 offset:12288
  v_mfma_f32_16x16x32_bf16 a[148:151], v[60:63], v[128:131], a[148:151]
  v_mfma_f32_16x16x32_bf16 a[152:155], v[60:63], v[132:135], a[152:155]
  ds_read_b64_tr_b16 v[164:165], v36 offset:49152
  v_mfma_f32_16x16x32_bf16 a[156:159], v[60:63], v[136:139], a[156:159]
  v_mfma_f32_16x16x32_bf16 a[160:163], v[64:67], v[108:111], a[160:163]
  ds_read_b64_tr_b16 v[166:167], v36 offset:51200
  v_mfma_f32_16x16x32_bf16 a[164:167], v[64:67], v[112:115], a[164:167]
  v_mfma_f32_16x16x32_bf16 a[168:171], v[64:67], v[116:119], a[168:171]
  ds_read_b128 v[104:107], v21 offset:14336
  v_mfma_f32_16x16x32_bf16 a[172:175], v[64:67], v[120:123], a[172:175]
  v_mfma_f32_16x16x32_bf16 a[176:179], v[64:67], v[124:127], a[176:179]
  ds_read_b64_tr_b16 v[168:169], v37 offset:49152
  v_mfma_f32_16x16x32_bf16 a[180:183], v[64:67], v[128:131], a[180:183]
  v_mfma_f32_16x16x32_bf16 a[184:187], v[64:67], v[132:135], a[184:187]
  ds_read_b64_tr_b16 v[170:171], v37 offset:51200
  v_mfma_f32_16x16x32_bf16 a[188:191], v[64:67], v[136:139], a[188:191]
  v_mfma_f32_16x16x32_bf16 a[192:195], v[68:71], v[108:111], a[192:195]
  v_mfma_f32_16x16x32_bf16 a[196:199], v[68:71], v[112:115], a[196:199]
  v_mfma_f32_16x16x32_bf16 a[200:203], v[68:71], v[116:119], a[200:203]
  v_mfma_f32_16x16x32_bf16 a[204:207], v[68:71], v[120:123], a[204:207]
  v_mfma_f32_16x16x32_bf16 a[208:211], v[68:71], v[124:127], a[208:211]
  v_mfma_f32_16x16x32_bf16 a[212:215], v[68:71], v[128:131], a[212:215]
  v_mfma_f32_16x16x32_bf16 a[216:219], v[68:71], v[132:135], a[216:219]
  v_mfma_f32_16x16x32_bf16 a[220:223], v[68:71], v[136:139], a[220:223]
  v_mfma_f32_16x16x32_bf16 a[224:227], v[72:75], v[108:111], a[224:227]
  v_mfma_f32_16x16x32_bf16 a[228:231], v[72:75], v[112:115], a[228:231]
  v_mfma_f32_16x16x32_bf16 a[232:235], v[72:75], v[116:119], a[232:235]
  v_mfma_f32_16x16x32_bf16 a[236:239], v[72:75], v[120:123], a[236:239]
  v_mfma_f32_16x16x32_bf16 a[240:243], v[72:75], v[124:127], a[240:243]
  v_mfma_f32_16x16x32_bf16 a[244:247], v[72:75], v[128:131], a[244:247]
  v_mfma_f32_16x16x32_bf16 a[248:251], v[72:75], v[132:135], a[248:251]
  v_mfma_f32_16x16x32_bf16 a[252:255], v[72:75], v[136:139], a[252:255]
  s_waitcnt lgkmcnt(0)
  v_mfma_f32_16x16x32_bf16 a[0:3], v[76:79], v[140:143], a[0:3]
  s_barrier
  s_add_u32 m0, s52, 65536
  v_mfma_f32_16x16x32_bf16 a[4:7], v[76:79], v[144:147], a[4:7]
  s_cbranch_vccz L_gd_68
  buffer_load_dwordx4 v2, s[8:11], s20 offen  lds
L_gd_68:
  v_mfma_f32_16x16x32_bf16 a[8:11], v[76:79], v[148:151], a[8:11]
  v_mfma_f32_16x16x32_bf16 a[12:15], v[76:79], v[152:155], a[12:15]
  s_add_u32 m0, s53, 65536
  v_mfma_f32_16x16x32_bf16 a[16:19], v[76:79], v[156:159], a[16:19]
  s_cbranch_vccz L_gd_69
  buffer_load_dwordx4 v10, s[12:15], s21 offen  lds
L_gd_69:
  v_mfma_f32_16x16x32_bf16 a[20:23], v[76:79], v[160:163], a[20:23]
  v_mfma_f32_16x16x32_bf16 a[24:27], v[76:79], v[164:167], a[24:27]
  v_mfma_f32_16x16x32_bf16 a[28:31], v[76:79], v[168:171], a[28:31]
  s_add_u32 m0, s52, 66560
  v_mfma_f32_16x16x32_bf16 a[32:35], v[80:83], v[140:143], a[32:35]
  s_cbranch_vccz L_gd_70
  buffer_load_dwordx4 v3, s[8:11], s20 offen  lds
L_gd_70:
  v_mfma_f32_16x16x32_bf16 a[36:39], v[80:83], v[144:147], a[36:39]
  v_mfma_f32_16x16x32_bf16 a[40:43], v[80:83], v[148:151], a[40:43]
  v_mfma_f32_16x16x32_bf16 a[44:47], v[80:83], v[152:155], a[44:47]
  s_add_u32 m0, s53, 66560
  v_mfma_f32_16x16x32_bf16 a[48:51], v[80:83], v[156:159], a[48:51]
  s_cbranch_vccz L_gd_71
  buffer_load_dwordx4 v11, s[12:15], s21 offen  lds
L_gd_71:
  v_mfma_f32_16x16x32_bf16 a[52:55], v[80:83], v[160:163], a[52:55]
  v_mfma_f32_16x16x32_bf16 a[56:59], v[80:83], v[164:167], a[56:59]
  v_mfma_f32_16x16x32_bf16 a[60:63], v[80:83], v[168:171], a[60:63]
  s_add_u32 m0, s52, 67584
  v_mfma_f32_16x16x32_bf16 a[64:67], v[84:87], v[140:143], a[64:67]
  s_cbranch_vccz L_gd_72
  buffer_load_dwordx4 v4, s[8:11], s20 offen  lds
L_gd_72:
  v_mfma_f32_16x16x32_bf16 a[68:71], v[84:87], v[144:147], a[68:71]
  v_mfma_f32_16x16x32_bf16 a[72:75], v[84:87], v[148:151], a[72:75]
  v_mfma_f32_16x16x32_bf16 a[76:79], v[84:87], v[152:155], a[76:79]
  s_add_u32 m0, s53, 67584
  v_mfma_f32_16x16x32_bf16 a[80:83], v[84:87], v[156:159], a[80:83]
  s_cbranch_vccz L_gd_73
  buffer_load_dwordx4 v12, s[12:15], s21 offen  lds
L_gd_73:
  v_mfma_f32_16x16x32_bf16 a[84:87], v[84:87], v[160:163], a[84:87]
  v_mfma_f32_16x16x32_bf16 a[88:91], v[84:87], v[164:167], a[88:91]
  v_mfma_f32_16x16x32_bf16 a[92:95], v[84:87], v[168:171], a[92:95]
  s_add_u32 m0, s52, 68608
  v_mfma_f32_16x16x32_bf16 a[96:99], v[88:91], v[140:143], a[96:99]
  s_cbranch_vccz L_gd_74
  buffer_load_dwordx4 v5, s[8:11], s20 offen  lds
L_gd_74:
  v_mfma_f32_16x16x32_bf16 a[100:103], v[88:91], v[144:147], a[100:103]
  v_mfma_f32_16x16x32_bf16 a[104:107], v[88:91], v[148:151], a[104:107]
  v_mfma_f32_16x16x32_bf16 a[108:111], v[88:91], v[152:155], a[108:111]
  s_add_u32 m0, s53, 68608
  v_mfma_f32_16x16x32_bf16 a[112:115], v[88:91], v[156:159], a[112:115]
  s_cbranch_vccz L_gd_75
  buffer_load_dwordx4 v13, s[12:15], s21 offen  lds
L_gd_75:
  v_mfma_f32_16x16x32_bf16 a[116:119], v[88:91], v[160:163], a[116:119]
  v_mfma_f32_16x16x32_bf16 a[120:123], v[88:91], v[164:167], a[120:123]
  v_mfma_f32_16x16x32_bf16 a[124:127], v[88:91], v[168:171], a[124:127]
  s_add_u32 m0, s52, 69632
  v_mfma_f32_16x16x32_bf16 a[128:131], v[92:95], v[140:143], a[128:131]
  s_cbranch_vccz L_gd_76
  buffer_load_dwordx4 v6, s[8:11], s20 offen  lds
L_gd_76:
  v_mfma_f32_16x16x32_bf16 a[132:135], v[92:95], v[144:147], a[132:135]
  v_mfma_f32_16x16x32_bf16 a[136:139], v[92:95], v[148:151], a[136:139]
  v_mfma_f32_16x16x32_bf16 a[140:143], v[92:95], v[152:155], a[140:143]
  s_add_u32 m0, s53, 69632
  v_mfma_f32_16x16x32_bf16 a[144:147], v[92:95], v[156:159], a[144:147]
  s_cbranch_vccz L_gd_77
  buffer_load_dwordx4 v14, s[12:15], s21 offen  lds
L_gd_77:
  v_mfma_f32_16x16x32_bf16 a[148:151], v[92:95], v[160:163], a[148:151]
  v_mfma_f32_16x16x32_bf16 a[152:155], v[92:95], v[164:167], a[152:155]
  v_mfma_f32_16x16x32_bf16 a[156:159], v[92:95], v[168:171], a[156:159]
  s_add_u32 m0, s52, 70656
  v_mfma_f32_16x16x32_bf16 a[160:163], v[96:99], v[140:143], a[160:163]
  s_cbranch_vccz L_gd_78
  buffer_load_dwordx4 v7, s[8:11], s20 offen  lds
L_gd_78:
  v_mfma_f32_16x16x32_bf16 a[164:167], v[96:99], v[144:147], a[164:167]
  v_mfma_f32_16x16x32_bf16 a[168:171], v[96:99], v[148:151], a[168:171]
  v_mfma_f32_16x16x32_bf16 a[172:175], v[96:99], v[152:155], a[172:175]
  s_add_u32 m0, s53, 70656
  v_mfma_f32_16x16x32_bf16 a[176:179], v[96:99], v[156:159], a[176:179]
  s_cbranch_vccz L_gd_79
  buffer_load_dwordx4 v15, s[12:15], s21 offen  lds
L_gd_79:
  v_mfma_f32_16x16x32_bf16 a[180:183], v[96:99], v[160:163], a[180:183]
  v_mfma_f32_16x16x32_bf16 a[184:187], v[96:99], v[164:167], a[184:187]
  v_mfma_f32_16x16x32_bf16 a[188:191], v[96:99], v[168:171], a[188:191]
  s_add_u32 m0, s52, 71680
  v_mfma_f32_16x16x32_bf16 a[192:195], v[100:103], v[140:143], a[192:195]
  s_cbranch_vccz L_gd_80
  buffer_load_dwordx4 v8, s[8:11], s20 offen  lds
L_gd_80:
  v_mfma_f32_16x16x32_bf16 a[196:199], v[100:103], v[144:147], a[196:199]
  v_mfma_f32_16x16x32_bf16 a[200:203], v[100:103], v[148:151], a[200:203]
  v_mfma_f32_16x16x32_bf16 a[204:207], v[100:103], v[152:155], a[204:207]
  s_add_u32 m0, s53, 71680
  v_mfma_f32_16x16x32_bf16 a[208:211], v[100:103], v[156:159], a[208:211]
  s_cbranch_vccz L_gd_81
  buffer_load_dwordx4 v16, s[12:15], s21 offen  lds
L_gd_81:
  v_mfma_f32_16x16x32_bf16 a[212:215], v[100:103], v[160:163], a[212:215]
  v_mfma_f32_16x16x32_bf16 a[216:219], v[100:103], v[164:167], a[216:219]
  v_mfma_f32_16x16x32_bf16 a[220:223], v[100:103], v[168:171], a[220:223]
  s_add_u32 m0, s52, 72704
  v_mfma_f32_16x16x32_bf16 a[224:227], v[104:107], v[140:143], a[224:227]
  s_cbranch_vccz L_gd_82
  buffer_load_dwordx4 v9, s[8:11], s20 offen  lds
L_gd_82:
  v_mfma_f32_16x16x32_bf16 a[228:231], v[104:107], v[144:147], a[228:231]
  v_mfma_f32_16x16x32_bf16 a[232:235], v[104:107], v[148:151], a[232:235]
  v_mfma_f32_16x16x32_bf16 a[236:239], v[104:107], v[152:155], a[236:239]
  s_add_u32 m0, s53, 72704
  v_mfma_f32_16x16x32_bf16 a[240:243], v[104:107], v[156:159], a[240:243]
  s_cbranch_vccz L_gd_83
  buffer_load_dwordx4 v17, s[12:15], s21 offen  lds
  s_add_u32 s20, s20, 128
  s_add_u32 s21, s21, s51
L_gd_83:
  v_mfma_f32_16x16x32_bf16 a[244:247], v[104:107], v[160:163], a[244:247]
  v_mfma_f32_16x16x32_bf16 a[248:251], v[104:107], v[164:167], a[248:251]
  v_mfma_f32_16x16x32_bf16 a[252:255], v[104:107], v[168:171], a[252:255]
  s_cmp_eq_u32 s58, 1
  s_cbranch_scc1 L_epi
  s_branch L_have1
L_g2_cw:
  s_mov_b64 exec, 1
  ds_write_b32 v175, v244
  s_mov_b64 exec, -1
  s_branch L_g2_cwb
L_g2_cr:
  ds_read_b32 v246, v241
  s_cmp_eq_u32 s25, 1
  s_cbranch_scc1 L_g2_crb
  s_cmp_lg_u32 s32, 0
  s_cbranch_scc1 L_rq_84
  s_cmp_eq_u32 s39, 0
  s_cbranch_scc1 L_rq_84
  s_lshl_b32 s99, s33, 7
  s_add_u32 s99, s99, 0x3d00200
  v_mov_b32 v244, 1
  v_mov_b32 v245, 0
  s_mov_b64 exec, 1
  buffer_atomic_add v244, v245, s[4:7], s99 offen sc0 sc1
  s_mov_b64 exec, -1
L_rq_84:
  s_branch L_g2_crb
L_small:
  s_mov_b32 s8, s64
  s_and_b32 s9, s65, 0xffff
  s_mov_b32 s10, 0x400000
  s_mov_b32 s11, 0x20000
  s_cmp_eq_u32 s35, 9
  s_cselect_b64 s[88:89], s[70:71], s[72:73]
  s_mov_b32 s12, s88
  s_and_b32 s13, s89, 0xffff
  s_mov_b32 s14, 0x800000
  s_mov_b32 s15, 0x20000
  s_lshl_b32 s91, s33, 3
  s_add_u32 s91, s91, s37
  s_mov_b32 s24, 8192
  s_mov_b32 s26, 262144
  s_mov_b32 s23, 2048
  s_mov_b32 s25, 4
  s_lshl_b32 s20, s36, 18
  s_lshl_b32 s21, s91, 8
  s_sub_u32 s22, s35, 8
  s_lshl_b32 s22, s22, 24
  s_lshl_b32 s90, s36, 20
  s_add_u32 s22, s22, s90
  s_lshl_b32 s90, s91, 13
  s_add_u32 s22, s22, s90
  s_lshl_b32 s38, s36, 9
  s_add_u32 s38, s38, 28672
  s_lshl_b32 s90, s33, 7
  s_add_u32 s38, s38, s90
  v_and_b32 v1, 63, v0
  v_lshrrev_b32 v22, 6, v0
  s_nop 0
  v_readfirstlane_b32 s27, v22
  s_mul_i32 s90, s27, 32
  v_lshrrev_b32 v22, 3, v1
  v_add_u32 v22, s90, v22
  v_mul_lo_u32 v22, v22, s23
  v_lshrrev_b32 v23, 4, v1
  v_xor_b32 v23, v23, v1
  v_and_b32 v23, 7, v23
  v_lshl_add_u32 v2, v23, 4, v22
  s_mul_i32 s91, s23, 8
  v_add_u32 v3, s91, v2
  v_xor_b32 v3, 64, v3
  v_add_u32 v4, s91, v3
  v_xor_b32 v4, 64, v4
  v_add_u32 v5, s91, v4
  v_xor_b32 v5, 64, v5
  s_mul_i32 s90, s27, 16
  v_lshrrev_b32 v22, 4, v1
  v_add_u32 v22, 0, v22
  v_add_u32 v22, s90, v22
  v_and_b32 v23, 3, v22
  v_lshlrev_b32 v23, 1, v23
  v_and_b32 v24, 8, v22
  v_or_b32 v23, v23, v24
  v_xor_b32 v23, v23, v1
  v_and_b32 v23, 15, v23
  v_mul_lo_u32 v22, v22, s24
  v_lshl_add_u32 v6, v23, 4, v22
  v_lshrrev_b32 v22, 4, v1
  v_add_u32 v22, 4, v22
  v_add_u32 v22, s90, v22
  v_and_b32 v23, 3, v22
  v_lshlrev_b32 v23, 1, v23
  v_and_b32 v24, 8, v22
  v_or_b32 v23, v23, v24
  v_xor_b32 v23, v23, v1
  v_and_b32 v23, 15, v23
  v_mul_lo_u32 v22, v22, s24
  v_lshl_add_u32 v7, v23, 4, v22
  v_lshrrev_b32 v22, 4, v1
  v_add_u32 v22, 8, v22
  v_add_u32 v22, s90, v22
  v_and_b32 v23, 3, v22
  v_lshlrev_b32 v23, 1, v23
  v_and_b32 v24, 8, v22
  v_or_b32 v23, v23, v24
  v_xor_b32 v23, v23, v1
  v_and_b32 v23, 15, v23
  v_mul_lo_u32 v22, v22, s24
  v_lshl_add_u32 v8, v23, 4, v22
  v_lshrrev_b32 v22, 4, v1
  v_add_u32 v22, 12, v22
  v_add_u32 v22, s90, v22
  v_and_b32 v23, 3, v22
  v_lshlrev_b32 v23, 1, v23
  v_and_b32 v24, 8, v22
  v_or_b32 v23, v23, v24
  v_xor_b32 v23, v23, v1
  v_and_b32 v23, 15, v23
  v_mul_lo_u32 v22, v22, s24
  v_lshl_add_u32 v9, v23, 4, v22
  s_mul_i32 s51, s24, 64
  s_mul_i32 s52, s27, 4096
  s_mul_i32 s53, s27, 4096
  s_add_u32 s53, s53, 16384
  s_add_u32 m0, s52, 0
  s_nop 0
  buffer_load_dwordx4 v2, s[8:11], s20 offen  lds
  s_add_u32 m0, s53, 0
  s_nop 0
  buffer_load_dwordx4 v6, s[12:15], s21 offen  lds
  s_add_u32 m0, s52, 1024
  s_nop 0
  buffer_load_dwordx4 v3, s[8:11], s20 offen  lds
  s_add_u32 m0, s53, 1024
  s_nop 0
  buffer_load_dwordx4 v7, s[12:15], s21 offen  lds
  s_add_u32 m0, s52, 2048
  s_nop 0
  buffer_load_dwordx4 v4, s[8:11], s20 offen  lds
  s_add_u32 m0, s53, 2048
  s_nop 0
  buffer_load_dwordx4 v8, s[12:15], s21 offen  lds
  s_add_u32 m0, s52, 3072
  s_nop 0
  buffer_load_dwordx4 v5, s[8:11], s20 offen  lds
  s_add_u32 m0, s53, 3072
  s_nop 0
  buffer_load_dwordx4 v9, s[12:15], s21 offen  lds
  s_add_u32 s20, s20, 128
  s_add_u32 s21, s21, s51
  s_add_u32 m0, s52, 32768
  s_nop 0
  buffer_load_dwordx4 v2, s[8:11], s20 offen  lds
  s_add_u32 m0, s53, 32768
  s_nop 0
  buffer_load_dwordx4 v6, s[12:15], s21 offen  lds
  s_add_u32 m0, s52, 33792
  s_nop 0
  buffer_load_dwordx4 v3, s[8:11], s20 offen  lds
  s_add_u32 m0, s53, 33792
  s_nop 0
  buffer_load_dwordx4 v7, s[12:15], s21 offen  lds
  s_add_u32 m0, s52, 34816
  s_nop 0
  buffer_load_dwordx4 v4, s[8:11], s20 offen  lds
  s_add_u32 m0, s53, 34816
  s_nop 0
  buffer_load_dwordx4 v8, s[12:15], s21 offen  lds
  s_add_u32 m0, s52, 35840
  s_nop 0
  buffer_load_dwordx4 v5, s[8:11], s20 offen  lds
  s_add_u32 m0, s53, 35840
  s_nop 0
  buffer_load_dwordx4 v9, s[12:15], s21 offen  lds
  s_add_u32 s20, s20, 128
  s_add_u32 s21, s21, s51
  s_add_u32 m0, s52, 65536
  s_nop 0
  buffer_load_dwordx4 v2, s[8:11], s20 offen  lds
  s_add_u32 m0, s53, 65536
  s_nop 0
  buffer_load_dwordx4 v6, s[12:15], s21 offen  lds
  s_add_u32 m0, s52, 66560
  s_nop 0
  buffer_load_dwordx4 v3, s[8:11], s20 offen  lds
  s_add_u32 m0, s53, 66560
  s_nop 0
  buffer_load_dwordx4 v7, s[12:15], s21 offen  lds
  s_add_u32 m0, s52, 67584
  s_nop 0
  buffer_load_dwordx4 v4, s[8:11], s20 offen  lds
  s_add_u32 m0, s53, 67584
  s_nop 0
  buffer_load_dwordx4 v8, s[12:15], s21 offen  lds
  s_add_u32 m0, s52, 68608
  s_nop 0
  buffer_load_dwordx4 v5, s[8:11], s20 offen  lds
  s_add_u32 m0, s53, 68608
  s_nop 0
  buffer_load_dwordx4 v9, s[12:15], s21 offen  lds
  s_add_u32 s20, s20, 128
  s_add_u32 s21, s21, s51
  s_add_u32 m0, s52, 98304
  s_nop 0
  buffer_load_dwordx4 v2, s[8:11], s20 offen  lds
  s_add_u32 m0, s53, 98304
  s_nop 0
  buffer_load_dwordx4 v6, s[12:15], s21 offen  lds
  s_add_u32 m0, s52, 99328
  s_nop 0
  buffer_load_dwordx4 v3, s[8:11], s20 offen  lds
  s_add_u32 m0, s53, 99328
  s_nop 0
  buffer_load_dwordx4 v7, s[12:15], s21 offen  lds
  s_add_u32 m0, s52, 100352
  s_nop 0
  buffer_load_dwordx4 v4, s[8:11], s20 offen  lds
  s_add_u32 m0, s53, 100352
  s_nop 0
  buffer_load_dwordx4 v8, s[12:15], s21 offen  lds
  s_add_u32 m0, s52, 101376
  s_nop 0
  buffer_load_dwordx4 v5, s[8:11], s20 offen  lds
  s_add_u32 m0, s53, 101376
  s_nop 0
  buffer_load_dwordx4 v9, s[12:15], s21 offen  lds
  s_add_u32 s20, s20, 128
  s_add_u32 s21, s21, s51
  s_lshr_b32 s90, s27, 1
  s_and_b32 s91, s27, 1
  s_mul_i32 s92, s90, 8192
  v_mov_b32 v22, 0x0
  v_bfe_u32 v23, v1, 0, 4
  v_lshl_add_u32 v22, v23, 7, v22
  v_add_u32 v22, s92, v22
  v_lshrrev_b32 v23, 1, v1
  v_and_b32 v23, 7, v23
  v_lshrrev_b32 v24, 4, v1
  v_xor_b32 v23, v23, v24
  v_lshl_add_u32 v10, v23, 4, v22
  v_xor_b32 v11, 64, v10
  v_add_u32 v12, 65536, v10
  v_add_u32 v13, 65536, v11
  v_mov_b32 v22, 0x0
  v_bfe_u32 v23, v1, 2, 2
  v_lshl_add_u32 v22, v23, 8, v22
  v_bfe_u32 v23, v1, 4, 2
  v_lshl_add_u32 v22, v23, 11, v22
  v_bfe_u32 v23, v1, 0, 2
  v_lshl_add_u32 v22, v23, 3, v22
  v_bfe_u32 v24, v1, 2, 3
  s_mul_i32 s92, s91, 4
  s_add_u32 s93, s92, 0
  v_xor_b32 v23, s93, v24
  v_lshl_add_u32 v14, v23, 5, v22
  v_add_u32 v18, 65536, v14
  s_add_u32 s93, s92, 1
  v_xor_b32 v23, s93, v24
  v_lshl_add_u32 v15, v23, 5, v22
  v_add_u32 v19, 65536, v15
  s_add_u32 s93, s92, 2
  v_xor_b32 v23, s93, v24
  v_lshl_add_u32 v16, v23, 5, v22
  v_add_u32 v20, 65536, v16
  s_add_u32 s93, s92, 3
  v_xor_b32 v23, s93, v24
  v_lshl_add_u32 v17, v23, 5, v22
  v_add_u32 v21, 65536, v17
  s_mov_b32 s58, 2
  s_branch L_epi
L_r2:
  v_lshlrev_b32 v174, 7, v1
  s_sub_u32 s42, s34, 32
  s_lshl_b32 s40, s42, 2
  s_add_u32 s40, s40, s33
  s_lshl_b32 s40, s40, 2
  s_add_u32 s40, s40, s32
  s_lshl_b32 s40, s40, 13
  s_cmp_ge_u32 s42, 16
  s_cselect_b32 s40, 0x40000000, s40
  s_add_u32 s41, s40, 2097152
  s_mov_b32 s44, s64
  s_and_b32 s45, s65, 0xffff
  s_mov_b32 s46, 0x400000
  s_mov_b32 s47, 0x20000
  buffer_load_dword v175, v174, s[44:47], s40 offen
  s_mov_b32 s44, s64
  s_and_b32 s45, s65, 0xffff
  s_mov_b32 s46, 0x400000
  s_mov_b32 s47, 0x20000
  buffer_load_dword v175, v174, s[44:47], s41 offen
  s_cmp_eq_u32 s35, 10
  s_cbranch_scc1 L_g5
  s_waitcnt vmcnt(26)
  s_barrier
  ds_read_b128 v[28:31], v10 offset:0
  ds_read_b64_tr_b16 v[60:61], v14 offset:16384
  ds_read_b64_tr_b16 v[62:63], v14 offset:17408
  ds_read_b128 v[32:35], v10 offset:2048
  ds_read_b64_tr_b16 v[64:65], v15 offset:16384
  ds_read_b64_tr_b16 v[66:67], v15 offset:17408
  ds_read_b128 v[36:39], v10 offset:4096
  ds_read_b64_tr_b16 v[68:69], v16 offset:16384
  ds_read_b64_tr_b16 v[70:71], v16 offset:17408
  ds_read_b128 v[40:43], v10 offset:6144
  ds_read_b64_tr_b16 v[72:73], v17 offset:16384
  ds_read_b64_tr_b16 v[74:75], v17 offset:17408
  s_sub_u32 s25, s25, 1
  s_waitcnt lgkmcnt(0)
  v_mfma_f32_16x16x32_bf16 a[0:3], v[60:63], v[28:31], 0
  ds_read_b128 v[44:47], v11 offset:0
  v_mfma_f32_16x16x32_bf16 a[4:7], v[64:67], v[28:31], 0
  ds_read_b64_tr_b16 v[76:77], v14 offset:24576
  v_mfma_f32_16x16x32_bf16 a[8:11], v[68:71], v[28:31], 0
  ds_read_b64_tr_b16 v[78:79], v14 offset:25600
  v_mfma_f32_16x16x32_bf16 a[12:15], v[72:75], v[28:31], 0
  ds_read_b128 v[48:51], v11 offset:2048
  v_mfma_f32_16x16x32_bf16 a[16:19], v[60:63], v[32:35], 0
  ds_read_b64_tr_b16 v[80:81], v15 offset:24576
  v_mfma_f32_16x16x32_bf16 a[20:23], v[64:67], v[32:35], 0
  ds_read_b64_tr_b16 v[82:83], v15 offset:25600
  v_mfma_f32_16x16x32_bf16 a[24:27], v[68:71], v[32:35], 0
  ds_read_b128 v[52:55], v11 offset:4096
  v_mfma_f32_16x16x32_bf16 a[28:31], v[72:75], v[32:35], 0
  ds_read_b64_tr_b16 v[84:85], v16 offset:24576
  v_mfma_f32_16x16x32_bf16 a[32:35], v[60:63], v[36:39], 0
  ds_read_b64_tr_b16 v[86:87], v16 offset:25600
  v_mfma_f32_16x16x32_bf16 a[36:39], v[64:67], v[36:39], 0
  ds_read_b128 v[56:59], v11 offset:6144
  v_mfma_f32_16x16x32_bf16 a[40:43], v[68:71], v[36:39], 0
  ds_read_b64_tr_b16 v[88:89], v17 offset:24576
  v_mfma_f32_16x16x32_bf16 a[44:47], v[72:75], v[36:39], 0
  ds_read_b64_tr_b16 v[90:91], v17 offset:25600
  v_mfma_f32_16x16x32_bf16 a[48:51], v[60:63], v[40:43], 0
  v_mfma_f32_16x16x32_bf16 a[52:55], v[64:67], v[40:43], 0
  v_mfma_f32_16x16x32_bf16 a[56:59], v[68:71], v[40:43], 0
  v_mfma_f32_16x16x32_bf16 a[60:63], v[72:75], v[40:43], 0
  s_waitcnt lgkmcnt(0)
  v_mfma_f32_16x16x32_bf16 a[0:3], v[76:79], v[44:47], a[0:3]
  s_waitcnt vmcnt(18)
  s_barrier
  s_add_u32 m0, s52, 0
  v_mfma_f32_16x16x32_bf16 a[4:7], v[80:83], v[44:47], a[4:7]
  buffer_load_dwordx4 v2, s[8:11], s20 offen  lds
  ds_read_b128 v[28:31], v10 offset:32768
  v_mfma_f32_16x16x32_bf16 a[8:11], v[84:87], v[44:47], a[8:11]
  ds_read_b64_tr_b16 v[60:61], v14 offset:49152
  v_mfma_f32_16x16x32_bf16 a[12:15], v[88:91], v[44:47], a[12:15]
  ds_read_b64_tr_b16 v[62:63], v14 offset:50176
  s_add_u32 m0, s53, 0
  v_mfma_f32_16x16x32_bf16 a[16:19], v[76:79], v[48:51], a[16:19]
  buffer_load_dwordx4 v6, s[12:15], s21 offen  lds
  ds_read_b128 v[32:35], v10 offset:34816
  v_mfma_f32_16x16x32_bf16 a[20:23], v[80:83], v[48:51], a[20:23]
  ds_read_b64_tr_b16 v[64:65], v15 offset:49152
  v_mfma_f32_16x16x32_bf16 a[24:27], v[84:87], v[48:51], a[24:27]
  ds_read_b64_tr_b16 v[66:67], v15 offset:50176
  s_add_u32 m0, s52, 1024
  v_mfma_f32_16x16x32_bf16 a[28:31], v[88:91], v[48:51], a[28:31]
  buffer_load_dwordx4 v3, s[8:11], s20 offen  lds
  ds_read_b128 v[36:39], v10 offset:36864
  v_mfma_f32_16x16x32_bf16 a[32:35], v[76:79], v[52:55], a[32:35]
  ds_read_b64_tr_b16 v[68:69], v16 offset:49152
  v_mfma_f32_16x16x32_bf16 a[36:39], v[80:83], v[52:55], a[36:39]
  ds_read_b64_tr_b16 v[70:71], v16 offset:50176
  s_add_u32 m0, s53, 1024
  v_mfma_f32_16x16x32_bf16 a[40:43], v[84:87], v[52:55], a[40:43]
  buffer_load_dwordx4 v7, s[12:15], s21 offen  lds
  ds_read_b128 v[40:43], v10 offset:38912
  v_mfma_f32_16x16x32_bf16 a[44:47], v[88:91], v[52:55], a[44:47]
  ds_read_b64_tr_b16 v[72:73], v17 offset:49152
  v_mfma_f32_16x16x32_bf16 a[48:51], v[76:79], v[56:59], a[48:51]
  ds_read_b64_tr_b16 v[74:75], v17 offset:50176
  s_add_u32 m0, s52, 2048
  v_mfma_f32_16x16x32_bf16 a[52:55], v[80:83], v[56:59], a[52:55]
  buffer_load_dwordx4 v4, s[8:11], s20 offen  lds
  v_mfma_f32_16x16x32_bf16 a[56:59], v[84:87], v[56:59], a[56:59]
  v_mfma_f32_16x16x32_bf16 a[60:63], v[88:91], v[56:59], a[60:63]
  s_waitcnt lgkmcnt(0)
  s_add_u32 m0, s53, 2048
  v_mfma_f32_16x16x32_bf16 a[0:3], v[60:63], v[28:31], a[0:3]
  buffer_load_dwordx4 v8, s[12:15], s21 offen  lds
  ds_read_b128 v[44:47], v11 offset:32768
  v_mfma_f32_16x16x32_bf16 a[4:7], v[64:67], v[28:31], a[4:7]
  ds_read_b64_tr_b16 v[76:77], v14 offset:57344
  v_mfma_f32_16x16x32_bf16 a[8:11], v[68:71], v[28:31], a[8:11]
  ds_read_b64_tr_b16 v[78:79], v14 offset:58368
  v_mfma_f32_16x16x32_bf16 a[12:15], v[72:75], v[28:31], a[12:15]
  ds_read_b128 v[48:51], v11 offset:34816
  s_add_u32 m0, s52, 3072
  v_mfma_f32_16x16x32_bf16 a[16:19], v[60:63], v[32:35], a[16:19]
  buffer_load_dwordx4 v5, s[8:11], s20 offen  lds
  ds_read_b64_tr_b16 v[80:81], v15 offset:57344
  v_mfma_f32_16x16x32_bf16 a[20:23], v[64:67], v[32:35], a[20:23]
  ds_read_b64_tr_b16 v[82:83], v15 offset:58368
  v_mfma_f32_16x16x32_bf16 a[24:27], v[68:71], v[32:35], a[24:27]
  ds_read_b128 v[52:55], v11 offset:36864
  v_mfma_f32_16x16x32_bf16 a[28:31], v[72:75], v[32:35], a[28:31]
  ds_read_b64_tr_b16 v[84:85], v16 offset:57344
  s_add_u32 m0, s53, 3072
  v_mfma_f32_16x16x32_bf16 a[32:35], v[60:63], v[36:39], a[32:35]
  buffer_load_dwordx4 v9, s[12:15], s21 offen  lds
  ds_read_b64_tr_b16 v[86:87], v16 offset:58368
  v_mfma_f32_16x16x32_bf16 a[36:39], v[64:67], v[36:39], a[36:39]
  ds_read_b128 v[56:59], v11 offset:38912
  v_mfma_f32_16x16x32_bf16 a[40:43], v[68:71], v[36:39], a[40:43]
  ds_read_b64_tr_b16 v[88:89], v17 offset:57344
  v_mfma_f32_16x16x32_bf16 a[44:47], v[72:75], v[36:39], a[44:47]
  ds_read_b64_tr_b16 v[90:91], v17 offset:58368
  s_add_u32 s20, s20, 128
  v_mfma_f32_16x16x32_bf16 a[48:51], v[60:63], v[40:43], a[48:51]
  s_add_u32 s21, s21, s51
  v_mfma_f32_16x16x32_bf16 a[52:55], v[64:67], v[40:43], a[52:55]
  v_mfma_f32_16x16x32_bf16 a[56:59], v[68:71], v[40:43], a[56:59]
  v_mfma_f32_16x16x32_bf16 a[60:63], v[72:75], v[40:43], a[60:63]
  s_waitcnt lgkmcnt(0)
  v_mfma_f32_16x16x32_bf16 a[0:3], v[76:79], v[44:47], a[0:3]
  s_waitcnt vmcnt(18)
  s_barrier
  s_add_u32 m0, s52, 32768
  v_mfma_f32_16x16x32_bf16 a[4:7], v[80:83], v[44:47], a[4:7]
  buffer_load_dwordx4 v2, s[8:11], s20 offen  lds
  ds_read_b128 v[28:31], v12 offset:0
  v_mfma_f32_16x16x32_bf16 a[8:11], v[84:87], v[44:47], a[8:11]
  ds_read_b64_tr_b16 v[60:61], v18 offset:16384
  v_mfma_f32_16x16x32_bf16 a[12:15], v[88:91], v[44:47], a[12:15]
  ds_read_b64_tr_b16 v[62:63], v18 offset:17408
  s_add_u32 m0, s53, 32768
  v_mfma_f32_16x16x32_bf16 a[16:19], v[76:79], v[48:51], a[16:19]
  buffer_load_dwordx4 v6, s[12:15], s21 offen  lds
  ds_read_b128 v[32:35], v12 offset:2048
  v_mfma_f32_16x16x32_bf16 a[20:23], v[80:83], v[48:51], a[20:23]
  ds_read_b64_tr_b16 v[64:65], v19 offset:16384
  v_mfma_f32_16x16x32_bf16 a[24:27], v[84:87], v[48:51], a[24:27]
  ds_read_b64_tr_b16 v[66:67], v19 offset:17408
  s_add_u32 m0, s52, 33792
  v_mfma_f32_16x16x32_bf16 a[28:31], v[88:91], v[48:51], a[28:31]
  buffer_load_dwordx4 v3, s[8:11], s20 offen  lds
  ds_read_b128 v[36:39], v12 offset:4096
  v_mfma_f32_16x16x32_bf16 a[32:35], v[76:79], v[52:55], a[32:35]
  ds_read_b64_tr_b16 v[68:69], v20 offset:16384
  v_mfma_f32_16x16x32_bf16 a[36:39], v[80:83], v[52:55], a[36:39]
  ds_read_b64_tr_b16 v[70:71], v20 offset:17408
  s_add_u32 m0, s53, 33792
  v_mfma_f32_16x16x32_bf16 a[40:43], v[84:87], v[52:55], a[40:43]
  buffer_load_dwordx4 v7, s[12:15], s21 offen  lds
  ds_read_b128 v[40:43], v12 offset:6144
  v_mfma_f32_16x16x32_bf16 a[44:47], v[88:91], v[52:55], a[44:47]
  ds_read_b64_tr_b16 v[72:73], v21 offset:16384
  v_mfma_f32_16x16x32_bf16 a[48:51], v[76:79], v[56:59], a[48:51]
  ds_read_b64_tr_b16 v[74:75], v21 offset:17408
  s_add_u32 m0, s52, 34816
  v_mfma_f32_16x16x32_bf16 a[52:55], v[80:83], v[56:59], a[52:55]
  buffer_load_dwordx4 v4, s[8:11], s20 offen  lds
  v_mfma_f32_16x16x32_bf16 a[56:59], v[84:87], v[56:59], a[56:59]
  v_mfma_f32_16x16x32_bf16 a[60:63], v[88:91], v[56:59], a[60:63]
  s_waitcnt lgkmcnt(0)
  s_add_u32 m0, s53, 34816
  v_mfma_f32_16x16x32_bf16 a[0:3], v[60:63], v[28:31], a[0:3]
  buffer_load_dwordx4 v8, s[12:15], s21 offen  lds
  ds_read_b128 v[44:47], v13 offset:0
  v_mfma_f32_16x16x32_bf16 a[4:7], v[64:67], v[28:31], a[4:7]
  ds_read_b64_tr_b16 v[76:77], v18 offset:24576
  v_mfma_f32_16x16x32_bf16 a[8:11], v[68:71], v[28:31], a[8:11]
  ds_read_b64_tr_b16 v[78:79], v18 offset:25600
  v_mfma_f32_16x16x32_bf16 a[12:15], v[72:75], v[28:31], a[12:15]
  ds_read_b128 v[48:51], v13 offset:2048
  s_add_u32 m0, s52, 35840
  v_mfma_f32_16x16x32_bf16 a[16:19], v[60:63], v[32:35], a[16:19]
  buffer_load_dwordx4 v5, s[8:11], s20 offen  lds
  ds_read_b64_tr_b16 v[80:81], v19 offset:24576
  v_mfma_f32_16x16x32_bf16 a[20:23], v[64:67], v[32:35], a[20:23]
  ds_read_b64_tr_b16 v[82:83], v19 offset:25600
  v_mfma_f32_16x16x32_bf16 a[24:27], v[68:71], v[32:35], a[24:27]
  ds_read_b128 v[52:55], v13 offset:4096
  v_mfma_f32_16x16x32_bf16 a[28:31], v[72:75], v[32:35], a[28:31]
  ds_read_b64_tr_b16 v[84:85], v20 offset:24576
  s_add_u32 m0, s53, 35840
  v_mfma_f32_16x16x32_bf16 a[32:35], v[60:63], v[36:39], a[32:35]
  buffer_load_dwordx4 v9, s[12:15], s21 offen  lds
  ds_read_b64_tr_b16 v[86:87], v20 offset:25600
  v_mfma_f32_16x16x32_bf16 a[36:39], v[64:67], v[36:39], a[36:39]
  ds_read_b128 v[56:59], v13 offset:6144
  v_mfma_f32_16x16x32_bf16 a[40:43], v[68:71], v[36:39], a[40:43]
  ds_read_b64_tr_b16 v[88:89], v21 offset:24576
  v_mfma_f32_16x16x32_bf16 a[44:47], v[72:75], v[36:39], a[44:47]
  ds_read_b64_tr_b16 v[90:91], v21 offset:25600
  s_add_u32 s20, s20, 128
  v_mfma_f32_16x16x32_bf16 a[48:51], v[60:63], v[40:43], a[48:51]
  s_add_u32 s21, s21, s51
  v_mfma_f32_16x16x32_bf16 a[52:55], v[64:67], v[40:43], a[52:55]
  v_mfma_f32_16x16x32_bf16 a[56:59], v[68:71], v[40:43], a[56:59]
  v_mfma_f32_16x16x32_bf16 a[60:63], v[72:75], v[40:43], a[60:63]
  s_waitcnt lgkmcnt(0)
  v_mfma_f32_16x16x32_bf16 a[0:3], v[76:79], v[44:47], a[0:3]
  s_waitcnt vmcnt(18)
  s_barrier
  s_add_u32 m0, s52, 65536
  v_mfma_f32_16x16x32_bf16 a[4:7], v[80:83], v[44:47], a[4:7]
  buffer_load_dwordx4 v2, s[8:11], s20 offen  lds
  ds_read_b128 v[28:31], v12 offset:32768
  v_mfma_f32_16x16x32_bf16 a[8:11], v[84:87], v[44:47], a[8:11]
  ds_read_b64_tr_b16 v[60:61], v18 offset:49152
  v_mfma_f32_16x16x32_bf16 a[12:15], v[88:91], v[44:47], a[12:15]
  ds_read_b64_tr_b16 v[62:63], v18 offset:50176
  s_add_u32 m0, s53, 65536
  v_mfma_f32_16x16x32_bf16 a[16:19], v[76:79], v[48:51], a[16:19]
  buffer_load_dwordx4 v6, s[12:15], s21 offen  lds
  ds_read_b128 v[32:35], v12 offset:34816
  v_mfma_f32_16x16x32_bf16 a[20:23], v[80:83], v[48:51], a[20:23]
  ds_read_b64_tr_b16 v[64:65], v19 offset:49152
  v_mfma_f32_16x16x32_bf16 a[24:27], v[84:87], v[48:51], a[24:27]
  ds_read_b64_tr_b16 v[66:67], v19 offset:50176
  s_add_u32 m0, s52, 66560
  v_mfma_f32_16x16x32_bf16 a[28:31], v[88:91], v[48:51], a[28:31]
  buffer_load_dwordx4 v3, s[8:11], s20 offen  lds
  ds_read_b128 v[36:39], v12 offset:36864
  v_mfma_f32_16x16x32_bf16 a[32:35], v[76:79], v[52:55], a[32:35]
  ds_read_b64_tr_b16 v[68:69], v20 offset:49152
  v_mfma_f32_16x16x32_bf16 a[36:39], v[80:83], v[52:55], a[36:39]
  ds_read_b64_tr_b16 v[70:71], v20 offset:50176
  s_add_u32 m0, s53, 66560
  v_mfma_f32_16x16x32_bf16 a[40:43], v[84:87], v[52:55], a[40:43]
  buffer_load_dwordx4 v7, s[12:15], s21 offen  lds
  ds_read_b128 v[40:43], v12 offset:38912
  v_mfma_f32_16x16x32_bf16 a[44:47], v[88:91], v[52:55], a[44:47]
  ds_read_b64_tr_b16 v[72:73], v21 offset:49152
  v_mfma_f32_16x16x32_bf16 a[48:51], v[76:79], v[56:59], a[48:51]
  ds_read_b64_tr_b16 v[74:75], v21 offset:50176
  s_add_u32 m0, s52, 67584
  v_mfma_f32_16x16x32_bf16 a[52:55], v[80:83], v[56:59], a[52:55]
  buffer_load_dwordx4 v4, s[8:11], s20 offen  lds
  v_mfma_f32_16x16x32_bf16 a[56:59], v[84:87], v[56:59], a[56:59]
  v_mfma_f32_16x16x32_bf16 a[60:63], v[88:91], v[56:59], a[60:63]
  s_waitcnt lgkmcnt(0)
  s_add_u32 m0, s53, 67584
  v_mfma_f32_16x16x32_bf16 a[0:3], v[60:63], v[28:31], a[0:3]
  buffer_load_dwordx4 v8, s[12:15], s21 offen  lds
  ds_read_b128 v[44:47], v13 offset:32768
  v_mfma_f32_16x16x32_bf16 a[4:7], v[64:67], v[28:31], a[4:7]
  ds_read_b64_tr_b16 v[76:77], v18 offset:57344
  v_mfma_f32_16x16x32_bf16 a[8:11], v[68:71], v[28:31], a[8:11]
  ds_read_b64_tr_b16 v[78:79], v18 offset:58368
  v_mfma_f32_16x16x32_bf16 a[12:15], v[72:75], v[28:31], a[12:15]
  ds_read_b128 v[48:51], v13 offset:34816
  s_add_u32 m0, s52, 68608
  v_mfma_f32_16x16x32_bf16 a[16:19], v[60:63], v[32:35], a[16:19]
  buffer_load_dwordx4 v5, s[8:11], s20 offen  lds
  ds_read_b64_tr_b16 v[80:81], v19 offset:57344
  v_mfma_f32_16x16x32_bf16 a[20:23], v[64:67], v[32:35], a[20:23]
  ds_read_b64_tr_b16 v[82:83], v19 offset:58368
  v_mfma_f32_16x16x32_bf16 a[24:27], v[68:71], v[32:35], a[24:27]
  ds_read_b128 v[52:55], v13 offset:36864
  v_mfma_f32_16x16x32_bf16 a[28:31], v[72:75], v[32:35], a[28:31]
  ds_read_b64_tr_b16 v[84:85], v20 offset:57344
  s_add_u32 m0, s53, 68608
  v_mfma_f32_16x16x32_bf16 a[32:35], v[60:63], v[36:39], a[32:35]
  buffer_load_dwordx4 v9, s[12:15], s21 offen  lds
  ds_read_b64_tr_b16 v[86:87], v20 offset:58368
  v_mfma_f32_16x16x32_bf16 a[36:39], v[64:67], v[36:39], a[36:39]
  ds_read_b128 v[56:59], v13 offset:38912
  v_mfma_f32_16x16x32_bf16 a[40:43], v[68:71], v[36:39], a[40:43]
  ds_read_b64_tr_b16 v[88:89], v21 offset:57344
  v_mfma_f32_16x16x32_bf16 a[44:47], v[72:75], v[36:39], a[44:47]
  ds_read_b64_tr_b16 v[90:91], v21 offset:58368
  s_add_u32 s20, s20, 128
  v_mfma_f32_16x16x32_bf16 a[48:51], v[60:63], v[40:43], a[48:51]
  s_add_u32 s21, s21, s51
  v_mfma_f32_16x16x32_bf16 a[52:55], v[64:67], v[40:43], a[52:55]
  v_mfma_f32_16x16x32_bf16 a[56:59], v[68:71], v[40:43], a[56:59]
  v_mfma_f32_16x16x32_bf16 a[60:63], v[72:75], v[40:43], a[60:63]
  s_waitcnt lgkmcnt(0)
  v_mfma_f32_16x16x32_bf16 a[0:3], v[76:79], v[44:47], a[0:3]
  s_waitcnt vmcnt(16)
  s_barrier
  s_add_u32 m0, s52, 98304
  v_mfma_f32_16x16x32_bf16 a[4:7], v[80:83], v[44:47], a[4:7]
  buffer_load_dwordx4 v2, s[8:11], s20 offen  lds
  ds_read_b128 v[28:31], v10 offset:0
  v_mfma_f32_16x16x32_bf16 a[8:11], v[84:87], v[44:47], a[8:11]
  ds_read_b64_tr_b16 v[60:61], v14 offset:16384
  v_mfma_f32_16x16x32_bf16 a[12:15], v[88:91], v[44:47], a[12:15]
  ds_read_b64_tr_b16 v[62:63], v14 offset:17408
  s_add_u32 m0, s53, 98304
  v_mfma_f32_16x16x32_bf16 a[16:19], v[76:79], v[48:51], a[16:19]
  buffer_load_dwordx4 v6, s[12:15], s21 offen  lds
  ds_read_b128 v[32:35], v10 offset:2048
  v_mfma_f32_16x16x32_bf16 a[20:23], v[80:83], v[48:51], a[20:23]
  ds_read_b64_tr_b16 v[64:65], v15 offset:16384
  v_mfma_f32_16x16x32_bf16 a[24:27], v[84:87], v[48:51], a[24:27]
  ds_read_b64_tr_b16 v[66:67], v15 offset:17408
  s_add_u32 m0, s52, 99328
  v_mfma_f32_16x16x32_bf16 a[28:31], v[88:91], v[48:51], a[28:31]
  buffer_load_dwordx4 v3, s[8:11], s20 offen  lds
  ds_read_b128 v[36:39], v10 offset:4096
  v_mfma_f32_16x16x32_bf16 a[32:35], v[76:79], v[52:55], a[32:35]
  ds_read_b64_tr_b16 v[68:69], v16 offset:16384
  v_mfma_f32_16x16x32_bf16 a[36:39], v[80:83], v[52:55], a[36:39]
  ds_read_b64_tr_b16 v[70:71], v16 offset:17408
  s_add_u32 m0, s53, 99328
  v_mfma_f32_16x16x32_bf16 a[40:43], v[84:87], v[52:55], a[40:43]
  buffer_load_dwordx4 v7, s[12:15], s21 offen  lds
  ds_read_b128 v[40:43], v10 offset:6144
  v_mfma_f32_16x16x32_bf16 a[44:47], v[88:91], v[52:55], a[44:47]
  ds_read_b64_tr_b16 v[72:73], v17 offset:16384
  v_mfma_f32_16x16x32_bf16 a[48:51], v[76:79], v[56:59], a[48:51]
  ds_read_b64_tr_b16 v[74:75], v17 offset:17408
  s_add_u32 m0, s52, 100352
  v_mfma_f32_16x16x32_bf16 a[52:55], v[80:83], v[56:59], a[52:55]
  buffer_load_dwordx4 v4, s[8:11], s20 offen  lds
  v_mfma_f32_16x16x32_bf16 a[56:59], v[84:87], v[56:59], a[56:59]
  v_mfma_f32_16x16x32_bf16 a[60:63], v[88:91], v[56:59], a[60:63]
L_g4_loop:
  s_sub_u32 s25, s25, 1
  s_cmp_eq_u32 s25, 0
  s_cbranch_scc1 L_g4_fin
  s_waitcnt lgkmcnt(0)
  s_add_u32 m0, s53, 100352
  v_mfma_f32_16x16x32_bf16 a[0:3], v[60:63], v[28:31], a[0:3]
  buffer_load_dwordx4 v8, s[12:15], s21 offen  lds
  ds_read_b128 v[44:47], v11 offset:0
  v_mfma_f32_16x16x32_bf16 a[4:7], v[64:67], v[28:31], a[4:7]
  ds_read_b64_tr_b16 v[76:77], v14 offset:24576
  v_mfma_f32_16x16x32_bf16 a[8:11], v[68:71], v[28:31], a[8:11]
  ds_read_b64_tr_b16 v[78:79], v14 offset:25600
  v_mfma_f32_16x16x32_bf16 a[12:15], v[72:75], v[28:31], a[12:15]
  ds_read_b128 v[48:51], v11 offset:2048
  s_add_u32 m0, s52, 101376
  v_mfma_f32_16x16x32_bf16 a[16:19], v[60:63], v[32:35], a[16:19]
  buffer_load_dwordx4 v5, s[8:11], s20 offen  lds
  ds_read_b64_tr_b16 v[80:81], v15 offset:24576
  v_mfma_f32_16x16x32_bf16 a[20:23], v[64:67], v[32:35], a[20:23]
  ds_read_b64_tr_b16 v[82:83], v15 offset:25600
  v_mfma_f32_16x16x32_bf16 a[24:27], v[68:71], v[32:35], a[24:27]
  ds_read_b128 v[52:55], v11 offset:4096
  v_mfma_f32_16x16x32_bf16 a[28:31], v[72:75], v[32:35], a[28:31]
  ds_read_b64_tr_b16 v[84:85], v16 offset:24576
  s_add_u32 m0, s53, 101376
  v_mfma_f32_16x16x32_bf16 a[32:35], v[60:63], v[36:39], a[32:35]
  buffer_load_dwordx4 v9, s[12:15], s21 offen  lds
  ds_read_b64_tr_b16 v[86:87], v16 offset:25600
  v_mfma_f32_16x16x32_bf16 a[36:39], v[64:67], v[36:39], a[36:39]
  ds_read_b128 v[56:59], v11 offset:6144
  v_mfma_f32_16x16x32_bf16 a[40:43], v[68:71], v[36:39], a[40:43]
  ds_read_b64_tr_b16 v[88:89], v17 offset:24576
  v_mfma_f32_16x16x32_bf16 a[44:47], v[72:75], v[36:39], a[44:47]
  ds_read_b64_tr_b16 v[90:91], v17 offset:25600
  s_add_u32 s20, s20, 128
  v_mfma_f32_16x16x32_bf16 a[48:51], v[60:63], v[40:43], a[48:51]
  s_add_u32 s21, s21, s51
  v_mfma_f32_16x16x32_bf16 a[52:55], v[64:67], v[40:43], a[52:55]
  v_mfma_f32_16x16x32_bf16 a[56:59], v[68:71], v[40:43], a[56:59]
  v_mfma_f32_16x16x32_bf16 a[60:63], v[72:75], v[40:43], a[60:63]
  s_waitcnt lgkmcnt(0)
  v_mfma_f32_16x16x32_bf16 a[0:3], v[76:79], v[44:47], a[0:3]
  s_waitcnt vmcnt(16)
  s_barrier
  s_add_u32 m0, s52, 0
  v_mfma_f32_16x16x32_bf16 a[4:7], v[80:83], v[44:47], a[4:7]
  buffer_load_dwordx4 v2, s[8:11], s20 offen  lds
  ds_read_b128 v[28:31], v10 offset:32768
  v_mfma_f32_16x16x32_bf16 a[8:11], v[84:87], v[44:47], a[8:11]
  ds_read_b64_tr_b16 v[60:61], v14 offset:49152
  v_mfma_f32_16x16x32_bf16 a[12:15], v[88:91], v[44:47], a[12:15]
  ds_read_b64_tr_b16 v[62:63], v14 offset:50176
  s_add_u32 m0, s53, 0
  v_mfma_f32_16x16x32_bf16 a[16:19], v[76:79], v[48:51], a[16:19]
  buffer_load_dwordx4 v6, s[12:15], s21 offen  lds
  ds_read_b128 v[32:35], v10 offset:34816
  v_mfma_f32_16x16x32_bf16 a[20:23], v[80:83], v[48:51], a[20:23]
  ds_read_b64_tr_b16 v[64:65], v15 offset:49152
  v_mfma_f32_16x16x32_bf16 a[24:27], v[84:87], v[48:51], a[24:27]
  ds_read_b64_tr_b16 v[66:67], v15 offset:50176
  s_add_u32 m0, s52, 1024
  v_mfma_f32_16x16x32_bf16 a[28:31], v[88:91], v[48:51], a[28:31]
  buffer_load_dwordx4 v3, s[8:11], s20 offen  lds
  ds_read_b128 v[36:39], v10 offset:36864
  v_mfma_f32_16x16x32_bf16 a[32:35], v[76:79], v[52:55], a[32:35]
  ds_read_b64_tr_b16 v[68:69], v16 offset:49152
  v_mfma_f32_16x16x32_bf16 a[36:39], v[80:83], v[52:55], a[36:39]
  ds_read_b64_tr_b16 v[70:71], v16 offset:50176
  s_add_u32 m0, s53, 1024
  v_mfma_f32_16x16x32_bf16 a[40:43], v[84:87], v[52:55], a[40:43]
  buffer_load_dwordx4 v7, s[12:15], s21 offen  lds
  ds_read_b128 v[40:43], v10 offset:38912
  v_mfma_f32_16x16x32_bf16 a[44:47], v[88:91], v[52:55], a[44:47]
  ds_read_b64_tr_b16 v[72:73], v17 offset:49152
  v_mfma_f32_16x16x32_bf16 a[48:51], v[76:79], v[56:59], a[48:51]
  ds_read_b64_tr_b16 v[74:75], v17 offset:50176
  s_add_u32 m0, s52, 2048
  v_mfma_f32_16x16x32_bf16 a[52:55], v[80:83], v[56:59], a[52:55]
  buffer_load_dwordx4 v4, s[8:11], s20 offen  lds
  v_mfma_f32_16x16x32_bf16 a[56:59], v[84:87], v[56:59], a[56:59]
  v_mfma_f32_16x16x32_bf16 a[60:63], v[88:91], v[56:59], a[60:63]
  s_waitcnt lgkmcnt(0)
  s_add_u32 m0, s53, 2048
  v_mfma_f32_16x16x32_bf16 a[0:3], v[60:63], v[28:31], a[0:3]
  buffer_load_dwordx4 v8, s[12:15], s21 offen  lds
  ds_read_b128 v[44:47], v11 offset:32768
  v_mfma_f32_16x16x32_bf16 a[4:7], v[64:67], v[28:31], a[4:7]
  ds_read_b64_tr_b16 v[76:77], v14 offset:57344
  v_mfma_f32_16x16x32_bf16 a[8:11], v[68:71], v[28:31], a[8:11]
  ds_read_b64_tr_b16 v[78:79], v14 offset:58368
  v_mfma_f32_16x16x32_bf16 a[12:15], v[72:75], v[28:31], a[12:15]
  ds_read_b128 v[48:51], v11 offset:34816
  s_add_u32 m0, s52, 3072
  v_mfma_f32_16x16x32_bf16 a[16:19], v[60:63], v[32:35], a[16:19]
  buffer_load_dwordx4 v5, s[8:11], s20 offen  lds
  ds_read_b64_tr_b16 v[80:81], v15 offset:57344
  v_mfma_f32_16x16x32_bf16 a[20:23], v[64:67], v[32:35], a[20:23]
  ds_read_b64_tr_b16 v[82:83], v15 offset:58368
  v_mfma_f32_16x16x32_bf16 a[24:27], v[68:71], v[32:35], a[24:27]
  ds_read_b128 v[52:55], v11 offset:36864
  v_mfma_f32_16x16x32_bf16 a[28:31], v[72:75], v[32:35], a[28:31]
  ds_read_b64_tr_b16 v[84:85], v16 offset:57344
  s_add_u32 m0, s53, 3072
  v_mfma_f32_16x16x32_bf16 a[32:35], v[60:63], v[36:39], a[32:35]
  buffer_load_dwordx4 v9, s[12:15], s21 offen  lds
  ds_read_b64_tr_b16 v[86:87], v16 offset:58368
  v_mfma_f32_16x16x32_bf16 a[36:39], v[64:67], v[36:39], a[36:39]
  ds_read_b128 v[56:59], v11 offset:38912
  v_mfma_f32_16x16x32_bf16 a[40:43], v[68:71], v[36:39], a[40:43]
  ds_read_b64_tr_b16 v[88:89], v17 offset:57344
  v_mfma_f32_16x16x32_bf16 a[44:47], v[72:75], v[36:39], a[44:47]
  ds_read_b64_tr_b16 v[90:91], v17 offset:58368
  s_add_u32 s20, s20, 128
  v_mfma_f32_16x16x32_bf16 a[48:51], v[60:63], v[40:43], a[48:51]
  s_add_u32 s21, s21, s51
  v_mfma_f32_16x16x32_bf16 a[52:55], v[64:67], v[40:43], a[52:55]
  v_mfma_f32_16x16x32_bf16 a[56:59], v[68:71], v[40:43], a[56:59]
  v_mfma_f32_16x16x32_bf16 a[60:63], v[72:75], v[40:43], a[60:63]
  s_waitcnt lgkmcnt(0)
  v_mfma_f32_16x16x32_bf16 a[0:3], v[76:79], v[44:47], a[0:3]
  s_waitcnt vmcnt(16)
  s_barrier
  s_add_u32 m0, s52, 32768
  v_mfma_f32_16x16x32_bf16 a[4:7], v[80:83], v[44:47], a[4:7]
  buffer_load_dwordx4 v2, s[8:11], s20 offen  lds
  ds_read_b128 v[28:31], v12 offset:0
  v_mfma_f32_16x16x32_bf16 a[8:11], v[84:87], v[44:47], a[8:11]
  ds_read_b64_tr_b16 v[60:61], v18 offset:16384
  v_mfma_f32_16x16x32_bf16 a[12:15], v[88:91], v[44:47], a[12:15]
  ds_read_b64_tr_b16 v[62:63], v18 offset:17408
  s_add_u32 m0, s53, 32768
  v_mfma_f32_16x16x32_bf16 a[16:19], v[76:79], v[48:51], a[16:19]
  buffer_load_dwordx4 v6, s[12:15], s21 offen  lds
  ds_read_b128 v[32:35], v12 offset:2048
  v_mfma_f32_16x16x32_bf16 a[20:23], v[80:83], v[48:51], a[20:23]
  ds_read_b64_tr_b16 v[64:65], v19 offset:16384
  v_mfma_f32_16x16x32_bf16 a[24:27], v[84:87], v[48:51], a[24:27]
  ds_read_b64_tr_b16 v[66:67], v19 offset:17408
  s_add_u32 m0, s52, 33792
  v_mfma_f32_16x16x32_bf16 a[28:31], v[88:91], v[48:51], a[28:31]
  buffer_load_dwordx4 v3, s[8:11], s20 offen  lds
  ds_read_b128 v[36:39], v12 offset:4096
  v_mfma_f32_16x16x32_bf16 a[32:35], v[76:79], v[52:55], a[32:35]
  ds_read_b64_tr_b16 v[68:69], v20 offset:16384
  v_mfma_f32_16x16x32_bf16 a[36:39], v[80:83], v[52:55], a[36:39]
  ds_read_b64_tr_b16 v[70:71], v20 offset:17408
  s_add_u32 m0, s53, 33792
  v_mfma_f32_16x16x32_bf16 a[40:43], v[84:87], v[52:55], a[40:43]
  buffer_load_dwordx4 v7, s[12:15], s21 offen  lds
  ds_read_b128 v[40:43], v12 offset:6144
  v_mfma_f32_16x16x32_bf16 a[44:47], v[88:91], v[52:55], a[44:47]
  ds_read_b64_tr_b16 v[72:73], v21 offset:16384
  v_mfma_f32_16x16x32_bf16 a[48:51], v[76:79], v[56:59], a[48:51]
  ds_read_b64_tr_b16 v[74:75], v21 offset:17408
  s_add_u32 m0, s52, 34816
  v_mfma_f32_16x16x32_bf16 a[52:55], v[80:83], v[56:59], a[52:55]
  buffer_load_dwordx4 v4, s[8:11], s20 offen  lds
  v_mfma_f32_16x16x32_bf16 a[56:59], v[84:87], v[56:59], a[56:59]
  v_mfma_f32_16x16x32_bf16 a[60:63], v[88:91], v[56:59], a[60:63]
  s_waitcnt lgkmcnt(0)
  s_add_u32 m0, s53, 34816
  v_mfma_f32_16x16x32_bf16 a[0:3], v[60:63], v[28:31], a[0:3]
  buffer_load_dwordx4 v8, s[12:15], s21 offen  lds
  ds_read_b128 v[44:47], v13 offset:0
  v_mfma_f32_16x16x32_bf16 a[4:7], v[64:67], v[28:31], a[4:7]
  ds_read_b64_tr_b16 v[76:77], v18 offset:24576
  v_mfma_f32_16x16x32_bf16 a[8:11], v[68:71], v[28:31], a[8:11]
  ds_read_b64_tr_b16 v[78:79], v18 offset:25600
  v_mfma_f32_16x16x32_bf16 a[12:15], v[72:75], v[28:31], a[12:15]
  ds_read_b128 v[48:51], v13 offset:2048
  s_add_u32 m0, s52, 35840
  v_mfma_f32_16x16x32_bf16 a[16:19], v[60:63], v[32:35], a[16:19]
  buffer_load_dwordx4 v5, s[8:11], s20 offen  lds
  ds_read_b64_tr_b16 v[80:81], v19 offset:24576
  v_mfma_f32_16x16x32_bf16 a[20:23], v[64:67], v[32:35], a[20:23]
  ds_read_b64_tr_b16 v[82:83], v19 offset:25600
  v_mfma_f32_16x16x32_bf16 a[24:27], v[68:71], v[32:35], a[24:27]
  ds_read_b128 v[52:55], v13 offset:4096
  v_mfma_f32_16x16x32_bf16 a[28:31], v[72:75], v[32:35], a[28:31]
  ds_read_b64_tr_b16 v[84:85], v20 offset:24576
  s_add_u32 m0, s53, 35840
  v_mfma_f32_16x16x32_bf16 a[32:35], v[60:63], v[36:39], a[32:35]
  buffer_load_dwordx4 v9, s[12:15], s21 offen  lds
  ds_read_b64_tr_b16 v[86:87], v20 offset:25600
  v_mfma_f32_16x16x32_bf16 a[36:39], v[64:67], v[36:39], a[36:39]
  ds_read_b128 v[56:59], v13 offset:6144
  v_mfma_f32_16x16x32_bf16 a[40:43], v[68:71], v[36:39], a[40:43]
  ds_read_b64_tr_b16 v[88:89], v21 offset:24576
  v_mfma_f32_16x16x32_bf16 a[44:47], v[72:75], v[36:39], a[44:47]
  ds_read_b64_tr_b16 v[90:91], v21 offset:25600
  s_add_u32 s20, s20, 128
  v_mfma_f32_16x16x32_bf16 a[48:51], v[60:63], v[40:43], a[48:51]
  s_add_u32 s21, s21, s51
  v_mfma_f32_16x16x32_bf16 a[52:55], v[64:67], v[40:43], a[52:55]
  v_mfma_f32_16x16x32_bf16 a[56:59], v[68:71], v[40:43], a[56:59]
  v_mfma_f32_16x16x32_bf16 a[60:63], v[72:75], v[40:43], a[60:63]
  s_waitcnt lgkmcnt(0)
  v_mfma_f32_16x16x32_bf16 a[0:3], v[76:79], v[44:47], a[0:3]
  s_waitcnt vmcnt(16)
  s_barrier
  s_add_u32 m0, s52, 65536
  v_mfma_f32_16x16x32_bf16 a[4:7], v[80:83], v[44:47], a[4:7]
  buffer_load_dwordx4 v2, s[8:11], s20 offen  lds
  ds_read_b128 v[28:31], v12 offset:32768
  v_mfma_f32_16x16x32_bf16 a[8:11], v[84:87], v[44:47], a[8:11]
  ds_read_b64_tr_b16 v[60:61], v18 offset:49152
  v_mfma_f32_16x16x32_bf16 a[12:15], v[88:91], v[44:47], a[12:15]
  ds_read_b64_tr_b16 v[62:63], v18 offset:50176
  s_add_u32 m0, s53, 65536
  v_mfma_f32_16x16x32_bf16 a[16:19], v[76:79], v[48:51], a[16:19]
  buffer_load_dwordx4 v6, s[12:15], s21 offen  lds
  ds_read_b128 v[32:35], v12 offset:34816
  v_mfma_f32_16x16x32_bf16 a[20:23], v[80:83], v[48:51], a[20:23]
  ds_read_b64_tr_b16 v[64:65], v19 offset:49152
  v_mfma_f32_16x16x32_bf16 a[24:27], v[84:87], v[48:51], a[24:27]
  ds_read_b64_tr_b16 v[66:67], v19 offset:50176
  s_add_u32 m0, s52, 66560
  v_mfma_f32_16x16x32_bf16 a[28:31], v[88:91], v[48:51], a[28:31]
  buffer_load_dwordx4 v3, s[8:11], s20 offen  lds
  ds_read_b128 v[36:39], v12 offset:36864
  v_mfma_f32_16x16x32_bf16 a[32:35], v[76:79], v[52:55], a[32:35]
  ds_read_b64_tr_b16 v[68:69], v20 offset:49152
  v_mfma_f32_16x16x32_bf16 a[36:39], v[80:83], v[52:55], a[36:39]
  ds_read_b64_tr_b16 v[70:71], v20 offset:50176
  s_add_u32 m0, s53, 66560
  v_mfma_f32_16x16x32_bf16 a[40:43], v[84:87], v[52:55], a[40:43]
  buffer_load_dwordx4 v7, s[12:15], s21 offen  lds
  ds_read_b128 v[40:43], v12 offset:38912
  v_mfma_f32_16x16x32_bf16 a[44:47], v[88:91], v[52:55], a[44:47]
  ds_read_b64_tr_b16 v[72:73], v21 offset:49152
  v_mfma_f32_16x16x32_bf16 a[48:51], v[76:79], v[56:59], a[48:51]
  ds_read_b64_tr_b16 v[74:75], v21 offset:50176
  s_add_u32 m0, s52, 67584
  v_mfma_f32_16x16x32_bf16 a[52:55], v[80:83], v[56:59], a[52:55]
  buffer_load_dwordx4 v4, s[8:11], s20 offen  lds
  v_mfma_f32_16x16x32_bf16 a[56:59], v[84:87], v[56:59], a[56:59]
  v_mfma_f32_16x16x32_bf16 a[60:63], v[88:91], v[56:59], a[60:63]
  s_waitcnt lgkmcnt(0)
  s_add_u32 m0, s53, 67584
  v_mfma_f32_16x16x32_bf16 a[0:3], v[60:63], v[28:31], a[0:3]
  buffer_load_dwordx4 v8, s[12:15], s21 offen  lds
  ds_read_b128 v[44:47], v13 offset:32768
  v_mfma_f32_16x16x32_bf16 a[4:7], v[64:67], v[28:31], a[4:7]
  ds_read_b64_tr_b16 v[76:77], v18 offset:57344
  v_mfma_f32_16x16x32_bf16 a[8:11], v[68:71], v[28:31], a[8:11]
  ds_read_b64_tr_b16 v[78:79], v18 offset:58368
  v_mfma_f32_16x16x32_bf16 a[12:15], v[72:75], v[28:31], a[12:15]
  ds_read_b128 v[48:51], v13 offset:34816
  s_add_u32 m0, s52, 68608
  v_mfma_f32_16x16x32_bf16 a[16:19], v[60:63], v[32:35], a[16:19]
  buffer_load_dwordx4 v5, s[8:11], s20 offen  lds
  ds_read_b64_tr_b16 v[80:81], v19 offset:57344
  v_mfma_f32_16x16x32_bf16 a[20:23], v[64:67], v[32:35], a[20:23]
  ds_read_b64_tr_b16 v[82:83], v19 offset:58368
  v_mfma_f32_16x16x32_bf16 a[24:27], v[68:71], v[32:35], a[24:27]
  ds_read_b128 v[52:55], v13 offset:36864
  v_mfma_f32_16x16x32_bf16 a[28:31], v[72:75], v[32:35], a[28:31]
  ds_read_b64_tr_b16 v[84:85], v20 offset:57344
  s_add_u32 m0, s53, 68608
  v_mfma_f32_16x16x32_bf16 a[32:35], v[60:63], v[36:39], a[32:35]
  buffer_load_dwordx4 v9, s[12:15], s21 offen  lds
  ds_read_b64_tr_b16 v[86:87], v20 offset:58368
  v_mfma_f32_16x16x32_bf16 a[36:39], v[64:67], v[36:39], a[36:39]
  ds_read_b128 v[56:59], v13 offset:38912
  v_mfma_f32_16x16x32_bf16 a[40:43], v[68:71], v[36:39], a[40:43]
  ds_read_b64_tr_b16 v[88:89], v21 offset:57344
  v_mfma_f32_16x16x32_bf16 a[44:47], v[72:75], v[36:39], a[44:47]
  ds_read_b64_tr_b16 v[90:91], v21 offset:58368
  s_add_u32 s20, s20, 128
  v_mfma_f32_16x16x32_bf16 a[48:51], v[60:63], v[40:43], a[48:51]
  s_add_u32 s21, s21, s51
  v_mfma_f32_16x16x32_bf16 a[52:55], v[64:67], v[40:43], a[52:55]
  v_mfma_f32_16x16x32_bf16 a[56:59], v[68:71], v[40:43], a[56:59]
  v_mfma_f32_16x16x32_bf16 a[60:63], v[72:75], v[40:43], a[60:63]
  s_waitcnt lgkmcnt(0)
  v_mfma_f32_16x16x32_bf16 a[0:3], v[76:79], v[44:47], a[0:3]
  s_waitcnt vmcnt(16)
  s_barrier
  s_add_u32 m0, s52, 98304
  v_mfma_f32_16x16x32_bf16 a[4:7], v[80:83], v[44:47], a[4:7]
  buffer_load_dwordx4 v2, s[8:11], s20 offen  lds
  ds_read_b128 v[28:31], v10 offset:0
  v_mfma_f32_16x16x32_bf16 a[8:11], v[84:87], v[44:47], a[8:11]
  ds_read_b64_tr_b16 v[60:61], v14 offset:16384
  v_mfma_f32_16x16x32_bf16 a[12:15], v[88:91], v[44:47], a[12:15]
  ds_read_b64_tr_b16 v[62:63], v14 offset:17408
  s_add_u32 m0, s53, 98304
  v_mfma_f32_16x16x32_bf16 a[16:19], v[76:79], v[48:51], a[16:19]
  buffer_load_dwordx4 v6, s[12:15], s21 offen  lds
  ds_read_b128 v[32:35], v10 offset:2048
  v_mfma_f32_16x16x32_bf16 a[20:23], v[80:83], v[48:51], a[20:23]
  ds_read_b64_tr_b16 v[64:65], v15 offset:16384
  v_mfma_f32_16x16x32_bf16 a[24:27], v[84:87], v[48:51], a[24:27]
  ds_read_b64_tr_b16 v[66:67], v15 offset:17408
  s_add_u32 m0, s52, 99328
  v_mfma_f32_16x16x32_bf16 a[28:31], v[88:91], v[48:51], a[28:31]
  buffer_load_dwordx4 v3, s[8:11], s20 offen  lds
  ds_read_b128 v[36:39], v10 offset:4096
  v_mfma_f32_16x16x32_bf16 a[32:35], v[76:79], v[52:55], a[32:35]
  ds_read_b64_tr_b16 v[68:69], v16 offset:16384
  v_mfma_f32_16x16x32_bf16 a[36:39], v[80:83], v[52:55], a[36:39]
  ds_read_b64_tr_b16 v[70:71], v16 offset:17408
  s_add_u32 m0, s53, 99328
  v_mfma_f32_16x16x32_bf16 a[40:43], v[84:87], v[52:55], a[40:43]
  buffer_load_dwordx4 v7, s[12:15], s21 offen  lds
  ds_read_b128 v[40:43], v10 offset:6144
  v_mfma_f32_16x16x32_bf16 a[44:47], v[88:91], v[52:55], a[44:47]
  ds_read_b64_tr_b16 v[72:73], v17 offset:16384
  v_mfma_f32_16x16x32_bf16 a[48:51], v[76:79], v[56:59], a[48:51]
  ds_read_b64_tr_b16 v[74:75], v17 offset:17408
  s_add_u32 m0, s52, 100352
  v_mfma_f32_16x16x32_bf16 a[52:55], v[80:83], v[56:59], a[52:55]
  buffer_load_dwordx4 v4, s[8:11], s20 offen  lds
  v_mfma_f32_16x16x32_bf16 a[56:59], v[84:87], v[56:59], a[56:59]
  v_mfma_f32_16x16x32_bf16 a[60:63], v[88:91], v[56:59], a[60:63]
  s_branch L_g4_loop
L_g4_fin:
  s_cmp_lg_u32 s32, 0
  s_cbranch_scc1 L_rq_85
  s_cmp_eq_u32 s39, 0
  s_cbranch_scc1 L_rq_85
  s_lshl_b32 s99, s33, 7
  s_add_u32 s99, s99, 0x3d00200
  v_mov_b32 v244, 1
  v_mov_b32 v245, 0
  s_mov_b64 exec, 1
  buffer_atomic_add v244, v245, s[4:7], s99 offen sc0 sc1
  s_mov_b64 exec, -1
L_rq_85:
  s_waitcnt lgkmcnt(0)
  s_add_u32 m0, s53, 100352
  v_mfma_f32_16x16x32_bf16 a[0:3], v[60:63], v[28:31], a[0:3]
  buffer_load_dwordx4 v8, s[12:15], s21 offen  lds
  ds_read_b128 v[44:47], v11 offset:0
  v_mfma_f32_16x16x32_bf16 a[4:7], v[64:67], v[28:31], a[4:7]
  ds_read_b64_tr_b16 v[76:77], v14 offset:24576
  v_mfma_f32_16x16x32_bf16 a[8:11], v[68:71], v[28:31], a[8:11]
  ds_read_b64_tr_b16 v[78:79], v14 offset:25600
  v_mfma_f32_16x16x32_bf16 a[12:15], v[72:75], v[28:31], a[12:15]
  ds_read_b128 v[48:51], v11 offset:2048
  s_add_u32 m0, s52, 101376
  v_mfma_f32_16x16x32_bf16 a[16:19], v[60:63], v[32:35], a[16:19]
  buffer_load_dwordx4 v5, s[8:11], s20 offen  lds
  ds_read_b64_tr_b16 v[80:81], v15 offset:24576
  v_mfma_f32_16x16x32_bf16 a[20:23], v[64:67], v[32:35], a[20:23]
  ds_read_b64_tr_b16 v[82:83], v15 offset:25600
  v_mfma_f32_16x16x32_bf16 a[24:27], v[68:71], v[32:35], a[24:27]
  ds_read_b128 v[52:55], v11 offset:4096
  v_mfma_f32_16x16x32_bf16 a[28:31], v[72:75], v[32:35], a[28:31]
  ds_read_b64_tr_b16 v[84:85], v16 offset:24576
  s_add_u32 m0, s53, 101376
  v_mfma_f32_16x16x32_bf16 a[32:35], v[60:63], v[36:39], a[32:35]
  buffer_load_dwordx4 v9, s[12:15], s21 offen  lds
  ds_read_b64_tr_b16 v[86:87], v16 offset:25600
  v_mfma_f32_16x16x32_bf16 a[36:39], v[64:67], v[36:39], a[36:39]
  ds_read_b128 v[56:59], v11 offset:6144
  v_mfma_f32_16x16x32_bf16 a[40:43], v[68:71], v[36:39], a[40:43]
  ds_read_b64_tr_b16 v[88:89], v17 offset:24576
  v_mfma_f32_16x16x32_bf16 a[44:47], v[72:75], v[36:39], a[44:47]
  ds_read_b64_tr_b16 v[90:91], v17 offset:25600
  s_add_u32 s20, s20, 128
  v_mfma_f32_16x16x32_bf16 a[48:51], v[60:63], v[40:43], a[48:51]
  s_add_u32 s21, s21, s51
  v_mfma_f32_16x16x32_bf16 a[52:55], v[64:67], v[40:43], a[52:55]
  v_mfma_f32_16x16x32_bf16 a[56:59], v[68:71], v[40:43], a[56:59]
  v_mfma_f32_16x16x32_bf16 a[60:63], v[72:75], v[40:43], a[60:63]
  s_waitcnt lgkmcnt(0)
  v_mfma_f32_16x16x32_bf16 a[0:3], v[76:79], v[44:47], a[0:3]
  s_waitcnt vmcnt(16)
  s_barrier
  v_mfma_f32_16x16x32_bf16 a[4:7], v[80:83], v[44:47], a[4:7]
  ds_read_b128 v[28:31], v10 offset:32768
  v_mfma_f32_16x16x32_bf16 a[8:11], v[84:87], v[44:47], a[8:11]
  ds_read_b64_tr_b16 v[60:61], v14 offset:49152
  v_mfma_f32_16x16x32_bf16 a[12:15], v[88:91], v[44:47], a[12:15]
  ds_read_b64_tr_b16 v[62:63], v14 offset:50176
  v_mfma_f32_16x16x32_bf16 a[16:19], v[76:79], v[48:51], a[16:19]
  ds_read_b128 v[32:35], v10 offset:34816
  v_mfma_f32_16x16x32_bf16 a[20:23], v[80:83], v[48:51], a[20:23]
  ds_read_b64_tr_b16 v[64:65], v15 offset:49152
  v_mfma_f32_16x16x32_bf16 a[24:27], v[84:87], v[48:51], a[24:27]
  ds_read_b64_tr_b16 v[66:67], v15 offset:50176
  v_mfma_f32_16x16x32_bf16 a[28:31], v[88:91], v[48:51], a[28:31]
  ds_read_b128 v[36:39], v10 offset:36864
  v_mfma_f32_16x16x32_bf16 a[32:35], v[76:79], v[52:55], a[32:35]
  ds_read_b64_tr_b16 v[68:69], v16 offset:49152
  v_mfma_f32_16x16x32_bf16 a[36:39], v[80:83], v[52:55], a[36:39]
  ds_read_b64_tr_b16 v[70:71], v16 offset:50176
  v_mfma_f32_16x16x32_bf16 a[40:43], v[84:87], v[52:55], a[40:43]
  ds_read_b128 v[40:43], v10 offset:38912
  v_mfma_f32_16x16x32_bf16 a[44:47], v[88:91], v[52:55], a[44:47]
  ds_read_b64_tr_b16 v[72:73], v17 offset:49152
  v_mfma_f32_16x16x32_bf16 a[48:51], v[76:79], v[56:59], a[48:51]
  ds_read_b64_tr_b16 v[74:75], v17 offset:50176
  v_mfma_f32_16x16x32_bf16 a[52:55], v[80:83], v[56:59], a[52:55]
  v_mfma_f32_16x16x32_bf16 a[56:59], v[84:87], v[56:59], a[56:59]
  v_mfma_f32_16x16x32_bf16 a[60:63], v[88:91], v[56:59], a[60:63]
  s_waitcnt lgkmcnt(0)
  v_mfma_f32_16x16x32_bf16 a[0:3], v[60:63], v[28:31], a[0:3]
  ds_read_b128 v[44:47], v11 offset:32768
  v_mfma_f32_16x16x32_bf16 a[4:7], v[64:67], v[28:31], a[4:7]
  ds_read_b64_tr_b16 v[76:77], v14 offset:57344
  v_mfma_f32_16x16x32_bf16 a[8:11], v[68:71], v[28:31], a[8:11]
  ds_read_b64_tr_b16 v[78:79], v14 offset:58368
  v_mfma_f32_16x16x32_bf16 a[12:15], v[72:75], v[28:31], a[12:15]
  ds_read_b128 v[48:51], v11 offset:34816
  v_mfma_f32_16x16x32_bf16 a[16:19], v[60:63], v[32:35], a[16:19]
  ds_read_b64_tr_b16 v[80:81], v15 offset:57344
  v_mfma_f32_16x16x32_bf16 a[20:23], v[64:67], v[32:35], a[20:23]
  ds_read_b64_tr_b16 v[82:83], v15 offset:58368
  v_mfma_f32_16x16x32_bf16 a[24:27], v[68:71], v[32:35], a[24:27]
  ds_read_b128 v[52:55], v11 offset:36864
  v_mfma_f32_16x16x32_bf16 a[28:31], v[72:75], v[32:35], a[28:31]
  ds_read_b64_tr_b16 v[84:85], v16 offset:57344
  v_mfma_f32_16x16x32_bf16 a[32:35], v[60:63], v[36:39], a[32:35]
  ds_read_b64_tr_b16 v[86:87], v16 offset:58368
  v_mfma_f32_16x16x32_bf16 a[36:39], v[64:67], v[36:39], a[36:39]
  ds_read_b128 v[56:59], v11 offset:38912
  v_mfma_f32_16x16x32_bf16 a[40:43], v[68:71], v[36:39], a[40:43]
  ds_read_b64_tr_b16 v[88:89], v17 offset:57344
  v_mfma_f32_16x16x32_bf16 a[44:47], v[72:75], v[36:39], a[44:47]
  ds_read_b64_tr_b16 v[90:91], v17 offset:58368
  v_mfma_f32_16x16x32_bf16 a[48:51], v[60:63], v[40:43], a[48:51]
  v_mfma_f32_16x16x32_bf16 a[52:55], v[64:67], v[40:43], a[52:55]
  v_mfma_f32_16x16x32_bf16 a[56:59], v[68:71], v[40:43], a[56:59]
  v_mfma_f32_16x16x32_bf16 a[60:63], v[72:75], v[40:43], a[60:63]
  s_waitcnt lgkmcnt(0)
  v_mfma_f32_16x16x32_bf16 a[0:3], v[76:79], v[44:47], a[0:3]
  s_waitcnt vmcnt(8)
  s_barrier
  v_mfma_f32_16x16x32_bf16 a[4:7], v[80:83], v[44:47], a[4:7]
  ds_read_b128 v[28:31], v12 offset:0
  v_mfma_f32_16x16x32_bf16 a[8:11], v[84:87], v[44:47], a[8:11]
  ds_read_b64_tr_b16 v[60:61], v18 offset:16384
  v_mfma_f32_16x16x32_bf16 a[12:15], v[88:91], v[44:47], a[12:15]
  ds_read_b64_tr_b16 v[62:63], v18 offset:17408
  v_mfma_f32_16x16x32_bf16 a[16:19], v[76:79], v[48:51], a[16:19]
  ds_read_b128 v[32:35], v12 offset:2048
  v_mfma_f32_16x16x32_bf16 a[20:23], v[80:83], v[48:51], a[20:23]
  ds_read_b64_tr_b16 v[64:65], v19 offset:16384
  v_mfma_f32_16x16x32_bf16 a[24:27], v[84:87], v[48:51], a[24:27]
  ds_read_b64_tr_b16 v[66:67], v19 offset:17408
  v_mfma_f32_16x16x32_bf16 a[28:31], v[88:91], v[48:51], a[28:31]
  ds_read_b128 v[36:39], v12 offset:4096
  v_mfma_f32_16x16x32_bf16 a[32:35], v[76:79], v[52:55], a[32:35]
  ds_read_b64_tr_b16 v[68:69], v20 offset:16384
  v_mfma_f32_16x16x32_bf16 a[36:39], v[80:83], v[52:55], a[36:39]
  ds_read_b64_tr_b16 v[70:71], v20 offset:17408
  v_mfma_f32_16x16x32_bf16 a[40:43], v[84:87], v[52:55], a[40:43]
  ds_read_b128 v[40:43], v12 offset:6144
  v_mfma_f32_16x16x32_bf16 a[44:47], v[88:91], v[52:55], a[44:47]
  ds_read_b64_tr_b16 v[72:73], v21 offset:16384
  v_mfma_f32_16x16x32_bf16 a[48:51], v[76:79], v[56:59], a[48:51]
  ds_read_b64_tr_b16 v[74:75], v21 offset:17408
  v_mfma_f32_16x16x32_bf16 a[52:55], v[80:83], v[56:59], a[52:55]
  v_mfma_f32_16x16x32_bf16 a[56:59], v[84:87], v[56:59], a[56:59]
  v_mfma_f32_16x16x32_bf16 a[60:63], v[88:91], v[56:59], a[60:63]
  s_waitcnt lgkmcnt(0)
  v_mfma_f32_16x16x32_bf16 a[0:3], v[60:63], v[28:31], a[0:3]
  ds_read_b128 v[44:47], v13 offset:0
  v_mfma_f32_16x16x32_bf16 a[4:7], v[64:67], v[28:31], a[4:7]
  ds_read_b64_tr_b16 v[76:77], v18 offset:24576
  v_mfma_f32_16x16x32_bf16 a[8:11], v[68:71], v[28:31], a[8:11]
  ds_read_b64_tr_b16 v[78:79], v18 offset:25600
  v_mfma_f32_16x16x32_bf16 a[12:15], v[72:75], v[28:31], a[12:15]
  ds_read_b128 v[48:51], v13 offset:2048
  v_mfma_f32_16x16x32_bf16 a[16:19], v[60:63], v[32:35], a[16:19]
  ds_read_b64_tr_b16 v[80:81], v19 offset:24576
  v_mfma_f32_16x16x32_bf16 a[20:23], v[64:67], v[32:35], a[20:23]
  ds_read_b64_tr_b16 v[82:83], v19 offset:25600
  v_mfma_f32_16x16x32_bf16 a[24:27], v[68:71], v[32:35], a[24:27]
  ds_read_b128 v[52:55], v13 offset:4096
  v_mfma_f32_16x16x32_bf16 a[28:31], v[72:75], v[32:35], a[28:31]
  ds_read_b64_tr_b16 v[84:85], v20 offset:24576
  v_mfma_f32_16x16x32_bf16 a[32:35], v[60:63], v[36:39], a[32:35]
  ds_read_b64_tr_b16 v[86:87], v20 offset:25600
  v_mfma_f32_16x16x32_bf16 a[36:39], v[64:67], v[36:39], a[36:39]
  ds_read_b128 v[56:59], v13 offset:6144
  v_mfma_f32_16x16x32_bf16 a[40:43], v[68:71], v[36:39], a[40:43]
  ds_read_b64_tr_b16 v[88:89], v21 offset:24576
  v_mfma_f32_16x16x32_bf16 a[44:47], v[72:75], v[36:39], a[44:47]
  ds_read_b64_tr_b16 v[90:91], v21 offset:25600
  v_mfma_f32_16x16x32_bf16 a[48:51], v[60:63], v[40:43], a[48:51]
  v_mfma_f32_16x16x32_bf16 a[52:55], v[64:67], v[40:43], a[52:55]
  v_mfma_f32_16x16x32_bf16 a[56:59], v[68:71], v[40:43], a[56:59]
  v_mfma_f32_16x16x32_bf16 a[60:63], v[72:75], v[40:43], a[60:63]
  s_waitcnt lgkmcnt(0)
  v_mfma_f32_16x16x32_bf16 a[0:3], v[76:79], v[44:47], a[0:3]
  s_waitcnt vmcnt(0)
  s_barrier
  v_mfma_f32_16x16x32_bf16 a[4:7], v[80:83], v[44:47], a[4:7]
  ds_read_b128 v[28:31], v12 offset:32768
  v_mfma_f32_16x16x32_bf16 a[8:11], v[84:87], v[44:47], a[8:11]
  ds_read_b64_tr_b16 v[60:61], v18 offset:49152
  v_mfma_f32_16x16x32_bf16 a[12:15], v[88:91], v[44:47], a[12:15]
  ds_read_b64_tr_b16 v[62:63], v18 offset:50176
  v_mfma_f32_16x16x32_bf16 a[16:19], v[76:79], v[48:51], a[16:19]
  ds_read_b128 v[32:35], v12 offset:34816
  v_mfma_f32_16x16x32_bf16 a[20:23], v[80:83], v[48:51], a[20:23]
  ds_read_b64_tr_b16 v[64:65], v19 offset:49152
  v_mfma_f32_16x16x32_bf16 a[24:27], v[84:87], v[48:51], a[24:27]
  ds_read_b64_tr_b16 v[66:67], v19 offset:50176
  v_mfma_f32_16x16x32_bf16 a[28:31], v[88:91], v[48:51], a[28:31]
  ds_read_b128 v[36:39], v12 offset:36864
  v_mfma_f32_16x16x32_bf16 a[32:35], v[76:79], v[52:55], a[32:35]
  ds_read_b64_tr_b16 v[68:69], v20 offset:49152
  v_mfma_f32_16x16x32_bf16 a[36:39], v[80:83], v[52:55], a[36:39]
  ds_read_b64_tr_b16 v[70:71], v20 offset:50176
  v_mfma_f32_16x16x32_bf16 a[40:43], v[84:87], v[52:55], a[40:43]
  ds_read_b128 v[40:43], v12 offset:38912
  v_mfma_f32_16x16x32_bf16 a[44:47], v[88:91], v[52:55], a[44:47]
  ds_read_b64_tr_b16 v[72:73], v21 offset:49152
  v_mfma_f32_16x16x32_bf16 a[48:51], v[76:79], v[56:59], a[48:51]
  ds_read_b64_tr_b16 v[74:75], v21 offset:50176
  v_mfma_f32_16x16x32_bf16 a[52:55], v[80:83], v[56:59], a[52:55]
  v_mfma_f32_16x16x32_bf16 a[56:59], v[84:87], v[56:59], a[56:59]
  v_mfma_f32_16x16x32_bf16 a[60:63], v[88:91], v[56:59], a[60:63]
  s_waitcnt lgkmcnt(0)
  v_mfma_f32_16x16x32_bf16 a[0:3], v[60:63], v[28:31], a[0:3]
  ds_read_b128 v[44:47], v13 offset:32768
  v_mfma_f32_16x16x32_bf16 a[4:7], v[64:67], v[28:31], a[4:7]
  ds_read_b64_tr_b16 v[76:77], v18 offset:57344
  v_mfma_f32_16x16x32_bf16 a[8:11], v[68:71], v[28:31], a[8:11]
  ds_read_b64_tr_b16 v[78:79], v18 offset:58368
  v_mfma_f32_16x16x32_bf16 a[12:15], v[72:75], v[28:31], a[12:15]
  ds_read_b128 v[48:51], v13 offset:34816
  v_mfma_f32_16x16x32_bf16 a[16:19], v[60:63], v[32:35], a[16:19]
  ds_read_b64_tr_b16 v[80:81], v19 offset:57344
  v_mfma_f32_16x16x32_bf16 a[20:23], v[64:67], v[32:35], a[20:23]
  ds_read_b64_tr_b16 v[82:83], v19 offset:58368
  v_mfma_f32_16x16x32_bf16 a[24:27], v[68:71], v[32:35], a[24:27]
  ds_read_b128 v[52:55], v13 offset:36864
  v_mfma_f32_16x16x32_bf16 a[28:31], v[72:75], v[32:35], a[28:31]
  ds_read_b64_tr_b16 v[84:85], v20 offset:57344
  v_mfma_f32_16x16x32_bf16 a[32:35], v[60:63], v[36:39], a[32:35]
  ds_read_b64_tr_b16 v[86:87], v20 offset:58368
  v_mfma_f32_16x16x32_bf16 a[36:39], v[64:67], v[36:39], a[36:39]
  ds_read_b128 v[56:59], v13 offset:38912
  v_mfma_f32_16x16x32_bf16 a[40:43], v[68:71], v[36:39], a[40:43]
  ds_read_b64_tr_b16 v[88:89], v21 offset:57344
  v_mfma_f32_16x16x32_bf16 a[44:47], v[72:75], v[36:39], a[44:47]
  ds_read_b64_tr_b16 v[90:91], v21 offset:58368
  v_mfma_f32_16x16x32_bf16 a[48:51], v[60:63], v[40:43], a[48:51]
  v_mfma_f32_16x16x32_bf16 a[52:55], v[64:67], v[40:43], a[52:55]
  v_mfma_f32_16x16x32_bf16 a[56:59], v[68:71], v[40:43], a[56:59]
  v_mfma_f32_16x16x32_bf16 a[60:63], v[72:75], v[40:43], a[60:63]
  s_waitcnt lgkmcnt(0)
  v_mfma_f32_16x16x32_bf16 a[0:3], v[76:79], v[44:47], a[0:3]
  v_mfma_f32_16x16x32_bf16 a[4:7], v[80:83], v[44:47], a[4:7]
  v_mfma_f32_16x16x32_bf16 a[8:11], v[84:87], v[44:47], a[8:11]
  v_mfma_f32_16x16x32_bf16 a[12:15], v[88:91], v[44:47], a[12:15]
  v_mfma_f32_16x16x32_bf16 a[16:19], v[76:79], v[48:51], a[16:19]
  v_mfma_f32_16x16x32_bf16 a[20:23], v[80:83], v[48:51], a[20:23]
  v_mfma_f32_16x16x32_bf16 a[24:27], v[84:87], v[48:51], a[24:27]
  v_mfma_f32_16x16x32_bf16 a[28:31], v[88:91], v[48:51], a[28:31]
  v_mfma_f32_16x16x32_bf16 a[32:35], v[76:79], v[52:55], a[32:35]
  v_mfma_f32_16x16x32_bf16 a[36:39], v[80:83], v[52:55], a[36:39]
  v_mfma_f32_16x16x32_bf16 a[40:43], v[84:87], v[52:55], a[40:43]
  v_mfma_f32_16x16x32_bf16 a[44:47], v[88:91], v[52:55], a[44:47]
  v_mfma_f32_16x16x32_bf16 a[48:51], v[76:79], v[56:59], a[48:51]
  v_mfma_f32_16x16x32_bf16 a[52:55], v[80:83], v[56:59], a[52:55]
  v_mfma_f32_16x16x32_bf16 a[56:59], v[84:87], v[56:59], a[56:59]
  v_mfma_f32_16x16x32_bf16 a[60:63], v[88:91], v[56:59], a[60:63]
  s_mov_b32 s59, 3
  s_mov_b32 s60, s22
  s_mov_b32 s61, s26
  s_add_u32 s62, s38, 0x3d00000
  s_mov_b32 s63, s98
  s_cmp_lg_u32 s39, 0
  s_cbranch_scc1 L_got
  s_mov_b32 s58, 3
  s_branch L_epi
L_g5:
  s_waitcnt vmcnt(26)
  s_barrier
  ds_read_b128 v[28:31], v10 offset:0
  ds_read_b64_tr_b16 v[60:61], v14 offset:16384
  ds_read_b64_tr_b16 v[62:63], v14 offset:17408
  ds_read_b128 v[32:35], v10 offset:2048
  ds_read_b64_tr_b16 v[64:65], v15 offset:16384
  ds_read_b64_tr_b16 v[66:67], v15 offset:17408
  ds_read_b128 v[36:39], v10 offset:4096
  ds_read_b64_tr_b16 v[68:69], v16 offset:16384
  ds_read_b64_tr_b16 v[70:71], v16 offset:17408
  ds_read_b128 v[40:43], v10 offset:6144
  ds_read_b64_tr_b16 v[72:73], v17 offset:16384
  ds_read_b64_tr_b16 v[74:75], v17 offset:17408
  s_sub_u32 s25, s25, 1
  s_waitcnt lgkmcnt(0)
  v_mfma_f32_16x16x32_bf16 a[0:3], v[28:31], v[60:63], 0
  ds_read_b128 v[44:47], v11 offset:0
  v_mfma_f32_16x16x32_bf16 a[4:7], v[28:31], v[64:67], 0
  ds_read_b64_tr_b16 v[76:77], v14 offset:24576
  v_mfma_f32_16x16x32_bf16 a[8:11], v[28:31], v[68:71], 0
  ds_read_b64_tr_b16 v[78:79], v14 offset:25600
  v_mfma_f32_16x16x32_bf16 a[12:15], v[28:31], v[72:75], 0
  ds_read_b128 v[48:51], v11 offset:2048
  v_mfma_f32_16x16x32_bf16 a[16:19], v[32:35], v[60:63], 0
  ds_read_b64_tr_b16 v[80:81], v15 offset:24576
  v_mfma_f32_16x16x32_bf16 a[20:23], v[32:35], v[64:67], 0
  ds_read_b64_tr_b16 v[82:83], v15 offset:25600
  v_mfma_f32_16x16x32_bf16 a[24:27], v[32:35], v[68:71], 0
  ds_read_b128 v[52:55], v11 offset:4096
  v_mfma_f32_16x16x32_bf16 a[28:31], v[32:35], v[72:75], 0
  ds_read_b64_tr_b16 v[84:85], v16 offset:24576
  v_mfma_f32_16x16x32_bf16 a[32:35], v[36:39], v[60:63], 0
  ds_read_b64_tr_b16 v[86:87], v16 offset:25600
  v_mfma_f32_16x16x32_bf16 a[36:39], v[36:39], v[64:67], 0
  ds_read_b128 v[56:59], v11 offset:6144
  v_mfma_f32_16x16x32_bf16 a[40:43], v[36:39], v[68:71], 0
  ds_read_b64_tr_b16 v[88:89], v17 offset:24576
  v_mfma_f32_16x16x32_bf16 a[44:47], v[36:39], v[72:75], 0
  ds_read_b64_tr_b16 v[90:91], v17 offset:25600
  v_mfma_f32_16x16x32_bf16 a[48:51], v[40:43], v[60:63], 0
  v_mfma_f32_16x16x32_bf16 a[52:55], v[40:43], v[64:67], 0
  v_mfma_f32_16x16x32_bf16 a[56:59], v[40:43], v[68:71], 0
  v_mfma_f32_16x16x32_bf16 a[60:63], v[40:43], v[72:75], 0
  s_waitcnt lgkmcnt(0)
  v_mfma_f32_16x16x32_bf16 a[0:3], v[44:47], v[76:79], a[0:3]
  s_waitcnt vmcnt(18)
  s_barrier
  s_add_u32 m0, s52, 0
  v_mfma_f32_16x16x32_bf16 a[4:7], v[44:47], v[80:83], a[4:7]
  buffer_load_dwordx4 v2, s[8:11], s20 offen  lds
  ds_read_b128 v[28:31], v10 offset:32768
  v_mfma_f32_16x16x32_bf16 a[8:11], v[44:47], v[84:87], a[8:11]
  ds_read_b64_tr_b16 v[60:61], v14 offset:49152
  v_mfma_f32_16x16x32_bf16 a[12:15], v[44:47], v[88:91], a[12:15]
  ds_read_b64_tr_b16 v[62:63], v14 offset:50176
  s_add_u32 m0, s53, 0
  v_mfma_f32_16x16x32_bf16 a[16:19], v[48:51], v[76:79], a[16:19]
  buffer_load_dwordx4 v6, s[12:15], s21 offen  lds
  ds_read_b128 v[32:35], v10 offset:34816
  v_mfma_f32_16x16x32_bf16 a[20:23], v[48:51], v[80:83], a[20:23]
  ds_read_b64_tr_b16 v[64:65], v15 offset:49152
  v_mfma_f32_16x16x32_bf16 a[24:27], v[48:51], v[84:87], a[24:27]
  ds_read_b64_tr_b16 v[66:67], v15 offset:50176
  s_add_u32 m0, s52, 1024
  v_mfma_f32_16x16x32_bf16 a[28:31], v[48:51], v[88:91], a[28:31]
  buffer_load_dwordx4 v3, s[8:11], s20 offen  lds
  ds_read_b128 v[36:39], v10 offset:36864
  v_mfma_f32_16x16x32_bf16 a[32:35], v[52:55], v[76:79], a[32:35]
  ds_read_b64_tr_b16 v[68:69], v16 offset:49152
  v_mfma_f32_16x16x32_bf16 a[36:39], v[52:55], v[80:83], a[36:39]
  ds_read_b64_tr_b16 v[70:71], v16 offset:50176
  s_add_u32 m0, s53, 1024
  v_mfma_f32_16x16x32_bf16 a[40:43], v[52:55], v[84:87], a[40:43]
  buffer_load_dwordx4 v7, s[12:15], s21 offen  lds
  ds_read_b128 v[40:43], v10 offset:38912
  v_mfma_f32_16x16x32_bf16 a[44:47], v[52:55], v[88:91], a[44:47]
  ds_read_b64_tr_b16 v[72:73], v17 offset:49152
  v_mfma_f32_16x16x32_bf16 a[48:51], v[56:59], v[76:79], a[48:51]
  ds_read_b64_tr_b16 v[74:75], v17 offset:50176
  s_add_u32 m0, s52, 2048
  v_mfma_f32_16x16x32_bf16 a[52:55], v[56:59], v[80:83], a[52:55]
  buffer_load_dwordx4 v4, s[8:11], s20 offen  lds
  v_mfma_f32_16x16x32_bf16 a[56:59], v[56:59], v[84:87], a[56:59]
  v_mfma_f32_16x16x32_bf16 a[60:63], v[56:59], v[88:91], a[60:63]
  s_waitcnt lgkmcnt(0)
  s_add_u32 m0, s53, 2048
  v_mfma_f32_16x16x32_bf16 a[0:3], v[28:31], v[60:63], a[0:3]
  buffer_load_dwordx4 v8, s[12:15], s21 offen  lds
  ds_read_b128 v[44:47], v11 offset:32768
  v_mfma_f32_16x16x32_bf16 a[4:7], v[28:31], v[64:67], a[4:7]
  ds_read_b64_tr_b16 v[76:77], v14 offset:57344
  v_mfma_f32_16x16x32_bf16 a[8:11], v[28:31], v[68:71], a[8:11]
  ds_read_b64_tr_b16 v[78:79], v14 offset:58368
  v_mfma_f32_16x16x32_bf16 a[12:15], v[28:31], v[72:75], a[12:15]
  ds_read_b128 v[48:51], v11 offset:34816
  s_add_u32 m0, s52, 3072
  v_mfma_f32_16x16x32_bf16 a[16:19], v[32:35], v[60:63], a[16:19]
  buffer_load_dwordx4 v5, s[8:11], s20 offen  lds
  ds_read_b64_tr_b16 v[80:81], v15 offset:57344
  v_mfma_f32_16x16x32_bf16 a[20:23], v[32:35], v[64:67], a[20:23]
  ds_read_b64_tr_b16 v[82:83], v15 offset:58368
  v_mfma_f32_16x16x32_bf16 a[24:27], v[32:35], v[68:71], a[24:27]
  ds_read_b128 v[52:55], v11 offset:36864
  v_mfma_f32_16x16x32_bf16 a[28:31], v[32:35], v[72:75], a[28:31]
  ds_read_b64_tr_b16 v[84:85], v16 offset:57344
  s_add_u32 m0, s53, 3072
  v_mfma_f32_16x16x32_bf16 a[32:35], v[36:39], v[60:63], a[32:35]
  buffer_load_dwordx4 v9, s[12:15], s21 offen  lds
  ds_read_b64_tr_b16 v[86:87], v16 offset:58368
  v_mfma_f32_16x16x32_bf16 a[36:39], v[36:39], v[64:67], a[36:39]
  ds_read_b128 v[56:59], v11 offset:38912
  v_mfma_f32_16x16x32_bf16 a[40:43], v[36:39], v[68:71], a[40:43]
  ds_read_b64_tr_b16 v[88:89], v17 offset:57344
  v_mfma_f32_16x16x32_bf16 a[44:47], v[36:39], v[72:75], a[44:47]
  ds_read_b64_tr_b16 v[90:91], v17 offset:58368
  s_add_u32 s20, s20, 128
  v_mfma_f32_16x16x32_bf16 a[48:51], v[40:43], v[60:63], a[48:51]
  s_add_u32 s21, s21, s51
  v_mfma_f32_16x16x32_bf16 a[52:55], v[40:43], v[64:67], a[52:55]
  v_mfma_f32_16x16x32_bf16 a[56:59], v[40:43], v[68:71], a[56:59]
  v_mfma_f32_16x16x32_bf16 a[60:63], v[40:43], v[72:75], a[60:63]
  s_waitcnt lgkmcnt(0)
  v_mfma_f32_16x16x32_bf16 a[0:3], v[44:47], v[76:79], a[0:3]
  s_waitcnt vmcnt(18)
  s_barrier
  s_add_u32 m0, s52, 32768
  v_mfma_f32_16x16x32_bf16 a[4:7], v[44:47], v[80:83], a[4:7]
  buffer_load_dwordx4 v2, s[8:11], s20 offen  lds
  ds_read_b128 v[28:31], v12 offset:0
  v_mfma_f32_16x16x32_bf16 a[8:11], v[44:47], v[84:87], a[8:11]
  ds_read_b64_tr_b16 v[60:61], v18 offset:16384
  v_mfma_f32_16x16x32_bf16 a[12:15], v[44:47], v[88:91], a[12:15]
  ds_read_b64_tr_b16 v[62:63], v18 offset:17408
  s_add_u32 m0, s53, 32768
  v_mfma_f32_16x16x32_bf16 a[16:19], v[48:51], v[76:79], a[16:19]
  buffer_load_dwordx4 v6, s[12:15], s21 offen  lds
  ds_read_b128 v[32:35], v12 offset:2048
  v_mfma_f32_16x16x32_bf16 a[20:23], v[48:51], v[80:83], a[20:23]
  ds_read_b64_tr_b16 v[64:65], v19 offset:16384
  v_mfma_f32_16x16x32_bf16 a[24:27], v[48:51], v[84:87], a[24:27]
  ds_read_b64_tr_b16 v[66:67], v19 offset:17408
  s_add_u32 m0, s52, 33792
  v_mfma_f32_16x16x32_bf16 a[28:31], v[48:51], v[88:91], a[28:31]
  buffer_load_dwordx4 v3, s[8:11], s20 offen  lds
  ds_read_b128 v[36:39], v12 offset:4096
  v_mfma_f32_16x16x32_bf16 a[32:35], v[52:55], v[76:79], a[32:35]
  ds_read_b64_tr_b16 v[68:69], v20 offset:16384
  v_mfma_f32_16x16x32_bf16 a[36:39], v[52:55], v[80:83], a[36:39]
  ds_read_b64_tr_b16 v[70:71], v20 offset:17408
  s_add_u32 m0, s53, 33792
  v_mfma_f32_16x16x32_bf16 a[40:43], v[52:55], v[84:87], a[40:43]
  buffer_load_dwordx4 v7, s[12:15], s21 offen  lds
  ds_read_b128 v[40:43], v12 offset:6144
  v_mfma_f32_16x16x32_bf16 a[44:47], v[52:55], v[88:91], a[44:47]
  ds_read_b64_tr_b16 v[72:73], v21 offset:16384
  v_mfma_f32_16x16x32_bf16 a[48:51], v[56:59], v[76:79], a[48:51]
  ds_read_b64_tr_b16 v[74:75], v21 offset:17408
  s_add_u32 m0, s52, 34816
  v_mfma_f32_16x16x32_bf16 a[52:55], v[56:59], v[80:83], a[52:55]
  buffer_load_dwordx4 v4, s[8:11], s20 offen  lds
  v_mfma_f32_16x16x32_bf16 a[56:59], v[56:59], v[84:87], a[56:59]
  v_mfma_f32_16x16x32_bf16 a[60:63], v[56:59], v[88:91], a[60:63]
  s_waitcnt lgkmcnt(0)
  s_add_u32 m0, s53, 34816
  v_mfma_f32_16x16x32_bf16 a[0:3], v[28:31], v[60:63], a[0:3]
  buffer_load_dwordx4 v8, s[12:15], s21 offen  lds
  ds_read_b128 v[44:47], v13 offset:0
  v_mfma_f32_16x16x32_bf16 a[4:7], v[28:31], v[64:67], a[4:7]
  ds_read_b64_tr_b16 v[76:77], v18 offset:24576
  v_mfma_f32_16x16x32_bf16 a[8:11], v[28:31], v[68:71], a[8:11]
  ds_read_b64_tr_b16 v[78:79], v18 offset:25600
  v_mfma_f32_16x16x32_bf16 a[12:15], v[28:31], v[72:75], a[12:15]
  ds_read_b128 v[48:51], v13 offset:2048
  s_add_u32 m0, s52, 35840
  v_mfma_f32_16x16x32_bf16 a[16:19], v[32:35], v[60:63], a[16:19]
  buffer_load_dwordx4 v5, s[8:11], s20 offen  lds
  ds_read_b64_tr_b16 v[80:81], v19 offset:24576
  v_mfma_f32_16x16x32_bf16 a[20:23], v[32:35], v[64:67], a[20:23]
  ds_read_b64_tr_b16 v[82:83], v19 offset:25600
  v_mfma_f32_16x16x32_bf16 a[24:27], v[32:35], v[68:71], a[24:27]
  ds_read_b128 v[52:55], v13 offset:4096
  v_mfma_f32_16x16x32_bf16 a[28:31], v[32:35], v[72:75], a[28:31]
  ds_read_b64_tr_b16 v[84:85], v20 offset:24576
  s_add_u32 m0, s53, 35840
  v_mfma_f32_16x16x32_bf16 a[32:35], v[36:39], v[60:63], a[32:35]
  buffer_load_dwordx4 v9, s[12:15], s21 offen  lds
  ds_read_b64_tr_b16 v[86:87], v20 offset:25600
  v_mfma_f32_16x16x32_bf16 a[36:39], v[36:39], v[64:67], a[36:39]
  ds_read_b128 v[56:59], v13 offset:6144
  v_mfma_f32_16x16x32_bf16 a[40:43], v[36:39], v[68:71], a[40:43]
  ds_read_b64_tr_b16 v[88:89], v21 offset:24576
  v_mfma_f32_16x16x32_bf16 a[44:47], v[36:39], v[72:75], a[44:47]
  ds_read_b64_tr_b16 v[90:91], v21 offset:25600
  s_add_u32 s20, s20, 128
  v_mfma_f32_16x16x32_bf16 a[48:51], v[40:43], v[60:63], a[48:51]
  s_add_u32 s21, s21, s51
  v_mfma_f32_16x16x32_bf16 a[52:55], v[40:43], v[64:67], a[52:55]
  v_mfma_f32_16x16x32_bf16 a[56:59], v[40:43], v[68:71], a[56:59]
  v_mfma_f32_16x16x32_bf16 a[60:63], v[40:43], v[72:75], a[60:63]
  s_waitcnt lgkmcnt(0)
  v_mfma_f32_16x16x32_bf16 a[0:3], v[44:47], v[76:79], a[0:3]
  s_waitcnt vmcnt(18)
  s_barrier
  s_add_u32 m0, s52, 65536
  v_mfma_f32_16x16x32_bf16 a[4:7], v[44:47], v[80:83], a[4:7]
  buffer_load_dwordx4 v2, s[8:11], s20 offen  lds
  ds_read_b128 v[28:31], v12 offset:32768
  v_mfma_f32_16x16x32_bf16 a[8:11], v[44:47], v[84:87], a[8:11]
  ds_read_b64_tr_b16 v[60:61], v18 offset:49152
  v_mfma_f32_16x16x32_bf16 a[12:15], v[44:47], v[88:91], a[12:15]
  ds_read_b64_tr_b16 v[62:63], v18 offset:50176
  s_add_u32 m0, s53, 65536
  v_mfma_f32_16x16x32_bf16 a[16:19], v[48:51], v[76:79], a[16:19]
  buffer_load_dwordx4 v6, s[12:15], s21 offen  lds
  ds_read_b128 v[32:35], v12 offset:34816
  v_mfma_f32_16x16x32_bf16 a[20:23], v[48:51], v[80:83], a[20:23]
  ds_read_b64_tr_b16 v[64:65], v19 offset:49152
  v_mfma_f32_16x16x32_bf16 a[24:27], v[48:51], v[84:87], a[24:27]
  ds_read_b64_tr_b16 v[66:67], v19 offset:50176
  s_add_u32 m0, s52, 66560
  v_mfma_f32_16x16x32_bf16 a[28:31], v[48:51], v[88:91], a[28:31]
  buffer_load_dwordx4 v3, s[8:11], s20 offen  lds
  ds_read_b128 v[36:39], v12 offset:36864
  v_mfma_f32_16x16x32_bf16 a[32:35], v[52:55], v[76:79], a[32:35]
  ds_read_b64_tr_b16 v[68:69], v20 offset:49152
  v_mfma_f32_16x16x32_bf16 a[36:39], v[52:55], v[80:83], a[36:39]
  ds_read_b64_tr_b16 v[70:71], v20 offset:50176
  s_add_u32 m0, s53, 66560
  v_mfma_f32_16x16x32_bf16 a[40:43], v[52:55], v[84:87], a[40:43]
  buffer_load_dwordx4 v7, s[12:15], s21 offen  lds
  ds_read_b128 v[40:43], v12 offset:38912
  v_mfma_f32_16x16x32_bf16 a[44:47], v[52:55], v[88:91], a[44:47]
  ds_read_b64_tr_b16 v[72:73], v21 offset:49152
  v_mfma_f32_16x16x32_bf16 a[48:51], v[56:59], v[76:79], a[48:51]
  ds_read_b64_tr_b16 v[74:75], v21 offset:50176
  s_add_u32 m0, s52, 67584
  v_mfma_f32_16x16x32_bf16 a[52:55], v[56:59], v[80:83], a[52:55]
  buffer_load_dwordx4 v4, s[8:11], s20 offen  lds
  v_mfma_f32_16x16x32_bf16 a[56:59], v[56:59], v[84:87], a[56:59]
  v_mfma_f32_16x16x32_bf16 a[60:63], v[56:59], v[88:91], a[60:63]
  s_waitcnt lgkmcnt(0)
  s_add_u32 m0, s53, 67584
  v_mfma_f32_16x16x32_bf16 a[0:3], v[28:31], v[60:63], a[0:3]
  buffer_load_dwordx4 v8, s[12:15], s21 offen  lds
  ds_read_b128 v[44:47], v13 offset:32768
  v_mfma_f32_16x16x32_bf16 a[4:7], v[28:31], v[64:67], a[4:7]
  ds_read_b64_tr_b16 v[76:77], v18 offset:57344
  v_mfma_f32_16x16x32_bf16 a[8:11], v[28:31], v[68:71], a[8:11]
  ds_read_b64_tr_b16 v[78:79], v18 offset:58368
  v_mfma_f32_16x16x32_bf16 a[12:15], v[28:31], v[72:75], a[12:15]
  ds_read_b128 v[48:51], v13 offset:34816
  s_add_u32 m0, s52, 68608
  v_mfma_f32_16x16x32_bf16 a[16:19], v[32:35], v[60:63], a[16:19]
  buffer_load_dwordx4 v5, s[8:11], s20 offen  lds
  ds_read_b64_tr_b16 v[80:81], v19 offset:57344
  v_mfma_f32_16x16x32_bf16 a[20:23], v[32:35], v[64:67], a[20:23]
  ds_read_b64_tr_b16 v[82:83], v19 offset:58368
  v_mfma_f32_16x16x32_bf16 a[24:27], v[32:35], v[68:71], a[24:27]
  ds_read_b128 v[52:55], v13 offset:36864
  v_mfma_f32_16x16x32_bf16 a[28:31], v[32:35], v[72:75], a[28:31]
  ds_read_b64_tr_b16 v[84:85], v20 offset:57344
  s_add_u32 m0, s53, 68608
  v_mfma_f32_16x16x32_bf16 a[32:35], v[36:39], v[60:63], a[32:35]
  buffer_load_dwordx4 v9, s[12:15], s21 offen  lds
  ds_read_b64_tr_b16 v[86:87], v20 offset:58368
  v_mfma_f32_16x16x32_bf16 a[36:39], v[36:39], v[64:67], a[36:39]
  ds_read_b128 v[56:59], v13 offset:38912
  v_mfma_f32_16x16x32_bf16 a[40:43], v[36:39], v[68:71], a[40:43]
  ds_read_b64_tr_b16 v[88:89], v21 offset:57344
  v_mfma_f32_16x16x32_bf16 a[44:47], v[36:39], v[72:75], a[44:47]
  ds_read_b64_tr_b16 v[90:91], v21 offset:58368
  s_add_u32 s20, s20, 128
  v_mfma_f32_16x16x32_bf16 a[48:51], v[40:43], v[60:63], a[48:51]
  s_add_u32 s21, s21, s51
  v_mfma_f32_16x16x32_bf16 a[52:55], v[40:43], v[64:67], a[52:55]
  v_mfma_f32_16x16x32_bf16 a[56:59], v[40:43], v[68:71], a[56:59]
  v_mfma_f32_16x16x32_bf16 a[60:63], v[40:43], v[72:75], a[60:63]
  s_waitcnt lgkmcnt(0)
  v_mfma_f32_16x16x32_bf16 a[0:3], v[44:47], v[76:79], a[0:3]
  s_waitcnt vmcnt(16)
  s_barrier
  s_add_u32 m0, s52, 98304
  v_mfma_f32_16x16x32_bf16 a[4:7], v[44:47], v[80:83], a[4:7]
  buffer_load_dwordx4 v2, s[8:11], s20 offen  lds
  ds_read_b128 v[28:31], v10 offset:0
  v_mfma_f32_16x16x32_bf16 a[8:11], v[44:47], v[84:87], a[8:11]
  ds_read_b64_tr_b16 v[60:61], v14 offset:16384
  v_mfma_f32_16x16x32_bf16 a[12:15], v[44:47], v[88:91], a[12:15]
  ds_read_b64_tr_b16 v[62:63], v14 offset:17408
  s_add_u32 m0, s53, 98304
  v_mfma_f32_16x16x32_bf16 a[16:19], v[48:51], v[76:79], a[16:19]
  buffer_load_dwordx4 v6, s[12:15], s21 offen  lds
  ds_read_b128 v[32:35], v10 offset:2048
  v_mfma_f32_16x16x32_bf16 a[20:23], v[48:51], v[80:83], a[20:23]
  ds_read_b64_tr_b16 v[64:65], v15 offset:16384
  v_mfma_f32_16x16x32_bf16 a[24:27], v[48:51], v[84:87], a[24:27]
  ds_read_b64_tr_b16 v[66:67], v15 offset:17408
  s_add_u32 m0, s52, 99328
  v_mfma_f32_16x16x32_bf16 a[28:31], v[48:51], v[88:91], a[28:31]
  buffer_load_dwordx4 v3, s[8:11], s20 offen  lds
  ds_read_b128 v[36:39], v10 offset:4096
  v_mfma_f32_16x16x32_bf16 a[32:35], v[52:55], v[76:79], a[32:35]
  ds_read_b64_tr_b16 v[68:69], v16 offset:16384
  v_mfma_f32_16x16x32_bf16 a[36:39], v[52:55], v[80:83], a[36:39]
  ds_read_b64_tr_b16 v[70:71], v16 offset:17408
  s_add_u32 m0, s53, 99328
  v_mfma_f32_16x16x32_bf16 a[40:43], v[52:55], v[84:87], a[40:43]
  buffer_load_dwordx4 v7, s[12:15], s21 offen  lds
  ds_read_b128 v[40:43], v10 offset:6144
  v_mfma_f32_16x16x32_bf16 a[44:47], v[52:55], v[88:91], a[44:47]
  ds_read_b64_tr_b16 v[72:73], v17 offset:16384
  v_mfma_f32_16x16x32_bf16 a[48:51], v[56:59], v[76:79], a[48:51]
  ds_read_b64_tr_b16 v[74:75], v17 offset:17408
  s_add_u32 m0, s52, 100352
  v_mfma_f32_16x16x32_bf16 a[52:55], v[56:59], v[80:83], a[52:55]
  buffer_load_dwordx4 v4, s[8:11], s20 offen  lds
  v_mfma_f32_16x16x32_bf16 a[56:59], v[56:59], v[84:87], a[56:59]
  v_mfma_f32_16x16x32_bf16 a[60:63], v[56:59], v[88:91], a[60:63]
L_g5_loop:
  s_sub_u32 s25, s25, 1
  s_cmp_eq_u32 s25, 0
  s_cbranch_scc1 L_g5_fin
  s_waitcnt lgkmcnt(0)
  s_add_u32 m0, s53, 100352
  v_mfma_f32_16x16x32_bf16 a[0:3], v[28:31], v[60:63], a[0:3]
  buffer_load_dwordx4 v8, s[12:15], s21 offen  lds
  ds_read_b128 v[44:47], v11 offset:0
  v_mfma_f32_16x16x32_bf16 a[4:7], v[28:31], v[64:67], a[4:7]
  ds_read_b64_tr_b16 v[76:77], v14 offset:24576
  v_mfma_f32_16x16x32_bf16 a[8:11], v[28:31], v[68:71], a[8:11]
  ds_read_b64_tr_b16 v[78:79], v14 offset:25600
  v_mfma_f32_16x16x32_bf16 a[12:15], v[28:31], v[72:75], a[12:15]
  ds_read_b128 v[48:51], v11 offset:2048
  s_add_u32 m0, s52, 101376
  v_mfma_f32_16x16x32_bf16 a[16:19], v[32:35], v[60:63], a[16:19]
  buffer_load_dwordx4 v5, s[8:11], s20 offen  lds
  ds_read_b64_tr_b16 v[80:81], v15 offset:24576
  v_mfma_f32_16x16x32_bf16 a[20:23], v[32:35], v[64:67], a[20:23]
  ds_read_b64_tr_b16 v[82:83], v15 offset:25600
  v_mfma_f32_16x16x32_bf16 a[24:27], v[32:35], v[68:71], a[24:27]
  ds_read_b128 v[52:55], v11 offset:4096
  v_mfma_f32_16x16x32_bf16 a[28:31], v[32:35], v[72:75], a[28:31]
  ds_read_b64_tr_b16 v[84:85], v16 offset:24576
  s_add_u32 m0, s53, 101376
  v_mfma_f32_16x16x32_bf16 a[32:35], v[36:39], v[60:63], a[32:35]
  buffer_load_dwordx4 v9, s[12:15], s21 offen  lds
  ds_read_b64_tr_b16 v[86:87], v16 offset:25600
  v_mfma_f32_16x16x32_bf16 a[36:39], v[36:39], v[64:67], a[36:39]
  ds_read_b128 v[56:59], v11 offset:6144
  v_mfma_f32_16x16x32_bf16 a[40:43], v[36:39], v[68:71], a[40:43]
  ds_read_b64_tr_b16 v[88:89], v17 offset:24576
  v_mfma_f32_16x16x32_bf16 a[44:47], v[36:39], v[72:75], a[44:47]
  ds_read_b64_tr_b16 v[90:91], v17 offset:25600
  s_add_u32 s20, s20, 128
  v_mfma_f32_16x16x32_bf16 a[48:51], v[40:43], v[60:63], a[48:51]
  s_add_u32 s21, s21, s51
  v_mfma_f32_16x16x32_bf16 a[52:55], v[40:43], v[64:67], a[52:55]
  v_mfma_f32_16x16x32_bf16 a[56:59], v[40:43], v[68:71], a[56:59]
  v_mfma_f32_16x16x32_bf16 a[60:63], v[40:43], v[72:75], a[60:63]
  s_waitcnt lgkmcnt(0)
  v_mfma_f32_16x16x32_bf16 a[0:3], v[44:47], v[76:79], a[0:3]
  s_waitcnt vmcnt(16)
  s_barrier
  s_add_u32 m0, s52, 0
  v_mfma_f32_16x16x32_bf16 a[4:7], v[44:47], v[80:83], a[4:7]
  buffer_load_dwordx4 v2, s[8:11], s20 offen  lds
  ds_read_b128 v[28:31], v10 offset:32768
  v_mfma_f32_16x16x32_bf16 a[8:11], v[44:47], v[84:87], a[8:11]
  ds_read_b64_tr_b16 v[60:61], v14 offset:49152
  v_mfma_f32_16x16x32_bf16 a[12:15], v[44:47], v[88:91], a[12:15]
  ds_read_b64_tr_b16 v[62:63], v14 offset:50176
  s_add_u32 m0, s53, 0
  v_mfma_f32_16x16x32_bf16 a[16:19], v[48:51], v[76:79], a[16:19]
  buffer_load_dwordx4 v6, s[12:15], s21 offen  lds
  ds_read_b128 v[32:35], v10 offset:34816
  v_mfma_f32_16x16x32_bf16 a[20:23], v[48:51], v[80:83], a[20:23]
  ds_read_b64_tr_b16 v[64:65], v15 offset:49152
  v_mfma_f32_16x16x32_bf16 a[24:27], v[48:51], v[84:87], a[24:27]
  ds_read_b64_tr_b16 v[66:67], v15 offset:50176
  s_add_u32 m0, s52, 1024
  v_mfma_f32_16x16x32_bf16 a[28:31], v[48:51], v[88:91], a[28:31]
  buffer_load_dwordx4 v3, s[8:11], s20 offen  lds
  ds_read_b128 v[36:39], v10 offset:36864
  v_mfma_f32_16x16x32_bf16 a[32:35], v[52:55], v[76:79], a[32:35]
  ds_read_b64_tr_b16 v[68:69], v16 offset:49152
  v_mfma_f32_16x16x32_bf16 a[36:39], v[52:55], v[80:83], a[36:39]
  ds_read_b64_tr_b16 v[70:71], v16 offset:50176
  s_add_u32 m0, s53, 1024
  v_mfma_f32_16x16x32_bf16 a[40:43], v[52:55], v[84:87], a[40:43]
  buffer_load_dwordx4 v7, s[12:15], s21 offen  lds
  ds_read_b128 v[40:43], v10 offset:38912
  v_mfma_f32_16x16x32_bf16 a[44:47], v[52:55], v[88:91], a[44:47]
  ds_read_b64_tr_b16 v[72:73], v17 offset:49152
  v_mfma_f32_16x16x32_bf16 a[48:51], v[56:59], v[76:79], a[48:51]
  ds_read_b64_tr_b16 v[74:75], v17 offset:50176
  s_add_u32 m0, s52, 2048
  v_mfma_f32_16x16x32_bf16 a[52:55], v[56:59], v[80:83], a[52:55]
  buffer_load_dwordx4 v4, s[8:11], s20 offen  lds
  v_mfma_f32_16x16x32_bf16 a[56:59], v[56:59], v[84:87], a[56:59]
  v_mfma_f32_16x16x32_bf16 a[60:63], v[56:59], v[88:91], a[60:63]
  s_waitcnt lgkmcnt(0)
  s_add_u32 m0, s53, 2048
  v_mfma_f32_16x16x32_bf16 a[0:3], v[28:31], v[60:63], a[0:3]
  buffer_load_dwordx4 v8, s[12:15], s21 offen  lds
  ds_read_b128 v[44:47], v11 offset:32768
  v_mfma_f32_16x16x32_bf16 a[4:7], v[28:31], v[64:67], a[4:7]
  ds_read_b64_tr_b16 v[76:77], v14 offset:57344
  v_mfma_f32_16x16x32_bf16 a[8:11], v[28:31], v[68:71], a[8:11]
  ds_read_b64_tr_b16 v[78:79], v14 offset:58368
  v_mfma_f32_16x16x32_bf16 a[12:15], v[28:31], v[72:75], a[12:15]
  ds_read_b128 v[48:51], v11 offset:34816
  s_add_u32 m0, s52, 3072
  v_mfma_f32_16x16x32_bf16 a[16:19], v[32:35], v[60:63], a[16:19]
  buffer_load_dwordx4 v5, s[8:11], s20 offen  lds
  ds_read_b64_tr_b16 v[80:81], v15 offset:57344
  v_mfma_f32_16x16x32_bf16 a[20:23], v[32:35], v[64:67], a[20:23]
  ds_read_b64_tr_b16 v[82:83], v15 offset:58368
  v_mfma_f32_16x16x32_bf16 a[24:27], v[32:35], v[68:71], a[24:27]
  ds_read_b128 v[52:55], v11 offset:36864
  v_mfma_f32_16x16x32_bf16 a[28:31], v[32:35], v[72:75], a[28:31]
  ds_read_b64_tr_b16 v[84:85], v16 offset:57344
  s_add_u32 m0, s53, 3072
  v_mfma_f32_16x16x32_bf16 a[32:35], v[36:39], v[60:63], a[32:35]
  buffer_load_dwordx4 v9, s[12:15], s21 offen  lds
  ds_read_b64_tr_b16 v[86:87], v16 offset:58368
  v_mfma_f32_16x16x32_bf16 a[36:39], v[36:39], v[64:67], a[36:39]
  ds_read_b128 v[56:59], v11 offset:38912
  v_mfma_f32_16x16x32_bf16 a[40:43], v[36:39], v[68:71], a[40:43]
  ds_read_b64_tr_b16 v[88:89], v17 offset:57344
  v_mfma_f32_16x16x32_bf16 a[44:47], v[36:39], v[72:75], a[44:47]
  ds_read_b64_tr_b16 v[90:91], v17 offset:58368
  s_add_u32 s20, s20, 128
  v_mfma_f32_16x16x32_bf16 a[48:51], v[40:43], v[60:63], a[48:51]
  s_add_u32 s21, s21, s51
  v_mfma_f32_16x16x32_bf16 a[52:55], v[40:43], v[64:67], a[52:55]
  v_mfma_f32_16x16x32_bf16 a[56:59], v[40:43], v[68:71], a[56:59]
  v_mfma_f32_16x16x32_bf16 a[60:63], v[40:43], v[72:75], a[60:63]
  s_waitcnt lgkmcnt(0)
  v_mfma_f32_16x16x32_bf16 a[0:3], v[44:47], v[76:79], a[0:3]
  s_waitcnt vmcnt(16)
  s_barrier
  s_add_u32 m0, s52, 32768
  v_mfma_f32_16x16x32_bf16 a[4:7], v[44:47], v[80:83], a[4:7]
  buffer_load_dwordx4 v2, s[8:11], s20 offen  lds
  ds_read_b128 v[28:31], v12 offset:0
  v_mfma_f32_16x16x32_bf16 a[8:11], v[44:47], v[84:87], a[8:11]
  ds_read_b64_tr_b16 v[60:61], v18 offset:16384
  v_mfma_f32_16x16x32_bf16 a[12:15], v[44:47], v[88:91], a[12:15]
  ds_read_b64_tr_b16 v[62:63], v18 offset:17408
  s_add_u32 m0, s53, 32768
  v_mfma_f32_16x16x32_bf16 a[16:19], v[48:51], v[76:79], a[16:19]
  buffer_load_dwordx4 v6, s[12:15], s21 offen  lds
  ds_read_b128 v[32:35], v12 offset:2048
  v_mfma_f32_16x16x32_bf16 a[20:23], v[48:51], v[80:83], a[20:23]
  ds_read_b64_tr_b16 v[64:65], v19 offset:16384
  v_mfma_f32_16x16x32_bf16 a[24:27], v[48:51], v[84:87], a[24:27]
  ds_read_b64_tr_b16 v[66:67], v19 offset:17408
  s_add_u32 m0, s52, 33792
  v_mfma_f32_16x16x32_bf16 a[28:31], v[48:51], v[88:91], a[28:31]
  buffer_load_dwordx4 v3, s[8:11], s20 offen  lds
  ds_read_b128 v[36:39], v12 offset:4096
  v_mfma_f32_16x16x32_bf16 a[32:35], v[52:55], v[76:79], a[32:35]
  ds_read_b64_tr_b16 v[68:69], v20 offset:16384
  v_mfma_f32_16x16x32_bf16 a[36:39], v[52:55], v[80:83], a[36:39]
  ds_read_b64_tr_b16 v[70:71], v20 offset:17408
  s_add_u32 m0, s53, 33792
  v_mfma_f32_16x16x32_bf16 a[40:43], v[52:55], v[84:87], a[40:43]
  buffer_load_dwordx4 v7, s[12:15], s21 offen  lds
  ds_read_b128 v[40:43], v12 offset:6144
  v_mfma_f32_16x16x32_bf16 a[44:47], v[52:55], v[88:91], a[44:47]
  ds_read_b64_tr_b16 v[72:73], v21 offset:16384
  v_mfma_f32_16x16x32_bf16 a[48:51], v[56:59], v[76:79], a[48:51]
  ds_read_b64_tr_b16 v[74:75], v21 offset:17408
  s_add_u32 m0, s52, 34816
  v_mfma_f32_16x16x32_bf16 a[52:55], v[56:59], v[80:83], a[52:55]
  buffer_load_dwordx4 v4, s[8:11], s20 offen  lds
  v_mfma_f32_16x16x32_bf16 a[56:59], v[56:59], v[84:87], a[56:59]
  v_mfma_f32_16x16x32_bf16 a[60:63], v[56:59], v[88:91], a[60:63]
  s_waitcnt lgkmcnt(0)
  s_add_u32 m0, s53, 34816
  v_mfma_f32_16x16x32_bf16 a[0:3], v[28:31], v[60:63], a[0:3]
  buffer_load_dwordx4 v8, s[12:15], s21 offen  lds
  ds_read_b128 v[44:47], v13 offset:0
  v_mfma_f32_16x16x32_bf16 a[4:7], v[28:31], v[64:67], a[4:7]
  ds_read_b64_tr_b16 v[76:77], v18 offset:24576
  v_mfma_f32_16x16x32_bf16 a[8:11], v[28:31], v[68:71], a[8:11]
  ds_read_b64_tr_b16 v[78:79], v18 offset:25600
  v_mfma_f32_16x16x32_bf16 a[12:15], v[28:31], v[72:75], a[12:15]
  ds_read_b128 v[48:51], v13 offset:2048
  s_add_u32 m0, s52, 35840
  v_mfma_f32_16x16x32_bf16 a[16:19], v[32:35], v[60:63], a[16:19]
  buffer_load_dwordx4 v5, s[8:11], s20 offen  lds
  ds_read_b64_tr_b16 v[80:81], v19 offset:24576
  v_mfma_f32_16x16x32_bf16 a[20:23], v[32:35], v[64:67], a[20:23]
  ds_read_b64_tr_b16 v[82:83], v19 offset:25600
  v_mfma_f32_16x16x32_bf16 a[24:27], v[32:35], v[68:71], a[24:27]
  ds_read_b128 v[52:55], v13 offset:4096
  v_mfma_f32_16x16x32_bf16 a[28:31], v[32:35], v[72:75], a[28:31]
  ds_read_b64_tr_b16 v[84:85], v20 offset:24576
  s_add_u32 m0, s53, 35840
  v_mfma_f32_16x16x32_bf16 a[32:35], v[36:39], v[60:63], a[32:35]
  buffer_load_dwordx4 v9, s[12:15], s21 offen  lds
  ds_read_b64_tr_b16 v[86:87], v20 offset:25600
  v_mfma_f32_16x16x32_bf16 a[36:39], v[36:39], v[64:67], a[36:39]
  ds_read_b128 v[56:59], v13 offset:6144
  v_mfma_f32_16x16x32_bf16 a[40:43], v[36:39], v[68:71], a[40:43]
  ds_read_b64_tr_b16 v[88:89], v21 offset:24576
  v_mfma_f32_16x16x32_bf16 a[44:47], v[36:39], v[72:75], a[44:47]
  ds_read_b64_tr_b16 v[90:91], v21 offset:25600
  s_add_u32 s20, s20, 128
  v_mfma_f32_16x16x32_bf16 a[48:51], v[40:43], v[60:63], a[48:51]
  s_add_u32 s21, s21, s51
  v_mfma_f32_16x16x32_bf16 a[52:55], v[40:43], v[64:67], a[52:55]
  v_mfma_f32_16x16x32_bf16 a[56:59], v[40:43], v[68:71], a[56:59]
  v_mfma_f32_16x16x32_bf16 a[60:63], v[40:43], v[72:75], a[60:63]
  s_waitcnt lgkmcnt(0)
  v_mfma_f32_16x16x32_bf16 a[0:3], v[44:47], v[76:79], a[0:3]
  s_waitcnt vmcnt(16)
  s_barrier
  s_add_u32 m0, s52, 65536
  v_mfma_f32_16x16x32_bf16 a[4:7], v[44:47], v[80:83], a[4:7]
  buffer_load_dwordx4 v2, s[8:11], s20 offen  lds
  ds_read_b128 v[28:31], v12 offset:32768
  v_mfma_f32_16x16x32_bf16 a[8:11], v[44:47], v[84:87], a[8:11]
  ds_read_b64_tr_b16 v[60:61], v18 offset:49152
  v_mfma_f32_16x16x32_bf16 a[12:15], v[44:47], v[88:91], a[12:15]
  ds_read_b64_tr_b16 v[62:63], v18 offset:50176
  s_add_u32 m0, s53, 65536
  v_mfma_f32_16x16x32_bf16 a[16:19], v[48:51], v[76:79], a[16:19]
  buffer_load_dwordx4 v6, s[12:15], s21 offen  lds
  ds_read_b128 v[32:35], v12 offset:34816
  v_mfma_f32_16x16x32_bf16 a[20:23], v[48:51], v[80:83], a[20:23]
  ds_read_b64_tr_b16 v[64:65], v19 offset:49152
  v_mfma_f32_16x16x32_bf16 a[24:27], v[48:51], v[84:87], a[24:27]
  ds_read_b64_tr_b16 v[66:67], v19 offset:50176
  s_add_u32 m0, s52, 66560
  v_mfma_f32_16x16x32_bf16 a[28:31], v[48:51], v[88:91], a[28:31]
  buffer_load_dwordx4 v3, s[8:11], s20 offen  lds
  ds_read_b128 v[36:39], v12 offset:36864
  v_mfma_f32_16x16x32_bf16 a[32:35], v[52:55], v[76:79], a[32:35]
  ds_read_b64_tr_b16 v[68:69], v20 offset:49152
  v_mfma_f32_16x16x32_bf16 a[36:39], v[52:55], v[80:83], a[36:39]
  ds_read_b64_tr_b16 v[70:71], v20 offset:50176
  s_add_u32 m0, s53, 66560
  v_mfma_f32_16x16x32_bf16 a[40:43], v[52:55], v[84:87], a[40:43]
  buffer_load_dwordx4 v7, s[12:15], s21 offen  lds
  ds_read_b128 v[40:43], v12 offset:38912
  v_mfma_f32_16x16x32_bf16 a[44:47], v[52:55], v[88:91], a[44:47]
  ds_read_b64_tr_b16 v[72:73], v21 offset:49152
  v_mfma_f32_16x16x32_bf16 a[48:51], v[56:59], v[76:79], a[48:51]
  ds_read_b64_tr_b16 v[74:75], v21 offset:50176
  s_add_u32 m0, s52, 67584
  v_mfma_f32_16x16x32_bf16 a[52:55], v[56:59], v[80:83], a[52:55]
  buffer_load_dwordx4 v4, s[8:11], s20 offen  lds
  v_mfma_f32_16x16x32_bf16 a[56:59], v[56:59], v[84:87], a[56:59]
  v_mfma_f32_16x16x32_bf16 a[60:63], v[56:59], v[88:91], a[60:63]
  s_waitcnt lgkmcnt(0)
  s_add_u32 m0, s53, 67584
  v_mfma_f32_16x16x32_bf16 a[0:3], v[28:31], v[60:63], a[0:3]
  buffer_load_dwordx4 v8, s[12:15], s21 offen  lds
  ds_read_b128 v[44:47], v13 offset:32768
  v_mfma_f32_16x16x32_bf16 a[4:7], v[28:31], v[64:67], a[4:7]
  ds_read_b64_tr_b16 v[76:77], v18 offset:57344
  v_mfma_f32_16x16x32_bf16 a[8:11], v[28:31], v[68:71], a[8:11]
  ds_read_b64_tr_b16 v[78:79], v18 offset:58368
  v_mfma_f32_16x16x32_bf16 a[12:15], v[28:31], v[72:75], a[12:15]
  ds_read_b128 v[48:51], v13 offset:34816
  s_add_u32 m0, s52, 68608
  v_mfma_f32_16x16x32_bf16 a[16:19], v[32:35], v[60:63], a[16:19]
  buffer_load_dwordx4 v5, s[8:11], s20 offen  lds
  ds_read_b64_tr_b16 v[80:81], v19 offset:57344
  v_mfma_f32_16x16x32_bf16 a[20:23], v[32:35], v[64:67], a[20:23]
  ds_read_b64_tr_b16 v[82:83], v19 offset:58368
  v_mfma_f32_16x16x32_bf16 a[24:27], v[32:35], v[68:71], a[24:27]
  ds_read_b128 v[52:55], v13 offset:36864
  v_mfma_f32_16x16x32_bf16 a[28:31], v[32:35], v[72:75], a[28:31]
  ds_read_b64_tr_b16 v[84:85], v20 offset:57344
  s_add_u32 m0, s53, 68608
  v_mfma_f32_16x16x32_bf16 a[32:35], v[36:39], v[60:63], a[32:35]
  buffer_load_dwordx4 v9, s[12:15], s21 offen  lds
  ds_read_b64_tr_b16 v[86:87], v20 offset:58368
  v_mfma_f32_16x16x32_bf16 a[36:39], v[36:39], v[64:67], a[36:39]
  ds_read_b128 v[56:59], v13 offset:38912
  v_mfma_f32_16x16x32_bf16 a[40:43], v[36:39], v[68:71], a[40:43]
  ds_read_b64_tr_b16 v[88:89], v21 offset:57344
  v_mfma_f32_16x16x32_bf16 a[44:47], v[36:39], v[72:75], a[44:47]
  ds_read_b64_tr_b16 v[90:91], v21 offset:58368
  s_add_u32 s20, s20, 128
  v_mfma_f32_16x16x32_bf16 a[48:51], v[40:43], v[60:63], a[48:51]
  s_add_u32 s21, s21, s51
  v_mfma_f32_16x16x32_bf16 a[52:55], v[40:43], v[64:67], a[52:55]
  v_mfma_f32_16x16x32_bf16 a[56:59], v[40:43], v[68:71], a[56:59]
  v_mfma_f32_16x16x32_bf16 a[60:63], v[40:43], v[72:75], a[60:63]
  s_waitcnt lgkmcnt(0)
  v_mfma_f32_16x16x32_bf16 a[0:3], v[44:47], v[76:79], a[0:3]
  s_waitcnt vmcnt(16)
  s_barrier
  s_add_u32 m0, s52, 98304
  v_mfma_f32_16x16x32_bf16 a[4:7], v[44:47], v[80:83], a[4:7]
  buffer_load_dwordx4 v2, s[8:11], s20 offen  lds
  ds_read_b128 v[28:31], v10 offset:0
  v_mfma_f32_16x16x32_bf16 a[8:11], v[44:47], v[84:87], a[8:11]
  ds_read_b64_tr_b16 v[60:61], v14 offset:16384
  v_mfma_f32_16x16x32_bf16 a[12:15], v[44:47], v[88:91], a[12:15]
  ds_read_b64_tr_b16 v[62:63], v14 offset:17408
  s_add_u32 m0, s53, 98304
  v_mfma_f32_16x16x32_bf16 a[16:19], v[48:51], v[76:79], a[16:19]
  buffer_load_dwordx4 v6, s[12:15], s21 offen  lds
  ds_read_b128 v[32:35], v10 offset:2048
  v_mfma_f32_16x16x32_bf16 a[20:23], v[48:51], v[80:83], a[20:23]
  ds_read_b64_tr_b16 v[64:65], v15 offset:16384
  v_mfma_f32_16x16x32_bf16 a[24:27], v[48:51], v[84:87], a[24:27]
  ds_read_b64_tr_b16 v[66:67], v15 offset:17408
  s_add_u32 m0, s52, 99328
  v_mfma_f32_16x16x32_bf16 a[28:31], v[48:51], v[88:91], a[28:31]
  buffer_load_dwordx4 v3, s[8:11], s20 offen  lds
  ds_read_b128 v[36:39], v10 offset:4096
  v_mfma_f32_16x16x32_bf16 a[32:35], v[52:55], v[76:79], a[32:35]
  ds_read_b64_tr_b16 v[68:69], v16 offset:16384
  v_mfma_f32_16x16x32_bf16 a[36:39], v[52:55], v[80:83], a[36:39]
  ds_read_b64_tr_b16 v[70:71], v16 offset:17408
  s_add_u32 m0, s53, 99328
  v_mfma_f32_16x16x32_bf16 a[40:43], v[52:55], v[84:87], a[40:43]
  buffer_load_dwordx4 v7, s[12:15], s21 offen  lds
  ds_read_b128 v[40:43], v10 offset:6144
  v_mfma_f32_16x16x32_bf16 a[44:47], v[52:55], v[88:91], a[44:47]
  ds_read_b64_tr_b16 v[72:73], v17 offset:16384
  v_mfma_f32_16x16x32_bf16 a[48:51], v[56:59], v[76:79], a[48:51]
  ds_read_b64_tr_b16 v[74:75], v17 offset:17408
  s_add_u32 m0, s52, 100352
  v_mfma_f32_16x16x32_bf16 a[52:55], v[56:59], v[80:83], a[52:55]
  buffer_load_dwordx4 v4, s[8:11], s20 offen  lds
  v_mfma_f32_16x16x32_bf16 a[56:59], v[56:59], v[84:87], a[56:59]
  v_mfma_f32_16x16x32_bf16 a[60:63], v[56:59], v[88:91], a[60:63]
  s_branch L_g5_loop
L_g5_fin:
  s_cmp_lg_u32 s32, 0
  s_cbranch_scc1 L_rq_86
  s_cmp_eq_u32 s39, 0
  s_cbranch_scc1 L_rq_86
  s_lshl_b32 s99, s33, 7
  s_add_u32 s99, s99, 0x3d00200
  v_mov_b32 v244, 1
  v_mov_b32 v245, 0
  s_mov_b64 exec, 1
  buffer_atomic_add v244, v245, s[4:7], s99 offen sc0 sc1
  s_mov_b64 exec, -1
L_rq_86:
  s_waitcnt lgkmcnt(0)
  s_add_u32 m0, s53, 100352
  v_mfma_f32_16x16x32_bf16 a[0:3], v[28:31], v[60:63], a[0:3]
  buffer_load_dwordx4 v8, s[12:15], s21 offen  lds
  ds_read_b128 v[44:47], v11 offset:0
  v_mfma_f32_16x16x32_bf16 a[4:7], v[28:31], v[64:67], a[4:7]
  ds_read_b64_tr_b16 v[76:77], v14 offset:24576
  v_mfma_f32_16x16x32_bf16 a[8:11], v[28:31], v[68:71], a[8:11]
  ds_read_b64_tr_b16 v[78:79], v14 offset:25600
  v_mfma_f32_16x16x32_bf16 a[12:15], v[28:31], v[72:75], a[12:15]
  ds_read_b128 v[48:51], v11 offset:2048
  s_add_u32 m0, s52, 101376
  v_mfma_f32_16x16x32_bf16 a[16:19], v[32:35], v[60:63], a[16:19]
  buffer_load_dwordx4 v5, s[8:11], s20 offen  lds
  ds_read_b64_tr_b16 v[80:81], v15 offset:24576
  v_mfma_f32_16x16x32_bf16 a[20:23], v[32:35], v[64:67], a[20:23]
  ds_read_b64_tr_b16 v[82:83], v15 offset:25600
  v_mfma_f32_16x16x32_bf16 a[24:27], v[32:35], v[68:71], a[24:27]
  ds_read_b128 v[52:55], v11 offset:4096
  v_mfma_f32_16x16x32_bf16 a[28:31], v[32:35], v[72:75], a[28:31]
  ds_read_b64_tr_b16 v[84:85], v16 offset:24576
  s_add_u32 m0, s53, 101376
  v_mfma_f32_16x16x32_bf16 a[32:35], v[36:39], v[60:63], a[32:35]
  buffer_load_dwordx4 v9, s[12:15], s21 offen  lds
  ds_read_b64_tr_b16 v[86:87], v16 offset:25600
  v_mfma_f32_16x16x32_bf16 a[36:39], v[36:39], v[64:67], a[36:39]
  ds_read_b128 v[56:59], v11 offset:6144
  v_mfma_f32_16x16x32_bf16 a[40:43], v[36:39], v[68:71], a[40:43]
  ds_read_b64_tr_b16 v[88:89], v17 offset:24576
  v_mfma_f32_16x16x32_bf16 a[44:47], v[36:39], v[72:75], a[44:47]
  ds_read_b64_tr_b16 v[90:91], v17 offset:25600
  s_add_u32 s20, s20, 128
  v_mfma_f32_16x16x32_bf16 a[48:51], v[40:43], v[60:63], a[48:51]
  s_add_u32 s21, s21, s51
  v_mfma_f32_16x16x32_bf16 a[52:55], v[40:43], v[64:67], a[52:55]
  v_mfma_f32_16x16x32_bf16 a[56:59], v[40:43], v[68:71], a[56:59]
  v_mfma_f32_16x16x32_bf16 a[60:63], v[40:43], v[72:75], a[60:63]
  s_waitcnt lgkmcnt(0)
  v_mfma_f32_16x16x32_bf16 a[0:3], v[44:47], v[76:79], a[0:3]
  s_waitcnt vmcnt(16)
  s_barrier
  v_mfma_f32_16x16x32_bf16 a[4:7], v[44:47], v[80:83], a[4:7]
  ds_read_b128 v[28:31], v10 offset:32768
  v_mfma_f32_16x16x32_bf16 a[8:11], v[44:47], v[84:87], a[8:11]
  ds_read_b64_tr_b16 v[60:61], v14 offset:49152
  v_mfma_f32_16x16x32_bf16 a[12:15], v[44:47], v[88:91], a[12:15]
  ds_read_b64_tr_b16 v[62:63], v14 offset:50176
  v_mfma_f32_16x16x32_bf16 a[16:19], v[48:51], v[76:79], a[16:19]
  ds_read_b128 v[32:35], v10 offset:34816
  v_mfma_f32_16x16x32_bf16 a[20:23], v[48:51], v[80:83], a[20:23]
  ds_read_b64_tr_b16 v[64:65], v15 offset:49152
  v_mfma_f32_16x16x32_bf16 a[24:27], v[48:51], v[84:87], a[24:27]
  ds_read_b64_tr_b16 v[66:67], v15 offset:50176
  v_mfma_f32_16x16x32_bf16 a[28:31], v[48:51], v[88:91], a[28:31]
  ds_read_b128 v[36:39], v10 offset:36864
  v_mfma_f32_16x16x32_bf16 a[32:35], v[52:55], v[76:79], a[32:35]
  ds_read_b64_tr_b16 v[68:69], v16 offset:49152
  v_mfma_f32_16x16x32_bf16 a[36:39], v[52:55], v[80:83], a[36:39]
  ds_read_b64_tr_b16 v[70:71], v16 offset:50176
  v_mfma_f32_16x16x32_bf16 a[40:43], v[52:55], v[84:87], a[40:43]
  ds_read_b128 v[40:43], v10 offset:38912
  v_mfma_f32_16x16x32_bf16 a[44:47], v[52:55], v[88:91], a[44:47]
  ds_read_b64_tr_b16 v[72:73], v17 offset:49152
  v_mfma_f32_16x16x32_bf16 a[48:51], v[56:59], v[76:79], a[48:51]
  ds_read_b64_tr_b16 v[74:75], v17 offset:50176
  v_mfma_f32_16x16x32_bf16 a[52:55], v[56:59], v[80:83], a[52:55]
  v_mfma_f32_16x16x32_bf16 a[56:59], v[56:59], v[84:87], a[56:59]
  v_mfma_f32_16x16x32_bf16 a[60:63], v[56:59], v[88:91], a[60:63]
  s_waitcnt lgkmcnt(0)
  v_mfma_f32_16x16x32_bf16 a[0:3], v[28:31], v[60:63], a[0:3]
  ds_read_b128 v[44:47], v11 offset:32768
  v_mfma_f32_16x16x32_bf16 a[4:7], v[28:31], v[64:67], a[4:7]
  ds_read_b64_tr_b16 v[76:77], v14 offset:57344
  v_mfma_f32_16x16x32_bf16 a[8:11], v[28:31], v[68:71], a[8:11]
  ds_read_b64_tr_b16 v[78:79], v14 offset:58368
  v_mfma_f32_16x16x32_bf16 a[12:15], v[28:31], v[72:75], a[12:15]
  ds_read_b128 v[48:51], v11 offset:34816
  v_mfma_f32_16x16x32_bf16 a[16:19], v[32:35], v[60:63], a[16:19]
  ds_read_b64_tr_b16 v[80:81], v15 offset:57344
  v_mfma_f32_16x16x32_bf16 a[20:23], v[32:35], v[64:67], a[20:23]
  ds_read_b64_tr_b16 v[82:83], v15 offset:58368
  v_mfma_f32_16x16x32_bf16 a[24:27], v[32:35], v[68:71], a[24:27]
  ds_read_b128 v[52:55], v11 offset:36864
  v_mfma_f32_16x16x32_bf16 a[28:31], v[32:35], v[72:75], a[28:31]
  ds_read_b64_tr_b16 v[84:85], v16 offset:57344
  v_mfma_f32_16x16x32_bf16 a[32:35], v[36:39], v[60:63], a[32:35]
  ds_read_b64_tr_b16 v[86:87], v16 offset:58368
  v_mfma_f32_16x16x32_bf16 a[36:39], v[36:39], v[64:67], a[36:39]
  ds_read_b128 v[56:59], v11 offset:38912
  v_mfma_f32_16x16x32_bf16 a[40:43], v[36:39], v[68:71], a[40:43]
  ds_read_b64_tr_b16 v[88:89], v17 offset:57344
  v_mfma_f32_16x16x32_bf16 a[44:47], v[36:39], v[72:75], a[44:47]
  ds_read_b64_tr_b16 v[90:91], v17 offset:58368
  v_mfma_f32_16x16x32_bf16 a[48:51], v[40:43], v[60:63], a[48:51]
  v_mfma_f32_16x16x32_bf16 a[52:55], v[40:43], v[64:67], a[52:55]
  v_mfma_f32_16x16x32_bf16 a[56:59], v[40:43], v[68:71], a[56:59]
  v_mfma_f32_16x16x32_bf16 a[60:63], v[40:43], v[72:75], a[60:63]
  s_waitcnt lgkmcnt(0)
  v_mfma_f32_16x16x32_bf16 a[0:3], v[44:47], v[76:79], a[0:3]
  s_waitcnt vmcnt(8)
  s_barrier
  v_mfma_f32_16x16x32_bf16 a[4:7], v[44:47], v[80:83], a[4:7]
  ds_read_b128 v[28:31], v12 offset:0
  v_mfma_f32_16x16x32_bf16 a[8:11], v[44:47], v[84:87], a[8:11]
  ds_read_b64_tr_b16 v[60:61], v18 offset:16384
  v_mfma_f32_16x16x32_bf16 a[12:15], v[44:47], v[88:91], a[12:15]
  ds_read_b64_tr_b16 v[62:63], v18 offset:17408
  v_mfma_f32_16x16x32_bf16 a[16:19], v[48:51], v[76:79], a[16:19]
  ds_read_b128 v[32:35], v12 offset:2048
  v_mfma_f32_16x16x32_bf16 a[20:23], v[48:51], v[80:83], a[20:23]
  ds_read_b64_tr_b16 v[64:65], v19 offset:16384
  v_mfma_f32_16x16x32_bf16 a[24:27], v[48:51], v[84:87], a[24:27]
  ds_read_b64_tr_b16 v[66:67], v19 offset:17408
  v_mfma_f32_16x16x32_bf16 a[28:31], v[48:51], v[88:91], a[28:31]
  ds_read_b128 v[36:39], v12 offset:4096
  v_mfma_f32_16x16x32_bf16 a[32:35], v[52:55], v[76:79], a[32:35]
  ds_read_b64_tr_b16 v[68:69], v20 offset:16384
  v_mfma_f32_16x16x32_bf16 a[36:39], v[52:55], v[80:83], a[36:39]
  ds_read_b64_tr_b16 v[70:71], v20 offset:17408
  v_mfma_f32_16x16x32_bf16 a[40:43], v[52:55], v[84:87], a[40:43]
  ds_read_b128 v[40:43], v12 offset:6144
  v_mfma_f32_16x16x32_bf16 a[44:47], v[52:55], v[88:91], a[44:47]
  ds_read_b64_tr_b16 v[72:73], v21 offset:16384
  v_mfma_f32_16x16x32_bf16 a[48:51], v[56:59], v[76:79], a[48:51]
  ds_read_b64_tr_b16 v[74:75], v21 offset:17408
  v_mfma_f32_16x16x32_bf16 a[52:55], v[56:59], v[80:83], a[52:55]
  v_mfma_f32_16x16x32_bf16 a[56:59], v[56:59], v[84:87], a[56:59]
  v_mfma_f32_16x16x32_bf16 a[60:63], v[56:59], v[88:91], a[60:63]
  s_waitcnt lgkmcnt(0)
  v_mfma_f32_16x16x32_bf16 a[0:3], v[28:31], v[60:63], a[0:3]
  ds_read_b128 v[44:47], v13 offset:0
  v_mfma_f32_16x16x32_bf16 a[4:7], v[28:31], v[64:67], a[4:7]
  ds_read_b64_tr_b16 v[76:77], v18 offset:24576
  v_mfma_f32_16x16x32_bf16 a[8:11], v[28:31], v[68:71], a[8:11]
  ds_read_b64_tr_b16 v[78:79], v18 offset:25600
  v_mfma_f32_16x16x32_bf16 a[12:15], v[28:31], v[72:75], a[12:15]
  ds_read_b128 v[48:51], v13 offset:2048
  v_mfma_f32_16x16x32_bf16 a[16:19], v[32:35], v[60:63], a[16:19]
  ds_read_b64_tr_b16 v[80:81], v19 offset:24576
  v_mfma_f32_16x16x32_bf16 a[20:23], v[32:35], v[64:67], a[20:23]
  ds_read_b64_tr_b16 v[82:83], v19 offset:25600
  v_mfma_f32_16x16x32_bf16 a[24:27], v[32:35], v[68:71], a[24:27]
  ds_read_b128 v[52:55], v13 offset:4096
  v_mfma_f32_16x16x32_bf16 a[28:31], v[32:35], v[72:75], a[28:31]
  ds_read_b64_tr_b16 v[84:85], v20 offset:24576
  v_mfma_f32_16x16x32_bf16 a[32:35], v[36:39], v[60:63], a[32:35]
  ds_read_b64_tr_b16 v[86:87], v20 offset:25600
  v_mfma_f32_16x16x32_bf16 a[36:39], v[36:39], v[64:67], a[36:39]
  ds_read_b128 v[56:59], v13 offset:6144
  v_mfma_f32_16x16x32_bf16 a[40:43], v[36:39], v[68:71], a[40:43]
  ds_read_b64_tr_b16 v[88:89], v21 offset:24576
  v_mfma_f32_16x16x32_bf16 a[44:47], v[36:39], v[72:75], a[44:47]
  ds_read_b64_tr_b16 v[90:91], v21 offset:25600
  v_mfma_f32_16x16x32_bf16 a[48:51], v[40:43], v[60:63], a[48:51]
  v_mfma_f32_16x16x32_bf16 a[52:55], v[40:43], v[64:67], a[52:55]
  v_mfma_f32_16x16x32_bf16 a[56:59], v[40:43], v[68:71], a[56:59]
  v_mfma_f32_16x16x32_bf16 a[60:63], v[40:43], v[72:75], a[60:63]
  s_waitcnt lgkmcnt(0)
  v_mfma_f32_16x16x32_bf16 a[0:3], v[44:47], v[76:79], a[0:3]
  s_waitcnt vmcnt(0)
  s_barrier
  v_mfma_f32_16x16x32_bf16 a[4:7], v[44:47], v[80:83], a[4:7]
  ds_read_b128 v[28:31], v12 offset:32768
  v_mfma_f32_16x16x32_bf16 a[8:11], v[44:47], v[84:87], a[8:11]
  ds_read_b64_tr_b16 v[60:61], v18 offset:49152
  v_mfma_f32_16x16x32_bf16 a[12:15], v[44:47], v[88:91], a[12:15]
  ds_read_b64_tr_b16 v[62:63], v18 offset:50176
  v_mfma_f32_16x16x32_bf16 a[16:19], v[48:51], v[76:79], a[16:19]
  ds_read_b128 v[32:35], v12 offset:34816
  v_mfma_f32_16x16x32_bf16 a[20:23], v[48:51], v[80:83], a[20:23]
  ds_read_b64_tr_b16 v[64:65], v19 offset:49152
  v_mfma_f32_16x16x32_bf16 a[24:27], v[48:51], v[84:87], a[24:27]
  ds_read_b64_tr_b16 v[66:67], v19 offset:50176
  v_mfma_f32_16x16x32_bf16 a[28:31], v[48:51], v[88:91], a[28:31]
  ds_read_b128 v[36:39], v12 offset:36864
  v_mfma_f32_16x16x32_bf16 a[32:35], v[52:55], v[76:79], a[32:35]
  ds_read_b64_tr_b16 v[68:69], v20 offset:49152
  v_mfma_f32_16x16x32_bf16 a[36:39], v[52:55], v[80:83], a[36:39]
  ds_read_b64_tr_b16 v[70:71], v20 offset:50176
  v_mfma_f32_16x16x32_bf16 a[40:43], v[52:55], v[84:87], a[40:43]
  ds_read_b128 v[40:43], v12 offset:38912
  v_mfma_f32_16x16x32_bf16 a[44:47], v[52:55], v[88:91], a[44:47]
  ds_read_b64_tr_b16 v[72:73], v21 offset:49152
  v_mfma_f32_16x16x32_bf16 a[48:51], v[56:59], v[76:79], a[48:51]
  ds_read_b64_tr_b16 v[74:75], v21 offset:50176
  v_mfma_f32_16x16x32_bf16 a[52:55], v[56:59], v[80:83], a[52:55]
  v_mfma_f32_16x16x32_bf16 a[56:59], v[56:59], v[84:87], a[56:59]
  v_mfma_f32_16x16x32_bf16 a[60:63], v[56:59], v[88:91], a[60:63]
  s_waitcnt lgkmcnt(0)
  v_mfma_f32_16x16x32_bf16 a[0:3], v[28:31], v[60:63], a[0:3]
  ds_read_b128 v[44:47], v13 offset:32768
  v_mfma_f32_16x16x32_bf16 a[4:7], v[28:31], v[64:67], a[4:7]
  ds_read_b64_tr_b16 v[76:77], v18 offset:57344
  v_mfma_f32_16x16x32_bf16 a[8:11], v[28:31], v[68:71], a[8:11]
  ds_read_b64_tr_b16 v[78:79], v18 offset:58368
  v_mfma_f32_16x16x32_bf16 a[12:15], v[28:31], v[72:75], a[12:15]
  ds_read_b128 v[48:51], v13 offset:34816
  v_mfma_f32_16x16x32_bf16 a[16:19], v[32:35], v[60:63], a[16:19]
  ds_read_b64_tr_b16 v[80:81], v19 offset:57344
  v_mfma_f32_16x16x32_bf16 a[20:23], v[32:35], v[64:67], a[20:23]
  ds_read_b64_tr_b16 v[82:83], v19 offset:58368
  v_mfma_f32_16x16x32_bf16 a[24:27], v[32:35], v[68:71], a[24:27]
  ds_read_b128 v[52:55], v13 offset:36864
  v_mfma_f32_16x16x32_bf16 a[28:31], v[32:35], v[72:75], a[28:31]
  ds_read_b64_tr_b16 v[84:85], v20 offset:57344
  v_mfma_f32_16x16x32_bf16 a[32:35], v[36:39], v[60:63], a[32:35]
  ds_read_b64_tr_b16 v[86:87], v20 offset:58368
  v_mfma_f32_16x16x32_bf16 a[36:39], v[36:39], v[64:67], a[36:39]
  ds_read_b128 v[56:59], v13 offset:38912
  v_mfma_f32_16x16x32_bf16 a[40:43], v[36:39], v[68:71], a[40:43]
  ds_read_b64_tr_b16 v[88:89], v21 offset:57344
  v_mfma_f32_16x16x32_bf16 a[44:47], v[36:39], v[72:75], a[44:47]
  ds_read_b64_tr_b16 v[90:91], v21 offset:58368
  v_mfma_f32_16x16x32_bf16 a[48:51], v[40:43], v[60:63], a[48:51]
  v_mfma_f32_16x16x32_bf16 a[52:55], v[40:43], v[64:67], a[52:55]
  v_mfma_f32_16x16x32_bf16 a[56:59], v[40:43], v[68:71], a[56:59]
  v_mfma_f32_16x16x32_bf16 a[60:63], v[40:43], v[72:75], a[60:63]
  s_waitcnt lgkmcnt(0)
  v_mfma_f32_16x16x32_bf16 a[0:3], v[44:47], v[76:79], a[0:3]
  v_mfma_f32_16x16x32_bf16 a[4:7], v[44:47], v[80:83], a[4:7]
  v_mfma_f32_16x16x32_bf16 a[8:11], v[44:47], v[84:87], a[8:11]
  v_mfma_f32_16x16x32_bf16 a[12:15], v[44:47], v[88:91], a[12:15]
  v_mfma_f32_16x16x32_bf16 a[16:19], v[48:51], v[76:79], a[16:19]
  v_mfma_f32_16x16x32_bf16 a[20:23], v[48:51], v[80:83], a[20:23]
  v_mfma_f32_16x16x32_bf16 a[24:27], v[48:51], v[84:87], a[24:27]
  v_mfma_f32_16x16x32_bf16 a[28:31], v[48:51], v[88:91], a[28:31]
  v_mfma_f32_16x16x32_bf16 a[32:35], v[52:55], v[76:79], a[32:35]
  v_mfma_f32_16x16x32_bf16 a[36:39], v[52:55], v[80:83], a[36:39]
  v_mfma_f32_16x16x32_bf16 a[40:43], v[52:55], v[84:87], a[40:43]
  v_mfma_f32_16x16x32_bf16 a[44:47], v[52:55], v[88:91], a[44:47]
  v_mfma_f32_16x16x32_bf16 a[48:51], v[56:59], v[76:79], a[48:51]
  v_mfma_f32_16x16x32_bf16 a[52:55], v[56:59], v[80:83], a[52:55]
  v_mfma_f32_16x16x32_bf16 a[56:59], v[56:59], v[84:87], a[56:59]
  v_mfma_f32_16x16x32_bf16 a[60:63], v[56:59], v[88:91], a[60:63]
  s_mov_b32 s59, 4
  s_mov_b32 s60, s22
  s_mov_b32 s61, s26
  s_add_u32 s62, s38, 0x3d00000
  s_mov_b32 s63, s98
  s_cmp_lg_u32 s39, 0
  s_cbranch_scc1 L_got
  s_mov_b32 s58, 3
  s_branch L_epi
L_swp:
  s_barrier
  v_and_b32 v1, 63, v0
  v_lshlrev_b32 v2, 7, v1
  s_lshl_b32 s40, s36, 2
  s_add_u32 s40, s40, s33
  s_lshl_b32 s40, s40, 2
  s_add_u32 s40, s40, s32
  s_lshl_b32 s40, s40, 13
  s_mov_b32 s44, s78
  s_and_b32 s45, s79, 0xffff
  s_mov_b32 s46, 0x400000
  s_mov_b32 s47, 0x20000
  s_mov_b32 s41, s40
  buffer_load_dword v4, v2, s[44:47], s41 offen
  s_add_u32 s41, s41, 524288
  buffer_load_dword v5, v2, s[44:47], s41 offen
  s_add_u32 s41, s41, 524288
  buffer_load_dword v6, v2, s[44:47], s41 offen
  s_add_u32 s41, s41, 524288
  buffer_load_dword v7, v2, s[44:47], s41 offen
  s_add_u32 s41, s41, 524288
  buffer_load_dword v8, v2, s[44:47], s41 offen
  s_add_u32 s41, s41, 524288
  buffer_load_dword v9, v2, s[44:47], s41 offen
  s_add_u32 s41, s41, 524288
  buffer_load_dword v10, v2, s[44:47], s41 offen
  s_add_u32 s41, s41, 524288
  buffer_load_dword v11, v2, s[44:47], s41 offen
  s_add_u32 s41, s41, 524288
  s_mov_b32 s44, s80
  s_and_b32 s45, s81, 0xffff
  s_mov_b32 s46, 0x600000
  s_mov_b32 s47, 0x20000
  s_mov_b32 s41, s40
  buffer_load_dword v4, v2, s[44:47], s41 offen
  s_add_u32 s41, s41, 524288
  buffer_load_dword v5, v2, s[44:47], s41 offen
  s_add_u32 s41, s41, 524288
  buffer_load_dword v6, v2, s[44:47], s41 offen
  s_add_u32 s41, s41, 524288
  buffer_load_dword v7, v2, s[44:47], s41 offen
  s_add_u32 s41, s41, 524288
  buffer_load_dword v8, v2, s[44:47], s41 offen
  s_add_u32 s41, s41, 524288
  buffer_load_dword v9, v2, s[44:47], s41 offen
  s_add_u32 s41, s41, 524288
  buffer_load_dword v10, v2, s[44:47], s41 offen
  s_add_u32 s41, s41, 524288
  buffer_load_dword v11, v2, s[44:47], s41 offen
  s_add_u32 s41, s41, 524288
  buffer_load_dword v12, v2, s[44:47], s41 offen
  s_add_u32 s41, s41, 524288
  buffer_load_dword v13, v2, s[44:47], s41 offen
  s_add_u32 s41, s41, 524288
  buffer_load_dword v14, v2, s[44:47], s41 offen
  s_add_u32 s41, s41, 524288
  buffer_load_dword v15, v2, s[44:47], s41 offen
  s_add_u32 s41, s41, 524288
  s_mov_b32 s44, s82
  s_and_b32 s45, s83, 0xffff
  s_mov_b32 s46, 0x200000
  s_mov_b32 s47, 0x20000
  s_mov_b32 s41, s40
  buffer_load_dword v4, v2, s[44:47], s41 offen
  s_add_u32 s41, s41, 524288
  buffer_load_dword v5, v2, s[44:47], s41 offen
  s_add_u32 s41, s41, 524288
  buffer_load_dword v6, v2, s[44:47], s41 offen
  s_add_u32 s41, s41, 524288
  buffer_load_dword v7, v2, s[44:47], s41 offen
  s_add_u32 s41, s41, 524288
  v_lshlrev_b32 v2, 4, v1
  v_mov_b32 v32, -1
  v_mov_b32 v33, -1
  v_mov_b32 v34, -1
  v_mov_b32 v35, -1
  s_lshl_b32 s41, s40, 3
  s_add_u32 s41, s41, 0x7000000
  s_mov_b32 s42, 16
L_swf:
  buffer_store_dwordx4 v[32:35], v2, s[4:7], s41 offen offset:0 sc1
  buffer_store_dwordx4 v[32:35], v2, s[4:7], s41 offen offset:1024 sc1
  buffer_store_dwordx4 v[32:35], v2, s[4:7], s41 offen offset:2048 sc1
  buffer_store_dwordx4 v[32:35], v2, s[4:7], s41 offen offset:3072 sc1
  s_add_u32 s41, s41, 4096
  s_sub_u32 s42, s42, 1
  s_cmp_lg_u32 s42, 0
  s_cbranch_scc1 L_swf
  s_waitcnt vmcnt(0)
  s_cmp_lg_u32 s32, 0
  s_cbranch_scc1 L_rq_87
  s_cmp_eq_u32 s39, 0
  s_cbranch_scc1 L_rq_87
  s_lshl_b32 s99, s33, 7
  s_add_u32 s99, s99, 0x3d00200
  v_mov_b32 v244, 1
  v_mov_b32 v245, 0
  s_mov_b64 exec, 1
  buffer_atomic_add v244, v245, s[4:7], s99 offen sc0 sc1
  s_mov_b64 exec, -1
L_rq_87:
  s_mov_b32 s38, 5120
  s_branch L_done
  s_branch L_next
L_atb:
  s_lshl_b32 s90, s33, 7
  s_lshl_b32 s40, s36, 9
  s_add_u32 s40, s40, s90
  s_max_u32 s41, s36, 1
  s_sub_u32 s41, s41, 1
  s_lshl_b32 s41, s41, 9
  s_add_u32 s41, s41, s90
  s_cmp_lg_u32 s32, 0
  s_cbranch_scc1 L_dd_89
  v_mov_b32 v228, 0x3d00000
  v_mov_b32 v231, 0x3d03000
L_dw_88:
  buffer_load_dword v234, v231, s[4:7], s40 offen offset:0 sc1
  buffer_load_dword v235, v231, s[4:7], s41 offen offset:0 sc1
  s_waitcnt vmcnt(0)
  s_mov_b32 s44, 1
  v_readfirstlane_b32 s45, v234
  s_cmp_ge_u32 s45, 3
  s_cselect_b32 s44, s44, 0
  v_readfirstlane_b32 s45, v235
  s_cmp_ge_u32 s45, 3
  s_cselect_b32 s44, s44, 0
  s_cmp_eq_u32 s44, 1
  s_cbranch_scc1 L_dd_89
  s_sleep 6
  s_add_u32 s3, s3, 1
  s_cmp_lt_u32 s3, 131072
  s_cbranch_scc1 L_dw_88
L_dd_89:
  s_barrier
  s_lshl_b32 s38, s36, 7
  s_add_u32 s38, s38, 1024
  s_lshl_b32 s46, s36, 3
  s_lshl_b32 s90, s37, 1
  s_add_u32 s99, s46, s90
  s_lshr_b32 s90, s32, 1
  s_add_u32 s99, s99, s90
  s_lshl_b32 s99, s99, 3
  s_lshl_b32 s90, s33, 1
  s_add_u32 s99, s99, s90
  s_and_b32 s90, s32, 1
  s_add_u32 s20, s99, s90
  v_and_b32 v1, 63, v0
  s_lshl_b32 s90, s20, 13
  s_sub_u32 s91, s90, 65536
  s_cmp_lt_u32 s20, 8
  s_cselect_b32 s91, s90, s91
  v_mov_b32 v2, 0x0
  v_bfe_u32 v7, v1, 0, 6
  v_lshl_add_u32 v2, v7, 4, v2
  v_add_u32 v3, 4096, v2
  s_add_u32 s92, s90, 67108864
  s_add_u32 s93, s90, 71303168
  s_add_u32 s94, s91, 71303168
  s_add_u32 s95, s90, 75497472
  s_add_u32 s96, s91, 75497472
  s_add_u32 s97, s90, 100663296
  buffer_load_dwordx4 v[8:11], v2, s[4:7], s92 offen offset:0 sc1
  buffer_load_dwordx4 v[12:15], v2, s[4:7], s92 offen offset:1024 sc1
  buffer_load_dwordx4 v[16:19], v2, s[4:7], s92 offen offset:2048 sc1
  buffer_load_dwordx4 v[20:23], v2, s[4:7], s92 offen offset:3072 sc1
  buffer_load_dwordx4 v[24:27], v3, s[4:7], s92 offen offset:0 sc1
  buffer_load_dwordx4 v[28:31], v3, s[4:7], s92 offen offset:1024 sc1
  buffer_load_dwordx4 v[32:35], v3, s[4:7], s92 offen offset:2048 sc1
  buffer_load_dwordx4 v[36:39], v3, s[4:7], s92 offen offset:3072 sc1
  buffer_load_dwordx4 v[40:43], v3, s[4:7], s94 offen offset:0 sc1
  buffer_load_dwordx4 v[44:47], v3, s[4:7], s94 offen offset:1024 sc1
  buffer_load_dwordx4 v[48:51], v3, s[4:7], s94 offen offset:2048 sc1
  buffer_load_dwordx4 v[52:55], v3, s[4:7], s94 offen offset:3072 sc1
  buffer_load_dwordx4 v[56:59], v2, s[4:7], s93 offen offset:0 sc1
  buffer_load_dwordx4 v[60:63], v2, s[4:7], s93 offen offset:1024 sc1
  buffer_load_dwordx4 v[64:67], v2, s[4:7], s93 offen offset:2048 sc1
  buffer_load_dwordx4 v[68:71], v2, s[4:7], s93 offen offset:3072 sc1
  buffer_load_dwordx4 v[72:75], v3, s[4:7], s93 offen offset:0 sc1
  buffer_load_dwordx4 v[76:79], v3, s[4:7], s93 offen offset:1024 sc1
  buffer_load_dwordx4 v[80:83], v3, s[4:7], s93 offen offset:2048 sc1
  buffer_load_dwordx4 v[84:87], v3, s[4:7], s93 offen offset:3072 sc1
  buffer_load_dwordx2 v[88:89], v2, s[4:7], s96 offen offset:8 sc1
  buffer_load_dwordx2 v[94:95], v2, s[4:7], s96 offen offset:1032 sc1
  buffer_load_dwordx2 v[100:101], v2, s[4:7], s96 offen offset:2056 sc1
  buffer_load_dwordx2 v[106:107], v2, s[4:7], s96 offen offset:3080 sc1
  buffer_load_dwordx2 v[112:113], v3, s[4:7], s96 offen offset:8 sc1
  buffer_load_dwordx2 v[118:119], v3, s[4:7], s96 offen offset:1032 sc1
  buffer_load_dwordx2 v[124:125], v3, s[4:7], s96 offen offset:2056 sc1
  buffer_load_dwordx2 v[130:131], v3, s[4:7], s96 offen offset:3080 sc1
  buffer_load_dwordx4 v[90:93], v2, s[4:7], s95 offen offset:0 sc1
  buffer_load_dwordx4 v[96:99], v2, s[4:7], s95 offen offset:1024 sc1
  buffer_load_dwordx4 v[102:105], v2, s[4:7], s95 offen offset:2048 sc1
  buffer_load_dwordx4 v[108:111], v2, s[4:7], s95 offen offset:3072 sc1
  buffer_load_dwordx4 v[114:117], v3, s[4:7], s95 offen offset:0 sc1
  buffer_load_dwordx4 v[120:123], v3, s[4:7], s95 offen offset:1024 sc1
  buffer_load_dwordx4 v[126:129], v3, s[4:7], s95 offen offset:2048 sc1
  buffer_load_dwordx4 v[132:135], v3, s[4:7], s95 offen offset:3072 sc1
  s_mov_b32 s40, 0x50000
  s_mov_b32 s41, 0x5550055
  s_mov_b32 s42, 0xa0000
  s_mov_b32 s43, 0xaaa00aa
  s_mov_b32 s44, 0x150001
  s_mov_b32 s45, 0x15550155
  s_mov_b32 s46, 0x2a0002
  s_mov_b32 s47, 0x2aaa02aa
  s_mov_b32 s48, 0x55505555
  s_mov_b32 s49, 0x50005500
  s_mov_b32 s50, 0xaaa0aaaa
  s_mov_b32 s51, 0xa000aa00
  s_mov_b32 s52, 0x55405554
  s_mov_b32 s53, 0x40005400
  s_mov_b32 s54, 0xaa80aaa8
  s_mov_b32 s55, 0x8000a800
  s_cmp_lt_u32 s20, 8
  s_cselect_b64 s[56:57], 0, s[40:41]
  s_cselect_b64 s[58:59], 0, s[42:43]
  s_cselect_b64 s[60:61], 0, s[44:45]
  s_cselect_b64 s[62:63], 0, s[46:47]
  s_mov_b32 s21, 0x3e8293ee
  v_mov_b32 v6, 0xcfa8965f
  s_waitcnt vmcnt(16)
  v_mfma_f32_16x16x32_bf16 v[136:139], v[40:43], v[8:11], 0
  v_mfma_f32_16x16x32_bf16 v[140:143], v[56:59], v[8:11], 0
  v_mfma_f32_16x16x32_bf16 v[144:147], v[44:47], v[12:15], 0
  v_mfma_f32_16x16x32_bf16 v[148:151], v[60:63], v[12:15], 0
  v_mfma_f32_16x16x32_bf16 v[152:155], v[48:51], v[16:19], 0
  v_mfma_f32_16x16x32_bf16 v[156:159], v[64:67], v[16:19], 0
  v_mfma_f32_16x16x32_bf16 v[160:163], v[52:55], v[20:23], 0
  v_mfma_f32_16x16x32_bf16 v[164:167], v[68:71], v[20:23], 0
  v_mfma_f32_16x16x32_bf16 v[168:171], v[56:59], v[24:27], 0
  v_mfma_f32_16x16x32_bf16 v[172:175], v[72:75], v[24:27], 0
  v_mfma_f32_16x16x32_bf16 v[176:179], v[60:63], v[28:31], 0
  v_mfma_f32_16x16x32_bf16 v[180:183], v[76:79], v[28:31], 0
  v_mfma_f32_16x16x32_bf16 v[184:187], v[64:67], v[32:35], 0
  v_mfma_f32_16x16x32_bf16 v[188:191], v[80:83], v[32:35], 0
  v_mfma_f32_16x16x32_bf16 v[192:195], v[68:71], v[36:39], 0
  v_mfma_f32_16x16x32_bf16 v[196:199], v[84:87], v[36:39], 0
  v_cndmask_b32 v136, v6, v136, s[56:57]
  v_cndmask_b32 v137, v6, v137, s[58:59]
  v_cndmask_b32 v138, v6, v138, s[60:61]
  v_cndmask_b32 v139, v6, v139, s[62:63]
  v_cndmask_b32 v140, v6, v140, s[48:49]
  v_cndmask_b32 v141, v6, v141, s[50:51]
  v_cndmask_b32 v142, v6, v142, s[52:53]
  v_cndmask_b32 v143, v6, v143, s[54:55]
  v_max3_f32 v4, v136, v137, v138
  v_max3_f32 v4, v4, v139, v140
  v_max3_f32 v4, v4, v141, v142
  v_max_f32 v4, v4, v143
  v_mov_b32 v5, v4
  s_nop 1
  v_permlane32_swap_b32 v4, v5
  v_max_f32 v4, v4, v5
  v_mov_b32 v5, v4
  s_nop 1
  v_permlane16_swap_b32 v4, v5
  v_max_f32 v4, v4, v5
  v_mul_f32 v4, s21, v4
  v_fma_f32 v136, v136, s21, -v4
  v_fma_f32 v137, v137, s21, -v4
  v_fma_f32 v138, v138, s21, -v4
  v_fma_f32 v139, v139, s21, -v4
  v_fma_f32 v140, v140, s21, -v4
  v_fma_f32 v141, v141, s21, -v4
  v_fma_f32 v142, v142, s21, -v4
  v_fma_f32 v143, v143, s21, -v4
  v_exp_f32 v136, v136
  v_exp_f32 v137, v137
  v_exp_f32 v138, v138
  v_exp_f32 v139, v139
  v_exp_f32 v140, v140
  v_exp_f32 v141, v141
  v_exp_f32 v142, v142
  v_exp_f32 v143, v143
  v_add_f32 v4, v136, v137
  v_add_f32 v4, v4, v138
  v_add_f32 v4, v4, v139
  v_add_f32 v4, v4, v140
  v_add_f32 v4, v4, v141
  v_add_f32 v4, v4, v142
  v_add_f32 v4, v4, v143
  v_mov_b32 v5, v4
  s_nop 1
  v_permlane32_swap_b32 v4, v5
  v_add_f32 v4, v4, v5
  v_mov_b32 v5, v4
  s_nop 1
  v_permlane16_swap_b32 v4, v5
  v_add_f32 v4, v4, v5
  v_rcp_f32 v4, v4
  s_nop 0
  v_mul_f32 v136, v136, v4
  v_mul_f32 v137, v137, v4
  v_mul_f32 v138, v138, v4
  v_mul_f32 v139, v139, v4
  v_mul_f32 v140, v140, v4
  v_mul_f32 v141, v141, v4
  v_mul_f32 v142, v142, v4
  v_mul_f32 v143, v143, v4
  v_cvt_pk_bf16_f32 v8, v136, v137
  v_cvt_pk_bf16_f32 v9, v138, v139
  v_cvt_pk_bf16_f32 v10, v140, v141
  v_cvt_pk_bf16_f32 v11, v142, v143
  v_cndmask_b32 v144, v6, v144, s[56:57]
  v_cndmask_b32 v145, v6, v145, s[58:59]
  v_cndmask_b32 v146, v6, v146, s[60:61]
  v_cndmask_b32 v147, v6, v147, s[62:63]
  v_cndmask_b32 v148, v6, v148, s[48:49]
  v_cndmask_b32 v149, v6, v149, s[50:51]
  v_cndmask_b32 v150, v6, v150, s[52:53]
  v_cndmask_b32 v151, v6, v151, s[54:55]
  v_max3_f32 v4, v144, v145, v146
  v_max3_f32 v4, v4, v147, v148
  v_max3_f32 v4, v4, v149, v150
  v_max_f32 v4, v4, v151
  v_mov_b32 v5, v4
  s_nop 1
  v_permlane32_swap_b32 v4, v5
  v_max_f32 v4, v4, v5
  v_mov_b32 v5, v4
  s_nop 1
  v_permlane16_swap_b32 v4, v5
  v_max_f32 v4, v4, v5
  v_mul_f32 v4, s21, v4
  v_fma_f32 v144, v144, s21, -v4
  v_fma_f32 v145, v145, s21, -v4
  v_fma_f32 v146, v146, s21, -v4
  v_fma_f32 v147, v147, s21, -v4
  v_fma_f32 v148, v148, s21, -v4
  v_fma_f32 v149, v149, s21, -v4
  v_fma_f32 v150, v150, s21, -v4
  v_fma_f32 v151, v151, s21, -v4
  v_exp_f32 v144, v144
  v_exp_f32 v145, v145
  v_exp_f32 v146, v146
  v_exp_f32 v147, v147
  v_exp_f32 v148, v148
  v_exp_f32 v149, v149
  v_exp_f32 v150, v150
  v_exp_f32 v151, v151
  v_add_f32 v4, v144, v145
  v_add_f32 v4, v4, v146
  v_add_f32 v4, v4, v147
  v_add_f32 v4, v4, v148
  v_add_f32 v4, v4, v149
  v_add_f32 v4, v4, v150
  v_add_f32 v4, v4, v151
  v_mov_b32 v5, v4
  s_nop 1
  v_permlane32_swap_b32 v4, v5
  v_add_f32 v4, v4, v5
  v_mov_b32 v5, v4
  s_nop 1
  v_permlane16_swap_b32 v4, v5
  v_add_f32 v4, v4, v5
  v_rcp_f32 v4, v4
  s_nop 0
  v_mul_f32 v144, v144, v4
  v_mul_f32 v145, v145, v4
  v_mul_f32 v146, v146, v4
  v_mul_f32 v147, v147, v4
  v_mul_f32 v148, v148, v4
  v_mul_f32 v149, v149, v4
  v_mul_f32 v150, v150, v4
  v_mul_f32 v151, v151, v4
  v_cvt_pk_bf16_f32 v12, v144, v145
  v_cvt_pk_bf16_f32 v13, v146, v147
  v_cvt_pk_bf16_f32 v14, v148, v149
  v_cvt_pk_bf16_f32 v15, v150, v151
  v_cndmask_b32 v152, v6, v152, s[56:57]
  v_cndmask_b32 v153, v6, v153, s[58:59]
  v_cndmask_b32 v154, v6, v154, s[60:61]
  v_cndmask_b32 v155, v6, v155, s[62:63]
  v_cndmask_b32 v156, v6, v156, s[48:49]
  v_cndmask_b32 v157, v6, v157, s[50:51]
  v_cndmask_b32 v158, v6, v158, s[52:53]
  v_cndmask_b32 v159, v6, v159, s[54:55]
  v_max3_f32 v4, v152, v153, v154
  v_max3_f32 v4, v4, v155, v156
  v_max3_f32 v4, v4, v157, v158
  v_max_f32 v4, v4, v159
  v_mov_b32 v5, v4
  s_nop 1
  v_permlane32_swap_b32 v4, v5
  v_max_f32 v4, v4, v5
  v_mov_b32 v5, v4
  s_nop 1
  v_permlane16_swap_b32 v4, v5
  v_max_f32 v4, v4, v5
  v_mul_f32 v4, s21, v4
  v_fma_f32 v152, v152, s21, -v4
  v_fma_f32 v153, v153, s21, -v4
  v_fma_f32 v154, v154, s21, -v4
  v_fma_f32 v155, v155, s21, -v4
  v_fma_f32 v156, v156, s21, -v4
  v_fma_f32 v157, v157, s21, -v4
  v_fma_f32 v158, v158, s21, -v4
  v_fma_f32 v159, v159, s21, -v4
  v_exp_f32 v152, v152
  v_exp_f32 v153, v153
  v_exp_f32 v154, v154
  v_exp_f32 v155, v155
  v_exp_f32 v156, v156
  v_exp_f32 v157, v157
  v_exp_f32 v158, v158
  v_exp_f32 v159, v159
  v_add_f32 v4, v152, v153
  v_add_f32 v4, v4, v154
  v_add_f32 v4, v4, v155
  v_add_f32 v4, v4, v156
  v_add_f32 v4, v4, v157
  v_add_f32 v4, v4, v158
  v_add_f32 v4, v4, v159
  v_mov_b32 v5, v4
  s_nop 1
  v_permlane32_swap_b32 v4, v5
  v_add_f32 v4, v4, v5
  v_mov_b32 v5, v4
  s_nop 1
  v_permlane16_swap_b32 v4, v5
  v_add_f32 v4, v4, v5
  v_rcp_f32 v4, v4
  s_nop 0
  v_mul_f32 v152, v152, v4
  v_mul_f32 v153, v153, v4
  v_mul_f32 v154, v154, v4
  v_mul_f32 v155, v155, v4
  v_mul_f32 v156, v156, v4
  v_mul_f32 v157, v157, v4
  v_mul_f32 v158, v158, v4
  v_mul_f32 v159, v159, v4
  v_cvt_pk_bf16_f32 v16, v152, v153
  v_cvt_pk_bf16_f32 v17, v154, v155
  v_cvt_pk_bf16_f32 v18, v156, v157
  v_cvt_pk_bf16_f32 v19, v158, v159
  v_cndmask_b32 v160, v6, v160, s[56:57]
  v_cndmask_b32 v161, v6, v161, s[58:59]
  v_cndmask_b32 v162, v6, v162, s[60:61]
  v_cndmask_b32 v163, v6, v163, s[62:63]
  v_cndmask_b32 v164, v6, v164, s[48:49]
  v_cndmask_b32 v165, v6, v165, s[50:51]
  v_cndmask_b32 v166, v6, v166, s[52:53]
  v_cndmask_b32 v167, v6, v167, s[54:55]
  v_max3_f32 v4, v160, v161, v162
  v_max3_f32 v4, v4, v163, v164
  v_max3_f32 v4, v4, v165, v166
  v_max_f32 v4, v4, v167
  v_mov_b32 v5, v4
  s_nop 1
  v_permlane32_swap_b32 v4, v5
  v_max_f32 v4, v4, v5
  v_mov_b32 v5, v4
  s_nop 1
  v_permlane16_swap_b32 v4, v5
  v_max_f32 v4, v4, v5
  v_mul_f32 v4, s21, v4
  v_fma_f32 v160, v160, s21, -v4
  v_fma_f32 v161, v161, s21, -v4
  v_fma_f32 v162, v162, s21, -v4
  v_fma_f32 v163, v163, s21, -v4
  v_fma_f32 v164, v164, s21, -v4
  v_fma_f32 v165, v165, s21, -v4
  v_fma_f32 v166, v166, s21, -v4
  v_fma_f32 v167, v167, s21, -v4
  v_exp_f32 v160, v160
  v_exp_f32 v161, v161
  v_exp_f32 v162, v162
  v_exp_f32 v163, v163
  v_exp_f32 v164, v164
  v_exp_f32 v165, v165
  v_exp_f32 v166, v166
  v_exp_f32 v167, v167
  v_add_f32 v4, v160, v161
  v_add_f32 v4, v4, v162
  v_add_f32 v4, v4, v163
  v_add_f32 v4, v4, v164
  v_add_f32 v4, v4, v165
  v_add_f32 v4, v4, v166
  v_add_f32 v4, v4, v167
  v_mov_b32 v5, v4
  s_nop 1
  v_permlane32_swap_b32 v4, v5
  v_add_f32 v4, v4, v5
  v_mov_b32 v5, v4
  s_nop 1
  v_permlane16_swap_b32 v4, v5
  v_add_f32 v4, v4, v5
  v_rcp_f32 v4, v4
  s_nop 0
  v_mul_f32 v160, v160, v4
  v_mul_f32 v161, v161, v4
  v_mul_f32 v162, v162, v4
  v_mul_f32 v163, v163, v4
  v_mul_f32 v164, v164, v4
  v_mul_f32 v165, v165, v4
  v_mul_f32 v166, v166, v4
  v_mul_f32 v167, v167, v4
  v_cvt_pk_bf16_f32 v20, v160, v161
  v_cvt_pk_bf16_f32 v21, v162, v163
  v_cvt_pk_bf16_f32 v22, v164, v165
  v_cvt_pk_bf16_f32 v23, v166, v167
  v_cndmask_b32 v168, v6, v168, s[40:41]
  v_cndmask_b32 v169, v6, v169, s[42:43]
  v_cndmask_b32 v170, v6, v170, s[44:45]
  v_cndmask_b32 v171, v6, v171, s[46:47]
  v_cndmask_b32 v172, v6, v172, s[48:49]
  v_cndmask_b32 v173, v6, v173, s[50:51]
  v_cndmask_b32 v174, v6, v174, s[52:53]
  v_cndmask_b32 v175, v6, v175, s[54:55]
  v_max3_f32 v4, v168, v169, v170
  v_max3_f32 v4, v4, v171, v172
  v_max3_f32 v4, v4, v173, v174
  v_max_f32 v4, v4, v175
  v_mov_b32 v5, v4
  s_nop 1
  v_permlane32_swap_b32 v4, v5
  v_max_f32 v4, v4, v5
  v_mov_b32 v5, v4
  s_nop 1
  v_permlane16_swap_b32 v4, v5
  v_max_f32 v4, v4, v5
  v_mul_f32 v4, s21, v4
  v_fma_f32 v168, v168, s21, -v4
  v_fma_f32 v169, v169, s21, -v4
  v_fma_f32 v170, v170, s21, -v4
  v_fma_f32 v171, v171, s21, -v4
  v_fma_f32 v172, v172, s21, -v4
  v_fma_f32 v173, v173, s21, -v4
  v_fma_f32 v174, v174, s21, -v4
  v_fma_f32 v175, v175, s21, -v4
  v_exp_f32 v168, v168
  v_exp_f32 v169, v169
  v_exp_f32 v170, v170
  v_exp_f32 v171, v171
  v_exp_f32 v172, v172
  v_exp_f32 v173, v173
  v_exp_f32 v174, v174
  v_exp_f32 v175, v175
  v_add_f32 v4, v168, v169
  v_add_f32 v4, v4, v170
  v_add_f32 v4, v4, v171
  v_add_f32 v4, v4, v172
  v_add_f32 v4, v4, v173
  v_add_f32 v4, v4, v174
  v_add_f32 v4, v4, v175
  v_mov_b32 v5, v4
  s_nop 1
  v_permlane32_swap_b32 v4, v5
  v_add_f32 v4, v4, v5
  v_mov_b32 v5, v4
  s_nop 1
  v_permlane16_swap_b32 v4, v5
  v_add_f32 v4, v4, v5
  v_rcp_f32 v4, v4
  s_nop 0
  v_mul_f32 v168, v168, v4
  v_mul_f32 v169, v169, v4
  v_mul_f32 v170, v170, v4
  v_mul_f32 v171, v171, v4
  v_mul_f32 v172, v172, v4
  v_mul_f32 v173, v173, v4
  v_mul_f32 v174, v174, v4
  v_mul_f32 v175, v175, v4
  v_cvt_pk_bf16_f32 v24, v168, v169
  v_cvt_pk_bf16_f32 v25, v170, v171
  v_cvt_pk_bf16_f32 v26, v172, v173
  v_cvt_pk_bf16_f32 v27, v174, v175
  v_cndmask_b32 v176, v6, v176, s[40:41]
  v_cndmask_b32 v177, v6, v177, s[42:43]
  v_cndmask_b32 v178, v6, v178, s[44:45]
  v_cndmask_b32 v179, v6, v179, s[46:47]
  v_cndmask_b32 v180, v6, v180, s[48:49]
  v_cndmask_b32 v181, v6, v181, s[50:51]
  v_cndmask_b32 v182, v6, v182, s[52:53]
  v_cndmask_b32 v183, v6, v183, s[54:55]
  v_max3_f32 v4, v176, v177, v178
  v_max3_f32 v4, v4, v179, v180
  v_max3_f32 v4, v4, v181, v182
  v_max_f32 v4, v4, v183
  v_mov_b32 v5, v4
  s_nop 1
  v_permlane32_swap_b32 v4, v5
  v_max_f32 v4, v4, v5
  v_mov_b32 v5, v4
  s_nop 1
  v_permlane16_swap_b32 v4, v5
  v_max_f32 v4, v4, v5
  v_mul_f32 v4, s21, v4
  v_fma_f32 v176, v176, s21, -v4
  v_fma_f32 v177, v177, s21, -v4
  v_fma_f32 v178, v178, s21, -v4
  v_fma_f32 v179, v179, s21, -v4
  v_fma_f32 v180, v180, s21, -v4
  v_fma_f32 v181, v181, s21, -v4
  v_fma_f32 v182, v182, s21, -v4
  v_fma_f32 v183, v183, s21, -v4
  v_exp_f32 v176, v176
  v_exp_f32 v177, v177
  v_exp_f32 v178, v178
  v_exp_f32 v179, v179
  v_exp_f32 v180, v180
  v_exp_f32 v181, v181
  v_exp_f32 v182, v182
  v_exp_f32 v183, v183
  v_add_f32 v4, v176, v177
  v_add_f32 v4, v4, v178
  v_add_f32 v4, v4, v179
  v_add_f32 v4, v4, v180
  v_add_f32 v4, v4, v181
  v_add_f32 v4, v4, v182
  v_add_f32 v4, v4, v183
  v_mov_b32 v5, v4
  s_nop 1
  v_permlane32_swap_b32 v4, v5
  v_add_f32 v4, v4, v5
  v_mov_b32 v5, v4
  s_nop 1
  v_permlane16_swap_b32 v4, v5
  v_add_f32 v4, v4, v5
  v_rcp_f32 v4, v4
  s_nop 0
  v_mul_f32 v176, v176, v4
  v_mul_f32 v177, v177, v4
  v_mul_f32 v178, v178, v4
  v_mul_f32 v179, v179, v4
  v_mul_f32 v180, v180, v4
  v_mul_f32 v181, v181, v4
  v_mul_f32 v182, v182, v4
  v_mul_f32 v183, v183, v4
  v_cvt_pk_bf16_f32 v28, v176, v177
  v_cvt_pk_bf16_f32 v29, v178, v179
  v_cvt_pk_bf16_f32 v30, v180, v181
  v_cvt_pk_bf16_f32 v31, v182, v183
  v_cndmask_b32 v184, v6, v184, s[40:41]
  v_cndmask_b32 v185, v6, v185, s[42:43]
  v_cndmask_b32 v186, v6, v186, s[44:45]
  v_cndmask_b32 v187, v6, v187, s[46:47]
  v_cndmask_b32 v188, v6, v188, s[48:49]
  v_cndmask_b32 v189, v6, v189, s[50:51]
  v_cndmask_b32 v190, v6, v190, s[52:53]
  v_cndmask_b32 v191, v6, v191, s[54:55]
  v_max3_f32 v4, v184, v185, v186
  v_max3_f32 v4, v4, v187, v188
  v_max3_f32 v4, v4, v189, v190
  v_max_f32 v4, v4, v191
  v_mov_b32 v5, v4
  s_nop 1
  v_permlane32_swap_b32 v4, v5
  v_max_f32 v4, v4, v5
  v_mov_b32 v5, v4
  s_nop 1
  v_permlane16_swap_b32 v4, v5
  v_max_f32 v4, v4, v5
  v_mul_f32 v4, s21, v4
  v_fma_f32 v184, v184, s21, -v4
  v_fma_f32 v185, v185, s21, -v4
  v_fma_f32 v186, v186, s21, -v4
  v_fma_f32 v187, v187, s21, -v4
  v_fma_f32 v188, v188, s21, -v4
  v_fma_f32 v189, v189, s21, -v4
  v_fma_f32 v190, v190, s21, -v4
  v_fma_f32 v191, v191, s21, -v4
  v_exp_f32 v184, v184
  v_exp_f32 v185, v185
  v_exp_f32 v186, v186
  v_exp_f32 v187, v187
  v_exp_f32 v188, v188
  v_exp_f32 v189, v189
  v_exp_f32 v190, v190
  v_exp_f32 v191, v191
  v_add_f32 v4, v184, v185
  v_add_f32 v4, v4, v186
  v_add_f32 v4, v4, v187
  v_add_f32 v4, v4, v188
  v_add_f32 v4, v4, v189
  v_add_f32 v4, v4, v190
  v_add_f32 v4, v4, v191
  v_mov_b32 v5, v4
  s_nop 1
  v_permlane32_swap_b32 v4, v5
  v_add_f32 v4, v4, v5
  v_mov_b32 v5, v4
  s_nop 1
  v_permlane16_swap_b32 v4, v5
  v_add_f32 v4, v4, v5
  v_rcp_f32 v4, v4
  s_nop 0
  v_mul_f32 v184, v184, v4
  v_mul_f32 v185, v185, v4
  v_mul_f32 v186, v186, v4
  v_mul_f32 v187, v187, v4
  v_mul_f32 v188, v188, v4
  v_mul_f32 v189, v189, v4
  v_mul_f32 v190, v190, v4
  v_mul_f32 v191, v191, v4
  v_cvt_pk_bf16_f32 v32, v184, v185
  v_cvt_pk_bf16_f32 v33, v186, v187
  v_cvt_pk_bf16_f32 v34, v188, v189
  v_cvt_pk_bf16_f32 v35, v190, v191
  v_cndmask_b32 v192, v6, v192, s[40:41]
  v_cndmask_b32 v193, v6, v193, s[42:43]
  v_cndmask_b32 v194, v6, v194, s[44:45]
  v_cndmask_b32 v195, v6, v195, s[46:47]
  v_cndmask_b32 v196, v6, v196, s[48:49]
  v_cndmask_b32 v197, v6, v197, s[50:51]
  v_cndmask_b32 v198, v6, v198, s[52:53]
  v_cndmask_b32 v199, v6, v199, s[54:55]
  v_max3_f32 v4, v192, v193, v194
  v_max3_f32 v4, v4, v195, v196
  v_max3_f32 v4, v4, v197, v198
  v_max_f32 v4, v4, v199
  v_mov_b32 v5, v4
  s_nop 1
  v_permlane32_swap_b32 v4, v5
  v_max_f32 v4, v4, v5
  v_mov_b32 v5, v4
  s_nop 1
  v_permlane16_swap_b32 v4, v5
  v_max_f32 v4, v4, v5
  v_mul_f32 v4, s21, v4
  v_fma_f32 v192, v192, s21, -v4
  v_fma_f32 v193, v193, s21, -v4
  v_fma_f32 v194, v194, s21, -v4
  v_fma_f32 v195, v195, s21, -v4
  v_fma_f32 v196, v196, s21, -v4
  v_fma_f32 v197, v197, s21, -v4
  v_fma_f32 v198, v198, s21, -v4
  v_fma_f32 v199, v199, s21, -v4
  v_exp_f32 v192, v192
  v_exp_f32 v193, v193
  v_exp_f32 v194, v194
  v_exp_f32 v195, v195
  v_exp_f32 v196, v196
  v_exp_f32 v197, v197
  v_exp_f32 v198, v198
  v_exp_f32 v199, v199
  v_add_f32 v4, v192, v193
  v_add_f32 v4, v4, v194
  v_add_f32 v4, v4, v195
  v_add_f32 v4, v4, v196
  v_add_f32 v4, v4, v197
  v_add_f32 v4, v4, v198
  v_add_f32 v4, v4, v199
  v_mov_b32 v5, v4
  s_nop 1
  v_permlane32_swap_b32 v4, v5
  v_add_f32 v4, v4, v5
  v_mov_b32 v5, v4
  s_nop 1
  v_permlane16_swap_b32 v4, v5
  v_add_f32 v4, v4, v5
  v_rcp_f32 v4, v4
  s_nop 0
  v_mul_f32 v192, v192, v4
  v_mul_f32 v193, v193, v4
  v_mul_f32 v194, v194, v4
  v_mul_f32 v195, v195, v4
  v_mul_f32 v196, v196, v4
  v_mul_f32 v197, v197, v4
  v_mul_f32 v198, v198, v4
  v_mul_f32 v199, v199, v4
  v_cvt_pk_bf16_f32 v36, v192, v193
  v_cvt_pk_bf16_f32 v37, v194, v195
  v_cvt_pk_bf16_f32 v38, v196, v197
  v_cvt_pk_bf16_f32 v39, v198, v199
  s_waitcnt vmcnt(0)
  s_cmp_lg_u32 s32, 0
  s_cbranch_scc1 L_rq_90
  s_cmp_eq_u32 s39, 0
  s_cbranch_scc1 L_rq_90
  s_lshl_b32 s99, s33, 7
  s_add_u32 s99, s99, 0x3d00200
  v_mov_b32 v244, 1
  v_mov_b32 v245, 0
  s_mov_b64 exec, 1
  buffer_atomic_add v244, v245, s[4:7], s99 offen sc0 sc1
  s_mov_b64 exec, -1
L_rq_90:
  v_mfma_f32_16x16x32_bf16 v[136:139], v[88:91], v[8:11], 0
  v_mfma_f32_16x16x32_bf16 v[140:143], v[94:97], v[8:11], 0
  v_mfma_f32_16x16x32_bf16 v[144:147], v[100:103], v[12:15], 0
  v_mfma_f32_16x16x32_bf16 v[148:151], v[106:109], v[12:15], 0
  v_mfma_f32_16x16x32_bf16 v[152:155], v[112:115], v[16:19], 0
  v_mfma_f32_16x16x32_bf16 v[156:159], v[118:121], v[16:19], 0
  v_mfma_f32_16x16x32_bf16 v[160:163], v[124:127], v[20:23], 0
  v_mfma_f32_16x16x32_bf16 v[164:167], v[130:133], v[20:23], 0
  v_mfma_f32_16x16x32_bf16 v[168:171], v[90:93], v[24:27], 0
  v_mfma_f32_16x16x32_bf16 v[172:175], v[96:99], v[24:27], 0
  v_mfma_f32_16x16x32_bf16 v[176:179], v[102:105], v[28:31], 0
  v_mfma_f32_16x16x32_bf16 v[180:183], v[108:111], v[28:31], 0
  v_mfma_f32_16x16x32_bf16 v[184:187], v[114:117], v[32:35], 0
  v_mfma_f32_16x16x32_bf16 v[188:191], v[120:123], v[32:35], 0
  v_mfma_f32_16x16x32_bf16 v[192:195], v[126:129], v[36:39], 0
  v_mfma_f32_16x16x32_bf16 v[196:199], v[132:135], v[36:39], 0
  v_cvt_pk_bf16_f32 v40, v136, v137
  v_cvt_pk_bf16_f32 v41, v138, v139
  v_cvt_pk_bf16_f32 v42, v140, v141
  v_cvt_pk_bf16_f32 v43, v142, v143
  buffer_store_dwordx4 v[40:43], v2, s[4:7], s97 offen offset:0 sc1
  v_cvt_pk_bf16_f32 v44, v144, v145
  v_cvt_pk_bf16_f32 v45, v146, v147
  v_cvt_pk_bf16_f32 v46, v148, v149
  v_cvt_pk_bf16_f32 v47, v150, v151
  buffer_store_dwordx4 v[44:47], v2, s[4:7], s97 offen offset:1024 sc1
  v_cvt_pk_bf16_f32 v48, v152, v153
  v_cvt_pk_bf16_f32 v49, v154, v155
  v_cvt_pk_bf16_f32 v50, v156, v157
  v_cvt_pk_bf16_f32 v51, v158, v159
  buffer_store_dwordx4 v[48:51], v2, s[4:7], s97 offen offset:2048 sc1
  v_cvt_pk_bf16_f32 v52, v160, v161
  v_cvt_pk_bf16_f32 v53, v162, v163
  v_cvt_pk_bf16_f32 v54, v164, v165
  v_cvt_pk_bf16_f32 v55, v166, v167
  buffer_store_dwordx4 v[52:55], v2, s[4:7], s97 offen offset:3072 sc1
  v_cvt_pk_bf16_f32 v56, v168, v169
  v_cvt_pk_bf16_f32 v57, v170, v171
  v_cvt_pk_bf16_f32 v58, v172, v173
  v_cvt_pk_bf16_f32 v59, v174, v175
  buffer_store_dwordx4 v[56:59], v3, s[4:7], s97 offen offset:0 sc1
  v_cvt_pk_bf16_f32 v60, v176, v177
  v_cvt_pk_bf16_f32 v61, v178, v179
  v_cvt_pk_bf16_f32 v62, v180, v181
  v_cvt_pk_bf16_f32 v63, v182, v183
  buffer_store_dwordx4 v[60:63], v3, s[4:7], s97 offen offset:1024 sc1
  v_cvt_pk_bf16_f32 v64, v184, v185
  v_cvt_pk_bf16_f32 v65, v186, v187
  v_cvt_pk_bf16_f32 v66, v188, v189
  v_cvt_pk_bf16_f32 v67, v190, v191
  buffer_store_dwordx4 v[64:67], v3, s[4:7], s97 offen offset:2048 sc1
  v_cvt_pk_bf16_f32 v68, v192, v193
  v_cvt_pk_bf16_f32 v69, v194, v195
  v_cvt_pk_bf16_f32 v70, v196, v197
  v_cvt_pk_bf16_f32 v71, v198, v199
  buffer_store_dwordx4 v[68:71], v3, s[4:7], s97 offen offset:3072 sc1
  s_branch L_done
L_ata:
  s_mov_b32 s50, 0
L_ata_c:
  s_lshr_b32 s40, s36, 3
  s_lshl_b32 s40, s40, 9
  s_lshl_b32 s90, s33, 7
  s_add_u32 s40, s40, s90
  s_add_u32 s41, s36, 1
  s_min_u32 s41, s41, 62
  s_lshr_b32 s43, s36, 2
  s_lshl_b32 s43, s43, 9
  s_add_u32 s43, s43, s90
  s_add_u32 s43, s43, 28672
  s_lshl_b32 s42, s33, 1
  s_add_u32 s42, s42, s37
  s_lshl_b32 s42, s42, 7
  s_add_u32 s42, s42, 4096
  s_cmp_ge_u32 s50, 2
  s_cbranch_scc1 L_ata_s
  s_cmp_lg_u32 s32, 0
  s_cbranch_scc1 L_dd_92
  v_mov_b32 v228, 0x3d00000
  v_mov_b32 v230, 0x3d02000
L_dw_91:
  buffer_load_dword v234, v230, s[4:7], s40 offen offset:0 sc1
  buffer_load_dword v235, v228, s[4:7], s43 offen offset:0 sc1
  s_waitcnt vmcnt(0)
  s_mov_b32 s44, 1
  v_readfirstlane_b32 s45, v234
  s_cmp_ge_u32 s45, 4
  s_cselect_b32 s44, s44, 0
  v_readfirstlane_b32 s45, v235
  s_cmp_ge_u32 s45, 16
  s_cselect_b32 s44, s44, 0
  s_cmp_eq_u32 s44, 1
  s_cbranch_scc1 L_dd_92
  s_sleep 6
  s_add_u32 s3, s3, 1
  s_cmp_lt_u32 s3, 131072
  s_cbranch_scc1 L_dw_91
L_dd_92:
  s_barrier
L_ata_s:
  s_mov_b32 s98, 1
  s_lshr_b32 s38, s36, 2
  s_lshl_b32 s38, s38, 7
  s_add_u32 s38, s38, 2048
  s_lshr_b32 s90, s36, 1
  s_sub_u32 s90, s90, 24
  s_lshl_b32 s90, s90, 2
  s_add_u32 s90, s90, s33
  s_lshl_b32 s90, s90, 1
  s_add_u32 s90, s90, s37
  s_lshl_b32 s90, s90, 7
  s_add_u32 s90, s90, 20480
  s_cmp_ge_u32 s36, 60
  s_cselect_b32 s38, s90, s38
  s_lshl_b32 s20, s36, 5
  s_lshl_b32 s90, s33, 3
  s_add_u32 s20, s20, s90
  s_lshl_b32 s90, s37, 2
  s_add_u32 s20, s20, s90
  s_add_u32 s20, s20, s32
  v_and_b32 v1, 63, v0
  v_mov_b32 v228, 0x3d00000
  s_lshl_b32 s45, s33, 7
  buffer_load_dword v238, v228, s[4:7], s45 offen offset:0 sc1
  s_lshl_b32 s90, s20, 13
  s_lshl_b32 s91, s20, 11
  v_mov_b32 v2, 0x0
  v_bfe_u32 v7, v1, 0, 6
  v_lshl_add_u32 v2, v7, 4, v2
  v_add_u32 v3, 4096, v2
  v_mov_b32 v4, 0x3000000
  v_bfe_u32 v7, v1, 0, 1
  v_lshl_add_u32 v4, v7, 4, v4
  v_bfe_u32 v7, v1, 2, 2
  v_lshl_add_u32 v4, v7, 5, v4
  v_bfe_u32 v7, v1, 4, 2
  v_lshl_add_u32 v4, v7, 7, v4
  v_add_u32 v5, 0x3400000, v2
  v_mov_b32 v8, 0x0
  v_bfe_u32 v7, v1, 0, 3
  v_lshl_add_u32 v8, v7, 4, v8
  v_bfe_u32 v7, v1, 3, 1
  v_lshl_add_u32 v8, v7, 11, v8
  v_bfe_u32 v7, v1, 4, 2
  v_lshl_add_u32 v8, v7, 8, v8
  v_add_u32 v9, 4096, v8
  v_mov_b32 v10, 0x0
  v_bfe_u32 v7, v1, 0, 4
  v_lshl_add_u32 v10, v7, 4, v10
  v_bfe_u32 v7, v1, 4, 1
  v_lshl_add_u32 v10, v7, 8, v10
  v_bfe_u32 v7, v1, 5, 1
  v_lshl_add_u32 v10, v7, 10, v10
  v_add_u32 v11, 4096, v10
  s_add_u32 s92, s90, 16777216
  s_add_u32 s93, s90, 33554432
  s_add_u32 s94, s90, 0
  s_add_u32 s95, s90, 83886080
  buffer_load_dwordx4 v[16:19], v2, s[4:7], s94 offen offset:0 sc1
  buffer_load_dwordx4 v[20:23], v2, s[4:7], s94 offen offset:1024 sc1
  buffer_load_dwordx4 v[24:27], v2, s[4:7], s94 offen offset:2048 sc1
  buffer_load_dwordx4 v[28:31], v2, s[4:7], s94 offen offset:3072 sc1
  buffer_load_dwordx4 v[32:35], v3, s[4:7], s94 offen offset:0 sc1
  buffer_load_dwordx4 v[36:39], v3, s[4:7], s94 offen offset:1024 sc1
  buffer_load_dwordx4 v[40:43], v3, s[4:7], s94 offen offset:2048 sc1
  buffer_load_dwordx4 v[44:47], v3, s[4:7], s94 offen offset:3072 sc1
  buffer_load_dwordx4 v[48:51], v2, s[4:7], s92 offen offset:0 sc1
  buffer_load_dwordx4 v[52:55], v2, s[4:7], s92 offen offset:1024 sc1
  buffer_load_dwordx4 v[56:59], v2, s[4:7], s92 offen offset:2048 sc1
  buffer_load_dwordx4 v[60:63], v2, s[4:7], s92 offen offset:3072 sc1
  buffer_load_dwordx4 v[64:67], v3, s[4:7], s92 offen offset:0 sc1
  buffer_load_dwordx4 v[68:71], v3, s[4:7], s92 offen offset:1024 sc1
  buffer_load_dwordx4 v[72:75], v3, s[4:7], s92 offen offset:2048 sc1
  buffer_load_dwordx4 v[76:79], v3, s[4:7], s92 offen offset:3072 sc1
  buffer_load_dwordx4 v[80:83], v8, s[4:7], s93 offen offset:0 sc1
  buffer_load_dwordx4 v[84:87], v8, s[4:7], s93 offen offset:128 sc1
  buffer_load_dwordx4 v[88:91], v8, s[4:7], s93 offen offset:1024 sc1
  buffer_load_dwordx4 v[92:95], v8, s[4:7], s93 offen offset:1152 sc1
  buffer_load_dwordx4 v[96:99], v9, s[4:7], s93 offen offset:0 sc1
  buffer_load_dwordx4 v[100:103], v9, s[4:7], s93 offen offset:128 sc1
  buffer_load_dwordx4 v[104:107], v9, s[4:7], s93 offen offset:1024 sc1
  buffer_load_dwordx4 v[108:111], v9, s[4:7], s93 offen offset:1152 sc1
  s_waitcnt vmcnt(24)
L_m1:
  v_readfirstlane_b32 s44, v238
  s_cmp_ge_u32 s44, s41
  s_cbranch_scc1 L_m1d
  s_add_u32 s3, s3, 1
  s_cmp_ge_u32 s3, 131072
  s_cbranch_scc1 L_m1d
  s_sleep 3
  buffer_load_dword v238, v228, s[4:7], s45 offen offset:0 sc1
  s_waitcnt vmcnt(0)
  s_branch L_m1
L_m1d:
  buffer_load_dwordx4 v[112:115], v4, s[4:7], s91 offen offset:0 sc1
  buffer_load_dwordx4 v[116:119], v4, s[4:7], s91 offen offset:512 sc1
  buffer_load_dwordx4 v[120:123], v4, s[4:7], s91 offen offset:1024 sc1
  buffer_load_dwordx4 v[124:127], v4, s[4:7], s91 offen offset:1536 sc1
  buffer_load_dwordx4 v[128:131], v5, s[4:7], s91 offen offset:0 sc1
  buffer_load_dwordx4 v[132:135], v5, s[4:7], s91 offen offset:1024 sc1
  s_mov_b32 s40, 0xfff0ffff
  s_mov_b32 s41, 0xf000ff00
  s_mov_b32 s42, 0xffe0fffe
  s_mov_b32 s43, 0xe000fe00
  s_mov_b32 s44, 0xffc0fffc
  s_mov_b32 s45, 0xc000fc00
  s_mov_b32 s46, 0xff80fff8
  s_mov_b32 s47, 0x8000f800
  s_mov_b32 s50, 0x3e0293ee
  v_mov_b32 v6, 0xd028965f
  s_waitcnt vmcnt(6)
  v_mfma_f32_16x16x32_bf16 v[140:143], v[48:51], v[16:19], 0
  v_mfma_f32_16x16x32_bf16 v[148:151], v[48:51], v[32:35], 0
  v_mfma_f32_16x16x32_bf16 v[152:155], v[64:67], v[32:35], 0
  v_mfma_f32_16x16x32_bf16 v[140:143], v[52:55], v[20:23], v[140:143]
  v_mfma_f32_16x16x32_bf16 v[148:151], v[52:55], v[36:39], v[148:151]
  v_mfma_f32_16x16x32_bf16 v[152:155], v[68:71], v[36:39], v[152:155]
  v_mfma_f32_16x16x32_bf16 v[140:143], v[56:59], v[24:27], v[140:143]
  v_mfma_f32_16x16x32_bf16 v[148:151], v[56:59], v[40:43], v[148:151]
  v_mfma_f32_16x16x32_bf16 v[152:155], v[72:75], v[40:43], v[152:155]
  v_mfma_f32_16x16x32_bf16 v[140:143], v[60:63], v[28:31], v[140:143]
  v_mfma_f32_16x16x32_bf16 v[148:151], v[60:63], v[44:47], v[148:151]
  v_mfma_f32_16x16x32_bf16 v[152:155], v[76:79], v[44:47], v[152:155]
L_av:
  s_waitcnt vmcnt(0)
  v_max3_u32 v12, v112, v113, v114
  v_max3_u32 v12, v12, v115, v116
  v_max3_u32 v12, v12, v117, v118
  v_max3_u32 v12, v12, v119, v120
  v_max3_u32 v12, v12, v121, v122
  v_max3_u32 v12, v12, v123, v124
  v_max3_u32 v12, v12, v125, v126
  v_max3_u32 v12, v12, v127, v128
  v_max3_u32 v12, v12, v129, v130
  v_max3_u32 v12, v12, v131, v132
  v_max3_u32 v12, v12, v133, v134
  v_max_u32 v12, v12, v135
  v_cmp_eq_u32 vcc, -1, v12
  s_cbranch_vccz L_avd
  s_add_u32 s3, s3, 1
  s_cmp_ge_u32 s3, 131072
  s_cbranch_scc1 L_avd
  buffer_load_dwordx4 v[112:115], v4, s[4:7], s91 offen offset:0 sc1
  buffer_load_dwordx4 v[116:119], v4, s[4:7], s91 offen offset:512 sc1
  buffer_load_dwordx4 v[120:123], v4, s[4:7], s91 offen offset:1024 sc1
  buffer_load_dwordx4 v[124:127], v4, s[4:7], s91 offen offset:1536 sc1
  buffer_load_dwordx4 v[128:131], v5, s[4:7], s91 offen offset:0 sc1
  buffer_load_dwordx4 v[132:135], v5, s[4:7], s91 offen offset:1024 sc1
  s_branch L_av
L_avd:
  s_waitcnt vmcnt(0)
  s_cmp_lt_u32 s36, 60
  s_cbranch_scc1 L_rf_93
  s_cmp_lg_u32 s32, 0
  s_cbranch_scc1 L_rq_94
  s_cmp_eq_u32 s39, 0
  s_cbranch_scc1 L_rq_94
  s_lshl_b32 s99, s33, 7
  s_add_u32 s99, s99, 0x3d00200
  v_mov_b32 v244, 1
  v_mov_b32 v245, 0
  s_mov_b64 exec, 1
  buffer_atomic_add v244, v245, s[4:7], s99 offen sc0 sc1
  s_mov_b64 exec, -1
L_rq_94:
L_rf_93:
  v_mfma_f32_16x16x32_bf16 v[136:139], v[112:115], v[16:19], 0
  v_mfma_f32_16x16x32_bf16 v[144:147], v[112:115], v[32:35], 0
  v_mfma_f32_16x16x32_bf16 v[136:139], v[116:119], v[20:23], v[136:139]
  v_mfma_f32_16x16x32_bf16 v[144:147], v[116:119], v[36:39], v[144:147]
  v_mfma_f32_16x16x32_bf16 v[136:139], v[120:123], v[24:27], v[136:139]
  v_mfma_f32_16x16x32_bf16 v[144:147], v[120:123], v[40:43], v[144:147]
  v_mfma_f32_16x16x32_bf16 v[136:139], v[124:127], v[28:31], v[136:139]
  v_mfma_f32_16x16x32_bf16 v[144:147], v[124:127], v[44:47], v[144:147]
  v_cndmask_b32 v140, v6, v140, s[40:41]
  v_cndmask_b32 v141, v6, v141, s[42:43]
  v_cndmask_b32 v142, v6, v142, s[44:45]
  v_cndmask_b32 v143, v6, v143, s[46:47]
  s_nop 2
  v_max3_f32 v12, v136, v137, v140
  v_max3_f32 v12, v12, v141, v142
  v_max_f32 v12, v12, v143
  v_mov_b32 v13, v12
  s_nop 1
  v_permlane32_swap_b32 v12, v13
  v_max_f32 v12, v12, v13
  v_mov_b32 v13, v12
  s_nop 1
  v_permlane16_swap_b32 v12, v13
  v_max_f32 v12, v12, v13
  v_mul_f32 v12, s50, v12
  v_fma_f32 v136, v136, s50, -v12
  v_fma_f32 v137, v137, s50, -v12
  v_fma_f32 v140, v140, s50, -v12
  v_fma_f32 v141, v141, s50, -v12
  v_fma_f32 v142, v142, s50, -v12
  v_fma_f32 v143, v143, s50, -v12
  v_exp_f32 v136, v136
  v_exp_f32 v137, v137
  v_exp_f32 v140, v140
  v_exp_f32 v141, v141
  v_exp_f32 v142, v142
  v_exp_f32 v143, v143
  v_add_f32 v12, v136, v137
  v_add_f32 v12, v12, v140
  v_add_f32 v12, v12, v141
  v_add_f32 v12, v12, v142
  v_add_f32 v12, v12, v143
  v_mov_b32 v13, v12
  s_nop 1
  v_permlane32_swap_b32 v12, v13
  v_add_f32 v12, v12, v13
  v_mov_b32 v13, v12
  s_nop 1
  v_permlane16_swap_b32 v12, v13
  v_add_f32 v12, v12, v13
  v_rcp_f32 v12, v12
  s_nop 0
  v_mul_f32 v136, v136, v12
  v_mul_f32 v137, v137, v12
  v_mul_f32 v140, v140, v12
  v_mul_f32 v141, v141, v12
  v_mul_f32 v142, v142, v12
  v_mul_f32 v143, v143, v12
  v_cvt_pk_bf16_f32 v160, v136, v137
  v_mov_b32 v161, 0
  v_mov_b32 v162, 0
  v_mov_b32 v163, v160
  v_cvt_pk_bf16_f32 v156, v140, v141
  v_cvt_pk_bf16_f32 v157, v142, v143
  v_mov_b32 v158, 0
  v_mov_b32 v159, 0
  v_cndmask_b32 v152, v6, v152, s[40:41]
  v_cndmask_b32 v153, v6, v153, s[42:43]
  v_cndmask_b32 v154, v6, v154, s[44:45]
  v_cndmask_b32 v155, v6, v155, s[46:47]
  v_max3_f32 v12, v144, v145, v148
  v_max3_f32 v12, v12, v149, v150
  v_max3_f32 v12, v12, v151, v152
  v_max3_f32 v12, v12, v153, v154
  v_max_f32 v12, v12, v155
  v_mov_b32 v13, v12
  s_nop 1
  v_permlane32_swap_b32 v12, v13
  v_max_f32 v12, v12, v13
  v_mov_b32 v13, v12
  s_nop 1
  v_permlane16_swap_b32 v12, v13
  v_max_f32 v12, v12, v13
  v_mul_f32 v12, s50, v12
  v_fma_f32 v144, v144, s50, -v12
  v_fma_f32 v145, v145, s50, -v12
  v_fma_f32 v148, v148, s50, -v12
  v_fma_f32 v149, v149, s50, -v12
  v_fma_f32 v150, v150, s50, -v12
  v_fma_f32 v151, v151, s50, -v12
  v_fma_f32 v152, v152, s50, -v12
  v_fma_f32 v153, v153, s50, -v12
  v_fma_f32 v154, v154, s50, -v12
  v_fma_f32 v155, v155, s50, -v12
  v_exp_f32 v144, v144
  v_exp_f32 v145, v145
  v_exp_f32 v148, v148
  v_exp_f32 v149, v149
  v_exp_f32 v150, v150
  v_exp_f32 v151, v151
  v_exp_f32 v152, v152
  v_exp_f32 v153, v153
  v_exp_f32 v154, v154
  v_exp_f32 v155, v155
  v_add_f32 v12, v144, v145
  v_add_f32 v12, v12, v148
  v_add_f32 v12, v12, v149
  v_add_f32 v12, v12, v150
  v_add_f32 v12, v12, v151
  v_add_f32 v12, v12, v152
  v_add_f32 v12, v12, v153
  v_add_f32 v12, v12, v154
  v_add_f32 v12, v12, v155
  v_mov_b32 v13, v12
  s_nop 1
  v_permlane32_swap_b32 v12, v13
  v_add_f32 v12, v12, v13
  v_mov_b32 v13, v12
  s_nop 1
  v_permlane16_swap_b32 v12, v13
  v_add_f32 v12, v12, v13
  v_rcp_f32 v12, v12
  s_nop 0
  v_mul_f32 v144, v144, v12
  v_mul_f32 v145, v145, v12
  v_mul_f32 v148, v148, v12
  v_mul_f32 v149, v149, v12
  v_mul_f32 v150, v150, v12
  v_mul_f32 v151, v151, v12
  v_mul_f32 v152, v152, v12
  v_mul_f32 v153, v153, v12
  v_mul_f32 v154, v154, v12
  v_mul_f32 v155, v155, v12
  v_cvt_pk_bf16_f32 v168, v144, v145
  v_mov_b32 v169, 0
  v_mov_b32 v170, 0
  v_mov_b32 v171, v168
  v_cvt_pk_bf16_f32 v164, v148, v149
  v_cvt_pk_bf16_f32 v165, v150, v151
  v_cvt_pk_bf16_f32 v166, v152, v153
  v_cvt_pk_bf16_f32 v167, v154, v155
  v_mfma_f32_16x16x32_bf16 v[176:179], v[80:83], v[156:159], 0
  v_mfma_f32_16x16x32_bf16 v[180:183], v[84:87], v[156:159], 0
  v_mfma_f32_16x16x32_bf16 v[184:187], v[88:91], v[156:159], 0
  v_mfma_f32_16x16x32_bf16 v[188:191], v[92:95], v[156:159], 0
  v_mfma_f32_16x16x32_bf16 v[192:195], v[96:99], v[156:159], 0
  v_mfma_f32_16x16x32_bf16 v[196:199], v[100:103], v[156:159], 0
  v_mfma_f32_16x16x32_bf16 v[200:203], v[104:107], v[156:159], 0
  v_mfma_f32_16x16x32_bf16 v[204:207], v[108:111], v[156:159], 0
  v_mfma_f32_16x16x16_bf16 v[176:179], v[128:129], v[160:161], v[176:179]
  v_mfma_f32_16x16x16_bf16 v[180:183], v[128:129], v[162:163], v[180:183]
  v_mfma_f32_16x16x16_bf16 v[184:187], v[130:131], v[160:161], v[184:187]
  v_mfma_f32_16x16x16_bf16 v[188:191], v[130:131], v[162:163], v[188:191]
  v_mfma_f32_16x16x16_bf16 v[192:195], v[132:133], v[160:161], v[192:195]
  v_mfma_f32_16x16x16_bf16 v[196:199], v[132:133], v[162:163], v[196:199]
  v_mfma_f32_16x16x16_bf16 v[200:203], v[134:135], v[160:161], v[200:203]
  v_mfma_f32_16x16x16_bf16 v[204:207], v[134:135], v[162:163], v[204:207]
  v_mfma_f32_16x16x32_bf16 v[208:211], v[80:83], v[164:167], 0
  v_mfma_f32_16x16x32_bf16 v[212:215], v[84:87], v[164:167], 0
  v_mfma_f32_16x16x32_bf16 v[216:219], v[88:91], v[164:167], 0
  v_mfma_f32_16x16x32_bf16 v[220:223], v[92:95], v[164:167], 0
  v_mfma_f32_16x16x32_bf16 v[224:227], v[96:99], v[164:167], 0
  v_mfma_f32_16x16x32_bf16 v[228:231], v[100:103], v[164:167], 0
  v_mfma_f32_16x16x32_bf16 v[232:235], v[104:107], v[164:167], 0
  v_mfma_f32_16x16x32_bf16 v[236:239], v[108:111], v[164:167], 0
  v_mfma_f32_16x16x16_bf16 v[208:211], v[128:129], v[168:169], v[208:211]
  v_mfma_f32_16x16x16_bf16 v[212:215], v[128:129], v[170:171], v[212:215]
  v_mfma_f32_16x16x16_bf16 v[216:219], v[130:131], v[168:169], v[216:219]
  v_mfma_f32_16x16x16_bf16 v[220:223], v[130:131], v[170:171], v[220:223]
  v_mfma_f32_16x16x16_bf16 v[224:227], v[132:133], v[168:169], v[224:227]
  v_mfma_f32_16x16x16_bf16 v[228:231], v[132:133], v[170:171], v[228:231]
  v_mfma_f32_16x16x16_bf16 v[232:235], v[134:135], v[168:169], v[232:235]
  v_mfma_f32_16x16x16_bf16 v[236:239], v[134:135], v[170:171], v[236:239]
  v_cvt_pk_bf16_f32 v136, v176, v177
  v_cvt_pk_bf16_f32 v137, v178, v179
  v_cvt_pk_bf16_f32 v138, v184, v185
  v_cvt_pk_bf16_f32 v139, v186, v187
  buffer_store_dwordx4 v[136:139], v10, s[4:7], s95 offen offset:0 sc1
  v_cvt_pk_bf16_f32 v140, v180, v181
  v_cvt_pk_bf16_f32 v141, v182, v183
  v_cvt_pk_bf16_f32 v142, v188, v189
  v_cvt_pk_bf16_f32 v143, v190, v191
  buffer_store_dwordx4 v[140:143], v10, s[4:7], s95 offen offset:512 sc1
  v_cvt_pk_bf16_f32 v144, v192, v193
  v_cvt_pk_bf16_f32 v145, v194, v195
  v_cvt_pk_bf16_f32 v146, v200, v201
  v_cvt_pk_bf16_f32 v147, v202, v203
  buffer_store_dwordx4 v[144:147], v10, s[4:7], s95 offen offset:2048 sc1
  v_cvt_pk_bf16_f32 v148, v196, v197
  v_cvt_pk_bf16_f32 v149, v198, v199
  v_cvt_pk_bf16_f32 v150, v204, v205
  v_cvt_pk_bf16_f32 v151, v206, v207
  buffer_store_dwordx4 v[148:151], v10, s[4:7], s95 offen offset:2560 sc1
  v_cvt_pk_bf16_f32 v136, v208, v209
  v_cvt_pk_bf16_f32 v137, v210, v211
  v_cvt_pk_bf16_f32 v138, v216, v217
  v_cvt_pk_bf16_f32 v139, v218, v219
  buffer_store_dwordx4 v[136:139], v11, s[4:7], s95 offen offset:0 sc1
  v_cvt_pk_bf16_f32 v140, v212, v213
  v_cvt_pk_bf16_f32 v141, v214, v215
  v_cvt_pk_bf16_f32 v142, v220, v221
  v_cvt_pk_bf16_f32 v143, v222, v223
  buffer_store_dwordx4 v[140:143], v11, s[4:7], s95 offen offset:512 sc1
  v_cvt_pk_bf16_f32 v144, v224, v225
  v_cvt_pk_bf16_f32 v145, v226, v227
  v_cvt_pk_bf16_f32 v146, v232, v233
  v_cvt_pk_bf16_f32 v147, v234, v235
  buffer_store_dwordx4 v[144:147], v11, s[4:7], s95 offen offset:2048 sc1
  v_cvt_pk_bf16_f32 v148, v228, v229
  v_cvt_pk_bf16_f32 v149, v230, v231
  v_cvt_pk_bf16_f32 v150, v236, v237
  v_cvt_pk_bf16_f32 v151, v238, v239
  buffer_store_dwordx4 v[148:151], v11, s[4:7], s95 offen offset:2560 sc1
  s_add_u32 s95, s95, 262144
  s_branch L_done
L_ata4:
  s_lshr_b32 s40, s36, 3
  s_lshl_b32 s40, s40, 9
  s_lshl_b32 s90, s33, 7
  s_add_u32 s40, s40, s90
  s_add_u32 s41, s36, 4
  s_lshr_b32 s43, s36, 2
  s_lshl_b32 s43, s43, 9
  s_add_u32 s43, s43, s90
  s_add_u32 s43, s43, 28672
  s_lshl_b32 s42, s33, 1
  s_add_u32 s42, s42, s37
  s_lshl_b32 s42, s42, 7
  s_add_u32 s42, s42, 4096
  s_cmp_lg_u32 s32, 0
  s_cbranch_scc1 L_dd_96
  v_mov_b32 v228, 0x3d00000
  v_mov_b32 v230, 0x3d02000
L_dw_95:
  buffer_load_dword v234, v230, s[4:7], s40 offen offset:0 sc1
  buffer_load_dword v235, v228, s[4:7], s43 offen offset:0 sc1
  s_lshl_b32 s45, s33, 7
  buffer_load_dword v238, v228, s[4:7], s45 offen offset:0 sc1
  buffer_load_dword v239, v228, s[4:7], s42 offen sc1
  s_waitcnt vmcnt(0)
  s_mov_b32 s44, 1
  v_readfirstlane_b32 s45, v234
  s_cmp_ge_u32 s45, 4
  s_cselect_b32 s44, s44, 0
  v_readfirstlane_b32 s45, v235
  s_cmp_ge_u32 s45, 16
  s_cselect_b32 s44, s44, 0
  v_readfirstlane_b32 s45, v238
  v_readfirstlane_b32 s47, v239
  s_cmp_ge_u32 s47, 16
  s_cselect_b32 s45, 64, s45
  s_cmp_ge_u32 s45, s41
  s_cselect_b32 s44, s44, 0
  s_cmp_eq_u32 s44, 1
  s_cbranch_scc1 L_dd_96
  s_sleep 6
  s_add_u32 s3, s3, 1
  s_cmp_lt_u32 s3, 131072
  s_cbranch_scc1 L_dw_95
L_dd_96:
  s_barrier
  s_mov_b32 s98, 4
  s_lshr_b32 s38, s36, 2
  s_lshl_b32 s38, s38, 7
  s_add_u32 s38, s38, 2048
  s_lshl_b32 s20, s36, 5
  s_lshl_b32 s90, s33, 3
  s_add_u32 s20, s20, s90
  s_lshl_b32 s90, s37, 2
  s_add_u32 s20, s20, s90
  s_add_u32 s20, s20, s32
  v_and_b32 v1, 63, v0
  s_lshl_b32 s90, s20, 13
  s_lshl_b32 s91, s20, 11
  v_mov_b32 v2, 0x0
  v_bfe_u32 v7, v1, 0, 6
  v_lshl_add_u32 v2, v7, 4, v2
  v_add_u32 v3, 4096, v2
  v_mov_b32 v4, 0x3000000
  v_bfe_u32 v7, v1, 0, 1
  v_lshl_add_u32 v4, v7, 4, v4
  v_bfe_u32 v7, v1, 2, 2
  v_lshl_add_u32 v4, v7, 5, v4
  v_bfe_u32 v7, v1, 4, 2
  v_lshl_add_u32 v4, v7, 7, v4
  v_add_u32 v5, 0x3400000, v2
  v_mov_b32 v8, 0x0
  v_bfe_u32 v7, v1, 0, 3
  v_lshl_add_u32 v8, v7, 4, v8
  v_bfe_u32 v7, v1, 3, 1
  v_lshl_add_u32 v8, v7, 11, v8
  v_bfe_u32 v7, v1, 4, 2
  v_lshl_add_u32 v8, v7, 8, v8
  v_add_u32 v9, 4096, v8
  v_mov_b32 v10, 0x0
  v_bfe_u32 v7, v1, 0, 4
  v_lshl_add_u32 v10, v7, 4, v10
  v_bfe_u32 v7, v1, 4, 1
  v_lshl_add_u32 v10, v7, 8, v10
  v_bfe_u32 v7, v1, 5, 1
  v_lshl_add_u32 v10, v7, 10, v10
  v_add_u32 v11, 4096, v10
  s_add_u32 s92, s90, 16777216
  s_add_u32 s93, s90, 33554432
  s_add_u32 s94, s90, 0
  s_add_u32 s95, s90, 83886080
  buffer_load_dwordx4 v[16:19], v2, s[4:7], s94 offen offset:0 sc1
  buffer_load_dwordx4 v[20:23], v2, s[4:7], s94 offen offset:1024 sc1
  buffer_load_dwordx4 v[24:27], v2, s[4:7], s94 offen offset:2048 sc1
  buffer_load_dwordx4 v[28:31], v2, s[4:7], s94 offen offset:3072 sc1
  buffer_load_dwordx4 v[32:35], v3, s[4:7], s94 offen offset:0 sc1
  buffer_load_dwordx4 v[36:39], v3, s[4:7], s94 offen offset:1024 sc1
  buffer_load_dwordx4 v[40:43], v3, s[4:7], s94 offen offset:2048 sc1
  buffer_load_dwordx4 v[44:47], v3, s[4:7], s94 offen offset:3072 sc1
  buffer_load_dwordx4 v[48:51], v2, s[4:7], s92 offen offset:0 sc1
  buffer_load_dwordx4 v[52:55], v2, s[4:7], s92 offen offset:1024 sc1
  buffer_load_dwordx4 v[56:59], v2, s[4:7], s92 offen offset:2048 sc1
  buffer_load_dwordx4 v[60:63], v2, s[4:7], s92 offen offset:3072 sc1
  buffer_load_dwordx4 v[64:67], v3, s[4:7], s92 offen offset:0 sc1
  buffer_load_dwordx4 v[68:71], v3, s[4:7], s92 offen offset:1024 sc1
  buffer_load_dwordx4 v[72:75], v3, s[4:7], s92 offen offset:2048 sc1
  buffer_load_dwordx4 v[76:79], v3, s[4:7], s92 offen offset:3072 sc1
  buffer_load_dwordx4 v[80:83], v8, s[4:7], s93 offen offset:0 sc1
  buffer_load_dwordx4 v[84:87], v8, s[4:7], s93 offen offset:128 sc1
  buffer_load_dwordx4 v[88:91], v8, s[4:7], s93 offen offset:1024 sc1
  buffer_load_dwordx4 v[92:95], v8, s[4:7], s93 offen offset:1152 sc1
  buffer_load_dwordx4 v[96:99], v9, s[4:7], s93 offen offset:0 sc1
  buffer_load_dwordx4 v[100:103], v9, s[4:7], s93 offen offset:128 sc1
  buffer_load_dwordx4 v[104:107], v9, s[4:7], s93 offen offset:1024 sc1
  buffer_load_dwordx4 v[108:111], v9, s[4:7], s93 offen offset:1152 sc1
  buffer_load_dwordx4 v[112:115], v4, s[4:7], s91 offen offset:0 sc1
  buffer_load_dwordx4 v[116:119], v4, s[4:7], s91 offen offset:512 sc1
  buffer_load_dwordx4 v[120:123], v4, s[4:7], s91 offen offset:1024 sc1
  buffer_load_dwordx4 v[124:127], v4, s[4:7], s91 offen offset:1536 sc1
  buffer_load_dwordx4 v[128:131], v5, s[4:7], s91 offen offset:0 sc1
  buffer_load_dwordx4 v[132:135], v5, s[4:7], s91 offen offset:1024 sc1
  s_add_u32 s92, s92, 262144
  s_add_u32 s93, s93, 262144
  s_add_u32 s94, s94, 262144
  s_add_u32 s91, s91, 65536
  buffer_load_dwordx4 a[0:3], v2, s[4:7], s94 offen offset:0 sc1
  buffer_load_dwordx4 a[4:7], v2, s[4:7], s94 offen offset:1024 sc1
  buffer_load_dwordx4 a[8:11], v2, s[4:7], s94 offen offset:2048 sc1
  buffer_load_dwordx4 a[12:15], v2, s[4:7], s94 offen offset:3072 sc1
  buffer_load_dwordx4 a[16:19], v3, s[4:7], s94 offen offset:0 sc1
  buffer_load_dwordx4 a[20:23], v3, s[4:7], s94 offen offset:1024 sc1
  buffer_load_dwordx4 a[24:27], v3, s[4:7], s94 offen offset:2048 sc1
  buffer_load_dwordx4 a[28:31], v3, s[4:7], s94 offen offset:3072 sc1
  buffer_load_dwordx4 a[32:35], v2, s[4:7], s92 offen offset:0 sc1
  buffer_load_dwordx4 a[36:39], v2, s[4:7], s92 offen offset:1024 sc1
  buffer_load_dwordx4 a[40:43], v2, s[4:7], s92 offen offset:2048 sc1
  buffer_load_dwordx4 a[44:47], v2, s[4:7], s92 offen offset:3072 sc1
  buffer_load_dwordx4 a[48:51], v3, s[4:7], s92 offen offset:0 sc1
  buffer_load_dwordx4 a[52:55], v3, s[4:7], s92 offen offset:1024 sc1
  buffer_load_dwordx4 a[56:59], v3, s[4:7], s92 offen offset:2048 sc1
  buffer_load_dwordx4 a[60:63], v3, s[4:7], s92 offen offset:3072 sc1
  buffer_load_dwordx4 a[64:67], v8, s[4:7], s93 offen offset:0 sc1
  buffer_load_dwordx4 a[68:71], v8, s[4:7], s93 offen offset:128 sc1
  buffer_load_dwordx4 a[72:75], v8, s[4:7], s93 offen offset:1024 sc1
  buffer_load_dwordx4 a[76:79], v8, s[4:7], s93 offen offset:1152 sc1
  buffer_load_dwordx4 a[80:83], v9, s[4:7], s93 offen offset:0 sc1
  buffer_load_dwordx4 a[84:87], v9, s[4:7], s93 offen offset:128 sc1
  buffer_load_dwordx4 a[88:91], v9, s[4:7], s93 offen offset:1024 sc1
  buffer_load_dwordx4 a[92:95], v9, s[4:7], s93 offen offset:1152 sc1
  buffer_load_dwordx4 a[96:99], v4, s[4:7], s91 offen offset:0 sc1
  buffer_load_dwordx4 a[100:103], v4, s[4:7], s91 offen offset:512 sc1
  buffer_load_dwordx4 a[104:107], v4, s[4:7], s91 offen offset:1024 sc1
  buffer_load_dwordx4 a[108:111], v4, s[4:7], s91 offen offset:1536 sc1
  buffer_load_dwordx4 a[112:115], v5, s[4:7], s91 offen offset:0 sc1
  buffer_load_dwordx4 a[116:119], v5, s[4:7], s91 offen offset:1024 sc1
  s_add_u32 s92, s92, 262144
  s_add_u32 s93, s93, 262144
  s_add_u32 s94, s94, 262144
  s_add_u32 s91, s91, 65536
  s_mov_b32 s40, 0xfff0ffff
  s_mov_b32 s41, 0xf000ff00
  s_mov_b32 s42, 0xffe0fffe
  s_mov_b32 s43, 0xe000fe00
  s_mov_b32 s44, 0xffc0fffc
  s_mov_b32 s45, 0xc000fc00
  s_mov_b32 s46, 0xff80fff8
  s_mov_b32 s47, 0x8000f800
  s_mov_b32 s50, 0x3e0293ee
  v_mov_b32 v6, 0xd028965f
  s_waitcnt vmcnt(30)
  v_mfma_f32_16x16x32_bf16 v[136:139], v[112:115], v[16:19], 0
  v_mfma_f32_16x16x32_bf16 v[140:143], v[48:51], v[16:19], 0
  v_mfma_f32_16x16x32_bf16 v[144:147], v[112:115], v[32:35], 0
  v_mfma_f32_16x16x32_bf16 v[148:151], v[48:51], v[32:35], 0
  v_mfma_f32_16x16x32_bf16 v[152:155], v[64:67], v[32:35], 0
  v_mfma_f32_16x16x32_bf16 v[136:139], v[116:119], v[20:23], v[136:139]
  v_mfma_f32_16x16x32_bf16 v[140:143], v[52:55], v[20:23], v[140:143]
  v_mfma_f32_16x16x32_bf16 v[144:147], v[116:119], v[36:39], v[144:147]
  v_mfma_f32_16x16x32_bf16 v[148:151], v[52:55], v[36:39], v[148:151]
  v_mfma_f32_16x16x32_bf16 v[152:155], v[68:71], v[36:39], v[152:155]
  v_mfma_f32_16x16x32_bf16 v[136:139], v[120:123], v[24:27], v[136:139]
  v_mfma_f32_16x16x32_bf16 v[140:143], v[56:59], v[24:27], v[140:143]
  v_mfma_f32_16x16x32_bf16 v[144:147], v[120:123], v[40:43], v[144:147]
  v_mfma_f32_16x16x32_bf16 v[148:151], v[56:59], v[40:43], v[148:151]
  v_mfma_f32_16x16x32_bf16 v[152:155], v[72:75], v[40:43], v[152:155]
  v_mfma_f32_16x16x32_bf16 v[136:139], v[124:127], v[28:31], v[136:139]
  v_mfma_f32_16x16x32_bf16 v[140:143], v[60:63], v[28:31], v[140:143]
  v_mfma_f32_16x16x32_bf16 v[144:147], v[124:127], v[44:47], v[144:147]
  v_mfma_f32_16x16x32_bf16 v[148:151], v[60:63], v[44:47], v[148:151]
  v_mfma_f32_16x16x32_bf16 v[152:155], v[76:79], v[44:47], v[152:155]
  s_nop 4
  v_cndmask_b32 v140, v6, v140, s[40:41]
  v_cndmask_b32 v141, v6, v141, s[42:43]
  v_cndmask_b32 v142, v6, v142, s[44:45]
  v_cndmask_b32 v143, v6, v143, s[46:47]
  v_max3_f32 v12, v136, v137, v140
  v_max3_f32 v12, v12, v141, v142
  v_max_f32 v12, v12, v143
  v_mov_b32 v13, v12
  s_nop 1
  v_permlane32_swap_b32 v12, v13
  v_max_f32 v12, v12, v13
  v_mov_b32 v13, v12
  s_nop 1
  v_permlane16_swap_b32 v12, v13
  v_max_f32 v12, v12, v13
  v_mul_f32 v12, s50, v12
  v_fma_f32 v136, v136, s50, -v12
  v_fma_f32 v137, v137, s50, -v12
  v_fma_f32 v140, v140, s50, -v12
  v_fma_f32 v141, v141, s50, -v12
  v_fma_f32 v142, v142, s50, -v12
  v_fma_f32 v143, v143, s50, -v12
  v_exp_f32 v136, v136
  v_exp_f32 v137, v137
  v_exp_f32 v140, v140
  v_exp_f32 v141, v141
  v_exp_f32 v142, v142
  v_exp_f32 v143, v143
  v_add_f32 v12, v136, v137
  v_add_f32 v12, v12, v140
  v_add_f32 v12, v12, v141
  v_add_f32 v12, v12, v142
  v_add_f32 v12, v12, v143
  v_mov_b32 v13, v12
  s_nop 1
  v_permlane32_swap_b32 v12, v13
  v_add_f32 v12, v12, v13
  v_mov_b32 v13, v12
  s_nop 1
  v_permlane16_swap_b32 v12, v13
  v_add_f32 v12, v12, v13
  v_rcp_f32 v12, v12
  s_nop 0
  v_mul_f32 v136, v136, v12
  v_mul_f32 v137, v137, v12
  v_mul_f32 v140, v140, v12
  v_mul_f32 v141, v141, v12
  v_mul_f32 v142, v142, v12
  v_mul_f32 v143, v143, v12
  v_cvt_pk_bf16_f32 v160, v136, v137
  v_mov_b32 v161, 0
  v_mov_b32 v162, 0
  v_mov_b32 v163, v160
  v_cvt_pk_bf16_f32 v156, v140, v141
  v_cvt_pk_bf16_f32 v157, v142, v143
  v_mov_b32 v158, 0
  v_mov_b32 v159, 0
  v_cndmask_b32 v152, v6, v152, s[40:41]
  v_cndmask_b32 v153, v6, v153, s[42:43]
  v_cndmask_b32 v154, v6, v154, s[44:45]
  v_cndmask_b32 v155, v6, v155, s[46:47]
  v_max3_f32 v12, v144, v145, v148
  v_max3_f32 v12, v12, v149, v150
  v_max3_f32 v12, v12, v151, v152
  v_max3_f32 v12, v12, v153, v154
  v_max_f32 v12, v12, v155
  v_mov_b32 v13, v12
  s_nop 1
  v_permlane32_swap_b32 v12, v13
  v_max_f32 v12, v12, v13
  v_mov_b32 v13, v12
  s_nop 1
  v_permlane16_swap_b32 v12, v13
  v_max_f32 v12, v12, v13
  v_mul_f32 v12, s50, v12
  v_fma_f32 v144, v144, s50, -v12
  v_fma_f32 v145, v145, s50, -v12
  v_fma_f32 v148, v148, s50, -v12
  v_fma_f32 v149, v149, s50, -v12
  v_fma_f32 v150, v150, s50, -v12
  v_fma_f32 v151, v151, s50, -v12
  v_fma_f32 v152, v152, s50, -v12
  v_fma_f32 v153, v153, s50, -v12
  v_fma_f32 v154, v154, s50, -v12
  v_fma_f32 v155, v155, s50, -v12
  v_exp_f32 v144, v144
  v_exp_f32 v145, v145
  v_exp_f32 v148, v148
  v_exp_f32 v149, v149
  v_exp_f32 v150, v150
  v_exp_f32 v151, v151
  v_exp_f32 v152, v152
  v_exp_f32 v153, v153
  v_exp_f32 v154, v154
  v_exp_f32 v155, v155
  v_add_f32 v12, v144, v145
  v_add_f32 v12, v12, v148
  v_add_f32 v12, v12, v149
  v_add_f32 v12, v12, v150
  v_add_f32 v12, v12, v151
  v_add_f32 v12, v12, v152
  v_add_f32 v12, v12, v153
  v_add_f32 v12, v12, v154
  v_add_f32 v12, v12, v155
  v_mov_b32 v13, v12
  s_nop 1
  v_permlane32_swap_b32 v12, v13
  v_add_f32 v12, v12, v13
  v_mov_b32 v13, v12
  s_nop 1
  v_permlane16_swap_b32 v12, v13
  v_add_f32 v12, v12, v13
  v_rcp_f32 v12, v12
  s_nop 0
  v_mul_f32 v144, v144, v12
  v_mul_f32 v145, v145, v12
  v_mul_f32 v148, v148, v12
  v_mul_f32 v149, v149, v12
  v_mul_f32 v150, v150, v12
  v_mul_f32 v151, v151, v12
  v_mul_f32 v152, v152, v12
  v_mul_f32 v153, v153, v12
  v_mul_f32 v154, v154, v12
  v_mul_f32 v155, v155, v12
  v_cvt_pk_bf16_f32 v168, v144, v145
  v_mov_b32 v169, 0
  v_mov_b32 v170, 0
  v_mov_b32 v171, v168
  v_cvt_pk_bf16_f32 v164, v148, v149
  v_cvt_pk_bf16_f32 v165, v150, v151
  v_cvt_pk_bf16_f32 v166, v152, v153
  v_cvt_pk_bf16_f32 v167, v154, v155
  v_mfma_f32_16x16x32_bf16 v[176:179], v[80:83], v[156:159], 0
  v_mfma_f32_16x16x32_bf16 v[180:183], v[84:87], v[156:159], 0
  v_mfma_f32_16x16x32_bf16 v[184:187], v[88:91], v[156:159], 0
  v_mfma_f32_16x16x32_bf16 v[188:191], v[92:95], v[156:159], 0
  v_mfma_f32_16x16x32_bf16 v[192:195], v[96:99], v[156:159], 0
  v_mfma_f32_16x16x32_bf16 v[196:199], v[100:103], v[156:159], 0
  v_mfma_f32_16x16x32_bf16 v[200:203], v[104:107], v[156:159], 0
  v_mfma_f32_16x16x32_bf16 v[204:207], v[108:111], v[156:159], 0
  v_mfma_f32_16x16x16_bf16 v[176:179], v[128:129], v[160:161], v[176:179]
  v_mfma_f32_16x16x16_bf16 v[180:183], v[128:129], v[162:163], v[180:183]
  v_mfma_f32_16x16x16_bf16 v[184:187], v[130:131], v[160:161], v[184:187]
  v_mfma_f32_16x16x16_bf16 v[188:191], v[130:131], v[162:163], v[188:191]
  v_mfma_f32_16x16x16_bf16 v[192:195], v[132:133], v[160:161], v[192:195]
  v_mfma_f32_16x16x16_bf16 v[196:199], v[132:133], v[162:163], v[196:199]
  v_mfma_f32_16x16x16_bf16 v[200:203], v[134:135], v[160:161], v[200:203]
  v_mfma_f32_16x16x16_bf16 v[204:207], v[134:135], v[162:163], v[204:207]
  v_mfma_f32_16x16x32_bf16 v[208:211], v[80:83], v[164:167], 0
  v_mfma_f32_16x16x32_bf16 v[212:215], v[84:87], v[164:167], 0
  v_mfma_f32_16x16x32_bf16 v[216:219], v[88:91], v[164:167], 0
  v_mfma_f32_16x16x32_bf16 v[220:223], v[92:95], v[164:167], 0
  v_mfma_f32_16x16x32_bf16 v[224:227], v[96:99], v[164:167], 0
  v_mfma_f32_16x16x32_bf16 v[228:231], v[100:103], v[164:167], 0
  v_mfma_f32_16x16x32_bf16 v[232:235], v[104:107], v[164:167], 0
  v_mfma_f32_16x16x32_bf16 v[236:239], v[108:111], v[164:167], 0
  v_mfma_f32_16x16x16_bf16 v[208:211], v[128:129], v[168:169], v[208:211]
  v_mfma_f32_16x16x16_bf16 v[212:215], v[128:129], v[170:171], v[212:215]
  v_mfma_f32_16x16x16_bf16 v[216:219], v[130:131], v[168:169], v[216:219]
  v_mfma_f32_16x16x16_bf16 v[220:223], v[130:131], v[170:171], v[220:223]
  v_mfma_f32_16x16x16_bf16 v[224:227], v[132:133], v[168:169], v[224:227]
  v_mfma_f32_16x16x16_bf16 v[228:231], v[132:133], v[170:171], v[228:231]
  v_mfma_f32_16x16x16_bf16 v[232:235], v[134:135], v[168:169], v[232:235]
  v_mfma_f32_16x16x16_bf16 v[236:239], v[134:135], v[170:171], v[236:239]
  buffer_load_dwordx4 v[16:19], v2, s[4:7], s94 offen offset:0 sc1
  buffer_load_dwordx4 v[20:23], v2, s[4:7], s94 offen offset:1024 sc1
  buffer_load_dwordx4 v[24:27], v2, s[4:7], s94 offen offset:2048 sc1
  buffer_load_dwordx4 v[28:31], v2, s[4:7], s94 offen offset:3072 sc1
  buffer_load_dwordx4 v[32:35], v3, s[4:7], s94 offen offset:0 sc1
  buffer_load_dwordx4 v[36:39], v3, s[4:7], s94 offen offset:1024 sc1
  buffer_load_dwordx4 v[40:43], v3, s[4:7], s94 offen offset:2048 sc1
  buffer_load_dwordx4 v[44:47], v3, s[4:7], s94 offen offset:3072 sc1
  buffer_load_dwordx4 v[48:51], v2, s[4:7], s92 offen offset:0 sc1
  buffer_load_dwordx4 v[52:55], v2, s[4:7], s92 offen offset:1024 sc1
  buffer_load_dwordx4 v[56:59], v2, s[4:7], s92 offen offset:2048 sc1
  buffer_load_dwordx4 v[60:63], v2, s[4:7], s92 offen offset:3072 sc1
  buffer_load_dwordx4 v[64:67], v3, s[4:7], s92 offen offset:0 sc1
  buffer_load_dwordx4 v[68:71], v3, s[4:7], s92 offen offset:1024 sc1
  buffer_load_dwordx4 v[72:75], v3, s[4:7], s92 offen offset:2048 sc1
  buffer_load_dwordx4 v[76:79], v3, s[4:7], s92 offen offset:3072 sc1
  buffer_load_dwordx4 v[80:83], v8, s[4:7], s93 offen offset:0 sc1
  buffer_load_dwordx4 v[84:87], v8, s[4:7], s93 offen offset:128 sc1
  buffer_load_dwordx4 v[88:91], v8, s[4:7], s93 offen offset:1024 sc1
  buffer_load_dwordx4 v[92:95], v8, s[4:7], s93 offen offset:1152 sc1
  buffer_load_dwordx4 v[96:99], v9, s[4:7], s93 offen offset:0 sc1
  buffer_load_dwordx4 v[100:103], v9, s[4:7], s93 offen offset:128 sc1
  buffer_load_dwordx4 v[104:107], v9, s[4:7], s93 offen offset:1024 sc1
  buffer_load_dwordx4 v[108:111], v9, s[4:7], s93 offen offset:1152 sc1
  buffer_load_dwordx4 v[112:115], v4, s[4:7], s91 offen offset:0 sc1
  buffer_load_dwordx4 v[116:119], v4, s[4:7], s91 offen offset:512 sc1
  buffer_load_dwordx4 v[120:123], v4, s[4:7], s91 offen offset:1024 sc1
  buffer_load_dwordx4 v[124:127], v4, s[4:7], s91 offen offset:1536 sc1
  buffer_load_dwordx4 v[128:131], v5, s[4:7], s91 offen offset:0 sc1
  buffer_load_dwordx4 v[132:135], v5, s[4:7], s91 offen offset:1024 sc1
  s_add_u32 s92, s92, 262144
  s_add_u32 s93, s93, 262144
  s_add_u32 s94, s94, 262144
  s_add_u32 s91, s91, 65536
  v_cvt_pk_bf16_f32 v136, v176, v177
  v_cvt_pk_bf16_f32 v137, v178, v179
  v_cvt_pk_bf16_f32 v138, v184, v185
  v_cvt_pk_bf16_f32 v139, v186, v187
  buffer_store_dwordx4 v[136:139], v10, s[4:7], s95 offen offset:0 sc1
  v_cvt_pk_bf16_f32 v140, v180, v181
  v_cvt_pk_bf16_f32 v141, v182, v183
  v_cvt_pk_bf16_f32 v142, v188, v189
  v_cvt_pk_bf16_f32 v143, v190, v191
  buffer_store_dwordx4 v[140:143], v10, s[4:7], s95 offen offset:512 sc1
  v_cvt_pk_bf16_f32 v144, v192, v193
  v_cvt_pk_bf16_f32 v145, v194, v195
  v_cvt_pk_bf16_f32 v146, v200, v201
  v_cvt_pk_bf16_f32 v147, v202, v203
  buffer_store_dwordx4 v[144:147], v10, s[4:7], s95 offen offset:2048 sc1
  v_cvt_pk_bf16_f32 v148, v196, v197
  v_cvt_pk_bf16_f32 v149, v198, v199
  v_cvt_pk_bf16_f32 v150, v204, v205
  v_cvt_pk_bf16_f32 v151, v206, v207
  buffer_store_dwordx4 v[148:151], v10, s[4:7], s95 offen offset:2560 sc1
  v_cvt_pk_bf16_f32 v136, v208, v209
  v_cvt_pk_bf16_f32 v137, v210, v211
  v_cvt_pk_bf16_f32 v138, v216, v217
  v_cvt_pk_bf16_f32 v139, v218, v219
  buffer_store_dwordx4 v[136:139], v11, s[4:7], s95 offen offset:0 sc1
  v_cvt_pk_bf16_f32 v140, v212, v213
  v_cvt_pk_bf16_f32 v141, v214, v215
  v_cvt_pk_bf16_f32 v142, v220, v221
  v_cvt_pk_bf16_f32 v143, v222, v223
  buffer_store_dwordx4 v[140:143], v11, s[4:7], s95 offen offset:512 sc1
  v_cvt_pk_bf16_f32 v144, v224, v225
  v_cvt_pk_bf16_f32 v145, v226, v227
  v_cvt_pk_bf16_f32 v146, v232, v233
  v_cvt_pk_bf16_f32 v147, v234, v235
  buffer_store_dwordx4 v[144:147], v11, s[4:7], s95 offen offset:2048 sc1
  v_cvt_pk_bf16_f32 v148, v228, v229
  v_cvt_pk_bf16_f32 v149, v230, v231
  v_cvt_pk_bf16_f32 v150, v236, v237
  v_cvt_pk_bf16_f32 v151, v238, v239
  buffer_store_dwordx4 v[148:151], v11, s[4:7], s95 offen offset:2560 sc1
  s_add_u32 s95, s95, 262144
  s_waitcnt vmcnt(38)
  v_mfma_f32_16x16x32_bf16 v[136:139], a[96:99], a[0:3], 0
  v_mfma_f32_16x16x32_bf16 v[140:143], a[32:35], a[0:3], 0
  v_mfma_f32_16x16x32_bf16 v[144:147], a[96:99], a[16:19], 0
  v_mfma_f32_16x16x32_bf16 v[148:151], a[32:35], a[16:19], 0
  v_mfma_f32_16x16x32_bf16 v[152:155], a[48:51], a[16:19], 0
  v_mfma_f32_16x16x32_bf16 v[136:139], a[100:103], a[4:7], v[136:139]
  v_mfma_f32_16x16x32_bf16 v[140:143], a[36:39], a[4:7], v[140:143]
  v_mfma_f32_16x16x32_bf16 v[144:147], a[100:103], a[20:23], v[144:147]
  v_mfma_f32_16x16x32_bf16 v[148:151], a[36:39], a[20:23], v[148:151]
  v_mfma_f32_16x16x32_bf16 v[152:155], a[52:55], a[20:23], v[152:155]
  v_mfma_f32_16x16x32_bf16 v[136:139], a[104:107], a[8:11], v[136:139]
  v_mfma_f32_16x16x32_bf16 v[140:143], a[40:43], a[8:11], v[140:143]
  v_mfma_f32_16x16x32_bf16 v[144:147], a[104:107], a[24:27], v[144:147]
  v_mfma_f32_16x16x32_bf16 v[148:151], a[40:43], a[24:27], v[148:151]
  v_mfma_f32_16x16x32_bf16 v[152:155], a[56:59], a[24:27], v[152:155]
  v_mfma_f32_16x16x32_bf16 v[136:139], a[108:111], a[12:15], v[136:139]
  v_mfma_f32_16x16x32_bf16 v[140:143], a[44:47], a[12:15], v[140:143]
  v_mfma_f32_16x16x32_bf16 v[144:147], a[108:111], a[28:31], v[144:147]
  v_mfma_f32_16x16x32_bf16 v[148:151], a[44:47], a[28:31], v[148:151]
  v_mfma_f32_16x16x32_bf16 v[152:155], a[60:63], a[28:31], v[152:155]
  s_nop 4
  v_cndmask_b32 v140, v6, v140, s[40:41]
  v_cndmask_b32 v141, v6, v141, s[42:43]
  v_cndmask_b32 v142, v6, v142, s[44:45]
  v_cndmask_b32 v143, v6, v143, s[46:47]
  v_max3_f32 v12, v136, v137, v140
  v_max3_f32 v12, v12, v141, v142
  v_max_f32 v12, v12, v143
  v_mov_b32 v13, v12
  s_nop 1
  v_permlane32_swap_b32 v12, v13
  v_max_f32 v12, v12, v13
  v_mov_b32 v13, v12
  s_nop 1
  v_permlane16_swap_b32 v12, v13
  v_max_f32 v12, v12, v13
  v_mul_f32 v12, s50, v12
  v_fma_f32 v136, v136, s50, -v12
  v_fma_f32 v137, v137, s50, -v12
  v_fma_f32 v140, v140, s50, -v12
  v_fma_f32 v141, v141, s50, -v12
  v_fma_f32 v142, v142, s50, -v12
  v_fma_f32 v143, v143, s50, -v12
  v_exp_f32 v136, v136
  v_exp_f32 v137, v137
  v_exp_f32 v140, v140
  v_exp_f32 v141, v141
  v_exp_f32 v142, v142
  v_exp_f32 v143, v143
  v_add_f32 v12, v136, v137
  v_add_f32 v12, v12, v140
  v_add_f32 v12, v12, v141
  v_add_f32 v12, v12, v142
  v_add_f32 v12, v12, v143
  v_mov_b32 v13, v12
  s_nop 1
  v_permlane32_swap_b32 v12, v13
  v_add_f32 v12, v12, v13
  v_mov_b32 v13, v12
  s_nop 1
  v_permlane16_swap_b32 v12, v13
  v_add_f32 v12, v12, v13
  v_rcp_f32 v12, v12
  s_nop 0
  v_mul_f32 v136, v136, v12
  v_mul_f32 v137, v137, v12
  v_mul_f32 v140, v140, v12
  v_mul_f32 v141, v141, v12
  v_mul_f32 v142, v142, v12
  v_mul_f32 v143, v143, v12
  v_cvt_pk_bf16_f32 v160, v136, v137
  v_mov_b32 v161, 0
  v_mov_b32 v162, 0
  v_mov_b32 v163, v160
  v_cvt_pk_bf16_f32 v156, v140, v141
  v_cvt_pk_bf16_f32 v157, v142, v143
  v_mov_b32 v158, 0
  v_mov_b32 v159, 0
  v_cndmask_b32 v152, v6, v152, s[40:41]
  v_cndmask_b32 v153, v6, v153, s[42:43]
  v_cndmask_b32 v154, v6, v154, s[44:45]
  v_cndmask_b32 v155, v6, v155, s[46:47]
  v_max3_f32 v12, v144, v145, v148
  v_max3_f32 v12, v12, v149, v150
  v_max3_f32 v12, v12, v151, v152
  v_max3_f32 v12, v12, v153, v154
  v_max_f32 v12, v12, v155
  v_mov_b32 v13, v12
  s_nop 1
  v_permlane32_swap_b32 v12, v13
  v_max_f32 v12, v12, v13
  v_mov_b32 v13, v12
  s_nop 1
  v_permlane16_swap_b32 v12, v13
  v_max_f32 v12, v12, v13
  v_mul_f32 v12, s50, v12
  v_fma_f32 v144, v144, s50, -v12
  v_fma_f32 v145, v145, s50, -v12
  v_fma_f32 v148, v148, s50, -v12
  v_fma_f32 v149, v149, s50, -v12
  v_fma_f32 v150, v150, s50, -v12
  v_fma_f32 v151, v151, s50, -v12
  v_fma_f32 v152, v152, s50, -v12
  v_fma_f32 v153, v153, s50, -v12
  v_fma_f32 v154, v154, s50, -v12
  v_fma_f32 v155, v155, s50, -v12
  v_exp_f32 v144, v144
  v_exp_f32 v145, v145
  v_exp_f32 v148, v148
  v_exp_f32 v149, v149
  v_exp_f32 v150, v150
  v_exp_f32 v151, v151
  v_exp_f32 v152, v152
  v_exp_f32 v153, v153
  v_exp_f32 v154, v154
  v_exp_f32 v155, v155
  v_add_f32 v12, v144, v145
  v_add_f32 v12, v12, v148
  v_add_f32 v12, v12, v149
  v_add_f32 v12, v12, v150
  v_add_f32 v12, v12, v151
  v_add_f32 v12, v12, v152
  v_add_f32 v12, v12, v153
  v_add_f32 v12, v12, v154
  v_add_f32 v12, v12, v155
  v_mov_b32 v13, v12
  s_nop 1
  v_permlane32_swap_b32 v12, v13
  v_add_f32 v12, v12, v13
  v_mov_b32 v13, v12
  s_nop 1
  v_permlane16_swap_b32 v12, v13
  v_add_f32 v12, v12, v13
  v_rcp_f32 v12, v12
  s_nop 0
  v_mul_f32 v144, v144, v12
  v_mul_f32 v145, v145, v12
  v_mul_f32 v148, v148, v12
  v_mul_f32 v149, v149, v12
  v_mul_f32 v150, v150, v12
  v_mul_f32 v151, v151, v12
  v_mul_f32 v152, v152, v12
  v_mul_f32 v153, v153, v12
  v_mul_f32 v154, v154, v12
  v_mul_f32 v155, v155, v12
  v_cvt_pk_bf16_f32 v168, v144, v145
  v_mov_b32 v169, 0
  v_mov_b32 v170, 0
  v_mov_b32 v171, v168
  v_cvt_pk_bf16_f32 v164, v148, v149
  v_cvt_pk_bf16_f32 v165, v150, v151
  v_cvt_pk_bf16_f32 v166, v152, v153
  v_cvt_pk_bf16_f32 v167, v154, v155
  v_mfma_f32_16x16x32_bf16 v[176:179], a[64:67], v[156:159], 0
  v_mfma_f32_16x16x32_bf16 v[180:183], a[68:71], v[156:159], 0
  v_mfma_f32_16x16x32_bf16 v[184:187], a[72:75], v[156:159], 0
  v_mfma_f32_16x16x32_bf16 v[188:191], a[76:79], v[156:159], 0
  v_mfma_f32_16x16x32_bf16 v[192:195], a[80:83], v[156:159], 0
  v_mfma_f32_16x16x32_bf16 v[196:199], a[84:87], v[156:159], 0
  v_mfma_f32_16x16x32_bf16 v[200:203], a[88:91], v[156:159], 0
  v_mfma_f32_16x16x32_bf16 v[204:207], a[92:95], v[156:159], 0
  v_mfma_f32_16x16x16_bf16 v[176:179], a[112:113], v[160:161], v[176:179]
  v_mfma_f32_16x16x16_bf16 v[180:183], a[112:113], v[162:163], v[180:183]
  v_mfma_f32_16x16x16_bf16 v[184:187], a[114:115], v[160:161], v[184:187]
  v_mfma_f32_16x16x16_bf16 v[188:191], a[114:115], v[162:163], v[188:191]
  v_mfma_f32_16x16x16_bf16 v[192:195], a[116:117], v[160:161], v[192:195]
  v_mfma_f32_16x16x16_bf16 v[196:199], a[116:117], v[162:163], v[196:199]
  v_mfma_f32_16x16x16_bf16 v[200:203], a[118:119], v[160:161], v[200:203]
  v_mfma_f32_16x16x16_bf16 v[204:207], a[118:119], v[162:163], v[204:207]
  v_mfma_f32_16x16x32_bf16 v[208:211], a[64:67], v[164:167], 0
  v_mfma_f32_16x16x32_bf16 v[212:215], a[68:71], v[164:167], 0
  v_mfma_f32_16x16x32_bf16 v[216:219], a[72:75], v[164:167], 0
  v_mfma_f32_16x16x32_bf16 v[220:223], a[76:79], v[164:167], 0
  v_mfma_f32_16x16x32_bf16 v[224:227], a[80:83], v[164:167], 0
  v_mfma_f32_16x16x32_bf16 v[228:231], a[84:87], v[164:167], 0
  v_mfma_f32_16x16x32_bf16 v[232:235], a[88:91], v[164:167], 0
  v_mfma_f32_16x16x32_bf16 v[236:239], a[92:95], v[164:167], 0
  v_mfma_f32_16x16x16_bf16 v[208:211], a[112:113], v[168:169], v[208:211]
  v_mfma_f32_16x16x16_bf16 v[212:215], a[112:113], v[170:171], v[212:215]
  v_mfma_f32_16x16x16_bf16 v[216:219], a[114:115], v[168:169], v[216:219]
  v_mfma_f32_16x16x16_bf16 v[220:223], a[114:115], v[170:171], v[220:223]
  v_mfma_f32_16x16x16_bf16 v[224:227], a[116:117], v[168:169], v[224:227]
  v_mfma_f32_16x16x16_bf16 v[228:231], a[116:117], v[170:171], v[228:231]
  v_mfma_f32_16x16x16_bf16 v[232:235], a[118:119], v[168:169], v[232:235]
  v_mfma_f32_16x16x16_bf16 v[236:239], a[118:119], v[170:171], v[236:239]
  buffer_load_dwordx4 a[0:3], v2, s[4:7], s94 offen offset:0 sc1
  buffer_load_dwordx4 a[4:7], v2, s[4:7], s94 offen offset:1024 sc1
  buffer_load_dwordx4 a[8:11], v2, s[4:7], s94 offen offset:2048 sc1
  buffer_load_dwordx4 a[12:15], v2, s[4:7], s94 offen offset:3072 sc1
  buffer_load_dwordx4 a[16:19], v3, s[4:7], s94 offen offset:0 sc1
  buffer_load_dwordx4 a[20:23], v3, s[4:7], s94 offen offset:1024 sc1
  buffer_load_dwordx4 a[24:27], v3, s[4:7], s94 offen offset:2048 sc1
  buffer_load_dwordx4 a[28:31], v3, s[4:7], s94 offen offset:3072 sc1
  buffer_load_dwordx4 a[32:35], v2, s[4:7], s92 offen offset:0 sc1
  buffer_load_dwordx4 a[36:39], v2, s[4:7], s92 offen offset:1024 sc1
  buffer_load_dwordx4 a[40:43], v2, s[4:7], s92 offen offset:2048 sc1
  buffer_load_dwordx4 a[44:47], v2, s[4:7], s92 offen offset:3072 sc1
  buffer_load_dwordx4 a[48:51], v3, s[4:7], s92 offen offset:0 sc1
  buffer_load_dwordx4 a[52:55], v3, s[4:7], s92 offen offset:1024 sc1
  buffer_load_dwordx4 a[56:59], v3, s[4:7], s92 offen offset:2048 sc1
  buffer_load_dwordx4 a[60:63], v3, s[4:7], s92 offen offset:3072 sc1
  buffer_load_dwordx4 a[64:67], v8, s[4:7], s93 offen offset:0 sc1
  buffer_load_dwordx4 a[68:71], v8, s[4:7], s93 offen offset:128 sc1
  buffer_load_dwordx4 a[72:75], v8, s[4:7], s93 offen offset:1024 sc1
  buffer_load_dwordx4 a[76:79], v8, s[4:7], s93 offen offset:1152 sc1
  buffer_load_dwordx4 a[80:83], v9, s[4:7], s93 offen offset:0 sc1
  buffer_load_dwordx4 a[84:87], v9, s[4:7], s93 offen offset:128 sc1
  buffer_load_dwordx4 a[88:91], v9, s[4:7], s93 offen offset:1024 sc1
  buffer_load_dwordx4 a[92:95], v9, s[4:7], s93 offen offset:1152 sc1
  buffer_load_dwordx4 a[96:99], v4, s[4:7], s91 offen offset:0 sc1
  buffer_load_dwordx4 a[100:103], v4, s[4:7], s91 offen offset:512 sc1
  buffer_load_dwordx4 a[104:107], v4, s[4:7], s91 offen offset:1024 sc1
  buffer_load_dwordx4 a[108:111], v4, s[4:7], s91 offen offset:1536 sc1
  buffer_load_dwordx4 a[112:115], v5, s[4:7], s91 offen offset:0 sc1
  buffer_load_dwordx4 a[116:119], v5, s[4:7], s91 offen offset:1024 sc1
  s_add_u32 s92, s92, 262144
  s_add_u32 s93, s93, 262144
  s_add_u32 s94, s94, 262144
  s_add_u32 s91, s91, 65536
  v_cvt_pk_bf16_f32 v136, v176, v177
  v_cvt_pk_bf16_f32 v137, v178, v179
  v_cvt_pk_bf16_f32 v138, v184, v185
  v_cvt_pk_bf16_f32 v139, v186, v187
  buffer_store_dwordx4 v[136:139], v10, s[4:7], s95 offen offset:0 sc1
  v_cvt_pk_bf16_f32 v140, v180, v181
  v_cvt_pk_bf16_f32 v141, v182, v183
  v_cvt_pk_bf16_f32 v142, v188, v189
  v_cvt_pk_bf16_f32 v143, v190, v191
  buffer_store_dwordx4 v[140:143], v10, s[4:7], s95 offen offset:512 sc1
  v_cvt_pk_bf16_f32 v144, v192, v193
  v_cvt_pk_bf16_f32 v145, v194, v195
  v_cvt_pk_bf16_f32 v146, v200, v201
  v_cvt_pk_bf16_f32 v147, v202, v203
  buffer_store_dwordx4 v[144:147], v10, s[4:7], s95 offen offset:2048 sc1
  v_cvt_pk_bf16_f32 v148, v196, v197
  v_cvt_pk_bf16_f32 v149, v198, v199
  v_cvt_pk_bf16_f32 v150, v204, v205
  v_cvt_pk_bf16_f32 v151, v206, v207
  buffer_store_dwordx4 v[148:151], v10, s[4:7], s95 offen offset:2560 sc1
  v_cvt_pk_bf16_f32 v136, v208, v209
  v_cvt_pk_bf16_f32 v137, v210, v211
  v_cvt_pk_bf16_f32 v138, v216, v217
  v_cvt_pk_bf16_f32 v139, v218, v219
  buffer_store_dwordx4 v[136:139], v11, s[4:7], s95 offen offset:0 sc1
  v_cvt_pk_bf16_f32 v140, v212, v213
  v_cvt_pk_bf16_f32 v141, v214, v215
  v_cvt_pk_bf16_f32 v142, v220, v221
  v_cvt_pk_bf16_f32 v143, v222, v223
  buffer_store_dwordx4 v[140:143], v11, s[4:7], s95 offen offset:512 sc1
  v_cvt_pk_bf16_f32 v144, v224, v225
  v_cvt_pk_bf16_f32 v145, v226, v227
  v_cvt_pk_bf16_f32 v146, v232, v233
  v_cvt_pk_bf16_f32 v147, v234, v235
  buffer_store_dwordx4 v[144:147], v11, s[4:7], s95 offen offset:2048 sc1
  v_cvt_pk_bf16_f32 v148, v228, v229
  v_cvt_pk_bf16_f32 v149, v230, v231
  v_cvt_pk_bf16_f32 v150, v236, v237
  v_cvt_pk_bf16_f32 v151, v238, v239
  buffer_store_dwordx4 v[148:151], v11, s[4:7], s95 offen offset:2560 sc1
  s_add_u32 s95, s95, 262144
  s_waitcnt vmcnt(46)
  v_mfma_f32_16x16x32_bf16 v[136:139], v[112:115], v[16:19], 0
  v_mfma_f32_16x16x32_bf16 v[140:143], v[48:51], v[16:19], 0
  v_mfma_f32_16x16x32_bf16 v[144:147], v[112:115], v[32:35], 0
  v_mfma_f32_16x16x32_bf16 v[148:151], v[48:51], v[32:35], 0
  v_mfma_f32_16x16x32_bf16 v[152:155], v[64:67], v[32:35], 0
  v_mfma_f32_16x16x32_bf16 v[136:139], v[116:119], v[20:23], v[136:139]
  v_mfma_f32_16x16x32_bf16 v[140:143], v[52:55], v[20:23], v[140:143]
  v_mfma_f32_16x16x32_bf16 v[144:147], v[116:119], v[36:39], v[144:147]
  v_mfma_f32_16x16x32_bf16 v[148:151], v[52:55], v[36:39], v[148:151]
  v_mfma_f32_16x16x32_bf16 v[152:155], v[68:71], v[36:39], v[152:155]
  v_mfma_f32_16x16x32_bf16 v[136:139], v[120:123], v[24:27], v[136:139]
  v_mfma_f32_16x16x32_bf16 v[140:143], v[56:59], v[24:27], v[140:143]
  v_mfma_f32_16x16x32_bf16 v[144:147], v[120:123], v[40:43], v[144:147]
  v_mfma_f32_16x16x32_bf16 v[148:151], v[56:59], v[40:43], v[148:151]
  v_mfma_f32_16x16x32_bf16 v[152:155], v[72:75], v[40:43], v[152:155]
  v_mfma_f32_16x16x32_bf16 v[136:139], v[124:127], v[28:31], v[136:139]
  v_mfma_f32_16x16x32_bf16 v[140:143], v[60:63], v[28:31], v[140:143]
  v_mfma_f32_16x16x32_bf16 v[144:147], v[124:127], v[44:47], v[144:147]
  v_mfma_f32_16x16x32_bf16 v[148:151], v[60:63], v[44:47], v[148:151]
  v_mfma_f32_16x16x32_bf16 v[152:155], v[76:79], v[44:47], v[152:155]
  s_nop 4
  v_cndmask_b32 v140, v6, v140, s[40:41]
  v_cndmask_b32 v141, v6, v141, s[42:43]
  v_cndmask_b32 v142, v6, v142, s[44:45]
  v_cndmask_b32 v143, v6, v143, s[46:47]
  v_max3_f32 v12, v136, v137, v140
  v_max3_f32 v12, v12, v141, v142
  v_max_f32 v12, v12, v143
  v_mov_b32 v13, v12
  s_nop 1
  v_permlane32_swap_b32 v12, v13
  v_max_f32 v12, v12, v13
  v_mov_b32 v13, v12
  s_nop 1
  v_permlane16_swap_b32 v12, v13
  v_max_f32 v12, v12, v13
  v_mul_f32 v12, s50, v12
  v_fma_f32 v136, v136, s50, -v12
  v_fma_f32 v137, v137, s50, -v12
  v_fma_f32 v140, v140, s50, -v12
  v_fma_f32 v141, v141, s50, -v12
  v_fma_f32 v142, v142, s50, -v12
  v_fma_f32 v143, v143, s50, -v12
  v_exp_f32 v136, v136
  v_exp_f32 v137, v137
  v_exp_f32 v140, v140
  v_exp_f32 v141, v141
  v_exp_f32 v142, v142
  v_exp_f32 v143, v143
  v_add_f32 v12, v136, v137
  v_add_f32 v12, v12, v140
  v_add_f32 v12, v12, v141
  v_add_f32 v12, v12, v142
  v_add_f32 v12, v12, v143
  v_mov_b32 v13, v12
  s_nop 1
  v_permlane32_swap_b32 v12, v13
  v_add_f32 v12, v12, v13
  v_mov_b32 v13, v12
  s_nop 1
  v_permlane16_swap_b32 v12, v13
  v_add_f32 v12, v12, v13
  v_rcp_f32 v12, v12
  s_nop 0
  v_mul_f32 v136, v136, v12
  v_mul_f32 v137, v137, v12
  v_mul_f32 v140, v140, v12
  v_mul_f32 v141, v141, v12
  v_mul_f32 v142, v142, v12
  v_mul_f32 v143, v143, v12
  v_cvt_pk_bf16_f32 v160, v136, v137
  v_mov_b32 v161, 0
  v_mov_b32 v162, 0
  v_mov_b32 v163, v160
  v_cvt_pk_bf16_f32 v156, v140, v141
  v_cvt_pk_bf16_f32 v157, v142, v143
  v_mov_b32 v158, 0
  v_mov_b32 v159, 0
  v_cndmask_b32 v152, v6, v152, s[40:41]
  v_cndmask_b32 v153, v6, v153, s[42:43]
  v_cndmask_b32 v154, v6, v154, s[44:45]
  v_cndmask_b32 v155, v6, v155, s[46:47]
  v_max3_f32 v12, v144, v145, v148
  v_max3_f32 v12, v12, v149, v150
  v_max3_f32 v12, v12, v151, v152
  v_max3_f32 v12, v12, v153, v154
  v_max_f32 v12, v12, v155
  v_mov_b32 v13, v12
  s_nop 1
  v_permlane32_swap_b32 v12, v13
  v_max_f32 v12, v12, v13
  v_mov_b32 v13, v12
  s_nop 1
  v_permlane16_swap_b32 v12, v13
  v_max_f32 v12, v12, v13
  v_mul_f32 v12, s50, v12
  v_fma_f32 v144, v144, s50, -v12
  v_fma_f32 v145, v145, s50, -v12
  v_fma_f32 v148, v148, s50, -v12
  v_fma_f32 v149, v149, s50, -v12
  v_fma_f32 v150, v150, s50, -v12
  v_fma_f32 v151, v151, s50, -v12
  v_fma_f32 v152, v152, s50, -v12
  v_fma_f32 v153, v153, s50, -v12
  v_fma_f32 v154, v154, s50, -v12
  v_fma_f32 v155, v155, s50, -v12
  v_exp_f32 v144, v144
  v_exp_f32 v145, v145
  v_exp_f32 v148, v148
  v_exp_f32 v149, v149
  v_exp_f32 v150, v150
  v_exp_f32 v151, v151
  v_exp_f32 v152, v152
  v_exp_f32 v153, v153
  v_exp_f32 v154, v154
  v_exp_f32 v155, v155
  v_add_f32 v12, v144, v145
  v_add_f32 v12, v12, v148
  v_add_f32 v12, v12, v149
  v_add_f32 v12, v12, v150
  v_add_f32 v12, v12, v151
  v_add_f32 v12, v12, v152
  v_add_f32 v12, v12, v153
  v_add_f32 v12, v12, v154
  v_add_f32 v12, v12, v155
  v_mov_b32 v13, v12
  s_nop 1
  v_permlane32_swap_b32 v12, v13
  v_add_f32 v12, v12, v13
  v_mov_b32 v13, v12
  s_nop 1
  v_permlane16_swap_b32 v12, v13
  v_add_f32 v12, v12, v13
  v_rcp_f32 v12, v12
  s_nop 0
  v_mul_f32 v144, v144, v12
  v_mul_f32 v145, v145, v12
  v_mul_f32 v148, v148, v12
  v_mul_f32 v149, v149, v12
  v_mul_f32 v150, v150, v12
  v_mul_f32 v151, v151, v12
  v_mul_f32 v152, v152, v12
  v_mul_f32 v153, v153, v12
  v_mul_f32 v154, v154, v12
  v_mul_f32 v155, v155, v12
  v_cvt_pk_bf16_f32 v168, v144, v145
  v_mov_b32 v169, 0
  v_mov_b32 v170, 0
  v_mov_b32 v171, v168
  v_cvt_pk_bf16_f32 v164, v148, v149
  v_cvt_pk_bf16_f32 v165, v150, v151
  v_cvt_pk_bf16_f32 v166, v152, v153
  v_cvt_pk_bf16_f32 v167, v154, v155
  v_mfma_f32_16x16x32_bf16 v[176:179], v[80:83], v[156:159], 0
  v_mfma_f32_16x16x32_bf16 v[180:183], v[84:87], v[156:159], 0
  v_mfma_f32_16x16x32_bf16 v[184:187], v[88:91], v[156:159], 0
  v_mfma_f32_16x16x32_bf16 v[188:191], v[92:95], v[156:159], 0
  v_mfma_f32_16x16x32_bf16 v[192:195], v[96:99], v[156:159], 0
  v_mfma_f32_16x16x32_bf16 v[196:199], v[100:103], v[156:159], 0
  v_mfma_f32_16x16x32_bf16 v[200:203], v[104:107], v[156:159], 0
  v_mfma_f32_16x16x32_bf16 v[204:207], v[108:111], v[156:159], 0
  v_mfma_f32_16x16x16_bf16 v[176:179], v[128:129], v[160:161], v[176:179]
  v_mfma_f32_16x16x16_bf16 v[180:183], v[128:129], v[162:163], v[180:183]
  v_mfma_f32_16x16x16_bf16 v[184:187], v[130:131], v[160:161], v[184:187]
  v_mfma_f32_16x16x16_bf16 v[188:191], v[130:131], v[162:163], v[188:191]
  v_mfma_f32_16x16x16_bf16 v[192:195], v[132:133], v[160:161], v[192:195]
  v_mfma_f32_16x16x16_bf16 v[196:199], v[132:133], v[162:163], v[196:199]
  v_mfma_f32_16x16x16_bf16 v[200:203], v[134:135], v[160:161], v[200:203]
  v_mfma_f32_16x16x16_bf16 v[204:207], v[134:135], v[162:163], v[204:207]
  v_mfma_f32_16x16x32_bf16 v[208:211], v[80:83], v[164:167], 0
  v_mfma_f32_16x16x32_bf16 v[212:215], v[84:87], v[164:167], 0
  v_mfma_f32_16x16x32_bf16 v[216:219], v[88:91], v[164:167], 0
  v_mfma_f32_16x16x32_bf16 v[220:223], v[92:95], v[164:167], 0
  v_mfma_f32_16x16x32_bf16 v[224:227], v[96:99], v[164:167], 0
  v_mfma_f32_16x16x32_bf16 v[228:231], v[100:103], v[164:167], 0
  v_mfma_f32_16x16x32_bf16 v[232:235], v[104:107], v[164:167], 0
  v_mfma_f32_16x16x32_bf16 v[236:239], v[108:111], v[164:167], 0
  v_mfma_f32_16x16x16_bf16 v[208:211], v[128:129], v[168:169], v[208:211]
  v_mfma_f32_16x16x16_bf16 v[212:215], v[128:129], v[170:171], v[212:215]
  v_mfma_f32_16x16x16_bf16 v[216:219], v[130:131], v[168:169], v[216:219]
  v_mfma_f32_16x16x16_bf16 v[220:223], v[130:131], v[170:171], v[220:223]
  v_mfma_f32_16x16x16_bf16 v[224:227], v[132:133], v[168:169], v[224:227]
  v_mfma_f32_16x16x16_bf16 v[228:231], v[132:133], v[170:171], v[228:231]
  v_mfma_f32_16x16x16_bf16 v[232:235], v[134:135], v[168:169], v[232:235]
  v_mfma_f32_16x16x16_bf16 v[236:239], v[134:135], v[170:171], v[236:239]
  v_cvt_pk_bf16_f32 v136, v176, v177
  v_cvt_pk_bf16_f32 v137, v178, v179
  v_cvt_pk_bf16_f32 v138, v184, v185
  v_cvt_pk_bf16_f32 v139, v186, v187
  buffer_store_dwordx4 v[136:139], v10, s[4:7], s95 offen offset:0 sc1
  v_cvt_pk_bf16_f32 v140, v180, v181
  v_cvt_pk_bf16_f32 v141, v182, v183
  v_cvt_pk_bf16_f32 v142, v188, v189
  v_cvt_pk_bf16_f32 v143, v190, v191
  buffer_store_dwordx4 v[140:143], v10, s[4:7], s95 offen offset:512 sc1
  v_cvt_pk_bf16_f32 v144, v192, v193
  v_cvt_pk_bf16_f32 v145, v194, v195
  v_cvt_pk_bf16_f32 v146, v200, v201
  v_cvt_pk_bf16_f32 v147, v202, v203
  buffer_store_dwordx4 v[144:147], v10, s[4:7], s95 offen offset:2048 sc1
  v_cvt_pk_bf16_f32 v148, v196, v197
  v_cvt_pk_bf16_f32 v149, v198, v199
  v_cvt_pk_bf16_f32 v150, v204, v205
  v_cvt_pk_bf16_f32 v151, v206, v207
  buffer_store_dwordx4 v[148:151], v10, s[4:7], s95 offen offset:2560 sc1
  v_cvt_pk_bf16_f32 v136, v208, v209
  v_cvt_pk_bf16_f32 v137, v210, v211
  v_cvt_pk_bf16_f32 v138, v216, v217
  v_cvt_pk_bf16_f32 v139, v218, v219
  buffer_store_dwordx4 v[136:139], v11, s[4:7], s95 offen offset:0 sc1
  v_cvt_pk_bf16_f32 v140, v212, v213
  v_cvt_pk_bf16_f32 v141, v214, v215
  v_cvt_pk_bf16_f32 v142, v220, v221
  v_cvt_pk_bf16_f32 v143, v222, v223
  buffer_store_dwordx4 v[140:143], v11, s[4:7], s95 offen offset:512 sc1
  v_cvt_pk_bf16_f32 v144, v224, v225
  v_cvt_pk_bf16_f32 v145, v226, v227
  v_cvt_pk_bf16_f32 v146, v232, v233
  v_cvt_pk_bf16_f32 v147, v234, v235
  buffer_store_dwordx4 v[144:147], v11, s[4:7], s95 offen offset:2048 sc1
  v_cvt_pk_bf16_f32 v148, v228, v229
  v_cvt_pk_bf16_f32 v149, v230, v231
  v_cvt_pk_bf16_f32 v150, v236, v237
  v_cvt_pk_bf16_f32 v151, v238, v239
  buffer_store_dwordx4 v[148:151], v11, s[4:7], s95 offen offset:2560 sc1
  s_add_u32 s95, s95, 262144
  s_waitcnt vmcnt(16)
  s_cmp_lg_u32 s32, 0
  s_cbranch_scc1 L_rq_97
  s_cmp_eq_u32 s39, 0
  s_cbranch_scc1 L_rq_97
  s_lshl_b32 s99, s33, 7
  s_add_u32 s99, s99, 0x3d00200
  v_mov_b32 v244, 1
  v_mov_b32 v245, 0
  s_mov_b64 exec, 1
  buffer_atomic_add v244, v245, s[4:7], s99 offen sc0 sc1
  s_mov_b64 exec, -1
L_rq_97:
  v_mfma_f32_16x16x32_bf16 v[136:139], a[96:99], a[0:3], 0
  v_mfma_f32_16x16x32_bf16 v[140:143], a[32:35], a[0:3], 0
  v_mfma_f32_16x16x32_bf16 v[144:147], a[96:99], a[16:19], 0
  v_mfma_f32_16x16x32_bf16 v[148:151], a[32:35], a[16:19], 0
  v_mfma_f32_16x16x32_bf16 v[152:155], a[48:51], a[16:19], 0
  v_mfma_f32_16x16x32_bf16 v[136:139], a[100:103], a[4:7], v[136:139]
  v_mfma_f32_16x16x32_bf16 v[140:143], a[36:39], a[4:7], v[140:143]
  v_mfma_f32_16x16x32_bf16 v[144:147], a[100:103], a[20:23], v[144:147]
  v_mfma_f32_16x16x32_bf16 v[148:151], a[36:39], a[20:23], v[148:151]
  v_mfma_f32_16x16x32_bf16 v[152:155], a[52:55], a[20:23], v[152:155]
  v_mfma_f32_16x16x32_bf16 v[136:139], a[104:107], a[8:11], v[136:139]
  v_mfma_f32_16x16x32_bf16 v[140:143], a[40:43], a[8:11], v[140:143]
  v_mfma_f32_16x16x32_bf16 v[144:147], a[104:107], a[24:27], v[144:147]
  v_mfma_f32_16x16x32_bf16 v[148:151], a[40:43], a[24:27], v[148:151]
  v_mfma_f32_16x16x32_bf16 v[152:155], a[56:59], a[24:27], v[152:155]
  v_mfma_f32_16x16x32_bf16 v[136:139], a[108:111], a[12:15], v[136:139]
  v_mfma_f32_16x16x32_bf16 v[140:143], a[44:47], a[12:15], v[140:143]
  v_mfma_f32_16x16x32_bf16 v[144:147], a[108:111], a[28:31], v[144:147]
  v_mfma_f32_16x16x32_bf16 v[148:151], a[44:47], a[28:31], v[148:151]
  v_mfma_f32_16x16x32_bf16 v[152:155], a[60:63], a[28:31], v[152:155]
  s_nop 4
  v_cndmask_b32 v140, v6, v140, s[40:41]
  v_cndmask_b32 v141, v6, v141, s[42:43]
  v_cndmask_b32 v142, v6, v142, s[44:45]
  v_cndmask_b32 v143, v6, v143, s[46:47]
  v_max3_f32 v12, v136, v137, v140
  v_max3_f32 v12, v12, v141, v142
  v_max_f32 v12, v12, v143
  v_mov_b32 v13, v12
  s_nop 1
  v_permlane32_swap_b32 v12, v13
  v_max_f32 v12, v12, v13
  v_mov_b32 v13, v12
  s_nop 1
  v_permlane16_swap_b32 v12, v13
  v_max_f32 v12, v12, v13
  v_mul_f32 v12, s50, v12
  v_fma_f32 v136, v136, s50, -v12
  v_fma_f32 v137, v137, s50, -v12
  v_fma_f32 v140, v140, s50, -v12
  v_fma_f32 v141, v141, s50, -v12
  v_fma_f32 v142, v142, s50, -v12
  v_fma_f32 v143, v143, s50, -v12
  v_exp_f32 v136, v136
  v_exp_f32 v137, v137
  v_exp_f32 v140, v140
  v_exp_f32 v141, v141
  v_exp_f32 v142, v142
  v_exp_f32 v143, v143
  v_add_f32 v12, v136, v137
  v_add_f32 v12, v12, v140
  v_add_f32 v12, v12, v141
  v_add_f32 v12, v12, v142
  v_add_f32 v12, v12, v143
  v_mov_b32 v13, v12
  s_nop 1
  v_permlane32_swap_b32 v12, v13
  v_add_f32 v12, v12, v13
  v_mov_b32 v13, v12
  s_nop 1
  v_permlane16_swap_b32 v12, v13
  v_add_f32 v12, v12, v13
  v_rcp_f32 v12, v12
  s_nop 0
  v_mul_f32 v136, v136, v12
  v_mul_f32 v137, v137, v12
  v_mul_f32 v140, v140, v12
  v_mul_f32 v141, v141, v12
  v_mul_f32 v142, v142, v12
  v_mul_f32 v143, v143, v12
  v_cvt_pk_bf16_f32 v160, v136, v137
  v_mov_b32 v161, 0
  v_mov_b32 v162, 0
  v_mov_b32 v163, v160
  v_cvt_pk_bf16_f32 v156, v140, v141
  v_cvt_pk_bf16_f32 v157, v142, v143
  v_mov_b32 v158, 0
  v_mov_b32 v159, 0
  v_cndmask_b32 v152, v6, v152, s[40:41]
  v_cndmask_b32 v153, v6, v153, s[42:43]
  v_cndmask_b32 v154, v6, v154, s[44:45]
  v_cndmask_b32 v155, v6, v155, s[46:47]
  v_max3_f32 v12, v144, v145, v148
  v_max3_f32 v12, v12, v149, v150
  v_max3_f32 v12, v12, v151, v152
  v_max3_f32 v12, v12, v153, v154
  v_max_f32 v12, v12, v155
  v_mov_b32 v13, v12
  s_nop 1
  v_permlane32_swap_b32 v12, v13
  v_max_f32 v12, v12, v13
  v_mov_b32 v13, v12
  s_nop 1
  v_permlane16_swap_b32 v12, v13
  v_max_f32 v12, v12, v13
  v_mul_f32 v12, s50, v12
  v_fma_f32 v144, v144, s50, -v12
  v_fma_f32 v145, v145, s50, -v12
  v_fma_f32 v148, v148, s50, -v12
  v_fma_f32 v149, v149, s50, -v12
  v_fma_f32 v150, v150, s50, -v12
  v_fma_f32 v151, v151, s50, -v12
  v_fma_f32 v152, v152, s50, -v12
  v_fma_f32 v153, v153, s50, -v12
  v_fma_f32 v154, v154, s50, -v12
  v_fma_f32 v155, v155, s50, -v12
  v_exp_f32 v144, v144
  v_exp_f32 v145, v145
  v_exp_f32 v148, v148
  v_exp_f32 v149, v149
  v_exp_f32 v150, v150
  v_exp_f32 v151, v151
  v_exp_f32 v152, v152
  v_exp_f32 v153, v153
  v_exp_f32 v154, v154
  v_exp_f32 v155, v155
  v_add_f32 v12, v144, v145
  v_add_f32 v12, v12, v148
  v_add_f32 v12, v12, v149
  v_add_f32 v12, v12, v150
  v_add_f32 v12, v12, v151
  v_add_f32 v12, v12, v152
  v_add_f32 v12, v12, v153
  v_add_f32 v12, v12, v154
  v_add_f32 v12, v12, v155
  v_mov_b32 v13, v12
  s_nop 1
  v_permlane32_swap_b32 v12, v13
  v_add_f32 v12, v12, v13
  v_mov_b32 v13, v12
  s_nop 1
  v_permlane16_swap_b32 v12, v13
  v_add_f32 v12, v12, v13
  v_rcp_f32 v12, v12
  s_nop 0
  v_mul_f32 v144, v144, v12
  v_mul_f32 v145, v145, v12
  v_mul_f32 v148, v148, v12
  v_mul_f32 v149, v149, v12
  v_mul_f32 v150, v150, v12
  v_mul_f32 v151, v151, v12
  v_mul_f32 v152, v152, v12
  v_mul_f32 v153, v153, v12
  v_mul_f32 v154, v154, v12
  v_mul_f32 v155, v155, v12
  v_cvt_pk_bf16_f32 v168, v144, v145
  v_mov_b32 v169, 0
  v_mov_b32 v170, 0
  v_mov_b32 v171, v168
  v_cvt_pk_bf16_f32 v164, v148, v149
  v_cvt_pk_bf16_f32 v165, v150, v151
  v_cvt_pk_bf16_f32 v166, v152, v153
  v_cvt_pk_bf16_f32 v167, v154, v155
  v_mfma_f32_16x16x32_bf16 v[176:179], a[64:67], v[156:159], 0
  v_mfma_f32_16x16x32_bf16 v[180:183], a[68:71], v[156:159], 0
  v_mfma_f32_16x16x32_bf16 v[184:187], a[72:75], v[156:159], 0
  v_mfma_f32_16x16x32_bf16 v[188:191], a[76:79], v[156:159], 0
  v_mfma_f32_16x16x32_bf16 v[192:195], a[80:83], v[156:159], 0
  v_mfma_f32_16x16x32_bf16 v[196:199], a[84:87], v[156:159], 0
  v_mfma_f32_16x16x32_bf16 v[200:203], a[88:91], v[156:159], 0
  v_mfma_f32_16x16x32_bf16 v[204:207], a[92:95], v[156:159], 0
  v_mfma_f32_16x16x16_bf16 v[176:179], a[112:113], v[160:161], v[176:179]
  v_mfma_f32_16x16x16_bf16 v[180:183], a[112:113], v[162:163], v[180:183]
  v_mfma_f32_16x16x16_bf16 v[184:187], a[114:115], v[160:161], v[184:187]
  v_mfma_f32_16x16x16_bf16 v[188:191], a[114:115], v[162:163], v[188:191]
  v_mfma_f32_16x16x16_bf16 v[192:195], a[116:117], v[160:161], v[192:195]
  v_mfma_f32_16x16x16_bf16 v[196:199], a[116:117], v[162:163], v[196:199]
  v_mfma_f32_16x16x16_bf16 v[200:203], a[118:119], v[160:161], v[200:203]
  v_mfma_f32_16x16x16_bf16 v[204:207], a[118:119], v[162:163], v[204:207]
  v_mfma_f32_16x16x32_bf16 v[208:211], a[64:67], v[164:167], 0
  v_mfma_f32_16x16x32_bf16 v[212:215], a[68:71], v[164:167], 0
  v_mfma_f32_16x16x32_bf16 v[216:219], a[72:75], v[164:167], 0
  v_mfma_f32_16x16x32_bf16 v[220:223], a[76:79], v[164:167], 0
  v_mfma_f32_16x16x32_bf16 v[224:227], a[80:83], v[164:167], 0
  v_mfma_f32_16x16x32_bf16 v[228:231], a[84:87], v[164:167], 0
  v_mfma_f32_16x16x32_bf16 v[232:235], a[88:91], v[164:167], 0
  v_mfma_f32_16x16x32_bf16 v[236:239], a[92:95], v[164:167], 0
  v_mfma_f32_16x16x16_bf16 v[208:211], a[112:113], v[168:169], v[208:211]
  v_mfma_f32_16x16x16_bf16 v[212:215], a[112:113], v[170:171], v[212:215]
  v_mfma_f32_16x16x16_bf16 v[216:219], a[114:115], v[168:169], v[216:219]
  v_mfma_f32_16x16x16_bf16 v[220:223], a[114:115], v[170:171], v[220:223]
  v_mfma_f32_16x16x16_bf16 v[224:227], a[116:117], v[168:169], v[224:227]
  v_mfma_f32_16x16x16_bf16 v[228:231], a[116:117], v[170:171], v[228:231]
  v_mfma_f32_16x16x16_bf16 v[232:235], a[118:119], v[168:169], v[232:235]
  v_mfma_f32_16x16x16_bf16 v[236:239], a[118:119], v[170:171], v[236:239]
  v_cvt_pk_bf16_f32 v136, v176, v177
  v_cvt_pk_bf16_f32 v137, v178, v179
  v_cvt_pk_bf16_f32 v138, v184, v185
  v_cvt_pk_bf16_f32 v139, v186, v187
  buffer_store_dwordx4 v[136:139], v10, s[4:7], s95 offen offset:0 sc1
  v_cvt_pk_bf16_f32 v140, v180, v181
  v_cvt_pk_bf16_f32 v141, v182, v183
  v_cvt_pk_bf16_f32 v142, v188, v189
  v_cvt_pk_bf16_f32 v143, v190, v191
  buffer_store_dwordx4 v[140:143], v10, s[4:7], s95 offen offset:512 sc1
  v_cvt_pk_bf16_f32 v144, v192, v193
  v_cvt_pk_bf16_f32 v145, v194, v195
  v_cvt_pk_bf16_f32 v146, v200, v201
  v_cvt_pk_bf16_f32 v147, v202, v203
  buffer_store_dwordx4 v[144:147], v10, s[4:7], s95 offen offset:2048 sc1
  v_cvt_pk_bf16_f32 v148, v196, v197
  v_cvt_pk_bf16_f32 v149, v198, v199
  v_cvt_pk_bf16_f32 v150, v204, v205
  v_cvt_pk_bf16_f32 v151, v206, v207
  buffer_store_dwordx4 v[148:151], v10, s[4:7], s95 offen offset:2560 sc1
  v_cvt_pk_bf16_f32 v136, v208, v209
  v_cvt_pk_bf16_f32 v137, v210, v211
  v_cvt_pk_bf16_f32 v138, v216, v217
  v_cvt_pk_bf16_f32 v139, v218, v219
  buffer_store_dwordx4 v[136:139], v11, s[4:7], s95 offen offset:0 sc1
  v_cvt_pk_bf16_f32 v140, v212, v213
  v_cvt_pk_bf16_f32 v141, v214, v215
  v_cvt_pk_bf16_f32 v142, v220, v221
  v_cvt_pk_bf16_f32 v143, v222, v223
  buffer_store_dwordx4 v[140:143], v11, s[4:7], s95 offen offset:512 sc1
  v_cvt_pk_bf16_f32 v144, v224, v225
  v_cvt_pk_bf16_f32 v145, v226, v227
  v_cvt_pk_bf16_f32 v146, v232, v233
  v_cvt_pk_bf16_f32 v147, v234, v235
  buffer_store_dwordx4 v[144:147], v11, s[4:7], s95 offen offset:2048 sc1
  v_cvt_pk_bf16_f32 v148, v228, v229
  v_cvt_pk_bf16_f32 v149, v230, v231
  v_cvt_pk_bf16_f32 v150, v236, v237
  v_cvt_pk_bf16_f32 v151, v238, v239
  buffer_store_dwordx4 v[148:151], v11, s[4:7], s95 offen offset:2560 sc1
  s_add_u32 s95, s95, 262144
  s_branch L_done
L_bo:
  s_lshr_b32 s40, s36, 1
  s_lshl_b32 s40, s40, 7
  s_add_u32 s40, s40, 1024
  s_mov_b32 s41, 16
  s_mov_b32 s12, s82
  s_and_b32 s13, s83, 0xffff
  s_mov_b32 s14, 0x200000
  s_mov_b32 s15, 0x20000
  s_mov_b32 s23, 65536
  s_mov_b32 s25, 4
  s_lshl_b32 s20, s36, 18
  s_add_u32 s20, s20, 0x6000000
  s_mov_b32 s22, 2048
  s_branch L_g3
L_aos:
  s_mov_b32 s12, s74
  s_and_b32 s13, s75, 0xffff
  s_mov_b32 s14, 0x800000
  s_mov_b32 s15, 0x20000
  s_and_b32 s48, s37, 7
  s_lshr_b32 s37, s37, 3
  s_sub_u32 s40, s36, 12
  s_lshl_b32 s40, s40, 4
  s_add_u32 s40, s40, s48
  s_lshl_b32 s40, s40, 7
  s_add_u32 s40, s40, 20480
  s_mov_b32 s41, 2
  s_add_u32 s42, s40, 1024
  s_mov_b32 s23, 262144
  s_mov_b32 s25, 2
  s_lshl_b32 s20, s36, 20
  s_add_u32 s20, s20, 0x5000000
  s_lshl_b32 s90, s48, 15
  s_add_u32 s20, s20, s90
  s_mov_b32 s22, 0
  s_lshl_b32 s49, s48, 20
  s_branch L_g3b
L_ao4:
  s_lshl_b32 s40, s36, 7
  s_add_u32 s40, s40, 2048
  s_mov_b32 s41, 32
  s_mov_b32 s42, s40
  s_mov_b32 s12, s74
  s_and_b32 s13, s75, 0xffff
  s_mov_b32 s14, 0x800000
  s_mov_b32 s15, 0x20000
  s_and_b32 s48, s37, 3
  s_lshr_b32 s37, s37, 2
  s_mov_b32 s23, 262144
  s_mov_b32 s25, 4
  s_lshl_b32 s20, s36, 20
  s_add_u32 s20, s20, 0x5000000
  s_lshl_b32 s90, s48, 16
  s_add_u32 s20, s20, s90
  s_mov_b32 s22, 0
  s_lshl_b32 s49, s48, 21
  s_branch L_g3b
L_ao:
  s_lshl_b32 s40, s36, 7
  s_add_u32 s40, s40, 2048
  s_mov_b32 s41, 32
  s_mov_b32 s12, s74
  s_and_b32 s13, s75, 0xffff
  s_mov_b32 s14, 0x800000
  s_mov_b32 s15, 0x20000
  s_mov_b32 s23, 262144
  s_mov_b32 s25, 16
  s_lshl_b32 s20, s36, 20
  s_add_u32 s20, s20, 0x5000000
  s_mov_b32 s22, 0
L_g3:
  s_mov_b32 s49, 0
  s_cmp_eq_u32 s35, 16
  s_cselect_b32 s42, 128, 0
  s_add_u32 s42, s42, s40
L_g3b:
  s_mov_b32 s8, s4
  s_and_b32 s9, s5, 0xffff
  s_mov_b32 s10, 0x10000000
  s_mov_b32 s11, 0x20000
  s_lshl_b32 s91, s33, 1
  s_add_u32 s91, s91, s37
  s_mov_b32 s24, 2048
  s_mov_b32 s26, 4096
  s_lshl_b32 s21, s91, 8
  s_add_u32 s22, s22, s21
  s_lshl_b32 s90, s36, 19
  s_add_u32 s22, s22, s90
  s_add_u32 s21, s21, s49
  s_mov_b32 s50, s91
  s_cmp_lt_u32 s35, 16
  s_cbranch_scc1 L_g3c
  s_cmp_eq_u32 s35, 16
  s_cselect_b32 s25, 21, 5
  s_mov_b32 s48, 2048
  v_and_b32 v1, 63, v0
  v_lshrrev_b32 v23, 6, v0
  s_nop 0
  v_readfirstlane_b32 s27, v23
  s_mul_i32 s90, s27, 2
  s_mul_i32 s90, s90, s23
  v_mov_b32 v2, 0x0
  v_bfe_u32 v24, v1, 0, 6
  v_lshl_add_u32 v2, v24, 4, v2
  v_add_u32 v2, s90, v2
  v_mov_b32 v3, 0x400
  v_bfe_u32 v24, v1, 0, 6
  v_lshl_add_u32 v3, v24, 4, v3
  v_add_u32 v3, s90, v3
  v_mov_b32 v4, 0x1000
  v_bfe_u32 v24, v1, 0, 6
  v_lshl_add_u32 v4, v24, 4, v4
  v_add_u32 v4, s90, v4
  v_mov_b32 v5, 0x1400
  v_bfe_u32 v24, v1, 0, 6
  v_lshl_add_u32 v5, v24, 4, v5
  v_add_u32 v5, s90, v5
  s_add_u32 s90, s90, s23
  v_mov_b32 v6, 0x0
  v_bfe_u32 v24, v1, 0, 6
  v_lshl_add_u32 v6, v24, 4, v6
  v_add_u32 v6, s90, v6
  v_mov_b32 v7, 0x400
  v_bfe_u32 v24, v1, 0, 6
  v_lshl_add_u32 v7, v24, 4, v7
  v_add_u32 v7, s90, v7
  v_mov_b32 v8, 0x1000
  v_bfe_u32 v24, v1, 0, 6
  v_lshl_add_u32 v8, v24, 4, v8
  v_add_u32 v8, s90, v8
  v_mov_b32 v9, 0x1400
  v_bfe_u32 v24, v1, 0, 6
  v_lshl_add_u32 v9, v24, 4, v9
  v_add_u32 v9, s90, v9
  s_mul_i32 s90, s27, 16
  v_lshrrev_b32 v23, 4, v1
  v_add_u32 v23, 0, v23
  v_add_u32 v23, s90, v23
  v_and_b32 v24, 7, v23
  v_lshlrev_b32 v24, 1, v24
  v_xor_b32 v24, v24, v1
  v_and_b32 v24, 15, v24
  v_mul_lo_u32 v23, v23, s24
  v_lshl_add_u32 v10, v24, 4, v23
  v_lshrrev_b32 v23, 4, v1
  v_add_u32 v23, 4, v23
  v_add_u32 v23, s90, v23
  v_and_b32 v24, 7, v23
  v_lshlrev_b32 v24, 1, v24
  v_xor_b32 v24, v24, v1
  v_and_b32 v24, 15, v24
  v_mul_lo_u32 v23, v23, s24
  v_lshl_add_u32 v11, v24, 4, v23
  v_lshrrev_b32 v23, 4, v1
  v_add_u32 v23, 8, v23
  v_add_u32 v23, s90, v23
  v_and_b32 v24, 7, v23
  v_lshlrev_b32 v24, 1, v24
  v_xor_b32 v24, v24, v1
  v_and_b32 v24, 15, v24
  v_mul_lo_u32 v23, v23, s24
  v_lshl_add_u32 v12, v24, 4, v23
  v_lshrrev_b32 v23, 4, v1
  v_add_u32 v23, 12, v23
  v_add_u32 v23, s90, v23
  v_and_b32 v24, 7, v23
  v_lshlrev_b32 v24, 1, v24
  v_xor_b32 v24, v24, v1
  v_and_b32 v24, 15, v24
  v_mul_lo_u32 v23, v23, s24
  v_lshl_add_u32 v13, v24, 4, v23
  s_mul_i32 s51, s24, 64
  s_mul_i32 s52, s27, 8192
  s_mul_i32 s53, s27, 4096
  s_add_u32 s53, s53, 32768
  s_add_u32 m0, s53, 0
  s_nop 0
  buffer_load_dwordx4 v10, s[12:15], s21 offen  lds
  s_add_u32 m0, s53, 1024
  s_nop 0
  buffer_load_dwordx4 v11, s[12:15], s21 offen  lds
  s_add_u32 m0, s53, 2048
  s_nop 0
  buffer_load_dwordx4 v12, s[12:15], s21 offen  lds
  s_add_u32 m0, s53, 3072
  s_nop 0
  buffer_load_dwordx4 v13, s[12:15], s21 offen  lds
  s_add_u32 s21, s21, s51
  s_add_u32 m0, s53, 49152
  s_nop 0
  buffer_load_dwordx4 v10, s[12:15], s21 offen  lds
  s_add_u32 m0, s53, 50176
  s_nop 0
  buffer_load_dwordx4 v11, s[12:15], s21 offen  lds
  s_add_u32 m0, s53, 51200
  s_nop 0
  buffer_load_dwordx4 v12, s[12:15], s21 offen  lds
  s_add_u32 m0, s53, 52224
  s_nop 0
  buffer_load_dwordx4 v13, s[12:15], s21 offen  lds
  s_add_u32 s21, s21, s51
  s_add_u32 m0, s53, 98304
  s_nop 0
  buffer_load_dwordx4 v10, s[12:15], s21 offen  lds
  s_add_u32 m0, s53, 99328
  s_nop 0
  buffer_load_dwordx4 v11, s[12:15], s21 offen  lds
  s_add_u32 m0, s53, 100352
  s_nop 0
  buffer_load_dwordx4 v12, s[12:15], s21 offen  lds
  s_add_u32 m0, s53, 101376
  s_nop 0
  buffer_load_dwordx4 v13, s[12:15], s21 offen  lds
  s_add_u32 s21, s21, s51
  s_cmp_lg_u32 s32, 0
  s_cbranch_scc1 L_dd_99
  v_mov_b32 v228, 0x3d00000
L_dw_98:
  buffer_load_dword v234, v228, s[4:7], s40 offen offset:0 sc1
  buffer_load_dword v235, v228, s[4:7], s42 offen offset:0 sc1
  s_waitcnt vmcnt(0)
  s_mov_b32 s44, 1
  v_readfirstlane_b32 s45, v234
  s_cmp_ge_u32 s45, s41
  s_cselect_b32 s44, s44, 0
  v_readfirstlane_b32 s45, v235
  s_cmp_ge_u32 s45, s41
  s_cselect_b32 s44, s44, 0
  s_cmp_eq_u32 s44, 1
  s_cbranch_scc1 L_dd_99
  s_sleep 3
  s_add_u32 s3, s3, 1
  s_cmp_lt_u32 s3, 131072
  s_cbranch_scc1 L_dw_98
L_dd_99:
  s_barrier
  s_add_u32 m0, s52, 0
  s_nop 0
  buffer_load_dwordx4 v2, s[8:11], s20 offen sc1 lds
  s_add_u32 m0, s52, 1024
  s_nop 0
  buffer_load_dwordx4 v3, s[8:11], s20 offen sc1 lds
  s_add_u32 m0, s52, 2048
  s_nop 0
  buffer_load_dwordx4 v4, s[8:11], s20 offen sc1 lds
  s_add_u32 m0, s52, 3072
  s_nop 0
  buffer_load_dwordx4 v5, s[8:11], s20 offen sc1 lds
  s_add_u32 m0, s52, 4096
  s_nop 0
  buffer_load_dwordx4 v6, s[8:11], s20 offen sc1 lds
  s_add_u32 m0, s52, 5120
  s_nop 0
  buffer_load_dwordx4 v7, s[8:11], s20 offen sc1 lds
  s_add_u32 m0, s52, 6144
  s_nop 0
  buffer_load_dwordx4 v8, s[8:11], s20 offen sc1 lds
  s_add_u32 m0, s52, 7168
  s_nop 0
  buffer_load_dwordx4 v9, s[8:11], s20 offen sc1 lds
  s_add_u32 s20, s20, s48
  s_xor_b32 s48, s48, 4096
  s_add_u32 m0, s52, 49152
  s_nop 0
  buffer_load_dwordx4 v2, s[8:11], s20 offen sc1 lds
  s_add_u32 m0, s52, 50176
  s_nop 0
  buffer_load_dwordx4 v3, s[8:11], s20 offen sc1 lds
  s_add_u32 m0, s52, 51200
  s_nop 0
  buffer_load_dwordx4 v4, s[8:11], s20 offen sc1 lds
  s_add_u32 m0, s52, 52224
  s_nop 0
  buffer_load_dwordx4 v5, s[8:11], s20 offen sc1 lds
  s_add_u32 m0, s52, 53248
  s_nop 0
  buffer_load_dwordx4 v6, s[8:11], s20 offen sc1 lds
  s_add_u32 m0, s52, 54272
  s_nop 0
  buffer_load_dwordx4 v7, s[8:11], s20 offen sc1 lds
  s_add_u32 m0, s52, 55296
  s_nop 0
  buffer_load_dwordx4 v8, s[8:11], s20 offen sc1 lds
  s_add_u32 m0, s52, 56320
  s_nop 0
  buffer_load_dwordx4 v9, s[8:11], s20 offen sc1 lds
  s_add_u32 s20, s20, s48
  s_xor_b32 s48, s48, 4096
  s_add_u32 m0, s52, 98304
  s_nop 0
  buffer_load_dwordx4 v2, s[8:11], s20 offen sc1 lds
  s_add_u32 m0, s52, 99328
  s_nop 0
  buffer_load_dwordx4 v3, s[8:11], s20 offen sc1 lds
  s_add_u32 m0, s52, 100352
  s_nop 0
  buffer_load_dwordx4 v4, s[8:11], s20 offen sc1 lds
  s_add_u32 m0, s52, 101376
  s_nop 0
  buffer_load_dwordx4 v5, s[8:11], s20 offen sc1 lds
  s_add_u32 m0, s52, 102400
  s_nop 0
  buffer_load_dwordx4 v6, s[8:11], s20 offen sc1 lds
  s_add_u32 m0, s52, 103424
  s_nop 0
  buffer_load_dwordx4 v7, s[8:11], s20 offen sc1 lds
  s_add_u32 m0, s52, 104448
  s_nop 0
  buffer_load_dwordx4 v8, s[8:11], s20 offen sc1 lds
  s_add_u32 m0, s52, 105472
  s_nop 0
  buffer_load_dwordx4 v9, s[8:11], s20 offen sc1 lds
  s_add_u32 s20, s20, s48
  s_xor_b32 s48, s48, 4096
  s_lshr_b32 s90, s27, 1
  s_and_b32 s91, s27, 1
  s_mul_i32 s92, s90, 16384
  v_mov_b32 v14, 0x0
  v_bfe_u32 v24, v1, 0, 6
  v_lshl_add_u32 v14, v24, 4, v14
  v_add_u32 v14, s92, v14
  v_add_u32 v15, 65536, v14
  v_add_u32 v16, 131072, v14
  v_mov_b32 v23, 0x0
  v_bfe_u32 v24, v1, 2, 2
  v_lshl_add_u32 v23, v24, 8, v23
  v_bfe_u32 v24, v1, 4, 2
  v_lshl_add_u32 v23, v24, 10, v23
  v_bfe_u32 v24, v1, 0, 1
  v_lshl_add_u32 v23, v24, 4, v23
  v_bfe_u32 v25, v1, 2, 3
  v_bfe_u32 v24, v1, 1, 1
  v_xor_b32 v25, v25, v24
  s_mul_i32 s92, s91, 4
  s_add_u32 s93, s92, 0
  v_xor_b32 v24, s93, v25
  v_lshl_add_u32 v17, v24, 5, v23
  v_add_u32 v19, 65536, v17
  v_add_u32 v21, 131072, v17
  s_add_u32 s93, s92, 2
  v_xor_b32 v24, s93, v25
  v_lshl_add_u32 v18, v24, 5, v23
  v_add_u32 v20, 65536, v18
  v_add_u32 v22, 131072, v18
  s_waitcnt vmcnt(16)
  s_barrier
  ds_read_b128 v[28:31], v14 offset:0
  ds_read_b64_tr_b16 v[92:93], v17 offset:32768
  ds_read_b64_tr_b16 v[94:95], v17 offset:36864
  ds_read_b128 v[32:35], v14 offset:2048
  ds_read_b64_tr_b16 v[96:97], v17 offset:32776
  ds_read_b64_tr_b16 v[98:99], v17 offset:36872
  ds_read_b128 v[36:39], v14 offset:4096
  ds_read_b64_tr_b16 v[100:101], v18 offset:32768
  ds_read_b64_tr_b16 v[102:103], v18 offset:36864
  ds_read_b128 v[40:43], v14 offset:6144
  ds_read_b64_tr_b16 v[104:105], v18 offset:32776
  ds_read_b64_tr_b16 v[106:107], v18 offset:36872
  ds_read_b128 v[44:47], v14 offset:8192
  ds_read_b128 v[48:51], v14 offset:10240
  ds_read_b128 v[52:55], v14 offset:12288
  ds_read_b128 v[56:59], v14 offset:14336
  s_sub_u32 s25, s25, 1
  s_waitcnt lgkmcnt(0)
  v_mfma_f32_16x16x32_bf16 a[0:3], v[92:95], v[28:31], 0
  ds_read_b128 v[60:63], v14 offset:1024
  v_mfma_f32_16x16x32_bf16 a[4:7], v[96:99], v[28:31], 0
  ds_read_b64_tr_b16 v[108:109], v17 offset:40960
  v_mfma_f32_16x16x32_bf16 a[8:11], v[100:103], v[28:31], 0
  ds_read_b64_tr_b16 v[110:111], v17 offset:45056
  v_mfma_f32_16x16x32_bf16 a[12:15], v[104:107], v[28:31], 0
  ds_read_b128 v[64:67], v14 offset:3072
  v_mfma_f32_16x16x32_bf16 a[16:19], v[92:95], v[32:35], 0
  ds_read_b64_tr_b16 v[112:113], v17 offset:40968
  v_mfma_f32_16x16x32_bf16 a[20:23], v[96:99], v[32:35], 0
  ds_read_b64_tr_b16 v[114:115], v17 offset:45064
  v_mfma_f32_16x16x32_bf16 a[24:27], v[100:103], v[32:35], 0
  ds_read_b128 v[68:71], v14 offset:5120
  v_mfma_f32_16x16x32_bf16 a[28:31], v[104:107], v[32:35], 0
  ds_read_b64_tr_b16 v[116:117], v18 offset:40960
  v_mfma_f32_16x16x32_bf16 a[32:35], v[92:95], v[36:39], 0
  ds_read_b64_tr_b16 v[118:119], v18 offset:45056
  v_mfma_f32_16x16x32_bf16 a[36:39], v[96:99], v[36:39], 0
  ds_read_b128 v[72:75], v14 offset:7168
  v_mfma_f32_16x16x32_bf16 a[40:43], v[100:103], v[36:39], 0
  ds_read_b64_tr_b16 v[120:121], v18 offset:40968
  v_mfma_f32_16x16x32_bf16 a[44:47], v[104:107], v[36:39], 0
  ds_read_b64_tr_b16 v[122:123], v18 offset:45064
  v_mfma_f32_16x16x32_bf16 a[48:51], v[92:95], v[40:43], 0
  ds_read_b128 v[76:79], v14 offset:9216
  v_mfma_f32_16x16x32_bf16 a[52:55], v[96:99], v[40:43], 0
  ds_read_b128 v[80:83], v14 offset:11264
  v_mfma_f32_16x16x32_bf16 a[56:59], v[100:103], v[40:43], 0
  ds_read_b128 v[84:87], v14 offset:13312
  v_mfma_f32_16x16x32_bf16 a[60:63], v[104:107], v[40:43], 0
  ds_read_b128 v[88:91], v14 offset:15360
  v_mfma_f32_16x16x32_bf16 a[64:67], v[92:95], v[44:47], 0
  v_mfma_f32_16x16x32_bf16 a[68:71], v[96:99], v[44:47], 0
  v_mfma_f32_16x16x32_bf16 a[72:75], v[100:103], v[44:47], 0
  v_mfma_f32_16x16x32_bf16 a[76:79], v[104:107], v[44:47], 0
  v_mfma_f32_16x16x32_bf16 a[80:83], v[92:95], v[48:51], 0
  v_mfma_f32_16x16x32_bf16 a[84:87], v[96:99], v[48:51], 0
  v_mfma_f32_16x16x32_bf16 a[88:91], v[100:103], v[48:51], 0
  v_mfma_f32_16x16x32_bf16 a[92:95], v[104:107], v[48:51], 0
  v_mfma_f32_16x16x32_bf16 a[96:99], v[92:95], v[52:55], 0
  v_mfma_f32_16x16x32_bf16 a[100:103], v[96:99], v[52:55], 0
  v_mfma_f32_16x16x32_bf16 a[104:107], v[100:103], v[52:55], 0
  v_mfma_f32_16x16x32_bf16 a[108:111], v[104:107], v[52:55], 0
  v_mfma_f32_16x16x32_bf16 a[112:115], v[92:95], v[56:59], 0
  v_mfma_f32_16x16x32_bf16 a[116:119], v[96:99], v[56:59], 0
  v_mfma_f32_16x16x32_bf16 a[120:123], v[100:103], v[56:59], 0
  v_mfma_f32_16x16x32_bf16 a[124:127], v[104:107], v[56:59], 0
  s_waitcnt lgkmcnt(0)
  v_mfma_f32_16x16x32_bf16 a[0:3], v[108:111], v[60:63], a[0:3]
  s_waitcnt vmcnt(8)
  s_barrier
  s_add_u32 m0, s52, 0
  v_mfma_f32_16x16x32_bf16 a[4:7], v[112:115], v[60:63], a[4:7]
  buffer_load_dwordx4 v2, s[8:11], s20 offen sc1 lds
  ds_read_b128 v[28:31], v14 offset:49152
  v_mfma_f32_16x16x32_bf16 a[8:11], v[116:119], v[60:63], a[8:11]
  ds_read_b64_tr_b16 v[92:93], v19 offset:16384
  v_mfma_f32_16x16x32_bf16 a[12:15], v[120:123], v[60:63], a[12:15]
  ds_read_b64_tr_b16 v[94:95], v19 offset:20480
  v_mfma_f32_16x16x32_bf16 a[16:19], v[108:111], v[64:67], a[16:19]
  ds_read_b128 v[32:35], v14 offset:51200
  s_add_u32 m0, s53, 0
  v_mfma_f32_16x16x32_bf16 a[20:23], v[112:115], v[64:67], a[20:23]
  buffer_load_dwordx4 v10, s[12:15], s21 offen  lds
  ds_read_b64_tr_b16 v[96:97], v19 offset:16392
  v_mfma_f32_16x16x32_bf16 a[24:27], v[116:119], v[64:67], a[24:27]
  ds_read_b64_tr_b16 v[98:99], v19 offset:20488
  v_mfma_f32_16x16x32_bf16 a[28:31], v[120:123], v[64:67], a[28:31]
  ds_read_b128 v[36:39], v14 offset:53248
  v_mfma_f32_16x16x32_bf16 a[32:35], v[108:111], v[68:71], a[32:35]
  ds_read_b64_tr_b16 v[100:101], v20 offset:16384
  s_add_u32 m0, s52, 1024
  v_mfma_f32_16x16x32_bf16 a[36:39], v[112:115], v[68:71], a[36:39]
  buffer_load_dwordx4 v3, s[8:11], s20 offen sc1 lds
  ds_read_b64_tr_b16 v[102:103], v20 offset:20480
  v_mfma_f32_16x16x32_bf16 a[40:43], v[116:119], v[68:71], a[40:43]
  ds_read_b128 v[40:43], v14 offset:55296
  v_mfma_f32_16x16x32_bf16 a[44:47], v[120:123], v[68:71], a[44:47]
  ds_read_b64_tr_b16 v[104:105], v20 offset:16392
  v_mfma_f32_16x16x32_bf16 a[48:51], v[108:111], v[72:75], a[48:51]
  ds_read_b64_tr_b16 v[106:107], v20 offset:20488
  v_mfma_f32_16x16x32_bf16 a[52:55], v[112:115], v[72:75], a[52:55]
  ds_read_b128 v[44:47], v14 offset:57344
  s_add_u32 m0, s53, 1024
  v_mfma_f32_16x16x32_bf16 a[56:59], v[116:119], v[72:75], a[56:59]
  buffer_load_dwordx4 v11, s[12:15], s21 offen  lds
  ds_read_b128 v[48:51], v14 offset:59392
  v_mfma_f32_16x16x32_bf16 a[60:63], v[120:123], v[72:75], a[60:63]
  ds_read_b128 v[52:55], v14 offset:61440
  v_mfma_f32_16x16x32_bf16 a[64:67], v[108:111], v[76:79], a[64:67]
  ds_read_b128 v[56:59], v14 offset:63488
  v_mfma_f32_16x16x32_bf16 a[68:71], v[112:115], v[76:79], a[68:71]
  s_add_u32 m0, s52, 2048
  v_mfma_f32_16x16x32_bf16 a[72:75], v[116:119], v[76:79], a[72:75]
  buffer_load_dwordx4 v4, s[8:11], s20 offen sc1 lds
  v_mfma_f32_16x16x32_bf16 a[76:79], v[120:123], v[76:79], a[76:79]
  v_mfma_f32_16x16x32_bf16 a[80:83], v[108:111], v[80:83], a[80:83]
  v_mfma_f32_16x16x32_bf16 a[84:87], v[112:115], v[80:83], a[84:87]
  v_mfma_f32_16x16x32_bf16 a[88:91], v[116:119], v[80:83], a[88:91]
  s_add_u32 m0, s53, 2048
  v_mfma_f32_16x16x32_bf16 a[92:95], v[120:123], v[80:83], a[92:95]
  buffer_load_dwordx4 v12, s[12:15], s21 offen  lds
  v_mfma_f32_16x16x32_bf16 a[96:99], v[108:111], v[84:87], a[96:99]
  v_mfma_f32_16x16x32_bf16 a[100:103], v[112:115], v[84:87], a[100:103]
  v_mfma_f32_16x16x32_bf16 a[104:107], v[116:119], v[84:87], a[104:107]
  s_add_u32 m0, s52, 3072
  v_mfma_f32_16x16x32_bf16 a[108:111], v[120:123], v[84:87], a[108:111]
  buffer_load_dwordx4 v5, s[8:11], s20 offen sc1 lds
  v_mfma_f32_16x16x32_bf16 a[112:115], v[108:111], v[88:91], a[112:115]
  v_mfma_f32_16x16x32_bf16 a[116:119], v[112:115], v[88:91], a[116:119]
  v_mfma_f32_16x16x32_bf16 a[120:123], v[116:119], v[88:91], a[120:123]
  v_mfma_f32_16x16x32_bf16 a[124:127], v[120:123], v[88:91], a[124:127]
  s_waitcnt lgkmcnt(0)
  s_add_u32 m0, s53, 3072
  v_mfma_f32_16x16x32_bf16 a[0:3], v[92:95], v[28:31], a[0:3]
  buffer_load_dwordx4 v13, s[12:15], s21 offen  lds
  ds_read_b128 v[60:63], v14 offset:50176
  v_mfma_f32_16x16x32_bf16 a[4:7], v[96:99], v[28:31], a[4:7]
  ds_read_b64_tr_b16 v[108:109], v19 offset:24576
  v_mfma_f32_16x16x32_bf16 a[8:11], v[100:103], v[28:31], a[8:11]
  ds_read_b64_tr_b16 v[110:111], v19 offset:28672
  v_mfma_f32_16x16x32_bf16 a[12:15], v[104:107], v[28:31], a[12:15]
  ds_read_b128 v[64:67], v14 offset:52224
  v_mfma_f32_16x16x32_bf16 a[16:19], v[92:95], v[32:35], a[16:19]
  ds_read_b64_tr_b16 v[112:113], v19 offset:24584
  s_add_u32 m0, s52, 4096
  v_mfma_f32_16x16x32_bf16 a[20:23], v[96:99], v[32:35], a[20:23]
  buffer_load_dwordx4 v6, s[8:11], s20 offen sc1 lds
  ds_read_b64_tr_b16 v[114:115], v19 offset:28680
  v_mfma_f32_16x16x32_bf16 a[24:27], v[100:103], v[32:35], a[24:27]
  ds_read_b128 v[68:71], v14 offset:54272
  v_mfma_f32_16x16x32_bf16 a[28:31], v[104:107], v[32:35], a[28:31]
  ds_read_b64_tr_b16 v[116:117], v20 offset:24576
  v_mfma_f32_16x16x32_bf16 a[32:35], v[92:95], v[36:39], a[32:35]
  ds_read_b64_tr_b16 v[118:119], v20 offset:28672
  v_mfma_f32_16x16x32_bf16 a[36:39], v[96:99], v[36:39], a[36:39]
  ds_read_b128 v[72:75], v14 offset:56320
  s_add_u32 m0, s52, 5120
  v_mfma_f32_16x16x32_bf16 a[40:43], v[100:103], v[36:39], a[40:43]
  buffer_load_dwordx4 v7, s[8:11], s20 offen sc1 lds
  ds_read_b64_tr_b16 v[120:121], v20 offset:24584
  v_mfma_f32_16x16x32_bf16 a[44:47], v[104:107], v[36:39], a[44:47]
  ds_read_b64_tr_b16 v[122:123], v20 offset:28680
  v_mfma_f32_16x16x32_bf16 a[48:51], v[92:95], v[40:43], a[48:51]
  ds_read_b128 v[76:79], v14 offset:58368
  v_mfma_f32_16x16x32_bf16 a[52:55], v[96:99], v[40:43], a[52:55]
  ds_read_b128 v[80:83], v14 offset:60416
  v_mfma_f32_16x16x32_bf16 a[56:59], v[100:103], v[40:43], a[56:59]
  ds_read_b128 v[84:87], v14 offset:62464
  v_mfma_f32_16x16x32_bf16 a[60:63], v[104:107], v[40:43], a[60:63]
  ds_read_b128 v[88:91], v14 offset:64512
  s_add_u32 m0, s52, 6144
  v_mfma_f32_16x16x32_bf16 a[64:67], v[92:95], v[44:47], a[64:67]
  buffer_load_dwordx4 v8, s[8:11], s20 offen sc1 lds
  v_mfma_f32_16x16x32_bf16 a[68:71], v[96:99], v[44:47], a[68:71]
  v_mfma_f32_16x16x32_bf16 a[72:75], v[100:103], v[44:47], a[72:75]
  v_mfma_f32_16x16x32_bf16 a[76:79], v[104:107], v[44:47], a[76:79]
  v_mfma_f32_16x16x32_bf16 a[80:83], v[92:95], v[48:51], a[80:83]
  s_add_u32 m0, s52, 7168
  v_mfma_f32_16x16x32_bf16 a[84:87], v[96:99], v[48:51], a[84:87]
  buffer_load_dwordx4 v9, s[8:11], s20 offen sc1 lds
  v_mfma_f32_16x16x32_bf16 a[88:91], v[100:103], v[48:51], a[88:91]
  v_mfma_f32_16x16x32_bf16 a[92:95], v[104:107], v[48:51], a[92:95]
  v_mfma_f32_16x16x32_bf16 a[96:99], v[92:95], v[52:55], a[96:99]
  v_mfma_f32_16x16x32_bf16 a[100:103], v[96:99], v[52:55], a[100:103]
  s_add_u32 s20, s20, s48
  s_xor_b32 s48, s48, 4096
  v_mfma_f32_16x16x32_bf16 a[104:107], v[100:103], v[52:55], a[104:107]
  s_add_u32 s21, s21, s51
  v_mfma_f32_16x16x32_bf16 a[108:111], v[104:107], v[52:55], a[108:111]
  v_mfma_f32_16x16x32_bf16 a[112:115], v[92:95], v[56:59], a[112:115]
  v_mfma_f32_16x16x32_bf16 a[116:119], v[96:99], v[56:59], a[116:119]
  v_mfma_f32_16x16x32_bf16 a[120:123], v[100:103], v[56:59], a[120:123]
  v_mfma_f32_16x16x32_bf16 a[124:127], v[104:107], v[56:59], a[124:127]
  s_waitcnt lgkmcnt(0)
  v_mfma_f32_16x16x32_bf16 a[0:3], v[108:111], v[60:63], a[0:3]
  s_waitcnt vmcnt(12)
  s_barrier
  s_add_u32 m0, s52, 49152
  v_mfma_f32_16x16x32_bf16 a[4:7], v[112:115], v[60:63], a[4:7]
  buffer_load_dwordx4 v2, s[8:11], s20 offen sc1 lds
  ds_read_b128 v[28:31], v15 offset:32768
  v_mfma_f32_16x16x32_bf16 a[8:11], v[116:119], v[60:63], a[8:11]
  ds_read_b64_tr_b16 v[92:93], v21 offset:0
  v_mfma_f32_16x16x32_bf16 a[12:15], v[120:123], v[60:63], a[12:15]
  ds_read_b64_tr_b16 v[94:95], v21 offset:4096
  v_mfma_f32_16x16x32_bf16 a[16:19], v[108:111], v[64:67], a[16:19]
  ds_read_b128 v[32:35], v15 offset:34816
  s_add_u32 m0, s53, 49152
  v_mfma_f32_16x16x32_bf16 a[20:23], v[112:115], v[64:67], a[20:23]
  buffer_load_dwordx4 v10, s[12:15], s21 offen  lds
  ds_read_b64_tr_b16 v[96:97], v21 offset:8
  v_mfma_f32_16x16x32_bf16 a[24:27], v[116:119], v[64:67], a[24:27]
  ds_read_b64_tr_b16 v[98:99], v21 offset:4104
  v_mfma_f32_16x16x32_bf16 a[28:31], v[120:123], v[64:67], a[28:31]
  ds_read_b128 v[36:39], v15 offset:36864
  v_mfma_f32_16x16x32_bf16 a[32:35], v[108:111], v[68:71], a[32:35]
  ds_read_b64_tr_b16 v[100:101], v22 offset:0
  s_add_u32 m0, s52, 50176
  v_mfma_f32_16x16x32_bf16 a[36:39], v[112:115], v[68:71], a[36:39]
  buffer_load_dwordx4 v3, s[8:11], s20 offen sc1 lds
  ds_read_b64_tr_b16 v[102:103], v22 offset:4096
  v_mfma_f32_16x16x32_bf16 a[40:43], v[116:119], v[68:71], a[40:43]
  ds_read_b128 v[40:43], v15 offset:38912
  v_mfma_f32_16x16x32_bf16 a[44:47], v[120:123], v[68:71], a[44:47]
  ds_read_b64_tr_b16 v[104:105], v22 offset:8
  v_mfma_f32_16x16x32_bf16 a[48:51], v[108:111], v[72:75], a[48:51]
  ds_read_b64_tr_b16 v[106:107], v22 offset:4104
  v_mfma_f32_16x16x32_bf16 a[52:55], v[112:115], v[72:75], a[52:55]
  ds_read_b128 v[44:47], v15 offset:40960
  s_add_u32 m0, s53, 50176
  v_mfma_f32_16x16x32_bf16 a[56:59], v[116:119], v[72:75], a[56:59]
  buffer_load_dwordx4 v11, s[12:15], s21 offen  lds
  ds_read_b128 v[48:51], v15 offset:43008
  v_mfma_f32_16x16x32_bf16 a[60:63], v[120:123], v[72:75], a[60:63]
  ds_read_b128 v[52:55], v15 offset:45056
  v_mfma_f32_16x16x32_bf16 a[64:67], v[108:111], v[76:79], a[64:67]
  ds_read_b128 v[56:59], v15 offset:47104
  v_mfma_f32_16x16x32_bf16 a[68:71], v[112:115], v[76:79], a[68:71]
  s_add_u32 m0, s52, 51200
  v_mfma_f32_16x16x32_bf16 a[72:75], v[116:119], v[76:79], a[72:75]
  buffer_load_dwordx4 v4, s[8:11], s20 offen sc1 lds
  v_mfma_f32_16x16x32_bf16 a[76:79], v[120:123], v[76:79], a[76:79]
  v_mfma_f32_16x16x32_bf16 a[80:83], v[108:111], v[80:83], a[80:83]
  v_mfma_f32_16x16x32_bf16 a[84:87], v[112:115], v[80:83], a[84:87]
  v_mfma_f32_16x16x32_bf16 a[88:91], v[116:119], v[80:83], a[88:91]
  s_add_u32 m0, s53, 51200
  v_mfma_f32_16x16x32_bf16 a[92:95], v[120:123], v[80:83], a[92:95]
  buffer_load_dwordx4 v12, s[12:15], s21 offen  lds
  v_mfma_f32_16x16x32_bf16 a[96:99], v[108:111], v[84:87], a[96:99]
  v_mfma_f32_16x16x32_bf16 a[100:103], v[112:115], v[84:87], a[100:103]
  v_mfma_f32_16x16x32_bf16 a[104:107], v[116:119], v[84:87], a[104:107]
  s_add_u32 m0, s52, 52224
  v_mfma_f32_16x16x32_bf16 a[108:111], v[120:123], v[84:87], a[108:111]
  buffer_load_dwordx4 v5, s[8:11], s20 offen sc1 lds
  v_mfma_f32_16x16x32_bf16 a[112:115], v[108:111], v[88:91], a[112:115]
  v_mfma_f32_16x16x32_bf16 a[116:119], v[112:115], v[88:91], a[116:119]
  v_mfma_f32_16x16x32_bf16 a[120:123], v[116:119], v[88:91], a[120:123]
  v_mfma_f32_16x16x32_bf16 a[124:127], v[120:123], v[88:91], a[124:127]
  s_waitcnt lgkmcnt(0)
  s_add_u32 m0, s53, 52224
  v_mfma_f32_16x16x32_bf16 a[0:3], v[92:95], v[28:31], a[0:3]
  buffer_load_dwordx4 v13, s[12:15], s21 offen  lds
  ds_read_b128 v[60:63], v15 offset:33792
  v_mfma_f32_16x16x32_bf16 a[4:7], v[96:99], v[28:31], a[4:7]
  ds_read_b64_tr_b16 v[108:109], v21 offset:8192
  v_mfma_f32_16x16x32_bf16 a[8:11], v[100:103], v[28:31], a[8:11]
  ds_read_b64_tr_b16 v[110:111], v21 offset:12288
  v_mfma_f32_16x16x32_bf16 a[12:15], v[104:107], v[28:31], a[12:15]
  ds_read_b128 v[64:67], v15 offset:35840
  v_mfma_f32_16x16x32_bf16 a[16:19], v[92:95], v[32:35], a[16:19]
  ds_read_b64_tr_b16 v[112:113], v21 offset:8200
  s_add_u32 m0, s52, 53248
  v_mfma_f32_16x16x32_bf16 a[20:23], v[96:99], v[32:35], a[20:23]
  buffer_load_dwordx4 v6, s[8:11], s20 offen sc1 lds
  ds_read_b64_tr_b16 v[114:115], v21 offset:12296
  v_mfma_f32_16x16x32_bf16 a[24:27], v[100:103], v[32:35], a[24:27]
  ds_read_b128 v[68:71], v15 offset:37888
  v_mfma_f32_16x16x32_bf16 a[28:31], v[104:107], v[32:35], a[28:31]
  ds_read_b64_tr_b16 v[116:117], v22 offset:8192
  v_mfma_f32_16x16x32_bf16 a[32:35], v[92:95], v[36:39], a[32:35]
  ds_read_b64_tr_b16 v[118:119], v22 offset:12288
  v_mfma_f32_16x16x32_bf16 a[36:39], v[96:99], v[36:39], a[36:39]
  ds_read_b128 v[72:75], v15 offset:39936
  s_add_u32 m0, s52, 54272
  v_mfma_f32_16x16x32_bf16 a[40:43], v[100:103], v[36:39], a[40:43]
  buffer_load_dwordx4 v7, s[8:11], s20 offen sc1 lds
  ds_read_b64_tr_b16 v[120:121], v22 offset:8200
  v_mfma_f32_16x16x32_bf16 a[44:47], v[104:107], v[36:39], a[44:47]
  ds_read_b64_tr_b16 v[122:123], v22 offset:12296
  v_mfma_f32_16x16x32_bf16 a[48:51], v[92:95], v[40:43], a[48:51]
  ds_read_b128 v[76:79], v15 offset:41984
  v_mfma_f32_16x16x32_bf16 a[52:55], v[96:99], v[40:43], a[52:55]
  ds_read_b128 v[80:83], v15 offset:44032
  v_mfma_f32_16x16x32_bf16 a[56:59], v[100:103], v[40:43], a[56:59]
  ds_read_b128 v[84:87], v15 offset:46080
  v_mfma_f32_16x16x32_bf16 a[60:63], v[104:107], v[40:43], a[60:63]
  ds_read_b128 v[88:91], v15 offset:48128
  s_add_u32 m0, s52, 55296
  v_mfma_f32_16x16x32_bf16 a[64:67], v[92:95], v[44:47], a[64:67]
  buffer_load_dwordx4 v8, s[8:11], s20 offen sc1 lds
  v_mfma_f32_16x16x32_bf16 a[68:71], v[96:99], v[44:47], a[68:71]
  v_mfma_f32_16x16x32_bf16 a[72:75], v[100:103], v[44:47], a[72:75]
  v_mfma_f32_16x16x32_bf16 a[76:79], v[104:107], v[44:47], a[76:79]
  v_mfma_f32_16x16x32_bf16 a[80:83], v[92:95], v[48:51], a[80:83]
  s_add_u32 m0, s52, 56320
  v_mfma_f32_16x16x32_bf16 a[84:87], v[96:99], v[48:51], a[84:87]
  buffer_load_dwordx4 v9, s[8:11], s20 offen sc1 lds
  v_mfma_f32_16x16x32_bf16 a[88:91], v[100:103], v[48:51], a[88:91]
  v_mfma_f32_16x16x32_bf16 a[92:95], v[104:107], v[48:51], a[92:95]
  v_mfma_f32_16x16x32_bf16 a[96:99], v[92:95], v[52:55], a[96:99]
  v_mfma_f32_16x16x32_bf16 a[100:103], v[96:99], v[52:55], a[100:103]
  s_add_u32 s20, s20, s48
  s_xor_b32 s48, s48, 4096
  v_mfma_f32_16x16x32_bf16 a[104:107], v[100:103], v[52:55], a[104:107]
  s_add_u32 s21, s21, s51
  v_mfma_f32_16x16x32_bf16 a[108:111], v[104:107], v[52:55], a[108:111]
  v_mfma_f32_16x16x32_bf16 a[112:115], v[92:95], v[56:59], a[112:115]
  v_mfma_f32_16x16x32_bf16 a[116:119], v[96:99], v[56:59], a[116:119]
  v_mfma_f32_16x16x32_bf16 a[120:123], v[100:103], v[56:59], a[120:123]
  v_mfma_f32_16x16x32_bf16 a[124:127], v[104:107], v[56:59], a[124:127]
  s_waitcnt lgkmcnt(0)
  v_mfma_f32_16x16x32_bf16 a[0:3], v[108:111], v[60:63], a[0:3]
  s_waitcnt vmcnt(12)
  s_barrier
  s_add_u32 m0, s52, 98304
  v_mfma_f32_16x16x32_bf16 a[4:7], v[112:115], v[60:63], a[4:7]
  buffer_load_dwordx4 v2, s[8:11], s20 offen sc1 lds
  ds_read_b128 v[28:31], v14 offset:0
  v_mfma_f32_16x16x32_bf16 a[8:11], v[116:119], v[60:63], a[8:11]
  ds_read_b64_tr_b16 v[92:93], v17 offset:32768
  v_mfma_f32_16x16x32_bf16 a[12:15], v[120:123], v[60:63], a[12:15]
  ds_read_b64_tr_b16 v[94:95], v17 offset:36864
  v_mfma_f32_16x16x32_bf16 a[16:19], v[108:111], v[64:67], a[16:19]
  ds_read_b128 v[32:35], v14 offset:2048
  s_add_u32 m0, s53, 98304
  v_mfma_f32_16x16x32_bf16 a[20:23], v[112:115], v[64:67], a[20:23]
  buffer_load_dwordx4 v10, s[12:15], s21 offen  lds
  ds_read_b64_tr_b16 v[96:97], v17 offset:32776
  v_mfma_f32_16x16x32_bf16 a[24:27], v[116:119], v[64:67], a[24:27]
  ds_read_b64_tr_b16 v[98:99], v17 offset:36872
  v_mfma_f32_16x16x32_bf16 a[28:31], v[120:123], v[64:67], a[28:31]
  ds_read_b128 v[36:39], v14 offset:4096
  v_mfma_f32_16x16x32_bf16 a[32:35], v[108:111], v[68:71], a[32:35]
  ds_read_b64_tr_b16 v[100:101], v18 offset:32768
  s_add_u32 m0, s52, 99328
  v_mfma_f32_16x16x32_bf16 a[36:39], v[112:115], v[68:71], a[36:39]
  buffer_load_dwordx4 v3, s[8:11], s20 offen sc1 lds
  ds_read_b64_tr_b16 v[102:103], v18 offset:36864
  v_mfma_f32_16x16x32_bf16 a[40:43], v[116:119], v[68:71], a[40:43]
  ds_read_b128 v[40:43], v14 offset:6144
  v_mfma_f32_16x16x32_bf16 a[44:47], v[120:123], v[68:71], a[44:47]
  ds_read_b64_tr_b16 v[104:105], v18 offset:32776
  v_mfma_f32_16x16x32_bf16 a[48:51], v[108:111], v[72:75], a[48:51]
  ds_read_b64_tr_b16 v[106:107], v18 offset:36872
  v_mfma_f32_16x16x32_bf16 a[52:55], v[112:115], v[72:75], a[52:55]
  ds_read_b128 v[44:47], v14 offset:8192
  s_add_u32 m0, s53, 99328
  v_mfma_f32_16x16x32_bf16 a[56:59], v[116:119], v[72:75], a[56:59]
  buffer_load_dwordx4 v11, s[12:15], s21 offen  lds
  ds_read_b128 v[48:51], v14 offset:10240
  v_mfma_f32_16x16x32_bf16 a[60:63], v[120:123], v[72:75], a[60:63]
  ds_read_b128 v[52:55], v14 offset:12288
  v_mfma_f32_16x16x32_bf16 a[64:67], v[108:111], v[76:79], a[64:67]
  ds_read_b128 v[56:59], v14 offset:14336
  v_mfma_f32_16x16x32_bf16 a[68:71], v[112:115], v[76:79], a[68:71]
  s_add_u32 m0, s52, 100352
  v_mfma_f32_16x16x32_bf16 a[72:75], v[116:119], v[76:79], a[72:75]
  buffer_load_dwordx4 v4, s[8:11], s20 offen sc1 lds
  v_mfma_f32_16x16x32_bf16 a[76:79], v[120:123], v[76:79], a[76:79]
  v_mfma_f32_16x16x32_bf16 a[80:83], v[108:111], v[80:83], a[80:83]
  v_mfma_f32_16x16x32_bf16 a[84:87], v[112:115], v[80:83], a[84:87]
  v_mfma_f32_16x16x32_bf16 a[88:91], v[116:119], v[80:83], a[88:91]
  s_add_u32 m0, s53, 100352
  v_mfma_f32_16x16x32_bf16 a[92:95], v[120:123], v[80:83], a[92:95]
  buffer_load_dwordx4 v12, s[12:15], s21 offen  lds
  v_mfma_f32_16x16x32_bf16 a[96:99], v[108:111], v[84:87], a[96:99]
  v_mfma_f32_16x16x32_bf16 a[100:103], v[112:115], v[84:87], a[100:103]
  v_mfma_f32_16x16x32_bf16 a[104:107], v[116:119], v[84:87], a[104:107]
  s_add_u32 m0, s52, 101376
  v_mfma_f32_16x16x32_bf16 a[108:111], v[120:123], v[84:87], a[108:111]
  buffer_load_dwordx4 v5, s[8:11], s20 offen sc1 lds
  v_mfma_f32_16x16x32_bf16 a[112:115], v[108:111], v[88:91], a[112:115]
  v_mfma_f32_16x16x32_bf16 a[116:119], v[112:115], v[88:91], a[116:119]
  v_mfma_f32_16x16x32_bf16 a[120:123], v[116:119], v[88:91], a[120:123]
  v_mfma_f32_16x16x32_bf16 a[124:127], v[120:123], v[88:91], a[124:127]
L_g6_loop:
  s_sub_u32 s25, s25, 1
  s_cmp_eq_u32 s25, 0
  s_cbranch_scc1 L_g6_fin
  s_waitcnt lgkmcnt(0)
  s_add_u32 m0, s53, 101376
  v_mfma_f32_16x16x32_bf16 a[0:3], v[92:95], v[28:31], a[0:3]
  buffer_load_dwordx4 v13, s[12:15], s21 offen  lds
  ds_read_b128 v[60:63], v14 offset:1024
  v_mfma_f32_16x16x32_bf16 a[4:7], v[96:99], v[28:31], a[4:7]
  ds_read_b64_tr_b16 v[108:109], v17 offset:40960
  v_mfma_f32_16x16x32_bf16 a[8:11], v[100:103], v[28:31], a[8:11]
  ds_read_b64_tr_b16 v[110:111], v17 offset:45056
  v_mfma_f32_16x16x32_bf16 a[12:15], v[104:107], v[28:31], a[12:15]
  ds_read_b128 v[64:67], v14 offset:3072
  v_mfma_f32_16x16x32_bf16 a[16:19], v[92:95], v[32:35], a[16:19]
  ds_read_b64_tr_b16 v[112:113], v17 offset:40968
  s_add_u32 m0, s52, 102400
  v_mfma_f32_16x16x32_bf16 a[20:23], v[96:99], v[32:35], a[20:23]
  buffer_load_dwordx4 v6, s[8:11], s20 offen sc1 lds
  ds_read_b64_tr_b16 v[114:115], v17 offset:45064
  v_mfma_f32_16x16x32_bf16 a[24:27], v[100:103], v[32:35], a[24:27]
  ds_read_b128 v[68:71], v14 offset:5120
  v_mfma_f32_16x16x32_bf16 a[28:31], v[104:107], v[32:35], a[28:31]
  ds_read_b64_tr_b16 v[116:117], v18 offset:40960
  v_mfma_f32_16x16x32_bf16 a[32:35], v[92:95], v[36:39], a[32:35]
  ds_read_b64_tr_b16 v[118:119], v18 offset:45056
  v_mfma_f32_16x16x32_bf16 a[36:39], v[96:99], v[36:39], a[36:39]
  ds_read_b128 v[72:75], v14 offset:7168
  s_add_u32 m0, s52, 103424
  v_mfma_f32_16x16x32_bf16 a[40:43], v[100:103], v[36:39], a[40:43]
  buffer_load_dwordx4 v7, s[8:11], s20 offen sc1 lds
  ds_read_b64_tr_b16 v[120:121], v18 offset:40968
  v_mfma_f32_16x16x32_bf16 a[44:47], v[104:107], v[36:39], a[44:47]
  ds_read_b64_tr_b16 v[122:123], v18 offset:45064
  v_mfma_f32_16x16x32_bf16 a[48:51], v[92:95], v[40:43], a[48:51]
  ds_read_b128 v[76:79], v14 offset:9216
  v_mfma_f32_16x16x32_bf16 a[52:55], v[96:99], v[40:43], a[52:55]
  ds_read_b128 v[80:83], v14 offset:11264
  v_mfma_f32_16x16x32_bf16 a[56:59], v[100:103], v[40:43], a[56:59]
  ds_read_b128 v[84:87], v14 offset:13312
  v_mfma_f32_16x16x32_bf16 a[60:63], v[104:107], v[40:43], a[60:63]
  ds_read_b128 v[88:91], v14 offset:15360
  s_add_u32 m0, s52, 104448
  v_mfma_f32_16x16x32_bf16 a[64:67], v[92:95], v[44:47], a[64:67]
  buffer_load_dwordx4 v8, s[8:11], s20 offen sc1 lds
  v_mfma_f32_16x16x32_bf16 a[68:71], v[96:99], v[44:47], a[68:71]
  v_mfma_f32_16x16x32_bf16 a[72:75], v[100:103], v[44:47], a[72:75]
  v_mfma_f32_16x16x32_bf16 a[76:79], v[104:107], v[44:47], a[76:79]
  v_mfma_f32_16x16x32_bf16 a[80:83], v[92:95], v[48:51], a[80:83]
  s_add_u32 m0, s52, 105472
  v_mfma_f32_16x16x32_bf16 a[84:87], v[96:99], v[48:51], a[84:87]
  buffer_load_dwordx4 v9, s[8:11], s20 offen sc1 lds
  v_mfma_f32_16x16x32_bf16 a[88:91], v[100:103], v[48:51], a[88:91]
  v_mfma_f32_16x16x32_bf16 a[92:95], v[104:107], v[48:51], a[92:95]
  v_mfma_f32_16x16x32_bf16 a[96:99], v[92:95], v[52:55], a[96:99]
  v_mfma_f32_16x16x32_bf16 a[100:103], v[96:99], v[52:55], a[100:103]
  s_add_u32 s20, s20, s48
  s_xor_b32 s48, s48, 4096
  v_mfma_f32_16x16x32_bf16 a[104:107], v[100:103], v[52:55], a[104:107]
  s_add_u32 s21, s21, s51
  v_mfma_f32_16x16x32_bf16 a[108:111], v[104:107], v[52:55], a[108:111]
  v_mfma_f32_16x16x32_bf16 a[112:115], v[92:95], v[56:59], a[112:115]
  v_mfma_f32_16x16x32_bf16 a[116:119], v[96:99], v[56:59], a[116:119]
  v_mfma_f32_16x16x32_bf16 a[120:123], v[100:103], v[56:59], a[120:123]
  v_mfma_f32_16x16x32_bf16 a[124:127], v[104:107], v[56:59], a[124:127]
  s_waitcnt lgkmcnt(0)
  v_mfma_f32_16x16x32_bf16 a[0:3], v[108:111], v[60:63], a[0:3]
  s_waitcnt vmcnt(12)
  s_barrier
  s_add_u32 m0, s52, 0
  v_mfma_f32_16x16x32_bf16 a[4:7], v[112:115], v[60:63], a[4:7]
  buffer_load_dwordx4 v2, s[8:11], s20 offen sc1 lds
  ds_read_b128 v[28:31], v14 offset:49152
  v_mfma_f32_16x16x32_bf16 a[8:11], v[116:119], v[60:63], a[8:11]
  ds_read_b64_tr_b16 v[92:93], v19 offset:16384
  v_mfma_f32_16x16x32_bf16 a[12:15], v[120:123], v[60:63], a[12:15]
  ds_read_b64_tr_b16 v[94:95], v19 offset:20480
  v_mfma_f32_16x16x32_bf16 a[16:19], v[108:111], v[64:67], a[16:19]
  ds_read_b128 v[32:35], v14 offset:51200
  s_add_u32 m0, s53, 0
  v_mfma_f32_16x16x32_bf16 a[20:23], v[112:115], v[64:67], a[20:23]
  buffer_load_dwordx4 v10, s[12:15], s21 offen  lds
  ds_read_b64_tr_b16 v[96:97], v19 offset:16392
  v_mfma_f32_16x16x32_bf16 a[24:27], v[116:119], v[64:67], a[24:27]
  ds_read_b64_tr_b16 v[98:99], v19 offset:20488
  v_mfma_f32_16x16x32_bf16 a[28:31], v[120:123], v[64:67], a[28:31]
  ds_read_b128 v[36:39], v14 offset:53248
  v_mfma_f32_16x16x32_bf16 a[32:35], v[108:111], v[68:71], a[32:35]
  ds_read_b64_tr_b16 v[100:101], v20 offset:16384
  s_add_u32 m0, s52, 1024
  v_mfma_f32_16x16x32_bf16 a[36:39], v[112:115], v[68:71], a[36:39]
  buffer_load_dwordx4 v3, s[8:11], s20 offen sc1 lds
  ds_read_b64_tr_b16 v[102:103], v20 offset:20480
  v_mfma_f32_16x16x32_bf16 a[40:43], v[116:119], v[68:71], a[40:43]
  ds_read_b128 v[40:43], v14 offset:55296
  v_mfma_f32_16x16x32_bf16 a[44:47], v[120:123], v[68:71], a[44:47]
  ds_read_b64_tr_b16 v[104:105], v20 offset:16392
  v_mfma_f32_16x16x32_bf16 a[48:51], v[108:111], v[72:75], a[48:51]
  ds_read_b64_tr_b16 v[106:107], v20 offset:20488
  v_mfma_f32_16x16x32_bf16 a[52:55], v[112:115], v[72:75], a[52:55]
  ds_read_b128 v[44:47], v14 offset:57344
  s_add_u32 m0, s53, 1024
  v_mfma_f32_16x16x32_bf16 a[56:59], v[116:119], v[72:75], a[56:59]
  buffer_load_dwordx4 v11, s[12:15], s21 offen  lds
  ds_read_b128 v[48:51], v14 offset:59392
  v_mfma_f32_16x16x32_bf16 a[60:63], v[120:123], v[72:75], a[60:63]
  ds_read_b128 v[52:55], v14 offset:61440
  v_mfma_f32_16x16x32_bf16 a[64:67], v[108:111], v[76:79], a[64:67]
  ds_read_b128 v[56:59], v14 offset:63488
  v_mfma_f32_16x16x32_bf16 a[68:71], v[112:115], v[76:79], a[68:71]
  s_add_u32 m0, s52, 2048
  v_mfma_f32_16x16x32_bf16 a[72:75], v[116:119], v[76:79], a[72:75]
  buffer_load_dwordx4 v4, s[8:11], s20 offen sc1 lds
  v_mfma_f32_16x16x32_bf16 a[76:79], v[120:123], v[76:79], a[76:79]
  v_mfma_f32_16x16x32_bf16 a[80:83], v[108:111], v[80:83], a[80:83]
  v_mfma_f32_16x16x32_bf16 a[84:87], v[112:115], v[80:83], a[84:87]
  v_mfma_f32_16x16x32_bf16 a[88:91], v[116:119], v[80:83], a[88:91]
  s_add_u32 m0, s53, 2048
  v_mfma_f32_16x16x32_bf16 a[92:95], v[120:123], v[80:83], a[92:95]
  buffer_load_dwordx4 v12, s[12:15], s21 offen  lds
  v_mfma_f32_16x16x32_bf16 a[96:99], v[108:111], v[84:87], a[96:99]
  v_mfma_f32_16x16x32_bf16 a[100:103], v[112:115], v[84:87], a[100:103]
  v_mfma_f32_16x16x32_bf16 a[104:107], v[116:119], v[84:87], a[104:107]
  s_add_u32 m0, s52, 3072
  v_mfma_f32_16x16x32_bf16 a[108:111], v[120:123], v[84:87], a[108:111]
  buffer_load_dwordx4 v5, s[8:11], s20 offen sc1 lds
  v_mfma_f32_16x16x32_bf16 a[112:115], v[108:111], v[88:91], a[112:115]
  v_mfma_f32_16x16x32_bf16 a[116:119], v[112:115], v[88:91], a[116:119]
  v_mfma_f32_16x16x32_bf16 a[120:123], v[116:119], v[88:91], a[120:123]
  v_mfma_f32_16x16x32_bf16 a[124:127], v[120:123], v[88:91], a[124:127]
  s_waitcnt lgkmcnt(0)
  s_add_u32 m0, s53, 3072
  v_mfma_f32_16x16x32_bf16 a[0:3], v[92:95], v[28:31], a[0:3]
  buffer_load_dwordx4 v13, s[12:15], s21 offen  lds
  ds_read_b128 v[60:63], v14 offset:50176
  v_mfma_f32_16x16x32_bf16 a[4:7], v[96:99], v[28:31], a[4:7]
  ds_read_b64_tr_b16 v[108:109], v19 offset:24576
  v_mfma_f32_16x16x32_bf16 a[8:11], v[100:103], v[28:31], a[8:11]
  ds_read_b64_tr_b16 v[110:111], v19 offset:28672
  v_mfma_f32_16x16x32_bf16 a[12:15], v[104:107], v[28:31], a[12:15]
  ds_read_b128 v[64:67], v14 offset:52224
  v_mfma_f32_16x16x32_bf16 a[16:19], v[92:95], v[32:35], a[16:19]
  ds_read_b64_tr_b16 v[112:113], v19 offset:24584
  s_add_u32 m0, s52, 4096
  v_mfma_f32_16x16x32_bf16 a[20:23], v[96:99], v[32:35], a[20:23]
  buffer_load_dwordx4 v6, s[8:11], s20 offen sc1 lds
  ds_read_b64_tr_b16 v[114:115], v19 offset:28680
  v_mfma_f32_16x16x32_bf16 a[24:27], v[100:103], v[32:35], a[24:27]
  ds_read_b128 v[68:71], v14 offset:54272
  v_mfma_f32_16x16x32_bf16 a[28:31], v[104:107], v[32:35], a[28:31]
  ds_read_b64_tr_b16 v[116:117], v20 offset:24576
  v_mfma_f32_16x16x32_bf16 a[32:35], v[92:95], v[36:39], a[32:35]
  ds_read_b64_tr_b16 v[118:119], v20 offset:28672
  v_mfma_f32_16x16x32_bf16 a[36:39], v[96:99], v[36:39], a[36:39]
  ds_read_b128 v[72:75], v14 offset:56320
  s_add_u32 m0, s52, 5120
  v_mfma_f32_16x16x32_bf16 a[40:43], v[100:103], v[36:39], a[40:43]
  buffer_load_dwordx4 v7, s[8:11], s20 offen sc1 lds
  ds_read_b64_tr_b16 v[120:121], v20 offset:24584
  v_mfma_f32_16x16x32_bf16 a[44:47], v[104:107], v[36:39], a[44:47]
  ds_read_b64_tr_b16 v[122:123], v20 offset:28680
  v_mfma_f32_16x16x32_bf16 a[48:51], v[92:95], v[40:43], a[48:51]
  ds_read_b128 v[76:79], v14 offset:58368
  v_mfma_f32_16x16x32_bf16 a[52:55], v[96:99], v[40:43], a[52:55]
  ds_read_b128 v[80:83], v14 offset:60416
  v_mfma_f32_16x16x32_bf16 a[56:59], v[100:103], v[40:43], a[56:59]
  ds_read_b128 v[84:87], v14 offset:62464
  v_mfma_f32_16x16x32_bf16 a[60:63], v[104:107], v[40:43], a[60:63]
  ds_read_b128 v[88:91], v14 offset:64512
  s_add_u32 m0, s52, 6144
  v_mfma_f32_16x16x32_bf16 a[64:67], v[92:95], v[44:47], a[64:67]
  buffer_load_dwordx4 v8, s[8:11], s20 offen sc1 lds
  v_mfma_f32_16x16x32_bf16 a[68:71], v[96:99], v[44:47], a[68:71]
  v_mfma_f32_16x16x32_bf16 a[72:75], v[100:103], v[44:47], a[72:75]
  v_mfma_f32_16x16x32_bf16 a[76:79], v[104:107], v[44:47], a[76:79]
  v_mfma_f32_16x16x32_bf16 a[80:83], v[92:95], v[48:51], a[80:83]
  s_add_u32 m0, s52, 7168
  v_mfma_f32_16x16x32_bf16 a[84:87], v[96:99], v[48:51], a[84:87]
  buffer_load_dwordx4 v9, s[8:11], s20 offen sc1 lds
  v_mfma_f32_16x16x32_bf16 a[88:91], v[100:103], v[48:51], a[88:91]
  v_mfma_f32_16x16x32_bf16 a[92:95], v[104:107], v[48:51], a[92:95]
  v_mfma_f32_16x16x32_bf16 a[96:99], v[92:95], v[52:55], a[96:99]
  v_mfma_f32_16x16x32_bf16 a[100:103], v[96:99], v[52:55], a[100:103]
  s_add_u32 s20, s20, s48
  s_xor_b32 s48, s48, 4096
  v_mfma_f32_16x16x32_bf16 a[104:107], v[100:103], v[52:55], a[104:107]
  s_add_u32 s21, s21, s51
  v_mfma_f32_16x16x32_bf16 a[108:111], v[104:107], v[52:55], a[108:111]
  v_mfma_f32_16x16x32_bf16 a[112:115], v[92:95], v[56:59], a[112:115]
  v_mfma_f32_16x16x32_bf16 a[116:119], v[96:99], v[56:59], a[116:119]
  v_mfma_f32_16x16x32_bf16 a[120:123], v[100:103], v[56:59], a[120:123]
  v_mfma_f32_16x16x32_bf16 a[124:127], v[104:107], v[56:59], a[124:127]
  s_waitcnt lgkmcnt(0)
  v_mfma_f32_16x16x32_bf16 a[0:3], v[108:111], v[60:63], a[0:3]
  s_waitcnt vmcnt(12)
  s_barrier
  s_add_u32 m0, s52, 49152
  v_mfma_f32_16x16x32_bf16 a[4:7], v[112:115], v[60:63], a[4:7]
  buffer_load_dwordx4 v2, s[8:11], s20 offen sc1 lds
  ds_read_b128 v[28:31], v15 offset:32768
  v_mfma_f32_16x16x32_bf16 a[8:11], v[116:119], v[60:63], a[8:11]
  ds_read_b64_tr_b16 v[92:93], v21 offset:0
  v_mfma_f32_16x16x32_bf16 a[12:15], v[120:123], v[60:63], a[12:15]
  ds_read_b64_tr_b16 v[94:95], v21 offset:4096
  v_mfma_f32_16x16x32_bf16 a[16:19], v[108:111], v[64:67], a[16:19]
  ds_read_b128 v[32:35], v15 offset:34816
  s_add_u32 m0, s53, 49152
  v_mfma_f32_16x16x32_bf16 a[20:23], v[112:115], v[64:67], a[20:23]
  buffer_load_dwordx4 v10, s[12:15], s21 offen  lds
  ds_read_b64_tr_b16 v[96:97], v21 offset:8
  v_mfma_f32_16x16x32_bf16 a[24:27], v[116:119], v[64:67], a[24:27]
  ds_read_b64_tr_b16 v[98:99], v21 offset:4104
  v_mfma_f32_16x16x32_bf16 a[28:31], v[120:123], v[64:67], a[28:31]
  ds_read_b128 v[36:39], v15 offset:36864
  v_mfma_f32_16x16x32_bf16 a[32:35], v[108:111], v[68:71], a[32:35]
  ds_read_b64_tr_b16 v[100:101], v22 offset:0
  s_add_u32 m0, s52, 50176
  v_mfma_f32_16x16x32_bf16 a[36:39], v[112:115], v[68:71], a[36:39]
  buffer_load_dwordx4 v3, s[8:11], s20 offen sc1 lds
  ds_read_b64_tr_b16 v[102:103], v22 offset:4096
  v_mfma_f32_16x16x32_bf16 a[40:43], v[116:119], v[68:71], a[40:43]
  ds_read_b128 v[40:43], v15 offset:38912
  v_mfma_f32_16x16x32_bf16 a[44:47], v[120:123], v[68:71], a[44:47]
  ds_read_b64_tr_b16 v[104:105], v22 offset:8
  v_mfma_f32_16x16x32_bf16 a[48:51], v[108:111], v[72:75], a[48:51]
  ds_read_b64_tr_b16 v[106:107], v22 offset:4104
  v_mfma_f32_16x16x32_bf16 a[52:55], v[112:115], v[72:75], a[52:55]
  ds_read_b128 v[44:47], v15 offset:40960
  s_add_u32 m0, s53, 50176
  v_mfma_f32_16x16x32_bf16 a[56:59], v[116:119], v[72:75], a[56:59]
  buffer_load_dwordx4 v11, s[12:15], s21 offen  lds
  ds_read_b128 v[48:51], v15 offset:43008
  v_mfma_f32_16x16x32_bf16 a[60:63], v[120:123], v[72:75], a[60:63]
  ds_read_b128 v[52:55], v15 offset:45056
  v_mfma_f32_16x16x32_bf16 a[64:67], v[108:111], v[76:79], a[64:67]
  ds_read_b128 v[56:59], v15 offset:47104
  v_mfma_f32_16x16x32_bf16 a[68:71], v[112:115], v[76:79], a[68:71]
  s_add_u32 m0, s52, 51200
  v_mfma_f32_16x16x32_bf16 a[72:75], v[116:119], v[76:79], a[72:75]
  buffer_load_dwordx4 v4, s[8:11], s20 offen sc1 lds
  v_mfma_f32_16x16x32_bf16 a[76:79], v[120:123], v[76:79], a[76:79]
  v_mfma_f32_16x16x32_bf16 a[80:83], v[108:111], v[80:83], a[80:83]
  v_mfma_f32_16x16x32_bf16 a[84:87], v[112:115], v[80:83], a[84:87]
  v_mfma_f32_16x16x32_bf16 a[88:91], v[116:119], v[80:83], a[88:91]
  s_add_u32 m0, s53, 51200
  v_mfma_f32_16x16x32_bf16 a[92:95], v[120:123], v[80:83], a[92:95]
  buffer_load_dwordx4 v12, s[12:15], s21 offen  lds
  v_mfma_f32_16x16x32_bf16 a[96:99], v[108:111], v[84:87], a[96:99]
  v_mfma_f32_16x16x32_bf16 a[100:103], v[112:115], v[84:87], a[100:103]
  v_mfma_f32_16x16x32_bf16 a[104:107], v[116:119], v[84:87], a[104:107]
  s_add_u32 m0, s52, 52224
  v_mfma_f32_16x16x32_bf16 a[108:111], v[120:123], v[84:87], a[108:111]
  buffer_load_dwordx4 v5, s[8:11], s20 offen sc1 lds
  v_mfma_f32_16x16x32_bf16 a[112:115], v[108:111], v[88:91], a[112:115]
  v_mfma_f32_16x16x32_bf16 a[116:119], v[112:115], v[88:91], a[116:119]
  v_mfma_f32_16x16x32_bf16 a[120:123], v[116:119], v[88:91], a[120:123]
  v_mfma_f32_16x16x32_bf16 a[124:127], v[120:123], v[88:91], a[124:127]
  s_waitcnt lgkmcnt(0)
  s_add_u32 m0, s53, 52224
  v_mfma_f32_16x16x32_bf16 a[0:3], v[92:95], v[28:31], a[0:3]
  buffer_load_dwordx4 v13, s[12:15], s21 offen  lds
  ds_read_b128 v[60:63], v15 offset:33792
  v_mfma_f32_16x16x32_bf16 a[4:7], v[96:99], v[28:31], a[4:7]
  ds_read_b64_tr_b16 v[108:109], v21 offset:8192
  v_mfma_f32_16x16x32_bf16 a[8:11], v[100:103], v[28:31], a[8:11]
  ds_read_b64_tr_b16 v[110:111], v21 offset:12288
  v_mfma_f32_16x16x32_bf16 a[12:15], v[104:107], v[28:31], a[12:15]
  ds_read_b128 v[64:67], v15 offset:35840
  v_mfma_f32_16x16x32_bf16 a[16:19], v[92:95], v[32:35], a[16:19]
  ds_read_b64_tr_b16 v[112:113], v21 offset:8200
  s_add_u32 m0, s52, 53248
  v_mfma_f32_16x16x32_bf16 a[20:23], v[96:99], v[32:35], a[20:23]
  buffer_load_dwordx4 v6, s[8:11], s20 offen sc1 lds
  ds_read_b64_tr_b16 v[114:115], v21 offset:12296
  v_mfma_f32_16x16x32_bf16 a[24:27], v[100:103], v[32:35], a[24:27]
  ds_read_b128 v[68:71], v15 offset:37888
  v_mfma_f32_16x16x32_bf16 a[28:31], v[104:107], v[32:35], a[28:31]
  ds_read_b64_tr_b16 v[116:117], v22 offset:8192
  v_mfma_f32_16x16x32_bf16 a[32:35], v[92:95], v[36:39], a[32:35]
  ds_read_b64_tr_b16 v[118:119], v22 offset:12288
  v_mfma_f32_16x16x32_bf16 a[36:39], v[96:99], v[36:39], a[36:39]
  ds_read_b128 v[72:75], v15 offset:39936
  s_add_u32 m0, s52, 54272
  v_mfma_f32_16x16x32_bf16 a[40:43], v[100:103], v[36:39], a[40:43]
  buffer_load_dwordx4 v7, s[8:11], s20 offen sc1 lds
  ds_read_b64_tr_b16 v[120:121], v22 offset:8200
  v_mfma_f32_16x16x32_bf16 a[44:47], v[104:107], v[36:39], a[44:47]
  ds_read_b64_tr_b16 v[122:123], v22 offset:12296
  v_mfma_f32_16x16x32_bf16 a[48:51], v[92:95], v[40:43], a[48:51]
  ds_read_b128 v[76:79], v15 offset:41984
  v_mfma_f32_16x16x32_bf16 a[52:55], v[96:99], v[40:43], a[52:55]
  ds_read_b128 v[80:83], v15 offset:44032
  v_mfma_f32_16x16x32_bf16 a[56:59], v[100:103], v[40:43], a[56:59]
  ds_read_b128 v[84:87], v15 offset:46080
  v_mfma_f32_16x16x32_bf16 a[60:63], v[104:107], v[40:43], a[60:63]
  ds_read_b128 v[88:91], v15 offset:48128
  s_add_u32 m0, s52, 55296
  v_mfma_f32_16x16x32_bf16 a[64:67], v[92:95], v[44:47], a[64:67]
  buffer_load_dwordx4 v8, s[8:11], s20 offen sc1 lds
  v_mfma_f32_16x16x32_bf16 a[68:71], v[96:99], v[44:47], a[68:71]
  v_mfma_f32_16x16x32_bf16 a[72:75], v[100:103], v[44:47], a[72:75]
  v_mfma_f32_16x16x32_bf16 a[76:79], v[104:107], v[44:47], a[76:79]
  v_mfma_f32_16x16x32_bf16 a[80:83], v[92:95], v[48:51], a[80:83]
  s_add_u32 m0, s52, 56320
  v_mfma_f32_16x16x32_bf16 a[84:87], v[96:99], v[48:51], a[84:87]
  buffer_load_dwordx4 v9, s[8:11], s20 offen sc1 lds
  v_mfma_f32_16x16x32_bf16 a[88:91], v[100:103], v[48:51], a[88:91]
  v_mfma_f32_16x16x32_bf16 a[92:95], v[104:107], v[48:51], a[92:95]
  v_mfma_f32_16x16x32_bf16 a[96:99], v[92:95], v[52:55], a[96:99]
  v_mfma_f32_16x16x32_bf16 a[100:103], v[96:99], v[52:55], a[100:103]
  s_add_u32 s20, s20, s48
  s_xor_b32 s48, s48, 4096
  v_mfma_f32_16x16x32_bf16 a[104:107], v[100:103], v[52:55], a[104:107]
  s_add_u32 s21, s21, s51
  v_mfma_f32_16x16x32_bf16 a[108:111], v[104:107], v[52:55], a[108:111]
  v_mfma_f32_16x16x32_bf16 a[112:115], v[92:95], v[56:59], a[112:115]
  v_mfma_f32_16x16x32_bf16 a[116:119], v[96:99], v[56:59], a[116:119]
  v_mfma_f32_16x16x32_bf16 a[120:123], v[100:103], v[56:59], a[120:123]
  v_mfma_f32_16x16x32_bf16 a[124:127], v[104:107], v[56:59], a[124:127]
  s_waitcnt lgkmcnt(0)
  v_mfma_f32_16x16x32_bf16 a[0:3], v[108:111], v[60:63], a[0:3]
  s_waitcnt vmcnt(12)
  s_barrier
  s_add_u32 m0, s52, 98304
  v_mfma_f32_16x16x32_bf16 a[4:7], v[112:115], v[60:63], a[4:7]
  buffer_load_dwordx4 v2, s[8:11], s20 offen sc1 lds
  ds_read_b128 v[28:31], v14 offset:0
  v_mfma_f32_16x16x32_bf16 a[8:11], v[116:119], v[60:63], a[8:11]
  ds_read_b64_tr_b16 v[92:93], v17 offset:32768
  v_mfma_f32_16x16x32_bf16 a[12:15], v[120:123], v[60:63], a[12:15]
  ds_read_b64_tr_b16 v[94:95], v17 offset:36864
  v_mfma_f32_16x16x32_bf16 a[16:19], v[108:111], v[64:67], a[16:19]
  ds_read_b128 v[32:35], v14 offset:2048
  s_add_u32 m0, s53, 98304
  v_mfma_f32_16x16x32_bf16 a[20:23], v[112:115], v[64:67], a[20:23]
  buffer_load_dwordx4 v10, s[12:15], s21 offen  lds
  ds_read_b64_tr_b16 v[96:97], v17 offset:32776
  v_mfma_f32_16x16x32_bf16 a[24:27], v[116:119], v[64:67], a[24:27]
  ds_read_b64_tr_b16 v[98:99], v17 offset:36872
  v_mfma_f32_16x16x32_bf16 a[28:31], v[120:123], v[64:67], a[28:31]
  ds_read_b128 v[36:39], v14 offset:4096
  v_mfma_f32_16x16x32_bf16 a[32:35], v[108:111], v[68:71], a[32:35]
  ds_read_b64_tr_b16 v[100:101], v18 offset:32768
  s_add_u32 m0, s52, 99328
  v_mfma_f32_16x16x32_bf16 a[36:39], v[112:115], v[68:71], a[36:39]
  buffer_load_dwordx4 v3, s[8:11], s20 offen sc1 lds
  ds_read_b64_tr_b16 v[102:103], v18 offset:36864
  v_mfma_f32_16x16x32_bf16 a[40:43], v[116:119], v[68:71], a[40:43]
  ds_read_b128 v[40:43], v14 offset:6144
  v_mfma_f32_16x16x32_bf16 a[44:47], v[120:123], v[68:71], a[44:47]
  ds_read_b64_tr_b16 v[104:105], v18 offset:32776
  v_mfma_f32_16x16x32_bf16 a[48:51], v[108:111], v[72:75], a[48:51]
  ds_read_b64_tr_b16 v[106:107], v18 offset:36872
  v_mfma_f32_16x16x32_bf16 a[52:55], v[112:115], v[72:75], a[52:55]
  ds_read_b128 v[44:47], v14 offset:8192
  s_add_u32 m0, s53, 99328
  v_mfma_f32_16x16x32_bf16 a[56:59], v[116:119], v[72:75], a[56:59]
  buffer_load_dwordx4 v11, s[12:15], s21 offen  lds
  ds_read_b128 v[48:51], v14 offset:10240
  v_mfma_f32_16x16x32_bf16 a[60:63], v[120:123], v[72:75], a[60:63]
  ds_read_b128 v[52:55], v14 offset:12288
  v_mfma_f32_16x16x32_bf16 a[64:67], v[108:111], v[76:79], a[64:67]
  ds_read_b128 v[56:59], v14 offset:14336
  v_mfma_f32_16x16x32_bf16 a[68:71], v[112:115], v[76:79], a[68:71]
  s_add_u32 m0, s52, 100352
  v_mfma_f32_16x16x32_bf16 a[72:75], v[116:119], v[76:79], a[72:75]
  buffer_load_dwordx4 v4, s[8:11], s20 offen sc1 lds
  v_mfma_f32_16x16x32_bf16 a[76:79], v[120:123], v[76:79], a[76:79]
  v_mfma_f32_16x16x32_bf16 a[80:83], v[108:111], v[80:83], a[80:83]
  v_mfma_f32_16x16x32_bf16 a[84:87], v[112:115], v[80:83], a[84:87]
  v_mfma_f32_16x16x32_bf16 a[88:91], v[116:119], v[80:83], a[88:91]
  s_add_u32 m0, s53, 100352
  v_mfma_f32_16x16x32_bf16 a[92:95], v[120:123], v[80:83], a[92:95]
  buffer_load_dwordx4 v12, s[12:15], s21 offen  lds
  v_mfma_f32_16x16x32_bf16 a[96:99], v[108:111], v[84:87], a[96:99]
  v_mfma_f32_16x16x32_bf16 a[100:103], v[112:115], v[84:87], a[100:103]
  v_mfma_f32_16x16x32_bf16 a[104:107], v[116:119], v[84:87], a[104:107]
  s_add_u32 m0, s52, 101376
  v_mfma_f32_16x16x32_bf16 a[108:111], v[120:123], v[84:87], a[108:111]
  buffer_load_dwordx4 v5, s[8:11], s20 offen sc1 lds
  v_mfma_f32_16x16x32_bf16 a[112:115], v[108:111], v[88:91], a[112:115]
  v_mfma_f32_16x16x32_bf16 a[116:119], v[112:115], v[88:91], a[116:119]
  v_mfma_f32_16x16x32_bf16 a[120:123], v[116:119], v[88:91], a[120:123]
  v_mfma_f32_16x16x32_bf16 a[124:127], v[120:123], v[88:91], a[124:127]
  s_branch L_g6_loop
L_g6_fin:
  s_cmp_eq_u32 s35, 16
  s_cselect_b32 s90, 999, s34
  s_cmp_lt_u32 s90, 242
  s_cbranch_scc0 L_re_100
  s_cmp_lg_u32 s32, 0
  s_cbranch_scc1 L_rq_101
  s_cmp_eq_u32 s39, 0
  s_cbranch_scc1 L_rq_101
  s_lshl_b32 s99, s33, 7
  s_add_u32 s99, s99, 0x3d00200
  v_mov_b32 v244, 1
  v_mov_b32 v245, 0
  s_mov_b64 exec, 1
  buffer_atomic_add v244, v245, s[4:7], s99 offen sc0 sc1
  s_mov_b64 exec, -1
L_rq_101:
L_re_100:
  s_waitcnt lgkmcnt(0)
  s_add_u32 m0, s53, 101376
  v_mfma_f32_16x16x32_bf16 a[0:3], v[92:95], v[28:31], a[0:3]
  buffer_load_dwordx4 v13, s[12:15], s21 offen  lds
  ds_read_b128 v[60:63], v14 offset:1024
  v_mfma_f32_16x16x32_bf16 a[4:7], v[96:99], v[28:31], a[4:7]
  ds_read_b64_tr_b16 v[108:109], v17 offset:40960
  v_mfma_f32_16x16x32_bf16 a[8:11], v[100:103], v[28:31], a[8:11]
  ds_read_b64_tr_b16 v[110:111], v17 offset:45056
  v_mfma_f32_16x16x32_bf16 a[12:15], v[104:107], v[28:31], a[12:15]
  ds_read_b128 v[64:67], v14 offset:3072
  v_mfma_f32_16x16x32_bf16 a[16:19], v[92:95], v[32:35], a[16:19]
  ds_read_b64_tr_b16 v[112:113], v17 offset:40968
  s_add_u32 m0, s52, 102400
  v_mfma_f32_16x16x32_bf16 a[20:23], v[96:99], v[32:35], a[20:23]
  buffer_load_dwordx4 v6, s[8:11], s20 offen sc1 lds
  ds_read_b64_tr_b16 v[114:115], v17 offset:45064
  v_mfma_f32_16x16x32_bf16 a[24:27], v[100:103], v[32:35], a[24:27]
  ds_read_b128 v[68:71], v14 offset:5120
  v_mfma_f32_16x16x32_bf16 a[28:31], v[104:107], v[32:35], a[28:31]
  ds_read_b64_tr_b16 v[116:117], v18 offset:40960
  v_mfma_f32_16x16x32_bf16 a[32:35], v[92:95], v[36:39], a[32:35]
  ds_read_b64_tr_b16 v[118:119], v18 offset:45056
  v_mfma_f32_16x16x32_bf16 a[36:39], v[96:99], v[36:39], a[36:39]
  ds_read_b128 v[72:75], v14 offset:7168
  s_add_u32 m0, s52, 103424
  v_mfma_f32_16x16x32_bf16 a[40:43], v[100:103], v[36:39], a[40:43]
  buffer_load_dwordx4 v7, s[8:11], s20 offen sc1 lds
  ds_read_b64_tr_b16 v[120:121], v18 offset:40968
  v_mfma_f32_16x16x32_bf16 a[44:47], v[104:107], v[36:39], a[44:47]
  ds_read_b64_tr_b16 v[122:123], v18 offset:45064
  v_mfma_f32_16x16x32_bf16 a[48:51], v[92:95], v[40:43], a[48:51]
  ds_read_b128 v[76:79], v14 offset:9216
  v_mfma_f32_16x16x32_bf16 a[52:55], v[96:99], v[40:43], a[52:55]
  ds_read_b128 v[80:83], v14 offset:11264
  v_mfma_f32_16x16x32_bf16 a[56:59], v[100:103], v[40:43], a[56:59]
  ds_read_b128 v[84:87], v14 offset:13312
  v_mfma_f32_16x16x32_bf16 a[60:63], v[104:107], v[40:43], a[60:63]
  ds_read_b128 v[88:91], v14 offset:15360
  s_add_u32 m0, s52, 104448
  v_mfma_f32_16x16x32_bf16 a[64:67], v[92:95], v[44:47], a[64:67]
  buffer_load_dwordx4 v8, s[8:11], s20 offen sc1 lds
  v_mfma_f32_16x16x32_bf16 a[68:71], v[96:99], v[44:47], a[68:71]
  v_mfma_f32_16x16x32_bf16 a[72:75], v[100:103], v[44:47], a[72:75]
  v_mfma_f32_16x16x32_bf16 a[76:79], v[104:107], v[44:47], a[76:79]
  v_mfma_f32_16x16x32_bf16 a[80:83], v[92:95], v[48:51], a[80:83]
  s_add_u32 m0, s52, 105472
  v_mfma_f32_16x16x32_bf16 a[84:87], v[96:99], v[48:51], a[84:87]
  buffer_load_dwordx4 v9, s[8:11], s20 offen sc1 lds
  v_mfma_f32_16x16x32_bf16 a[88:91], v[100:103], v[48:51], a[88:91]
  v_mfma_f32_16x16x32_bf16 a[92:95], v[104:107], v[48:51], a[92:95]
  v_mfma_f32_16x16x32_bf16 a[96:99], v[92:95], v[52:55], a[96:99]
  v_mfma_f32_16x16x32_bf16 a[100:103], v[96:99], v[52:55], a[100:103]
  s_add_u32 s20, s20, s48
  s_xor_b32 s48, s48, 4096
  v_mfma_f32_16x16x32_bf16 a[104:107], v[100:103], v[52:55], a[104:107]
  s_add_u32 s21, s21, s51
  v_mfma_f32_16x16x32_bf16 a[108:111], v[104:107], v[52:55], a[108:111]
  v_mfma_f32_16x16x32_bf16 a[112:115], v[92:95], v[56:59], a[112:115]
  v_mfma_f32_16x16x32_bf16 a[116:119], v[96:99], v[56:59], a[116:119]
  v_mfma_f32_16x16x32_bf16 a[120:123], v[100:103], v[56:59], a[120:123]
  v_mfma_f32_16x16x32_bf16 a[124:127], v[104:107], v[56:59], a[124:127]
  s_waitcnt lgkmcnt(0)
  v_mfma_f32_16x16x32_bf16 a[0:3], v[108:111], v[60:63], a[0:3]
  s_waitcnt vmcnt(12)
  s_barrier
  s_add_u32 m0, s52, 0
  v_mfma_f32_16x16x32_bf16 a[4:7], v[112:115], v[60:63], a[4:7]
  buffer_load_dwordx4 v2, s[8:11], s20 offen sc1 lds
  ds_read_b128 v[28:31], v14 offset:49152
  v_mfma_f32_16x16x32_bf16 a[8:11], v[116:119], v[60:63], a[8:11]
  ds_read_b64_tr_b16 v[92:93], v19 offset:16384
  v_mfma_f32_16x16x32_bf16 a[12:15], v[120:123], v[60:63], a[12:15]
  ds_read_b64_tr_b16 v[94:95], v19 offset:20480
  v_mfma_f32_16x16x32_bf16 a[16:19], v[108:111], v[64:67], a[16:19]
  ds_read_b128 v[32:35], v14 offset:51200
  s_add_u32 m0, s53, 0
  v_mfma_f32_16x16x32_bf16 a[20:23], v[112:115], v[64:67], a[20:23]
  buffer_load_dwordx4 v10, s[12:15], s21 offen  lds
  ds_read_b64_tr_b16 v[96:97], v19 offset:16392
  v_mfma_f32_16x16x32_bf16 a[24:27], v[116:119], v[64:67], a[24:27]
  ds_read_b64_tr_b16 v[98:99], v19 offset:20488
  v_mfma_f32_16x16x32_bf16 a[28:31], v[120:123], v[64:67], a[28:31]
  ds_read_b128 v[36:39], v14 offset:53248
  v_mfma_f32_16x16x32_bf16 a[32:35], v[108:111], v[68:71], a[32:35]
  ds_read_b64_tr_b16 v[100:101], v20 offset:16384
  s_add_u32 m0, s52, 1024
  v_mfma_f32_16x16x32_bf16 a[36:39], v[112:115], v[68:71], a[36:39]
  buffer_load_dwordx4 v3, s[8:11], s20 offen sc1 lds
  ds_read_b64_tr_b16 v[102:103], v20 offset:20480
  v_mfma_f32_16x16x32_bf16 a[40:43], v[116:119], v[68:71], a[40:43]
  ds_read_b128 v[40:43], v14 offset:55296
  v_mfma_f32_16x16x32_bf16 a[44:47], v[120:123], v[68:71], a[44:47]
  ds_read_b64_tr_b16 v[104:105], v20 offset:16392
  v_mfma_f32_16x16x32_bf16 a[48:51], v[108:111], v[72:75], a[48:51]
  ds_read_b64_tr_b16 v[106:107], v20 offset:20488
  v_mfma_f32_16x16x32_bf16 a[52:55], v[112:115], v[72:75], a[52:55]
  ds_read_b128 v[44:47], v14 offset:57344
  s_add_u32 m0, s53, 1024
  v_mfma_f32_16x16x32_bf16 a[56:59], v[116:119], v[72:75], a[56:59]
  buffer_load_dwordx4 v11, s[12:15], s21 offen  lds
  ds_read_b128 v[48:51], v14 offset:59392
  v_mfma_f32_16x16x32_bf16 a[60:63], v[120:123], v[72:75], a[60:63]
  ds_read_b128 v[52:55], v14 offset:61440
  v_mfma_f32_16x16x32_bf16 a[64:67], v[108:111], v[76:79], a[64:67]
  ds_read_b128 v[56:59], v14 offset:63488
  v_mfma_f32_16x16x32_bf16 a[68:71], v[112:115], v[76:79], a[68:71]
  s_add_u32 m0, s52, 2048
  v_mfma_f32_16x16x32_bf16 a[72:75], v[116:119], v[76:79], a[72:75]
  buffer_load_dwordx4 v4, s[8:11], s20 offen sc1 lds
  v_mfma_f32_16x16x32_bf16 a[76:79], v[120:123], v[76:79], a[76:79]
  v_mfma_f32_16x16x32_bf16 a[80:83], v[108:111], v[80:83], a[80:83]
  v_mfma_f32_16x16x32_bf16 a[84:87], v[112:115], v[80:83], a[84:87]
  v_mfma_f32_16x16x32_bf16 a[88:91], v[116:119], v[80:83], a[88:91]
  s_add_u32 m0, s53, 2048
  v_mfma_f32_16x16x32_bf16 a[92:95], v[120:123], v[80:83], a[92:95]
  buffer_load_dwordx4 v12, s[12:15], s21 offen  lds
  v_mfma_f32_16x16x32_bf16 a[96:99], v[108:111], v[84:87], a[96:99]
  v_mfma_f32_16x16x32_bf16 a[100:103], v[112:115], v[84:87], a[100:103]
  v_mfma_f32_16x16x32_bf16 a[104:107], v[116:119], v[84:87], a[104:107]
  s_add_u32 m0, s52, 3072
  v_mfma_f32_16x16x32_bf16 a[108:111], v[120:123], v[84:87], a[108:111]
  buffer_load_dwordx4 v5, s[8:11], s20 offen sc1 lds
  v_mfma_f32_16x16x32_bf16 a[112:115], v[108:111], v[88:91], a[112:115]
  v_mfma_f32_16x16x32_bf16 a[116:119], v[112:115], v[88:91], a[116:119]
  v_mfma_f32_16x16x32_bf16 a[120:123], v[116:119], v[88:91], a[120:123]
  v_mfma_f32_16x16x32_bf16 a[124:127], v[120:123], v[88:91], a[124:127]
  s_waitcnt lgkmcnt(0)
  s_add_u32 m0, s53, 3072
  v_mfma_f32_16x16x32_bf16 a[0:3], v[92:95], v[28:31], a[0:3]
  buffer_load_dwordx4 v13, s[12:15], s21 offen  lds
  ds_read_b128 v[60:63], v14 offset:50176
  v_mfma_f32_16x16x32_bf16 a[4:7], v[96:99], v[28:31], a[4:7]
  ds_read_b64_tr_b16 v[108:109], v19 offset:24576
  v_mfma_f32_16x16x32_bf16 a[8:11], v[100:103], v[28:31], a[8:11]
  ds_read_b64_tr_b16 v[110:111], v19 offset:28672
  v_mfma_f32_16x16x32_bf16 a[12:15], v[104:107], v[28:31], a[12:15]
  ds_read_b128 v[64:67], v14 offset:52224
  v_mfma_f32_16x16x32_bf16 a[16:19], v[92:95], v[32:35], a[16:19]
  ds_read_b64_tr_b16 v[112:113], v19 offset:24584
  s_add_u32 m0, s52, 4096
  v_mfma_f32_16x16x32_bf16 a[20:23], v[96:99], v[32:35], a[20:23]
  buffer_load_dwordx4 v6, s[8:11], s20 offen sc1 lds
  ds_read_b64_tr_b16 v[114:115], v19 offset:28680
  v_mfma_f32_16x16x32_bf16 a[24:27], v[100:103], v[32:35], a[24:27]
  ds_read_b128 v[68:71], v14 offset:54272
  v_mfma_f32_16x16x32_bf16 a[28:31], v[104:107], v[32:35], a[28:31]
  ds_read_b64_tr_b16 v[116:117], v20 offset:24576
  v_mfma_f32_16x16x32_bf16 a[32:35], v[92:95], v[36:39], a[32:35]
  ds_read_b64_tr_b16 v[118:119], v20 offset:28672
  v_mfma_f32_16x16x32_bf16 a[36:39], v[96:99], v[36:39], a[36:39]
  ds_read_b128 v[72:75], v14 offset:56320
  s_add_u32 m0, s52, 5120
  v_mfma_f32_16x16x32_bf16 a[40:43], v[100:103], v[36:39], a[40:43]
  buffer_load_dwordx4 v7, s[8:11], s20 offen sc1 lds
  ds_read_b64_tr_b16 v[120:121], v20 offset:24584
  v_mfma_f32_16x16x32_bf16 a[44:47], v[104:107], v[36:39], a[44:47]
  ds_read_b64_tr_b16 v[122:123], v20 offset:28680
  v_mfma_f32_16x16x32_bf16 a[48:51], v[92:95], v[40:43], a[48:51]
  ds_read_b128 v[76:79], v14 offset:58368
  v_mfma_f32_16x16x32_bf16 a[52:55], v[96:99], v[40:43], a[52:55]
  ds_read_b128 v[80:83], v14 offset:60416
  v_mfma_f32_16x16x32_bf16 a[56:59], v[100:103], v[40:43], a[56:59]
  ds_read_b128 v[84:87], v14 offset:62464
  v_mfma_f32_16x16x32_bf16 a[60:63], v[104:107], v[40:43], a[60:63]
  ds_read_b128 v[88:91], v14 offset:64512
  s_add_u32 m0, s52, 6144
  v_mfma_f32_16x16x32_bf16 a[64:67], v[92:95], v[44:47], a[64:67]
  buffer_load_dwordx4 v8, s[8:11], s20 offen sc1 lds
  v_mfma_f32_16x16x32_bf16 a[68:71], v[96:99], v[44:47], a[68:71]
  v_mfma_f32_16x16x32_bf16 a[72:75], v[100:103], v[44:47], a[72:75]
  v_mfma_f32_16x16x32_bf16 a[76:79], v[104:107], v[44:47], a[76:79]
  v_mfma_f32_16x16x32_bf16 a[80:83], v[92:95], v[48:51], a[80:83]
  s_add_u32 m0, s52, 7168
  v_mfma_f32_16x16x32_bf16 a[84:87], v[96:99], v[48:51], a[84:87]
  buffer_load_dwordx4 v9, s[8:11], s20 offen sc1 lds
  v_mfma_f32_16x16x32_bf16 a[88:91], v[100:103], v[48:51], a[88:91]
  v_mfma_f32_16x16x32_bf16 a[92:95], v[104:107], v[48:51], a[92:95]
  v_mfma_f32_16x16x32_bf16 a[96:99], v[92:95], v[52:55], a[96:99]
  v_mfma_f32_16x16x32_bf16 a[100:103], v[96:99], v[52:55], a[100:103]
  s_add_u32 s20, s20, s48
  s_xor_b32 s48, s48, 4096
  v_mfma_f32_16x16x32_bf16 a[104:107], v[100:103], v[52:55], a[104:107]
  s_add_u32 s21, s21, s51
  v_mfma_f32_16x16x32_bf16 a[108:111], v[104:107], v[52:55], a[108:111]
  v_mfma_f32_16x16x32_bf16 a[112:115], v[92:95], v[56:59], a[112:115]
  v_mfma_f32_16x16x32_bf16 a[116:119], v[96:99], v[56:59], a[116:119]
  v_mfma_f32_16x16x32_bf16 a[120:123], v[100:103], v[56:59], a[120:123]
  v_mfma_f32_16x16x32_bf16 a[124:127], v[104:107], v[56:59], a[124:127]
  s_waitcnt lgkmcnt(0)
  v_mfma_f32_16x16x32_bf16 a[0:3], v[108:111], v[60:63], a[0:3]
  s_waitcnt vmcnt(12)
  s_barrier
  v_mfma_f32_16x16x32_bf16 a[4:7], v[112:115], v[60:63], a[4:7]
  ds_read_b128 v[28:31], v15 offset:32768
  v_mfma_f32_16x16x32_bf16 a[8:11], v[116:119], v[60:63], a[8:11]
  ds_read_b64_tr_b16 v[92:93], v21 offset:0
  v_mfma_f32_16x16x32_bf16 a[12:15], v[120:123], v[60:63], a[12:15]
  ds_read_b64_tr_b16 v[94:95], v21 offset:4096
  v_mfma_f32_16x16x32_bf16 a[16:19], v[108:111], v[64:67], a[16:19]
  ds_read_b128 v[32:35], v15 offset:34816
  v_mfma_f32_16x16x32_bf16 a[20:23], v[112:115], v[64:67], a[20:23]
  ds_read_b64_tr_b16 v[96:97], v21 offset:8
  v_mfma_f32_16x16x32_bf16 a[24:27], v[116:119], v[64:67], a[24:27]
  ds_read_b64_tr_b16 v[98:99], v21 offset:4104
  v_mfma_f32_16x16x32_bf16 a[28:31], v[120:123], v[64:67], a[28:31]
  ds_read_b128 v[36:39], v15 offset:36864
  v_mfma_f32_16x16x32_bf16 a[32:35], v[108:111], v[68:71], a[32:35]
  ds_read_b64_tr_b16 v[100:101], v22 offset:0
  v_mfma_f32_16x16x32_bf16 a[36:39], v[112:115], v[68:71], a[36:39]
  ds_read_b64_tr_b16 v[102:103], v22 offset:4096
  v_mfma_f32_16x16x32_bf16 a[40:43], v[116:119], v[68:71], a[40:43]
  ds_read_b128 v[40:43], v15 offset:38912
  v_mfma_f32_16x16x32_bf16 a[44:47], v[120:123], v[68:71], a[44:47]
  ds_read_b64_tr_b16 v[104:105], v22 offset:8
  v_mfma_f32_16x16x32_bf16 a[48:51], v[108:111], v[72:75], a[48:51]
  ds_read_b64_tr_b16 v[106:107], v22 offset:4104
  v_mfma_f32_16x16x32_bf16 a[52:55], v[112:115], v[72:75], a[52:55]
  ds_read_b128 v[44:47], v15 offset:40960
  v_mfma_f32_16x16x32_bf16 a[56:59], v[116:119], v[72:75], a[56:59]
  ds_read_b128 v[48:51], v15 offset:43008
  v_mfma_f32_16x16x32_bf16 a[60:63], v[120:123], v[72:75], a[60:63]
  ds_read_b128 v[52:55], v15 offset:45056
  v_mfma_f32_16x16x32_bf16 a[64:67], v[108:111], v[76:79], a[64:67]
  ds_read_b128 v[56:59], v15 offset:47104
  v_mfma_f32_16x16x32_bf16 a[68:71], v[112:115], v[76:79], a[68:71]
  v_mfma_f32_16x16x32_bf16 a[72:75], v[116:119], v[76:79], a[72:75]
  v_mfma_f32_16x16x32_bf16 a[76:79], v[120:123], v[76:79], a[76:79]
  v_mfma_f32_16x16x32_bf16 a[80:83], v[108:111], v[80:83], a[80:83]
  v_mfma_f32_16x16x32_bf16 a[84:87], v[112:115], v[80:83], a[84:87]
  v_mfma_f32_16x16x32_bf16 a[88:91], v[116:119], v[80:83], a[88:91]
  v_mfma_f32_16x16x32_bf16 a[92:95], v[120:123], v[80:83], a[92:95]
  v_mfma_f32_16x16x32_bf16 a[96:99], v[108:111], v[84:87], a[96:99]
  v_mfma_f32_16x16x32_bf16 a[100:103], v[112:115], v[84:87], a[100:103]
  v_mfma_f32_16x16x32_bf16 a[104:107], v[116:119], v[84:87], a[104:107]
  v_mfma_f32_16x16x32_bf16 a[108:111], v[120:123], v[84:87], a[108:111]
  v_mfma_f32_16x16x32_bf16 a[112:115], v[108:111], v[88:91], a[112:115]
  v_mfma_f32_16x16x32_bf16 a[116:119], v[112:115], v[88:91], a[116:119]
  v_mfma_f32_16x16x32_bf16 a[120:123], v[116:119], v[88:91], a[120:123]
  v_mfma_f32_16x16x32_bf16 a[124:127], v[120:123], v[88:91], a[124:127]
  s_waitcnt lgkmcnt(0)
  v_mfma_f32_16x16x32_bf16 a[0:3], v[92:95], v[28:31], a[0:3]
  ds_read_b128 v[60:63], v15 offset:33792
  v_mfma_f32_16x16x32_bf16 a[4:7], v[96:99], v[28:31], a[4:7]
  ds_read_b64_tr_b16 v[108:109], v21 offset:8192
  v_mfma_f32_16x16x32_bf16 a[8:11], v[100:103], v[28:31], a[8:11]
  ds_read_b64_tr_b16 v[110:111], v21 offset:12288
  v_mfma_f32_16x16x32_bf16 a[12:15], v[104:107], v[28:31], a[12:15]
  ds_read_b128 v[64:67], v15 offset:35840
  v_mfma_f32_16x16x32_bf16 a[16:19], v[92:95], v[32:35], a[16:19]
  ds_read_b64_tr_b16 v[112:113], v21 offset:8200
  v_mfma_f32_16x16x32_bf16 a[20:23], v[96:99], v[32:35], a[20:23]
  ds_read_b64_tr_b16 v[114:115], v21 offset:12296
  v_mfma_f32_16x16x32_bf16 a[24:27], v[100:103], v[32:35], a[24:27]
  ds_read_b128 v[68:71], v15 offset:37888
  v_mfma_f32_16x16x32_bf16 a[28:31], v[104:107], v[32:35], a[28:31]
  ds_read_b64_tr_b16 v[116:117], v22 offset:8192
  v_mfma_f32_16x16x32_bf16 a[32:35], v[92:95], v[36:39], a[32:35]
  ds_read_b64_tr_b16 v[118:119], v22 offset:12288
  v_mfma_f32_16x16x32_bf16 a[36:39], v[96:99], v[36:39], a[36:39]
  ds_read_b128 v[72:75], v15 offset:39936
  v_mfma_f32_16x16x32_bf16 a[40:43], v[100:103], v[36:39], a[40:43]
  ds_read_b64_tr_b16 v[120:121], v22 offset:8200
  v_mfma_f32_16x16x32_bf16 a[44:47], v[104:107], v[36:39], a[44:47]
  ds_read_b64_tr_b16 v[122:123], v22 offset:12296
  v_mfma_f32_16x16x32_bf16 a[48:51], v[92:95], v[40:43], a[48:51]
  ds_read_b128 v[76:79], v15 offset:41984
  v_mfma_f32_16x16x32_bf16 a[52:55], v[96:99], v[40:43], a[52:55]
  ds_read_b128 v[80:83], v15 offset:44032
  v_mfma_f32_16x16x32_bf16 a[56:59], v[100:103], v[40:43], a[56:59]
  ds_read_b128 v[84:87], v15 offset:46080
  v_mfma_f32_16x16x32_bf16 a[60:63], v[104:107], v[40:43], a[60:63]
  ds_read_b128 v[88:91], v15 offset:48128
  v_mfma_f32_16x16x32_bf16 a[64:67], v[92:95], v[44:47], a[64:67]
  v_mfma_f32_16x16x32_bf16 a[68:71], v[96:99], v[44:47], a[68:71]
  v_mfma_f32_16x16x32_bf16 a[72:75], v[100:103], v[44:47], a[72:75]
  v_mfma_f32_16x16x32_bf16 a[76:79], v[104:107], v[44:47], a[76:79]
  v_mfma_f32_16x16x32_bf16 a[80:83], v[92:95], v[48:51], a[80:83]
  v_mfma_f32_16x16x32_bf16 a[84:87], v[96:99], v[48:51], a[84:87]
  v_mfma_f32_16x16x32_bf16 a[88:91], v[100:103], v[48:51], a[88:91]
  v_mfma_f32_16x16x32_bf16 a[92:95], v[104:107], v[48:51], a[92:95]
  v_mfma_f32_16x16x32_bf16 a[96:99], v[92:95], v[52:55], a[96:99]
  v_mfma_f32_16x16x32_bf16 a[100:103], v[96:99], v[52:55], a[100:103]
  v_mfma_f32_16x16x32_bf16 a[104:107], v[100:103], v[52:55], a[104:107]
  v_mfma_f32_16x16x32_bf16 a[108:111], v[104:107], v[52:55], a[108:111]
  v_mfma_f32_16x16x32_bf16 a[112:115], v[92:95], v[56:59], a[112:115]
  v_mfma_f32_16x16x32_bf16 a[116:119], v[96:99], v[56:59], a[116:119]
  v_mfma_f32_16x16x32_bf16 a[120:123], v[100:103], v[56:59], a[120:123]
  v_mfma_f32_16x16x32_bf16 a[124:127], v[104:107], v[56:59], a[124:127]
  s_waitcnt lgkmcnt(0)
  v_mfma_f32_16x16x32_bf16 a[0:3], v[108:111], v[60:63], a[0:3]
  s_waitcnt vmcnt(0)
  s_barrier
  v_mfma_f32_16x16x32_bf16 a[4:7], v[112:115], v[60:63], a[4:7]
  ds_read_b128 v[28:31], v14 offset:0
  v_mfma_f32_16x16x32_bf16 a[8:11], v[116:119], v[60:63], a[8:11]
  ds_read_b64_tr_b16 v[92:93], v17 offset:32768
  v_mfma_f32_16x16x32_bf16 a[12:15], v[120:123], v[60:63], a[12:15]
  ds_read_b64_tr_b16 v[94:95], v17 offset:36864
  v_mfma_f32_16x16x32_bf16 a[16:19], v[108:111], v[64:67], a[16:19]
  ds_read_b128 v[32:35], v14 offset:2048
  v_mfma_f32_16x16x32_bf16 a[20:23], v[112:115], v[64:67], a[20:23]
  ds_read_b64_tr_b16 v[96:97], v17 offset:32776
  v_mfma_f32_16x16x32_bf16 a[24:27], v[116:119], v[64:67], a[24:27]
  ds_read_b64_tr_b16 v[98:99], v17 offset:36872
  v_mfma_f32_16x16x32_bf16 a[28:31], v[120:123], v[64:67], a[28:31]
  ds_read_b128 v[36:39], v14 offset:4096
  v_mfma_f32_16x16x32_bf16 a[32:35], v[108:111], v[68:71], a[32:35]
  ds_read_b64_tr_b16 v[100:101], v18 offset:32768
  v_mfma_f32_16x16x32_bf16 a[36:39], v[112:115], v[68:71], a[36:39]
  ds_read_b64_tr_b16 v[102:103], v18 offset:36864
  v_mfma_f32_16x16x32_bf16 a[40:43], v[116:119], v[68:71], a[40:43]
  ds_read_b128 v[40:43], v14 offset:6144
  v_mfma_f32_16x16x32_bf16 a[44:47], v[120:123], v[68:71], a[44:47]
  ds_read_b64_tr_b16 v[104:105], v18 offset:32776
  v_mfma_f32_16x16x32_bf16 a[48:51], v[108:111], v[72:75], a[48:51]
  ds_read_b64_tr_b16 v[106:107], v18 offset:36872
  v_mfma_f32_16x16x32_bf16 a[52:55], v[112:115], v[72:75], a[52:55]
  ds_read_b128 v[44:47], v14 offset:8192
  v_mfma_f32_16x16x32_bf16 a[56:59], v[116:119], v[72:75], a[56:59]
  ds_read_b128 v[48:51], v14 offset:10240
  v_mfma_f32_16x16x32_bf16 a[60:63], v[120:123], v[72:75], a[60:63]
  ds_read_b128 v[52:55], v14 offset:12288
  v_mfma_f32_16x16x32_bf16 a[64:67], v[108:111], v[76:79], a[64:67]
  ds_read_b128 v[56:59], v14 offset:14336
  v_mfma_f32_16x16x32_bf16 a[68:71], v[112:115], v[76:79], a[68:71]
  v_mfma_f32_16x16x32_bf16 a[72:75], v[116:119], v[76:79], a[72:75]
  v_mfma_f32_16x16x32_bf16 a[76:79], v[120:123], v[76:79], a[76:79]
  v_mfma_f32_16x16x32_bf16 a[80:83], v[108:111], v[80:83], a[80:83]
  v_mfma_f32_16x16x32_bf16 a[84:87], v[112:115], v[80:83], a[84:87]
  v_mfma_f32_16x16x32_bf16 a[88:91], v[116:119], v[80:83], a[88:91]
  v_mfma_f32_16x16x32_bf16 a[92:95], v[120:123], v[80:83], a[92:95]
  v_mfma_f32_16x16x32_bf16 a[96:99], v[108:111], v[84:87], a[96:99]
  v_mfma_f32_16x16x32_bf16 a[100:103], v[112:115], v[84:87], a[100:103]
  v_mfma_f32_16x16x32_bf16 a[104:107], v[116:119], v[84:87], a[104:107]
  v_mfma_f32_16x16x32_bf16 a[108:111], v[120:123], v[84:87], a[108:111]
  v_mfma_f32_16x16x32_bf16 a[112:115], v[108:111], v[88:91], a[112:115]
  v_mfma_f32_16x16x32_bf16 a[116:119], v[112:115], v[88:91], a[116:119]
  v_mfma_f32_16x16x32_bf16 a[120:123], v[116:119], v[88:91], a[120:123]
  v_mfma_f32_16x16x32_bf16 a[124:127], v[120:123], v[88:91], a[124:127]
  s_waitcnt lgkmcnt(0)
  v_mfma_f32_16x16x32_bf16 a[0:3], v[92:95], v[28:31], a[0:3]
  ds_read_b128 v[60:63], v14 offset:1024
  v_mfma_f32_16x16x32_bf16 a[4:7], v[96:99], v[28:31], a[4:7]
  ds_read_b64_tr_b16 v[108:109], v17 offset:40960
  v_mfma_f32_16x16x32_bf16 a[8:11], v[100:103], v[28:31], a[8:11]
  ds_read_b64_tr_b16 v[110:111], v17 offset:45056
  v_mfma_f32_16x16x32_bf16 a[12:15], v[104:107], v[28:31], a[12:15]
  ds_read_b128 v[64:67], v14 offset:3072
  v_mfma_f32_16x16x32_bf16 a[16:19], v[92:95], v[32:35], a[16:19]
  ds_read_b64_tr_b16 v[112:113], v17 offset:40968
  v_mfma_f32_16x16x32_bf16 a[20:23], v[96:99], v[32:35], a[20:23]
  ds_read_b64_tr_b16 v[114:115], v17 offset:45064
  v_mfma_f32_16x16x32_bf16 a[24:27], v[100:103], v[32:35], a[24:27]
  ds_read_b128 v[68:71], v14 offset:5120
  v_mfma_f32_16x16x32_bf16 a[28:31], v[104:107], v[32:35], a[28:31]
  ds_read_b64_tr_b16 v[116:117], v18 offset:40960
  v_mfma_f32_16x16x32_bf16 a[32:35], v[92:95], v[36:39], a[32:35]
  ds_read_b64_tr_b16 v[118:119], v18 offset:45056
  v_mfma_f32_16x16x32_bf16 a[36:39], v[96:99], v[36:39], a[36:39]
  ds_read_b128 v[72:75], v14 offset:7168
  v_mfma_f32_16x16x32_bf16 a[40:43], v[100:103], v[36:39], a[40:43]
  ds_read_b64_tr_b16 v[120:121], v18 offset:40968
  v_mfma_f32_16x16x32_bf16 a[44:47], v[104:107], v[36:39], a[44:47]
  ds_read_b64_tr_b16 v[122:123], v18 offset:45064
  v_mfma_f32_16x16x32_bf16 a[48:51], v[92:95], v[40:43], a[48:51]
  ds_read_b128 v[76:79], v14 offset:9216
  v_mfma_f32_16x16x32_bf16 a[52:55], v[96:99], v[40:43], a[52:55]
  ds_read_b128 v[80:83], v14 offset:11264
  v_mfma_f32_16x16x32_bf16 a[56:59], v[100:103], v[40:43], a[56:59]
  ds_read_b128 v[84:87], v14 offset:13312
  v_mfma_f32_16x16x32_bf16 a[60:63], v[104:107], v[40:43], a[60:63]
  ds_read_b128 v[88:91], v14 offset:15360
  v_mfma_f32_16x16x32_bf16 a[64:67], v[92:95], v[44:47], a[64:67]
  v_mfma_f32_16x16x32_bf16 a[68:71], v[96:99], v[44:47], a[68:71]
  v_mfma_f32_16x16x32_bf16 a[72:75], v[100:103], v[44:47], a[72:75]
  v_mfma_f32_16x16x32_bf16 a[76:79], v[104:107], v[44:47], a[76:79]
  v_mfma_f32_16x16x32_bf16 a[80:83], v[92:95], v[48:51], a[80:83]
  v_mfma_f32_16x16x32_bf16 a[84:87], v[96:99], v[48:51], a[84:87]
  v_mfma_f32_16x16x32_bf16 a[88:91], v[100:103], v[48:51], a[88:91]
  v_mfma_f32_16x16x32_bf16 a[92:95], v[104:107], v[48:51], a[92:95]
  v_mfma_f32_16x16x32_bf16 a[96:99], v[92:95], v[52:55], a[96:99]
  v_mfma_f32_16x16x32_bf16 a[100:103], v[96:99], v[52:55], a[100:103]
  v_mfma_f32_16x16x32_bf16 a[104:107], v[100:103], v[52:55], a[104:107]
  v_mfma_f32_16x16x32_bf16 a[108:111], v[104:107], v[52:55], a[108:111]
  v_mfma_f32_16x16x32_bf16 a[112:115], v[92:95], v[56:59], a[112:115]
  v_mfma_f32_16x16x32_bf16 a[116:119], v[96:99], v[56:59], a[116:119]
  v_mfma_f32_16x16x32_bf16 a[120:123], v[100:103], v[56:59], a[120:123]
  v_mfma_f32_16x16x32_bf16 a[124:127], v[104:107], v[56:59], a[124:127]
  s_waitcnt lgkmcnt(0)
  v_mfma_f32_16x16x32_bf16 a[0:3], v[108:111], v[60:63], a[0:3]
  v_mfma_f32_16x16x32_bf16 a[4:7], v[112:115], v[60:63], a[4:7]
  v_mfma_f32_16x16x32_bf16 a[8:11], v[116:119], v[60:63], a[8:11]
  v_mfma_f32_16x16x32_bf16 a[12:15], v[120:123], v[60:63], a[12:15]
  v_mfma_f32_16x16x32_bf16 a[16:19], v[108:111], v[64:67], a[16:19]
  v_mfma_f32_16x16x32_bf16 a[20:23], v[112:115], v[64:67], a[20:23]
  v_mfma_f32_16x16x32_bf16 a[24:27], v[116:119], v[64:67], a[24:27]
  v_mfma_f32_16x16x32_bf16 a[28:31], v[120:123], v[64:67], a[28:31]
  v_mfma_f32_16x16x32_bf16 a[32:35], v[108:111], v[68:71], a[32:35]
  v_mfma_f32_16x16x32_bf16 a[36:39], v[112:115], v[68:71], a[36:39]
  v_mfma_f32_16x16x32_bf16 a[40:43], v[116:119], v[68:71], a[40:43]
  v_mfma_f32_16x16x32_bf16 a[44:47], v[120:123], v[68:71], a[44:47]
  v_mfma_f32_16x16x32_bf16 a[48:51], v[108:111], v[72:75], a[48:51]
  v_mfma_f32_16x16x32_bf16 a[52:55], v[112:115], v[72:75], a[52:55]
  v_mfma_f32_16x16x32_bf16 a[56:59], v[116:119], v[72:75], a[56:59]
  v_mfma_f32_16x16x32_bf16 a[60:63], v[120:123], v[72:75], a[60:63]
  v_mfma_f32_16x16x32_bf16 a[64:67], v[108:111], v[76:79], a[64:67]
  v_mfma_f32_16x16x32_bf16 a[68:71], v[112:115], v[76:79], a[68:71]
  v_mfma_f32_16x16x32_bf16 a[72:75], v[116:119], v[76:79], a[72:75]
  v_mfma_f32_16x16x32_bf16 a[76:79], v[120:123], v[76:79], a[76:79]
  v_mfma_f32_16x16x32_bf16 a[80:83], v[108:111], v[80:83], a[80:83]
  v_mfma_f32_16x16x32_bf16 a[84:87], v[112:115], v[80:83], a[84:87]
  v_mfma_f32_16x16x32_bf16 a[88:91], v[116:119], v[80:83], a[88:91]
  v_mfma_f32_16x16x32_bf16 a[92:95], v[120:123], v[80:83], a[92:95]
  v_mfma_f32_16x16x32_bf16 a[96:99], v[108:111], v[84:87], a[96:99]
  v_mfma_f32_16x16x32_bf16 a[100:103], v[112:115], v[84:87], a[100:103]
  v_mfma_f32_16x16x32_bf16 a[104:107], v[116:119], v[84:87], a[104:107]
  v_mfma_f32_16x16x32_bf16 a[108:111], v[120:123], v[84:87], a[108:111]
  v_mfma_f32_16x16x32_bf16 a[112:115], v[108:111], v[88:91], a[112:115]
  v_mfma_f32_16x16x32_bf16 a[116:119], v[112:115], v[88:91], a[116:119]
  v_mfma_f32_16x16x32_bf16 a[120:123], v[116:119], v[88:91], a[120:123]
  v_mfma_f32_16x16x32_bf16 a[124:127], v[120:123], v[88:91], a[124:127]
  s_mov_b32 s59, 6
  s_mov_b32 s60, s22
  s_mov_b32 s61, s26
  s_add_u32 s62, s38, 0x3d00000
  s_mov_b32 s63, s98
  s_cmp_eq_u32 s35, 16
  s_cselect_b32 s90, 999, s34
  s_cmp_lt_u32 s90, 242
  s_cbranch_scc1 L_got
  s_mov_b32 s58, 3
  s_branch L_epi
L_g3c:
  v_and_b32 v1, 63, v0
  v_lshrrev_b32 v16, 6, v0
  s_nop 0
  v_readfirstlane_b32 s27, v16
  s_mul_i32 s90, s27, 1
  s_mul_i32 s90, s90, s23
  v_mov_b32 v2, 0x0
  v_bfe_u32 v17, v1, 0, 6
  v_lshl_add_u32 v2, v17, 4, v2
  v_add_u32 v2, s90, v2
  v_mov_b32 v3, 0x400
  v_bfe_u32 v17, v1, 0, 6
  v_lshl_add_u32 v3, v17, 4, v3
  v_add_u32 v3, s90, v3
  v_mov_b32 v4, 0x1000
  v_bfe_u32 v17, v1, 0, 6
  v_lshl_add_u32 v4, v17, 4, v4
  v_add_u32 v4, s90, v4
  v_mov_b32 v5, 0x1400
  v_bfe_u32 v17, v1, 0, 6
  v_lshl_add_u32 v5, v17, 4, v5
  v_add_u32 v5, s90, v5
  s_mul_i32 s90, s27, 16
  v_lshrrev_b32 v16, 4, v1
  v_add_u32 v16, 0, v16
  v_add_u32 v16, s90, v16
  v_and_b32 v17, 7, v16
  v_lshlrev_b32 v17, 1, v17
  v_xor_b32 v17, v17, v1
  v_and_b32 v17, 15, v17
  v_mul_lo_u32 v16, v16, s24
  v_lshl_add_u32 v6, v17, 4, v16
  v_lshrrev_b32 v16, 4, v1
  v_add_u32 v16, 4, v16
  v_add_u32 v16, s90, v16
  v_and_b32 v17, 7, v16
  v_lshlrev_b32 v17, 1, v17
  v_xor_b32 v17, v17, v1
  v_and_b32 v17, 15, v17
  v_mul_lo_u32 v16, v16, s24
  v_lshl_add_u32 v7, v17, 4, v16
  v_lshrrev_b32 v16, 4, v1
  v_add_u32 v16, 8, v16
  v_add_u32 v16, s90, v16
  v_and_b32 v17, 7, v16
  v_lshlrev_b32 v17, 1, v17
  v_xor_b32 v17, v17, v1
  v_and_b32 v17, 15, v17
  v_mul_lo_u32 v16, v16, s24
  v_lshl_add_u32 v8, v17, 4, v16
  v_lshrrev_b32 v16, 4, v1
  v_add_u32 v16, 12, v16
  v_add_u32 v16, s90, v16
  v_and_b32 v17, 7, v16
  v_lshlrev_b32 v17, 1, v17
  v_xor_b32 v17, v17, v1
  v_and_b32 v17, 15, v17
  v_mul_lo_u32 v16, v16, s24
  v_lshl_add_u32 v9, v17, 4, v16
  s_mul_i32 s51, s24, 64
  s_mul_i32 s52, s27, 4096
  s_mul_i32 s53, s27, 4096
  s_add_u32 s53, s53, 16384
  s_add_u32 m0, s53, 0
  s_nop 0
  buffer_load_dwordx4 v6, s[12:15], s21 offen  lds
  s_add_u32 m0, s53, 1024
  s_nop 0
  buffer_load_dwordx4 v7, s[12:15], s21 offen  lds
  s_add_u32 m0, s53, 2048
  s_nop 0
  buffer_load_dwordx4 v8, s[12:15], s21 offen  lds
  s_add_u32 m0, s53, 3072
  s_nop 0
  buffer_load_dwordx4 v9, s[12:15], s21 offen  lds
  s_add_u32 s21, s21, s51
  s_add_u32 m0, s53, 32768
  s_nop 0
  buffer_load_dwordx4 v6, s[12:15], s21 offen  lds
  s_add_u32 m0, s53, 33792
  s_nop 0
  buffer_load_dwordx4 v7, s[12:15], s21 offen  lds
  s_add_u32 m0, s53, 34816
  s_nop 0
  buffer_load_dwordx4 v8, s[12:15], s21 offen  lds
  s_add_u32 m0, s53, 35840
  s_nop 0
  buffer_load_dwordx4 v9, s[12:15], s21 offen  lds
  s_add_u32 s21, s21, s51
  s_add_u32 m0, s53, 65536
  s_nop 0
  buffer_load_dwordx4 v6, s[12:15], s21 offen  lds
  s_add_u32 m0, s53, 66560
  s_nop 0
  buffer_load_dwordx4 v7, s[12:15], s21 offen  lds
  s_add_u32 m0, s53, 67584
  s_nop 0
  buffer_load_dwordx4 v8, s[12:15], s21 offen  lds
  s_add_u32 m0, s53, 68608
  s_nop 0
  buffer_load_dwordx4 v9, s[12:15], s21 offen  lds
  s_add_u32 s21, s21, s51
  s_add_u32 m0, s53, 98304
  s_nop 0
  buffer_load_dwordx4 v6, s[12:15], s21 offen  lds
  s_add_u32 m0, s53, 99328
  s_nop 0
  buffer_load_dwordx4 v7, s[12:15], s21 offen  lds
  s_add_u32 m0, s53, 100352
  s_nop 0
  buffer_load_dwordx4 v8, s[12:15], s21 offen  lds
  s_add_u32 m0, s53, 101376
  s_nop 0
  buffer_load_dwordx4 v9, s[12:15], s21 offen  lds
  s_add_u32 s21, s21, s51
  s_cmp_lg_u32 s32, 0
  s_cbranch_scc1 L_dd_103
  v_mov_b32 v228, 0x3d00000
  v_mov_b32 v229, 0x3d01000
L_dw_102:
  buffer_load_dword v234, v228, s[4:7], s40 offen offset:0 sc1
  buffer_load_dword v235, v228, s[4:7], s42 offen offset:0 sc1
  buffer_load_dword v236, v229, s[4:7], 0 offen offset:1024 sc1
  s_waitcnt vmcnt(0)
  s_mov_b32 s44, 1
  v_readfirstlane_b32 s45, v234
  s_cmp_ge_u32 s45, s41
  s_cselect_b32 s44, s44, 0
  v_readfirstlane_b32 s45, v235
  s_cmp_ge_u32 s45, s41
  s_cselect_b32 s44, s44, 0
  v_readfirstlane_b32 s45, v236
  s_cmp_ge_u32 s45, 16
  s_cselect_b32 s44, s44, 0
  s_cmp_eq_u32 s44, 1
  s_cbranch_scc1 L_dd_103
  s_sleep 3
  s_add_u32 s3, s3, 1
  s_cmp_lt_u32 s3, 131072
  s_cbranch_scc1 L_dw_102
L_dd_103:
  s_barrier
  s_add_u32 m0, s52, 0
  s_nop 0
  buffer_load_dwordx4 v2, s[8:11], s20 offen sc1 lds
  s_add_u32 m0, s52, 1024
  s_nop 0
  buffer_load_dwordx4 v3, s[8:11], s20 offen sc1 lds
  s_add_u32 m0, s52, 2048
  s_nop 0
  buffer_load_dwordx4 v4, s[8:11], s20 offen sc1 lds
  s_add_u32 m0, s52, 3072
  s_nop 0
  buffer_load_dwordx4 v5, s[8:11], s20 offen sc1 lds
  s_add_u32 s20, s20, 2048
  s_add_u32 m0, s52, 32768
  s_nop 0
  buffer_load_dwordx4 v2, s[8:11], s20 offen sc1 lds
  s_add_u32 m0, s52, 33792
  s_nop 0
  buffer_load_dwordx4 v3, s[8:11], s20 offen sc1 lds
  s_add_u32 m0, s52, 34816
  s_nop 0
  buffer_load_dwordx4 v4, s[8:11], s20 offen sc1 lds
  s_add_u32 m0, s52, 35840
  s_nop 0
  buffer_load_dwordx4 v5, s[8:11], s20 offen sc1 lds
  s_add_u32 s20, s20, 6144
  s_add_u32 m0, s52, 65536
  s_nop 0
  buffer_load_dwordx4 v2, s[8:11], s20 offen sc1 lds
  s_add_u32 m0, s52, 66560
  s_nop 0
  buffer_load_dwordx4 v3, s[8:11], s20 offen sc1 lds
  s_add_u32 m0, s52, 67584
  s_nop 0
  buffer_load_dwordx4 v4, s[8:11], s20 offen sc1 lds
  s_add_u32 m0, s52, 68608
  s_nop 0
  buffer_load_dwordx4 v5, s[8:11], s20 offen sc1 lds
  s_add_u32 s20, s20, 2048
  s_add_u32 m0, s52, 98304
  s_nop 0
  buffer_load_dwordx4 v2, s[8:11], s20 offen sc1 lds
  s_add_u32 m0, s52, 99328
  s_nop 0
  buffer_load_dwordx4 v3, s[8:11], s20 offen sc1 lds
  s_add_u32 m0, s52, 100352
  s_nop 0
  buffer_load_dwordx4 v4, s[8:11], s20 offen sc1 lds
  s_add_u32 m0, s52, 101376
  s_nop 0
  buffer_load_dwordx4 v5, s[8:11], s20 offen sc1 lds
  s_add_u32 s20, s20, 6144
  s_lshr_b32 s90, s27, 1
  s_and_b32 s91, s27, 1
  s_mul_i32 s92, s90, 8192
  v_mov_b32 v10, 0x0
  v_bfe_u32 v17, v1, 0, 6
  v_lshl_add_u32 v10, v17, 4, v10
  v_add_u32 v10, s92, v10
  v_add_u32 v11, 65536, v10
  v_mov_b32 v16, 0x0
  v_bfe_u32 v17, v1, 2, 2
  v_lshl_add_u32 v16, v17, 8, v16
  v_bfe_u32 v17, v1, 4, 2
  v_lshl_add_u32 v16, v17, 10, v16
  v_bfe_u32 v17, v1, 0, 1
  v_lshl_add_u32 v16, v17, 4, v16
  v_bfe_u32 v18, v1, 2, 3
  v_bfe_u32 v17, v1, 1, 1
  v_xor_b32 v18, v18, v17
  s_mul_i32 s92, s91, 4
  s_add_u32 s93, s92, 0
  v_xor_b32 v17, s93, v18
  v_lshl_add_u32 v12, v17, 5, v16
  v_add_u32 v14, 65536, v12
  s_add_u32 s93, s92, 2
  v_xor_b32 v17, s93, v18
  v_lshl_add_u32 v13, v17, 5, v16
  v_add_u32 v15, 65536, v13
  s_waitcnt vmcnt(12)
  s_barrier
  ds_read_b128 v[20:23], v10 offset:0
  ds_read_b64_tr_b16 v[52:53], v12 offset:16384
  ds_read_b64_tr_b16 v[54:55], v12 offset:20480
  ds_read_b128 v[24:27], v10 offset:2048
  ds_read_b64_tr_b16 v[56:57], v12 offset:16392
  ds_read_b64_tr_b16 v[58:59], v12 offset:20488
  ds_read_b128 v[28:31], v10 offset:4096
  ds_read_b64_tr_b16 v[60:61], v13 offset:16384
  ds_read_b64_tr_b16 v[62:63], v13 offset:20480
  ds_read_b128 v[32:35], v10 offset:6144
  ds_read_b64_tr_b16 v[64:65], v13 offset:16392
  ds_read_b64_tr_b16 v[66:67], v13 offset:20488
  s_sub_u32 s25, s25, 1
  s_waitcnt lgkmcnt(0)
  v_mfma_f32_16x16x32_bf16 a[0:3], v[52:55], v[20:23], 0
  ds_read_b128 v[36:39], v10 offset:1024
  v_mfma_f32_16x16x32_bf16 a[4:7], v[56:59], v[20:23], 0
  ds_read_b64_tr_b16 v[68:69], v12 offset:24576
  v_mfma_f32_16x16x32_bf16 a[8:11], v[60:63], v[20:23], 0
  ds_read_b64_tr_b16 v[70:71], v12 offset:28672
  v_mfma_f32_16x16x32_bf16 a[12:15], v[64:67], v[20:23], 0
  ds_read_b128 v[40:43], v10 offset:3072
  v_mfma_f32_16x16x32_bf16 a[16:19], v[52:55], v[24:27], 0
  ds_read_b64_tr_b16 v[72:73], v12 offset:24584
  v_mfma_f32_16x16x32_bf16 a[20:23], v[56:59], v[24:27], 0
  ds_read_b64_tr_b16 v[74:75], v12 offset:28680
  v_mfma_f32_16x16x32_bf16 a[24:27], v[60:63], v[24:27], 0
  ds_read_b128 v[44:47], v10 offset:5120
  v_mfma_f32_16x16x32_bf16 a[28:31], v[64:67], v[24:27], 0
  ds_read_b64_tr_b16 v[76:77], v13 offset:24576
  v_mfma_f32_16x16x32_bf16 a[32:35], v[52:55], v[28:31], 0
  ds_read_b64_tr_b16 v[78:79], v13 offset:28672
  v_mfma_f32_16x16x32_bf16 a[36:39], v[56:59], v[28:31], 0
  ds_read_b128 v[48:51], v10 offset:7168
  v_mfma_f32_16x16x32_bf16 a[40:43], v[60:63], v[28:31], 0
  ds_read_b64_tr_b16 v[80:81], v13 offset:24584
  v_mfma_f32_16x16x32_bf16 a[44:47], v[64:67], v[28:31], 0
  ds_read_b64_tr_b16 v[82:83], v13 offset:28680
  v_mfma_f32_16x16x32_bf16 a[48:51], v[52:55], v[32:35], 0
  v_mfma_f32_16x16x32_bf16 a[52:55], v[56:59], v[32:35], 0
  v_mfma_f32_16x16x32_bf16 a[56:59], v[60:63], v[32:35], 0
  v_mfma_f32_16x16x32_bf16 a[60:63], v[64:67], v[32:35], 0
  s_waitcnt lgkmcnt(0)
  v_mfma_f32_16x16x32_bf16 a[0:3], v[68:71], v[36:39], a[0:3]
  s_waitcnt vmcnt(8)
  s_barrier
  s_add_u32 m0, s52, 0
  v_mfma_f32_16x16x32_bf16 a[4:7], v[72:75], v[36:39], a[4:7]
  buffer_load_dwordx4 v2, s[8:11], s20 offen sc1 lds
  ds_read_b128 v[20:23], v10 offset:32768
  v_mfma_f32_16x16x32_bf16 a[8:11], v[76:79], v[36:39], a[8:11]
  ds_read_b64_tr_b16 v[52:53], v12 offset:49152
  v_mfma_f32_16x16x32_bf16 a[12:15], v[80:83], v[36:39], a[12:15]
  ds_read_b64_tr_b16 v[54:55], v12 offset:53248
  s_add_u32 m0, s53, 0
  v_mfma_f32_16x16x32_bf16 a[16:19], v[68:71], v[40:43], a[16:19]
  buffer_load_dwordx4 v6, s[12:15], s21 offen  lds
  ds_read_b128 v[24:27], v10 offset:34816
  v_mfma_f32_16x16x32_bf16 a[20:23], v[72:75], v[40:43], a[20:23]
  ds_read_b64_tr_b16 v[56:57], v12 offset:49160
  v_mfma_f32_16x16x32_bf16 a[24:27], v[76:79], v[40:43], a[24:27]
  ds_read_b64_tr_b16 v[58:59], v12 offset:53256
  s_add_u32 m0, s52, 1024
  v_mfma_f32_16x16x32_bf16 a[28:31], v[80:83], v[40:43], a[28:31]
  buffer_load_dwordx4 v3, s[8:11], s20 offen sc1 lds
  ds_read_b128 v[28:31], v10 offset:36864
  v_mfma_f32_16x16x32_bf16 a[32:35], v[68:71], v[44:47], a[32:35]
  ds_read_b64_tr_b16 v[60:61], v13 offset:49152
  v_mfma_f32_16x16x32_bf16 a[36:39], v[72:75], v[44:47], a[36:39]
  ds_read_b64_tr_b16 v[62:63], v13 offset:53248
  s_add_u32 m0, s53, 1024
  v_mfma_f32_16x16x32_bf16 a[40:43], v[76:79], v[44:47], a[40:43]
  buffer_load_dwordx4 v7, s[12:15], s21 offen  lds
  ds_read_b128 v[32:35], v10 offset:38912
  v_mfma_f32_16x16x32_bf16 a[44:47], v[80:83], v[44:47], a[44:47]
  ds_read_b64_tr_b16 v[64:65], v13 offset:49160
  v_mfma_f32_16x16x32_bf16 a[48:51], v[68:71], v[48:51], a[48:51]
  ds_read_b64_tr_b16 v[66:67], v13 offset:53256
  s_add_u32 m0, s52, 2048
  v_mfma_f32_16x16x32_bf16 a[52:55], v[72:75], v[48:51], a[52:55]
  buffer_load_dwordx4 v4, s[8:11], s20 offen sc1 lds
  v_mfma_f32_16x16x32_bf16 a[56:59], v[76:79], v[48:51], a[56:59]
  v_mfma_f32_16x16x32_bf16 a[60:63], v[80:83], v[48:51], a[60:63]
  s_waitcnt lgkmcnt(0)
  s_add_u32 m0, s53, 2048
  v_mfma_f32_16x16x32_bf16 a[0:3], v[52:55], v[20:23], a[0:3]
  buffer_load_dwordx4 v8, s[12:15], s21 offen  lds
  ds_read_b128 v[36:39], v10 offset:33792
  v_mfma_f32_16x16x32_bf16 a[4:7], v[56:59], v[20:23], a[4:7]
  ds_read_b64_tr_b16 v[68:69], v12 offset:57344
  v_mfma_f32_16x16x32_bf16 a[8:11], v[60:63], v[20:23], a[8:11]
  ds_read_b64_tr_b16 v[70:71], v12 offset:61440
  v_mfma_f32_16x16x32_bf16 a[12:15], v[64:67], v[20:23], a[12:15]
  ds_read_b128 v[40:43], v10 offset:35840
  s_add_u32 m0, s52, 3072
  v_mfma_f32_16x16x32_bf16 a[16:19], v[52:55], v[24:27], a[16:19]
  buffer_load_dwordx4 v5, s[8:11], s20 offen sc1 lds
  ds_read_b64_tr_b16 v[72:73], v12 offset:57352
  v_mfma_f32_16x16x32_bf16 a[20:23], v[56:59], v[24:27], a[20:23]
  ds_read_b64_tr_b16 v[74:75], v12 offset:61448
  v_mfma_f32_16x16x32_bf16 a[24:27], v[60:63], v[24:27], a[24:27]
  ds_read_b128 v[44:47], v10 offset:37888
  v_mfma_f32_16x16x32_bf16 a[28:31], v[64:67], v[24:27], a[28:31]
  ds_read_b64_tr_b16 v[76:77], v13 offset:57344
  s_add_u32 m0, s53, 3072
  v_mfma_f32_16x16x32_bf16 a[32:35], v[52:55], v[28:31], a[32:35]
  buffer_load_dwordx4 v9, s[12:15], s21 offen  lds
  ds_read_b64_tr_b16 v[78:79], v13 offset:61440
  v_mfma_f32_16x16x32_bf16 a[36:39], v[56:59], v[28:31], a[36:39]
  ds_read_b128 v[48:51], v10 offset:39936
  v_mfma_f32_16x16x32_bf16 a[40:43], v[60:63], v[28:31], a[40:43]
  ds_read_b64_tr_b16 v[80:81], v13 offset:57352
  v_mfma_f32_16x16x32_bf16 a[44:47], v[64:67], v[28:31], a[44:47]
  ds_read_b64_tr_b16 v[82:83], v13 offset:61448
  s_add_u32 s20, s20, 2048
  v_mfma_f32_16x16x32_bf16 a[48:51], v[52:55], v[32:35], a[48:51]
  s_add_u32 s21, s21, s51
  v_mfma_f32_16x16x32_bf16 a[52:55], v[56:59], v[32:35], a[52:55]
  v_mfma_f32_16x16x32_bf16 a[56:59], v[60:63], v[32:35], a[56:59]
  v_mfma_f32_16x16x32_bf16 a[60:63], v[64:67], v[32:35], a[60:63]
  s_waitcnt lgkmcnt(0)
  v_mfma_f32_16x16x32_bf16 a[0:3], v[68:71], v[36:39], a[0:3]
  s_waitcnt vmcnt(12)
  s_barrier
  s_add_u32 m0, s52, 32768
  v_mfma_f32_16x16x32_bf16 a[4:7], v[72:75], v[36:39], a[4:7]
  buffer_load_dwordx4 v2, s[8:11], s20 offen sc1 lds
  ds_read_b128 v[20:23], v11 offset:0
  v_mfma_f32_16x16x32_bf16 a[8:11], v[76:79], v[36:39], a[8:11]
  ds_read_b64_tr_b16 v[52:53], v14 offset:16384
  v_mfma_f32_16x16x32_bf16 a[12:15], v[80:83], v[36:39], a[12:15]
  ds_read_b64_tr_b16 v[54:55], v14 offset:20480
  s_add_u32 m0, s53, 32768
  v_mfma_f32_16x16x32_bf16 a[16:19], v[68:71], v[40:43], a[16:19]
  buffer_load_dwordx4 v6, s[12:15], s21 offen  lds
  ds_read_b128 v[24:27], v11 offset:2048
  v_mfma_f32_16x16x32_bf16 a[20:23], v[72:75], v[40:43], a[20:23]
  ds_read_b64_tr_b16 v[56:57], v14 offset:16392
  v_mfma_f32_16x16x32_bf16 a[24:27], v[76:79], v[40:43], a[24:27]
  ds_read_b64_tr_b16 v[58:59], v14 offset:20488
  s_add_u32 m0, s52, 33792
  v_mfma_f32_16x16x32_bf16 a[28:31], v[80:83], v[40:43], a[28:31]
  buffer_load_dwordx4 v3, s[8:11], s20 offen sc1 lds
  ds_read_b128 v[28:31], v11 offset:4096
  v_mfma_f32_16x16x32_bf16 a[32:35], v[68:71], v[44:47], a[32:35]
  ds_read_b64_tr_b16 v[60:61], v15 offset:16384
  v_mfma_f32_16x16x32_bf16 a[36:39], v[72:75], v[44:47], a[36:39]
  ds_read_b64_tr_b16 v[62:63], v15 offset:20480
  s_add_u32 m0, s53, 33792
  v_mfma_f32_16x16x32_bf16 a[40:43], v[76:79], v[44:47], a[40:43]
  buffer_load_dwordx4 v7, s[12:15], s21 offen  lds
  ds_read_b128 v[32:35], v11 offset:6144
  v_mfma_f32_16x16x32_bf16 a[44:47], v[80:83], v[44:47], a[44:47]
  ds_read_b64_tr_b16 v[64:65], v15 offset:16392
  v_mfma_f32_16x16x32_bf16 a[48:51], v[68:71], v[48:51], a[48:51]
  ds_read_b64_tr_b16 v[66:67], v15 offset:20488
  s_add_u32 m0, s52, 34816
  v_mfma_f32_16x16x32_bf16 a[52:55], v[72:75], v[48:51], a[52:55]
  buffer_load_dwordx4 v4, s[8:11], s20 offen sc1 lds
  v_mfma_f32_16x16x32_bf16 a[56:59], v[76:79], v[48:51], a[56:59]
  v_mfma_f32_16x16x32_bf16 a[60:63], v[80:83], v[48:51], a[60:63]
  s_waitcnt lgkmcnt(0)
  s_add_u32 m0, s53, 34816
  v_mfma_f32_16x16x32_bf16 a[0:3], v[52:55], v[20:23], a[0:3]
  buffer_load_dwordx4 v8, s[12:15], s21 offen  lds
  ds_read_b128 v[36:39], v11 offset:1024
  v_mfma_f32_16x16x32_bf16 a[4:7], v[56:59], v[20:23], a[4:7]
  ds_read_b64_tr_b16 v[68:69], v14 offset:24576
  v_mfma_f32_16x16x32_bf16 a[8:11], v[60:63], v[20:23], a[8:11]
  ds_read_b64_tr_b16 v[70:71], v14 offset:28672
  v_mfma_f32_16x16x32_bf16 a[12:15], v[64:67], v[20:23], a[12:15]
  ds_read_b128 v[40:43], v11 offset:3072
  s_add_u32 m0, s52, 35840
  v_mfma_f32_16x16x32_bf16 a[16:19], v[52:55], v[24:27], a[16:19]
  buffer_load_dwordx4 v5, s[8:11], s20 offen sc1 lds
  ds_read_b64_tr_b16 v[72:73], v14 offset:24584
  v_mfma_f32_16x16x32_bf16 a[20:23], v[56:59], v[24:27], a[20:23]
  ds_read_b64_tr_b16 v[74:75], v14 offset:28680
  v_mfma_f32_16x16x32_bf16 a[24:27], v[60:63], v[24:27], a[24:27]
  ds_read_b128 v[44:47], v11 offset:5120
  v_mfma_f32_16x16x32_bf16 a[28:31], v[64:67], v[24:27], a[28:31]
  ds_read_b64_tr_b16 v[76:77], v15 offset:24576
  s_add_u32 m0, s53, 35840
  v_mfma_f32_16x16x32_bf16 a[32:35], v[52:55], v[28:31], a[32:35]
  buffer_load_dwordx4 v9, s[12:15], s21 offen  lds
  ds_read_b64_tr_b16 v[78:79], v15 offset:28672
  v_mfma_f32_16x16x32_bf16 a[36:39], v[56:59], v[28:31], a[36:39]
  ds_read_b128 v[48:51], v11 offset:7168
  v_mfma_f32_16x16x32_bf16 a[40:43], v[60:63], v[28:31], a[40:43]
  ds_read_b64_tr_b16 v[80:81], v15 offset:24584
  v_mfma_f32_16x16x32_bf16 a[44:47], v[64:67], v[28:31], a[44:47]
  ds_read_b64_tr_b16 v[82:83], v15 offset:28680
  s_add_u32 s20, s20, 6144
  v_mfma_f32_16x16x32_bf16 a[48:51], v[52:55], v[32:35], a[48:51]
  s_add_u32 s21, s21, s51
  v_mfma_f32_16x16x32_bf16 a[52:55], v[56:59], v[32:35], a[52:55]
  v_mfma_f32_16x16x32_bf16 a[56:59], v[60:63], v[32:35], a[56:59]
  v_mfma_f32_16x16x32_bf16 a[60:63], v[64:67], v[32:35], a[60:63]
  s_waitcnt lgkmcnt(0)
  v_mfma_f32_16x16x32_bf16 a[0:3], v[68:71], v[36:39], a[0:3]
  s_waitcnt vmcnt(16)
  s_barrier
  s_add_u32 m0, s52, 65536
  v_mfma_f32_16x16x32_bf16 a[4:7], v[72:75], v[36:39], a[4:7]
  buffer_load_dwordx4 v2, s[8:11], s20 offen sc1 lds
  ds_read_b128 v[20:23], v11 offset:32768
  v_mfma_f32_16x16x32_bf16 a[8:11], v[76:79], v[36:39], a[8:11]
  ds_read_b64_tr_b16 v[52:53], v14 offset:49152
  v_mfma_f32_16x16x32_bf16 a[12:15], v[80:83], v[36:39], a[12:15]
  ds_read_b64_tr_b16 v[54:55], v14 offset:53248
  s_add_u32 m0, s53, 65536
  v_mfma_f32_16x16x32_bf16 a[16:19], v[68:71], v[40:43], a[16:19]
  buffer_load_dwordx4 v6, s[12:15], s21 offen  lds
  ds_read_b128 v[24:27], v11 offset:34816
  v_mfma_f32_16x16x32_bf16 a[20:23], v[72:75], v[40:43], a[20:23]
  ds_read_b64_tr_b16 v[56:57], v14 offset:49160
  v_mfma_f32_16x16x32_bf16 a[24:27], v[76:79], v[40:43], a[24:27]
  ds_read_b64_tr_b16 v[58:59], v14 offset:53256
  s_add_u32 m0, s52, 66560
  v_mfma_f32_16x16x32_bf16 a[28:31], v[80:83], v[40:43], a[28:31]
  buffer_load_dwordx4 v3, s[8:11], s20 offen sc1 lds
  ds_read_b128 v[28:31], v11 offset:36864
  v_mfma_f32_16x16x32_bf16 a[32:35], v[68:71], v[44:47], a[32:35]
  ds_read_b64_tr_b16 v[60:61], v15 offset:49152
  v_mfma_f32_16x16x32_bf16 a[36:39], v[72:75], v[44:47], a[36:39]
  ds_read_b64_tr_b16 v[62:63], v15 offset:53248
  s_add_u32 m0, s53, 66560
  v_mfma_f32_16x16x32_bf16 a[40:43], v[76:79], v[44:47], a[40:43]
  buffer_load_dwordx4 v7, s[12:15], s21 offen  lds
  ds_read_b128 v[32:35], v11 offset:38912
  v_mfma_f32_16x16x32_bf16 a[44:47], v[80:83], v[44:47], a[44:47]
  ds_read_b64_tr_b16 v[64:65], v15 offset:49160
  v_mfma_f32_16x16x32_bf16 a[48:51], v[68:71], v[48:51], a[48:51]
  ds_read_b64_tr_b16 v[66:67], v15 offset:53256
  s_add_u32 m0, s52, 67584
  v_mfma_f32_16x16x32_bf16 a[52:55], v[72:75], v[48:51], a[52:55]
  buffer_load_dwordx4 v4, s[8:11], s20 offen sc1 lds
  v_mfma_f32_16x16x32_bf16 a[56:59], v[76:79], v[48:51], a[56:59]
  v_mfma_f32_16x16x32_bf16 a[60:63], v[80:83], v[48:51], a[60:63]
  s_waitcnt lgkmcnt(0)
  s_add_u32 m0, s53, 67584
  v_mfma_f32_16x16x32_bf16 a[0:3], v[52:55], v[20:23], a[0:3]
  buffer_load_dwordx4 v8, s[12:15], s21 offen  lds
  ds_read_b128 v[36:39], v11 offset:33792
  v_mfma_f32_16x16x32_bf16 a[4:7], v[56:59], v[20:23], a[4:7]
  ds_read_b64_tr_b16 v[68:69], v14 offset:57344
  v_mfma_f32_16x16x32_bf16 a[8:11], v[60:63], v[20:23], a[8:11]
  ds_read_b64_tr_b16 v[70:71], v14 offset:61440
  v_mfma_f32_16x16x32_bf16 a[12:15], v[64:67], v[20:23], a[12:15]
  ds_read_b128 v[40:43], v11 offset:35840
  s_add_u32 m0, s52, 68608
  v_mfma_f32_16x16x32_bf16 a[16:19], v[52:55], v[24:27], a[16:19]
  buffer_load_dwordx4 v5, s[8:11], s20 offen sc1 lds
  ds_read_b64_tr_b16 v[72:73], v14 offset:57352
  v_mfma_f32_16x16x32_bf16 a[20:23], v[56:59], v[24:27], a[20:23]
  ds_read_b64_tr_b16 v[74:75], v14 offset:61448
  v_mfma_f32_16x16x32_bf16 a[24:27], v[60:63], v[24:27], a[24:27]
  ds_read_b128 v[44:47], v11 offset:37888
  v_mfma_f32_16x16x32_bf16 a[28:31], v[64:67], v[24:27], a[28:31]
  ds_read_b64_tr_b16 v[76:77], v15 offset:57344
  s_add_u32 m0, s53, 68608
  v_mfma_f32_16x16x32_bf16 a[32:35], v[52:55], v[28:31], a[32:35]
  buffer_load_dwordx4 v9, s[12:15], s21 offen  lds
  ds_read_b64_tr_b16 v[78:79], v15 offset:61440
  v_mfma_f32_16x16x32_bf16 a[36:39], v[56:59], v[28:31], a[36:39]
  ds_read_b128 v[48:51], v11 offset:39936
  v_mfma_f32_16x16x32_bf16 a[40:43], v[60:63], v[28:31], a[40:43]
  ds_read_b64_tr_b16 v[80:81], v15 offset:57352
  v_mfma_f32_16x16x32_bf16 a[44:47], v[64:67], v[28:31], a[44:47]
  ds_read_b64_tr_b16 v[82:83], v15 offset:61448
  s_add_u32 s20, s20, 2048
  v_mfma_f32_16x16x32_bf16 a[48:51], v[52:55], v[32:35], a[48:51]
  s_add_u32 s21, s21, s51
  v_mfma_f32_16x16x32_bf16 a[52:55], v[56:59], v[32:35], a[52:55]
  v_mfma_f32_16x16x32_bf16 a[56:59], v[60:63], v[32:35], a[56:59]
  v_mfma_f32_16x16x32_bf16 a[60:63], v[64:67], v[32:35], a[60:63]
  s_waitcnt lgkmcnt(0)
  v_mfma_f32_16x16x32_bf16 a[0:3], v[68:71], v[36:39], a[0:3]
  s_waitcnt vmcnt(16)
  s_barrier
  s_add_u32 m0, s52, 98304
  v_mfma_f32_16x16x32_bf16 a[4:7], v[72:75], v[36:39], a[4:7]
  buffer_load_dwordx4 v2, s[8:11], s20 offen sc1 lds
  ds_read_b128 v[20:23], v10 offset:0
  v_mfma_f32_16x16x32_bf16 a[8:11], v[76:79], v[36:39], a[8:11]
  ds_read_b64_tr_b16 v[52:53], v12 offset:16384
  v_mfma_f32_16x16x32_bf16 a[12:15], v[80:83], v[36:39], a[12:15]
  ds_read_b64_tr_b16 v[54:55], v12 offset:20480
  s_add_u32 m0, s53, 98304
  v_mfma_f32_16x16x32_bf16 a[16:19], v[68:71], v[40:43], a[16:19]
  buffer_load_dwordx4 v6, s[12:15], s21 offen  lds
  ds_read_b128 v[24:27], v10 offset:2048
  v_mfma_f32_16x16x32_bf16 a[20:23], v[72:75], v[40:43], a[20:23]
  ds_read_b64_tr_b16 v[56:57], v12 offset:16392
  v_mfma_f32_16x16x32_bf16 a[24:27], v[76:79], v[40:43], a[24:27]
  ds_read_b64_tr_b16 v[58:59], v12 offset:20488
  s_add_u32 m0, s52, 99328
  v_mfma_f32_16x16x32_bf16 a[28:31], v[80:83], v[40:43], a[28:31]
  buffer_load_dwordx4 v3, s[8:11], s20 offen sc1 lds
  ds_read_b128 v[28:31], v10 offset:4096
  v_mfma_f32_16x16x32_bf16 a[32:35], v[68:71], v[44:47], a[32:35]
  ds_read_b64_tr_b16 v[60:61], v13 offset:16384
  v_mfma_f32_16x16x32_bf16 a[36:39], v[72:75], v[44:47], a[36:39]
  ds_read_b64_tr_b16 v[62:63], v13 offset:20480
  s_add_u32 m0, s53, 99328
  v_mfma_f32_16x16x32_bf16 a[40:43], v[76:79], v[44:47], a[40:43]
  buffer_load_dwordx4 v7, s[12:15], s21 offen  lds
  ds_read_b128 v[32:35], v10 offset:6144
  v_mfma_f32_16x16x32_bf16 a[44:47], v[80:83], v[44:47], a[44:47]
  ds_read_b64_tr_b16 v[64:65], v13 offset:16392
  v_mfma_f32_16x16x32_bf16 a[48:51], v[68:71], v[48:51], a[48:51]
  ds_read_b64_tr_b16 v[66:67], v13 offset:20488
  s_add_u32 m0, s52, 100352
  v_mfma_f32_16x16x32_bf16 a[52:55], v[72:75], v[48:51], a[52:55]
  buffer_load_dwordx4 v4, s[8:11], s20 offen sc1 lds
  v_mfma_f32_16x16x32_bf16 a[56:59], v[76:79], v[48:51], a[56:59]
  v_mfma_f32_16x16x32_bf16 a[60:63], v[80:83], v[48:51], a[60:63]
L_g3_loop:
  s_sub_u32 s25, s25, 1
  s_cmp_eq_u32 s25, 0
  s_cbranch_scc1 L_g3_fin
  s_waitcnt lgkmcnt(0)
  s_add_u32 m0, s53, 100352
  v_mfma_f32_16x16x32_bf16 a[0:3], v[52:55], v[20:23], a[0:3]
  buffer_load_dwordx4 v8, s[12:15], s21 offen  lds
  ds_read_b128 v[36:39], v10 offset:1024
  v_mfma_f32_16x16x32_bf16 a[4:7], v[56:59], v[20:23], a[4:7]
  ds_read_b64_tr_b16 v[68:69], v12 offset:24576
  v_mfma_f32_16x16x32_bf16 a[8:11], v[60:63], v[20:23], a[8:11]
  ds_read_b64_tr_b16 v[70:71], v12 offset:28672
  v_mfma_f32_16x16x32_bf16 a[12:15], v[64:67], v[20:23], a[12:15]
  ds_read_b128 v[40:43], v10 offset:3072
  s_add_u32 m0, s52, 101376
  v_mfma_f32_16x16x32_bf16 a[16:19], v[52:55], v[24:27], a[16:19]
  buffer_load_dwordx4 v5, s[8:11], s20 offen sc1 lds
  ds_read_b64_tr_b16 v[72:73], v12 offset:24584
  v_mfma_f32_16x16x32_bf16 a[20:23], v[56:59], v[24:27], a[20:23]
  ds_read_b64_tr_b16 v[74:75], v12 offset:28680
  v_mfma_f32_16x16x32_bf16 a[24:27], v[60:63], v[24:27], a[24:27]
  ds_read_b128 v[44:47], v10 offset:5120
  v_mfma_f32_16x16x32_bf16 a[28:31], v[64:67], v[24:27], a[28:31]
  ds_read_b64_tr_b16 v[76:77], v13 offset:24576
  s_add_u32 m0, s53, 101376
  v_mfma_f32_16x16x32_bf16 a[32:35], v[52:55], v[28:31], a[32:35]
  buffer_load_dwordx4 v9, s[12:15], s21 offen  lds
  ds_read_b64_tr_b16 v[78:79], v13 offset:28672
  v_mfma_f32_16x16x32_bf16 a[36:39], v[56:59], v[28:31], a[36:39]
  ds_read_b128 v[48:51], v10 offset:7168
  v_mfma_f32_16x16x32_bf16 a[40:43], v[60:63], v[28:31], a[40:43]
  ds_read_b64_tr_b16 v[80:81], v13 offset:24584
  v_mfma_f32_16x16x32_bf16 a[44:47], v[64:67], v[28:31], a[44:47]
  ds_read_b64_tr_b16 v[82:83], v13 offset:28680
  s_add_u32 s20, s20, 6144
  v_mfma_f32_16x16x32_bf16 a[48:51], v[52:55], v[32:35], a[48:51]
  s_add_u32 s21, s21, s51
  v_mfma_f32_16x16x32_bf16 a[52:55], v[56:59], v[32:35], a[52:55]
  v_mfma_f32_16x16x32_bf16 a[56:59], v[60:63], v[32:35], a[56:59]
  v_mfma_f32_16x16x32_bf16 a[60:63], v[64:67], v[32:35], a[60:63]
  s_waitcnt lgkmcnt(0)
  v_mfma_f32_16x16x32_bf16 a[0:3], v[68:71], v[36:39], a[0:3]
  s_waitcnt vmcnt(16)
  s_barrier
  s_add_u32 m0, s52, 0
  v_mfma_f32_16x16x32_bf16 a[4:7], v[72:75], v[36:39], a[4:7]
  buffer_load_dwordx4 v2, s[8:11], s20 offen sc1 lds
  ds_read_b128 v[20:23], v10 offset:32768
  v_mfma_f32_16x16x32_bf16 a[8:11], v[76:79], v[36:39], a[8:11]
  ds_read_b64_tr_b16 v[52:53], v12 offset:49152
  v_mfma_f32_16x16x32_bf16 a[12:15], v[80:83], v[36:39], a[12:15]
  ds_read_b64_tr_b16 v[54:55], v12 offset:53248
  s_add_u32 m0, s53, 0
  v_mfma_f32_16x16x32_bf16 a[16:19], v[68:71], v[40:43], a[16:19]
  buffer_load_dwordx4 v6, s[12:15], s21 offen  lds
  ds_read_b128 v[24:27], v10 offset:34816
  v_mfma_f32_16x16x32_bf16 a[20:23], v[72:75], v[40:43], a[20:23]
  ds_read_b64_tr_b16 v[56:57], v12 offset:49160
  v_mfma_f32_16x16x32_bf16 a[24:27], v[76:79], v[40:43], a[24:27]
  ds_read_b64_tr_b16 v[58:59], v12 offset:53256
  s_add_u32 m0, s52, 1024
  v_mfma_f32_16x16x32_bf16 a[28:31], v[80:83], v[40:43], a[28:31]
  buffer_load_dwordx4 v3, s[8:11], s20 offen sc1 lds
  ds_read_b128 v[28:31], v10 offset:36864
  v_mfma_f32_16x16x32_bf16 a[32:35], v[68:71], v[44:47], a[32:35]
  ds_read_b64_tr_b16 v[60:61], v13 offset:49152
  v_mfma_f32_16x16x32_bf16 a[36:39], v[72:75], v[44:47], a[36:39]
  ds_read_b64_tr_b16 v[62:63], v13 offset:53248
  s_add_u32 m0, s53, 1024
  v_mfma_f32_16x16x32_bf16 a[40:43], v[76:79], v[44:47], a[40:43]
  buffer_load_dwordx4 v7, s[12:15], s21 offen  lds
  ds_read_b128 v[32:35], v10 offset:38912
  v_mfma_f32_16x16x32_bf16 a[44:47], v[80:83], v[44:47], a[44:47]
  ds_read_b64_tr_b16 v[64:65], v13 offset:49160
  v_mfma_f32_16x16x32_bf16 a[48:51], v[68:71], v[48:51], a[48:51]
  ds_read_b64_tr_b16 v[66:67], v13 offset:53256
  s_add_u32 m0, s52, 2048
  v_mfma_f32_16x16x32_bf16 a[52:55], v[72:75], v[48:51], a[52:55]
  buffer_load_dwordx4 v4, s[8:11], s20 offen sc1 lds
  v_mfma_f32_16x16x32_bf16 a[56:59], v[76:79], v[48:51], a[56:59]
  v_mfma_f32_16x16x32_bf16 a[60:63], v[80:83], v[48:51], a[60:63]
  s_waitcnt lgkmcnt(0)
  s_add_u32 m0, s53, 2048
  v_mfma_f32_16x16x32_bf16 a[0:3], v[52:55], v[20:23], a[0:3]
  buffer_load_dwordx4 v8, s[12:15], s21 offen  lds
  ds_read_b128 v[36:39], v10 offset:33792
  v_mfma_f32_16x16x32_bf16 a[4:7], v[56:59], v[20:23], a[4:7]
  ds_read_b64_tr_b16 v[68:69], v12 offset:57344
  v_mfma_f32_16x16x32_bf16 a[8:11], v[60:63], v[20:23], a[8:11]
  ds_read_b64_tr_b16 v[70:71], v12 offset:61440
  v_mfma_f32_16x16x32_bf16 a[12:15], v[64:67], v[20:23], a[12:15]
  ds_read_b128 v[40:43], v10 offset:35840
  s_add_u32 m0, s52, 3072
  v_mfma_f32_16x16x32_bf16 a[16:19], v[52:55], v[24:27], a[16:19]
  buffer_load_dwordx4 v5, s[8:11], s20 offen sc1 lds
  ds_read_b64_tr_b16 v[72:73], v12 offset:57352
  v_mfma_f32_16x16x32_bf16 a[20:23], v[56:59], v[24:27], a[20:23]
  ds_read_b64_tr_b16 v[74:75], v12 offset:61448
  v_mfma_f32_16x16x32_bf16 a[24:27], v[60:63], v[24:27], a[24:27]
  ds_read_b128 v[44:47], v10 offset:37888
  v_mfma_f32_16x16x32_bf16 a[28:31], v[64:67], v[24:27], a[28:31]
  ds_read_b64_tr_b16 v[76:77], v13 offset:57344
  s_add_u32 m0, s53, 3072
  v_mfma_f32_16x16x32_bf16 a[32:35], v[52:55], v[28:31], a[32:35]
  buffer_load_dwordx4 v9, s[12:15], s21 offen  lds
  ds_read_b64_tr_b16 v[78:79], v13 offset:61440
  v_mfma_f32_16x16x32_bf16 a[36:39], v[56:59], v[28:31], a[36:39]
  ds_read_b128 v[48:51], v10 offset:39936
  v_mfma_f32_16x16x32_bf16 a[40:43], v[60:63], v[28:31], a[40:43]
  ds_read_b64_tr_b16 v[80:81], v13 offset:57352
  v_mfma_f32_16x16x32_bf16 a[44:47], v[64:67], v[28:31], a[44:47]
  ds_read_b64_tr_b16 v[82:83], v13 offset:61448
  s_add_u32 s20, s20, 2048
  v_mfma_f32_16x16x32_bf16 a[48:51], v[52:55], v[32:35], a[48:51]
  s_add_u32 s21, s21, s51
  v_mfma_f32_16x16x32_bf16 a[52:55], v[56:59], v[32:35], a[52:55]
  v_mfma_f32_16x16x32_bf16 a[56:59], v[60:63], v[32:35], a[56:59]
  v_mfma_f32_16x16x32_bf16 a[60:63], v[64:67], v[32:35], a[60:63]
  s_waitcnt lgkmcnt(0)
  v_mfma_f32_16x16x32_bf16 a[0:3], v[68:71], v[36:39], a[0:3]
  s_waitcnt vmcnt(16)
  s_barrier
  s_add_u32 m0, s52, 32768
  v_mfma_f32_16x16x32_bf16 a[4:7], v[72:75], v[36:39], a[4:7]
  buffer_load_dwordx4 v2, s[8:11], s20 offen sc1 lds
  ds_read_b128 v[20:23], v11 offset:0
  v_mfma_f32_16x16x32_bf16 a[8:11], v[76:79], v[36:39], a[8:11]
  ds_read_b64_tr_b16 v[52:53], v14 offset:16384
  v_mfma_f32_16x16x32_bf16 a[12:15], v[80:83], v[36:39], a[12:15]
  ds_read_b64_tr_b16 v[54:55], v14 offset:20480
  s_add_u32 m0, s53, 32768
  v_mfma_f32_16x16x32_bf16 a[16:19], v[68:71], v[40:43], a[16:19]
  buffer_load_dwordx4 v6, s[12:15], s21 offen  lds
  ds_read_b128 v[24:27], v11 offset:2048
  v_mfma_f32_16x16x32_bf16 a[20:23], v[72:75], v[40:43], a[20:23]
  ds_read_b64_tr_b16 v[56:57], v14 offset:16392
  v_mfma_f32_16x16x32_bf16 a[24:27], v[76:79], v[40:43], a[24:27]
  ds_read_b64_tr_b16 v[58:59], v14 offset:20488
  s_add_u32 m0, s52, 33792
  v_mfma_f32_16x16x32_bf16 a[28:31], v[80:83], v[40:43], a[28:31]
  buffer_load_dwordx4 v3, s[8:11], s20 offen sc1 lds
  ds_read_b128 v[28:31], v11 offset:4096
  v_mfma_f32_16x16x32_bf16 a[32:35], v[68:71], v[44:47], a[32:35]
  ds_read_b64_tr_b16 v[60:61], v15 offset:16384
  v_mfma_f32_16x16x32_bf16 a[36:39], v[72:75], v[44:47], a[36:39]
  ds_read_b64_tr_b16 v[62:63], v15 offset:20480
  s_add_u32 m0, s53, 33792
  v_mfma_f32_16x16x32_bf16 a[40:43], v[76:79], v[44:47], a[40:43]
  buffer_load_dwordx4 v7, s[12:15], s21 offen  lds
  ds_read_b128 v[32:35], v11 offset:6144
  v_mfma_f32_16x16x32_bf16 a[44:47], v[80:83], v[44:47], a[44:47]
  ds_read_b64_tr_b16 v[64:65], v15 offset:16392
  v_mfma_f32_16x16x32_bf16 a[48:51], v[68:71], v[48:51], a[48:51]
  ds_read_b64_tr_b16 v[66:67], v15 offset:20488
  s_add_u32 m0, s52, 34816
  v_mfma_f32_16x16x32_bf16 a[52:55], v[72:75], v[48:51], a[52:55]
  buffer_load_dwordx4 v4, s[8:11], s20 offen sc1 lds
  v_mfma_f32_16x16x32_bf16 a[56:59], v[76:79], v[48:51], a[56:59]
  v_mfma_f32_16x16x32_bf16 a[60:63], v[80:83], v[48:51], a[60:63]
  s_waitcnt lgkmcnt(0)
  s_add_u32 m0, s53, 34816
  v_mfma_f32_16x16x32_bf16 a[0:3], v[52:55], v[20:23], a[0:3]
  buffer_load_dwordx4 v8, s[12:15], s21 offen  lds
  ds_read_b128 v[36:39], v11 offset:1024
  v_mfma_f32_16x16x32_bf16 a[4:7], v[56:59], v[20:23], a[4:7]
  ds_read_b64_tr_b16 v[68:69], v14 offset:24576
  v_mfma_f32_16x16x32_bf16 a[8:11], v[60:63], v[20:23], a[8:11]
  ds_read_b64_tr_b16 v[70:71], v14 offset:28672
  v_mfma_f32_16x16x32_bf16 a[12:15], v[64:67], v[20:23], a[12:15]
  ds_read_b128 v[40:43], v11 offset:3072
  s_add_u32 m0, s52, 35840
  v_mfma_f32_16x16x32_bf16 a[16:19], v[52:55], v[24:27], a[16:19]
  buffer_load_dwordx4 v5, s[8:11], s20 offen sc1 lds
  ds_read_b64_tr_b16 v[72:73], v14 offset:24584
  v_mfma_f32_16x16x32_bf16 a[20:23], v[56:59], v[24:27], a[20:23]
  ds_read_b64_tr_b16 v[74:75], v14 offset:28680
  v_mfma_f32_16x16x32_bf16 a[24:27], v[60:63], v[24:27], a[24:27]
  ds_read_b128 v[44:47], v11 offset:5120
  v_mfma_f32_16x16x32_bf16 a[28:31], v[64:67], v[24:27], a[28:31]
  ds_read_b64_tr_b16 v[76:77], v15 offset:24576
  s_add_u32 m0, s53, 35840
  v_mfma_f32_16x16x32_bf16 a[32:35], v[52:55], v[28:31], a[32:35]
  buffer_load_dwordx4 v9, s[12:15], s21 offen  lds
  ds_read_b64_tr_b16 v[78:79], v15 offset:28672
  v_mfma_f32_16x16x32_bf16 a[36:39], v[56:59], v[28:31], a[36:39]
  ds_read_b128 v[48:51], v11 offset:7168
  v_mfma_f32_16x16x32_bf16 a[40:43], v[60:63], v[28:31], a[40:43]
  ds_read_b64_tr_b16 v[80:81], v15 offset:24584
  v_mfma_f32_16x16x32_bf16 a[44:47], v[64:67], v[28:31], a[44:47]
  ds_read_b64_tr_b16 v[82:83], v15 offset:28680
  s_add_u32 s20, s20, 6144
  v_mfma_f32_16x16x32_bf16 a[48:51], v[52:55], v[32:35], a[48:51]
  s_add_u32 s21, s21, s51
  v_mfma_f32_16x16x32_bf16 a[52:55], v[56:59], v[32:35], a[52:55]
  v_mfma_f32_16x16x32_bf16 a[56:59], v[60:63], v[32:35], a[56:59]
  v_mfma_f32_16x16x32_bf16 a[60:63], v[64:67], v[32:35], a[60:63]
  s_waitcnt lgkmcnt(0)
  v_mfma_f32_16x16x32_bf16 a[0:3], v[68:71], v[36:39], a[0:3]
  s_waitcnt vmcnt(16)
  s_barrier
  s_add_u32 m0, s52, 65536
  v_mfma_f32_16x16x32_bf16 a[4:7], v[72:75], v[36:39], a[4:7]
  buffer_load_dwordx4 v2, s[8:11], s20 offen sc1 lds
  ds_read_b128 v[20:23], v11 offset:32768
  v_mfma_f32_16x16x32_bf16 a[8:11], v[76:79], v[36:39], a[8:11]
  ds_read_b64_tr_b16 v[52:53], v14 offset:49152
  v_mfma_f32_16x16x32_bf16 a[12:15], v[80:83], v[36:39], a[12:15]
  ds_read_b64_tr_b16 v[54:55], v14 offset:53248
  s_add_u32 m0, s53, 65536
  v_mfma_f32_16x16x32_bf16 a[16:19], v[68:71], v[40:43], a[16:19]
  buffer_load_dwordx4 v6, s[12:15], s21 offen  lds
  ds_read_b128 v[24:27], v11 offset:34816
  v_mfma_f32_16x16x32_bf16 a[20:23], v[72:75], v[40:43], a[20:23]
  ds_read_b64_tr_b16 v[56:57], v14 offset:49160
  v_mfma_f32_16x16x32_bf16 a[24:27], v[76:79], v[40:43], a[24:27]
  ds_read_b64_tr_b16 v[58:59], v14 offset:53256
  s_add_u32 m0, s52, 66560
  v_mfma_f32_16x16x32_bf16 a[28:31], v[80:83], v[40:43], a[28:31]
  buffer_load_dwordx4 v3, s[8:11], s20 offen sc1 lds
  ds_read_b128 v[28:31], v11 offset:36864
  v_mfma_f32_16x16x32_bf16 a[32:35], v[68:71], v[44:47], a[32:35]
  ds_read_b64_tr_b16 v[60:61], v15 offset:49152
  v_mfma_f32_16x16x32_bf16 a[36:39], v[72:75], v[44:47], a[36:39]
  ds_read_b64_tr_b16 v[62:63], v15 offset:53248
  s_add_u32 m0, s53, 66560
  v_mfma_f32_16x16x32_bf16 a[40:43], v[76:79], v[44:47], a[40:43]
  buffer_load_dwordx4 v7, s[12:15], s21 offen  lds
  ds_read_b128 v[32:35], v11 offset:38912
  v_mfma_f32_16x16x32_bf16 a[44:47], v[80:83], v[44:47], a[44:47]
  ds_read_b64_tr_b16 v[64:65], v15 offset:49160
  v_mfma_f32_16x16x32_bf16 a[48:51], v[68:71], v[48:51], a[48:51]
  ds_read_b64_tr_b16 v[66:67], v15 offset:53256
  s_add_u32 m0, s52, 67584
  v_mfma_f32_16x16x32_bf16 a[52:55], v[72:75], v[48:51], a[52:55]
  buffer_load_dwordx4 v4, s[8:11], s20 offen sc1 lds
  v_mfma_f32_16x16x32_bf16 a[56:59], v[76:79], v[48:51], a[56:59]
  v_mfma_f32_16x16x32_bf16 a[60:63], v[80:83], v[48:51], a[60:63]
  s_waitcnt lgkmcnt(0)
  s_add_u32 m0, s53, 67584
  v_mfma_f32_16x16x32_bf16 a[0:3], v[52:55], v[20:23], a[0:3]
  buffer_load_dwordx4 v8, s[12:15], s21 offen  lds
  ds_read_b128 v[36:39], v11 offset:33792
  v_mfma_f32_16x16x32_bf16 a[4:7], v[56:59], v[20:23], a[4:7]
  ds_read_b64_tr_b16 v[68:69], v14 offset:57344
  v_mfma_f32_16x16x32_bf16 a[8:11], v[60:63], v[20:23], a[8:11]
  ds_read_b64_tr_b16 v[70:71], v14 offset:61440
  v_mfma_f32_16x16x32_bf16 a[12:15], v[64:67], v[20:23], a[12:15]
  ds_read_b128 v[40:43], v11 offset:35840
  s_add_u32 m0, s52, 68608
  v_mfma_f32_16x16x32_bf16 a[16:19], v[52:55], v[24:27], a[16:19]
  buffer_load_dwordx4 v5, s[8:11], s20 offen sc1 lds
  ds_read_b64_tr_b16 v[72:73], v14 offset:57352
  v_mfma_f32_16x16x32_bf16 a[20:23], v[56:59], v[24:27], a[20:23]
  ds_read_b64_tr_b16 v[74:75], v14 offset:61448
  v_mfma_f32_16x16x32_bf16 a[24:27], v[60:63], v[24:27], a[24:27]
  ds_read_b128 v[44:47], v11 offset:37888
  v_mfma_f32_16x16x32_bf16 a[28:31], v[64:67], v[24:27], a[28:31]
  ds_read_b64_tr_b16 v[76:77], v15 offset:57344
  s_add_u32 m0, s53, 68608
  v_mfma_f32_16x16x32_bf16 a[32:35], v[52:55], v[28:31], a[32:35]
  buffer_load_dwordx4 v9, s[12:15], s21 offen  lds
  ds_read_b64_tr_b16 v[78:79], v15 offset:61440
  v_mfma_f32_16x16x32_bf16 a[36:39], v[56:59], v[28:31], a[36:39]
  ds_read_b128 v[48:51], v11 offset:39936
  v_mfma_f32_16x16x32_bf16 a[40:43], v[60:63], v[28:31], a[40:43]
  ds_read_b64_tr_b16 v[80:81], v15 offset:57352
  v_mfma_f32_16x16x32_bf16 a[44:47], v[64:67], v[28:31], a[44:47]
  ds_read_b64_tr_b16 v[82:83], v15 offset:61448
  s_add_u32 s20, s20, 2048
  v_mfma_f32_16x16x32_bf16 a[48:51], v[52:55], v[32:35], a[48:51]
  s_add_u32 s21, s21, s51
  v_mfma_f32_16x16x32_bf16 a[52:55], v[56:59], v[32:35], a[52:55]
  v_mfma_f32_16x16x32_bf16 a[56:59], v[60:63], v[32:35], a[56:59]
  v_mfma_f32_16x16x32_bf16 a[60:63], v[64:67], v[32:35], a[60:63]
  s_waitcnt lgkmcnt(0)
  v_mfma_f32_16x16x32_bf16 a[0:3], v[68:71], v[36:39], a[0:3]
  s_waitcnt vmcnt(16)
  s_barrier
  s_add_u32 m0, s52, 98304
  v_mfma_f32_16x16x32_bf16 a[4:7], v[72:75], v[36:39], a[4:7]
  buffer_load_dwordx4 v2, s[8:11], s20 offen sc1 lds
  ds_read_b128 v[20:23], v10 offset:0
  v_mfma_f32_16x16x32_bf16 a[8:11], v[76:79], v[36:39], a[8:11]
  ds_read_b64_tr_b16 v[52:53], v12 offset:16384
  v_mfma_f32_16x16x32_bf16 a[12:15], v[80:83], v[36:39], a[12:15]
  ds_read_b64_tr_b16 v[54:55], v12 offset:20480
  s_add_u32 m0, s53, 98304
  v_mfma_f32_16x16x32_bf16 a[16:19], v[68:71], v[40:43], a[16:19]
  buffer_load_dwordx4 v6, s[12:15], s21 offen  lds
  ds_read_b128 v[24:27], v10 offset:2048
  v_mfma_f32_16x16x32_bf16 a[20:23], v[72:75], v[40:43], a[20:23]
  ds_read_b64_tr_b16 v[56:57], v12 offset:16392
  v_mfma_f32_16x16x32_bf16 a[24:27], v[76:79], v[40:43], a[24:27]
  ds_read_b64_tr_b16 v[58:59], v12 offset:20488
  s_add_u32 m0, s52, 99328
  v_mfma_f32_16x16x32_bf16 a[28:31], v[80:83], v[40:43], a[28:31]
  buffer_load_dwordx4 v3, s[8:11], s20 offen sc1 lds
  ds_read_b128 v[28:31], v10 offset:4096
  v_mfma_f32_16x16x32_bf16 a[32:35], v[68:71], v[44:47], a[32:35]
  ds_read_b64_tr_b16 v[60:61], v13 offset:16384
  v_mfma_f32_16x16x32_bf16 a[36:39], v[72:75], v[44:47], a[36:39]
  ds_read_b64_tr_b16 v[62:63], v13 offset:20480
  s_add_u32 m0, s53, 99328
  v_mfma_f32_16x16x32_bf16 a[40:43], v[76:79], v[44:47], a[40:43]
  buffer_load_dwordx4 v7, s[12:15], s21 offen  lds
  ds_read_b128 v[32:35], v10 offset:6144
  v_mfma_f32_16x16x32_bf16 a[44:47], v[80:83], v[44:47], a[44:47]
  ds_read_b64_tr_b16 v[64:65], v13 offset:16392
  v_mfma_f32_16x16x32_bf16 a[48:51], v[68:71], v[48:51], a[48:51]
  ds_read_b64_tr_b16 v[66:67], v13 offset:20488
  s_add_u32 m0, s52, 100352
  v_mfma_f32_16x16x32_bf16 a[52:55], v[72:75], v[48:51], a[52:55]
  buffer_load_dwordx4 v4, s[8:11], s20 offen sc1 lds
  v_mfma_f32_16x16x32_bf16 a[56:59], v[76:79], v[48:51], a[56:59]
  v_mfma_f32_16x16x32_bf16 a[60:63], v[80:83], v[48:51], a[60:63]
  s_branch L_g3_loop
L_g3_fin:
  s_cmp_ge_u32 s35, 8
  s_cbranch_scc1 L_r3_104
  s_cmp_eq_u32 s35, 16
  s_cselect_b32 s90, 999, s34
  s_cmp_lt_u32 s90, 242
  s_cbranch_scc0 L_re_105
  s_cmp_lg_u32 s32, 0
  s_cbranch_scc1 L_rq_106
  s_cmp_eq_u32 s39, 0
  s_cbranch_scc1 L_rq_106
  s_lshl_b32 s99, s33, 7
  s_add_u32 s99, s99, 0x3d00200
  v_mov_b32 v244, 1
  v_mov_b32 v245, 0
  s_mov_b64 exec, 1
  buffer_atomic_add v244, v245, s[4:7], s99 offen sc0 sc1
  s_mov_b64 exec, -1
L_rq_106:
L_re_105:
L_r3_104:
  s_waitcnt lgkmcnt(0)
  s_add_u32 m0, s53, 100352
  v_mfma_f32_16x16x32_bf16 a[0:3], v[52:55], v[20:23], a[0:3]
  buffer_load_dwordx4 v8, s[12:15], s21 offen  lds
  ds_read_b128 v[36:39], v10 offset:1024
  v_mfma_f32_16x16x32_bf16 a[4:7], v[56:59], v[20:23], a[4:7]
  ds_read_b64_tr_b16 v[68:69], v12 offset:24576
  v_mfma_f32_16x16x32_bf16 a[8:11], v[60:63], v[20:23], a[8:11]
  ds_read_b64_tr_b16 v[70:71], v12 offset:28672
  v_mfma_f32_16x16x32_bf16 a[12:15], v[64:67], v[20:23], a[12:15]
  ds_read_b128 v[40:43], v10 offset:3072
  s_add_u32 m0, s52, 101376
  v_mfma_f32_16x16x32_bf16 a[16:19], v[52:55], v[24:27], a[16:19]
  buffer_load_dwordx4 v5, s[8:11], s20 offen sc1 lds
  ds_read_b64_tr_b16 v[72:73], v12 offset:24584
  v_mfma_f32_16x16x32_bf16 a[20:23], v[56:59], v[24:27], a[20:23]
  ds_read_b64_tr_b16 v[74:75], v12 offset:28680
  v_mfma_f32_16x16x32_bf16 a[24:27], v[60:63], v[24:27], a[24:27]
  ds_read_b128 v[44:47], v10 offset:5120
  v_mfma_f32_16x16x32_bf16 a[28:31], v[64:67], v[24:27], a[28:31]
  ds_read_b64_tr_b16 v[76:77], v13 offset:24576
  s_add_u32 m0, s53, 101376
  v_mfma_f32_16x16x32_bf16 a[32:35], v[52:55], v[28:31], a[32:35]
  buffer_load_dwordx4 v9, s[12:15], s21 offen  lds
  ds_read_b64_tr_b16 v[78:79], v13 offset:28672
  v_mfma_f32_16x16x32_bf16 a[36:39], v[56:59], v[28:31], a[36:39]
  ds_read_b128 v[48:51], v10 offset:7168
  v_mfma_f32_16x16x32_bf16 a[40:43], v[60:63], v[28:31], a[40:43]
  ds_read_b64_tr_b16 v[80:81], v13 offset:24584
  v_mfma_f32_16x16x32_bf16 a[44:47], v[64:67], v[28:31], a[44:47]
  ds_read_b64_tr_b16 v[82:83], v13 offset:28680
  s_add_u32 s20, s20, 6144
  v_mfma_f32_16x16x32_bf16 a[48:51], v[52:55], v[32:35], a[48:51]
  s_add_u32 s21, s21, s51
  v_mfma_f32_16x16x32_bf16 a[52:55], v[56:59], v[32:35], a[52:55]
  v_mfma_f32_16x16x32_bf16 a[56:59], v[60:63], v[32:35], a[56:59]
  v_mfma_f32_16x16x32_bf16 a[60:63], v[64:67], v[32:35], a[60:63]
  s_waitcnt lgkmcnt(0)
  v_mfma_f32_16x16x32_bf16 a[0:3], v[68:71], v[36:39], a[0:3]
  s_waitcnt vmcnt(16)
  s_barrier
  v_mfma_f32_16x16x32_bf16 a[4:7], v[72:75], v[36:39], a[4:7]
  ds_read_b128 v[20:23], v10 offset:32768
  v_mfma_f32_16x16x32_bf16 a[8:11], v[76:79], v[36:39], a[8:11]
  ds_read_b64_tr_b16 v[52:53], v12 offset:49152
  v_mfma_f32_16x16x32_bf16 a[12:15], v[80:83], v[36:39], a[12:15]
  ds_read_b64_tr_b16 v[54:55], v12 offset:53248
  v_mfma_f32_16x16x32_bf16 a[16:19], v[68:71], v[40:43], a[16:19]
  ds_read_b128 v[24:27], v10 offset:34816
  v_mfma_f32_16x16x32_bf16 a[20:23], v[72:75], v[40:43], a[20:23]
  ds_read_b64_tr_b16 v[56:57], v12 offset:49160
  v_mfma_f32_16x16x32_bf16 a[24:27], v[76:79], v[40:43], a[24:27]
  ds_read_b64_tr_b16 v[58:59], v12 offset:53256
  v_mfma_f32_16x16x32_bf16 a[28:31], v[80:83], v[40:43], a[28:31]
  ds_read_b128 v[28:31], v10 offset:36864
  v_mfma_f32_16x16x32_bf16 a[32:35], v[68:71], v[44:47], a[32:35]
  ds_read_b64_tr_b16 v[60:61], v13 offset:49152
  v_mfma_f32_16x16x32_bf16 a[36:39], v[72:75], v[44:47], a[36:39]
  ds_read_b64_tr_b16 v[62:63], v13 offset:53248
  v_mfma_f32_16x16x32_bf16 a[40:43], v[76:79], v[44:47], a[40:43]
  ds_read_b128 v[32:35], v10 offset:38912
  v_mfma_f32_16x16x32_bf16 a[44:47], v[80:83], v[44:47], a[44:47]
  ds_read_b64_tr_b16 v[64:65], v13 offset:49160
  v_mfma_f32_16x16x32_bf16 a[48:51], v[68:71], v[48:51], a[48:51]
  ds_read_b64_tr_b16 v[66:67], v13 offset:53256
  v_mfma_f32_16x16x32_bf16 a[52:55], v[72:75], v[48:51], a[52:55]
  v_mfma_f32_16x16x32_bf16 a[56:59], v[76:79], v[48:51], a[56:59]
  v_mfma_f32_16x16x32_bf16 a[60:63], v[80:83], v[48:51], a[60:63]
  s_waitcnt lgkmcnt(0)
  v_mfma_f32_16x16x32_bf16 a[0:3], v[52:55], v[20:23], a[0:3]
  ds_read_b128 v[36:39], v10 offset:33792
  v_mfma_f32_16x16x32_bf16 a[4:7], v[56:59], v[20:23], a[4:7]
  ds_read_b64_tr_b16 v[68:69], v12 offset:57344
  v_mfma_f32_16x16x32_bf16 a[8:11], v[60:63], v[20:23], a[8:11]
  ds_read_b64_tr_b16 v[70:71], v12 offset:61440
  v_mfma_f32_16x16x32_bf16 a[12:15], v[64:67], v[20:23], a[12:15]
  ds_read_b128 v[40:43], v10 offset:35840
  v_mfma_f32_16x16x32_bf16 a[16:19], v[52:55], v[24:27], a[16:19]
  ds_read_b64_tr_b16 v[72:73], v12 offset:57352
  v_mfma_f32_16x16x32_bf16 a[20:23], v[56:59], v[24:27], a[20:23]
  ds_read_b64_tr_b16 v[74:75], v12 offset:61448
  v_mfma_f32_16x16x32_bf16 a[24:27], v[60:63], v[24:27], a[24:27]
  ds_read_b128 v[44:47], v10 offset:37888
  v_mfma_f32_16x16x32_bf16 a[28:31], v[64:67], v[24:27], a[28:31]
  ds_read_b64_tr_b16 v[76:77], v13 offset:57344
  v_mfma_f32_16x16x32_bf16 a[32:35], v[52:55], v[28:31], a[32:35]
  ds_read_b64_tr_b16 v[78:79], v13 offset:61440
  v_mfma_f32_16x16x32_bf16 a[36:39], v[56:59], v[28:31], a[36:39]
  ds_read_b128 v[48:51], v10 offset:39936
  v_mfma_f32_16x16x32_bf16 a[40:43], v[60:63], v[28:31], a[40:43]
  ds_read_b64_tr_b16 v[80:81], v13 offset:57352
  v_mfma_f32_16x16x32_bf16 a[44:47], v[64:67], v[28:31], a[44:47]
  ds_read_b64_tr_b16 v[82:83], v13 offset:61448
  v_mfma_f32_16x16x32_bf16 a[48:51], v[52:55], v[32:35], a[48:51]
  v_mfma_f32_16x16x32_bf16 a[52:55], v[56:59], v[32:35], a[52:55]
  v_mfma_f32_16x16x32_bf16 a[56:59], v[60:63], v[32:35], a[56:59]
  v_mfma_f32_16x16x32_bf16 a[60:63], v[64:67], v[32:35], a[60:63]
  s_waitcnt lgkmcnt(0)
  v_mfma_f32_16x16x32_bf16 a[0:3], v[68:71], v[36:39], a[0:3]
  s_waitcnt vmcnt(8)
  s_barrier
  v_mfma_f32_16x16x32_bf16 a[4:7], v[72:75], v[36:39], a[4:7]
  ds_read_b128 v[20:23], v11 offset:0
  v_mfma_f32_16x16x32_bf16 a[8:11], v[76:79], v[36:39], a[8:11]
  ds_read_b64_tr_b16 v[52:53], v14 offset:16384
  v_mfma_f32_16x16x32_bf16 a[12:15], v[80:83], v[36:39], a[12:15]
  ds_read_b64_tr_b16 v[54:55], v14 offset:20480
  v_mfma_f32_16x16x32_bf16 a[16:19], v[68:71], v[40:43], a[16:19]
  ds_read_b128 v[24:27], v11 offset:2048
  v_mfma_f32_16x16x32_bf16 a[20:23], v[72:75], v[40:43], a[20:23]
  ds_read_b64_tr_b16 v[56:57], v14 offset:16392
  v_mfma_f32_16x16x32_bf16 a[24:27], v[76:79], v[40:43], a[24:27]
  ds_read_b64_tr_b16 v[58:59], v14 offset:20488
  v_mfma_f32_16x16x32_bf16 a[28:31], v[80:83], v[40:43], a[28:31]
  ds_read_b128 v[28:31], v11 offset:4096
  v_mfma_f32_16x16x32_bf16 a[32:35], v[68:71], v[44:47], a[32:35]
  ds_read_b64_tr_b16 v[60:61], v15 offset:16384
  v_mfma_f32_16x16x32_bf16 a[36:39], v[72:75], v[44:47], a[36:39]
  ds_read_b64_tr_b16 v[62:63], v15 offset:20480
  v_mfma_f32_16x16x32_bf16 a[40:43], v[76:79], v[44:47], a[40:43]
  ds_read_b128 v[32:35], v11 offset:6144
  v_mfma_f32_16x16x32_bf16 a[44:47], v[80:83], v[44:47], a[44:47]
  ds_read_b64_tr_b16 v[64:65], v15 offset:16392
  v_mfma_f32_16x16x32_bf16 a[48:51], v[68:71], v[48:51], a[48:51]
  ds_read_b64_tr_b16 v[66:67], v15 offset:20488
  v_mfma_f32_16x16x32_bf16 a[52:55], v[72:75], v[48:51], a[52:55]
  v_mfma_f32_16x16x32_bf16 a[56:59], v[76:79], v[48:51], a[56:59]
  v_mfma_f32_16x16x32_bf16 a[60:63], v[80:83], v[48:51], a[60:63]
  s_waitcnt lgkmcnt(0)
  v_mfma_f32_16x16x32_bf16 a[0:3], v[52:55], v[20:23], a[0:3]
  ds_read_b128 v[36:39], v11 offset:1024
  v_mfma_f32_16x16x32_bf16 a[4:7], v[56:59], v[20:23], a[4:7]
  ds_read_b64_tr_b16 v[68:69], v14 offset:24576
  v_mfma_f32_16x16x32_bf16 a[8:11], v[60:63], v[20:23], a[8:11]
  ds_read_b64_tr_b16 v[70:71], v14 offset:28672
  v_mfma_f32_16x16x32_bf16 a[12:15], v[64:67], v[20:23], a[12:15]
  ds_read_b128 v[40:43], v11 offset:3072
  v_mfma_f32_16x16x32_bf16 a[16:19], v[52:55], v[24:27], a[16:19]
  ds_read_b64_tr_b16 v[72:73], v14 offset:24584
  v_mfma_f32_16x16x32_bf16 a[20:23], v[56:59], v[24:27], a[20:23]
  ds_read_b64_tr_b16 v[74:75], v14 offset:28680
  v_mfma_f32_16x16x32_bf16 a[24:27], v[60:63], v[24:27], a[24:27]
  ds_read_b128 v[44:47], v11 offset:5120
  v_mfma_f32_16x16x32_bf16 a[28:31], v[64:67], v[24:27], a[28:31]
  ds_read_b64_tr_b16 v[76:77], v15 offset:24576
  v_mfma_f32_16x16x32_bf16 a[32:35], v[52:55], v[28:31], a[32:35]
  ds_read_b64_tr_b16 v[78:79], v15 offset:28672
  v_mfma_f32_16x16x32_bf16 a[36:39], v[56:59], v[28:31], a[36:39]
  ds_read_b128 v[48:51], v11 offset:7168
  v_mfma_f32_16x16x32_bf16 a[40:43], v[60:63], v[28:31], a[40:43]
  ds_read_b64_tr_b16 v[80:81], v15 offset:24584
  v_mfma_f32_16x16x32_bf16 a[44:47], v[64:67], v[28:31], a[44:47]
  ds_read_b64_tr_b16 v[82:83], v15 offset:28680
  v_mfma_f32_16x16x32_bf16 a[48:51], v[52:55], v[32:35], a[48:51]
  v_mfma_f32_16x16x32_bf16 a[52:55], v[56:59], v[32:35], a[52:55]
  v_mfma_f32_16x16x32_bf16 a[56:59], v[60:63], v[32:35], a[56:59]
  v_mfma_f32_16x16x32_bf16 a[60:63], v[64:67], v[32:35], a[60:63]
  s_waitcnt lgkmcnt(0)
  v_mfma_f32_16x16x32_bf16 a[0:3], v[68:71], v[36:39], a[0:3]
  s_waitcnt vmcnt(0)
  s_barrier
  v_mfma_f32_16x16x32_bf16 a[4:7], v[72:75], v[36:39], a[4:7]
  ds_read_b128 v[20:23], v11 offset:32768
  v_mfma_f32_16x16x32_bf16 a[8:11], v[76:79], v[36:39], a[8:11]
  ds_read_b64_tr_b16 v[52:53], v14 offset:49152
  v_mfma_f32_16x16x32_bf16 a[12:15], v[80:83], v[36:39], a[12:15]
  ds_read_b64_tr_b16 v[54:55], v14 offset:53248
  v_mfma_f32_16x16x32_bf16 a[16:19], v[68:71], v[40:43], a[16:19]
  ds_read_b128 v[24:27], v11 offset:34816
  v_mfma_f32_16x16x32_bf16 a[20:23], v[72:75], v[40:43], a[20:23]
  ds_read_b64_tr_b16 v[56:57], v14 offset:49160
  v_mfma_f32_16x16x32_bf16 a[24:27], v[76:79], v[40:43], a[24:27]
  ds_read_b64_tr_b16 v[58:59], v14 offset:53256
  v_mfma_f32_16x16x32_bf16 a[28:31], v[80:83], v[40:43], a[28:31]
  ds_read_b128 v[28:31], v11 offset:36864
  v_mfma_f32_16x16x32_bf16 a[32:35], v[68:71], v[44:47], a[32:35]
  ds_read_b64_tr_b16 v[60:61], v15 offset:49152
  v_mfma_f32_16x16x32_bf16 a[36:39], v[72:75], v[44:47], a[36:39]
  ds_read_b64_tr_b16 v[62:63], v15 offset:53248
  v_mfma_f32_16x16x32_bf16 a[40:43], v[76:79], v[44:47], a[40:43]
  ds_read_b128 v[32:35], v11 offset:38912
  v_mfma_f32_16x16x32_bf16 a[44:47], v[80:83], v[44:47], a[44:47]
  ds_read_b64_tr_b16 v[64:65], v15 offset:49160
  v_mfma_f32_16x16x32_bf16 a[48:51], v[68:71], v[48:51], a[48:51]
  ds_read_b64_tr_b16 v[66:67], v15 offset:53256
  v_mfma_f32_16x16x32_bf16 a[52:55], v[72:75], v[48:51], a[52:55]
  v_mfma_f32_16x16x32_bf16 a[56:59], v[76:79], v[48:51], a[56:59]
  v_mfma_f32_16x16x32_bf16 a[60:63], v[80:83], v[48:51], a[60:63]
  s_waitcnt lgkmcnt(0)
  v_mfma_f32_16x16x32_bf16 a[0:3], v[52:55], v[20:23], a[0:3]
  ds_read_b128 v[36:39], v11 offset:33792
  v_mfma_f32_16x16x32_bf16 a[4:7], v[56:59], v[20:23], a[4:7]
  ds_read_b64_tr_b16 v[68:69], v14 offset:57344
  v_mfma_f32_16x16x32_bf16 a[8:11], v[60:63], v[20:23], a[8:11]
  ds_read_b64_tr_b16 v[70:71], v14 offset:61440
  v_mfma_f32_16x16x32_bf16 a[12:15], v[64:67], v[20:23], a[12:15]
  ds_read_b128 v[40:43], v11 offset:35840
  v_mfma_f32_16x16x32_bf16 a[16:19], v[52:55], v[24:27], a[16:19]
  ds_read_b64_tr_b16 v[72:73], v14 offset:57352
  v_mfma_f32_16x16x32_bf16 a[20:23], v[56:59], v[24:27], a[20:23]
  ds_read_b64_tr_b16 v[74:75], v14 offset:61448
  v_mfma_f32_16x16x32_bf16 a[24:27], v[60:63], v[24:27], a[24:27]
  ds_read_b128 v[44:47], v11 offset:37888
  v_mfma_f32_16x16x32_bf16 a[28:31], v[64:67], v[24:27], a[28:31]
  ds_read_b64_tr_b16 v[76:77], v15 offset:57344
  v_mfma_f32_16x16x32_bf16 a[32:35], v[52:55], v[28:31], a[32:35]
  ds_read_b64_tr_b16 v[78:79], v15 offset:61440
  v_mfma_f32_16x16x32_bf16 a[36:39], v[56:59], v[28:31], a[36:39]
  ds_read_b128 v[48:51], v11 offset:39936
  v_mfma_f32_16x16x32_bf16 a[40:43], v[60:63], v[28:31], a[40:43]
  ds_read_b64_tr_b16 v[80:81], v15 offset:57352
  v_mfma_f32_16x16x32_bf16 a[44:47], v[64:67], v[28:31], a[44:47]
  ds_read_b64_tr_b16 v[82:83], v15 offset:61448
  v_mfma_f32_16x16x32_bf16 a[48:51], v[52:55], v[32:35], a[48:51]
  v_mfma_f32_16x16x32_bf16 a[52:55], v[56:59], v[32:35], a[52:55]
  v_mfma_f32_16x16x32_bf16 a[56:59], v[60:63], v[32:35], a[56:59]
  v_mfma_f32_16x16x32_bf16 a[60:63], v[64:67], v[32:35], a[60:63]
  s_waitcnt lgkmcnt(0)
  v_mfma_f32_16x16x32_bf16 a[0:3], v[68:71], v[36:39], a[0:3]
  v_mfma_f32_16x16x32_bf16 a[4:7], v[72:75], v[36:39], a[4:7]
  v_mfma_f32_16x16x32_bf16 a[8:11], v[76:79], v[36:39], a[8:11]
  v_mfma_f32_16x16x32_bf16 a[12:15], v[80:83], v[36:39], a[12:15]
  v_mfma_f32_16x16x32_bf16 a[16:19], v[68:71], v[40:43], a[16:19]
  v_mfma_f32_16x16x32_bf16 a[20:23], v[72:75], v[40:43], a[20:23]
  v_mfma_f32_16x16x32_bf16 a[24:27], v[76:79], v[40:43], a[24:27]
  v_mfma_f32_16x16x32_bf16 a[28:31], v[80:83], v[40:43], a[28:31]
  v_mfma_f32_16x16x32_bf16 a[32:35], v[68:71], v[44:47], a[32:35]
  v_mfma_f32_16x16x32_bf16 a[36:39], v[72:75], v[44:47], a[36:39]
  v_mfma_f32_16x16x32_bf16 a[40:43], v[76:79], v[44:47], a[40:43]
  v_mfma_f32_16x16x32_bf16 a[44:47], v[80:83], v[44:47], a[44:47]
  v_mfma_f32_16x16x32_bf16 a[48:51], v[68:71], v[48:51], a[48:51]
  v_mfma_f32_16x16x32_bf16 a[52:55], v[72:75], v[48:51], a[52:55]
  v_mfma_f32_16x16x32_bf16 a[56:59], v[76:79], v[48:51], a[56:59]
  v_mfma_f32_16x16x32_bf16 a[60:63], v[80:83], v[48:51], a[60:63]
  s_cmp_ge_u32 s35, 8
  s_cbranch_scc1 L_part
  s_mov_b32 s59, 5
  s_mov_b32 s60, s22
  s_mov_b32 s61, s26
  s_add_u32 s62, s38, 0x3d00000
  s_mov_b32 s63, s98
  s_cmp_eq_u32 s35, 16
  s_cselect_b32 s90, 999, s34
  s_cmp_lt_u32 s90, 242
  s_cbranch_scc1 L_got
  s_mov_b32 s58, 3
  s_branch L_epi
L_part:
  s_sub_u32 s40, s36, 12
  s_lshl_b32 s40, s40, 3
  s_add_u32 s40, s40, s50
  s_lshl_b32 s41, s40, 19
  s_add_u32 s41, s41, 0x6400000
  s_lshl_b32 s90, s32, 14
  s_add_u32 s41, s41, s90
  s_lshl_b32 s90, s48, 16
  s_add_u32 s42, s41, s90
  v_lshlrev_b32 v2, 4, v1
  buffer_store_dwordx4 a[0:3], v2, s[4:7], s42 offen offset:0 sc1
  buffer_store_dwordx4 a[4:7], v2, s[4:7], s42 offen offset:1024 sc1
  buffer_store_dwordx4 a[8:11], v2, s[4:7], s42 offen offset:2048 sc1
  buffer_store_dwordx4 a[12:15], v2, s[4:7], s42 offen offset:3072 sc1
  s_add_u32 s42, s42, 4096
  buffer_store_dwordx4 a[16:19], v2, s[4:7], s42 offen offset:0 sc1
  buffer_store_dwordx4 a[20:23], v2, s[4:7], s42 offen offset:1024 sc1
  buffer_store_dwordx4 a[24:27], v2, s[4:7], s42 offen offset:2048 sc1
  buffer_store_dwordx4 a[28:31], v2, s[4:7], s42 offen offset:3072 sc1
  s_add_u32 s42, s42, 4096
  buffer_store_dwordx4 a[32:35], v2, s[4:7], s42 offen offset:0 sc1
  buffer_store_dwordx4 a[36:39], v2, s[4:7], s42 offen offset:1024 sc1
  buffer_store_dwordx4 a[40:43], v2, s[4:7], s42 offen offset:2048 sc1
  buffer_store_dwordx4 a[44:47], v2, s[4:7], s42 offen offset:3072 sc1
  s_add_u32 s42, s42, 4096
  buffer_store_dwordx4 a[48:51], v2, s[4:7], s42 offen offset:0 sc1
  buffer_store_dwordx4 a[52:55], v2, s[4:7], s42 offen offset:1024 sc1
  buffer_store_dwordx4 a[56:59], v2, s[4:7], s42 offen offset:2048 sc1
  buffer_store_dwordx4 a[60:63], v2, s[4:7], s42 offen offset:3072 sc1
  s_lshl_b32 s40, s40, 7
  s_add_u32 s43, s40, 0x3d04000
  s_waitcnt vmcnt(0)
  s_cmp_eq_u32 s35, 8
  s_cbranch_scc1 L_part8
  s_waitcnt vmcnt(0)
  s_barrier
  s_cmp_lg_u32 s32, 0
  s_cbranch_scc1 L_sig_107
  v_mov_b32 v254, 1
  v_mov_b32 v255, 0
  s_mov_b64 exec, 1
  buffer_atomic_add v254, v255, s[4:7], s43 offen offset:0 sc1
  s_mov_b64 exec, -1
L_sig_107:
  s_cmp_eq_u32 s35, 8
  s_cselect_b32 s43, 8, 4
  s_cmp_lg_u32 s32, 0
  s_cbranch_scc1 L_dd_109
  v_mov_b32 v228, 0x3d00000
  v_mov_b32 v232, 0x3d04000
L_dw_108:
  buffer_load_dword v234, v232, s[4:7], s40 offen offset:0 sc1
  s_waitcnt vmcnt(0)
  s_mov_b32 s44, 1
  v_readfirstlane_b32 s45, v234
  s_cmp_ge_u32 s45, s43
  s_cselect_b32 s44, s44, 0
  s_cmp_eq_u32 s44, 1
  s_cbranch_scc1 L_dd_109
  s_sleep 1
  s_add_u32 s3, s3, 1
  s_cmp_lt_u32 s3, 131072
  s_cbranch_scc1 L_dw_108
L_dd_109:
  s_barrier
  s_cmp_lg_u32 s32, 0
  s_cbranch_scc1 L_rq_110
  s_cmp_eq_u32 s39, 0
  s_cbranch_scc1 L_rq_110
  s_lshl_b32 s99, s33, 7
  s_add_u32 s99, s99, 0x3d00200
  v_mov_b32 v244, 1
  v_mov_b32 v245, 0
  s_mov_b64 exec, 1
  buffer_atomic_add v244, v245, s[4:7], s99 offen sc0 sc1
  s_mov_b64 exec, -1
L_rq_110:
  s_cmp_eq_u32 s35, 14
  s_cbranch_scc1 L_part4
L_part8:
  s_lshl_b32 s90, s48, 11
  s_add_u32 s42, s41, s90
  v_mov_b32 v3, 0x0
  v_bfe_u32 v4, v1, 0, 4
  v_lshl_add_u32 v3, v4, 12, v3
  v_bfe_u32 v4, v1, 4, 2
  v_lshl_add_u32 v3, v4, 4, v3
  s_lshr_b32 s90, s32, 1
  s_lshl_b32 s90, s90, 18
  s_add_u32 s22, s22, s90
  s_and_b32 s90, s32, 1
  s_lshl_b32 s90, s90, 7
  s_add_u32 s22, s22, s90
  s_lshr_b32 s90, s48, 1
  s_lshl_b32 s90, s90, 16
  s_add_u32 s22, s22, s90
  s_and_b32 s90, s48, 1
  s_lshl_b32 s90, s90, 6
  s_add_u32 s22, s22, s90
L_part8r:
  s_mov_b32 s41, s42
  buffer_load_dwordx4 v[16:19], v2, s[4:7], s41 offen offset:0 sc1
  buffer_load_dwordx4 v[20:23], v2, s[4:7], s41 offen offset:1024 sc1
  s_add_u32 s41, s41, 0x10000
  buffer_load_dwordx4 v[24:27], v2, s[4:7], s41 offen offset:0 sc1
  buffer_load_dwordx4 v[28:31], v2, s[4:7], s41 offen offset:1024 sc1
  s_add_u32 s41, s41, 0x10000
  buffer_load_dwordx4 v[32:35], v2, s[4:7], s41 offen offset:0 sc1
  buffer_load_dwordx4 v[36:39], v2, s[4:7], s41 offen offset:1024 sc1
  s_add_u32 s41, s41, 0x10000
  buffer_load_dwordx4 v[40:43], v2, s[4:7], s41 offen offset:0 sc1
  buffer_load_dwordx4 v[44:47], v2, s[4:7], s41 offen offset:1024 sc1
  s_add_u32 s41, s41, 0x10000
  buffer_load_dwordx4 v[48:51], v2, s[4:7], s41 offen offset:0 sc1
  buffer_load_dwordx4 v[52:55], v2, s[4:7], s41 offen offset:1024 sc1
  s_add_u32 s41, s41, 0x10000
  buffer_load_dwordx4 v[56:59], v2, s[4:7], s41 offen offset:0 sc1
  buffer_load_dwordx4 v[60:63], v2, s[4:7], s41 offen offset:1024 sc1
  s_add_u32 s41, s41, 0x10000
  buffer_load_dwordx4 v[64:67], v2, s[4:7], s41 offen offset:0 sc1
  buffer_load_dwordx4 v[68:71], v2, s[4:7], s41 offen offset:1024 sc1
  s_add_u32 s41, s41, 0x10000
  buffer_load_dwordx4 v[72:75], v2, s[4:7], s41 offen offset:0 sc1
  buffer_load_dwordx4 v[76:79], v2, s[4:7], s41 offen offset:1024 sc1
  s_add_u32 s41, s41, 0x10000
  v_mov_b32 v5, 0
  s_waitcnt vmcnt(14)
  v_max3_u32 v5, v5, v16, v17
  v_max3_u32 v5, v5, v18, v19
  v_max3_u32 v5, v5, v20, v21
  v_max3_u32 v5, v5, v22, v23
  s_waitcnt vmcnt(12)
  v_max3_u32 v5, v5, v24, v25
  v_max3_u32 v5, v5, v26, v27
  v_max3_u32 v5, v5, v28, v29
  v_max3_u32 v5, v5, v30, v31
  s_waitcnt vmcnt(10)
  v_max3_u32 v5, v5, v32, v33
  v_max3_u32 v5, v5, v34, v35
  v_max3_u32 v5, v5, v36, v37
  v_max3_u32 v5, v5, v38, v39
  s_waitcnt vmcnt(8)
  v_max3_u32 v5, v5, v40, v41
  v_max3_u32 v5, v5, v42, v43
  v_max3_u32 v5, v5, v44, v45
  v_max3_u32 v5, v5, v46, v47
  s_waitcnt vmcnt(6)
  v_max3_u32 v5, v5, v48, v49
  v_max3_u32 v5, v5, v50, v51
  v_max3_u32 v5, v5, v52, v53
  v_max3_u32 v5, v5, v54, v55
  s_waitcnt vmcnt(4)
  v_max3_u32 v5, v5, v56, v57
  v_max3_u32 v5, v5, v58, v59
  v_max3_u32 v5, v5, v60, v61
  v_max3_u32 v5, v5, v62, v63
  s_waitcnt vmcnt(2)
  v_max3_u32 v5, v5, v64, v65
  v_max3_u32 v5, v5, v66, v67
  v_max3_u32 v5, v5, v68, v69
  v_max3_u32 v5, v5, v70, v71
  s_waitcnt vmcnt(0)
  v_max3_u32 v5, v5, v72, v73
  v_max3_u32 v5, v5, v74, v75
  v_max3_u32 v5, v5, v76, v77
  v_max3_u32 v5, v5, v78, v79
  v_cmp_eq_u32 vcc, -1, v5
  s_add_u32 s3, s3, 1
  s_cmp_ge_u32 s3, 131072
  s_cbranch_scc1 L_part8k
  s_cbranch_vccnz L_part8r
L_part8k:
  s_waitcnt vmcnt(12)
  v_pk_add_f32 v[16:17], v[16:17], v[24:25]
  v_pk_add_f32 v[18:19], v[18:19], v[26:27]
  v_pk_add_f32 v[20:21], v[20:21], v[28:29]
  v_pk_add_f32 v[22:23], v[22:23], v[30:31]
  s_waitcnt vmcnt(10)
  v_pk_add_f32 v[16:17], v[16:17], v[32:33]
  v_pk_add_f32 v[18:19], v[18:19], v[34:35]
  v_pk_add_f32 v[20:21], v[20:21], v[36:37]
  v_pk_add_f32 v[22:23], v[22:23], v[38:39]
  s_waitcnt vmcnt(8)
  v_pk_add_f32 v[16:17], v[16:17], v[40:41]
  v_pk_add_f32 v[18:19], v[18:19], v[42:43]
  v_pk_add_f32 v[20:21], v[20:21], v[44:45]
  v_pk_add_f32 v[22:23], v[22:23], v[46:47]
  s_waitcnt vmcnt(6)
  v_pk_add_f32 v[16:17], v[16:17], v[48:49]
  v_pk_add_f32 v[18:19], v[18:19], v[50:51]
  v_pk_add_f32 v[20:21], v[20:21], v[52:53]
  v_pk_add_f32 v[22:23], v[22:23], v[54:55]
  s_waitcnt vmcnt(4)
  v_pk_add_f32 v[16:17], v[16:17], v[56:57]
  v_pk_add_f32 v[18:19], v[18:19], v[58:59]
  v_pk_add_f32 v[20:21], v[20:21], v[60:61]
  v_pk_add_f32 v[22:23], v[22:23], v[62:63]
  s_waitcnt vmcnt(2)
  v_pk_add_f32 v[16:17], v[16:17], v[64:65]
  v_pk_add_f32 v[18:19], v[18:19], v[66:67]
  v_pk_add_f32 v[20:21], v[20:21], v[68:69]
  v_pk_add_f32 v[22:23], v[22:23], v[70:71]
  s_waitcnt vmcnt(0)
  v_pk_add_f32 v[16:17], v[16:17], v[72:73]
  v_pk_add_f32 v[18:19], v[18:19], v[74:75]
  v_pk_add_f32 v[20:21], v[20:21], v[76:77]
  v_pk_add_f32 v[22:23], v[22:23], v[78:79]
  v_cvt_pk_bf16_f32 v8, v16, v17
  v_cvt_pk_bf16_f32 v9, v18, v19
  v_cvt_pk_bf16_f32 v10, v20, v21
  v_cvt_pk_bf16_f32 v11, v22, v23
  buffer_store_dwordx4 v[8:11], v3, s[16:19], s22 offen sc1
  s_branch L_exit
L_part4:
  s_lshl_b32 s90, s48, 12
  s_add_u32 s41, s41, s90
  buffer_load_dwordx4 v[16:19], v2, s[4:7], s41 offen offset:0 sc1
  buffer_load_dwordx4 v[20:23], v2, s[4:7], s41 offen offset:1024 sc1
  buffer_load_dwordx4 v[24:27], v2, s[4:7], s41 offen offset:2048 sc1
  buffer_load_dwordx4 v[28:31], v2, s[4:7], s41 offen offset:3072 sc1
  s_add_u32 s41, s41, 0x10000
  buffer_load_dwordx4 v[32:35], v2, s[4:7], s41 offen offset:0 sc1
  buffer_load_dwordx4 v[36:39], v2, s[4:7], s41 offen offset:1024 sc1
  buffer_load_dwordx4 v[40:43], v2, s[4:7], s41 offen offset:2048 sc1
  buffer_load_dwordx4 v[44:47], v2, s[4:7], s41 offen offset:3072 sc1
  s_add_u32 s41, s41, 0x10000
  buffer_load_dwordx4 v[48:51], v2, s[4:7], s41 offen offset:0 sc1
  buffer_load_dwordx4 v[52:55], v2, s[4:7], s41 offen offset:1024 sc1
  buffer_load_dwordx4 v[56:59], v2, s[4:7], s41 offen offset:2048 sc1
  buffer_load_dwordx4 v[60:63], v2, s[4:7], s41 offen offset:3072 sc1
  s_add_u32 s41, s41, 0x10000
  buffer_load_dwordx4 v[64:67], v2, s[4:7], s41 offen offset:0 sc1
  buffer_load_dwordx4 v[68:71], v2, s[4:7], s41 offen offset:1024 sc1
  buffer_load_dwordx4 v[72:75], v2, s[4:7], s41 offen offset:2048 sc1
  buffer_load_dwordx4 v[76:79], v2, s[4:7], s41 offen offset:3072 sc1
  s_add_u32 s41, s41, 0x10000
  v_mov_b32 v3, 0x0
  v_bfe_u32 v4, v1, 0, 4
  v_lshl_add_u32 v3, v4, 12, v3
  v_bfe_u32 v4, v1, 4, 2
  v_lshl_add_u32 v3, v4, 4, v3
  s_lshr_b32 s90, s32, 1
  s_lshl_b32 s90, s90, 18
  s_add_u32 s22, s22, s90
  s_and_b32 s90, s32, 1
  s_lshl_b32 s90, s90, 7
  s_add_u32 s22, s22, s90
  s_lshl_b32 s90, s48, 16
  s_add_u32 s22, s22, s90
  s_waitcnt vmcnt(8)
  v_pk_add_f32 v[16:17], v[16:17], v[32:33]
  v_pk_add_f32 v[18:19], v[18:19], v[34:35]
  v_pk_add_f32 v[20:21], v[20:21], v[36:37]
  v_pk_add_f32 v[22:23], v[22:23], v[38:39]
  v_pk_add_f32 v[24:25], v[24:25], v[40:41]
  v_pk_add_f32 v[26:27], v[26:27], v[42:43]
  v_pk_add_f32 v[28:29], v[28:29], v[44:45]
  v_pk_add_f32 v[30:31], v[30:31], v[46:47]
  s_waitcnt vmcnt(4)
  v_pk_add_f32 v[16:17], v[16:17], v[48:49]
  v_pk_add_f32 v[18:19], v[18:19], v[50:51]
  v_pk_add_f32 v[20:21], v[20:21], v[52:53]
  v_pk_add_f32 v[22:23], v[22:23], v[54:55]
  v_pk_add_f32 v[24:25], v[24:25], v[56:57]
  v_pk_add_f32 v[26:27], v[26:27], v[58:59]
  v_pk_add_f32 v[28:29], v[28:29], v[60:61]
  v_pk_add_f32 v[30:31], v[30:31], v[62:63]
  s_waitcnt vmcnt(0)
  v_pk_add_f32 v[16:17], v[16:17], v[64:65]
  v_pk_add_f32 v[18:19], v[18:19], v[66:67]
  v_pk_add_f32 v[20:21], v[20:21], v[68:69]
  v_pk_add_f32 v[22:23], v[22:23], v[70:71]
  v_pk_add_f32 v[24:25], v[24:25], v[72:73]
  v_pk_add_f32 v[26:27], v[26:27], v[74:75]
  v_pk_add_f32 v[28:29], v[28:29], v[76:77]
  v_pk_add_f32 v[30:31], v[30:31], v[78:79]
  v_cvt_pk_bf16_f32 v8, v16, v17
  v_cvt_pk_bf16_f32 v9, v18, v19
  v_cvt_pk_bf16_f32 v10, v20, v21
  v_cvt_pk_bf16_f32 v11, v22, v23
  v_cvt_pk_bf16_f32 v12, v24, v25
  v_cvt_pk_bf16_f32 v13, v26, v27
  v_cvt_pk_bf16_f32 v14, v28, v29
  v_cvt_pk_bf16_f32 v15, v30, v31
  buffer_store_dwordx4 v[8:11], v3, s[16:19], s22 offen offset:0 sc1
  buffer_store_dwordx4 v[12:15], v3, s[16:19], s22 offen offset:64 sc1
  s_branch L_got
L_done:
  s_waitcnt vmcnt(0)
  s_barrier
  s_add_u32 s38, s38, 0x3d00000
  s_cmp_lg_u32 s32, 0
  s_cbranch_scc1 L_sig_111
  v_mov_b32 v254, s98
  v_mov_b32 v255, 0
  s_mov_b64 exec, 1
  buffer_atomic_add v254, v255, s[4:7], s38 offen offset:0 sc1
  s_mov_b64 exec, -1
L_sig_111:
  s_mov_b32 s59, 0
  s_cmp_lg_u32 s35, 6
  s_cbranch_scc1 L_got
  s_add_u32 s36, s36, 2
  s_and_b32 s50, s36, 7
  s_cmp_lt_u32 s36, 62
  s_cbranch_scc1 L_ata_c
  s_branch L_got
L_exit:
  s_endpgm
.p2align 3
L_table:
.long 0x9
.long 0xa
.long 0x10009
.long 0x1000a
.long 0x20009
.long 0x2000a
.long 0x30009
.long 0x3000a
.long 0x40009
.long 0x4000a
.long 0x50009
.long 0x5000a
.long 0x60009
.long 0x6000a
.long 0x70009
.long 0x7000a
.long 0x109
.long 0x10a
.long 0x10109
.long 0x1010a
.long 0x20109
.long 0x2010a
.long 0x30109
.long 0x3010a
.long 0x40109
.long 0x4010a
.long 0x50109
.long 0x5010a
.long 0x60109
.long 0x6010a
.long 0x70109
.long 0x7010a
.long 0x209
.long 0x20a
.long 0x10209
.long 0x1020a
.long 0x20209
.long 0x2020a
.long 0x30209
.long 0x3020a
.long 0x40209
.long 0x4020a
.long 0x50209
.long 0x5020a
.long 0x60209
.long 0x6020a
.long 0x70209
.long 0x7020a
.long 0x201
.long 0x202
.long 0x10201
.long 0x10202
.long 0x20201
.long 0x20202
.long 0x30201
.long 0x30202
.long 0x301
.long 0x302
.long 0x10301
.long 0x10302
.long 0x20301
.long 0x20302
.long 0x30301
.long 0x30302
.long 0x309
.long 0x30a
.long 0x10309
.long 0x1030a
.long 0x20309
.long 0x2030a
.long 0x30309
.long 0x3030a
.long 0x40309
.long 0x4030a
.long 0x50309
.long 0x5030a
.long 0x60309
.long 0x6030a
.long 0x70309
.long 0x7030a
.long 0xc
.long 0x10c
.long 0x20c
.long 0x30c
.long 0x0
.long 0x10000
.long 0x20000
.long 0x30000
.long 0x100
.long 0x10100
.long 0x20100
.long 0x30100
.long 0x200
.long 0x10200
.long 0x20200
.long 0x30200
.long 0x401
.long 0x402
.long 0x10401
.long 0x10402
.long 0x20401
.long 0x20402
.long 0x30401
.long 0x30402
.long 0x501
.long 0x502
.long 0x10501
.long 0x10502
.long 0x20501
.long 0x20502
.long 0x30501
.long 0x30502
.long 0x300
.long 0x10300
.long 0x20300
.long 0x30300
.long 0x3
.long 0x10003
.long 0x20003
.long 0x103
.long 0x10103
.long 0x20103
.long 0x203
.long 0x10203
.long 0x20203
.long 0x303
.long 0x10303
.long 0x20303
.long 0x400
.long 0x10400
.long 0x20400
.long 0x30400
.long 0x500
.long 0x10500
.long 0x20500
.long 0x30500
.long 0x600
.long 0x10600
.long 0x20600
.long 0x30600
.long 0x700
.long 0x10700
.long 0x20700
.long 0x30700
.long 0xb
.long 0x1000b
.long 0x40b
.long 0x1040b
.long 0x80b
.long 0x1080b
.long 0xc0b
.long 0x10c0b
.long 0x403
.long 0x10403
.long 0x20403
.long 0x503
.long 0x10503
.long 0x20503
.long 0x603
.long 0x10603
.long 0x601
.long 0x602
.long 0x10601
.long 0x10602
.long 0x20601
.long 0x20602
.long 0x30601
.long 0x30602
.long 0x701
.long 0x702
.long 0x10701
.long 0x10702
.long 0x20701
.long 0x20702
.long 0x30701
.long 0x30702
.long 0x100b
.long 0x1100b
.long 0x140b
.long 0x1140b
.long 0x180b
.long 0x1180b
.long 0x1c0b
.long 0x11c0b
.long 0x20603
.long 0x703
.long 0x10703
.long 0x20703
.long 0x200b
.long 0x1200b
.long 0x240b
.long 0x1240b
.long 0x10
.long 0x10010
.long 0x210
.long 0x10210
.long 0x410
.long 0x10410
.long 0x610
.long 0x10610
.long 0x404
.long 0x10404
.long 0x20404
.long 0x30404
.long 0x304
.long 0x10304
.long 0x20304
.long 0x30304
.long 0x2806
.long 0x12806
.long 0x2906
.long 0x12906
.long 0x4
.long 0x10004
.long 0x20004
.long 0x30004
.long 0x104
.long 0x10104
.long 0x20104
.long 0x30104
.long 0x204
.long 0x10204
.long 0x20204
.long 0x30204
.long 0x11
.long 0x10011
.long 0x211
.long 0x10211
.long 0x504
.long 0x10504
.long 0x20504
.long 0x30504
.long 0x411
.long 0x10411
.long 0x611
.long 0x10611
.long 0x807
.long 0x10807
.long 0x907
.long 0x10907
.long 0xa07
.long 0x10a07
.long 0x811
.long 0x10811
.long 0xb07
.long 0x10b07
.long 0xa11
.long 0x10a11
.long 0xc07
.long 0x10c07
.long 0x604
.long 0x10604
.long 0x20604
.long 0x30604
.long 0x704
.long 0x10704
.long 0x20704
.long 0x30704
.long 0xc05
.long 0x10c05
.long 0xd05
.long 0x10d05
.long 0xe05
.long 0x10e05
.long 0xf05
.long 0x10f05
.long 0xd0e
.long 0x10d0e
.long 0x20d0e
.long 0x30d0e
.long 0x40d0e
.long 0x50d0e
.long 0x60d0e
.long 0x70d0e
.long 0x3e06
.long 0x13e06
.long 0x3f06
.long 0x13f06
.long 0xe0e
.long 0x10e0e
.long 0x20e0e
.long 0x30e0e
.long 0x40e0e
.long 0x50e0e
.long 0x60e0e
.long 0x70e0e
.long 0xf08
.long 0x10f08
.long 0x20f08
.long 0x30f08
.long 0x40f08
.long 0x50f08
.long 0x60f08
.long 0x70f08
.long 0x80f08
.long 0x90f08
.long 0xa0f08
.long 0xb0f08
.long 0xc0f08
.long 0xd0f08
.long 0xe0f08
.long 0xf0f08
.long 0xf
.long 0x0
.long 0x0
.long 0x0
.fill 206, 4, 0
.section .rodata,"a"
.p2align 6
.amdhsa_kernel concat_heads__memory_aug_recurrent_mem_tr__sliding_local_dilated__prompt_kernel
  .amdhsa_next_free_vgpr 512
  .amdhsa_next_free_sgpr 102
  .amdhsa_accum_offset 256
  .amdhsa_group_segment_fixed_size 0
  .amdhsa_kernarg_size 104
  .amdhsa_user_sgpr_count 2
  .amdhsa_user_sgpr_kernarg_segment_ptr 1
  .amdhsa_system_sgpr_workgroup_id_x 1
  .amdhsa_float_denorm_mode_32 3
  .amdhsa_float_denorm_mode_16_64 3
.end_amdhsa_kernel
```

```asm
; @launch grid=(256,1,1) block=(256,1,1) lds=149568
.amdgcn_target "amdgcn-amd-amdhsa--gfx950"
.text
.globl concat_heads__memory_aug_recurrent_mem_tr__sliding_local_dilated__prompt_kernel
.p2align 8
.type concat_heads__memory_aug_recurrent_mem_tr__sliding_local_dilated__prompt_kernel,@function
concat_heads__memory_aug_recurrent_mem_tr__sliding_local_dilated__prompt_kernel:
  s_cmp_ge_u32 s2, 256
  s_cbranch_scc1 L_exit
  s_load_dwordx4 s[92:95], s[0:1], 88
  s_load_dwordx16 s[64:79], s[0:1], 0
  s_getreg_b32 s39, hwreg(HW_REG_XCC_ID, 0, 3)
  v_lshrrev_b32 v2, 6, v0
  s_nop 0
  v_readfirstlane_b32 s32, v2
  s_mov_b32 s3, 0
  s_getpc_b64 s[86:87]
L_pc0:
  s_lshr_b32 s90, s2, 3
  s_lshl_b32 s90, s90, 2
  s_add_u32 s90, s90, s32
  s_and_b32 s90, s90, 31
  s_lshl_b32 s90, s90, 12
  v_and_b32 v1, 63, v0
  v_lshlrev_b32 v1, 6, v1
  v_add_u32 v1, s90, v1
  v_min_u32 v1, L_table-L_pc0, v1
  global_load_dword v199, v1, s[86:87]
  v_lshlrev_b32 v1, 3, v0
  v_add_u32 v1, L_table-L_pc0, v1
  global_load_dwordx2 v[248:249], v1, s[86:87]
  s_waitcnt lgkmcnt(0)
  s_mov_b32 s4, s94
  s_and_b32 s5, s95, 0xffff
  s_mov_b32 s6, 0x10000000
  s_mov_b32 s7, 0x20000
  s_mov_b32 s28, s92
  s_and_b32 s29, s93, 0xffff
  s_mov_b32 s30, 0x100
  s_mov_b32 s31, 0x20000
  s_mov_b32 s100, 0
  s_lshr_b32 s41, s2, 3
  s_lshl_b32 s101, 1, s41
  s_cmp_lg_u32 s32, 0
  s_cbranch_scc1 L_sweep
  s_lshl_b32 s90, s39, 2
  v_mov_b32 v247, s101
  v_mov_b32 v2, 0
  s_mov_b64 exec, 1
  buffer_atomic_or v247, v2, s[28:31], s90 offen offset:0 sc0 sc1
  s_mov_b64 exec, -1
L_sweep:
  s_lshl_b32 s40, s39, 5
  s_add_u32 s40, s40, s41
  s_mov_b32 s43, 1
  s_branch L_role
L_fallback:
  s_load_dwordx4 s[92:95], s[0:1], 88
  s_load_dwordx16 s[64:79], s[0:1], 0
  s_getreg_b32 s39, hwreg(HW_REG_XCC_ID, 0, 3)
  s_mov_b32 s100, 4
  v_mbcnt_lo_u32_b32 v0, -1, 0
  v_mbcnt_hi_u32_b32 v0, -1, v0
  s_lshl_b32 s90, s32, 6
  v_add_u32 v0, s90, v0
  s_waitcnt vmcnt(0) lgkmcnt(0)
  s_barrier
  s_cmp_lg_u32 s32, 0
  s_cbranch_scc1 L_tkd
  s_lshl_b32 s90, s39, 2
  v_mov_b32 v1, 1
  v_mov_b32 v2, 0
  v_lshlrev_b32 v3, 2, v0
  s_mov_b64 exec, 1
  buffer_atomic_add v1, v2, s[28:31], s90 offen offset:192 sc0 sc1
  s_mov_b64 exec, 0xff
L_tkw:
  buffer_load_dword v4, v3, s[28:31], 0 offen offset:192 sc1
  s_waitcnt vmcnt(0)
  v_readfirstlane_b32 s40, v1
  s_mov_b32 s41, 0
  s_mov_b32 s42, 0
  s_mov_b32 s43, 1
  v_readlane_b32 s44, v4, 0
  s_add_u32 s41, s41, s44
  s_cmp_gt_u32 s39, 0
  s_cselect_b32 s45, s44, 0
  s_add_u32 s42, s42, s45
  s_cmp_eq_u32 s44, 32
  s_cselect_b32 s43, s43, 0
  v_readlane_b32 s44, v4, 1
  s_add_u32 s41, s41, s44
  s_cmp_gt_u32 s39, 1
  s_cselect_b32 s45, s44, 0
  s_add_u32 s42, s42, s45
  s_cmp_eq_u32 s44, 32
  s_cselect_b32 s43, s43, 0
  v_readlane_b32 s44, v4, 2
  s_add_u32 s41, s41, s44
  s_cmp_gt_u32 s39, 2
  s_cselect_b32 s45, s44, 0
  s_add_u32 s42, s42, s45
  s_cmp_eq_u32 s44, 32
  s_cselect_b32 s43, s43, 0
  v_readlane_b32 s44, v4, 3
  s_add_u32 s41, s41, s44
  s_cmp_gt_u32 s39, 3
  s_cselect_b32 s45, s44, 0
  s_add_u32 s42, s42, s45
  s_cmp_eq_u32 s44, 32
  s_cselect_b32 s43, s43, 0
  v_readlane_b32 s44, v4, 4
  s_add_u32 s41, s41, s44
  s_cmp_gt_u32 s39, 4
  s_cselect_b32 s45, s44, 0
  s_add_u32 s42, s42, s45
  v_readlane_b32 s44, v4, 5
  s_add_u32 s41, s41, s44
  s_cmp_gt_u32 s39, 5
  s_cselect_b32 s45, s44, 0
  s_add_u32 s42, s42, s45
  v_readlane_b32 s44, v4, 6
  s_add_u32 s41, s41, s44
  s_cmp_gt_u32 s39, 6
  s_cselect_b32 s45, s44, 0
  s_add_u32 s42, s42, s45
  v_readlane_b32 s44, v4, 7
  s_add_u32 s41, s41, s44
  s_cmp_gt_u32 s39, 7
  s_cselect_b32 s45, s44, 0
  s_add_u32 s42, s42, s45
  s_add_u32 s3, s3, 1
  s_cmp_ge_u32 s3, 131072
  s_cbranch_scc1 L_tkbad
  s_sleep 4
  s_cmp_lt_u32 s41, 256
  s_cbranch_scc1 L_tkw
  s_add_u32 s40, s40, s42
  s_lshl_b32 s43, s43, 16
  s_or_b32 s40, s40, s43
  s_branch L_tkok
L_tkbad:
  s_mov_b32 s40, 0xffff
L_tkok:
  s_mov_b64 exec, -1
  v_mov_b32 v1, s40
  v_mov_b32 v2, 147456
  ds_write_b32 v2, v1
  s_waitcnt lgkmcnt(0)
L_tkd:
  s_barrier
  v_mov_b32 v2, 147456
  ds_read_b32 v1, v2
  s_waitcnt lgkmcnt(0)
  v_readfirstlane_b32 s40, v1
  s_barrier
  s_lshr_b32 s43, s40, 16
  s_and_b32 s40, s40, 0xffff
  s_cmp_ge_u32 s40, 256
  s_cbranch_scc1 L_exit
L_role:
  s_cmp_ge_u32 s40, 128
  s_cbranch_scc1 L_worker
  s_lshr_b32 s33, s40, 5
  s_and_b32 s34, s40, 31
  s_cmp_eq_u32 s43, 0
  s_cbranch_scc1 L_recslow
  s_load_dwordx4 s[80:83], s[0:1], 8
  s_load_dwordx4 s[84:87], s[0:1], 24
  s_load_dwordx2 s[88:89], s[0:1], 40
  v_lshrrev_b32 v31, 6, v0
  s_nop 0
  v_readfirstlane_b32 s32, v31
  v_and_b32 v0, 63, v0
  s_lshr_b32 s35, s34, 4
  s_lshl_b32 s90, s33, 1
  s_add_u32 s35, s35, s90
  s_and_b32 s36, s34, 15
  s_lshr_b32 s37, s36, 2
  s_lshl_b32 s90, s35, 2
  s_add_u32 s37, s37, s90
  s_and_b32 s38, s36, 3
  s_waitcnt lgkmcnt(0)
  s_mov_b32 s24, s80
  s_and_b32 s25, s81, 0xffff
  s_mov_b32 s26, 0x4000
  s_mov_b32 s27, 0x20000
  s_mov_b32 s8, s82
  s_and_b32 s9, s83, 0xffff
  s_mov_b32 s10, 0x800000
  s_mov_b32 s11, 0x20000
  s_mov_b32 s12, s84
  s_and_b32 s13, s85, 0xffff
  s_mov_b32 s14, 0x800000
  s_mov_b32 s15, 0x20000
  s_mov_b32 s16, s86
  s_and_b32 s17, s87, 0xffff
  s_mov_b32 s18, 0x800000
  s_mov_b32 s19, 0x20000
  s_mov_b32 s20, s88
  s_and_b32 s21, s89, 0xffff
  s_mov_b32 s22, 0x800000
  s_mov_b32 s23, 0x20000
  s_lshl_b32 s90, s32, 21
  s_lshl_b32 s91, s37, 8
  s_add_u32 s90, s90, s91
  s_lshr_b32 s91, s38, 1
  s_lshl_b32 s91, s91, 7
  s_add_u32 s90, s90, s91
  v_mov_b32 v180, 0x0
  v_bfe_u32 v31, v0, 3, 3
  v_lshl_add_u32 v180, v31, 13, v180
  v_bfe_u32 v31, v0, 0, 3
  v_lshl_add_u32 v180, v31, 4, v180
  v_add_u32 v180, s90, v180
  v_xor_b32 v185, 128, v180
  s_lshl_b32 s90, s35, 2
  s_add_u32 s90, s90, s32
  s_lshl_b32 s90, s90, 18
  s_lshl_b32 s91, s36, 7
  s_add_u32 s90, s90, s91
  v_mov_b32 v181, 0x0
  v_bfe_u32 v31, v0, 3, 3
  v_lshl_add_u32 v181, v31, 11, v181
  v_bfe_u32 v31, v0, 0, 3
  v_lshl_add_u32 v181, v31, 4, v181
  v_add_u32 v181, s90, v181
  s_lshl_b32 s96, s32, 15
  s_and_b32 s91, s38, 1
  s_lshl_b32 s91, s91, 6
  s_add_u32 s91, s91, s96
  v_mov_b32 v182, 0x0
  v_bfe_u32 v31, v0, 5, 1
  v_lshl_add_u32 v182, v31, 11, v182
  v_bfe_u32 v31, v0, 4, 1
  v_lshl_add_u32 v182, v31, 10, v182
  v_bfe_u32 v31, v0, 2, 2
  v_lshl_add_u32 v182, v31, 7, v182
  v_bfe_u32 v31, v0, 0, 2
  v_lshl_add_u32 v182, v31, 3, v182
  v_add_u32 v182, s91, v182
  s_lshl_b32 s91, s32, 5
  v_mov_b32 v183, 0x0
  v_bfe_u32 v31, v0, 4, 1
  v_lshl_add_u32 v183, v31, 13, v183
  v_bfe_u32 v31, v0, 5, 1
  v_lshl_add_u32 v183, v31, 8, v183
  v_bfe_u32 v31, v0, 2, 1
  v_lshl_add_u32 v183, v31, 10, v183
  v_bfe_u32 v31, v0, 3, 1
  v_lshl_add_u32 v183, v31, 7, v183
  v_bfe_u32 v31, v0, 0, 2
  v_lshl_add_u32 v183, v31, 3, v183
  v_add_u32 v183, s91, v183
  v_add_u32 v184, 0x10000, v183
  s_lshl_b32 s97, s34, 2
  s_add_u32 s97, s97, s32
  s_lshl_b32 s98, s97, 14
  s_lshl_b32 s91, s33, 21
  s_add_u32 s98, s98, s91
  s_lshl_b32 s97, s97, 16
  s_lshl_b32 s91, s33, 11
  s_add_u32 s97, s97, s91
  v_mov_b32 v16, 0x0
  v_bfe_u32 v31, v0, 0, 4
  v_lshl_add_u32 v16, v31, 7, v16
  v_bfe_u32 v31, v0, 4, 2
  v_lshl_add_u32 v16, v31, 13, v16
  v_add_u32 v17, 0x8000, v16
  v_lshlrev_b32 v18, 7, v0
  v_add_u32 v19, 0x2000, v18
  s_lshl_b32 s97, s34, 2
  s_add_u32 s97, s97, s32
  s_lshl_b32 s98, s97, 14
  s_lshl_b32 s91, s33, 21
  s_add_u32 s98, s98, s91
  s_lshl_b32 s97, s97, 16
  s_lshl_b32 s91, s33, 11
  s_add_u32 s97, s97, s91
  v_mov_b32 v16, 0x180
  v_bfe_u32 v31, v0, 0, 1
  v_lshl_add_u32 v16, v31, 10, v16
  v_bfe_u32 v31, v0, 1, 3
  v_lshl_add_u32 v16, v31, 13, v16
  v_mov_b32 v17, 0x180
  v_bfe_u32 v31, v0, 0, 4
  v_lshl_add_u32 v17, v31, 10, v17
  s_mov_b64 exec, 0xffff
  buffer_load_dword v201, v16, s[12:15], s97 offen
  buffer_load_dword v202, v16, s[16:19], s97 offen
  buffer_load_dword v200, v16, s[8:11], s97 offen
  buffer_load_dword v203, v17, s[20:23], s98 offen
  s_mov_b64 exec, -1
  s_lshl_b32 s58, s33, 5
  s_add_u32 s58, s58, s34
  s_lshl_b32 s59, s32, 19
  s_add_u32 s59, s59, 0x3800000
  s_lshl_b32 s90, s58, 11
  s_add_u32 s90, s90, s59
  s_mul_i32 s91, s58, 3072
  s_add_u32 s91, s91, s59
  s_add_u32 s91, s91, 0x200000
  v_lshlrev_b32 v6, 4, v0
  v_mov_b32 v8, -1
  v_mov_b32 v12, 0
  v_mov_b32 v9, -1
  v_mov_b32 v13, 0
  v_mov_b32 v10, -1
  v_mov_b32 v14, 0
  v_mov_b32 v11, -1
  v_mov_b32 v15, 0
  buffer_store_dwordx4 v[8:11], v6, s[4:7], s90 offen offset:0 sc1
  buffer_store_dwordx4 v[8:11], v6, s[4:7], s90 offen offset:1024 sc1
  buffer_store_dwordx4 v[8:11], v6, s[4:7], s91 offen offset:0 sc1
  buffer_store_dwordx4 v[8:11], v6, s[4:7], s91 offen offset:1024 sc1
  buffer_store_dwordx4 v[8:11], v6, s[4:7], s91 offen offset:2048 sc1
  s_lshl_b32 s58, s58, 2
  s_add_u32 s58, s58, s32
  s_cmp_ge_u32 s58, 36
  s_cbranch_scc1 FL_nz_1
  s_lshl_b32 s90, s58, 10
  s_add_u32 s90, s90, 0x3d00000
  buffer_store_dwordx4 v[12:15], v6, s[4:7], s90 offen sc1
FL_nz_1:
  s_cmp_lg_u32 s58, 3
  s_cbranch_scc1 FL_np_2
  v_mov_b32 v6, 0x3840000
  v_bfe_u32 v31, v0, 0, 1
  v_lshl_add_u32 v6, v31, 13, v6
  v_bfe_u32 v31, v0, 1, 1
  s_mov_b32 s99, 4352
  v_mad_u32_u24 v6, v31, s99, v6
  v_bfe_u32 v31, v0, 2, 2
  s_mov_b32 s99, 82432
  v_mad_u32_u24 v6, v31, s99, v6
  v_mov_b32 v7, -1
  s_mov_b64 exec, 0xffff
  buffer_store_dword v7, v6, s[4:7], 0 offen sc1
  s_mov_b64 exec, -1
  s_waitcnt vmcnt(0)
FL_np_2:
  s_add_u32 m0, s96, 0
  s_mov_b32 s90, 0x0
  buffer_load_dwordx4 v180, s[12:15], s90 offen  lds
  s_add_u32 m0, s96, 1024
  s_mov_b32 s90, 0x10000
  buffer_load_dwordx4 v180, s[12:15], s90 offen  lds
  s_add_u32 m0, s96, 2048
  s_mov_b32 s90, 0x20000
  buffer_load_dwordx4 v180, s[12:15], s90 offen  lds
  s_add_u32 m0, s96, 3072
  s_mov_b32 s90, 0x30000
  buffer_load_dwordx4 v180, s[12:15], s90 offen  lds
  s_add_u32 m0, s96, 4096
  s_mov_b32 s90, 0x0
  buffer_load_dwordx4 v185, s[16:19], s90 offen  lds
  s_add_u32 m0, s96, 5120
  s_mov_b32 s90, 0x10000
  buffer_load_dwordx4 v185, s[16:19], s90 offen  lds
  s_add_u32 m0, s96, 6144
  s_mov_b32 s90, 0x20000
  buffer_load_dwordx4 v185, s[16:19], s90 offen  lds
  s_add_u32 m0, s96, 7168
  s_mov_b32 s90, 0x30000
  buffer_load_dwordx4 v185, s[16:19], s90 offen  lds
  s_add_u32 m0, s96, 8192
  s_mov_b32 s90, 0x40000
  buffer_load_dwordx4 v180, s[12:15], s90 offen  lds
  s_add_u32 m0, s96, 9216
  s_mov_b32 s90, 0x50000
  buffer_load_dwordx4 v180, s[12:15], s90 offen  lds
  s_add_u32 m0, s96, 10240
  s_mov_b32 s90, 0x60000
  buffer_load_dwordx4 v180, s[12:15], s90 offen  lds
  s_add_u32 m0, s96, 11264
  s_mov_b32 s90, 0x70000
  buffer_load_dwordx4 v180, s[12:15], s90 offen  lds
  s_add_u32 m0, s96, 12288
  s_mov_b32 s90, 0x40000
  buffer_load_dwordx4 v185, s[16:19], s90 offen  lds
  s_add_u32 m0, s96, 13312
  s_mov_b32 s90, 0x50000
  buffer_load_dwordx4 v185, s[16:19], s90 offen  lds
  s_add_u32 m0, s96, 14336
  s_mov_b32 s90, 0x60000
  buffer_load_dwordx4 v185, s[16:19], s90 offen  lds
  s_add_u32 m0, s96, 15360
  s_mov_b32 s90, 0x70000
  buffer_load_dwordx4 v185, s[16:19], s90 offen  lds
  s_add_u32 m0, s96, 16384
  s_mov_b32 s90, 0x80000
  buffer_load_dwordx4 v180, s[12:15], s90 offen  lds
  s_add_u32 m0, s96, 17408
  s_mov_b32 s90, 0x90000
  buffer_load_dwordx4 v180, s[12:15], s90 offen  lds
  s_add_u32 m0, s96, 18432
  s_mov_b32 s90, 0xa0000
  buffer_load_dwordx4 v180, s[12:15], s90 offen  lds
  s_add_u32 m0, s96, 19456
  s_mov_b32 s90, 0xb0000
  buffer_load_dwordx4 v180, s[12:15], s90 offen  lds
  s_add_u32 m0, s96, 20480
  s_mov_b32 s90, 0x80000
  buffer_load_dwordx4 v185, s[16:19], s90 offen  lds
  s_add_u32 m0, s96, 21504
  s_mov_b32 s90, 0x90000
  buffer_load_dwordx4 v185, s[16:19], s90 offen  lds
  s_add_u32 m0, s96, 22528
  s_mov_b32 s90, 0xa0000
  buffer_load_dwordx4 v185, s[16:19], s90 offen  lds
  s_add_u32 m0, s96, 23552
  s_mov_b32 s90, 0xb0000
  buffer_load_dwordx4 v185, s[16:19], s90 offen  lds
  s_add_u32 m0, s96, 24576
  s_mov_b32 s90, 0xc0000
  buffer_load_dwordx4 v180, s[12:15], s90 offen  lds
  s_add_u32 m0, s96, 25600
  s_mov_b32 s90, 0xd0000
  buffer_load_dwordx4 v180, s[12:15], s90 offen  lds
  s_add_u32 m0, s96, 26624
  s_mov_b32 s90, 0xe0000
  buffer_load_dwordx4 v180, s[12:15], s90 offen  lds
  s_add_u32 m0, s96, 27648
  s_mov_b32 s90, 0xf0000
  buffer_load_dwordx4 v180, s[12:15], s90 offen  lds
  s_add_u32 m0, s96, 28672
  s_mov_b32 s90, 0xc0000
  buffer_load_dwordx4 v185, s[16:19], s90 offen  lds
  s_add_u32 m0, s96, 29696
  s_mov_b32 s90, 0xd0000
  buffer_load_dwordx4 v185, s[16:19], s90 offen  lds
  s_add_u32 m0, s96, 30720
  s_mov_b32 s90, 0xe0000
  buffer_load_dwordx4 v185, s[16:19], s90 offen  lds
  s_add_u32 m0, s96, 31744
  s_mov_b32 s90, 0xf0000
  buffer_load_dwordx4 v185, s[16:19], s90 offen  lds
  s_cmp_lg_u32 s58, 3
  s_cbranch_scc1 FL_np_3
  s_add_u32 s92, s94, 0x3840000
  s_addc_u32 s93, s95, 0
  s_mov_b32 s62, -1
  s_mov_b32 s63, -1
  s_memtime s[56:57]
  s_waitcnt lgkmcnt(0)
  s_load_dword s60, s[92:93], 0x0
  s_waitcnt lgkmcnt(0)
  s_memtime s[58:59]
  s_waitcnt lgkmcnt(0)
  s_sub_u32 s58, s58, s56
  s_min_u32 s62, s62, s58
  s_memtime s[56:57]
  s_waitcnt lgkmcnt(0)
  s_load_dword s60, s[92:93], 0x2000
  s_waitcnt lgkmcnt(0)
  s_memtime s[58:59]
  s_waitcnt lgkmcnt(0)
  s_sub_u32 s58, s58, s56
  s_min_u32 s63, s63, s58
  s_memtime s[56:57]
  s_waitcnt lgkmcnt(0)
  s_load_dword s60, s[92:93], 0x1100
  s_waitcnt lgkmcnt(0)
  s_memtime s[58:59]
  s_waitcnt lgkmcnt(0)
  s_sub_u32 s58, s58, s56
  s_min_u32 s62, s62, s58
  s_memtime s[56:57]
  s_waitcnt lgkmcnt(0)
  s_load_dword s60, s[92:93], 0x3100
  s_waitcnt lgkmcnt(0)
  s_memtime s[58:59]
  s_waitcnt lgkmcnt(0)
  s_sub_u32 s58, s58, s56
  s_min_u32 s63, s63, s58
  s_memtime s[56:57]
  s_waitcnt lgkmcnt(0)
  s_load_dword s60, s[92:93], 0x14200
  s_waitcnt lgkmcnt(0)
  s_memtime s[58:59]
  s_waitcnt lgkmcnt(0)
  s_sub_u32 s58, s58, s56
  s_min_u32 s62, s62, s58
  s_memtime s[56:57]
  s_waitcnt lgkmcnt(0)
  s_load_dword s60, s[92:93], 0x16200
  s_waitcnt lgkmcnt(0)
  s_memtime s[58:59]
  s_waitcnt lgkmcnt(0)
  s_sub_u32 s58, s58, s56
  s_min_u32 s63, s63, s58
  s_memtime s[56:57]
  s_waitcnt lgkmcnt(0)
  s_load_dword s60, s[92:93], 0x15300
  s_waitcnt lgkmcnt(0)
  s_memtime s[58:59]
  s_waitcnt lgkmcnt(0)
  s_sub_u32 s58, s58, s56
  s_min_u32 s62, s62, s58
  s_memtime s[56:57]
  s_waitcnt lgkmcnt(0)
  s_load_dword s60, s[92:93], 0x17300
  s_waitcnt lgkmcnt(0)
  s_memtime s[58:59]
  s_waitcnt lgkmcnt(0)
  s_sub_u32 s58, s58, s56
  s_min_u32 s63, s63, s58
  s_cmp_lt_u32 s63, s62
  s_cselect_b32 s60, 2, 1
  v_mov_b32 v6, s60
  v_mov_b32 v7, s62
  v_mov_b32 v8, s63
  v_mov_b32 v9, 0
  s_mov_b64 exec, 1
  buffer_store_dword v6, v9, s[28:31], 0 offen offset:128 sc1
  s_mov_b64 exec, -1
FL_np_3:
  s_lshl_b32 s90, s34, 2
  s_add_u32 s90, s90, s32
  s_lshr_b32 s91, s90, 3
  s_lshl_b32 s91, s91, 14
  s_and_b32 s92, s90, 7
  s_lshl_b32 s92, s92, 10
  s_add_u32 s91, s91, s92
  v_mov_b32 v1, 0x0
  v_bfe_u32 v31, v0, 0, 6
  v_lshl_add_u32 v1, v31, 4, v1
  v_add_u32 v1, s91, v1
  v_lshrrev_b32 v30, 4, v0
  v_cmp_eq_u32 vcc, s33, v30
  v_xor_b32 v29, 0x2000, v1
  s_nop 0
  v_cndmask_b32 v1, v1, v29, vcc
  s_lshl_b32 s91, s33, 14
  s_lshl_b32 s92, s90, 7
  s_add_u32 s91, s91, s92
  v_mov_b32 v2, 0x200000
  v_bfe_u32 v31, v0, 0, 2
  v_lshl_add_u32 v2, v31, 2, v2
  v_bfe_u32 v31, v0, 2, 1
  v_lshl_add_u32 v2, v31, 6, v2
  v_bfe_u32 v31, v0, 4, 1
  v_lshl_add_u32 v2, v31, 4, v2
  v_bfe_u32 v31, v0, 5, 1
  v_lshl_add_u32 v2, v31, 5, v2
  v_bfe_u32 v31, v0, 3, 1
  v_lshl_add_u32 v2, v31, 31, v2
  v_add_u32 v2, s91, v2
  s_lshr_b32 s92, s90, 1
  s_lshl_b32 s92, s92, 5
  s_and_b32 s91, s90, 1
  s_lshl_b32 s91, s91, 13
  s_add_u32 s92, s92, s91
  v_mov_b32 v30, 0x0
  v_bfe_u32 v31, v0, 2, 1
  v_lshl_add_u32 v30, v31, 12, v30
  v_bfe_u32 v31, v0, 4, 1
  v_lshl_add_u32 v30, v31, 11, v30
  v_bfe_u32 v31, v0, 0, 2
  v_lshl_add_u32 v30, v31, 3, v30
  v_bfe_u32 v31, v0, 5, 1
  v_lshl_add_u32 v30, v31, 2, v30
  v_add_u32 v30, s92, v30
  buffer_load_dword v44, v30, s[24:27], 0 offen
  s_lshl_b32 s91, s33, 14
  s_lshl_b32 s92, s32, 12
  s_add_u32 s91, s91, s92
  v_mov_b32 v3, 0x200000
  v_bfe_u32 v31, v0, 0, 6
  v_lshl_add_u32 v3, v31, 4, v3
  v_add_u32 v3, s91, v3
  s_mul_i32 s91, s32, 3264
  v_mov_b32 v4, 0x0
  v_bfe_u32 v31, v0, 0, 6
  v_lshl_add_u32 v4, v31, 4, v4
  v_add_u32 v4, s91, v4
  s_lshl_b32 s91, s32, 6
  v_mov_b32 v6, 0x0
  v_bfe_u32 v31, v0, 0, 2
  v_lshl_add_u32 v6, v31, 4, v6
  v_bfe_u32 v31, v0, 2, 1
  v_lshl_add_u32 v6, v31, 2, v6
  v_bfe_u32 v31, v0, 3, 1
  s_mov_b32 s99, 1088
  v_mad_u32_u24 v6, v31, s99, v6
  v_bfe_u32 v31, v0, 4, 2
  v_lshl_add_u32 v6, v31, 8, v6
  v_add_u32 v6, s91, v6
  v_add_u32 v240, 3264, v6
  v_add_u32 v241, 6528, v6
  v_add_u32 v242, 9792, v6
  s_lshl_b32 s93, s37, 13
  s_lshl_b32 s91, s38, 10
  s_add_u32 s91, s91, s93
  s_lshl_b32 s92, s32, 8
  s_add_u32 s91, s91, s92
  v_mov_b32 v7, 0x210000
  v_bfe_u32 v31, v0, 0, 6
  v_lshl_add_u32 v7, v31, 2, v7
  v_add_u32 v7, s91, v7
  s_lshl_b32 s91, s37, 11
  s_lshl_b32 s92, s38, 9
  s_add_u32 s59, s91, s92
  s_lshl_b32 s92, s32, 7
  s_add_u32 s91, s59, s92
  v_mov_b32 v19, 0x83000000
  v_bfe_u32 v31, v0, 0, 3
  v_lshl_add_u32 v19, v31, 2, v19
  v_bfe_u32 v31, v0, 4, 2
  v_lshl_add_u32 v19, v31, 5, v19
  v_bfe_u32 v31, v0, 3, 1
  v_lshl_add_u32 v19, v31, 31, v19
  v_add_u32 v19, s91, v19
  s_lshl_b32 s91, s32, 8
  v_mov_b32 v5, 0x880
  v_bfe_u32 v31, v0, 0, 1
  v_lshl_add_u32 v5, v31, 7, v5
  v_bfe_u32 v31, v0, 1, 1
  v_lshl_add_u32 v5, v31, 3, v5
  v_bfe_u32 v31, v0, 2, 3
  v_lshl_add_u32 v5, v31, 4, v5
  v_add_u32 v5, s91, v5
  s_lshr_b32 s92, s38, 1
  s_xor_b32 s92, s92, 1
  s_lshl_b32 s92, s92, 10
  s_add_u32 s91, s91, s92
  s_add_u32 s91, s91, s93
  s_and_b32 s92, s38, 1
  s_lshl_b32 s92, s92, 7
  s_add_u32 s91, s91, s92
  v_mov_b32 v8, 0x211000
  v_bfe_u32 v31, v0, 0, 5
  v_lshl_add_u32 v8, v31, 2, v8
  v_bfe_u32 v31, v0, 5, 1
  v_lshl_add_u32 v8, v31, 31, v8
  v_add_u32 v8, s91, v8
  s_sub_u32 s91, s91, s93
  s_lshl_b32 s92, s37, 11
  s_add_u32 s91, s91, s92
  v_mov_b32 v20, 0x3400000
  v_bfe_u32 v31, v0, 0, 5
  v_lshl_add_u32 v20, v31, 2, v20
  v_bfe_u32 v31, v0, 5, 1
  v_lshl_add_u32 v20, v31, 31, v20
  v_add_u32 v20, s91, v20
  s_lshl_b32 s97, s35, 2
  s_add_u32 s97, s97, s32
  s_lshl_b32 s97, s97, 13
  v_mov_b32 v9, 0x210000
  v_bfe_u32 v31, v0, 0, 6
  v_lshl_add_u32 v9, v31, 4, v9
  v_add_u32 v9, s97, v9
  v_add_u32 v10, 4096, v9
  v_mov_b32 v11, 0x1000000
  v_bfe_u32 v31, v0, 0, 2
  v_lshl_add_u32 v11, v31, 4, v11
  v_bfe_u32 v31, v0, 2, 1
  v_lshl_add_u32 v11, v31, 7, v11
  v_bfe_u32 v31, v0, 3, 1
  v_lshl_add_u32 v11, v31, 12, v11
  v_bfe_u32 v31, v0, 4, 2
  v_lshl_add_u32 v11, v31, 8, v11
  v_add_u32 v11, s97, v11
  v_mov_b32 v12, 0x2000000
  v_bfe_u32 v31, v0, 0, 3
  v_lshl_add_u32 v12, v31, 4, v12
  v_bfe_u32 v31, v0, 3, 1
  v_lshl_add_u32 v12, v31, 11, v12
  v_bfe_u32 v31, v0, 4, 2
  v_lshl_add_u32 v12, v31, 8, v12
  v_add_u32 v12, s97, v12
  v_add_u32 v13, 4096, v12
  s_lshl_b32 s91, s36, 9
  s_add_u32 s91, s91, s97
  s_add_u32 s63, s91, 0x1000000
  v_mov_b32 v21, 0x1000000
  v_bfe_u32 v31, v0, 0, 2
  v_lshl_add_u32 v21, v31, 7, v21
  v_bfe_u32 v31, v0, 2, 1
  v_lshl_add_u32 v21, v31, 24, v21
  v_add_u32 v21, s91, v21
  v_cmp_gt_u32 vcc, 8, v0
  v_mov_b32 v30, 0x80000000
  s_nop 0
  v_cndmask_b32 v21, v30, v21, vcc
  s_lshl_b32 s91, s32, 11
  v_mov_b32 v30, 0x0
  v_bfe_u32 v31, v0, 2, 1
  v_lshl_add_u32 v30, v31, 6, v30
  v_bfe_u32 v31, v0, 0, 1
  v_lshl_add_u32 v30, v31, 5, v30
  v_bfe_u32 v31, v0, 1, 1
  v_lshl_add_u32 v30, v31, 4, v30
  v_mov_b32 v29, 0x0
  v_bfe_u32 v31, v0, 4, 2
  v_lshl_add_u32 v29, v31, 5, v29
  v_xor_b32 v30, v30, v29
  v_mov_b32 v14, 0x3400
  v_bfe_u32 v31, v0, 0, 4
  v_lshl_add_u32 v14, v31, 7, v14
  v_add_u32 v14, s91, v14
  v_add_u32 v14, v14, v30
  v_xor_b32 v15, 16, v14
  v_mov_b32 v30, 0x0
  v_bfe_u32 v31, v0, 5, 1
  v_lshl_add_u32 v30, v31, 6, v30
  v_bfe_u32 v31, v0, 1, 1
  v_lshl_add_u32 v30, v31, 5, v30
  v_bfe_u32 v31, v0, 4, 1
  v_lshl_add_u32 v30, v31, 4, v30
  v_mov_b32 v29, 0x0
  v_bfe_u32 v31, v0, 2, 2
  v_lshl_add_u32 v29, v31, 5, v29
  v_bfe_u32 v31, v0, 0, 1
  v_lshl_add_u32 v29, v31, 4, v29
  v_xor_b32 v30, v30, v29
  v_mov_b32 v16, 0x3400
  v_bfe_u32 v31, v0, 4, 2
  v_lshl_add_u32 v16, v31, 8, v16
  v_bfe_u32 v31, v0, 1, 1
  v_lshl_add_u32 v16, v31, 7, v16
  v_add_u32 v16, v16, v30
  s_lshl_b32 s98, s36, 14
  s_lshl_b32 s92, s35, 7
  s_add_u32 s98, s98, s92
  s_lshl_b32 s92, s32, 11
  s_add_u32 s91, s98, s92
  v_mov_b32 v17, 0x0
  v_bfe_u32 v31, v0, 0, 5
  v_lshl_add_u32 v17, v31, 2, v17
  v_bfe_u32 v31, v0, 5, 1
  v_lshl_add_u32 v17, v31, 10, v17
  v_add_u32 v17, s91, v17
  v_xor_b32 v18, 0x2000, v17
  s_mov_b32 s48, 0x33333333
  s_mov_b32 s49, 0x33333333
  s_mov_b32 s50, 0xffff0000
  s_mov_b32 s51, 0xffff0000
  s_mov_b32 s52, 0x0000ffff
  s_mov_b32 s53, 0x0000ffff
  s_mov_b32 s54, 0xfffffffe
  s_mov_b32 s47, 0x3e0293ee
  v_mov_b32 v30, 0x4444
  v_mov_b32 v31, 0xeeee
  v_cndmask_b32 v23, v31, v30, s[48:49]
  v_mov_b32 v22, -1
  v_mov_b32 v232, 0
  v_mov_b32 v233, 0
  v_mov_b32 v234, 0
  v_mov_b32 v235, 0
  v_mov_b32 v112, 0
  v_mov_b32 v113, 0
  s_mov_b32 s56, 0xf0f0f0f0
  s_mov_b32 s57, 0xf0f0f0f0
  v_mov_b32 v30, 0x3f80
  v_mov_b32 v31, 1.0
  v_cndmask_b32 v30, v30, v31, s[56:57]
  s_mov_b32 s56, 0x110011
  s_mov_b32 s57, 0x110011
  v_cndmask_b32 v24, 0, v30, s[56:57]
  s_mov_b32 s56, 0x220022
  s_mov_b32 s57, 0x220022
  v_cndmask_b32 v25, 0, v30, s[56:57]
  s_mov_b32 s56, 0x11001100
  s_mov_b32 s57, 0x11001100
  v_cndmask_b32 v26, 0, v30, s[56:57]
  s_mov_b32 s56, 0x22002200
  s_mov_b32 s57, 0x22002200
  v_cndmask_b32 v27, 0, v30, s[56:57]
  s_mov_b32 s40, 0
  s_mov_b32 s41, 0x3800000
  s_mov_b32 s43, 0x3900000
  s_mov_b32 s44, 0
  s_mov_b32 s55, 0x40000
  s_mov_b32 s45, 0
  s_waitcnt vmcnt(33)
  s_barrier
  s_cmp_lg_u32 s32, 0
  s_cbranch_scc1 FL_sig_4
  v_mov_b32 v254, 1
  v_mov_b32 v255, 0
  s_mov_b64 exec, 1
  buffer_atomic_add v254, v255, s[28:31], s100 offen offset:132 sc1
  s_mov_b64 exec, -1
FL_sig_4:
  s_mov_b32 s90, 0x3e0000
  buffer_store_dword v22, v19, s[4:7], s90 offen sc1
  buffer_store_dword v22, v20, s[4:7], s90 offen sc1
  s_mov_b32 s90, 0x3f0000
  buffer_store_dword v22, v19, s[4:7], s90 offen sc1
  buffer_store_dword v22, v20, s[4:7], s90 offen sc1
  s_waitcnt vmcnt(28)
  ds_read_b64_tr_b16 a[16:17], v182 offset:0
  ds_read_b64_tr_b16 a[18:19], v182 offset:512
  ds_read_b64_tr_b16 a[24:25], v182 offset:32
  ds_read_b64_tr_b16 a[26:27], v182 offset:544
  s_waitcnt lgkmcnt(0)
  s_add_u32 m0, s96, 0
  s_mov_b32 s90, 0x100000
  buffer_load_dwordx4 v180, s[12:15], s90 offen  lds
  s_add_u32 m0, s96, 1024
  s_mov_b32 s90, 0x110000
  buffer_load_dwordx4 v180, s[12:15], s90 offen  lds
  s_add_u32 m0, s96, 2048
  s_mov_b32 s90, 0x120000
  buffer_load_dwordx4 v180, s[12:15], s90 offen  lds
  s_add_u32 m0, s96, 3072
  s_mov_b32 s90, 0x130000
  buffer_load_dwordx4 v180, s[12:15], s90 offen  lds
  s_waitcnt vmcnt(28)
  ds_read_b64_tr_b16 a[32:33], v182 offset:4096
  ds_read_b64_tr_b16 a[34:35], v182 offset:4608
  ds_read_b64_tr_b16 a[40:41], v182 offset:4128
  ds_read_b64_tr_b16 a[42:43], v182 offset:4640
  s_waitcnt lgkmcnt(0)
  s_add_u32 m0, s96, 4096
  s_mov_b32 s90, 0x100000
  buffer_load_dwordx4 v185, s[16:19], s90 offen  lds
  s_add_u32 m0, s96, 5120
  s_mov_b32 s90, 0x110000
  buffer_load_dwordx4 v185, s[16:19], s90 offen  lds
  s_add_u32 m0, s96, 6144
  s_mov_b32 s90, 0x120000
  buffer_load_dwordx4 v185, s[16:19], s90 offen  lds
  s_add_u32 m0, s96, 7168
  s_mov_b32 s90, 0x130000
  buffer_load_dwordx4 v185, s[16:19], s90 offen  lds
  s_waitcnt vmcnt(28)
  ds_read_b64_tr_b16 a[20:21], v182 offset:8192
  ds_read_b64_tr_b16 a[22:23], v182 offset:8704
  ds_read_b64_tr_b16 a[28:29], v182 offset:8224
  ds_read_b64_tr_b16 a[30:31], v182 offset:8736
  s_waitcnt lgkmcnt(0)
  s_add_u32 m0, s96, 8192
  s_mov_b32 s90, 0x140000
  buffer_load_dwordx4 v180, s[12:15], s90 offen  lds
  s_add_u32 m0, s96, 9216
  s_mov_b32 s90, 0x150000
  buffer_load_dwordx4 v180, s[12:15], s90 offen  lds
  s_add_u32 m0, s96, 10240
  s_mov_b32 s90, 0x160000
  buffer_load_dwordx4 v180, s[12:15], s90 offen  lds
  s_add_u32 m0, s96, 11264
  s_mov_b32 s90, 0x170000
  buffer_load_dwordx4 v180, s[12:15], s90 offen  lds
  s_waitcnt vmcnt(28)
  ds_read_b64_tr_b16 a[36:37], v182 offset:12288
  ds_read_b64_tr_b16 a[38:39], v182 offset:12800
  ds_read_b64_tr_b16 a[44:45], v182 offset:12320
  ds_read_b64_tr_b16 a[46:47], v182 offset:12832
  s_waitcnt lgkmcnt(0)
  s_add_u32 m0, s96, 12288
  s_mov_b32 s90, 0x140000
  buffer_load_dwordx4 v185, s[16:19], s90 offen  lds
  s_add_u32 m0, s96, 13312
  s_mov_b32 s90, 0x150000
  buffer_load_dwordx4 v185, s[16:19], s90 offen  lds
  s_add_u32 m0, s96, 14336
  s_mov_b32 s90, 0x160000
  buffer_load_dwordx4 v185, s[16:19], s90 offen  lds
  s_add_u32 m0, s96, 15360
  s_mov_b32 s90, 0x170000
  buffer_load_dwordx4 v185, s[16:19], s90 offen  lds
  s_waitcnt vmcnt(28)
  ds_read_b64_tr_b16 a[64:65], v182 offset:16384
  ds_read_b64_tr_b16 a[66:67], v182 offset:16896
  ds_read_b64_tr_b16 a[72:73], v182 offset:16416
  ds_read_b64_tr_b16 a[74:75], v182 offset:16928
  s_waitcnt lgkmcnt(0)
  s_add_u32 m0, s96, 16384
  s_mov_b32 s90, 0x180000
  buffer_load_dwordx4 v180, s[12:15], s90 offen  lds
  s_add_u32 m0, s96, 17408
  s_mov_b32 s90, 0x190000
  buffer_load_dwordx4 v180, s[12:15], s90 offen  lds
  s_add_u32 m0, s96, 18432
  s_mov_b32 s90, 0x1a0000
  buffer_load_dwordx4 v180, s[12:15], s90 offen  lds
  s_add_u32 m0, s96, 19456
  s_mov_b32 s90, 0x1b0000
  buffer_load_dwordx4 v180, s[12:15], s90 offen  lds
  s_waitcnt vmcnt(28)
  ds_read_b64_tr_b16 a[80:81], v182 offset:20480
  ds_read_b64_tr_b16 a[82:83], v182 offset:20992
  ds_read_b64_tr_b16 a[88:89], v182 offset:20512
  ds_read_b64_tr_b16 a[90:91], v182 offset:21024
  s_waitcnt lgkmcnt(0)
  s_add_u32 m0, s96, 20480
  s_mov_b32 s90, 0x180000
  buffer_load_dwordx4 v185, s[16:19], s90 offen  lds
  s_add_u32 m0, s96, 21504
  s_mov_b32 s90, 0x190000
  buffer_load_dwordx4 v185, s[16:19], s90 offen  lds
  s_add_u32 m0, s96, 22528
  s_mov_b32 s90, 0x1a0000
  buffer_load_dwordx4 v185, s[16:19], s90 offen  lds
  s_add_u32 m0, s96, 23552
  s_mov_b32 s90, 0x1b0000
  buffer_load_dwordx4 v185, s[16:19], s90 offen  lds
  s_waitcnt vmcnt(28)
  ds_read_b64_tr_b16 a[68:69], v182 offset:24576
  ds_read_b64_tr_b16 a[70:71], v182 offset:25088
  ds_read_b64_tr_b16 a[76:77], v182 offset:24608
  ds_read_b64_tr_b16 a[78:79], v182 offset:25120
  s_waitcnt lgkmcnt(0)
  s_add_u32 m0, s96, 24576
  s_mov_b32 s90, 0x1c0000
  buffer_load_dwordx4 v180, s[12:15], s90 offen  lds
  s_add_u32 m0, s96, 25600
  s_mov_b32 s90, 0x1d0000
  buffer_load_dwordx4 v180, s[12:15], s90 offen  lds
  s_add_u32 m0, s96, 26624
  s_mov_b32 s90, 0x1e0000
  buffer_load_dwordx4 v180, s[12:15], s90 offen  lds
  s_add_u32 m0, s96, 27648
  s_mov_b32 s90, 0x1f0000
  buffer_load_dwordx4 v180, s[12:15], s90 offen  lds
  s_waitcnt vmcnt(28)
  ds_read_b64_tr_b16 a[84:85], v182 offset:28672
  ds_read_b64_tr_b16 a[86:87], v182 offset:29184
  ds_read_b64_tr_b16 a[92:93], v182 offset:28704
  ds_read_b64_tr_b16 a[94:95], v182 offset:29216
  s_waitcnt lgkmcnt(0)
  s_add_u32 m0, s96, 28672
  s_mov_b32 s90, 0x1c0000
  buffer_load_dwordx4 v185, s[16:19], s90 offen  lds
  s_add_u32 m0, s96, 29696
  s_mov_b32 s90, 0x1d0000
  buffer_load_dwordx4 v185, s[16:19], s90 offen  lds
  s_add_u32 m0, s96, 30720
  s_mov_b32 s90, 0x1e0000
  buffer_load_dwordx4 v185, s[16:19], s90 offen  lds
  s_add_u32 m0, s96, 31744
  s_mov_b32 s90, 0x1f0000
  buffer_load_dwordx4 v185, s[16:19], s90 offen  lds
  s_waitcnt vmcnt(28)
  ds_read_b64_tr_b16 a[112:113], v182 offset:0
  ds_read_b64_tr_b16 a[114:115], v182 offset:512
  ds_read_b64_tr_b16 a[120:121], v182 offset:32
  ds_read_b64_tr_b16 a[122:123], v182 offset:544
  s_waitcnt lgkmcnt(0)
  s_add_u32 m0, s96, 0
  s_mov_b32 s90, 0x0
  buffer_load_dwordx4 v180, s[8:11], s90 offen  lds
  s_add_u32 m0, s96, 1024
  s_mov_b32 s90, 0x10000
  buffer_load_dwordx4 v180, s[8:11], s90 offen  lds
  s_add_u32 m0, s96, 2048
  s_mov_b32 s90, 0x20000
  buffer_load_dwordx4 v180, s[8:11], s90 offen  lds
  s_add_u32 m0, s96, 3072
  s_mov_b32 s90, 0x30000
  buffer_load_dwordx4 v180, s[8:11], s90 offen  lds
  s_waitcnt vmcnt(28)
  ds_read_b64_tr_b16 a[128:129], v182 offset:4096
  ds_read_b64_tr_b16 a[130:131], v182 offset:4608
  ds_read_b64_tr_b16 a[136:137], v182 offset:4128
  ds_read_b64_tr_b16 a[138:139], v182 offset:4640
  s_waitcnt lgkmcnt(0)
  s_add_u32 m0, s96, 4096
  s_mov_b32 s90, 0x40000
  buffer_load_dwordx4 v180, s[8:11], s90 offen  lds
  s_add_u32 m0, s96, 5120
  s_mov_b32 s90, 0x50000
  buffer_load_dwordx4 v180, s[8:11], s90 offen  lds
  s_add_u32 m0, s96, 6144
  s_mov_b32 s90, 0x60000
  buffer_load_dwordx4 v180, s[8:11], s90 offen  lds
  s_add_u32 m0, s96, 7168
  s_mov_b32 s90, 0x70000
  buffer_load_dwordx4 v180, s[8:11], s90 offen  lds
  s_waitcnt vmcnt(28)
  ds_read_b64_tr_b16 a[116:117], v182 offset:8192
  ds_read_b64_tr_b16 a[118:119], v182 offset:8704
  ds_read_b64_tr_b16 a[124:125], v182 offset:8224
  ds_read_b64_tr_b16 a[126:127], v182 offset:8736
  s_waitcnt lgkmcnt(0)
  s_add_u32 m0, s96, 8192
  s_mov_b32 s90, 0x80000
  buffer_load_dwordx4 v180, s[8:11], s90 offen  lds
  s_add_u32 m0, s96, 9216
  s_mov_b32 s90, 0x90000
  buffer_load_dwordx4 v180, s[8:11], s90 offen  lds
  s_add_u32 m0, s96, 10240
  s_mov_b32 s90, 0xa0000
  buffer_load_dwordx4 v180, s[8:11], s90 offen  lds
  s_add_u32 m0, s96, 11264
  s_mov_b32 s90, 0xb0000
  buffer_load_dwordx4 v180, s[8:11], s90 offen  lds
  s_waitcnt vmcnt(28)
  ds_read_b64_tr_b16 a[132:133], v182 offset:12288
  ds_read_b64_tr_b16 a[134:135], v182 offset:12800
  ds_read_b64_tr_b16 a[140:141], v182 offset:12320
  ds_read_b64_tr_b16 a[142:143], v182 offset:12832
  s_waitcnt lgkmcnt(0)
  s_add_u32 m0, s96, 12288
  s_mov_b32 s90, 0xc0000
  buffer_load_dwordx4 v180, s[8:11], s90 offen  lds
  s_add_u32 m0, s96, 13312
  s_mov_b32 s90, 0xd0000
  buffer_load_dwordx4 v180, s[8:11], s90 offen  lds
  s_add_u32 m0, s96, 14336
  s_mov_b32 s90, 0xe0000
  buffer_load_dwordx4 v180, s[8:11], s90 offen  lds
  s_add_u32 m0, s96, 15360
  s_mov_b32 s90, 0xf0000
  buffer_load_dwordx4 v180, s[8:11], s90 offen  lds
  s_waitcnt vmcnt(28)
  ds_read_b64_tr_b16 a[160:161], v182 offset:16384
  ds_read_b64_tr_b16 a[162:163], v182 offset:16896
  ds_read_b64_tr_b16 a[168:169], v182 offset:16416
  ds_read_b64_tr_b16 a[170:171], v182 offset:16928
  s_waitcnt lgkmcnt(0)
  s_add_u32 m0, s96, 16384
  s_mov_b32 s90, 0x100000
  buffer_load_dwordx4 v180, s[8:11], s90 offen  lds
  s_add_u32 m0, s96, 17408
  s_mov_b32 s90, 0x110000
  buffer_load_dwordx4 v180, s[8:11], s90 offen  lds
  s_add_u32 m0, s96, 18432
  s_mov_b32 s90, 0x120000
  buffer_load_dwordx4 v180, s[8:11], s90 offen  lds
  s_add_u32 m0, s96, 19456
  s_mov_b32 s90, 0x130000
  buffer_load_dwordx4 v180, s[8:11], s90 offen  lds
  s_waitcnt vmcnt(28)
  ds_read_b64_tr_b16 a[176:177], v182 offset:20480
  ds_read_b64_tr_b16 a[178:179], v182 offset:20992
  ds_read_b64_tr_b16 a[184:185], v182 offset:20512
  ds_read_b64_tr_b16 a[186:187], v182 offset:21024
  s_waitcnt lgkmcnt(0)
  s_add_u32 m0, s96, 20480
  s_mov_b32 s90, 0x140000
  buffer_load_dwordx4 v180, s[8:11], s90 offen  lds
  s_add_u32 m0, s96, 21504
  s_mov_b32 s90, 0x150000
  buffer_load_dwordx4 v180, s[8:11], s90 offen  lds
  s_add_u32 m0, s96, 22528
  s_mov_b32 s90, 0x160000
  buffer_load_dwordx4 v180, s[8:11], s90 offen  lds
  s_add_u32 m0, s96, 23552
  s_mov_b32 s90, 0x170000
  buffer_load_dwordx4 v180, s[8:11], s90 offen  lds
  s_waitcnt vmcnt(28)
  ds_read_b64_tr_b16 a[164:165], v182 offset:24576
  ds_read_b64_tr_b16 a[166:167], v182 offset:25088
  ds_read_b64_tr_b16 a[172:173], v182 offset:24608
  ds_read_b64_tr_b16 a[174:175], v182 offset:25120
  s_waitcnt lgkmcnt(0)
  s_add_u32 m0, s96, 24576
  s_mov_b32 s90, 0x180000
  buffer_load_dwordx4 v180, s[8:11], s90 offen  lds
  s_add_u32 m0, s96, 25600
  s_mov_b32 s90, 0x190000
  buffer_load_dwordx4 v180, s[8:11], s90 offen  lds
  s_add_u32 m0, s96, 26624
  s_mov_b32 s90, 0x1a0000
  buffer_load_dwordx4 v180, s[8:11], s90 offen  lds
  s_add_u32 m0, s96, 27648
  s_mov_b32 s90, 0x1b0000
  buffer_load_dwordx4 v180, s[8:11], s90 offen  lds
  s_waitcnt vmcnt(28)
  ds_read_b64_tr_b16 a[180:181], v182 offset:28672
  ds_read_b64_tr_b16 a[182:183], v182 offset:29184
  ds_read_b64_tr_b16 a[188:189], v182 offset:28704
  ds_read_b64_tr_b16 a[190:191], v182 offset:29216
  s_waitcnt lgkmcnt(0)
  s_add_u32 m0, s96, 28672
  s_mov_b32 s90, 0x1c0000
  buffer_load_dwordx4 v180, s[8:11], s90 offen  lds
  s_add_u32 m0, s96, 29696
  s_mov_b32 s90, 0x1d0000
  buffer_load_dwordx4 v180, s[8:11], s90 offen  lds
  s_add_u32 m0, s96, 30720
  s_mov_b32 s90, 0x1e0000
  buffer_load_dwordx4 v180, s[8:11], s90 offen  lds
  s_add_u32 m0, s96, 31744
  s_mov_b32 s90, 0x1f0000
  buffer_load_dwordx4 v180, s[8:11], s90 offen  lds
  s_waitcnt vmcnt(28)
  ds_read_b64_tr_b16 a[0:1], v182 offset:0
  ds_read_b64_tr_b16 a[2:3], v182 offset:512
  ds_read_b64_tr_b16 a[8:9], v182 offset:32
  ds_read_b64_tr_b16 a[10:11], v182 offset:544
  s_waitcnt lgkmcnt(0)
  s_add_u32 m0, s96, 0
  s_mov_b32 s90, 0x0
  buffer_load_dwordx4 v181, s[20:23], s90 offen  lds
  s_add_u32 m0, s96, 1024
  s_mov_b32 s90, 0x4000
  buffer_load_dwordx4 v181, s[20:23], s90 offen  lds
  s_add_u32 m0, s96, 2048
  s_mov_b32 s90, 0x8000
  buffer_load_dwordx4 v181, s[20:23], s90 offen  lds
  s_add_u32 m0, s96, 3072
  s_mov_b32 s90, 0xc000
  buffer_load_dwordx4 v181, s[20:23], s90 offen  lds
  s_waitcnt vmcnt(28)
  ds_read_b64_tr_b16 a[4:5], v182 offset:4096
  ds_read_b64_tr_b16 a[6:7], v182 offset:4608
  ds_read_b64_tr_b16 a[12:13], v182 offset:4128
  ds_read_b64_tr_b16 a[14:15], v182 offset:4640
  s_waitcnt lgkmcnt(0)
  s_add_u32 m0, s96, 4096
  s_mov_b32 s90, 0x10000
  buffer_load_dwordx4 v181, s[20:23], s90 offen  lds
  s_add_u32 m0, s96, 5120
  s_mov_b32 s90, 0x14000
  buffer_load_dwordx4 v181, s[20:23], s90 offen  lds
  s_add_u32 m0, s96, 6144
  s_mov_b32 s90, 0x18000
  buffer_load_dwordx4 v181, s[20:23], s90 offen  lds
  s_add_u32 m0, s96, 7168
  s_mov_b32 s90, 0x1c000
  buffer_load_dwordx4 v181, s[20:23], s90 offen  lds
  s_waitcnt vmcnt(28)
  ds_read_b64_tr_b16 a[48:49], v182 offset:8192
  ds_read_b64_tr_b16 a[50:51], v182 offset:8704
  ds_read_b64_tr_b16 a[56:57], v182 offset:8224
  ds_read_b64_tr_b16 a[58:59], v182 offset:8736
  s_waitcnt lgkmcnt(0)
  s_add_u32 m0, s96, 8192
  s_mov_b32 s90, 0x20000
  buffer_load_dwordx4 v181, s[20:23], s90 offen  lds
  s_add_u32 m0, s96, 9216
  s_mov_b32 s90, 0x24000
  buffer_load_dwordx4 v181, s[20:23], s90 offen  lds
  s_add_u32 m0, s96, 10240
  s_mov_b32 s90, 0x28000
  buffer_load_dwordx4 v181, s[20:23], s90 offen  lds
  s_add_u32 m0, s96, 11264
  s_mov_b32 s90, 0x2c000
  buffer_load_dwordx4 v181, s[20:23], s90 offen  lds
  s_waitcnt vmcnt(28)
  ds_read_b64_tr_b16 a[52:53], v182 offset:12288
  ds_read_b64_tr_b16 a[54:55], v182 offset:12800
  ds_read_b64_tr_b16 a[60:61], v182 offset:12320
  ds_read_b64_tr_b16 a[62:63], v182 offset:12832
  s_waitcnt lgkmcnt(0)
  s_add_u32 m0, s96, 12288
  s_mov_b32 s90, 0x30000
  buffer_load_dwordx4 v181, s[20:23], s90 offen  lds
  s_add_u32 m0, s96, 13312
  s_mov_b32 s90, 0x34000
  buffer_load_dwordx4 v181, s[20:23], s90 offen  lds
  s_add_u32 m0, s96, 14336
  s_mov_b32 s90, 0x38000
  buffer_load_dwordx4 v181, s[20:23], s90 offen  lds
  s_add_u32 m0, s96, 15360
  s_mov_b32 s90, 0x3c000
  buffer_load_dwordx4 v181, s[20:23], s90 offen  lds
  s_mov_b32 s90, 0x3800000
  buffer_load_dword v204, v2, s[4:7], s90 offen sc1
  buffer_load_dword v204, v7, s[4:7], s90 offen sc1
  buffer_load_dword v204, v8, s[4:7], s90 offen sc1
  s_mov_b32 s90, 0x3880000
  buffer_load_dword v204, v2, s[4:7], s90 offen sc1
  buffer_load_dword v204, v7, s[4:7], s90 offen sc1
  buffer_load_dword v204, v8, s[4:7], s90 offen sc1
  s_mov_b32 s90, 0x3900000
  buffer_load_dword v204, v2, s[4:7], s90 offen sc1
  buffer_load_dword v204, v7, s[4:7], s90 offen sc1
  buffer_load_dword v204, v8, s[4:7], s90 offen sc1
  s_mov_b32 s90, 0x3980000
  buffer_load_dword v204, v2, s[4:7], s90 offen sc1
  buffer_load_dword v204, v7, s[4:7], s90 offen sc1
  buffer_load_dword v204, v8, s[4:7], s90 offen sc1
  s_waitcnt vmcnt(28)
  ds_read_b64_tr_b16 a[96:97], v182 offset:16384
  ds_read_b64_tr_b16 a[98:99], v182 offset:16896
  ds_read_b64_tr_b16 a[104:105], v182 offset:16416
  ds_read_b64_tr_b16 a[106:107], v182 offset:16928
  s_waitcnt vmcnt(24)
  ds_read_b64_tr_b16 a[100:101], v182 offset:20480
  ds_read_b64_tr_b16 a[102:103], v182 offset:20992
  ds_read_b64_tr_b16 a[108:109], v182 offset:20512
  ds_read_b64_tr_b16 a[110:111], v182 offset:21024
  s_waitcnt vmcnt(20)
  ds_read_b64_tr_b16 a[144:145], v182 offset:24576
  ds_read_b64_tr_b16 a[146:147], v182 offset:25088
  ds_read_b64_tr_b16 a[152:153], v182 offset:24608
  ds_read_b64_tr_b16 a[154:155], v182 offset:25120
  s_waitcnt vmcnt(16)
  ds_read_b64_tr_b16 a[148:149], v182 offset:28672
  ds_read_b64_tr_b16 a[150:151], v182 offset:29184
  ds_read_b64_tr_b16 a[156:157], v182 offset:28704
  ds_read_b64_tr_b16 a[158:159], v182 offset:29216
  v_mbcnt_lo_u32_b32 v250, -1, 0
  v_mbcnt_hi_u32_b32 v250, -1, v250
  s_lshl_b32 s90, s32, 9
  s_add_u32 s90, s90, 147520
  v_lshl_add_u32 v251, v250, 3, s90
  ds_write_b64 v251, v[248:249]
  s_waitcnt lgkmcnt(0)
  s_cmp_lg_u32 s32, 0
  s_cbranch_scc1 FL_vd_6
  v_lshlrev_b32 v250, 2, v250
  s_cmp_lg_u32 s100, 0
  s_cbranch_scc1 FL_vw_5
  v_readfirstlane_b32 s90, v247
  s_and_b32 s90, s90, s101
  s_cbranch_scc0 FL_vw_5
  v_mov_b32 v251, 1
  s_mov_b64 exec, 1
  buffer_store_dword v251, v250, s[28:31], 0 offen offset:32 sc1
  s_mov_b64 exec, -1
FL_vw_5:
  buffer_load_dword v251, v250, s[28:31], 0 offen sc1
  s_waitcnt vmcnt(0)
  v_cmp_eq_u32 vcc, -1, v251
  v_readlane_b32 s91, v251, 8
  v_readlane_b32 s92, v251, 32
  v_readlane_b32 s93, v251, 33
  v_readlane_b32 s90, v251, 34
  s_cmp_lg_u32 s100, 0
  s_cselect_b32 s93, s90, s93
  s_cselect_b32 s91, 0, s91
  s_cselect_b32 s92, 1, s92
  s_cselect_b32 s90, 0xff, vcc_lo
  s_cmp_lg_u32 s91, 0
  s_cselect_b32 s92, 3, s92
  s_cbranch_scc1 FL_vk_7
  s_add_u32 s3, s3, 1
  s_cmp_ge_u32 s3, 131072
  s_cselect_b32 s92, 4, s92
  s_cbranch_scc1 FL_vk_7
  s_sleep 8
  s_and_b32 s90, s90, 0xff
  s_cmp_lg_u32 s90, 0xff
  s_cbranch_scc1 FL_vw_5
  s_cmp_lt_u32 s93, 128
  s_cbranch_scc1 FL_vw_5
  s_cmp_eq_u32 s92, 0
  s_cbranch_scc1 FL_vw_5
FL_vk_7:
  v_mov_b32 v251, s92
  v_mov_b32 v250, 147456
  ds_write_b32 v250, v251
  s_waitcnt lgkmcnt(0)
FL_vd_6:
  s_barrier
  v_mov_b32 v250, 147456
  ds_read_b32 v251, v250
  s_waitcnt lgkmcnt(0)
  v_readfirstlane_b32 s92, v251
  s_barrier
  s_cmp_eq_u32 s92, 3
  s_cbranch_scc1 L_fallback
  s_cmp_eq_u32 s92, 4
  s_cbranch_scc1 L_exit
  s_sub_u32 s39, s92, 1
  s_and_b32 s39, s39, 1
  s_lshl_b32 s39, s39, 13
  s_waitcnt vmcnt(0)
  s_barrier
  ds_read_b64_tr_b16 a[192:193], v183 offset:0
  ds_read_b64_tr_b16 a[194:195], v183 offset:2048
  ds_read_b64_tr_b16 a[196:197], v183 offset:512
  ds_read_b64_tr_b16 a[198:199], v183 offset:2560
  ds_read_b64_tr_b16 a[200:201], v183 offset:4096
  ds_read_b64_tr_b16 a[202:203], v183 offset:6144
  ds_read_b64_tr_b16 a[204:205], v183 offset:4608
  ds_read_b64_tr_b16 a[206:207], v183 offset:6656
  s_waitcnt lgkmcnt(0)
  ds_read_b64_tr_b16 a[208:209], v183 offset:32768
  ds_read_b64_tr_b16 a[210:211], v183 offset:34816
  ds_read_b64_tr_b16 a[212:213], v183 offset:33280
  ds_read_b64_tr_b16 a[214:215], v183 offset:35328
  ds_read_b64_tr_b16 a[216:217], v183 offset:36864
  ds_read_b64_tr_b16 a[218:219], v183 offset:38912
  ds_read_b64_tr_b16 a[220:221], v183 offset:37376
  ds_read_b64_tr_b16 a[222:223], v183 offset:39424
  s_waitcnt lgkmcnt(0)
  ds_read_b64_tr_b16 a[224:225], v184 offset:0
  ds_read_b64_tr_b16 a[226:227], v184 offset:2048
  ds_read_b64_tr_b16 a[228:229], v184 offset:512
  ds_read_b64_tr_b16 a[230:231], v184 offset:2560
  ds_read_b64_tr_b16 a[232:233], v184 offset:4096
  ds_read_b64_tr_b16 a[234:235], v184 offset:6144
  ds_read_b64_tr_b16 a[236:237], v184 offset:4608
  ds_read_b64_tr_b16 a[238:239], v184 offset:6656
  s_waitcnt lgkmcnt(0)
  ds_read_b64_tr_b16 a[240:241], v184 offset:32768
  ds_read_b64_tr_b16 a[242:243], v184 offset:34816
  ds_read_b64_tr_b16 a[244:245], v184 offset:33280
  ds_read_b64_tr_b16 a[246:247], v184 offset:35328
  ds_read_b64_tr_b16 a[248:249], v184 offset:36864
  ds_read_b64_tr_b16 a[250:251], v184 offset:38912
  ds_read_b64_tr_b16 a[252:253], v184 offset:37376
  ds_read_b64_tr_b16 a[254:255], v184 offset:39424
  s_waitcnt lgkmcnt(0)
  s_barrier
  s_mov_b32 s46, 0
  v_xor_b32 v1, s39, v1
  v_xor_b32 v17, s39, v17
  v_xor_b32 v18, s39, v18
  s_mov_b32 s12, s63
  s_mov_b32 s90, 0x3800000
  s_mov_b32 s90, 0x3880000
  s_mov_b32 s90, 0x3900000
  s_mov_b32 s90, 0x3980000
  v_mov_b32 v248, 0x3f803f80
  v_mov_b32 v249, 0x3f803f80
  v_mov_b32 v250, 0x3f803f80
  v_mov_b32 v251, 0x3f803f80
  v_mov_b32 v252, 0x3f803f80
  v_mov_b32 v253, 0x3f803f80
  v_mov_b32 v254, 0x3f803f80
  v_mov_b32 v255, 0x3f803f80
  s_cmp_lg_u32 s32, 0
  s_cbranch_scc1 FL_kv0d
  s_lshl_b32 s90, s33, 7
  s_add_u32 s90, s90, 0x3d07000
  v_mov_b32 v30, s90
FL_kv0:
  buffer_load_dword v31, v30, s[4:7], 0 offen sc1
  s_waitcnt vmcnt(0)
  v_readfirstlane_b32 s90, v31
  s_add_u32 s46, s46, 1
  s_cmp_ge_u32 s46, 131072
  s_cbranch_scc1 FL_rec_abort
  s_sleep 2
  s_cmp_lt_u32 s90, 16
  s_cbranch_scc1 FL_kv0
FL_kv0d:
  s_barrier
  buffer_load_dwordx4 v[180:183], v12, s[4:7], s44 offen offset:0
  buffer_load_dwordx4 v[184:187], v12, s[4:7], s44 offen offset:128
  buffer_load_dwordx4 v[188:191], v12, s[4:7], s44 offen offset:1024
  buffer_load_dwordx4 v[192:195], v12, s[4:7], s44 offen offset:1152
  buffer_load_dwordx4 v[196:199], v13, s[4:7], s44 offen offset:0
  buffer_load_dwordx4 v[200:203], v13, s[4:7], s44 offen offset:128
  buffer_load_dwordx4 v[204:207], v13, s[4:7], s44 offen offset:1024
  buffer_load_dwordx4 v[208:211], v13, s[4:7], s44 offen offset:1152
  buffer_load_dwordx4 v[116:119], v11, s[4:7], s44 offen offset:0
  buffer_load_dwordx4 v[132:135], v11, s[4:7], s44 offen offset:64
  buffer_load_dwordx4 v[120:123], v11, s[4:7], s44 offen offset:1024
  buffer_load_dwordx4 v[136:139], v11, s[4:7], s44 offen offset:1088
  buffer_load_dwordx4 v[124:127], v11, s[4:7], s44 offen offset:2048
  buffer_load_dwordx4 v[140:143], v11, s[4:7], s44 offen offset:2112
  buffer_load_dwordx4 v[128:131], v11, s[4:7], s44 offen offset:3072
  buffer_load_dwordx4 v[144:147], v11, s[4:7], s44 offen offset:3136
  s_add_u32 s44, s44, 0x40000
  v_mov_b64 v[64:65], 0
  v_mov_b64 v[66:67], 0
  v_mov_b64 v[68:69], 0
  v_mov_b64 v[70:71], 0
  v_mov_b64 v[72:73], 0
  v_mov_b64 v[74:75], 0
  v_mov_b64 v[76:77], 0
  v_mov_b64 v[78:79], 0
  v_mov_b64 v[80:81], 0
  v_mov_b64 v[82:83], 0
  v_mov_b64 v[84:85], 0
  v_mov_b64 v[86:87], 0
  v_mov_b64 v[32:33], 0
  v_mov_b64 v[34:35], 0
  v_mov_b64 v[212:213], 0
  v_mov_b64 v[214:215], 0
  v_mov_b64 v[216:217], 0
  v_mov_b64 v[218:219], 0
  v_mov_b64 v[220:221], 0
  v_mov_b64 v[222:223], 0
  v_mov_b64 v[224:225], 0
  v_mov_b64 v[226:227], 0
  v_mov_b64 v[228:229], 0
  v_mov_b64 v[230:231], 0
  s_waitcnt vmcnt(0)
  v_min_u32 v44, s54, v44
  s_lshl_b32 s90, s33, 7
  s_add_u32 s90, s90, 0x3d07000
  v_mov_b32 v244, s90
  s_lshl_b32 s90, s34, 2
  s_add_u32 s90, s90, s32
  s_lshl_b32 s91, s33, 7
  s_add_u32 s91, s91, 0x3d00000
  v_mbcnt_lo_u32_b32 v30, -1, 0
  v_mbcnt_hi_u32_b32 v30, -1, v30
  v_add_u32 v30, s90, v30
  v_cmp_eq_u32 vcc, 0, v30
  v_mov_b32 v30, 0x80000000
  v_mov_b32 v31, s91
  v_cndmask_b32 v245, v30, v31, vcc
  s_mov_b64 s[8:9], s[94:95]
  s_mov_b64 s[10:11], s[94:95]
  s_branch FL_pubmem
FL_step:
  s_load_dword s16, s[8:9], 256
  s_load_dword s17, s[10:11], 256
  s_load_dword s18, s[8:9], 320
  s_load_dword s19, s[10:11], 320
  s_load_dword s20, s[8:9], 384
  s_load_dword s21, s[10:11], 384
  s_load_dword s22, s[8:9], 448
  s_load_dword s23, s[10:11], 448
  buffer_load_dwordx4 v[200:203], v13, s[4:7], s44 offen offset:128
  buffer_load_dwordx4 v[204:207], v13, s[4:7], s44 offen offset:1024
  buffer_load_dwordx4 v[208:211], v13, s[4:7], s44 offen offset:1152
  buffer_load_dwordx4 v[128:131], v11, s[4:7], s44 offen offset:3072
  buffer_load_dwordx4 v[144:147], v11, s[4:7], s44 offen offset:3136
  v_mov_b64 v[64:65], 0
  v_mov_b64 v[66:67], 0
  v_mov_b64 v[68:69], 0
  v_mov_b64 v[70:71], 0
  v_mov_b64 v[72:73], 0
  v_mov_b64 v[74:75], 0
  v_mov_b64 v[76:77], 0
  v_mov_b64 v[78:79], 0
  v_mov_b64 v[80:81], 0
  v_mov_b64 v[82:83], 0
  v_mov_b64 v[84:85], 0
  v_mov_b64 v[86:87], 0
  v_mov_b64 v[32:33], 0
  v_mov_b64 v[34:35], 0
  buffer_load_dwordx4 v[36:39], v1, s[4:7], s42 offen sc1
  buffer_store_dword v22, v18, s[4:7], s13 offen
  buffer_store_dword v22, v2, s[4:7], s13 offen
  buffer_store_dword v22, v7, s[4:7], s13 offen
  buffer_store_dword v22, v8, s[4:7], s13 offen
  s_add_u32 s44, s44, 0x40000
  s_min_u32 s44, s44, 0xfc0000
  s_add_u32 s45, s45, 0x10000
  s_waitcnt vmcnt(12)
FL_kv_chk:
  v_readfirstlane_b32 s90, v243
  s_cmp_lt_u32 s90, 16
  s_cbranch_scc1 FL_kv_f
  s_waitcnt vmcnt(4)
FL_g_chk:
  v_max3_u32 v31, v36, v37, v38
  v_max_u32 v31, v31, v39
  v_cmp_eq_u32 vcc, -1, v31
  v_mfma_f32_16x16x32_bf16 v[40:43], v[24:27], v[36:39], 0
  s_cbranch_vccnz FL_g_f
  s_nop 6
  v_add_f32_dpp v45, v40, v40 row_ror:8 row_mask:0xf bank_mask:0xf
  v_add_f32_dpp v46, v41, v41 row_ror:8 row_mask:0xf bank_mask:0xf
  v_cvt_pk_bf16_f32 v44, v45, v46
  v_min_u32 v44, s54, v44
FL_pubmem:
  buffer_store_dword v44, v2, s[4:7], s41 offen
  v_mov_b32 v148, v180
  v_mov_b32 v150, v181
  v_mov_b32 v152, v182
  v_mov_b32 v154, v183
  v_mov_b32 v149, v184
  v_mov_b32 v151, v185
  v_mov_b32 v153, v186
  v_mov_b32 v155, v187
  v_mov_b32 v156, v188
  v_mov_b32 v158, v189
  v_mov_b32 v160, v190
  v_mov_b32 v162, v191
  v_mov_b32 v157, v192
  v_mov_b32 v159, v193
  v_mov_b32 v161, v194
  v_mov_b32 v163, v195
  v_mov_b32 v164, v196
  v_mov_b32 v166, v197
  v_mov_b32 v168, v198
  v_mov_b32 v170, v199
  v_mov_b32 v165, v200
  v_mov_b32 v167, v201
  v_mov_b32 v169, v202
  v_mov_b32 v171, v203
  buffer_load_dwordx4 v[48:51], v3, s[4:7], s41 offen offset:0 sc1
  v_mov_b32 v172, v204
  v_mov_b32 v174, v205
  buffer_load_dwordx4 v[52:55], v3, s[4:7], s41 offen offset:1024 sc1
  v_mov_b32 v176, v206
  v_mov_b32 v178, v207
  buffer_load_dwordx4 v[56:59], v3, s[4:7], s41 offen offset:2048 sc1
  v_mov_b32 v173, v208
  v_mov_b32 v175, v209
  buffer_load_dwordx4 v[60:63], v3, s[4:7], s41 offen offset:3072 sc1
  v_mov_b32 v177, v210
  v_mov_b32 v179, v211
  s_waitcnt vmcnt(3)
  v_max3_u32 v31, v48, v49, v50
  v_max_u32 v31, v31, v51
  v_cmp_eq_u32 vcc, -1, v31
  s_cbranch_vccnz FL_m_f0
  v_smfmac_f32_16x16x64_bf16 v[64:67], v[48:51], a[0:7], v23
  s_waitcnt vmcnt(2)
  v_max3_u32 v31, v52, v53, v54
  v_max_u32 v31, v31, v55
  v_cmp_eq_u32 vcc, -1, v31
  v_smfmac_f32_16x16x64_bf16 v[68:71], v[48:51], a[8:15], v23
  v_smfmac_f32_16x16x64_bf16 v[72:75], v[48:51], a[16:23], v23
  v_smfmac_f32_16x16x64_bf16 v[76:79], v[48:51], a[24:31], v23
  s_cbranch_vccnz FL_m_f1
  v_smfmac_f32_16x16x64_bf16 v[64:67], v[52:55], a[48:55], v23
  s_waitcnt vmcnt(1)
  v_max3_u32 v31, v56, v57, v58
  v_max_u32 v31, v31, v59
  v_cmp_eq_u32 vcc, -1, v31
  v_smfmac_f32_16x16x64_bf16 v[68:71], v[52:55], a[56:63], v23
  v_smfmac_f32_16x16x64_bf16 v[72:75], v[52:55], a[64:71], v23
  v_smfmac_f32_16x16x64_bf16 v[76:79], v[52:55], a[72:79], v23
  s_cbranch_vccnz FL_m_f2
  v_smfmac_f32_16x16x64_bf16 v[64:67], v[56:59], a[96:103], v23
  s_waitcnt vmcnt(0)
  v_max3_u32 v31, v60, v61, v62
  v_max_u32 v31, v31, v63
  v_cmp_eq_u32 vcc, -1, v31
  v_smfmac_f32_16x16x64_bf16 v[68:71], v[56:59], a[104:111], v23
  v_smfmac_f32_16x16x64_bf16 v[72:75], v[56:59], a[112:119], v23
  v_smfmac_f32_16x16x64_bf16 v[76:79], v[56:59], a[120:127], v23
  s_cbranch_vccnz FL_m_f3
  v_smfmac_f32_16x16x64_bf16 v[64:67], v[60:63], a[144:151], v23
  v_smfmac_f32_16x16x64_bf16 v[68:71], v[60:63], a[152:159], v23
  v_smfmac_f32_16x16x64_bf16 v[72:75], v[60:63], a[160:167], v23
  v_smfmac_f32_16x16x64_bf16 v[76:79], v[60:63], a[168:175], v23
FL_m_done:
  s_nop 4
  v_pk_add_f32 v[88:89], v[64:65], v[66:67]
  v_pk_add_f32 v[90:91], v[68:69], v[70:71]
  ds_write_b128 v4, v[88:91] offset:0
  v_pk_add_f32 v[92:93], v[72:73], v[74:75]
  v_pk_add_f32 v[94:95], v[76:77], v[78:79]
  ds_write_b128 v4, v[92:95] offset:1088
  v_smfmac_f32_16x16x64_bf16 v[80:83], v[48:51], a[32:39], v23
  buffer_load_dwordx4 v[180:183], v12, s[4:7], s44 offen offset:0
  v_mov_b32 v36, 0
  v_smfmac_f32_16x16x64_bf16 v[84:87], v[48:51], a[40:47], v23
  buffer_load_dwordx4 v[184:187], v12, s[4:7], s44 offen offset:128
  v_mov_b32 v37, 0
  v_smfmac_f32_16x16x64_bf16 v[80:83], v[52:55], a[80:87], v23
  buffer_load_dwordx4 v[188:191], v12, s[4:7], s44 offen offset:1024
  v_mov_b32 v38, 0
  v_smfmac_f32_16x16x64_bf16 v[84:87], v[52:55], a[88:95], v23
  buffer_load_dwordx4 v[192:195], v12, s[4:7], s44 offen offset:1152
  v_mov_b32 v39, 0
  v_smfmac_f32_16x16x64_bf16 v[80:83], v[56:59], a[128:135], v23
  buffer_load_dwordx4 v[196:199], v13, s[4:7], s44 offen offset:0
  v_mov_b32 v40, 0
  s_waitcnt lgkmcnt(0)
  s_barrier
  ds_read2_b32 v[100:101], v6 offset0:0 offset1:2
  ds_read2_b32 v[102:103], v240 offset0:0 offset1:2
  ds_read2_b32 v[104:105], v241 offset0:0 offset1:2
  ds_read2_b32 v[106:107], v242 offset0:0 offset1:2
  v_smfmac_f32_16x16x64_bf16 v[84:87], v[56:59], a[136:143], v23
  v_mov_b32 v41, 0
  v_smfmac_f32_16x16x64_bf16 v[80:83], v[60:63], a[176:183], v23
  v_mov_b32 v42, 0
  v_smfmac_f32_16x16x64_bf16 v[84:87], v[60:63], a[184:191], v23
  v_mov_b32 v43, 0
  v_mov_b32 v44, 0
  v_mov_b32 v45, 0
  v_mov_b32 v46, 0
  v_mov_b32 v47, 0
  s_waitcnt lgkmcnt(2)
  v_pk_add_f32 v[100:101], v[100:101], v[102:103]
  s_waitcnt lgkmcnt(0)
  v_pk_add_f32 v[104:105], v[104:105], v[106:107]
  v_pk_add_f32 v[100:101], v[100:101], v[104:105]
  v_cvt_pk_bf16_f32 v112, v100, v101
  v_min_u32 v112, s54, v112
  buffer_store_dword v112, v7, s[4:7], s41 offen
  v_pk_add_f32 v[96:97], v[80:81], v[82:83]
  v_pk_add_f32 v[98:99], v[84:85], v[86:87]
  ds_write_b128 v4, v[96:99] offset:2176
  v_mov_b64 v[212:213], 0
  v_mov_b64 v[214:215], 0
  v_mov_b64 v[216:217], 0
  v_mov_b64 v[218:219], 0
  v_mov_b64 v[220:221], 0
  v_mov_b64 v[222:223], 0
  v_mov_b64 v[224:225], 0
  v_mov_b64 v[226:227], 0
  v_mov_b64 v[228:229], 0
  v_mov_b64 v[230:231], 0
  s_waitcnt lgkmcnt(0)
  s_barrier
  ds_read_b64 v[88:89], v5 offset:0
  buffer_load_dwordx4 v[64:67], v9, s[4:7], s41 offen offset:0 sc1
  s_mov_b32 s42, s41
  s_add_u32 s90, s40, 1
  ds_read_b64 v[90:91], v5 offset:3264
  buffer_load_dwordx4 v[68:71], v9, s[4:7], s41 offen offset:1024 sc1
  s_and_b32 s90, s90, 3
  s_lshl_b32 s90, s90, 19
  ds_read_b64 v[92:93], v5 offset:6528
  buffer_load_dwordx4 v[72:75], v9, s[4:7], s41 offen offset:2048 sc1
  s_add_u32 s91, s90, 0x3800000
  s_add_u32 s55, s55, 0x40000
  ds_read_b64 v[94:95], v5 offset:9792
  buffer_load_dwordx4 v[76:79], v9, s[4:7], s41 offen offset:3072 sc1
  s_min_u32 s55, s55, 0xfc0000
  s_nop 0
  s_waitcnt lgkmcnt(2)
  v_pk_add_f32 v[88:89], v[88:89], v[90:91]
  s_waitcnt lgkmcnt(0)
  v_pk_add_f32 v[92:93], v[92:93], v[94:95]
  v_pk_add_f32 v[88:89], v[88:89], v[92:93]
  v_cvt_pk_bf16_f32 v113, v88, v89
  v_min_u32 v113, s54, v113
  buffer_store_dword v113, v8, s[4:7], s41 offen
  s_add_u32 s8, s94, s55
  s_addc_u32 s9, s95, 0
  s_add_u32 s8, s8, s12
  s_addc_u32 s9, s9, 0
  s_add_u32 s10, s8, 0x1000000
  s_addc_u32 s11, s9, 0
  s_load_dword s16, s[8:9], 0
  s_load_dword s17, s[10:11], 0
  s_load_dword s18, s[8:9], 64
  s_load_dword s19, s[10:11], 64
  s_load_dword s20, s[8:9], 128
  s_load_dword s21, s[10:11], 128
  s_load_dword s22, s[8:9], 192
  s_load_dword s23, s[10:11], 192
  s_cmp_eq_u32 s40, 63
  s_cbranch_scc1 FL_last
  s_waitcnt vmcnt(4)
  v_max3_u32 v31, v64, v65, v66
  v_max_u32 v31, v31, v67
  v_cmp_eq_u32 vcc, -1, v31
  s_cbranch_vccnz FL_x_f0
  v_mfma_f32_16x16x32_bf16 v[44:47], v[64:67], v[64:67], v[44:47]
  s_waitcnt vmcnt(3)
  v_max3_u32 v31, v68, v69, v70
  v_max_u32 v31, v31, v71
  v_cmp_eq_u32 vcc, -1, v31
  v_mfma_f32_16x16x32_bf16 v[36:39], v[116:119], v[64:67], v[36:39]
  v_mfma_f32_16x16x32_bf16 v[40:43], v[132:135], v[64:67], v[40:43]
  s_cbranch_vccnz FL_x_f1
  v_mfma_f32_16x16x32_bf16 v[44:47], v[68:71], v[68:71], v[44:47]
  s_waitcnt vmcnt(2)
  v_max3_u32 v31, v72, v73, v74
  v_max_u32 v31, v31, v75
  v_cmp_eq_u32 vcc, -1, v31
  v_mfma_f32_16x16x32_bf16 v[36:39], v[120:123], v[68:71], v[36:39]
  v_mfma_f32_16x16x32_bf16 v[40:43], v[136:139], v[68:71], v[40:43]
  s_cbranch_vccnz FL_x_f2
  v_mfma_f32_16x16x32_bf16 v[44:47], v[72:75], v[72:75], v[44:47]
  s_waitcnt vmcnt(1)
  v_max3_u32 v31, v76, v77, v78
  v_max_u32 v31, v31, v79
  v_cmp_eq_u32 vcc, -1, v31
  v_mfma_f32_16x16x32_bf16 v[36:39], v[124:127], v[72:75], v[36:39]
  v_mfma_f32_16x16x32_bf16 v[40:43], v[140:143], v[72:75], v[40:43]
  s_cbranch_vccnz FL_x_f3
  v_mfma_f32_16x16x32_bf16 v[44:47], v[76:79], v[76:79], v[44:47]
  v_mfma_f32_16x16x32_bf16 v[36:39], v[128:131], v[76:79], v[36:39]
  v_mfma_f32_16x16x32_bf16 v[40:43], v[144:147], v[76:79], v[40:43]
FL_x_done:
  buffer_load_dwordx4 v[88:91], v10, s[4:7], s41 offen offset:0 sc1
  buffer_load_dwordx4 v[92:95], v10, s[4:7], s41 offen offset:1024 sc1
  s_mov_b64 vcc, s[48:49]
  s_nop 2
  v_max_f32 v30, v46, v47
  s_nop 0
  v_cndmask_b32_dpp v96, v40, v36, vcc quad_perm:[0,1,0,1] row_mask:0xf bank_mask:0xf
  v_cndmask_b32_dpp v97, v41, v37, vcc quad_perm:[0,1,0,1] row_mask:0xf bank_mask:0xf
  v_cndmask_b32_dpp v98, v42, v38, vcc quad_perm:[0,1,0,1] row_mask:0xf bank_mask:0xf
  v_cndmask_b32_dpp v99, v43, v39, vcc quad_perm:[0,1,0,1] row_mask:0xf bank_mask:0xf
  v_max3_f32 v29, v96, v97, v98
  s_nop 0
  v_max_f32_dpp v28, v30, v99 quad_perm:[0,1,0,1] row_mask:0xf bank_mask:0xf
  v_max_f32 v29, v29, v28
  s_nop 1
  v_max_f32_dpp v28, v29, v29 quad_perm:[2,3,0,1] row_mask:0xf bank_mask:0xf
  v_mov_b32 v29, v28
  s_nop 1
  v_permlane32_swap_b32 v28, v29
  v_max_f32 v28, v28, v29
  v_mov_b32 v29, v28
  s_nop 1
  v_permlane16_swap_b32 v28, v29
  v_max_f32 v28, v28, v29
  v_mul_f32 v28, s47, v28
  v_fma_f32 v96, v96, s47, -v28
  v_fma_f32 v97, v97, s47, -v28
  v_fma_f32 v98, v98, s47, -v28
  v_fma_f32 v99, v99, s47, -v28
  v_fma_f32 v46, v46, s47, -v28
  v_fma_f32 v47, v47, s47, -v28
  v_exp_f32 v96, v96
  v_exp_f32 v97, v97
  v_exp_f32 v98, v98
  v_exp_f32 v99, v99
  v_cvt_pk_bf16_f32 v236, v96, v97
  v_cvt_pk_bf16_f32 v237, v98, v99
  v_exp_f32 v46, v46
  v_mov_b32_dpp v100, v236 quad_perm:[0,1,0,1] row_mask:0xf bank_mask:0xf
  v_mov_b32_dpp v102, v236 quad_perm:[2,3,2,3] row_mask:0xf bank_mask:0xf
  v_mov_b32_dpp v101, v237 quad_perm:[0,1,0,1] row_mask:0xf bank_mask:0xf
  v_mov_b32_dpp v103, v237 quad_perm:[2,3,2,3] row_mask:0xf bank_mask:0xf
  v_exp_f32 v47, v47
  s_nop 0
  v_smfmac_f32_16x16x64_bf16 v[228:231], v[100:103], v[248:255], v23
  v_cvt_pk_bf16_f32 v238, v46, v47
  buffer_load_dwordx4 v[116:119], v11, s[4:7], s44 offen offset:0
  v_smfmac_f32_16x16x64_bf16 v[212:215], v[100:103], v[148:155], v23
  buffer_load_dwordx4 v[132:135], v11, s[4:7], s44 offen offset:64
  v_mov_b32_dpp v232, v238 quad_perm:[0,1,0,1] row_mask:0xf bank_mask:0xf
  v_smfmac_f32_16x16x64_bf16 v[216:219], v[100:103], v[156:163], v23
  buffer_load_dwordx4 v[120:123], v11, s[4:7], s44 offen offset:1024
  v_mov_b32_dpp v235, v238 quad_perm:[0,1,0,1] row_mask:0xf bank_mask:0xf
  v_smfmac_f32_16x16x64_bf16 v[220:223], v[100:103], v[164:171], v23
  buffer_load_dwordx4 v[136:139], v11, s[4:7], s44 offen offset:1088
  s_waitcnt vmcnt(4)
  v_max3_u32 v31, v88, v89, v90
  v_max3_u32 v31, v31, v91, v92
  v_smfmac_f32_16x16x32_bf16 v[228:231], v[232:233], v[248:251], v23
  v_max3_u32 v31, v31, v93, v94
  v_max_u32 v31, v31, v95
  v_cmp_eq_u32 vcc, -1, v31
  v_smfmac_f32_16x16x64_bf16 v[224:227], v[100:103], v[172:179], v23
  s_cbranch_vccnz FL_v_f
FL_v_ok:
  v_smfmac_f32_16x16x32_bf16 v[212:215], v[232:233], v[88:91], v23
  buffer_load_dwordx4 v[124:127], v11, s[4:7], s44 offen offset:2048
  buffer_load_dwordx4 v[140:143], v11, s[4:7], s44 offen offset:2112
  v_smfmac_f32_16x16x32_bf16 v[216:219], v[234:235], v[88:91], v23
  v_rcp_f32 v28, v228
  v_smfmac_f32_16x16x32_bf16 v[220:223], v[232:233], v[92:95], v23
  v_rcp_f32 v29, v229
  v_smfmac_f32_16x16x32_bf16 v[224:227], v[234:235], v[92:95], v23
  s_nop 0
  v_pk_mul_f32 v[212:213], v[212:213], v[28:29]
  v_pk_mul_f32 v[214:215], v[214:215], v[28:29]
  v_cvt_pk_bf16_f32 v104, v212, v214
  v_cvt_pk_bf16_f32 v108, v213, v215
  v_pk_mul_f32 v[216:217], v[216:217], v[28:29]
  v_pk_mul_f32 v[218:219], v[218:219], v[28:29]
  v_cvt_pk_bf16_f32 v105, v216, v218
  v_cvt_pk_bf16_f32 v109, v217, v219
  v_pk_mul_f32 v[220:221], v[220:221], v[28:29]
  v_pk_mul_f32 v[222:223], v[222:223], v[28:29]
  v_cvt_pk_bf16_f32 v106, v220, v222
  v_cvt_pk_bf16_f32 v110, v221, v223
  v_pk_mul_f32 v[224:225], v[224:225], v[28:29]
  v_pk_mul_f32 v[226:227], v[226:227], v[28:29]
  v_cvt_pk_bf16_f32 v107, v224, v226
  v_cvt_pk_bf16_f32 v111, v225, v227
  ds_write_b128 v14, v[104:107]
  ds_write_b128 v15, v[108:111]
  s_add_u32 s92, s40, 3
  s_min_u32 s92, s92, 63
  s_lshr_b32 s92, s92, 2
  s_lshl_b32 s92, s92, 9
  v_mov_b32 v246, s40
  s_waitcnt lgkmcnt(0)
  s_barrier
  ds_read_b128 v[48:51], v16 offset:0
  ds_read_b128 v[52:55], v16 offset:1024
  ds_read_b128 v[56:59], v16 offset:2048
  ds_read_b128 v[60:63], v16 offset:3072
  ds_read_b128 v[64:67], v16 offset:4096
  buffer_store_dword v22, v17, s[4:7], s43 offen sc1
  buffer_store_dword v112, v19, s[4:7], s45 offen sc1
  s_waitcnt lgkmcnt(4)
  v_smfmac_f32_16x16x64_bf16 v[32:35], v[48:51], a[192:199], v23
  ds_read_b128 v[68:71], v16 offset:5120
  buffer_store_dword v113, v20, s[4:7], s45 offen sc1
  s_waitcnt lgkmcnt(4)
  v_smfmac_f32_16x16x64_bf16 v[32:35], v[52:55], a[200:207], v23
  ds_read_b128 v[72:75], v16 offset:6144
  buffer_store_dword v246, v245, s[4:7], 0 offen sc1
  s_waitcnt lgkmcnt(4)
  v_smfmac_f32_16x16x64_bf16 v[32:35], v[56:59], a[208:215], v23
  ds_read_b128 v[76:79], v16 offset:7168
  buffer_load_dword v243, v244, s[4:7], s92 offen sc1
  s_waitcnt lgkmcnt(4)
  v_smfmac_f32_16x16x64_bf16 v[32:35], v[60:63], a[216:223], v23
  s_mov_b32 s13, s43
  s_waitcnt lgkmcnt(3)
  v_smfmac_f32_16x16x64_bf16 v[32:35], v[64:67], a[224:231], v23
  s_add_u32 s40, s40, 1
  s_waitcnt lgkmcnt(2)
  v_smfmac_f32_16x16x64_bf16 v[32:35], v[68:71], a[232:239], v23
  s_mov_b32 s41, s91
  s_waitcnt lgkmcnt(1)
  v_smfmac_f32_16x16x64_bf16 v[32:35], v[72:75], a[240:247], v23
  s_xor_b32 s43, s91, 0x100000
  s_waitcnt lgkmcnt(0)
  v_smfmac_f32_16x16x64_bf16 v[32:35], v[76:79], a[248:255], v23
  s_nop 7
  v_pk_add_f32 v[28:29], v[32:33], v[34:35]
  v_cvt_pk_bf16_f32 v28, v28, v29
  v_min_u32 v28, s54, v28
  buffer_store_dword v28, v17, s[4:7], s42 offen sc1
  buffer_store_dword v28, v18, s[4:7], s42 offen
  s_branch FL_step
FL_last:
  buffer_store_dword v112, v19, s[4:7], s45 offen sc1
  buffer_store_dword v113, v20, s[4:7], s45 offen sc1
  s_branch L_join
FL_kv_f:
  s_sleep 8
  buffer_load_dword v243, v244, s[4:7], s92 offen sc1
  s_add_u32 s46, s46, 1
  s_cmp_ge_u32 s46, 131072
  s_cbranch_scc1 FL_rec_abort
  s_waitcnt vmcnt(0)
  s_branch FL_kv_chk
FL_g_f:
  s_mov_b64 exec, vcc
  buffer_load_dwordx4 v[36:39], v1, s[4:7], s42 offen sc1
  s_mov_b64 exec, -1
  s_add_u32 s46, s46, 1
  s_cmp_ge_u32 s46, 131072
  s_cbranch_scc1 FL_rec_abort
  s_waitcnt vmcnt(0)
  s_branch FL_g_chk
FL_m_f0:
  s_mov_b64 exec, vcc
  buffer_load_dwordx4 v[48:51], v3, s[4:7], s41 offen offset:0 sc1
  s_mov_b64 exec, -1
  s_waitcnt vmcnt(1)
  s_branch FL_m_0123_c1
FL_m_f1:
  s_mov_b64 exec, vcc
  buffer_load_dwordx4 v[52:55], v3, s[4:7], s41 offen offset:1024 sc1
  s_mov_b64 exec, -1
  s_waitcnt vmcnt(1)
  s_branch FL_m_123_c2
FL_m_f2:
  s_mov_b64 exec, vcc
  buffer_load_dwordx4 v[56:59], v3, s[4:7], s41 offen offset:2048 sc1
  s_mov_b64 exec, -1
  s_waitcnt vmcnt(1)
  s_branch FL_m_23_c3
FL_m_f3:
  s_mov_b64 exec, vcc
  buffer_load_dwordx4 v[60:63], v3, s[4:7], s41 offen offset:3072 sc1
  s_mov_b64 exec, -1
  s_nop 7
  s_branch FL_m_3_c3
FL_m_0_c0:
  v_max3_u32 v31, v48, v49, v50
  v_max_u32 v31, v31, v51
  v_cmp_eq_u32 vcc, -1, v31
  s_cbranch_vccz FL_m_0_ok0
FL_m_0_x0:
  s_mov_b64 exec, vcc
  buffer_load_dwordx4 v[48:51], v3, s[4:7], s41 offen offset:0 sc1
  s_mov_b64 exec, -1
  s_add_u32 s46, s46, 1
  s_cmp_ge_u32 s46, 131072
  s_cbranch_scc1 FL_rec_abort
  s_waitcnt vmcnt(2)
  s_branch FL_m_0_c0
FL_m_0_ok0:
  v_smfmac_f32_16x16x64_bf16 v[64:67], v[48:51], a[0:7], v23
  v_smfmac_f32_16x16x64_bf16 v[68:71], v[48:51], a[8:15], v23
  v_smfmac_f32_16x16x64_bf16 v[72:75], v[48:51], a[16:23], v23
  v_smfmac_f32_16x16x64_bf16 v[76:79], v[48:51], a[24:31], v23
  s_branch FL_m_done
FL_m_1_c1:
  v_max3_u32 v31, v52, v53, v54
  v_max_u32 v31, v31, v55
  v_cmp_eq_u32 vcc, -1, v31
  s_cbranch_vccz FL_m_1_ok1
FL_m_1_x1:
  s_mov_b64 exec, vcc
  buffer_load_dwordx4 v[52:55], v3, s[4:7], s41 offen offset:1024 sc1
  s_mov_b64 exec, -1
  s_add_u32 s46, s46, 1
  s_cmp_ge_u32 s46, 131072
  s_cbranch_scc1 FL_rec_abort
  s_waitcnt vmcnt(2)
  s_branch FL_m_1_c1
FL_m_1_ok1:
  v_smfmac_f32_16x16x64_bf16 v[64:67], v[52:55], a[48:55], v23
  v_smfmac_f32_16x16x64_bf16 v[68:71], v[52:55], a[56:63], v23
  v_smfmac_f32_16x16x64_bf16 v[72:75], v[52:55], a[64:71], v23
  v_smfmac_f32_16x16x64_bf16 v[76:79], v[52:55], a[72:79], v23
  s_branch FL_m_done
FL_m_2_c2:
  v_max3_u32 v31, v56, v57, v58
  v_max_u32 v31, v31, v59
  v_cmp_eq_u32 vcc, -1, v31
  s_cbranch_vccz FL_m_2_ok2
FL_m_2_x2:
  s_mov_b64 exec, vcc
  buffer_load_dwordx4 v[56:59], v3, s[4:7], s41 offen offset:2048 sc1
  s_mov_b64 exec, -1
  s_add_u32 s46, s46, 1
  s_cmp_ge_u32 s46, 131072
  s_cbranch_scc1 FL_rec_abort
  s_waitcnt vmcnt(2)
  s_branch FL_m_2_c2
FL_m_2_ok2:
  v_smfmac_f32_16x16x64_bf16 v[64:67], v[56:59], a[96:103], v23
  v_smfmac_f32_16x16x64_bf16 v[68:71], v[56:59], a[104:111], v23
  v_smfmac_f32_16x16x64_bf16 v[72:75], v[56:59], a[112:119], v23
  v_smfmac_f32_16x16x64_bf16 v[76:79], v[56:59], a[120:127], v23
  s_branch FL_m_done
FL_m_3_c3:
  v_max3_u32 v31, v60, v61, v62
  v_max_u32 v31, v31, v63
  v_cmp_eq_u32 vcc, -1, v31
  s_cbranch_vccz FL_m_3_ok3
FL_m_3_x3:
  s_mov_b64 exec, vcc
  buffer_load_dwordx4 v[60:63], v3, s[4:7], s41 offen offset:3072 sc1
  s_mov_b64 exec, -1
  s_add_u32 s46, s46, 1
  s_cmp_ge_u32 s46, 131072
  s_cbranch_scc1 FL_rec_abort
  s_waitcnt vmcnt(2)
  s_branch FL_m_3_c3
FL_m_3_ok3:
  v_smfmac_f32_16x16x64_bf16 v[64:67], v[60:63], a[144:151], v23
  v_smfmac_f32_16x16x64_bf16 v[68:71], v[60:63], a[152:159], v23
  v_smfmac_f32_16x16x64_bf16 v[72:75], v[60:63], a[160:167], v23
  v_smfmac_f32_16x16x64_bf16 v[76:79], v[60:63], a[168:175], v23
  s_branch FL_m_done
FL_m_01_c0:
  v_max3_u32 v31, v48, v49, v50
  v_max_u32 v31, v31, v51
  v_cmp_eq_u32 vcc, -1, v31
  s_cbranch_vccz FL_m_01_ok0
FL_m_01_x0:
  s_mov_b64 exec, vcc
  buffer_load_dwordx4 v[48:51], v3, s[4:7], s41 offen offset:0 sc1
  s_mov_b64 exec, -1
FL_m_01_c1:
  v_max3_u32 v31, v52, v53, v54
  v_max_u32 v31, v31, v55
  v_cmp_eq_u32 vcc, -1, v31
  s_cbranch_vccz FL_m_01_ok1
FL_m_01_x1:
  s_mov_b64 exec, vcc
  buffer_load_dwordx4 v[52:55], v3, s[4:7], s41 offen offset:1024 sc1
  s_mov_b64 exec, -1
  s_add_u32 s46, s46, 1
  s_cmp_ge_u32 s46, 131072
  s_cbranch_scc1 FL_rec_abort
  s_waitcnt vmcnt(4)
  s_branch FL_m_01_c0
FL_m_01_ok0:
  v_smfmac_f32_16x16x64_bf16 v[64:67], v[48:51], a[0:7], v23
  v_max3_u32 v31, v52, v53, v54
  v_max_u32 v31, v31, v55
  v_cmp_eq_u32 vcc, -1, v31
  v_smfmac_f32_16x16x64_bf16 v[68:71], v[48:51], a[8:15], v23
  v_smfmac_f32_16x16x64_bf16 v[72:75], v[48:51], a[16:23], v23
  v_smfmac_f32_16x16x64_bf16 v[76:79], v[48:51], a[24:31], v23
  s_cbranch_vccz FL_m_1_ok1
  s_branch FL_m_1_x1
FL_m_01_ok1:
  v_smfmac_f32_16x16x64_bf16 v[64:67], v[52:55], a[48:55], v23
  v_max3_u32 v31, v48, v49, v50
  v_max_u32 v31, v31, v51
  v_cmp_eq_u32 vcc, -1, v31
  v_smfmac_f32_16x16x64_bf16 v[68:71], v[52:55], a[56:63], v23
  v_smfmac_f32_16x16x64_bf16 v[72:75], v[52:55], a[64:71], v23
  v_smfmac_f32_16x16x64_bf16 v[76:79], v[52:55], a[72:79], v23
  s_cbranch_vccz FL_m_0_ok0
  s_branch FL_m_0_x0
FL_m_02_c0:
  v_max3_u32 v31, v48, v49, v50
  v_max_u32 v31, v31, v51
  v_cmp_eq_u32 vcc, -1, v31
  s_cbranch_vccz FL_m_02_ok0
FL_m_02_x0:
  s_mov_b64 exec, vcc
  buffer_load_dwordx4 v[48:51], v3, s[4:7], s41 offen offset:0 sc1
  s_mov_b64 exec, -1
FL_m_02_c2:
  v_max3_u32 v31, v56, v57, v58
  v_max_u32 v31, v31, v59
  v_cmp_eq_u32 vcc, -1, v31
  s_cbranch_vccz FL_m_02_ok2
FL_m_02_x2:
  s_mov_b64 exec, vcc
  buffer_load_dwordx4 v[56:59], v3, s[4:7], s41 offen offset:2048 sc1
  s_mov_b64 exec, -1
  s_add_u32 s46, s46, 1
  s_cmp_ge_u32 s46, 131072
  s_cbranch_scc1 FL_rec_abort
  s_waitcnt vmcnt(4)
  s_branch FL_m_02_c0
FL_m_02_ok0:
  v_smfmac_f32_16x16x64_bf16 v[64:67], v[48:51], a[0:7], v23
  v_max3_u32 v31, v56, v57, v58
  v_max_u32 v31, v31, v59
  v_cmp_eq_u32 vcc, -1, v31
  v_smfmac_f32_16x16x64_bf16 v[68:71], v[48:51], a[8:15], v23
  v_smfmac_f32_16x16x64_bf16 v[72:75], v[48:51], a[16:23], v23
  v_smfmac_f32_16x16x64_bf16 v[76:79], v[48:51], a[24:31], v23
  s_cbranch_vccz FL_m_2_ok2
  s_branch FL_m_2_x2
FL_m_02_ok2:
  v_smfmac_f32_16x16x64_bf16 v[64:67], v[56:59], a[96:103], v23
  v_max3_u32 v31, v48, v49, v50
  v_max_u32 v31, v31, v51
  v_cmp_eq_u32 vcc, -1, v31
  v_smfmac_f32_16x16x64_bf16 v[68:71], v[56:59], a[104:111], v23
  v_smfmac_f32_16x16x64_bf16 v[72:75], v[56:59], a[112:119], v23
  v_smfmac_f32_16x16x64_bf16 v[76:79], v[56:59], a[120:127], v23
  s_cbranch_vccz FL_m_0_ok0
  s_branch FL_m_0_x0
FL_m_03_c0:
  v_max3_u32 v31, v48, v49, v50
  v_max_u32 v31, v31, v51
  v_cmp_eq_u32 vcc, -1, v31
  s_cbranch_vccz FL_m_03_ok0
FL_m_03_x0:
  s_mov_b64 exec, vcc
  buffer_load_dwordx4 v[48:51], v3, s[4:7], s41 offen offset:0 sc1
  s_mov_b64 exec, -1
FL_m_03_c3:
  v_max3_u32 v31, v60, v61, v62
  v_max_u32 v31, v31, v63
  v_cmp_eq_u32 vcc, -1, v31
  s_cbranch_vccz FL_m_03_ok3
FL_m_03_x3:
  s_mov_b64 exec, vcc
  buffer_load_dwordx4 v[60:63], v3, s[4:7], s41 offen offset:3072 sc1
  s_mov_b64 exec, -1
  s_add_u32 s46, s46, 1
  s_cmp_ge_u32 s46, 131072
  s_cbranch_scc1 FL_rec_abort
  s_waitcnt vmcnt(4)
  s_branch FL_m_03_c0
FL_m_03_ok0:
  v_smfmac_f32_16x16x64_bf16 v[64:67], v[48:51], a[0:7], v23
  v_max3_u32 v31, v60, v61, v62
  v_max_u32 v31, v31, v63
  v_cmp_eq_u32 vcc, -1, v31
  v_smfmac_f32_16x16x64_bf16 v[68:71], v[48:51], a[8:15], v23
  v_smfmac_f32_16x16x64_bf16 v[72:75], v[48:51], a[16:23], v23
  v_smfmac_f32_16x16x64_bf16 v[76:79], v[48:51], a[24:31], v23
  s_cbranch_vccz FL_m_3_ok3
  s_branch FL_m_3_x3
FL_m_03_ok3:
  v_smfmac_f32_16x16x64_bf16 v[64:67], v[60:63], a[144:151], v23
  v_max3_u32 v31, v48, v49, v50
  v_max_u32 v31, v31, v51
  v_cmp_eq_u32 vcc, -1, v31
  v_smfmac_f32_16x16x64_bf16 v[68:71], v[60:63], a[152:159], v23
  v_smfmac_f32_16x16x64_bf16 v[72:75], v[60:63], a[160:167], v23
  v_smfmac_f32_16x16x64_bf16 v[76:79], v[60:63], a[168:175], v23
  s_cbranch_vccz FL_m_0_ok0
  s_branch FL_m_0_x0
FL_m_12_c1:
  v_max3_u32 v31, v52, v53, v54
  v_max_u32 v31, v31, v55
  v_cmp_eq_u32 vcc, -1, v31
  s_cbranch_vccz FL_m_12_ok1
FL_m_12_x1:
  s_mov_b64 exec, vcc
  buffer_load_dwordx4 v[52:55], v3, s[4:7], s41 offen offset:1024 sc1
  s_mov_b64 exec, -1
FL_m_12_c2:
  v_max3_u32 v31, v56, v57, v58
  v_max_u32 v31, v31, v59
  v_cmp_eq_u32 vcc, -1, v31
  s_cbranch_vccz FL_m_12_ok2
FL_m_12_x2:
  s_mov_b64 exec, vcc
  buffer_load_dwordx4 v[56:59], v3, s[4:7], s41 offen offset:2048 sc1
  s_mov_b64 exec, -1
  s_add_u32 s46, s46, 1
  s_cmp_ge_u32 s46, 131072
  s_cbranch_scc1 FL_rec_abort
  s_waitcnt vmcnt(4)
  s_branch FL_m_12_c1
FL_m_12_ok1:
  v_smfmac_f32_16x16x64_bf16 v[64:67], v[52:55], a[48:55], v23
  v_max3_u32 v31, v56, v57, v58
  v_max_u32 v31, v31, v59
  v_cmp_eq_u32 vcc, -1, v31
  v_smfmac_f32_16x16x64_bf16 v[68:71], v[52:55], a[56:63], v23
  v_smfmac_f32_16x16x64_bf16 v[72:75], v[52:55], a[64:71], v23
  v_smfmac_f32_16x16x64_bf16 v[76:79], v[52:55], a[72:79], v23
  s_cbranch_vccz FL_m_2_ok2
  s_branch FL_m_2_x2
FL_m_12_ok2:
  v_smfmac_f32_16x16x64_bf16 v[64:67], v[56:59], a[96:103], v23
  v_max3_u32 v31, v52, v53, v54
  v_max_u32 v31, v31, v55
  v_cmp_eq_u32 vcc, -1, v31
  v_smfmac_f32_16x16x64_bf16 v[68:71], v[56:59], a[104:111], v23
  v_smfmac_f32_16x16x64_bf16 v[72:75], v[56:59], a[112:119], v23
  v_smfmac_f32_16x16x64_bf16 v[76:79], v[56:59], a[120:127], v23
  s_cbranch_vccz FL_m_1_ok1
  s_branch FL_m_1_x1
FL_m_13_c1:
  v_max3_u32 v31, v52, v53, v54
  v_max_u32 v31, v31, v55
  v_cmp_eq_u32 vcc, -1, v31
  s_cbranch_vccz FL_m_13_ok1
FL_m_13_x1:
  s_mov_b64 exec, vcc
  buffer_load_dwordx4 v[52:55], v3, s[4:7], s41 offen offset:1024 sc1
  s_mov_b64 exec, -1
FL_m_13_c3:
  v_max3_u32 v31, v60, v61, v62
  v_max_u32 v31, v31, v63
  v_cmp_eq_u32 vcc, -1, v31
  s_cbranch_vccz FL_m_13_ok3
FL_m_13_x3:
  s_mov_b64 exec, vcc
  buffer_load_dwordx4 v[60:63], v3, s[4:7], s41 offen offset:3072 sc1
  s_mov_b64 exec, -1
  s_add_u32 s46, s46, 1
  s_cmp_ge_u32 s46, 131072
  s_cbranch_scc1 FL_rec_abort
  s_waitcnt vmcnt(4)
  s_branch FL_m_13_c1
FL_m_13_ok1:
  v_smfmac_f32_16x16x64_bf16 v[64:67], v[52:55], a[48:55], v23
  v_max3_u32 v31, v60, v61, v62
  v_max_u32 v31, v31, v63
  v_cmp_eq_u32 vcc, -1, v31
  v_smfmac_f32_16x16x64_bf16 v[68:71], v[52:55], a[56:63], v23
  v_smfmac_f32_16x16x64_bf16 v[72:75], v[52:55], a[64:71], v23
  v_smfmac_f32_16x16x64_bf16 v[76:79], v[52:55], a[72:79], v23
  s_cbranch_vccz FL_m_3_ok3
  s_branch FL_m_3_x3
FL_m_13_ok3:
  v_smfmac_f32_16x16x64_bf16 v[64:67], v[60:63], a[144:151], v23
  v_max3_u32 v31, v52, v53, v54
  v_max_u32 v31, v31, v55
  v_cmp_eq_u32 vcc, -1, v31
  v_smfmac_f32_16x16x64_bf16 v[68:71], v[60:63], a[152:159], v23
  v_smfmac_f32_16x16x64_bf16 v[72:75], v[60:63], a[160:167], v23
  v_smfmac_f32_16x16x64_bf16 v[76:79], v[60:63], a[168:175], v23
  s_cbranch_vccz FL_m_1_ok1
  s_branch FL_m_1_x1
FL_m_23_c2:
  v_max3_u32 v31, v56, v57, v58
  v_max_u32 v31, v31, v59
  v_cmp_eq_u32 vcc, -1, v31
  s_cbranch_vccz FL_m_23_ok2
FL_m_23_x2:
  s_mov_b64 exec, vcc
  buffer_load_dwordx4 v[56:59], v3, s[4:7], s41 offen offset:2048 sc1
  s_mov_b64 exec, -1
FL_m_23_c3:
  v_max3_u32 v31, v60, v61, v62
  v_max_u32 v31, v31, v63
  v_cmp_eq_u32 vcc, -1, v31
  s_cbranch_vccz FL_m_23_ok3
FL_m_23_x3:
  s_mov_b64 exec, vcc
  buffer_load_dwordx4 v[60:63], v3, s[4:7], s41 offen offset:3072 sc1
  s_mov_b64 exec, -1
  s_add_u32 s46, s46, 1
  s_cmp_ge_u32 s46, 131072
  s_cbranch_scc1 FL_rec_abort
  s_waitcnt vmcnt(4)
  s_branch FL_m_23_c2
FL_m_23_ok2:
  v_smfmac_f32_16x16x64_bf16 v[64:67], v[56:59], a[96:103], v23
  v_max3_u32 v31, v60, v61, v62
  v_max_u32 v31, v31, v63
  v_cmp_eq_u32 vcc, -1, v31
  v_smfmac_f32_16x16x64_bf16 v[68:71], v[56:59], a[104:111], v23
  v_smfmac_f32_16x16x64_bf16 v[72:75], v[56:59], a[112:119], v23
  v_smfmac_f32_16x16x64_bf16 v[76:79], v[56:59], a[120:127], v23
  s_cbranch_vccz FL_m_3_ok3
  s_branch FL_m_3_x3
FL_m_23_ok3:
  v_smfmac_f32_16x16x64_bf16 v[64:67], v[60:63], a[144:151], v23
  v_max3_u32 v31, v56, v57, v58
  v_max_u32 v31, v31, v59
  v_cmp_eq_u32 vcc, -1, v31
  v_smfmac_f32_16x16x64_bf16 v[68:71], v[60:63], a[152:159], v23
  v_smfmac_f32_16x16x64_bf16 v[72:75], v[60:63], a[160:167], v23
  v_smfmac_f32_16x16x64_bf16 v[76:79], v[60:63], a[168:175], v23
  s_cbranch_vccz FL_m_2_ok2
  s_branch FL_m_2_x2
FL_m_012_c0:
  v_max3_u32 v31, v48, v49, v50
  v_max_u32 v31, v31, v51
  v_cmp_eq_u32 vcc, -1, v31
  s_cbranch_vccz FL_m_012_ok0
FL_m_012_x0:
  s_mov_b64 exec, vcc
  buffer_load_dwordx4 v[48:51], v3, s[4:7], s41 offen offset:0 sc1
  s_mov_b64 exec, -1
FL_m_012_c1:
  v_max3_u32 v31, v52, v53, v54
  v_max_u32 v31, v31, v55
  v_cmp_eq_u32 vcc, -1, v31
  s_cbranch_vccz FL_m_012_ok1
FL_m_012_x1:
  s_mov_b64 exec, vcc
  buffer_load_dwordx4 v[52:55], v3, s[4:7], s41 offen offset:1024 sc1
  s_mov_b64 exec, -1
FL_m_012_c2:
  v_max3_u32 v31, v56, v57, v58
  v_max_u32 v31, v31, v59
  v_cmp_eq_u32 vcc, -1, v31
  s_cbranch_vccz FL_m_012_ok2
FL_m_012_x2:
  s_mov_b64 exec, vcc
  buffer_load_dwordx4 v[56:59], v3, s[4:7], s41 offen offset:2048 sc1
  s_mov_b64 exec, -1
  s_add_u32 s46, s46, 1
  s_cmp_ge_u32 s46, 131072
  s_cbranch_scc1 FL_rec_abort
  s_waitcnt vmcnt(4)
  s_branch FL_m_012_c0
FL_m_012_ok0:
  v_smfmac_f32_16x16x64_bf16 v[64:67], v[48:51], a[0:7], v23
  v_max3_u32 v31, v52, v53, v54
  v_max_u32 v31, v31, v55
  v_cmp_eq_u32 vcc, -1, v31
  v_smfmac_f32_16x16x64_bf16 v[68:71], v[48:51], a[8:15], v23
  v_smfmac_f32_16x16x64_bf16 v[72:75], v[48:51], a[16:23], v23
  v_smfmac_f32_16x16x64_bf16 v[76:79], v[48:51], a[24:31], v23
  s_cbranch_vccz FL_m_12_ok1
  s_branch FL_m_12_x1
FL_m_012_ok1:
  v_smfmac_f32_16x16x64_bf16 v[64:67], v[52:55], a[48:55], v23
  v_max3_u32 v31, v56, v57, v58
  v_max_u32 v31, v31, v59
  v_cmp_eq_u32 vcc, -1, v31
  v_smfmac_f32_16x16x64_bf16 v[68:71], v[52:55], a[56:63], v23
  v_smfmac_f32_16x16x64_bf16 v[72:75], v[52:55], a[64:71], v23
  v_smfmac_f32_16x16x64_bf16 v[76:79], v[52:55], a[72:79], v23
  s_cbranch_vccz FL_m_02_ok2
  s_branch FL_m_02_x2
FL_m_012_ok2:
  v_smfmac_f32_16x16x64_bf16 v[64:67], v[56:59], a[96:103], v23
  v_max3_u32 v31, v48, v49, v50
  v_max_u32 v31, v31, v51
  v_cmp_eq_u32 vcc, -1, v31
  v_smfmac_f32_16x16x64_bf16 v[68:71], v[56:59], a[104:111], v23
  v_smfmac_f32_16x16x64_bf16 v[72:75], v[56:59], a[112:119], v23
  v_smfmac_f32_16x16x64_bf16 v[76:79], v[56:59], a[120:127], v23
  s_cbranch_vccz FL_m_01_ok0
  s_branch FL_m_01_x0
FL_m_013_c0:
  v_max3_u32 v31, v48, v49, v50
  v_max_u32 v31, v31, v51
  v_cmp_eq_u32 vcc, -1, v31
  s_cbranch_vccz FL_m_013_ok0
FL_m_013_x0:
  s_mov_b64 exec, vcc
  buffer_load_dwordx4 v[48:51], v3, s[4:7], s41 offen offset:0 sc1
  s_mov_b64 exec, -1
FL_m_013_c1:
  v_max3_u32 v31, v52, v53, v54
  v_max_u32 v31, v31, v55
  v_cmp_eq_u32 vcc, -1, v31
  s_cbranch_vccz FL_m_013_ok1
FL_m_013_x1:
  s_mov_b64 exec, vcc
  buffer_load_dwordx4 v[52:55], v3, s[4:7], s41 offen offset:1024 sc1
  s_mov_b64 exec, -1
FL_m_013_c3:
  v_max3_u32 v31, v60, v61, v62
  v_max_u32 v31, v31, v63
  v_cmp_eq_u32 vcc, -1, v31
  s_cbranch_vccz FL_m_013_ok3
FL_m_013_x3:
  s_mov_b64 exec, vcc
  buffer_load_dwordx4 v[60:63], v3, s[4:7], s41 offen offset:3072 sc1
  s_mov_b64 exec, -1
  s_add_u32 s46, s46, 1
  s_cmp_ge_u32 s46, 131072
  s_cbranch_scc1 FL_rec_abort
  s_waitcnt vmcnt(4)
  s_branch FL_m_013_c0
FL_m_013_ok0:
  v_smfmac_f32_16x16x64_bf16 v[64:67], v[48:51], a[0:7], v23
  v_max3_u32 v31, v52, v53, v54
  v_max_u32 v31, v31, v55
  v_cmp_eq_u32 vcc, -1, v31
  v_smfmac_f32_16x16x64_bf16 v[68:71], v[48:51], a[8:15], v23
  v_smfmac_f32_16x16x64_bf16 v[72:75], v[48:51], a[16:23], v23
  v_smfmac_f32_16x16x64_bf16 v[76:79], v[48:51], a[24:31], v23
  s_cbranch_vccz FL_m_13_ok1
  s_branch FL_m_13_x1
FL_m_013_ok1:
  v_smfmac_f32_16x16x64_bf16 v[64:67], v[52:55], a[48:55], v23
  v_max3_u32 v31, v60, v61, v62
  v_max_u32 v31, v31, v63
  v_cmp_eq_u32 vcc, -1, v31
  v_smfmac_f32_16x16x64_bf16 v[68:71], v[52:55], a[56:63], v23
  v_smfmac_f32_16x16x64_bf16 v[72:75], v[52:55], a[64:71], v23
  v_smfmac_f32_16x16x64_bf16 v[76:79], v[52:55], a[72:79], v23
  s_cbranch_vccz FL_m_03_ok3
  s_branch FL_m_03_x3
FL_m_013_ok3:
  v_smfmac_f32_16x16x64_bf16 v[64:67], v[60:63], a[144:151], v23
  v_max3_u32 v31, v48, v49, v50
  v_max_u32 v31, v31, v51
  v_cmp_eq_u32 vcc, -1, v31
  v_smfmac_f32_16x16x64_bf16 v[68:71], v[60:63], a[152:159], v23
  v_smfmac_f32_16x16x64_bf16 v[72:75], v[60:63], a[160:167], v23
  v_smfmac_f32_16x16x64_bf16 v[76:79], v[60:63], a[168:175], v23
  s_cbranch_vccz FL_m_01_ok0
  s_branch FL_m_01_x0
FL_m_023_c0:
  v_max3_u32 v31, v48, v49, v50
  v_max_u32 v31, v31, v51
  v_cmp_eq_u32 vcc, -1, v31
  s_cbranch_vccz FL_m_023_ok0
FL_m_023_x0:
  s_mov_b64 exec, vcc
  buffer_load_dwordx4 v[48:51], v3, s[4:7], s41 offen offset:0 sc1
  s_mov_b64 exec, -1
FL_m_023_c2:
  v_max3_u32 v31, v56, v57, v58
  v_max_u32 v31, v31, v59
  v_cmp_eq_u32 vcc, -1, v31
  s_cbranch_vccz FL_m_023_ok2
FL_m_023_x2:
  s_mov_b64 exec, vcc
  buffer_load_dwordx4 v[56:59], v3, s[4:7], s41 offen offset:2048 sc1
  s_mov_b64 exec, -1
FL_m_023_c3:
  v_max3_u32 v31, v60, v61, v62
  v_max_u32 v31, v31, v63
  v_cmp_eq_u32 vcc, -1, v31
  s_cbranch_vccz FL_m_023_ok3
FL_m_023_x3:
  s_mov_b64 exec, vcc
  buffer_load_dwordx4 v[60:63], v3, s[4:7], s41 offen offset:3072 sc1
  s_mov_b64 exec, -1
  s_add_u32 s46, s46, 1
  s_cmp_ge_u32 s46, 131072
  s_cbranch_scc1 FL_rec_abort
  s_waitcnt vmcnt(4)
  s_branch FL_m_023_c0
FL_m_023_ok0:
  v_smfmac_f32_16x16x64_bf16 v[64:67], v[48:51], a[0:7], v23
  v_max3_u32 v31, v56, v57, v58
  v_max_u32 v31, v31, v59
  v_cmp_eq_u32 vcc, -1, v31
  v_smfmac_f32_16x16x64_bf16 v[68:71], v[48:51], a[8:15], v23
  v_smfmac_f32_16x16x64_bf16 v[72:75], v[48:51], a[16:23], v23
  v_smfmac_f32_16x16x64_bf16 v[76:79], v[48:51], a[24:31], v23
  s_cbranch_vccz FL_m_23_ok2
  s_branch FL_m_23_x2
FL_m_023_ok2:
  v_smfmac_f32_16x16x64_bf16 v[64:67], v[56:59], a[96:103], v23
  v_max3_u32 v31, v60, v61, v62
  v_max_u32 v31, v31, v63
  v_cmp_eq_u32 vcc, -1, v31
  v_smfmac_f32_16x16x64_bf16 v[68:71], v[56:59], a[104:111], v23
  v_smfmac_f32_16x16x64_bf16 v[72:75], v[56:59], a[112:119], v23
  v_smfmac_f32_16x16x64_bf16 v[76:79], v[56:59], a[120:127], v23
  s_cbranch_vccz FL_m_03_ok3
  s_branch FL_m_03_x3
FL_m_023_ok3:
  v_smfmac_f32_16x16x64_bf16 v[64:67], v[60:63], a[144:151], v23
  v_max3_u32 v31, v48, v49, v50
  v_max_u32 v31, v31, v51
  v_cmp_eq_u32 vcc, -1, v31
  v_smfmac_f32_16x16x64_bf16 v[68:71], v[60:63], a[152:159], v23
  v_smfmac_f32_16x16x64_bf16 v[72:75], v[60:63], a[160:167], v23
  v_smfmac_f32_16x16x64_bf16 v[76:79], v[60:63], a[168:175], v23
  s_cbranch_vccz FL_m_02_ok0
  s_branch FL_m_02_x0
FL_m_123_c1:
  v_max3_u32 v31, v52, v53, v54
  v_max_u32 v31, v31, v55
  v_cmp_eq_u32 vcc, -1, v31
  s_cbranch_vccz FL_m_123_ok1
FL_m_123_x1:
  s_mov_b64 exec, vcc
  buffer_load_dwordx4 v[52:55], v3, s[4:7], s41 offen offset:1024 sc1
  s_mov_b64 exec, -1
FL_m_123_c2:
  v_max3_u32 v31, v56, v57, v58
  v_max_u32 v31, v31, v59
  v_cmp_eq_u32 vcc, -1, v31
  s_cbranch_vccz FL_m_123_ok2
FL_m_123_x2:
  s_mov_b64 exec, vcc
  buffer_load_dwordx4 v[56:59], v3, s[4:7], s41 offen offset:2048 sc1
  s_mov_b64 exec, -1
FL_m_123_c3:
  v_max3_u32 v31, v60, v61, v62
  v_max_u32 v31, v31, v63
  v_cmp_eq_u32 vcc, -1, v31
  s_cbranch_vccz FL_m_123_ok3
FL_m_123_x3:
  s_mov_b64 exec, vcc
  buffer_load_dwordx4 v[60:63], v3, s[4:7], s41 offen offset:3072 sc1
  s_mov_b64 exec, -1
  s_add_u32 s46, s46, 1
  s_cmp_ge_u32 s46, 131072
  s_cbranch_scc1 FL_rec_abort
  s_waitcnt vmcnt(4)
  s_branch FL_m_123_c1
FL_m_123_ok1:
  v_smfmac_f32_16x16x64_bf16 v[64:67], v[52:55], a[48:55], v23
  v_max3_u32 v31, v56, v57, v58
  v_max_u32 v31, v31, v59
  v_cmp_eq_u32 vcc, -1, v31
  v_smfmac_f32_16x16x64_bf16 v[68:71], v[52:55], a[56:63], v23
  v_smfmac_f32_16x16x64_bf16 v[72:75], v[52:55], a[64:71], v23
  v_smfmac_f32_16x16x64_bf16 v[76:79], v[52:55], a[72:79], v23
  s_cbranch_vccz FL_m_23_ok2
  s_branch FL_m_23_x2
FL_m_123_ok2:
  v_smfmac_f32_16x16x64_bf16 v[64:67], v[56:59], a[96:103], v23
  v_max3_u32 v31, v60, v61, v62
  v_max_u32 v31, v31, v63
  v_cmp_eq_u32 vcc, -1, v31
  v_smfmac_f32_16x16x64_bf16 v[68:71], v[56:59], a[104:111], v23
  v_smfmac_f32_16x16x64_bf16 v[72:75], v[56:59], a[112:119], v23
  v_smfmac_f32_16x16x64_bf16 v[76:79], v[56:59], a[120:127], v23
  s_cbranch_vccz FL_m_13_ok3
  s_branch FL_m_13_x3
FL_m_123_ok3:
  v_smfmac_f32_16x16x64_bf16 v[64:67], v[60:63], a[144:151], v23
  v_max3_u32 v31, v52, v53, v54
  v_max_u32 v31, v31, v55
  v_cmp_eq_u32 vcc, -1, v31
  v_smfmac_f32_16x16x64_bf16 v[68:71], v[60:63], a[152:159], v23
  v_smfmac_f32_16x16x64_bf16 v[72:75], v[60:63], a[160:167], v23
  v_smfmac_f32_16x16x64_bf16 v[76:79], v[60:63], a[168:175], v23
  s_cbranch_vccz FL_m_12_ok1
  s_branch FL_m_12_x1
FL_m_0123_c0:
  v_max3_u32 v31, v48, v49, v50
  v_max_u32 v31, v31, v51
  v_cmp_eq_u32 vcc, -1, v31
  s_cbranch_vccz FL_m_0123_ok0
FL_m_0123_x0:
  s_mov_b64 exec, vcc
  buffer_load_dwordx4 v[48:51], v3, s[4:7], s41 offen offset:0 sc1
  s_mov_b64 exec, -1
FL_m_0123_c1:
  v_max3_u32 v31, v52, v53, v54
  v_max_u32 v31, v31, v55
  v_cmp_eq_u32 vcc, -1, v31
  s_cbranch_vccz FL_m_0123_ok1
FL_m_0123_x1:
  s_mov_b64 exec, vcc
  buffer_load_dwordx4 v[52:55], v3, s[4:7], s41 offen offset:1024 sc1
  s_mov_b64 exec, -1
FL_m_0123_c2:
  v_max3_u32 v31, v56, v57, v58
  v_max_u32 v31, v31, v59
  v_cmp_eq_u32 vcc, -1, v31
  s_cbranch_vccz FL_m_0123_ok2
FL_m_0123_x2:
  s_mov_b64 exec, vcc
  buffer_load_dwordx4 v[56:59], v3, s[4:7], s41 offen offset:2048 sc1
  s_mov_b64 exec, -1
FL_m_0123_c3:
  v_max3_u32 v31, v60, v61, v62
  v_max_u32 v31, v31, v63
  v_cmp_eq_u32 vcc, -1, v31
  s_cbranch_vccz FL_m_0123_ok3
FL_m_0123_x3:
  s_mov_b64 exec, vcc
  buffer_load_dwordx4 v[60:63], v3, s[4:7], s41 offen offset:3072 sc1
  s_mov_b64 exec, -1
  s_add_u32 s46, s46, 1
  s_cmp_ge_u32 s46, 131072
  s_cbranch_scc1 FL_rec_abort
  s_waitcnt vmcnt(4)
  s_branch FL_m_0123_c0
FL_m_0123_ok0:
  v_smfmac_f32_16x16x64_bf16 v[64:67], v[48:51], a[0:7], v23
  v_max3_u32 v31, v52, v53, v54
  v_max_u32 v31, v31, v55
  v_cmp_eq_u32 vcc, -1, v31
  v_smfmac_f32_16x16x64_bf16 v[68:71], v[48:51], a[8:15], v23
  v_smfmac_f32_16x16x64_bf16 v[72:75], v[48:51], a[16:23], v23
  v_smfmac_f32_16x16x64_bf16 v[76:79], v[48:51], a[24:31], v23
  s_cbranch_vccz FL_m_123_ok1
  s_branch FL_m_123_x1
FL_m_0123_ok1:
  v_smfmac_f32_16x16x64_bf16 v[64:67], v[52:55], a[48:55], v23
  v_max3_u32 v31, v56, v57, v58
  v_max_u32 v31, v31, v59
  v_cmp_eq_u32 vcc, -1, v31
  v_smfmac_f32_16x16x64_bf16 v[68:71], v[52:55], a[56:63], v23
  v_smfmac_f32_16x16x64_bf16 v[72:75], v[52:55], a[64:71], v23
  v_smfmac_f32_16x16x64_bf16 v[76:79], v[52:55], a[72:79], v23
  s_cbranch_vccz FL_m_023_ok2
  s_branch FL_m_023_x2
FL_m_0123_ok2:
  v_smfmac_f32_16x16x64_bf16 v[64:67], v[56:59], a[96:103], v23
  v_max3_u32 v31, v60, v61, v62
  v_max_u32 v31, v31, v63
  v_cmp_eq_u32 vcc, -1, v31
  v_smfmac_f32_16x16x64_bf16 v[68:71], v[56:59], a[104:111], v23
  v_smfmac_f32_16x16x64_bf16 v[72:75], v[56:59], a[112:119], v23
  v_smfmac_f32_16x16x64_bf16 v[76:79], v[56:59], a[120:127], v23
  s_cbranch_vccz FL_m_013_ok3
  s_branch FL_m_013_x3
FL_m_0123_ok3:
  v_smfmac_f32_16x16x64_bf16 v[64:67], v[60:63], a[144:151], v23
  v_max3_u32 v31, v48, v49, v50
  v_max_u32 v31, v31, v51
  v_cmp_eq_u32 vcc, -1, v31
  v_smfmac_f32_16x16x64_bf16 v[68:71], v[60:63], a[152:159], v23
  v_smfmac_f32_16x16x64_bf16 v[72:75], v[60:63], a[160:167], v23
  v_smfmac_f32_16x16x64_bf16 v[76:79], v[60:63], a[168:175], v23
  s_cbranch_vccz FL_m_012_ok0
  s_branch FL_m_012_x0
FL_x_f0:
  s_mov_b64 exec, vcc
  buffer_load_dwordx4 v[64:67], v9, s[4:7], s41 offen offset:0 sc1
  s_mov_b64 exec, -1
  s_waitcnt vmcnt(2)
  s_branch FL_x_0123_c1
FL_x_f1:
  s_mov_b64 exec, vcc
  buffer_load_dwordx4 v[68:71], v9, s[4:7], s41 offen offset:1024 sc1
  s_mov_b64 exec, -1
  s_waitcnt vmcnt(2)
  s_branch FL_x_123_c2
FL_x_f2:
  s_mov_b64 exec, vcc
  buffer_load_dwordx4 v[72:75], v9, s[4:7], s41 offen offset:2048 sc1
  s_mov_b64 exec, -1
  s_waitcnt vmcnt(2)
  s_branch FL_x_23_c3
FL_x_f3:
  s_mov_b64 exec, vcc
  buffer_load_dwordx4 v[76:79], v9, s[4:7], s41 offen offset:3072 sc1
  s_mov_b64 exec, -1
  s_nop 7
  s_branch FL_x_3_c3
FL_x_0_c0:
  v_max3_u32 v31, v64, v65, v66
  v_max_u32 v31, v31, v67
  v_cmp_eq_u32 vcc, -1, v31
  s_cbranch_vccz FL_x_0_ok0
FL_x_0_x0:
  s_mov_b64 exec, vcc
  buffer_load_dwordx4 v[64:67], v9, s[4:7], s41 offen offset:0 sc1
  s_mov_b64 exec, -1
  s_add_u32 s46, s46, 1
  s_cmp_ge_u32 s46, 131072
  s_cbranch_scc1 FL_rec_abort
  s_waitcnt vmcnt(2)
  s_branch FL_x_0_c0
FL_x_0_ok0:
  v_mfma_f32_16x16x32_bf16 v[44:47], v[64:67], v[64:67], v[44:47]
  v_mfma_f32_16x16x32_bf16 v[36:39], v[116:119], v[64:67], v[36:39]
  v_mfma_f32_16x16x32_bf16 v[40:43], v[132:135], v[64:67], v[40:43]
  s_branch FL_x_done
FL_x_1_c1:
  v_max3_u32 v31, v68, v69, v70
  v_max_u32 v31, v31, v71
  v_cmp_eq_u32 vcc, -1, v31
  s_cbranch_vccz FL_x_1_ok1
FL_x_1_x1:
  s_mov_b64 exec, vcc
  buffer_load_dwordx4 v[68:71], v9, s[4:7], s41 offen offset:1024 sc1
  s_mov_b64 exec, -1
  s_add_u32 s46, s46, 1
  s_cmp_ge_u32 s46, 131072
  s_cbranch_scc1 FL_rec_abort
  s_waitcnt vmcnt(2)
  s_branch FL_x_1_c1
FL_x_1_ok1:
  v_mfma_f32_16x16x32_bf16 v[44:47], v[68:71], v[68:71], v[44:47]
  v_mfma_f32_16x16x32_bf16 v[36:39], v[120:123], v[68:71], v[36:39]
  v_mfma_f32_16x16x32_bf16 v[40:43], v[136:139], v[68:71], v[40:43]
  s_branch FL_x_done
FL_x_2_c2:
  v_max3_u32 v31, v72, v73, v74
  v_max_u32 v31, v31, v75
  v_cmp_eq_u32 vcc, -1, v31
  s_cbranch_vccz FL_x_2_ok2
FL_x_2_x2:
  s_mov_b64 exec, vcc
  buffer_load_dwordx4 v[72:75], v9, s[4:7], s41 offen offset:2048 sc1
  s_mov_b64 exec, -1
  s_add_u32 s46, s46, 1
  s_cmp_ge_u32 s46, 131072
  s_cbranch_scc1 FL_rec_abort
  s_waitcnt vmcnt(2)
  s_branch FL_x_2_c2
FL_x_2_ok2:
  v_mfma_f32_16x16x32_bf16 v[44:47], v[72:75], v[72:75], v[44:47]
  v_mfma_f32_16x16x32_bf16 v[36:39], v[124:127], v[72:75], v[36:39]
  v_mfma_f32_16x16x32_bf16 v[40:43], v[140:143], v[72:75], v[40:43]
  s_branch FL_x_done
FL_x_3_c3:
  v_max3_u32 v31, v76, v77, v78
  v_max_u32 v31, v31, v79
  v_cmp_eq_u32 vcc, -1, v31
  s_cbranch_vccz FL_x_3_ok3
FL_x_3_x3:
  s_mov_b64 exec, vcc
  buffer_load_dwordx4 v[76:79], v9, s[4:7], s41 offen offset:3072 sc1
  s_mov_b64 exec, -1
  s_add_u32 s46, s46, 1
  s_cmp_ge_u32 s46, 131072
  s_cbranch_scc1 FL_rec_abort
  s_waitcnt vmcnt(2)
  s_branch FL_x_3_c3
FL_x_3_ok3:
  v_mfma_f32_16x16x32_bf16 v[44:47], v[76:79], v[76:79], v[44:47]
  v_mfma_f32_16x16x32_bf16 v[36:39], v[128:131], v[76:79], v[36:39]
  v_mfma_f32_16x16x32_bf16 v[40:43], v[144:147], v[76:79], v[40:43]
  s_branch FL_x_done
FL_x_01_c0:
  v_max3_u32 v31, v64, v65, v66
  v_max_u32 v31, v31, v67
  v_cmp_eq_u32 vcc, -1, v31
  s_cbranch_vccz FL_x_01_ok0
FL_x_01_x0:
  s_mov_b64 exec, vcc
  buffer_load_dwordx4 v[64:67], v9, s[4:7], s41 offen offset:0 sc1
  s_mov_b64 exec, -1
FL_x_01_c1:
  v_max3_u32 v31, v68, v69, v70
  v_max_u32 v31, v31, v71
  v_cmp_eq_u32 vcc, -1, v31
  s_cbranch_vccz FL_x_01_ok1
FL_x_01_x1:
  s_mov_b64 exec, vcc
  buffer_load_dwordx4 v[68:71], v9, s[4:7], s41 offen offset:1024 sc1
  s_mov_b64 exec, -1
  s_add_u32 s46, s46, 1
  s_cmp_ge_u32 s46, 131072
  s_cbranch_scc1 FL_rec_abort
  s_waitcnt vmcnt(4)
  s_branch FL_x_01_c0
FL_x_01_ok0:
  v_mfma_f32_16x16x32_bf16 v[44:47], v[64:67], v[64:67], v[44:47]
  v_max3_u32 v31, v68, v69, v70
  v_max_u32 v31, v31, v71
  v_cmp_eq_u32 vcc, -1, v31
  v_mfma_f32_16x16x32_bf16 v[36:39], v[116:119], v[64:67], v[36:39]
  v_mfma_f32_16x16x32_bf16 v[40:43], v[132:135], v[64:67], v[40:43]
  s_cbranch_vccz FL_x_1_ok1
  s_branch FL_x_1_x1
FL_x_01_ok1:
  v_mfma_f32_16x16x32_bf16 v[44:47], v[68:71], v[68:71], v[44:47]
  v_max3_u32 v31, v64, v65, v66
  v_max_u32 v31, v31, v67
  v_cmp_eq_u32 vcc, -1, v31
  v_mfma_f32_16x16x32_bf16 v[36:39], v[120:123], v[68:71], v[36:39]
  v_mfma_f32_16x16x32_bf16 v[40:43], v[136:139], v[68:71], v[40:43]
  s_cbranch_vccz FL_x_0_ok0
  s_branch FL_x_0_x0
FL_x_02_c0:
  v_max3_u32 v31, v64, v65, v66
  v_max_u32 v31, v31, v67
  v_cmp_eq_u32 vcc, -1, v31
  s_cbranch_vccz FL_x_02_ok0
FL_x_02_x0:
  s_mov_b64 exec, vcc
  buffer_load_dwordx4 v[64:67], v9, s[4:7], s41 offen offset:0 sc1
  s_mov_b64 exec, -1
FL_x_02_c2:
  v_max3_u32 v31, v72, v73, v74
  v_max_u32 v31, v31, v75
  v_cmp_eq_u32 vcc, -1, v31
  s_cbranch_vccz FL_x_02_ok2
FL_x_02_x2:
  s_mov_b64 exec, vcc
  buffer_load_dwordx4 v[72:75], v9, s[4:7], s41 offen offset:2048 sc1
  s_mov_b64 exec, -1
  s_add_u32 s46, s46, 1
  s_cmp_ge_u32 s46, 131072
  s_cbranch_scc1 FL_rec_abort
  s_waitcnt vmcnt(4)
  s_branch FL_x_02_c0
FL_x_02_ok0:
  v_mfma_f32_16x16x32_bf16 v[44:47], v[64:67], v[64:67], v[44:47]
  v_max3_u32 v31, v72, v73, v74
  v_max_u32 v31, v31, v75
  v_cmp_eq_u32 vcc, -1, v31
  v_mfma_f32_16x16x32_bf16 v[36:39], v[116:119], v[64:67], v[36:39]
  v_mfma_f32_16x16x32_bf16 v[40:43], v[132:135], v[64:67], v[40:43]
  s_cbranch_vccz FL_x_2_ok2
  s_branch FL_x_2_x2
FL_x_02_ok2:
  v_mfma_f32_16x16x32_bf16 v[44:47], v[72:75], v[72:75], v[44:47]
  v_max3_u32 v31, v64, v65, v66
  v_max_u32 v31, v31, v67
  v_cmp_eq_u32 vcc, -1, v31
  v_mfma_f32_16x16x32_bf16 v[36:39], v[124:127], v[72:75], v[36:39]
  v_mfma_f32_16x16x32_bf16 v[40:43], v[140:143], v[72:75], v[40:43]
  s_cbranch_vccz FL_x_0_ok0
  s_branch FL_x_0_x0
FL_x_03_c0:
  v_max3_u32 v31, v64, v65, v66
  v_max_u32 v31, v31, v67
  v_cmp_eq_u32 vcc, -1, v31
  s_cbranch_vccz FL_x_03_ok0
FL_x_03_x0:
  s_mov_b64 exec, vcc
  buffer_load_dwordx4 v[64:67], v9, s[4:7], s41 offen offset:0 sc1
  s_mov_b64 exec, -1
FL_x_03_c3:
  v_max3_u32 v31, v76, v77, v78
  v_max_u32 v31, v31, v79
  v_cmp_eq_u32 vcc, -1, v31
  s_cbranch_vccz FL_x_03_ok3
FL_x_03_x3:
  s_mov_b64 exec, vcc
  buffer_load_dwordx4 v[76:79], v9, s[4:7], s41 offen offset:3072 sc1
  s_mov_b64 exec, -1
  s_add_u32 s46, s46, 1
  s_cmp_ge_u32 s46, 131072
  s_cbranch_scc1 FL_rec_abort
  s_waitcnt vmcnt(4)
  s_branch FL_x_03_c0
FL_x_03_ok0:
  v_mfma_f32_16x16x32_bf16 v[44:47], v[64:67], v[64:67], v[44:47]
  v_max3_u32 v31, v76, v77, v78
  v_max_u32 v31, v31, v79
  v_cmp_eq_u32 vcc, -1, v31
  v_mfma_f32_16x16x32_bf16 v[36:39], v[116:119], v[64:67], v[36:39]
  v_mfma_f32_16x16x32_bf16 v[40:43], v[132:135], v[64:67], v[40:43]
  s_cbranch_vccz FL_x_3_ok3
  s_branch FL_x_3_x3
FL_x_03_ok3:
  v_mfma_f32_16x16x32_bf16 v[44:47], v[76:79], v[76:79], v[44:47]
  v_max3_u32 v31, v64, v65, v66
  v_max_u32 v31, v31, v67
  v_cmp_eq_u32 vcc, -1, v31
  v_mfma_f32_16x16x32_bf16 v[36:39], v[128:131], v[76:79], v[36:39]
  v_mfma_f32_16x16x32_bf16 v[40:43], v[144:147], v[76:79], v[40:43]
  s_cbranch_vccz FL_x_0_ok0
  s_branch FL_x_0_x0
FL_x_12_c1:
  v_max3_u32 v31, v68, v69, v70
  v_max_u32 v31, v31, v71
  v_cmp_eq_u32 vcc, -1, v31
  s_cbranch_vccz FL_x_12_ok1
FL_x_12_x1:
  s_mov_b64 exec, vcc
  buffer_load_dwordx4 v[68:71], v9, s[4:7], s41 offen offset:1024 sc1
  s_mov_b64 exec, -1
FL_x_12_c2:
  v_max3_u32 v31, v72, v73, v74
  v_max_u32 v31, v31, v75
  v_cmp_eq_u32 vcc, -1, v31
  s_cbranch_vccz FL_x_12_ok2
FL_x_12_x2:
  s_mov_b64 exec, vcc
  buffer_load_dwordx4 v[72:75], v9, s[4:7], s41 offen offset:2048 sc1
  s_mov_b64 exec, -1
  s_add_u32 s46, s46, 1
  s_cmp_ge_u32 s46, 131072
  s_cbranch_scc1 FL_rec_abort
  s_waitcnt vmcnt(4)
  s_branch FL_x_12_c1
FL_x_12_ok1:
  v_mfma_f32_16x16x32_bf16 v[44:47], v[68:71], v[68:71], v[44:47]
  v_max3_u32 v31, v72, v73, v74
  v_max_u32 v31, v31, v75
  v_cmp_eq_u32 vcc, -1, v31
  v_mfma_f32_16x16x32_bf16 v[36:39], v[120:123], v[68:71], v[36:39]
  v_mfma_f32_16x16x32_bf16 v[40:43], v[136:139], v[68:71], v[40:43]
  s_cbranch_vccz FL_x_2_ok2
  s_branch FL_x_2_x2
FL_x_12_ok2:
  v_mfma_f32_16x16x32_bf16 v[44:47], v[72:75], v[72:75], v[44:47]
  v_max3_u32 v31, v68, v69, v70
  v_max_u32 v31, v31, v71
  v_cmp_eq_u32 vcc, -1, v31
  v_mfma_f32_16x16x32_bf16 v[36:39], v[124:127], v[72:75], v[36:39]
  v_mfma_f32_16x16x32_bf16 v[40:43], v[140:143], v[72:75], v[40:43]
  s_cbranch_vccz FL_x_1_ok1
  s_branch FL_x_1_x1
FL_x_13_c1:
  v_max3_u32 v31, v68, v69, v70
  v_max_u32 v31, v31, v71
  v_cmp_eq_u32 vcc, -1, v31
  s_cbranch_vccz FL_x_13_ok1
FL_x_13_x1:
  s_mov_b64 exec, vcc
  buffer_load_dwordx4 v[68:71], v9, s[4:7], s41 offen offset:1024 sc1
  s_mov_b64 exec, -1
FL_x_13_c3:
  v_max3_u32 v31, v76, v77, v78
  v_max_u32 v31, v31, v79
  v_cmp_eq_u32 vcc, -1, v31
  s_cbranch_vccz FL_x_13_ok3
FL_x_13_x3:
  s_mov_b64 exec, vcc
  buffer_load_dwordx4 v[76:79], v9, s[4:7], s41 offen offset:3072 sc1
  s_mov_b64 exec, -1
  s_add_u32 s46, s46, 1
  s_cmp_ge_u32 s46, 131072
  s_cbranch_scc1 FL_rec_abort
  s_waitcnt vmcnt(4)
  s_branch FL_x_13_c1
FL_x_13_ok1:
  v_mfma_f32_16x16x32_bf16 v[44:47], v[68:71], v[68:71], v[44:47]
  v_max3_u32 v31, v76, v77, v78
  v_max_u32 v31, v31, v79
  v_cmp_eq_u32 vcc, -1, v31
  v_mfma_f32_16x16x32_bf16 v[36:39], v[120:123], v[68:71], v[36:39]
  v_mfma_f32_16x16x32_bf16 v[40:43], v[136:139], v[68:71], v[40:43]
  s_cbranch_vccz FL_x_3_ok3
  s_branch FL_x_3_x3
FL_x_13_ok3:
  v_mfma_f32_16x16x32_bf16 v[44:47], v[76:79], v[76:79], v[44:47]
  v_max3_u32 v31, v68, v69, v70
  v_max_u32 v31, v31, v71
  v_cmp_eq_u32 vcc, -1, v31
  v_mfma_f32_16x16x32_bf16 v[36:39], v[128:131], v[76:79], v[36:39]
  v_mfma_f32_16x16x32_bf16 v[40:43], v[144:147], v[76:79], v[40:43]
  s_cbranch_vccz FL_x_1_ok1
  s_branch FL_x_1_x1
FL_x_23_c2:
  v_max3_u32 v31, v72, v73, v74
  v_max_u32 v31, v31, v75
  v_cmp_eq_u32 vcc, -1, v31
  s_cbranch_vccz FL_x_23_ok2
FL_x_23_x2:
  s_mov_b64 exec, vcc
  buffer_load_dwordx4 v[72:75], v9, s[4:7], s41 offen offset:2048 sc1
  s_mov_b64 exec, -1
FL_x_23_c3:
  v_max3_u32 v31, v76, v77, v78
  v_max_u32 v31, v31, v79
  v_cmp_eq_u32 vcc, -1, v31
  s_cbranch_vccz FL_x_23_ok3
FL_x_23_x3:
  s_mov_b64 exec, vcc
  buffer_load_dwordx4 v[76:79], v9, s[4:7], s41 offen offset:3072 sc1
  s_mov_b64 exec, -1
  s_add_u32 s46, s46, 1
  s_cmp_ge_u32 s46, 131072
  s_cbranch_scc1 FL_rec_abort
  s_waitcnt vmcnt(4)
  s_branch FL_x_23_c2
FL_x_23_ok2:
  v_mfma_f32_16x16x32_bf16 v[44:47], v[72:75], v[72:75], v[44:47]
  v_max3_u32 v31, v76, v77, v78
  v_max_u32 v31, v31, v79
  v_cmp_eq_u32 vcc, -1, v31
  v_mfma_f32_16x16x32_bf16 v[36:39], v[124:127], v[72:75], v[36:39]
  v_mfma_f32_16x16x32_bf16 v[40:43], v[140:143], v[72:75], v[40:43]
  s_cbranch_vccz FL_x_3_ok3
  s_branch FL_x_3_x3
FL_x_23_ok3:
  v_mfma_f32_16x16x32_bf16 v[44:47], v[76:79], v[76:79], v[44:47]
  v_max3_u32 v31, v72, v73, v74
  v_max_u32 v31, v31, v75
  v_cmp_eq_u32 vcc, -1, v31
  v_mfma_f32_16x16x32_bf16 v[36:39], v[128:131], v[76:79], v[36:39]
  v_mfma_f32_16x16x32_bf16 v[40:43], v[144:147], v[76:79], v[40:43]
  s_cbranch_vccz FL_x_2_ok2
  s_branch FL_x_2_x2
FL_x_012_c0:
  v_max3_u32 v31, v64, v65, v66
  v_max_u32 v31, v31, v67
  v_cmp_eq_u32 vcc, -1, v31
  s_cbranch_vccz FL_x_012_ok0
FL_x_012_x0:
  s_mov_b64 exec, vcc
  buffer_load_dwordx4 v[64:67], v9, s[4:7], s41 offen offset:0 sc1
  s_mov_b64 exec, -1
FL_x_012_c1:
  v_max3_u32 v31, v68, v69, v70
  v_max_u32 v31, v31, v71
  v_cmp_eq_u32 vcc, -1, v31
  s_cbranch_vccz FL_x_012_ok1
FL_x_012_x1:
  s_mov_b64 exec, vcc
  buffer_load_dwordx4 v[68:71], v9, s[4:7], s41 offen offset:1024 sc1
  s_mov_b64 exec, -1
FL_x_012_c2:
  v_max3_u32 v31, v72, v73, v74
  v_max_u32 v31, v31, v75
  v_cmp_eq_u32 vcc, -1, v31
  s_cbranch_vccz FL_x_012_ok2
FL_x_012_x2:
  s_mov_b64 exec, vcc
  buffer_load_dwordx4 v[72:75], v9, s[4:7], s41 offen offset:2048 sc1
  s_mov_b64 exec, -1
  s_add_u32 s46, s46, 1
  s_cmp_ge_u32 s46, 131072
  s_cbranch_scc1 FL_rec_abort
  s_waitcnt vmcnt(4)
  s_branch FL_x_012_c0
FL_x_012_ok0:
  v_mfma_f32_16x16x32_bf16 v[44:47], v[64:67], v[64:67], v[44:47]
  v_max3_u32 v31, v68, v69, v70
  v_max_u32 v31, v31, v71
  v_cmp_eq_u32 vcc, -1, v31
  v_mfma_f32_16x16x32_bf16 v[36:39], v[116:119], v[64:67], v[36:39]
  v_mfma_f32_16x16x32_bf16 v[40:43], v[132:135], v[64:67], v[40:43]
  s_cbranch_vccz FL_x_12_ok1
  s_branch FL_x_12_x1
FL_x_012_ok1:
  v_mfma_f32_16x16x32_bf16 v[44:47], v[68:71], v[68:71], v[44:47]
  v_max3_u32 v31, v72, v73, v74
  v_max_u32 v31, v31, v75
  v_cmp_eq_u32 vcc, -1, v31
  v_mfma_f32_16x16x32_bf16 v[36:39], v[120:123], v[68:71], v[36:39]
  v_mfma_f32_16x16x32_bf16 v[40:43], v[136:139], v[68:71], v[40:43]
  s_cbranch_vccz FL_x_02_ok2
  s_branch FL_x_02_x2
FL_x_012_ok2:
  v_mfma_f32_16x16x32_bf16 v[44:47], v[72:75], v[72:75], v[44:47]
  v_max3_u32 v31, v64, v65, v66
  v_max_u32 v31, v31, v67
  v_cmp_eq_u32 vcc, -1, v31
  v_mfma_f32_16x16x32_bf16 v[36:39], v[124:127], v[72:75], v[36:39]
  v_mfma_f32_16x16x32_bf16 v[40:43], v[140:143], v[72:75], v[40:43]
  s_cbranch_vccz FL_x_01_ok0
  s_branch FL_x_01_x0
FL_x_013_c0:
  v_max3_u32 v31, v64, v65, v66
  v_max_u32 v31, v31, v67
  v_cmp_eq_u32 vcc, -1, v31
  s_cbranch_vccz FL_x_013_ok0
FL_x_013_x0:
  s_mov_b64 exec, vcc
  buffer_load_dwordx4 v[64:67], v9, s[4:7], s41 offen offset:0 sc1
  s_mov_b64 exec, -1
FL_x_013_c1:
  v_max3_u32 v31, v68, v69, v70
  v_max_u32 v31, v31, v71
  v_cmp_eq_u32 vcc, -1, v31
  s_cbranch_vccz FL_x_013_ok1
FL_x_013_x1:
  s_mov_b64 exec, vcc
  buffer_load_dwordx4 v[68:71], v9, s[4:7], s41 offen offset:1024 sc1
  s_mov_b64 exec, -1
FL_x_013_c3:
  v_max3_u32 v31, v76, v77, v78
  v_max_u32 v31, v31, v79
  v_cmp_eq_u32 vcc, -1, v31
  s_cbranch_vccz FL_x_013_ok3
FL_x_013_x3:
  s_mov_b64 exec, vcc
  buffer_load_dwordx4 v[76:79], v9, s[4:7], s41 offen offset:3072 sc1
  s_mov_b64 exec, -1
  s_add_u32 s46, s46, 1
  s_cmp_ge_u32 s46, 131072
  s_cbranch_scc1 FL_rec_abort
  s_waitcnt vmcnt(4)
  s_branch FL_x_013_c0
FL_x_013_ok0:
  v_mfma_f32_16x16x32_bf16 v[44:47], v[64:67], v[64:67], v[44:47]
  v_max3_u32 v31, v68, v69, v70
  v_max_u32 v31, v31, v71
  v_cmp_eq_u32 vcc, -1, v31
  v_mfma_f32_16x16x32_bf16 v[36:39], v[116:119], v[64:67], v[36:39]
  v_mfma_f32_16x16x32_bf16 v[40:43], v[132:135], v[64:67], v[40:43]
  s_cbranch_vccz FL_x_13_ok1
  s_branch FL_x_13_x1
FL_x_013_ok1:
  v_mfma_f32_16x16x32_bf16 v[44:47], v[68:71], v[68:71], v[44:47]
  v_max3_u32 v31, v76, v77, v78
  v_max_u32 v31, v31, v79
  v_cmp_eq_u32 vcc, -1, v31
  v_mfma_f32_16x16x32_bf16 v[36:39], v[120:123], v[68:71], v[36:39]
  v_mfma_f32_16x16x32_bf16 v[40:43], v[136:139], v[68:71], v[40:43]
  s_cbranch_vccz FL_x_03_ok3
  s_branch FL_x_03_x3
FL_x_013_ok3:
  v_mfma_f32_16x16x32_bf16 v[44:47], v[76:79], v[76:79], v[44:47]
  v_max3_u32 v31, v64, v65, v66
  v_max_u32 v31, v31, v67
  v_cmp_eq_u32 vcc, -1, v31
  v_mfma_f32_16x16x32_bf16 v[36:39], v[128:131], v[76:79], v[36:39]
  v_mfma_f32_16x16x32_bf16 v[40:43], v[144:147], v[76:79], v[40:43]
  s_cbranch_vccz FL_x_01_ok0
  s_branch FL_x_01_x0
FL_x_023_c0:
  v_max3_u32 v31, v64, v65, v66
  v_max_u32 v31, v31, v67
  v_cmp_eq_u32 vcc, -1, v31
  s_cbranch_vccz FL_x_023_ok0
FL_x_023_x0:
  s_mov_b64 exec, vcc
  buffer_load_dwordx4 v[64:67], v9, s[4:7], s41 offen offset:0 sc1
  s_mov_b64 exec, -1
FL_x_023_c2:
  v_max3_u32 v31, v72, v73, v74
  v_max_u32 v31, v31, v75
  v_cmp_eq_u32 vcc, -1, v31
  s_cbranch_vccz FL_x_023_ok2
FL_x_023_x2:
  s_mov_b64 exec, vcc
  buffer_load_dwordx4 v[72:75], v9, s[4:7], s41 offen offset:2048 sc1
  s_mov_b64 exec, -1
FL_x_023_c3:
  v_max3_u32 v31, v76, v77, v78
  v_max_u32 v31, v31, v79
  v_cmp_eq_u32 vcc, -1, v31
  s_cbranch_vccz FL_x_023_ok3
FL_x_023_x3:
  s_mov_b64 exec, vcc
  buffer_load_dwordx4 v[76:79], v9, s[4:7], s41 offen offset:3072 sc1
  s_mov_b64 exec, -1
  s_add_u32 s46, s46, 1
  s_cmp_ge_u32 s46, 131072
  s_cbranch_scc1 FL_rec_abort
  s_waitcnt vmcnt(4)
  s_branch FL_x_023_c0
FL_x_023_ok0:
  v_mfma_f32_16x16x32_bf16 v[44:47], v[64:67], v[64:67], v[44:47]
  v_max3_u32 v31, v72, v73, v74
  v_max_u32 v31, v31, v75
  v_cmp_eq_u32 vcc, -1, v31
  v_mfma_f32_16x16x32_bf16 v[36:39], v[116:119], v[64:67], v[36:39]
  v_mfma_f32_16x16x32_bf16 v[40:43], v[132:135], v[64:67], v[40:43]
  s_cbranch_vccz FL_x_23_ok2
  s_branch FL_x_23_x2
FL_x_023_ok2:
  v_mfma_f32_16x16x32_bf16 v[44:47], v[72:75], v[72:75], v[44:47]
  v_max3_u32 v31, v76, v77, v78
  v_max_u32 v31, v31, v79
  v_cmp_eq_u32 vcc, -1, v31
  v_mfma_f32_16x16x32_bf16 v[36:39], v[124:127], v[72:75], v[36:39]
  v_mfma_f32_16x16x32_bf16 v[40:43], v[140:143], v[72:75], v[40:43]
  s_cbranch_vccz FL_x_03_ok3
  s_branch FL_x_03_x3
FL_x_023_ok3:
  v_mfma_f32_16x16x32_bf16 v[44:47], v[76:79], v[76:79], v[44:47]
  v_max3_u32 v31, v64, v65, v66
  v_max_u32 v31, v31, v67
  v_cmp_eq_u32 vcc, -1, v31
  v_mfma_f32_16x16x32_bf16 v[36:39], v[128:131], v[76:79], v[36:39]
  v_mfma_f32_16x16x32_bf16 v[40:43], v[144:147], v[76:79], v[40:43]
  s_cbranch_vccz FL_x_02_ok0
  s_branch FL_x_02_x0
FL_x_123_c1:
  v_max3_u32 v31, v68, v69, v70
  v_max_u32 v31, v31, v71
  v_cmp_eq_u32 vcc, -1, v31
  s_cbranch_vccz FL_x_123_ok1
FL_x_123_x1:
  s_mov_b64 exec, vcc
  buffer_load_dwordx4 v[68:71], v9, s[4:7], s41 offen offset:1024 sc1
  s_mov_b64 exec, -1
FL_x_123_c2:
  v_max3_u32 v31, v72, v73, v74
  v_max_u32 v31, v31, v75
  v_cmp_eq_u32 vcc, -1, v31
  s_cbranch_vccz FL_x_123_ok2
FL_x_123_x2:
  s_mov_b64 exec, vcc
  buffer_load_dwordx4 v[72:75], v9, s[4:7], s41 offen offset:2048 sc1
  s_mov_b64 exec, -1
FL_x_123_c3:
  v_max3_u32 v31, v76, v77, v78
  v_max_u32 v31, v31, v79
  v_cmp_eq_u32 vcc, -1, v31
  s_cbranch_vccz FL_x_123_ok3
FL_x_123_x3:
  s_mov_b64 exec, vcc
  buffer_load_dwordx4 v[76:79], v9, s[4:7], s41 offen offset:3072 sc1
  s_mov_b64 exec, -1
  s_add_u32 s46, s46, 1
  s_cmp_ge_u32 s46, 131072
  s_cbranch_scc1 FL_rec_abort
  s_waitcnt vmcnt(4)
  s_branch FL_x_123_c1
FL_x_123_ok1:
  v_mfma_f32_16x16x32_bf16 v[44:47], v[68:71], v[68:71], v[44:47]
  v_max3_u32 v31, v72, v73, v74
  v_max_u32 v31, v31, v75
  v_cmp_eq_u32 vcc, -1, v31
  v_mfma_f32_16x16x32_bf16 v[36:39], v[120:123], v[68:71], v[36:39]
  v_mfma_f32_16x16x32_bf16 v[40:43], v[136:139], v[68:71], v[40:43]
  s_cbranch_vccz FL_x_23_ok2
  s_branch FL_x_23_x2
FL_x_123_ok2:
  v_mfma_f32_16x16x32_bf16 v[44:47], v[72:75], v[72:75], v[44:47]
  v_max3_u32 v31, v76, v77, v78
  v_max_u32 v31, v31, v79
  v_cmp_eq_u32 vcc, -1, v31
  v_mfma_f32_16x16x32_bf16 v[36:39], v[124:127], v[72:75], v[36:39]
  v_mfma_f32_16x16x32_bf16 v[40:43], v[140:143], v[72:75], v[40:43]
  s_cbranch_vccz FL_x_13_ok3
  s_branch FL_x_13_x3
FL_x_123_ok3:
  v_mfma_f32_16x16x32_bf16 v[44:47], v[76:79], v[76:79], v[44:47]
  v_max3_u32 v31, v68, v69, v70
  v_max_u32 v31, v31, v71
  v_cmp_eq_u32 vcc, -1, v31
  v_mfma_f32_16x16x32_bf16 v[36:39], v[128:131], v[76:79], v[36:39]
  v_mfma_f32_16x16x32_bf16 v[40:43], v[144:147], v[76:79], v[40:43]
  s_cbranch_vccz FL_x_12_ok1
  s_branch FL_x_12_x1
FL_x_0123_c0:
  v_max3_u32 v31, v64, v65, v66
  v_max_u32 v31, v31, v67
  v_cmp_eq_u32 vcc, -1, v31
  s_cbranch_vccz FL_x_0123_ok0
FL_x_0123_x0:
  s_mov_b64 exec, vcc
  buffer_load_dwordx4 v[64:67], v9, s[4:7], s41 offen offset:0 sc1
  s_mov_b64 exec, -1
FL_x_0123_c1:
  v_max3_u32 v31, v68, v69, v70
  v_max_u32 v31, v31, v71
  v_cmp_eq_u32 vcc, -1, v31
  s_cbranch_vccz FL_x_0123_ok1
FL_x_0123_x1:
  s_mov_b64 exec, vcc
  buffer_load_dwordx4 v[68:71], v9, s[4:7], s41 offen offset:1024 sc1
  s_mov_b64 exec, -1
FL_x_0123_c2:
  v_max3_u32 v31, v72, v73, v74
  v_max_u32 v31, v31, v75
  v_cmp_eq_u32 vcc, -1, v31
  s_cbranch_vccz FL_x_0123_ok2
FL_x_0123_x2:
  s_mov_b64 exec, vcc
  buffer_load_dwordx4 v[72:75], v9, s[4:7], s41 offen offset:2048 sc1
  s_mov_b64 exec, -1
FL_x_0123_c3:
  v_max3_u32 v31, v76, v77, v78
  v_max_u32 v31, v31, v79
  v_cmp_eq_u32 vcc, -1, v31
  s_cbranch_vccz FL_x_0123_ok3
FL_x_0123_x3:
  s_mov_b64 exec, vcc
  buffer_load_dwordx4 v[76:79], v9, s[4:7], s41 offen offset:3072 sc1
  s_mov_b64 exec, -1
  s_add_u32 s46, s46, 1
  s_cmp_ge_u32 s46, 131072
  s_cbranch_scc1 FL_rec_abort
  s_waitcnt vmcnt(4)
  s_branch FL_x_0123_c0
FL_x_0123_ok0:
  v_mfma_f32_16x16x32_bf16 v[44:47], v[64:67], v[64:67], v[44:47]
  v_max3_u32 v31, v68, v69, v70
  v_max_u32 v31, v31, v71
  v_cmp_eq_u32 vcc, -1, v31
  v_mfma_f32_16x16x32_bf16 v[36:39], v[116:119], v[64:67], v[36:39]
  v_mfma_f32_16x16x32_bf16 v[40:43], v[132:135], v[64:67], v[40:43]
  s_cbranch_vccz FL_x_123_ok1
  s_branch FL_x_123_x1
FL_x_0123_ok1:
  v_mfma_f32_16x16x32_bf16 v[44:47], v[68:71], v[68:71], v[44:47]
  v_max3_u32 v31, v72, v73, v74
  v_max_u32 v31, v31, v75
  v_cmp_eq_u32 vcc, -1, v31
  v_mfma_f32_16x16x32_bf16 v[36:39], v[120:123], v[68:71], v[36:39]
  v_mfma_f32_16x16x32_bf16 v[40:43], v[136:139], v[68:71], v[40:43]
  s_cbranch_vccz FL_x_023_ok2
  s_branch FL_x_023_x2
FL_x_0123_ok2:
  v_mfma_f32_16x16x32_bf16 v[44:47], v[72:75], v[72:75], v[44:47]
  v_max3_u32 v31, v76, v77, v78
  v_max_u32 v31, v31, v79
  v_cmp_eq_u32 vcc, -1, v31
  v_mfma_f32_16x16x32_bf16 v[36:39], v[124:127], v[72:75], v[36:39]
  v_mfma_f32_16x16x32_bf16 v[40:43], v[140:143], v[72:75], v[40:43]
  s_cbranch_vccz FL_x_013_ok3
  s_branch FL_x_013_x3
FL_x_0123_ok3:
  v_mfma_f32_16x16x32_bf16 v[44:47], v[76:79], v[76:79], v[44:47]
  v_max3_u32 v31, v64, v65, v66
  v_max_u32 v31, v31, v67
  v_cmp_eq_u32 vcc, -1, v31
  v_mfma_f32_16x16x32_bf16 v[36:39], v[128:131], v[76:79], v[36:39]
  v_mfma_f32_16x16x32_bf16 v[40:43], v[144:147], v[76:79], v[40:43]
  s_cbranch_vccz FL_x_012_ok0
  s_branch FL_x_012_x0
FL_v_f:
  buffer_load_dwordx4 v[88:91], v10, s[4:7], s41 offen offset:0 sc1
  buffer_load_dwordx4 v[92:95], v10, s[4:7], s41 offen offset:1024 sc1
  s_add_u32 s46, s46, 1
  s_cmp_ge_u32 s46, 131072
  s_cbranch_scc1 FL_rec_abort
  s_waitcnt vmcnt(0)
  v_max3_u32 v31, v88, v89, v90
  v_max3_u32 v31, v31, v91, v92
  v_max3_u32 v31, v31, v93, v94
  v_max_u32 v31, v31, v95
  v_cmp_eq_u32 vcc, -1, v31
  s_cbranch_vccnz FL_v_f
  s_branch FL_v_ok
FL_rec_abort:
  s_waitcnt vmcnt(0)
  s_endpgm
L_recslow:
  s_load_dwordx4 s[80:83], s[0:1], 8
  s_load_dwordx4 s[84:87], s[0:1], 24
  s_load_dwordx2 s[88:89], s[0:1], 40
  v_lshrrev_b32 v31, 6, v0
  s_nop 0
  v_readfirstlane_b32 s32, v31
  v_and_b32 v0, 63, v0
  s_lshr_b32 s35, s34, 4
  s_lshl_b32 s90, s33, 1
  s_add_u32 s35, s35, s90
  s_and_b32 s36, s34, 15
  s_lshr_b32 s37, s36, 2
  s_lshl_b32 s90, s35, 2
  s_add_u32 s37, s37, s90
  s_and_b32 s38, s36, 3
  s_waitcnt lgkmcnt(0)
  s_mov_b32 s24, s80
  s_and_b32 s25, s81, 0xffff
  s_mov_b32 s26, 0x4000
  s_mov_b32 s27, 0x20000
  s_mov_b32 s8, s82
  s_and_b32 s9, s83, 0xffff
  s_mov_b32 s10, 0x800000
  s_mov_b32 s11, 0x20000
  s_mov_b32 s12, s84
  s_and_b32 s13, s85, 0xffff
  s_mov_b32 s14, 0x800000
  s_mov_b32 s15, 0x20000
  s_mov_b32 s16, s86
  s_and_b32 s17, s87, 0xffff
  s_mov_b32 s18, 0x800000
  s_mov_b32 s19, 0x20000
  s_mov_b32 s20, s88
  s_and_b32 s21, s89, 0xffff
  s_mov_b32 s22, 0x800000
  s_mov_b32 s23, 0x20000
  s_lshl_b32 s90, s32, 21
  s_lshl_b32 s91, s37, 8
  s_add_u32 s90, s90, s91
  s_lshr_b32 s91, s38, 1
  s_lshl_b32 s91, s91, 7
  s_add_u32 s90, s90, s91
  v_mov_b32 v180, 0x0
  v_bfe_u32 v31, v0, 3, 3
  v_lshl_add_u32 v180, v31, 13, v180
  v_bfe_u32 v31, v0, 0, 3
  v_lshl_add_u32 v180, v31, 4, v180
  v_add_u32 v180, s90, v180
  v_xor_b32 v185, 128, v180
  s_lshl_b32 s90, s35, 2
  s_add_u32 s90, s90, s32
  s_lshl_b32 s90, s90, 18
  s_lshl_b32 s91, s36, 7
  s_add_u32 s90, s90, s91
  v_mov_b32 v181, 0x0
  v_bfe_u32 v31, v0, 3, 3
  v_lshl_add_u32 v181, v31, 11, v181
  v_bfe_u32 v31, v0, 0, 3
  v_lshl_add_u32 v181, v31, 4, v181
  v_add_u32 v181, s90, v181
  s_lshl_b32 s96, s32, 15
  s_and_b32 s91, s38, 1
  s_lshl_b32 s91, s91, 6
  s_add_u32 s91, s91, s96
  v_mov_b32 v182, 0x0
  v_bfe_u32 v31, v0, 5, 1
  v_lshl_add_u32 v182, v31, 11, v182
  v_bfe_u32 v31, v0, 4, 1
  v_lshl_add_u32 v182, v31, 10, v182
  v_bfe_u32 v31, v0, 2, 2
  v_lshl_add_u32 v182, v31, 7, v182
  v_bfe_u32 v31, v0, 0, 2
  v_lshl_add_u32 v182, v31, 3, v182
  v_add_u32 v182, s91, v182
  s_lshl_b32 s91, s32, 5
  v_mov_b32 v183, 0x0
  v_bfe_u32 v31, v0, 4, 1
  v_lshl_add_u32 v183, v31, 13, v183
  v_bfe_u32 v31, v0, 5, 1
  v_lshl_add_u32 v183, v31, 8, v183
  v_bfe_u32 v31, v0, 2, 1
  v_lshl_add_u32 v183, v31, 10, v183
  v_bfe_u32 v31, v0, 3, 1
  v_lshl_add_u32 v183, v31, 7, v183
  v_bfe_u32 v31, v0, 0, 2
  v_lshl_add_u32 v183, v31, 3, v183
  v_add_u32 v183, s91, v183
  v_add_u32 v184, 0x10000, v183
  s_lshl_b32 s97, s34, 2
  s_add_u32 s97, s97, s32
  s_lshl_b32 s98, s97, 14
  s_lshl_b32 s91, s33, 21
  s_add_u32 s98, s98, s91
  s_lshl_b32 s97, s97, 16
  s_lshl_b32 s91, s33, 11
  s_add_u32 s97, s97, s91
  v_mov_b32 v16, 0x0
  v_bfe_u32 v31, v0, 0, 4
  v_lshl_add_u32 v16, v31, 7, v16
  v_bfe_u32 v31, v0, 4, 2
  v_lshl_add_u32 v16, v31, 13, v16
  v_add_u32 v17, 0x8000, v16
  v_lshlrev_b32 v18, 7, v0
  v_add_u32 v19, 0x2000, v18
  s_lshl_b32 s97, s34, 2
  s_add_u32 s97, s97, s32
  s_lshl_b32 s98, s97, 14
  s_lshl_b32 s91, s33, 21
  s_add_u32 s98, s98, s91
  s_lshl_b32 s97, s97, 16
  s_lshl_b32 s91, s33, 11
  s_add_u32 s97, s97, s91
  v_mov_b32 v16, 0x180
  v_bfe_u32 v31, v0, 0, 1
  v_lshl_add_u32 v16, v31, 10, v16
  v_bfe_u32 v31, v0, 1, 3
  v_lshl_add_u32 v16, v31, 13, v16
  v_mov_b32 v17, 0x180
  v_bfe_u32 v31, v0, 0, 4
  v_lshl_add_u32 v17, v31, 10, v17
  s_mov_b64 exec, 0xffff
  buffer_load_dword v201, v16, s[12:15], s97 offen
  buffer_load_dword v202, v16, s[16:19], s97 offen
  buffer_load_dword v200, v16, s[8:11], s97 offen
  buffer_load_dword v203, v17, s[20:23], s98 offen
  s_mov_b64 exec, -1
  s_lshl_b32 s58, s33, 5
  s_add_u32 s58, s58, s34
  s_lshl_b32 s59, s32, 19
  s_add_u32 s59, s59, 0x3800000
  s_lshl_b32 s90, s58, 11
  s_add_u32 s90, s90, s59
  s_mul_i32 s91, s58, 3072
  s_add_u32 s91, s91, s59
  s_add_u32 s91, s91, 0x200000
  v_lshlrev_b32 v6, 4, v0
  v_mov_b32 v8, -1
  v_mov_b32 v12, 0
  v_mov_b32 v9, -1
  v_mov_b32 v13, 0
  v_mov_b32 v10, -1
  v_mov_b32 v14, 0
  v_mov_b32 v11, -1
  v_mov_b32 v15, 0
  buffer_store_dwordx4 v[8:11], v6, s[4:7], s90 offen offset:0 sc1
  buffer_store_dwordx4 v[8:11], v6, s[4:7], s90 offen offset:1024 sc1
  buffer_store_dwordx4 v[8:11], v6, s[4:7], s91 offen offset:0 sc1
  buffer_store_dwordx4 v[8:11], v6, s[4:7], s91 offen offset:1024 sc1
  buffer_store_dwordx4 v[8:11], v6, s[4:7], s91 offen offset:2048 sc1
  s_lshl_b32 s58, s58, 2
  s_add_u32 s58, s58, s32
  s_cmp_ge_u32 s58, 36
  s_cbranch_scc1 SL_nz_1
  s_lshl_b32 s90, s58, 10
  s_add_u32 s90, s90, 0x3d00000
  buffer_store_dwordx4 v[12:15], v6, s[4:7], s90 offen sc1
SL_nz_1:
  s_add_u32 m0, s96, 0
  s_mov_b32 s90, 0x0
  buffer_load_dwordx4 v180, s[12:15], s90 offen  lds
  s_add_u32 m0, s96, 1024
  s_mov_b32 s90, 0x10000
  buffer_load_dwordx4 v180, s[12:15], s90 offen  lds
  s_add_u32 m0, s96, 2048
  s_mov_b32 s90, 0x20000
  buffer_load_dwordx4 v180, s[12:15], s90 offen  lds
  s_add_u32 m0, s96, 3072
  s_mov_b32 s90, 0x30000
  buffer_load_dwordx4 v180, s[12:15], s90 offen  lds
  s_add_u32 m0, s96, 4096
  s_mov_b32 s90, 0x0
  buffer_load_dwordx4 v185, s[16:19], s90 offen  lds
  s_add_u32 m0, s96, 5120
  s_mov_b32 s90, 0x10000
  buffer_load_dwordx4 v185, s[16:19], s90 offen  lds
  s_add_u32 m0, s96, 6144
  s_mov_b32 s90, 0x20000
  buffer_load_dwordx4 v185, s[16:19], s90 offen  lds
  s_add_u32 m0, s96, 7168
  s_mov_b32 s90, 0x30000
  buffer_load_dwordx4 v185, s[16:19], s90 offen  lds
  s_add_u32 m0, s96, 8192
  s_mov_b32 s90, 0x40000
  buffer_load_dwordx4 v180, s[12:15], s90 offen  lds
  s_add_u32 m0, s96, 9216
  s_mov_b32 s90, 0x50000
  buffer_load_dwordx4 v180, s[12:15], s90 offen  lds
  s_add_u32 m0, s96, 10240
  s_mov_b32 s90, 0x60000
  buffer_load_dwordx4 v180, s[12:15], s90 offen  lds
  s_add_u32 m0, s96, 11264
  s_mov_b32 s90, 0x70000
  buffer_load_dwordx4 v180, s[12:15], s90 offen  lds
  s_add_u32 m0, s96, 12288
  s_mov_b32 s90, 0x40000
  buffer_load_dwordx4 v185, s[16:19], s90 offen  lds
  s_add_u32 m0, s96, 13312
  s_mov_b32 s90, 0x50000
  buffer_load_dwordx4 v185, s[16:19], s90 offen  lds
  s_add_u32 m0, s96, 14336
  s_mov_b32 s90, 0x60000
  buffer_load_dwordx4 v185, s[16:19], s90 offen  lds
  s_add_u32 m0, s96, 15360
  s_mov_b32 s90, 0x70000
  buffer_load_dwordx4 v185, s[16:19], s90 offen  lds
  s_add_u32 m0, s96, 16384
  s_mov_b32 s90, 0x80000
  buffer_load_dwordx4 v180, s[12:15], s90 offen  lds
  s_add_u32 m0, s96, 17408
  s_mov_b32 s90, 0x90000
  buffer_load_dwordx4 v180, s[12:15], s90 offen  lds
  s_add_u32 m0, s96, 18432
  s_mov_b32 s90, 0xa0000
  buffer_load_dwordx4 v180, s[12:15], s90 offen  lds
  s_add_u32 m0, s96, 19456
  s_mov_b32 s90, 0xb0000
  buffer_load_dwordx4 v180, s[12:15], s90 offen  lds
  s_add_u32 m0, s96, 20480
  s_mov_b32 s90, 0x80000
  buffer_load_dwordx4 v185, s[16:19], s90 offen  lds
  s_add_u32 m0, s96, 21504
  s_mov_b32 s90, 0x90000
  buffer_load_dwordx4 v185, s[16:19], s90 offen  lds
  s_add_u32 m0, s96, 22528
  s_mov_b32 s90, 0xa0000
  buffer_load_dwordx4 v185, s[16:19], s90 offen  lds
  s_add_u32 m0, s96, 23552
  s_mov_b32 s90, 0xb0000
  buffer_load_dwordx4 v185, s[16:19], s90 offen  lds
  s_add_u32 m0, s96, 24576
  s_mov_b32 s90, 0xc0000
  buffer_load_dwordx4 v180, s[12:15], s90 offen  lds
  s_add_u32 m0, s96, 25600
  s_mov_b32 s90, 0xd0000
  buffer_load_dwordx4 v180, s[12:15], s90 offen  lds
  s_add_u32 m0, s96, 26624
  s_mov_b32 s90, 0xe0000
  buffer_load_dwordx4 v180, s[12:15], s90 offen  lds
  s_add_u32 m0, s96, 27648
  s_mov_b32 s90, 0xf0000
  buffer_load_dwordx4 v180, s[12:15], s90 offen  lds
  s_add_u32 m0, s96, 28672
  s_mov_b32 s90, 0xc0000
  buffer_load_dwordx4 v185, s[16:19], s90 offen  lds
  s_add_u32 m0, s96, 29696
  s_mov_b32 s90, 0xd0000
  buffer_load_dwordx4 v185, s[16:19], s90 offen  lds
  s_add_u32 m0, s96, 30720
  s_mov_b32 s90, 0xe0000
  buffer_load_dwordx4 v185, s[16:19], s90 offen  lds
  s_add_u32 m0, s96, 31744
  s_mov_b32 s90, 0xf0000
  buffer_load_dwordx4 v185, s[16:19], s90 offen  lds
  s_lshl_b32 s90, s34, 2
  s_add_u32 s90, s90, s32
  s_lshr_b32 s91, s90, 3
  s_lshl_b32 s91, s91, 14
  s_and_b32 s92, s90, 7
  s_lshl_b32 s92, s92, 10
  s_add_u32 s91, s91, s92
  v_mov_b32 v1, 0x0
  v_bfe_u32 v31, v0, 0, 6
  v_lshl_add_u32 v1, v31, 4, v1
  v_add_u32 v1, s91, v1
  v_lshrrev_b32 v30, 4, v0
  v_cmp_eq_u32 vcc, s33, v30
  v_xor_b32 v29, 0x2000, v1
  s_nop 0
  v_cndmask_b32 v1, v1, v29, vcc
  s_lshl_b32 s91, s33, 14
  s_lshl_b32 s92, s90, 7
  s_add_u32 s91, s91, s92
  v_mov_b32 v2, 0x200000
  v_bfe_u32 v31, v0, 0, 2
  v_lshl_add_u32 v2, v31, 2, v2
  v_bfe_u32 v31, v0, 2, 1
  v_lshl_add_u32 v2, v31, 6, v2
  v_bfe_u32 v31, v0, 4, 1
  v_lshl_add_u32 v2, v31, 4, v2
  v_bfe_u32 v31, v0, 5, 1
  v_lshl_add_u32 v2, v31, 5, v2
  v_bfe_u32 v31, v0, 3, 1
  v_lshl_add_u32 v2, v31, 31, v2
  v_add_u32 v2, s91, v2
  s_lshr_b32 s92, s90, 1
  s_lshl_b32 s92, s92, 5
  s_and_b32 s91, s90, 1
  s_lshl_b32 s91, s91, 13
  s_add_u32 s92, s92, s91
  v_mov_b32 v30, 0x0
  v_bfe_u32 v31, v0, 2, 1
  v_lshl_add_u32 v30, v31, 12, v30
  v_bfe_u32 v31, v0, 4, 1
  v_lshl_add_u32 v30, v31, 11, v30
  v_bfe_u32 v31, v0, 0, 2
  v_lshl_add_u32 v30, v31, 3, v30
  v_bfe_u32 v31, v0, 5, 1
  v_lshl_add_u32 v30, v31, 2, v30
  v_add_u32 v30, s92, v30
  buffer_load_dword v44, v30, s[24:27], 0 offen
  s_lshl_b32 s91, s33, 14
  s_lshl_b32 s92, s32, 12
  s_add_u32 s91, s91, s92
  v_mov_b32 v3, 0x200000
  v_bfe_u32 v31, v0, 0, 6
  v_lshl_add_u32 v3, v31, 4, v3
  v_add_u32 v3, s91, v3
  s_mul_i32 s91, s32, 3264
  v_mov_b32 v4, 0x0
  v_bfe_u32 v31, v0, 0, 6
  v_lshl_add_u32 v4, v31, 4, v4
  v_add_u32 v4, s91, v4
  s_lshl_b32 s91, s32, 6
  v_mov_b32 v6, 0x0
  v_bfe_u32 v31, v0, 0, 2
  v_lshl_add_u32 v6, v31, 4, v6
  v_bfe_u32 v31, v0, 2, 1
  v_lshl_add_u32 v6, v31, 2, v6
  v_bfe_u32 v31, v0, 3, 1
  s_mov_b32 s99, 1088
  v_mad_u32_u24 v6, v31, s99, v6
  v_bfe_u32 v31, v0, 4, 2
  v_lshl_add_u32 v6, v31, 8, v6
  v_add_u32 v6, s91, v6
  v_add_u32 v240, 3264, v6
  v_add_u32 v241, 6528, v6
  v_add_u32 v242, 9792, v6
  s_lshl_b32 s93, s37, 13
  s_lshl_b32 s91, s38, 10
  s_add_u32 s91, s91, s93
  s_lshl_b32 s92, s32, 8
  s_add_u32 s91, s91, s92
  v_mov_b32 v7, 0x210000
  v_bfe_u32 v31, v0, 0, 6
  v_lshl_add_u32 v7, v31, 2, v7
  v_add_u32 v7, s91, v7
  s_lshl_b32 s91, s37, 11
  s_lshl_b32 s92, s38, 9
  s_add_u32 s59, s91, s92
  s_lshl_b32 s92, s32, 7
  s_add_u32 s91, s59, s92
  v_mov_b32 v19, 0x83000000
  v_bfe_u32 v31, v0, 0, 3
  v_lshl_add_u32 v19, v31, 2, v19
  v_bfe_u32 v31, v0, 4, 2
  v_lshl_add_u32 v19, v31, 5, v19
  v_bfe_u32 v31, v0, 3, 1
  v_lshl_add_u32 v19, v31, 31, v19
  v_add_u32 v19, s91, v19
  s_lshl_b32 s91, s32, 8
  v_mov_b32 v5, 0x880
  v_bfe_u32 v31, v0, 0, 1
  v_lshl_add_u32 v5, v31, 7, v5
  v_bfe_u32 v31, v0, 1, 1
  v_lshl_add_u32 v5, v31, 3, v5
  v_bfe_u32 v31, v0, 2, 3
  v_lshl_add_u32 v5, v31, 4, v5
  v_add_u32 v5, s91, v5
  s_lshr_b32 s92, s38, 1
  s_xor_b32 s92, s92, 1
  s_lshl_b32 s92, s92, 10
  s_add_u32 s91, s91, s92
  s_add_u32 s91, s91, s93
  s_and_b32 s92, s38, 1
  s_lshl_b32 s92, s92, 7
  s_add_u32 s91, s91, s92
  v_mov_b32 v8, 0x211000
  v_bfe_u32 v31, v0, 0, 5
  v_lshl_add_u32 v8, v31, 2, v8
  v_bfe_u32 v31, v0, 5, 1
  v_lshl_add_u32 v8, v31, 31, v8
  v_add_u32 v8, s91, v8
  s_sub_u32 s91, s91, s93
  s_lshl_b32 s92, s37, 11
  s_add_u32 s91, s91, s92
  v_mov_b32 v20, 0x3400000
  v_bfe_u32 v31, v0, 0, 5
  v_lshl_add_u32 v20, v31, 2, v20
  v_bfe_u32 v31, v0, 5, 1
  v_lshl_add_u32 v20, v31, 31, v20
  v_add_u32 v20, s91, v20
  s_lshl_b32 s97, s35, 2
  s_add_u32 s97, s97, s32
  s_lshl_b32 s97, s97, 13
  v_mov_b32 v9, 0x210000
  v_bfe_u32 v31, v0, 0, 6
  v_lshl_add_u32 v9, v31, 4, v9
  v_add_u32 v9, s97, v9
  v_add_u32 v10, 4096, v9
  v_mov_b32 v11, 0x1000000
  v_bfe_u32 v31, v0, 0, 2
  v_lshl_add_u32 v11, v31, 4, v11
  v_bfe_u32 v31, v0, 2, 1
  v_lshl_add_u32 v11, v31, 7, v11
  v_bfe_u32 v31, v0, 3, 1
  v_lshl_add_u32 v11, v31, 12, v11
  v_bfe_u32 v31, v0, 4, 2
  v_lshl_add_u32 v11, v31, 8, v11
  v_add_u32 v11, s97, v11
  v_mov_b32 v12, 0x2000000
  v_bfe_u32 v31, v0, 0, 3
  v_lshl_add_u32 v12, v31, 4, v12
  v_bfe_u32 v31, v0, 3, 1
  v_lshl_add_u32 v12, v31, 11, v12
  v_bfe_u32 v31, v0, 4, 2
  v_lshl_add_u32 v12, v31, 8, v12
  v_add_u32 v12, s97, v12
  v_add_u32 v13, 4096, v12
  s_lshl_b32 s91, s36, 9
  s_add_u32 s91, s91, s97
  s_add_u32 s63, s91, 0x1000000
  v_mov_b32 v21, 0x1000000
  v_bfe_u32 v31, v0, 0, 2
  v_lshl_add_u32 v21, v31, 7, v21
  v_bfe_u32 v31, v0, 2, 1
  v_lshl_add_u32 v21, v31, 24, v21
  v_add_u32 v21, s91, v21
  v_cmp_gt_u32 vcc, 8, v0
  v_mov_b32 v30, 0x80000000
  s_nop 0
  v_cndmask_b32 v21, v30, v21, vcc
  s_lshl_b32 s91, s32, 11
  v_mov_b32 v30, 0x0
  v_bfe_u32 v31, v0, 2, 1
  v_lshl_add_u32 v30, v31, 6, v30
  v_bfe_u32 v31, v0, 0, 1
  v_lshl_add_u32 v30, v31, 5, v30
  v_bfe_u32 v31, v0, 1, 1
  v_lshl_add_u32 v30, v31, 4, v30
  v_mov_b32 v29, 0x0
  v_bfe_u32 v31, v0, 4, 2
  v_lshl_add_u32 v29, v31, 5, v29
  v_xor_b32 v30, v30, v29
  v_mov_b32 v14, 0x3400
  v_bfe_u32 v31, v0, 0, 4
  v_lshl_add_u32 v14, v31, 7, v14
  v_add_u32 v14, s91, v14
  v_add_u32 v14, v14, v30
  v_xor_b32 v15, 16, v14
  v_mov_b32 v30, 0x0
  v_bfe_u32 v31, v0, 5, 1
  v_lshl_add_u32 v30, v31, 6, v30
  v_bfe_u32 v31, v0, 1, 1
  v_lshl_add_u32 v30, v31, 5, v30
  v_bfe_u32 v31, v0, 4, 1
  v_lshl_add_u32 v30, v31, 4, v30
  v_mov_b32 v29, 0x0
  v_bfe_u32 v31, v0, 2, 2
  v_lshl_add_u32 v29, v31, 5, v29
  v_bfe_u32 v31, v0, 0, 1
  v_lshl_add_u32 v29, v31, 4, v29
  v_xor_b32 v30, v30, v29
  v_mov_b32 v16, 0x3400
  v_bfe_u32 v31, v0, 4, 2
  v_lshl_add_u32 v16, v31, 8, v16
  v_bfe_u32 v31, v0, 1, 1
  v_lshl_add_u32 v16, v31, 7, v16
  v_add_u32 v16, v16, v30
  s_lshl_b32 s98, s36, 14
  s_lshl_b32 s92, s35, 7
  s_add_u32 s98, s98, s92
  s_lshl_b32 s92, s32, 11
  s_add_u32 s91, s98, s92
  v_mov_b32 v17, 0x0
  v_bfe_u32 v31, v0, 0, 5
  v_lshl_add_u32 v17, v31, 2, v17
  v_bfe_u32 v31, v0, 5, 1
  v_lshl_add_u32 v17, v31, 10, v17
  v_add_u32 v17, s91, v17
  v_xor_b32 v18, 0x2000, v17
  s_mov_b32 s48, 0x33333333
  s_mov_b32 s49, 0x33333333
  s_mov_b32 s50, 0xffff0000
  s_mov_b32 s51, 0xffff0000
  s_mov_b32 s52, 0x0000ffff
  s_mov_b32 s53, 0x0000ffff
  s_mov_b32 s54, 0xfffffffe
  s_mov_b32 s47, 0x3e0293ee
  v_mov_b32 v30, 0x4444
  v_mov_b32 v31, 0xeeee
  v_cndmask_b32 v23, v31, v30, s[48:49]
  v_mov_b32 v22, -1
  v_mov_b32 v232, 0
  v_mov_b32 v233, 0
  v_mov_b32 v234, 0
  v_mov_b32 v235, 0
  v_mov_b32 v112, 0
  v_mov_b32 v113, 0
  s_mov_b32 s56, 0xf0f0f0f0
  s_mov_b32 s57, 0xf0f0f0f0
  v_mov_b32 v30, 0x3f80
  v_mov_b32 v31, 1.0
  v_cndmask_b32 v30, v30, v31, s[56:57]
  s_mov_b32 s56, 0x110011
  s_mov_b32 s57, 0x110011
  v_cndmask_b32 v24, 0, v30, s[56:57]
  s_mov_b32 s56, 0x220022
  s_mov_b32 s57, 0x220022
  v_cndmask_b32 v25, 0, v30, s[56:57]
  s_mov_b32 s56, 0x11001100
  s_mov_b32 s57, 0x11001100
  v_cndmask_b32 v26, 0, v30, s[56:57]
  s_mov_b32 s56, 0x22002200
  s_mov_b32 s57, 0x22002200
  v_cndmask_b32 v27, 0, v30, s[56:57]
  s_mov_b32 s40, 0
  s_mov_b32 s41, 0x3800000
  s_mov_b32 s43, 0x3900000
  s_mov_b32 s44, 0
  s_mov_b32 s55, 0x40000
  s_mov_b32 s45, 0
  s_waitcnt vmcnt(33)
  s_barrier
  s_cmp_lg_u32 s32, 0
  s_cbranch_scc1 SL_sig_2
  v_mov_b32 v254, 1
  v_mov_b32 v255, 0
  s_mov_b64 exec, 1
  buffer_atomic_add v254, v255, s[28:31], s100 offen offset:132 sc1
  s_mov_b64 exec, -1
SL_sig_2:
  s_mov_b32 s90, 0x3e0000
  buffer_store_dword v22, v19, s[4:7], s90 offen sc1
  buffer_store_dword v22, v20, s[4:7], s90 offen sc1
  s_mov_b32 s90, 0x3f0000
  buffer_store_dword v22, v19, s[4:7], s90 offen sc1
  buffer_store_dword v22, v20, s[4:7], s90 offen sc1
  s_waitcnt vmcnt(28)
  ds_read_b64_tr_b16 a[16:17], v182 offset:0
  ds_read_b64_tr_b16 a[18:19], v182 offset:512
  ds_read_b64_tr_b16 a[24:25], v182 offset:32
  ds_read_b64_tr_b16 a[26:27], v182 offset:544
  s_waitcnt lgkmcnt(0)
  s_add_u32 m0, s96, 0
  s_mov_b32 s90, 0x100000
  buffer_load_dwordx4 v180, s[12:15], s90 offen  lds
  s_add_u32 m0, s96, 1024
  s_mov_b32 s90, 0x110000
  buffer_load_dwordx4 v180, s[12:15], s90 offen  lds
  s_add_u32 m0, s96, 2048
  s_mov_b32 s90, 0x120000
  buffer_load_dwordx4 v180, s[12:15], s90 offen  lds
  s_add_u32 m0, s96, 3072
  s_mov_b32 s90, 0x130000
  buffer_load_dwordx4 v180, s[12:15], s90 offen  lds
  s_waitcnt vmcnt(28)
  ds_read_b64_tr_b16 a[32:33], v182 offset:4096
  ds_read_b64_tr_b16 a[34:35], v182 offset:4608
  ds_read_b64_tr_b16 a[40:41], v182 offset:4128
  ds_read_b64_tr_b16 a[42:43], v182 offset:4640
  s_waitcnt lgkmcnt(0)
  s_add_u32 m0, s96, 4096
  s_mov_b32 s90, 0x100000
  buffer_load_dwordx4 v185, s[16:19], s90 offen  lds
  s_add_u32 m0, s96, 5120
  s_mov_b32 s90, 0x110000
  buffer_load_dwordx4 v185, s[16:19], s90 offen  lds
  s_add_u32 m0, s96, 6144
  s_mov_b32 s90, 0x120000
  buffer_load_dwordx4 v185, s[16:19], s90 offen  lds
  s_add_u32 m0, s96, 7168
  s_mov_b32 s90, 0x130000
  buffer_load_dwordx4 v185, s[16:19], s90 offen  lds
  s_waitcnt vmcnt(28)
  ds_read_b64_tr_b16 a[20:21], v182 offset:8192
  ds_read_b64_tr_b16 a[22:23], v182 offset:8704
  ds_read_b64_tr_b16 a[28:29], v182 offset:8224
  ds_read_b64_tr_b16 a[30:31], v182 offset:8736
  s_waitcnt lgkmcnt(0)
  s_add_u32 m0, s96, 8192
  s_mov_b32 s90, 0x140000
  buffer_load_dwordx4 v180, s[12:15], s90 offen  lds
  s_add_u32 m0, s96, 9216
  s_mov_b32 s90, 0x150000
  buffer_load_dwordx4 v180, s[12:15], s90 offen  lds
  s_add_u32 m0, s96, 10240
  s_mov_b32 s90, 0x160000
  buffer_load_dwordx4 v180, s[12:15], s90 offen  lds
  s_add_u32 m0, s96, 11264
  s_mov_b32 s90, 0x170000
  buffer_load_dwordx4 v180, s[12:15], s90 offen  lds
  s_waitcnt vmcnt(28)
  ds_read_b64_tr_b16 a[36:37], v182 offset:12288
  ds_read_b64_tr_b16 a[38:39], v182 offset:12800
  ds_read_b64_tr_b16 a[44:45], v182 offset:12320
  ds_read_b64_tr_b16 a[46:47], v182 offset:12832
  s_waitcnt lgkmcnt(0)
  s_add_u32 m0, s96, 12288
  s_mov_b32 s90, 0x140000
  buffer_load_dwordx4 v185, s[16:19], s90 offen  lds
  s_add_u32 m0, s96, 13312
  s_mov_b32 s90, 0x150000
  buffer_load_dwordx4 v185, s[16:19], s90 offen  lds
  s_add_u32 m0, s96, 14336
  s_mov_b32 s90, 0x160000
  buffer_load_dwordx4 v185, s[16:19], s90 offen  lds
  s_add_u32 m0, s96, 15360
  s_mov_b32 s90, 0x170000
  buffer_load_dwordx4 v185, s[16:19], s90 offen  lds
  s_waitcnt vmcnt(28)
  ds_read_b64_tr_b16 a[64:65], v182 offset:16384
  ds_read_b64_tr_b16 a[66:67], v182 offset:16896
  ds_read_b64_tr_b16 a[72:73], v182 offset:16416
  ds_read_b64_tr_b16 a[74:75], v182 offset:16928
  s_waitcnt lgkmcnt(0)
  s_add_u32 m0, s96, 16384
  s_mov_b32 s90, 0x180000
  buffer_load_dwordx4 v180, s[12:15], s90 offen  lds
  s_add_u32 m0, s96, 17408
  s_mov_b32 s90, 0x190000
  buffer_load_dwordx4 v180, s[12:15], s90 offen  lds
  s_add_u32 m0, s96, 18432
  s_mov_b32 s90, 0x1a0000
  buffer_load_dwordx4 v180, s[12:15], s90 offen  lds
  s_add_u32 m0, s96, 19456
  s_mov_b32 s90, 0x1b0000
  buffer_load_dwordx4 v180, s[12:15], s90 offen  lds
  s_waitcnt vmcnt(28)
  ds_read_b64_tr_b16 a[80:81], v182 offset:20480
  ds_read_b64_tr_b16 a[82:83], v182 offset:20992
  ds_read_b64_tr_b16 a[88:89], v182 offset:20512
  ds_read_b64_tr_b16 a[90:91], v182 offset:21024
  s_waitcnt lgkmcnt(0)
  s_add_u32 m0, s96, 20480
  s_mov_b32 s90, 0x180000
  buffer_load_dwordx4 v185, s[16:19], s90 offen  lds
  s_add_u32 m0, s96, 21504
  s_mov_b32 s90, 0x190000
  buffer_load_dwordx4 v185, s[16:19], s90 offen  lds
  s_add_u32 m0, s96, 22528
  s_mov_b32 s90, 0x1a0000
  buffer_load_dwordx4 v185, s[16:19], s90 offen  lds
  s_add_u32 m0, s96, 23552
  s_mov_b32 s90, 0x1b0000
  buffer_load_dwordx4 v185, s[16:19], s90 offen  lds
  s_waitcnt vmcnt(28)
  ds_read_b64_tr_b16 a[68:69], v182 offset:24576
  ds_read_b64_tr_b16 a[70:71], v182 offset:25088
  ds_read_b64_tr_b16 a[76:77], v182 offset:24608
  ds_read_b64_tr_b16 a[78:79], v182 offset:25120
  s_waitcnt lgkmcnt(0)
  s_add_u32 m0, s96, 24576
  s_mov_b32 s90, 0x1c0000
  buffer_load_dwordx4 v180, s[12:15], s90 offen  lds
  s_add_u32 m0, s96, 25600
  s_mov_b32 s90, 0x1d0000
  buffer_load_dwordx4 v180, s[12:15], s90 offen  lds
  s_add_u32 m0, s96, 26624
  s_mov_b32 s90, 0x1e0000
  buffer_load_dwordx4 v180, s[12:15], s90 offen  lds
  s_add_u32 m0, s96, 27648
  s_mov_b32 s90, 0x1f0000
  buffer_load_dwordx4 v180, s[12:15], s90 offen  lds
  s_waitcnt vmcnt(28)
  ds_read_b64_tr_b16 a[84:85], v182 offset:28672
  ds_read_b64_tr_b16 a[86:87], v182 offset:29184
  ds_read_b64_tr_b16 a[92:93], v182 offset:28704
  ds_read_b64_tr_b16 a[94:95], v182 offset:29216
  s_waitcnt lgkmcnt(0)
  s_add_u32 m0, s96, 28672
  s_mov_b32 s90, 0x1c0000
  buffer_load_dwordx4 v185, s[16:19], s90 offen  lds
  s_add_u32 m0, s96, 29696
  s_mov_b32 s90, 0x1d0000
  buffer_load_dwordx4 v185, s[16:19], s90 offen  lds
  s_add_u32 m0, s96, 30720
  s_mov_b32 s90, 0x1e0000
  buffer_load_dwordx4 v185, s[16:19], s90 offen  lds
  s_add_u32 m0, s96, 31744
  s_mov_b32 s90, 0x1f0000
  buffer_load_dwordx4 v185, s[16:19], s90 offen  lds
  s_waitcnt vmcnt(28)
  ds_read_b64_tr_b16 a[112:113], v182 offset:0
  ds_read_b64_tr_b16 a[114:115], v182 offset:512
  ds_read_b64_tr_b16 a[120:121], v182 offset:32
  ds_read_b64_tr_b16 a[122:123], v182 offset:544
  s_waitcnt lgkmcnt(0)
  s_add_u32 m0, s96, 0
  s_mov_b32 s90, 0x0
  buffer_load_dwordx4 v180, s[8:11], s90 offen  lds
  s_add_u32 m0, s96, 1024
  s_mov_b32 s90, 0x10000
  buffer_load_dwordx4 v180, s[8:11], s90 offen  lds
  s_add_u32 m0, s96, 2048
  s_mov_b32 s90, 0x20000
  buffer_load_dwordx4 v180, s[8:11], s90 offen  lds
  s_add_u32 m0, s96, 3072
  s_mov_b32 s90, 0x30000
  buffer_load_dwordx4 v180, s[8:11], s90 offen  lds
  s_waitcnt vmcnt(28)
  ds_read_b64_tr_b16 a[128:129], v182 offset:4096
  ds_read_b64_tr_b16 a[130:131], v182 offset:4608
  ds_read_b64_tr_b16 a[136:137], v182 offset:4128
  ds_read_b64_tr_b16 a[138:139], v182 offset:4640
  s_waitcnt lgkmcnt(0)
  s_add_u32 m0, s96, 4096
  s_mov_b32 s90, 0x40000
  buffer_load_dwordx4 v180, s[8:11], s90 offen  lds
  s_add_u32 m0, s96, 5120
  s_mov_b32 s90, 0x50000
  buffer_load_dwordx4 v180, s[8:11], s90 offen  lds
  s_add_u32 m0, s96, 6144
  s_mov_b32 s90, 0x60000
  buffer_load_dwordx4 v180, s[8:11], s90 offen  lds
  s_add_u32 m0, s96, 7168
  s_mov_b32 s90, 0x70000
  buffer_load_dwordx4 v180, s[8:11], s90 offen  lds
  s_waitcnt vmcnt(28)
  ds_read_b64_tr_b16 a[116:117], v182 offset:8192
  ds_read_b64_tr_b16 a[118:119], v182 offset:8704
  ds_read_b64_tr_b16 a[124:125], v182 offset:8224
  ds_read_b64_tr_b16 a[126:127], v182 offset:8736
  s_waitcnt lgkmcnt(0)
  s_add_u32 m0, s96, 8192
  s_mov_b32 s90, 0x80000
  buffer_load_dwordx4 v180, s[8:11], s90 offen  lds
  s_add_u32 m0, s96, 9216
  s_mov_b32 s90, 0x90000
  buffer_load_dwordx4 v180, s[8:11], s90 offen  lds
  s_add_u32 m0, s96, 10240
  s_mov_b32 s90, 0xa0000
  buffer_load_dwordx4 v180, s[8:11], s90 offen  lds
  s_add_u32 m0, s96, 11264
  s_mov_b32 s90, 0xb0000
  buffer_load_dwordx4 v180, s[8:11], s90 offen  lds
  s_waitcnt vmcnt(28)
  ds_read_b64_tr_b16 a[132:133], v182 offset:12288
  ds_read_b64_tr_b16 a[134:135], v182 offset:12800
  ds_read_b64_tr_b16 a[140:141], v182 offset:12320
  ds_read_b64_tr_b16 a[142:143], v182 offset:12832
  s_waitcnt lgkmcnt(0)
  s_add_u32 m0, s96, 12288
  s_mov_b32 s90, 0xc0000
  buffer_load_dwordx4 v180, s[8:11], s90 offen  lds
  s_add_u32 m0, s96, 13312
  s_mov_b32 s90, 0xd0000
  buffer_load_dwordx4 v180, s[8:11], s90 offen  lds
  s_add_u32 m0, s96, 14336
  s_mov_b32 s90, 0xe0000
  buffer_load_dwordx4 v180, s[8:11], s90 offen  lds
  s_add_u32 m0, s96, 15360
  s_mov_b32 s90, 0xf0000
  buffer_load_dwordx4 v180, s[8:11], s90 offen  lds
  s_waitcnt vmcnt(28)
  ds_read_b64_tr_b16 a[160:161], v182 offset:16384
  ds_read_b64_tr_b16 a[162:163], v182 offset:16896
  ds_read_b64_tr_b16 a[168:169], v182 offset:16416
  ds_read_b64_tr_b16 a[170:171], v182 offset:16928
  s_waitcnt lgkmcnt(0)
  s_add_u32 m0, s96, 16384
  s_mov_b32 s90, 0x100000
  buffer_load_dwordx4 v180, s[8:11], s90 offen  lds
  s_add_u32 m0, s96, 17408
  s_mov_b32 s90, 0x110000
  buffer_load_dwordx4 v180, s[8:11], s90 offen  lds
  s_add_u32 m0, s96, 18432
  s_mov_b32 s90, 0x120000
  buffer_load_dwordx4 v180, s[8:11], s90 offen  lds
  s_add_u32 m0, s96, 19456
  s_mov_b32 s90, 0x130000
  buffer_load_dwordx4 v180, s[8:11], s90 offen  lds
  s_waitcnt vmcnt(28)
  ds_read_b64_tr_b16 a[176:177], v182 offset:20480
  ds_read_b64_tr_b16 a[178:179], v182 offset:20992
  ds_read_b64_tr_b16 a[184:185], v182 offset:20512
  ds_read_b64_tr_b16 a[186:187], v182 offset:21024
  s_waitcnt lgkmcnt(0)
  s_add_u32 m0, s96, 20480
  s_mov_b32 s90, 0x140000
  buffer_load_dwordx4 v180, s[8:11], s90 offen  lds
  s_add_u32 m0, s96, 21504
  s_mov_b32 s90, 0x150000
  buffer_load_dwordx4 v180, s[8:11], s90 offen  lds
  s_add_u32 m0, s96, 22528
  s_mov_b32 s90, 0x160000
  buffer_load_dwordx4 v180, s[8:11], s90 offen  lds
  s_add_u32 m0, s96, 23552
  s_mov_b32 s90, 0x170000
  buffer_load_dwordx4 v180, s[8:11], s90 offen  lds
  s_waitcnt vmcnt(28)
  ds_read_b64_tr_b16 a[164:165], v182 offset:24576
  ds_read_b64_tr_b16 a[166:167], v182 offset:25088
  ds_read_b64_tr_b16 a[172:173], v182 offset:24608
  ds_read_b64_tr_b16 a[174:175], v182 offset:25120
  s_waitcnt lgkmcnt(0)
  s_add_u32 m0, s96, 24576
  s_mov_b32 s90, 0x180000
  buffer_load_dwordx4 v180, s[8:11], s90 offen  lds
  s_add_u32 m0, s96, 25600
  s_mov_b32 s90, 0x190000
  buffer_load_dwordx4 v180, s[8:11], s90 offen  lds
  s_add_u32 m0, s96, 26624
  s_mov_b32 s90, 0x1a0000
  buffer_load_dwordx4 v180, s[8:11], s90 offen  lds
  s_add_u32 m0, s96, 27648
  s_mov_b32 s90, 0x1b0000
  buffer_load_dwordx4 v180, s[8:11], s90 offen  lds
  s_waitcnt vmcnt(28)
  ds_read_b64_tr_b16 a[180:181], v182 offset:28672
  ds_read_b64_tr_b16 a[182:183], v182 offset:29184
  ds_read_b64_tr_b16 a[188:189], v182 offset:28704
  ds_read_b64_tr_b16 a[190:191], v182 offset:29216
  s_waitcnt lgkmcnt(0)
  s_add_u32 m0, s96, 28672
  s_mov_b32 s90, 0x1c0000
  buffer_load_dwordx4 v180, s[8:11], s90 offen  lds
  s_add_u32 m0, s96, 29696
  s_mov_b32 s90, 0x1d0000
  buffer_load_dwordx4 v180, s[8:11], s90 offen  lds
  s_add_u32 m0, s96, 30720
  s_mov_b32 s90, 0x1e0000
  buffer_load_dwordx4 v180, s[8:11], s90 offen  lds
  s_add_u32 m0, s96, 31744
  s_mov_b32 s90, 0x1f0000
  buffer_load_dwordx4 v180, s[8:11], s90 offen  lds
  s_waitcnt vmcnt(28)
  ds_read_b64_tr_b16 a[0:1], v182 offset:0
  ds_read_b64_tr_b16 a[2:3], v182 offset:512
  ds_read_b64_tr_b16 a[8:9], v182 offset:32
  ds_read_b64_tr_b16 a[10:11], v182 offset:544
  s_waitcnt lgkmcnt(0)
  s_add_u32 m0, s96, 0
  s_mov_b32 s90, 0x0
  buffer_load_dwordx4 v181, s[20:23], s90 offen  lds
  s_add_u32 m0, s96, 1024
  s_mov_b32 s90, 0x4000
  buffer_load_dwordx4 v181, s[20:23], s90 offen  lds
  s_add_u32 m0, s96, 2048
  s_mov_b32 s90, 0x8000
  buffer_load_dwordx4 v181, s[20:23], s90 offen  lds
  s_add_u32 m0, s96, 3072
  s_mov_b32 s90, 0xc000
  buffer_load_dwordx4 v181, s[20:23], s90 offen  lds
  s_waitcnt vmcnt(28)
  ds_read_b64_tr_b16 a[4:5], v182 offset:4096
  ds_read_b64_tr_b16 a[6:7], v182 offset:4608
  ds_read_b64_tr_b16 a[12:13], v182 offset:4128
  ds_read_b64_tr_b16 a[14:15], v182 offset:4640
  s_waitcnt lgkmcnt(0)
  s_add_u32 m0, s96, 4096
  s_mov_b32 s90, 0x10000
  buffer_load_dwordx4 v181, s[20:23], s90 offen  lds
  s_add_u32 m0, s96, 5120
  s_mov_b32 s90, 0x14000
  buffer_load_dwordx4 v181, s[20:23], s90 offen  lds
  s_add_u32 m0, s96, 6144
  s_mov_b32 s90, 0x18000
  buffer_load_dwordx4 v181, s[20:23], s90 offen  lds
  s_add_u32 m0, s96, 7168
  s_mov_b32 s90, 0x1c000
  buffer_load_dwordx4 v181, s[20:23], s90 offen  lds
  s_waitcnt vmcnt(28)
  ds_read_b64_tr_b16 a[48:49], v182 offset:8192
  ds_read_b64_tr_b16 a[50:51], v182 offset:8704
  ds_read_b64_tr_b16 a[56:57], v182 offset:8224
  ds_read_b64_tr_b16 a[58:59], v182 offset:8736
  s_waitcnt lgkmcnt(0)
  s_add_u32 m0, s96, 8192
  s_mov_b32 s90, 0x20000
  buffer_load_dwordx4 v181, s[20:23], s90 offen  lds
  s_add_u32 m0, s96, 9216
  s_mov_b32 s90, 0x24000
  buffer_load_dwordx4 v181, s[20:23], s90 offen  lds
  s_add_u32 m0, s96, 10240
  s_mov_b32 s90, 0x28000
  buffer_load_dwordx4 v181, s[20:23], s90 offen  lds
  s_add_u32 m0, s96, 11264
  s_mov_b32 s90, 0x2c000
  buffer_load_dwordx4 v181, s[20:23], s90 offen  lds
  s_waitcnt vmcnt(28)
  ds_read_b64_tr_b16 a[52:53], v182 offset:12288
  ds_read_b64_tr_b16 a[54:55], v182 offset:12800
  ds_read_b64_tr_b16 a[60:61], v182 offset:12320
  ds_read_b64_tr_b16 a[62:63], v182 offset:12832
  s_waitcnt lgkmcnt(0)
  s_add_u32 m0, s96, 12288
  s_mov_b32 s90, 0x30000
  buffer_load_dwordx4 v181, s[20:23], s90 offen  lds
  s_add_u32 m0, s96, 13312
  s_mov_b32 s90, 0x34000
  buffer_load_dwordx4 v181, s[20:23], s90 offen  lds
  s_add_u32 m0, s96, 14336
  s_mov_b32 s90, 0x38000
  buffer_load_dwordx4 v181, s[20:23], s90 offen  lds
  s_add_u32 m0, s96, 15360
  s_mov_b32 s90, 0x3c000
  buffer_load_dwordx4 v181, s[20:23], s90 offen  lds
  s_mov_b32 s90, 0x3800000
  buffer_load_dword v204, v2, s[4:7], s90 offen sc1
  buffer_load_dword v204, v7, s[4:7], s90 offen sc1
  buffer_load_dword v204, v8, s[4:7], s90 offen sc1
  s_mov_b32 s90, 0x3880000
  buffer_load_dword v204, v2, s[4:7], s90 offen sc1
  buffer_load_dword v204, v7, s[4:7], s90 offen sc1
  buffer_load_dword v204, v8, s[4:7], s90 offen sc1
  s_mov_b32 s90, 0x3900000
  buffer_load_dword v204, v2, s[4:7], s90 offen sc1
  buffer_load_dword v204, v7, s[4:7], s90 offen sc1
  buffer_load_dword v204, v8, s[4:7], s90 offen sc1
  s_mov_b32 s90, 0x3980000
  buffer_load_dword v204, v2, s[4:7], s90 offen sc1
  buffer_load_dword v204, v7, s[4:7], s90 offen sc1
  buffer_load_dword v204, v8, s[4:7], s90 offen sc1
  s_waitcnt vmcnt(28)
  ds_read_b64_tr_b16 a[96:97], v182 offset:16384
  ds_read_b64_tr_b16 a[98:99], v182 offset:16896
  ds_read_b64_tr_b16 a[104:105], v182 offset:16416
  ds_read_b64_tr_b16 a[106:107], v182 offset:16928
  s_waitcnt vmcnt(24)
  ds_read_b64_tr_b16 a[100:101], v182 offset:20480
  ds_read_b64_tr_b16 a[102:103], v182 offset:20992
  ds_read_b64_tr_b16 a[108:109], v182 offset:20512
  ds_read_b64_tr_b16 a[110:111], v182 offset:21024
  s_waitcnt vmcnt(20)
  ds_read_b64_tr_b16 a[144:145], v182 offset:24576
  ds_read_b64_tr_b16 a[146:147], v182 offset:25088
  ds_read_b64_tr_b16 a[152:153], v182 offset:24608
  ds_read_b64_tr_b16 a[154:155], v182 offset:25120
  s_waitcnt vmcnt(16)
  ds_read_b64_tr_b16 a[148:149], v182 offset:28672
  ds_read_b64_tr_b16 a[150:151], v182 offset:29184
  ds_read_b64_tr_b16 a[156:157], v182 offset:28704
  ds_read_b64_tr_b16 a[158:159], v182 offset:29216
  v_mbcnt_lo_u32_b32 v250, -1, 0
  v_mbcnt_hi_u32_b32 v250, -1, v250
  s_lshl_b32 s90, s32, 9
  s_add_u32 s90, s90, 147520
  v_lshl_add_u32 v251, v250, 3, s90
  ds_write_b64 v251, v[248:249]
  s_waitcnt lgkmcnt(0)
  s_cmp_lg_u32 s32, 0
  s_cbranch_scc1 SL_vd_4
  v_lshlrev_b32 v250, 2, v250
  s_cmp_lg_u32 s100, 0
  s_cbranch_scc1 SL_vw_3
  v_readfirstlane_b32 s90, v247
  s_and_b32 s90, s90, s101
  s_cbranch_scc0 SL_vw_3
  v_mov_b32 v251, 1
  s_mov_b64 exec, 1
  buffer_store_dword v251, v250, s[28:31], 0 offen offset:32 sc1
  s_mov_b64 exec, -1
SL_vw_3:
  buffer_load_dword v251, v250, s[28:31], 0 offen sc1
  s_waitcnt vmcnt(0)
  v_cmp_eq_u32 vcc, -1, v251
  v_readlane_b32 s91, v251, 8
  v_readlane_b32 s92, v251, 32
  v_readlane_b32 s93, v251, 33
  v_readlane_b32 s90, v251, 34
  s_cmp_lg_u32 s100, 0
  s_cselect_b32 s93, s90, s93
  s_cselect_b32 s91, 0, s91
  s_cselect_b32 s92, 1, s92
  s_cselect_b32 s90, 0xff, vcc_lo
  s_cmp_lg_u32 s91, 0
  s_cselect_b32 s92, 3, s92
  s_cbranch_scc1 SL_vk_5
  s_add_u32 s3, s3, 1
  s_cmp_ge_u32 s3, 131072
  s_cselect_b32 s92, 4, s92
  s_cbranch_scc1 SL_vk_5
  s_sleep 8
  s_and_b32 s90, s90, 0xff
  s_cmp_lg_u32 s90, 0xff
  s_cbranch_scc1 SL_vw_3
  s_cmp_lt_u32 s93, 128
  s_cbranch_scc1 SL_vw_3
SL_vk_5:
  v_mov_b32 v251, s92
  v_mov_b32 v250, 147456
  ds_write_b32 v250, v251
  s_waitcnt lgkmcnt(0)
SL_vd_4:
  s_barrier
  v_mov_b32 v250, 147456
  ds_read_b32 v251, v250
  s_waitcnt lgkmcnt(0)
  v_readfirstlane_b32 s92, v251
  s_barrier
  s_cmp_eq_u32 s92, 3
  s_cbranch_scc1 L_fallback
  s_cmp_eq_u32 s92, 4
  s_cbranch_scc1 L_exit
  s_waitcnt vmcnt(0)
  s_barrier
  ds_read_b64_tr_b16 a[192:193], v183 offset:0
  ds_read_b64_tr_b16 a[194:195], v183 offset:2048
  ds_read_b64_tr_b16 a[196:197], v183 offset:512
  ds_read_b64_tr_b16 a[198:199], v183 offset:2560
  ds_read_b64_tr_b16 a[200:201], v183 offset:4096
  ds_read_b64_tr_b16 a[202:203], v183 offset:6144
  ds_read_b64_tr_b16 a[204:205], v183 offset:4608
  ds_read_b64_tr_b16 a[206:207], v183 offset:6656
  s_waitcnt lgkmcnt(0)
  ds_read_b64_tr_b16 a[208:209], v183 offset:32768
  ds_read_b64_tr_b16 a[210:211], v183 offset:34816
  ds_read_b64_tr_b16 a[212:213], v183 offset:33280
  ds_read_b64_tr_b16 a[214:215], v183 offset:35328
  ds_read_b64_tr_b16 a[216:217], v183 offset:36864
  ds_read_b64_tr_b16 a[218:219], v183 offset:38912
  ds_read_b64_tr_b16 a[220:221], v183 offset:37376
  ds_read_b64_tr_b16 a[222:223], v183 offset:39424
  s_waitcnt lgkmcnt(0)
  ds_read_b64_tr_b16 a[224:225], v184 offset:0
  ds_read_b64_tr_b16 a[226:227], v184 offset:2048
  ds_read_b64_tr_b16 a[228:229], v184 offset:512
  ds_read_b64_tr_b16 a[230:231], v184 offset:2560
  ds_read_b64_tr_b16 a[232:233], v184 offset:4096
  ds_read_b64_tr_b16 a[234:235], v184 offset:6144
  ds_read_b64_tr_b16 a[236:237], v184 offset:4608
  ds_read_b64_tr_b16 a[238:239], v184 offset:6656
  s_waitcnt lgkmcnt(0)
  ds_read_b64_tr_b16 a[240:241], v184 offset:32768
  ds_read_b64_tr_b16 a[242:243], v184 offset:34816
  ds_read_b64_tr_b16 a[244:245], v184 offset:33280
  ds_read_b64_tr_b16 a[246:247], v184 offset:35328
  ds_read_b64_tr_b16 a[248:249], v184 offset:36864
  ds_read_b64_tr_b16 a[250:251], v184 offset:38912
  ds_read_b64_tr_b16 a[252:253], v184 offset:37376
  ds_read_b64_tr_b16 a[254:255], v184 offset:39424
  s_waitcnt lgkmcnt(0)
  s_barrier
  s_mov_b32 s46, 0
  s_mov_b32 s39, 0
  v_xor_b32 v1, s39, v1
  v_xor_b32 v17, s39, v17
  v_xor_b32 v18, s39, v18
  s_mov_b32 s12, s63
  s_mov_b32 s90, 0x3800000
  s_mov_b32 s90, 0x3880000
  s_mov_b32 s90, 0x3900000
  s_mov_b32 s90, 0x3980000
  v_mov_b32 v248, 0x3f803f80
  v_mov_b32 v249, 0x3f803f80
  v_mov_b32 v250, 0x3f803f80
  v_mov_b32 v251, 0x3f803f80
  v_mov_b32 v252, 0x3f803f80
  v_mov_b32 v253, 0x3f803f80
  v_mov_b32 v254, 0x3f803f80
  v_mov_b32 v255, 0x3f803f80
  s_cmp_lg_u32 s32, 0
  s_cbranch_scc1 SL_kv0d
  s_lshl_b32 s90, s33, 7
  s_add_u32 s90, s90, 0x3d07000
  v_mov_b32 v30, s90
SL_kv0:
  buffer_load_dword v31, v30, s[4:7], 0 offen sc1
  s_waitcnt vmcnt(0)
  v_readfirstlane_b32 s90, v31
  s_add_u32 s46, s46, 1
  s_cmp_ge_u32 s46, 131072
  s_cbranch_scc1 SL_rec_abort
  s_sleep 2
  s_cmp_lt_u32 s90, 16
  s_cbranch_scc1 SL_kv0
SL_kv0d:
  s_barrier
  buffer_load_dwordx4 v[180:183], v12, s[4:7], s44 offen offset:0
  buffer_load_dwordx4 v[184:187], v12, s[4:7], s44 offen offset:128
  buffer_load_dwordx4 v[188:191], v12, s[4:7], s44 offen offset:1024
  buffer_load_dwordx4 v[192:195], v12, s[4:7], s44 offen offset:1152
  buffer_load_dwordx4 v[196:199], v13, s[4:7], s44 offen offset:0
  buffer_load_dwordx4 v[200:203], v13, s[4:7], s44 offen offset:128
  buffer_load_dwordx4 v[204:207], v13, s[4:7], s44 offen offset:1024
  buffer_load_dwordx4 v[208:211], v13, s[4:7], s44 offen offset:1152
  buffer_load_dwordx4 v[116:119], v11, s[4:7], s44 offen offset:0
  buffer_load_dwordx4 v[132:135], v11, s[4:7], s44 offen offset:64
  buffer_load_dwordx4 v[120:123], v11, s[4:7], s44 offen offset:1024
  buffer_load_dwordx4 v[136:139], v11, s[4:7], s44 offen offset:1088
  buffer_load_dwordx4 v[124:127], v11, s[4:7], s44 offen offset:2048
  buffer_load_dwordx4 v[140:143], v11, s[4:7], s44 offen offset:2112
  buffer_load_dwordx4 v[128:131], v11, s[4:7], s44 offen offset:3072
  buffer_load_dwordx4 v[144:147], v11, s[4:7], s44 offen offset:3136
  s_add_u32 s44, s44, 0x40000
  v_mov_b64 v[64:65], 0
  v_mov_b64 v[66:67], 0
  v_mov_b64 v[68:69], 0
  v_mov_b64 v[70:71], 0
  v_mov_b64 v[72:73], 0
  v_mov_b64 v[74:75], 0
  v_mov_b64 v[76:77], 0
  v_mov_b64 v[78:79], 0
  v_mov_b64 v[80:81], 0
  v_mov_b64 v[82:83], 0
  v_mov_b64 v[84:85], 0
  v_mov_b64 v[86:87], 0
  v_mov_b64 v[32:33], 0
  v_mov_b64 v[34:35], 0
  v_mov_b64 v[212:213], 0
  v_mov_b64 v[214:215], 0
  v_mov_b64 v[216:217], 0
  v_mov_b64 v[218:219], 0
  v_mov_b64 v[220:221], 0
  v_mov_b64 v[222:223], 0
  v_mov_b64 v[224:225], 0
  v_mov_b64 v[226:227], 0
  v_mov_b64 v[228:229], 0
  v_mov_b64 v[230:231], 0
  s_waitcnt vmcnt(0)
  v_min_u32 v44, s54, v44
  s_lshl_b32 s90, s33, 7
  s_add_u32 s90, s90, 0x3d07000
  v_mov_b32 v244, s90
  s_lshl_b32 s90, s34, 2
  s_add_u32 s90, s90, s32
  s_lshl_b32 s91, s33, 7
  s_add_u32 s91, s91, 0x3d00000
  v_mbcnt_lo_u32_b32 v30, -1, 0
  v_mbcnt_hi_u32_b32 v30, -1, v30
  v_add_u32 v30, s90, v30
  v_cmp_eq_u32 vcc, 0, v30
  v_mov_b32 v30, 0x80000000
  v_mov_b32 v31, s91
  v_cndmask_b32 v245, v30, v31, vcc
  s_mov_b64 s[8:9], s[94:95]
  s_mov_b64 s[10:11], s[94:95]
  s_branch SL_pubmem
SL_step:
  s_load_dword s16, s[8:9], 256
  s_load_dword s17, s[10:11], 256
  s_load_dword s18, s[8:9], 320
  s_load_dword s19, s[10:11], 320
  s_load_dword s20, s[8:9], 384
  s_load_dword s21, s[10:11], 384
  s_load_dword s22, s[8:9], 448
  s_load_dword s23, s[10:11], 448
  buffer_load_dwordx4 v[200:203], v13, s[4:7], s44 offen offset:128
  buffer_load_dwordx4 v[204:207], v13, s[4:7], s44 offen offset:1024
  buffer_load_dwordx4 v[208:211], v13, s[4:7], s44 offen offset:1152
  buffer_load_dwordx4 v[128:131], v11, s[4:7], s44 offen offset:3072
  buffer_load_dwordx4 v[144:147], v11, s[4:7], s44 offen offset:3136
  v_mov_b64 v[64:65], 0
  v_mov_b64 v[66:67], 0
  v_mov_b64 v[68:69], 0
  v_mov_b64 v[70:71], 0
  v_mov_b64 v[72:73], 0
  v_mov_b64 v[74:75], 0
  v_mov_b64 v[76:77], 0
  v_mov_b64 v[78:79], 0
  v_mov_b64 v[80:81], 0
  v_mov_b64 v[82:83], 0
  v_mov_b64 v[84:85], 0
  v_mov_b64 v[86:87], 0
  v_mov_b64 v[32:33], 0
  v_mov_b64 v[34:35], 0
  buffer_load_dwordx4 v[36:39], v1, s[4:7], s42 offen sc1
  buffer_store_dword v22, v18, s[4:7], s13 offen sc1
  buffer_store_dword v22, v2, s[4:7], s13 offen sc1
  buffer_store_dword v22, v7, s[4:7], s13 offen sc1
  buffer_store_dword v22, v8, s[4:7], s13 offen sc1
  s_add_u32 s44, s44, 0x40000
  s_min_u32 s44, s44, 0xfc0000
  s_add_u32 s45, s45, 0x10000
  s_waitcnt vmcnt(12)
SL_kv_chk:
  v_readfirstlane_b32 s90, v243
  s_cmp_lt_u32 s90, 16
  s_cbranch_scc1 SL_kv_f
  s_waitcnt vmcnt(4)
SL_g_chk:
  v_max3_u32 v31, v36, v37, v38
  v_max_u32 v31, v31, v39
  v_cmp_eq_u32 vcc, -1, v31
  v_mfma_f32_16x16x32_bf16 v[40:43], v[24:27], v[36:39], 0
  s_cbranch_vccnz SL_g_f
  s_nop 6
  v_add_f32_dpp v45, v40, v40 row_ror:8 row_mask:0xf bank_mask:0xf
  v_add_f32_dpp v46, v41, v41 row_ror:8 row_mask:0xf bank_mask:0xf
  v_cvt_pk_bf16_f32 v44, v45, v46
  v_min_u32 v44, s54, v44
SL_pubmem:
  buffer_store_dword v44, v2, s[4:7], s41 offen sc1
  v_mov_b32 v148, v180
  v_mov_b32 v150, v181
  v_mov_b32 v152, v182
  v_mov_b32 v154, v183
  v_mov_b32 v149, v184
  v_mov_b32 v151, v185
  v_mov_b32 v153, v186
  v_mov_b32 v155, v187
  v_mov_b32 v156, v188
  v_mov_b32 v158, v189
  v_mov_b32 v160, v190
  v_mov_b32 v162, v191
  v_mov_b32 v157, v192
  v_mov_b32 v159, v193
  v_mov_b32 v161, v194
  v_mov_b32 v163, v195
  v_mov_b32 v164, v196
  v_mov_b32 v166, v197
  v_mov_b32 v168, v198
  v_mov_b32 v170, v199
  v_mov_b32 v165, v200
  v_mov_b32 v167, v201
  v_mov_b32 v169, v202
  v_mov_b32 v171, v203
  buffer_load_dwordx4 v[48:51], v3, s[4:7], s41 offen offset:0 sc1
  v_mov_b32 v172, v204
  v_mov_b32 v174, v205
  buffer_load_dwordx4 v[52:55], v3, s[4:7], s41 offen offset:1024 sc1
  v_mov_b32 v176, v206
  v_mov_b32 v178, v207
  buffer_load_dwordx4 v[56:59], v3, s[4:7], s41 offen offset:2048 sc1
  v_mov_b32 v173, v208
  v_mov_b32 v175, v209
  buffer_load_dwordx4 v[60:63], v3, s[4:7], s41 offen offset:3072 sc1
  v_mov_b32 v177, v210
  v_mov_b32 v179, v211
  s_waitcnt vmcnt(3)
  v_max3_u32 v31, v48, v49, v50
  v_max_u32 v31, v31, v51
  v_cmp_eq_u32 vcc, -1, v31
  s_cbranch_vccnz SL_m_f0
  v_smfmac_f32_16x16x64_bf16 v[64:67], v[48:51], a[0:7], v23
  s_waitcnt vmcnt(2)
  v_max3_u32 v31, v52, v53, v54
  v_max_u32 v31, v31, v55
  v_cmp_eq_u32 vcc, -1, v31
  v_smfmac_f32_16x16x64_bf16 v[68:71], v[48:51], a[8:15], v23
  v_smfmac_f32_16x16x64_bf16 v[72:75], v[48:51], a[16:23], v23
  v_smfmac_f32_16x16x64_bf16 v[76:79], v[48:51], a[24:31], v23
  s_cbranch_vccnz SL_m_f1
  v_smfmac_f32_16x16x64_bf16 v[64:67], v[52:55], a[48:55], v23
  s_waitcnt vmcnt(1)
  v_max3_u32 v31, v56, v57, v58
  v_max_u32 v31, v31, v59
  v_cmp_eq_u32 vcc, -1, v31
  v_smfmac_f32_16x16x64_bf16 v[68:71], v[52:55], a[56:63], v23
  v_smfmac_f32_16x16x64_bf16 v[72:75], v[52:55], a[64:71], v23
  v_smfmac_f32_16x16x64_bf16 v[76:79], v[52:55], a[72:79], v23
  s_cbranch_vccnz SL_m_f2
  v_smfmac_f32_16x16x64_bf16 v[64:67], v[56:59], a[96:103], v23
  s_waitcnt vmcnt(0)
  v_max3_u32 v31, v60, v61, v62
  v_max_u32 v31, v31, v63
  v_cmp_eq_u32 vcc, -1, v31
  v_smfmac_f32_16x16x64_bf16 v[68:71], v[56:59], a[104:111], v23
  v_smfmac_f32_16x16x64_bf16 v[72:75], v[56:59], a[112:119], v23
  v_smfmac_f32_16x16x64_bf16 v[76:79], v[56:59], a[120:127], v23
  s_cbranch_vccnz SL_m_f3
  v_smfmac_f32_16x16x64_bf16 v[64:67], v[60:63], a[144:151], v23
  v_smfmac_f32_16x16x64_bf16 v[68:71], v[60:63], a[152:159], v23
  v_smfmac_f32_16x16x64_bf16 v[72:75], v[60:63], a[160:167], v23
  v_smfmac_f32_16x16x64_bf16 v[76:79], v[60:63], a[168:175], v23
SL_m_done:
  s_nop 4
  v_pk_add_f32 v[88:89], v[64:65], v[66:67]
  v_pk_add_f32 v[90:91], v[68:69], v[70:71]
  ds_write_b128 v4, v[88:91] offset:0
  v_pk_add_f32 v[92:93], v[72:73], v[74:75]
  v_pk_add_f32 v[94:95], v[76:77], v[78:79]
  ds_write_b128 v4, v[92:95] offset:1088
  v_smfmac_f32_16x16x64_bf16 v[80:83], v[48:51], a[32:39], v23
  buffer_load_dwordx4 v[180:183], v12, s[4:7], s44 offen offset:0
  v_mov_b32 v36, 0
  v_smfmac_f32_16x16x64_bf16 v[84:87], v[48:51], a[40:47], v23
  buffer_load_dwordx4 v[184:187], v12, s[4:7], s44 offen offset:128
  v_mov_b32 v37, 0
  v_smfmac_f32_16x16x64_bf16 v[80:83], v[52:55], a[80:87], v23
  buffer_load_dwordx4 v[188:191], v12, s[4:7], s44 offen offset:1024
  v_mov_b32 v38, 0
  v_smfmac_f32_16x16x64_bf16 v[84:87], v[52:55], a[88:95], v23
  buffer_load_dwordx4 v[192:195], v12, s[4:7], s44 offen offset:1152
  v_mov_b32 v39, 0
  v_smfmac_f32_16x16x64_bf16 v[80:83], v[56:59], a[128:135], v23
  buffer_load_dwordx4 v[196:199], v13, s[4:7], s44 offen offset:0
  v_mov_b32 v40, 0
  s_waitcnt lgkmcnt(0)
  s_barrier
  ds_read2_b32 v[100:101], v6 offset0:0 offset1:2
  ds_read2_b32 v[102:103], v240 offset0:0 offset1:2
  ds_read2_b32 v[104:105], v241 offset0:0 offset1:2
  ds_read2_b32 v[106:107], v242 offset0:0 offset1:2
  v_smfmac_f32_16x16x64_bf16 v[84:87], v[56:59], a[136:143], v23
  v_mov_b32 v41, 0
  v_smfmac_f32_16x16x64_bf16 v[80:83], v[60:63], a[176:183], v23
  v_mov_b32 v42, 0
  v_smfmac_f32_16x16x64_bf16 v[84:87], v[60:63], a[184:191], v23
  v_mov_b32 v43, 0
  v_mov_b32 v44, 0
  v_mov_b32 v45, 0
  v_mov_b32 v46, 0
  v_mov_b32 v47, 0
  s_waitcnt lgkmcnt(2)
  v_pk_add_f32 v[100:101], v[100:101], v[102:103]
  s_waitcnt lgkmcnt(0)
  v_pk_add_f32 v[104:105], v[104:105], v[106:107]
  v_pk_add_f32 v[100:101], v[100:101], v[104:105]
  v_cvt_pk_bf16_f32 v112, v100, v101
  v_min_u32 v112, s54, v112
  buffer_store_dword v112, v7, s[4:7], s41 offen sc1
  v_pk_add_f32 v[96:97], v[80:81], v[82:83]
  v_pk_add_f32 v[98:99], v[84:85], v[86:87]
  ds_write_b128 v4, v[96:99] offset:2176
  v_mov_b64 v[212:213], 0
  v_mov_b64 v[214:215], 0
  v_mov_b64 v[216:217], 0
  v_mov_b64 v[218:219], 0
  v_mov_b64 v[220:221], 0
  v_mov_b64 v[222:223], 0
  v_mov_b64 v[224:225], 0
  v_mov_b64 v[226:227], 0
  v_mov_b64 v[228:229], 0
  v_mov_b64 v[230:231], 0
  s_waitcnt lgkmcnt(0)
  s_barrier
  ds_read_b64 v[88:89], v5 offset:0
  buffer_load_dwordx4 v[64:67], v9, s[4:7], s41 offen offset:0 sc1
  s_mov_b32 s42, s41
  s_add_u32 s90, s40, 1
  ds_read_b64 v[90:91], v5 offset:3264
  buffer_load_dwordx4 v[68:71], v9, s[4:7], s41 offen offset:1024 sc1
  s_and_b32 s90, s90, 3
  s_lshl_b32 s90, s90, 19
  ds_read_b64 v[92:93], v5 offset:6528
  buffer_load_dwordx4 v[72:75], v9, s[4:7], s41 offen offset:2048 sc1
  s_add_u32 s91, s90, 0x3800000
  s_add_u32 s55, s55, 0x40000
  ds_read_b64 v[94:95], v5 offset:9792
  buffer_load_dwordx4 v[76:79], v9, s[4:7], s41 offen offset:3072 sc1
  s_min_u32 s55, s55, 0xfc0000
  s_nop 0
  s_waitcnt lgkmcnt(2)
  v_pk_add_f32 v[88:89], v[88:89], v[90:91]
  s_waitcnt lgkmcnt(0)
  v_pk_add_f32 v[92:93], v[92:93], v[94:95]
  v_pk_add_f32 v[88:89], v[88:89], v[92:93]
  v_cvt_pk_bf16_f32 v113, v88, v89
  v_min_u32 v113, s54, v113
  buffer_store_dword v113, v8, s[4:7], s41 offen sc1
  s_add_u32 s8, s94, s55
  s_addc_u32 s9, s95, 0
  s_add_u32 s8, s8, s12
  s_addc_u32 s9, s9, 0
  s_add_u32 s10, s8, 0x1000000
  s_addc_u32 s11, s9, 0
  s_load_dword s16, s[8:9], 0
  s_load_dword s17, s[10:11], 0
  s_load_dword s18, s[8:9], 64
  s_load_dword s19, s[10:11], 64
  s_load_dword s20, s[8:9], 128
  s_load_dword s21, s[10:11], 128
  s_load_dword s22, s[8:9], 192
  s_load_dword s23, s[10:11], 192
  s_cmp_eq_u32 s40, 63
  s_cbranch_scc1 SL_last
  s_waitcnt vmcnt(4)
  v_max3_u32 v31, v64, v65, v66
  v_max_u32 v31, v31, v67
  v_cmp_eq_u32 vcc, -1, v31
  s_cbranch_vccnz SL_x_f0
  v_mfma_f32_16x16x32_bf16 v[44:47], v[64:67], v[64:67], v[44:47]
  s_waitcnt vmcnt(3)
  v_max3_u32 v31, v68, v69, v70
  v_max_u32 v31, v31, v71
  v_cmp_eq_u32 vcc, -1, v31
  v_mfma_f32_16x16x32_bf16 v[36:39], v[116:119], v[64:67], v[36:39]
  v_mfma_f32_16x16x32_bf16 v[40:43], v[132:135], v[64:67], v[40:43]
  s_cbranch_vccnz SL_x_f1
  v_mfma_f32_16x16x32_bf16 v[44:47], v[68:71], v[68:71], v[44:47]
  s_waitcnt vmcnt(2)
  v_max3_u32 v31, v72, v73, v74
  v_max_u32 v31, v31, v75
  v_cmp_eq_u32 vcc, -1, v31
  v_mfma_f32_16x16x32_bf16 v[36:39], v[120:123], v[68:71], v[36:39]
  v_mfma_f32_16x16x32_bf16 v[40:43], v[136:139], v[68:71], v[40:43]
  s_cbranch_vccnz SL_x_f2
  v_mfma_f32_16x16x32_bf16 v[44:47], v[72:75], v[72:75], v[44:47]
  s_waitcnt vmcnt(1)
  v_max3_u32 v31, v76, v77, v78
  v_max_u32 v31, v31, v79
  v_cmp_eq_u32 vcc, -1, v31
  v_mfma_f32_16x16x32_bf16 v[36:39], v[124:127], v[72:75], v[36:39]
  v_mfma_f32_16x16x32_bf16 v[40:43], v[140:143], v[72:75], v[40:43]
  s_cbranch_vccnz SL_x_f3
  v_mfma_f32_16x16x32_bf16 v[44:47], v[76:79], v[76:79], v[44:47]
  v_mfma_f32_16x16x32_bf16 v[36:39], v[128:131], v[76:79], v[36:39]
  v_mfma_f32_16x16x32_bf16 v[40:43], v[144:147], v[76:79], v[40:43]
SL_x_done:
  buffer_load_dwordx4 v[88:91], v10, s[4:7], s41 offen offset:0 sc1
  buffer_load_dwordx4 v[92:95], v10, s[4:7], s41 offen offset:1024 sc1
  s_mov_b64 vcc, s[48:49]
  s_nop 2
  v_max_f32 v30, v46, v47
  s_nop 0
  v_cndmask_b32_dpp v96, v40, v36, vcc quad_perm:[0,1,0,1] row_mask:0xf bank_mask:0xf
  v_cndmask_b32_dpp v97, v41, v37, vcc quad_perm:[0,1,0,1] row_mask:0xf bank_mask:0xf
  v_cndmask_b32_dpp v98, v42, v38, vcc quad_perm:[0,1,0,1] row_mask:0xf bank_mask:0xf
  v_cndmask_b32_dpp v99, v43, v39, vcc quad_perm:[0,1,0,1] row_mask:0xf bank_mask:0xf
  v_max3_f32 v29, v96, v97, v98
  s_nop 0
  v_max_f32_dpp v28, v30, v99 quad_perm:[0,1,0,1] row_mask:0xf bank_mask:0xf
  v_max_f32 v29, v29, v28
  s_nop 1
  v_max_f32_dpp v28, v29, v29 quad_perm:[2,3,0,1] row_mask:0xf bank_mask:0xf
  v_mov_b32 v29, v28
  s_nop 1
  v_permlane32_swap_b32 v28, v29
  v_max_f32 v28, v28, v29
  v_mov_b32 v29, v28
  s_nop 1
  v_permlane16_swap_b32 v28, v29
  v_max_f32 v28, v28, v29
  v_mul_f32 v28, s47, v28
  v_fma_f32 v96, v96, s47, -v28
  v_fma_f32 v97, v97, s47, -v28
  v_fma_f32 v98, v98, s47, -v28
  v_fma_f32 v99, v99, s47, -v28
  v_fma_f32 v46, v46, s47, -v28
  v_fma_f32 v47, v47, s47, -v28
  v_exp_f32 v96, v96
  v_exp_f32 v97, v97
  v_exp_f32 v98, v98
  v_exp_f32 v99, v99
  v_cvt_pk_bf16_f32 v236, v96, v97
  v_cvt_pk_bf16_f32 v237, v98, v99
  v_exp_f32 v46, v46
  v_mov_b32_dpp v100, v236 quad_perm:[0,1,0,1] row_mask:0xf bank_mask:0xf
  v_mov_b32_dpp v102, v236 quad_perm:[2,3,2,3] row_mask:0xf bank_mask:0xf
  v_mov_b32_dpp v101, v237 quad_perm:[0,1,0,1] row_mask:0xf bank_mask:0xf
  v_mov_b32_dpp v103, v237 quad_perm:[2,3,2,3] row_mask:0xf bank_mask:0xf
  v_exp_f32 v47, v47
  s_nop 0
  v_smfmac_f32_16x16x64_bf16 v[228:231], v[100:103], v[248:255], v23
  v_cvt_pk_bf16_f32 v238, v46, v47
  buffer_load_dwordx4 v[116:119], v11, s[4:7], s44 offen offset:0
  v_smfmac_f32_16x16x64_bf16 v[212:215], v[100:103], v[148:155], v23
  buffer_load_dwordx4 v[132:135], v11, s[4:7], s44 offen offset:64
  v_mov_b32_dpp v232, v238 quad_perm:[0,1,0,1] row_mask:0xf bank_mask:0xf
  v_smfmac_f32_16x16x64_bf16 v[216:219], v[100:103], v[156:163], v23
  buffer_load_dwordx4 v[120:123], v11, s[4:7], s44 offen offset:1024
  v_mov_b32_dpp v235, v238 quad_perm:[0,1,0,1] row_mask:0xf bank_mask:0xf
  v_smfmac_f32_16x16x64_bf16 v[220:223], v[100:103], v[164:171], v23
  buffer_load_dwordx4 v[136:139], v11, s[4:7], s44 offen offset:1088
  s_waitcnt vmcnt(4)
  v_max3_u32 v31, v88, v89, v90
  v_max3_u32 v31, v31, v91, v92
  v_smfmac_f32_16x16x32_bf16 v[228:231], v[232:233], v[248:251], v23
  v_max3_u32 v31, v31, v93, v94
  v_max_u32 v31, v31, v95
  v_cmp_eq_u32 vcc, -1, v31
  v_smfmac_f32_16x16x64_bf16 v[224:227], v[100:103], v[172:179], v23
  s_cbranch_vccnz SL_v_f
SL_v_ok:
  v_smfmac_f32_16x16x32_bf16 v[212:215], v[232:233], v[88:91], v23
  buffer_load_dwordx4 v[124:127], v11, s[4:7], s44 offen offset:2048
  buffer_load_dwordx4 v[140:143], v11, s[4:7], s44 offen offset:2112
  v_smfmac_f32_16x16x32_bf16 v[216:219], v[234:235], v[88:91], v23
  v_rcp_f32 v28, v228
  v_smfmac_f32_16x16x32_bf16 v[220:223], v[232:233], v[92:95], v23
  v_rcp_f32 v29, v229
  v_smfmac_f32_16x16x32_bf16 v[224:227], v[234:235], v[92:95], v23
  s_nop 0
  v_pk_mul_f32 v[212:213], v[212:213], v[28:29]
  v_pk_mul_f32 v[214:215], v[214:215], v[28:29]
  v_cvt_pk_bf16_f32 v104, v212, v214
  v_cvt_pk_bf16_f32 v108, v213, v215
  v_pk_mul_f32 v[216:217], v[216:217], v[28:29]
  v_pk_mul_f32 v[218:219], v[218:219], v[28:29]
  v_cvt_pk_bf16_f32 v105, v216, v218
  v_cvt_pk_bf16_f32 v109, v217, v219
  v_pk_mul_f32 v[220:221], v[220:221], v[28:29]
  v_pk_mul_f32 v[222:223], v[222:223], v[28:29]
  v_cvt_pk_bf16_f32 v106, v220, v222
  v_cvt_pk_bf16_f32 v110, v221, v223
  v_pk_mul_f32 v[224:225], v[224:225], v[28:29]
  v_pk_mul_f32 v[226:227], v[226:227], v[28:29]
  v_cvt_pk_bf16_f32 v107, v224, v226
  v_cvt_pk_bf16_f32 v111, v225, v227
  ds_write_b128 v14, v[104:107]
  ds_write_b128 v15, v[108:111]
  s_add_u32 s92, s40, 3
  s_min_u32 s92, s92, 63
  s_lshr_b32 s92, s92, 2
  s_lshl_b32 s92, s92, 9
  v_mov_b32 v246, s40
  s_waitcnt lgkmcnt(0)
  s_barrier
  ds_read_b128 v[48:51], v16 offset:0
  ds_read_b128 v[52:55], v16 offset:1024
  ds_read_b128 v[56:59], v16 offset:2048
  ds_read_b128 v[60:63], v16 offset:3072
  ds_read_b128 v[64:67], v16 offset:4096
  buffer_store_dword v22, v17, s[4:7], s43 offen sc1
  buffer_store_dword v112, v19, s[4:7], s45 offen sc1
  s_waitcnt lgkmcnt(4)
  v_smfmac_f32_16x16x64_bf16 v[32:35], v[48:51], a[192:199], v23
  ds_read_b128 v[68:71], v16 offset:5120
  buffer_store_dword v113, v20, s[4:7], s45 offen sc1
  s_waitcnt lgkmcnt(4)
  v_smfmac_f32_16x16x64_bf16 v[32:35], v[52:55], a[200:207], v23
  ds_read_b128 v[72:75], v16 offset:6144
  buffer_store_dword v246, v245, s[4:7], 0 offen sc1
  s_waitcnt lgkmcnt(4)
  v_smfmac_f32_16x16x64_bf16 v[32:35], v[56:59], a[208:215], v23
  ds_read_b128 v[76:79], v16 offset:7168
  buffer_load_dword v243, v244, s[4:7], s92 offen sc1
  s_waitcnt lgkmcnt(4)
  v_smfmac_f32_16x16x64_bf16 v[32:35], v[60:63], a[216:223], v23
  s_mov_b32 s13, s43
  s_waitcnt lgkmcnt(3)
  v_smfmac_f32_16x16x64_bf16 v[32:35], v[64:67], a[224:231], v23
  s_add_u32 s40, s40, 1
  s_waitcnt lgkmcnt(2)
  v_smfmac_f32_16x16x64_bf16 v[32:35], v[68:71], a[232:239], v23
  s_mov_b32 s41, s91
  s_waitcnt lgkmcnt(1)
  v_smfmac_f32_16x16x64_bf16 v[32:35], v[72:75], a[240:247], v23
  s_xor_b32 s43, s91, 0x100000
  s_waitcnt lgkmcnt(0)
  v_smfmac_f32_16x16x64_bf16 v[32:35], v[76:79], a[248:255], v23
  s_nop 7
  v_pk_add_f32 v[28:29], v[32:33], v[34:35]
  v_cvt_pk_bf16_f32 v28, v28, v29
  v_min_u32 v28, s54, v28
  buffer_store_dword v28, v17, s[4:7], s42 offen sc1
  buffer_store_dword v28, v18, s[4:7], s42 offen sc1
  s_branch SL_step
SL_last:
  buffer_store_dword v112, v19, s[4:7], s45 offen sc1
  buffer_store_dword v113, v20, s[4:7], s45 offen sc1
  s_branch L_join
SL_kv_f:
  s_sleep 8
  buffer_load_dword v243, v244, s[4:7], s92 offen sc1
  s_add_u32 s46, s46, 1
  s_cmp_ge_u32 s46, 131072
  s_cbranch_scc1 SL_rec_abort
  s_waitcnt vmcnt(0)
  s_branch SL_kv_chk
SL_g_f:
  s_mov_b64 exec, vcc
  buffer_load_dwordx4 v[36:39], v1, s[4:7], s42 offen sc1
  s_mov_b64 exec, -1
  s_add_u32 s46, s46, 1
  s_cmp_ge_u32 s46, 131072
  s_cbranch_scc1 SL_rec_abort
  s_waitcnt vmcnt(0)
  s_branch SL_g_chk
SL_m_f0:
  s_mov_b64 exec, vcc
  buffer_load_dwordx4 v[48:51], v3, s[4:7], s41 offen offset:0 sc1
  s_mov_b64 exec, -1
  s_waitcnt vmcnt(1)
  s_branch SL_m_0123_c1
SL_m_f1:
  s_mov_b64 exec, vcc
  buffer_load_dwordx4 v[52:55], v3, s[4:7], s41 offen offset:1024 sc1
  s_mov_b64 exec, -1
  s_waitcnt vmcnt(1)
  s_branch SL_m_123_c2
SL_m_f2:
  s_mov_b64 exec, vcc
  buffer_load_dwordx4 v[56:59], v3, s[4:7], s41 offen offset:2048 sc1
  s_mov_b64 exec, -1
  s_waitcnt vmcnt(1)
  s_branch SL_m_23_c3
SL_m_f3:
  s_mov_b64 exec, vcc
  buffer_load_dwordx4 v[60:63], v3, s[4:7], s41 offen offset:3072 sc1
  s_mov_b64 exec, -1
  s_nop 7
  s_branch SL_m_3_c3
SL_m_0_c0:
  v_max3_u32 v31, v48, v49, v50
  v_max_u32 v31, v31, v51
  v_cmp_eq_u32 vcc, -1, v31
  s_cbranch_vccz SL_m_0_ok0
SL_m_0_x0:
  s_mov_b64 exec, vcc
  buffer_load_dwordx4 v[48:51], v3, s[4:7], s41 offen offset:0 sc1
  s_mov_b64 exec, -1
  s_add_u32 s46, s46, 1
  s_cmp_ge_u32 s46, 131072
  s_cbranch_scc1 SL_rec_abort
  s_waitcnt vmcnt(2)
  s_branch SL_m_0_c0
SL_m_0_ok0:
  v_smfmac_f32_16x16x64_bf16 v[64:67], v[48:51], a[0:7], v23
  v_smfmac_f32_16x16x64_bf16 v[68:71], v[48:51], a[8:15], v23
  v_smfmac_f32_16x16x64_bf16 v[72:75], v[48:51], a[16:23], v23
  v_smfmac_f32_16x16x64_bf16 v[76:79], v[48:51], a[24:31], v23
  s_branch SL_m_done
SL_m_1_c1:
  v_max3_u32 v31, v52, v53, v54
  v_max_u32 v31, v31, v55
  v_cmp_eq_u32 vcc, -1, v31
  s_cbranch_vccz SL_m_1_ok1
SL_m_1_x1:
  s_mov_b64 exec, vcc
  buffer_load_dwordx4 v[52:55], v3, s[4:7], s41 offen offset:1024 sc1
  s_mov_b64 exec, -1
  s_add_u32 s46, s46, 1
  s_cmp_ge_u32 s46, 131072
  s_cbranch_scc1 SL_rec_abort
  s_waitcnt vmcnt(2)
  s_branch SL_m_1_c1
SL_m_1_ok1:
  v_smfmac_f32_16x16x64_bf16 v[64:67], v[52:55], a[48:55], v23
  v_smfmac_f32_16x16x64_bf16 v[68:71], v[52:55], a[56:63], v23
  v_smfmac_f32_16x16x64_bf16 v[72:75], v[52:55], a[64:71], v23
  v_smfmac_f32_16x16x64_bf16 v[76:79], v[52:55], a[72:79], v23
  s_branch SL_m_done
SL_m_2_c2:
  v_max3_u32 v31, v56, v57, v58
  v_max_u32 v31, v31, v59
  v_cmp_eq_u32 vcc, -1, v31
  s_cbranch_vccz SL_m_2_ok2
SL_m_2_x2:
  s_mov_b64 exec, vcc
  buffer_load_dwordx4 v[56:59], v3, s[4:7], s41 offen offset:2048 sc1
  s_mov_b64 exec, -1
  s_add_u32 s46, s46, 1
  s_cmp_ge_u32 s46, 131072
  s_cbranch_scc1 SL_rec_abort
  s_waitcnt vmcnt(2)
  s_branch SL_m_2_c2
SL_m_2_ok2:
  v_smfmac_f32_16x16x64_bf16 v[64:67], v[56:59], a[96:103], v23
  v_smfmac_f32_16x16x64_bf16 v[68:71], v[56:59], a[104:111], v23
  v_smfmac_f32_16x16x64_bf16 v[72:75], v[56:59], a[112:119], v23
  v_smfmac_f32_16x16x64_bf16 v[76:79], v[56:59], a[120:127], v23
  s_branch SL_m_done
SL_m_3_c3:
  v_max3_u32 v31, v60, v61, v62
  v_max_u32 v31, v31, v63
  v_cmp_eq_u32 vcc, -1, v31
  s_cbranch_vccz SL_m_3_ok3
SL_m_3_x3:
  s_mov_b64 exec, vcc
  buffer_load_dwordx4 v[60:63], v3, s[4:7], s41 offen offset:3072 sc1
  s_mov_b64 exec, -1
  s_add_u32 s46, s46, 1
  s_cmp_ge_u32 s46, 131072
  s_cbranch_scc1 SL_rec_abort
  s_waitcnt vmcnt(2)
  s_branch SL_m_3_c3
SL_m_3_ok3:
  v_smfmac_f32_16x16x64_bf16 v[64:67], v[60:63], a[144:151], v23
  v_smfmac_f32_16x16x64_bf16 v[68:71], v[60:63], a[152:159], v23
  v_smfmac_f32_16x16x64_bf16 v[72:75], v[60:63], a[160:167], v23
  v_smfmac_f32_16x16x64_bf16 v[76:79], v[60:63], a[168:175], v23
  s_branch SL_m_done
SL_m_01_c0:
  v_max3_u32 v31, v48, v49, v50
  v_max_u32 v31, v31, v51
  v_cmp_eq_u32 vcc, -1, v31
  s_cbranch_vccz SL_m_01_ok0
SL_m_01_x0:
  s_mov_b64 exec, vcc
  buffer_load_dwordx4 v[48:51], v3, s[4:7], s41 offen offset:0 sc1
  s_mov_b64 exec, -1
SL_m_01_c1:
  v_max3_u32 v31, v52, v53, v54
  v_max_u32 v31, v31, v55
  v_cmp_eq_u32 vcc, -1, v31
  s_cbranch_vccz SL_m_01_ok1
SL_m_01_x1:
  s_mov_b64 exec, vcc
  buffer_load_dwordx4 v[52:55], v3, s[4:7], s41 offen offset:1024 sc1
  s_mov_b64 exec, -1
  s_add_u32 s46, s46, 1
  s_cmp_ge_u32 s46, 131072
  s_cbranch_scc1 SL_rec_abort
  s_waitcnt vmcnt(4)
  s_branch SL_m_01_c0
SL_m_01_ok0:
  v_smfmac_f32_16x16x64_bf16 v[64:67], v[48:51], a[0:7], v23
  v_max3_u32 v31, v52, v53, v54
  v_max_u32 v31, v31, v55
  v_cmp_eq_u32 vcc, -1, v31
  v_smfmac_f32_16x16x64_bf16 v[68:71], v[48:51], a[8:15], v23
  v_smfmac_f32_16x16x64_bf16 v[72:75], v[48:51], a[16:23], v23
  v_smfmac_f32_16x16x64_bf16 v[76:79], v[48:51], a[24:31], v23
  s_cbranch_vccz SL_m_1_ok1
  s_branch SL_m_1_x1
SL_m_01_ok1:
  v_smfmac_f32_16x16x64_bf16 v[64:67], v[52:55], a[48:55], v23
  v_max3_u32 v31, v48, v49, v50
  v_max_u32 v31, v31, v51
  v_cmp_eq_u32 vcc, -1, v31
  v_smfmac_f32_16x16x64_bf16 v[68:71], v[52:55], a[56:63], v23
  v_smfmac_f32_16x16x64_bf16 v[72:75], v[52:55], a[64:71], v23
  v_smfmac_f32_16x16x64_bf16 v[76:79], v[52:55], a[72:79], v23
  s_cbranch_vccz SL_m_0_ok0
  s_branch SL_m_0_x0
SL_m_02_c0:
  v_max3_u32 v31, v48, v49, v50
  v_max_u32 v31, v31, v51
  v_cmp_eq_u32 vcc, -1, v31
  s_cbranch_vccz SL_m_02_ok0
SL_m_02_x0:
  s_mov_b64 exec, vcc
  buffer_load_dwordx4 v[48:51], v3, s[4:7], s41 offen offset:0 sc1
  s_mov_b64 exec, -1
SL_m_02_c2:
  v_max3_u32 v31, v56, v57, v58
  v_max_u32 v31, v31, v59
  v_cmp_eq_u32 vcc, -1, v31
  s_cbranch_vccz SL_m_02_ok2
SL_m_02_x2:
  s_mov_b64 exec, vcc
  buffer_load_dwordx4 v[56:59], v3, s[4:7], s41 offen offset:2048 sc1
  s_mov_b64 exec, -1
  s_add_u32 s46, s46, 1
  s_cmp_ge_u32 s46, 131072
  s_cbranch_scc1 SL_rec_abort
  s_waitcnt vmcnt(4)
  s_branch SL_m_02_c0
SL_m_02_ok0:
  v_smfmac_f32_16x16x64_bf16 v[64:67], v[48:51], a[0:7], v23
  v_max3_u32 v31, v56, v57, v58
  v_max_u32 v31, v31, v59
  v_cmp_eq_u32 vcc, -1, v31
  v_smfmac_f32_16x16x64_bf16 v[68:71], v[48:51], a[8:15], v23
  v_smfmac_f32_16x16x64_bf16 v[72:75], v[48:51], a[16:23], v23
  v_smfmac_f32_16x16x64_bf16 v[76:79], v[48:51], a[24:31], v23
  s_cbranch_vccz SL_m_2_ok2
  s_branch SL_m_2_x2
SL_m_02_ok2:
  v_smfmac_f32_16x16x64_bf16 v[64:67], v[56:59], a[96:103], v23
  v_max3_u32 v31, v48, v49, v50
  v_max_u32 v31, v31, v51
  v_cmp_eq_u32 vcc, -1, v31
  v_smfmac_f32_16x16x64_bf16 v[68:71], v[56:59], a[104:111], v23
  v_smfmac_f32_16x16x64_bf16 v[72:75], v[56:59], a[112:119], v23
  v_smfmac_f32_16x16x64_bf16 v[76:79], v[56:59], a[120:127], v23
  s_cbranch_vccz SL_m_0_ok0
  s_branch SL_m_0_x0
SL_m_03_c0:
  v_max3_u32 v31, v48, v49, v50
  v_max_u32 v31, v31, v51
  v_cmp_eq_u32 vcc, -1, v31
  s_cbranch_vccz SL_m_03_ok0
SL_m_03_x0:
  s_mov_b64 exec, vcc
  buffer_load_dwordx4 v[48:51], v3, s[4:7], s41 offen offset:0 sc1
  s_mov_b64 exec, -1
SL_m_03_c3:
  v_max3_u32 v31, v60, v61, v62
  v_max_u32 v31, v31, v63
  v_cmp_eq_u32 vcc, -1, v31
  s_cbranch_vccz SL_m_03_ok3
SL_m_03_x3:
  s_mov_b64 exec, vcc
  buffer_load_dwordx4 v[60:63], v3, s[4:7], s41 offen offset:3072 sc1
  s_mov_b64 exec, -1
  s_add_u32 s46, s46, 1
  s_cmp_ge_u32 s46, 131072
  s_cbranch_scc1 SL_rec_abort
  s_waitcnt vmcnt(4)
  s_branch SL_m_03_c0
SL_m_03_ok0:
  v_smfmac_f32_16x16x64_bf16 v[64:67], v[48:51], a[0:7], v23
  v_max3_u32 v31, v60, v61, v62
  v_max_u32 v31, v31, v63
  v_cmp_eq_u32 vcc, -1, v31
  v_smfmac_f32_16x16x64_bf16 v[68:71], v[48:51], a[8:15], v23
  v_smfmac_f32_16x16x64_bf16 v[72:75], v[48:51], a[16:23], v23
  v_smfmac_f32_16x16x64_bf16 v[76:79], v[48:51], a[24:31], v23
  s_cbranch_vccz SL_m_3_ok3
  s_branch SL_m_3_x3
SL_m_03_ok3:
  v_smfmac_f32_16x16x64_bf16 v[64:67], v[60:63], a[144:151], v23
  v_max3_u32 v31, v48, v49, v50
  v_max_u32 v31, v31, v51
  v_cmp_eq_u32 vcc, -1, v31
  v_smfmac_f32_16x16x64_bf16 v[68:71], v[60:63], a[152:159], v23
  v_smfmac_f32_16x16x64_bf16 v[72:75], v[60:63], a[160:167], v23
  v_smfmac_f32_16x16x64_bf16 v[76:79], v[60:63], a[168:175], v23
  s_cbranch_vccz SL_m_0_ok0
  s_branch SL_m_0_x0
SL_m_12_c1:
  v_max3_u32 v31, v52, v53, v54
  v_max_u32 v31, v31, v55
  v_cmp_eq_u32 vcc, -1, v31
  s_cbranch_vccz SL_m_12_ok1
SL_m_12_x1:
  s_mov_b64 exec, vcc
  buffer_load_dwordx4 v[52:55], v3, s[4:7], s41 offen offset:1024 sc1
  s_mov_b64 exec, -1
SL_m_12_c2:
  v_max3_u32 v31, v56, v57, v58
  v_max_u32 v31, v31, v59
  v_cmp_eq_u32 vcc, -1, v31
  s_cbranch_vccz SL_m_12_ok2
SL_m_12_x2:
  s_mov_b64 exec, vcc
  buffer_load_dwordx4 v[56:59], v3, s[4:7], s41 offen offset:2048 sc1
  s_mov_b64 exec, -1
  s_add_u32 s46, s46, 1
  s_cmp_ge_u32 s46, 131072
  s_cbranch_scc1 SL_rec_abort
  s_waitcnt vmcnt(4)
  s_branch SL_m_12_c1
SL_m_12_ok1:
  v_smfmac_f32_16x16x64_bf16 v[64:67], v[52:55], a[48:55], v23
  v_max3_u32 v31, v56, v57, v58
  v_max_u32 v31, v31, v59
  v_cmp_eq_u32 vcc, -1, v31
  v_smfmac_f32_16x16x64_bf16 v[68:71], v[52:55], a[56:63], v23
  v_smfmac_f32_16x16x64_bf16 v[72:75], v[52:55], a[64:71], v23
  v_smfmac_f32_16x16x64_bf16 v[76:79], v[52:55], a[72:79], v23
  s_cbranch_vccz SL_m_2_ok2
  s_branch SL_m_2_x2
SL_m_12_ok2:
  v_smfmac_f32_16x16x64_bf16 v[64:67], v[56:59], a[96:103], v23
  v_max3_u32 v31, v52, v53, v54
  v_max_u32 v31, v31, v55
  v_cmp_eq_u32 vcc, -1, v31
  v_smfmac_f32_16x16x64_bf16 v[68:71], v[56:59], a[104:111], v23
  v_smfmac_f32_16x16x64_bf16 v[72:75], v[56:59], a[112:119], v23
  v_smfmac_f32_16x16x64_bf16 v[76:79], v[56:59], a[120:127], v23
  s_cbranch_vccz SL_m_1_ok1
  s_branch SL_m_1_x1
SL_m_13_c1:
  v_max3_u32 v31, v52, v53, v54
  v_max_u32 v31, v31, v55
  v_cmp_eq_u32 vcc, -1, v31
  s_cbranch_vccz SL_m_13_ok1
SL_m_13_x1:
  s_mov_b64 exec, vcc
  buffer_load_dwordx4 v[52:55], v3, s[4:7], s41 offen offset:1024 sc1
  s_mov_b64 exec, -1
SL_m_13_c3:
  v_max3_u32 v31, v60, v61, v62
  v_max_u32 v31, v31, v63
  v_cmp_eq_u32 vcc, -1, v31
  s_cbranch_vccz SL_m_13_ok3
SL_m_13_x3:
  s_mov_b64 exec, vcc
  buffer_load_dwordx4 v[60:63], v3, s[4:7], s41 offen offset:3072 sc1
  s_mov_b64 exec, -1
  s_add_u32 s46, s46, 1
  s_cmp_ge_u32 s46, 131072
  s_cbranch_scc1 SL_rec_abort
  s_waitcnt vmcnt(4)
  s_branch SL_m_13_c1
SL_m_13_ok1:
  v_smfmac_f32_16x16x64_bf16 v[64:67], v[52:55], a[48:55], v23
  v_max3_u32 v31, v60, v61, v62
  v_max_u32 v31, v31, v63
  v_cmp_eq_u32 vcc, -1, v31
  v_smfmac_f32_16x16x64_bf16 v[68:71], v[52:55], a[56:63], v23
  v_smfmac_f32_16x16x64_bf16 v[72:75], v[52:55], a[64:71], v23
  v_smfmac_f32_16x16x64_bf16 v[76:79], v[52:55], a[72:79], v23
  s_cbranch_vccz SL_m_3_ok3
  s_branch SL_m_3_x3
SL_m_13_ok3:
  v_smfmac_f32_16x16x64_bf16 v[64:67], v[60:63], a[144:151], v23
  v_max3_u32 v31, v52, v53, v54
  v_max_u32 v31, v31, v55
  v_cmp_eq_u32 vcc, -1, v31
  v_smfmac_f32_16x16x64_bf16 v[68:71], v[60:63], a[152:159], v23
  v_smfmac_f32_16x16x64_bf16 v[72:75], v[60:63], a[160:167], v23
  v_smfmac_f32_16x16x64_bf16 v[76:79], v[60:63], a[168:175], v23
  s_cbranch_vccz SL_m_1_ok1
  s_branch SL_m_1_x1
SL_m_23_c2:
  v_max3_u32 v31, v56, v57, v58
  v_max_u32 v31, v31, v59
  v_cmp_eq_u32 vcc, -1, v31
  s_cbranch_vccz SL_m_23_ok2
SL_m_23_x2:
  s_mov_b64 exec, vcc
  buffer_load_dwordx4 v[56:59], v3, s[4:7], s41 offen offset:2048 sc1
  s_mov_b64 exec, -1
SL_m_23_c3:
  v_max3_u32 v31, v60, v61, v62
  v_max_u32 v31, v31, v63
  v_cmp_eq_u32 vcc, -1, v31
  s_cbranch_vccz SL_m_23_ok3
SL_m_23_x3:
  s_mov_b64 exec, vcc
  buffer_load_dwordx4 v[60:63], v3, s[4:7], s41 offen offset:3072 sc1
  s_mov_b64 exec, -1
  s_add_u32 s46, s46, 1
  s_cmp_ge_u32 s46, 131072
  s_cbranch_scc1 SL_rec_abort
  s_waitcnt vmcnt(4)
  s_branch SL_m_23_c2
SL_m_23_ok2:
  v_smfmac_f32_16x16x64_bf16 v[64:67], v[56:59], a[96:103], v23
  v_max3_u32 v31, v60, v61, v62
  v_max_u32 v31, v31, v63
  v_cmp_eq_u32 vcc, -1, v31
  v_smfmac_f32_16x16x64_bf16 v[68:71], v[56:59], a[104:111], v23
  v_smfmac_f32_16x16x64_bf16 v[72:75], v[56:59], a[112:119], v23
  v_smfmac_f32_16x16x64_bf16 v[76:79], v[56:59], a[120:127], v23
  s_cbranch_vccz SL_m_3_ok3
  s_branch SL_m_3_x3
SL_m_23_ok3:
  v_smfmac_f32_16x16x64_bf16 v[64:67], v[60:63], a[144:151], v23
  v_max3_u32 v31, v56, v57, v58
  v_max_u32 v31, v31, v59
  v_cmp_eq_u32 vcc, -1, v31
  v_smfmac_f32_16x16x64_bf16 v[68:71], v[60:63], a[152:159], v23
  v_smfmac_f32_16x16x64_bf16 v[72:75], v[60:63], a[160:167], v23
  v_smfmac_f32_16x16x64_bf16 v[76:79], v[60:63], a[168:175], v23
  s_cbranch_vccz SL_m_2_ok2
  s_branch SL_m_2_x2
SL_m_012_c0:
  v_max3_u32 v31, v48, v49, v50
  v_max_u32 v31, v31, v51
  v_cmp_eq_u32 vcc, -1, v31
  s_cbranch_vccz SL_m_012_ok0
SL_m_012_x0:
  s_mov_b64 exec, vcc
  buffer_load_dwordx4 v[48:51], v3, s[4:7], s41 offen offset:0 sc1
  s_mov_b64 exec, -1
SL_m_012_c1:
  v_max3_u32 v31, v52, v53, v54
  v_max_u32 v31, v31, v55
  v_cmp_eq_u32 vcc, -1, v31
  s_cbranch_vccz SL_m_012_ok1
SL_m_012_x1:
  s_mov_b64 exec, vcc
  buffer_load_dwordx4 v[52:55], v3, s[4:7], s41 offen offset:1024 sc1
  s_mov_b64 exec, -1
SL_m_012_c2:
  v_max3_u32 v31, v56, v57, v58
  v_max_u32 v31, v31, v59
  v_cmp_eq_u32 vcc, -1, v31
  s_cbranch_vccz SL_m_012_ok2
SL_m_012_x2:
  s_mov_b64 exec, vcc
  buffer_load_dwordx4 v[56:59], v3, s[4:7], s41 offen offset:2048 sc1
  s_mov_b64 exec, -1
  s_add_u32 s46, s46, 1
  s_cmp_ge_u32 s46, 131072
  s_cbranch_scc1 SL_rec_abort
  s_waitcnt vmcnt(4)
  s_branch SL_m_012_c0
SL_m_012_ok0:
  v_smfmac_f32_16x16x64_bf16 v[64:67], v[48:51], a[0:7], v23
  v_max3_u32 v31, v52, v53, v54
  v_max_u32 v31, v31, v55
  v_cmp_eq_u32 vcc, -1, v31
  v_smfmac_f32_16x16x64_bf16 v[68:71], v[48:51], a[8:15], v23
  v_smfmac_f32_16x16x64_bf16 v[72:75], v[48:51], a[16:23], v23
  v_smfmac_f32_16x16x64_bf16 v[76:79], v[48:51], a[24:31], v23
  s_cbranch_vccz SL_m_12_ok1
  s_branch SL_m_12_x1
SL_m_012_ok1:
  v_smfmac_f32_16x16x64_bf16 v[64:67], v[52:55], a[48:55], v23
  v_max3_u32 v31, v56, v57, v58
  v_max_u32 v31, v31, v59
  v_cmp_eq_u32 vcc, -1, v31
  v_smfmac_f32_16x16x64_bf16 v[68:71], v[52:55], a[56:63], v23
  v_smfmac_f32_16x16x64_bf16 v[72:75], v[52:55], a[64:71], v23
  v_smfmac_f32_16x16x64_bf16 v[76:79], v[52:55], a[72:79], v23
  s_cbranch_vccz SL_m_02_ok2
  s_branch SL_m_02_x2
SL_m_012_ok2:
  v_smfmac_f32_16x16x64_bf16 v[64:67], v[56:59], a[96:103], v23
  v_max3_u32 v31, v48, v49, v50
  v_max_u32 v31, v31, v51
  v_cmp_eq_u32 vcc, -1, v31
  v_smfmac_f32_16x16x64_bf16 v[68:71], v[56:59], a[104:111], v23
  v_smfmac_f32_16x16x64_bf16 v[72:75], v[56:59], a[112:119], v23
  v_smfmac_f32_16x16x64_bf16 v[76:79], v[56:59], a[120:127], v23
  s_cbranch_vccz SL_m_01_ok0
  s_branch SL_m_01_x0
SL_m_013_c0:
  v_max3_u32 v31, v48, v49, v50
  v_max_u32 v31, v31, v51
  v_cmp_eq_u32 vcc, -1, v31
  s_cbranch_vccz SL_m_013_ok0
SL_m_013_x0:
  s_mov_b64 exec, vcc
  buffer_load_dwordx4 v[48:51], v3, s[4:7], s41 offen offset:0 sc1
  s_mov_b64 exec, -1
SL_m_013_c1:
  v_max3_u32 v31, v52, v53, v54
  v_max_u32 v31, v31, v55
  v_cmp_eq_u32 vcc, -1, v31
  s_cbranch_vccz SL_m_013_ok1
SL_m_013_x1:
  s_mov_b64 exec, vcc
  buffer_load_dwordx4 v[52:55], v3, s[4:7], s41 offen offset:1024 sc1
  s_mov_b64 exec, -1
SL_m_013_c3:
  v_max3_u32 v31, v60, v61, v62
  v_max_u32 v31, v31, v63
  v_cmp_eq_u32 vcc, -1, v31
  s_cbranch_vccz SL_m_013_ok3
SL_m_013_x3:
  s_mov_b64 exec, vcc
  buffer_load_dwordx4 v[60:63], v3, s[4:7], s41 offen offset:3072 sc1
  s_mov_b64 exec, -1
  s_add_u32 s46, s46, 1
  s_cmp_ge_u32 s46, 131072
  s_cbranch_scc1 SL_rec_abort
  s_waitcnt vmcnt(4)
  s_branch SL_m_013_c0
SL_m_013_ok0:
  v_smfmac_f32_16x16x64_bf16 v[64:67], v[48:51], a[0:7], v23
  v_max3_u32 v31, v52, v53, v54
  v_max_u32 v31, v31, v55
  v_cmp_eq_u32 vcc, -1, v31
  v_smfmac_f32_16x16x64_bf16 v[68:71], v[48:51], a[8:15], v23
  v_smfmac_f32_16x16x64_bf16 v[72:75], v[48:51], a[16:23], v23
  v_smfmac_f32_16x16x64_bf16 v[76:79], v[48:51], a[24:31], v23
  s_cbranch_vccz SL_m_13_ok1
  s_branch SL_m_13_x1
SL_m_013_ok1:
  v_smfmac_f32_16x16x64_bf16 v[64:67], v[52:55], a[48:55], v23
  v_max3_u32 v31, v60, v61, v62
  v_max_u32 v31, v31, v63
  v_cmp_eq_u32 vcc, -1, v31
  v_smfmac_f32_16x16x64_bf16 v[68:71], v[52:55], a[56:63], v23
  v_smfmac_f32_16x16x64_bf16 v[72:75], v[52:55], a[64:71], v23
  v_smfmac_f32_16x16x64_bf16 v[76:79], v[52:55], a[72:79], v23
  s_cbranch_vccz SL_m_03_ok3
  s_branch SL_m_03_x3
SL_m_013_ok3:
  v_smfmac_f32_16x16x64_bf16 v[64:67], v[60:63], a[144:151], v23
  v_max3_u32 v31, v48, v49, v50
  v_max_u32 v31, v31, v51
  v_cmp_eq_u32 vcc, -1, v31
  v_smfmac_f32_16x16x64_bf16 v[68:71], v[60:63], a[152:159], v23
  v_smfmac_f32_16x16x64_bf16 v[72:75], v[60:63], a[160:167], v23
  v_smfmac_f32_16x16x64_bf16 v[76:79], v[60:63], a[168:175], v23
  s_cbranch_vccz SL_m_01_ok0
  s_branch SL_m_01_x0
SL_m_023_c0:
  v_max3_u32 v31, v48, v49, v50
  v_max_u32 v31, v31, v51
  v_cmp_eq_u32 vcc, -1, v31
  s_cbranch_vccz SL_m_023_ok0
SL_m_023_x0:
  s_mov_b64 exec, vcc
  buffer_load_dwordx4 v[48:51], v3, s[4:7], s41 offen offset:0 sc1
  s_mov_b64 exec, -1
SL_m_023_c2:
  v_max3_u32 v31, v56, v57, v58
  v_max_u32 v31, v31, v59
  v_cmp_eq_u32 vcc, -1, v31
  s_cbranch_vccz SL_m_023_ok2
SL_m_023_x2:
  s_mov_b64 exec, vcc
  buffer_load_dwordx4 v[56:59], v3, s[4:7], s41 offen offset:2048 sc1
  s_mov_b64 exec, -1
SL_m_023_c3:
  v_max3_u32 v31, v60, v61, v62
  v_max_u32 v31, v31, v63
  v_cmp_eq_u32 vcc, -1, v31
  s_cbranch_vccz SL_m_023_ok3
SL_m_023_x3:
  s_mov_b64 exec, vcc
  buffer_load_dwordx4 v[60:63], v3, s[4:7], s41 offen offset:3072 sc1
  s_mov_b64 exec, -1
  s_add_u32 s46, s46, 1
  s_cmp_ge_u32 s46, 131072
  s_cbranch_scc1 SL_rec_abort
  s_waitcnt vmcnt(4)
  s_branch SL_m_023_c0
SL_m_023_ok0:
  v_smfmac_f32_16x16x64_bf16 v[64:67], v[48:51], a[0:7], v23
  v_max3_u32 v31, v56, v57, v58
  v_max_u32 v31, v31, v59
  v_cmp_eq_u32 vcc, -1, v31
  v_smfmac_f32_16x16x64_bf16 v[68:71], v[48:51], a[8:15], v23
  v_smfmac_f32_16x16x64_bf16 v[72:75], v[48:51], a[16:23], v23
  v_smfmac_f32_16x16x64_bf16 v[76:79], v[48:51], a[24:31], v23
  s_cbranch_vccz SL_m_23_ok2
  s_branch SL_m_23_x2
SL_m_023_ok2:
  v_smfmac_f32_16x16x64_bf16 v[64:67], v[56:59], a[96:103], v23
  v_max3_u32 v31, v60, v61, v62
  v_max_u32 v31, v31, v63
  v_cmp_eq_u32 vcc, -1, v31
  v_smfmac_f32_16x16x64_bf16 v[68:71], v[56:59], a[104:111], v23
  v_smfmac_f32_16x16x64_bf16 v[72:75], v[56:59], a[112:119], v23
  v_smfmac_f32_16x16x64_bf16 v[76:79], v[56:59], a[120:127], v23
  s_cbranch_vccz SL_m_03_ok3
  s_branch SL_m_03_x3
SL_m_023_ok3:
  v_smfmac_f32_16x16x64_bf16 v[64:67], v[60:63], a[144:151], v23
  v_max3_u32 v31, v48, v49, v50
  v_max_u32 v31, v31, v51
  v_cmp_eq_u32 vcc, -1, v31
  v_smfmac_f32_16x16x64_bf16 v[68:71], v[60:63], a[152:159], v23
  v_smfmac_f32_16x16x64_bf16 v[72:75], v[60:63], a[160:167], v23
  v_smfmac_f32_16x16x64_bf16 v[76:79], v[60:63], a[168:175], v23
  s_cbranch_vccz SL_m_02_ok0
  s_branch SL_m_02_x0
SL_m_123_c1:
  v_max3_u32 v31, v52, v53, v54
  v_max_u32 v31, v31, v55
  v_cmp_eq_u32 vcc, -1, v31
  s_cbranch_vccz SL_m_123_ok1
SL_m_123_x1:
  s_mov_b64 exec, vcc
  buffer_load_dwordx4 v[52:55], v3, s[4:7], s41 offen offset:1024 sc1
  s_mov_b64 exec, -1
SL_m_123_c2:
  v_max3_u32 v31, v56, v57, v58
  v_max_u32 v31, v31, v59
  v_cmp_eq_u32 vcc, -1, v31
  s_cbranch_vccz SL_m_123_ok2
SL_m_123_x2:
  s_mov_b64 exec, vcc
  buffer_load_dwordx4 v[56:59], v3, s[4:7], s41 offen offset:2048 sc1
  s_mov_b64 exec, -1
SL_m_123_c3:
  v_max3_u32 v31, v60, v61, v62
  v_max_u32 v31, v31, v63
  v_cmp_eq_u32 vcc, -1, v31
  s_cbranch_vccz SL_m_123_ok3
SL_m_123_x3:
  s_mov_b64 exec, vcc
  buffer_load_dwordx4 v[60:63], v3, s[4:7], s41 offen offset:3072 sc1
  s_mov_b64 exec, -1
  s_add_u32 s46, s46, 1
  s_cmp_ge_u32 s46, 131072
  s_cbranch_scc1 SL_rec_abort
  s_waitcnt vmcnt(4)
  s_branch SL_m_123_c1
SL_m_123_ok1:
  v_smfmac_f32_16x16x64_bf16 v[64:67], v[52:55], a[48:55], v23
  v_max3_u32 v31, v56, v57, v58
  v_max_u32 v31, v31, v59
  v_cmp_eq_u32 vcc, -1, v31
  v_smfmac_f32_16x16x64_bf16 v[68:71], v[52:55], a[56:63], v23
  v_smfmac_f32_16x16x64_bf16 v[72:75], v[52:55], a[64:71], v23
  v_smfmac_f32_16x16x64_bf16 v[76:79], v[52:55], a[72:79], v23
  s_cbranch_vccz SL_m_23_ok2
  s_branch SL_m_23_x2
SL_m_123_ok2:
  v_smfmac_f32_16x16x64_bf16 v[64:67], v[56:59], a[96:103], v23
  v_max3_u32 v31, v60, v61, v62
  v_max_u32 v31, v31, v63
  v_cmp_eq_u32 vcc, -1, v31
  v_smfmac_f32_16x16x64_bf16 v[68:71], v[56:59], a[104:111], v23
  v_smfmac_f32_16x16x64_bf16 v[72:75], v[56:59], a[112:119], v23
  v_smfmac_f32_16x16x64_bf16 v[76:79], v[56:59], a[120:127], v23
  s_cbranch_vccz SL_m_13_ok3
  s_branch SL_m_13_x3
SL_m_123_ok3:
  v_smfmac_f32_16x16x64_bf16 v[64:67], v[60:63], a[144:151], v23
  v_max3_u32 v31, v52, v53, v54
  v_max_u32 v31, v31, v55
  v_cmp_eq_u32 vcc, -1, v31
  v_smfmac_f32_16x16x64_bf16 v[68:71], v[60:63], a[152:159], v23
  v_smfmac_f32_16x16x64_bf16 v[72:75], v[60:63], a[160:167], v23
  v_smfmac_f32_16x16x64_bf16 v[76:79], v[60:63], a[168:175], v23
  s_cbranch_vccz SL_m_12_ok1
  s_branch SL_m_12_x1
SL_m_0123_c0:
  v_max3_u32 v31, v48, v49, v50
  v_max_u32 v31, v31, v51
  v_cmp_eq_u32 vcc, -1, v31
  s_cbranch_vccz SL_m_0123_ok0
SL_m_0123_x0:
  s_mov_b64 exec, vcc
  buffer_load_dwordx4 v[48:51], v3, s[4:7], s41 offen offset:0 sc1
  s_mov_b64 exec, -1
SL_m_0123_c1:
  v_max3_u32 v31, v52, v53, v54
  v_max_u32 v31, v31, v55
  v_cmp_eq_u32 vcc, -1, v31
  s_cbranch_vccz SL_m_0123_ok1
SL_m_0123_x1:
  s_mov_b64 exec, vcc
  buffer_load_dwordx4 v[52:55], v3, s[4:7], s41 offen offset:1024 sc1
  s_mov_b64 exec, -1
SL_m_0123_c2:
  v_max3_u32 v31, v56, v57, v58
  v_max_u32 v31, v31, v59
  v_cmp_eq_u32 vcc, -1, v31
  s_cbranch_vccz SL_m_0123_ok2
SL_m_0123_x2:
  s_mov_b64 exec, vcc
  buffer_load_dwordx4 v[56:59], v3, s[4:7], s41 offen offset:2048 sc1
  s_mov_b64 exec, -1
SL_m_0123_c3:
  v_max3_u32 v31, v60, v61, v62
  v_max_u32 v31, v31, v63
  v_cmp_eq_u32 vcc, -1, v31
  s_cbranch_vccz SL_m_0123_ok3
SL_m_0123_x3:
  s_mov_b64 exec, vcc
  buffer_load_dwordx4 v[60:63], v3, s[4:7], s41 offen offset:3072 sc1
  s_mov_b64 exec, -1
  s_add_u32 s46, s46, 1
  s_cmp_ge_u32 s46, 131072
  s_cbranch_scc1 SL_rec_abort
  s_waitcnt vmcnt(4)
  s_branch SL_m_0123_c0
SL_m_0123_ok0:
  v_smfmac_f32_16x16x64_bf16 v[64:67], v[48:51], a[0:7], v23
  v_max3_u32 v31, v52, v53, v54
  v_max_u32 v31, v31, v55
  v_cmp_eq_u32 vcc, -1, v31
  v_smfmac_f32_16x16x64_bf16 v[68:71], v[48:51], a[8:15], v23
  v_smfmac_f32_16x16x64_bf16 v[72:75], v[48:51], a[16:23], v23
  v_smfmac_f32_16x16x64_bf16 v[76:79], v[48:51], a[24:31], v23
  s_cbranch_vccz SL_m_123_ok1
  s_branch SL_m_123_x1
SL_m_0123_ok1:
  v_smfmac_f32_16x16x64_bf16 v[64:67], v[52:55], a[48:55], v23
  v_max3_u32 v31, v56, v57, v58
  v_max_u32 v31, v31, v59
  v_cmp_eq_u32 vcc, -1, v31
  v_smfmac_f32_16x16x64_bf16 v[68:71], v[52:55], a[56:63], v23
  v_smfmac_f32_16x16x64_bf16 v[72:75], v[52:55], a[64:71], v23
  v_smfmac_f32_16x16x64_bf16 v[76:79], v[52:55], a[72:79], v23
  s_cbranch_vccz SL_m_023_ok2
  s_branch SL_m_023_x2
SL_m_0123_ok2:
  v_smfmac_f32_16x16x64_bf16 v[64:67], v[56:59], a[96:103], v23
  v_max3_u32 v31, v60, v61, v62
  v_max_u32 v31, v31, v63
  v_cmp_eq_u32 vcc, -1, v31
  v_smfmac_f32_16x16x64_bf16 v[68:71], v[56:59], a[104:111], v23
  v_smfmac_f32_16x16x64_bf16 v[72:75], v[56:59], a[112:119], v23
  v_smfmac_f32_16x16x64_bf16 v[76:79], v[56:59], a[120:127], v23
  s_cbranch_vccz SL_m_013_ok3
  s_branch SL_m_013_x3
SL_m_0123_ok3:
  v_smfmac_f32_16x16x64_bf16 v[64:67], v[60:63], a[144:151], v23
  v_max3_u32 v31, v48, v49, v50
  v_max_u32 v31, v31, v51
  v_cmp_eq_u32 vcc, -1, v31
  v_smfmac_f32_16x16x64_bf16 v[68:71], v[60:63], a[152:159], v23
  v_smfmac_f32_16x16x64_bf16 v[72:75], v[60:63], a[160:167], v23
  v_smfmac_f32_16x16x64_bf16 v[76:79], v[60:63], a[168:175], v23
  s_cbranch_vccz SL_m_012_ok0
  s_branch SL_m_012_x0
SL_x_f0:
  s_mov_b64 exec, vcc
  buffer_load_dwordx4 v[64:67], v9, s[4:7], s41 offen offset:0 sc1
  s_mov_b64 exec, -1
  s_waitcnt vmcnt(2)
  s_branch SL_x_0123_c1
SL_x_f1:
  s_mov_b64 exec, vcc
  buffer_load_dwordx4 v[68:71], v9, s[4:7], s41 offen offset:1024 sc1
  s_mov_b64 exec, -1
  s_waitcnt vmcnt(2)
  s_branch SL_x_123_c2
SL_x_f2:
  s_mov_b64 exec, vcc
  buffer_load_dwordx4 v[72:75], v9, s[4:7], s41 offen offset:2048 sc1
  s_mov_b64 exec, -1
  s_waitcnt vmcnt(2)
  s_branch SL_x_23_c3
SL_x_f3:
  s_mov_b64 exec, vcc
  buffer_load_dwordx4 v[76:79], v9, s[4:7], s41 offen offset:3072 sc1
  s_mov_b64 exec, -1
  s_nop 7
  s_branch SL_x_3_c3
SL_x_0_c0:
  v_max3_u32 v31, v64, v65, v66
  v_max_u32 v31, v31, v67
  v_cmp_eq_u32 vcc, -1, v31
  s_cbranch_vccz SL_x_0_ok0
SL_x_0_x0:
  s_mov_b64 exec, vcc
  buffer_load_dwordx4 v[64:67], v9, s[4:7], s41 offen offset:0 sc1
  s_mov_b64 exec, -1
  s_add_u32 s46, s46, 1
  s_cmp_ge_u32 s46, 131072
  s_cbranch_scc1 SL_rec_abort
  s_waitcnt vmcnt(2)
  s_branch SL_x_0_c0
SL_x_0_ok0:
  v_mfma_f32_16x16x32_bf16 v[44:47], v[64:67], v[64:67], v[44:47]
  v_mfma_f32_16x16x32_bf16 v[36:39], v[116:119], v[64:67], v[36:39]
  v_mfma_f32_16x16x32_bf16 v[40:43], v[132:135], v[64:67], v[40:43]
  s_branch SL_x_done
SL_x_1_c1:
  v_max3_u32 v31, v68, v69, v70
  v_max_u32 v31, v31, v71
  v_cmp_eq_u32 vcc, -1, v31
  s_cbranch_vccz SL_x_1_ok1
SL_x_1_x1:
  s_mov_b64 exec, vcc
  buffer_load_dwordx4 v[68:71], v9, s[4:7], s41 offen offset:1024 sc1
  s_mov_b64 exec, -1
  s_add_u32 s46, s46, 1
  s_cmp_ge_u32 s46, 131072
  s_cbranch_scc1 SL_rec_abort
  s_waitcnt vmcnt(2)
  s_branch SL_x_1_c1
SL_x_1_ok1:
  v_mfma_f32_16x16x32_bf16 v[44:47], v[68:71], v[68:71], v[44:47]
  v_mfma_f32_16x16x32_bf16 v[36:39], v[120:123], v[68:71], v[36:39]
  v_mfma_f32_16x16x32_bf16 v[40:43], v[136:139], v[68:71], v[40:43]
  s_branch SL_x_done
SL_x_2_c2:
  v_max3_u32 v31, v72, v73, v74
  v_max_u32 v31, v31, v75
  v_cmp_eq_u32 vcc, -1, v31
  s_cbranch_vccz SL_x_2_ok2
SL_x_2_x2:
  s_mov_b64 exec, vcc
  buffer_load_dwordx4 v[72:75], v9, s[4:7], s41 offen offset:2048 sc1
  s_mov_b64 exec, -1
  s_add_u32 s46, s46, 1
  s_cmp_ge_u32 s46, 131072
  s_cbranch_scc1 SL_rec_abort
  s_waitcnt vmcnt(2)
  s_branch SL_x_2_c2
SL_x_2_ok2:
  v_mfma_f32_16x16x32_bf16 v[44:47], v[72:75], v[72:75], v[44:47]
  v_mfma_f32_16x16x32_bf16 v[36:39], v[124:127], v[72:75], v[36:39]
  v_mfma_f32_16x16x32_bf16 v[40:43], v[140:143], v[72:75], v[40:43]
  s_branch SL_x_done
SL_x_3_c3:
  v_max3_u32 v31, v76, v77, v78
  v_max_u32 v31, v31, v79
  v_cmp_eq_u32 vcc, -1, v31
  s_cbranch_vccz SL_x_3_ok3
SL_x_3_x3:
  s_mov_b64 exec, vcc
  buffer_load_dwordx4 v[76:79], v9, s[4:7], s41 offen offset:3072 sc1
  s_mov_b64 exec, -1
  s_add_u32 s46, s46, 1
  s_cmp_ge_u32 s46, 131072
  s_cbranch_scc1 SL_rec_abort
  s_waitcnt vmcnt(2)
  s_branch SL_x_3_c3
SL_x_3_ok3:
  v_mfma_f32_16x16x32_bf16 v[44:47], v[76:79], v[76:79], v[44:47]
  v_mfma_f32_16x16x32_bf16 v[36:39], v[128:131], v[76:79], v[36:39]
  v_mfma_f32_16x16x32_bf16 v[40:43], v[144:147], v[76:79], v[40:43]
  s_branch SL_x_done
SL_x_01_c0:
  v_max3_u32 v31, v64, v65, v66
  v_max_u32 v31, v31, v67
  v_cmp_eq_u32 vcc, -1, v31
  s_cbranch_vccz SL_x_01_ok0
SL_x_01_x0:
  s_mov_b64 exec, vcc
  buffer_load_dwordx4 v[64:67], v9, s[4:7], s41 offen offset:0 sc1
  s_mov_b64 exec, -1
SL_x_01_c1:
  v_max3_u32 v31, v68, v69, v70
  v_max_u32 v31, v31, v71
  v_cmp_eq_u32 vcc, -1, v31
  s_cbranch_vccz SL_x_01_ok1
SL_x_01_x1:
  s_mov_b64 exec, vcc
  buffer_load_dwordx4 v[68:71], v9, s[4:7], s41 offen offset:1024 sc1
  s_mov_b64 exec, -1
  s_add_u32 s46, s46, 1
  s_cmp_ge_u32 s46, 131072
  s_cbranch_scc1 SL_rec_abort
  s_waitcnt vmcnt(4)
  s_branch SL_x_01_c0
SL_x_01_ok0:
  v_mfma_f32_16x16x32_bf16 v[44:47], v[64:67], v[64:67], v[44:47]
  v_max3_u32 v31, v68, v69, v70
  v_max_u32 v31, v31, v71
  v_cmp_eq_u32 vcc, -1, v31
  v_mfma_f32_16x16x32_bf16 v[36:39], v[116:119], v[64:67], v[36:39]
  v_mfma_f32_16x16x32_bf16 v[40:43], v[132:135], v[64:67], v[40:43]
  s_cbranch_vccz SL_x_1_ok1
  s_branch SL_x_1_x1
SL_x_01_ok1:
  v_mfma_f32_16x16x32_bf16 v[44:47], v[68:71], v[68:71], v[44:47]
  v_max3_u32 v31, v64, v65, v66
  v_max_u32 v31, v31, v67
  v_cmp_eq_u32 vcc, -1, v31
  v_mfma_f32_16x16x32_bf16 v[36:39], v[120:123], v[68:71], v[36:39]
  v_mfma_f32_16x16x32_bf16 v[40:43], v[136:139], v[68:71], v[40:43]
  s_cbranch_vccz SL_x_0_ok0
  s_branch SL_x_0_x0
SL_x_02_c0:
  v_max3_u32 v31, v64, v65, v66
  v_max_u32 v31, v31, v67
  v_cmp_eq_u32 vcc, -1, v31
  s_cbranch_vccz SL_x_02_ok0
SL_x_02_x0:
  s_mov_b64 exec, vcc
  buffer_load_dwordx4 v[64:67], v9, s[4:7], s41 offen offset:0 sc1
  s_mov_b64 exec, -1
SL_x_02_c2:
  v_max3_u32 v31, v72, v73, v74
  v_max_u32 v31, v31, v75
  v_cmp_eq_u32 vcc, -1, v31
  s_cbranch_vccz SL_x_02_ok2
SL_x_02_x2:
  s_mov_b64 exec, vcc
  buffer_load_dwordx4 v[72:75], v9, s[4:7], s41 offen offset:2048 sc1
  s_mov_b64 exec, -1
  s_add_u32 s46, s46, 1
  s_cmp_ge_u32 s46, 131072
  s_cbranch_scc1 SL_rec_abort
  s_waitcnt vmcnt(4)
  s_branch SL_x_02_c0
SL_x_02_ok0:
  v_mfma_f32_16x16x32_bf16 v[44:47], v[64:67], v[64:67], v[44:47]
  v_max3_u32 v31, v72, v73, v74
  v_max_u32 v31, v31, v75
  v_cmp_eq_u32 vcc, -1, v31
  v_mfma_f32_16x16x32_bf16 v[36:39], v[116:119], v[64:67], v[36:39]
  v_mfma_f32_16x16x32_bf16 v[40:43], v[132:135], v[64:67], v[40:43]
  s_cbranch_vccz SL_x_2_ok2
  s_branch SL_x_2_x2
SL_x_02_ok2:
  v_mfma_f32_16x16x32_bf16 v[44:47], v[72:75], v[72:75], v[44:47]
  v_max3_u32 v31, v64, v65, v66
  v_max_u32 v31, v31, v67
  v_cmp_eq_u32 vcc, -1, v31
  v_mfma_f32_16x16x32_bf16 v[36:39], v[124:127], v[72:75], v[36:39]
  v_mfma_f32_16x16x32_bf16 v[40:43], v[140:143], v[72:75], v[40:43]
  s_cbranch_vccz SL_x_0_ok0
  s_branch SL_x_0_x0
SL_x_03_c0:
  v_max3_u32 v31, v64, v65, v66
  v_max_u32 v31, v31, v67
  v_cmp_eq_u32 vcc, -1, v31
  s_cbranch_vccz SL_x_03_ok0
SL_x_03_x0:
  s_mov_b64 exec, vcc
  buffer_load_dwordx4 v[64:67], v9, s[4:7], s41 offen offset:0 sc1
  s_mov_b64 exec, -1
SL_x_03_c3:
  v_max3_u32 v31, v76, v77, v78
  v_max_u32 v31, v31, v79
  v_cmp_eq_u32 vcc, -1, v31
  s_cbranch_vccz SL_x_03_ok3
SL_x_03_x3:
  s_mov_b64 exec, vcc
  buffer_load_dwordx4 v[76:79], v9, s[4:7], s41 offen offset:3072 sc1
  s_mov_b64 exec, -1
  s_add_u32 s46, s46, 1
  s_cmp_ge_u32 s46, 131072
  s_cbranch_scc1 SL_rec_abort
  s_waitcnt vmcnt(4)
  s_branch SL_x_03_c0
SL_x_03_ok0:
  v_mfma_f32_16x16x32_bf16 v[44:47], v[64:67], v[64:67], v[44:47]
  v_max3_u32 v31, v76, v77, v78
  v_max_u32 v31, v31, v79
  v_cmp_eq_u32 vcc, -1, v31
  v_mfma_f32_16x16x32_bf16 v[36:39], v[116:119], v[64:67], v[36:39]
  v_mfma_f32_16x16x32_bf16 v[40:43], v[132:135], v[64:67], v[40:43]
  s_cbranch_vccz SL_x_3_ok3
  s_branch SL_x_3_x3
SL_x_03_ok3:
  v_mfma_f32_16x16x32_bf16 v[44:47], v[76:79], v[76:79], v[44:47]
  v_max3_u32 v31, v64, v65, v66
  v_max_u32 v31, v31, v67
  v_cmp_eq_u32 vcc, -1, v31
  v_mfma_f32_16x16x32_bf16 v[36:39], v[128:131], v[76:79], v[36:39]
  v_mfma_f32_16x16x32_bf16 v[40:43], v[144:147], v[76:79], v[40:43]
  s_cbranch_vccz SL_x_0_ok0
  s_branch SL_x_0_x0
SL_x_12_c1:
  v_max3_u32 v31, v68, v69, v70
  v_max_u32 v31, v31, v71
  v_cmp_eq_u32 vcc, -1, v31
  s_cbranch_vccz SL_x_12_ok1
SL_x_12_x1:
  s_mov_b64 exec, vcc
  buffer_load_dwordx4 v[68:71], v9, s[4:7], s41 offen offset:1024 sc1
  s_mov_b64 exec, -1
SL_x_12_c2:
  v_max3_u32 v31, v72, v73, v74
  v_max_u32 v31, v31, v75
  v_cmp_eq_u32 vcc, -1, v31
  s_cbranch_vccz SL_x_12_ok2
SL_x_12_x2:
  s_mov_b64 exec, vcc
  buffer_load_dwordx4 v[72:75], v9, s[4:7], s41 offen offset:2048 sc1
  s_mov_b64 exec, -1
  s_add_u32 s46, s46, 1
  s_cmp_ge_u32 s46, 131072
  s_cbranch_scc1 SL_rec_abort
  s_waitcnt vmcnt(4)
  s_branch SL_x_12_c1
SL_x_12_ok1:
  v_mfma_f32_16x16x32_bf16 v[44:47], v[68:71], v[68:71], v[44:47]
  v_max3_u32 v31, v72, v73, v74
  v_max_u32 v31, v31, v75
  v_cmp_eq_u32 vcc, -1, v31
  v_mfma_f32_16x16x32_bf16 v[36:39], v[120:123], v[68:71], v[36:39]
  v_mfma_f32_16x16x32_bf16 v[40:43], v[136:139], v[68:71], v[40:43]
  s_cbranch_vccz SL_x_2_ok2
  s_branch SL_x_2_x2
SL_x_12_ok2:
  v_mfma_f32_16x16x32_bf16 v[44:47], v[72:75], v[72:75], v[44:47]
  v_max3_u32 v31, v68, v69, v70
  v_max_u32 v31, v31, v71
  v_cmp_eq_u32 vcc, -1, v31
  v_mfma_f32_16x16x32_bf16 v[36:39], v[124:127], v[72:75], v[36:39]
  v_mfma_f32_16x16x32_bf16 v[40:43], v[140:143], v[72:75], v[40:43]
  s_cbranch_vccz SL_x_1_ok1
  s_branch SL_x_1_x1
SL_x_13_c1:
  v_max3_u32 v31, v68, v69, v70
  v_max_u32 v31, v31, v71
  v_cmp_eq_u32 vcc, -1, v31
  s_cbranch_vccz SL_x_13_ok1
SL_x_13_x1:
  s_mov_b64 exec, vcc
  buffer_load_dwordx4 v[68:71], v9, s[4:7], s41 offen offset:1024 sc1
  s_mov_b64 exec, -1
SL_x_13_c3:
  v_max3_u32 v31, v76, v77, v78
  v_max_u32 v31, v31, v79
  v_cmp_eq_u32 vcc, -1, v31
  s_cbranch_vccz SL_x_13_ok3
SL_x_13_x3:
  s_mov_b64 exec, vcc
  buffer_load_dwordx4 v[76:79], v9, s[4:7], s41 offen offset:3072 sc1
  s_mov_b64 exec, -1
  s_add_u32 s46, s46, 1
  s_cmp_ge_u32 s46, 131072
  s_cbranch_scc1 SL_rec_abort
  s_waitcnt vmcnt(4)
  s_branch SL_x_13_c1
SL_x_13_ok1:
  v_mfma_f32_16x16x32_bf16 v[44:47], v[68:71], v[68:71], v[44:47]
  v_max3_u32 v31, v76, v77, v78
  v_max_u32 v31, v31, v79
  v_cmp_eq_u32 vcc, -1, v31
  v_mfma_f32_16x16x32_bf16 v[36:39], v[120:123], v[68:71], v[36:39]
  v_mfma_f32_16x16x32_bf16 v[40:43], v[136:139], v[68:71], v[40:43]
  s_cbranch_vccz SL_x_3_ok3
  s_branch SL_x_3_x3
SL_x_13_ok3:
  v_mfma_f32_16x16x32_bf16 v[44:47], v[76:79], v[76:79], v[44:47]
  v_max3_u32 v31, v68, v69, v70
  v_max_u32 v31, v31, v71
  v_cmp_eq_u32 vcc, -1, v31
  v_mfma_f32_16x16x32_bf16 v[36:39], v[128:131], v[76:79], v[36:39]
  v_mfma_f32_16x16x32_bf16 v[40:43], v[144:147], v[76:79], v[40:43]
  s_cbranch_vccz SL_x_1_ok1
  s_branch SL_x_1_x1
SL_x_23_c2:
  v_max3_u32 v31, v72, v73, v74
  v_max_u32 v31, v31, v75
  v_cmp_eq_u32 vcc, -1, v31
  s_cbranch_vccz SL_x_23_ok2
SL_x_23_x2:
  s_mov_b64 exec, vcc
  buffer_load_dwordx4 v[72:75], v9, s[4:7], s41 offen offset:2048 sc1
  s_mov_b64 exec, -1
SL_x_23_c3:
  v_max3_u32 v31, v76, v77, v78
  v_max_u32 v31, v31, v79
  v_cmp_eq_u32 vcc, -1, v31
  s_cbranch_vccz SL_x_23_ok3
SL_x_23_x3:
  s_mov_b64 exec, vcc
  buffer_load_dwordx4 v[76:79], v9, s[4:7], s41 offen offset:3072 sc1
  s_mov_b64 exec, -1
  s_add_u32 s46, s46, 1
  s_cmp_ge_u32 s46, 131072
  s_cbranch_scc1 SL_rec_abort
  s_waitcnt vmcnt(4)
  s_branch SL_x_23_c2
SL_x_23_ok2:
  v_mfma_f32_16x16x32_bf16 v[44:47], v[72:75], v[72:75], v[44:47]
  v_max3_u32 v31, v76, v77, v78
  v_max_u32 v31, v31, v79
  v_cmp_eq_u32 vcc, -1, v31
  v_mfma_f32_16x16x32_bf16 v[36:39], v[124:127], v[72:75], v[36:39]
  v_mfma_f32_16x16x32_bf16 v[40:43], v[140:143], v[72:75], v[40:43]
  s_cbranch_vccz SL_x_3_ok3
  s_branch SL_x_3_x3
SL_x_23_ok3:
  v_mfma_f32_16x16x32_bf16 v[44:47], v[76:79], v[76:79], v[44:47]
  v_max3_u32 v31, v72, v73, v74
  v_max_u32 v31, v31, v75
  v_cmp_eq_u32 vcc, -1, v31
  v_mfma_f32_16x16x32_bf16 v[36:39], v[128:131], v[76:79], v[36:39]
  v_mfma_f32_16x16x32_bf16 v[40:43], v[144:147], v[76:79], v[40:43]
  s_cbranch_vccz SL_x_2_ok2
  s_branch SL_x_2_x2
SL_x_012_c0:
  v_max3_u32 v31, v64, v65, v66
  v_max_u32 v31, v31, v67
  v_cmp_eq_u32 vcc, -1, v31
  s_cbranch_vccz SL_x_012_ok0
SL_x_012_x0:
  s_mov_b64 exec, vcc
  buffer_load_dwordx4 v[64:67], v9, s[4:7], s41 offen offset:0 sc1
  s_mov_b64 exec, -1
SL_x_012_c1:
  v_max3_u32 v31, v68, v69, v70
  v_max_u32 v31, v31, v71
  v_cmp_eq_u32 vcc, -1, v31
  s_cbranch_vccz SL_x_012_ok1
SL_x_012_x1:
  s_mov_b64 exec, vcc
  buffer_load_dwordx4 v[68:71], v9, s[4:7], s41 offen offset:1024 sc1
  s_mov_b64 exec, -1
SL_x_012_c2:
  v_max3_u32 v31, v72, v73, v74
  v_max_u32 v31, v31, v75
  v_cmp_eq_u32 vcc, -1, v31
  s_cbranch_vccz SL_x_012_ok2
SL_x_012_x2:
  s_mov_b64 exec, vcc
  buffer_load_dwordx4 v[72:75], v9, s[4:7], s41 offen offset:2048 sc1
  s_mov_b64 exec, -1
  s_add_u32 s46, s46, 1
  s_cmp_ge_u32 s46, 131072
  s_cbranch_scc1 SL_rec_abort
  s_waitcnt vmcnt(4)
  s_branch SL_x_012_c0
SL_x_012_ok0:
  v_mfma_f32_16x16x32_bf16 v[44:47], v[64:67], v[64:67], v[44:47]
  v_max3_u32 v31, v68, v69, v70
  v_max_u32 v31, v31, v71
  v_cmp_eq_u32 vcc, -1, v31
  v_mfma_f32_16x16x32_bf16 v[36:39], v[116:119], v[64:67], v[36:39]
  v_mfma_f32_16x16x32_bf16 v[40:43], v[132:135], v[64:67], v[40:43]
  s_cbranch_vccz SL_x_12_ok1
  s_branch SL_x_12_x1
SL_x_012_ok1:
  v_mfma_f32_16x16x32_bf16 v[44:47], v[68:71], v[68:71], v[44:47]
  v_max3_u32 v31, v72, v73, v74
  v_max_u32 v31, v31, v75
  v_cmp_eq_u32 vcc, -1, v31
  v_mfma_f32_16x16x32_bf16 v[36:39], v[120:123], v[68:71], v[36:39]
  v_mfma_f32_16x16x32_bf16 v[40:43], v[136:139], v[68:71], v[40:43]
  s_cbranch_vccz SL_x_02_ok2
  s_branch SL_x_02_x2
SL_x_012_ok2:
  v_mfma_f32_16x16x32_bf16 v[44:47], v[72:75], v[72:75], v[44:47]
  v_max3_u32 v31, v64, v65, v66
  v_max_u32 v31, v31, v67
  v_cmp_eq_u32 vcc, -1, v31
  v_mfma_f32_16x16x32_bf16 v[36:39], v[124:127], v[72:75], v[36:39]
  v_mfma_f32_16x16x32_bf16 v[40:43], v[140:143], v[72:75], v[40:43]
  s_cbranch_vccz SL_x_01_ok0
  s_branch SL_x_01_x0
SL_x_013_c0:
  v_max3_u32 v31, v64, v65, v66
  v_max_u32 v31, v31, v67
  v_cmp_eq_u32 vcc, -1, v31
  s_cbranch_vccz SL_x_013_ok0
SL_x_013_x0:
  s_mov_b64 exec, vcc
  buffer_load_dwordx4 v[64:67], v9, s[4:7], s41 offen offset:0 sc1
  s_mov_b64 exec, -1
SL_x_013_c1:
  v_max3_u32 v31, v68, v69, v70
  v_max_u32 v31, v31, v71
  v_cmp_eq_u32 vcc, -1, v31
  s_cbranch_vccz SL_x_013_ok1
SL_x_013_x1:
  s_mov_b64 exec, vcc
  buffer_load_dwordx4 v[68:71], v9, s[4:7], s41 offen offset:1024 sc1
  s_mov_b64 exec, -1
SL_x_013_c3:
  v_max3_u32 v31, v76, v77, v78
  v_max_u32 v31, v31, v79
  v_cmp_eq_u32 vcc, -1, v31
  s_cbranch_vccz SL_x_013_ok3
SL_x_013_x3:
  s_mov_b64 exec, vcc
  buffer_load_dwordx4 v[76:79], v9, s[4:7], s41 offen offset:3072 sc1
  s_mov_b64 exec, -1
  s_add_u32 s46, s46, 1
  s_cmp_ge_u32 s46, 131072
  s_cbranch_scc1 SL_rec_abort
  s_waitcnt vmcnt(4)
  s_branch SL_x_013_c0
SL_x_013_ok0:
  v_mfma_f32_16x16x32_bf16 v[44:47], v[64:67], v[64:67], v[44:47]
  v_max3_u32 v31, v68, v69, v70
  v_max_u32 v31, v31, v71
  v_cmp_eq_u32 vcc, -1, v31
  v_mfma_f32_16x16x32_bf16 v[36:39], v[116:119], v[64:67], v[36:39]
  v_mfma_f32_16x16x32_bf16 v[40:43], v[132:135], v[64:67], v[40:43]
  s_cbranch_vccz SL_x_13_ok1
  s_branch SL_x_13_x1
SL_x_013_ok1:
  v_mfma_f32_16x16x32_bf16 v[44:47], v[68:71], v[68:71], v[44:47]
  v_max3_u32 v31, v76, v77, v78
  v_max_u32 v31, v31, v79
  v_cmp_eq_u32 vcc, -1, v31
  v_mfma_f32_16x16x32_bf16 v[36:39], v[120:123], v[68:71], v[36:39]
  v_mfma_f32_16x16x32_bf16 v[40:43], v[136:139], v[68:71], v[40:43]
  s_cbranch_vccz SL_x_03_ok3
  s_branch SL_x_03_x3
SL_x_013_ok3:
  v_mfma_f32_16x16x32_bf16 v[44:47], v[76:79], v[76:79], v[44:47]
  v_max3_u32 v31, v64, v65, v66
  v_max_u32 v31, v31, v67
  v_cmp_eq_u32 vcc, -1, v31
  v_mfma_f32_16x16x32_bf16 v[36:39], v[128:131], v[76:79], v[36:39]
  v_mfma_f32_16x16x32_bf16 v[40:43], v[144:147], v[76:79], v[40:43]
  s_cbranch_vccz SL_x_01_ok0
  s_branch SL_x_01_x0
SL_x_023_c0:
  v_max3_u32 v31, v64, v65, v66
  v_max_u32 v31, v31, v67
  v_cmp_eq_u32 vcc, -1, v31
  s_cbranch_vccz SL_x_023_ok0
SL_x_023_x0:
  s_mov_b64 exec, vcc
  buffer_load_dwordx4 v[64:67], v9, s[4:7], s41 offen offset:0 sc1
  s_mov_b64 exec, -1
SL_x_023_c2:
  v_max3_u32 v31, v72, v73, v74
  v_max_u32 v31, v31, v75
  v_cmp_eq_u32 vcc, -1, v31
  s_cbranch_vccz SL_x_023_ok2
SL_x_023_x2:
  s_mov_b64 exec, vcc
  buffer_load_dwordx4 v[72:75], v9, s[4:7], s41 offen offset:2048 sc1
  s_mov_b64 exec, -1
SL_x_023_c3:
  v_max3_u32 v31, v76, v77, v78
  v_max_u32 v31, v31, v79
  v_cmp_eq_u32 vcc, -1, v31
  s_cbranch_vccz SL_x_023_ok3
SL_x_023_x3:
  s_mov_b64 exec, vcc
  buffer_load_dwordx4 v[76:79], v9, s[4:7], s41 offen offset:3072 sc1
  s_mov_b64 exec, -1
  s_add_u32 s46, s46, 1
  s_cmp_ge_u32 s46, 131072
  s_cbranch_scc1 SL_rec_abort
  s_waitcnt vmcnt(4)
  s_branch SL_x_023_c0
SL_x_023_ok0:
  v_mfma_f32_16x16x32_bf16 v[44:47], v[64:67], v[64:67], v[44:47]
  v_max3_u32 v31, v72, v73, v74
  v_max_u32 v31, v31, v75
  v_cmp_eq_u32 vcc, -1, v31
  v_mfma_f32_16x16x32_bf16 v[36:39], v[116:119], v[64:67], v[36:39]
  v_mfma_f32_16x16x32_bf16 v[40:43], v[132:135], v[64:67], v[40:43]
  s_cbranch_vccz SL_x_23_ok2
  s_branch SL_x_23_x2
SL_x_023_ok2:
  v_mfma_f32_16x16x32_bf16 v[44:47], v[72:75], v[72:75], v[44:47]
  v_max3_u32 v31, v76, v77, v78
  v_max_u32 v31, v31, v79
  v_cmp_eq_u32 vcc, -1, v31
  v_mfma_f32_16x16x32_bf16 v[36:39], v[124:127], v[72:75], v[36:39]
  v_mfma_f32_16x16x32_bf16 v[40:43], v[140:143], v[72:75], v[40:43]
  s_cbranch_vccz SL_x_03_ok3
  s_branch SL_x_03_x3
SL_x_023_ok3:
  v_mfma_f32_16x16x32_bf16 v[44:47], v[76:79], v[76:79], v[44:47]
  v_max3_u32 v31, v64, v65, v66
  v_max_u32 v31, v31, v67
  v_cmp_eq_u32 vcc, -1, v31
  v_mfma_f32_16x16x32_bf16 v[36:39], v[128:131], v[76:79], v[36:39]
  v_mfma_f32_16x16x32_bf16 v[40:43], v[144:147], v[76:79], v[40:43]
  s_cbranch_vccz SL_x_02_ok0
  s_branch SL_x_02_x0
SL_x_123_c1:
  v_max3_u32 v31, v68, v69, v70
  v_max_u32 v31, v31, v71
  v_cmp_eq_u32 vcc, -1, v31
  s_cbranch_vccz SL_x_123_ok1
SL_x_123_x1:
  s_mov_b64 exec, vcc
  buffer_load_dwordx4 v[68:71], v9, s[4:7], s41 offen offset:1024 sc1
  s_mov_b64 exec, -1
SL_x_123_c2:
  v_max3_u32 v31, v72, v73, v74
  v_max_u32 v31, v31, v75
  v_cmp_eq_u32 vcc, -1, v31
  s_cbranch_vccz SL_x_123_ok2
SL_x_123_x2:
  s_mov_b64 exec, vcc
  buffer_load_dwordx4 v[72:75], v9, s[4:7], s41 offen offset:2048 sc1
  s_mov_b64 exec, -1
SL_x_123_c3:
  v_max3_u32 v31, v76, v77, v78
  v_max_u32 v31, v31, v79
  v_cmp_eq_u32 vcc, -1, v31
  s_cbranch_vccz SL_x_123_ok3
SL_x_123_x3:
  s_mov_b64 exec, vcc
  buffer_load_dwordx4 v[76:79], v9, s[4:7], s41 offen offset:3072 sc1
  s_mov_b64 exec, -1
  s_add_u32 s46, s46, 1
  s_cmp_ge_u32 s46, 131072
  s_cbranch_scc1 SL_rec_abort
  s_waitcnt vmcnt(4)
  s_branch SL_x_123_c1
SL_x_123_ok1:
  v_mfma_f32_16x16x32_bf16 v[44:47], v[68:71], v[68:71], v[44:47]
  v_max3_u32 v31, v72, v73, v74
  v_max_u32 v31, v31, v75
  v_cmp_eq_u32 vcc, -1, v31
  v_mfma_f32_16x16x32_bf16 v[36:39], v[120:123], v[68:71], v[36:39]
  v_mfma_f32_16x16x32_bf16 v[40:43], v[136:139], v[68:71], v[40:43]
  s_cbranch_vccz SL_x_23_ok2
  s_branch SL_x_23_x2
SL_x_123_ok2:
  v_mfma_f32_16x16x32_bf16 v[44:47], v[72:75], v[72:75], v[44:47]
  v_max3_u32 v31, v76, v77, v78
  v_max_u32 v31, v31, v79
  v_cmp_eq_u32 vcc, -1, v31
  v_mfma_f32_16x16x32_bf16 v[36:39], v[124:127], v[72:75], v[36:39]
  v_mfma_f32_16x16x32_bf16 v[40:43], v[140:143], v[72:75], v[40:43]
  s_cbranch_vccz SL_x_13_ok3
  s_branch SL_x_13_x3
SL_x_123_ok3:
  v_mfma_f32_16x16x32_bf16 v[44:47], v[76:79], v[76:79], v[44:47]
  v_max3_u32 v31, v68, v69, v70
  v_max_u32 v31, v31, v71
  v_cmp_eq_u32 vcc, -1, v31
  v_mfma_f32_16x16x32_bf16 v[36:39], v[128:131], v[76:79], v[36:39]
  v_mfma_f32_16x16x32_bf16 v[40:43], v[144:147], v[76:79], v[40:43]
  s_cbranch_vccz SL_x_12_ok1
  s_branch SL_x_12_x1
SL_x_0123_c0:
  v_max3_u32 v31, v64, v65, v66
  v_max_u32 v31, v31, v67
  v_cmp_eq_u32 vcc, -1, v31
  s_cbranch_vccz SL_x_0123_ok0
SL_x_0123_x0:
  s_mov_b64 exec, vcc
  buffer_load_dwordx4 v[64:67], v9, s[4:7], s41 offen offset:0 sc1
  s_mov_b64 exec, -1
SL_x_0123_c1:
  v_max3_u32 v31, v68, v69, v70
  v_max_u32 v31, v31, v71
  v_cmp_eq_u32 vcc, -1, v31
  s_cbranch_vccz SL_x_0123_ok1
SL_x_0123_x1:
  s_mov_b64 exec, vcc
  buffer_load_dwordx4 v[68:71], v9, s[4:7], s41 offen offset:1024 sc1
  s_mov_b64 exec, -1
SL_x_0123_c2:
  v_max3_u32 v31, v72, v73, v74
  v_max_u32 v31, v31, v75
  v_cmp_eq_u32 vcc, -1, v31
  s_cbranch_vccz SL_x_0123_ok2
SL_x_0123_x2:
  s_mov_b64 exec, vcc
  buffer_load_dwordx4 v[72:75], v9, s[4:7], s41 offen offset:2048 sc1
  s_mov_b64 exec, -1
SL_x_0123_c3:
  v_max3_u32 v31, v76, v77, v78
  v_max_u32 v31, v31, v79
  v_cmp_eq_u32 vcc, -1, v31
  s_cbranch_vccz SL_x_0123_ok3
SL_x_0123_x3:
  s_mov_b64 exec, vcc
  buffer_load_dwordx4 v[76:79], v9, s[4:7], s41 offen offset:3072 sc1
  s_mov_b64 exec, -1
  s_add_u32 s46, s46, 1
  s_cmp_ge_u32 s46, 131072
  s_cbranch_scc1 SL_rec_abort
  s_waitcnt vmcnt(4)
  s_branch SL_x_0123_c0
SL_x_0123_ok0:
  v_mfma_f32_16x16x32_bf16 v[44:47], v[64:67], v[64:67], v[44:47]
  v_max3_u32 v31, v68, v69, v70
  v_max_u32 v31, v31, v71
  v_cmp_eq_u32 vcc, -1, v31
  v_mfma_f32_16x16x32_bf16 v[36:39], v[116:119], v[64:67], v[36:39]
  v_mfma_f32_16x16x32_bf16 v[40:43], v[132:135], v[64:67], v[40:43]
  s_cbranch_vccz SL_x_123_ok1
  s_branch SL_x_123_x1
SL_x_0123_ok1:
  v_mfma_f32_16x16x32_bf16 v[44:47], v[68:71], v[68:71], v[44:47]
  v_max3_u32 v31, v72, v73, v74
  v_max_u32 v31, v31, v75
  v_cmp_eq_u32 vcc, -1, v31
  v_mfma_f32_16x16x32_bf16 v[36:39], v[120:123], v[68:71], v[36:39]
  v_mfma_f32_16x16x32_bf16 v[40:43], v[136:139], v[68:71], v[40:43]
  s_cbranch_vccz SL_x_023_ok2
  s_branch SL_x_023_x2
SL_x_0123_ok2:
  v_mfma_f32_16x16x32_bf16 v[44:47], v[72:75], v[72:75], v[44:47]
  v_max3_u32 v31, v76, v77, v78
  v_max_u32 v31, v31, v79
  v_cmp_eq_u32 vcc, -1, v31
  v_mfma_f32_16x16x32_bf16 v[36:39], v[124:127], v[72:75], v[36:39]
  v_mfma_f32_16x16x32_bf16 v[40:43], v[140:143], v[72:75], v[40:43]
  s_cbranch_vccz SL_x_013_ok3
  s_branch SL_x_013_x3
SL_x_0123_ok3:
  v_mfma_f32_16x16x32_bf16 v[44:47], v[76:79], v[76:79], v[44:47]
  v_max3_u32 v31, v64, v65, v66
  v_max_u32 v31, v31, v67
  v_cmp_eq_u32 vcc, -1, v31
  v_mfma_f32_16x16x32_bf16 v[36:39], v[128:131], v[76:79], v[36:39]
  v_mfma_f32_16x16x32_bf16 v[40:43], v[144:147], v[76:79], v[40:43]
  s_cbranch_vccz SL_x_012_ok0
  s_branch SL_x_012_x0
SL_v_f:
  buffer_load_dwordx4 v[88:91], v10, s[4:7], s41 offen offset:0 sc1
  buffer_load_dwordx4 v[92:95], v10, s[4:7], s41 offen offset:1024 sc1
  s_add_u32 s46, s46, 1
  s_cmp_ge_u32 s46, 131072
  s_cbranch_scc1 SL_rec_abort
  s_waitcnt vmcnt(0)
  v_max3_u32 v31, v88, v89, v90
  v_max3_u32 v31, v31, v91, v92
  v_max3_u32 v31, v31, v93, v94
  v_max_u32 v31, v31, v95
  v_cmp_eq_u32 vcc, -1, v31
  s_cbranch_vccnz SL_v_f
  s_branch SL_v_ok
SL_rec_abort:
  s_waitcnt vmcnt(0)
  s_endpgm
L_join:
  s_load_dwordx16 s[64:79], s[0:1], 0
  s_mov_b32 s39, 1
  s_cmp_lg_u32 s32, 0
  s_cbranch_scc1 L_rq_1
  s_cmp_eq_u32 s39, 0
  s_cbranch_scc1 L_rq_1
  s_lshl_b32 s99, s33, 7
  s_add_u32 s99, s99, 0x3d00200
  v_mov_b32 v244, 1
  v_mov_b32 v245, 0
  s_mov_b64 exec, 1
  buffer_atomic_add v244, v245, s[4:7], s99 offen sc0 sc1
  s_mov_b64 exec, -1
L_rq_1:
  s_getpc_b64 s[86:87]
L_pc1:
  s_lshl_b32 s90, s34, 2
  s_add_u32 s90, s90, s32
  s_and_b32 s90, s90, 31
  s_lshl_b32 s90, s90, 12
  v_mbcnt_lo_u32_b32 v1, -1, 0
  v_mbcnt_hi_u32_b32 v1, -1, v1
  v_lshlrev_b32 v1, 6, v1
  v_add_u32 v1, s90, v1
  v_min_u32 v1, L_table-L_pc1, v1
  global_load_dword v199, v1, s[86:87]
  v_mbcnt_lo_u32_b32 v0, -1, 0
  v_mbcnt_hi_u32_b32 v0, -1, v0
  s_lshl_b32 s90, s32, 6
  v_add_u32 v0, s90, v0
  s_lshl_b32 s40, s33, 5
  s_add_u32 s40, s40, 128
  s_mov_b32 s39, 1
  s_barrier
  s_branch L_worker1
L_worker:
  s_mov_b32 s39, 0
L_worker1:
  s_load_dwordx4 s[80:83], s[0:1], 64
  s_load_dwordx2 s[84:85], s[0:1], 80
  s_sub_u32 s33, s40, 128
  s_lshr_b32 s33, s33, 5
  s_and_b32 s34, s40, 31
  s_getpc_b64 s[86:87]
L_pc:
  s_add_u32 s86, s86, L_table-L_pc
  s_addc_u32 s87, s87, 0
  s_waitcnt lgkmcnt(0)
  s_mov_b32 s16, s84
  s_and_b32 s17, s85, 0xffff
  s_mov_b32 s18, 0x800000
  s_mov_b32 s19, 0x20000
  s_mov_b32 s8, s64
  s_and_b32 s9, s65, 0xffff
  s_mov_b32 s10, 0x400000
  s_mov_b32 s11, 0x20000
  s_mov_b32 s12, s70
  s_and_b32 s13, s71, 0xffff
  s_mov_b32 s14, 0x800000
  s_mov_b32 s15, 0x20000
  v_mov_b32 v1, 0
  v_mov_b32 v2, 0
  v_mov_b32 v3, 0
  v_mov_b32 v4, 0
  v_mov_b32 v5, 0
  v_mov_b32 v6, 0
  v_mov_b32 v7, 0
  v_mov_b32 v8, 0
  v_mov_b32 v9, 0
  v_mov_b32 v10, 0
  v_mov_b32 v11, 0
  v_mov_b32 v12, 0
  v_mov_b32 v13, 0
  v_mov_b32 v14, 0
  v_mov_b32 v15, 0
  v_mov_b32 v16, 0
  v_mov_b32 v17, 0
  v_mov_b32 v172, 0
  v_mov_b32 v173, 0
  s_mov_b32 s59, 0
  s_cmp_eq_u32 s39, 0
  s_cbranch_scc1 L_have
  s_branch L_next1
L_next:
  s_cmp_lg_u32 s32, 0
  s_cbranch_scc1 L_rq_2
  s_cmp_eq_u32 s39, 0
  s_cbranch_scc1 L_rq_2
  s_lshl_b32 s99, s33, 7
  s_add_u32 s99, s99, 0x3d00200
  v_mov_b32 v244, 1
  v_mov_b32 v245, 0
  s_mov_b64 exec, 1
  buffer_atomic_add v244, v245, s[4:7], s99 offen sc0 sc1
  s_mov_b64 exec, -1
L_rq_2:
L_next1:
  s_waitcnt vmcnt(0)
L_got:
  s_cmp_lg_u32 s32, 0
  s_cbranch_scc1 L_nx1
  v_mov_b32 v245, 147456
  s_mov_b64 exec, 1
  ds_write_b32 v245, v244
  s_mov_b64 exec, -1
  s_waitcnt lgkmcnt(0)
L_nx1:
  s_barrier
  v_mov_b32 v245, 147456
  ds_read_b32 v246, v245
  s_waitcnt lgkmcnt(0)
  v_min_u32 v245, 270, v246
  v_lshlrev_b32 v245, 2, v245
  v_add_u32 v245, 147648, v245
  ds_read_b32 v245, v245
  v_readfirstlane_b32 s34, v246
  s_add_u32 s34, s34, 32
  s_waitcnt lgkmcnt(0)
  v_readfirstlane_b32 s91, v245
  s_branch L_have1
L_have:
  s_lshl_b32 s90, s34, 2
  s_load_dword s91, s[86:87], s90
  s_waitcnt lgkmcnt(0)
L_have1:
  s_mov_b32 s98, 1
  s_and_b32 s35, s91, 255
  s_lshr_b32 s36, s91, 8
  s_and_b32 s36, s36, 255
  s_lshr_b32 s37, s91, 16
  s_cmp_eq_u32 s35, 0
  s_cbranch_scc1 L_aqkv
  s_cmp_eq_u32 s35, 1
  s_cbranch_scc1 L_aqkv
  s_cmp_eq_u32 s35, 2
  s_cbranch_scc1 L_aqkv
  s_cmp_eq_u32 s35, 3
  s_cbranch_scc1 L_bqkv
  s_cmp_eq_u32 s35, 9
  s_cbranch_scc1 L_small
  s_cmp_eq_u32 s35, 10
  s_cbranch_scc1 L_small
  s_mov_b32 s58, 0
L_epi:
  s_mov_b32 s46, 0x40000000
  s_mov_b32 s47, 0x40000000
  s_mov_b32 s49, 0
  s_cmp_eq_u32 s58, 1
  s_cselect_b64 vcc, -1, 0
  s_cmp_eq_u32 s59, 0
  s_cbranch_scc1 L_epid
  s_cmp_lg_u32 s59, 1
  s_cbranch_scc1 L_e0
  s_lshr_b32 s90, s27, 1
  s_and_b32 s91, s27, 1
  v_mov_b32 v172, 0x0
  v_bfe_u32 v45, v1, 0, 6
  v_lshl_add_u32 v172, v45, 4, v172
  v_add_u32 v173, 4096, v172
  s_mul_i32 s92, s90, 4
  s_mul_i32 s92, s92, s61
  s_add_u32 s92, s92, s60
  s_mul_i32 s93, s91, 8192
  s_add_u32 s92, s92, s93
  v_accvgpr_read_b32 v52, a0
  v_accvgpr_read_b32 v53, a4
  v_accvgpr_read_b32 v54, a1
  v_accvgpr_read_b32 v55, a5
  v_accvgpr_read_b32 v56, a2
  v_accvgpr_read_b32 v57, a6
  v_accvgpr_read_b32 v58, a3
  v_accvgpr_read_b32 v59, a7
  v_cvt_pk_bf16_f32 v48, v52, v53
  v_cvt_pk_bf16_f32 v49, v54, v55
  v_cvt_pk_bf16_f32 v50, v56, v57
  v_cvt_pk_bf16_f32 v51, v58, v59
  buffer_store_dwordx4 v[48:51], v172, s[4:7], s92 offen offset:0 sc1
  v_accvgpr_read_b32 v64, a128
  v_accvgpr_read_b32 v65, a132
  v_accvgpr_read_b32 v66, a129
  v_accvgpr_read_b32 v67, a133
  v_accvgpr_read_b32 v68, a130
  v_accvgpr_read_b32 v69, a134
  v_accvgpr_read_b32 v70, a131
  v_accvgpr_read_b32 v71, a135
  v_cvt_pk_bf16_f32 v176, v64, v65
  v_cvt_pk_bf16_f32 v177, v66, v67
  v_cvt_pk_bf16_f32 v178, v68, v69
  v_cvt_pk_bf16_f32 v179, v70, v71
  v_accvgpr_read_b32 v76, a8
  v_accvgpr_read_b32 v77, a12
  v_accvgpr_read_b32 v78, a9
  v_accvgpr_read_b32 v79, a13
  v_accvgpr_read_b32 v80, a10
  v_accvgpr_read_b32 v81, a14
  v_accvgpr_read_b32 v82, a11
  v_accvgpr_read_b32 v83, a15
  v_cvt_pk_bf16_f32 v72, v76, v77
  v_cvt_pk_bf16_f32 v73, v78, v79
  v_cvt_pk_bf16_f32 v74, v80, v81
  v_cvt_pk_bf16_f32 v75, v82, v83
  buffer_store_dwordx4 v[72:75], v172, s[4:7], s92 offen offset:1024 sc1
  v_accvgpr_read_b32 v88, a136
  v_accvgpr_read_b32 v89, a140
  v_accvgpr_read_b32 v90, a137
  v_accvgpr_read_b32 v91, a141
  v_accvgpr_read_b32 v92, a138
  v_accvgpr_read_b32 v93, a142
  v_accvgpr_read_b32 v94, a139
  v_accvgpr_read_b32 v95, a143
  v_cvt_pk_bf16_f32 v180, v88, v89
  v_cvt_pk_bf16_f32 v181, v90, v91
  v_cvt_pk_bf16_f32 v182, v92, v93
  v_cvt_pk_bf16_f32 v183, v94, v95
  v_accvgpr_read_b32 v52, a16
  v_accvgpr_read_b32 v53, a20
  v_accvgpr_read_b32 v54, a17
  v_accvgpr_read_b32 v55, a21
  v_accvgpr_read_b32 v56, a18
  v_accvgpr_read_b32 v57, a22
  v_accvgpr_read_b32 v58, a19
  v_accvgpr_read_b32 v59, a23
  v_cvt_pk_bf16_f32 v48, v52, v53
  v_cvt_pk_bf16_f32 v49, v54, v55
  v_cvt_pk_bf16_f32 v50, v56, v57
  v_cvt_pk_bf16_f32 v51, v58, v59
  buffer_store_dwordx4 v[48:51], v172, s[4:7], s92 offen offset:2048 sc1
  v_accvgpr_read_b32 v64, a144
  v_accvgpr_read_b32 v65, a148
  v_accvgpr_read_b32 v66, a145
  v_accvgpr_read_b32 v67, a149
  v_accvgpr_read_b32 v68, a146
  v_accvgpr_read_b32 v69, a150
  v_accvgpr_read_b32 v70, a147
  v_accvgpr_read_b32 v71, a151
  v_cvt_pk_bf16_f32 v184, v64, v65
  v_cvt_pk_bf16_f32 v185, v66, v67
  v_cvt_pk_bf16_f32 v186, v68, v69
  v_cvt_pk_bf16_f32 v187, v70, v71
  v_accvgpr_read_b32 v76, a24
  v_accvgpr_read_b32 v77, a28
  v_accvgpr_read_b32 v78, a25
  v_accvgpr_read_b32 v79, a29
  v_accvgpr_read_b32 v80, a26
  v_accvgpr_read_b32 v81, a30
  v_accvgpr_read_b32 v82, a27
  v_accvgpr_read_b32 v83, a31
  v_cvt_pk_bf16_f32 v72, v76, v77
  v_cvt_pk_bf16_f32 v73, v78, v79
  v_cvt_pk_bf16_f32 v74, v80, v81
  v_cvt_pk_bf16_f32 v75, v82, v83
  buffer_store_dwordx4 v[72:75], v172, s[4:7], s92 offen offset:3072 sc1
  v_accvgpr_read_b32 v88, a152
  v_accvgpr_read_b32 v89, a156
  v_accvgpr_read_b32 v90, a153
  v_accvgpr_read_b32 v91, a157
  v_accvgpr_read_b32 v92, a154
  v_accvgpr_read_b32 v93, a158
  v_accvgpr_read_b32 v94, a155
  v_accvgpr_read_b32 v95, a159
  v_cvt_pk_bf16_f32 v188, v88, v89
  v_cvt_pk_bf16_f32 v189, v90, v91
  v_cvt_pk_bf16_f32 v190, v92, v93
  v_cvt_pk_bf16_f32 v191, v94, v95
  v_accvgpr_read_b32 v52, a32
  v_accvgpr_read_b32 v53, a36
  v_accvgpr_read_b32 v54, a33
  v_accvgpr_read_b32 v55, a37
  v_accvgpr_read_b32 v56, a34
  v_accvgpr_read_b32 v57, a38
  v_accvgpr_read_b32 v58, a35
  v_accvgpr_read_b32 v59, a39
  v_cvt_pk_bf16_f32 v48, v52, v53
  v_cvt_pk_bf16_f32 v49, v54, v55
  v_cvt_pk_bf16_f32 v50, v56, v57
  v_cvt_pk_bf16_f32 v51, v58, v59
  buffer_store_dwordx4 v[48:51], v173, s[4:7], s92 offen offset:0 sc1
  v_accvgpr_read_b32 v64, a160
  v_accvgpr_read_b32 v65, a164
  v_accvgpr_read_b32 v66, a161
  v_accvgpr_read_b32 v67, a165
  v_accvgpr_read_b32 v68, a162
  v_accvgpr_read_b32 v69, a166
  v_accvgpr_read_b32 v70, a163
  v_accvgpr_read_b32 v71, a167
  v_cvt_pk_bf16_f32 v192, v64, v65
  v_cvt_pk_bf16_f32 v193, v66, v67
  v_cvt_pk_bf16_f32 v194, v68, v69
  v_cvt_pk_bf16_f32 v195, v70, v71
  v_accvgpr_read_b32 v76, a40
  v_accvgpr_read_b32 v77, a44
  v_accvgpr_read_b32 v78, a41
  v_accvgpr_read_b32 v79, a45
  v_accvgpr_read_b32 v80, a42
  v_accvgpr_read_b32 v81, a46
  v_accvgpr_read_b32 v82, a43
  v_accvgpr_read_b32 v83, a47
  v_cvt_pk_bf16_f32 v72, v76, v77
  v_cvt_pk_bf16_f32 v73, v78, v79
  v_cvt_pk_bf16_f32 v74, v80, v81
  v_cvt_pk_bf16_f32 v75, v82, v83
  buffer_store_dwordx4 v[72:75], v173, s[4:7], s92 offen offset:1024 sc1
  v_accvgpr_read_b32 v88, a168
  v_accvgpr_read_b32 v89, a172
  v_accvgpr_read_b32 v90, a169
  v_accvgpr_read_b32 v91, a173
  v_accvgpr_read_b32 v92, a170
  v_accvgpr_read_b32 v93, a174
  v_accvgpr_read_b32 v94, a171
  v_accvgpr_read_b32 v95, a175
  v_cvt_pk_bf16_f32 v196, v88, v89
  v_cvt_pk_bf16_f32 v197, v90, v91
  v_cvt_pk_bf16_f32 v198, v92, v93
  v_cvt_pk_bf16_f32 v199, v94, v95
  v_accvgpr_read_b32 v52, a48
  v_accvgpr_read_b32 v53, a52
  v_accvgpr_read_b32 v54, a49
  v_accvgpr_read_b32 v55, a53
  v_accvgpr_read_b32 v56, a50
  v_accvgpr_read_b32 v57, a54
  v_accvgpr_read_b32 v58, a51
  v_accvgpr_read_b32 v59, a55
  v_cvt_pk_bf16_f32 v48, v52, v53
  v_cvt_pk_bf16_f32 v49, v54, v55
  v_cvt_pk_bf16_f32 v50, v56, v57
  v_cvt_pk_bf16_f32 v51, v58, v59
  buffer_store_dwordx4 v[48:51], v173, s[4:7], s92 offen offset:2048 sc1
  v_accvgpr_read_b32 v64, a176
  v_accvgpr_read_b32 v65, a180
  v_accvgpr_read_b32 v66, a177
  v_accvgpr_read_b32 v67, a181
  v_accvgpr_read_b32 v68, a178
  v_accvgpr_read_b32 v69, a182
  v_accvgpr_read_b32 v70, a179
  v_accvgpr_read_b32 v71, a183
  v_cvt_pk_bf16_f32 v200, v64, v65
  v_cvt_pk_bf16_f32 v201, v66, v67
  v_cvt_pk_bf16_f32 v202, v68, v69
  v_cvt_pk_bf16_f32 v203, v70, v71
  v_accvgpr_read_b32 v76, a56
  v_accvgpr_read_b32 v77, a60
  v_accvgpr_read_b32 v78, a57
  v_accvgpr_read_b32 v79, a61
  v_accvgpr_read_b32 v80, a58
  v_accvgpr_read_b32 v81, a62
  v_accvgpr_read_b32 v82, a59
  v_accvgpr_read_b32 v83, a63
  v_cvt_pk_bf16_f32 v72, v76, v77
  v_cvt_pk_bf16_f32 v73, v78, v79
  v_cvt_pk_bf16_f32 v74, v80, v81
  v_cvt_pk_bf16_f32 v75, v82, v83
  buffer_store_dwordx4 v[72:75], v173, s[4:7], s92 offen offset:3072 sc1
  v_accvgpr_read_b32 v88, a184
  v_accvgpr_read_b32 v89, a188
  v_accvgpr_read_b32 v90, a185
  v_accvgpr_read_b32 v91, a189
  v_accvgpr_read_b32 v92, a186
  v_accvgpr_read_b32 v93, a190
  v_accvgpr_read_b32 v94, a187
  v_accvgpr_read_b32 v95, a191
  v_cvt_pk_bf16_f32 v204, v88, v89
  v_cvt_pk_bf16_f32 v205, v90, v91
  v_cvt_pk_bf16_f32 v206, v92, v93
  v_cvt_pk_bf16_f32 v207, v94, v95
  s_add_u32 s92, s92, s61
  v_accvgpr_read_b32 v52, a64
  v_accvgpr_read_b32 v53, a68
  v_accvgpr_read_b32 v54, a65
  v_accvgpr_read_b32 v55, a69
  v_accvgpr_read_b32 v56, a66
  v_accvgpr_read_b32 v57, a70
  v_accvgpr_read_b32 v58, a67
  v_accvgpr_read_b32 v59, a71
  v_cvt_pk_bf16_f32 v48, v52, v53
  v_cvt_pk_bf16_f32 v49, v54, v55
  v_cvt_pk_bf16_f32 v50, v56, v57
  v_cvt_pk_bf16_f32 v51, v58, v59
  buffer_store_dwordx4 v[48:51], v172, s[4:7], s92 offen offset:0 sc1
  v_accvgpr_read_b32 v64, a192
  v_accvgpr_read_b32 v65, a196
  v_accvgpr_read_b32 v66, a193
  v_accvgpr_read_b32 v67, a197
  v_accvgpr_read_b32 v68, a194
  v_accvgpr_read_b32 v69, a198
  v_accvgpr_read_b32 v70, a195
  v_accvgpr_read_b32 v71, a199
  v_cvt_pk_bf16_f32 v208, v64, v65
  v_cvt_pk_bf16_f32 v209, v66, v67
  v_cvt_pk_bf16_f32 v210, v68, v69
  v_cvt_pk_bf16_f32 v211, v70, v71
  v_accvgpr_read_b32 v76, a72
  v_accvgpr_read_b32 v77, a76
  v_accvgpr_read_b32 v78, a73
  v_accvgpr_read_b32 v79, a77
  v_accvgpr_read_b32 v80, a74
  v_accvgpr_read_b32 v81, a78
  v_accvgpr_read_b32 v82, a75
  v_accvgpr_read_b32 v83, a79
  v_cvt_pk_bf16_f32 v72, v76, v77
  v_cvt_pk_bf16_f32 v73, v78, v79
  v_cvt_pk_bf16_f32 v74, v80, v81
  v_cvt_pk_bf16_f32 v75, v82, v83
  buffer_store_dwordx4 v[72:75], v172, s[4:7], s92 offen offset:1024 sc1
  v_accvgpr_read_b32 v88, a200
  v_accvgpr_read_b32 v89, a204
  v_accvgpr_read_b32 v90, a201
  v_accvgpr_read_b32 v91, a205
  v_accvgpr_read_b32 v92, a202
  v_accvgpr_read_b32 v93, a206
  v_accvgpr_read_b32 v94, a203
  v_accvgpr_read_b32 v95, a207
  v_cvt_pk_bf16_f32 v212, v88, v89
  v_cvt_pk_bf16_f32 v213, v90, v91
  v_cvt_pk_bf16_f32 v214, v92, v93
  v_cvt_pk_bf16_f32 v215, v94, v95
  v_accvgpr_read_b32 v52, a80
  v_accvgpr_read_b32 v53, a84
  v_accvgpr_read_b32 v54, a81
  v_accvgpr_read_b32 v55, a85
  v_accvgpr_read_b32 v56, a82
  v_accvgpr_read_b32 v57, a86
  v_accvgpr_read_b32 v58, a83
  v_accvgpr_read_b32 v59, a87
  v_cvt_pk_bf16_f32 v48, v52, v53
  v_cvt_pk_bf16_f32 v49, v54, v55
  v_cvt_pk_bf16_f32 v50, v56, v57
  v_cvt_pk_bf16_f32 v51, v58, v59
  buffer_store_dwordx4 v[48:51], v172, s[4:7], s92 offen offset:2048 sc1
  v_accvgpr_read_b32 v64, a208
  v_accvgpr_read_b32 v65, a212
  v_accvgpr_read_b32 v66, a209
  v_accvgpr_read_b32 v67, a213
  v_accvgpr_read_b32 v68, a210
  v_accvgpr_read_b32 v69, a214
  v_accvgpr_read_b32 v70, a211
  v_accvgpr_read_b32 v71, a215
  v_cvt_pk_bf16_f32 v216, v64, v65
  v_cvt_pk_bf16_f32 v217, v66, v67
  v_cvt_pk_bf16_f32 v218, v68, v69
  v_cvt_pk_bf16_f32 v219, v70, v71
  v_accvgpr_read_b32 v76, a88
  v_accvgpr_read_b32 v77, a92
  v_accvgpr_read_b32 v78, a89
  v_accvgpr_read_b32 v79, a93
  v_accvgpr_read_b32 v80, a90
  v_accvgpr_read_b32 v81, a94
  v_accvgpr_read_b32 v82, a91
  v_accvgpr_read_b32 v83, a95
  v_cvt_pk_bf16_f32 v72, v76, v77
  v_cvt_pk_bf16_f32 v73, v78, v79
  v_cvt_pk_bf16_f32 v74, v80, v81
  v_cvt_pk_bf16_f32 v75, v82, v83
  buffer_store_dwordx4 v[72:75], v172, s[4:7], s92 offen offset:3072 sc1
  v_accvgpr_read_b32 v88, a216
  v_accvgpr_read_b32 v89, a220
  v_accvgpr_read_b32 v90, a217
  v_accvgpr_read_b32 v91, a221
  v_accvgpr_read_b32 v92, a218
  v_accvgpr_read_b32 v93, a222
  v_accvgpr_read_b32 v94, a219
  v_accvgpr_read_b32 v95, a223
  v_cvt_pk_bf16_f32 v220, v88, v89
  v_cvt_pk_bf16_f32 v221, v90, v91
  v_cvt_pk_bf16_f32 v222, v92, v93
  v_cvt_pk_bf16_f32 v223, v94, v95
  v_accvgpr_read_b32 v52, a96
  v_accvgpr_read_b32 v53, a100
  v_accvgpr_read_b32 v54, a97
  v_accvgpr_read_b32 v55, a101
  v_accvgpr_read_b32 v56, a98
  v_accvgpr_read_b32 v57, a102
  v_accvgpr_read_b32 v58, a99
  v_accvgpr_read_b32 v59, a103
  v_cvt_pk_bf16_f32 v48, v52, v53
  v_cvt_pk_bf16_f32 v49, v54, v55
  v_cvt_pk_bf16_f32 v50, v56, v57
  v_cvt_pk_bf16_f32 v51, v58, v59
  buffer_store_dwordx4 v[48:51], v173, s[4:7], s92 offen offset:0 sc1
  v_accvgpr_read_b32 v64, a224
  v_accvgpr_read_b32 v65, a228
  v_accvgpr_read_b32 v66, a225
  v_accvgpr_read_b32 v67, a229
  v_accvgpr_read_b32 v68, a226
  v_accvgpr_read_b32 v69, a230
  v_accvgpr_read_b32 v70, a227
  v_accvgpr_read_b32 v71, a231
  v_cvt_pk_bf16_f32 v224, v64, v65
  v_cvt_pk_bf16_f32 v225, v66, v67
  v_cvt_pk_bf16_f32 v226, v68, v69
  v_cvt_pk_bf16_f32 v227, v70, v71
  v_accvgpr_read_b32 v76, a104
  v_accvgpr_read_b32 v77, a108
  v_accvgpr_read_b32 v78, a105
  v_accvgpr_read_b32 v79, a109
  v_accvgpr_read_b32 v80, a106
  v_accvgpr_read_b32 v81, a110
  v_accvgpr_read_b32 v82, a107
  v_accvgpr_read_b32 v83, a111
  v_cvt_pk_bf16_f32 v72, v76, v77
  v_cvt_pk_bf16_f32 v73, v78, v79
  v_cvt_pk_bf16_f32 v74, v80, v81
  v_cvt_pk_bf16_f32 v75, v82, v83
  buffer_store_dwordx4 v[72:75], v173, s[4:7], s92 offen offset:1024 sc1
  v_accvgpr_read_b32 v88, a232
  v_accvgpr_read_b32 v89, a236
  v_accvgpr_read_b32 v90, a233
  v_accvgpr_read_b32 v91, a237
  v_accvgpr_read_b32 v92, a234
  v_accvgpr_read_b32 v93, a238
  v_accvgpr_read_b32 v94, a235
  v_accvgpr_read_b32 v95, a239
  v_cvt_pk_bf16_f32 v228, v88, v89
  v_cvt_pk_bf16_f32 v229, v90, v91
  v_cvt_pk_bf16_f32 v230, v92, v93
  v_cvt_pk_bf16_f32 v231, v94, v95
  v_accvgpr_read_b32 v52, a112
  v_accvgpr_read_b32 v53, a116
  v_accvgpr_read_b32 v54, a113
  v_accvgpr_read_b32 v55, a117
  v_accvgpr_read_b32 v56, a114
  v_accvgpr_read_b32 v57, a118
  v_accvgpr_read_b32 v58, a115
  v_accvgpr_read_b32 v59, a119
  v_cvt_pk_bf16_f32 v48, v52, v53
  v_cvt_pk_bf16_f32 v49, v54, v55
  v_cvt_pk_bf16_f32 v50, v56, v57
  v_cvt_pk_bf16_f32 v51, v58, v59
  buffer_store_dwordx4 v[48:51], v173, s[4:7], s92 offen offset:2048 sc1
  v_accvgpr_read_b32 v64, a240
  v_accvgpr_read_b32 v65, a244
  v_accvgpr_read_b32 v66, a241
  v_accvgpr_read_b32 v67, a245
  v_accvgpr_read_b32 v68, a242
  v_accvgpr_read_b32 v69, a246
  v_accvgpr_read_b32 v70, a243
  v_accvgpr_read_b32 v71, a247
  v_cvt_pk_bf16_f32 v232, v64, v65
  v_cvt_pk_bf16_f32 v233, v66, v67
  v_cvt_pk_bf16_f32 v234, v68, v69
  v_cvt_pk_bf16_f32 v235, v70, v71
  v_accvgpr_read_b32 v76, a120
  v_accvgpr_read_b32 v77, a124
  v_accvgpr_read_b32 v78, a121
  v_accvgpr_read_b32 v79, a125
  v_accvgpr_read_b32 v80, a122
  v_accvgpr_read_b32 v81, a126
  v_accvgpr_read_b32 v82, a123
  v_accvgpr_read_b32 v83, a127
  v_cvt_pk_bf16_f32 v72, v76, v77
  v_cvt_pk_bf16_f32 v73, v78, v79
  v_cvt_pk_bf16_f32 v74, v80, v81
  v_cvt_pk_bf16_f32 v75, v82, v83
  buffer_store_dwordx4 v[72:75], v173, s[4:7], s92 offen offset:3072 sc1
  v_accvgpr_read_b32 v88, a248
  v_accvgpr_read_b32 v89, a252
  v_accvgpr_read_b32 v90, a249
  v_accvgpr_read_b32 v91, a253
  v_accvgpr_read_b32 v92, a250
  v_accvgpr_read_b32 v93, a254
  v_accvgpr_read_b32 v94, a251
  v_accvgpr_read_b32 v95, a255
  v_cvt_pk_bf16_f32 v236, v88, v89
  v_cvt_pk_bf16_f32 v237, v90, v91
  v_cvt_pk_bf16_f32 v238, v92, v93
  v_cvt_pk_bf16_f32 v239, v94, v95
  s_add_u32 s92, s92, s61
  s_mov_b32 s46, s92
  s_add_u32 s47, s92, s61
  s_branch L_edef
L_e0:
  s_cmp_lg_u32 s59, 2
  s_cbranch_scc1 L_e1
  s_lshr_b32 s90, s27, 1
  s_and_b32 s91, s27, 1
  v_mov_b32 v172, 0x0
  v_bfe_u32 v45, v1, 0, 6
  v_lshl_add_u32 v172, v45, 4, v172
  v_add_u32 v173, 4096, v172
  s_mul_i32 s92, s90, 4
  s_mul_i32 s92, s92, s61
  s_add_u32 s92, s92, s60
  s_mul_i32 s93, s91, 8192
  s_add_u32 s92, s92, s93
  v_accvgpr_read_b32 v52, a0
  v_accvgpr_read_b32 v53, a1
  v_accvgpr_read_b32 v54, a2
  v_accvgpr_read_b32 v55, a3
  v_accvgpr_read_b32 v56, a32
  v_accvgpr_read_b32 v57, a33
  v_accvgpr_read_b32 v58, a34
  v_accvgpr_read_b32 v59, a35
  v_cvt_pk_bf16_f32 v48, v52, v53
  v_cvt_pk_bf16_f32 v49, v54, v55
  v_cvt_pk_bf16_f32 v50, v56, v57
  v_cvt_pk_bf16_f32 v51, v58, v59
  buffer_store_dwordx4 v[48:51], v172, s[4:7], s92 offen offset:0 sc1
  v_accvgpr_read_b32 v64, a128
  v_accvgpr_read_b32 v65, a129
  v_accvgpr_read_b32 v66, a130
  v_accvgpr_read_b32 v67, a131
  v_accvgpr_read_b32 v68, a160
  v_accvgpr_read_b32 v69, a161
  v_accvgpr_read_b32 v70, a162
  v_accvgpr_read_b32 v71, a163
  v_cvt_pk_bf16_f32 v176, v64, v65
  v_cvt_pk_bf16_f32 v177, v66, v67
  v_cvt_pk_bf16_f32 v178, v68, v69
  v_cvt_pk_bf16_f32 v179, v70, v71
  v_accvgpr_read_b32 v76, a4
  v_accvgpr_read_b32 v77, a5
  v_accvgpr_read_b32 v78, a6
  v_accvgpr_read_b32 v79, a7
  v_accvgpr_read_b32 v80, a36
  v_accvgpr_read_b32 v81, a37
  v_accvgpr_read_b32 v82, a38
  v_accvgpr_read_b32 v83, a39
  v_cvt_pk_bf16_f32 v72, v76, v77
  v_cvt_pk_bf16_f32 v73, v78, v79
  v_cvt_pk_bf16_f32 v74, v80, v81
  v_cvt_pk_bf16_f32 v75, v82, v83
  buffer_store_dwordx4 v[72:75], v172, s[4:7], s92 offen offset:1024 sc1
  v_accvgpr_read_b32 v88, a132
  v_accvgpr_read_b32 v89, a133
  v_accvgpr_read_b32 v90, a134
  v_accvgpr_read_b32 v91, a135
  v_accvgpr_read_b32 v92, a164
  v_accvgpr_read_b32 v93, a165
  v_accvgpr_read_b32 v94, a166
  v_accvgpr_read_b32 v95, a167
  v_cvt_pk_bf16_f32 v180, v88, v89
  v_cvt_pk_bf16_f32 v181, v90, v91
  v_cvt_pk_bf16_f32 v182, v92, v93
  v_cvt_pk_bf16_f32 v183, v94, v95
  v_accvgpr_read_b32 v52, a8
  v_accvgpr_read_b32 v53, a9
  v_accvgpr_read_b32 v54, a10
  v_accvgpr_read_b32 v55, a11
  v_accvgpr_read_b32 v56, a40
  v_accvgpr_read_b32 v57, a41
  v_accvgpr_read_b32 v58, a42
  v_accvgpr_read_b32 v59, a43
  v_cvt_pk_bf16_f32 v48, v52, v53
  v_cvt_pk_bf16_f32 v49, v54, v55
  v_cvt_pk_bf16_f32 v50, v56, v57
  v_cvt_pk_bf16_f32 v51, v58, v59
  buffer_store_dwordx4 v[48:51], v172, s[4:7], s92 offen offset:2048 sc1
  v_accvgpr_read_b32 v64, a136
  v_accvgpr_read_b32 v65, a137
  v_accvgpr_read_b32 v66, a138
  v_accvgpr_read_b32 v67, a139
  v_accvgpr_read_b32 v68, a168
  v_accvgpr_read_b32 v69, a169
  v_accvgpr_read_b32 v70, a170
  v_accvgpr_read_b32 v71, a171
  v_cvt_pk_bf16_f32 v184, v64, v65
  v_cvt_pk_bf16_f32 v185, v66, v67
  v_cvt_pk_bf16_f32 v186, v68, v69
  v_cvt_pk_bf16_f32 v187, v70, v71
  v_accvgpr_read_b32 v76, a12
  v_accvgpr_read_b32 v77, a13
  v_accvgpr_read_b32 v78, a14
  v_accvgpr_read_b32 v79, a15
  v_accvgpr_read_b32 v80, a44
  v_accvgpr_read_b32 v81, a45
  v_accvgpr_read_b32 v82, a46
  v_accvgpr_read_b32 v83, a47
  v_cvt_pk_bf16_f32 v72, v76, v77
  v_cvt_pk_bf16_f32 v73, v78, v79
  v_cvt_pk_bf16_f32 v74, v80, v81
  v_cvt_pk_bf16_f32 v75, v82, v83
  buffer_store_dwordx4 v[72:75], v172, s[4:7], s92 offen offset:3072 sc1
  v_accvgpr_read_b32 v88, a140
  v_accvgpr_read_b32 v89, a141
  v_accvgpr_read_b32 v90, a142
  v_accvgpr_read_b32 v91, a143
  v_accvgpr_read_b32 v92, a172
  v_accvgpr_read_b32 v93, a173
  v_accvgpr_read_b32 v94, a174
  v_accvgpr_read_b32 v95, a175
  v_cvt_pk_bf16_f32 v188, v88, v89
  v_cvt_pk_bf16_f32 v189, v90, v91
  v_cvt_pk_bf16_f32 v190, v92, v93
  v_cvt_pk_bf16_f32 v191, v94, v95
  v_accvgpr_read_b32 v52, a16
  v_accvgpr_read_b32 v53, a17
  v_accvgpr_read_b32 v54, a18
  v_accvgpr_read_b32 v55, a19
  v_accvgpr_read_b32 v56, a48
  v_accvgpr_read_b32 v57, a49
  v_accvgpr_read_b32 v58, a50
  v_accvgpr_read_b32 v59, a51
  v_cvt_pk_bf16_f32 v48, v52, v53
  v_cvt_pk_bf16_f32 v49, v54, v55
  v_cvt_pk_bf16_f32 v50, v56, v57
  v_cvt_pk_bf16_f32 v51, v58, v59
  buffer_store_dwordx4 v[48:51], v173, s[4:7], s92 offen offset:0 sc1
  v_accvgpr_read_b32 v64, a144
  v_accvgpr_read_b32 v65, a145
  v_accvgpr_read_b32 v66, a146
  v_accvgpr_read_b32 v67, a147
  v_accvgpr_read_b32 v68, a176
  v_accvgpr_read_b32 v69, a177
  v_accvgpr_read_b32 v70, a178
  v_accvgpr_read_b32 v71, a179
  v_cvt_pk_bf16_f32 v192, v64, v65
  v_cvt_pk_bf16_f32 v193, v66, v67
  v_cvt_pk_bf16_f32 v194, v68, v69
  v_cvt_pk_bf16_f32 v195, v70, v71
  v_accvgpr_read_b32 v76, a20
  v_accvgpr_read_b32 v77, a21
  v_accvgpr_read_b32 v78, a22
  v_accvgpr_read_b32 v79, a23
  v_accvgpr_read_b32 v80, a52
  v_accvgpr_read_b32 v81, a53
  v_accvgpr_read_b32 v82, a54
  v_accvgpr_read_b32 v83, a55
  v_cvt_pk_bf16_f32 v72, v76, v77
  v_cvt_pk_bf16_f32 v73, v78, v79
  v_cvt_pk_bf16_f32 v74, v80, v81
  v_cvt_pk_bf16_f32 v75, v82, v83
  buffer_store_dwordx4 v[72:75], v173, s[4:7], s92 offen offset:1024 sc1
  v_accvgpr_read_b32 v88, a148
  v_accvgpr_read_b32 v89, a149
  v_accvgpr_read_b32 v90, a150
  v_accvgpr_read_b32 v91, a151
  v_accvgpr_read_b32 v92, a180
  v_accvgpr_read_b32 v93, a181
  v_accvgpr_read_b32 v94, a182
  v_accvgpr_read_b32 v95, a183
  v_cvt_pk_bf16_f32 v196, v88, v89
  v_cvt_pk_bf16_f32 v197, v90, v91
  v_cvt_pk_bf16_f32 v198, v92, v93
  v_cvt_pk_bf16_f32 v199, v94, v95
  v_accvgpr_read_b32 v52, a24
  v_accvgpr_read_b32 v53, a25
  v_accvgpr_read_b32 v54, a26
  v_accvgpr_read_b32 v55, a27
  v_accvgpr_read_b32 v56, a56
  v_accvgpr_read_b32 v57, a57
  v_accvgpr_read_b32 v58, a58
  v_accvgpr_read_b32 v59, a59
  v_cvt_pk_bf16_f32 v48, v52, v53
  v_cvt_pk_bf16_f32 v49, v54, v55
  v_cvt_pk_bf16_f32 v50, v56, v57
  v_cvt_pk_bf16_f32 v51, v58, v59
  buffer_store_dwordx4 v[48:51], v173, s[4:7], s92 offen offset:2048 sc1
  v_accvgpr_read_b32 v64, a152
  v_accvgpr_read_b32 v65, a153
  v_accvgpr_read_b32 v66, a154
  v_accvgpr_read_b32 v67, a155
  v_accvgpr_read_b32 v68, a184
  v_accvgpr_read_b32 v69, a185
  v_accvgpr_read_b32 v70, a186
  v_accvgpr_read_b32 v71, a187
  v_cvt_pk_bf16_f32 v200, v64, v65
  v_cvt_pk_bf16_f32 v201, v66, v67
  v_cvt_pk_bf16_f32 v202, v68, v69
  v_cvt_pk_bf16_f32 v203, v70, v71
  v_accvgpr_read_b32 v76, a28
  v_accvgpr_read_b32 v77, a29
  v_accvgpr_read_b32 v78, a30
  v_accvgpr_read_b32 v79, a31
  v_accvgpr_read_b32 v80, a60
  v_accvgpr_read_b32 v81, a61
  v_accvgpr_read_b32 v82, a62
  v_accvgpr_read_b32 v83, a63
  v_cvt_pk_bf16_f32 v72, v76, v77
  v_cvt_pk_bf16_f32 v73, v78, v79
  v_cvt_pk_bf16_f32 v74, v80, v81
  v_cvt_pk_bf16_f32 v75, v82, v83
  buffer_store_dwordx4 v[72:75], v173, s[4:7], s92 offen offset:3072 sc1
  v_accvgpr_read_b32 v88, a156
  v_accvgpr_read_b32 v89, a157
  v_accvgpr_read_b32 v90, a158
  v_accvgpr_read_b32 v91, a159
  v_accvgpr_read_b32 v92, a188
  v_accvgpr_read_b32 v93, a189
  v_accvgpr_read_b32 v94, a190
  v_accvgpr_read_b32 v95, a191
  v_cvt_pk_bf16_f32 v204, v88, v89
  v_cvt_pk_bf16_f32 v205, v90, v91
  v_cvt_pk_bf16_f32 v206, v92, v93
  v_cvt_pk_bf16_f32 v207, v94, v95
  s_add_u32 s92, s92, s61
  v_accvgpr_read_b32 v52, a64
  v_accvgpr_read_b32 v53, a65
  v_accvgpr_read_b32 v54, a66
  v_accvgpr_read_b32 v55, a67
  v_accvgpr_read_b32 v56, a96
  v_accvgpr_read_b32 v57, a97
  v_accvgpr_read_b32 v58, a98
  v_accvgpr_read_b32 v59, a99
  v_cvt_pk_bf16_f32 v48, v52, v53
  v_cvt_pk_bf16_f32 v49, v54, v55
  v_cvt_pk_bf16_f32 v50, v56, v57
  v_cvt_pk_bf16_f32 v51, v58, v59
  buffer_store_dwordx4 v[48:51], v172, s[4:7], s92 offen offset:0 sc1
  v_accvgpr_read_b32 v64, a192
  v_accvgpr_read_b32 v65, a193
  v_accvgpr_read_b32 v66, a194
  v_accvgpr_read_b32 v67, a195
  v_accvgpr_read_b32 v68, a224
  v_accvgpr_read_b32 v69, a225
  v_accvgpr_read_b32 v70, a226
  v_accvgpr_read_b32 v71, a227
  v_cvt_pk_bf16_f32 v208, v64, v65
  v_cvt_pk_bf16_f32 v209, v66, v67
  v_cvt_pk_bf16_f32 v210, v68, v69
  v_cvt_pk_bf16_f32 v211, v70, v71
  v_accvgpr_read_b32 v76, a68
  v_accvgpr_read_b32 v77, a69
  v_accvgpr_read_b32 v78, a70
  v_accvgpr_read_b32 v79, a71
  v_accvgpr_read_b32 v80, a100
  v_accvgpr_read_b32 v81, a101
  v_accvgpr_read_b32 v82, a102
  v_accvgpr_read_b32 v83, a103
  v_cvt_pk_bf16_f32 v72, v76, v77
  v_cvt_pk_bf16_f32 v73, v78, v79
  v_cvt_pk_bf16_f32 v74, v80, v81
  v_cvt_pk_bf16_f32 v75, v82, v83
  buffer_store_dwordx4 v[72:75], v172, s[4:7], s92 offen offset:1024 sc1
  v_accvgpr_read_b32 v88, a196
  v_accvgpr_read_b32 v89, a197
  v_accvgpr_read_b32 v90, a198
  v_accvgpr_read_b32 v91, a199
  v_accvgpr_read_b32 v92, a228
  v_accvgpr_read_b32 v93, a229
  v_accvgpr_read_b32 v94, a230
  v_accvgpr_read_b32 v95, a231
  v_cvt_pk_bf16_f32 v212, v88, v89
  v_cvt_pk_bf16_f32 v213, v90, v91
  v_cvt_pk_bf16_f32 v214, v92, v93
  v_cvt_pk_bf16_f32 v215, v94, v95
  v_accvgpr_read_b32 v52, a72
  v_accvgpr_read_b32 v53, a73
  v_accvgpr_read_b32 v54, a74
  v_accvgpr_read_b32 v55, a75
  v_accvgpr_read_b32 v56, a104
  v_accvgpr_read_b32 v57, a105
  v_accvgpr_read_b32 v58, a106
  v_accvgpr_read_b32 v59, a107
  v_cvt_pk_bf16_f32 v48, v52, v53
  v_cvt_pk_bf16_f32 v49, v54, v55
  v_cvt_pk_bf16_f32 v50, v56, v57
  v_cvt_pk_bf16_f32 v51, v58, v59
  buffer_store_dwordx4 v[48:51], v172, s[4:7], s92 offen offset:2048 sc1
  v_accvgpr_read_b32 v64, a200
  v_accvgpr_read_b32 v65, a201
  v_accvgpr_read_b32 v66, a202
  v_accvgpr_read_b32 v67, a203
  v_accvgpr_read_b32 v68, a232
  v_accvgpr_read_b32 v69, a233
  v_accvgpr_read_b32 v70, a234
  v_accvgpr_read_b32 v71, a235
  v_cvt_pk_bf16_f32 v216, v64, v65
  v_cvt_pk_bf16_f32 v217, v66, v67
  v_cvt_pk_bf16_f32 v218, v68, v69
  v_cvt_pk_bf16_f32 v219, v70, v71
  v_accvgpr_read_b32 v76, a76
  v_accvgpr_read_b32 v77, a77
  v_accvgpr_read_b32 v78, a78
  v_accvgpr_read_b32 v79, a79
  v_accvgpr_read_b32 v80, a108
  v_accvgpr_read_b32 v81, a109
  v_accvgpr_read_b32 v82, a110
  v_accvgpr_read_b32 v83, a111
  v_cvt_pk_bf16_f32 v72, v76, v77
  v_cvt_pk_bf16_f32 v73, v78, v79
  v_cvt_pk_bf16_f32 v74, v80, v81
  v_cvt_pk_bf16_f32 v75, v82, v83
  buffer_store_dwordx4 v[72:75], v172, s[4:7], s92 offen offset:3072 sc1
  v_accvgpr_read_b32 v88, a204
  v_accvgpr_read_b32 v89, a205
  v_accvgpr_read_b32 v90, a206
  v_accvgpr_read_b32 v91, a207
  v_accvgpr_read_b32 v92, a236
  v_accvgpr_read_b32 v93, a237
  v_accvgpr_read_b32 v94, a238
  v_accvgpr_read_b32 v95, a239
  v_cvt_pk_bf16_f32 v220, v88, v89
  v_cvt_pk_bf16_f32 v221, v90, v91
  v_cvt_pk_bf16_f32 v222, v92, v93
  v_cvt_pk_bf16_f32 v223, v94, v95
  v_accvgpr_read_b32 v52, a80
  v_accvgpr_read_b32 v53, a81
  v_accvgpr_read_b32 v54, a82
  v_accvgpr_read_b32 v55, a83
  v_accvgpr_read_b32 v56, a112
  v_accvgpr_read_b32 v57, a113
  v_accvgpr_read_b32 v58, a114
  v_accvgpr_read_b32 v59, a115
  v_cvt_pk_bf16_f32 v48, v52, v53
  v_cvt_pk_bf16_f32 v49, v54, v55
  v_cvt_pk_bf16_f32 v50, v56, v57
  v_cvt_pk_bf16_f32 v51, v58, v59
  buffer_store_dwordx4 v[48:51], v173, s[4:7], s92 offen offset:0 sc1
  v_accvgpr_read_b32 v64, a208
  v_accvgpr_read_b32 v65, a209
  v_accvgpr_read_b32 v66, a210
  v_accvgpr_read_b32 v67, a211
  v_accvgpr_read_b32 v68, a240
  v_accvgpr_read_b32 v69, a241
  v_accvgpr_read_b32 v70, a242
  v_accvgpr_read_b32 v71, a243
  v_cvt_pk_bf16_f32 v224, v64, v65
  v_cvt_pk_bf16_f32 v225, v66, v67
  v_cvt_pk_bf16_f32 v226, v68, v69
  v_cvt_pk_bf16_f32 v227, v70, v71
  v_accvgpr_read_b32 v76, a84
  v_accvgpr_read_b32 v77, a85
  v_accvgpr_read_b32 v78, a86
  v_accvgpr_read_b32 v79, a87
  v_accvgpr_read_b32 v80, a116
  v_accvgpr_read_b32 v81, a117
  v_accvgpr_read_b32 v82, a118
  v_accvgpr_read_b32 v83, a119
  v_cvt_pk_bf16_f32 v72, v76, v77
  v_cvt_pk_bf16_f32 v73, v78, v79
  v_cvt_pk_bf16_f32 v74, v80, v81
  v_cvt_pk_bf16_f32 v75, v82, v83
  buffer_store_dwordx4 v[72:75], v173, s[4:7], s92 offen offset:1024 sc1
  v_accvgpr_read_b32 v88, a212
  v_accvgpr_read_b32 v89, a213
  v_accvgpr_read_b32 v90, a214
  v_accvgpr_read_b32 v91, a215
  v_accvgpr_read_b32 v92, a244
  v_accvgpr_read_b32 v93, a245
  v_accvgpr_read_b32 v94, a246
  v_accvgpr_read_b32 v95, a247
  v_cvt_pk_bf16_f32 v228, v88, v89
  v_cvt_pk_bf16_f32 v229, v90, v91
  v_cvt_pk_bf16_f32 v230, v92, v93
  v_cvt_pk_bf16_f32 v231, v94, v95
  v_accvgpr_read_b32 v52, a88
  v_accvgpr_read_b32 v53, a89
  v_accvgpr_read_b32 v54, a90
  v_accvgpr_read_b32 v55, a91
  v_accvgpr_read_b32 v56, a120
  v_accvgpr_read_b32 v57, a121
  v_accvgpr_read_b32 v58, a122
  v_accvgpr_read_b32 v59, a123
  v_cvt_pk_bf16_f32 v48, v52, v53
  v_cvt_pk_bf16_f32 v49, v54, v55
  v_cvt_pk_bf16_f32 v50, v56, v57
  v_cvt_pk_bf16_f32 v51, v58, v59
  buffer_store_dwordx4 v[48:51], v173, s[4:7], s92 offen offset:2048 sc1
  v_accvgpr_read_b32 v64, a216
  v_accvgpr_read_b32 v65, a217
  v_accvgpr_read_b32 v66, a218
  v_accvgpr_read_b32 v67, a219
  v_accvgpr_read_b32 v68, a248
  v_accvgpr_read_b32 v69, a249
  v_accvgpr_read_b32 v70, a250
  v_accvgpr_read_b32 v71, a251
  v_cvt_pk_bf16_f32 v232, v64, v65
  v_cvt_pk_bf16_f32 v233, v66, v67
  v_cvt_pk_bf16_f32 v234, v68, v69
  v_cvt_pk_bf16_f32 v235, v70, v71
  v_accvgpr_read_b32 v76, a92
  v_accvgpr_read_b32 v77, a93
  v_accvgpr_read_b32 v78, a94
  v_accvgpr_read_b32 v79, a95
  v_accvgpr_read_b32 v80, a124
  v_accvgpr_read_b32 v81, a125
  v_accvgpr_read_b32 v82, a126
  v_accvgpr_read_b32 v83, a127
  v_cvt_pk_bf16_f32 v72, v76, v77
  v_cvt_pk_bf16_f32 v73, v78, v79
  v_cvt_pk_bf16_f32 v74, v80, v81
  v_cvt_pk_bf16_f32 v75, v82, v83
  buffer_store_dwordx4 v[72:75], v173, s[4:7], s92 offen offset:3072 sc1
  v_accvgpr_read_b32 v88, a220
  v_accvgpr_read_b32 v89, a221
  v_accvgpr_read_b32 v90, a222
  v_accvgpr_read_b32 v91, a223
  v_accvgpr_read_b32 v92, a252
  v_accvgpr_read_b32 v93, a253
  v_accvgpr_read_b32 v94, a254
  v_accvgpr_read_b32 v95, a255
  v_cvt_pk_bf16_f32 v236, v88, v89
  v_cvt_pk_bf16_f32 v237, v90, v91
  v_cvt_pk_bf16_f32 v238, v92, v93
  v_cvt_pk_bf16_f32 v239, v94, v95
  s_add_u32 s92, s92, s61
  s_mov_b32 s46, s92
  s_add_u32 s47, s92, s61
  s_branch L_edef
L_e1:
  s_cmp_lg_u32 s59, 3
  s_cbranch_scc1 L_e2
  s_lshr_b32 s90, s27, 1
  s_and_b32 s91, s27, 1
  v_mov_b32 v178, 0x0
  v_bfe_u32 v177, v1, 0, 6
  v_lshl_add_u32 v178, v177, 4, v178
  v_add_u32 v176, 4096, v178
  s_mul_i32 s92, s90, 2
  s_mul_i32 s92, s92, s61
  s_add_u32 s92, s92, s60
  s_mul_i32 s93, s91, 2048
  s_add_u32 s92, s92, s93
  v_accvgpr_read_b32 v184, a0
  v_accvgpr_read_b32 v185, a4
  v_accvgpr_read_b32 v186, a1
  v_accvgpr_read_b32 v187, a5
  v_accvgpr_read_b32 v188, a2
  v_accvgpr_read_b32 v189, a6
  v_accvgpr_read_b32 v190, a3
  v_accvgpr_read_b32 v191, a7
  v_cvt_pk_bf16_f32 v180, v184, v185
  v_cvt_pk_bf16_f32 v181, v186, v187
  v_cvt_pk_bf16_f32 v182, v188, v189
  v_cvt_pk_bf16_f32 v183, v190, v191
  buffer_store_dwordx4 v[180:183], v178, s[4:7], s92 offen offset:0 sc1
  v_accvgpr_read_b32 v196, a8
  v_accvgpr_read_b32 v197, a12
  v_accvgpr_read_b32 v198, a9
  v_accvgpr_read_b32 v199, a13
  v_accvgpr_read_b32 v200, a10
  v_accvgpr_read_b32 v201, a14
  v_accvgpr_read_b32 v202, a11
  v_accvgpr_read_b32 v203, a15
  v_cvt_pk_bf16_f32 v192, v196, v197
  v_cvt_pk_bf16_f32 v193, v198, v199
  v_cvt_pk_bf16_f32 v194, v200, v201
  v_cvt_pk_bf16_f32 v195, v202, v203
  buffer_store_dwordx4 v[192:195], v178, s[4:7], s92 offen offset:1024 sc1
  v_accvgpr_read_b32 v208, a16
  v_accvgpr_read_b32 v209, a20
  v_accvgpr_read_b32 v210, a17
  v_accvgpr_read_b32 v211, a21
  v_accvgpr_read_b32 v212, a18
  v_accvgpr_read_b32 v213, a22
  v_accvgpr_read_b32 v214, a19
  v_accvgpr_read_b32 v215, a23
  v_cvt_pk_bf16_f32 v204, v208, v209
  v_cvt_pk_bf16_f32 v205, v210, v211
  v_cvt_pk_bf16_f32 v206, v212, v213
  v_cvt_pk_bf16_f32 v207, v214, v215
  buffer_store_dwordx4 v[204:207], v176, s[4:7], s92 offen offset:0 sc1
  v_accvgpr_read_b32 v220, a24
  v_accvgpr_read_b32 v221, a28
  v_accvgpr_read_b32 v222, a25
  v_accvgpr_read_b32 v223, a29
  v_accvgpr_read_b32 v224, a26
  v_accvgpr_read_b32 v225, a30
  v_accvgpr_read_b32 v226, a27
  v_accvgpr_read_b32 v227, a31
  v_cvt_pk_bf16_f32 v216, v220, v221
  v_cvt_pk_bf16_f32 v217, v222, v223
  v_cvt_pk_bf16_f32 v218, v224, v225
  v_cvt_pk_bf16_f32 v219, v226, v227
  buffer_store_dwordx4 v[216:219], v176, s[4:7], s92 offen offset:1024 sc1
  s_add_u32 s92, s92, s61
  v_accvgpr_read_b32 v184, a32
  v_accvgpr_read_b32 v185, a36
  v_accvgpr_read_b32 v186, a33
  v_accvgpr_read_b32 v187, a37
  v_accvgpr_read_b32 v188, a34
  v_accvgpr_read_b32 v189, a38
  v_accvgpr_read_b32 v190, a35
  v_accvgpr_read_b32 v191, a39
  v_cvt_pk_bf16_f32 v180, v184, v185
  v_cvt_pk_bf16_f32 v181, v186, v187
  v_cvt_pk_bf16_f32 v182, v188, v189
  v_cvt_pk_bf16_f32 v183, v190, v191
  buffer_store_dwordx4 v[180:183], v178, s[4:7], s92 offen offset:0 sc1
  v_accvgpr_read_b32 v196, a40
  v_accvgpr_read_b32 v197, a44
  v_accvgpr_read_b32 v198, a41
  v_accvgpr_read_b32 v199, a45
  v_accvgpr_read_b32 v200, a42
  v_accvgpr_read_b32 v201, a46
  v_accvgpr_read_b32 v202, a43
  v_accvgpr_read_b32 v203, a47
  v_cvt_pk_bf16_f32 v192, v196, v197
  v_cvt_pk_bf16_f32 v193, v198, v199
  v_cvt_pk_bf16_f32 v194, v200, v201
  v_cvt_pk_bf16_f32 v195, v202, v203
  buffer_store_dwordx4 v[192:195], v178, s[4:7], s92 offen offset:1024 sc1
  v_accvgpr_read_b32 v208, a48
  v_accvgpr_read_b32 v209, a52
  v_accvgpr_read_b32 v210, a49
  v_accvgpr_read_b32 v211, a53
  v_accvgpr_read_b32 v212, a50
  v_accvgpr_read_b32 v213, a54
  v_accvgpr_read_b32 v214, a51
  v_accvgpr_read_b32 v215, a55
  v_cvt_pk_bf16_f32 v204, v208, v209
  v_cvt_pk_bf16_f32 v205, v210, v211
  v_cvt_pk_bf16_f32 v206, v212, v213
  v_cvt_pk_bf16_f32 v207, v214, v215
  buffer_store_dwordx4 v[204:207], v176, s[4:7], s92 offen offset:0 sc1
  v_accvgpr_read_b32 v220, a56
  v_accvgpr_read_b32 v221, a60
  v_accvgpr_read_b32 v222, a57
  v_accvgpr_read_b32 v223, a61
  v_accvgpr_read_b32 v224, a58
  v_accvgpr_read_b32 v225, a62
  v_accvgpr_read_b32 v226, a59
  v_accvgpr_read_b32 v227, a63
  v_cvt_pk_bf16_f32 v216, v220, v221
  v_cvt_pk_bf16_f32 v217, v222, v223
  v_cvt_pk_bf16_f32 v218, v224, v225
  v_cvt_pk_bf16_f32 v219, v226, v227
  buffer_store_dwordx4 v[216:219], v176, s[4:7], s92 offen offset:1024 sc1
  s_add_u32 s92, s92, s61
  s_branch L_esig
L_e2:
  s_cmp_lg_u32 s59, 4
  s_cbranch_scc1 L_e3
  s_lshr_b32 s90, s27, 1
  s_and_b32 s91, s27, 1
  v_mov_b32 v178, 0x0
  v_bfe_u32 v177, v1, 0, 6
  v_lshl_add_u32 v178, v177, 4, v178
  v_add_u32 v176, 4096, v178
  s_mul_i32 s92, s90, 2
  s_mul_i32 s92, s92, s61
  s_add_u32 s92, s92, s60
  s_mul_i32 s93, s91, 4096
  s_add_u32 s92, s92, s93
  v_accvgpr_read_b32 v184, a0
  v_accvgpr_read_b32 v185, a1
  v_accvgpr_read_b32 v186, a2
  v_accvgpr_read_b32 v187, a3
  v_accvgpr_read_b32 v188, a16
  v_accvgpr_read_b32 v189, a17
  v_accvgpr_read_b32 v190, a18
  v_accvgpr_read_b32 v191, a19
  v_cvt_pk_bf16_f32 v180, v184, v185
  v_cvt_pk_bf16_f32 v181, v186, v187
  v_cvt_pk_bf16_f32 v182, v188, v189
  v_cvt_pk_bf16_f32 v183, v190, v191
  buffer_store_dwordx4 v[180:183], v178, s[4:7], s92 offen offset:0 sc1
  v_accvgpr_read_b32 v196, a4
  v_accvgpr_read_b32 v197, a5
  v_accvgpr_read_b32 v198, a6
  v_accvgpr_read_b32 v199, a7
  v_accvgpr_read_b32 v200, a20
  v_accvgpr_read_b32 v201, a21
  v_accvgpr_read_b32 v202, a22
  v_accvgpr_read_b32 v203, a23
  v_cvt_pk_bf16_f32 v192, v196, v197
  v_cvt_pk_bf16_f32 v193, v198, v199
  v_cvt_pk_bf16_f32 v194, v200, v201
  v_cvt_pk_bf16_f32 v195, v202, v203
  buffer_store_dwordx4 v[192:195], v178, s[4:7], s92 offen offset:1024 sc1
  v_accvgpr_read_b32 v208, a8
  v_accvgpr_read_b32 v209, a9
  v_accvgpr_read_b32 v210, a10
  v_accvgpr_read_b32 v211, a11
  v_accvgpr_read_b32 v212, a24
  v_accvgpr_read_b32 v213, a25
  v_accvgpr_read_b32 v214, a26
  v_accvgpr_read_b32 v215, a27
  v_cvt_pk_bf16_f32 v204, v208, v209
  v_cvt_pk_bf16_f32 v205, v210, v211
  v_cvt_pk_bf16_f32 v206, v212, v213
  v_cvt_pk_bf16_f32 v207, v214, v215
  buffer_store_dwordx4 v[204:207], v178, s[4:7], s92 offen offset:2048 sc1
  v_accvgpr_read_b32 v220, a12
  v_accvgpr_read_b32 v221, a13
  v_accvgpr_read_b32 v222, a14
  v_accvgpr_read_b32 v223, a15
  v_accvgpr_read_b32 v224, a28
  v_accvgpr_read_b32 v225, a29
  v_accvgpr_read_b32 v226, a30
  v_accvgpr_read_b32 v227, a31
  v_cvt_pk_bf16_f32 v216, v220, v221
  v_cvt_pk_bf16_f32 v217, v222, v223
  v_cvt_pk_bf16_f32 v218, v224, v225
  v_cvt_pk_bf16_f32 v219, v226, v227
  buffer_store_dwordx4 v[216:219], v178, s[4:7], s92 offen offset:3072 sc1
  s_add_u32 s92, s92, s61
  v_accvgpr_read_b32 v184, a32
  v_accvgpr_read_b32 v185, a33
  v_accvgpr_read_b32 v186, a34
  v_accvgpr_read_b32 v187, a35
  v_accvgpr_read_b32 v188, a48
  v_accvgpr_read_b32 v189, a49
  v_accvgpr_read_b32 v190, a50
  v_accvgpr_read_b32 v191, a51
  v_cvt_pk_bf16_f32 v180, v184, v185
  v_cvt_pk_bf16_f32 v181, v186, v187
  v_cvt_pk_bf16_f32 v182, v188, v189
  v_cvt_pk_bf16_f32 v183, v190, v191
  buffer_store_dwordx4 v[180:183], v178, s[4:7], s92 offen offset:0 sc1
  v_accvgpr_read_b32 v196, a36
  v_accvgpr_read_b32 v197, a37
  v_accvgpr_read_b32 v198, a38
  v_accvgpr_read_b32 v199, a39
  v_accvgpr_read_b32 v200, a52
  v_accvgpr_read_b32 v201, a53
  v_accvgpr_read_b32 v202, a54
  v_accvgpr_read_b32 v203, a55
  v_cvt_pk_bf16_f32 v192, v196, v197
  v_cvt_pk_bf16_f32 v193, v198, v199
  v_cvt_pk_bf16_f32 v194, v200, v201
  v_cvt_pk_bf16_f32 v195, v202, v203
  buffer_store_dwordx4 v[192:195], v178, s[4:7], s92 offen offset:1024 sc1
  v_accvgpr_read_b32 v208, a40
  v_accvgpr_read_b32 v209, a41
  v_accvgpr_read_b32 v210, a42
  v_accvgpr_read_b32 v211, a43
  v_accvgpr_read_b32 v212, a56
  v_accvgpr_read_b32 v213, a57
  v_accvgpr_read_b32 v214, a58
  v_accvgpr_read_b32 v215, a59
  v_cvt_pk_bf16_f32 v204, v208, v209
  v_cvt_pk_bf16_f32 v205, v210, v211
  v_cvt_pk_bf16_f32 v206, v212, v213
  v_cvt_pk_bf16_f32 v207, v214, v215
  buffer_store_dwordx4 v[204:207], v178, s[4:7], s92 offen offset:2048 sc1
  v_accvgpr_read_b32 v220, a44
  v_accvgpr_read_b32 v221, a45
  v_accvgpr_read_b32 v222, a46
  v_accvgpr_read_b32 v223, a47
  v_accvgpr_read_b32 v224, a60
  v_accvgpr_read_b32 v225, a61
  v_accvgpr_read_b32 v226, a62
  v_accvgpr_read_b32 v227, a63
  v_cvt_pk_bf16_f32 v216, v220, v221
  v_cvt_pk_bf16_f32 v217, v222, v223
  v_cvt_pk_bf16_f32 v218, v224, v225
  v_cvt_pk_bf16_f32 v219, v226, v227
  buffer_store_dwordx4 v[216:219], v178, s[4:7], s92 offen offset:3072 sc1
  s_add_u32 s92, s92, s61
  s_branch L_esig
L_e3:
  s_cmp_lg_u32 s59, 5
  s_cbranch_scc1 L_e4
  s_lshr_b32 s90, s27, 1
  s_and_b32 s91, s27, 1
  v_and_b32 v176, 15, v1
  v_mul_lo_u32 v176, v176, s61
  v_lshrrev_b32 v177, 4, v1
  v_lshl_add_u32 v178, v177, 4, v176
  s_mul_i32 s92, s90, 64
  s_mul_i32 s92, s92, s61
  s_add_u32 s92, s92, s60
  s_mul_i32 s93, s91, 128
  s_add_u32 s92, s92, s93
  s_lshl_b32 s94, s61, 4
  v_accvgpr_read_b32 v184, a0
  v_accvgpr_read_b32 v185, a1
  v_accvgpr_read_b32 v186, a2
  v_accvgpr_read_b32 v187, a3
  v_accvgpr_read_b32 v188, a4
  v_accvgpr_read_b32 v189, a5
  v_accvgpr_read_b32 v190, a6
  v_accvgpr_read_b32 v191, a7
  v_cvt_pk_bf16_f32 v180, v184, v185
  v_cvt_pk_bf16_f32 v181, v186, v187
  v_cvt_pk_bf16_f32 v182, v188, v189
  v_cvt_pk_bf16_f32 v183, v190, v191
  buffer_store_dwordx4 v[180:183], v178, s[16:19], s92 offen offset:0 sc1
  v_accvgpr_read_b32 v196, a8
  v_accvgpr_read_b32 v197, a9
  v_accvgpr_read_b32 v198, a10
  v_accvgpr_read_b32 v199, a11
  v_accvgpr_read_b32 v200, a12
  v_accvgpr_read_b32 v201, a13
  v_accvgpr_read_b32 v202, a14
  v_accvgpr_read_b32 v203, a15
  v_cvt_pk_bf16_f32 v192, v196, v197
  v_cvt_pk_bf16_f32 v193, v198, v199
  v_cvt_pk_bf16_f32 v194, v200, v201
  v_cvt_pk_bf16_f32 v195, v202, v203
  buffer_store_dwordx4 v[192:195], v178, s[16:19], s92 offen offset:64 sc1
  s_add_u32 s92, s92, s94
  v_accvgpr_read_b32 v208, a16
  v_accvgpr_read_b32 v209, a17
  v_accvgpr_read_b32 v210, a18
  v_accvgpr_read_b32 v211, a19
  v_accvgpr_read_b32 v212, a20
  v_accvgpr_read_b32 v213, a21
  v_accvgpr_read_b32 v214, a22
  v_accvgpr_read_b32 v215, a23
  v_cvt_pk_bf16_f32 v204, v208, v209
  v_cvt_pk_bf16_f32 v205, v210, v211
  v_cvt_pk_bf16_f32 v206, v212, v213
  v_cvt_pk_bf16_f32 v207, v214, v215
  buffer_store_dwordx4 v[204:207], v178, s[16:19], s92 offen offset:0 sc1
  v_accvgpr_read_b32 v220, a24
  v_accvgpr_read_b32 v221, a25
  v_accvgpr_read_b32 v222, a26
  v_accvgpr_read_b32 v223, a27
  v_accvgpr_read_b32 v224, a28
  v_accvgpr_read_b32 v225, a29
  v_accvgpr_read_b32 v226, a30
  v_accvgpr_read_b32 v227, a31
  v_cvt_pk_bf16_f32 v216, v220, v221
  v_cvt_pk_bf16_f32 v217, v222, v223
  v_cvt_pk_bf16_f32 v218, v224, v225
  v_cvt_pk_bf16_f32 v219, v226, v227
  buffer_store_dwordx4 v[216:219], v178, s[16:19], s92 offen offset:64 sc1
  s_add_u32 s92, s92, s94
  v_accvgpr_read_b32 v184, a32
  v_accvgpr_read_b32 v185, a33
  v_accvgpr_read_b32 v186, a34
  v_accvgpr_read_b32 v187, a35
  v_accvgpr_read_b32 v188, a36
  v_accvgpr_read_b32 v189, a37
  v_accvgpr_read_b32 v190, a38
  v_accvgpr_read_b32 v191, a39
  v_cvt_pk_bf16_f32 v180, v184, v185
  v_cvt_pk_bf16_f32 v181, v186, v187
  v_cvt_pk_bf16_f32 v182, v188, v189
  v_cvt_pk_bf16_f32 v183, v190, v191
  buffer_store_dwordx4 v[180:183], v178, s[16:19], s92 offen offset:0 sc1
  v_accvgpr_read_b32 v196, a40
  v_accvgpr_read_b32 v197, a41
  v_accvgpr_read_b32 v198, a42
  v_accvgpr_read_b32 v199, a43
  v_accvgpr_read_b32 v200, a44
  v_accvgpr_read_b32 v201, a45
  v_accvgpr_read_b32 v202, a46
  v_accvgpr_read_b32 v203, a47
  v_cvt_pk_bf16_f32 v192, v196, v197
  v_cvt_pk_bf16_f32 v193, v198, v199
  v_cvt_pk_bf16_f32 v194, v200, v201
  v_cvt_pk_bf16_f32 v195, v202, v203
  buffer_store_dwordx4 v[192:195], v178, s[16:19], s92 offen offset:64 sc1
  s_add_u32 s92, s92, s94
  v_accvgpr_read_b32 v208, a48
  v_accvgpr_read_b32 v209, a49
  v_accvgpr_read_b32 v210, a50
  v_accvgpr_read_b32 v211, a51
  v_accvgpr_read_b32 v212, a52
  v_accvgpr_read_b32 v213, a53
  v_accvgpr_read_b32 v214, a54
  v_accvgpr_read_b32 v215, a55
  v_cvt_pk_bf16_f32 v204, v208, v209
  v_cvt_pk_bf16_f32 v205, v210, v211
  v_cvt_pk_bf16_f32 v206, v212, v213
  v_cvt_pk_bf16_f32 v207, v214, v215
  buffer_store_dwordx4 v[204:207], v178, s[16:19], s92 offen offset:0 sc1
  v_accvgpr_read_b32 v220, a56
  v_accvgpr_read_b32 v221, a57
  v_accvgpr_read_b32 v222, a58
  v_accvgpr_read_b32 v223, a59
  v_accvgpr_read_b32 v224, a60
  v_accvgpr_read_b32 v225, a61
  v_accvgpr_read_b32 v226, a62
  v_accvgpr_read_b32 v227, a63
  v_cvt_pk_bf16_f32 v216, v220, v221
  v_cvt_pk_bf16_f32 v217, v222, v223
  v_cvt_pk_bf16_f32 v218, v224, v225
  v_cvt_pk_bf16_f32 v219, v226, v227
  buffer_store_dwordx4 v[216:219], v178, s[16:19], s92 offen offset:64 sc1
  s_add_u32 s92, s92, s94
  s_branch L_epid
L_e4:
  s_cmp_lg_u32 s59, 6
  s_cbranch_scc1 L_e5
  s_lshr_b32 s90, s27, 1
  s_and_b32 s91, s27, 1
  v_and_b32 v176, 15, v1
  v_mul_lo_u32 v176, v176, s61
  v_lshrrev_b32 v177, 4, v1
  v_lshl_add_u32 v178, v177, 4, v176
  s_mul_i32 s92, s90, 128
  s_mul_i32 s92, s92, s61
  s_add_u32 s92, s92, s60
  s_mul_i32 s93, s91, 128
  s_add_u32 s92, s92, s93
  s_lshl_b32 s94, s61, 4
  v_accvgpr_read_b32 v184, a0
  v_accvgpr_read_b32 v185, a1
  v_accvgpr_read_b32 v186, a2
  v_accvgpr_read_b32 v187, a3
  v_accvgpr_read_b32 v188, a4
  v_accvgpr_read_b32 v189, a5
  v_accvgpr_read_b32 v190, a6
  v_accvgpr_read_b32 v191, a7
  v_cvt_pk_bf16_f32 v180, v184, v185
  v_cvt_pk_bf16_f32 v181, v186, v187
  v_cvt_pk_bf16_f32 v182, v188, v189
  v_cvt_pk_bf16_f32 v183, v190, v191
  buffer_store_dwordx4 v[180:183], v178, s[16:19], s92 offen offset:0 sc1
  v_accvgpr_read_b32 v196, a8
  v_accvgpr_read_b32 v197, a9
  v_accvgpr_read_b32 v198, a10
  v_accvgpr_read_b32 v199, a11
  v_accvgpr_read_b32 v200, a12
  v_accvgpr_read_b32 v201, a13
  v_accvgpr_read_b32 v202, a14
  v_accvgpr_read_b32 v203, a15
  v_cvt_pk_bf16_f32 v192, v196, v197
  v_cvt_pk_bf16_f32 v193, v198, v199
  v_cvt_pk_bf16_f32 v194, v200, v201
  v_cvt_pk_bf16_f32 v195, v202, v203
  buffer_store_dwordx4 v[192:195], v178, s[16:19], s92 offen offset:64 sc1
  s_add_u32 s92, s92, s94
  v_accvgpr_read_b32 v208, a16
  v_accvgpr_read_b32 v209, a17
  v_accvgpr_read_b32 v210, a18
  v_accvgpr_read_b32 v211, a19
  v_accvgpr_read_b32 v212, a20
  v_accvgpr_read_b32 v213, a21
  v_accvgpr_read_b32 v214, a22
  v_accvgpr_read_b32 v215, a23
  v_cvt_pk_bf16_f32 v204, v208, v209
  v_cvt_pk_bf16_f32 v205, v210, v211
  v_cvt_pk_bf16_f32 v206, v212, v213
  v_cvt_pk_bf16_f32 v207, v214, v215
  buffer_store_dwordx4 v[204:207], v178, s[16:19], s92 offen offset:0 sc1
  v_accvgpr_read_b32 v220, a24
  v_accvgpr_read_b32 v221, a25
  v_accvgpr_read_b32 v222, a26
  v_accvgpr_read_b32 v223, a27
  v_accvgpr_read_b32 v224, a28
  v_accvgpr_read_b32 v225, a29
  v_accvgpr_read_b32 v226, a30
  v_accvgpr_read_b32 v227, a31
  v_cvt_pk_bf16_f32 v216, v220, v221
  v_cvt_pk_bf16_f32 v217, v222, v223
  v_cvt_pk_bf16_f32 v218, v224, v225
  v_cvt_pk_bf16_f32 v219, v226, v227
  buffer_store_dwordx4 v[216:219], v178, s[16:19], s92 offen offset:64 sc1
  s_add_u32 s92, s92, s94
  v_accvgpr_read_b32 v184, a32
  v_accvgpr_read_b32 v185, a33
  v_accvgpr_read_b32 v186, a34
  v_accvgpr_read_b32 v187, a35
  v_accvgpr_read_b32 v188, a36
  v_accvgpr_read_b32 v189, a37
  v_accvgpr_read_b32 v190, a38
  v_accvgpr_read_b32 v191, a39
  v_cvt_pk_bf16_f32 v180, v184, v185
  v_cvt_pk_bf16_f32 v181, v186, v187
  v_cvt_pk_bf16_f32 v182, v188, v189
  v_cvt_pk_bf16_f32 v183, v190, v191
  buffer_store_dwordx4 v[180:183], v178, s[16:19], s92 offen offset:0 sc1
  v_accvgpr_read_b32 v196, a40
  v_accvgpr_read_b32 v197, a41
  v_accvgpr_read_b32 v198, a42
  v_accvgpr_read_b32 v199, a43
  v_accvgpr_read_b32 v200, a44
  v_accvgpr_read_b32 v201, a45
  v_accvgpr_read_b32 v202, a46
  v_accvgpr_read_b32 v203, a47
  v_cvt_pk_bf16_f32 v192, v196, v197
  v_cvt_pk_bf16_f32 v193, v198, v199
  v_cvt_pk_bf16_f32 v194, v200, v201
  v_cvt_pk_bf16_f32 v195, v202, v203
  buffer_store_dwordx4 v[192:195], v178, s[16:19], s92 offen offset:64 sc1
  s_add_u32 s92, s92, s94
  v_accvgpr_read_b32 v208, a48
  v_accvgpr_read_b32 v209, a49
  v_accvgpr_read_b32 v210, a50
  v_accvgpr_read_b32 v211, a51
  v_accvgpr_read_b32 v212, a52
  v_accvgpr_read_b32 v213, a53
  v_accvgpr_read_b32 v214, a54
  v_accvgpr_read_b32 v215, a55
  v_cvt_pk_bf16_f32 v204, v208, v209
  v_cvt_pk_bf16_f32 v205, v210, v211
  v_cvt_pk_bf16_f32 v206, v212, v213
  v_cvt_pk_bf16_f32 v207, v214, v215
  buffer_store_dwordx4 v[204:207], v178, s[16:19], s92 offen offset:0 sc1
  v_accvgpr_read_b32 v220, a56
  v_accvgpr_read_b32 v221, a57
  v_accvgpr_read_b32 v222, a58
  v_accvgpr_read_b32 v223, a59
  v_accvgpr_read_b32 v224, a60
  v_accvgpr_read_b32 v225, a61
  v_accvgpr_read_b32 v226, a62
  v_accvgpr_read_b32 v227, a63
  v_cvt_pk_bf16_f32 v216, v220, v221
  v_cvt_pk_bf16_f32 v217, v222, v223
  v_cvt_pk_bf16_f32 v218, v224, v225
  v_cvt_pk_bf16_f32 v219, v226, v227
  buffer_store_dwordx4 v[216:219], v178, s[16:19], s92 offen offset:64 sc1
  s_add_u32 s92, s92, s94
  v_accvgpr_read_b32 v184, a64
  v_accvgpr_read_b32 v185, a65
  v_accvgpr_read_b32 v186, a66
  v_accvgpr_read_b32 v187, a67
  v_accvgpr_read_b32 v188, a68
  v_accvgpr_read_b32 v189, a69
  v_accvgpr_read_b32 v190, a70
  v_accvgpr_read_b32 v191, a71
  v_cvt_pk_bf16_f32 v180, v184, v185
  v_cvt_pk_bf16_f32 v181, v186, v187
  v_cvt_pk_bf16_f32 v182, v188, v189
  v_cvt_pk_bf16_f32 v183, v190, v191
  buffer_store_dwordx4 v[180:183], v178, s[16:19], s92 offen offset:0 sc1
  v_accvgpr_read_b32 v196, a72
  v_accvgpr_read_b32 v197, a73
  v_accvgpr_read_b32 v198, a74
  v_accvgpr_read_b32 v199, a75
  v_accvgpr_read_b32 v200, a76
  v_accvgpr_read_b32 v201, a77
  v_accvgpr_read_b32 v202, a78
  v_accvgpr_read_b32 v203, a79
  v_cvt_pk_bf16_f32 v192, v196, v197
  v_cvt_pk_bf16_f32 v193, v198, v199
  v_cvt_pk_bf16_f32 v194, v200, v201
  v_cvt_pk_bf16_f32 v195, v202, v203
  buffer_store_dwordx4 v[192:195], v178, s[16:19], s92 offen offset:64 sc1
  s_add_u32 s92, s92, s94
  v_accvgpr_read_b32 v208, a80
  v_accvgpr_read_b32 v209, a81
  v_accvgpr_read_b32 v210, a82
  v_accvgpr_read_b32 v211, a83
  v_accvgpr_read_b32 v212, a84
  v_accvgpr_read_b32 v213, a85
  v_accvgpr_read_b32 v214, a86
  v_accvgpr_read_b32 v215, a87
  v_cvt_pk_bf16_f32 v204, v208, v209
  v_cvt_pk_bf16_f32 v205, v210, v211
  v_cvt_pk_bf16_f32 v206, v212, v213
  v_cvt_pk_bf16_f32 v207, v214, v215
  buffer_store_dwordx4 v[204:207], v178, s[16:19], s92 offen offset:0 sc1
  v_accvgpr_read_b32 v220, a88
  v_accvgpr_read_b32 v221, a89
  v_accvgpr_read_b32 v222, a90
  v_accvgpr_read_b32 v223, a91
  v_accvgpr_read_b32 v224, a92
  v_accvgpr_read_b32 v225, a93
  v_accvgpr_read_b32 v226, a94
  v_accvgpr_read_b32 v227, a95
  v_cvt_pk_bf16_f32 v216, v220, v221
  v_cvt_pk_bf16_f32 v217, v222, v223
  v_cvt_pk_bf16_f32 v218, v224, v225
  v_cvt_pk_bf16_f32 v219, v226, v227
  buffer_store_dwordx4 v[216:219], v178, s[16:19], s92 offen offset:64 sc1
  s_add_u32 s92, s92, s94
  v_accvgpr_read_b32 v184, a96
  v_accvgpr_read_b32 v185, a97
  v_accvgpr_read_b32 v186, a98
  v_accvgpr_read_b32 v187, a99
  v_accvgpr_read_b32 v188, a100
  v_accvgpr_read_b32 v189, a101
  v_accvgpr_read_b32 v190, a102
  v_accvgpr_read_b32 v191, a103
  v_cvt_pk_bf16_f32 v180, v184, v185
  v_cvt_pk_bf16_f32 v181, v186, v187
  v_cvt_pk_bf16_f32 v182, v188, v189
  v_cvt_pk_bf16_f32 v183, v190, v191
  buffer_store_dwordx4 v[180:183], v178, s[16:19], s92 offen offset:0 sc1
  v_accvgpr_read_b32 v196, a104
  v_accvgpr_read_b32 v197, a105
  v_accvgpr_read_b32 v198, a106
  v_accvgpr_read_b32 v199, a107
  v_accvgpr_read_b32 v200, a108
  v_accvgpr_read_b32 v201, a109
  v_accvgpr_read_b32 v202, a110
  v_accvgpr_read_b32 v203, a111
  v_cvt_pk_bf16_f32 v192, v196, v197
  v_cvt_pk_bf16_f32 v193, v198, v199
  v_cvt_pk_bf16_f32 v194, v200, v201
  v_cvt_pk_bf16_f32 v195, v202, v203
  buffer_store_dwordx4 v[192:195], v178, s[16:19], s92 offen offset:64 sc1
  s_add_u32 s92, s92, s94
  v_accvgpr_read_b32 v208, a112
  v_accvgpr_read_b32 v209, a113
  v_accvgpr_read_b32 v210, a114
  v_accvgpr_read_b32 v211, a115
  v_accvgpr_read_b32 v212, a116
  v_accvgpr_read_b32 v213, a117
  v_accvgpr_read_b32 v214, a118
  v_accvgpr_read_b32 v215, a119
  v_cvt_pk_bf16_f32 v204, v208, v209
  v_cvt_pk_bf16_f32 v205, v210, v211
  v_cvt_pk_bf16_f32 v206, v212, v213
  v_cvt_pk_bf16_f32 v207, v214, v215
  buffer_store_dwordx4 v[204:207], v178, s[16:19], s92 offen offset:0 sc1
  v_accvgpr_read_b32 v220, a120
  v_accvgpr_read_b32 v221, a121
  v_accvgpr_read_b32 v222, a122
  v_accvgpr_read_b32 v223, a123
  v_accvgpr_read_b32 v224, a124
  v_accvgpr_read_b32 v225, a125
  v_accvgpr_read_b32 v226, a126
  v_accvgpr_read_b32 v227, a127
  v_cvt_pk_bf16_f32 v216, v220, v221
  v_cvt_pk_bf16_f32 v217, v222, v223
  v_cvt_pk_bf16_f32 v218, v224, v225
  v_cvt_pk_bf16_f32 v219, v226, v227
  buffer_store_dwordx4 v[216:219], v178, s[16:19], s92 offen offset:64 sc1
  s_add_u32 s92, s92, s94
  s_branch L_epid
L_e5:
L_edef:
  s_mov_b32 s49, 1
  s_cmp_eq_u32 s58, 1
  s_cbranch_scc1 L_epid
  s_mov_b32 s49, 0
  buffer_store_dwordx4 v[176:179], v172, s[4:7], s46 offen offset:0 sc1
  buffer_store_dwordx4 v[180:183], v172, s[4:7], s46 offen offset:1024 sc1
  buffer_store_dwordx4 v[184:187], v172, s[4:7], s46 offen offset:2048 sc1
  buffer_store_dwordx4 v[188:191], v172, s[4:7], s46 offen offset:3072 sc1
  buffer_store_dwordx4 v[192:195], v173, s[4:7], s46 offen offset:0 sc1
  buffer_store_dwordx4 v[196:199], v173, s[4:7], s46 offen offset:1024 sc1
  buffer_store_dwordx4 v[200:203], v173, s[4:7], s46 offen offset:2048 sc1
  buffer_store_dwordx4 v[204:207], v173, s[4:7], s46 offen offset:3072 sc1
  buffer_store_dwordx4 v[208:211], v172, s[4:7], s47 offen offset:0 sc1
  buffer_store_dwordx4 v[212:215], v172, s[4:7], s47 offen offset:1024 sc1
  buffer_store_dwordx4 v[216:219], v172, s[4:7], s47 offen offset:2048 sc1
  buffer_store_dwordx4 v[220:223], v172, s[4:7], s47 offen offset:3072 sc1
  buffer_store_dwordx4 v[224:227], v173, s[4:7], s47 offen offset:0 sc1
  buffer_store_dwordx4 v[228:231], v173, s[4:7], s47 offen offset:1024 sc1
  buffer_store_dwordx4 v[232:235], v173, s[4:7], s47 offen offset:2048 sc1
  buffer_store_dwordx4 v[236:239], v173, s[4:7], s47 offen offset:3072 sc1
  s_mov_b32 s46, 0x40000000
  s_mov_b32 s47, 0x40000000
L_esig:
  s_waitcnt vmcnt(0)
  s_cmp_lg_u32 s39, 0
  s_cbranch_scc1 L_vok
  v_mbcnt_lo_u32_b32 v250, -1, 0
  v_mbcnt_hi_u32_b32 v250, -1, v250
  s_lshl_b32 s90, s32, 9
  s_add_u32 s90, s90, 147520
  v_lshl_add_u32 v251, v250, 3, s90
  ds_write_b64 v251, v[248:249]
  s_waitcnt lgkmcnt(0)
  s_cmp_lg_u32 s32, 0
  s_cbranch_scc1 L_vd_4
  v_lshlrev_b32 v250, 2, v250
  s_cmp_lg_u32 s100, 0
  s_cbranch_scc1 L_vw_3
  v_readfirstlane_b32 s90, v247
  s_and_b32 s90, s90, s101
  s_cbranch_scc0 L_vw_3
  v_mov_b32 v251, 1
  s_mov_b64 exec, 1
  buffer_store_dword v251, v250, s[28:31], 0 offen offset:32 sc1
  s_mov_b64 exec, -1
L_vw_3:
  buffer_load_dword v251, v250, s[28:31], 0 offen sc1
  s_waitcnt vmcnt(0)
  v_cmp_eq_u32 vcc, -1, v251
  v_readlane_b32 s91, v251, 8
  v_readlane_b32 s92, v251, 32
  v_readlane_b32 s93, v251, 33
  v_readlane_b32 s90, v251, 34
  s_cmp_lg_u32 s100, 0
  s_cselect_b32 s93, s90, s93
  s_cselect_b32 s91, 0, s91
  s_cselect_b32 s92, 1, s92
  s_cselect_b32 s90, 0xff, vcc_lo
  s_cmp_lg_u32 s91, 0
  s_cselect_b32 s92, 3, s92
  s_cbranch_scc1 L_vk_5
  s_add_u32 s3, s3, 1
  s_cmp_ge_u32 s3, 131072
  s_cselect_b32 s92, 4, s92
  s_cbranch_scc1 L_vk_5
  s_sleep 8
  s_and_b32 s90, s90, 0xff
  s_cmp_lg_u32 s90, 0xff
  s_cbranch_scc1 L_vw_3
  s_cmp_lt_u32 s93, 128
  s_cbranch_scc1 L_vw_3
L_vk_5:
  v_mov_b32 v251, s92
  v_mov_b32 v250, 147456
  ds_write_b32 v250, v251
  s_waitcnt lgkmcnt(0)
L_vd_4:
  s_barrier
  v_mov_b32 v250, 147456
  ds_read_b32 v251, v250
  s_waitcnt lgkmcnt(0)
  v_readfirstlane_b32 s92, v251
  s_barrier
  s_cmp_eq_u32 s92, 3
  s_cbranch_scc1 L_fallback
  s_cmp_eq_u32 s92, 4
  s_cbranch_scc1 L_exit
  s_mov_b32 s39, 1
L_vok:
  s_barrier
  s_cmp_lg_u32 s32, 0
  s_cbranch_scc1 L_sig_6
  v_mov_b32 v254, s63
  v_mov_b32 v255, 0
  v_and_b32 v254, 3, v254
  v_mbcnt_lo_u32_b32 v255, -1, 0
  v_lshlrev_b32 v255, 9, v255
  s_cmp_ge_u32 s63, 2
  s_cselect_b64 exec, 3, 1
  buffer_atomic_add v254, v255, s[4:7], s62 offen offset:0 sc1
  s_mov_b64 exec, -1
L_sig_6:
L_epid:
  s_mov_b32 s59, 0
  s_cmp_eq_u32 s58, 1
  s_cbranch_scc1 L_r1
  s_cmp_eq_u32 s58, 2
  s_cbranch_scc1 L_r2
  s_cmp_eq_u32 s58, 3
  s_cbranch_scc1 L_next
  s_cmp_eq_u32 s35, 4
  s_cbranch_scc1 L_atb
  s_cmp_eq_u32 s35, 5
  s_cbranch_scc1 L_bo
  s_cmp_eq_u32 s35, 6
  s_cbranch_scc1 L_ata
  s_cmp_eq_u32 s35, 11
  s_cbranch_scc1 L_ata4
  s_cmp_eq_u32 s35, 7
  s_cbranch_scc1 L_ao
  s_cmp_eq_u32 s35, 8
  s_cbranch_scc1 L_aos
  s_cmp_eq_u32 s35, 12
  s_cbranch_scc1 L_swp
  s_cmp_eq_u32 s35, 14
  s_cbranch_scc1 L_ao4
  s_cmp_eq_u32 s35, 16
  s_cbranch_scc1 L_ao
  s_cmp_eq_u32 s35, 17
  s_cbranch_scc1 L_bo
  s_branch L_exit
L_aqkv:
  s_mov_b32 s8, s64
  s_and_b32 s9, s65, 0xffff
  s_mov_b32 s10, 0x400000
  s_mov_b32 s11, 0x20000
  s_cmp_eq_u32 s35, 0
  s_cselect_b64 s[88:89], s[68:69], s[70:71]
  s_cmp_eq_u32 s35, 2
  s_cselect_b64 s[88:89], s[72:73], s[88:89]
  s_mov_b32 s12, s88
  s_and_b32 s13, s89, 0xffff
  s_mov_b32 s14, 0x800000
  s_mov_b32 s15, 0x20000
  s_lshl_b32 s91, s33, 2
  s_add_u32 s91, s91, s37
  s_mov_b32 s24, 8192
  s_mov_b32 s26, 262144
  s_lshl_b32 s20, s36, 19
  s_lshl_b32 s21, s91, 9
  s_lshl_b32 s22, s35, 24
  s_lshl_b32 s90, s36, 21
  s_add_u32 s22, s22, s90
  s_lshl_b32 s90, s91, 14
  s_add_u32 s22, s22, s90
  s_lshl_b32 s38, s36, 9
  s_add_u32 s38, s38, 28672
  s_cmp_eq_u32 s35, 0
  s_cselect_b32 s38, 8192, s38
  s_cselect_b32 s98, 1, 2
  s_mov_b32 s48, s35
  s_branch L_g1
L_bqkv:
  s_mov_b32 s8, s78
  s_and_b32 s9, s79, 0xffff
  s_mov_b32 s10, 0x400000
  s_mov_b32 s11, 0x20000
  s_mov_b32 s12, s80
  s_and_b32 s13, s81, 0xffff
  s_mov_b32 s14, 0x600000
  s_mov_b32 s15, 0x20000
  s_lshl_b32 s91, s37, 2
  s_add_u32 s91, s91, s33
  s_mov_b32 s24, 6144
  s_mov_b32 s26, 65536
  s_lshl_b32 s20, s36, 19
  s_lshl_b32 s21, s91, 9
  s_lshl_b32 s22, s37, 22
  s_lshl_b32 s90, s36, 19
  s_add_u32 s22, s22, s90
  s_lshl_b32 s90, s33, 14
  s_add_u32 s22, s22, s90
  s_add_u32 s22, s22, 0x4000000
  s_mov_b32 s38, 12288
  s_mov_b32 s48, s37
  s_mov_b32 s98, 1
L_g1:
  s_lshl_b32 s90, s36, 9
  s_add_u32 s38, s38, s90
  s_lshl_b32 s90, s33, 7
  s_add_u32 s38, s38, s90
  s_mov_b32 s23, 2048
  s_mov_b32 s25, 8
  v_and_b32 v1, 63, v0
  v_lshrrev_b32 v38, 6, v0
  s_nop 0
  v_readfirstlane_b32 s27, v38
  s_mul_i32 s90, s27, 64
  v_lshrrev_b32 v38, 3, v1
  v_add_u32 v38, s90, v38
  v_mul_lo_u32 v38, v38, s23
  v_lshrrev_b32 v39, 4, v1
  v_xor_b32 v39, v39, v1
  v_and_b32 v39, 7, v39
  v_lshl_add_u32 v2, v39, 4, v38
  s_mul_i32 s91, s23, 8
  v_add_u32 v3, s91, v2
  v_xor_b32 v3, 64, v3
  v_add_u32 v4, s91, v3
  v_xor_b32 v4, 64, v4
  v_add_u32 v5, s91, v4
  v_xor_b32 v5, 64, v5
  v_add_u32 v6, s91, v5
  v_xor_b32 v6, 64, v6
  v_add_u32 v7, s91, v6
  v_xor_b32 v7, 64, v7
  v_add_u32 v8, s91, v7
  v_xor_b32 v8, 64, v8
  v_add_u32 v9, s91, v8
  v_xor_b32 v9, 64, v9
  s_mul_i32 s90, s27, 16
  v_lshrrev_b32 v38, 5, v1
  v_add_u32 v38, 0, v38
  v_add_u32 v38, s90, v38
  v_mov_b32 v174, v38
  v_and_b32 v39, 3, v38
  v_lshlrev_b32 v39, 1, v39
  v_and_b32 v40, 8, v38
  v_or_b32 v39, v39, v40
  v_xor_b32 v39, v39, v1
  v_and_b32 v39, 31, v39
  v_mul_lo_u32 v38, v38, s24
  v_lshl_add_u32 v10, v39, 4, v38
  v_lshrrev_b32 v38, 5, v1
  v_add_u32 v38, 2, v38
  v_add_u32 v38, s90, v38
  v_and_b32 v39, 3, v38
  v_lshlrev_b32 v39, 1, v39
  v_and_b32 v40, 8, v38
  v_or_b32 v39, v39, v40
  v_xor_b32 v39, v39, v1
  v_and_b32 v39, 31, v39
  v_mul_lo_u32 v38, v38, s24
  v_lshl_add_u32 v11, v39, 4, v38
  v_lshrrev_b32 v38, 5, v1
  v_add_u32 v38, 4, v38
  v_add_u32 v38, s90, v38
  v_and_b32 v39, 3, v38
  v_lshlrev_b32 v39, 1, v39
  v_and_b32 v40, 8, v38
  v_or_b32 v39, v39, v40
  v_xor_b32 v39, v39, v1
  v_and_b32 v39, 31, v39
  v_mul_lo_u32 v38, v38, s24
  v_lshl_add_u32 v12, v39, 4, v38
  v_lshrrev_b32 v38, 5, v1
  v_add_u32 v38, 6, v38
  v_add_u32 v38, s90, v38
  v_and_b32 v39, 3, v38
  v_lshlrev_b32 v39, 1, v39
  v_and_b32 v40, 8, v38
  v_or_b32 v39, v39, v40
  v_xor_b32 v39, v39, v1
  v_and_b32 v39, 31, v39
  v_mul_lo_u32 v38, v38, s24
  v_lshl_add_u32 v13, v39, 4, v38
  v_lshrrev_b32 v38, 5, v1
  v_add_u32 v38, 8, v38
  v_add_u32 v38, s90, v38
  v_and_b32 v39, 3, v38
  v_lshlrev_b32 v39, 1, v39
  v_and_b32 v40, 8, v38
  v_or_b32 v39, v39, v40
  v_xor_b32 v39, v39, v1
  v_and_b32 v39, 31, v39
  v_mul_lo_u32 v38, v38, s24
  v_lshl_add_u32 v14, v39, 4, v38
  v_lshrrev_b32 v38, 5, v1
  v_add_u32 v38, 10, v38
  v_add_u32 v38, s90, v38
  v_and_b32 v39, 3, v38
  v_lshlrev_b32 v39, 1, v39
  v_and_b32 v40, 8, v38
  v_or_b32 v39, v39, v40
  v_xor_b32 v39, v39, v1
  v_and_b32 v39, 31, v39
  v_mul_lo_u32 v38, v38, s24
  v_lshl_add_u32 v15, v39, 4, v38
  v_lshrrev_b32 v38, 5, v1
  v_add_u32 v38, 12, v38
  v_add_u32 v38, s90, v38
  v_and_b32 v39, 3, v38
  v_lshlrev_b32 v39, 1, v39
  v_and_b32 v40, 8, v38
  v_or_b32 v39, v39, v40
  v_xor_b32 v39, v39, v1
  v_and_b32 v39, 31, v39
  v_mul_lo_u32 v38, v38, s24
  v_lshl_add_u32 v16, v39, 4, v38
  v_lshrrev_b32 v38, 5, v1
  v_add_u32 v38, 14, v38
  v_add_u32 v38, s90, v38
  v_and_b32 v39, 3, v38
  v_lshlrev_b32 v39, 1, v39
  v_and_b32 v40, 8, v38
  v_or_b32 v39, v39, v40
  v_xor_b32 v39, v39, v1
  v_and_b32 v39, 31, v39
  v_mul_lo_u32 v38, v38, s24
  v_lshl_add_u32 v17, v39, 4, v38
  s_mul_i32 s51, s24, 64
  s_mul_i32 s52, s27, 8192
  s_mul_i32 s53, s27, 8192
  s_add_u32 s53, s53, 32768
  s_add_u32 m0, s52, 0
  s_nop 0
  buffer_load_dwordx4 v2, s[8:11], s20 offen  lds
  s_add_u32 m0, s53, 0
  s_nop 0
  buffer_load_dwordx4 v10, s[12:15], s21 offen  lds
  s_add_u32 m0, s52, 1024
  s_nop 0
  buffer_load_dwordx4 v3, s[8:11], s20 offen  lds
  s_add_u32 m0, s53, 1024
  s_nop 0
  buffer_load_dwordx4 v11, s[12:15], s21 offen  lds
  s_add_u32 m0, s52, 2048
  s_nop 0
  buffer_load_dwordx4 v4, s[8:11], s20 offen  lds
  s_add_u32 m0, s53, 2048
  s_nop 0
  buffer_load_dwordx4 v12, s[12:15], s21 offen  lds
  s_add_u32 m0, s52, 3072
  s_nop 0
  buffer_load_dwordx4 v5, s[8:11], s20 offen  lds
  s_add_u32 m0, s53, 3072
  s_nop 0
  buffer_load_dwordx4 v13, s[12:15], s21 offen  lds
  s_add_u32 m0, s52, 4096
  s_nop 0
  buffer_load_dwordx4 v6, s[8:11], s20 offen  lds
  s_add_u32 m0, s53, 4096
  s_nop 0
  buffer_load_dwordx4 v14, s[12:15], s21 offen  lds
  s_add_u32 m0, s52, 5120
  s_nop 0
  buffer_load_dwordx4 v7, s[8:11], s20 offen  lds
  s_add_u32 m0, s53, 5120
  s_nop 0
  buffer_load_dwordx4 v15, s[12:15], s21 offen  lds
  s_add_u32 m0, s52, 6144
  s_nop 0
  buffer_load_dwordx4 v8, s[8:11], s20 offen  lds
  s_add_u32 m0, s53, 6144
  s_nop 0
  buffer_load_dwordx4 v16, s[12:15], s21 offen  lds
  s_add_u32 m0, s52, 7168
  s_nop 0
  buffer_load_dwordx4 v9, s[8:11], s20 offen  lds
  s_add_u32 m0, s53, 7168
  s_nop 0
  buffer_load_dwordx4 v17, s[12:15], s21 offen  lds
  s_add_u32 s20, s20, 128
  s_add_u32 s21, s21, s51
  s_add_u32 m0, s52, 65536
  s_nop 0
  buffer_load_dwordx4 v2, s[8:11], s20 offen  lds
  s_add_u32 m0, s53, 65536
  s_nop 0
  buffer_load_dwordx4 v10, s[12:15], s21 offen  lds
  s_add_u32 m0, s52, 66560
  s_nop 0
  buffer_load_dwordx4 v3, s[8:11], s20 offen  lds
  s_add_u32 m0, s53, 66560
  s_nop 0
  buffer_load_dwordx4 v11, s[12:15], s21 offen  lds
  s_add_u32 m0, s52, 67584
  s_nop 0
  buffer_load_dwordx4 v4, s[8:11], s20 offen  lds
  s_add_u32 m0, s53, 67584
  s_nop 0
  buffer_load_dwordx4 v12, s[12:15], s21 offen  lds
  s_add_u32 m0, s52, 68608
  s_nop 0
  buffer_load_dwordx4 v5, s[8:11], s20 offen  lds
  s_add_u32 m0, s53, 68608
  s_nop 0
  buffer_load_dwordx4 v13, s[12:15], s21 offen  lds
  s_add_u32 m0, s52, 69632
  s_nop 0
  buffer_load_dwordx4 v6, s[8:11], s20 offen  lds
  s_add_u32 m0, s53, 69632
  s_nop 0
  buffer_load_dwordx4 v14, s[12:15], s21 offen  lds
  s_add_u32 m0, s52, 70656
  s_nop 0
  buffer_load_dwordx4 v7, s[8:11], s20 offen  lds
  s_add_u32 m0, s53, 70656
  s_nop 0
  buffer_load_dwordx4 v15, s[12:15], s21 offen  lds
  s_add_u32 m0, s52, 71680
  s_nop 0
  buffer_load_dwordx4 v8, s[8:11], s20 offen  lds
  s_add_u32 m0, s53, 71680
  s_nop 0
  buffer_load_dwordx4 v16, s[12:15], s21 offen  lds
  s_add_u32 m0, s52, 72704
  s_nop 0
  buffer_load_dwordx4 v9, s[8:11], s20 offen  lds
  s_add_u32 m0, s53, 72704
  s_nop 0
  buffer_load_dwordx4 v17, s[12:15], s21 offen  lds
  s_add_u32 s20, s20, 128
  s_add_u32 s21, s21, s51
  s_lshr_b32 s90, s27, 1
  s_and_b32 s91, s27, 1
  s_mul_i32 s92, s90, 16384
  v_mov_b32 v38, 0x0
  v_bfe_u32 v39, v1, 0, 4
  v_lshl_add_u32 v38, v39, 7, v38
  v_add_u32 v38, s92, v38
  v_lshrrev_b32 v39, 1, v1
  v_and_b32 v39, 7, v39
  v_lshrrev_b32 v40, 4, v1
  v_xor_b32 v39, v39, v40
  v_lshl_add_u32 v18, v39, 4, v38
  v_xor_b32 v19, 64, v18
  v_add_u32 v20, 65536, v18
  v_add_u32 v21, 65536, v19
  v_mov_b32 v38, 0x0
  v_bfe_u32 v39, v1, 2, 2
  v_lshl_add_u32 v38, v39, 9, v38
  v_bfe_u32 v39, v1, 4, 2
  v_lshl_add_u32 v38, v39, 12, v38
  v_bfe_u32 v39, v1, 0, 2
  v_lshl_add_u32 v38, v39, 3, v38
  v_bfe_u32 v40, v1, 2, 3
  s_mul_i32 s92, s91, 8
  s_add_u32 s93, s92, 0
  v_xor_b32 v39, s93, v40
  v_lshl_add_u32 v22, v39, 5, v38
  v_add_u32 v30, 65536, v22
  s_add_u32 s93, s92, 1
  v_xor_b32 v39, s93, v40
  v_lshl_add_u32 v23, v39, 5, v38
  v_add_u32 v31, 65536, v23
  s_add_u32 s93, s92, 2
  v_xor_b32 v39, s93, v40
  v_lshl_add_u32 v24, v39, 5, v38
  v_add_u32 v32, 65536, v24
  s_add_u32 s93, s92, 3
  v_xor_b32 v39, s93, v40
  v_lshl_add_u32 v25, v39, 5, v38
  v_add_u32 v33, 65536, v25
  s_add_u32 s93, s92, 4
  v_xor_b32 v39, s93, v40
  v_lshl_add_u32 v26, v39, 5, v38
  v_add_u32 v34, 65536, v26
  s_add_u32 s93, s92, 5
  v_xor_b32 v39, s93, v40
  v_lshl_add_u32 v27, v39, 5, v38
  v_add_u32 v35, 65536, v27
  s_add_u32 s93, s92, 6
  v_xor_b32 v39, s93, v40
  v_lshl_add_u32 v28, v39, 5, v38
  v_add_u32 v36, 65536, v28
  s_add_u32 s93, s92, 7
  v_xor_b32 v39, s93, v40
  v_lshl_add_u32 v29, v39, 5, v38
  v_add_u32 v37, 65536, v29
  v_mov_b32 v241, 147456
  v_lshrrev_b32 v175, 4, v0
  v_add_u32 v175, v175, v241
  s_mov_b32 s58, 1
  s_branch L_epi
L_r1:
  s_cmp_eq_u32 s49, 1
  s_cbranch_scc1 L_r1c
  s_waitcnt vmcnt(16)
L_r1c:
  s_cmp_eq_u32 s48, 2
  s_cbranch_scc1 L_g2
  s_waitcnt vmcnt(16)
  s_barrier
  ds_read_b128 v[44:47], v18 offset:0
  ds_read_b64_tr_b16 v[108:109], v22 offset:32768
  ds_read_b64_tr_b16 v[110:111], v22 offset:34816
  ds_read_b128 v[48:51], v18 offset:2048
  ds_read_b64_tr_b16 v[112:113], v23 offset:32768
  ds_read_b64_tr_b16 v[114:115], v23 offset:34816
  ds_read_b128 v[52:55], v18 offset:4096
  ds_read_b64_tr_b16 v[116:117], v24 offset:32768
  ds_read_b64_tr_b16 v[118:119], v24 offset:34816
  ds_read_b128 v[56:59], v18 offset:6144
  ds_read_b64_tr_b16 v[120:121], v25 offset:32768
  ds_read_b64_tr_b16 v[122:123], v25 offset:34816
  ds_read_b128 v[60:63], v18 offset:8192
  ds_read_b64_tr_b16 v[124:125], v26 offset:32768
  ds_read_b64_tr_b16 v[126:127], v26 offset:34816
  ds_read_b128 v[64:67], v18 offset:10240
  ds_read_b64_tr_b16 v[128:129], v27 offset:32768
  ds_read_b64_tr_b16 v[130:131], v27 offset:34816
  ds_read_b128 v[68:71], v18 offset:12288
  ds_read_b64_tr_b16 v[132:133], v28 offset:32768
  ds_read_b64_tr_b16 v[134:135], v28 offset:34816
  ds_read_b128 v[72:75], v18 offset:14336
  ds_read_b64_tr_b16 v[136:137], v29 offset:32768
  ds_read_b64_tr_b16 v[138:139], v29 offset:34816
  s_sub_u32 s25, s25, 1
  s_waitcnt lgkmcnt(0)
  s_nop 0
  v_mfma_f32_16x16x32_bf16 a[0:3], v[108:111], v[44:47], 0
  buffer_store_dwordx4 v[176:179], v172, s[4:7], s46 offen offset:0 sc1
  ds_read_b128 v[76:79], v19 offset:0
  v_mfma_f32_16x16x32_bf16 a[4:7], v[112:115], v[44:47], 0
  v_mfma_f32_16x16x32_bf16 a[8:11], v[116:119], v[44:47], 0
  ds_read_b64_tr_b16 v[140:141], v22 offset:49152
  v_mfma_f32_16x16x32_bf16 a[12:15], v[120:123], v[44:47], 0
  s_nop 0
  v_mfma_f32_16x16x32_bf16 a[16:19], v[124:127], v[44:47], 0
  buffer_store_dwordx4 v[180:183], v172, s[4:7], s46 offen offset:1024 sc1
  ds_read_b64_tr_b16 v[142:143], v22 offset:51200
  v_mfma_f32_16x16x32_bf16 a[20:23], v[128:131], v[44:47], 0
  v_mfma_f32_16x16x32_bf16 a[24:27], v[132:135], v[44:47], 0
  ds_read_b128 v[80:83], v19 offset:2048
  v_mfma_f32_16x16x32_bf16 a[28:31], v[136:139], v[44:47], 0
  s_nop 0
  v_mfma_f32_16x16x32_bf16 a[32:35], v[108:111], v[48:51], 0
  buffer_store_dwordx4 v[184:187], v172, s[4:7], s46 offen offset:2048 sc1
  ds_read_b64_tr_b16 v[144:145], v23 offset:49152
  v_mfma_f32_16x16x32_bf16 a[36:39], v[112:115], v[48:51], 0
  v_mfma_f32_16x16x32_bf16 a[40:43], v[116:119], v[48:51], 0
  ds_read_b64_tr_b16 v[146:147], v23 offset:51200
  v_mfma_f32_16x16x32_bf16 a[44:47], v[120:123], v[48:51], 0
  s_nop 0
  v_mfma_f32_16x16x32_bf16 a[48:51], v[124:127], v[48:51], 0
  buffer_store_dwordx4 v[188:191], v172, s[4:7], s46 offen offset:3072 sc1
  ds_read_b128 v[84:87], v19 offset:4096
  v_mfma_f32_16x16x32_bf16 a[52:55], v[128:131], v[48:51], 0
  v_mfma_f32_16x16x32_bf16 a[56:59], v[132:135], v[48:51], 0
  ds_read_b64_tr_b16 v[148:149], v24 offset:49152
  v_mfma_f32_16x16x32_bf16 a[60:63], v[136:139], v[48:51], 0
  s_nop 0
  v_mfma_f32_16x16x32_bf16 a[64:67], v[108:111], v[52:55], 0
  buffer_store_dwordx4 v[192:195], v173, s[4:7], s46 offen offset:0 sc1
  ds_read_b64_tr_b16 v[150:151], v24 offset:51200
  v_mfma_f32_16x16x32_bf16 a[68:71], v[112:115], v[52:55], 0
  v_mfma_f32_16x16x32_bf16 a[72:75], v[116:119], v[52:55], 0
  ds_read_b128 v[88:91], v19 offset:6144
  v_mfma_f32_16x16x32_bf16 a[76:79], v[120:123], v[52:55], 0
  s_nop 0
  v_mfma_f32_16x16x32_bf16 a[80:83], v[124:127], v[52:55], 0
  buffer_store_dwordx4 v[196:199], v173, s[4:7], s46 offen offset:1024 sc1
  ds_read_b64_tr_b16 v[152:153], v25 offset:49152
  v_mfma_f32_16x16x32_bf16 a[84:87], v[128:131], v[52:55], 0
  v_mfma_f32_16x16x32_bf16 a[88:91], v[132:135], v[52:55], 0
  ds_read_b64_tr_b16 v[154:155], v25 offset:51200
  v_mfma_f32_16x16x32_bf16 a[92:95], v[136:139], v[52:55], 0
  s_nop 0
  v_mfma_f32_16x16x32_bf16 a[96:99], v[108:111], v[56:59], 0
  buffer_store_dwordx4 v[200:203], v173, s[4:7], s46 offen offset:2048 sc1
  ds_read_b128 v[92:95], v19 offset:8192
  v_mfma_f32_16x16x32_bf16 a[100:103], v[112:115], v[56:59], 0
  v_mfma_f32_16x16x32_bf16 a[104:107], v[116:119], v[56:59], 0
  ds_read_b64_tr_b16 v[156:157], v26 offset:49152
  v_mfma_f32_16x16x32_bf16 a[108:111], v[120:123], v[56:59], 0
  s_nop 0
  v_mfma_f32_16x16x32_bf16 a[112:115], v[124:127], v[56:59], 0
  buffer_store_dwordx4 v[204:207], v173, s[4:7], s46 offen offset:3072 sc1
  ds_read_b64_tr_b16 v[158:159], v26 offset:51200
  v_mfma_f32_16x16x32_bf16 a[116:119], v[128:131], v[56:59], 0
  v_mfma_f32_16x16x32_bf16 a[120:123], v[132:135], v[56:59], 0
  ds_read_b128 v[96:99], v19 offset:10240
  v_mfma_f32_16x16x32_bf16 a[124:127], v[136:139], v[56:59], 0
  s_nop 0
  v_mfma_f32_16x16x32_bf16 a[128:131], v[108:111], v[60:63], 0
  buffer_store_dwordx4 v[208:211], v172, s[4:7], s47 offen offset:0 sc1
  ds_read_b64_tr_b16 v[160:161], v27 offset:49152
  v_mfma_f32_16x16x32_bf16 a[132:135], v[112:115], v[60:63], 0
  v_mfma_f32_16x16x32_bf16 a[136:139], v[116:119], v[60:63], 0
  ds_read_b64_tr_b16 v[162:163], v27 offset:51200
  v_mfma_f32_16x16x32_bf16 a[140:143], v[120:123], v[60:63], 0
  s_nop 0
  v_mfma_f32_16x16x32_bf16 a[144:147], v[124:127], v[60:63], 0
  buffer_store_dwordx4 v[212:215], v172, s[4:7], s47 offen offset:1024 sc1
  ds_read_b128 v[100:103], v19 offset:12288
  v_mfma_f32_16x16x32_bf16 a[148:151], v[128:131], v[60:63], 0
  v_mfma_f32_16x16x32_bf16 a[152:155], v[132:135], v[60:63], 0
  ds_read_b64_tr_b16 v[164:165], v28 offset:49152
  v_mfma_f32_16x16x32_bf16 a[156:159], v[136:139], v[60:63], 0
  s_nop 0
  v_mfma_f32_16x16x32_bf16 a[160:163], v[108:111], v[64:67], 0
  buffer_store_dwordx4 v[216:219], v172, s[4:7], s47 offen offset:2048 sc1
  ds_read_b64_tr_b16 v[166:167], v28 offset:51200
  v_mfma_f32_16x16x32_bf16 a[164:167], v[112:115], v[64:67], 0
  v_mfma_f32_16x16x32_bf16 a[168:171], v[116:119], v[64:67], 0
  ds_read_b128 v[104:107], v19 offset:14336
  v_mfma_f32_16x16x32_bf16 a[172:175], v[120:123], v[64:67], 0
  s_nop 0
  v_mfma_f32_16x16x32_bf16 a[176:179], v[124:127], v[64:67], 0
  buffer_store_dwordx4 v[220:223], v172, s[4:7], s47 offen offset:3072 sc1
  ds_read_b64_tr_b16 v[168:169], v29 offset:49152
  v_mfma_f32_16x16x32_bf16 a[180:183], v[128:131], v[64:67], 0
  v_mfma_f32_16x16x32_bf16 a[184:187], v[132:135], v[64:67], 0
  ds_read_b64_tr_b16 v[170:171], v29 offset:51200
  v_mfma_f32_16x16x32_bf16 a[188:191], v[136:139], v[64:67], 0
  s_nop 0
  v_mfma_f32_16x16x32_bf16 a[192:195], v[108:111], v[68:71], 0
  buffer_store_dwordx4 v[224:227], v173, s[4:7], s47 offen offset:0 sc1
  v_mfma_f32_16x16x32_bf16 a[196:199], v[112:115], v[68:71], 0
  v_mfma_f32_16x16x32_bf16 a[200:203], v[116:119], v[68:71], 0
  v_mfma_f32_16x16x32_bf16 a[204:207], v[120:123], v[68:71], 0
  s_nop 0
  v_mfma_f32_16x16x32_bf16 a[208:211], v[124:127], v[68:71], 0
  buffer_store_dwordx4 v[228:231], v173, s[4:7], s47 offen offset:1024 sc1
  v_mfma_f32_16x16x32_bf16 a[212:215], v[128:131], v[68:71], 0
  v_mfma_f32_16x16x32_bf16 a[216:219], v[132:135], v[68:71], 0
  v_mfma_f32_16x16x32_bf16 a[220:223], v[136:139], v[68:71], 0
  s_nop 0
  v_mfma_f32_16x16x32_bf16 a[224:227], v[108:111], v[72:75], 0
  buffer_store_dwordx4 v[232:235], v173, s[4:7], s47 offen offset:2048 sc1
  v_mfma_f32_16x16x32_bf16 a[228:231], v[112:115], v[72:75], 0
  v_mfma_f32_16x16x32_bf16 a[232:235], v[116:119], v[72:75], 0
  v_mfma_f32_16x16x32_bf16 a[236:239], v[120:123], v[72:75], 0
  s_nop 0
  v_mfma_f32_16x16x32_bf16 a[240:243], v[124:127], v[72:75], 0
  buffer_store_dwordx4 v[236:239], v173, s[4:7], s47 offen offset:3072 sc1
  v_mfma_f32_16x16x32_bf16 a[244:247], v[128:131], v[72:75], 0
  v_mfma_f32_16x16x32_bf16 a[248:251], v[132:135], v[72:75], 0
  v_mfma_f32_16x16x32_bf16 a[252:255], v[136:139], v[72:75], 0
  s_waitcnt lgkmcnt(0)
  v_mfma_f32_16x16x32_bf16 a[0:3], v[140:143], v[76:79], a[0:3]
  s_waitcnt vmcnt(16)
  s_barrier
  s_add_u32 m0, s52, 0
  v_mfma_f32_16x16x32_bf16 a[4:7], v[144:147], v[76:79], a[4:7]
  buffer_load_dwordx4 v2, s[8:11], s20 offen  lds
  ds_read_b128 v[44:47], v20 offset:0
  v_mfma_f32_16x16x32_bf16 a[8:11], v[148:151], v[76:79], a[8:11]
  v_mfma_f32_16x16x32_bf16 a[12:15], v[152:155], v[76:79], a[12:15]
  ds_read_b64_tr_b16 v[108:109], v30 offset:32768
  s_add_u32 m0, s53, 0
  v_mfma_f32_16x16x32_bf16 a[16:19], v[156:159], v[76:79], a[16:19]
  buffer_load_dwordx4 v10, s[12:15], s21 offen  lds
  v_mfma_f32_16x16x32_bf16 a[20:23], v[160:163], v[76:79], a[20:23]
  ds_read_b64_tr_b16 v[110:111], v30 offset:34816
  v_mfma_f32_16x16x32_bf16 a[24:27], v[164:167], v[76:79], a[24:27]
  v_mfma_f32_16x16x32_bf16 a[28:31], v[168:171], v[76:79], a[28:31]
  ds_read_b128 v[48:51], v20 offset:2048
  s_add_u32 m0, s52, 1024
  v_mfma_f32_16x16x32_bf16 a[32:35], v[140:143], v[80:83], a[32:35]
  buffer_load_dwordx4 v3, s[8:11], s20 offen  lds
  v_mfma_f32_16x16x32_bf16 a[36:39], v[144:147], v[80:83], a[36:39]
  ds_read_b64_tr_b16 v[112:113], v31 offset:32768
  v_mfma_f32_16x16x32_bf16 a[40:43], v[148:151], v[80:83], a[40:43]
  v_mfma_f32_16x16x32_bf16 a[44:47], v[152:155], v[80:83], a[44:47]
  ds_read_b64_tr_b16 v[114:115], v31 offset:34816
  s_add_u32 m0, s53, 1024
  v_mfma_f32_16x16x32_bf16 a[48:51], v[156:159], v[80:83], a[48:51]
  buffer_load_dwordx4 v11, s[12:15], s21 offen  lds
  v_mfma_f32_16x16x32_bf16 a[52:55], v[160:163], v[80:83], a[52:55]
  ds_read_b128 v[52:55], v20 offset:4096
  v_mfma_f32_16x16x32_bf16 a[56:59], v[164:167], v[80:83], a[56:59]
  s_add_u32 m0, s52, 2048
  v_mfma_f32_16x16x32_bf16 a[60:63], v[168:171], v[80:83], a[60:63]
  buffer_load_dwordx4 v4, s[8:11], s20 offen  lds
  ds_read_b64_tr_b16 v[116:117], v32 offset:32768
  v_mfma_f32_16x16x32_bf16 a[64:67], v[140:143], v[84:87], a[64:67]
  v_mfma_f32_16x16x32_bf16 a[68:71], v[144:147], v[84:87], a[68:71]
  ds_read_b64_tr_b16 v[118:119], v32 offset:34816
  v_mfma_f32_16x16x32_bf16 a[72:75], v[148:151], v[84:87], a[72:75]
  s_add_u32 m0, s53, 2048
  v_mfma_f32_16x16x32_bf16 a[76:79], v[152:155], v[84:87], a[76:79]
  buffer_load_dwordx4 v12, s[12:15], s21 offen  lds
  ds_read_b128 v[56:59], v20 offset:6144
  v_mfma_f32_16x16x32_bf16 a[80:83], v[156:159], v[84:87], a[80:83]
  v_mfma_f32_16x16x32_bf16 a[84:87], v[160:163], v[84:87], a[84:87]
  ds_read_b64_tr_b16 v[120:121], v33 offset:32768
  v_mfma_f32_16x16x32_bf16 a[88:91], v[164:167], v[84:87], a[88:91]
  s_add_u32 m0, s52, 3072
  v_mfma_f32_16x16x32_bf16 a[92:95], v[168:171], v[84:87], a[92:95]
  buffer_load_dwordx4 v5, s[8:11], s20 offen  lds
  ds_read_b64_tr_b16 v[122:123], v33 offset:34816
  v_mfma_f32_16x16x32_bf16 a[96:99], v[140:143], v[88:91], a[96:99]
  v_mfma_f32_16x16x32_bf16 a[100:103], v[144:147], v[88:91], a[100:103]
  ds_read_b128 v[60:63], v20 offset:8192
  s_add_u32 m0, s53, 3072
  v_mfma_f32_16x16x32_bf16 a[104:107], v[148:151], v[88:91], a[104:107]
  buffer_load_dwordx4 v13, s[12:15], s21 offen  lds
  v_mfma_f32_16x16x32_bf16 a[108:111], v[152:155], v[88:91], a[108:111]
  ds_read_b64_tr_b16 v[124:125], v34 offset:32768
  v_mfma_f32_16x16x32_bf16 a[112:115], v[156:159], v[88:91], a[112:115]
  v_mfma_f32_16x16x32_bf16 a[116:119], v[160:163], v[88:91], a[116:119]
  ds_read_b64_tr_b16 v[126:127], v34 offset:34816
  s_add_u32 m0, s52, 4096
  v_mfma_f32_16x16x32_bf16 a[120:123], v[164:167], v[88:91], a[120:123]
  buffer_load_dwordx4 v6, s[8:11], s20 offen  lds
  v_mfma_f32_16x16x32_bf16 a[124:127], v[168:171], v[88:91], a[124:127]
  ds_read_b128 v[64:67], v20 offset:10240
  v_mfma_f32_16x16x32_bf16 a[128:131], v[140:143], v[92:95], a[128:131]
  v_mfma_f32_16x16x32_bf16 a[132:135], v[144:147], v[92:95], a[132:135]
  ds_read_b64_tr_b16 v[128:129], v35 offset:32768
  s_add_u32 m0, s53, 4096
  v_mfma_f32_16x16x32_bf16 a[136:139], v[148:151], v[92:95], a[136:139]
  buffer_load_dwordx4 v14, s[12:15], s21 offen  lds
  v_mfma_f32_16x16x32_bf16 a[140:143], v[152:155], v[92:95], a[140:143]
  ds_read_b64_tr_b16 v[130:131], v35 offset:34816
  v_mfma_f32_16x16x32_bf16 a[144:147], v[156:159], v[92:95], a[144:147]
  v_mfma_f32_16x16x32_bf16 a[148:151], v[160:163], v[92:95], a[148:151]
  ds_read_b128 v[68:71], v20 offset:12288
  s_add_u32 m0, s52, 5120
  v_mfma_f32_16x16x32_bf16 a[152:155], v[164:167], v[92:95], a[152:155]
  buffer_load_dwordx4 v7, s[8:11], s20 offen  lds
  v_mfma_f32_16x16x32_bf16 a[156:159], v[168:171], v[92:95], a[156:159]
  ds_read_b64_tr_b16 v[132:133], v36 offset:32768
  v_mfma_f32_16x16x32_bf16 a[160:163], v[140:143], v[96:99], a[160:163]
  s_add_u32 m0, s53, 5120
  v_mfma_f32_16x16x32_bf16 a[164:167], v[144:147], v[96:99], a[164:167]
  buffer_load_dwordx4 v15, s[12:15], s21 offen  lds
  ds_read_b64_tr_b16 v[134:135], v36 offset:34816
  v_mfma_f32_16x16x32_bf16 a[168:171], v[148:151], v[96:99], a[168:171]
  v_mfma_f32_16x16x32_bf16 a[172:175], v[152:155], v[96:99], a[172:175]
  ds_read_b128 v[72:75], v20 offset:14336
  v_mfma_f32_16x16x32_bf16 a[176:179], v[156:159], v[96:99], a[176:179]
  s_add_u32 m0, s52, 6144
  v_mfma_f32_16x16x32_bf16 a[180:183], v[160:163], v[96:99], a[180:183]
  buffer_load_dwordx4 v8, s[8:11], s20 offen  lds
  ds_read_b64_tr_b16 v[136:137], v37 offset:32768
  v_mfma_f32_16x16x32_bf16 a[184:187], v[164:167], v[96:99], a[184:187]
  v_mfma_f32_16x16x32_bf16 a[188:191], v[168:171], v[96:99], a[188:191]
  ds_read_b64_tr_b16 v[138:139], v37 offset:34816
  v_mfma_f32_16x16x32_bf16 a[192:195], v[140:143], v[100:103], a[192:195]
  s_add_u32 m0, s53, 6144
  v_mfma_f32_16x16x32_bf16 a[196:199], v[144:147], v[100:103], a[196:199]
  buffer_load_dwordx4 v16, s[12:15], s21 offen  lds
  v_mfma_f32_16x16x32_bf16 a[200:203], v[148:151], v[100:103], a[200:203]
  v_mfma_f32_16x16x32_bf16 a[204:207], v[152:155], v[100:103], a[204:207]
  s_add_u32 m0, s52, 7168
  v_mfma_f32_16x16x32_bf16 a[208:211], v[156:159], v[100:103], a[208:211]
  buffer_load_dwordx4 v9, s[8:11], s20 offen  lds
  v_mfma_f32_16x16x32_bf16 a[212:215], v[160:163], v[100:103], a[212:215]
  v_mfma_f32_16x16x32_bf16 a[216:219], v[164:167], v[100:103], a[216:219]
  v_mfma_f32_16x16x32_bf16 a[220:223], v[168:171], v[100:103], a[220:223]
  s_add_u32 m0, s53, 7168
  v_mfma_f32_16x16x32_bf16 a[224:227], v[140:143], v[104:107], a[224:227]
  buffer_load_dwordx4 v17, s[12:15], s21 offen  lds
  v_mfma_f32_16x16x32_bf16 a[228:231], v[144:147], v[104:107], a[228:231]
  v_mfma_f32_16x16x32_bf16 a[232:235], v[148:151], v[104:107], a[232:235]
  v_mfma_f32_16x16x32_bf16 a[236:239], v[152:155], v[104:107], a[236:239]
  s_add_u32 s20, s20, 128
  v_mfma_f32_16x16x32_bf16 a[240:243], v[156:159], v[104:107], a[240:243]
  s_add_u32 s21, s21, s51
  v_mfma_f32_16x16x32_bf16 a[244:247], v[160:163], v[104:107], a[244:247]
  v_mfma_f32_16x16x32_bf16 a[248:251], v[164:167], v[104:107], a[248:251]
  v_mfma_f32_16x16x32_bf16 a[252:255], v[168:171], v[104:107], a[252:255]
  s_waitcnt lgkmcnt(0)
  v_mfma_f32_16x16x32_bf16 a[0:3], v[108:111], v[44:47], a[0:3]
  ds_read_b128 v[76:79], v21 offset:0
  v_mfma_f32_16x16x32_bf16 a[4:7], v[112:115], v[44:47], a[4:7]
  v_mfma_f32_16x16x32_bf16 a[8:11], v[116:119], v[44:47], a[8:11]
  ds_read_b64_tr_b16 v[140:141], v30 offset:49152
  v_mfma_f32_16x16x32_bf16 a[12:15], v[120:123], v[44:47], a[12:15]
  v_mfma_f32_16x16x32_bf16 a[16:19], v[124:127], v[44:47], a[16:19]
  ds_read_b64_tr_b16 v[142:143], v30 offset:51200
  v_mfma_f32_16x16x32_bf16 a[20:23], v[128:131], v[44:47], a[20:23]
  v_mfma_f32_16x16x32_bf16 a[24:27], v[132:135], v[44:47], a[24:27]
  ds_read_b128 v[80:83], v21 offset:2048
  v_mfma_f32_16x16x32_bf16 a[28:31], v[136:139], v[44:47], a[28:31]
  v_mfma_f32_16x16x32_bf16 a[32:35], v[108:111], v[48:51], a[32:35]
  ds_read_b64_tr_b16 v[144:145], v31 offset:49152
  v_mfma_f32_16x16x32_bf16 a[36:39], v[112:115], v[48:51], a[36:39]
  v_mfma_f32_16x16x32_bf16 a[40:43], v[116:119], v[48:51], a[40:43]
  ds_read_b64_tr_b16 v[146:147], v31 offset:51200
  v_mfma_f32_16x16x32_bf16 a[44:47], v[120:123], v[48:51], a[44:47]
  v_mfma_f32_16x16x32_bf16 a[48:51], v[124:127], v[48:51], a[48:51]
  ds_read_b128 v[84:87], v21 offset:4096
  v_mfma_f32_16x16x32_bf16 a[52:55], v[128:131], v[48:51], a[52:55]
  v_mfma_f32_16x16x32_bf16 a[56:59], v[132:135], v[48:51], a[56:59]
  ds_read_b64_tr_b16 v[148:149], v32 offset:49152
  v_mfma_f32_16x16x32_bf16 a[60:63], v[136:139], v[48:51], a[60:63]
  v_mfma_f32_16x16x32_bf16 a[64:67], v[108:111], v[52:55], a[64:67]
  ds_read_b64_tr_b16 v[150:151], v32 offset:51200
  v_mfma_f32_16x16x32_bf16 a[68:71], v[112:115], v[52:55], a[68:71]
  v_mfma_f32_16x16x32_bf16 a[72:75], v[116:119], v[52:55], a[72:75]
  ds_read_b128 v[88:91], v21 offset:6144
  v_mfma_f32_16x16x32_bf16 a[76:79], v[120:123], v[52:55], a[76:79]
  v_mfma_f32_16x16x32_bf16 a[80:83], v[124:127], v[52:55], a[80:83]
  ds_read_b64_tr_b16 v[152:153], v33 offset:49152
  v_mfma_f32_16x16x32_bf16 a[84:87], v[128:131], v[52:55], a[84:87]
  v_mfma_f32_16x16x32_bf16 a[88:91], v[132:135], v[52:55], a[88:91]
  ds_read_b64_tr_b16 v[154:155], v33 offset:51200
  v_mfma_f32_16x16x32_bf16 a[92:95], v[136:139], v[52:55], a[92:95]
  v_mfma_f32_16x16x32_bf16 a[96:99], v[108:111], v[56:59], a[96:99]
  ds_read_b128 v[92:95], v21 offset:8192
  v_mfma_f32_16x16x32_bf16 a[100:103], v[112:115], v[56:59], a[100:103]
  v_mfma_f32_16x16x32_bf16 a[104:107], v[116:119], v[56:59], a[104:107]
  ds_read_b64_tr_b16 v[156:157], v34 offset:49152
  v_mfma_f32_16x16x32_bf16 a[108:111], v[120:123], v[56:59], a[108:111]
  v_mfma_f32_16x16x32_bf16 a[112:115], v[124:127], v[56:59], a[112:115]
  ds_read_b64_tr_b16 v[158:159], v34 offset:51200
  v_mfma_f32_16x16x32_bf16 a[116:119], v[128:131], v[56:59], a[116:119]
  v_mfma_f32_16x16x32_bf16 a[120:123], v[132:135], v[56:59], a[120:123]
  ds_read_b128 v[96:99], v21 offset:10240
  v_mfma_f32_16x16x32_bf16 a[124:127], v[136:139], v[56:59], a[124:127]
  v_mfma_f32_16x16x32_bf16 a[128:131], v[108:111], v[60:63], a[128:131]
  ds_read_b64_tr_b16 v[160:161], v35 offset:49152
  v_mfma_f32_16x16x32_bf16 a[132:135], v[112:115], v[60:63], a[132:135]
  v_mfma_f32_16x16x32_bf16 a[136:139], v[116:119], v[60:63], a[136:139]
  ds_read_b64_tr_b16 v[162:163], v35 offset:51200
  v_mfma_f32_16x16x32_bf16 a[140:143], v[120:123], v[60:63], a[140:143]
  v_mfma_f32_16x16x32_bf16 a[144:147], v[124:127], v[60:63], a[144:147]
  ds_read_b128 v[100:103], v21 offset:12288
  v_mfma_f32_16x16x32_bf16 a[148:151], v[128:131], v[60:63], a[148:151]
  v_mfma_f32_16x16x32_bf16 a[152:155], v[132:135], v[60:63], a[152:155]
  ds_read_b64_tr_b16 v[164:165], v36 offset:49152
  v_mfma_f32_16x16x32_bf16 a[156:159], v[136:139], v[60:63], a[156:159]
  v_mfma_f32_16x16x32_bf16 a[160:163], v[108:111], v[64:67], a[160:163]
  ds_read_b64_tr_b16 v[166:167], v36 offset:51200
  v_mfma_f32_16x16x32_bf16 a[164:167], v[112:115], v[64:67], a[164:167]
  v_mfma_f32_16x16x32_bf16 a[168:171], v[116:119], v[64:67], a[168:171]
  ds_read_b128 v[104:107], v21 offset:14336
  v_mfma_f32_16x16x32_bf16 a[172:175], v[120:123], v[64:67], a[172:175]
  v_mfma_f32_16x16x32_bf16 a[176:179], v[124:127], v[64:67], a[176:179]
  ds_read_b64_tr_b16 v[168:169], v37 offset:49152
  v_mfma_f32_16x16x32_bf16 a[180:183], v[128:131], v[64:67], a[180:183]
  v_mfma_f32_16x16x32_bf16 a[184:187], v[132:135], v[64:67], a[184:187]
  ds_read_b64_tr_b16 v[170:171], v37 offset:51200
  v_mfma_f32_16x16x32_bf16 a[188:191], v[136:139], v[64:67], a[188:191]
  v_mfma_f32_16x16x32_bf16 a[192:195], v[108:111], v[68:71], a[192:195]
  v_mfma_f32_16x16x32_bf16 a[196:199], v[112:115], v[68:71], a[196:199]
  v_mfma_f32_16x16x32_bf16 a[200:203], v[116:119], v[68:71], a[200:203]
  v_mfma_f32_16x16x32_bf16 a[204:207], v[120:123], v[68:71], a[204:207]
  v_mfma_f32_16x16x32_bf16 a[208:211], v[124:127], v[68:71], a[208:211]
  v_mfma_f32_16x16x32_bf16 a[212:215], v[128:131], v[68:71], a[212:215]
  v_mfma_f32_16x16x32_bf16 a[216:219], v[132:135], v[68:71], a[216:219]
  v_mfma_f32_16x16x32_bf16 a[220:223], v[136:139], v[68:71], a[220:223]
  v_mfma_f32_16x16x32_bf16 a[224:227], v[108:111], v[72:75], a[224:227]
  v_mfma_f32_16x16x32_bf16 a[228:231], v[112:115], v[72:75], a[228:231]
  v_mfma_f32_16x16x32_bf16 a[232:235], v[116:119], v[72:75], a[232:235]
  v_mfma_f32_16x16x32_bf16 a[236:239], v[120:123], v[72:75], a[236:239]
  v_mfma_f32_16x16x32_bf16 a[240:243], v[124:127], v[72:75], a[240:243]
  v_mfma_f32_16x16x32_bf16 a[244:247], v[128:131], v[72:75], a[244:247]
  v_mfma_f32_16x16x32_bf16 a[248:251], v[132:135], v[72:75], a[248:251]
  v_mfma_f32_16x16x32_bf16 a[252:255], v[136:139], v[72:75], a[252:255]
  s_waitcnt lgkmcnt(0)
  v_mfma_f32_16x16x32_bf16 a[0:3], v[140:143], v[76:79], a[0:3]
  s_waitcnt vmcnt(0)
  s_barrier
  s_cmp_eq_u32 s49, 0
  s_cbranch_scc1 L_hs_7
  s_cmp_lg_u32 s32, 0
  s_cbranch_scc1 L_sig_8
  v_mov_b32 v254, s63
  v_mov_b32 v255, 0
  v_and_b32 v254, 3, v254
  v_mbcnt_lo_u32_b32 v255, -1, 0
  v_lshlrev_b32 v255, 9, v255
  s_cmp_ge_u32 s63, 2
  s_cselect_b64 exec, 3, 1
  buffer_atomic_add v254, v255, s[4:7], s62 offen offset:0 sc1
  s_mov_b64 exec, -1
L_sig_8:
L_hs_7:
  s_add_u32 m0, s52, 65536
  v_mfma_f32_16x16x32_bf16 a[4:7], v[144:147], v[76:79], a[4:7]
  buffer_load_dwordx4 v2, s[8:11], s20 offen  lds
  ds_read_b128 v[44:47], v18 offset:0
  v_mfma_f32_16x16x32_bf16 a[8:11], v[148:151], v[76:79], a[8:11]
  v_mfma_f32_16x16x32_bf16 a[12:15], v[152:155], v[76:79], a[12:15]
  ds_read_b64_tr_b16 v[108:109], v22 offset:32768
  s_add_u32 m0, s53, 65536
  v_mfma_f32_16x16x32_bf16 a[16:19], v[156:159], v[76:79], a[16:19]
  buffer_load_dwordx4 v10, s[12:15], s21 offen  lds
  v_mfma_f32_16x16x32_bf16 a[20:23], v[160:163], v[76:79], a[20:23]
  ds_read_b64_tr_b16 v[110:111], v22 offset:34816
  v_mfma_f32_16x16x32_bf16 a[24:27], v[164:167], v[76:79], a[24:27]
  v_mfma_f32_16x16x32_bf16 a[28:31], v[168:171], v[76:79], a[28:31]
  ds_read_b128 v[48:51], v18 offset:2048
  s_add_u32 m0, s52, 66560
  v_mfma_f32_16x16x32_bf16 a[32:35], v[140:143], v[80:83], a[32:35]
  buffer_load_dwordx4 v3, s[8:11], s20 offen  lds
  v_mfma_f32_16x16x32_bf16 a[36:39], v[144:147], v[80:83], a[36:39]
  ds_read_b64_tr_b16 v[112:113], v23 offset:32768
  v_mfma_f32_16x16x32_bf16 a[40:43], v[148:151], v[80:83], a[40:43]
  v_mfma_f32_16x16x32_bf16 a[44:47], v[152:155], v[80:83], a[44:47]
  ds_read_b64_tr_b16 v[114:115], v23 offset:34816
  s_add_u32 m0, s53, 66560
  v_mfma_f32_16x16x32_bf16 a[48:51], v[156:159], v[80:83], a[48:51]
  buffer_load_dwordx4 v11, s[12:15], s21 offen  lds
  v_mfma_f32_16x16x32_bf16 a[52:55], v[160:163], v[80:83], a[52:55]
  ds_read_b128 v[52:55], v18 offset:4096
  v_mfma_f32_16x16x32_bf16 a[56:59], v[164:167], v[80:83], a[56:59]
  s_add_u32 m0, s52, 67584
  v_mfma_f32_16x16x32_bf16 a[60:63], v[168:171], v[80:83], a[60:63]
  buffer_load_dwordx4 v4, s[8:11], s20 offen  lds
  ds_read_b64_tr_b16 v[116:117], v24 offset:32768
  v_mfma_f32_16x16x32_bf16 a[64:67], v[140:143], v[84:87], a[64:67]
  v_mfma_f32_16x16x32_bf16 a[68:71], v[144:147], v[84:87], a[68:71]
  ds_read_b64_tr_b16 v[118:119], v24 offset:34816
  v_mfma_f32_16x16x32_bf16 a[72:75], v[148:151], v[84:87], a[72:75]
  s_add_u32 m0, s53, 67584
  v_mfma_f32_16x16x32_bf16 a[76:79], v[152:155], v[84:87], a[76:79]
  buffer_load_dwordx4 v12, s[12:15], s21 offen  lds
  ds_read_b128 v[56:59], v18 offset:6144
  v_mfma_f32_16x16x32_bf16 a[80:83], v[156:159], v[84:87], a[80:83]
  v_mfma_f32_16x16x32_bf16 a[84:87], v[160:163], v[84:87], a[84:87]
  ds_read_b64_tr_b16 v[120:121], v25 offset:32768
  v_mfma_f32_16x16x32_bf16 a[88:91], v[164:167], v[84:87], a[88:91]
  s_add_u32 m0, s52, 68608
  v_mfma_f32_16x16x32_bf16 a[92:95], v[168:171], v[84:87], a[92:95]
  buffer_load_dwordx4 v5, s[8:11], s20 offen  lds
  ds_read_b64_tr_b16 v[122:123], v25 offset:34816
  v_mfma_f32_16x16x32_bf16 a[96:99], v[140:143], v[88:91], a[96:99]
  v_mfma_f32_16x16x32_bf16 a[100:103], v[144:147], v[88:91], a[100:103]
  ds_read_b128 v[60:63], v18 offset:8192
  s_add_u32 m0, s53, 68608
  v_mfma_f32_16x16x32_bf16 a[104:107], v[148:151], v[88:91], a[104:107]
  buffer_load_dwordx4 v13, s[12:15], s21 offen  lds
  v_mfma_f32_16x16x32_bf16 a[108:111], v[152:155], v[88:91], a[108:111]
  ds_read_b64_tr_b16 v[124:125], v26 offset:32768
  v_mfma_f32_16x16x32_bf16 a[112:115], v[156:159], v[88:91], a[112:115]
  v_mfma_f32_16x16x32_bf16 a[116:119], v[160:163], v[88:91], a[116:119]
  ds_read_b64_tr_b16 v[126:127], v26 offset:34816
  s_add_u32 m0, s52, 69632
  v_mfma_f32_16x16x32_bf16 a[120:123], v[164:167], v[88:91], a[120:123]
  buffer_load_dwordx4 v6, s[8:11], s20 offen  lds
  v_mfma_f32_16x16x32_bf16 a[124:127], v[168:171], v[88:91], a[124:127]
  ds_read_b128 v[64:67], v18 offset:10240
  v_mfma_f32_16x16x32_bf16 a[128:131], v[140:143], v[92:95], a[128:131]
  v_mfma_f32_16x16x32_bf16 a[132:135], v[144:147], v[92:95], a[132:135]
  ds_read_b64_tr_b16 v[128:129], v27 offset:32768
  s_add_u32 m0, s53, 69632
  v_mfma_f32_16x16x32_bf16 a[136:139], v[148:151], v[92:95], a[136:139]
  buffer_load_dwordx4 v14, s[12:15], s21 offen  lds
  v_mfma_f32_16x16x32_bf16 a[140:143], v[152:155], v[92:95], a[140:143]
  ds_read_b64_tr_b16 v[130:131], v27 offset:34816
  v_mfma_f32_16x16x32_bf16 a[144:147], v[156:159], v[92:95], a[144:147]
  v_mfma_f32_16x16x32_bf16 a[148:151], v[160:163], v[92:95], a[148:151]
  ds_read_b128 v[68:71], v18 offset:12288
  s_add_u32 m0, s52, 70656
  v_mfma_f32_16x16x32_bf16 a[152:155], v[164:167], v[92:95], a[152:155]
  buffer_load_dwordx4 v7, s[8:11], s20 offen  lds
  v_mfma_f32_16x16x32_bf16 a[156:159], v[168:171], v[92:95], a[156:159]
  ds_read_b64_tr_b16 v[132:133], v28 offset:32768
  v_mfma_f32_16x16x32_bf16 a[160:163], v[140:143], v[96:99], a[160:163]
  s_add_u32 m0, s53, 70656
  v_mfma_f32_16x16x32_bf16 a[164:167], v[144:147], v[96:99], a[164:167]
  buffer_load_dwordx4 v15, s[12:15], s21 offen  lds
  ds_read_b64_tr_b16 v[134:135], v28 offset:34816
  v_mfma_f32_16x16x32_bf16 a[168:171], v[148:151], v[96:99], a[168:171]
  v_mfma_f32_16x16x32_bf16 a[172:175], v[152:155], v[96:99], a[172:175]
  ds_read_b128 v[72:75], v18 offset:14336
  v_mfma_f32_16x16x32_bf16 a[176:179], v[156:159], v[96:99], a[176:179]
  s_add_u32 m0, s52, 71680
  v_mfma_f32_16x16x32_bf16 a[180:183], v[160:163], v[96:99], a[180:183]
  buffer_load_dwordx4 v8, s[8:11], s20 offen  lds
  ds_read_b64_tr_b16 v[136:137], v29 offset:32768
  v_mfma_f32_16x16x32_bf16 a[184:187], v[164:167], v[96:99], a[184:187]
  v_mfma_f32_16x16x32_bf16 a[188:191], v[168:171], v[96:99], a[188:191]
  ds_read_b64_tr_b16 v[138:139], v29 offset:34816
  v_mfma_f32_16x16x32_bf16 a[192:195], v[140:143], v[100:103], a[192:195]
  s_add_u32 m0, s53, 71680
  v_mfma_f32_16x16x32_bf16 a[196:199], v[144:147], v[100:103], a[196:199]
  buffer_load_dwordx4 v16, s[12:15], s21 offen  lds
  v_mfma_f32_16x16x32_bf16 a[200:203], v[148:151], v[100:103], a[200:203]
  v_mfma_f32_16x16x32_bf16 a[204:207], v[152:155], v[100:103], a[204:207]
  s_add_u32 m0, s52, 72704
  v_mfma_f32_16x16x32_bf16 a[208:211], v[156:159], v[100:103], a[208:211]
  buffer_load_dwordx4 v9, s[8:11], s20 offen  lds
  v_mfma_f32_16x16x32_bf16 a[212:215], v[160:163], v[100:103], a[212:215]
  v_mfma_f32_16x16x32_bf16 a[216:219], v[164:167], v[100:103], a[216:219]
  v_mfma_f32_16x16x32_bf16 a[220:223], v[168:171], v[100:103], a[220:223]
  s_add_u32 m0, s53, 72704
  v_mfma_f32_16x16x32_bf16 a[224:227], v[140:143], v[104:107], a[224:227]
  buffer_load_dwordx4 v17, s[12:15], s21 offen  lds
  v_mfma_f32_16x16x32_bf16 a[228:231], v[144:147], v[104:107], a[228:231]
  v_mfma_f32_16x16x32_bf16 a[232:235], v[148:151], v[104:107], a[232:235]
  v_mfma_f32_16x16x32_bf16 a[236:239], v[152:155], v[104:107], a[236:239]
  s_add_u32 s20, s20, 128
  v_mfma_f32_16x16x32_bf16 a[240:243], v[156:159], v[104:107], a[240:243]
  s_add_u32 s21, s21, s51
  v_mfma_f32_16x16x32_bf16 a[244:247], v[160:163], v[104:107], a[244:247]
  v_mfma_f32_16x16x32_bf16 a[248:251], v[164:167], v[104:107], a[248:251]
  v_mfma_f32_16x16x32_bf16 a[252:255], v[168:171], v[104:107], a[252:255]
L_g1_loop:
  s_sub_u32 s25, s25, 1
  s_cmp_eq_u32 s25, 0
  s_cbranch_scc1 L_g1_fin
  s_waitcnt lgkmcnt(0)
  v_mfma_f32_16x16x32_bf16 a[0:3], v[108:111], v[44:47], a[0:3]
  ds_read_b128 v[76:79], v19 offset:0
  v_mfma_f32_16x16x32_bf16 a[4:7], v[112:115], v[44:47], a[4:7]
  v_mfma_f32_16x16x32_bf16 a[8:11], v[116:119], v[44:47], a[8:11]
  ds_read_b64_tr_b16 v[140:141], v22 offset:49152
  v_mfma_f32_16x16x32_bf16 a[12:15], v[120:123], v[44:47], a[12:15]
  v_mfma_f32_16x16x32_bf16 a[16:19], v[124:127], v[44:47], a[16:19]
  ds_read_b64_tr_b16 v[142:143], v22 offset:51200
  v_mfma_f32_16x16x32_bf16 a[20:23], v[128:131], v[44:47], a[20:23]
  v_mfma_f32_16x16x32_bf16 a[24:27], v[132:135], v[44:47], a[24:27]
  ds_read_b128 v[80:83], v19 offset:2048
  v_mfma_f32_16x16x32_bf16 a[28:31], v[136:139], v[44:47], a[28:31]
  v_mfma_f32_16x16x32_bf16 a[32:35], v[108:111], v[48:51], a[32:35]
  ds_read_b64_tr_b16 v[144:145], v23 offset:49152
  v_mfma_f32_16x16x32_bf16 a[36:39], v[112:115], v[48:51], a[36:39]
  v_mfma_f32_16x16x32_bf16 a[40:43], v[116:119], v[48:51], a[40:43]
  ds_read_b64_tr_b16 v[146:147], v23 offset:51200
  v_mfma_f32_16x16x32_bf16 a[44:47], v[120:123], v[48:51], a[44:47]
  v_mfma_f32_16x16x32_bf16 a[48:51], v[124:127], v[48:51], a[48:51]
  ds_read_b128 v[84:87], v19 offset:4096
  v_mfma_f32_16x16x32_bf16 a[52:55], v[128:131], v[48:51], a[52:55]
  v_mfma_f32_16x16x32_bf16 a[56:59], v[132:135], v[48:51], a[56:59]
  ds_read_b64_tr_b16 v[148:149], v24 offset:49152
  v_mfma_f32_16x16x32_bf16 a[60:63], v[136:139], v[48:51], a[60:63]
  v_mfma_f32_16x16x32_bf16 a[64:67], v[108:111], v[52:55], a[64:67]
  ds_read_b64_tr_b16 v[150:151], v24 offset:51200
  v_mfma_f32_16x16x32_bf16 a[68:71], v[112:115], v[52:55], a[68:71]
  v_mfma_f32_16x16x32_bf16 a[72:75], v[116:119], v[52:55], a[72:75]
  ds_read_b128 v[88:91], v19 offset:6144
  v_mfma_f32_16x16x32_bf16 a[76:79], v[120:123], v[52:55], a[76:79]
  v_mfma_f32_16x16x32_bf16 a[80:83], v[124:127], v[52:55], a[80:83]
  ds_read_b64_tr_b16 v[152:153], v25 offset:49152
  v_mfma_f32_16x16x32_bf16 a[84:87], v[128:131], v[52:55], a[84:87]
  v_mfma_f32_16x16x32_bf16 a[88:91], v[132:135], v[52:55], a[88:91]
  ds_read_b64_tr_b16 v[154:155], v25 offset:51200
  v_mfma_f32_16x16x32_bf16 a[92:95], v[136:139], v[52:55], a[92:95]
  v_mfma_f32_16x16x32_bf16 a[96:99], v[108:111], v[56:59], a[96:99]
  ds_read_b128 v[92:95], v19 offset:8192
  v_mfma_f32_16x16x32_bf16 a[100:103], v[112:115], v[56:59], a[100:103]
  v_mfma_f32_16x16x32_bf16 a[104:107], v[116:119], v[56:59], a[104:107]
  ds_read_b64_tr_b16 v[156:157], v26 offset:49152
  v_mfma_f32_16x16x32_bf16 a[108:111], v[120:123], v[56:59], a[108:111]
  v_mfma_f32_16x16x32_bf16 a[112:115], v[124:127], v[56:59], a[112:115]
  ds_read_b64_tr_b16 v[158:159], v26 offset:51200
  v_mfma_f32_16x16x32_bf16 a[116:119], v[128:131], v[56:59], a[116:119]
  v_mfma_f32_16x16x32_bf16 a[120:123], v[132:135], v[56:59], a[120:123]
  ds_read_b128 v[96:99], v19 offset:10240
  v_mfma_f32_16x16x32_bf16 a[124:127], v[136:139], v[56:59], a[124:127]
  v_mfma_f32_16x16x32_bf16 a[128:131], v[108:111], v[60:63], a[128:131]
  ds_read_b64_tr_b16 v[160:161], v27 offset:49152
  v_mfma_f32_16x16x32_bf16 a[132:135], v[112:115], v[60:63], a[132:135]
  v_mfma_f32_16x16x32_bf16 a[136:139], v[116:119], v[60:63], a[136:139]
  ds_read_b64_tr_b16 v[162:163], v27 offset:51200
  v_mfma_f32_16x16x32_bf16 a[140:143], v[120:123], v[60:63], a[140:143]
  v_mfma_f32_16x16x32_bf16 a[144:147], v[124:127], v[60:63], a[144:147]
  ds_read_b128 v[100:103], v19 offset:12288
  v_mfma_f32_16x16x32_bf16 a[148:151], v[128:131], v[60:63], a[148:151]
  v_mfma_f32_16x16x32_bf16 a[152:155], v[132:135], v[60:63], a[152:155]
  ds_read_b64_tr_b16 v[164:165], v28 offset:49152
  v_mfma_f32_16x16x32_bf16 a[156:159], v[136:139], v[60:63], a[156:159]
  v_mfma_f32_16x16x32_bf16 a[160:163], v[108:111], v[64:67], a[160:163]
  ds_read_b64_tr_b16 v[166:167], v28 offset:51200
  v_mfma_f32_16x16x32_bf16 a[164:167], v[112:115], v[64:67], a[164:167]
  v_mfma_f32_16x16x32_bf16 a[168:171], v[116:119], v[64:67], a[168:171]
  ds_read_b128 v[104:107], v19 offset:14336
  v_mfma_f32_16x16x32_bf16 a[172:175], v[120:123], v[64:67], a[172:175]
  v_mfma_f32_16x16x32_bf16 a[176:179], v[124:127], v[64:67], a[176:179]
  ds_read_b64_tr_b16 v[168:169], v29 offset:49152
  v_mfma_f32_16x16x32_bf16 a[180:183], v[128:131], v[64:67], a[180:183]
  v_mfma_f32_16x16x32_bf16 a[184:187], v[132:135], v[64:67], a[184:187]
  ds_read_b64_tr_b16 v[170:171], v29 offset:51200
  v_mfma_f32_16x16x32_bf16 a[188:191], v[136:139], v[64:67], a[188:191]
  v_mfma_f32_16x16x32_bf16 a[192:195], v[108:111], v[68:71], a[192:195]
  v_mfma_f32_16x16x32_bf16 a[196:199], v[112:115], v[68:71], a[196:199]
  v_mfma_f32_16x16x32_bf16 a[200:203], v[116:119], v[68:71], a[200:203]
  v_mfma_f32_16x16x32_bf16 a[204:207], v[120:123], v[68:71], a[204:207]
  v_mfma_f32_16x16x32_bf16 a[208:211], v[124:127], v[68:71], a[208:211]
  v_mfma_f32_16x16x32_bf16 a[212:215], v[128:131], v[68:71], a[212:215]
  v_mfma_f32_16x16x32_bf16 a[216:219], v[132:135], v[68:71], a[216:219]
  v_mfma_f32_16x16x32_bf16 a[220:223], v[136:139], v[68:71], a[220:223]
  v_mfma_f32_16x16x32_bf16 a[224:227], v[108:111], v[72:75], a[224:227]
  v_mfma_f32_16x16x32_bf16 a[228:231], v[112:115], v[72:75], a[228:231]
  v_mfma_f32_16x16x32_bf16 a[232:235], v[116:119], v[72:75], a[232:235]
  v_mfma_f32_16x16x32_bf16 a[236:239], v[120:123], v[72:75], a[236:239]
  v_mfma_f32_16x16x32_bf16 a[240:243], v[124:127], v[72:75], a[240:243]
  v_mfma_f32_16x16x32_bf16 a[244:247], v[128:131], v[72:75], a[244:247]
  v_mfma_f32_16x16x32_bf16 a[248:251], v[132:135], v[72:75], a[248:251]
  v_mfma_f32_16x16x32_bf16 a[252:255], v[136:139], v[72:75], a[252:255]
  s_waitcnt lgkmcnt(0)
  v_mfma_f32_16x16x32_bf16 a[0:3], v[140:143], v[76:79], a[0:3]
  s_waitcnt vmcnt(0)
  s_barrier
  s_add_u32 m0, s52, 0
  v_mfma_f32_16x16x32_bf16 a[4:7], v[144:147], v[76:79], a[4:7]
  buffer_load_dwordx4 v2, s[8:11], s20 offen  lds
  ds_read_b128 v[44:47], v20 offset:0
  v_mfma_f32_16x16x32_bf16 a[8:11], v[148:151], v[76:79], a[8:11]
  v_mfma_f32_16x16x32_bf16 a[12:15], v[152:155], v[76:79], a[12:15]
  ds_read_b64_tr_b16 v[108:109], v30 offset:32768
  s_add_u32 m0, s53, 0
  v_mfma_f32_16x16x32_bf16 a[16:19], v[156:159], v[76:79], a[16:19]
  buffer_load_dwordx4 v10, s[12:15], s21 offen  lds
  v_mfma_f32_16x16x32_bf16 a[20:23], v[160:163], v[76:79], a[20:23]
  ds_read_b64_tr_b16 v[110:111], v30 offset:34816
  v_mfma_f32_16x16x32_bf16 a[24:27], v[164:167], v[76:79], a[24:27]
  v_mfma_f32_16x16x32_bf16 a[28:31], v[168:171], v[76:79], a[28:31]
  ds_read_b128 v[48:51], v20 offset:2048
  s_add_u32 m0, s52, 1024
  v_mfma_f32_16x16x32_bf16 a[32:35], v[140:143], v[80:83], a[32:35]
  buffer_load_dwordx4 v3, s[8:11], s20 offen  lds
  v_mfma_f32_16x16x32_bf16 a[36:39], v[144:147], v[80:83], a[36:39]
  ds_read_b64_tr_b16 v[112:113], v31 offset:32768
  v_mfma_f32_16x16x32_bf16 a[40:43], v[148:151], v[80:83], a[40:43]
  v_mfma_f32_16x16x32_bf16 a[44:47], v[152:155], v[80:83], a[44:47]
  ds_read_b64_tr_b16 v[114:115], v31 offset:34816
  s_add_u32 m0, s53, 1024
  v_mfma_f32_16x16x32_bf16 a[48:51], v[156:159], v[80:83], a[48:51]
  buffer_load_dwordx4 v11, s[12:15], s21 offen  lds
  v_mfma_f32_16x16x32_bf16 a[52:55], v[160:163], v[80:83], a[52:55]
  ds_read_b128 v[52:55], v20 offset:4096
  v_mfma_f32_16x16x32_bf16 a[56:59], v[164:167], v[80:83], a[56:59]
  s_add_u32 m0, s52, 2048
  v_mfma_f32_16x16x32_bf16 a[60:63], v[168:171], v[80:83], a[60:63]
  buffer_load_dwordx4 v4, s[8:11], s20 offen  lds
  ds_read_b64_tr_b16 v[116:117], v32 offset:32768
  v_mfma_f32_16x16x32_bf16 a[64:67], v[140:143], v[84:87], a[64:67]
  v_mfma_f32_16x16x32_bf16 a[68:71], v[144:147], v[84:87], a[68:71]
  ds_read_b64_tr_b16 v[118:119], v32 offset:34816
  v_mfma_f32_16x16x32_bf16 a[72:75], v[148:151], v[84:87], a[72:75]
  s_add_u32 m0, s53, 2048
  v_mfma_f32_16x16x32_bf16 a[76:79], v[152:155], v[84:87], a[76:79]
  buffer_load_dwordx4 v12, s[12:15], s21 offen  lds
  ds_read_b128 v[56:59], v20 offset:6144
  v_mfma_f32_16x16x32_bf16 a[80:83], v[156:159], v[84:87], a[80:83]
  v_mfma_f32_16x16x32_bf16 a[84:87], v[160:163], v[84:87], a[84:87]
  ds_read_b64_tr_b16 v[120:121], v33 offset:32768
  v_mfma_f32_16x16x32_bf16 a[88:91], v[164:167], v[84:87], a[88:91]
  s_add_u32 m0, s52, 3072
  v_mfma_f32_16x16x32_bf16 a[92:95], v[168:171], v[84:87], a[92:95]
  buffer_load_dwordx4 v5, s[8:11], s20 offen  lds
  ds_read_b64_tr_b16 v[122:123], v33 offset:34816
  v_mfma_f32_16x16x32_bf16 a[96:99], v[140:143], v[88:91], a[96:99]
  v_mfma_f32_16x16x32_bf16 a[100:103], v[144:147], v[88:91], a[100:103]
  ds_read_b128 v[60:63], v20 offset:8192
  s_add_u32 m0, s53, 3072
  v_mfma_f32_16x16x32_bf16 a[104:107], v[148:151], v[88:91], a[104:107]
  buffer_load_dwordx4 v13, s[12:15], s21 offen  lds
  v_mfma_f32_16x16x32_bf16 a[108:111], v[152:155], v[88:91], a[108:111]
  ds_read_b64_tr_b16 v[124:125], v34 offset:32768
  v_mfma_f32_16x16x32_bf16 a[112:115], v[156:159], v[88:91], a[112:115]
  v_mfma_f32_16x16x32_bf16 a[116:119], v[160:163], v[88:91], a[116:119]
  ds_read_b64_tr_b16 v[126:127], v34 offset:34816
  s_add_u32 m0, s52, 4096
  v_mfma_f32_16x16x32_bf16 a[120:123], v[164:167], v[88:91], a[120:123]
  buffer_load_dwordx4 v6, s[8:11], s20 offen  lds
  v_mfma_f32_16x16x32_bf16 a[124:127], v[168:171], v[88:91], a[124:127]
  ds_read_b128 v[64:67], v20 offset:10240
  v_mfma_f32_16x16x32_bf16 a[128:131], v[140:143], v[92:95], a[128:131]
  v_mfma_f32_16x16x32_bf16 a[132:135], v[144:147], v[92:95], a[132:135]
  ds_read_b64_tr_b16 v[128:129], v35 offset:32768
  s_add_u32 m0, s53, 4096
  v_mfma_f32_16x16x32_bf16 a[136:139], v[148:151], v[92:95], a[136:139]
  buffer_load_dwordx4 v14, s[12:15], s21 offen  lds
  v_mfma_f32_16x16x32_bf16 a[140:143], v[152:155], v[92:95], a[140:143]
  ds_read_b64_tr_b16 v[130:131], v35 offset:34816
  v_mfma_f32_16x16x32_bf16 a[144:147], v[156:159], v[92:95], a[144:147]
  v_mfma_f32_16x16x32_bf16 a[148:151], v[160:163], v[92:95], a[148:151]
  ds_read_b128 v[68:71], v20 offset:12288
  s_add_u32 m0, s52, 5120
  v_mfma_f32_16x16x32_bf16 a[152:155], v[164:167], v[92:95], a[152:155]
  buffer_load_dwordx4 v7, s[8:11], s20 offen  lds
  v_mfma_f32_16x16x32_bf16 a[156:159], v[168:171], v[92:95], a[156:159]
  ds_read_b64_tr_b16 v[132:133], v36 offset:32768
  v_mfma_f32_16x16x32_bf16 a[160:163], v[140:143], v[96:99], a[160:163]
  s_add_u32 m0, s53, 5120
  v_mfma_f32_16x16x32_bf16 a[164:167], v[144:147], v[96:99], a[164:167]
  buffer_load_dwordx4 v15, s[12:15], s21 offen  lds
  ds_read_b64_tr_b16 v[134:135], v36 offset:34816
  v_mfma_f32_16x16x32_bf16 a[168:171], v[148:151], v[96:99], a[168:171]
  v_mfma_f32_16x16x32_bf16 a[172:175], v[152:155], v[96:99], a[172:175]
  ds_read_b128 v[72:75], v20 offset:14336
  v_mfma_f32_16x16x32_bf16 a[176:179], v[156:159], v[96:99], a[176:179]
  s_add_u32 m0, s52, 6144
  v_mfma_f32_16x16x32_bf16 a[180:183], v[160:163], v[96:99], a[180:183]
  buffer_load_dwordx4 v8, s[8:11], s20 offen  lds
  ds_read_b64_tr_b16 v[136:137], v37 offset:32768
  v_mfma_f32_16x16x32_bf16 a[184:187], v[164:167], v[96:99], a[184:187]
  v_mfma_f32_16x16x32_bf16 a[188:191], v[168:171], v[96:99], a[188:191]
  ds_read_b64_tr_b16 v[138:139], v37 offset:34816
  v_mfma_f32_16x16x32_bf16 a[192:195], v[140:143], v[100:103], a[192:195]
  s_add_u32 m0, s53, 6144
  v_mfma_f32_16x16x32_bf16 a[196:199], v[144:147], v[100:103], a[196:199]
  buffer_load_dwordx4 v16, s[12:15], s21 offen  lds
  v_mfma_f32_16x16x32_bf16 a[200:203], v[148:151], v[100:103], a[200:203]
  v_mfma_f32_16x16x32_bf16 a[204:207], v[152:155], v[100:103], a[204:207]
  s_add_u32 m0, s52, 7168
  v_mfma_f32_16x16x32_bf16 a[208:211], v[156:159], v[100:103], a[208:211]
  buffer_load_dwordx4 v9, s[8:11], s20 offen  lds
  v_mfma_f32_16x16x32_bf16 a[212:215], v[160:163], v[100:103], a[212:215]
  v_mfma_f32_16x16x32_bf16 a[216:219], v[164:167], v[100:103], a[216:219]
  v_mfma_f32_16x16x32_bf16 a[220:223], v[168:171], v[100:103], a[220:223]
  s_add_u32 m0, s53, 7168
  v_mfma_f32_16x16x32_bf16 a[224:227], v[140:143], v[104:107], a[224:227]
  buffer_load_dwordx4 v17, s[12:15], s21 offen  lds
  v_mfma_f32_16x16x32_bf16 a[228:231], v[144:147], v[104:107], a[228:231]
  v_mfma_f32_16x16x32_bf16 a[232:235], v[148:151], v[104:107], a[232:235]
  v_mfma_f32_16x16x32_bf16 a[236:239], v[152:155], v[104:107], a[236:239]
  s_add_u32 s20, s20, 128
  v_mfma_f32_16x16x32_bf16 a[240:243], v[156:159], v[104:107], a[240:243]
  s_add_u32 s21, s21, s51
  v_mfma_f32_16x16x32_bf16 a[244:247], v[160:163], v[104:107], a[244:247]
  v_mfma_f32_16x16x32_bf16 a[248:251], v[164:167], v[104:107], a[248:251]
  v_mfma_f32_16x16x32_bf16 a[252:255], v[168:171], v[104:107], a[252:255]
  s_waitcnt lgkmcnt(0)
  s_cmp_eq_u32 s25, 1
  s_cbranch_scc1 L_g1_cw
L_g1_cwb:
  v_mfma_f32_16x16x32_bf16 a[0:3], v[108:111], v[44:47], a[0:3]
  ds_read_b128 v[76:79], v21 offset:0
  v_mfma_f32_16x16x32_bf16 a[4:7], v[112:115], v[44:47], a[4:7]
  v_mfma_f32_16x16x32_bf16 a[8:11], v[116:119], v[44:47], a[8:11]
  ds_read_b64_tr_b16 v[140:141], v30 offset:49152
  v_mfma_f32_16x16x32_bf16 a[12:15], v[120:123], v[44:47], a[12:15]
  v_mfma_f32_16x16x32_bf16 a[16:19], v[124:127], v[44:47], a[16:19]
  ds_read_b64_tr_b16 v[142:143], v30 offset:51200
  v_mfma_f32_16x16x32_bf16 a[20:23], v[128:131], v[44:47], a[20:23]
  v_mfma_f32_16x16x32_bf16 a[24:27], v[132:135], v[44:47], a[24:27]
  ds_read_b128 v[80:83], v21 offset:2048
  v_mfma_f32_16x16x32_bf16 a[28:31], v[136:139], v[44:47], a[28:31]
  v_mfma_f32_16x16x32_bf16 a[32:35], v[108:111], v[48:51], a[32:35]
  ds_read_b64_tr_b16 v[144:145], v31 offset:49152
  v_mfma_f32_16x16x32_bf16 a[36:39], v[112:115], v[48:51], a[36:39]
  v_mfma_f32_16x16x32_bf16 a[40:43], v[116:119], v[48:51], a[40:43]
  ds_read_b64_tr_b16 v[146:147], v31 offset:51200
  v_mfma_f32_16x16x32_bf16 a[44:47], v[120:123], v[48:51], a[44:47]
  v_mfma_f32_16x16x32_bf16 a[48:51], v[124:127], v[48:51], a[48:51]
  ds_read_b128 v[84:87], v21 offset:4096
  v_mfma_f32_16x16x32_bf16 a[52:55], v[128:131], v[48:51], a[52:55]
  v_mfma_f32_16x16x32_bf16 a[56:59], v[132:135], v[48:51], a[56:59]
  ds_read_b64_tr_b16 v[148:149], v32 offset:49152
  v_mfma_f32_16x16x32_bf16 a[60:63], v[136:139], v[48:51], a[60:63]
  v_mfma_f32_16x16x32_bf16 a[64:67], v[108:111], v[52:55], a[64:67]
  ds_read_b64_tr_b16 v[150:151], v32 offset:51200
  v_mfma_f32_16x16x32_bf16 a[68:71], v[112:115], v[52:55], a[68:71]
  v_mfma_f32_16x16x32_bf16 a[72:75], v[116:119], v[52:55], a[72:75]
  ds_read_b128 v[88:91], v21 offset:6144
  v_mfma_f32_16x16x32_bf16 a[76:79], v[120:123], v[52:55], a[76:79]
  v_mfma_f32_16x16x32_bf16 a[80:83], v[124:127], v[52:55], a[80:83]
  ds_read_b64_tr_b16 v[152:153], v33 offset:49152
  v_mfma_f32_16x16x32_bf16 a[84:87], v[128:131], v[52:55], a[84:87]
  v_mfma_f32_16x16x32_bf16 a[88:91], v[132:135], v[52:55], a[88:91]
  ds_read_b64_tr_b16 v[154:155], v33 offset:51200
  v_mfma_f32_16x16x32_bf16 a[92:95], v[136:139], v[52:55], a[92:95]
  v_mfma_f32_16x16x32_bf16 a[96:99], v[108:111], v[56:59], a[96:99]
  ds_read_b128 v[92:95], v21 offset:8192
  v_mfma_f32_16x16x32_bf16 a[100:103], v[112:115], v[56:59], a[100:103]
  v_mfma_f32_16x16x32_bf16 a[104:107], v[116:119], v[56:59], a[104:107]
  ds_read_b64_tr_b16 v[156:157], v34 offset:49152
  v_mfma_f32_16x16x32_bf16 a[108:111], v[120:123], v[56:59], a[108:111]
  v_mfma_f32_16x16x32_bf16 a[112:115], v[124:127], v[56:59], a[112:115]
  ds_read_b64_tr_b16 v[158:159], v34 offset:51200
  v_mfma_f32_16x16x32_bf16 a[116:119], v[128:131], v[56:59], a[116:119]
  v_mfma_f32_16x16x32_bf16 a[120:123], v[132:135], v[56:59], a[120:123]
  ds_read_b128 v[96:99], v21 offset:10240
  v_mfma_f32_16x16x32_bf16 a[124:127], v[136:139], v[56:59], a[124:127]
  v_mfma_f32_16x16x32_bf16 a[128:131], v[108:111], v[60:63], a[128:131]
  ds_read_b64_tr_b16 v[160:161], v35 offset:49152
  v_mfma_f32_16x16x32_bf16 a[132:135], v[112:115], v[60:63], a[132:135]
  v_mfma_f32_16x16x32_bf16 a[136:139], v[116:119], v[60:63], a[136:139]
  ds_read_b64_tr_b16 v[162:163], v35 offset:51200
  v_mfma_f32_16x16x32_bf16 a[140:143], v[120:123], v[60:63], a[140:143]
  v_mfma_f32_16x16x32_bf16 a[144:147], v[124:127], v[60:63], a[144:147]
  ds_read_b128 v[100:103], v21 offset:12288
  v_mfma_f32_16x16x32_bf16 a[148:151], v[128:131], v[60:63], a[148:151]
  v_mfma_f32_16x16x32_bf16 a[152:155], v[132:135], v[60:63], a[152:155]
  ds_read_b64_tr_b16 v[164:165], v36 offset:49152
  v_mfma_f32_16x16x32_bf16 a[156:159], v[136:139], v[60:63], a[156:159]
  v_mfma_f32_16x16x32_bf16 a[160:163], v[108:111], v[64:67], a[160:163]
  ds_read_b64_tr_b16 v[166:167], v36 offset:51200
  v_mfma_f32_16x16x32_bf16 a[164:167], v[112:115], v[64:67], a[164:167]
  v_mfma_f32_16x16x32_bf16 a[168:171], v[116:119], v[64:67], a[168:171]
  ds_read_b128 v[104:107], v21 offset:14336
  v_mfma_f32_16x16x32_bf16 a[172:175], v[120:123], v[64:67], a[172:175]
  v_mfma_f32_16x16x32_bf16 a[176:179], v[124:127], v[64:67], a[176:179]
  ds_read_b64_tr_b16 v[168:169], v37 offset:49152
  v_mfma_f32_16x16x32_bf16 a[180:183], v[128:131], v[64:67], a[180:183]
  v_mfma_f32_16x16x32_bf16 a[184:187], v[132:135], v[64:67], a[184:187]
  ds_read_b64_tr_b16 v[170:171], v37 offset:51200
  v_mfma_f32_16x16x32_bf16 a[188:191], v[136:139], v[64:67], a[188:191]
  v_mfma_f32_16x16x32_bf16 a[192:195], v[108:111], v[68:71], a[192:195]
  v_mfma_f32_16x16x32_bf16 a[196:199], v[112:115], v[68:71], a[196:199]
  v_mfma_f32_16x16x32_bf16 a[200:203], v[116:119], v[68:71], a[200:203]
  v_mfma_f32_16x16x32_bf16 a[204:207], v[120:123], v[68:71], a[204:207]
  v_mfma_f32_16x16x32_bf16 a[208:211], v[124:127], v[68:71], a[208:211]
  v_mfma_f32_16x16x32_bf16 a[212:215], v[128:131], v[68:71], a[212:215]
  v_mfma_f32_16x16x32_bf16 a[216:219], v[132:135], v[68:71], a[216:219]
  v_mfma_f32_16x16x32_bf16 a[220:223], v[136:139], v[68:71], a[220:223]
  v_mfma_f32_16x16x32_bf16 a[224:227], v[108:111], v[72:75], a[224:227]
  v_mfma_f32_16x16x32_bf16 a[228:231], v[112:115], v[72:75], a[228:231]
  v_mfma_f32_16x16x32_bf16 a[232:235], v[116:119], v[72:75], a[232:235]
  v_mfma_f32_16x16x32_bf16 a[236:239], v[120:123], v[72:75], a[236:239]
  v_mfma_f32_16x16x32_bf16 a[240:243], v[124:127], v[72:75], a[240:243]
  v_mfma_f32_16x16x32_bf16 a[244:247], v[128:131], v[72:75], a[244:247]
  v_mfma_f32_16x16x32_bf16 a[248:251], v[132:135], v[72:75], a[248:251]
  v_mfma_f32_16x16x32_bf16 a[252:255], v[136:139], v[72:75], a[252:255]
  s_waitcnt lgkmcnt(0)
  v_mfma_f32_16x16x32_bf16 a[0:3], v[140:143], v[76:79], a[0:3]
  s_waitcnt vmcnt(0)
  s_barrier
  s_cmp_le_u32 s25, 2
  s_cbranch_scc1 L_g1_cr
L_g1_crb:
  s_add_u32 m0, s52, 65536
  v_mfma_f32_16x16x32_bf16 a[4:7], v[144:147], v[76:79], a[4:7]
  buffer_load_dwordx4 v2, s[8:11], s20 offen  lds
  ds_read_b128 v[44:47], v18 offset:0
  v_mfma_f32_16x16x32_bf16 a[8:11], v[148:151], v[76:79], a[8:11]
  v_mfma_f32_16x16x32_bf16 a[12:15], v[152:155], v[76:79], a[12:15]
  ds_read_b64_tr_b16 v[108:109], v22 offset:32768
  s_add_u32 m0, s53, 65536
  v_mfma_f32_16x16x32_bf16 a[16:19], v[156:159], v[76:79], a[16:19]
  buffer_load_dwordx4 v10, s[12:15], s21 offen  lds
  v_mfma_f32_16x16x32_bf16 a[20:23], v[160:163], v[76:79], a[20:23]
  ds_read_b64_tr_b16 v[110:111], v22 offset:34816
  v_mfma_f32_16x16x32_bf16 a[24:27], v[164:167], v[76:79], a[24:27]
  v_mfma_f32_16x16x32_bf16 a[28:31], v[168:171], v[76:79], a[28:31]
  ds_read_b128 v[48:51], v18 offset:2048
  s_add_u32 m0, s52, 66560
  v_mfma_f32_16x16x32_bf16 a[32:35], v[140:143], v[80:83], a[32:35]
  buffer_load_dwordx4 v3, s[8:11], s20 offen  lds
  v_mfma_f32_16x16x32_bf16 a[36:39], v[144:147], v[80:83], a[36:39]
  ds_read_b64_tr_b16 v[112:113], v23 offset:32768
  v_mfma_f32_16x16x32_bf16 a[40:43], v[148:151], v[80:83], a[40:43]
  v_mfma_f32_16x16x32_bf16 a[44:47], v[152:155], v[80:83], a[44:47]
  ds_read_b64_tr_b16 v[114:115], v23 offset:34816
  s_add_u32 m0, s53, 66560
  v_mfma_f32_16x16x32_bf16 a[48:51], v[156:159], v[80:83], a[48:51]
  buffer_load_dwordx4 v11, s[12:15], s21 offen  lds
  v_mfma_f32_16x16x32_bf16 a[52:55], v[160:163], v[80:83], a[52:55]
  ds_read_b128 v[52:55], v18 offset:4096
  v_mfma_f32_16x16x32_bf16 a[56:59], v[164:167], v[80:83], a[56:59]
  s_add_u32 m0, s52, 67584
  v_mfma_f32_16x16x32_bf16 a[60:63], v[168:171], v[80:83], a[60:63]
  buffer_load_dwordx4 v4, s[8:11], s20 offen  lds
  ds_read_b64_tr_b16 v[116:117], v24 offset:32768
  v_mfma_f32_16x16x32_bf16 a[64:67], v[140:143], v[84:87], a[64:67]
  v_mfma_f32_16x16x32_bf16 a[68:71], v[144:147], v[84:87], a[68:71]
  ds_read_b64_tr_b16 v[118:119], v24 offset:34816
  v_mfma_f32_16x16x32_bf16 a[72:75], v[148:151], v[84:87], a[72:75]
  s_add_u32 m0, s53, 67584
  v_mfma_f32_16x16x32_bf16 a[76:79], v[152:155], v[84:87], a[76:79]
  buffer_load_dwordx4 v12, s[12:15], s21 offen  lds
  ds_read_b128 v[56:59], v18 offset:6144
  v_mfma_f32_16x16x32_bf16 a[80:83], v[156:159], v[84:87], a[80:83]
  v_mfma_f32_16x16x32_bf16 a[84:87], v[160:163], v[84:87], a[84:87]
  ds_read_b64_tr_b16 v[120:121], v25 offset:32768
  v_mfma_f32_16x16x32_bf16 a[88:91], v[164:167], v[84:87], a[88:91]
  s_add_u32 m0, s52, 68608
  v_mfma_f32_16x16x32_bf16 a[92:95], v[168:171], v[84:87], a[92:95]
  buffer_load_dwordx4 v5, s[8:11], s20 offen  lds
  ds_read_b64_tr_b16 v[122:123], v25 offset:34816
  v_mfma_f32_16x16x32_bf16 a[96:99], v[140:143], v[88:91], a[96:99]
  v_mfma_f32_16x16x32_bf16 a[100:103], v[144:147], v[88:91], a[100:103]
  ds_read_b128 v[60:63], v18 offset:8192
  s_add_u32 m0, s53, 68608
  v_mfma_f32_16x16x32_bf16 a[104:107], v[148:151], v[88:91], a[104:107]
  buffer_load_dwordx4 v13, s[12:15], s21 offen  lds
  v_mfma_f32_16x16x32_bf16 a[108:111], v[152:155], v[88:91], a[108:111]
  ds_read_b64_tr_b16 v[124:125], v26 offset:32768
  v_mfma_f32_16x16x32_bf16 a[112:115], v[156:159], v[88:91], a[112:115]
  v_mfma_f32_16x16x32_bf16 a[116:119], v[160:163], v[88:91], a[116:119]
  ds_read_b64_tr_b16 v[126:127], v26 offset:34816
  s_add_u32 m0, s52, 69632
  v_mfma_f32_16x16x32_bf16 a[120:123], v[164:167], v[88:91], a[120:123]
  buffer_load_dwordx4 v6, s[8:11], s20 offen  lds
  v_mfma_f32_16x16x32_bf16 a[124:127], v[168:171], v[88:91], a[124:127]
  ds_read_b128 v[64:67], v18 offset:10240
  v_mfma_f32_16x16x32_bf16 a[128:131], v[140:143], v[92:95], a[128:131]
  v_mfma_f32_16x16x32_bf16 a[132:135], v[144:147], v[92:95], a[132:135]
  ds_read_b64_tr_b16 v[128:129], v27 offset:32768
  s_add_u32 m0, s53, 69632
  v_mfma_f32_16x16x32_bf16 a[136:139], v[148:151], v[92:95], a[136:139]
  buffer_load_dwordx4 v14, s[12:15], s21 offen  lds
  v_mfma_f32_16x16x32_bf16 a[140:143], v[152:155], v[92:95], a[140:143]
  ds_read_b64_tr_b16 v[130:131], v27 offset:34816
  v_mfma_f32_16x16x32_bf16 a[144:147], v[156:159], v[92:95], a[144:147]
  v_mfma_f32_16x16x32_bf16 a[148:151], v[160:163], v[92:95], a[148:151]
  ds_read_b128 v[68:71], v18 offset:12288
  s_add_u32 m0, s52, 70656
  v_mfma_f32_16x16x32_bf16 a[152:155], v[164:167], v[92:95], a[152:155]
  buffer_load_dwordx4 v7, s[8:11], s20 offen  lds
  v_mfma_f32_16x16x32_bf16 a[156:159], v[168:171], v[92:95], a[156:159]
  ds_read_b64_tr_b16 v[132:133], v28 offset:32768
  v_mfma_f32_16x16x32_bf16 a[160:163], v[140:143], v[96:99], a[160:163]
  s_add_u32 m0, s53, 70656
  v_mfma_f32_16x16x32_bf16 a[164:167], v[144:147], v[96:99], a[164:167]
  buffer_load_dwordx4 v15, s[12:15], s21 offen  lds
  ds_read_b64_tr_b16 v[134:135], v28 offset:34816
  v_mfma_f32_16x16x32_bf16 a[168:171], v[148:151], v[96:99], a[168:171]
  v_mfma_f32_16x16x32_bf16 a[172:175], v[152:155], v[96:99], a[172:175]
  ds_read_b128 v[72:75], v18 offset:14336
  v_mfma_f32_16x16x32_bf16 a[176:179], v[156:159], v[96:99], a[176:179]
  s_add_u32 m0, s52, 71680
  v_mfma_f32_16x16x32_bf16 a[180:183], v[160:163], v[96:99], a[180:183]
  buffer_load_dwordx4 v8, s[8:11], s20 offen  lds
  ds_read_b64_tr_b16 v[136:137], v29 offset:32768
  v_mfma_f32_16x16x32_bf16 a[184:187], v[164:167], v[96:99], a[184:187]
  v_mfma_f32_16x16x32_bf16 a[188:191], v[168:171], v[96:99], a[188:191]
  ds_read_b64_tr_b16 v[138:139], v29 offset:34816
  v_mfma_f32_16x16x32_bf16 a[192:195], v[140:143], v[100:103], a[192:195]
  s_add_u32 m0, s53, 71680
  v_mfma_f32_16x16x32_bf16 a[196:199], v[144:147], v[100:103], a[196:199]
  buffer_load_dwordx4 v16, s[12:15], s21 offen  lds
  v_mfma_f32_16x16x32_bf16 a[200:203], v[148:151], v[100:103], a[200:203]
  v_mfma_f32_16x16x32_bf16 a[204:207], v[152:155], v[100:103], a[204:207]
  s_add_u32 m0, s52, 72704
  v_mfma_f32_16x16x32_bf16 a[208:211], v[156:159], v[100:103], a[208:211]
  buffer_load_dwordx4 v9, s[8:11], s20 offen  lds
  v_mfma_f32_16x16x32_bf16 a[212:215], v[160:163], v[100:103], a[212:215]
  v_mfma_f32_16x16x32_bf16 a[216:219], v[164:167], v[100:103], a[216:219]
  v_mfma_f32_16x16x32_bf16 a[220:223], v[168:171], v[100:103], a[220:223]
  s_add_u32 m0, s53, 72704
  v_mfma_f32_16x16x32_bf16 a[224:227], v[140:143], v[104:107], a[224:227]
  buffer_load_dwordx4 v17, s[12:15], s21 offen  lds
  v_mfma_f32_16x16x32_bf16 a[228:231], v[144:147], v[104:107], a[228:231]
  v_mfma_f32_16x16x32_bf16 a[232:235], v[148:151], v[104:107], a[232:235]
  v_mfma_f32_16x16x32_bf16 a[236:239], v[152:155], v[104:107], a[236:239]
  s_add_u32 s20, s20, 128
  v_mfma_f32_16x16x32_bf16 a[240:243], v[156:159], v[104:107], a[240:243]
  s_add_u32 s21, s21, s51
  v_mfma_f32_16x16x32_bf16 a[244:247], v[160:163], v[104:107], a[244:247]
  v_mfma_f32_16x16x32_bf16 a[248:251], v[164:167], v[104:107], a[248:251]
  v_mfma_f32_16x16x32_bf16 a[252:255], v[168:171], v[104:107], a[252:255]
  s_branch L_g1_loop
L_g1_fin:
  s_mov_b32 s59, 1
  s_mov_b32 s60, s22
  s_mov_b32 s61, s26
  s_add_u32 s62, s38, 0x3d00000
  s_mov_b32 s63, s98
  s_waitcnt lgkmcnt(0)
  v_min_u32 v245, 270, v246
  v_lshlrev_b32 v245, 2, v245
  v_add_u32 v245, 147648, v245
  ds_read_b32 v245, v245
  v_readfirstlane_b32 s34, v246
  s_add_u32 s34, s34, 32
  v_mfma_f32_16x16x32_bf16 a[0:3], v[108:111], v[44:47], a[0:3]
  ds_read_b128 v[76:79], v19 offset:0
  v_mfma_f32_16x16x32_bf16 a[4:7], v[112:115], v[44:47], a[4:7]
  v_mfma_f32_16x16x32_bf16 a[8:11], v[116:119], v[44:47], a[8:11]
  ds_read_b64_tr_b16 v[140:141], v22 offset:49152
  v_mfma_f32_16x16x32_bf16 a[12:15], v[120:123], v[44:47], a[12:15]
  v_mfma_f32_16x16x32_bf16 a[16:19], v[124:127], v[44:47], a[16:19]
  ds_read_b64_tr_b16 v[142:143], v22 offset:51200
  v_mfma_f32_16x16x32_bf16 a[20:23], v[128:131], v[44:47], a[20:23]
  v_mfma_f32_16x16x32_bf16 a[24:27], v[132:135], v[44:47], a[24:27]
  ds_read_b128 v[80:83], v19 offset:2048
  v_mfma_f32_16x16x32_bf16 a[28:31], v[136:139], v[44:47], a[28:31]
  v_mfma_f32_16x16x32_bf16 a[32:35], v[108:111], v[48:51], a[32:35]
  ds_read_b64_tr_b16 v[144:145], v23 offset:49152
  v_mfma_f32_16x16x32_bf16 a[36:39], v[112:115], v[48:51], a[36:39]
  v_mfma_f32_16x16x32_bf16 a[40:43], v[116:119], v[48:51], a[40:43]
  ds_read_b64_tr_b16 v[146:147], v23 offset:51200
  v_mfma_f32_16x16x32_bf16 a[44:47], v[120:123], v[48:51], a[44:47]
  v_mfma_f32_16x16x32_bf16 a[48:51], v[124:127], v[48:51], a[48:51]
  ds_read_b128 v[84:87], v19 offset:4096
  v_mfma_f32_16x16x32_bf16 a[52:55], v[128:131], v[48:51], a[52:55]
  v_mfma_f32_16x16x32_bf16 a[56:59], v[132:135], v[48:51], a[56:59]
  ds_read_b64_tr_b16 v[148:149], v24 offset:49152
  v_mfma_f32_16x16x32_bf16 a[60:63], v[136:139], v[48:51], a[60:63]
  v_mfma_f32_16x16x32_bf16 a[64:67], v[108:111], v[52:55], a[64:67]
  ds_read_b64_tr_b16 v[150:151], v24 offset:51200
  v_mfma_f32_16x16x32_bf16 a[68:71], v[112:115], v[52:55], a[68:71]
  v_mfma_f32_16x16x32_bf16 a[72:75], v[116:119], v[52:55], a[72:75]
  ds_read_b128 v[88:91], v19 offset:6144
  v_mfma_f32_16x16x32_bf16 a[76:79], v[120:123], v[52:55], a[76:79]
  v_mfma_f32_16x16x32_bf16 a[80:83], v[124:127], v[52:55], a[80:83]
  ds_read_b64_tr_b16 v[152:153], v25 offset:49152
  v_mfma_f32_16x16x32_bf16 a[84:87], v[128:131], v[52:55], a[84:87]
  v_mfma_f32_16x16x32_bf16 a[88:91], v[132:135], v[52:55], a[88:91]
  ds_read_b64_tr_b16 v[154:155], v25 offset:51200
  v_mfma_f32_16x16x32_bf16 a[92:95], v[136:139], v[52:55], a[92:95]
  v_mfma_f32_16x16x32_bf16 a[96:99], v[108:111], v[56:59], a[96:99]
  ds_read_b128 v[92:95], v19 offset:8192
  v_mfma_f32_16x16x32_bf16 a[100:103], v[112:115], v[56:59], a[100:103]
  v_mfma_f32_16x16x32_bf16 a[104:107], v[116:119], v[56:59], a[104:107]
  ds_read_b64_tr_b16 v[156:157], v26 offset:49152
  v_mfma_f32_16x16x32_bf16 a[108:111], v[120:123], v[56:59], a[108:111]
  v_mfma_f32_16x16x32_bf16 a[112:115], v[124:127], v[56:59], a[112:115]
  ds_read_b64_tr_b16 v[158:159], v26 offset:51200
  v_mfma_f32_16x16x32_bf16 a[116:119], v[128:131], v[56:59], a[116:119]
  v_mfma_f32_16x16x32_bf16 a[120:123], v[132:135], v[56:59], a[120:123]
  ds_read_b128 v[96:99], v19 offset:10240
  v_mfma_f32_16x16x32_bf16 a[124:127], v[136:139], v[56:59], a[124:127]
  v_mfma_f32_16x16x32_bf16 a[128:131], v[108:111], v[60:63], a[128:131]
  ds_read_b64_tr_b16 v[160:161], v27 offset:49152
  v_mfma_f32_16x16x32_bf16 a[132:135], v[112:115], v[60:63], a[132:135]
  v_mfma_f32_16x16x32_bf16 a[136:139], v[116:119], v[60:63], a[136:139]
  ds_read_b64_tr_b16 v[162:163], v27 offset:51200
  v_mfma_f32_16x16x32_bf16 a[140:143], v[120:123], v[60:63], a[140:143]
  v_mfma_f32_16x16x32_bf16 a[144:147], v[124:127], v[60:63], a[144:147]
  ds_read_b128 v[100:103], v19 offset:12288
  v_mfma_f32_16x16x32_bf16 a[148:151], v[128:131], v[60:63], a[148:151]
  v_mfma_f32_16x16x32_bf16 a[152:155], v[132:135], v[60:63], a[152:155]
  ds_read_b64_tr_b16 v[164:165], v28 offset:49152
  v_mfma_f32_16x16x32_bf16 a[156:159], v[136:139], v[60:63], a[156:159]
  v_mfma_f32_16x16x32_bf16 a[160:163], v[108:111], v[64:67], a[160:163]
  ds_read_b64_tr_b16 v[166:167], v28 offset:51200
  v_mfma_f32_16x16x32_bf16 a[164:167], v[112:115], v[64:67], a[164:167]
  v_mfma_f32_16x16x32_bf16 a[168:171], v[116:119], v[64:67], a[168:171]
  ds_read_b128 v[104:107], v19 offset:14336
  v_mfma_f32_16x16x32_bf16 a[172:175], v[120:123], v[64:67], a[172:175]
  v_mfma_f32_16x16x32_bf16 a[176:179], v[124:127], v[64:67], a[176:179]
  ds_read_b64_tr_b16 v[168:169], v29 offset:49152
  v_mfma_f32_16x16x32_bf16 a[180:183], v[128:131], v[64:67], a[180:183]
  v_mfma_f32_16x16x32_bf16 a[184:187], v[132:135], v[64:67], a[184:187]
  ds_read_b64_tr_b16 v[170:171], v29 offset:51200
  v_mfma_f32_16x16x32_bf16 a[188:191], v[136:139], v[64:67], a[188:191]
  v_mfma_f32_16x16x32_bf16 a[192:195], v[108:111], v[68:71], a[192:195]
  v_mfma_f32_16x16x32_bf16 a[196:199], v[112:115], v[68:71], a[196:199]
  v_mfma_f32_16x16x32_bf16 a[200:203], v[116:119], v[68:71], a[200:203]
  v_mfma_f32_16x16x32_bf16 a[204:207], v[120:123], v[68:71], a[204:207]
  v_mfma_f32_16x16x32_bf16 a[208:211], v[124:127], v[68:71], a[208:211]
  v_mfma_f32_16x16x32_bf16 a[212:215], v[128:131], v[68:71], a[212:215]
  v_mfma_f32_16x16x32_bf16 a[216:219], v[132:135], v[68:71], a[216:219]
  v_mfma_f32_16x16x32_bf16 a[220:223], v[136:139], v[68:71], a[220:223]
  v_mfma_f32_16x16x32_bf16 a[224:227], v[108:111], v[72:75], a[224:227]
  v_mfma_f32_16x16x32_bf16 a[228:231], v[112:115], v[72:75], a[228:231]
  v_mfma_f32_16x16x32_bf16 a[232:235], v[116:119], v[72:75], a[232:235]
  v_mfma_f32_16x16x32_bf16 a[236:239], v[120:123], v[72:75], a[236:239]
  v_mfma_f32_16x16x32_bf16 a[240:243], v[124:127], v[72:75], a[240:243]
  v_mfma_f32_16x16x32_bf16 a[244:247], v[128:131], v[72:75], a[244:247]
  v_mfma_f32_16x16x32_bf16 a[248:251], v[132:135], v[72:75], a[248:251]
  v_mfma_f32_16x16x32_bf16 a[252:255], v[136:139], v[72:75], a[252:255]
  s_waitcnt lgkmcnt(0)
  v_mfma_f32_16x16x32_bf16 a[0:3], v[140:143], v[76:79], a[0:3]
  s_waitcnt vmcnt(0)
  s_barrier
  v_readfirstlane_b32 s91, v245
  s_and_b32 s35, s91, 255
  s_lshr_b32 s36, s91, 8
  s_and_b32 s36, s36, 255
  s_lshr_b32 s37, s91, 16
  s_mov_b32 s92, s24
  s_cmp_gt_u32 s35, 3
  s_cbranch_scc1 L_cd_11
  s_cmp_eq_u32 s35, 3
  s_cbranch_scc1 L_cd_9
  s_mov_b32 s8, s64
  s_and_b32 s9, s65, 0xffff
  s_mov_b32 s10, 0x400000
  s_mov_b32 s11, 0x20000
  s_cmp_eq_u32 s35, 0
  s_cselect_b64 s[88:89], s[68:69], s[70:71]
  s_cmp_eq_u32 s35, 2
  s_cselect_b64 s[88:89], s[72:73], s[88:89]
  s_mov_b32 s12, s88
  s_and_b32 s13, s89, 0xffff
  s_mov_b32 s14, 0x800000
  s_mov_b32 s15, 0x20000
  s_lshl_b32 s91, s33, 2
  s_add_u32 s91, s91, s37
  s_mov_b32 s24, 8192
  s_mov_b32 s26, 262144
  s_lshl_b32 s20, s36, 19
  s_lshl_b32 s21, s91, 9
  s_lshl_b32 s22, s35, 24
  s_lshl_b32 s90, s36, 21
  s_add_u32 s22, s22, s90
  s_lshl_b32 s90, s91, 14
  s_add_u32 s22, s22, s90
  s_lshl_b32 s38, s36, 9
  s_add_u32 s38, s38, 28672
  s_cmp_eq_u32 s35, 0
  s_cselect_b32 s38, 8192, s38
  s_cselect_b32 s98, 1, 2
  s_mov_b32 s48, s35
  s_branch L_cd_10
L_cd_11:
  s_mov_b64 vcc, 0
  s_mov_b32 s58, 0
  s_branch L_cd_12
L_cd_9:
  s_mov_b32 s8, s78
  s_and_b32 s9, s79, 0xffff
  s_mov_b32 s10, 0x400000
  s_mov_b32 s11, 0x20000
  s_mov_b32 s12, s80
  s_and_b32 s13, s81, 0xffff
  s_mov_b32 s14, 0x600000
  s_mov_b32 s15, 0x20000
  s_lshl_b32 s91, s37, 2
  s_add_u32 s91, s91, s33
  s_mov_b32 s24, 6144
  s_mov_b32 s26, 65536
  s_lshl_b32 s20, s36, 19
  s_lshl_b32 s21, s91, 9
  s_lshl_b32 s22, s37, 22
  s_lshl_b32 s90, s36, 19
  s_add_u32 s22, s22, s90
  s_lshl_b32 s90, s33, 14
  s_add_u32 s22, s22, s90
  s_add_u32 s22, s22, 0x4000000
  s_mov_b32 s38, 12288
  s_mov_b32 s48, s37
  s_mov_b32 s98, 1
L_cd_10:
  s_lshl_b32 s90, s36, 9
  s_add_u32 s38, s38, s90
  s_lshl_b32 s90, s33, 7
  s_add_u32 s38, s38, s90
  s_mov_b32 s23, 2048
  s_mov_b32 s25, 8
  s_mov_b64 vcc, -1
  s_sub_i32 s92, s24, s92
  s_lshl_b32 s51, s24, 6
  v_mul_i32_i24 v38, s92, v174
  s_mul_i32 s92, s92, 2
  s_mov_b32 s93, 0
  v_add3_u32 v10, v10, v38, s93
  s_add_u32 s93, s93, s92
  v_add3_u32 v11, v11, v38, s93
  s_add_u32 s93, s93, s92
  v_add3_u32 v12, v12, v38, s93
  s_add_u32 s93, s93, s92
  v_add3_u32 v13, v13, v38, s93
  s_add_u32 s93, s93, s92
  v_add3_u32 v14, v14, v38, s93
  s_add_u32 s93, s93, s92
  v_add3_u32 v15, v15, v38, s93
  s_add_u32 s93, s93, s92
  v_add3_u32 v16, v16, v38, s93
  s_add_u32 s93, s93, s92
  v_add3_u32 v17, v17, v38, s93
  s_add_u32 s93, s93, s92
L_cd_12:
  s_add_u32 m0, s52, 0
  v_mfma_f32_16x16x32_bf16 a[4:7], v[144:147], v[76:79], a[4:7]
  s_cbranch_vccz L_gd_13
  buffer_load_dwordx4 v2, s[8:11], s20 offen  lds
L_gd_13:
  ds_read_b128 v[44:47], v20 offset:0
  v_mfma_f32_16x16x32_bf16 a[8:11], v[148:151], v[76:79], a[8:11]
  v_mfma_f32_16x16x32_bf16 a[12:15], v[152:155], v[76:79], a[12:15]
  ds_read_b64_tr_b16 v[108:109], v30 offset:32768
  s_add_u32 m0, s53, 0
  v_mfma_f32_16x16x32_bf16 a[16:19], v[156:159], v[76:79], a[16:19]
  s_cbranch_vccz L_gd_14
  buffer_load_dwordx4 v10, s[12:15], s21 offen  lds
L_gd_14:
  v_mfma_f32_16x16x32_bf16 a[20:23], v[160:163], v[76:79], a[20:23]
  ds_read_b64_tr_b16 v[110:111], v30 offset:34816
  v_mfma_f32_16x16x32_bf16 a[24:27], v[164:167], v[76:79], a[24:27]
  v_mfma_f32_16x16x32_bf16 a[28:31], v[168:171], v[76:79], a[28:31]
  ds_read_b128 v[48:51], v20 offset:2048
  s_add_u32 m0, s52, 1024
  v_mfma_f32_16x16x32_bf16 a[32:35], v[140:143], v[80:83], a[32:35]
  s_cbranch_vccz L_gd_15
  buffer_load_dwordx4 v3, s[8:11], s20 offen  lds
L_gd_15:
  v_mfma_f32_16x16x32_bf16 a[36:39], v[144:147], v[80:83], a[36:39]
  ds_read_b64_tr_b16 v[112:113], v31 offset:32768
  v_mfma_f32_16x16x32_bf16 a[40:43], v[148:151], v[80:83], a[40:43]
  v_mfma_f32_16x16x32_bf16 a[44:47], v[152:155], v[80:83], a[44:47]
  ds_read_b64_tr_b16 v[114:115], v31 offset:34816
  s_add_u32 m0, s53, 1024
  v_mfma_f32_16x16x32_bf16 a[48:51], v[156:159], v[80:83], a[48:51]
  s_cbranch_vccz L_gd_16
  buffer_load_dwordx4 v11, s[12:15], s21 offen  lds
L_gd_16:
  v_mfma_f32_16x16x32_bf16 a[52:55], v[160:163], v[80:83], a[52:55]
  ds_read_b128 v[52:55], v20 offset:4096
  v_mfma_f32_16x16x32_bf16 a[56:59], v[164:167], v[80:83], a[56:59]
  v_mfma_f32_16x16x32_bf16 a[60:63], v[168:171], v[80:83], a[60:63]
  ds_read_b64_tr_b16 v[116:117], v32 offset:32768
  s_add_u32 m0, s52, 2048
  v_mfma_f32_16x16x32_bf16 a[64:67], v[140:143], v[84:87], a[64:67]
  s_cbranch_vccz L_gd_17
  buffer_load_dwordx4 v4, s[8:11], s20 offen  lds
L_gd_17:
  v_mfma_f32_16x16x32_bf16 a[68:71], v[144:147], v[84:87], a[68:71]
  ds_read_b64_tr_b16 v[118:119], v32 offset:34816
  v_mfma_f32_16x16x32_bf16 a[72:75], v[148:151], v[84:87], a[72:75]
  v_mfma_f32_16x16x32_bf16 a[76:79], v[152:155], v[84:87], a[76:79]
  ds_read_b128 v[56:59], v20 offset:6144
  s_add_u32 m0, s53, 2048
  v_mfma_f32_16x16x32_bf16 a[80:83], v[156:159], v[84:87], a[80:83]
  s_cbranch_vccz L_gd_18
  buffer_load_dwordx4 v12, s[12:15], s21 offen  lds
L_gd_18:
  v_mfma_f32_16x16x32_bf16 a[84:87], v[160:163], v[84:87], a[84:87]
  ds_read_b64_tr_b16 v[120:121], v33 offset:32768
  v_mfma_f32_16x16x32_bf16 a[88:91], v[164:167], v[84:87], a[88:91]
  v_mfma_f32_16x16x32_bf16 a[92:95], v[168:171], v[84:87], a[92:95]
  ds_read_b64_tr_b16 v[122:123], v33 offset:34816
  s_add_u32 m0, s52, 3072
  v_mfma_f32_16x16x32_bf16 a[96:99], v[140:143], v[88:91], a[96:99]
  s_cbranch_vccz L_gd_19
  buffer_load_dwordx4 v5, s[8:11], s20 offen  lds
L_gd_19:
  v_mfma_f32_16x16x32_bf16 a[100:103], v[144:147], v[88:91], a[100:103]
  ds_read_b128 v[60:63], v20 offset:8192
  v_mfma_f32_16x16x32_bf16 a[104:107], v[148:151], v[88:91], a[104:107]
  v_mfma_f32_16x16x32_bf16 a[108:111], v[152:155], v[88:91], a[108:111]
  ds_read_b64_tr_b16 v[124:125], v34 offset:32768
  s_add_u32 m0, s53, 3072
  v_mfma_f32_16x16x32_bf16 a[112:115], v[156:159], v[88:91], a[112:115]
  s_cbranch_vccz L_gd_20
  buffer_load_dwordx4 v13, s[12:15], s21 offen  lds
L_gd_20:
  v_mfma_f32_16x16x32_bf16 a[116:119], v[160:163], v[88:91], a[116:119]
  ds_read_b64_tr_b16 v[126:127], v34 offset:34816
  v_mfma_f32_16x16x32_bf16 a[120:123], v[164:167], v[88:91], a[120:123]
  v_mfma_f32_16x16x32_bf16 a[124:127], v[168:171], v[88:91], a[124:127]
  ds_read_b128 v[64:67], v20 offset:10240
  s_add_u32 m0, s52, 4096
  v_mfma_f32_16x16x32_bf16 a[128:131], v[140:143], v[92:95], a[128:131]
  s_cbranch_vccz L_gd_21
  buffer_load_dwordx4 v6, s[8:11], s20 offen  lds
L_gd_21:
  v_mfma_f32_16x16x32_bf16 a[132:135], v[144:147], v[92:95], a[132:135]
  ds_read_b64_tr_b16 v[128:129], v35 offset:32768
  v_mfma_f32_16x16x32_bf16 a[136:139], v[148:151], v[92:95], a[136:139]
  v_mfma_f32_16x16x32_bf16 a[140:143], v[152:155], v[92:95], a[140:143]
  ds_read_b64_tr_b16 v[130:131], v35 offset:34816
  s_add_u32 m0, s53, 4096
  v_mfma_f32_16x16x32_bf16 a[144:147], v[156:159], v[92:95], a[144:147]
  s_cbranch_vccz L_gd_22
  buffer_load_dwordx4 v14, s[12:15], s21 offen  lds
L_gd_22:
  v_mfma_f32_16x16x32_bf16 a[148:151], v[160:163], v[92:95], a[148:151]
  ds_read_b128 v[68:71], v20 offset:12288
  v_mfma_f32_16x16x32_bf16 a[152:155], v[164:167], v[92:95], a[152:155]
  v_mfma_f32_16x16x32_bf16 a[156:159], v[168:171], v[92:95], a[156:159]
  ds_read_b64_tr_b16 v[132:133], v36 offset:32768
  s_add_u32 m0, s52, 5120
  v_mfma_f32_16x16x32_bf16 a[160:163], v[140:143], v[96:99], a[160:163]
  s_cbranch_vccz L_gd_23
  buffer_load_dwordx4 v7, s[8:11], s20 offen  lds
L_gd_23:
  v_mfma_f32_16x16x32_bf16 a[164:167], v[144:147], v[96:99], a[164:167]
  ds_read_b64_tr_b16 v[134:135], v36 offset:34816
  v_mfma_f32_16x16x32_bf16 a[168:171], v[148:151], v[96:99], a[168:171]
  v_mfma_f32_16x16x32_bf16 a[172:175], v[152:155], v[96:99], a[172:175]
  ds_read_b128 v[72:75], v20 offset:14336
  s_add_u32 m0, s53, 5120
  v_mfma_f32_16x16x32_bf16 a[176:179], v[156:159], v[96:99], a[176:179]
  s_cbranch_vccz L_gd_24
  buffer_load_dwordx4 v15, s[12:15], s21 offen  lds
L_gd_24:
  v_mfma_f32_16x16x32_bf16 a[180:183], v[160:163], v[96:99], a[180:183]
  ds_read_b64_tr_b16 v[136:137], v37 offset:32768
  v_mfma_f32_16x16x32_bf16 a[184:187], v[164:167], v[96:99], a[184:187]
  v_mfma_f32_16x16x32_bf16 a[188:191], v[168:171], v[96:99], a[188:191]
  ds_read_b64_tr_b16 v[138:139], v37 offset:34816
  s_add_u32 m0, s52, 6144
  v_mfma_f32_16x16x32_bf16 a[192:195], v[140:143], v[100:103], a[192:195]
  s_cbranch_vccz L_gd_25
  buffer_load_dwordx4 v8, s[8:11], s20 offen  lds
L_gd_25:
  v_mfma_f32_16x16x32_bf16 a[196:199], v[144:147], v[100:103], a[196:199]
  v_mfma_f32_16x16x32_bf16 a[200:203], v[148:151], v[100:103], a[200:203]
  v_mfma_f32_16x16x32_bf16 a[204:207], v[152:155], v[100:103], a[204:207]
  s_add_u32 m0, s53, 6144
  v_mfma_f32_16x16x32_bf16 a[208:211], v[156:159], v[100:103], a[208:211]
  s_cbranch_vccz L_gd_26
  buffer_load_dwordx4 v16, s[12:15], s21 offen  lds
L_gd_26:
  v_mfma_f32_16x16x32_bf16 a[212:215], v[160:163], v[100:103], a[212:215]
  v_mfma_f32_16x16x32_bf16 a[216:219], v[164:167], v[100:103], a[216:219]
  v_mfma_f32_16x16x32_bf16 a[220:223], v[168:171], v[100:103], a[220:223]
  s_add_u32 m0, s52, 7168
  v_mfma_f32_16x16x32_bf16 a[224:227], v[140:143], v[104:107], a[224:227]
  s_cbranch_vccz L_gd_27
  buffer_load_dwordx4 v9, s[8:11], s20 offen  lds
L_gd_27:
  v_mfma_f32_16x16x32_bf16 a[228:231], v[144:147], v[104:107], a[228:231]
  v_mfma_f32_16x16x32_bf16 a[232:235], v[148:151], v[104:107], a[232:235]
  v_mfma_f32_16x16x32_bf16 a[236:239], v[152:155], v[104:107], a[236:239]
  s_add_u32 m0, s53, 7168
  v_mfma_f32_16x16x32_bf16 a[240:243], v[156:159], v[104:107], a[240:243]
  s_cbranch_vccz L_gd_28
  buffer_load_dwordx4 v17, s[12:15], s21 offen  lds
  s_add_u32 s20, s20, 128
  s_add_u32 s21, s21, s51
L_gd_28:
  v_mfma_f32_16x16x32_bf16 a[244:247], v[160:163], v[104:107], a[244:247]
  v_mfma_f32_16x16x32_bf16 a[248:251], v[164:167], v[104:107], a[248:251]
  v_mfma_f32_16x16x32_bf16 a[252:255], v[168:171], v[104:107], a[252:255]
  s_waitcnt lgkmcnt(0)
  v_mfma_f32_16x16x32_bf16 a[0:3], v[108:111], v[44:47], a[0:3]
  ds_read_b128 v[76:79], v21 offset:0
  v_mfma_f32_16x16x32_bf16 a[4:7], v[112:115], v[44:47], a[4:7]
  v_mfma_f32_16x16x32_bf16 a[8:11], v[116:119], v[44:47], a[8:11]
  ds_read_b64_tr_b16 v[140:141], v30 offset:49152
  v_mfma_f32_16x16x32_bf16 a[12:15], v[120:123], v[44:47], a[12:15]
  v_mfma_f32_16x16x32_bf16 a[16:19], v[124:127], v[44:47], a[16:19]
  ds_read_b64_tr_b16 v[142:143], v30 offset:51200
  v_mfma_f32_16x16x32_bf16 a[20:23], v[128:131], v[44:47], a[20:23]
  v_mfma_f32_16x16x32_bf16 a[24:27], v[132:135], v[44:47], a[24:27]
  ds_read_b128 v[80:83], v21 offset:2048
  v_mfma_f32_16x16x32_bf16 a[28:31], v[136:139], v[44:47], a[28:31]
  v_mfma_f32_16x16x32_bf16 a[32:35], v[108:111], v[48:51], a[32:35]
  ds_read_b64_tr_b16 v[144:145], v31 offset:49152
  v_mfma_f32_16x16x32_bf16 a[36:39], v[112:115], v[48:51], a[36:39]
  v_mfma_f32_16x16x32_bf16 a[40:43], v[116:119], v[48:51], a[40:43]
  ds_read_b64_tr_b16 v[146:147], v31 offset:51200
  v_mfma_f32_16x16x32_bf16 a[44:47], v[120:123], v[48:51], a[44:47]
  v_mfma_f32_16x16x32_bf16 a[48:51], v[124:127], v[48:51], a[48:51]
  ds_read_b128 v[84:87], v21 offset:4096
  v_mfma_f32_16x16x32_bf16 a[52:55], v[128:131], v[48:51], a[52:55]
  v_mfma_f32_16x16x32_bf16 a[56:59], v[132:135], v[48:51], a[56:59]
  ds_read_b64_tr_b16 v[148:149], v32 offset:49152
  v_mfma_f32_16x16x32_bf16 a[60:63], v[136:139], v[48:51], a[60:63]
  v_mfma_f32_16x16x32_bf16 a[64:67], v[108:111], v[52:55], a[64:67]
  ds_read_b64_tr_b16 v[150:151], v32 offset:51200
  v_mfma_f32_16x16x32_bf16 a[68:71], v[112:115], v[52:55], a[68:71]
  v_mfma_f32_16x16x32_bf16 a[72:75], v[116:119], v[52:55], a[72:75]
  ds_read_b128 v[88:91], v21 offset:6144
  v_mfma_f32_16x16x32_bf16 a[76:79], v[120:123], v[52:55], a[76:79]
  v_mfma_f32_16x16x32_bf16 a[80:83], v[124:127], v[52:55], a[80:83]
  ds_read_b64_tr_b16 v[152:153], v33 offset:49152
  v_mfma_f32_16x16x32_bf16 a[84:87], v[128:131], v[52:55], a[84:87]
  v_mfma_f32_16x16x32_bf16 a[88:91], v[132:135], v[52:55], a[88:91]
  ds_read_b64_tr_b16 v[154:155], v33 offset:51200
  v_mfma_f32_16x16x32_bf16 a[92:95], v[136:139], v[52:55], a[92:95]
  v_mfma_f32_16x16x32_bf16 a[96:99], v[108:111], v[56:59], a[96:99]
  ds_read_b128 v[92:95], v21 offset:8192
  v_mfma_f32_16x16x32_bf16 a[100:103], v[112:115], v[56:59], a[100:103]
  v_mfma_f32_16x16x32_bf16 a[104:107], v[116:119], v[56:59], a[104:107]
  ds_read_b64_tr_b16 v[156:157], v34 offset:49152
  v_mfma_f32_16x16x32_bf16 a[108:111], v[120:123], v[56:59], a[108:111]
  v_mfma_f32_16x16x32_bf16 a[112:115], v[124:127], v[56:59], a[112:115]
  ds_read_b64_tr_b16 v[158:159], v34 offset:51200
  v_mfma_f32_16x16x32_bf16 a[116:119], v[128:131], v[56:59], a[116:119]
  v_mfma_f32_16x16x32_bf16 a[120:123], v[132:135], v[56:59], a[120:123]
  ds_read_b128 v[96:99], v21 offset:10240
  v_mfma_f32_16x16x32_bf16 a[124:127], v[136:139], v[56:59], a[124:127]
  v_mfma_f32_16x16x32_bf16 a[128:131], v[108:111], v[60:63], a[128:131]
  ds_read_b64_tr_b16 v[160:161], v35 offset:49152
  v_mfma_f32_16x16x32_bf16 a[132:135], v[112:115], v[60:63], a[132:135]
  v_mfma_f32_16x16x32_bf16 a[136:139], v[116:119], v[60:63], a[136:139]
  ds_read_b64_tr_b16 v[162:163], v35 offset:51200
  v_mfma_f32_16x16x32_bf16 a[140:143], v[120:123], v[60:63], a[140:143]
  v_mfma_f32_16x16x32_bf16 a[144:147], v[124:127], v[60:63], a[144:147]
  ds_read_b128 v[100:103], v21 offset:12288
  v_mfma_f32_16x16x32_bf16 a[148:151], v[128:131], v[60:63], a[148:151]
  v_mfma_f32_16x16x32_bf16 a[152:155], v[132:135], v[60:63], a[152:155]
  ds_read_b64_tr_b16 v[164:165], v36 offset:49152
  v_mfma_f32_16x16x32_bf16 a[156:159], v[136:139], v[60:63], a[156:159]
  v_mfma_f32_16x16x32_bf16 a[160:163], v[108:111], v[64:67], a[160:163]
  ds_read_b64_tr_b16 v[166:167], v36 offset:51200
  v_mfma_f32_16x16x32_bf16 a[164:167], v[112:115], v[64:67], a[164:167]
  v_mfma_f32_16x16x32_bf16 a[168:171], v[116:119], v[64:67], a[168:171]
  ds_read_b128 v[104:107], v21 offset:14336
  v_mfma_f32_16x16x32_bf16 a[172:175], v[120:123], v[64:67], a[172:175]
  v_mfma_f32_16x16x32_bf16 a[176:179], v[124:127], v[64:67], a[176:179]
  ds_read_b64_tr_b16 v[168:169], v37 offset:49152
  v_mfma_f32_16x16x32_bf16 a[180:183], v[128:131], v[64:67], a[180:183]
  v_mfma_f32_16x16x32_bf16 a[184:187], v[132:135], v[64:67], a[184:187]
  ds_read_b64_tr_b16 v[170:171], v37 offset:51200
  v_mfma_f32_16x16x32_bf16 a[188:191], v[136:139], v[64:67], a[188:191]
  v_mfma_f32_16x16x32_bf16 a[192:195], v[108:111], v[68:71], a[192:195]
  v_mfma_f32_16x16x32_bf16 a[196:199], v[112:115], v[68:71], a[196:199]
  v_mfma_f32_16x16x32_bf16 a[200:203], v[116:119], v[68:71], a[200:203]
  v_mfma_f32_16x16x32_bf16 a[204:207], v[120:123], v[68:71], a[204:207]
  v_mfma_f32_16x16x32_bf16 a[208:211], v[124:127], v[68:71], a[208:211]
  v_mfma_f32_16x16x32_bf16 a[212:215], v[128:131], v[68:71], a[212:215]
  v_mfma_f32_16x16x32_bf16 a[216:219], v[132:135], v[68:71], a[216:219]
  v_mfma_f32_16x16x32_bf16 a[220:223], v[136:139], v[68:71], a[220:223]
  v_mfma_f32_16x16x32_bf16 a[224:227], v[108:111], v[72:75], a[224:227]
  v_mfma_f32_16x16x32_bf16 a[228:231], v[112:115], v[72:75], a[228:231]
  v_mfma_f32_16x16x32_bf16 a[232:235], v[116:119], v[72:75], a[232:235]
  v_mfma_f32_16x16x32_bf16 a[236:239], v[120:123], v[72:75], a[236:239]
  v_mfma_f32_16x16x32_bf16 a[240:243], v[124:127], v[72:75], a[240:243]
  v_mfma_f32_16x16x32_bf16 a[244:247], v[128:131], v[72:75], a[244:247]
  v_mfma_f32_16x16x32_bf16 a[248:251], v[132:135], v[72:75], a[248:251]
  v_mfma_f32_16x16x32_bf16 a[252:255], v[136:139], v[72:75], a[252:255]
  s_waitcnt lgkmcnt(0)
  v_mfma_f32_16x16x32_bf16 a[0:3], v[140:143], v[76:79], a[0:3]
  s_barrier
  s_add_u32 m0, s52, 65536
  v_mfma_f32_16x16x32_bf16 a[4:7], v[144:147], v[76:79], a[4:7]
  s_cbranch_vccz L_gd_29
  buffer_load_dwordx4 v2, s[8:11], s20 offen  lds
L_gd_29:
  v_mfma_f32_16x16x32_bf16 a[8:11], v[148:151], v[76:79], a[8:11]
  v_mfma_f32_16x16x32_bf16 a[12:15], v[152:155], v[76:79], a[12:15]
  s_add_u32 m0, s53, 65536
  v_mfma_f32_16x16x32_bf16 a[16:19], v[156:159], v[76:79], a[16:19]
  s_cbranch_vccz L_gd_30
  buffer_load_dwordx4 v10, s[12:15], s21 offen  lds
L_gd_30:
  v_mfma_f32_16x16x32_bf16 a[20:23], v[160:163], v[76:79], a[20:23]
  v_mfma_f32_16x16x32_bf16 a[24:27], v[164:167], v[76:79], a[24:27]
  v_mfma_f32_16x16x32_bf16 a[28:31], v[168:171], v[76:79], a[28:31]
  s_add_u32 m0, s52, 66560
  v_mfma_f32_16x16x32_bf16 a[32:35], v[140:143], v[80:83], a[32:35]
  s_cbranch_vccz L_gd_31
  buffer_load_dwordx4 v3, s[8:11], s20 offen  lds
L_gd_31:
  v_mfma_f32_16x16x32_bf16 a[36:39], v[144:147], v[80:83], a[36:39]
  v_mfma_f32_16x16x32_bf16 a[40:43], v[148:151], v[80:83], a[40:43]
  v_mfma_f32_16x16x32_bf16 a[44:47], v[152:155], v[80:83], a[44:47]
  s_add_u32 m0, s53, 66560
  v_mfma_f32_16x16x32_bf16 a[48:51], v[156:159], v[80:83], a[48:51]
  s_cbranch_vccz L_gd_32
  buffer_load_dwordx4 v11, s[12:15], s21 offen  lds
L_gd_32:
  v_mfma_f32_16x16x32_bf16 a[52:55], v[160:163], v[80:83], a[52:55]
  v_mfma_f32_16x16x32_bf16 a[56:59], v[164:167], v[80:83], a[56:59]
  v_mfma_f32_16x16x32_bf16 a[60:63], v[168:171], v[80:83], a[60:63]
  s_add_u32 m0, s52, 67584
  v_mfma_f32_16x16x32_bf16 a[64:67], v[140:143], v[84:87], a[64:67]
  s_cbranch_vccz L_gd_33
  buffer_load_dwordx4 v4, s[8:11], s20 offen  lds
L_gd_33:
  v_mfma_f32_16x16x32_bf16 a[68:71], v[144:147], v[84:87], a[68:71]
  v_mfma_f32_16x16x32_bf16 a[72:75], v[148:151], v[84:87], a[72:75]
  v_mfma_f32_16x16x32_bf16 a[76:79], v[152:155], v[84:87], a[76:79]
  s_add_u32 m0, s53, 67584
  v_mfma_f32_16x16x32_bf16 a[80:83], v[156:159], v[84:87], a[80:83]
  s_cbranch_vccz L_gd_34
  buffer_load_dwordx4 v12, s[12:15], s21 offen  lds
L_gd_34:
  v_mfma_f32_16x16x32_bf16 a[84:87], v[160:163], v[84:87], a[84:87]
  v_mfma_f32_16x16x32_bf16 a[88:91], v[164:167], v[84:87], a[88:91]
  v_mfma_f32_16x16x32_bf16 a[92:95], v[168:171], v[84:87], a[92:95]
  s_add_u32 m0, s52, 68608
  v_mfma_f32_16x16x32_bf16 a[96:99], v[140:143], v[88:91], a[96:99]
  s_cbranch_vccz L_gd_35
  buffer_load_dwordx4 v5, s[8:11], s20 offen  lds
L_gd_35:
  v_mfma_f32_16x16x32_bf16 a[100:103], v[144:147], v[88:91], a[100:103]
  v_mfma_f32_16x16x32_bf16 a[104:107], v[148:151], v[88:91], a[104:107]
  v_mfma_f32_16x16x32_bf16 a[108:111], v[152:155], v[88:91], a[108:111]
  s_add_u32 m0, s53, 68608
  v_mfma_f32_16x16x32_bf16 a[112:115], v[156:159], v[88:91], a[112:115]
  s_cbranch_vccz L_gd_36
  buffer_load_dwordx4 v13, s[12:15], s21 offen  lds
L_gd_36:
  v_mfma_f32_16x16x32_bf16 a[116:119], v[160:163], v[88:91], a[116:119]
  v_mfma_f32_16x16x32_bf16 a[120:123], v[164:167], v[88:91], a[120:123]
  v_mfma_f32_16x16x32_bf16 a[124:127], v[168:171], v[88:91], a[124:127]
  s_add_u32 m0, s52, 69632
  v_mfma_f32_16x16x32_bf16 a[128:131], v[140:143], v[92:95], a[128:131]
  s_cbranch_vccz L_gd_37
  buffer_load_dwordx4 v6, s[8:11], s20 offen  lds
L_gd_37:
  v_mfma_f32_16x16x32_bf16 a[132:135], v[144:147], v[92:95], a[132:135]
  v_mfma_f32_16x16x32_bf16 a[136:139], v[148:151], v[92:95], a[136:139]
  v_mfma_f32_16x16x32_bf16 a[140:143], v[152:155], v[92:95], a[140:143]
  s_add_u32 m0, s53, 69632
  v_mfma_f32_16x16x32_bf16 a[144:147], v[156:159], v[92:95], a[144:147]
  s_cbranch_vccz L_gd_38
  buffer_load_dwordx4 v14, s[12:15], s21 offen  lds
L_gd_38:
  v_mfma_f32_16x16x32_bf16 a[148:151], v[160:163], v[92:95], a[148:151]
  v_mfma_f32_16x16x32_bf16 a[152:155], v[164:167], v[92:95], a[152:155]
  v_mfma_f32_16x16x32_bf16 a[156:159], v[168:171], v[92:95], a[156:159]
  s_add_u32 m0, s52, 70656
  v_mfma_f32_16x16x32_bf16 a[160:163], v[140:143], v[96:99], a[160:163]
  s_cbranch_vccz L_gd_39
  buffer_load_dwordx4 v7, s[8:11], s20 offen  lds
L_gd_39:
  v_mfma_f32_16x16x32_bf16 a[164:167], v[144:147], v[96:99], a[164:167]
  v_mfma_f32_16x16x32_bf16 a[168:171], v[148:151], v[96:99], a[168:171]
  v_mfma_f32_16x16x32_bf16 a[172:175], v[152:155], v[96:99], a[172:175]
  s_add_u32 m0, s53, 70656
  v_mfma_f32_16x16x32_bf16 a[176:179], v[156:159], v[96:99], a[176:179]
  s_cbranch_vccz L_gd_40
  buffer_load_dwordx4 v15, s[12:15], s21 offen  lds
L_gd_40:
  v_mfma_f32_16x16x32_bf16 a[180:183], v[160:163], v[96:99], a[180:183]
  v_mfma_f32_16x16x32_bf16 a[184:187], v[164:167], v[96:99], a[184:187]
  v_mfma_f32_16x16x32_bf16 a[188:191], v[168:171], v[96:99], a[188:191]
  s_add_u32 m0, s52, 71680
  v_mfma_f32_16x16x32_bf16 a[192:195], v[140:143], v[100:103], a[192:195]
  s_cbranch_vccz L_gd_41
  buffer_load_dwordx4 v8, s[8:11], s20 offen  lds
L_gd_41:
  v_mfma_f32_16x16x32_bf16 a[196:199], v[144:147], v[100:103], a[196:199]
  v_mfma_f32_16x16x32_bf16 a[200:203], v[148:151], v[100:103], a[200:203]
  v_mfma_f32_16x16x32_bf16 a[204:207], v[152:155], v[100:103], a[204:207]
  s_add_u32 m0, s53, 71680
  v_mfma_f32_16x16x32_bf16 a[208:211], v[156:159], v[100:103], a[208:211]
  s_cbranch_vccz L_gd_42
  buffer_load_dwordx4 v16, s[12:15], s21 offen  lds
L_gd_42:
  v_mfma_f32_16x16x32_bf16 a[212:215], v[160:163], v[100:103], a[212:215]
  v_mfma_f32_16x16x32_bf16 a[216:219], v[164:167], v[100:103], a[216:219]
  v_mfma_f32_16x16x32_bf16 a[220:223], v[168:171], v[100:103], a[220:223]
  s_add_u32 m0, s52, 72704
  v_mfma_f32_16x16x32_bf16 a[224:227], v[140:143], v[104:107], a[224:227]
  s_cbranch_vccz L_gd_43
  buffer_load_dwordx4 v9, s[8:11], s20 offen  lds
L_gd_43:
  v_mfma_f32_16x16x32_bf16 a[228:231], v[144:147], v[104:107], a[228:231]
  v_mfma_f32_16x16x32_bf16 a[232:235], v[148:151], v[104:107], a[232:235]
  v_mfma_f32_16x16x32_bf16 a[236:239], v[152:155], v[104:107], a[236:239]
  s_add_u32 m0, s53, 72704
  v_mfma_f32_16x16x32_bf16 a[240:243], v[156:159], v[104:107], a[240:243]
  s_cbranch_vccz L_gd_44
  buffer_load_dwordx4 v17, s[12:15], s21 offen  lds
  s_add_u32 s20, s20, 128
  s_add_u32 s21, s21, s51
L_gd_44:
  v_mfma_f32_16x16x32_bf16 a[244:247], v[160:163], v[104:107], a[244:247]
  v_mfma_f32_16x16x32_bf16 a[248:251], v[164:167], v[104:107], a[248:251]
  v_mfma_f32_16x16x32_bf16 a[252:255], v[168:171], v[104:107], a[252:255]
  s_cmp_eq_u32 s58, 1
  s_cbranch_scc1 L_epi
  s_branch L_have1
L_g1_cw:
  s_mov_b64 exec, 1
  ds_write_b32 v175, v244
  s_mov_b64 exec, -1
  s_branch L_g1_cwb
L_g1_cr:
  ds_read_b32 v246, v241
  s_cmp_eq_u32 s25, 1
  s_cbranch_scc1 L_g1_crb
  s_cmp_lg_u32 s32, 0
  s_cbranch_scc1 L_rq_45
  s_cmp_eq_u32 s39, 0
  s_cbranch_scc1 L_rq_45
  s_lshl_b32 s99, s33, 7
  s_add_u32 s99, s99, 0x3d00200
  v_mov_b32 v244, 1
  v_mov_b32 v245, 0
  s_mov_b64 exec, 1
  buffer_atomic_add v244, v245, s[4:7], s99 offen sc0 sc1
  s_mov_b64 exec, -1
L_rq_45:
  s_branch L_g1_crb
L_g2:
  s_waitcnt vmcnt(16)
  s_barrier
  ds_read_b128 v[44:47], v18 offset:0
  ds_read_b64_tr_b16 v[108:109], v22 offset:32768
  ds_read_b64_tr_b16 v[110:111], v22 offset:34816
  ds_read_b128 v[48:51], v18 offset:2048
  ds_read_b64_tr_b16 v[112:113], v23 offset:32768
  ds_read_b64_tr_b16 v[114:115], v23 offset:34816
  ds_read_b128 v[52:55], v18 offset:4096
  ds_read_b64_tr_b16 v[116:117], v24 offset:32768
  ds_read_b64_tr_b16 v[118:119], v24 offset:34816
  ds_read_b128 v[56:59], v18 offset:6144
  ds_read_b64_tr_b16 v[120:121], v25 offset:32768
  ds_read_b64_tr_b16 v[122:123], v25 offset:34816
  ds_read_b128 v[60:63], v18 offset:8192
  ds_read_b64_tr_b16 v[124:125], v26 offset:32768
  ds_read_b64_tr_b16 v[126:127], v26 offset:34816
  ds_read_b128 v[64:67], v18 offset:10240
  ds_read_b64_tr_b16 v[128:129], v27 offset:32768
  ds_read_b64_tr_b16 v[130:131], v27 offset:34816
  ds_read_b128 v[68:71], v18 offset:12288
  ds_read_b64_tr_b16 v[132:133], v28 offset:32768
  ds_read_b64_tr_b16 v[134:135], v28 offset:34816
  ds_read_b128 v[72:75], v18 offset:14336
  ds_read_b64_tr_b16 v[136:137], v29 offset:32768
  ds_read_b64_tr_b16 v[138:139], v29 offset:34816
  s_sub_u32 s25, s25, 1
  s_waitcnt lgkmcnt(0)
  s_nop 0
  v_mfma_f32_16x16x32_bf16 a[0:3], v[44:47], v[108:111], 0
  buffer_store_dwordx4 v[176:179], v172, s[4:7], s46 offen offset:0 sc1
  ds_read_b128 v[76:79], v19 offset:0
  v_mfma_f32_16x16x32_bf16 a[4:7], v[44:47], v[112:115], 0
  v_mfma_f32_16x16x32_bf16 a[8:11], v[44:47], v[116:119], 0
  ds_read_b64_tr_b16 v[140:141], v22 offset:49152
  v_mfma_f32_16x16x32_bf16 a[12:15], v[44:47], v[120:123], 0
  s_nop 0
  v_mfma_f32_16x16x32_bf16 a[16:19], v[44:47], v[124:127], 0
  buffer_store_dwordx4 v[180:183], v172, s[4:7], s46 offen offset:1024 sc1
  ds_read_b64_tr_b16 v[142:143], v22 offset:51200
  v_mfma_f32_16x16x32_bf16 a[20:23], v[44:47], v[128:131], 0
  v_mfma_f32_16x16x32_bf16 a[24:27], v[44:47], v[132:135], 0
  ds_read_b128 v[80:83], v19 offset:2048
  v_mfma_f32_16x16x32_bf16 a[28:31], v[44:47], v[136:139], 0
  s_nop 0
  v_mfma_f32_16x16x32_bf16 a[32:35], v[48:51], v[108:111], 0
  buffer_store_dwordx4 v[184:187], v172, s[4:7], s46 offen offset:2048 sc1
  ds_read_b64_tr_b16 v[144:145], v23 offset:49152
  v_mfma_f32_16x16x32_bf16 a[36:39], v[48:51], v[112:115], 0
  v_mfma_f32_16x16x32_bf16 a[40:43], v[48:51], v[116:119], 0
  ds_read_b64_tr_b16 v[146:147], v23 offset:51200
  v_mfma_f32_16x16x32_bf16 a[44:47], v[48:51], v[120:123], 0
  s_nop 0
  v_mfma_f32_16x16x32_bf16 a[48:51], v[48:51], v[124:127], 0
  buffer_store_dwordx4 v[188:191], v172, s[4:7], s46 offen offset:3072 sc1
  ds_read_b128 v[84:87], v19 offset:4096
  v_mfma_f32_16x16x32_bf16 a[52:55], v[48:51], v[128:131], 0
  v_mfma_f32_16x16x32_bf16 a[56:59], v[48:51], v[132:135], 0
  ds_read_b64_tr_b16 v[148:149], v24 offset:49152
  v_mfma_f32_16x16x32_bf16 a[60:63], v[48:51], v[136:139], 0
  s_nop 0
  v_mfma_f32_16x16x32_bf16 a[64:67], v[52:55], v[108:111], 0
  buffer_store_dwordx4 v[192:195], v173, s[4:7], s46 offen offset:0 sc1
  ds_read_b64_tr_b16 v[150:151], v24 offset:51200
  v_mfma_f32_16x16x32_bf16 a[68:71], v[52:55], v[112:115], 0
  v_mfma_f32_16x16x32_bf16 a[72:75], v[52:55], v[116:119], 0
  ds_read_b128 v[88:91], v19 offset:6144
  v_mfma_f32_16x16x32_bf16 a[76:79], v[52:55], v[120:123], 0
  s_nop 0
  v_mfma_f32_16x16x32_bf16 a[80:83], v[52:55], v[124:127], 0
  buffer_store_dwordx4 v[196:199], v173, s[4:7], s46 offen offset:1024 sc1
  ds_read_b64_tr_b16 v[152:153], v25 offset:49152
  v_mfma_f32_16x16x32_bf16 a[84:87], v[52:55], v[128:131], 0
  v_mfma_f32_16x16x32_bf16 a[88:91], v[52:55], v[132:135], 0
  ds_read_b64_tr_b16 v[154:155], v25 offset:51200
  v_mfma_f32_16x16x32_bf16 a[92:95], v[52:55], v[136:139], 0
  s_nop 0
  v_mfma_f32_16x16x32_bf16 a[96:99], v[56:59], v[108:111], 0
  buffer_store_dwordx4 v[200:203], v173, s[4:7], s46 offen offset:2048 sc1
  ds_read_b128 v[92:95], v19 offset:8192
  v_mfma_f32_16x16x32_bf16 a[100:103], v[56:59], v[112:115], 0
  v_mfma_f32_16x16x32_bf16 a[104:107], v[56:59], v[116:119], 0
  ds_read_b64_tr_b16 v[156:157], v26 offset:49152
  v_mfma_f32_16x16x32_bf16 a[108:111], v[56:59], v[120:123], 0
  s_nop 0
  v_mfma_f32_16x16x32_bf16 a[112:115], v[56:59], v[124:127], 0
  buffer_store_dwordx4 v[204:207], v173, s[4:7], s46 offen offset:3072 sc1
  ds_read_b64_tr_b16 v[158:159], v26 offset:51200
  v_mfma_f32_16x16x32_bf16 a[116:119], v[56:59], v[128:131], 0
  v_mfma_f32_16x16x32_bf16 a[120:123], v[56:59], v[132:135], 0
  ds_read_b128 v[96:99], v19 offset:10240
  v_mfma_f32_16x16x32_bf16 a[124:127], v[56:59], v[136:139], 0
  s_nop 0
  v_mfma_f32_16x16x32_bf16 a[128:131], v[60:63], v[108:111], 0
  buffer_store_dwordx4 v[208:211], v172, s[4:7], s47 offen offset:0 sc1
  ds_read_b64_tr_b16 v[160:161], v27 offset:49152
  v_mfma_f32_16x16x32_bf16 a[132:135], v[60:63], v[112:115], 0
  v_mfma_f32_16x16x32_bf16 a[136:139], v[60:63], v[116:119], 0
  ds_read_b64_tr_b16 v[162:163], v27 offset:51200
  v_mfma_f32_16x16x32_bf16 a[140:143], v[60:63], v[120:123], 0
  s_nop 0
  v_mfma_f32_16x16x32_bf16 a[144:147], v[60:63], v[124:127], 0
  buffer_store_dwordx4 v[212:215], v172, s[4:7], s47 offen offset:1024 sc1
  ds_read_b128 v[100:103], v19 offset:12288
  v_mfma_f32_16x16x32_bf16 a[148:151], v[60:63], v[128:131], 0
  v_mfma_f32_16x16x32_bf16 a[152:155], v[60:63], v[132:135], 0
  ds_read_b64_tr_b16 v[164:165], v28 offset:49152
  v_mfma_f32_16x16x32_bf16 a[156:159], v[60:63], v[136:139], 0
  s_nop 0
  v_mfma_f32_16x16x32_bf16 a[160:163], v[64:67], v[108:111], 0
  buffer_store_dwordx4 v[216:219], v172, s[4:7], s47 offen offset:2048 sc1
  ds_read_b64_tr_b16 v[166:167], v28 offset:51200
  v_mfma_f32_16x16x32_bf16 a[164:167], v[64:67], v[112:115], 0
  v_mfma_f32_16x16x32_bf16 a[168:171], v[64:67], v[116:119], 0
  ds_read_b128 v[104:107], v19 offset:14336
  v_mfma_f32_16x16x32_bf16 a[172:175], v[64:67], v[120:123], 0
  s_nop 0
  v_mfma_f32_16x16x32_bf16 a[176:179], v[64:67], v[124:127], 0
  buffer_store_dwordx4 v[220:223], v172, s[4:7], s47 offen offset:3072 sc1
  ds_read_b64_tr_b16 v[168:169], v29 offset:49152
  v_mfma_f32_16x16x32_bf16 a[180:183], v[64:67], v[128:131], 0
  v_mfma_f32_16x16x32_bf16 a[184:187], v[64:67], v[132:135], 0
  ds_read_b64_tr_b16 v[170:171], v29 offset:51200
  v_mfma_f32_16x16x32_bf16 a[188:191], v[64:67], v[136:139], 0
  s_nop 0
  v_mfma_f32_16x16x32_bf16 a[192:195], v[68:71], v[108:111], 0
  buffer_store_dwordx4 v[224:227], v173, s[4:7], s47 offen offset:0 sc1
  v_mfma_f32_16x16x32_bf16 a[196:199], v[68:71], v[112:115], 0
  v_mfma_f32_16x16x32_bf16 a[200:203], v[68:71], v[116:119], 0
  v_mfma_f32_16x16x32_bf16 a[204:207], v[68:71], v[120:123], 0
  s_nop 0
  v_mfma_f32_16x16x32_bf16 a[208:211], v[68:71], v[124:127], 0
  buffer_store_dwordx4 v[228:231], v173, s[4:7], s47 offen offset:1024 sc1
  v_mfma_f32_16x16x32_bf16 a[212:215], v[68:71], v[128:131], 0
  v_mfma_f32_16x16x32_bf16 a[216:219], v[68:71], v[132:135], 0
  v_mfma_f32_16x16x32_bf16 a[220:223], v[68:71], v[136:139], 0
  s_nop 0
  v_mfma_f32_16x16x32_bf16 a[224:227], v[72:75], v[108:111], 0
  buffer_store_dwordx4 v[232:235], v173, s[4:7], s47 offen offset:2048 sc1
  v_mfma_f32_16x16x32_bf16 a[228:231], v[72:75], v[112:115], 0
  v_mfma_f32_16x16x32_bf16 a[232:235], v[72:75], v[116:119], 0
  v_mfma_f32_16x16x32_bf16 a[236:239], v[72:75], v[120:123], 0
  s_nop 0
  v_mfma_f32_16x16x32_bf16 a[240:243], v[72:75], v[124:127], 0
  buffer_store_dwordx4 v[236:239], v173, s[4:7], s47 offen offset:3072 sc1
  v_mfma_f32_16x16x32_bf16 a[244:247], v[72:75], v[128:131], 0
  v_mfma_f32_16x16x32_bf16 a[248:251], v[72:75], v[132:135], 0
  v_mfma_f32_16x16x32_bf16 a[252:255], v[72:75], v[136:139], 0
  s_waitcnt lgkmcnt(0)
  v_mfma_f32_16x16x32_bf16 a[0:3], v[76:79], v[140:143], a[0:3]
  s_waitcnt vmcnt(16)
  s_barrier
  s_add_u32 m0, s52, 0
  v_mfma_f32_16x16x32_bf16 a[4:7], v[76:79], v[144:147], a[4:7]
  buffer_load_dwordx4 v2, s[8:11], s20 offen  lds
  ds_read_b128 v[44:47], v20 offset:0
  v_mfma_f32_16x16x32_bf16 a[8:11], v[76:79], v[148:151], a[8:11]
  v_mfma_f32_16x16x32_bf16 a[12:15], v[76:79], v[152:155], a[12:15]
  ds_read_b64_tr_b16 v[108:109], v30 offset:32768
  s_add_u32 m0, s53, 0
  v_mfma_f32_16x16x32_bf16 a[16:19], v[76:79], v[156:159], a[16:19]
  buffer_load_dwordx4 v10, s[12:15], s21 offen  lds
  v_mfma_f32_16x16x32_bf16 a[20:23], v[76:79], v[160:163], a[20:23]
  ds_read_b64_tr_b16 v[110:111], v30 offset:34816
  v_mfma_f32_16x16x32_bf16 a[24:27], v[76:79], v[164:167], a[24:27]
  v_mfma_f32_16x16x32_bf16 a[28:31], v[76:79], v[168:171], a[28:31]
  ds_read_b128 v[48:51], v20 offset:2048
  s_add_u32 m0, s52, 1024
  v_mfma_f32_16x16x32_bf16 a[32:35], v[80:83], v[140:143], a[32:35]
  buffer_load_dwordx4 v3, s[8:11], s20 offen  lds
  v_mfma_f32_16x16x32_bf16 a[36:39], v[80:83], v[144:147], a[36:39]
  ds_read_b64_tr_b16 v[112:113], v31 offset:32768
  v_mfma_f32_16x16x32_bf16 a[40:43], v[80:83], v[148:151], a[40:43]
  v_mfma_f32_16x16x32_bf16 a[44:47], v[80:83], v[152:155], a[44:47]
  ds_read_b64_tr_b16 v[114:115], v31 offset:34816
  s_add_u32 m0, s53, 1024
  v_mfma_f32_16x16x32_bf16 a[48:51], v[80:83], v[156:159], a[48:51]
  buffer_load_dwordx4 v11, s[12:15], s21 offen  lds
  v_mfma_f32_16x16x32_bf16 a[52:55], v[80:83], v[160:163], a[52:55]
  ds_read_b128 v[52:55], v20 offset:4096
  v_mfma_f32_16x16x32_bf16 a[56:59], v[80:83], v[164:167], a[56:59]
  s_add_u32 m0, s52, 2048
  v_mfma_f32_16x16x32_bf16 a[60:63], v[80:83], v[168:171], a[60:63]
  buffer_load_dwordx4 v4, s[8:11], s20 offen  lds
  ds_read_b64_tr_b16 v[116:117], v32 offset:32768
  v_mfma_f32_16x16x32_bf16 a[64:67], v[84:87], v[140:143], a[64:67]
  v_mfma_f32_16x16x32_bf16 a[68:71], v[84:87], v[144:147], a[68:71]
  ds_read_b64_tr_b16 v[118:119], v32 offset:34816
  v_mfma_f32_16x16x32_bf16 a[72:75], v[84:87], v[148:151], a[72:75]
  s_add_u32 m0, s53, 2048
  v_mfma_f32_16x16x32_bf16 a[76:79], v[84:87], v[152:155], a[76:79]
  buffer_load_dwordx4 v12, s[12:15], s21 offen  lds
  ds_read_b128 v[56:59], v20 offset:6144
  v_mfma_f32_16x16x32_bf16 a[80:83], v[84:87], v[156:159], a[80:83]
  v_mfma_f32_16x16x32_bf16 a[84:87], v[84:87], v[160:163], a[84:87]
  ds_read_b64_tr_b16 v[120:121], v33 offset:32768
  v_mfma_f32_16x16x32_bf16 a[88:91], v[84:87], v[164:167], a[88:91]
  s_add_u32 m0, s52, 3072
  v_mfma_f32_16x16x32_bf16 a[92:95], v[84:87], v[168:171], a[92:95]
  buffer_load_dwordx4 v5, s[8:11], s20 offen  lds
  ds_read_b64_tr_b16 v[122:123], v33 offset:34816
  v_mfma_f32_16x16x32_bf16 a[96:99], v[88:91], v[140:143], a[96:99]
  v_mfma_f32_16x16x32_bf16 a[100:103], v[88:91], v[144:147], a[100:103]
  ds_read_b128 v[60:63], v20 offset:8192
  s_add_u32 m0, s53, 3072
  v_mfma_f32_16x16x32_bf16 a[104:107], v[88:91], v[148:151], a[104:107]
  buffer_load_dwordx4 v13, s[12:15], s21 offen  lds
  v_mfma_f32_16x16x32_bf16 a[108:111], v[88:91], v[152:155], a[108:111]
  ds_read_b64_tr_b16 v[124:125], v34 offset:32768
  v_mfma_f32_16x16x32_bf16 a[112:115], v[88:91], v[156:159], a[112:115]
  v_mfma_f32_16x16x32_bf16 a[116:119], v[88:91], v[160:163], a[116:119]
  ds_read_b64_tr_b16 v[126:127], v34 offset:34816
  s_add_u32 m0, s52, 4096
  v_mfma_f32_16x16x32_bf16 a[120:123], v[88:91], v[164:167], a[120:123]
  buffer_load_dwordx4 v6, s[8:11], s20 offen  lds
  v_mfma_f32_16x16x32_bf16 a[124:127], v[88:91], v[168:171], a[124:127]
  ds_read_b128 v[64:67], v20 offset:10240
  v_mfma_f32_16x16x32_bf16 a[128:131], v[92:95], v[140:143], a[128:131]
  v_mfma_f32_16x16x32_bf16 a[132:135], v[92:95], v[144:147], a[132:135]
  ds_read_b64_tr_b16 v[128:129], v35 offset:32768
  s_add_u32 m0, s53, 4096
  v_mfma_f32_16x16x32_bf16 a[136:139], v[92:95], v[148:151], a[136:139]
  buffer_load_dwordx4 v14, s[12:15], s21 offen  lds
  v_mfma_f32_16x16x32_bf16 a[140:143], v[92:95], v[152:155], a[140:143]
  ds_read_b64_tr_b16 v[130:131], v35 offset:34816
  v_mfma_f32_16x16x32_bf16 a[144:147], v[92:95], v[156:159], a[144:147]
  v_mfma_f32_16x16x32_bf16 a[148:151], v[92:95], v[160:163], a[148:151]
  ds_read_b128 v[68:71], v20 offset:12288
  s_add_u32 m0, s52, 5120
  v_mfma_f32_16x16x32_bf16 a[152:155], v[92:95], v[164:167], a[152:155]
  buffer_load_dwordx4 v7, s[8:11], s20 offen  lds
  v_mfma_f32_16x16x32_bf16 a[156:159], v[92:95], v[168:171], a[156:159]
  ds_read_b64_tr_b16 v[132:133], v36 offset:32768
  v_mfma_f32_16x16x32_bf16 a[160:163], v[96:99], v[140:143], a[160:163]
  s_add_u32 m0, s53, 5120
  v_mfma_f32_16x16x32_bf16 a[164:167], v[96:99], v[144:147], a[164:167]
  buffer_load_dwordx4 v15, s[12:15], s21 offen  lds
  ds_read_b64_tr_b16 v[134:135], v36 offset:34816
  v_mfma_f32_16x16x32_bf16 a[168:171], v[96:99], v[148:151], a[168:171]
  v_mfma_f32_16x16x32_bf16 a[172:175], v[96:99], v[152:155], a[172:175]
  ds_read_b128 v[72:75], v20 offset:14336
  v_mfma_f32_16x16x32_bf16 a[176:179], v[96:99], v[156:159], a[176:179]
  s_add_u32 m0, s52, 6144
  v_mfma_f32_16x16x32_bf16 a[180:183], v[96:99], v[160:163], a[180:183]
  buffer_load_dwordx4 v8, s[8:11], s20 offen  lds
  ds_read_b64_tr_b16 v[136:137], v37 offset:32768
  v_mfma_f32_16x16x32_bf16 a[184:187], v[96:99], v[164:167], a[184:187]
  v_mfma_f32_16x16x32_bf16 a[188:191], v[96:99], v[168:171], a[188:191]
  ds_read_b64_tr_b16 v[138:139], v37 offset:34816
  v_mfma_f32_16x16x32_bf16 a[192:195], v[100:103], v[140:143], a[192:195]
  s_add_u32 m0, s53, 6144
  v_mfma_f32_16x16x32_bf16 a[196:199], v[100:103], v[144:147], a[196:199]
  buffer_load_dwordx4 v16, s[12:15], s21 offen  lds
  v_mfma_f32_16x16x32_bf16 a[200:203], v[100:103], v[148:151], a[200:203]
  v_mfma_f32_16x16x32_bf16 a[204:207], v[100:103], v[152:155], a[204:207]
  s_add_u32 m0, s52, 7168
  v_mfma_f32_16x16x32_bf16 a[208:211], v[100:103], v[156:159], a[208:211]
  buffer_load_dwordx4 v9, s[8:11], s20 offen  lds
  v_mfma_f32_16x16x32_bf16 a[212:215], v[100:103], v[160:163], a[212:215]
  v_mfma_f32_16x16x32_bf16 a[216:219], v[100:103], v[164:167], a[216:219]
  v_mfma_f32_16x16x32_bf16 a[220:223], v[100:103], v[168:171], a[220:223]
  s_add_u32 m0, s53, 7168
  v_mfma_f32_16x16x32_bf16 a[224:227], v[104:107], v[140:143], a[224:227]
  buffer_load_dwordx4 v17, s[12:15], s21 offen  lds
  v_mfma_f32_16x16x32_bf16 a[228:231], v[104:107], v[144:147], a[228:231]
  v_mfma_f32_16x16x32_bf16 a[232:235], v[104:107], v[148:151], a[232:235]
  v_mfma_f32_16x16x32_bf16 a[236:239], v[104:107], v[152:155], a[236:239]
  s_add_u32 s20, s20, 128
  v_mfma_f32_16x16x32_bf16 a[240:243], v[104:107], v[156:159], a[240:243]
  s_add_u32 s21, s21, s51
  v_mfma_f32_16x16x32_bf16 a[244:247], v[104:107], v[160:163], a[244:247]
  v_mfma_f32_16x16x32_bf16 a[248:251], v[104:107], v[164:167], a[248:251]
  v_mfma_f32_16x16x32_bf16 a[252:255], v[104:107], v[168:171], a[252:255]
  s_waitcnt lgkmcnt(0)
  v_mfma_f32_16x16x32_bf16 a[0:3], v[44:47], v[108:111], a[0:3]
  ds_read_b128 v[76:79], v21 offset:0
  v_mfma_f32_16x16x32_bf16 a[4:7], v[44:47], v[112:115], a[4:7]
  v_mfma_f32_16x16x32_bf16 a[8:11], v[44:47], v[116:119], a[8:11]
  ds_read_b64_tr_b16 v[140:141], v30 offset:49152
  v_mfma_f32_16x16x32_bf16 a[12:15], v[44:47], v[120:123], a[12:15]
  v_mfma_f32_16x16x32_bf16 a[16:19], v[44:47], v[124:127], a[16:19]
  ds_read_b64_tr_b16 v[142:143], v30 offset:51200
  v_mfma_f32_16x16x32_bf16 a[20:23], v[44:47], v[128:131], a[20:23]
  v_mfma_f32_16x16x32_bf16 a[24:27], v[44:47], v[132:135], a[24:27]
  ds_read_b128 v[80:83], v21 offset:2048
  v_mfma_f32_16x16x32_bf16 a[28:31], v[44:47], v[136:139], a[28:31]
  v_mfma_f32_16x16x32_bf16 a[32:35], v[48:51], v[108:111], a[32:35]
  ds_read_b64_tr_b16 v[144:145], v31 offset:49152
  v_mfma_f32_16x16x32_bf16 a[36:39], v[48:51], v[112:115], a[36:39]
  v_mfma_f32_16x16x32_bf16 a[40:43], v[48:51], v[116:119], a[40:43]
  ds_read_b64_tr_b16 v[146:147], v31 offset:51200
  v_mfma_f32_16x16x32_bf16 a[44:47], v[48:51], v[120:123], a[44:47]
  v_mfma_f32_16x16x32_bf16 a[48:51], v[48:51], v[124:127], a[48:51]
  ds_read_b128 v[84:87], v21 offset:4096
  v_mfma_f32_16x16x32_bf16 a[52:55], v[48:51], v[128:131], a[52:55]
  v_mfma_f32_16x16x32_bf16 a[56:59], v[48:51], v[132:135], a[56:59]
  ds_read_b64_tr_b16 v[148:149], v32 offset:49152
  v_mfma_f32_16x16x32_bf16 a[60:63], v[48:51], v[136:139], a[60:63]
  v_mfma_f32_16x16x32_bf16 a[64:67], v[52:55], v[108:111], a[64:67]
  ds_read_b64_tr_b16 v[150:151], v32 offset:51200
  v_mfma_f32_16x16x32_bf16 a[68:71], v[52:55], v[112:115], a[68:71]
  v_mfma_f32_16x16x32_bf16 a[72:75], v[52:55], v[116:119], a[72:75]
  ds_read_b128 v[88:91], v21 offset:6144
  v_mfma_f32_16x16x32_bf16 a[76:79], v[52:55], v[120:123], a[76:79]
  v_mfma_f32_16x16x32_bf16 a[80:83], v[52:55], v[124:127], a[80:83]
  ds_read_b64_tr_b16 v[152:153], v33 offset:49152
  v_mfma_f32_16x16x32_bf16 a[84:87], v[52:55], v[128:131], a[84:87]
  v_mfma_f32_16x16x32_bf16 a[88:91], v[52:55], v[132:135], a[88:91]
  ds_read_b64_tr_b16 v[154:155], v33 offset:51200
  v_mfma_f32_16x16x32_bf16 a[92:95], v[52:55], v[136:139], a[92:95]
  v_mfma_f32_16x16x32_bf16 a[96:99], v[56:59], v[108:111], a[96:99]
  ds_read_b128 v[92:95], v21 offset:8192
  v_mfma_f32_16x16x32_bf16 a[100:103], v[56:59], v[112:115], a[100:103]
  v_mfma_f32_16x16x32_bf16 a[104:107], v[56:59], v[116:119], a[104:107]
  ds_read_b64_tr_b16 v[156:157], v34 offset:49152
  v_mfma_f32_16x16x32_bf16 a[108:111], v[56:59], v[120:123], a[108:111]
  v_mfma_f32_16x16x32_bf16 a[112:115], v[56:59], v[124:127], a[112:115]
  ds_read_b64_tr_b16 v[158:159], v34 offset:51200
  v_mfma_f32_16x16x32_bf16 a[116:119], v[56:59], v[128:131], a[116:119]
  v_mfma_f32_16x16x32_bf16 a[120:123], v[56:59], v[132:135], a[120:123]
  ds_read_b128 v[96:99], v21 offset:10240
  v_mfma_f32_16x16x32_bf16 a[124:127], v[56:59], v[136:139], a[124:127]
  v_mfma_f32_16x16x32_bf16 a[128:131], v[60:63], v[108:111], a[128:131]
  ds_read_b64_tr_b16 v[160:161], v35 offset:49152
  v_mfma_f32_16x16x32_bf16 a[132:135], v[60:63], v[112:115], a[132:135]
  v_mfma_f32_16x16x32_bf16 a[136:139], v[60:63], v[116:119], a[136:139]
  ds_read_b64_tr_b16 v[162:163], v35 offset:51200
  v_mfma_f32_16x16x32_bf16 a[140:143], v[60:63], v[120:123], a[140:143]
  v_mfma_f32_16x16x32_bf16 a[144:147], v[60:63], v[124:127], a[144:147]
  ds_read_b128 v[100:103], v21 offset:12288
  v_mfma_f32_16x16x32_bf16 a[148:151], v[60:63], v[128:131], a[148:151]
  v_mfma_f32_16x16x32_bf16 a[152:155], v[60:63], v[132:135], a[152:155]
  ds_read_b64_tr_b16 v[164:165], v36 offset:49152
  v_mfma_f32_16x16x32_bf16 a[156:159], v[60:63], v[136:139], a[156:159]
  v_mfma_f32_16x16x32_bf16 a[160:163], v[64:67], v[108:111], a[160:163]
  ds_read_b64_tr_b16 v[166:167], v36 offset:51200
  v_mfma_f32_16x16x32_bf16 a[164:167], v[64:67], v[112:115], a[164:167]
  v_mfma_f32_16x16x32_bf16 a[168:171], v[64:67], v[116:119], a[168:171]
  ds_read_b128 v[104:107], v21 offset:14336
  v_mfma_f32_16x16x32_bf16 a[172:175], v[64:67], v[120:123], a[172:175]
  v_mfma_f32_16x16x32_bf16 a[176:179], v[64:67], v[124:127], a[176:179]
  ds_read_b64_tr_b16 v[168:169], v37 offset:49152
  v_mfma_f32_16x16x32_bf16 a[180:183], v[64:67], v[128:131], a[180:183]
  v_mfma_f32_16x16x32_bf16 a[184:187], v[64:67], v[132:135], a[184:187]
  ds_read_b64_tr_b16 v[170:171], v37 offset:51200
  v_mfma_f32_16x16x32_bf16 a[188:191], v[64:67], v[136:139], a[188:191]
  v_mfma_f32_16x16x32_bf16 a[192:195], v[68:71], v[108:111], a[192:195]
  v_mfma_f32_16x16x32_bf16 a[196:199], v[68:71], v[112:115], a[196:199]
  v_mfma_f32_16x16x32_bf16 a[200:203], v[68:71], v[116:119], a[200:203]
  v_mfma_f32_16x16x32_bf16 a[204:207], v[68:71], v[120:123], a[204:207]
  v_mfma_f32_16x16x32_bf16 a[208:211], v[68:71], v[124:127], a[208:211]
  v_mfma_f32_16x16x32_bf16 a[212:215], v[68:71], v[128:131], a[212:215]
  v_mfma_f32_16x16x32_bf16 a[216:219], v[68:71], v[132:135], a[216:219]
  v_mfma_f32_16x16x32_bf16 a[220:223], v[68:71], v[136:139], a[220:223]
  v_mfma_f32_16x16x32_bf16 a[224:227], v[72:75], v[108:111], a[224:227]
  v_mfma_f32_16x16x32_bf16 a[228:231], v[72:75], v[112:115], a[228:231]
  v_mfma_f32_16x16x32_bf16 a[232:235], v[72:75], v[116:119], a[232:235]
  v_mfma_f32_16x16x32_bf16 a[236:239], v[72:75], v[120:123], a[236:239]
  v_mfma_f32_16x16x32_bf16 a[240:243], v[72:75], v[124:127], a[240:243]
  v_mfma_f32_16x16x32_bf16 a[244:247], v[72:75], v[128:131], a[244:247]
  v_mfma_f32_16x16x32_bf16 a[248:251], v[72:75], v[132:135], a[248:251]
  v_mfma_f32_16x16x32_bf16 a[252:255], v[72:75], v[136:139], a[252:255]
  s_waitcnt lgkmcnt(0)
  v_mfma_f32_16x16x32_bf16 a[0:3], v[76:79], v[140:143], a[0:3]
  s_waitcnt vmcnt(0)
  s_barrier
  s_cmp_eq_u32 s49, 0
  s_cbranch_scc1 L_hs_46
  s_cmp_lg_u32 s32, 0
  s_cbranch_scc1 L_sig_47
  v_mov_b32 v254, s63
  v_mov_b32 v255, 0
  v_and_b32 v254, 3, v254
  v_mbcnt_lo_u32_b32 v255, -1, 0
  v_lshlrev_b32 v255, 9, v255
  s_cmp_ge_u32 s63, 2
  s_cselect_b64 exec, 3, 1
  buffer_atomic_add v254, v255, s[4:7], s62 offen offset:0 sc1
  s_mov_b64 exec, -1
L_sig_47:
L_hs_46:
  s_add_u32 m0, s52, 65536
  v_mfma_f32_16x16x32_bf16 a[4:7], v[76:79], v[144:147], a[4:7]
  buffer_load_dwordx4 v2, s[8:11], s20 offen  lds
  ds_read_b128 v[44:47], v18 offset:0
  v_mfma_f32_16x16x32_bf16 a[8:11], v[76:79], v[148:151], a[8:11]
  v_mfma_f32_16x16x32_bf16 a[12:15], v[76:79], v[152:155], a[12:15]
  ds_read_b64_tr_b16 v[108:109], v22 offset:32768
  s_add_u32 m0, s53, 65536
  v_mfma_f32_16x16x32_bf16 a[16:19], v[76:79], v[156:159], a[16:19]
  buffer_load_dwordx4 v10, s[12:15], s21 offen  lds
  v_mfma_f32_16x16x32_bf16 a[20:23], v[76:79], v[160:163], a[20:23]
  ds_read_b64_tr_b16 v[110:111], v22 offset:34816
  v_mfma_f32_16x16x32_bf16 a[24:27], v[76:79], v[164:167], a[24:27]
  v_mfma_f32_16x16x32_bf16 a[28:31], v[76:79], v[168:171], a[28:31]
  ds_read_b128 v[48:51], v18 offset:2048
  s_add_u32 m0, s52, 66560
  v_mfma_f32_16x16x32_bf16 a[32:35], v[80:83], v[140:143], a[32:35]
  buffer_load_dwordx4 v3, s[8:11], s20 offen  lds
  v_mfma_f32_16x16x32_bf16 a[36:39], v[80:83], v[144:147], a[36:39]
  ds_read_b64_tr_b16 v[112:113], v23 offset:32768
  v_mfma_f32_16x16x32_bf16 a[40:43], v[80:83], v[148:151], a[40:43]
  v_mfma_f32_16x16x32_bf16 a[44:47], v[80:83], v[152:155], a[44:47]
  ds_read_b64_tr_b16 v[114:115], v23 offset:34816
  s_add_u32 m0, s53, 66560
  v_mfma_f32_16x16x32_bf16 a[48:51], v[80:83], v[156:159], a[48:51]
  buffer_load_dwordx4 v11, s[12:15], s21 offen  lds
  v_mfma_f32_16x16x32_bf16 a[52:55], v[80:83], v[160:163], a[52:55]
  ds_read_b128 v[52:55], v18 offset:4096
  v_mfma_f32_16x16x32_bf16 a[56:59], v[80:83], v[164:167], a[56:59]
  s_add_u32 m0, s52, 67584
  v_mfma_f32_16x16x32_bf16 a[60:63], v[80:83], v[168:171], a[60:63]
  buffer_load_dwordx4 v4, s[8:11], s20 offen  lds
  ds_read_b64_tr_b16 v[116:117], v24 offset:32768
  v_mfma_f32_16x16x32_bf16 a[64:67], v[84:87], v[140:143], a[64:67]
  v_mfma_f32_16x16x32_bf16 a[68:71], v[84:87], v[144:147], a[68:71]
  ds_read_b64_tr_b16 v[118:119], v24 offset:34816
  v_mfma_f32_16x16x32_bf16 a[72:75], v[84:87], v[148:151], a[72:75]
  s_add_u32 m0, s53, 67584
  v_mfma_f32_16x16x32_bf16 a[76:79], v[84:87], v[152:155], a[76:79]
  buffer_load_dwordx4 v12, s[12:15], s21 offen  lds
  ds_read_b128 v[56:59], v18 offset:6144
  v_mfma_f32_16x16x32_bf16 a[80:83], v[84:87], v[156:159], a[80:83]
  v_mfma_f32_16x16x32_bf16 a[84:87], v[84:87], v[160:163], a[84:87]
  ds_read_b64_tr_b16 v[120:121], v25 offset:32768
  v_mfma_f32_16x16x32_bf16 a[88:91], v[84:87], v[164:167], a[88:91]
  s_add_u32 m0, s52, 68608
  v_mfma_f32_16x16x32_bf16 a[92:95], v[84:87], v[168:171], a[92:95]
  buffer_load_dwordx4 v5, s[8:11], s20 offen  lds
  ds_read_b64_tr_b16 v[122:123], v25 offset:34816
  v_mfma_f32_16x16x32_bf16 a[96:99], v[88:91], v[140:143], a[96:99]
  v_mfma_f32_16x16x32_bf16 a[100:103], v[88:91], v[144:147], a[100:103]
  ds_read_b128 v[60:63], v18 offset:8192
  s_add_u32 m0, s53, 68608
  v_mfma_f32_16x16x32_bf16 a[104:107], v[88:91], v[148:151], a[104:107]
  buffer_load_dwordx4 v13, s[12:15], s21 offen  lds
  v_mfma_f32_16x16x32_bf16 a[108:111], v[88:91], v[152:155], a[108:111]
  ds_read_b64_tr_b16 v[124:125], v26 offset:32768
  v_mfma_f32_16x16x32_bf16 a[112:115], v[88:91], v[156:159], a[112:115]
  v_mfma_f32_16x16x32_bf16 a[116:119], v[88:91], v[160:163], a[116:119]
  ds_read_b64_tr_b16 v[126:127], v26 offset:34816
  s_add_u32 m0, s52, 69632
  v_mfma_f32_16x16x32_bf16 a[120:123], v[88:91], v[164:167], a[120:123]
  buffer_load_dwordx4 v6, s[8:11], s20 offen  lds
  v_mfma_f32_16x16x32_bf16 a[124:127], v[88:91], v[168:171], a[124:127]
  ds_read_b128 v[64:67], v18 offset:10240
  v_mfma_f32_16x16x32_bf16 a[128:131], v[92:95], v[140:143], a[128:131]
  v_mfma_f32_16x16x32_bf16 a[132:135], v[92:95], v[144:147], a[132:135]
  ds_read_b64_tr_b16 v[128:129], v27 offset:32768
  s_add_u32 m0, s53, 69632
  v_mfma_f32_16x16x32_bf16 a[136:139], v[92:95], v[148:151], a[136:139]
  buffer_load_dwordx4 v14, s[12:15], s21 offen  lds
  v_mfma_f32_16x16x32_bf16 a[140:143], v[92:95], v[152:155], a[140:143]
  ds_read_b64_tr_b16 v[130:131], v27 offset:34816
  v_mfma_f32_16x16x32_bf16 a[144:147], v[92:95], v[156:159], a[144:147]
  v_mfma_f32_16x16x32_bf16 a[148:151], v[92:95], v[160:163], a[148:151]
  ds_read_b128 v[68:71], v18 offset:12288
  s_add_u32 m0, s52, 70656
  v_mfma_f32_16x16x32_bf16 a[152:155], v[92:95], v[164:167], a[152:155]
  buffer_load_dwordx4 v7, s[8:11], s20 offen  lds
  v_mfma_f32_16x16x32_bf16 a[156:159], v[92:95], v[168:171], a[156:159]
  ds_read_b64_tr_b16 v[132:133], v28 offset:32768
  v_mfma_f32_16x16x32_bf16 a[160:163], v[96:99], v[140:143], a[160:163]
  s_add_u32 m0, s53, 70656
  v_mfma_f32_16x16x32_bf16 a[164:167], v[96:99], v[144:147], a[164:167]
  buffer_load_dwordx4 v15, s[12:15], s21 offen  lds
  ds_read_b64_tr_b16 v[134:135], v28 offset:34816
  v_mfma_f32_16x16x32_bf16 a[168:171], v[96:99], v[148:151], a[168:171]
  v_mfma_f32_16x16x32_bf16 a[172:175], v[96:99], v[152:155], a[172:175]
  ds_read_b128 v[72:75], v18 offset:14336
  v_mfma_f32_16x16x32_bf16 a[176:179], v[96:99], v[156:159], a[176:179]
  s_add_u32 m0, s52, 71680
  v_mfma_f32_16x16x32_bf16 a[180:183], v[96:99], v[160:163], a[180:183]
  buffer_load_dwordx4 v8, s[8:11], s20 offen  lds
  ds_read_b64_tr_b16 v[136:137], v29 offset:32768
  v_mfma_f32_16x16x32_bf16 a[184:187], v[96:99], v[164:167], a[184:187]
  v_mfma_f32_16x16x32_bf16 a[188:191], v[96:99], v[168:171], a[188:191]
  ds_read_b64_tr_b16 v[138:139], v29 offset:34816
  v_mfma_f32_16x16x32_bf16 a[192:195], v[100:103], v[140:143], a[192:195]
  s_add_u32 m0, s53, 71680
  v_mfma_f32_16x16x32_bf16 a[196:199], v[100:103], v[144:147], a[196:199]
  buffer_load_dwordx4 v16, s[12:15], s21 offen  lds
  v_mfma_f32_16x16x32_bf16 a[200:203], v[100:103], v[148:151], a[200:203]
  v_mfma_f32_16x16x32_bf16 a[204:207], v[100:103], v[152:155], a[204:207]
  s_add_u32 m0, s52, 72704
  v_mfma_f32_16x16x32_bf16 a[208:211], v[100:103], v[156:159], a[208:211]
  buffer_load_dwordx4 v9, s[8:11], s20 offen  lds
  v_mfma_f32_16x16x32_bf16 a[212:215], v[100:103], v[160:163], a[212:215]
  v_mfma_f32_16x16x32_bf16 a[216:219], v[100:103], v[164:167], a[216:219]
  v_mfma_f32_16x16x32_bf16 a[220:223], v[100:103], v[168:171], a[220:223]
  s_add_u32 m0, s53, 72704
  v_mfma_f32_16x16x32_bf16 a[224:227], v[104:107], v[140:143], a[224:227]
  buffer_load_dwordx4 v17, s[12:15], s21 offen  lds
  v_mfma_f32_16x16x32_bf16 a[228:231], v[104:107], v[144:147], a[228:231]
  v_mfma_f32_16x16x32_bf16 a[232:235], v[104:107], v[148:151], a[232:235]
  v_mfma_f32_16x16x32_bf16 a[236:239], v[104:107], v[152:155], a[236:239]
  s_add_u32 s20, s20, 128
  v_mfma_f32_16x16x32_bf16 a[240:243], v[104:107], v[156:159], a[240:243]
  s_add_u32 s21, s21, s51
  v_mfma_f32_16x16x32_bf16 a[244:247], v[104:107], v[160:163], a[244:247]
  v_mfma_f32_16x16x32_bf16 a[248:251], v[104:107], v[164:167], a[248:251]
  v_mfma_f32_16x16x32_bf16 a[252:255], v[104:107], v[168:171], a[252:255]
L_g2_loop:
  s_sub_u32 s25, s25, 1
  s_cmp_eq_u32 s25, 0
  s_cbranch_scc1 L_g2_fin
  s_waitcnt lgkmcnt(0)
  v_mfma_f32_16x16x32_bf16 a[0:3], v[44:47], v[108:111], a[0:3]
  ds_read_b128 v[76:79], v19 offset:0
  v_mfma_f32_16x16x32_bf16 a[4:7], v[44:47], v[112:115], a[4:7]
  v_mfma_f32_16x16x32_bf16 a[8:11], v[44:47], v[116:119], a[8:11]
  ds_read_b64_tr_b16 v[140:141], v22 offset:49152
  v_mfma_f32_16x16x32_bf16 a[12:15], v[44:47], v[120:123], a[12:15]
  v_mfma_f32_16x16x32_bf16 a[16:19], v[44:47], v[124:127], a[16:19]
  ds_read_b64_tr_b16 v[142:143], v22 offset:51200
  v_mfma_f32_16x16x32_bf16 a[20:23], v[44:47], v[128:131], a[20:23]
  v_mfma_f32_16x16x32_bf16 a[24:27], v[44:47], v[132:135], a[24:27]
  ds_read_b128 v[80:83], v19 offset:2048
  v_mfma_f32_16x16x32_bf16 a[28:31], v[44:47], v[136:139], a[28:31]
  v_mfma_f32_16x16x32_bf16 a[32:35], v[48:51], v[108:111], a[32:35]
  ds_read_b64_tr_b16 v[144:145], v23 offset:49152
  v_mfma_f32_16x16x32_bf16 a[36:39], v[48:51], v[112:115], a[36:39]
  v_mfma_f32_16x16x32_bf16 a[40:43], v[48:51], v[116:119], a[40:43]
  ds_read_b64_tr_b16 v[146:147], v23 offset:51200
  v_mfma_f32_16x16x32_bf16 a[44:47], v[48:51], v[120:123], a[44:47]
  v_mfma_f32_16x16x32_bf16 a[48:51], v[48:51], v[124:127], a[48:51]
  ds_read_b128 v[84:87], v19 offset:4096
  v_mfma_f32_16x16x32_bf16 a[52:55], v[48:51], v[128:131], a[52:55]
  v_mfma_f32_16x16x32_bf16 a[56:59], v[48:51], v[132:135], a[56:59]
  ds_read_b64_tr_b16 v[148:149], v24 offset:49152
  v_mfma_f32_16x16x32_bf16 a[60:63], v[48:51], v[136:139], a[60:63]
  v_mfma_f32_16x16x32_bf16 a[64:67], v[52:55], v[108:111], a[64:67]
  ds_read_b64_tr_b16 v[150:151], v24 offset:51200
  v_mfma_f32_16x16x32_bf16 a[68:71], v[52:55], v[112:115], a[68:71]
  v_mfma_f32_16x16x32_bf16 a[72:75], v[52:55], v[116:119], a[72:75]
  ds_read_b128 v[88:91], v19 offset:6144
  v_mfma_f32_16x16x32_bf16 a[76:79], v[52:55], v[120:123], a[76:79]
  v_mfma_f32_16x16x32_bf16 a[80:83], v[52:55], v[124:127], a[80:83]
  ds_read_b64_tr_b16 v[152:153], v25 offset:49152
  v_mfma_f32_16x16x32_bf16 a[84:87], v[52:55], v[128:131], a[84:87]
  v_mfma_f32_16x16x32_bf16 a[88:91], v[52:55], v[132:135], a[88:91]
  ds_read_b64_tr_b16 v[154:155], v25 offset:51200
  v_mfma_f32_16x16x32_bf16 a[92:95], v[52:55], v[136:139], a[92:95]
  v_mfma_f32_16x16x32_bf16 a[96:99], v[56:59], v[108:111], a[96:99]
  ds_read_b128 v[92:95], v19 offset:8192
  v_mfma_f32_16x16x32_bf16 a[100:103], v[56:59], v[112:115], a[100:103]
  v_mfma_f32_16x16x32_bf16 a[104:107], v[56:59], v[116:119], a[104:107]
  ds_read_b64_tr_b16 v[156:157], v26 offset:49152
  v_mfma_f32_16x16x32_bf16 a[108:111], v[56:59], v[120:123], a[108:111]
  v_mfma_f32_16x16x32_bf16 a[112:115], v[56:59], v[124:127], a[112:115]
  ds_read_b64_tr_b16 v[158:159], v26 offset:51200
  v_mfma_f32_16x16x32_bf16 a[116:119], v[56:59], v[128:131], a[116:119]
  v_mfma_f32_16x16x32_bf16 a[120:123], v[56:59], v[132:135], a[120:123]
  ds_read_b128 v[96:99], v19 offset:10240
  v_mfma_f32_16x16x32_bf16 a[124:127], v[56:59], v[136:139], a[124:127]
  v_mfma_f32_16x16x32_bf16 a[128:131], v[60:63], v[108:111], a[128:131]
  ds_read_b64_tr_b16 v[160:161], v27 offset:49152
  v_mfma_f32_16x16x32_bf16 a[132:135], v[60:63], v[112:115], a[132:135]
  v_mfma_f32_16x16x32_bf16 a[136:139], v[60:63], v[116:119], a[136:139]
  ds_read_b64_tr_b16 v[162:163], v27 offset:51200
  v_mfma_f32_16x16x32_bf16 a[140:143], v[60:63], v[120:123], a[140:143]
  v_mfma_f32_16x16x32_bf16 a[144:147], v[60:63], v[124:127], a[144:147]
  ds_read_b128 v[100:103], v19 offset:12288
  v_mfma_f32_16x16x32_bf16 a[148:151], v[60:63], v[128:131], a[148:151]
  v_mfma_f32_16x16x32_bf16 a[152:155], v[60:63], v[132:135], a[152:155]
  ds_read_b64_tr_b16 v[164:165], v28 offset:49152
  v_mfma_f32_16x16x32_bf16 a[156:159], v[60:63], v[136:139], a[156:159]
  v_mfma_f32_16x16x32_bf16 a[160:163], v[64:67], v[108:111], a[160:163]
  ds_read_b64_tr_b16 v[166:167], v28 offset:51200
  v_mfma_f32_16x16x32_bf16 a[164:167], v[64:67], v[112:115], a[164:167]
  v_mfma_f32_16x16x32_bf16 a[168:171], v[64:67], v[116:119], a[168:171]
  ds_read_b128 v[104:107], v19 offset:14336
  v_mfma_f32_16x16x32_bf16 a[172:175], v[64:67], v[120:123], a[172:175]
  v_mfma_f32_16x16x32_bf16 a[176:179], v[64:67], v[124:127], a[176:179]
  ds_read_b64_tr_b16 v[168:169], v29 offset:49152
  v_mfma_f32_16x16x32_bf16 a[180:183], v[64:67], v[128:131], a[180:183]
  v_mfma_f32_16x16x32_bf16 a[184:187], v[64:67], v[132:135], a[184:187]
  ds_read_b64_tr_b16 v[170:171], v29 offset:51200
  v_mfma_f32_16x16x32_bf16 a[188:191], v[64:67], v[136:139], a[188:191]
  v_mfma_f32_16x16x32_bf16 a[192:195], v[68:71], v[108:111], a[192:195]
  v_mfma_f32_16x16x32_bf16 a[196:199], v[68:71], v[112:115], a[196:199]
  v_mfma_f32_16x16x32_bf16 a[200:203], v[68:71], v[116:119], a[200:203]
  v_mfma_f32_16x16x32_bf16 a[204:207], v[68:71], v[120:123], a[204:207]
  v_mfma_f32_16x16x32_bf16 a[208:211], v[68:71], v[124:127], a[208:211]
  v_mfma_f32_16x16x32_bf16 a[212:215], v[68:71], v[128:131], a[212:215]
  v_mfma_f32_16x16x32_bf16 a[216:219], v[68:71], v[132:135], a[216:219]
  v_mfma_f32_16x16x32_bf16 a[220:223], v[68:71], v[136:139], a[220:223]
  v_mfma_f32_16x16x32_bf16 a[224:227], v[72:75], v[108:111], a[224:227]
  v_mfma_f32_16x16x32_bf16 a[228:231], v[72:75], v[112:115], a[228:231]
  v_mfma_f32_16x16x32_bf16 a[232:235], v[72:75], v[116:119], a[232:235]
  v_mfma_f32_16x16x32_bf16 a[236:239], v[72:75], v[120:123], a[236:239]
  v_mfma_f32_16x16x32_bf16 a[240:243], v[72:75], v[124:127], a[240:243]
  v_mfma_f32_16x16x32_bf16 a[244:247], v[72:75], v[128:131], a[244:247]
  v_mfma_f32_16x16x32_bf16 a[248:251], v[72:75], v[132:135], a[248:251]
  v_mfma_f32_16x16x32_bf16 a[252:255], v[72:75], v[136:139], a[252:255]
  s_waitcnt lgkmcnt(0)
  v_mfma_f32_16x16x32_bf16 a[0:3], v[76:79], v[140:143], a[0:3]
  s_waitcnt vmcnt(0)
  s_barrier
  s_add_u32 m0, s52, 0
  v_mfma_f32_16x16x32_bf16 a[4:7], v[76:79], v[144:147], a[4:7]
  buffer_load_dwordx4 v2, s[8:11], s20 offen  lds
  ds_read_b128 v[44:47], v20 offset:0
  v_mfma_f32_16x16x32_bf16 a[8:11], v[76:79], v[148:151], a[8:11]
  v_mfma_f32_16x16x32_bf16 a[12:15], v[76:79], v[152:155], a[12:15]
  ds_read_b64_tr_b16 v[108:109], v30 offset:32768
  s_add_u32 m0, s53, 0
  v_mfma_f32_16x16x32_bf16 a[16:19], v[76:79], v[156:159], a[16:19]
  buffer_load_dwordx4 v10, s[12:15], s21 offen  lds
  v_mfma_f32_16x16x32_bf16 a[20:23], v[76:79], v[160:163], a[20:23]
  ds_read_b64_tr_b16 v[110:111], v30 offset:34816
  v_mfma_f32_16x16x32_bf16 a[24:27], v[76:79], v[164:167], a[24:27]
  v_mfma_f32_16x16x32_bf16 a[28:31], v[76:79], v[168:171], a[28:31]
  ds_read_b128 v[48:51], v20 offset:2048
  s_add_u32 m0, s52, 1024
  v_mfma_f32_16x16x32_bf16 a[32:35], v[80:83], v[140:143], a[32:35]
  buffer_load_dwordx4 v3, s[8:11], s20 offen  lds
  v_mfma_f32_16x16x32_bf16 a[36:39], v[80:83], v[144:147], a[36:39]
  ds_read_b64_tr_b16 v[112:113], v31 offset:32768
  v_mfma_f32_16x16x32_bf16 a[40:43], v[80:83], v[148:151], a[40:43]
  v_mfma_f32_16x16x32_bf16 a[44:47], v[80:83], v[152:155], a[44:47]
  ds_read_b64_tr_b16 v[114:115], v31 offset:34816
  s_add_u32 m0, s53, 1024
  v_mfma_f32_16x16x32_bf16 a[48:51], v[80:83], v[156:159], a[48:51]
  buffer_load_dwordx4 v11, s[12:15], s21 offen  lds
  v_mfma_f32_16x16x32_bf16 a[52:55], v[80:83], v[160:163], a[52:55]
  ds_read_b128 v[52:55], v20 offset:4096
  v_mfma_f32_16x16x32_bf16 a[56:59], v[80:83], v[164:167], a[56:59]
  s_add_u32 m0, s52, 2048
  v_mfma_f32_16x16x32_bf16 a[60:63], v[80:83], v[168:171], a[60:63]
  buffer_load_dwordx4 v4, s[8:11], s20 offen  lds
  ds_read_b64_tr_b16 v[116:117], v32 offset:32768
  v_mfma_f32_16x16x32_bf16 a[64:67], v[84:87], v[140:143], a[64:67]
  v_mfma_f32_16x16x32_bf16 a[68:71], v[84:87], v[144:147], a[68:71]
  ds_read_b64_tr_b16 v[118:119], v32 offset:34816
  v_mfma_f32_16x16x32_bf16 a[72:75], v[84:87], v[148:151], a[72:75]
  s_add_u32 m0, s53, 2048
  v_mfma_f32_16x16x32_bf16 a[76:79], v[84:87], v[152:155], a[76:79]
  buffer_load_dwordx4 v12, s[12:15], s21 offen  lds
  ds_read_b128 v[56:59], v20 offset:6144
  v_mfma_f32_16x16x32_bf16 a[80:83], v[84:87], v[156:159], a[80:83]
  v_mfma_f32_16x16x32_bf16 a[84:87], v[84:87], v[160:163], a[84:87]
  ds_read_b64_tr_b16 v[120:121], v33 offset:32768
  v_mfma_f32_16x16x32_bf16 a[88:91], v[84:87], v[164:167], a[88:91]
  s_add_u32 m0, s52, 3072
  v_mfma_f32_16x16x32_bf16 a[92:95], v[84:87], v[168:171], a[92:95]
  buffer_load_dwordx4 v5, s[8:11], s20 offen  lds
  ds_read_b64_tr_b16 v[122:123], v33 offset:34816
  v_mfma_f32_16x16x32_bf16 a[96:99], v[88:91], v[140:143], a[96:99]
  v_mfma_f32_16x16x32_bf16 a[100:103], v[88:91], v[144:147], a[100:103]
  ds_read_b128 v[60:63], v20 offset:8192
  s_add_u32 m0, s53, 3072
  v_mfma_f32_16x16x32_bf16 a[104:107], v[88:91], v[148:151], a[104:107]
  buffer_load_dwordx4 v13, s[12:15], s21 offen  lds
  v_mfma_f32_16x16x32_bf16 a[108:111], v[88:91], v[152:155], a[108:111]
  ds_read_b64_tr_b16 v[124:125], v34 offset:32768
  v_mfma_f32_16x16x32_bf16 a[112:115], v[88:91], v[156:159], a[112:115]
  v_mfma_f32_16x16x32_bf16 a[116:119], v[88:91], v[160:163], a[116:119]
  ds_read_b64_tr_b16 v[126:127], v34 offset:34816
  s_add_u32 m0, s52, 4096
  v_mfma_f32_16x16x32_bf16 a[120:123], v[88:91], v[164:167], a[120:123]
  buffer_load_dwordx4 v6, s[8:11], s20 offen  lds
  v_mfma_f32_16x16x32_bf16 a[124:127], v[88:91], v[168:171], a[124:127]
  ds_read_b128 v[64:67], v20 offset:10240
  v_mfma_f32_16x16x32_bf16 a[128:131], v[92:95], v[140:143], a[128:131]
  v_mfma_f32_16x16x32_bf16 a[132:135], v[92:95], v[144:147], a[132:135]
  ds_read_b64_tr_b16 v[128:129], v35 offset:32768
  s_add_u32 m0, s53, 4096
  v_mfma_f32_16x16x32_bf16 a[136:139], v[92:95], v[148:151], a[136:139]
  buffer_load_dwordx4 v14, s[12:15], s21 offen  lds
  v_mfma_f32_16x16x32_bf16 a[140:143], v[92:95], v[152:155], a[140:143]
  ds_read_b64_tr_b16 v[130:131], v35 offset:34816
  v_mfma_f32_16x16x32_bf16 a[144:147], v[92:95], v[156:159], a[144:147]
  v_mfma_f32_16x16x32_bf16 a[148:151], v[92:95], v[160:163], a[148:151]
  ds_read_b128 v[68:71], v20 offset:12288
  s_add_u32 m0, s52, 5120
  v_mfma_f32_16x16x32_bf16 a[152:155], v[92:95], v[164:167], a[152:155]
  buffer_load_dwordx4 v7, s[8:11], s20 offen  lds
  v_mfma_f32_16x16x32_bf16 a[156:159], v[92:95], v[168:171], a[156:159]
  ds_read_b64_tr_b16 v[132:133], v36 offset:32768
  v_mfma_f32_16x16x32_bf16 a[160:163], v[96:99], v[140:143], a[160:163]
  s_add_u32 m0, s53, 5120
  v_mfma_f32_16x16x32_bf16 a[164:167], v[96:99], v[144:147], a[164:167]
  buffer_load_dwordx4 v15, s[12:15], s21 offen  lds
  ds_read_b64_tr_b16 v[134:135], v36 offset:34816
  v_mfma_f32_16x16x32_bf16 a[168:171], v[96:99], v[148:151], a[168:171]
  v_mfma_f32_16x16x32_bf16 a[172:175], v[96:99], v[152:155], a[172:175]
  ds_read_b128 v[72:75], v20 offset:14336
  v_mfma_f32_16x16x32_bf16 a[176:179], v[96:99], v[156:159], a[176:179]
  s_add_u32 m0, s52, 6144
  v_mfma_f32_16x16x32_bf16 a[180:183], v[96:99], v[160:163], a[180:183]
  buffer_load_dwordx4 v8, s[8:11], s20 offen  lds
  ds_read_b64_tr_b16 v[136:137], v37 offset:32768
  v_mfma_f32_16x16x32_bf16 a[184:187], v[96:99], v[164:167], a[184:187]
  v_mfma_f32_16x16x32_bf16 a[188:191], v[96:99], v[168:171], a[188:191]
  ds_read_b64_tr_b16 v[138:139], v37 offset:34816
  v_mfma_f32_16x16x32_bf16 a[192:195], v[100:103], v[140:143], a[192:195]
  s_add_u32 m0, s53, 6144
  v_mfma_f32_16x16x32_bf16 a[196:199], v[100:103], v[144:147], a[196:199]
  buffer_load_dwordx4 v16, s[12:15], s21 offen  lds
  v_mfma_f32_16x16x32_bf16 a[200:203], v[100:103], v[148:151], a[200:203]
  v_mfma_f32_16x16x32_bf16 a[204:207], v[100:103], v[152:155], a[204:207]
  s_add_u32 m0, s52, 7168
  v_mfma_f32_16x16x32_bf16 a[208:211], v[100:103], v[156:159], a[208:211]
  buffer_load_dwordx4 v9, s[8:11], s20 offen  lds
  v_mfma_f32_16x16x32_bf16 a[212:215], v[100:103], v[160:163], a[212:215]
  v_mfma_f32_16x16x32_bf16 a[216:219], v[100:103], v[164:167], a[216:219]
  v_mfma_f32_16x16x32_bf16 a[220:223], v[100:103], v[168:171], a[220:223]
  s_add_u32 m0, s53, 7168
  v_mfma_f32_16x16x32_bf16 a[224:227], v[104:107], v[140:143], a[224:227]
  buffer_load_dwordx4 v17, s[12:15], s21 offen  lds
  v_mfma_f32_16x16x32_bf16 a[228:231], v[104:107], v[144:147], a[228:231]
  v_mfma_f32_16x16x32_bf16 a[232:235], v[104:107], v[148:151], a[232:235]
  v_mfma_f32_16x16x32_bf16 a[236:239], v[104:107], v[152:155], a[236:239]
  s_add_u32 s20, s20, 128
  v_mfma_f32_16x16x32_bf16 a[240:243], v[104:107], v[156:159], a[240:243]
  s_add_u32 s21, s21, s51
  v_mfma_f32_16x16x32_bf16 a[244:247], v[104:107], v[160:163], a[244:247]
  v_mfma_f32_16x16x32_bf16 a[248:251], v[104:107], v[164:167], a[248:251]
  v_mfma_f32_16x16x32_bf16 a[252:255], v[104:107], v[168:171], a[252:255]
  s_waitcnt lgkmcnt(0)
  s_cmp_eq_u32 s25, 1
  s_cbranch_scc1 L_g2_cw
L_g2_cwb:
  v_mfma_f32_16x16x32_bf16 a[0:3], v[44:47], v[108:111], a[0:3]
  ds_read_b128 v[76:79], v21 offset:0
  v_mfma_f32_16x16x32_bf16 a[4:7], v[44:47], v[112:115], a[4:7]
  v_mfma_f32_16x16x32_bf16 a[8:11], v[44:47], v[116:119], a[8:11]
  ds_read_b64_tr_b16 v[140:141], v30 offset:49152
  v_mfma_f32_16x16x32_bf16 a[12:15], v[44:47], v[120:123], a[12:15]
  v_mfma_f32_16x16x32_bf16 a[16:19], v[44:47], v[124:127], a[16:19]
  ds_read_b64_tr_b16 v[142:143], v30 offset:51200
  v_mfma_f32_16x16x32_bf16 a[20:23], v[44:47], v[128:131], a[20:23]
  v_mfma_f32_16x16x32_bf16 a[24:27], v[44:47], v[132:135], a[24:27]
  ds_read_b128 v[80:83], v21 offset:2048
  v_mfma_f32_16x16x32_bf16 a[28:31], v[44:47], v[136:139], a[28:31]
  v_mfma_f32_16x16x32_bf16 a[32:35], v[48:51], v[108:111], a[32:35]
  ds_read_b64_tr_b16 v[144:145], v31 offset:49152
  v_mfma_f32_16x16x32_bf16 a[36:39], v[48:51], v[112:115], a[36:39]
  v_mfma_f32_16x16x32_bf16 a[40:43], v[48:51], v[116:119], a[40:43]
  ds_read_b64_tr_b16 v[146:147], v31 offset:51200
  v_mfma_f32_16x16x32_bf16 a[44:47], v[48:51], v[120:123], a[44:47]
  v_mfma_f32_16x16x32_bf16 a[48:51], v[48:51], v[124:127], a[48:51]
  ds_read_b128 v[84:87], v21 offset:4096
  v_mfma_f32_16x16x32_bf16 a[52:55], v[48:51], v[128:131], a[52:55]
  v_mfma_f32_16x16x32_bf16 a[56:59], v[48:51], v[132:135], a[56:59]
  ds_read_b64_tr_b16 v[148:149], v32 offset:49152
  v_mfma_f32_16x16x32_bf16 a[60:63], v[48:51], v[136:139], a[60:63]
  v_mfma_f32_16x16x32_bf16 a[64:67], v[52:55], v[108:111], a[64:67]
  ds_read_b64_tr_b16 v[150:151], v32 offset:51200
  v_mfma_f32_16x16x32_bf16 a[68:71], v[52:55], v[112:115], a[68:71]
  v_mfma_f32_16x16x32_bf16 a[72:75], v[52:55], v[116:119], a[72:75]
  ds_read_b128 v[88:91], v21 offset:6144
  v_mfma_f32_16x16x32_bf16 a[76:79], v[52:55], v[120:123], a[76:79]
  v_mfma_f32_16x16x32_bf16 a[80:83], v[52:55], v[124:127], a[80:83]
  ds_read_b64_tr_b16 v[152:153], v33 offset:49152
  v_mfma_f32_16x16x32_bf16 a[84:87], v[52:55], v[128:131], a[84:87]
  v_mfma_f32_16x16x32_bf16 a[88:91], v[52:55], v[132:135], a[88:91]
  ds_read_b64_tr_b16 v[154:155], v33 offset:51200
  v_mfma_f32_16x16x32_bf16 a[92:95], v[52:55], v[136:139], a[92:95]
  v_mfma_f32_16x16x32_bf16 a[96:99], v[56:59], v[108:111], a[96:99]
  ds_read_b128 v[92:95], v21 offset:8192
  v_mfma_f32_16x16x32_bf16 a[100:103], v[56:59], v[112:115], a[100:103]
  v_mfma_f32_16x16x32_bf16 a[104:107], v[56:59], v[116:119], a[104:107]
  ds_read_b64_tr_b16 v[156:157], v34 offset:49152
  v_mfma_f32_16x16x32_bf16 a[108:111], v[56:59], v[120:123], a[108:111]
  v_mfma_f32_16x16x32_bf16 a[112:115], v[56:59], v[124:127], a[112:115]
  ds_read_b64_tr_b16 v[158:159], v34 offset:51200
  v_mfma_f32_16x16x32_bf16 a[116:119], v[56:59], v[128:131], a[116:119]
  v_mfma_f32_16x16x32_bf16 a[120:123], v[56:59], v[132:135], a[120:123]
  ds_read_b128 v[96:99], v21 offset:10240
  v_mfma_f32_16x16x32_bf16 a[124:127], v[56:59], v[136:139], a[124:127]
  v_mfma_f32_16x16x32_bf16 a[128:131], v[60:63], v[108:111], a[128:131]
  ds_read_b64_tr_b16 v[160:161], v35 offset:49152
  v_mfma_f32_16x16x32_bf16 a[132:135], v[60:63], v[112:115], a[132:135]
  v_mfma_f32_16x16x32_bf16 a[136:139], v[60:63], v[116:119], a[136:139]
  ds_read_b64_tr_b16 v[162:163], v35 offset:51200
  v_mfma_f32_16x16x32_bf16 a[140:143], v[60:63], v[120:123], a[140:143]
  v_mfma_f32_16x16x32_bf16 a[144:147], v[60:63], v[124:127], a[144:147]
  ds_read_b128 v[100:103], v21 offset:12288
  v_mfma_f32_16x16x32_bf16 a[148:151], v[60:63], v[128:131], a[148:151]
  v_mfma_f32_16x16x32_bf16 a[152:155], v[60:63], v[132:135], a[152:155]
  ds_read_b64_tr_b16 v[164:165], v36 offset:49152
  v_mfma_f32_16x16x32_bf16 a[156:159], v[60:63], v[136:139], a[156:159]
  v_mfma_f32_16x16x32_bf16 a[160:163], v[64:67], v[108:111], a[160:163]
  ds_read_b64_tr_b16 v[166:167], v36 offset:51200
  v_mfma_f32_16x16x32_bf16 a[164:167], v[64:67], v[112:115], a[164:167]
  v_mfma_f32_16x16x32_bf16 a[168:171], v[64:67], v[116:119], a[168:171]
  ds_read_b128 v[104:107], v21 offset:14336
  v_mfma_f32_16x16x32_bf16 a[172:175], v[64:67], v[120:123], a[172:175]
  v_mfma_f32_16x16x32_bf16 a[176:179], v[64:67], v[124:127], a[176:179]
  ds_read_b64_tr_b16 v[168:169], v37 offset:49152
  v_mfma_f32_16x16x32_bf16 a[180:183], v[64:67], v[128:131], a[180:183]
  v_mfma_f32_16x16x32_bf16 a[184:187], v[64:67], v[132:135], a[184:187]
  ds_read_b64_tr_b16 v[170:171], v37 offset:51200
  v_mfma_f32_16x16x32_bf16 a[188:191], v[64:67], v[136:139], a[188:191]
  v_mfma_f32_16x16x32_bf16 a[192:195], v[68:71], v[108:111], a[192:195]
  v_mfma_f32_16x16x32_bf16 a[196:199], v[68:71], v[112:115], a[196:199]
  v_mfma_f32_16x16x32_bf16 a[200:203], v[68:71], v[116:119], a[200:203]
  v_mfma_f32_16x16x32_bf16 a[204:207], v[68:71], v[120:123], a[204:207]
  v_mfma_f32_16x16x32_bf16 a[208:211], v[68:71], v[124:127], a[208:211]
  v_mfma_f32_16x16x32_bf16 a[212:215], v[68:71], v[128:131], a[212:215]
  v_mfma_f32_16x16x32_bf16 a[216:219], v[68:71], v[132:135], a[216:219]
  v_mfma_f32_16x16x32_bf16 a[220:223], v[68:71], v[136:139], a[220:223]
  v_mfma_f32_16x16x32_bf16 a[224:227], v[72:75], v[108:111], a[224:227]
  v_mfma_f32_16x16x32_bf16 a[228:231], v[72:75], v[112:115], a[228:231]
  v_mfma_f32_16x16x32_bf16 a[232:235], v[72:75], v[116:119], a[232:235]
  v_mfma_f32_16x16x32_bf16 a[236:239], v[72:75], v[120:123], a[236:239]
  v_mfma_f32_16x16x32_bf16 a[240:243], v[72:75], v[124:127], a[240:243]
  v_mfma_f32_16x16x32_bf16 a[244:247], v[72:75], v[128:131], a[244:247]
  v_mfma_f32_16x16x32_bf16 a[248:251], v[72:75], v[132:135], a[248:251]
  v_mfma_f32_16x16x32_bf16 a[252:255], v[72:75], v[136:139], a[252:255]
  s_waitcnt lgkmcnt(0)
  v_mfma_f32_16x16x32_bf16 a[0:3], v[76:79], v[140:143], a[0:3]
  s_waitcnt vmcnt(0)
  s_barrier
  s_cmp_le_u32 s25, 2
  s_cbranch_scc1 L_g2_cr
L_g2_crb:
  s_add_u32 m0, s52, 65536
  v_mfma_f32_16x16x32_bf16 a[4:7], v[76:79], v[144:147], a[4:7]
  buffer_load_dwordx4 v2, s[8:11], s20 offen  lds
  ds_read_b128 v[44:47], v18 offset:0
  v_mfma_f32_16x16x32_bf16 a[8:11], v[76:79], v[148:151], a[8:11]
  v_mfma_f32_16x16x32_bf16 a[12:15], v[76:79], v[152:155], a[12:15]
  ds_read_b64_tr_b16 v[108:109], v22 offset:32768
  s_add_u32 m0, s53, 65536
  v_mfma_f32_16x16x32_bf16 a[16:19], v[76:79], v[156:159], a[16:19]
  buffer_load_dwordx4 v10, s[12:15], s21 offen  lds
  v_mfma_f32_16x16x32_bf16 a[20:23], v[76:79], v[160:163], a[20:23]
  ds_read_b64_tr_b16 v[110:111], v22 offset:34816
  v_mfma_f32_16x16x32_bf16 a[24:27], v[76:79], v[164:167], a[24:27]
  v_mfma_f32_16x16x32_bf16 a[28:31], v[76:79], v[168:171], a[28:31]
  ds_read_b128 v[48:51], v18 offset:2048
  s_add_u32 m0, s52, 66560
  v_mfma_f32_16x16x32_bf16 a[32:35], v[80:83], v[140:143], a[32:35]
  buffer_load_dwordx4 v3, s[8:11], s20 offen  lds
  v_mfma_f32_16x16x32_bf16 a[36:39], v[80:83], v[144:147], a[36:39]
  ds_read_b64_tr_b16 v[112:113], v23 offset:32768
  v_mfma_f32_16x16x32_bf16 a[40:43], v[80:83], v[148:151], a[40:43]
  v_mfma_f32_16x16x32_bf16 a[44:47], v[80:83], v[152:155], a[44:47]
  ds_read_b64_tr_b16 v[114:115], v23 offset:34816
  s_add_u32 m0, s53, 66560
  v_mfma_f32_16x16x32_bf16 a[48:51], v[80:83], v[156:159], a[48:51]
  buffer_load_dwordx4 v11, s[12:15], s21 offen  lds
  v_mfma_f32_16x16x32_bf16 a[52:55], v[80:83], v[160:163], a[52:55]
  ds_read_b128 v[52:55], v18 offset:4096
  v_mfma_f32_16x16x32_bf16 a[56:59], v[80:83], v[164:167], a[56:59]
  s_add_u32 m0, s52, 67584
  v_mfma_f32_16x16x32_bf16 a[60:63], v[80:83], v[168:171], a[60:63]
  buffer_load_dwordx4 v4, s[8:11], s20 offen  lds
  ds_read_b64_tr_b16 v[116:117], v24 offset:32768
  v_mfma_f32_16x16x32_bf16 a[64:67], v[84:87], v[140:143], a[64:67]
  v_mfma_f32_16x16x32_bf16 a[68:71], v[84:87], v[144:147], a[68:71]
  ds_read_b64_tr_b16 v[118:119], v24 offset:34816
  v_mfma_f32_16x16x32_bf16 a[72:75], v[84:87], v[148:151], a[72:75]
  s_add_u32 m0, s53, 67584
  v_mfma_f32_16x16x32_bf16 a[76:79], v[84:87], v[152:155], a[76:79]
  buffer_load_dwordx4 v12, s[12:15], s21 offen  lds
  ds_read_b128 v[56:59], v18 offset:6144
  v_mfma_f32_16x16x32_bf16 a[80:83], v[84:87], v[156:159], a[80:83]
  v_mfma_f32_16x16x32_bf16 a[84:87], v[84:87], v[160:163], a[84:87]
  ds_read_b64_tr_b16 v[120:121], v25 offset:32768
  v_mfma_f32_16x16x32_bf16 a[88:91], v[84:87], v[164:167], a[88:91]
  s_add_u32 m0, s52, 68608
  v_mfma_f32_16x16x32_bf16 a[92:95], v[84:87], v[168:171], a[92:95]
  buffer_load_dwordx4 v5, s[8:11], s20 offen  lds
  ds_read_b64_tr_b16 v[122:123], v25 offset:34816
  v_mfma_f32_16x16x32_bf16 a[96:99], v[88:91], v[140:143], a[96:99]
  v_mfma_f32_16x16x32_bf16 a[100:103], v[88:91], v[144:147], a[100:103]
  ds_read_b128 v[60:63], v18 offset:8192
  s_add_u32 m0, s53, 68608
  v_mfma_f32_16x16x32_bf16 a[104:107], v[88:91], v[148:151], a[104:107]
  buffer_load_dwordx4 v13, s[12:15], s21 offen  lds
  v_mfma_f32_16x16x32_bf16 a[108:111], v[88:91], v[152:155], a[108:111]
  ds_read_b64_tr_b16 v[124:125], v26 offset:32768
  v_mfma_f32_16x16x32_bf16 a[112:115], v[88:91], v[156:159], a[112:115]
  v_mfma_f32_16x16x32_bf16 a[116:119], v[88:91], v[160:163], a[116:119]
  ds_read_b64_tr_b16 v[126:127], v26 offset:34816
  s_add_u32 m0, s52, 69632
  v_mfma_f32_16x16x32_bf16 a[120:123], v[88:91], v[164:167], a[120:123]
  buffer_load_dwordx4 v6, s[8:11], s20 offen  lds
  v_mfma_f32_16x16x32_bf16 a[124:127], v[88:91], v[168:171], a[124:127]
  ds_read_b128 v[64:67], v18 offset:10240
  v_mfma_f32_16x16x32_bf16 a[128:131], v[92:95], v[140:143], a[128:131]
  v_mfma_f32_16x16x32_bf16 a[132:135], v[92:95], v[144:147], a[132:135]
  ds_read_b64_tr_b16 v[128:129], v27 offset:32768
  s_add_u32 m0, s53, 69632
  v_mfma_f32_16x16x32_bf16 a[136:139], v[92:95], v[148:151], a[136:139]
  buffer_load_dwordx4 v14, s[12:15], s21 offen  lds
  v_mfma_f32_16x16x32_bf16 a[140:143], v[92:95], v[152:155], a[140:143]
  ds_read_b64_tr_b16 v[130:131], v27 offset:34816
  v_mfma_f32_16x16x32_bf16 a[144:147], v[92:95], v[156:159], a[144:147]
  v_mfma_f32_16x16x32_bf16 a[148:151], v[92:95], v[160:163], a[148:151]
  ds_read_b128 v[68:71], v18 offset:12288
  s_add_u32 m0, s52, 70656
  v_mfma_f32_16x16x32_bf16 a[152:155], v[92:95], v[164:167], a[152:155]
  buffer_load_dwordx4 v7, s[8:11], s20 offen  lds
  v_mfma_f32_16x16x32_bf16 a[156:159], v[92:95], v[168:171], a[156:159]
  ds_read_b64_tr_b16 v[132:133], v28 offset:32768
  v_mfma_f32_16x16x32_bf16 a[160:163], v[96:99], v[140:143], a[160:163]
  s_add_u32 m0, s53, 70656
  v_mfma_f32_16x16x32_bf16 a[164:167], v[96:99], v[144:147], a[164:167]
  buffer_load_dwordx4 v15, s[12:15], s21 offen  lds
  ds_read_b64_tr_b16 v[134:135], v28 offset:34816
  v_mfma_f32_16x16x32_bf16 a[168:171], v[96:99], v[148:151], a[168:171]
  v_mfma_f32_16x16x32_bf16 a[172:175], v[96:99], v[152:155], a[172:175]
  ds_read_b128 v[72:75], v18 offset:14336
  v_mfma_f32_16x16x32_bf16 a[176:179], v[96:99], v[156:159], a[176:179]
  s_add_u32 m0, s52, 71680
  v_mfma_f32_16x16x32_bf16 a[180:183], v[96:99], v[160:163], a[180:183]
  buffer_load_dwordx4 v8, s[8:11], s20 offen  lds
  ds_read_b64_tr_b16 v[136:137], v29 offset:32768
  v_mfma_f32_16x16x32_bf16 a[184:187], v[96:99], v[164:167], a[184:187]
  v_mfma_f32_16x16x32_bf16 a[188:191], v[96:99], v[168:171], a[188:191]
  ds_read_b64_tr_b16 v[138:139], v29 offset:34816
  v_mfma_f32_16x16x32_bf16 a[192:195], v[100:103], v[140:143], a[192:195]
  s_add_u32 m0, s53, 71680
  v_mfma_f32_16x16x32_bf16 a[196:199], v[100:103], v[144:147], a[196:199]
  buffer_load_dwordx4 v16, s[12:15], s21 offen  lds
  v_mfma_f32_16x16x32_bf16 a[200:203], v[100:103], v[148:151], a[200:203]
  v_mfma_f32_16x16x32_bf16 a[204:207], v[100:103], v[152:155], a[204:207]
  s_add_u32 m0, s52, 72704
  v_mfma_f32_16x16x32_bf16 a[208:211], v[100:103], v[156:159], a[208:211]
  buffer_load_dwordx4 v9, s[8:11], s20 offen  lds
  v_mfma_f32_16x16x32_bf16 a[212:215], v[100:103], v[160:163], a[212:215]
  v_mfma_f32_16x16x32_bf16 a[216:219], v[100:103], v[164:167], a[216:219]
  v_mfma_f32_16x16x32_bf16 a[220:223], v[100:103], v[168:171], a[220:223]
  s_add_u32 m0, s53, 72704
  v_mfma_f32_16x16x32_bf16 a[224:227], v[104:107], v[140:143], a[224:227]
  buffer_load_dwordx4 v17, s[12:15], s21 offen  lds
  v_mfma_f32_16x16x32_bf16 a[228:231], v[104:107], v[144:147], a[228:231]
  v_mfma_f32_16x16x32_bf16 a[232:235], v[104:107], v[148:151], a[232:235]
  v_mfma_f32_16x16x32_bf16 a[236:239], v[104:107], v[152:155], a[236:239]
  s_add_u32 s20, s20, 128
  v_mfma_f32_16x16x32_bf16 a[240:243], v[104:107], v[156:159], a[240:243]
  s_add_u32 s21, s21, s51
  v_mfma_f32_16x16x32_bf16 a[244:247], v[104:107], v[160:163], a[244:247]
  v_mfma_f32_16x16x32_bf16 a[248:251], v[104:107], v[164:167], a[248:251]
  v_mfma_f32_16x16x32_bf16 a[252:255], v[104:107], v[168:171], a[252:255]
  s_branch L_g2_loop
L_g2_fin:
  s_mov_b32 s59, 2
  s_mov_b32 s60, s22
  s_mov_b32 s61, s26
  s_add_u32 s62, s38, 0x3d00000
  s_mov_b32 s63, s98
  s_waitcnt lgkmcnt(0)
  v_min_u32 v245, 270, v246
  v_lshlrev_b32 v245, 2, v245
  v_add_u32 v245, 147648, v245
  ds_read_b32 v245, v245
  v_readfirstlane_b32 s34, v246
  s_add_u32 s34, s34, 32
  v_mfma_f32_16x16x32_bf16 a[0:3], v[44:47], v[108:111], a[0:3]
  ds_read_b128 v[76:79], v19 offset:0
  v_mfma_f32_16x16x32_bf16 a[4:7], v[44:47], v[112:115], a[4:7]
  v_mfma_f32_16x16x32_bf16 a[8:11], v[44:47], v[116:119], a[8:11]
  ds_read_b64_tr_b16 v[140:141], v22 offset:49152
  v_mfma_f32_16x16x32_bf16 a[12:15], v[44:47], v[120:123], a[12:15]
  v_mfma_f32_16x16x32_bf16 a[16:19], v[44:47], v[124:127], a[16:19]
  ds_read_b64_tr_b16 v[142:143], v22 offset:51200
  v_mfma_f32_16x16x32_bf16 a[20:23], v[44:47], v[128:131], a[20:23]
  v_mfma_f32_16x16x32_bf16 a[24:27], v[44:47], v[132:135], a[24:27]
  ds_read_b128 v[80:83], v19 offset:2048
  v_mfma_f32_16x16x32_bf16 a[28:31], v[44:47], v[136:139], a[28:31]
  v_mfma_f32_16x16x32_bf16 a[32:35], v[48:51], v[108:111], a[32:35]
  ds_read_b64_tr_b16 v[144:145], v23 offset:49152
  v_mfma_f32_16x16x32_bf16 a[36:39], v[48:51], v[112:115], a[36:39]
  v_mfma_f32_16x16x32_bf16 a[40:43], v[48:51], v[116:119], a[40:43]
  ds_read_b64_tr_b16 v[146:147], v23 offset:51200
  v_mfma_f32_16x16x32_bf16 a[44:47], v[48:51], v[120:123], a[44:47]
  v_mfma_f32_16x16x32_bf16 a[48:51], v[48:51], v[124:127], a[48:51]
  ds_read_b128 v[84:87], v19 offset:4096
  v_mfma_f32_16x16x32_bf16 a[52:55], v[48:51], v[128:131], a[52:55]
  v_mfma_f32_16x16x32_bf16 a[56:59], v[48:51], v[132:135], a[56:59]
  ds_read_b64_tr_b16 v[148:149], v24 offset:49152
  v_mfma_f32_16x16x32_bf16 a[60:63], v[48:51], v[136:139], a[60:63]
  v_mfma_f32_16x16x32_bf16 a[64:67], v[52:55], v[108:111], a[64:67]
  ds_read_b64_tr_b16 v[150:151], v24 offset:51200
  v_mfma_f32_16x16x32_bf16 a[68:71], v[52:55], v[112:115], a[68:71]
  v_mfma_f32_16x16x32_bf16 a[72:75], v[52:55], v[116:119], a[72:75]
  ds_read_b128 v[88:91], v19 offset:6144
  v_mfma_f32_16x16x32_bf16 a[76:79], v[52:55], v[120:123], a[76:79]
  v_mfma_f32_16x16x32_bf16 a[80:83], v[52:55], v[124:127], a[80:83]
  ds_read_b64_tr_b16 v[152:153], v25 offset:49152
  v_mfma_f32_16x16x32_bf16 a[84:87], v[52:55], v[128:131], a[84:87]
  v_mfma_f32_16x16x32_bf16 a[88:91], v[52:55], v[132:135], a[88:91]
  ds_read_b64_tr_b16 v[154:155], v25 offset:51200
  v_mfma_f32_16x16x32_bf16 a[92:95], v[52:55], v[136:139], a[92:95]
  v_mfma_f32_16x16x32_bf16 a[96:99], v[56:59], v[108:111], a[96:99]
  ds_read_b128 v[92:95], v19 offset:8192
  v_mfma_f32_16x16x32_bf16 a[100:103], v[56:59], v[112:115], a[100:103]
  v_mfma_f32_16x16x32_bf16 a[104:107], v[56:59], v[116:119], a[104:107]
  ds_read_b64_tr_b16 v[156:157], v26 offset:49152
  v_mfma_f32_16x16x32_bf16 a[108:111], v[56:59], v[120:123], a[108:111]
  v_mfma_f32_16x16x32_bf16 a[112:115], v[56:59], v[124:127], a[112:115]
  ds_read_b64_tr_b16 v[158:159], v26 offset:51200
  v_mfma_f32_16x16x32_bf16 a[116:119], v[56:59], v[128:131], a[116:119]
  v_mfma_f32_16x16x32_bf16 a[120:123], v[56:59], v[132:135], a[120:123]
  ds_read_b128 v[96:99], v19 offset:10240
  v_mfma_f32_16x16x32_bf16 a[124:127], v[56:59], v[136:139], a[124:127]
  v_mfma_f32_16x16x32_bf16 a[128:131], v[60:63], v[108:111], a[128:131]
  ds_read_b64_tr_b16 v[160:161], v27 offset:49152
  v_mfma_f32_16x16x32_bf16 a[132:135], v[60:63], v[112:115], a[132:135]
  v_mfma_f32_16x16x32_bf16 a[136:139], v[60:63], v[116:119], a[136:139]
  ds_read_b64_tr_b16 v[162:163], v27 offset:51200
  v_mfma_f32_16x16x32_bf16 a[140:143], v[60:63], v[120:123], a[140:143]
  v_mfma_f32_16x16x32_bf16 a[144:147], v[60:63], v[124:127], a[144:147]
  ds_read_b128 v[100:103], v19 offset:12288
  v_mfma_f32_16x16x32_bf16 a[148:151], v[60:63], v[128:131], a[148:151]
  v_mfma_f32_16x16x32_bf16 a[152:155], v[60:63], v[132:135], a[152:155]
  ds_read_b64_tr_b16 v[164:165], v28 offset:49152
  v_mfma_f32_16x16x32_bf16 a[156:159], v[60:63], v[136:139], a[156:159]
  v_mfma_f32_16x16x32_bf16 a[160:163], v[64:67], v[108:111], a[160:163]
  ds_read_b64_tr_b16 v[166:167], v28 offset:51200
  v_mfma_f32_16x16x32_bf16 a[164:167], v[64:67], v[112:115], a[164:167]
  v_mfma_f32_16x16x32_bf16 a[168:171], v[64:67], v[116:119], a[168:171]
  ds_read_b128 v[104:107], v19 offset:14336
  v_mfma_f32_16x16x32_bf16 a[172:175], v[64:67], v[120:123], a[172:175]
  v_mfma_f32_16x16x32_bf16 a[176:179], v[64:67], v[124:127], a[176:179]
  ds_read_b64_tr_b16 v[168:169], v29 offset:49152
  v_mfma_f32_16x16x32_bf16 a[180:183], v[64:67], v[128:131], a[180:183]
  v_mfma_f32_16x16x32_bf16 a[184:187], v[64:67], v[132:135], a[184:187]
  ds_read_b64_tr_b16 v[170:171], v29 offset:51200
  v_mfma_f32_16x16x32_bf16 a[188:191], v[64:67], v[136:139], a[188:191]
  v_mfma_f32_16x16x32_bf16 a[192:195], v[68:71], v[108:111], a[192:195]
  v_mfma_f32_16x16x32_bf16 a[196:199], v[68:71], v[112:115], a[196:199]
  v_mfma_f32_16x16x32_bf16 a[200:203], v[68:71], v[116:119], a[200:203]
  v_mfma_f32_16x16x32_bf16 a[204:207], v[68:71], v[120:123], a[204:207]
  v_mfma_f32_16x16x32_bf16 a[208:211], v[68:71], v[124:127], a[208:211]
  v_mfma_f32_16x16x32_bf16 a[212:215], v[68:71], v[128:131], a[212:215]
  v_mfma_f32_16x16x32_bf16 a[216:219], v[68:71], v[132:135], a[216:219]
  v_mfma_f32_16x16x32_bf16 a[220:223], v[68:71], v[136:139], a[220:223]
  v_mfma_f32_16x16x32_bf16 a[224:227], v[72:75], v[108:111], a[224:227]
  v_mfma_f32_16x16x32_bf16 a[228:231], v[72:75], v[112:115], a[228:231]
  v_mfma_f32_16x16x32_bf16 a[232:235], v[72:75], v[116:119], a[232:235]
  v_mfma_f32_16x16x32_bf16 a[236:239], v[72:75], v[120:123], a[236:239]
  v_mfma_f32_16x16x32_bf16 a[240:243], v[72:75], v[124:127], a[240:243]
  v_mfma_f32_16x16x32_bf16 a[244:247], v[72:75], v[128:131], a[244:247]
  v_mfma_f32_16x16x32_bf16 a[248:251], v[72:75], v[132:135], a[248:251]
  v_mfma_f32_16x16x32_bf16 a[252:255], v[72:75], v[136:139], a[252:255]
  s_waitcnt lgkmcnt(0)
  v_mfma_f32_16x16x32_bf16 a[0:3], v[76:79], v[140:143], a[0:3]
  s_waitcnt vmcnt(0)
  s_barrier
  v_readfirstlane_b32 s91, v245
  s_and_b32 s35, s91, 255
  s_lshr_b32 s36, s91, 8
  s_and_b32 s36, s36, 255
  s_lshr_b32 s37, s91, 16
  s_mov_b32 s92, s24
  s_cmp_gt_u32 s35, 3
  s_cbranch_scc1 L_cd_50
  s_cmp_eq_u32 s35, 3
  s_cbranch_scc1 L_cd_48
  s_mov_b32 s8, s64
  s_and_b32 s9, s65, 0xffff
  s_mov_b32 s10, 0x400000
  s_mov_b32 s11, 0x20000
  s_cmp_eq_u32 s35, 0
  s_cselect_b64 s[88:89], s[68:69], s[70:71]
  s_cmp_eq_u32 s35, 2
  s_cselect_b64 s[88:89], s[72:73], s[88:89]
  s_mov_b32 s12, s88
  s_and_b32 s13, s89, 0xffff
  s_mov_b32 s14, 0x800000
  s_mov_b32 s15, 0x20000
  s_lshl_b32 s91, s33, 2
  s_add_u32 s91, s91, s37
  s_mov_b32 s24, 8192
  s_mov_b32 s26, 262144
  s_lshl_b32 s20, s36, 19
  s_lshl_b32 s21, s91, 9
  s_lshl_b32 s22, s35, 24
  s_lshl_b32 s90, s36, 21
  s_add_u32 s22, s22, s90
  s_lshl_b32 s90, s91, 14
  s_add_u32 s22, s22, s90
  s_lshl_b32 s38, s36, 9
  s_add_u32 s38, s38, 28672
  s_cmp_eq_u32 s35, 0
  s_cselect_b32 s38, 8192, s38
  s_cselect_b32 s98, 1, 2
  s_mov_b32 s48, s35
  s_branch L_cd_49
L_cd_50:
  s_mov_b64 vcc, 0
  s_mov_b32 s58, 0
  s_branch L_cd_51
L_cd_48:
  s_mov_b32 s8, s78
  s_and_b32 s9, s79, 0xffff
  s_mov_b32 s10, 0x400000
  s_mov_b32 s11, 0x20000
  s_mov_b32 s12, s80
  s_and_b32 s13, s81, 0xffff
  s_mov_b32 s14, 0x600000
  s_mov_b32 s15, 0x20000
  s_lshl_b32 s91, s37, 2
  s_add_u32 s91, s91, s33
  s_mov_b32 s24, 6144
  s_mov_b32 s26, 65536
  s_lshl_b32 s20, s36, 19
  s_lshl_b32 s21, s91, 9
  s_lshl_b32 s22, s37, 22
  s_lshl_b32 s90, s36, 19
  s_add_u32 s22, s22, s90
  s_lshl_b32 s90, s33, 14
  s_add_u32 s22, s22, s90
  s_add_u32 s22, s22, 0x4000000
  s_mov_b32 s38, 12288
  s_mov_b32 s48, s37
  s_mov_b32 s98, 1
L_cd_49:
  s_lshl_b32 s90, s36, 9
  s_add_u32 s38, s38, s90
  s_lshl_b32 s90, s33, 7
  s_add_u32 s38, s38, s90
  s_mov_b32 s23, 2048
  s_mov_b32 s25, 8
  s_mov_b64 vcc, -1
  s_sub_i32 s92, s24, s92
  s_lshl_b32 s51, s24, 6
  v_mul_i32_i24 v38, s92, v174
  s_mul_i32 s92, s92, 2
  s_mov_b32 s93, 0
  v_add3_u32 v10, v10, v38, s93
  s_add_u32 s93, s93, s92
  v_add3_u32 v11, v11, v38, s93
  s_add_u32 s93, s93, s92
  v_add3_u32 v12, v12, v38, s93
  s_add_u32 s93, s93, s92
  v_add3_u32 v13, v13, v38, s93
  s_add_u32 s93, s93, s92
  v_add3_u32 v14, v14, v38, s93
  s_add_u32 s93, s93, s92
  v_add3_u32 v15, v15, v38, s93
  s_add_u32 s93, s93, s92
  v_add3_u32 v16, v16, v38, s93
  s_add_u32 s93, s93, s92
  v_add3_u32 v17, v17, v38, s93
  s_add_u32 s93, s93, s92
L_cd_51:
  s_add_u32 m0, s52, 0
  v_mfma_f32_16x16x32_bf16 a[4:7], v[76:79], v[144:147], a[4:7]
  s_cbranch_vccz L_gd_52
  buffer_load_dwordx4 v2, s[8:11], s20 offen  lds
L_gd_52:
  ds_read_b128 v[44:47], v20 offset:0
  v_mfma_f32_16x16x32_bf16 a[8:11], v[76:79], v[148:151], a[8:11]
  v_mfma_f32_16x16x32_bf16 a[12:15], v[76:79], v[152:155], a[12:15]
  ds_read_b64_tr_b16 v[108:109], v30 offset:32768
  s_add_u32 m0, s53, 0
  v_mfma_f32_16x16x32_bf16 a[16:19], v[76:79], v[156:159], a[16:19]
  s_cbranch_vccz L_gd_53
  buffer_load_dwordx4 v10, s[12:15], s21 offen  lds
L_gd_53:
  v_mfma_f32_16x16x32_bf16 a[20:23], v[76:79], v[160:163], a[20:23]
  ds_read_b64_tr_b16 v[110:111], v30 offset:34816
  v_mfma_f32_16x16x32_bf16 a[24:27], v[76:79], v[164:167], a[24:27]
  v_mfma_f32_16x16x32_bf16 a[28:31], v[76:79], v[168:171], a[28:31]
  ds_read_b128 v[48:51], v20 offset:2048
  s_add_u32 m0, s52, 1024
  v_mfma_f32_16x16x32_bf16 a[32:35], v[80:83], v[140:143], a[32:35]
  s_cbranch_vccz L_gd_54
  buffer_load_dwordx4 v3, s[8:11], s20 offen  lds
L_gd_54:
  v_mfma_f32_16x16x32_bf16 a[36:39], v[80:83], v[144:147], a[36:39]
  ds_read_b64_tr_b16 v[112:113], v31 offset:32768
  v_mfma_f32_16x16x32_bf16 a[40:43], v[80:83], v[148:151], a[40:43]
  v_mfma_f32_16x16x32_bf16 a[44:47], v[80:83], v[152:155], a[44:47]
  ds_read_b64_tr_b16 v[114:115], v31 offset:34816
  s_add_u32 m0, s53, 1024
  v_mfma_f32_16x16x32_bf16 a[48:51], v[80:83], v[156:159], a[48:51]
  s_cbranch_vccz L_gd_55
  buffer_load_dwordx4 v11, s[12:15], s21 offen  lds
L_gd_55:
  v_mfma_f32_16x16x32_bf16 a[52:55], v[80:83], v[160:163], a[52:55]
  ds_read_b128 v[52:55], v20 offset:4096
  v_mfma_f32_16x16x32_bf16 a[56:59], v[80:83], v[164:167], a[56:59]
  v_mfma_f32_16x16x32_bf16 a[60:63], v[80:83], v[168:171], a[60:63]
  ds_read_b64_tr_b16 v[116:117], v32 offset:32768
  s_add_u32 m0, s52, 2048
  v_mfma_f32_16x16x32_bf16 a[64:67], v[84:87], v[140:143], a[64:67]
  s_cbranch_vccz L_gd_56
  buffer_load_dwordx4 v4, s[8:11], s20 offen  lds
L_gd_56:
  v_mfma_f32_16x16x32_bf16 a[68:71], v[84:87], v[144:147], a[68:71]
  ds_read_b64_tr_b16 v[118:119], v32 offset:34816
  v_mfma_f32_16x16x32_bf16 a[72:75], v[84:87], v[148:151], a[72:75]
  v_mfma_f32_16x16x32_bf16 a[76:79], v[84:87], v[152:155], a[76:79]
  ds_read_b128 v[56:59], v20 offset:6144
  s_add_u32 m0, s53, 2048
  v_mfma_f32_16x16x32_bf16 a[80:83], v[84:87], v[156:159], a[80:83]
  s_cbranch_vccz L_gd_57
  buffer_load_dwordx4 v12, s[12:15], s21 offen  lds
L_gd_57:
  v_mfma_f32_16x16x32_bf16 a[84:87], v[84:87], v[160:163], a[84:87]
  ds_read_b64_tr_b16 v[120:121], v33 offset:32768
  v_mfma_f32_16x16x32_bf16 a[88:91], v[84:87], v[164:167], a[88:91]
  v_mfma_f32_16x16x32_bf16 a[92:95], v[84:87], v[168:171], a[92:95]
  ds_read_b64_tr_b16 v[122:123], v33 offset:34816
  s_add_u32 m0, s52, 3072
  v_mfma_f32_16x16x32_bf16 a[96:99], v[88:91], v[140:143], a[96:99]
  s_cbranch_vccz L_gd_58
  buffer_load_dwordx4 v5, s[8:11], s20 offen  lds
L_gd_58:
  v_mfma_f32_16x16x32_bf16 a[100:103], v[88:91], v[144:147], a[100:103]
  ds_read_b128 v[60:63], v20 offset:8192
  v_mfma_f32_16x16x32_bf16 a[104:107], v[88:91], v[148:151], a[104:107]
  v_mfma_f32_16x16x32_bf16 a[108:111], v[88:91], v[152:155], a[108:111]
  ds_read_b64_tr_b16 v[124:125], v34 offset:32768
  s_add_u32 m0, s53, 3072
  v_mfma_f32_16x16x32_bf16 a[112:115], v[88:91], v[156:159], a[112:115]
  s_cbranch_vccz L_gd_59
  buffer_load_dwordx4 v13, s[12:15], s21 offen  lds
L_gd_59:
  v_mfma_f32_16x16x32_bf16 a[116:119], v[88:91], v[160:163], a[116:119]
  ds_read_b64_tr_b16 v[126:127], v34 offset:34816
  v_mfma_f32_16x16x32_bf16 a[120:123], v[88:91], v[164:167], a[120:123]
  v_mfma_f32_16x16x32_bf16 a[124:127], v[88:91], v[168:171], a[124:127]
  ds_read_b128 v[64:67], v20 offset:10240
  s_add_u32 m0, s52, 4096
  v_mfma_f32_16x16x32_bf16 a[128:131], v[92:95], v[140:143], a[128:131]
  s_cbranch_vccz L_gd_60
  buffer_load_dwordx4 v6, s[8:11], s20 offen  lds
L_gd_60:
  v_mfma_f32_16x16x32_bf16 a[132:135], v[92:95], v[144:147], a[132:135]
  ds_read_b64_tr_b16 v[128:129], v35 offset:32768
  v_mfma_f32_16x16x32_bf16 a[136:139], v[92:95], v[148:151], a[136:139]
  v_mfma_f32_16x16x32_bf16 a[140:143], v[92:95], v[152:155], a[140:143]
  ds_read_b64_tr_b16 v[130:131], v35 offset:34816
  s_add_u32 m0, s53, 4096
  v_mfma_f32_16x16x32_bf16 a[144:147], v[92:95], v[156:159], a[144:147]
  s_cbranch_vccz L_gd_61
  buffer_load_dwordx4 v14, s[12:15], s21 offen  lds
L_gd_61:
  v_mfma_f32_16x16x32_bf16 a[148:151], v[92:95], v[160:163], a[148:151]
  ds_read_b128 v[68:71], v20 offset:12288
  v_mfma_f32_16x16x32_bf16 a[152:155], v[92:95], v[164:167], a[152:155]
  v_mfma_f32_16x16x32_bf16 a[156:159], v[92:95], v[168:171], a[156:159]
  ds_read_b64_tr_b16 v[132:133], v36 offset:32768
  s_add_u32 m0, s52, 5120
  v_mfma_f32_16x16x32_bf16 a[160:163], v[96:99], v[140:143], a[160:163]
  s_cbranch_vccz L_gd_62
  buffer_load_dwordx4 v7, s[8:11], s20 offen  lds
L_gd_62:
  v_mfma_f32_16x16x32_bf16 a[164:167], v[96:99], v[144:147], a[164:167]
  ds_read_b64_tr_b16 v[134:135], v36 offset:34816
  v_mfma_f32_16x16x32_bf16 a[168:171], v[96:99], v[148:151], a[168:171]
  v_mfma_f32_16x16x32_bf16 a[172:175], v[96:99], v[152:155], a[172:175]
  ds_read_b128 v[72:75], v20 offset:14336
  s_add_u32 m0, s53, 5120
  v_mfma_f32_16x16x32_bf16 a[176:179], v[96:99], v[156:159], a[176:179]
  s_cbranch_vccz L_gd_63
  buffer_load_dwordx4 v15, s[12:15], s21 offen  lds
L_gd_63:
  v_mfma_f32_16x16x32_bf16 a[180:183], v[96:99], v[160:163], a[180:183]
  ds_read_b64_tr_b16 v[136:137], v37 offset:32768
  v_mfma_f32_16x16x32_bf16 a[184:187], v[96:99], v[164:167], a[184:187]
  v_mfma_f32_16x16x32_bf16 a[188:191], v[96:99], v[168:171], a[188:191]
  ds_read_b64_tr_b16 v[138:139], v37 offset:34816
  s_add_u32 m0, s52, 6144
  v_mfma_f32_16x16x32_bf16 a[192:195], v[100:103], v[140:143], a[192:195]
  s_cbranch_vccz L_gd_64
  buffer_load_dwordx4 v8, s[8:11], s20 offen  lds
L_gd_64:
  v_mfma_f32_16x16x32_bf16 a[196:199], v[100:103], v[144:147], a[196:199]
  v_mfma_f32_16x16x32_bf16 a[200:203], v[100:103], v[148:151], a[200:203]
  v_mfma_f32_16x16x32_bf16 a[204:207], v[100:103], v[152:155], a[204:207]
  s_add_u32 m0, s53, 6144
  v_mfma_f32_16x16x32_bf16 a[208:211], v[100:103], v[156:159], a[208:211]
  s_cbranch_vccz L_gd_65
  buffer_load_dwordx4 v16, s[12:15], s21 offen  lds
L_gd_65:
  v_mfma_f32_16x16x32_bf16 a[212:215], v[100:103], v[160:163], a[212:215]
  v_mfma_f32_16x16x32_bf16 a[216:219], v[100:103], v[164:167], a[216:219]
  v_mfma_f32_16x16x32_bf16 a[220:223], v[100:103], v[168:171], a[220:223]
  s_add_u32 m0, s52, 7168
  v_mfma_f32_16x16x32_bf16 a[224:227], v[104:107], v[140:143], a[224:227]
  s_cbranch_vccz L_gd_66
  buffer_load_dwordx4 v9, s[8:11], s20 offen  lds
L_gd_66:
  v_mfma_f32_16x16x32_bf16 a[228:231], v[104:107], v[144:147], a[228:231]
  v_mfma_f32_16x16x32_bf16 a[232:235], v[104:107], v[148:151], a[232:235]
  v_mfma_f32_16x16x32_bf16 a[236:239], v[104:107], v[152:155], a[236:239]
  s_add_u32 m0, s53, 7168
  v_mfma_f32_16x16x32_bf16 a[240:243], v[104:107], v[156:159], a[240:243]
  s_cbranch_vccz L_gd_67
  buffer_load_dwordx4 v17, s[12:15], s21 offen  lds
  s_add_u32 s20, s20, 128
  s_add_u32 s21, s21, s51
L_gd_67:
  v_mfma_f32_16x16x32_bf16 a[244:247], v[104:107], v[160:163], a[244:247]
  v_mfma_f32_16x16x32_bf16 a[248:251], v[104:107], v[164:167], a[248:251]
  v_mfma_f32_16x16x32_bf16 a[252:255], v[104:107], v[168:171], a[252:255]
  s_waitcnt lgkmcnt(0)
  v_mfma_f32_16x16x32_bf16 a[0:3], v[44:47], v[108:111], a[0:3]
  ds_read_b128 v[76:79], v21 offset:0
  v_mfma_f32_16x16x32_bf16 a[4:7], v[44:47], v[112:115], a[4:7]
  v_mfma_f32_16x16x32_bf16 a[8:11], v[44:47], v[116:119], a[8:11]
  ds_read_b64_tr_b16 v[140:141], v30 offset:49152
  v_mfma_f32_16x16x32_bf16 a[12:15], v[44:47], v[120:123], a[12:15]
  v_mfma_f32_16x16x32_bf16 a[16:19], v[44:47], v[124:127], a[16:19]
  ds_read_b64_tr_b16 v[142:143], v30 offset:51200
  v_mfma_f32_16x16x32_bf16 a[20:23], v[44:47], v[128:131], a[20:23]
  v_mfma_f32_16x16x32_bf16 a[24:27], v[44:47], v[132:135], a[24:27]
  ds_read_b128 v[80:83], v21 offset:2048
  v_mfma_f32_16x16x32_bf16 a[28:31], v[44:47], v[136:139], a[28:31]
  v_mfma_f32_16x16x32_bf16 a[32:35], v[48:51], v[108:111], a[32:35]
  ds_read_b64_tr_b16 v[144:145], v31 offset:49152
  v_mfma_f32_16x16x32_bf16 a[36:39], v[48:51], v[112:115], a[36:39]
  v_mfma_f32_16x16x32_bf16 a[40:43], v[48:51], v[116:119], a[40:43]
  ds_read_b64_tr_b16 v[146:147], v31 offset:51200
  v_mfma_f32_16x16x32_bf16 a[44:47], v[48:51], v[120:123], a[44:47]
  v_mfma_f32_16x16x32_bf16 a[48:51], v[48:51], v[124:127], a[48:51]
  ds_read_b128 v[84:87], v21 offset:4096
  v_mfma_f32_16x16x32_bf16 a[52:55], v[48:51], v[128:131], a[52:55]
  v_mfma_f32_16x16x32_bf16 a[56:59], v[48:51], v[132:135], a[56:59]
  ds_read_b64_tr_b16 v[148:149], v32 offset:49152
  v_mfma_f32_16x16x32_bf16 a[60:63], v[48:51], v[136:139], a[60:63]
  v_mfma_f32_16x16x32_bf16 a[64:67], v[52:55], v[108:111], a[64:67]
  ds_read_b64_tr_b16 v[150:151], v32 offset:51200
  v_mfma_f32_16x16x32_bf16 a[68:71], v[52:55], v[112:115], a[68:71]
  v_mfma_f32_16x16x32_bf16 a[72:75], v[52:55], v[116:119], a[72:75]
  ds_read_b128 v[88:91], v21 offset:6144
  v_mfma_f32_16x16x32_bf16 a[76:79], v[52:55], v[120:123], a[76:79]
  v_mfma_f32_16x16x32_bf16 a[80:83], v[52:55], v[124:127], a[80:83]
  ds_read_b64_tr_b16 v[152:153], v33 offset:49152
  v_mfma_f32_16x16x32_bf16 a[84:87], v[52:55], v[128:131], a[84:87]
  v_mfma_f32_16x16x32_bf16 a[88:91], v[52:55], v[132:135], a[88:91]
  ds_read_b64_tr_b16 v[154:155], v33 offset:51200
  v_mfma_f32_16x16x32_bf16 a[92:95], v[52:55], v[136:139], a[92:95]
  v_mfma_f32_16x16x32_bf16 a[96:99], v[56:59], v[108:111], a[96:99]
  ds_read_b128 v[92:95], v21 offset:8192
  v_mfma_f32_16x16x32_bf16 a[100:103], v[56:59], v[112:115], a[100:103]
  v_mfma_f32_16x16x32_bf16 a[104:107], v[56:59], v[116:119], a[104:107]
  ds_read_b64_tr_b16 v[156:157], v34 offset:49152
  v_mfma_f32_16x16x32_bf16 a[108:111], v[56:59], v[120:123], a[108:111]
  v_mfma_f32_16x16x32_bf16 a[112:115], v[56:59], v[124:127], a[112:115]
  ds_read_b64_tr_b16 v[158:159], v34 offset:51200
  v_mfma_f32_16x16x32_bf16 a[116:119], v[56:59], v[128:131], a[116:119]
  v_mfma_f32_16x16x32_bf16 a[120:123], v[56:59], v[132:135], a[120:123]
  ds_read_b128 v[96:99], v21 offset:10240
  v_mfma_f32_16x16x32_bf16 a[124:127], v[56:59], v[136:139], a[124:127]
  v_mfma_f32_16x16x32_bf16 a[128:131], v[60:63], v[108:111], a[128:131]
  ds_read_b64_tr_b16 v[160:161], v35 offset:49152
  v_mfma_f32_16x16x32_bf16 a[132:135], v[60:63], v[112:115], a[132:135]
  v_mfma_f32_16x16x32_bf16 a[136:139], v[60:63], v[116:119], a[136:139]
  ds_read_b64_tr_b16 v[162:163], v35 offset:51200
  v_mfma_f32_16x16x32_bf16 a[140:143], v[60:63], v[120:123], a[140:143]
  v_mfma_f32_16x16x32_bf16 a[144:147], v[60:63], v[124:127], a[144:147]
  ds_read_b128 v[100:103], v21 offset:12288
  v_mfma_f32_16x16x32_bf16 a[148:151], v[60:63], v[128:131], a[148:151]
  v_mfma_f32_16x16x32_bf16 a[152:155], v[60:63], v[132:135], a[152:155]
  ds_read_b64_tr_b16 v[164:165], v36 offset:49152
  v_mfma_f32_16x16x32_bf16 a[156:159], v[60:63], v[136:139], a[156:159]
  v_mfma_f32_16x16x32_bf16 a[160:163], v[64:67], v[108:111], a[160:163]
  ds_read_b64_tr_b16 v[166:167], v36 offset:51200
  v_mfma_f32_16x16x32_bf16 a[164:167], v[64:67], v[112:115], a[164:167]
  v_mfma_f32_16x16x32_bf16 a[168:171], v[64:67], v[116:119], a[168:171]
  ds_read_b128 v[104:107], v21 offset:14336
  v_mfma_f32_16x16x32_bf16 a[172:175], v[64:67], v[120:123], a[172:175]
  v_mfma_f32_16x16x32_bf16 a[176:179], v[64:67], v[124:127], a[176:179]
  ds_read_b64_tr_b16 v[168:169], v37 offset:49152
  v_mfma_f32_16x16x32_bf16 a[180:183], v[64:67], v[128:131], a[180:183]
  v_mfma_f32_16x16x32_bf16 a[184:187], v[64:67], v[132:135], a[184:187]
  ds_read_b64_tr_b16 v[170:171], v37 offset:51200
  v_mfma_f32_16x16x32_bf16 a[188:191], v[64:67], v[136:139], a[188:191]
  v_mfma_f32_16x16x32_bf16 a[192:195], v[68:71], v[108:111], a[192:195]
  v_mfma_f32_16x16x32_bf16 a[196:199], v[68:71], v[112:115], a[196:199]
  v_mfma_f32_16x16x32_bf16 a[200:203], v[68:71], v[116:119], a[200:203]
  v_mfma_f32_16x16x32_bf16 a[204:207], v[68:71], v[120:123], a[204:207]
  v_mfma_f32_16x16x32_bf16 a[208:211], v[68:71], v[124:127], a[208:211]
  v_mfma_f32_16x16x32_bf16 a[212:215], v[68:71], v[128:131], a[212:215]
  v_mfma_f32_16x16x32_bf16 a[216:219], v[68:71], v[132:135], a[216:219]
  v_mfma_f32_16x16x32_bf16 a[220:223], v[68:71], v[136:139], a[220:223]
  v_mfma_f32_16x16x32_bf16 a[224:227], v[72:75], v[108:111], a[224:227]
  v_mfma_f32_16x16x32_bf16 a[228:231], v[72:75], v[112:115], a[228:231]
  v_mfma_f32_16x16x32_bf16 a[232:235], v[72:75], v[116:119], a[232:235]
  v_mfma_f32_16x16x32_bf16 a[236:239], v[72:75], v[120:123], a[236:239]
  v_mfma_f32_16x16x32_bf16 a[240:243], v[72:75], v[124:127], a[240:243]
  v_mfma_f32_16x16x32_bf16 a[244:247], v[72:75], v[128:131], a[244:247]
  v_mfma_f32_16x16x32_bf16 a[248:251], v[72:75], v[132:135], a[248:251]
  v_mfma_f32_16x16x32_bf16 a[252:255], v[72:75], v[136:139], a[252:255]
  s_waitcnt lgkmcnt(0)
  v_mfma_f32_16x16x32_bf16 a[0:3], v[76:79], v[140:143], a[0:3]
  s_barrier
  s_add_u32 m0, s52, 65536
  v_mfma_f32_16x16x32_bf16 a[4:7], v[76:79], v[144:147], a[4:7]
  s_cbranch_vccz L_gd_68
  buffer_load_dwordx4 v2, s[8:11], s20 offen  lds
L_gd_68:
  v_mfma_f32_16x16x32_bf16 a[8:11], v[76:79], v[148:151], a[8:11]
  v_mfma_f32_16x16x32_bf16 a[12:15], v[76:79], v[152:155], a[12:15]
  s_add_u32 m0, s53, 65536
  v_mfma_f32_16x16x32_bf16 a[16:19], v[76:79], v[156:159], a[16:19]
  s_cbranch_vccz L_gd_69
  buffer_load_dwordx4 v10, s[12:15], s21 offen  lds
L_gd_69:
  v_mfma_f32_16x16x32_bf16 a[20:23], v[76:79], v[160:163], a[20:23]
  v_mfma_f32_16x16x32_bf16 a[24:27], v[76:79], v[164:167], a[24:27]
  v_mfma_f32_16x16x32_bf16 a[28:31], v[76:79], v[168:171], a[28:31]
  s_add_u32 m0, s52, 66560
  v_mfma_f32_16x16x32_bf16 a[32:35], v[80:83], v[140:143], a[32:35]
  s_cbranch_vccz L_gd_70
  buffer_load_dwordx4 v3, s[8:11], s20 offen  lds
L_gd_70:
  v_mfma_f32_16x16x32_bf16 a[36:39], v[80:83], v[144:147], a[36:39]
  v_mfma_f32_16x16x32_bf16 a[40:43], v[80:83], v[148:151], a[40:43]
  v_mfma_f32_16x16x32_bf16 a[44:47], v[80:83], v[152:155], a[44:47]
  s_add_u32 m0, s53, 66560
  v_mfma_f32_16x16x32_bf16 a[48:51], v[80:83], v[156:159], a[48:51]
  s_cbranch_vccz L_gd_71
  buffer_load_dwordx4 v11, s[12:15], s21 offen  lds
L_gd_71:
  v_mfma_f32_16x16x32_bf16 a[52:55], v[80:83], v[160:163], a[52:55]
  v_mfma_f32_16x16x32_bf16 a[56:59], v[80:83], v[164:167], a[56:59]
  v_mfma_f32_16x16x32_bf16 a[60:63], v[80:83], v[168:171], a[60:63]
  s_add_u32 m0, s52, 67584
  v_mfma_f32_16x16x32_bf16 a[64:67], v[84:87], v[140:143], a[64:67]
  s_cbranch_vccz L_gd_72
  buffer_load_dwordx4 v4, s[8:11], s20 offen  lds
L_gd_72:
  v_mfma_f32_16x16x32_bf16 a[68:71], v[84:87], v[144:147], a[68:71]
  v_mfma_f32_16x16x32_bf16 a[72:75], v[84:87], v[148:151], a[72:75]
  v_mfma_f32_16x16x32_bf16 a[76:79], v[84:87], v[152:155], a[76:79]
  s_add_u32 m0, s53, 67584
  v_mfma_f32_16x16x32_bf16 a[80:83], v[84:87], v[156:159], a[80:83]
  s_cbranch_vccz L_gd_73
  buffer_load_dwordx4 v12, s[12:15], s21 offen  lds
L_gd_73:
  v_mfma_f32_16x16x32_bf16 a[84:87], v[84:87], v[160:163], a[84:87]
  v_mfma_f32_16x16x32_bf16 a[88:91], v[84:87], v[164:167], a[88:91]
  v_mfma_f32_16x16x32_bf16 a[92:95], v[84:87], v[168:171], a[92:95]
  s_add_u32 m0, s52, 68608
  v_mfma_f32_16x16x32_bf16 a[96:99], v[88:91], v[140:143], a[96:99]
  s_cbranch_vccz L_gd_74
  buffer_load_dwordx4 v5, s[8:11], s20 offen  lds
L_gd_74:
  v_mfma_f32_16x16x32_bf16 a[100:103], v[88:91], v[144:147], a[100:103]
  v_mfma_f32_16x16x32_bf16 a[104:107], v[88:91], v[148:151], a[104:107]
  v_mfma_f32_16x16x32_bf16 a[108:111], v[88:91], v[152:155], a[108:111]
  s_add_u32 m0, s53, 68608
  v_mfma_f32_16x16x32_bf16 a[112:115], v[88:91], v[156:159], a[112:115]
  s_cbranch_vccz L_gd_75
  buffer_load_dwordx4 v13, s[12:15], s21 offen  lds
L_gd_75:
  v_mfma_f32_16x16x32_bf16 a[116:119], v[88:91], v[160:163], a[116:119]
  v_mfma_f32_16x16x32_bf16 a[120:123], v[88:91], v[164:167], a[120:123]
  v_mfma_f32_16x16x32_bf16 a[124:127], v[88:91], v[168:171], a[124:127]
  s_add_u32 m0, s52, 69632
  v_mfma_f32_16x16x32_bf16 a[128:131], v[92:95], v[140:143], a[128:131]
  s_cbranch_vccz L_gd_76
  buffer_load_dwordx4 v6, s[8:11], s20 offen  lds
L_gd_76:
  v_mfma_f32_16x16x32_bf16 a[132:135], v[92:95], v[144:147], a[132:135]
  v_mfma_f32_16x16x32_bf16 a[136:139], v[92:95], v[148:151], a[136:139]
  v_mfma_f32_16x16x32_bf16 a[140:143], v[92:95], v[152:155], a[140:143]
  s_add_u32 m0, s53, 69632
  v_mfma_f32_16x16x32_bf16 a[144:147], v[92:95], v[156:159], a[144:147]
  s_cbranch_vccz L_gd_77
  buffer_load_dwordx4 v14, s[12:15], s21 offen  lds
L_gd_77:
  v_mfma_f32_16x16x32_bf16 a[148:151], v[92:95], v[160:163], a[148:151]
  v_mfma_f32_16x16x32_bf16 a[152:155], v[92:95], v[164:167], a[152:155]
  v_mfma_f32_16x16x32_bf16 a[156:159], v[92:95], v[168:171], a[156:159]
  s_add_u32 m0, s52, 70656
  v_mfma_f32_16x16x32_bf16 a[160:163], v[96:99], v[140:143], a[160:163]
  s_cbranch_vccz L_gd_78
  buffer_load_dwordx4 v7, s[8:11], s20 offen  lds
L_gd_78:
  v_mfma_f32_16x16x32_bf16 a[164:167], v[96:99], v[144:147], a[164:167]
  v_mfma_f32_16x16x32_bf16 a[168:171], v[96:99], v[148:151], a[168:171]
  v_mfma_f32_16x16x32_bf16 a[172:175], v[96:99], v[152:155], a[172:175]
  s_add_u32 m0, s53, 70656
  v_mfma_f32_16x16x32_bf16 a[176:179], v[96:99], v[156:159], a[176:179]
  s_cbranch_vccz L_gd_79
  buffer_load_dwordx4 v15, s[12:15], s21 offen  lds
L_gd_79:
  v_mfma_f32_16x16x32_bf16 a[180:183], v[96:99], v[160:163], a[180:183]
  v_mfma_f32_16x16x32_bf16 a[184:187], v[96:99], v[164:167], a[184:187]
  v_mfma_f32_16x16x32_bf16 a[188:191], v[96:99], v[168:171], a[188:191]
  s_add_u32 m0, s52, 71680
  v_mfma_f32_16x16x32_bf16 a[192:195], v[100:103], v[140:143], a[192:195]
  s_cbranch_vccz L_gd_80
  buffer_load_dwordx4 v8, s[8:11], s20 offen  lds
L_gd_80:
  v_mfma_f32_16x16x32_bf16 a[196:199], v[100:103], v[144:147], a[196:199]
  v_mfma_f32_16x16x32_bf16 a[200:203], v[100:103], v[148:151], a[200:203]
  v_mfma_f32_16x16x32_bf16 a[204:207], v[100:103], v[152:155], a[204:207]
  s_add_u32 m0, s53, 71680
  v_mfma_f32_16x16x32_bf16 a[208:211], v[100:103], v[156:159], a[208:211]
  s_cbranch_vccz L_gd_81
  buffer_load_dwordx4 v16, s[12:15], s21 offen  lds
L_gd_81:
  v_mfma_f32_16x16x32_bf16 a[212:215], v[100:103], v[160:163], a[212:215]
  v_mfma_f32_16x16x32_bf16 a[216:219], v[100:103], v[164:167], a[216:219]
  v_mfma_f32_16x16x32_bf16 a[220:223], v[100:103], v[168:171], a[220:223]
  s_add_u32 m0, s52, 72704
  v_mfma_f32_16x16x32_bf16 a[224:227], v[104:107], v[140:143], a[224:227]
  s_cbranch_vccz L_gd_82
  buffer_load_dwordx4 v9, s[8:11], s20 offen  lds
L_gd_82:
  v_mfma_f32_16x16x32_bf16 a[228:231], v[104:107], v[144:147], a[228:231]
  v_mfma_f32_16x16x32_bf16 a[232:235], v[104:107], v[148:151], a[232:235]
  v_mfma_f32_16x16x32_bf16 a[236:239], v[104:107], v[152:155], a[236:239]
  s_add_u32 m0, s53, 72704
  v_mfma_f32_16x16x32_bf16 a[240:243], v[104:107], v[156:159], a[240:243]
  s_cbranch_vccz L_gd_83
  buffer_load_dwordx4 v17, s[12:15], s21 offen  lds
  s_add_u32 s20, s20, 128
  s_add_u32 s21, s21, s51
L_gd_83:
  v_mfma_f32_16x16x32_bf16 a[244:247], v[104:107], v[160:163], a[244:247]
  v_mfma_f32_16x16x32_bf16 a[248:251], v[104:107], v[164:167], a[248:251]
  v_mfma_f32_16x16x32_bf16 a[252:255], v[104:107], v[168:171], a[252:255]
  s_cmp_eq_u32 s58, 1
  s_cbranch_scc1 L_epi
  s_branch L_have1
L_g2_cw:
  s_mov_b64 exec, 1
  ds_write_b32 v175, v244
  s_mov_b64 exec, -1
  s_branch L_g2_cwb
L_g2_cr:
  ds_read_b32 v246, v241
  s_cmp_eq_u32 s25, 1
  s_cbranch_scc1 L_g2_crb
  s_cmp_lg_u32 s32, 0
  s_cbranch_scc1 L_rq_84
  s_cmp_eq_u32 s39, 0
  s_cbranch_scc1 L_rq_84
  s_lshl_b32 s99, s33, 7
  s_add_u32 s99, s99, 0x3d00200
  v_mov_b32 v244, 1
  v_mov_b32 v245, 0
  s_mov_b64 exec, 1
  buffer_atomic_add v244, v245, s[4:7], s99 offen sc0 sc1
  s_mov_b64 exec, -1
L_rq_84:
  s_branch L_g2_crb
L_small:
  s_mov_b32 s8, s64
  s_and_b32 s9, s65, 0xffff
  s_mov_b32 s10, 0x400000
  s_mov_b32 s11, 0x20000
  s_cmp_eq_u32 s35, 9
  s_cselect_b64 s[88:89], s[70:71], s[72:73]
  s_mov_b32 s12, s88
  s_and_b32 s13, s89, 0xffff
  s_mov_b32 s14, 0x800000
  s_mov_b32 s15, 0x20000
  s_lshl_b32 s91, s33, 3
  s_add_u32 s91, s91, s37
  s_mov_b32 s24, 8192
  s_mov_b32 s26, 262144
  s_mov_b32 s23, 2048
  s_mov_b32 s25, 4
  s_lshl_b32 s20, s36, 18
  s_lshl_b32 s21, s91, 8
  s_sub_u32 s22, s35, 8
  s_lshl_b32 s22, s22, 24
  s_lshl_b32 s90, s36, 20
  s_add_u32 s22, s22, s90
  s_lshl_b32 s90, s91, 13
  s_add_u32 s22, s22, s90
  s_lshl_b32 s38, s36, 9
  s_add_u32 s38, s38, 28672
  s_lshl_b32 s90, s33, 7
  s_add_u32 s38, s38, s90
  v_and_b32 v1, 63, v0
  v_lshrrev_b32 v22, 6, v0
  s_nop 0
  v_readfirstlane_b32 s27, v22
  s_mul_i32 s90, s27, 32
  v_lshrrev_b32 v22, 3, v1
  v_add_u32 v22, s90, v22
  v_mul_lo_u32 v22, v22, s23
  v_lshrrev_b32 v23, 4, v1
  v_xor_b32 v23, v23, v1
  v_and_b32 v23, 7, v23
  v_lshl_add_u32 v2, v23, 4, v22
  s_mul_i32 s91, s23, 8
  v_add_u32 v3, s91, v2
  v_xor_b32 v3, 64, v3
  v_add_u32 v4, s91, v3
  v_xor_b32 v4, 64, v4
  v_add_u32 v5, s91, v4
  v_xor_b32 v5, 64, v5
  s_mul_i32 s90, s27, 16
  v_lshrrev_b32 v22, 4, v1
  v_add_u32 v22, 0, v22
  v_add_u32 v22, s90, v22
  v_and_b32 v23, 3, v22
  v_lshlrev_b32 v23, 1, v23
  v_and_b32 v24, 8, v22
  v_or_b32 v23, v23, v24
  v_xor_b32 v23, v23, v1
  v_and_b32 v23, 15, v23
  v_mul_lo_u32 v22, v22, s24
  v_lshl_add_u32 v6, v23, 4, v22
  v_lshrrev_b32 v22, 4, v1
  v_add_u32 v22, 4, v22
  v_add_u32 v22, s90, v22
  v_and_b32 v23, 3, v22
  v_lshlrev_b32 v23, 1, v23
  v_and_b32 v24, 8, v22
  v_or_b32 v23, v23, v24
  v_xor_b32 v23, v23, v1
  v_and_b32 v23, 15, v23
  v_mul_lo_u32 v22, v22, s24
  v_lshl_add_u32 v7, v23, 4, v22
  v_lshrrev_b32 v22, 4, v1
  v_add_u32 v22, 8, v22
  v_add_u32 v22, s90, v22
  v_and_b32 v23, 3, v22
  v_lshlrev_b32 v23, 1, v23
  v_and_b32 v24, 8, v22
  v_or_b32 v23, v23, v24
  v_xor_b32 v23, v23, v1
  v_and_b32 v23, 15, v23
  v_mul_lo_u32 v22, v22, s24
  v_lshl_add_u32 v8, v23, 4, v22
  v_lshrrev_b32 v22, 4, v1
  v_add_u32 v22, 12, v22
  v_add_u32 v22, s90, v22
  v_and_b32 v23, 3, v22
  v_lshlrev_b32 v23, 1, v23
  v_and_b32 v24, 8, v22
  v_or_b32 v23, v23, v24
  v_xor_b32 v23, v23, v1
  v_and_b32 v23, 15, v23
  v_mul_lo_u32 v22, v22, s24
  v_lshl_add_u32 v9, v23, 4, v22
  s_mul_i32 s51, s24, 64
  s_mul_i32 s52, s27, 4096
  s_mul_i32 s53, s27, 4096
  s_add_u32 s53, s53, 16384
  s_add_u32 m0, s52, 0
  s_nop 0
  buffer_load_dwordx4 v2, s[8:11], s20 offen  lds
  s_add_u32 m0, s53, 0
  s_nop 0
  buffer_load_dwordx4 v6, s[12:15], s21 offen  lds
  s_add_u32 m0, s52, 1024
  s_nop 0
  buffer_load_dwordx4 v3, s[8:11], s20 offen  lds
  s_add_u32 m0, s53, 1024
  s_nop 0
  buffer_load_dwordx4 v7, s[12:15], s21 offen  lds
  s_add_u32 m0, s52, 2048
  s_nop 0
  buffer_load_dwordx4 v4, s[8:11], s20 offen  lds
  s_add_u32 m0, s53, 2048
  s_nop 0
  buffer_load_dwordx4 v8, s[12:15], s21 offen  lds
  s_add_u32 m0, s52, 3072
  s_nop 0
  buffer_load_dwordx4 v5, s[8:11], s20 offen  lds
  s_add_u32 m0, s53, 3072
  s_nop 0
  buffer_load_dwordx4 v9, s[12:15], s21 offen  lds
  s_add_u32 s20, s20, 128
  s_add_u32 s21, s21, s51
  s_add_u32 m0, s52, 32768
  s_nop 0
  buffer_load_dwordx4 v2, s[8:11], s20 offen  lds
  s_add_u32 m0, s53, 32768
  s_nop 0
  buffer_load_dwordx4 v6, s[12:15], s21 offen  lds
  s_add_u32 m0, s52, 33792
  s_nop 0
  buffer_load_dwordx4 v3, s[8:11], s20 offen  lds
  s_add_u32 m0, s53, 33792
  s_nop 0
  buffer_load_dwordx4 v7, s[12:15], s21 offen  lds
  s_add_u32 m0, s52, 34816
  s_nop 0
  buffer_load_dwordx4 v4, s[8:11], s20 offen  lds
  s_add_u32 m0, s53, 34816
  s_nop 0
  buffer_load_dwordx4 v8, s[12:15], s21 offen  lds
  s_add_u32 m0, s52, 35840
  s_nop 0
  buffer_load_dwordx4 v5, s[8:11], s20 offen  lds
  s_add_u32 m0, s53, 35840
  s_nop 0
  buffer_load_dwordx4 v9, s[12:15], s21 offen  lds
  s_add_u32 s20, s20, 128
  s_add_u32 s21, s21, s51
  s_add_u32 m0, s52, 65536
  s_nop 0
  buffer_load_dwordx4 v2, s[8:11], s20 offen  lds
  s_add_u32 m0, s53, 65536
  s_nop 0
  buffer_load_dwordx4 v6, s[12:15], s21 offen  lds
  s_add_u32 m0, s52, 66560
  s_nop 0
  buffer_load_dwordx4 v3, s[8:11], s20 offen  lds
  s_add_u32 m0, s53, 66560
  s_nop 0
  buffer_load_dwordx4 v7, s[12:15], s21 offen  lds
  s_add_u32 m0, s52, 67584
  s_nop 0
  buffer_load_dwordx4 v4, s[8:11], s20 offen  lds
  s_add_u32 m0, s53, 67584
  s_nop 0
  buffer_load_dwordx4 v8, s[12:15], s21 offen  lds
  s_add_u32 m0, s52, 68608
  s_nop 0
  buffer_load_dwordx4 v5, s[8:11], s20 offen  lds
  s_add_u32 m0, s53, 68608
  s_nop 0
  buffer_load_dwordx4 v9, s[12:15], s21 offen  lds
  s_add_u32 s20, s20, 128
  s_add_u32 s21, s21, s51
  s_add_u32 m0, s52, 98304
  s_nop 0
  buffer_load_dwordx4 v2, s[8:11], s20 offen  lds
  s_add_u32 m0, s53, 98304
  s_nop 0
  buffer_load_dwordx4 v6, s[12:15], s21 offen  lds
  s_add_u32 m0, s52, 99328
  s_nop 0
  buffer_load_dwordx4 v3, s[8:11], s20 offen  lds
  s_add_u32 m0, s53, 99328
  s_nop 0
  buffer_load_dwordx4 v7, s[12:15], s21 offen  lds
  s_add_u32 m0, s52, 100352
  s_nop 0
  buffer_load_dwordx4 v4, s[8:11], s20 offen  lds
  s_add_u32 m0, s53, 100352
  s_nop 0
  buffer_load_dwordx4 v8, s[12:15], s21 offen  lds
  s_add_u32 m0, s52, 101376
  s_nop 0
  buffer_load_dwordx4 v5, s[8:11], s20 offen  lds
  s_add_u32 m0, s53, 101376
  s_nop 0
  buffer_load_dwordx4 v9, s[12:15], s21 offen  lds
  s_add_u32 s20, s20, 128
  s_add_u32 s21, s21, s51
  s_lshr_b32 s90, s27, 1
  s_and_b32 s91, s27, 1
  s_mul_i32 s92, s90, 8192
  v_mov_b32 v22, 0x0
  v_bfe_u32 v23, v1, 0, 4
  v_lshl_add_u32 v22, v23, 7, v22
  v_add_u32 v22, s92, v22
  v_lshrrev_b32 v23, 1, v1
  v_and_b32 v23, 7, v23
  v_lshrrev_b32 v24, 4, v1
  v_xor_b32 v23, v23, v24
  v_lshl_add_u32 v10, v23, 4, v22
  v_xor_b32 v11, 64, v10
  v_add_u32 v12, 65536, v10
  v_add_u32 v13, 65536, v11
  v_mov_b32 v22, 0x0
  v_bfe_u32 v23, v1, 2, 2
  v_lshl_add_u32 v22, v23, 8, v22
  v_bfe_u32 v23, v1, 4, 2
  v_lshl_add_u32 v22, v23, 11, v22
  v_bfe_u32 v23, v1, 0, 2
  v_lshl_add_u32 v22, v23, 3, v22
  v_bfe_u32 v24, v1, 2, 3
  s_mul_i32 s92, s91, 4
  s_add_u32 s93, s92, 0
  v_xor_b32 v23, s93, v24
  v_lshl_add_u32 v14, v23, 5, v22
  v_add_u32 v18, 65536, v14
  s_add_u32 s93, s92, 1
  v_xor_b32 v23, s93, v24
  v_lshl_add_u32 v15, v23, 5, v22
  v_add_u32 v19, 65536, v15
  s_add_u32 s93, s92, 2
  v_xor_b32 v23, s93, v24
  v_lshl_add_u32 v16, v23, 5, v22
  v_add_u32 v20, 65536, v16
  s_add_u32 s93, s92, 3
  v_xor_b32 v23, s93, v24
  v_lshl_add_u32 v17, v23, 5, v22
  v_add_u32 v21, 65536, v17
  s_mov_b32 s58, 2
  s_branch L_epi
L_r2:
  v_lshlrev_b32 v174, 7, v1
  s_sub_u32 s42, s34, 32
  s_lshl_b32 s40, s42, 2
  s_add_u32 s40, s40, s33
  s_lshl_b32 s40, s40, 2
  s_add_u32 s40, s40, s32
  s_lshl_b32 s40, s40, 13
  s_cmp_ge_u32 s42, 16
  s_cselect_b32 s40, 0x40000000, s40
  s_add_u32 s41, s40, 2097152
  s_mov_b32 s44, s64
  s_and_b32 s45, s65, 0xffff
  s_mov_b32 s46, 0x400000
  s_mov_b32 s47, 0x20000
  buffer_load_dword v175, v174, s[44:47], s40 offen
  s_mov_b32 s44, s64
  s_and_b32 s45, s65, 0xffff
  s_mov_b32 s46, 0x400000
  s_mov_b32 s47, 0x20000
  buffer_load_dword v175, v174, s[44:47], s41 offen
  s_cmp_eq_u32 s35, 10
  s_cbranch_scc1 L_g5
  s_waitcnt vmcnt(26)
  s_barrier
  ds_read_b128 v[28:31], v10 offset:0
  ds_read_b64_tr_b16 v[60:61], v14 offset:16384
  ds_read_b64_tr_b16 v[62:63], v14 offset:17408
  ds_read_b128 v[32:35], v10 offset:2048
  ds_read_b64_tr_b16 v[64:65], v15 offset:16384
  ds_read_b64_tr_b16 v[66:67], v15 offset:17408
  ds_read_b128 v[36:39], v10 offset:4096
  ds_read_b64_tr_b16 v[68:69], v16 offset:16384
  ds_read_b64_tr_b16 v[70:71], v16 offset:17408
  ds_read_b128 v[40:43], v10 offset:6144
  ds_read_b64_tr_b16 v[72:73], v17 offset:16384
  ds_read_b64_tr_b16 v[74:75], v17 offset:17408
  s_sub_u32 s25, s25, 1
  s_waitcnt lgkmcnt(0)
  v_mfma_f32_16x16x32_bf16 a[0:3], v[60:63], v[28:31], 0
  ds_read_b128 v[44:47], v11 offset:0
  v_mfma_f32_16x16x32_bf16 a[4:7], v[64:67], v[28:31], 0
  ds_read_b64_tr_b16 v[76:77], v14 offset:24576
  v_mfma_f32_16x16x32_bf16 a[8:11], v[68:71], v[28:31], 0
  ds_read_b64_tr_b16 v[78:79], v14 offset:25600
  v_mfma_f32_16x16x32_bf16 a[12:15], v[72:75], v[28:31], 0
  ds_read_b128 v[48:51], v11 offset:2048
  v_mfma_f32_16x16x32_bf16 a[16:19], v[60:63], v[32:35], 0
  ds_read_b64_tr_b16 v[80:81], v15 offset:24576
  v_mfma_f32_16x16x32_bf16 a[20:23], v[64:67], v[32:35], 0
  ds_read_b64_tr_b16 v[82:83], v15 offset:25600
  v_mfma_f32_16x16x32_bf16 a[24:27], v[68:71], v[32:35], 0
  ds_read_b128 v[52:55], v11 offset:4096
  v_mfma_f32_16x16x32_bf16 a[28:31], v[72:75], v[32:35], 0
  ds_read_b64_tr_b16 v[84:85], v16 offset:24576
  v_mfma_f32_16x16x32_bf16 a[32:35], v[60:63], v[36:39], 0
  ds_read_b64_tr_b16 v[86:87], v16 offset:25600
  v_mfma_f32_16x16x32_bf16 a[36:39], v[64:67], v[36:39], 0
  ds_read_b128 v[56:59], v11 offset:6144
  v_mfma_f32_16x16x32_bf16 a[40:43], v[68:71], v[36:39], 0
  ds_read_b64_tr_b16 v[88:89], v17 offset:24576
  v_mfma_f32_16x16x32_bf16 a[44:47], v[72:75], v[36:39], 0
  ds_read_b64_tr_b16 v[90:91], v17 offset:25600
  v_mfma_f32_16x16x32_bf16 a[48:51], v[60:63], v[40:43], 0
  v_mfma_f32_16x16x32_bf16 a[52:55], v[64:67], v[40:43], 0
  v_mfma_f32_16x16x32_bf16 a[56:59], v[68:71], v[40:43], 0
  v_mfma_f32_16x16x32_bf16 a[60:63], v[72:75], v[40:43], 0
  s_waitcnt lgkmcnt(0)
  v_mfma_f32_16x16x32_bf16 a[0:3], v[76:79], v[44:47], a[0:3]
  s_waitcnt vmcnt(18)
  s_barrier
  s_add_u32 m0, s52, 0
  v_mfma_f32_16x16x32_bf16 a[4:7], v[80:83], v[44:47], a[4:7]
  buffer_load_dwordx4 v2, s[8:11], s20 offen  lds
  ds_read_b128 v[28:31], v10 offset:32768
  v_mfma_f32_16x16x32_bf16 a[8:11], v[84:87], v[44:47], a[8:11]
  ds_read_b64_tr_b16 v[60:61], v14 offset:49152
  v_mfma_f32_16x16x32_bf16 a[12:15], v[88:91], v[44:47], a[12:15]
  ds_read_b64_tr_b16 v[62:63], v14 offset:50176
  s_add_u32 m0, s53, 0
  v_mfma_f32_16x16x32_bf16 a[16:19], v[76:79], v[48:51], a[16:19]
  buffer_load_dwordx4 v6, s[12:15], s21 offen  lds
  ds_read_b128 v[32:35], v10 offset:34816
  v_mfma_f32_16x16x32_bf16 a[20:23], v[80:83], v[48:51], a[20:23]
  ds_read_b64_tr_b16 v[64:65], v15 offset:49152
  v_mfma_f32_16x16x32_bf16 a[24:27], v[84:87], v[48:51], a[24:27]
  ds_read_b64_tr_b16 v[66:67], v15 offset:50176
  s_add_u32 m0, s52, 1024
  v_mfma_f32_16x16x32_bf16 a[28:31], v[88:91], v[48:51], a[28:31]
  buffer_load_dwordx4 v3, s[8:11], s20 offen  lds
  ds_read_b128 v[36:39], v10 offset:36864
  v_mfma_f32_16x16x32_bf16 a[32:35], v[76:79], v[52:55], a[32:35]
  ds_read_b64_tr_b16 v[68:69], v16 offset:49152
  v_mfma_f32_16x16x32_bf16 a[36:39], v[80:83], v[52:55], a[36:39]
  ds_read_b64_tr_b16 v[70:71], v16 offset:50176
  s_add_u32 m0, s53, 1024
  v_mfma_f32_16x16x32_bf16 a[40:43], v[84:87], v[52:55], a[40:43]
  buffer_load_dwordx4 v7, s[12:15], s21 offen  lds
  ds_read_b128 v[40:43], v10 offset:38912
  v_mfma_f32_16x16x32_bf16 a[44:47], v[88:91], v[52:55], a[44:47]
  ds_read_b64_tr_b16 v[72:73], v17 offset:49152
  v_mfma_f32_16x16x32_bf16 a[48:51], v[76:79], v[56:59], a[48:51]
  ds_read_b64_tr_b16 v[74:75], v17 offset:50176
  s_add_u32 m0, s52, 2048
  v_mfma_f32_16x16x32_bf16 a[52:55], v[80:83], v[56:59], a[52:55]
  buffer_load_dwordx4 v4, s[8:11], s20 offen  lds
  v_mfma_f32_16x16x32_bf16 a[56:59], v[84:87], v[56:59], a[56:59]
  v_mfma_f32_16x16x32_bf16 a[60:63], v[88:91], v[56:59], a[60:63]
  s_waitcnt lgkmcnt(0)
  s_add_u32 m0, s53, 2048
  v_mfma_f32_16x16x32_bf16 a[0:3], v[60:63], v[28:31], a[0:3]
  buffer_load_dwordx4 v8, s[12:15], s21 offen  lds
  ds_read_b128 v[44:47], v11 offset:32768
  v_mfma_f32_16x16x32_bf16 a[4:7], v[64:67], v[28:31], a[4:7]
  ds_read_b64_tr_b16 v[76:77], v14 offset:57344
  v_mfma_f32_16x16x32_bf16 a[8:11], v[68:71], v[28:31], a[8:11]
  ds_read_b64_tr_b16 v[78:79], v14 offset:58368
  v_mfma_f32_16x16x32_bf16 a[12:15], v[72:75], v[28:31], a[12:15]
  ds_read_b128 v[48:51], v11 offset:34816
  s_add_u32 m0, s52, 3072
  v_mfma_f32_16x16x32_bf16 a[16:19], v[60:63], v[32:35], a[16:19]
  buffer_load_dwordx4 v5, s[8:11], s20 offen  lds
  ds_read_b64_tr_b16 v[80:81], v15 offset:57344
  v_mfma_f32_16x16x32_bf16 a[20:23], v[64:67], v[32:35], a[20:23]
  ds_read_b64_tr_b16 v[82:83], v15 offset:58368
  v_mfma_f32_16x16x32_bf16 a[24:27], v[68:71], v[32:35], a[24:27]
  ds_read_b128 v[52:55], v11 offset:36864
  v_mfma_f32_16x16x32_bf16 a[28:31], v[72:75], v[32:35], a[28:31]
  ds_read_b64_tr_b16 v[84:85], v16 offset:57344
  s_add_u32 m0, s53, 3072
  v_mfma_f32_16x16x32_bf16 a[32:35], v[60:63], v[36:39], a[32:35]
  buffer_load_dwordx4 v9, s[12:15], s21 offen  lds
  ds_read_b64_tr_b16 v[86:87], v16 offset:58368
  v_mfma_f32_16x16x32_bf16 a[36:39], v[64:67], v[36:39], a[36:39]
  ds_read_b128 v[56:59], v11 offset:38912
  v_mfma_f32_16x16x32_bf16 a[40:43], v[68:71], v[36:39], a[40:43]
  ds_read_b64_tr_b16 v[88:89], v17 offset:57344
  v_mfma_f32_16x16x32_bf16 a[44:47], v[72:75], v[36:39], a[44:47]
  ds_read_b64_tr_b16 v[90:91], v17 offset:58368
  s_add_u32 s20, s20, 128
  v_mfma_f32_16x16x32_bf16 a[48:51], v[60:63], v[40:43], a[48:51]
  s_add_u32 s21, s21, s51
  v_mfma_f32_16x16x32_bf16 a[52:55], v[64:67], v[40:43], a[52:55]
  v_mfma_f32_16x16x32_bf16 a[56:59], v[68:71], v[40:43], a[56:59]
  v_mfma_f32_16x16x32_bf16 a[60:63], v[72:75], v[40:43], a[60:63]
  s_waitcnt lgkmcnt(0)
  v_mfma_f32_16x16x32_bf16 a[0:3], v[76:79], v[44:47], a[0:3]
  s_waitcnt vmcnt(18)
  s_barrier
  s_add_u32 m0, s52, 32768
  v_mfma_f32_16x16x32_bf16 a[4:7], v[80:83], v[44:47], a[4:7]
  buffer_load_dwordx4 v2, s[8:11], s20 offen  lds
  ds_read_b128 v[28:31], v12 offset:0
  v_mfma_f32_16x16x32_bf16 a[8:11], v[84:87], v[44:47], a[8:11]
  ds_read_b64_tr_b16 v[60:61], v18 offset:16384
  v_mfma_f32_16x16x32_bf16 a[12:15], v[88:91], v[44:47], a[12:15]
  ds_read_b64_tr_b16 v[62:63], v18 offset:17408
  s_add_u32 m0, s53, 32768
  v_mfma_f32_16x16x32_bf16 a[16:19], v[76:79], v[48:51], a[16:19]
  buffer_load_dwordx4 v6, s[12:15], s21 offen  lds
  ds_read_b128 v[32:35], v12 offset:2048
  v_mfma_f32_16x16x32_bf16 a[20:23], v[80:83], v[48:51], a[20:23]
  ds_read_b64_tr_b16 v[64:65], v19 offset:16384
  v_mfma_f32_16x16x32_bf16 a[24:27], v[84:87], v[48:51], a[24:27]
  ds_read_b64_tr_b16 v[66:67], v19 offset:17408
  s_add_u32 m0, s52, 33792
  v_mfma_f32_16x16x32_bf16 a[28:31], v[88:91], v[48:51], a[28:31]
  buffer_load_dwordx4 v3, s[8:11], s20 offen  lds
  ds_read_b128 v[36:39], v12 offset:4096
  v_mfma_f32_16x16x32_bf16 a[32:35], v[76:79], v[52:55], a[32:35]
  ds_read_b64_tr_b16 v[68:69], v20 offset:16384
  v_mfma_f32_16x16x32_bf16 a[36:39], v[80:83], v[52:55], a[36:39]
  ds_read_b64_tr_b16 v[70:71], v20 offset:17408
  s_add_u32 m0, s53, 33792
  v_mfma_f32_16x16x32_bf16 a[40:43], v[84:87], v[52:55], a[40:43]
  buffer_load_dwordx4 v7, s[12:15], s21 offen  lds
  ds_read_b128 v[40:43], v12 offset:6144
  v_mfma_f32_16x16x32_bf16 a[44:47], v[88:91], v[52:55], a[44:47]
  ds_read_b64_tr_b16 v[72:73], v21 offset:16384
  v_mfma_f32_16x16x32_bf16 a[48:51], v[76:79], v[56:59], a[48:51]
  ds_read_b64_tr_b16 v[74:75], v21 offset:17408
  s_add_u32 m0, s52, 34816
  v_mfma_f32_16x16x32_bf16 a[52:55], v[80:83], v[56:59], a[52:55]
  buffer_load_dwordx4 v4, s[8:11], s20 offen  lds
  v_mfma_f32_16x16x32_bf16 a[56:59], v[84:87], v[56:59], a[56:59]
  v_mfma_f32_16x16x32_bf16 a[60:63], v[88:91], v[56:59], a[60:63]
  s_waitcnt lgkmcnt(0)
  s_add_u32 m0, s53, 34816
  v_mfma_f32_16x16x32_bf16 a[0:3], v[60:63], v[28:31], a[0:3]
  buffer_load_dwordx4 v8, s[12:15], s21 offen  lds
  ds_read_b128 v[44:47], v13 offset:0
  v_mfma_f32_16x16x32_bf16 a[4:7], v[64:67], v[28:31], a[4:7]
  ds_read_b64_tr_b16 v[76:77], v18 offset:24576
  v_mfma_f32_16x16x32_bf16 a[8:11], v[68:71], v[28:31], a[8:11]
  ds_read_b64_tr_b16 v[78:79], v18 offset:25600
  v_mfma_f32_16x16x32_bf16 a[12:15], v[72:75], v[28:31], a[12:15]
  ds_read_b128 v[48:51], v13 offset:2048
  s_add_u32 m0, s52, 35840
  v_mfma_f32_16x16x32_bf16 a[16:19], v[60:63], v[32:35], a[16:19]
  buffer_load_dwordx4 v5, s[8:11], s20 offen  lds
  ds_read_b64_tr_b16 v[80:81], v19 offset:24576
  v_mfma_f32_16x16x32_bf16 a[20:23], v[64:67], v[32:35], a[20:23]
  ds_read_b64_tr_b16 v[82:83], v19 offset:25600
  v_mfma_f32_16x16x32_bf16 a[24:27], v[68:71], v[32:35], a[24:27]
  ds_read_b128 v[52:55], v13 offset:4096
  v_mfma_f32_16x16x32_bf16 a[28:31], v[72:75], v[32:35], a[28:31]
  ds_read_b64_tr_b16 v[84:85], v20 offset:24576
  s_add_u32 m0, s53, 35840
  v_mfma_f32_16x16x32_bf16 a[32:35], v[60:63], v[36:39], a[32:35]
  buffer_load_dwordx4 v9, s[12:15], s21 offen  lds
  ds_read_b64_tr_b16 v[86:87], v20 offset:25600
  v_mfma_f32_16x16x32_bf16 a[36:39], v[64:67], v[36:39], a[36:39]
  ds_read_b128 v[56:59], v13 offset:6144
  v_mfma_f32_16x16x32_bf16 a[40:43], v[68:71], v[36:39], a[40:43]
  ds_read_b64_tr_b16 v[88:89], v21 offset:24576
  v_mfma_f32_16x16x32_bf16 a[44:47], v[72:75], v[36:39], a[44:47]
  ds_read_b64_tr_b16 v[90:91], v21 offset:25600
  s_add_u32 s20, s20, 128
  v_mfma_f32_16x16x32_bf16 a[48:51], v[60:63], v[40:43], a[48:51]
  s_add_u32 s21, s21, s51
  v_mfma_f32_16x16x32_bf16 a[52:55], v[64:67], v[40:43], a[52:55]
  v_mfma_f32_16x16x32_bf16 a[56:59], v[68:71], v[40:43], a[56:59]
  v_mfma_f32_16x16x32_bf16 a[60:63], v[72:75], v[40:43], a[60:63]
  s_waitcnt lgkmcnt(0)
  v_mfma_f32_16x16x32_bf16 a[0:3], v[76:79], v[44:47], a[0:3]
  s_waitcnt vmcnt(18)
  s_barrier
  s_add_u32 m0, s52, 65536
  v_mfma_f32_16x16x32_bf16 a[4:7], v[80:83], v[44:47], a[4:7]
  buffer_load_dwordx4 v2, s[8:11], s20 offen  lds
  ds_read_b128 v[28:31], v12 offset:32768
  v_mfma_f32_16x16x32_bf16 a[8:11], v[84:87], v[44:47], a[8:11]
  ds_read_b64_tr_b16 v[60:61], v18 offset:49152
  v_mfma_f32_16x16x32_bf16 a[12:15], v[88:91], v[44:47], a[12:15]
  ds_read_b64_tr_b16 v[62:63], v18 offset:50176
  s_add_u32 m0, s53, 65536
  v_mfma_f32_16x16x32_bf16 a[16:19], v[76:79], v[48:51], a[16:19]
  buffer_load_dwordx4 v6, s[12:15], s21 offen  lds
  ds_read_b128 v[32:35], v12 offset:34816
  v_mfma_f32_16x16x32_bf16 a[20:23], v[80:83], v[48:51], a[20:23]
  ds_read_b64_tr_b16 v[64:65], v19 offset:49152
  v_mfma_f32_16x16x32_bf16 a[24:27], v[84:87], v[48:51], a[24:27]
  ds_read_b64_tr_b16 v[66:67], v19 offset:50176
  s_add_u32 m0, s52, 66560
  v_mfma_f32_16x16x32_bf16 a[28:31], v[88:91], v[48:51], a[28:31]
  buffer_load_dwordx4 v3, s[8:11], s20 offen  lds
  ds_read_b128 v[36:39], v12 offset:36864
  v_mfma_f32_16x16x32_bf16 a[32:35], v[76:79], v[52:55], a[32:35]
  ds_read_b64_tr_b16 v[68:69], v20 offset:49152
  v_mfma_f32_16x16x32_bf16 a[36:39], v[80:83], v[52:55], a[36:39]
  ds_read_b64_tr_b16 v[70:71], v20 offset:50176
  s_add_u32 m0, s53, 66560
  v_mfma_f32_16x16x32_bf16 a[40:43], v[84:87], v[52:55], a[40:43]
  buffer_load_dwordx4 v7, s[12:15], s21 offen  lds
  ds_read_b128 v[40:43], v12 offset:38912
  v_mfma_f32_16x16x32_bf16 a[44:47], v[88:91], v[52:55], a[44:47]
  ds_read_b64_tr_b16 v[72:73], v21 offset:49152
  v_mfma_f32_16x16x32_bf16 a[48:51], v[76:79], v[56:59], a[48:51]
  ds_read_b64_tr_b16 v[74:75], v21 offset:50176
  s_add_u32 m0, s52, 67584
  v_mfma_f32_16x16x32_bf16 a[52:55], v[80:83], v[56:59], a[52:55]
  buffer_load_dwordx4 v4, s[8:11], s20 offen  lds
  v_mfma_f32_16x16x32_bf16 a[56:59], v[84:87], v[56:59], a[56:59]
  v_mfma_f32_16x16x32_bf16 a[60:63], v[88:91], v[56:59], a[60:63]
  s_waitcnt lgkmcnt(0)
  s_add_u32 m0, s53, 67584
  v_mfma_f32_16x16x32_bf16 a[0:3], v[60:63], v[28:31], a[0:3]
  buffer_load_dwordx4 v8, s[12:15], s21 offen  lds
  ds_read_b128 v[44:47], v13 offset:32768
  v_mfma_f32_16x16x32_bf16 a[4:7], v[64:67], v[28:31], a[4:7]
  ds_read_b64_tr_b16 v[76:77], v18 offset:57344
  v_mfma_f32_16x16x32_bf16 a[8:11], v[68:71], v[28:31], a[8:11]
  ds_read_b64_tr_b16 v[78:79], v18 offset:58368
  v_mfma_f32_16x16x32_bf16 a[12:15], v[72:75], v[28:31], a[12:15]
  ds_read_b128 v[48:51], v13 offset:34816
  s_add_u32 m0, s52, 68608
  v_mfma_f32_16x16x32_bf16 a[16:19], v[60:63], v[32:35], a[16:19]
  buffer_load_dwordx4 v5, s[8:11], s20 offen  lds
  ds_read_b64_tr_b16 v[80:81], v19 offset:57344
  v_mfma_f32_16x16x32_bf16 a[20:23], v[64:67], v[32:35], a[20:23]
  ds_read_b64_tr_b16 v[82:83], v19 offset:58368
  v_mfma_f32_16x16x32_bf16 a[24:27], v[68:71], v[32:35], a[24:27]
  ds_read_b128 v[52:55], v13 offset:36864
  v_mfma_f32_16x16x32_bf16 a[28:31], v[72:75], v[32:35], a[28:31]
  ds_read_b64_tr_b16 v[84:85], v20 offset:57344
  s_add_u32 m0, s53, 68608
  v_mfma_f32_16x16x32_bf16 a[32:35], v[60:63], v[36:39], a[32:35]
  buffer_load_dwordx4 v9, s[12:15], s21 offen  lds
  ds_read_b64_tr_b16 v[86:87], v20 offset:58368
  v_mfma_f32_16x16x32_bf16 a[36:39], v[64:67], v[36:39], a[36:39]
  ds_read_b128 v[56:59], v13 offset:38912
  v_mfma_f32_16x16x32_bf16 a[40:43], v[68:71], v[36:39], a[40:43]
  ds_read_b64_tr_b16 v[88:89], v21 offset:57344
  v_mfma_f32_16x16x32_bf16 a[44:47], v[72:75], v[36:39], a[44:47]
  ds_read_b64_tr_b16 v[90:91], v21 offset:58368
  s_add_u32 s20, s20, 128
  v_mfma_f32_16x16x32_bf16 a[48:51], v[60:63], v[40:43], a[48:51]
  s_add_u32 s21, s21, s51
  v_mfma_f32_16x16x32_bf16 a[52:55], v[64:67], v[40:43], a[52:55]
  v_mfma_f32_16x16x32_bf16 a[56:59], v[68:71], v[40:43], a[56:59]
  v_mfma_f32_16x16x32_bf16 a[60:63], v[72:75], v[40:43], a[60:63]
  s_waitcnt lgkmcnt(0)
  v_mfma_f32_16x16x32_bf16 a[0:3], v[76:79], v[44:47], a[0:3]
  s_waitcnt vmcnt(16)
  s_barrier
  s_add_u32 m0, s52, 98304
  v_mfma_f32_16x16x32_bf16 a[4:7], v[80:83], v[44:47], a[4:7]
  buffer_load_dwordx4 v2, s[8:11], s20 offen  lds
  ds_read_b128 v[28:31], v10 offset:0
  v_mfma_f32_16x16x32_bf16 a[8:11], v[84:87], v[44:47], a[8:11]
  ds_read_b64_tr_b16 v[60:61], v14 offset:16384
  v_mfma_f32_16x16x32_bf16 a[12:15], v[88:91], v[44:47], a[12:15]
  ds_read_b64_tr_b16 v[62:63], v14 offset:17408
  s_add_u32 m0, s53, 98304
  v_mfma_f32_16x16x32_bf16 a[16:19], v[76:79], v[48:51], a[16:19]
  buffer_load_dwordx4 v6, s[12:15], s21 offen  lds
  ds_read_b128 v[32:35], v10 offset:2048
  v_mfma_f32_16x16x32_bf16 a[20:23], v[80:83], v[48:51], a[20:23]
  ds_read_b64_tr_b16 v[64:65], v15 offset:16384
  v_mfma_f32_16x16x32_bf16 a[24:27], v[84:87], v[48:51], a[24:27]
  ds_read_b64_tr_b16 v[66:67], v15 offset:17408
  s_add_u32 m0, s52, 99328
  v_mfma_f32_16x16x32_bf16 a[28:31], v[88:91], v[48:51], a[28:31]
  buffer_load_dwordx4 v3, s[8:11], s20 offen  lds
  ds_read_b128 v[36:39], v10 offset:4096
  v_mfma_f32_16x16x32_bf16 a[32:35], v[76:79], v[52:55], a[32:35]
  ds_read_b64_tr_b16 v[68:69], v16 offset:16384
  v_mfma_f32_16x16x32_bf16 a[36:39], v[80:83], v[52:55], a[36:39]
  ds_read_b64_tr_b16 v[70:71], v16 offset:17408
  s_add_u32 m0, s53, 99328
  v_mfma_f32_16x16x32_bf16 a[40:43], v[84:87], v[52:55], a[40:43]
  buffer_load_dwordx4 v7, s[12:15], s21 offen  lds
  ds_read_b128 v[40:43], v10 offset:6144
  v_mfma_f32_16x16x32_bf16 a[44:47], v[88:91], v[52:55], a[44:47]
  ds_read_b64_tr_b16 v[72:73], v17 offset:16384
  v_mfma_f32_16x16x32_bf16 a[48:51], v[76:79], v[56:59], a[48:51]
  ds_read_b64_tr_b16 v[74:75], v17 offset:17408
  s_add_u32 m0, s52, 100352
  v_mfma_f32_16x16x32_bf16 a[52:55], v[80:83], v[56:59], a[52:55]
  buffer_load_dwordx4 v4, s[8:11], s20 offen  lds
  v_mfma_f32_16x16x32_bf16 a[56:59], v[84:87], v[56:59], a[56:59]
  v_mfma_f32_16x16x32_bf16 a[60:63], v[88:91], v[56:59], a[60:63]
L_g4_loop:
  s_sub_u32 s25, s25, 1
  s_cmp_eq_u32 s25, 0
  s_cbranch_scc1 L_g4_fin
  s_waitcnt lgkmcnt(0)
  s_add_u32 m0, s53, 100352
  v_mfma_f32_16x16x32_bf16 a[0:3], v[60:63], v[28:31], a[0:3]
  buffer_load_dwordx4 v8, s[12:15], s21 offen  lds
  ds_read_b128 v[44:47], v11 offset:0
  v_mfma_f32_16x16x32_bf16 a[4:7], v[64:67], v[28:31], a[4:7]
  ds_read_b64_tr_b16 v[76:77], v14 offset:24576
  v_mfma_f32_16x16x32_bf16 a[8:11], v[68:71], v[28:31], a[8:11]
  ds_read_b64_tr_b16 v[78:79], v14 offset:25600
  v_mfma_f32_16x16x32_bf16 a[12:15], v[72:75], v[28:31], a[12:15]
  ds_read_b128 v[48:51], v11 offset:2048
  s_add_u32 m0, s52, 101376
  v_mfma_f32_16x16x32_bf16 a[16:19], v[60:63], v[32:35], a[16:19]
  buffer_load_dwordx4 v5, s[8:11], s20 offen  lds
  ds_read_b64_tr_b16 v[80:81], v15 offset:24576
  v_mfma_f32_16x16x32_bf16 a[20:23], v[64:67], v[32:35], a[20:23]
  ds_read_b64_tr_b16 v[82:83], v15 offset:25600
  v_mfma_f32_16x16x32_bf16 a[24:27], v[68:71], v[32:35], a[24:27]
  ds_read_b128 v[52:55], v11 offset:4096
  v_mfma_f32_16x16x32_bf16 a[28:31], v[72:75], v[32:35], a[28:31]
  ds_read_b64_tr_b16 v[84:85], v16 offset:24576
  s_add_u32 m0, s53, 101376
  v_mfma_f32_16x16x32_bf16 a[32:35], v[60:63], v[36:39], a[32:35]
  buffer_load_dwordx4 v9, s[12:15], s21 offen  lds
  ds_read_b64_tr_b16 v[86:87], v16 offset:25600
  v_mfma_f32_16x16x32_bf16 a[36:39], v[64:67], v[36:39], a[36:39]
  ds_read_b128 v[56:59], v11 offset:6144
  v_mfma_f32_16x16x32_bf16 a[40:43], v[68:71], v[36:39], a[40:43]
  ds_read_b64_tr_b16 v[88:89], v17 offset:24576
  v_mfma_f32_16x16x32_bf16 a[44:47], v[72:75], v[36:39], a[44:47]
  ds_read_b64_tr_b16 v[90:91], v17 offset:25600
  s_add_u32 s20, s20, 128
  v_mfma_f32_16x16x32_bf16 a[48:51], v[60:63], v[40:43], a[48:51]
  s_add_u32 s21, s21, s51
  v_mfma_f32_16x16x32_bf16 a[52:55], v[64:67], v[40:43], a[52:55]
  v_mfma_f32_16x16x32_bf16 a[56:59], v[68:71], v[40:43], a[56:59]
  v_mfma_f32_16x16x32_bf16 a[60:63], v[72:75], v[40:43], a[60:63]
  s_waitcnt lgkmcnt(0)
  v_mfma_f32_16x16x32_bf16 a[0:3], v[76:79], v[44:47], a[0:3]
  s_waitcnt vmcnt(16)
  s_barrier
  s_add_u32 m0, s52, 0
  v_mfma_f32_16x16x32_bf16 a[4:7], v[80:83], v[44:47], a[4:7]
  buffer_load_dwordx4 v2, s[8:11], s20 offen  lds
  ds_read_b128 v[28:31], v10 offset:32768
  v_mfma_f32_16x16x32_bf16 a[8:11], v[84:87], v[44:47], a[8:11]
  ds_read_b64_tr_b16 v[60:61], v14 offset:49152
  v_mfma_f32_16x16x32_bf16 a[12:15], v[88:91], v[44:47], a[12:15]
  ds_read_b64_tr_b16 v[62:63], v14 offset:50176
  s_add_u32 m0, s53, 0
  v_mfma_f32_16x16x32_bf16 a[16:19], v[76:79], v[48:51], a[16:19]
  buffer_load_dwordx4 v6, s[12:15], s21 offen  lds
  ds_read_b128 v[32:35], v10 offset:34816
  v_mfma_f32_16x16x32_bf16 a[20:23], v[80:83], v[48:51], a[20:23]
  ds_read_b64_tr_b16 v[64:65], v15 offset:49152
  v_mfma_f32_16x16x32_bf16 a[24:27], v[84:87], v[48:51], a[24:27]
  ds_read_b64_tr_b16 v[66:67], v15 offset:50176
  s_add_u32 m0, s52, 1024
  v_mfma_f32_16x16x32_bf16 a[28:31], v[88:91], v[48:51], a[28:31]
  buffer_load_dwordx4 v3, s[8:11], s20 offen  lds
  ds_read_b128 v[36:39], v10 offset:36864
  v_mfma_f32_16x16x32_bf16 a[32:35], v[76:79], v[52:55], a[32:35]
  ds_read_b64_tr_b16 v[68:69], v16 offset:49152
  v_mfma_f32_16x16x32_bf16 a[36:39], v[80:83], v[52:55], a[36:39]
  ds_read_b64_tr_b16 v[70:71], v16 offset:50176
  s_add_u32 m0, s53, 1024
  v_mfma_f32_16x16x32_bf16 a[40:43], v[84:87], v[52:55], a[40:43]
  buffer_load_dwordx4 v7, s[12:15], s21 offen  lds
  ds_read_b128 v[40:43], v10 offset:38912
  v_mfma_f32_16x16x32_bf16 a[44:47], v[88:91], v[52:55], a[44:47]
  ds_read_b64_tr_b16 v[72:73], v17 offset:49152
  v_mfma_f32_16x16x32_bf16 a[48:51], v[76:79], v[56:59], a[48:51]
  ds_read_b64_tr_b16 v[74:75], v17 offset:50176
  s_add_u32 m0, s52, 2048
  v_mfma_f32_16x16x32_bf16 a[52:55], v[80:83], v[56:59], a[52:55]
  buffer_load_dwordx4 v4, s[8:11], s20 offen  lds
  v_mfma_f32_16x16x32_bf16 a[56:59], v[84:87], v[56:59], a[56:59]
  v_mfma_f32_16x16x32_bf16 a[60:63], v[88:91], v[56:59], a[60:63]
  s_waitcnt lgkmcnt(0)
  s_add_u32 m0, s53, 2048
  v_mfma_f32_16x16x32_bf16 a[0:3], v[60:63], v[28:31], a[0:3]
  buffer_load_dwordx4 v8, s[12:15], s21 offen  lds
  ds_read_b128 v[44:47], v11 offset:32768
  v_mfma_f32_16x16x32_bf16 a[4:7], v[64:67], v[28:31], a[4:7]
  ds_read_b64_tr_b16 v[76:77], v14 offset:57344
  v_mfma_f32_16x16x32_bf16 a[8:11], v[68:71], v[28:31], a[8:11]
  ds_read_b64_tr_b16 v[78:79], v14 offset:58368
  v_mfma_f32_16x16x32_bf16 a[12:15], v[72:75], v[28:31], a[12:15]
  ds_read_b128 v[48:51], v11 offset:34816
  s_add_u32 m0, s52, 3072
  v_mfma_f32_16x16x32_bf16 a[16:19], v[60:63], v[32:35], a[16:19]
  buffer_load_dwordx4 v5, s[8:11], s20 offen  lds
  ds_read_b64_tr_b16 v[80:81], v15 offset:57344
  v_mfma_f32_16x16x32_bf16 a[20:23], v[64:67], v[32:35], a[20:23]
  ds_read_b64_tr_b16 v[82:83], v15 offset:58368
  v_mfma_f32_16x16x32_bf16 a[24:27], v[68:71], v[32:35], a[24:27]
  ds_read_b128 v[52:55], v11 offset:36864
  v_mfma_f32_16x16x32_bf16 a[28:31], v[72:75], v[32:35], a[28:31]
  ds_read_b64_tr_b16 v[84:85], v16 offset:57344
  s_add_u32 m0, s53, 3072
  v_mfma_f32_16x16x32_bf16 a[32:35], v[60:63], v[36:39], a[32:35]
  buffer_load_dwordx4 v9, s[12:15], s21 offen  lds
  ds_read_b64_tr_b16 v[86:87], v16 offset:58368
  v_mfma_f32_16x16x32_bf16 a[36:39], v[64:67], v[36:39], a[36:39]
  ds_read_b128 v[56:59], v11 offset:38912
  v_mfma_f32_16x16x32_bf16 a[40:43], v[68:71], v[36:39], a[40:43]
  ds_read_b64_tr_b16 v[88:89], v17 offset:57344
  v_mfma_f32_16x16x32_bf16 a[44:47], v[72:75], v[36:39], a[44:47]
  ds_read_b64_tr_b16 v[90:91], v17 offset:58368
  s_add_u32 s20, s20, 128
  v_mfma_f32_16x16x32_bf16 a[48:51], v[60:63], v[40:43], a[48:51]
  s_add_u32 s21, s21, s51
  v_mfma_f32_16x16x32_bf16 a[52:55], v[64:67], v[40:43], a[52:55]
  v_mfma_f32_16x16x32_bf16 a[56:59], v[68:71], v[40:43], a[56:59]
  v_mfma_f32_16x16x32_bf16 a[60:63], v[72:75], v[40:43], a[60:63]
  s_waitcnt lgkmcnt(0)
  v_mfma_f32_16x16x32_bf16 a[0:3], v[76:79], v[44:47], a[0:3]
  s_waitcnt vmcnt(16)
  s_barrier
  s_add_u32 m0, s52, 32768
  v_mfma_f32_16x16x32_bf16 a[4:7], v[80:83], v[44:47], a[4:7]
  buffer_load_dwordx4 v2, s[8:11], s20 offen  lds
  ds_read_b128 v[28:31], v12 offset:0
  v_mfma_f32_16x16x32_bf16 a[8:11], v[84:87], v[44:47], a[8:11]
  ds_read_b64_tr_b16 v[60:61], v18 offset:16384
  v_mfma_f32_16x16x32_bf16 a[12:15], v[88:91], v[44:47], a[12:15]
  ds_read_b64_tr_b16 v[62:63], v18 offset:17408
  s_add_u32 m0, s53, 32768
  v_mfma_f32_16x16x32_bf16 a[16:19], v[76:79], v[48:51], a[16:19]
  buffer_load_dwordx4 v6, s[12:15], s21 offen  lds
  ds_read_b128 v[32:35], v12 offset:2048
  v_mfma_f32_16x16x32_bf16 a[20:23], v[80:83], v[48:51], a[20:23]
  ds_read_b64_tr_b16 v[64:65], v19 offset:16384
  v_mfma_f32_16x16x32_bf16 a[24:27], v[84:87], v[48:51], a[24:27]
  ds_read_b64_tr_b16 v[66:67], v19 offset:17408
  s_add_u32 m0, s52, 33792
  v_mfma_f32_16x16x32_bf16 a[28:31], v[88:91], v[48:51], a[28:31]
  buffer_load_dwordx4 v3, s[8:11], s20 offen  lds
  ds_read_b128 v[36:39], v12 offset:4096
  v_mfma_f32_16x16x32_bf16 a[32:35], v[76:79], v[52:55], a[32:35]
  ds_read_b64_tr_b16 v[68:69], v20 offset:16384
  v_mfma_f32_16x16x32_bf16 a[36:39], v[80:83], v[52:55], a[36:39]
  ds_read_b64_tr_b16 v[70:71], v20 offset:17408
  s_add_u32 m0, s53, 33792
  v_mfma_f32_16x16x32_bf16 a[40:43], v[84:87], v[52:55], a[40:43]
  buffer_load_dwordx4 v7, s[12:15], s21 offen  lds
  ds_read_b128 v[40:43], v12 offset:6144
  v_mfma_f32_16x16x32_bf16 a[44:47], v[88:91], v[52:55], a[44:47]
  ds_read_b64_tr_b16 v[72:73], v21 offset:16384
  v_mfma_f32_16x16x32_bf16 a[48:51], v[76:79], v[56:59], a[48:51]
  ds_read_b64_tr_b16 v[74:75], v21 offset:17408
  s_add_u32 m0, s52, 34816
  v_mfma_f32_16x16x32_bf16 a[52:55], v[80:83], v[56:59], a[52:55]
  buffer_load_dwordx4 v4, s[8:11], s20 offen  lds
  v_mfma_f32_16x16x32_bf16 a[56:59], v[84:87], v[56:59], a[56:59]
  v_mfma_f32_16x16x32_bf16 a[60:63], v[88:91], v[56:59], a[60:63]
  s_waitcnt lgkmcnt(0)
  s_add_u32 m0, s53, 34816
  v_mfma_f32_16x16x32_bf16 a[0:3], v[60:63], v[28:31], a[0:3]
  buffer_load_dwordx4 v8, s[12:15], s21 offen  lds
  ds_read_b128 v[44:47], v13 offset:0
  v_mfma_f32_16x16x32_bf16 a[4:7], v[64:67], v[28:31], a[4:7]
  ds_read_b64_tr_b16 v[76:77], v18 offset:24576
  v_mfma_f32_16x16x32_bf16 a[8:11], v[68:71], v[28:31], a[8:11]
  ds_read_b64_tr_b16 v[78:79], v18 offset:25600
  v_mfma_f32_16x16x32_bf16 a[12:15], v[72:75], v[28:31], a[12:15]
  ds_read_b128 v[48:51], v13 offset:2048
  s_add_u32 m0, s52, 35840
  v_mfma_f32_16x16x32_bf16 a[16:19], v[60:63], v[32:35], a[16:19]
  buffer_load_dwordx4 v5, s[8:11], s20 offen  lds
  ds_read_b64_tr_b16 v[80:81], v19 offset:24576
  v_mfma_f32_16x16x32_bf16 a[20:23], v[64:67], v[32:35], a[20:23]
  ds_read_b64_tr_b16 v[82:83], v19 offset:25600
  v_mfma_f32_16x16x32_bf16 a[24:27], v[68:71], v[32:35], a[24:27]
  ds_read_b128 v[52:55], v13 offset:4096
  v_mfma_f32_16x16x32_bf16 a[28:31], v[72:75], v[32:35], a[28:31]
  ds_read_b64_tr_b16 v[84:85], v20 offset:24576
  s_add_u32 m0, s53, 35840
  v_mfma_f32_16x16x32_bf16 a[32:35], v[60:63], v[36:39], a[32:35]
  buffer_load_dwordx4 v9, s[12:15], s21 offen  lds
  ds_read_b64_tr_b16 v[86:87], v20 offset:25600
  v_mfma_f32_16x16x32_bf16 a[36:39], v[64:67], v[36:39], a[36:39]
  ds_read_b128 v[56:59], v13 offset:6144
  v_mfma_f32_16x16x32_bf16 a[40:43], v[68:71], v[36:39], a[40:43]
  ds_read_b64_tr_b16 v[88:89], v21 offset:24576
  v_mfma_f32_16x16x32_bf16 a[44:47], v[72:75], v[36:39], a[44:47]
  ds_read_b64_tr_b16 v[90:91], v21 offset:25600
  s_add_u32 s20, s20, 128
  v_mfma_f32_16x16x32_bf16 a[48:51], v[60:63], v[40:43], a[48:51]
  s_add_u32 s21, s21, s51
  v_mfma_f32_16x16x32_bf16 a[52:55], v[64:67], v[40:43], a[52:55]
  v_mfma_f32_16x16x32_bf16 a[56:59], v[68:71], v[40:43], a[56:59]
  v_mfma_f32_16x16x32_bf16 a[60:63], v[72:75], v[40:43], a[60:63]
  s_waitcnt lgkmcnt(0)
  v_mfma_f32_16x16x32_bf16 a[0:3], v[76:79], v[44:47], a[0:3]
  s_waitcnt vmcnt(16)
  s_barrier
  s_add_u32 m0, s52, 65536
  v_mfma_f32_16x16x32_bf16 a[4:7], v[80:83], v[44:47], a[4:7]
  buffer_load_dwordx4 v2, s[8:11], s20 offen  lds
  ds_read_b128 v[28:31], v12 offset:32768
  v_mfma_f32_16x16x32_bf16 a[8:11], v[84:87], v[44:47], a[8:11]
  ds_read_b64_tr_b16 v[60:61], v18 offset:49152
  v_mfma_f32_16x16x32_bf16 a[12:15], v[88:91], v[44:47], a[12:15]
  ds_read_b64_tr_b16 v[62:63], v18 offset:50176
  s_add_u32 m0, s53, 65536
  v_mfma_f32_16x16x32_bf16 a[16:19], v[76:79], v[48:51], a[16:19]
  buffer_load_dwordx4 v6, s[12:15], s21 offen  lds
  ds_read_b128 v[32:35], v12 offset:34816
  v_mfma_f32_16x16x32_bf16 a[20:23], v[80:83], v[48:51], a[20:23]
  ds_read_b64_tr_b16 v[64:65], v19 offset:49152
  v_mfma_f32_16x16x32_bf16 a[24:27], v[84:87], v[48:51], a[24:27]
  ds_read_b64_tr_b16 v[66:67], v19 offset:50176
  s_add_u32 m0, s52, 66560
  v_mfma_f32_16x16x32_bf16 a[28:31], v[88:91], v[48:51], a[28:31]
  buffer_load_dwordx4 v3, s[8:11], s20 offen  lds
  ds_read_b128 v[36:39], v12 offset:36864
  v_mfma_f32_16x16x32_bf16 a[32:35], v[76:79], v[52:55], a[32:35]
  ds_read_b64_tr_b16 v[68:69], v20 offset:49152
  v_mfma_f32_16x16x32_bf16 a[36:39], v[80:83], v[52:55], a[36:39]
  ds_read_b64_tr_b16 v[70:71], v20 offset:50176
  s_add_u32 m0, s53, 66560
  v_mfma_f32_16x16x32_bf16 a[40:43], v[84:87], v[52:55], a[40:43]
  buffer_load_dwordx4 v7, s[12:15], s21 offen  lds
  ds_read_b128 v[40:43], v12 offset:38912
  v_mfma_f32_16x16x32_bf16 a[44:47], v[88:91], v[52:55], a[44:47]
  ds_read_b64_tr_b16 v[72:73], v21 offset:49152
  v_mfma_f32_16x16x32_bf16 a[48:51], v[76:79], v[56:59], a[48:51]
  ds_read_b64_tr_b16 v[74:75], v21 offset:50176
  s_add_u32 m0, s52, 67584
  v_mfma_f32_16x16x32_bf16 a[52:55], v[80:83], v[56:59], a[52:55]
  buffer_load_dwordx4 v4, s[8:11], s20 offen  lds
  v_mfma_f32_16x16x32_bf16 a[56:59], v[84:87], v[56:59], a[56:59]
  v_mfma_f32_16x16x32_bf16 a[60:63], v[88:91], v[56:59], a[60:63]
  s_waitcnt lgkmcnt(0)
  s_add_u32 m0, s53, 67584
  v_mfma_f32_16x16x32_bf16 a[0:3], v[60:63], v[28:31], a[0:3]
  buffer_load_dwordx4 v8, s[12:15], s21 offen  lds
  ds_read_b128 v[44:47], v13 offset:32768
  v_mfma_f32_16x16x32_bf16 a[4:7], v[64:67], v[28:31], a[4:7]
  ds_read_b64_tr_b16 v[76:77], v18 offset:57344
  v_mfma_f32_16x16x32_bf16 a[8:11], v[68:71], v[28:31], a[8:11]
  ds_read_b64_tr_b16 v[78:79], v18 offset:58368
  v_mfma_f32_16x16x32_bf16 a[12:15], v[72:75], v[28:31], a[12:15]
  ds_read_b128 v[48:51], v13 offset:34816
  s_add_u32 m0, s52, 68608
  v_mfma_f32_16x16x32_bf16 a[16:19], v[60:63], v[32:35], a[16:19]
  buffer_load_dwordx4 v5, s[8:11], s20 offen  lds
  ds_read_b64_tr_b16 v[80:81], v19 offset:57344
  v_mfma_f32_16x16x32_bf16 a[20:23], v[64:67], v[32:35], a[20:23]
  ds_read_b64_tr_b16 v[82:83], v19 offset:58368
  v_mfma_f32_16x16x32_bf16 a[24:27], v[68:71], v[32:35], a[24:27]
  ds_read_b128 v[52:55], v13 offset:36864
  v_mfma_f32_16x16x32_bf16 a[28:31], v[72:75], v[32:35], a[28:31]
  ds_read_b64_tr_b16 v[84:85], v20 offset:57344
  s_add_u32 m0, s53, 68608
  v_mfma_f32_16x16x32_bf16 a[32:35], v[60:63], v[36:39], a[32:35]
  buffer_load_dwordx4 v9, s[12:15], s21 offen  lds
  ds_read_b64_tr_b16 v[86:87], v20 offset:58368
  v_mfma_f32_16x16x32_bf16 a[36:39], v[64:67], v[36:39], a[36:39]
  ds_read_b128 v[56:59], v13 offset:38912
  v_mfma_f32_16x16x32_bf16 a[40:43], v[68:71], v[36:39], a[40:43]
  ds_read_b64_tr_b16 v[88:89], v21 offset:57344
  v_mfma_f32_16x16x32_bf16 a[44:47], v[72:75], v[36:39], a[44:47]
  ds_read_b64_tr_b16 v[90:91], v21 offset:58368
  s_add_u32 s20, s20, 128
  v_mfma_f32_16x16x32_bf16 a[48:51], v[60:63], v[40:43], a[48:51]
  s_add_u32 s21, s21, s51
  v_mfma_f32_16x16x32_bf16 a[52:55], v[64:67], v[40:43], a[52:55]
  v_mfma_f32_16x16x32_bf16 a[56:59], v[68:71], v[40:43], a[56:59]
  v_mfma_f32_16x16x32_bf16 a[60:63], v[72:75], v[40:43], a[60:63]
  s_waitcnt lgkmcnt(0)
  v_mfma_f32_16x16x32_bf16 a[0:3], v[76:79], v[44:47], a[0:3]
  s_waitcnt vmcnt(16)
  s_barrier
  s_add_u32 m0, s52, 98304
  v_mfma_f32_16x16x32_bf16 a[4:7], v[80:83], v[44:47], a[4:7]
  buffer_load_dwordx4 v2, s[8:11], s20 offen  lds
  ds_read_b128 v[28:31], v10 offset:0
  v_mfma_f32_16x16x32_bf16 a[8:11], v[84:87], v[44:47], a[8:11]
  ds_read_b64_tr_b16 v[60:61], v14 offset:16384
  v_mfma_f32_16x16x32_bf16 a[12:15], v[88:91], v[44:47], a[12:15]
  ds_read_b64_tr_b16 v[62:63], v14 offset:17408
  s_add_u32 m0, s53, 98304
  v_mfma_f32_16x16x32_bf16 a[16:19], v[76:79], v[48:51], a[16:19]
  buffer_load_dwordx4 v6, s[12:15], s21 offen  lds
  ds_read_b128 v[32:35], v10 offset:2048
  v_mfma_f32_16x16x32_bf16 a[20:23], v[80:83], v[48:51], a[20:23]
  ds_read_b64_tr_b16 v[64:65], v15 offset:16384
  v_mfma_f32_16x16x32_bf16 a[24:27], v[84:87], v[48:51], a[24:27]
  ds_read_b64_tr_b16 v[66:67], v15 offset:17408
  s_add_u32 m0, s52, 99328
  v_mfma_f32_16x16x32_bf16 a[28:31], v[88:91], v[48:51], a[28:31]
  buffer_load_dwordx4 v3, s[8:11], s20 offen  lds
  ds_read_b128 v[36:39], v10 offset:4096
  v_mfma_f32_16x16x32_bf16 a[32:35], v[76:79], v[52:55], a[32:35]
  ds_read_b64_tr_b16 v[68:69], v16 offset:16384
  v_mfma_f32_16x16x32_bf16 a[36:39], v[80:83], v[52:55], a[36:39]
  ds_read_b64_tr_b16 v[70:71], v16 offset:17408
  s_add_u32 m0, s53, 99328
  v_mfma_f32_16x16x32_bf16 a[40:43], v[84:87], v[52:55], a[40:43]
  buffer_load_dwordx4 v7, s[12:15], s21 offen  lds
  ds_read_b128 v[40:43], v10 offset:6144
  v_mfma_f32_16x16x32_bf16 a[44:47], v[88:91], v[52:55], a[44:47]
  ds_read_b64_tr_b16 v[72:73], v17 offset:16384
  v_mfma_f32_16x16x32_bf16 a[48:51], v[76:79], v[56:59], a[48:51]
  ds_read_b64_tr_b16 v[74:75], v17 offset:17408
  s_add_u32 m0, s52, 100352
  v_mfma_f32_16x16x32_bf16 a[52:55], v[80:83], v[56:59], a[52:55]
  buffer_load_dwordx4 v4, s[8:11], s20 offen  lds
  v_mfma_f32_16x16x32_bf16 a[56:59], v[84:87], v[56:59], a[56:59]
  v_mfma_f32_16x16x32_bf16 a[60:63], v[88:91], v[56:59], a[60:63]
  s_branch L_g4_loop
L_g4_fin:
  s_cmp_lg_u32 s32, 0
  s_cbranch_scc1 L_rq_85
  s_cmp_eq_u32 s39, 0
  s_cbranch_scc1 L_rq_85
  s_lshl_b32 s99, s33, 7
  s_add_u32 s99, s99, 0x3d00200
  v_mov_b32 v244, 1
  v_mov_b32 v245, 0
  s_mov_b64 exec, 1
  buffer_atomic_add v244, v245, s[4:7], s99 offen sc0 sc1
  s_mov_b64 exec, -1
L_rq_85:
  s_waitcnt lgkmcnt(0)
  s_add_u32 m0, s53, 100352
  v_mfma_f32_16x16x32_bf16 a[0:3], v[60:63], v[28:31], a[0:3]
  buffer_load_dwordx4 v8, s[12:15], s21 offen  lds
  ds_read_b128 v[44:47], v11 offset:0
  v_mfma_f32_16x16x32_bf16 a[4:7], v[64:67], v[28:31], a[4:7]
  ds_read_b64_tr_b16 v[76:77], v14 offset:24576
  v_mfma_f32_16x16x32_bf16 a[8:11], v[68:71], v[28:31], a[8:11]
  ds_read_b64_tr_b16 v[78:79], v14 offset:25600
  v_mfma_f32_16x16x32_bf16 a[12:15], v[72:75], v[28:31], a[12:15]
  ds_read_b128 v[48:51], v11 offset:2048
  s_add_u32 m0, s52, 101376
  v_mfma_f32_16x16x32_bf16 a[16:19], v[60:63], v[32:35], a[16:19]
  buffer_load_dwordx4 v5, s[8:11], s20 offen  lds
  ds_read_b64_tr_b16 v[80:81], v15 offset:24576
  v_mfma_f32_16x16x32_bf16 a[20:23], v[64:67], v[32:35], a[20:23]
  ds_read_b64_tr_b16 v[82:83], v15 offset:25600
  v_mfma_f32_16x16x32_bf16 a[24:27], v[68:71], v[32:35], a[24:27]
  ds_read_b128 v[52:55], v11 offset:4096
  v_mfma_f32_16x16x32_bf16 a[28:31], v[72:75], v[32:35], a[28:31]
  ds_read_b64_tr_b16 v[84:85], v16 offset:24576
  s_add_u32 m0, s53, 101376
  v_mfma_f32_16x16x32_bf16 a[32:35], v[60:63], v[36:39], a[32:35]
  buffer_load_dwordx4 v9, s[12:15], s21 offen  lds
  ds_read_b64_tr_b16 v[86:87], v16 offset:25600
  v_mfma_f32_16x16x32_bf16 a[36:39], v[64:67], v[36:39], a[36:39]
  ds_read_b128 v[56:59], v11 offset:6144
  v_mfma_f32_16x16x32_bf16 a[40:43], v[68:71], v[36:39], a[40:43]
  ds_read_b64_tr_b16 v[88:89], v17 offset:24576
  v_mfma_f32_16x16x32_bf16 a[44:47], v[72:75], v[36:39], a[44:47]
  ds_read_b64_tr_b16 v[90:91], v17 offset:25600
  s_add_u32 s20, s20, 128
  v_mfma_f32_16x16x32_bf16 a[48:51], v[60:63], v[40:43], a[48:51]
  s_add_u32 s21, s21, s51
  v_mfma_f32_16x16x32_bf16 a[52:55], v[64:67], v[40:43], a[52:55]
  v_mfma_f32_16x16x32_bf16 a[56:59], v[68:71], v[40:43], a[56:59]
  v_mfma_f32_16x16x32_bf16 a[60:63], v[72:75], v[40:43], a[60:63]
  s_waitcnt lgkmcnt(0)
  v_mfma_f32_16x16x32_bf16 a[0:3], v[76:79], v[44:47], a[0:3]
  s_waitcnt vmcnt(16)
  s_barrier
  v_mfma_f32_16x16x32_bf16 a[4:7], v[80:83], v[44:47], a[4:7]
  ds_read_b128 v[28:31], v10 offset:32768
  v_mfma_f32_16x16x32_bf16 a[8:11], v[84:87], v[44:47], a[8:11]
  ds_read_b64_tr_b16 v[60:61], v14 offset:49152
  v_mfma_f32_16x16x32_bf16 a[12:15], v[88:91], v[44:47], a[12:15]
  ds_read_b64_tr_b16 v[62:63], v14 offset:50176
  v_mfma_f32_16x16x32_bf16 a[16:19], v[76:79], v[48:51], a[16:19]
  ds_read_b128 v[32:35], v10 offset:34816
  v_mfma_f32_16x16x32_bf16 a[20:23], v[80:83], v[48:51], a[20:23]
  ds_read_b64_tr_b16 v[64:65], v15 offset:49152
  v_mfma_f32_16x16x32_bf16 a[24:27], v[84:87], v[48:51], a[24:27]
  ds_read_b64_tr_b16 v[66:67], v15 offset:50176
  v_mfma_f32_16x16x32_bf16 a[28:31], v[88:91], v[48:51], a[28:31]
  ds_read_b128 v[36:39], v10 offset:36864
  v_mfma_f32_16x16x32_bf16 a[32:35], v[76:79], v[52:55], a[32:35]
  ds_read_b64_tr_b16 v[68:69], v16 offset:49152
  v_mfma_f32_16x16x32_bf16 a[36:39], v[80:83], v[52:55], a[36:39]
  ds_read_b64_tr_b16 v[70:71], v16 offset:50176
  v_mfma_f32_16x16x32_bf16 a[40:43], v[84:87], v[52:55], a[40:43]
  ds_read_b128 v[40:43], v10 offset:38912
  v_mfma_f32_16x16x32_bf16 a[44:47], v[88:91], v[52:55], a[44:47]
  ds_read_b64_tr_b16 v[72:73], v17 offset:49152
  v_mfma_f32_16x16x32_bf16 a[48:51], v[76:79], v[56:59], a[48:51]
  ds_read_b64_tr_b16 v[74:75], v17 offset:50176
  v_mfma_f32_16x16x32_bf16 a[52:55], v[80:83], v[56:59], a[52:55]
  v_mfma_f32_16x16x32_bf16 a[56:59], v[84:87], v[56:59], a[56:59]
  v_mfma_f32_16x16x32_bf16 a[60:63], v[88:91], v[56:59], a[60:63]
  s_waitcnt lgkmcnt(0)
  v_mfma_f32_16x16x32_bf16 a[0:3], v[60:63], v[28:31], a[0:3]
  ds_read_b128 v[44:47], v11 offset:32768
  v_mfma_f32_16x16x32_bf16 a[4:7], v[64:67], v[28:31], a[4:7]
  ds_read_b64_tr_b16 v[76:77], v14 offset:57344
  v_mfma_f32_16x16x32_bf16 a[8:11], v[68:71], v[28:31], a[8:11]
  ds_read_b64_tr_b16 v[78:79], v14 offset:58368
  v_mfma_f32_16x16x32_bf16 a[12:15], v[72:75], v[28:31], a[12:15]
  ds_read_b128 v[48:51], v11 offset:34816
  v_mfma_f32_16x16x32_bf16 a[16:19], v[60:63], v[32:35], a[16:19]
  ds_read_b64_tr_b16 v[80:81], v15 offset:57344
  v_mfma_f32_16x16x32_bf16 a[20:23], v[64:67], v[32:35], a[20:23]
  ds_read_b64_tr_b16 v[82:83], v15 offset:58368
  v_mfma_f32_16x16x32_bf16 a[24:27], v[68:71], v[32:35], a[24:27]
  ds_read_b128 v[52:55], v11 offset:36864
  v_mfma_f32_16x16x32_bf16 a[28:31], v[72:75], v[32:35], a[28:31]
  ds_read_b64_tr_b16 v[84:85], v16 offset:57344
  v_mfma_f32_16x16x32_bf16 a[32:35], v[60:63], v[36:39], a[32:35]
  ds_read_b64_tr_b16 v[86:87], v16 offset:58368
  v_mfma_f32_16x16x32_bf16 a[36:39], v[64:67], v[36:39], a[36:39]
  ds_read_b128 v[56:59], v11 offset:38912
  v_mfma_f32_16x16x32_bf16 a[40:43], v[68:71], v[36:39], a[40:43]
  ds_read_b64_tr_b16 v[88:89], v17 offset:57344
  v_mfma_f32_16x16x32_bf16 a[44:47], v[72:75], v[36:39], a[44:47]
  ds_read_b64_tr_b16 v[90:91], v17 offset:58368
  v_mfma_f32_16x16x32_bf16 a[48:51], v[60:63], v[40:43], a[48:51]
  v_mfma_f32_16x16x32_bf16 a[52:55], v[64:67], v[40:43], a[52:55]
  v_mfma_f32_16x16x32_bf16 a[56:59], v[68:71], v[40:43], a[56:59]
  v_mfma_f32_16x16x32_bf16 a[60:63], v[72:75], v[40:43], a[60:63]
  s_waitcnt lgkmcnt(0)
  v_mfma_f32_16x16x32_bf16 a[0:3], v[76:79], v[44:47], a[0:3]
  s_waitcnt vmcnt(8)
  s_barrier
  v_mfma_f32_16x16x32_bf16 a[4:7], v[80:83], v[44:47], a[4:7]
  ds_read_b128 v[28:31], v12 offset:0
  v_mfma_f32_16x16x32_bf16 a[8:11], v[84:87], v[44:47], a[8:11]
  ds_read_b64_tr_b16 v[60:61], v18 offset:16384
  v_mfma_f32_16x16x32_bf16 a[12:15], v[88:91], v[44:47], a[12:15]
  ds_read_b64_tr_b16 v[62:63], v18 offset:17408
  v_mfma_f32_16x16x32_bf16 a[16:19], v[76:79], v[48:51], a[16:19]
  ds_read_b128 v[32:35], v12 offset:2048
  v_mfma_f32_16x16x32_bf16 a[20:23], v[80:83], v[48:51], a[20:23]
  ds_read_b64_tr_b16 v[64:65], v19 offset:16384
  v_mfma_f32_16x16x32_bf16 a[24:27], v[84:87], v[48:51], a[24:27]
  ds_read_b64_tr_b16 v[66:67], v19 offset:17408
  v_mfma_f32_16x16x32_bf16 a[28:31], v[88:91], v[48:51], a[28:31]
  ds_read_b128 v[36:39], v12 offset:4096
  v_mfma_f32_16x16x32_bf16 a[32:35], v[76:79], v[52:55], a[32:35]
  ds_read_b64_tr_b16 v[68:69], v20 offset:16384
  v_mfma_f32_16x16x32_bf16 a[36:39], v[80:83], v[52:55], a[36:39]
  ds_read_b64_tr_b16 v[70:71], v20 offset:17408
  v_mfma_f32_16x16x32_bf16 a[40:43], v[84:87], v[52:55], a[40:43]
  ds_read_b128 v[40:43], v12 offset:6144
  v_mfma_f32_16x16x32_bf16 a[44:47], v[88:91], v[52:55], a[44:47]
  ds_read_b64_tr_b16 v[72:73], v21 offset:16384
  v_mfma_f32_16x16x32_bf16 a[48:51], v[76:79], v[56:59], a[48:51]
  ds_read_b64_tr_b16 v[74:75], v21 offset:17408
  v_mfma_f32_16x16x32_bf16 a[52:55], v[80:83], v[56:59], a[52:55]
  v_mfma_f32_16x16x32_bf16 a[56:59], v[84:87], v[56:59], a[56:59]
  v_mfma_f32_16x16x32_bf16 a[60:63], v[88:91], v[56:59], a[60:63]
  s_waitcnt lgkmcnt(0)
  v_mfma_f32_16x16x32_bf16 a[0:3], v[60:63], v[28:31], a[0:3]
  ds_read_b128 v[44:47], v13 offset:0
  v_mfma_f32_16x16x32_bf16 a[4:7], v[64:67], v[28:31], a[4:7]
  ds_read_b64_tr_b16 v[76:77], v18 offset:24576
  v_mfma_f32_16x16x32_bf16 a[8:11], v[68:71], v[28:31], a[8:11]
  ds_read_b64_tr_b16 v[78:79], v18 offset:25600
  v_mfma_f32_16x16x32_bf16 a[12:15], v[72:75], v[28:31], a[12:15]
  ds_read_b128 v[48:51], v13 offset:2048
  v_mfma_f32_16x16x32_bf16 a[16:19], v[60:63], v[32:35], a[16:19]
  ds_read_b64_tr_b16 v[80:81], v19 offset:24576
  v_mfma_f32_16x16x32_bf16 a[20:23], v[64:67], v[32:35], a[20:23]
  ds_read_b64_tr_b16 v[82:83], v19 offset:25600
  v_mfma_f32_16x16x32_bf16 a[24:27], v[68:71], v[32:35], a[24:27]
  ds_read_b128 v[52:55], v13 offset:4096
  v_mfma_f32_16x16x32_bf16 a[28:31], v[72:75], v[32:35], a[28:31]
  ds_read_b64_tr_b16 v[84:85], v20 offset:24576
  v_mfma_f32_16x16x32_bf16 a[32:35], v[60:63], v[36:39], a[32:35]
  ds_read_b64_tr_b16 v[86:87], v20 offset:25600
  v_mfma_f32_16x16x32_bf16 a[36:39], v[64:67], v[36:39], a[36:39]
  ds_read_b128 v[56:59], v13 offset:6144
  v_mfma_f32_16x16x32_bf16 a[40:43], v[68:71], v[36:39], a[40:43]
  ds_read_b64_tr_b16 v[88:89], v21 offset:24576
  v_mfma_f32_16x16x32_bf16 a[44:47], v[72:75], v[36:39], a[44:47]
  ds_read_b64_tr_b16 v[90:91], v21 offset:25600
  v_mfma_f32_16x16x32_bf16 a[48:51], v[60:63], v[40:43], a[48:51]
  v_mfma_f32_16x16x32_bf16 a[52:55], v[64:67], v[40:43], a[52:55]
  v_mfma_f32_16x16x32_bf16 a[56:59], v[68:71], v[40:43], a[56:59]
  v_mfma_f32_16x16x32_bf16 a[60:63], v[72:75], v[40:43], a[60:63]
  s_waitcnt lgkmcnt(0)
  v_mfma_f32_16x16x32_bf16 a[0:3], v[76:79], v[44:47], a[0:3]
  s_waitcnt vmcnt(0)
  s_barrier
  v_mfma_f32_16x16x32_bf16 a[4:7], v[80:83], v[44:47], a[4:7]
  ds_read_b128 v[28:31], v12 offset:32768
  v_mfma_f32_16x16x32_bf16 a[8:11], v[84:87], v[44:47], a[8:11]
  ds_read_b64_tr_b16 v[60:61], v18 offset:49152
  v_mfma_f32_16x16x32_bf16 a[12:15], v[88:91], v[44:47], a[12:15]
  ds_read_b64_tr_b16 v[62:63], v18 offset:50176
  v_mfma_f32_16x16x32_bf16 a[16:19], v[76:79], v[48:51], a[16:19]
  ds_read_b128 v[32:35], v12 offset:34816
  v_mfma_f32_16x16x32_bf16 a[20:23], v[80:83], v[48:51], a[20:23]
  ds_read_b64_tr_b16 v[64:65], v19 offset:49152
  v_mfma_f32_16x16x32_bf16 a[24:27], v[84:87], v[48:51], a[24:27]
  ds_read_b64_tr_b16 v[66:67], v19 offset:50176
  v_mfma_f32_16x16x32_bf16 a[28:31], v[88:91], v[48:51], a[28:31]
  ds_read_b128 v[36:39], v12 offset:36864
  v_mfma_f32_16x16x32_bf16 a[32:35], v[76:79], v[52:55], a[32:35]
  ds_read_b64_tr_b16 v[68:69], v20 offset:49152
  v_mfma_f32_16x16x32_bf16 a[36:39], v[80:83], v[52:55], a[36:39]
  ds_read_b64_tr_b16 v[70:71], v20 offset:50176
  v_mfma_f32_16x16x32_bf16 a[40:43], v[84:87], v[52:55], a[40:43]
  ds_read_b128 v[40:43], v12 offset:38912
  v_mfma_f32_16x16x32_bf16 a[44:47], v[88:91], v[52:55], a[44:47]
  ds_read_b64_tr_b16 v[72:73], v21 offset:49152
  v_mfma_f32_16x16x32_bf16 a[48:51], v[76:79], v[56:59], a[48:51]
  ds_read_b64_tr_b16 v[74:75], v21 offset:50176
  v_mfma_f32_16x16x32_bf16 a[52:55], v[80:83], v[56:59], a[52:55]
  v_mfma_f32_16x16x32_bf16 a[56:59], v[84:87], v[56:59], a[56:59]
  v_mfma_f32_16x16x32_bf16 a[60:63], v[88:91], v[56:59], a[60:63]
  s_waitcnt lgkmcnt(0)
  v_mfma_f32_16x16x32_bf16 a[0:3], v[60:63], v[28:31], a[0:3]
  ds_read_b128 v[44:47], v13 offset:32768
  v_mfma_f32_16x16x32_bf16 a[4:7], v[64:67], v[28:31], a[4:7]
  ds_read_b64_tr_b16 v[76:77], v18 offset:57344
  v_mfma_f32_16x16x32_bf16 a[8:11], v[68:71], v[28:31], a[8:11]
  ds_read_b64_tr_b16 v[78:79], v18 offset:58368
  v_mfma_f32_16x16x32_bf16 a[12:15], v[72:75], v[28:31], a[12:15]
  ds_read_b128 v[48:51], v13 offset:34816
  v_mfma_f32_16x16x32_bf16 a[16:19], v[60:63], v[32:35], a[16:19]
  ds_read_b64_tr_b16 v[80:81], v19 offset:57344
  v_mfma_f32_16x16x32_bf16 a[20:23], v[64:67], v[32:35], a[20:23]
  ds_read_b64_tr_b16 v[82:83], v19 offset:58368
  v_mfma_f32_16x16x32_bf16 a[24:27], v[68:71], v[32:35], a[24:27]
  ds_read_b128 v[52:55], v13 offset:36864
  v_mfma_f32_16x16x32_bf16 a[28:31], v[72:75], v[32:35], a[28:31]
  ds_read_b64_tr_b16 v[84:85], v20 offset:57344
  v_mfma_f32_16x16x32_bf16 a[32:35], v[60:63], v[36:39], a[32:35]
  ds_read_b64_tr_b16 v[86:87], v20 offset:58368
  v_mfma_f32_16x16x32_bf16 a[36:39], v[64:67], v[36:39], a[36:39]
  ds_read_b128 v[56:59], v13 offset:38912
  v_mfma_f32_16x16x32_bf16 a[40:43], v[68:71], v[36:39], a[40:43]
  ds_read_b64_tr_b16 v[88:89], v21 offset:57344
  v_mfma_f32_16x16x32_bf16 a[44:47], v[72:75], v[36:39], a[44:47]
  ds_read_b64_tr_b16 v[90:91], v21 offset:58368
  v_mfma_f32_16x16x32_bf16 a[48:51], v[60:63], v[40:43], a[48:51]
  v_mfma_f32_16x16x32_bf16 a[52:55], v[64:67], v[40:43], a[52:55]
  v_mfma_f32_16x16x32_bf16 a[56:59], v[68:71], v[40:43], a[56:59]
  v_mfma_f32_16x16x32_bf16 a[60:63], v[72:75], v[40:43], a[60:63]
  s_waitcnt lgkmcnt(0)
  v_mfma_f32_16x16x32_bf16 a[0:3], v[76:79], v[44:47], a[0:3]
  v_mfma_f32_16x16x32_bf16 a[4:7], v[80:83], v[44:47], a[4:7]
  v_mfma_f32_16x16x32_bf16 a[8:11], v[84:87], v[44:47], a[8:11]
  v_mfma_f32_16x16x32_bf16 a[12:15], v[88:91], v[44:47], a[12:15]
  v_mfma_f32_16x16x32_bf16 a[16:19], v[76:79], v[48:51], a[16:19]
  v_mfma_f32_16x16x32_bf16 a[20:23], v[80:83], v[48:51], a[20:23]
  v_mfma_f32_16x16x32_bf16 a[24:27], v[84:87], v[48:51], a[24:27]
  v_mfma_f32_16x16x32_bf16 a[28:31], v[88:91], v[48:51], a[28:31]
  v_mfma_f32_16x16x32_bf16 a[32:35], v[76:79], v[52:55], a[32:35]
  v_mfma_f32_16x16x32_bf16 a[36:39], v[80:83], v[52:55], a[36:39]
  v_mfma_f32_16x16x32_bf16 a[40:43], v[84:87], v[52:55], a[40:43]
  v_mfma_f32_16x16x32_bf16 a[44:47], v[88:91], v[52:55], a[44:47]
  v_mfma_f32_16x16x32_bf16 a[48:51], v[76:79], v[56:59], a[48:51]
  v_mfma_f32_16x16x32_bf16 a[52:55], v[80:83], v[56:59], a[52:55]
  v_mfma_f32_16x16x32_bf16 a[56:59], v[84:87], v[56:59], a[56:59]
  v_mfma_f32_16x16x32_bf16 a[60:63], v[88:91], v[56:59], a[60:63]
  s_mov_b32 s59, 3
  s_mov_b32 s60, s22
  s_mov_b32 s61, s26
  s_add_u32 s62, s38, 0x3d00000
  s_mov_b32 s63, s98
  s_cmp_lg_u32 s39, 0
  s_cbranch_scc1 L_got
  s_mov_b32 s58, 3
  s_branch L_epi
L_g5:
  s_waitcnt vmcnt(26)
  s_barrier
  ds_read_b128 v[28:31], v10 offset:0
  ds_read_b64_tr_b16 v[60:61], v14 offset:16384
  ds_read_b64_tr_b16 v[62:63], v14 offset:17408
  ds_read_b128 v[32:35], v10 offset:2048
  ds_read_b64_tr_b16 v[64:65], v15 offset:16384
  ds_read_b64_tr_b16 v[66:67], v15 offset:17408
  ds_read_b128 v[36:39], v10 offset:4096
  ds_read_b64_tr_b16 v[68:69], v16 offset:16384
  ds_read_b64_tr_b16 v[70:71], v16 offset:17408
  ds_read_b128 v[40:43], v10 offset:6144
  ds_read_b64_tr_b16 v[72:73], v17 offset:16384
  ds_read_b64_tr_b16 v[74:75], v17 offset:17408
  s_sub_u32 s25, s25, 1
  s_waitcnt lgkmcnt(0)
  v_mfma_f32_16x16x32_bf16 a[0:3], v[28:31], v[60:63], 0
  ds_read_b128 v[44:47], v11 offset:0
  v_mfma_f32_16x16x32_bf16 a[4:7], v[28:31], v[64:67], 0
  ds_read_b64_tr_b16 v[76:77], v14 offset:24576
  v_mfma_f32_16x16x32_bf16 a[8:11], v[28:31], v[68:71], 0
  ds_read_b64_tr_b16 v[78:79], v14 offset:25600
  v_mfma_f32_16x16x32_bf16 a[12:15], v[28:31], v[72:75], 0
  ds_read_b128 v[48:51], v11 offset:2048
  v_mfma_f32_16x16x32_bf16 a[16:19], v[32:35], v[60:63], 0
  ds_read_b64_tr_b16 v[80:81], v15 offset:24576
  v_mfma_f32_16x16x32_bf16 a[20:23], v[32:35], v[64:67], 0
  ds_read_b64_tr_b16 v[82:83], v15 offset:25600
  v_mfma_f32_16x16x32_bf16 a[24:27], v[32:35], v[68:71], 0
  ds_read_b128 v[52:55], v11 offset:4096
  v_mfma_f32_16x16x32_bf16 a[28:31], v[32:35], v[72:75], 0
  ds_read_b64_tr_b16 v[84:85], v16 offset:24576
  v_mfma_f32_16x16x32_bf16 a[32:35], v[36:39], v[60:63], 0
  ds_read_b64_tr_b16 v[86:87], v16 offset:25600
  v_mfma_f32_16x16x32_bf16 a[36:39], v[36:39], v[64:67], 0
  ds_read_b128 v[56:59], v11 offset:6144
  v_mfma_f32_16x16x32_bf16 a[40:43], v[36:39], v[68:71], 0
  ds_read_b64_tr_b16 v[88:89], v17 offset:24576
  v_mfma_f32_16x16x32_bf16 a[44:47], v[36:39], v[72:75], 0
  ds_read_b64_tr_b16 v[90:91], v17 offset:25600
  v_mfma_f32_16x16x32_bf16 a[48:51], v[40:43], v[60:63], 0
  v_mfma_f32_16x16x32_bf16 a[52:55], v[40:43], v[64:67], 0
  v_mfma_f32_16x16x32_bf16 a[56:59], v[40:43], v[68:71], 0
  v_mfma_f32_16x16x32_bf16 a[60:63], v[40:43], v[72:75], 0
  s_waitcnt lgkmcnt(0)
  v_mfma_f32_16x16x32_bf16 a[0:3], v[44:47], v[76:79], a[0:3]
  s_waitcnt vmcnt(18)
  s_barrier
  s_add_u32 m0, s52, 0
  v_mfma_f32_16x16x32_bf16 a[4:7], v[44:47], v[80:83], a[4:7]
  buffer_load_dwordx4 v2, s[8:11], s20 offen  lds
  ds_read_b128 v[28:31], v10 offset:32768
  v_mfma_f32_16x16x32_bf16 a[8:11], v[44:47], v[84:87], a[8:11]
  ds_read_b64_tr_b16 v[60:61], v14 offset:49152
  v_mfma_f32_16x16x32_bf16 a[12:15], v[44:47], v[88:91], a[12:15]
  ds_read_b64_tr_b16 v[62:63], v14 offset:50176
  s_add_u32 m0, s53, 0
  v_mfma_f32_16x16x32_bf16 a[16:19], v[48:51], v[76:79], a[16:19]
  buffer_load_dwordx4 v6, s[12:15], s21 offen  lds
  ds_read_b128 v[32:35], v10 offset:34816
  v_mfma_f32_16x16x32_bf16 a[20:23], v[48:51], v[80:83], a[20:23]
  ds_read_b64_tr_b16 v[64:65], v15 offset:49152
  v_mfma_f32_16x16x32_bf16 a[24:27], v[48:51], v[84:87], a[24:27]
  ds_read_b64_tr_b16 v[66:67], v15 offset:50176
  s_add_u32 m0, s52, 1024
  v_mfma_f32_16x16x32_bf16 a[28:31], v[48:51], v[88:91], a[28:31]
  buffer_load_dwordx4 v3, s[8:11], s20 offen  lds
  ds_read_b128 v[36:39], v10 offset:36864
  v_mfma_f32_16x16x32_bf16 a[32:35], v[52:55], v[76:79], a[32:35]
  ds_read_b64_tr_b16 v[68:69], v16 offset:49152
  v_mfma_f32_16x16x32_bf16 a[36:39], v[52:55], v[80:83], a[36:39]
  ds_read_b64_tr_b16 v[70:71], v16 offset:50176
  s_add_u32 m0, s53, 1024
  v_mfma_f32_16x16x32_bf16 a[40:43], v[52:55], v[84:87], a[40:43]
  buffer_load_dwordx4 v7, s[12:15], s21 offen  lds
  ds_read_b128 v[40:43], v10 offset:38912
  v_mfma_f32_16x16x32_bf16 a[44:47], v[52:55], v[88:91], a[44:47]
  ds_read_b64_tr_b16 v[72:73], v17 offset:49152
  v_mfma_f32_16x16x32_bf16 a[48:51], v[56:59], v[76:79], a[48:51]
  ds_read_b64_tr_b16 v[74:75], v17 offset:50176
  s_add_u32 m0, s52, 2048
  v_mfma_f32_16x16x32_bf16 a[52:55], v[56:59], v[80:83], a[52:55]
  buffer_load_dwordx4 v4, s[8:11], s20 offen  lds
  v_mfma_f32_16x16x32_bf16 a[56:59], v[56:59], v[84:87], a[56:59]
  v_mfma_f32_16x16x32_bf16 a[60:63], v[56:59], v[88:91], a[60:63]
  s_waitcnt lgkmcnt(0)
  s_add_u32 m0, s53, 2048
  v_mfma_f32_16x16x32_bf16 a[0:3], v[28:31], v[60:63], a[0:3]
  buffer_load_dwordx4 v8, s[12:15], s21 offen  lds
  ds_read_b128 v[44:47], v11 offset:32768
  v_mfma_f32_16x16x32_bf16 a[4:7], v[28:31], v[64:67], a[4:7]
  ds_read_b64_tr_b16 v[76:77], v14 offset:57344
  v_mfma_f32_16x16x32_bf16 a[8:11], v[28:31], v[68:71], a[8:11]
  ds_read_b64_tr_b16 v[78:79], v14 offset:58368
  v_mfma_f32_16x16x32_bf16 a[12:15], v[28:31], v[72:75], a[12:15]
  ds_read_b128 v[48:51], v11 offset:34816
  s_add_u32 m0, s52, 3072
  v_mfma_f32_16x16x32_bf16 a[16:19], v[32:35], v[60:63], a[16:19]
  buffer_load_dwordx4 v5, s[8:11], s20 offen  lds
  ds_read_b64_tr_b16 v[80:81], v15 offset:57344
  v_mfma_f32_16x16x32_bf16 a[20:23], v[32:35], v[64:67], a[20:23]
  ds_read_b64_tr_b16 v[82:83], v15 offset:58368
  v_mfma_f32_16x16x32_bf16 a[24:27], v[32:35], v[68:71], a[24:27]
  ds_read_b128 v[52:55], v11 offset:36864
  v_mfma_f32_16x16x32_bf16 a[28:31], v[32:35], v[72:75], a[28:31]
  ds_read_b64_tr_b16 v[84:85], v16 offset:57344
  s_add_u32 m0, s53, 3072
  v_mfma_f32_16x16x32_bf16 a[32:35], v[36:39], v[60:63], a[32:35]
  buffer_load_dwordx4 v9, s[12:15], s21 offen  lds
  ds_read_b64_tr_b16 v[86:87], v16 offset:58368
  v_mfma_f32_16x16x32_bf16 a[36:39], v[36:39], v[64:67], a[36:39]
  ds_read_b128 v[56:59], v11 offset:38912
  v_mfma_f32_16x16x32_bf16 a[40:43], v[36:39], v[68:71], a[40:43]
  ds_read_b64_tr_b16 v[88:89], v17 offset:57344
  v_mfma_f32_16x16x32_bf16 a[44:47], v[36:39], v[72:75], a[44:47]
  ds_read_b64_tr_b16 v[90:91], v17 offset:58368
  s_add_u32 s20, s20, 128
  v_mfma_f32_16x16x32_bf16 a[48:51], v[40:43], v[60:63], a[48:51]
  s_add_u32 s21, s21, s51
  v_mfma_f32_16x16x32_bf16 a[52:55], v[40:43], v[64:67], a[52:55]
  v_mfma_f32_16x16x32_bf16 a[56:59], v[40:43], v[68:71], a[56:59]
  v_mfma_f32_16x16x32_bf16 a[60:63], v[40:43], v[72:75], a[60:63]
  s_waitcnt lgkmcnt(0)
  v_mfma_f32_16x16x32_bf16 a[0:3], v[44:47], v[76:79], a[0:3]
  s_waitcnt vmcnt(18)
  s_barrier
  s_add_u32 m0, s52, 32768
  v_mfma_f32_16x16x32_bf16 a[4:7], v[44:47], v[80:83], a[4:7]
  buffer_load_dwordx4 v2, s[8:11], s20 offen  lds
  ds_read_b128 v[28:31], v12 offset:0
  v_mfma_f32_16x16x32_bf16 a[8:11], v[44:47], v[84:87], a[8:11]
  ds_read_b64_tr_b16 v[60:61], v18 offset:16384
  v_mfma_f32_16x16x32_bf16 a[12:15], v[44:47], v[88:91], a[12:15]
  ds_read_b64_tr_b16 v[62:63], v18 offset:17408
  s_add_u32 m0, s53, 32768
  v_mfma_f32_16x16x32_bf16 a[16:19], v[48:51], v[76:79], a[16:19]
  buffer_load_dwordx4 v6, s[12:15], s21 offen  lds
  ds_read_b128 v[32:35], v12 offset:2048
  v_mfma_f32_16x16x32_bf16 a[20:23], v[48:51], v[80:83], a[20:23]
  ds_read_b64_tr_b16 v[64:65], v19 offset:16384
  v_mfma_f32_16x16x32_bf16 a[24:27], v[48:51], v[84:87], a[24:27]
  ds_read_b64_tr_b16 v[66:67], v19 offset:17408
  s_add_u32 m0, s52, 33792
  v_mfma_f32_16x16x32_bf16 a[28:31], v[48:51], v[88:91], a[28:31]
  buffer_load_dwordx4 v3, s[8:11], s20 offen  lds
  ds_read_b128 v[36:39], v12 offset:4096
  v_mfma_f32_16x16x32_bf16 a[32:35], v[52:55], v[76:79], a[32:35]
  ds_read_b64_tr_b16 v[68:69], v20 offset:16384
  v_mfma_f32_16x16x32_bf16 a[36:39], v[52:55], v[80:83], a[36:39]
  ds_read_b64_tr_b16 v[70:71], v20 offset:17408
  s_add_u32 m0, s53, 33792
  v_mfma_f32_16x16x32_bf16 a[40:43], v[52:55], v[84:87], a[40:43]
  buffer_load_dwordx4 v7, s[12:15], s21 offen  lds
  ds_read_b128 v[40:43], v12 offset:6144
  v_mfma_f32_16x16x32_bf16 a[44:47], v[52:55], v[88:91], a[44:47]
  ds_read_b64_tr_b16 v[72:73], v21 offset:16384
  v_mfma_f32_16x16x32_bf16 a[48:51], v[56:59], v[76:79], a[48:51]
  ds_read_b64_tr_b16 v[74:75], v21 offset:17408
  s_add_u32 m0, s52, 34816
  v_mfma_f32_16x16x32_bf16 a[52:55], v[56:59], v[80:83], a[52:55]
  buffer_load_dwordx4 v4, s[8:11], s20 offen  lds
  v_mfma_f32_16x16x32_bf16 a[56:59], v[56:59], v[84:87], a[56:59]
  v_mfma_f32_16x16x32_bf16 a[60:63], v[56:59], v[88:91], a[60:63]
  s_waitcnt lgkmcnt(0)
  s_add_u32 m0, s53, 34816
  v_mfma_f32_16x16x32_bf16 a[0:3], v[28:31], v[60:63], a[0:3]
  buffer_load_dwordx4 v8, s[12:15], s21 offen  lds
  ds_read_b128 v[44:47], v13 offset:0
  v_mfma_f32_16x16x32_bf16 a[4:7], v[28:31], v[64:67], a[4:7]
  ds_read_b64_tr_b16 v[76:77], v18 offset:24576
  v_mfma_f32_16x16x32_bf16 a[8:11], v[28:31], v[68:71], a[8:11]
  ds_read_b64_tr_b16 v[78:79], v18 offset:25600
  v_mfma_f32_16x16x32_bf16 a[12:15], v[28:31], v[72:75], a[12:15]
  ds_read_b128 v[48:51], v13 offset:2048
  s_add_u32 m0, s52, 35840
  v_mfma_f32_16x16x32_bf16 a[16:19], v[32:35], v[60:63], a[16:19]
  buffer_load_dwordx4 v5, s[8:11], s20 offen  lds
  ds_read_b64_tr_b16 v[80:81], v19 offset:24576
  v_mfma_f32_16x16x32_bf16 a[20:23], v[32:35], v[64:67], a[20:23]
  ds_read_b64_tr_b16 v[82:83], v19 offset:25600
  v_mfma_f32_16x16x32_bf16 a[24:27], v[32:35], v[68:71], a[24:27]
  ds_read_b128 v[52:55], v13 offset:4096
  v_mfma_f32_16x16x32_bf16 a[28:31], v[32:35], v[72:75], a[28:31]
  ds_read_b64_tr_b16 v[84:85], v20 offset:24576
  s_add_u32 m0, s53, 35840
  v_mfma_f32_16x16x32_bf16 a[32:35], v[36:39], v[60:63], a[32:35]
  buffer_load_dwordx4 v9, s[12:15], s21 offen  lds
  ds_read_b64_tr_b16 v[86:87], v20 offset:25600
  v_mfma_f32_16x16x32_bf16 a[36:39], v[36:39], v[64:67], a[36:39]
  ds_read_b128 v[56:59], v13 offset:6144
  v_mfma_f32_16x16x32_bf16 a[40:43], v[36:39], v[68:71], a[40:43]
  ds_read_b64_tr_b16 v[88:89], v21 offset:24576
  v_mfma_f32_16x16x32_bf16 a[44:47], v[36:39], v[72:75], a[44:47]
  ds_read_b64_tr_b16 v[90:91], v21 offset:25600
  s_add_u32 s20, s20, 128
  v_mfma_f32_16x16x32_bf16 a[48:51], v[40:43], v[60:63], a[48:51]
  s_add_u32 s21, s21, s51
  v_mfma_f32_16x16x32_bf16 a[52:55], v[40:43], v[64:67], a[52:55]
  v_mfma_f32_16x16x32_bf16 a[56:59], v[40:43], v[68:71], a[56:59]
  v_mfma_f32_16x16x32_bf16 a[60:63], v[40:43], v[72:75], a[60:63]
  s_waitcnt lgkmcnt(0)
  v_mfma_f32_16x16x32_bf16 a[0:3], v[44:47], v[76:79], a[0:3]
  s_waitcnt vmcnt(18)
  s_barrier
  s_add_u32 m0, s52, 65536
  v_mfma_f32_16x16x32_bf16 a[4:7], v[44:47], v[80:83], a[4:7]
  buffer_load_dwordx4 v2, s[8:11], s20 offen  lds
  ds_read_b128 v[28:31], v12 offset:32768
  v_mfma_f32_16x16x32_bf16 a[8:11], v[44:47], v[84:87], a[8:11]
  ds_read_b64_tr_b16 v[60:61], v18 offset:49152
  v_mfma_f32_16x16x32_bf16 a[12:15], v[44:47], v[88:91], a[12:15]
  ds_read_b64_tr_b16 v[62:63], v18 offset:50176
  s_add_u32 m0, s53, 65536
  v_mfma_f32_16x16x32_bf16 a[16:19], v[48:51], v[76:79], a[16:19]
  buffer_load_dwordx4 v6, s[12:15], s21 offen  lds
  ds_read_b128 v[32:35], v12 offset:34816
  v_mfma_f32_16x16x32_bf16 a[20:23], v[48:51], v[80:83], a[20:23]
  ds_read_b64_tr_b16 v[64:65], v19 offset:49152
  v_mfma_f32_16x16x32_bf16 a[24:27], v[48:51], v[84:87], a[24:27]
  ds_read_b64_tr_b16 v[66:67], v19 offset:50176
  s_add_u32 m0, s52, 66560
  v_mfma_f32_16x16x32_bf16 a[28:31], v[48:51], v[88:91], a[28:31]
  buffer_load_dwordx4 v3, s[8:11], s20 offen  lds
  ds_read_b128 v[36:39], v12 offset:36864
  v_mfma_f32_16x16x32_bf16 a[32:35], v[52:55], v[76:79], a[32:35]
  ds_read_b64_tr_b16 v[68:69], v20 offset:49152
  v_mfma_f32_16x16x32_bf16 a[36:39], v[52:55], v[80:83], a[36:39]
  ds_read_b64_tr_b16 v[70:71], v20 offset:50176
  s_add_u32 m0, s53, 66560
  v_mfma_f32_16x16x32_bf16 a[40:43], v[52:55], v[84:87], a[40:43]
  buffer_load_dwordx4 v7, s[12:15], s21 offen  lds
  ds_read_b128 v[40:43], v12 offset:38912
  v_mfma_f32_16x16x32_bf16 a[44:47], v[52:55], v[88:91], a[44:47]
  ds_read_b64_tr_b16 v[72:73], v21 offset:49152
  v_mfma_f32_16x16x32_bf16 a[48:51], v[56:59], v[76:79], a[48:51]
  ds_read_b64_tr_b16 v[74:75], v21 offset:50176
  s_add_u32 m0, s52, 67584
  v_mfma_f32_16x16x32_bf16 a[52:55], v[56:59], v[80:83], a[52:55]
  buffer_load_dwordx4 v4, s[8:11], s20 offen  lds
  v_mfma_f32_16x16x32_bf16 a[56:59], v[56:59], v[84:87], a[56:59]
  v_mfma_f32_16x16x32_bf16 a[60:63], v[56:59], v[88:91], a[60:63]
  s_waitcnt lgkmcnt(0)
  s_add_u32 m0, s53, 67584
  v_mfma_f32_16x16x32_bf16 a[0:3], v[28:31], v[60:63], a[0:3]
  buffer_load_dwordx4 v8, s[12:15], s21 offen  lds
  ds_read_b128 v[44:47], v13 offset:32768
  v_mfma_f32_16x16x32_bf16 a[4:7], v[28:31], v[64:67], a[4:7]
  ds_read_b64_tr_b16 v[76:77], v18 offset:57344
  v_mfma_f32_16x16x32_bf16 a[8:11], v[28:31], v[68:71], a[8:11]
  ds_read_b64_tr_b16 v[78:79], v18 offset:58368
  v_mfma_f32_16x16x32_bf16 a[12:15], v[28:31], v[72:75], a[12:15]
  ds_read_b128 v[48:51], v13 offset:34816
  s_add_u32 m0, s52, 68608
  v_mfma_f32_16x16x32_bf16 a[16:19], v[32:35], v[60:63], a[16:19]
  buffer_load_dwordx4 v5, s[8:11], s20 offen  lds
  ds_read_b64_tr_b16 v[80:81], v19 offset:57344
  v_mfma_f32_16x16x32_bf16 a[20:23], v[32:35], v[64:67], a[20:23]
  ds_read_b64_tr_b16 v[82:83], v19 offset:58368
  v_mfma_f32_16x16x32_bf16 a[24:27], v[32:35], v[68:71], a[24:27]
  ds_read_b128 v[52:55], v13 offset:36864
  v_mfma_f32_16x16x32_bf16 a[28:31], v[32:35], v[72:75], a[28:31]
  ds_read_b64_tr_b16 v[84:85], v20 offset:57344
  s_add_u32 m0, s53, 68608
  v_mfma_f32_16x16x32_bf16 a[32:35], v[36:39], v[60:63], a[32:35]
  buffer_load_dwordx4 v9, s[12:15], s21 offen  lds
  ds_read_b64_tr_b16 v[86:87], v20 offset:58368
  v_mfma_f32_16x16x32_bf16 a[36:39], v[36:39], v[64:67], a[36:39]
  ds_read_b128 v[56:59], v13 offset:38912
  v_mfma_f32_16x16x32_bf16 a[40:43], v[36:39], v[68:71], a[40:43]
  ds_read_b64_tr_b16 v[88:89], v21 offset:57344
  v_mfma_f32_16x16x32_bf16 a[44:47], v[36:39], v[72:75], a[44:47]
  ds_read_b64_tr_b16 v[90:91], v21 offset:58368
  s_add_u32 s20, s20, 128
  v_mfma_f32_16x16x32_bf16 a[48:51], v[40:43], v[60:63], a[48:51]
  s_add_u32 s21, s21, s51
  v_mfma_f32_16x16x32_bf16 a[52:55], v[40:43], v[64:67], a[52:55]
  v_mfma_f32_16x16x32_bf16 a[56:59], v[40:43], v[68:71], a[56:59]
  v_mfma_f32_16x16x32_bf16 a[60:63], v[40:43], v[72:75], a[60:63]
  s_waitcnt lgkmcnt(0)
  v_mfma_f32_16x16x32_bf16 a[0:3], v[44:47], v[76:79], a[0:3]
  s_waitcnt vmcnt(16)
  s_barrier
  s_add_u32 m0, s52, 98304
  v_mfma_f32_16x16x32_bf16 a[4:7], v[44:47], v[80:83], a[4:7]
  buffer_load_dwordx4 v2, s[8:11], s20 offen  lds
  ds_read_b128 v[28:31], v10 offset:0
  v_mfma_f32_16x16x32_bf16 a[8:11], v[44:47], v[84:87], a[8:11]
  ds_read_b64_tr_b16 v[60:61], v14 offset:16384
  v_mfma_f32_16x16x32_bf16 a[12:15], v[44:47], v[88:91], a[12:15]
  ds_read_b64_tr_b16 v[62:63], v14 offset:17408
  s_add_u32 m0, s53, 98304
  v_mfma_f32_16x16x32_bf16 a[16:19], v[48:51], v[76:79], a[16:19]
  buffer_load_dwordx4 v6, s[12:15], s21 offen  lds
  ds_read_b128 v[32:35], v10 offset:2048
  v_mfma_f32_16x16x32_bf16 a[20:23], v[48:51], v[80:83], a[20:23]
  ds_read_b64_tr_b16 v[64:65], v15 offset:16384
  v_mfma_f32_16x16x32_bf16 a[24:27], v[48:51], v[84:87], a[24:27]
  ds_read_b64_tr_b16 v[66:67], v15 offset:17408
  s_add_u32 m0, s52, 99328
  v_mfma_f32_16x16x32_bf16 a[28:31], v[48:51], v[88:91], a[28:31]
  buffer_load_dwordx4 v3, s[8:11], s20 offen  lds
  ds_read_b128 v[36:39], v10 offset:4096
  v_mfma_f32_16x16x32_bf16 a[32:35], v[52:55], v[76:79], a[32:35]
  ds_read_b64_tr_b16 v[68:69], v16 offset:16384
  v_mfma_f32_16x16x32_bf16 a[36:39], v[52:55], v[80:83], a[36:39]
  ds_read_b64_tr_b16 v[70:71], v16 offset:17408
  s_add_u32 m0, s53, 99328
  v_mfma_f32_16x16x32_bf16 a[40:43], v[52:55], v[84:87], a[40:43]
  buffer_load_dwordx4 v7, s[12:15], s21 offen  lds
  ds_read_b128 v[40:43], v10 offset:6144
  v_mfma_f32_16x16x32_bf16 a[44:47], v[52:55], v[88:91], a[44:47]
  ds_read_b64_tr_b16 v[72:73], v17 offset:16384
  v_mfma_f32_16x16x32_bf16 a[48:51], v[56:59], v[76:79], a[48:51]
  ds_read_b64_tr_b16 v[74:75], v17 offset:17408
  s_add_u32 m0, s52, 100352
  v_mfma_f32_16x16x32_bf16 a[52:55], v[56:59], v[80:83], a[52:55]
  buffer_load_dwordx4 v4, s[8:11], s20 offen  lds
  v_mfma_f32_16x16x32_bf16 a[56:59], v[56:59], v[84:87], a[56:59]
  v_mfma_f32_16x16x32_bf16 a[60:63], v[56:59], v[88:91], a[60:63]
L_g5_loop:
  s_sub_u32 s25, s25, 1
  s_cmp_eq_u32 s25, 0
  s_cbranch_scc1 L_g5_fin
  s_waitcnt lgkmcnt(0)
  s_add_u32 m0, s53, 100352
  v_mfma_f32_16x16x32_bf16 a[0:3], v[28:31], v[60:63], a[0:3]
  buffer_load_dwordx4 v8, s[12:15], s21 offen  lds
  ds_read_b128 v[44:47], v11 offset:0
  v_mfma_f32_16x16x32_bf16 a[4:7], v[28:31], v[64:67], a[4:7]
  ds_read_b64_tr_b16 v[76:77], v14 offset:24576
  v_mfma_f32_16x16x32_bf16 a[8:11], v[28:31], v[68:71], a[8:11]
  ds_read_b64_tr_b16 v[78:79], v14 offset:25600
  v_mfma_f32_16x16x32_bf16 a[12:15], v[28:31], v[72:75], a[12:15]
  ds_read_b128 v[48:51], v11 offset:2048
  s_add_u32 m0, s52, 101376
  v_mfma_f32_16x16x32_bf16 a[16:19], v[32:35], v[60:63], a[16:19]
  buffer_load_dwordx4 v5, s[8:11], s20 offen  lds
  ds_read_b64_tr_b16 v[80:81], v15 offset:24576
  v_mfma_f32_16x16x32_bf16 a[20:23], v[32:35], v[64:67], a[20:23]
  ds_read_b64_tr_b16 v[82:83], v15 offset:25600
  v_mfma_f32_16x16x32_bf16 a[24:27], v[32:35], v[68:71], a[24:27]
  ds_read_b128 v[52:55], v11 offset:4096
  v_mfma_f32_16x16x32_bf16 a[28:31], v[32:35], v[72:75], a[28:31]
  ds_read_b64_tr_b16 v[84:85], v16 offset:24576
  s_add_u32 m0, s53, 101376
  v_mfma_f32_16x16x32_bf16 a[32:35], v[36:39], v[60:63], a[32:35]
  buffer_load_dwordx4 v9, s[12:15], s21 offen  lds
  ds_read_b64_tr_b16 v[86:87], v16 offset:25600
  v_mfma_f32_16x16x32_bf16 a[36:39], v[36:39], v[64:67], a[36:39]
  ds_read_b128 v[56:59], v11 offset:6144
  v_mfma_f32_16x16x32_bf16 a[40:43], v[36:39], v[68:71], a[40:43]
  ds_read_b64_tr_b16 v[88:89], v17 offset:24576
  v_mfma_f32_16x16x32_bf16 a[44:47], v[36:39], v[72:75], a[44:47]
  ds_read_b64_tr_b16 v[90:91], v17 offset:25600
  s_add_u32 s20, s20, 128
  v_mfma_f32_16x16x32_bf16 a[48:51], v[40:43], v[60:63], a[48:51]
  s_add_u32 s21, s21, s51
  v_mfma_f32_16x16x32_bf16 a[52:55], v[40:43], v[64:67], a[52:55]
  v_mfma_f32_16x16x32_bf16 a[56:59], v[40:43], v[68:71], a[56:59]
  v_mfma_f32_16x16x32_bf16 a[60:63], v[40:43], v[72:75], a[60:63]
  s_waitcnt lgkmcnt(0)
  v_mfma_f32_16x16x32_bf16 a[0:3], v[44:47], v[76:79], a[0:3]
  s_waitcnt vmcnt(16)
  s_barrier
  s_add_u32 m0, s52, 0
  v_mfma_f32_16x16x32_bf16 a[4:7], v[44:47], v[80:83], a[4:7]
  buffer_load_dwordx4 v2, s[8:11], s20 offen  lds
  ds_read_b128 v[28:31], v10 offset:32768
  v_mfma_f32_16x16x32_bf16 a[8:11], v[44:47], v[84:87], a[8:11]
  ds_read_b64_tr_b16 v[60:61], v14 offset:49152
  v_mfma_f32_16x16x32_bf16 a[12:15], v[44:47], v[88:91], a[12:15]
  ds_read_b64_tr_b16 v[62:63], v14 offset:50176
  s_add_u32 m0, s53, 0
  v_mfma_f32_16x16x32_bf16 a[16:19], v[48:51], v[76:79], a[16:19]
  buffer_load_dwordx4 v6, s[12:15], s21 offen  lds
  ds_read_b128 v[32:35], v10 offset:34816
  v_mfma_f32_16x16x32_bf16 a[20:23], v[48:51], v[80:83], a[20:23]
  ds_read_b64_tr_b16 v[64:65], v15 offset:49152
  v_mfma_f32_16x16x32_bf16 a[24:27], v[48:51], v[84:87], a[24:27]
  ds_read_b64_tr_b16 v[66:67], v15 offset:50176
  s_add_u32 m0, s52, 1024
  v_mfma_f32_16x16x32_bf16 a[28:31], v[48:51], v[88:91], a[28:31]
  buffer_load_dwordx4 v3, s[8:11], s20 offen  lds
  ds_read_b128 v[36:39], v10 offset:36864
  v_mfma_f32_16x16x32_bf16 a[32:35], v[52:55], v[76:79], a[32:35]
  ds_read_b64_tr_b16 v[68:69], v16 offset:49152
  v_mfma_f32_16x16x32_bf16 a[36:39], v[52:55], v[80:83], a[36:39]
  ds_read_b64_tr_b16 v[70:71], v16 offset:50176
  s_add_u32 m0, s53, 1024
  v_mfma_f32_16x16x32_bf16 a[40:43], v[52:55], v[84:87], a[40:43]
  buffer_load_dwordx4 v7, s[12:15], s21 offen  lds
  ds_read_b128 v[40:43], v10 offset:38912
  v_mfma_f32_16x16x32_bf16 a[44:47], v[52:55], v[88:91], a[44:47]
  ds_read_b64_tr_b16 v[72:73], v17 offset:49152
  v_mfma_f32_16x16x32_bf16 a[48:51], v[56:59], v[76:79], a[48:51]
  ds_read_b64_tr_b16 v[74:75], v17 offset:50176
  s_add_u32 m0, s52, 2048
  v_mfma_f32_16x16x32_bf16 a[52:55], v[56:59], v[80:83], a[52:55]
  buffer_load_dwordx4 v4, s[8:11], s20 offen  lds
  v_mfma_f32_16x16x32_bf16 a[56:59], v[56:59], v[84:87], a[56:59]
  v_mfma_f32_16x16x32_bf16 a[60:63], v[56:59], v[88:91], a[60:63]
  s_waitcnt lgkmcnt(0)
  s_add_u32 m0, s53, 2048
  v_mfma_f32_16x16x32_bf16 a[0:3], v[28:31], v[60:63], a[0:3]
  buffer_load_dwordx4 v8, s[12:15], s21 offen  lds
  ds_read_b128 v[44:47], v11 offset:32768
  v_mfma_f32_16x16x32_bf16 a[4:7], v[28:31], v[64:67], a[4:7]
  ds_read_b64_tr_b16 v[76:77], v14 offset:57344
  v_mfma_f32_16x16x32_bf16 a[8:11], v[28:31], v[68:71], a[8:11]
  ds_read_b64_tr_b16 v[78:79], v14 offset:58368
  v_mfma_f32_16x16x32_bf16 a[12:15], v[28:31], v[72:75], a[12:15]
  ds_read_b128 v[48:51], v11 offset:34816
  s_add_u32 m0, s52, 3072
  v_mfma_f32_16x16x32_bf16 a[16:19], v[32:35], v[60:63], a[16:19]
  buffer_load_dwordx4 v5, s[8:11], s20 offen  lds
  ds_read_b64_tr_b16 v[80:81], v15 offset:57344
  v_mfma_f32_16x16x32_bf16 a[20:23], v[32:35], v[64:67], a[20:23]
  ds_read_b64_tr_b16 v[82:83], v15 offset:58368
  v_mfma_f32_16x16x32_bf16 a[24:27], v[32:35], v[68:71], a[24:27]
  ds_read_b128 v[52:55], v11 offset:36864
  v_mfma_f32_16x16x32_bf16 a[28:31], v[32:35], v[72:75], a[28:31]
  ds_read_b64_tr_b16 v[84:85], v16 offset:57344
  s_add_u32 m0, s53, 3072
  v_mfma_f32_16x16x32_bf16 a[32:35], v[36:39], v[60:63], a[32:35]
  buffer_load_dwordx4 v9, s[12:15], s21 offen  lds
  ds_read_b64_tr_b16 v[86:87], v16 offset:58368
  v_mfma_f32_16x16x32_bf16 a[36:39], v[36:39], v[64:67], a[36:39]
  ds_read_b128 v[56:59], v11 offset:38912
  v_mfma_f32_16x16x32_bf16 a[40:43], v[36:39], v[68:71], a[40:43]
  ds_read_b64_tr_b16 v[88:89], v17 offset:57344
  v_mfma_f32_16x16x32_bf16 a[44:47], v[36:39], v[72:75], a[44:47]
  ds_read_b64_tr_b16 v[90:91], v17 offset:58368
  s_add_u32 s20, s20, 128
  v_mfma_f32_16x16x32_bf16 a[48:51], v[40:43], v[60:63], a[48:51]
  s_add_u32 s21, s21, s51
  v_mfma_f32_16x16x32_bf16 a[52:55], v[40:43], v[64:67], a[52:55]
  v_mfma_f32_16x16x32_bf16 a[56:59], v[40:43], v[68:71], a[56:59]
  v_mfma_f32_16x16x32_bf16 a[60:63], v[40:43], v[72:75], a[60:63]
  s_waitcnt lgkmcnt(0)
  v_mfma_f32_16x16x32_bf16 a[0:3], v[44:47], v[76:79], a[0:3]
  s_waitcnt vmcnt(16)
  s_barrier
  s_add_u32 m0, s52, 32768
  v_mfma_f32_16x16x32_bf16 a[4:7], v[44:47], v[80:83], a[4:7]
  buffer_load_dwordx4 v2, s[8:11], s20 offen  lds
  ds_read_b128 v[28:31], v12 offset:0
  v_mfma_f32_16x16x32_bf16 a[8:11], v[44:47], v[84:87], a[8:11]
  ds_read_b64_tr_b16 v[60:61], v18 offset:16384
  v_mfma_f32_16x16x32_bf16 a[12:15], v[44:47], v[88:91], a[12:15]
  ds_read_b64_tr_b16 v[62:63], v18 offset:17408
  s_add_u32 m0, s53, 32768
  v_mfma_f32_16x16x32_bf16 a[16:19], v[48:51], v[76:79], a[16:19]
  buffer_load_dwordx4 v6, s[12:15], s21 offen  lds
  ds_read_b128 v[32:35], v12 offset:2048
  v_mfma_f32_16x16x32_bf16 a[20:23], v[48:51], v[80:83], a[20:23]
  ds_read_b64_tr_b16 v[64:65], v19 offset:16384
  v_mfma_f32_16x16x32_bf16 a[24:27], v[48:51], v[84:87], a[24:27]
  ds_read_b64_tr_b16 v[66:67], v19 offset:17408
  s_add_u32 m0, s52, 33792
  v_mfma_f32_16x16x32_bf16 a[28:31], v[48:51], v[88:91], a[28:31]
  buffer_load_dwordx4 v3, s[8:11], s20 offen  lds
  ds_read_b128 v[36:39], v12 offset:4096
  v_mfma_f32_16x16x32_bf16 a[32:35], v[52:55], v[76:79], a[32:35]
  ds_read_b64_tr_b16 v[68:69], v20 offset:16384
  v_mfma_f32_16x16x32_bf16 a[36:39], v[52:55], v[80:83], a[36:39]
  ds_read_b64_tr_b16 v[70:71], v20 offset:17408
  s_add_u32 m0, s53, 33792
  v_mfma_f32_16x16x32_bf16 a[40:43], v[52:55], v[84:87], a[40:43]
  buffer_load_dwordx4 v7, s[12:15], s21 offen  lds
  ds_read_b128 v[40:43], v12 offset:6144
  v_mfma_f32_16x16x32_bf16 a[44:47], v[52:55], v[88:91], a[44:47]
  ds_read_b64_tr_b16 v[72:73], v21 offset:16384
  v_mfma_f32_16x16x32_bf16 a[48:51], v[56:59], v[76:79], a[48:51]
  ds_read_b64_tr_b16 v[74:75], v21 offset:17408
  s_add_u32 m0, s52, 34816
  v_mfma_f32_16x16x32_bf16 a[52:55], v[56:59], v[80:83], a[52:55]
  buffer_load_dwordx4 v4, s[8:11], s20 offen  lds
  v_mfma_f32_16x16x32_bf16 a[56:59], v[56:59], v[84:87], a[56:59]
  v_mfma_f32_16x16x32_bf16 a[60:63], v[56:59], v[88:91], a[60:63]
  s_waitcnt lgkmcnt(0)
  s_add_u32 m0, s53, 34816
  v_mfma_f32_16x16x32_bf16 a[0:3], v[28:31], v[60:63], a[0:3]
  buffer_load_dwordx4 v8, s[12:15], s21 offen  lds
  ds_read_b128 v[44:47], v13 offset:0
  v_mfma_f32_16x16x32_bf16 a[4:7], v[28:31], v[64:67], a[4:7]
  ds_read_b64_tr_b16 v[76:77], v18 offset:24576
  v_mfma_f32_16x16x32_bf16 a[8:11], v[28:31], v[68:71], a[8:11]
  ds_read_b64_tr_b16 v[78:79], v18 offset:25600
  v_mfma_f32_16x16x32_bf16 a[12:15], v[28:31], v[72:75], a[12:15]
  ds_read_b128 v[48:51], v13 offset:2048
  s_add_u32 m0, s52, 35840
  v_mfma_f32_16x16x32_bf16 a[16:19], v[32:35], v[60:63], a[16:19]
  buffer_load_dwordx4 v5, s[8:11], s20 offen  lds
  ds_read_b64_tr_b16 v[80:81], v19 offset:24576
  v_mfma_f32_16x16x32_bf16 a[20:23], v[32:35], v[64:67], a[20:23]
  ds_read_b64_tr_b16 v[82:83], v19 offset:25600
  v_mfma_f32_16x16x32_bf16 a[24:27], v[32:35], v[68:71], a[24:27]
  ds_read_b128 v[52:55], v13 offset:4096
  v_mfma_f32_16x16x32_bf16 a[28:31], v[32:35], v[72:75], a[28:31]
  ds_read_b64_tr_b16 v[84:85], v20 offset:24576
  s_add_u32 m0, s53, 35840
  v_mfma_f32_16x16x32_bf16 a[32:35], v[36:39], v[60:63], a[32:35]
  buffer_load_dwordx4 v9, s[12:15], s21 offen  lds
  ds_read_b64_tr_b16 v[86:87], v20 offset:25600
  v_mfma_f32_16x16x32_bf16 a[36:39], v[36:39], v[64:67], a[36:39]
  ds_read_b128 v[56:59], v13 offset:6144
  v_mfma_f32_16x16x32_bf16 a[40:43], v[36:39], v[68:71], a[40:43]
  ds_read_b64_tr_b16 v[88:89], v21 offset:24576
  v_mfma_f32_16x16x32_bf16 a[44:47], v[36:39], v[72:75], a[44:47]
  ds_read_b64_tr_b16 v[90:91], v21 offset:25600
  s_add_u32 s20, s20, 128
  v_mfma_f32_16x16x32_bf16 a[48:51], v[40:43], v[60:63], a[48:51]
  s_add_u32 s21, s21, s51
  v_mfma_f32_16x16x32_bf16 a[52:55], v[40:43], v[64:67], a[52:55]
  v_mfma_f32_16x16x32_bf16 a[56:59], v[40:43], v[68:71], a[56:59]
  v_mfma_f32_16x16x32_bf16 a[60:63], v[40:43], v[72:75], a[60:63]
  s_waitcnt lgkmcnt(0)
  v_mfma_f32_16x16x32_bf16 a[0:3], v[44:47], v[76:79], a[0:3]
  s_waitcnt vmcnt(16)
  s_barrier
  s_add_u32 m0, s52, 65536
  v_mfma_f32_16x16x32_bf16 a[4:7], v[44:47], v[80:83], a[4:7]
  buffer_load_dwordx4 v2, s[8:11], s20 offen  lds
  ds_read_b128 v[28:31], v12 offset:32768
  v_mfma_f32_16x16x32_bf16 a[8:11], v[44:47], v[84:87], a[8:11]
  ds_read_b64_tr_b16 v[60:61], v18 offset:49152
  v_mfma_f32_16x16x32_bf16 a[12:15], v[44:47], v[88:91], a[12:15]
  ds_read_b64_tr_b16 v[62:63], v18 offset:50176
  s_add_u32 m0, s53, 65536
  v_mfma_f32_16x16x32_bf16 a[16:19], v[48:51], v[76:79], a[16:19]
  buffer_load_dwordx4 v6, s[12:15], s21 offen  lds
  ds_read_b128 v[32:35], v12 offset:34816
  v_mfma_f32_16x16x32_bf16 a[20:23], v[48:51], v[80:83], a[20:23]
  ds_read_b64_tr_b16 v[64:65], v19 offset:49152
  v_mfma_f32_16x16x32_bf16 a[24:27], v[48:51], v[84:87], a[24:27]
  ds_read_b64_tr_b16 v[66:67], v19 offset:50176
  s_add_u32 m0, s52, 66560
  v_mfma_f32_16x16x32_bf16 a[28:31], v[48:51], v[88:91], a[28:31]
  buffer_load_dwordx4 v3, s[8:11], s20 offen  lds
  ds_read_b128 v[36:39], v12 offset:36864
  v_mfma_f32_16x16x32_bf16 a[32:35], v[52:55], v[76:79], a[32:35]
  ds_read_b64_tr_b16 v[68:69], v20 offset:49152
  v_mfma_f32_16x16x32_bf16 a[36:39], v[52:55], v[80:83], a[36:39]
  ds_read_b64_tr_b16 v[70:71], v20 offset:50176
  s_add_u32 m0, s53, 66560
  v_mfma_f32_16x16x32_bf16 a[40:43], v[52:55], v[84:87], a[40:43]
  buffer_load_dwordx4 v7, s[12:15], s21 offen  lds
  ds_read_b128 v[40:43], v12 offset:38912
  v_mfma_f32_16x16x32_bf16 a[44:47], v[52:55], v[88:91], a[44:47]
  ds_read_b64_tr_b16 v[72:73], v21 offset:49152
  v_mfma_f32_16x16x32_bf16 a[48:51], v[56:59], v[76:79], a[48:51]
  ds_read_b64_tr_b16 v[74:75], v21 offset:50176
  s_add_u32 m0, s52, 67584
  v_mfma_f32_16x16x32_bf16 a[52:55], v[56:59], v[80:83], a[52:55]
  buffer_load_dwordx4 v4, s[8:11], s20 offen  lds
  v_mfma_f32_16x16x32_bf16 a[56:59], v[56:59], v[84:87], a[56:59]
  v_mfma_f32_16x16x32_bf16 a[60:63], v[56:59], v[88:91], a[60:63]
  s_waitcnt lgkmcnt(0)
  s_add_u32 m0, s53, 67584
  v_mfma_f32_16x16x32_bf16 a[0:3], v[28:31], v[60:63], a[0:3]
  buffer_load_dwordx4 v8, s[12:15], s21 offen  lds
  ds_read_b128 v[44:47], v13 offset:32768
  v_mfma_f32_16x16x32_bf16 a[4:7], v[28:31], v[64:67], a[4:7]
  ds_read_b64_tr_b16 v[76:77], v18 offset:57344
  v_mfma_f32_16x16x32_bf16 a[8:11], v[28:31], v[68:71], a[8:11]
  ds_read_b64_tr_b16 v[78:79], v18 offset:58368
  v_mfma_f32_16x16x32_bf16 a[12:15], v[28:31], v[72:75], a[12:15]
  ds_read_b128 v[48:51], v13 offset:34816
  s_add_u32 m0, s52, 68608
  v_mfma_f32_16x16x32_bf16 a[16:19], v[32:35], v[60:63], a[16:19]
  buffer_load_dwordx4 v5, s[8:11], s20 offen  lds
  ds_read_b64_tr_b16 v[80:81], v19 offset:57344
  v_mfma_f32_16x16x32_bf16 a[20:23], v[32:35], v[64:67], a[20:23]
  ds_read_b64_tr_b16 v[82:83], v19 offset:58368
  v_mfma_f32_16x16x32_bf16 a[24:27], v[32:35], v[68:71], a[24:27]
  ds_read_b128 v[52:55], v13 offset:36864
  v_mfma_f32_16x16x32_bf16 a[28:31], v[32:35], v[72:75], a[28:31]
  ds_read_b64_tr_b16 v[84:85], v20 offset:57344
  s_add_u32 m0, s53, 68608
  v_mfma_f32_16x16x32_bf16 a[32:35], v[36:39], v[60:63], a[32:35]
  buffer_load_dwordx4 v9, s[12:15], s21 offen  lds
  ds_read_b64_tr_b16 v[86:87], v20 offset:58368
  v_mfma_f32_16x16x32_bf16 a[36:39], v[36:39], v[64:67], a[36:39]
  ds_read_b128 v[56:59], v13 offset:38912
  v_mfma_f32_16x16x32_bf16 a[40:43], v[36:39], v[68:71], a[40:43]
  ds_read_b64_tr_b16 v[88:89], v21 offset:57344
  v_mfma_f32_16x16x32_bf16 a[44:47], v[36:39], v[72:75], a[44:47]
  ds_read_b64_tr_b16 v[90:91], v21 offset:58368
  s_add_u32 s20, s20, 128
  v_mfma_f32_16x16x32_bf16 a[48:51], v[40:43], v[60:63], a[48:51]
  s_add_u32 s21, s21, s51
  v_mfma_f32_16x16x32_bf16 a[52:55], v[40:43], v[64:67], a[52:55]
  v_mfma_f32_16x16x32_bf16 a[56:59], v[40:43], v[68:71], a[56:59]
  v_mfma_f32_16x16x32_bf16 a[60:63], v[40:43], v[72:75], a[60:63]
  s_waitcnt lgkmcnt(0)
  v_mfma_f32_16x16x32_bf16 a[0:3], v[44:47], v[76:79], a[0:3]
  s_waitcnt vmcnt(16)
  s_barrier
  s_add_u32 m0, s52, 98304
  v_mfma_f32_16x16x32_bf16 a[4:7], v[44:47], v[80:83], a[4:7]
  buffer_load_dwordx4 v2, s[8:11], s20 offen  lds
  ds_read_b128 v[28:31], v10 offset:0
  v_mfma_f32_16x16x32_bf16 a[8:11], v[44:47], v[84:87], a[8:11]
  ds_read_b64_tr_b16 v[60:61], v14 offset:16384
  v_mfma_f32_16x16x32_bf16 a[12:15], v[44:47], v[88:91], a[12:15]
  ds_read_b64_tr_b16 v[62:63], v14 offset:17408
  s_add_u32 m0, s53, 98304
  v_mfma_f32_16x16x32_bf16 a[16:19], v[48:51], v[76:79], a[16:19]
  buffer_load_dwordx4 v6, s[12:15], s21 offen  lds
  ds_read_b128 v[32:35], v10 offset:2048
  v_mfma_f32_16x16x32_bf16 a[20:23], v[48:51], v[80:83], a[20:23]
  ds_read_b64_tr_b16 v[64:65], v15 offset:16384
  v_mfma_f32_16x16x32_bf16 a[24:27], v[48:51], v[84:87], a[24:27]
  ds_read_b64_tr_b16 v[66:67], v15 offset:17408
  s_add_u32 m0, s52, 99328
  v_mfma_f32_16x16x32_bf16 a[28:31], v[48:51], v[88:91], a[28:31]
  buffer_load_dwordx4 v3, s[8:11], s20 offen  lds
  ds_read_b128 v[36:39], v10 offset:4096
  v_mfma_f32_16x16x32_bf16 a[32:35], v[52:55], v[76:79], a[32:35]
  ds_read_b64_tr_b16 v[68:69], v16 offset:16384
  v_mfma_f32_16x16x32_bf16 a[36:39], v[52:55], v[80:83], a[36:39]
  ds_read_b64_tr_b16 v[70:71], v16 offset:17408
  s_add_u32 m0, s53, 99328
  v_mfma_f32_16x16x32_bf16 a[40:43], v[52:55], v[84:87], a[40:43]
  buffer_load_dwordx4 v7, s[12:15], s21 offen  lds
  ds_read_b128 v[40:43], v10 offset:6144
  v_mfma_f32_16x16x32_bf16 a[44:47], v[52:55], v[88:91], a[44:47]
  ds_read_b64_tr_b16 v[72:73], v17 offset:16384
  v_mfma_f32_16x16x32_bf16 a[48:51], v[56:59], v[76:79], a[48:51]
  ds_read_b64_tr_b16 v[74:75], v17 offset:17408
  s_add_u32 m0, s52, 100352
  v_mfma_f32_16x16x32_bf16 a[52:55], v[56:59], v[80:83], a[52:55]
  buffer_load_dwordx4 v4, s[8:11], s20 offen  lds
  v_mfma_f32_16x16x32_bf16 a[56:59], v[56:59], v[84:87], a[56:59]
  v_mfma_f32_16x16x32_bf16 a[60:63], v[56:59], v[88:91], a[60:63]
  s_branch L_g5_loop
L_g5_fin:
  s_cmp_lg_u32 s32, 0
  s_cbranch_scc1 L_rq_86
  s_cmp_eq_u32 s39, 0
  s_cbranch_scc1 L_rq_86
  s_lshl_b32 s99, s33, 7
  s_add_u32 s99, s99, 0x3d00200
  v_mov_b32 v244, 1
  v_mov_b32 v245, 0
  s_mov_b64 exec, 1
  buffer_atomic_add v244, v245, s[4:7], s99 offen sc0 sc1
  s_mov_b64 exec, -1
L_rq_86:
  s_waitcnt lgkmcnt(0)
  s_add_u32 m0, s53, 100352
  v_mfma_f32_16x16x32_bf16 a[0:3], v[28:31], v[60:63], a[0:3]
  buffer_load_dwordx4 v8, s[12:15], s21 offen  lds
  ds_read_b128 v[44:47], v11 offset:0
  v_mfma_f32_16x16x32_bf16 a[4:7], v[28:31], v[64:67], a[4:7]
  ds_read_b64_tr_b16 v[76:77], v14 offset:24576
  v_mfma_f32_16x16x32_bf16 a[8:11], v[28:31], v[68:71], a[8:11]
  ds_read_b64_tr_b16 v[78:79], v14 offset:25600
  v_mfma_f32_16x16x32_bf16 a[12:15], v[28:31], v[72:75], a[12:15]
  ds_read_b128 v[48:51], v11 offset:2048
  s_add_u32 m0, s52, 101376
  v_mfma_f32_16x16x32_bf16 a[16:19], v[32:35], v[60:63], a[16:19]
  buffer_load_dwordx4 v5, s[8:11], s20 offen  lds
  ds_read_b64_tr_b16 v[80:81], v15 offset:24576
  v_mfma_f32_16x16x32_bf16 a[20:23], v[32:35], v[64:67], a[20:23]
  ds_read_b64_tr_b16 v[82:83], v15 offset:25600
  v_mfma_f32_16x16x32_bf16 a[24:27], v[32:35], v[68:71], a[24:27]
  ds_read_b128 v[52:55], v11 offset:4096
  v_mfma_f32_16x16x32_bf16 a[28:31], v[32:35], v[72:75], a[28:31]
  ds_read_b64_tr_b16 v[84:85], v16 offset:24576
  s_add_u32 m0, s53, 101376
  v_mfma_f32_16x16x32_bf16 a[32:35], v[36:39], v[60:63], a[32:35]
  buffer_load_dwordx4 v9, s[12:15], s21 offen  lds
  ds_read_b64_tr_b16 v[86:87], v16 offset:25600
  v_mfma_f32_16x16x32_bf16 a[36:39], v[36:39], v[64:67], a[36:39]
  ds_read_b128 v[56:59], v11 offset:6144
  v_mfma_f32_16x16x32_bf16 a[40:43], v[36:39], v[68:71], a[40:43]
  ds_read_b64_tr_b16 v[88:89], v17 offset:24576
  v_mfma_f32_16x16x32_bf16 a[44:47], v[36:39], v[72:75], a[44:47]
  ds_read_b64_tr_b16 v[90:91], v17 offset:25600
  s_add_u32 s20, s20, 128
  v_mfma_f32_16x16x32_bf16 a[48:51], v[40:43], v[60:63], a[48:51]
  s_add_u32 s21, s21, s51
  v_mfma_f32_16x16x32_bf16 a[52:55], v[40:43], v[64:67], a[52:55]
  v_mfma_f32_16x16x32_bf16 a[56:59], v[40:43], v[68:71], a[56:59]
  v_mfma_f32_16x16x32_bf16 a[60:63], v[40:43], v[72:75], a[60:63]
  s_waitcnt lgkmcnt(0)
  v_mfma_f32_16x16x32_bf16 a[0:3], v[44:47], v[76:79], a[0:3]
  s_waitcnt vmcnt(16)
  s_barrier
  v_mfma_f32_16x16x32_bf16 a[4:7], v[44:47], v[80:83], a[4:7]
  ds_read_b128 v[28:31], v10 offset:32768
  v_mfma_f32_16x16x32_bf16 a[8:11], v[44:47], v[84:87], a[8:11]
  ds_read_b64_tr_b16 v[60:61], v14 offset:49152
  v_mfma_f32_16x16x32_bf16 a[12:15], v[44:47], v[88:91], a[12:15]
  ds_read_b64_tr_b16 v[62:63], v14 offset:50176
  v_mfma_f32_16x16x32_bf16 a[16:19], v[48:51], v[76:79], a[16:19]
  ds_read_b128 v[32:35], v10 offset:34816
  v_mfma_f32_16x16x32_bf16 a[20:23], v[48:51], v[80:83], a[20:23]
  ds_read_b64_tr_b16 v[64:65], v15 offset:49152
  v_mfma_f32_16x16x32_bf16 a[24:27], v[48:51], v[84:87], a[24:27]
  ds_read_b64_tr_b16 v[66:67], v15 offset:50176
  v_mfma_f32_16x16x32_bf16 a[28:31], v[48:51], v[88:91], a[28:31]
  ds_read_b128 v[36:39], v10 offset:36864
  v_mfma_f32_16x16x32_bf16 a[32:35], v[52:55], v[76:79], a[32:35]
  ds_read_b64_tr_b16 v[68:69], v16 offset:49152
  v_mfma_f32_16x16x32_bf16 a[36:39], v[52:55], v[80:83], a[36:39]
  ds_read_b64_tr_b16 v[70:71], v16 offset:50176
  v_mfma_f32_16x16x32_bf16 a[40:43], v[52:55], v[84:87], a[40:43]
  ds_read_b128 v[40:43], v10 offset:38912
  v_mfma_f32_16x16x32_bf16 a[44:47], v[52:55], v[88:91], a[44:47]
  ds_read_b64_tr_b16 v[72:73], v17 offset:49152
  v_mfma_f32_16x16x32_bf16 a[48:51], v[56:59], v[76:79], a[48:51]
  ds_read_b64_tr_b16 v[74:75], v17 offset:50176
  v_mfma_f32_16x16x32_bf16 a[52:55], v[56:59], v[80:83], a[52:55]
  v_mfma_f32_16x16x32_bf16 a[56:59], v[56:59], v[84:87], a[56:59]
  v_mfma_f32_16x16x32_bf16 a[60:63], v[56:59], v[88:91], a[60:63]
  s_waitcnt lgkmcnt(0)
  v_mfma_f32_16x16x32_bf16 a[0:3], v[28:31], v[60:63], a[0:3]
  ds_read_b128 v[44:47], v11 offset:32768
  v_mfma_f32_16x16x32_bf16 a[4:7], v[28:31], v[64:67], a[4:7]
  ds_read_b64_tr_b16 v[76:77], v14 offset:57344
  v_mfma_f32_16x16x32_bf16 a[8:11], v[28:31], v[68:71], a[8:11]
  ds_read_b64_tr_b16 v[78:79], v14 offset:58368
  v_mfma_f32_16x16x32_bf16 a[12:15], v[28:31], v[72:75], a[12:15]
  ds_read_b128 v[48:51], v11 offset:34816
  v_mfma_f32_16x16x32_bf16 a[16:19], v[32:35], v[60:63], a[16:19]
  ds_read_b64_tr_b16 v[80:81], v15 offset:57344
  v_mfma_f32_16x16x32_bf16 a[20:23], v[32:35], v[64:67], a[20:23]
  ds_read_b64_tr_b16 v[82:83], v15 offset:58368
  v_mfma_f32_16x16x32_bf16 a[24:27], v[32:35], v[68:71], a[24:27]
  ds_read_b128 v[52:55], v11 offset:36864
  v_mfma_f32_16x16x32_bf16 a[28:31], v[32:35], v[72:75], a[28:31]
  ds_read_b64_tr_b16 v[84:85], v16 offset:57344
  v_mfma_f32_16x16x32_bf16 a[32:35], v[36:39], v[60:63], a[32:35]
  ds_read_b64_tr_b16 v[86:87], v16 offset:58368
  v_mfma_f32_16x16x32_bf16 a[36:39], v[36:39], v[64:67], a[36:39]
  ds_read_b128 v[56:59], v11 offset:38912
  v_mfma_f32_16x16x32_bf16 a[40:43], v[36:39], v[68:71], a[40:43]
  ds_read_b64_tr_b16 v[88:89], v17 offset:57344
  v_mfma_f32_16x16x32_bf16 a[44:47], v[36:39], v[72:75], a[44:47]
  ds_read_b64_tr_b16 v[90:91], v17 offset:58368
  v_mfma_f32_16x16x32_bf16 a[48:51], v[40:43], v[60:63], a[48:51]
  v_mfma_f32_16x16x32_bf16 a[52:55], v[40:43], v[64:67], a[52:55]
  v_mfma_f32_16x16x32_bf16 a[56:59], v[40:43], v[68:71], a[56:59]
  v_mfma_f32_16x16x32_bf16 a[60:63], v[40:43], v[72:75], a[60:63]
  s_waitcnt lgkmcnt(0)
  v_mfma_f32_16x16x32_bf16 a[0:3], v[44:47], v[76:79], a[0:3]
  s_waitcnt vmcnt(8)
  s_barrier
  v_mfma_f32_16x16x32_bf16 a[4:7], v[44:47], v[80:83], a[4:7]
  ds_read_b128 v[28:31], v12 offset:0
  v_mfma_f32_16x16x32_bf16 a[8:11], v[44:47], v[84:87], a[8:11]
  ds_read_b64_tr_b16 v[60:61], v18 offset:16384
  v_mfma_f32_16x16x32_bf16 a[12:15], v[44:47], v[88:91], a[12:15]
  ds_read_b64_tr_b16 v[62:63], v18 offset:17408
  v_mfma_f32_16x16x32_bf16 a[16:19], v[48:51], v[76:79], a[16:19]
  ds_read_b128 v[32:35], v12 offset:2048
  v_mfma_f32_16x16x32_bf16 a[20:23], v[48:51], v[80:83], a[20:23]
  ds_read_b64_tr_b16 v[64:65], v19 offset:16384
  v_mfma_f32_16x16x32_bf16 a[24:27], v[48:51], v[84:87], a[24:27]
  ds_read_b64_tr_b16 v[66:67], v19 offset:17408
  v_mfma_f32_16x16x32_bf16 a[28:31], v[48:51], v[88:91], a[28:31]
  ds_read_b128 v[36:39], v12 offset:4096
  v_mfma_f32_16x16x32_bf16 a[32:35], v[52:55], v[76:79], a[32:35]
  ds_read_b64_tr_b16 v[68:69], v20 offset:16384
  v_mfma_f32_16x16x32_bf16 a[36:39], v[52:55], v[80:83], a[36:39]
  ds_read_b64_tr_b16 v[70:71], v20 offset:17408
  v_mfma_f32_16x16x32_bf16 a[40:43], v[52:55], v[84:87], a[40:43]
  ds_read_b128 v[40:43], v12 offset:6144
  v_mfma_f32_16x16x32_bf16 a[44:47], v[52:55], v[88:91], a[44:47]
  ds_read_b64_tr_b16 v[72:73], v21 offset:16384
  v_mfma_f32_16x16x32_bf16 a[48:51], v[56:59], v[76:79], a[48:51]
  ds_read_b64_tr_b16 v[74:75], v21 offset:17408
  v_mfma_f32_16x16x32_bf16 a[52:55], v[56:59], v[80:83], a[52:55]
  v_mfma_f32_16x16x32_bf16 a[56:59], v[56:59], v[84:87], a[56:59]
  v_mfma_f32_16x16x32_bf16 a[60:63], v[56:59], v[88:91], a[60:63]
  s_waitcnt lgkmcnt(0)
  v_mfma_f32_16x16x32_bf16 a[0:3], v[28:31], v[60:63], a[0:3]
  ds_read_b128 v[44:47], v13 offset:0
  v_mfma_f32_16x16x32_bf16 a[4:7], v[28:31], v[64:67], a[4:7]
  ds_read_b64_tr_b16 v[76:77], v18 offset:24576
  v_mfma_f32_16x16x32_bf16 a[8:11], v[28:31], v[68:71], a[8:11]
  ds_read_b64_tr_b16 v[78:79], v18 offset:25600
  v_mfma_f32_16x16x32_bf16 a[12:15], v[28:31], v[72:75], a[12:15]
  ds_read_b128 v[48:51], v13 offset:2048
  v_mfma_f32_16x16x32_bf16 a[16:19], v[32:35], v[60:63], a[16:19]
  ds_read_b64_tr_b16 v[80:81], v19 offset:24576
  v_mfma_f32_16x16x32_bf16 a[20:23], v[32:35], v[64:67], a[20:23]
  ds_read_b64_tr_b16 v[82:83], v19 offset:25600
  v_mfma_f32_16x16x32_bf16 a[24:27], v[32:35], v[68:71], a[24:27]
  ds_read_b128 v[52:55], v13 offset:4096
  v_mfma_f32_16x16x32_bf16 a[28:31], v[32:35], v[72:75], a[28:31]
  ds_read_b64_tr_b16 v[84:85], v20 offset:24576
  v_mfma_f32_16x16x32_bf16 a[32:35], v[36:39], v[60:63], a[32:35]
  ds_read_b64_tr_b16 v[86:87], v20 offset:25600
  v_mfma_f32_16x16x32_bf16 a[36:39], v[36:39], v[64:67], a[36:39]
  ds_read_b128 v[56:59], v13 offset:6144
  v_mfma_f32_16x16x32_bf16 a[40:43], v[36:39], v[68:71], a[40:43]
  ds_read_b64_tr_b16 v[88:89], v21 offset:24576
  v_mfma_f32_16x16x32_bf16 a[44:47], v[36:39], v[72:75], a[44:47]
  ds_read_b64_tr_b16 v[90:91], v21 offset:25600
  v_mfma_f32_16x16x32_bf16 a[48:51], v[40:43], v[60:63], a[48:51]
  v_mfma_f32_16x16x32_bf16 a[52:55], v[40:43], v[64:67], a[52:55]
  v_mfma_f32_16x16x32_bf16 a[56:59], v[40:43], v[68:71], a[56:59]
  v_mfma_f32_16x16x32_bf16 a[60:63], v[40:43], v[72:75], a[60:63]
  s_waitcnt lgkmcnt(0)
  v_mfma_f32_16x16x32_bf16 a[0:3], v[44:47], v[76:79], a[0:3]
  s_waitcnt vmcnt(0)
  s_barrier
  v_mfma_f32_16x16x32_bf16 a[4:7], v[44:47], v[80:83], a[4:7]
  ds_read_b128 v[28:31], v12 offset:32768
  v_mfma_f32_16x16x32_bf16 a[8:11], v[44:47], v[84:87], a[8:11]
  ds_read_b64_tr_b16 v[60:61], v18 offset:49152
  v_mfma_f32_16x16x32_bf16 a[12:15], v[44:47], v[88:91], a[12:15]
  ds_read_b64_tr_b16 v[62:63], v18 offset:50176
  v_mfma_f32_16x16x32_bf16 a[16:19], v[48:51], v[76:79], a[16:19]
  ds_read_b128 v[32:35], v12 offset:34816
  v_mfma_f32_16x16x32_bf16 a[20:23], v[48:51], v[80:83], a[20:23]
  ds_read_b64_tr_b16 v[64:65], v19 offset:49152
  v_mfma_f32_16x16x32_bf16 a[24:27], v[48:51], v[84:87], a[24:27]
  ds_read_b64_tr_b16 v[66:67], v19 offset:50176
  v_mfma_f32_16x16x32_bf16 a[28:31], v[48:51], v[88:91], a[28:31]
  ds_read_b128 v[36:39], v12 offset:36864
  v_mfma_f32_16x16x32_bf16 a[32:35], v[52:55], v[76:79], a[32:35]
  ds_read_b64_tr_b16 v[68:69], v20 offset:49152
  v_mfma_f32_16x16x32_bf16 a[36:39], v[52:55], v[80:83], a[36:39]
  ds_read_b64_tr_b16 v[70:71], v20 offset:50176
  v_mfma_f32_16x16x32_bf16 a[40:43], v[52:55], v[84:87], a[40:43]
  ds_read_b128 v[40:43], v12 offset:38912
  v_mfma_f32_16x16x32_bf16 a[44:47], v[52:55], v[88:91], a[44:47]
  ds_read_b64_tr_b16 v[72:73], v21 offset:49152
  v_mfma_f32_16x16x32_bf16 a[48:51], v[56:59], v[76:79], a[48:51]
  ds_read_b64_tr_b16 v[74:75], v21 offset:50176
  v_mfma_f32_16x16x32_bf16 a[52:55], v[56:59], v[80:83], a[52:55]
  v_mfma_f32_16x16x32_bf16 a[56:59], v[56:59], v[84:87], a[56:59]
  v_mfma_f32_16x16x32_bf16 a[60:63], v[56:59], v[88:91], a[60:63]
  s_waitcnt lgkmcnt(0)
  v_mfma_f32_16x16x32_bf16 a[0:3], v[28:31], v[60:63], a[0:3]
  ds_read_b128 v[44:47], v13 offset:32768
  v_mfma_f32_16x16x32_bf16 a[4:7], v[28:31], v[64:67], a[4:7]
  ds_read_b64_tr_b16 v[76:77], v18 offset:57344
  v_mfma_f32_16x16x32_bf16 a[8:11], v[28:31], v[68:71], a[8:11]
  ds_read_b64_tr_b16 v[78:79], v18 offset:58368
  v_mfma_f32_16x16x32_bf16 a[12:15], v[28:31], v[72:75], a[12:15]
  ds_read_b128 v[48:51], v13 offset:34816
  v_mfma_f32_16x16x32_bf16 a[16:19], v[32:35], v[60:63], a[16:19]
  ds_read_b64_tr_b16 v[80:81], v19 offset:57344
  v_mfma_f32_16x16x32_bf16 a[20:23], v[32:35], v[64:67], a[20:23]
  ds_read_b64_tr_b16 v[82:83], v19 offset:58368
  v_mfma_f32_16x16x32_bf16 a[24:27], v[32:35], v[68:71], a[24:27]
  ds_read_b128 v[52:55], v13 offset:36864
  v_mfma_f32_16x16x32_bf16 a[28:31], v[32:35], v[72:75], a[28:31]
  ds_read_b64_tr_b16 v[84:85], v20 offset:57344
  v_mfma_f32_16x16x32_bf16 a[32:35], v[36:39], v[60:63], a[32:35]
  ds_read_b64_tr_b16 v[86:87], v20 offset:58368
  v_mfma_f32_16x16x32_bf16 a[36:39], v[36:39], v[64:67], a[36:39]
  ds_read_b128 v[56:59], v13 offset:38912
  v_mfma_f32_16x16x32_bf16 a[40:43], v[36:39], v[68:71], a[40:43]
  ds_read_b64_tr_b16 v[88:89], v21 offset:57344
  v_mfma_f32_16x16x32_bf16 a[44:47], v[36:39], v[72:75], a[44:47]
  ds_read_b64_tr_b16 v[90:91], v21 offset:58368
  v_mfma_f32_16x16x32_bf16 a[48:51], v[40:43], v[60:63], a[48:51]
  v_mfma_f32_16x16x32_bf16 a[52:55], v[40:43], v[64:67], a[52:55]
  v_mfma_f32_16x16x32_bf16 a[56:59], v[40:43], v[68:71], a[56:59]
  v_mfma_f32_16x16x32_bf16 a[60:63], v[40:43], v[72:75], a[60:63]
  s_waitcnt lgkmcnt(0)
  v_mfma_f32_16x16x32_bf16 a[0:3], v[44:47], v[76:79], a[0:3]
  v_mfma_f32_16x16x32_bf16 a[4:7], v[44:47], v[80:83], a[4:7]
  v_mfma_f32_16x16x32_bf16 a[8:11], v[44:47], v[84:87], a[8:11]
  v_mfma_f32_16x16x32_bf16 a[12:15], v[44:47], v[88:91], a[12:15]
  v_mfma_f32_16x16x32_bf16 a[16:19], v[48:51], v[76:79], a[16:19]
  v_mfma_f32_16x16x32_bf16 a[20:23], v[48:51], v[80:83], a[20:23]
  v_mfma_f32_16x16x32_bf16 a[24:27], v[48:51], v[84:87], a[24:27]
  v_mfma_f32_16x16x32_bf16 a[28:31], v[48:51], v[88:91], a[28:31]
  v_mfma_f32_16x16x32_bf16 a[32:35], v[52:55], v[76:79], a[32:35]
  v_mfma_f32_16x16x32_bf16 a[36:39], v[52:55], v[80:83], a[36:39]
  v_mfma_f32_16x16x32_bf16 a[40:43], v[52:55], v[84:87], a[40:43]
  v_mfma_f32_16x16x32_bf16 a[44:47], v[52:55], v[88:91], a[44:47]
  v_mfma_f32_16x16x32_bf16 a[48:51], v[56:59], v[76:79], a[48:51]
  v_mfma_f32_16x16x32_bf16 a[52:55], v[56:59], v[80:83], a[52:55]
  v_mfma_f32_16x16x32_bf16 a[56:59], v[56:59], v[84:87], a[56:59]
  v_mfma_f32_16x16x32_bf16 a[60:63], v[56:59], v[88:91], a[60:63]
  s_mov_b32 s59, 4
  s_mov_b32 s60, s22
  s_mov_b32 s61, s26
  s_add_u32 s62, s38, 0x3d00000
  s_mov_b32 s63, s98
  s_cmp_lg_u32 s39, 0
  s_cbranch_scc1 L_got
  s_mov_b32 s58, 3
  s_branch L_epi
L_swp:
  s_barrier
  v_and_b32 v1, 63, v0
  v_lshlrev_b32 v2, 7, v1
  s_lshl_b32 s40, s36, 2
  s_add_u32 s40, s40, s33
  s_lshl_b32 s40, s40, 2
  s_add_u32 s40, s40, s32
  s_lshl_b32 s40, s40, 13
  s_mov_b32 s44, s78
  s_and_b32 s45, s79, 0xffff
  s_mov_b32 s46, 0x400000
  s_mov_b32 s47, 0x20000
  s_mov_b32 s41, s40
  buffer_load_dword v4, v2, s[44:47], s41 offen
  s_add_u32 s41, s41, 524288
  buffer_load_dword v5, v2, s[44:47], s41 offen
  s_add_u32 s41, s41, 524288
  buffer_load_dword v6, v2, s[44:47], s41 offen
  s_add_u32 s41, s41, 524288
  buffer_load_dword v7, v2, s[44:47], s41 offen
  s_add_u32 s41, s41, 524288
  buffer_load_dword v8, v2, s[44:47], s41 offen
  s_add_u32 s41, s41, 524288
  buffer_load_dword v9, v2, s[44:47], s41 offen
  s_add_u32 s41, s41, 524288
  buffer_load_dword v10, v2, s[44:47], s41 offen
  s_add_u32 s41, s41, 524288
  buffer_load_dword v11, v2, s[44:47], s41 offen
  s_add_u32 s41, s41, 524288
  s_mov_b32 s44, s80
  s_and_b32 s45, s81, 0xffff
  s_mov_b32 s46, 0x600000
  s_mov_b32 s47, 0x20000
  s_mov_b32 s41, s40
  buffer_load_dword v4, v2, s[44:47], s41 offen
  s_add_u32 s41, s41, 524288
  buffer_load_dword v5, v2, s[44:47], s41 offen
  s_add_u32 s41, s41, 524288
  buffer_load_dword v6, v2, s[44:47], s41 offen
  s_add_u32 s41, s41, 524288
  buffer_load_dword v7, v2, s[44:47], s41 offen
  s_add_u32 s41, s41, 524288
  buffer_load_dword v8, v2, s[44:47], s41 offen
  s_add_u32 s41, s41, 524288
  buffer_load_dword v9, v2, s[44:47], s41 offen
  s_add_u32 s41, s41, 524288
  buffer_load_dword v10, v2, s[44:47], s41 offen
  s_add_u32 s41, s41, 524288
  buffer_load_dword v11, v2, s[44:47], s41 offen
  s_add_u32 s41, s41, 524288
  buffer_load_dword v12, v2, s[44:47], s41 offen
  s_add_u32 s41, s41, 524288
  buffer_load_dword v13, v2, s[44:47], s41 offen
  s_add_u32 s41, s41, 524288
  buffer_load_dword v14, v2, s[44:47], s41 offen
  s_add_u32 s41, s41, 524288
  buffer_load_dword v15, v2, s[44:47], s41 offen
  s_add_u32 s41, s41, 524288
  s_mov_b32 s44, s82
  s_and_b32 s45, s83, 0xffff
  s_mov_b32 s46, 0x200000
  s_mov_b32 s47, 0x20000
  s_mov_b32 s41, s40
  buffer_load_dword v4, v2, s[44:47], s41 offen
  s_add_u32 s41, s41, 524288
  buffer_load_dword v5, v2, s[44:47], s41 offen
  s_add_u32 s41, s41, 524288
  buffer_load_dword v6, v2, s[44:47], s41 offen
  s_add_u32 s41, s41, 524288
  buffer_load_dword v7, v2, s[44:47], s41 offen
  s_add_u32 s41, s41, 524288
  v_lshlrev_b32 v2, 4, v1
  v_mov_b32 v32, -1
  v_mov_b32 v33, -1
  v_mov_b32 v34, -1
  v_mov_b32 v35, -1
  s_lshl_b32 s41, s40, 3
  s_add_u32 s41, s41, 0x7000000
  s_mov_b32 s42, 16
L_swf:
  buffer_store_dwordx4 v[32:35], v2, s[4:7], s41 offen offset:0 sc1
  buffer_store_dwordx4 v[32:35], v2, s[4:7], s41 offen offset:1024 sc1
  buffer_store_dwordx4 v[32:35], v2, s[4:7], s41 offen offset:2048 sc1
  buffer_store_dwordx4 v[32:35], v2, s[4:7], s41 offen offset:3072 sc1
  s_add_u32 s41, s41, 4096
  s_sub_u32 s42, s42, 1
  s_cmp_lg_u32 s42, 0
  s_cbranch_scc1 L_swf
  s_waitcnt vmcnt(0)
  s_cmp_lg_u32 s32, 0
  s_cbranch_scc1 L_rq_87
  s_cmp_eq_u32 s39, 0
  s_cbranch_scc1 L_rq_87
  s_lshl_b32 s99, s33, 7
  s_add_u32 s99, s99, 0x3d00200
  v_mov_b32 v244, 1
  v_mov_b32 v245, 0
  s_mov_b64 exec, 1
  buffer_atomic_add v244, v245, s[4:7], s99 offen sc0 sc1
  s_mov_b64 exec, -1
L_rq_87:
  s_mov_b32 s38, 5120
  s_branch L_done
  s_branch L_next
L_atb:
  s_lshl_b32 s90, s33, 7
  s_lshl_b32 s40, s36, 9
  s_add_u32 s40, s40, s90
  s_max_u32 s41, s36, 1
  s_sub_u32 s41, s41, 1
  s_lshl_b32 s41, s41, 9
  s_add_u32 s41, s41, s90
  s_cmp_lg_u32 s32, 0
  s_cbranch_scc1 L_dd_89
  v_mov_b32 v228, 0x3d00000
  v_mov_b32 v231, 0x3d03000
L_dw_88:
  buffer_load_dword v234, v231, s[4:7], s40 offen offset:0 sc1
  buffer_load_dword v235, v231, s[4:7], s41 offen offset:0 sc1
  s_waitcnt vmcnt(0)
  s_mov_b32 s44, 1
  v_readfirstlane_b32 s45, v234
  s_cmp_ge_u32 s45, 3
  s_cselect_b32 s44, s44, 0
  v_readfirstlane_b32 s45, v235
  s_cmp_ge_u32 s45, 3
  s_cselect_b32 s44, s44, 0
  s_cmp_eq_u32 s44, 1
  s_cbranch_scc1 L_dd_89
  s_sleep 6
  s_add_u32 s3, s3, 1
  s_cmp_lt_u32 s3, 131072
  s_cbranch_scc1 L_dw_88
L_dd_89:
  s_barrier
  s_lshl_b32 s38, s36, 7
  s_add_u32 s38, s38, 1024
  s_lshl_b32 s46, s36, 3
  s_lshl_b32 s90, s37, 1
  s_add_u32 s99, s46, s90
  s_lshr_b32 s90, s32, 1
  s_add_u32 s99, s99, s90
  s_lshl_b32 s99, s99, 3
  s_lshl_b32 s90, s33, 1
  s_add_u32 s99, s99, s90
  s_and_b32 s90, s32, 1
  s_add_u32 s20, s99, s90
  v_and_b32 v1, 63, v0
  s_lshl_b32 s90, s20, 13
  s_sub_u32 s91, s90, 65536
  s_cmp_lt_u32 s20, 8
  s_cselect_b32 s91, s90, s91
  v_mov_b32 v2, 0x0
  v_bfe_u32 v7, v1, 0, 6
  v_lshl_add_u32 v2, v7, 4, v2
  v_add_u32 v3, 4096, v2
  s_add_u32 s92, s90, 67108864
  s_add_u32 s93, s90, 71303168
  s_add_u32 s94, s91, 71303168
  s_add_u32 s95, s90, 75497472
  s_add_u32 s96, s91, 75497472
  s_add_u32 s97, s90, 100663296
  buffer_load_dwordx4 v[8:11], v2, s[4:7], s92 offen offset:0 sc1
  buffer_load_dwordx4 v[12:15], v2, s[4:7], s92 offen offset:1024 sc1
  buffer_load_dwordx4 v[16:19], v2, s[4:7], s92 offen offset:2048 sc1
  buffer_load_dwordx4 v[20:23], v2, s[4:7], s92 offen offset:3072 sc1
  buffer_load_dwordx4 v[24:27], v3, s[4:7], s92 offen offset:0 sc1
  buffer_load_dwordx4 v[28:31], v3, s[4:7], s92 offen offset:1024 sc1
  buffer_load_dwordx4 v[32:35], v3, s[4:7], s92 offen offset:2048 sc1
  buffer_load_dwordx4 v[36:39], v3, s[4:7], s92 offen offset:3072 sc1
  buffer_load_dwordx4 v[40:43], v3, s[4:7], s94 offen offset:0 sc1
  buffer_load_dwordx4 v[44:47], v3, s[4:7], s94 offen offset:1024 sc1
  buffer_load_dwordx4 v[48:51], v3, s[4:7], s94 offen offset:2048 sc1
  buffer_load_dwordx4 v[52:55], v3, s[4:7], s94 offen offset:3072 sc1
  buffer_load_dwordx4 v[56:59], v2, s[4:7], s93 offen offset:0 sc1
  buffer_load_dwordx4 v[60:63], v2, s[4:7], s93 offen offset:1024 sc1
  buffer_load_dwordx4 v[64:67], v2, s[4:7], s93 offen offset:2048 sc1
  buffer_load_dwordx4 v[68:71], v2, s[4:7], s93 offen offset:3072 sc1
  buffer_load_dwordx4 v[72:75], v3, s[4:7], s93 offen offset:0 sc1
  buffer_load_dwordx4 v[76:79], v3, s[4:7], s93 offen offset:1024 sc1
  buffer_load_dwordx4 v[80:83], v3, s[4:7], s93 offen offset:2048 sc1
  buffer_load_dwordx4 v[84:87], v3, s[4:7], s93 offen offset:3072 sc1
  buffer_load_dwordx2 v[88:89], v2, s[4:7], s96 offen offset:8 sc1
  buffer_load_dwordx2 v[94:95], v2, s[4:7], s96 offen offset:1032 sc1
  buffer_load_dwordx2 v[100:101], v2, s[4:7], s96 offen offset:2056 sc1
  buffer_load_dwordx2 v[106:107], v2, s[4:7], s96 offen offset:3080 sc1
  buffer_load_dwordx2 v[112:113], v3, s[4:7], s96 offen offset:8 sc1
  buffer_load_dwordx2 v[118:119], v3, s[4:7], s96 offen offset:1032 sc1
  buffer_load_dwordx2 v[124:125], v3, s[4:7], s96 offen offset:2056 sc1
  buffer_load_dwordx2 v[130:131], v3, s[4:7], s96 offen offset:3080 sc1
  buffer_load_dwordx4 v[90:93], v2, s[4:7], s95 offen offset:0 sc1
  buffer_load_dwordx4 v[96:99], v2, s[4:7], s95 offen offset:1024 sc1
  buffer_load_dwordx4 v[102:105], v2, s[4:7], s95 offen offset:2048 sc1
  buffer_load_dwordx4 v[108:111], v2, s[4:7], s95 offen offset:3072 sc1
  buffer_load_dwordx4 v[114:117], v3, s[4:7], s95 offen offset:0 sc1
  buffer_load_dwordx4 v[120:123], v3, s[4:7], s95 offen offset:1024 sc1
  buffer_load_dwordx4 v[126:129], v3, s[4:7], s95 offen offset:2048 sc1
  buffer_load_dwordx4 v[132:135], v3, s[4:7], s95 offen offset:3072 sc1
  s_mov_b32 s40, 0x50000
  s_mov_b32 s41, 0x5550055
  s_mov_b32 s42, 0xa0000
  s_mov_b32 s43, 0xaaa00aa
  s_mov_b32 s44, 0x150001
  s_mov_b32 s45, 0x15550155
  s_mov_b32 s46, 0x2a0002
  s_mov_b32 s47, 0x2aaa02aa
  s_mov_b32 s48, 0x55505555
  s_mov_b32 s49, 0x50005500
  s_mov_b32 s50, 0xaaa0aaaa
  s_mov_b32 s51, 0xa000aa00
  s_mov_b32 s52, 0x55405554
  s_mov_b32 s53, 0x40005400
  s_mov_b32 s54, 0xaa80aaa8
  s_mov_b32 s55, 0x8000a800
  s_cmp_lt_u32 s20, 8
  s_cselect_b64 s[56:57], 0, s[40:41]
  s_cselect_b64 s[58:59], 0, s[42:43]
  s_cselect_b64 s[60:61], 0, s[44:45]
  s_cselect_b64 s[62:63], 0, s[46:47]
  s_mov_b32 s21, 0x3e8293ee
  v_mov_b32 v6, 0xcfa8965f
  s_waitcnt vmcnt(16)
  v_mfma_f32_16x16x32_bf16 v[136:139], v[40:43], v[8:11], 0
  v_mfma_f32_16x16x32_bf16 v[140:143], v[56:59], v[8:11], 0
  v_mfma_f32_16x16x32_bf16 v[144:147], v[44:47], v[12:15], 0
  v_mfma_f32_16x16x32_bf16 v[148:151], v[60:63], v[12:15], 0
  v_mfma_f32_16x16x32_bf16 v[152:155], v[48:51], v[16:19], 0
  v_mfma_f32_16x16x32_bf16 v[156:159], v[64:67], v[16:19], 0
  v_mfma_f32_16x16x32_bf16 v[160:163], v[52:55], v[20:23], 0
  v_mfma_f32_16x16x32_bf16 v[164:167], v[68:71], v[20:23], 0
  v_mfma_f32_16x16x32_bf16 v[168:171], v[56:59], v[24:27], 0
  v_mfma_f32_16x16x32_bf16 v[172:175], v[72:75], v[24:27], 0
  v_mfma_f32_16x16x32_bf16 v[176:179], v[60:63], v[28:31], 0
  v_mfma_f32_16x16x32_bf16 v[180:183], v[76:79], v[28:31], 0
  v_mfma_f32_16x16x32_bf16 v[184:187], v[64:67], v[32:35], 0
  v_mfma_f32_16x16x32_bf16 v[188:191], v[80:83], v[32:35], 0
  v_mfma_f32_16x16x32_bf16 v[192:195], v[68:71], v[36:39], 0
  v_mfma_f32_16x16x32_bf16 v[196:199], v[84:87], v[36:39], 0
  v_cndmask_b32 v136, v6, v136, s[56:57]
  v_cndmask_b32 v137, v6, v137, s[58:59]
  v_cndmask_b32 v138, v6, v138, s[60:61]
  v_cndmask_b32 v139, v6, v139, s[62:63]
  v_cndmask_b32 v140, v6, v140, s[48:49]
  v_cndmask_b32 v141, v6, v141, s[50:51]
  v_cndmask_b32 v142, v6, v142, s[52:53]
  v_cndmask_b32 v143, v6, v143, s[54:55]
  v_max3_f32 v4, v136, v137, v138
  v_max3_f32 v4, v4, v139, v140
  v_max3_f32 v4, v4, v141, v142
  v_max_f32 v4, v4, v143
  v_mov_b32 v5, v4
  s_nop 1
  v_permlane32_swap_b32 v4, v5
  v_max_f32 v4, v4, v5
  v_mov_b32 v5, v4
  s_nop 1
  v_permlane16_swap_b32 v4, v5
  v_max_f32 v4, v4, v5
  v_mul_f32 v4, s21, v4
  v_fma_f32 v136, v136, s21, -v4
  v_fma_f32 v137, v137, s21, -v4
  v_fma_f32 v138, v138, s21, -v4
  v_fma_f32 v139, v139, s21, -v4
  v_fma_f32 v140, v140, s21, -v4
  v_fma_f32 v141, v141, s21, -v4
  v_fma_f32 v142, v142, s21, -v4
  v_fma_f32 v143, v143, s21, -v4
  v_exp_f32 v136, v136
  v_exp_f32 v137, v137
  v_exp_f32 v138, v138
  v_exp_f32 v139, v139
  v_exp_f32 v140, v140
  v_exp_f32 v141, v141
  v_exp_f32 v142, v142
  v_exp_f32 v143, v143
  v_add_f32 v4, v136, v137
  v_add_f32 v4, v4, v138
  v_add_f32 v4, v4, v139
  v_add_f32 v4, v4, v140
  v_add_f32 v4, v4, v141
  v_add_f32 v4, v4, v142
  v_add_f32 v4, v4, v143
  v_mov_b32 v5, v4
  s_nop 1
  v_permlane32_swap_b32 v4, v5
  v_add_f32 v4, v4, v5
  v_mov_b32 v5, v4
  s_nop 1
  v_permlane16_swap_b32 v4, v5
  v_add_f32 v4, v4, v5
  v_rcp_f32 v4, v4
  s_nop 0
  v_mul_f32 v136, v136, v4
  v_mul_f32 v137, v137, v4
  v_mul_f32 v138, v138, v4
  v_mul_f32 v139, v139, v4
  v_mul_f32 v140, v140, v4
  v_mul_f32 v141, v141, v4
  v_mul_f32 v142, v142, v4
  v_mul_f32 v143, v143, v4
  v_cvt_pk_bf16_f32 v8, v136, v137
  v_cvt_pk_bf16_f32 v9, v138, v139
  v_cvt_pk_bf16_f32 v10, v140, v141
  v_cvt_pk_bf16_f32 v11, v142, v143
  v_cndmask_b32 v144, v6, v144, s[56:57]
  v_cndmask_b32 v145, v6, v145, s[58:59]
  v_cndmask_b32 v146, v6, v146, s[60:61]
  v_cndmask_b32 v147, v6, v147, s[62:63]
  v_cndmask_b32 v148, v6, v148, s[48:49]
  v_cndmask_b32 v149, v6, v149, s[50:51]
  v_cndmask_b32 v150, v6, v150, s[52:53]
  v_cndmask_b32 v151, v6, v151, s[54:55]
  v_max3_f32 v4, v144, v145, v146
  v_max3_f32 v4, v4, v147, v148
  v_max3_f32 v4, v4, v149, v150
  v_max_f32 v4, v4, v151
  v_mov_b32 v5, v4
  s_nop 1
  v_permlane32_swap_b32 v4, v5
  v_max_f32 v4, v4, v5
  v_mov_b32 v5, v4
  s_nop 1
  v_permlane16_swap_b32 v4, v5
  v_max_f32 v4, v4, v5
  v_mul_f32 v4, s21, v4
  v_fma_f32 v144, v144, s21, -v4
  v_fma_f32 v145, v145, s21, -v4
  v_fma_f32 v146, v146, s21, -v4
  v_fma_f32 v147, v147, s21, -v4
  v_fma_f32 v148, v148, s21, -v4
  v_fma_f32 v149, v149, s21, -v4
  v_fma_f32 v150, v150, s21, -v4
  v_fma_f32 v151, v151, s21, -v4
  v_exp_f32 v144, v144
  v_exp_f32 v145, v145
  v_exp_f32 v146, v146
  v_exp_f32 v147, v147
  v_exp_f32 v148, v148
  v_exp_f32 v149, v149
  v_exp_f32 v150, v150
  v_exp_f32 v151, v151
  v_add_f32 v4, v144, v145
  v_add_f32 v4, v4, v146
  v_add_f32 v4, v4, v147
  v_add_f32 v4, v4, v148
  v_add_f32 v4, v4, v149
  v_add_f32 v4, v4, v150
  v_add_f32 v4, v4, v151
  v_mov_b32 v5, v4
  s_nop 1
  v_permlane32_swap_b32 v4, v5
  v_add_f32 v4, v4, v5
  v_mov_b32 v5, v4
  s_nop 1
  v_permlane16_swap_b32 v4, v5
  v_add_f32 v4, v4, v5
  v_rcp_f32 v4, v4
  s_nop 0
  v_mul_f32 v144, v144, v4
  v_mul_f32 v145, v145, v4
  v_mul_f32 v146, v146, v4
  v_mul_f32 v147, v147, v4
  v_mul_f32 v148, v148, v4
  v_mul_f32 v149, v149, v4
  v_mul_f32 v150, v150, v4
  v_mul_f32 v151, v151, v4
  v_cvt_pk_bf16_f32 v12, v144, v145
  v_cvt_pk_bf16_f32 v13, v146, v147
  v_cvt_pk_bf16_f32 v14, v148, v149
  v_cvt_pk_bf16_f32 v15, v150, v151
  v_cndmask_b32 v152, v6, v152, s[56:57]
  v_cndmask_b32 v153, v6, v153, s[58:59]
  v_cndmask_b32 v154, v6, v154, s[60:61]
  v_cndmask_b32 v155, v6, v155, s[62:63]
  v_cndmask_b32 v156, v6, v156, s[48:49]
  v_cndmask_b32 v157, v6, v157, s[50:51]
  v_cndmask_b32 v158, v6, v158, s[52:53]
  v_cndmask_b32 v159, v6, v159, s[54:55]
  v_max3_f32 v4, v152, v153, v154
  v_max3_f32 v4, v4, v155, v156
  v_max3_f32 v4, v4, v157, v158
  v_max_f32 v4, v4, v159
  v_mov_b32 v5, v4
  s_nop 1
  v_permlane32_swap_b32 v4, v5
  v_max_f32 v4, v4, v5
  v_mov_b32 v5, v4
  s_nop 1
  v_permlane16_swap_b32 v4, v5
  v_max_f32 v4, v4, v5
  v_mul_f32 v4, s21, v4
  v_fma_f32 v152, v152, s21, -v4
  v_fma_f32 v153, v153, s21, -v4
  v_fma_f32 v154, v154, s21, -v4
  v_fma_f32 v155, v155, s21, -v4
  v_fma_f32 v156, v156, s21, -v4
  v_fma_f32 v157, v157, s21, -v4
  v_fma_f32 v158, v158, s21, -v4
  v_fma_f32 v159, v159, s21, -v4
  v_exp_f32 v152, v152
  v_exp_f32 v153, v153
  v_exp_f32 v154, v154
  v_exp_f32 v155, v155
  v_exp_f32 v156, v156
  v_exp_f32 v157, v157
  v_exp_f32 v158, v158
  v_exp_f32 v159, v159
  v_add_f32 v4, v152, v153
  v_add_f32 v4, v4, v154
  v_add_f32 v4, v4, v155
  v_add_f32 v4, v4, v156
  v_add_f32 v4, v4, v157
  v_add_f32 v4, v4, v158
  v_add_f32 v4, v4, v159
  v_mov_b32 v5, v4
  s_nop 1
  v_permlane32_swap_b32 v4, v5
  v_add_f32 v4, v4, v5
  v_mov_b32 v5, v4
  s_nop 1
  v_permlane16_swap_b32 v4, v5
  v_add_f32 v4, v4, v5
  v_rcp_f32 v4, v4
  s_nop 0
  v_mul_f32 v152, v152, v4
  v_mul_f32 v153, v153, v4
  v_mul_f32 v154, v154, v4
  v_mul_f32 v155, v155, v4
  v_mul_f32 v156, v156, v4
  v_mul_f32 v157, v157, v4
  v_mul_f32 v158, v158, v4
  v_mul_f32 v159, v159, v4
  v_cvt_pk_bf16_f32 v16, v152, v153
  v_cvt_pk_bf16_f32 v17, v154, v155
  v_cvt_pk_bf16_f32 v18, v156, v157
  v_cvt_pk_bf16_f32 v19, v158, v159
  v_cndmask_b32 v160, v6, v160, s[56:57]
  v_cndmask_b32 v161, v6, v161, s[58:59]
  v_cndmask_b32 v162, v6, v162, s[60:61]
  v_cndmask_b32 v163, v6, v163, s[62:63]
  v_cndmask_b32 v164, v6, v164, s[48:49]
  v_cndmask_b32 v165, v6, v165, s[50:51]
  v_cndmask_b32 v166, v6, v166, s[52:53]
  v_cndmask_b32 v167, v6, v167, s[54:55]
  v_max3_f32 v4, v160, v161, v162
  v_max3_f32 v4, v4, v163, v164
  v_max3_f32 v4, v4, v165, v166
  v_max_f32 v4, v4, v167
  v_mov_b32 v5, v4
  s_nop 1
  v_permlane32_swap_b32 v4, v5
  v_max_f32 v4, v4, v5
  v_mov_b32 v5, v4
  s_nop 1
  v_permlane16_swap_b32 v4, v5
  v_max_f32 v4, v4, v5
  v_mul_f32 v4, s21, v4
  v_fma_f32 v160, v160, s21, -v4
  v_fma_f32 v161, v161, s21, -v4
  v_fma_f32 v162, v162, s21, -v4
  v_fma_f32 v163, v163, s21, -v4
  v_fma_f32 v164, v164, s21, -v4
  v_fma_f32 v165, v165, s21, -v4
  v_fma_f32 v166, v166, s21, -v4
  v_fma_f32 v167, v167, s21, -v4
  v_exp_f32 v160, v160
  v_exp_f32 v161, v161
  v_exp_f32 v162, v162
  v_exp_f32 v163, v163
  v_exp_f32 v164, v164
  v_exp_f32 v165, v165
  v_exp_f32 v166, v166
  v_exp_f32 v167, v167
  v_add_f32 v4, v160, v161
  v_add_f32 v4, v4, v162
  v_add_f32 v4, v4, v163
  v_add_f32 v4, v4, v164
  v_add_f32 v4, v4, v165
  v_add_f32 v4, v4, v166
  v_add_f32 v4, v4, v167
  v_mov_b32 v5, v4
  s_nop 1
  v_permlane32_swap_b32 v4, v5
  v_add_f32 v4, v4, v5
  v_mov_b32 v5, v4
  s_nop 1
  v_permlane16_swap_b32 v4, v5
  v_add_f32 v4, v4, v5
  v_rcp_f32 v4, v4
  s_nop 0
  v_mul_f32 v160, v160, v4
  v_mul_f32 v161, v161, v4
  v_mul_f32 v162, v162, v4
  v_mul_f32 v163, v163, v4
  v_mul_f32 v164, v164, v4
  v_mul_f32 v165, v165, v4
  v_mul_f32 v166, v166, v4
  v_mul_f32 v167, v167, v4
  v_cvt_pk_bf16_f32 v20, v160, v161
  v_cvt_pk_bf16_f32 v21, v162, v163
  v_cvt_pk_bf16_f32 v22, v164, v165
  v_cvt_pk_bf16_f32 v23, v166, v167
  v_cndmask_b32 v168, v6, v168, s[40:41]
  v_cndmask_b32 v169, v6, v169, s[42:43]
  v_cndmask_b32 v170, v6, v170, s[44:45]
  v_cndmask_b32 v171, v6, v171, s[46:47]
  v_cndmask_b32 v172, v6, v172, s[48:49]
  v_cndmask_b32 v173, v6, v173, s[50:51]
  v_cndmask_b32 v174, v6, v174, s[52:53]
  v_cndmask_b32 v175, v6, v175, s[54:55]
  v_max3_f32 v4, v168, v169, v170
  v_max3_f32 v4, v4, v171, v172
  v_max3_f32 v4, v4, v173, v174
  v_max_f32 v4, v4, v175
  v_mov_b32 v5, v4
  s_nop 1
  v_permlane32_swap_b32 v4, v5
  v_max_f32 v4, v4, v5
  v_mov_b32 v5, v4
  s_nop 1
  v_permlane16_swap_b32 v4, v5
  v_max_f32 v4, v4, v5
  v_mul_f32 v4, s21, v4
  v_fma_f32 v168, v168, s21, -v4
  v_fma_f32 v169, v169, s21, -v4
  v_fma_f32 v170, v170, s21, -v4
  v_fma_f32 v171, v171, s21, -v4
  v_fma_f32 v172, v172, s21, -v4
  v_fma_f32 v173, v173, s21, -v4
  v_fma_f32 v174, v174, s21, -v4
  v_fma_f32 v175, v175, s21, -v4
  v_exp_f32 v168, v168
  v_exp_f32 v169, v169
  v_exp_f32 v170, v170
  v_exp_f32 v171, v171
  v_exp_f32 v172, v172
  v_exp_f32 v173, v173
  v_exp_f32 v174, v174
  v_exp_f32 v175, v175
  v_add_f32 v4, v168, v169
  v_add_f32 v4, v4, v170
  v_add_f32 v4, v4, v171
  v_add_f32 v4, v4, v172
  v_add_f32 v4, v4, v173
  v_add_f32 v4, v4, v174
  v_add_f32 v4, v4, v175
  v_mov_b32 v5, v4
  s_nop 1
  v_permlane32_swap_b32 v4, v5
  v_add_f32 v4, v4, v5
  v_mov_b32 v5, v4
  s_nop 1
  v_permlane16_swap_b32 v4, v5
  v_add_f32 v4, v4, v5
  v_rcp_f32 v4, v4
  s_nop 0
  v_mul_f32 v168, v168, v4
  v_mul_f32 v169, v169, v4
  v_mul_f32 v170, v170, v4
  v_mul_f32 v171, v171, v4
  v_mul_f32 v172, v172, v4
  v_mul_f32 v173, v173, v4
  v_mul_f32 v174, v174, v4
  v_mul_f32 v175, v175, v4
  v_cvt_pk_bf16_f32 v24, v168, v169
  v_cvt_pk_bf16_f32 v25, v170, v171
  v_cvt_pk_bf16_f32 v26, v172, v173
  v_cvt_pk_bf16_f32 v27, v174, v175
  v_cndmask_b32 v176, v6, v176, s[40:41]
  v_cndmask_b32 v177, v6, v177, s[42:43]
  v_cndmask_b32 v178, v6, v178, s[44:45]
  v_cndmask_b32 v179, v6, v179, s[46:47]
  v_cndmask_b32 v180, v6, v180, s[48:49]
  v_cndmask_b32 v181, v6, v181, s[50:51]
  v_cndmask_b32 v182, v6, v182, s[52:53]
  v_cndmask_b32 v183, v6, v183, s[54:55]
  v_max3_f32 v4, v176, v177, v178
  v_max3_f32 v4, v4, v179, v180
  v_max3_f32 v4, v4, v181, v182
  v_max_f32 v4, v4, v183
  v_mov_b32 v5, v4
  s_nop 1
  v_permlane32_swap_b32 v4, v5
  v_max_f32 v4, v4, v5
  v_mov_b32 v5, v4
  s_nop 1
  v_permlane16_swap_b32 v4, v5
  v_max_f32 v4, v4, v5
  v_mul_f32 v4, s21, v4
  v_fma_f32 v176, v176, s21, -v4
  v_fma_f32 v177, v177, s21, -v4
  v_fma_f32 v178, v178, s21, -v4
  v_fma_f32 v179, v179, s21, -v4
  v_fma_f32 v180, v180, s21, -v4
  v_fma_f32 v181, v181, s21, -v4
  v_fma_f32 v182, v182, s21, -v4
  v_fma_f32 v183, v183, s21, -v4
  v_exp_f32 v176, v176
  v_exp_f32 v177, v177
  v_exp_f32 v178, v178
  v_exp_f32 v179, v179
  v_exp_f32 v180, v180
  v_exp_f32 v181, v181
  v_exp_f32 v182, v182
  v_exp_f32 v183, v183
  v_add_f32 v4, v176, v177
  v_add_f32 v4, v4, v178
  v_add_f32 v4, v4, v179
  v_add_f32 v4, v4, v180
  v_add_f32 v4, v4, v181
  v_add_f32 v4, v4, v182
  v_add_f32 v4, v4, v183
  v_mov_b32 v5, v4
  s_nop 1
  v_permlane32_swap_b32 v4, v5
  v_add_f32 v4, v4, v5
  v_mov_b32 v5, v4
  s_nop 1
  v_permlane16_swap_b32 v4, v5
  v_add_f32 v4, v4, v5
  v_rcp_f32 v4, v4
  s_nop 0
  v_mul_f32 v176, v176, v4
  v_mul_f32 v177, v177, v4
  v_mul_f32 v178, v178, v4
  v_mul_f32 v179, v179, v4
  v_mul_f32 v180, v180, v4
  v_mul_f32 v181, v181, v4
  v_mul_f32 v182, v182, v4
  v_mul_f32 v183, v183, v4
  v_cvt_pk_bf16_f32 v28, v176, v177
  v_cvt_pk_bf16_f32 v29, v178, v179
  v_cvt_pk_bf16_f32 v30, v180, v181
  v_cvt_pk_bf16_f32 v31, v182, v183
  v_cndmask_b32 v184, v6, v184, s[40:41]
  v_cndmask_b32 v185, v6, v185, s[42:43]
  v_cndmask_b32 v186, v6, v186, s[44:45]
  v_cndmask_b32 v187, v6, v187, s[46:47]
  v_cndmask_b32 v188, v6, v188, s[48:49]
  v_cndmask_b32 v189, v6, v189, s[50:51]
  v_cndmask_b32 v190, v6, v190, s[52:53]
  v_cndmask_b32 v191, v6, v191, s[54:55]
  v_max3_f32 v4, v184, v185, v186
  v_max3_f32 v4, v4, v187, v188
  v_max3_f32 v4, v4, v189, v190
  v_max_f32 v4, v4, v191
  v_mov_b32 v5, v4
  s_nop 1
  v_permlane32_swap_b32 v4, v5
  v_max_f32 v4, v4, v5
  v_mov_b32 v5, v4
  s_nop 1
  v_permlane16_swap_b32 v4, v5
  v_max_f32 v4, v4, v5
  v_mul_f32 v4, s21, v4
  v_fma_f32 v184, v184, s21, -v4
  v_fma_f32 v185, v185, s21, -v4
  v_fma_f32 v186, v186, s21, -v4
  v_fma_f32 v187, v187, s21, -v4
  v_fma_f32 v188, v188, s21, -v4
  v_fma_f32 v189, v189, s21, -v4
  v_fma_f32 v190, v190, s21, -v4
  v_fma_f32 v191, v191, s21, -v4
  v_exp_f32 v184, v184
  v_exp_f32 v185, v185
  v_exp_f32 v186, v186
  v_exp_f32 v187, v187
  v_exp_f32 v188, v188
  v_exp_f32 v189, v189
  v_exp_f32 v190, v190
  v_exp_f32 v191, v191
  v_add_f32 v4, v184, v185
  v_add_f32 v4, v4, v186
  v_add_f32 v4, v4, v187
  v_add_f32 v4, v4, v188
  v_add_f32 v4, v4, v189
  v_add_f32 v4, v4, v190
  v_add_f32 v4, v4, v191
  v_mov_b32 v5, v4
  s_nop 1
  v_permlane32_swap_b32 v4, v5
  v_add_f32 v4, v4, v5
  v_mov_b32 v5, v4
  s_nop 1
  v_permlane16_swap_b32 v4, v5
  v_add_f32 v4, v4, v5
  v_rcp_f32 v4, v4
  s_nop 0
  v_mul_f32 v184, v184, v4
  v_mul_f32 v185, v185, v4
  v_mul_f32 v186, v186, v4
  v_mul_f32 v187, v187, v4
  v_mul_f32 v188, v188, v4
  v_mul_f32 v189, v189, v4
  v_mul_f32 v190, v190, v4
  v_mul_f32 v191, v191, v4
  v_cvt_pk_bf16_f32 v32, v184, v185
  v_cvt_pk_bf16_f32 v33, v186, v187
  v_cvt_pk_bf16_f32 v34, v188, v189
  v_cvt_pk_bf16_f32 v35, v190, v191
  v_cndmask_b32 v192, v6, v192, s[40:41]
  v_cndmask_b32 v193, v6, v193, s[42:43]
  v_cndmask_b32 v194, v6, v194, s[44:45]
  v_cndmask_b32 v195, v6, v195, s[46:47]
  v_cndmask_b32 v196, v6, v196, s[48:49]
  v_cndmask_b32 v197, v6, v197, s[50:51]
  v_cndmask_b32 v198, v6, v198, s[52:53]
  v_cndmask_b32 v199, v6, v199, s[54:55]
  v_max3_f32 v4, v192, v193, v194
  v_max3_f32 v4, v4, v195, v196
  v_max3_f32 v4, v4, v197, v198
  v_max_f32 v4, v4, v199
  v_mov_b32 v5, v4
  s_nop 1
  v_permlane32_swap_b32 v4, v5
  v_max_f32 v4, v4, v5
  v_mov_b32 v5, v4
  s_nop 1
  v_permlane16_swap_b32 v4, v5
  v_max_f32 v4, v4, v5
  v_mul_f32 v4, s21, v4
  v_fma_f32 v192, v192, s21, -v4
  v_fma_f32 v193, v193, s21, -v4
  v_fma_f32 v194, v194, s21, -v4
  v_fma_f32 v195, v195, s21, -v4
  v_fma_f32 v196, v196, s21, -v4
  v_fma_f32 v197, v197, s21, -v4
  v_fma_f32 v198, v198, s21, -v4
  v_fma_f32 v199, v199, s21, -v4
  v_exp_f32 v192, v192
  v_exp_f32 v193, v193
  v_exp_f32 v194, v194
  v_exp_f32 v195, v195
  v_exp_f32 v196, v196
  v_exp_f32 v197, v197
  v_exp_f32 v198, v198
  v_exp_f32 v199, v199
  v_add_f32 v4, v192, v193
  v_add_f32 v4, v4, v194
  v_add_f32 v4, v4, v195
  v_add_f32 v4, v4, v196
  v_add_f32 v4, v4, v197
  v_add_f32 v4, v4, v198
  v_add_f32 v4, v4, v199
  v_mov_b32 v5, v4
  s_nop 1
  v_permlane32_swap_b32 v4, v5
  v_add_f32 v4, v4, v5
  v_mov_b32 v5, v4
  s_nop 1
  v_permlane16_swap_b32 v4, v5
  v_add_f32 v4, v4, v5
  v_rcp_f32 v4, v4
  s_nop 0
  v_mul_f32 v192, v192, v4
  v_mul_f32 v193, v193, v4
  v_mul_f32 v194, v194, v4
  v_mul_f32 v195, v195, v4
  v_mul_f32 v196, v196, v4
  v_mul_f32 v197, v197, v4
  v_mul_f32 v198, v198, v4
  v_mul_f32 v199, v199, v4
  v_cvt_pk_bf16_f32 v36, v192, v193
  v_cvt_pk_bf16_f32 v37, v194, v195
  v_cvt_pk_bf16_f32 v38, v196, v197
  v_cvt_pk_bf16_f32 v39, v198, v199
  s_waitcnt vmcnt(0)
  s_cmp_lg_u32 s32, 0
  s_cbranch_scc1 L_rq_90
  s_cmp_eq_u32 s39, 0
  s_cbranch_scc1 L_rq_90
  s_lshl_b32 s99, s33, 7
  s_add_u32 s99, s99, 0x3d00200
  v_mov_b32 v244, 1
  v_mov_b32 v245, 0
  s_mov_b64 exec, 1
  buffer_atomic_add v244, v245, s[4:7], s99 offen sc0 sc1
  s_mov_b64 exec, -1
L_rq_90:
  v_mfma_f32_16x16x32_bf16 v[136:139], v[88:91], v[8:11], 0
  v_mfma_f32_16x16x32_bf16 v[140:143], v[94:97], v[8:11], 0
  v_mfma_f32_16x16x32_bf16 v[144:147], v[100:103], v[12:15], 0
  v_mfma_f32_16x16x32_bf16 v[148:151], v[106:109], v[12:15], 0
  v_mfma_f32_16x16x32_bf16 v[152:155], v[112:115], v[16:19], 0
  v_mfma_f32_16x16x32_bf16 v[156:159], v[118:121], v[16:19], 0
  v_mfma_f32_16x16x32_bf16 v[160:163], v[124:127], v[20:23], 0
  v_mfma_f32_16x16x32_bf16 v[164:167], v[130:133], v[20:23], 0
  v_mfma_f32_16x16x32_bf16 v[168:171], v[90:93], v[24:27], 0
  v_mfma_f32_16x16x32_bf16 v[172:175], v[96:99], v[24:27], 0
  v_mfma_f32_16x16x32_bf16 v[176:179], v[102:105], v[28:31], 0
  v_mfma_f32_16x16x32_bf16 v[180:183], v[108:111], v[28:31], 0
  v_mfma_f32_16x16x32_bf16 v[184:187], v[114:117], v[32:35], 0
  v_mfma_f32_16x16x32_bf16 v[188:191], v[120:123], v[32:35], 0
  v_mfma_f32_16x16x32_bf16 v[192:195], v[126:129], v[36:39], 0
  v_mfma_f32_16x16x32_bf16 v[196:199], v[132:135], v[36:39], 0
  v_cvt_pk_bf16_f32 v40, v136, v137
  v_cvt_pk_bf16_f32 v41, v138, v139
  v_cvt_pk_bf16_f32 v42, v140, v141
  v_cvt_pk_bf16_f32 v43, v142, v143
  buffer_store_dwordx4 v[40:43], v2, s[4:7], s97 offen offset:0 sc1
  v_cvt_pk_bf16_f32 v44, v144, v145
  v_cvt_pk_bf16_f32 v45, v146, v147
  v_cvt_pk_bf16_f32 v46, v148, v149
  v_cvt_pk_bf16_f32 v47, v150, v151
  buffer_store_dwordx4 v[44:47], v2, s[4:7], s97 offen offset:1024 sc1
  v_cvt_pk_bf16_f32 v48, v152, v153
  v_cvt_pk_bf16_f32 v49, v154, v155
  v_cvt_pk_bf16_f32 v50, v156, v157
  v_cvt_pk_bf16_f32 v51, v158, v159
  buffer_store_dwordx4 v[48:51], v2, s[4:7], s97 offen offset:2048 sc1
  v_cvt_pk_bf16_f32 v52, v160, v161
  v_cvt_pk_bf16_f32 v53, v162, v163
  v_cvt_pk_bf16_f32 v54, v164, v165
  v_cvt_pk_bf16_f32 v55, v166, v167
  buffer_store_dwordx4 v[52:55], v2, s[4:7], s97 offen offset:3072 sc1
  v_cvt_pk_bf16_f32 v56, v168, v169
  v_cvt_pk_bf16_f32 v57, v170, v171
  v_cvt_pk_bf16_f32 v58, v172, v173
  v_cvt_pk_bf16_f32 v59, v174, v175
  buffer_store_dwordx4 v[56:59], v3, s[4:7], s97 offen offset:0 sc1
  v_cvt_pk_bf16_f32 v60, v176, v177
  v_cvt_pk_bf16_f32 v61, v178, v179
  v_cvt_pk_bf16_f32 v62, v180, v181
  v_cvt_pk_bf16_f32 v63, v182, v183
  buffer_store_dwordx4 v[60:63], v3, s[4:7], s97 offen offset:1024 sc1
  v_cvt_pk_bf16_f32 v64, v184, v185
  v_cvt_pk_bf16_f32 v65, v186, v187
  v_cvt_pk_bf16_f32 v66, v188, v189
  v_cvt_pk_bf16_f32 v67, v190, v191
  buffer_store_dwordx4 v[64:67], v3, s[4:7], s97 offen offset:2048 sc1
  v_cvt_pk_bf16_f32 v68, v192, v193
  v_cvt_pk_bf16_f32 v69, v194, v195
  v_cvt_pk_bf16_f32 v70, v196, v197
  v_cvt_pk_bf16_f32 v71, v198, v199
  buffer_store_dwordx4 v[68:71], v3, s[4:7], s97 offen offset:3072 sc1
  s_branch L_done
L_ata:
  s_mov_b32 s50, 0
L_ata_c:
  s_lshr_b32 s40, s36, 3
  s_lshl_b32 s40, s40, 9
  s_lshl_b32 s90, s33, 7
  s_add_u32 s40, s40, s90
  s_add_u32 s41, s36, 1
  s_min_u32 s41, s41, 62
  s_lshr_b32 s43, s36, 2
  s_lshl_b32 s43, s43, 9
  s_add_u32 s43, s43, s90
  s_add_u32 s43, s43, 28672
  s_lshl_b32 s42, s33, 1
  s_add_u32 s42, s42, s37
  s_lshl_b32 s42, s42, 7
  s_add_u32 s42, s42, 4096
  s_cmp_ge_u32 s50, 2
  s_cbranch_scc1 L_ata_s
  s_cmp_lg_u32 s32, 0
  s_cbranch_scc1 L_dd_92
  v_mov_b32 v228, 0x3d00000
  v_mov_b32 v230, 0x3d02000
L_dw_91:
  buffer_load_dword v234, v230, s[4:7], s40 offen offset:0 sc1
  buffer_load_dword v235, v228, s[4:7], s43 offen offset:0 sc1
  s_waitcnt vmcnt(0)
  s_mov_b32 s44, 1
  v_readfirstlane_b32 s45, v234
  s_cmp_ge_u32 s45, 4
  s_cselect_b32 s44, s44, 0
  v_readfirstlane_b32 s45, v235
  s_cmp_ge_u32 s45, 16
  s_cselect_b32 s44, s44, 0
  s_cmp_eq_u32 s44, 1
  s_cbranch_scc1 L_dd_92
  s_sleep 6
  s_add_u32 s3, s3, 1
  s_cmp_lt_u32 s3, 131072
  s_cbranch_scc1 L_dw_91
L_dd_92:
  s_barrier
L_ata_s:
  s_mov_b32 s98, 1
  s_lshr_b32 s38, s36, 2
  s_lshl_b32 s38, s38, 7
  s_add_u32 s38, s38, 2048
  s_lshr_b32 s90, s36, 1
  s_sub_u32 s90, s90, 24
  s_lshl_b32 s90, s90, 2
  s_add_u32 s90, s90, s33
  s_lshl_b32 s90, s90, 1
  s_add_u32 s90, s90, s37
  s_lshl_b32 s90, s90, 7
  s_add_u32 s90, s90, 20480
  s_cmp_ge_u32 s36, 60
  s_cselect_b32 s38, s90, s38
  s_lshl_b32 s20, s36, 5
  s_lshl_b32 s90, s33, 3
  s_add_u32 s20, s20, s90
  s_lshl_b32 s90, s37, 2
  s_add_u32 s20, s20, s90
  s_add_u32 s20, s20, s32
  v_and_b32 v1, 63, v0
  v_mov_b32 v228, 0x3d00000
  s_lshl_b32 s45, s33, 7
  buffer_load_dword v238, v228, s[4:7], s45 offen offset:0 sc1
  s_lshl_b32 s90, s20, 13
  s_lshl_b32 s91, s20, 11
  v_mov_b32 v2, 0x0
  v_bfe_u32 v7, v1, 0, 6
  v_lshl_add_u32 v2, v7, 4, v2
  v_add_u32 v3, 4096, v2
  v_mov_b32 v4, 0x3000000
  v_bfe_u32 v7, v1, 0, 1
  v_lshl_add_u32 v4, v7, 4, v4
  v_bfe_u32 v7, v1, 2, 2
  v_lshl_add_u32 v4, v7, 5, v4
  v_bfe_u32 v7, v1, 4, 2
  v_lshl_add_u32 v4, v7, 7, v4
  v_add_u32 v5, 0x3400000, v2
  v_mov_b32 v8, 0x0
  v_bfe_u32 v7, v1, 0, 3
  v_lshl_add_u32 v8, v7, 4, v8
  v_bfe_u32 v7, v1, 3, 1
  v_lshl_add_u32 v8, v7, 11, v8
  v_bfe_u32 v7, v1, 4, 2
  v_lshl_add_u32 v8, v7, 8, v8
  v_add_u32 v9, 4096, v8
  v_mov_b32 v10, 0x0
  v_bfe_u32 v7, v1, 0, 4
  v_lshl_add_u32 v10, v7, 4, v10
  v_bfe_u32 v7, v1, 4, 1
  v_lshl_add_u32 v10, v7, 8, v10
  v_bfe_u32 v7, v1, 5, 1
  v_lshl_add_u32 v10, v7, 10, v10
  v_add_u32 v11, 4096, v10
  s_add_u32 s92, s90, 16777216
  s_add_u32 s93, s90, 33554432
  s_add_u32 s94, s90, 0
  s_add_u32 s95, s90, 83886080
  buffer_load_dwordx4 v[16:19], v2, s[4:7], s94 offen offset:0 sc1
  buffer_load_dwordx4 v[20:23], v2, s[4:7], s94 offen offset:1024 sc1
  buffer_load_dwordx4 v[24:27], v2, s[4:7], s94 offen offset:2048 sc1
  buffer_load_dwordx4 v[28:31], v2, s[4:7], s94 offen offset:3072 sc1
  buffer_load_dwordx4 v[32:35], v3, s[4:7], s94 offen offset:0 sc1
  buffer_load_dwordx4 v[36:39], v3, s[4:7], s94 offen offset:1024 sc1
  buffer_load_dwordx4 v[40:43], v3, s[4:7], s94 offen offset:2048 sc1
  buffer_load_dwordx4 v[44:47], v3, s[4:7], s94 offen offset:3072 sc1
  buffer_load_dwordx4 v[48:51], v2, s[4:7], s92 offen offset:0 sc1
  buffer_load_dwordx4 v[52:55], v2, s[4:7], s92 offen offset:1024 sc1
  buffer_load_dwordx4 v[56:59], v2, s[4:7], s92 offen offset:2048 sc1
  buffer_load_dwordx4 v[60:63], v2, s[4:7], s92 offen offset:3072 sc1
  buffer_load_dwordx4 v[64:67], v3, s[4:7], s92 offen offset:0 sc1
  buffer_load_dwordx4 v[68:71], v3, s[4:7], s92 offen offset:1024 sc1
  buffer_load_dwordx4 v[72:75], v3, s[4:7], s92 offen offset:2048 sc1
  buffer_load_dwordx4 v[76:79], v3, s[4:7], s92 offen offset:3072 sc1
  buffer_load_dwordx4 v[80:83], v8, s[4:7], s93 offen offset:0 sc1
  buffer_load_dwordx4 v[84:87], v8, s[4:7], s93 offen offset:128 sc1
  buffer_load_dwordx4 v[88:91], v8, s[4:7], s93 offen offset:1024 sc1
  buffer_load_dwordx4 v[92:95], v8, s[4:7], s93 offen offset:1152 sc1
  buffer_load_dwordx4 v[96:99], v9, s[4:7], s93 offen offset:0 sc1
  buffer_load_dwordx4 v[100:103], v9, s[4:7], s93 offen offset:128 sc1
  buffer_load_dwordx4 v[104:107], v9, s[4:7], s93 offen offset:1024 sc1
  buffer_load_dwordx4 v[108:111], v9, s[4:7], s93 offen offset:1152 sc1
  s_waitcnt vmcnt(24)
L_m1:
  v_readfirstlane_b32 s44, v238
  s_cmp_ge_u32 s44, s41
  s_cbranch_scc1 L_m1d
  s_add_u32 s3, s3, 1
  s_cmp_ge_u32 s3, 131072
  s_cbranch_scc1 L_m1d
  s_sleep 3
  buffer_load_dword v238, v228, s[4:7], s45 offen offset:0 sc1
  s_waitcnt vmcnt(0)
  s_branch L_m1
L_m1d:
  buffer_load_dwordx4 v[112:115], v4, s[4:7], s91 offen offset:0 sc1
  buffer_load_dwordx4 v[116:119], v4, s[4:7], s91 offen offset:512 sc1
  buffer_load_dwordx4 v[120:123], v4, s[4:7], s91 offen offset:1024 sc1
  buffer_load_dwordx4 v[124:127], v4, s[4:7], s91 offen offset:1536 sc1
  buffer_load_dwordx4 v[128:131], v5, s[4:7], s91 offen offset:0 sc1
  buffer_load_dwordx4 v[132:135], v5, s[4:7], s91 offen offset:1024 sc1
  s_mov_b32 s40, 0xfff0ffff
  s_mov_b32 s41, 0xf000ff00
  s_mov_b32 s42, 0xffe0fffe
  s_mov_b32 s43, 0xe000fe00
  s_mov_b32 s44, 0xffc0fffc
  s_mov_b32 s45, 0xc000fc00
  s_mov_b32 s46, 0xff80fff8
  s_mov_b32 s47, 0x8000f800
  s_mov_b32 s50, 0x3e0293ee
  v_mov_b32 v6, 0xd028965f
  s_waitcnt vmcnt(6)
  v_mfma_f32_16x16x32_bf16 v[140:143], v[48:51], v[16:19], 0
  v_mfma_f32_16x16x32_bf16 v[148:151], v[48:51], v[32:35], 0
  v_mfma_f32_16x16x32_bf16 v[152:155], v[64:67], v[32:35], 0
  v_mfma_f32_16x16x32_bf16 v[140:143], v[52:55], v[20:23], v[140:143]
  v_mfma_f32_16x16x32_bf16 v[148:151], v[52:55], v[36:39], v[148:151]
  v_mfma_f32_16x16x32_bf16 v[152:155], v[68:71], v[36:39], v[152:155]
  v_mfma_f32_16x16x32_bf16 v[140:143], v[56:59], v[24:27], v[140:143]
  v_mfma_f32_16x16x32_bf16 v[148:151], v[56:59], v[40:43], v[148:151]
  v_mfma_f32_16x16x32_bf16 v[152:155], v[72:75], v[40:43], v[152:155]
  v_mfma_f32_16x16x32_bf16 v[140:143], v[60:63], v[28:31], v[140:143]
  v_mfma_f32_16x16x32_bf16 v[148:151], v[60:63], v[44:47], v[148:151]
  v_mfma_f32_16x16x32_bf16 v[152:155], v[76:79], v[44:47], v[152:155]
L_av:
  s_waitcnt vmcnt(0)
  v_max3_u32 v12, v112, v113, v114
  v_max3_u32 v12, v12, v115, v116
  v_max3_u32 v12, v12, v117, v118
  v_max3_u32 v12, v12, v119, v120
  v_max3_u32 v12, v12, v121, v122
  v_max3_u32 v12, v12, v123, v124
  v_max3_u32 v12, v12, v125, v126
  v_max3_u32 v12, v12, v127, v128
  v_max3_u32 v12, v12, v129, v130
  v_max3_u32 v12, v12, v131, v132
  v_max3_u32 v12, v12, v133, v134
  v_max_u32 v12, v12, v135
  v_cmp_eq_u32 vcc, -1, v12
  s_cbranch_vccz L_avd
  s_add_u32 s3, s3, 1
  s_cmp_ge_u32 s3, 131072
  s_cbranch_scc1 L_avd
  buffer_load_dwordx4 v[112:115], v4, s[4:7], s91 offen offset:0 sc1
  buffer_load_dwordx4 v[116:119], v4, s[4:7], s91 offen offset:512 sc1
  buffer_load_dwordx4 v[120:123], v4, s[4:7], s91 offen offset:1024 sc1
  buffer_load_dwordx4 v[124:127], v4, s[4:7], s91 offen offset:1536 sc1
  buffer_load_dwordx4 v[128:131], v5, s[4:7], s91 offen offset:0 sc1
  buffer_load_dwordx4 v[132:135], v5, s[4:7], s91 offen offset:1024 sc1
  s_branch L_av
L_avd:
  s_waitcnt vmcnt(0)
  s_cmp_lt_u32 s36, 60
  s_cbranch_scc1 L_rf_93
  s_cmp_lg_u32 s32, 0
  s_cbranch_scc1 L_rq_94
  s_cmp_eq_u32 s39, 0
  s_cbranch_scc1 L_rq_94
  s_lshl_b32 s99, s33, 7
  s_add_u32 s99, s99, 0x3d00200
  v_mov_b32 v244, 1
  v_mov_b32 v245, 0
  s_mov_b64 exec, 1
  buffer_atomic_add v244, v245, s[4:7], s99 offen sc0 sc1
  s_mov_b64 exec, -1
L_rq_94:
L_rf_93:
  v_mfma_f32_16x16x32_bf16 v[136:139], v[112:115], v[16:19], 0
  v_mfma_f32_16x16x32_bf16 v[144:147], v[112:115], v[32:35], 0
  v_mfma_f32_16x16x32_bf16 v[136:139], v[116:119], v[20:23], v[136:139]
  v_mfma_f32_16x16x32_bf16 v[144:147], v[116:119], v[36:39], v[144:147]
  v_mfma_f32_16x16x32_bf16 v[136:139], v[120:123], v[24:27], v[136:139]
  v_mfma_f32_16x16x32_bf16 v[144:147], v[120:123], v[40:43], v[144:147]
  v_mfma_f32_16x16x32_bf16 v[136:139], v[124:127], v[28:31], v[136:139]
  v_mfma_f32_16x16x32_bf16 v[144:147], v[124:127], v[44:47], v[144:147]
  v_cndmask_b32 v140, v6, v140, s[40:41]
  v_cndmask_b32 v141, v6, v141, s[42:43]
  v_cndmask_b32 v142, v6, v142, s[44:45]
  v_cndmask_b32 v143, v6, v143, s[46:47]
  s_nop 2
  v_max3_f32 v12, v136, v137, v140
  v_max3_f32 v12, v12, v141, v142
  v_max_f32 v12, v12, v143
  v_mov_b32 v13, v12
  s_nop 1
  v_permlane32_swap_b32 v12, v13
  v_max_f32 v12, v12, v13
  v_mov_b32 v13, v12
  s_nop 1
  v_permlane16_swap_b32 v12, v13
  v_max_f32 v12, v12, v13
  v_mul_f32 v12, s50, v12
  v_fma_f32 v136, v136, s50, -v12
  v_fma_f32 v137, v137, s50, -v12
  v_fma_f32 v140, v140, s50, -v12
  v_fma_f32 v141, v141, s50, -v12
  v_fma_f32 v142, v142, s50, -v12
  v_fma_f32 v143, v143, s50, -v12
  v_exp_f32 v136, v136
  v_exp_f32 v137, v137
  v_exp_f32 v140, v140
  v_exp_f32 v141, v141
  v_exp_f32 v142, v142
  v_exp_f32 v143, v143
  v_add_f32 v12, v136, v137
  v_add_f32 v12, v12, v140
  v_add_f32 v12, v12, v141
  v_add_f32 v12, v12, v142
  v_add_f32 v12, v12, v143
  v_mov_b32 v13, v12
  s_nop 1
  v_permlane32_swap_b32 v12, v13
  v_add_f32 v12, v12, v13
  v_mov_b32 v13, v12
  s_nop 1
  v_permlane16_swap_b32 v12, v13
  v_add_f32 v12, v12, v13
  v_rcp_f32 v12, v12
  s_nop 0
  v_mul_f32 v136, v136, v12
  v_mul_f32 v137, v137, v12
  v_mul_f32 v140, v140, v12
  v_mul_f32 v141, v141, v12
  v_mul_f32 v142, v142, v12
  v_mul_f32 v143, v143, v12
  v_cvt_pk_bf16_f32 v160, v136, v137
  v_mov_b32 v161, 0
  v_mov_b32 v162, 0
  v_mov_b32 v163, v160
  v_cvt_pk_bf16_f32 v156, v140, v141
  v_cvt_pk_bf16_f32 v157, v142, v143
  v_mov_b32 v158, 0
  v_mov_b32 v159, 0
  v_cndmask_b32 v152, v6, v152, s[40:41]
  v_cndmask_b32 v153, v6, v153, s[42:43]
  v_cndmask_b32 v154, v6, v154, s[44:45]
  v_cndmask_b32 v155, v6, v155, s[46:47]
  v_max3_f32 v12, v144, v145, v148
  v_max3_f32 v12, v12, v149, v150
  v_max3_f32 v12, v12, v151, v152
  v_max3_f32 v12, v12, v153, v154
  v_max_f32 v12, v12, v155
  v_mov_b32 v13, v12
  s_nop 1
  v_permlane32_swap_b32 v12, v13
  v_max_f32 v12, v12, v13
  v_mov_b32 v13, v12
  s_nop 1
  v_permlane16_swap_b32 v12, v13
  v_max_f32 v12, v12, v13
  v_mul_f32 v12, s50, v12
  v_fma_f32 v144, v144, s50, -v12
  v_fma_f32 v145, v145, s50, -v12
  v_fma_f32 v148, v148, s50, -v12
  v_fma_f32 v149, v149, s50, -v12
  v_fma_f32 v150, v150, s50, -v12
  v_fma_f32 v151, v151, s50, -v12
  v_fma_f32 v152, v152, s50, -v12
  v_fma_f32 v153, v153, s50, -v12
  v_fma_f32 v154, v154, s50, -v12
  v_fma_f32 v155, v155, s50, -v12
  v_exp_f32 v144, v144
  v_exp_f32 v145, v145
  v_exp_f32 v148, v148
  v_exp_f32 v149, v149
  v_exp_f32 v150, v150
  v_exp_f32 v151, v151
  v_exp_f32 v152, v152
  v_exp_f32 v153, v153
  v_exp_f32 v154, v154
  v_exp_f32 v155, v155
  v_add_f32 v12, v144, v145
  v_add_f32 v12, v12, v148
  v_add_f32 v12, v12, v149
  v_add_f32 v12, v12, v150
  v_add_f32 v12, v12, v151
  v_add_f32 v12, v12, v152
  v_add_f32 v12, v12, v153
  v_add_f32 v12, v12, v154
  v_add_f32 v12, v12, v155
  v_mov_b32 v13, v12
  s_nop 1
  v_permlane32_swap_b32 v12, v13
  v_add_f32 v12, v12, v13
  v_mov_b32 v13, v12
  s_nop 1
  v_permlane16_swap_b32 v12, v13
  v_add_f32 v12, v12, v13
  v_rcp_f32 v12, v12
  s_nop 0
  v_mul_f32 v144, v144, v12
  v_mul_f32 v145, v145, v12
  v_mul_f32 v148, v148, v12
  v_mul_f32 v149, v149, v12
  v_mul_f32 v150, v150, v12
  v_mul_f32 v151, v151, v12
  v_mul_f32 v152, v152, v12
  v_mul_f32 v153, v153, v12
  v_mul_f32 v154, v154, v12
  v_mul_f32 v155, v155, v12
  v_cvt_pk_bf16_f32 v168, v144, v145
  v_mov_b32 v169, 0
  v_mov_b32 v170, 0
  v_mov_b32 v171, v168
  v_cvt_pk_bf16_f32 v164, v148, v149
  v_cvt_pk_bf16_f32 v165, v150, v151
  v_cvt_pk_bf16_f32 v166, v152, v153
  v_cvt_pk_bf16_f32 v167, v154, v155
  v_mfma_f32_16x16x32_bf16 v[176:179], v[80:83], v[156:159], 0
  v_mfma_f32_16x16x32_bf16 v[180:183], v[84:87], v[156:159], 0
  v_mfma_f32_16x16x32_bf16 v[184:187], v[88:91], v[156:159], 0
  v_mfma_f32_16x16x32_bf16 v[188:191], v[92:95], v[156:159], 0
  v_mfma_f32_16x16x32_bf16 v[192:195], v[96:99], v[156:159], 0
  v_mfma_f32_16x16x32_bf16 v[196:199], v[100:103], v[156:159], 0
  v_mfma_f32_16x16x32_bf16 v[200:203], v[104:107], v[156:159], 0
  v_mfma_f32_16x16x32_bf16 v[204:207], v[108:111], v[156:159], 0
  v_mfma_f32_16x16x16_bf16 v[176:179], v[128:129], v[160:161], v[176:179]
  v_mfma_f32_16x16x16_bf16 v[180:183], v[128:129], v[162:163], v[180:183]
  v_mfma_f32_16x16x16_bf16 v[184:187], v[130:131], v[160:161], v[184:187]
  v_mfma_f32_16x16x16_bf16 v[188:191], v[130:131], v[162:163], v[188:191]
  v_mfma_f32_16x16x16_bf16 v[192:195], v[132:133], v[160:161], v[192:195]
  v_mfma_f32_16x16x16_bf16 v[196:199], v[132:133], v[162:163], v[196:199]
  v_mfma_f32_16x16x16_bf16 v[200:203], v[134:135], v[160:161], v[200:203]
  v_mfma_f32_16x16x16_bf16 v[204:207], v[134:135], v[162:163], v[204:207]
  v_mfma_f32_16x16x32_bf16 v[208:211], v[80:83], v[164:167], 0
  v_mfma_f32_16x16x32_bf16 v[212:215], v[84:87], v[164:167], 0
  v_mfma_f32_16x16x32_bf16 v[216:219], v[88:91], v[164:167], 0
  v_mfma_f32_16x16x32_bf16 v[220:223], v[92:95], v[164:167], 0
  v_mfma_f32_16x16x32_bf16 v[224:227], v[96:99], v[164:167], 0
  v_mfma_f32_16x16x32_bf16 v[228:231], v[100:103], v[164:167], 0
  v_mfma_f32_16x16x32_bf16 v[232:235], v[104:107], v[164:167], 0
  v_mfma_f32_16x16x32_bf16 v[236:239], v[108:111], v[164:167], 0
  v_mfma_f32_16x16x16_bf16 v[208:211], v[128:129], v[168:169], v[208:211]
  v_mfma_f32_16x16x16_bf16 v[212:215], v[128:129], v[170:171], v[212:215]
  v_mfma_f32_16x16x16_bf16 v[216:219], v[130:131], v[168:169], v[216:219]
  v_mfma_f32_16x16x16_bf16 v[220:223], v[130:131], v[170:171], v[220:223]
  v_mfma_f32_16x16x16_bf16 v[224:227], v[132:133], v[168:169], v[224:227]
  v_mfma_f32_16x16x16_bf16 v[228:231], v[132:133], v[170:171], v[228:231]
  v_mfma_f32_16x16x16_bf16 v[232:235], v[134:135], v[168:169], v[232:235]
  v_mfma_f32_16x16x16_bf16 v[236:239], v[134:135], v[170:171], v[236:239]
  v_cvt_pk_bf16_f32 v136, v176, v177
  v_cvt_pk_bf16_f32 v137, v178, v179
  v_cvt_pk_bf16_f32 v138, v184, v185
  v_cvt_pk_bf16_f32 v139, v186, v187
  buffer_store_dwordx4 v[136:139], v10, s[4:7], s95 offen offset:0 sc1
  v_cvt_pk_bf16_f32 v140, v180, v181
  v_cvt_pk_bf16_f32 v141, v182, v183
  v_cvt_pk_bf16_f32 v142, v188, v189
  v_cvt_pk_bf16_f32 v143, v190, v191
  buffer_store_dwordx4 v[140:143], v10, s[4:7], s95 offen offset:512 sc1
  v_cvt_pk_bf16_f32 v144, v192, v193
  v_cvt_pk_bf16_f32 v145, v194, v195
  v_cvt_pk_bf16_f32 v146, v200, v201
  v_cvt_pk_bf16_f32 v147, v202, v203
  buffer_store_dwordx4 v[144:147], v10, s[4:7], s95 offen offset:2048 sc1
  v_cvt_pk_bf16_f32 v148, v196, v197
  v_cvt_pk_bf16_f32 v149, v198, v199
  v_cvt_pk_bf16_f32 v150, v204, v205
  v_cvt_pk_bf16_f32 v151, v206, v207
  buffer_store_dwordx4 v[148:151], v10, s[4:7], s95 offen offset:2560 sc1
  v_cvt_pk_bf16_f32 v136, v208, v209
  v_cvt_pk_bf16_f32 v137, v210, v211
  v_cvt_pk_bf16_f32 v138, v216, v217
  v_cvt_pk_bf16_f32 v139, v218, v219
  buffer_store_dwordx4 v[136:139], v11, s[4:7], s95 offen offset:0 sc1
  v_cvt_pk_bf16_f32 v140, v212, v213
  v_cvt_pk_bf16_f32 v141, v214, v215
  v_cvt_pk_bf16_f32 v142, v220, v221
  v_cvt_pk_bf16_f32 v143, v222, v223
  buffer_store_dwordx4 v[140:143], v11, s[4:7], s95 offen offset:512 sc1
  v_cvt_pk_bf16_f32 v144, v224, v225
  v_cvt_pk_bf16_f32 v145, v226, v227
  v_cvt_pk_bf16_f32 v146, v232, v233
  v_cvt_pk_bf16_f32 v147, v234, v235
  buffer_store_dwordx4 v[144:147], v11, s[4:7], s95 offen offset:2048 sc1
  v_cvt_pk_bf16_f32 v148, v228, v229
  v_cvt_pk_bf16_f32 v149, v230, v231
  v_cvt_pk_bf16_f32 v150, v236, v237
  v_cvt_pk_bf16_f32 v151, v238, v239
  buffer_store_dwordx4 v[148:151], v11, s[4:7], s95 offen offset:2560 sc1
  s_add_u32 s95, s95, 262144
  s_branch L_done
L_ata4:
  s_lshr_b32 s40, s36, 3
  s_lshl_b32 s40, s40, 9
  s_lshl_b32 s90, s33, 7
  s_add_u32 s40, s40, s90
  s_add_u32 s41, s36, 4
  s_lshr_b32 s43, s36, 2
  s_lshl_b32 s43, s43, 9
  s_add_u32 s43, s43, s90
  s_add_u32 s43, s43, 28672
  s_lshl_b32 s42, s33, 1
  s_add_u32 s42, s42, s37
  s_lshl_b32 s42, s42, 7
  s_add_u32 s42, s42, 4096
  s_cmp_lg_u32 s32, 0
  s_cbranch_scc1 L_dd_96
  v_mov_b32 v228, 0x3d00000
  v_mov_b32 v230, 0x3d02000
L_dw_95:
  buffer_load_dword v234, v230, s[4:7], s40 offen offset:0 sc1
  buffer_load_dword v235, v228, s[4:7], s43 offen offset:0 sc1
  s_lshl_b32 s45, s33, 7
  buffer_load_dword v238, v228, s[4:7], s45 offen offset:0 sc1
  buffer_load_dword v239, v228, s[4:7], s42 offen sc1
  s_waitcnt vmcnt(0)
  s_mov_b32 s44, 1
  v_readfirstlane_b32 s45, v234
  s_cmp_ge_u32 s45, 4
  s_cselect_b32 s44, s44, 0
  v_readfirstlane_b32 s45, v235
  s_cmp_ge_u32 s45, 16
  s_cselect_b32 s44, s44, 0
  v_readfirstlane_b32 s45, v238
  v_readfirstlane_b32 s47, v239
  s_cmp_ge_u32 s47, 16
  s_cselect_b32 s45, 64, s45
  s_cmp_ge_u32 s45, s41
  s_cselect_b32 s44, s44, 0
  s_cmp_eq_u32 s44, 1
  s_cbranch_scc1 L_dd_96
  s_sleep 6
  s_add_u32 s3, s3, 1
  s_cmp_lt_u32 s3, 131072
  s_cbranch_scc1 L_dw_95
L_dd_96:
  s_barrier
  s_mov_b32 s98, 4
  s_lshr_b32 s38, s36, 2
  s_lshl_b32 s38, s38, 7
  s_add_u32 s38, s38, 2048
  s_lshl_b32 s20, s36, 5
  s_lshl_b32 s90, s33, 3
  s_add_u32 s20, s20, s90
  s_lshl_b32 s90, s37, 2
  s_add_u32 s20, s20, s90
  s_add_u32 s20, s20, s32
  v_and_b32 v1, 63, v0
  s_lshl_b32 s90, s20, 13
  s_lshl_b32 s91, s20, 11
  v_mov_b32 v2, 0x0
  v_bfe_u32 v7, v1, 0, 6
  v_lshl_add_u32 v2, v7, 4, v2
  v_add_u32 v3, 4096, v2
  v_mov_b32 v4, 0x3000000
  v_bfe_u32 v7, v1, 0, 1
  v_lshl_add_u32 v4, v7, 4, v4
  v_bfe_u32 v7, v1, 2, 2
  v_lshl_add_u32 v4, v7, 5, v4
  v_bfe_u32 v7, v1, 4, 2
  v_lshl_add_u32 v4, v7, 7, v4
  v_add_u32 v5, 0x3400000, v2
  v_mov_b32 v8, 0x0
  v_bfe_u32 v7, v1, 0, 3
  v_lshl_add_u32 v8, v7, 4, v8
  v_bfe_u32 v7, v1, 3, 1
  v_lshl_add_u32 v8, v7, 11, v8
  v_bfe_u32 v7, v1, 4, 2
  v_lshl_add_u32 v8, v7, 8, v8
  v_add_u32 v9, 4096, v8
  v_mov_b32 v10, 0x0
  v_bfe_u32 v7, v1, 0, 4
  v_lshl_add_u32 v10, v7, 4, v10
  v_bfe_u32 v7, v1, 4, 1
  v_lshl_add_u32 v10, v7, 8, v10
  v_bfe_u32 v7, v1, 5, 1
  v_lshl_add_u32 v10, v7, 10, v10
  v_add_u32 v11, 4096, v10
  s_add_u32 s92, s90, 16777216
  s_add_u32 s93, s90, 33554432
  s_add_u32 s94, s90, 0
  s_add_u32 s95, s90, 83886080
  buffer_load_dwordx4 v[16:19], v2, s[4:7], s94 offen offset:0 sc1
  buffer_load_dwordx4 v[20:23], v2, s[4:7], s94 offen offset:1024 sc1
  buffer_load_dwordx4 v[24:27], v2, s[4:7], s94 offen offset:2048 sc1
  buffer_load_dwordx4 v[28:31], v2, s[4:7], s94 offen offset:3072 sc1
  buffer_load_dwordx4 v[32:35], v3, s[4:7], s94 offen offset:0 sc1
  buffer_load_dwordx4 v[36:39], v3, s[4:7], s94 offen offset:1024 sc1
  buffer_load_dwordx4 v[40:43], v3, s[4:7], s94 offen offset:2048 sc1
  buffer_load_dwordx4 v[44:47], v3, s[4:7], s94 offen offset:3072 sc1
  buffer_load_dwordx4 v[48:51], v2, s[4:7], s92 offen offset:0 sc1
  buffer_load_dwordx4 v[52:55], v2, s[4:7], s92 offen offset:1024 sc1
  buffer_load_dwordx4 v[56:59], v2, s[4:7], s92 offen offset:2048 sc1
  buffer_load_dwordx4 v[60:63], v2, s[4:7], s92 offen offset:3072 sc1
  buffer_load_dwordx4 v[64:67], v3, s[4:7], s92 offen offset:0 sc1
  buffer_load_dwordx4 v[68:71], v3, s[4:7], s92 offen offset:1024 sc1
  buffer_load_dwordx4 v[72:75], v3, s[4:7], s92 offen offset:2048 sc1
  buffer_load_dwordx4 v[76:79], v3, s[4:7], s92 offen offset:3072 sc1
  buffer_load_dwordx4 v[80:83], v8, s[4:7], s93 offen offset:0 sc1
  buffer_load_dwordx4 v[84:87], v8, s[4:7], s93 offen offset:128 sc1
  buffer_load_dwordx4 v[88:91], v8, s[4:7], s93 offen offset:1024 sc1
  buffer_load_dwordx4 v[92:95], v8, s[4:7], s93 offen offset:1152 sc1
  buffer_load_dwordx4 v[96:99], v9, s[4:7], s93 offen offset:0 sc1
  buffer_load_dwordx4 v[100:103], v9, s[4:7], s93 offen offset:128 sc1
  buffer_load_dwordx4 v[104:107], v9, s[4:7], s93 offen offset:1024 sc1
  buffer_load_dwordx4 v[108:111], v9, s[4:7], s93 offen offset:1152 sc1
  buffer_load_dwordx4 v[112:115], v4, s[4:7], s91 offen offset:0 sc1
  buffer_load_dwordx4 v[116:119], v4, s[4:7], s91 offen offset:512 sc1
  buffer_load_dwordx4 v[120:123], v4, s[4:7], s91 offen offset:1024 sc1
  buffer_load_dwordx4 v[124:127], v4, s[4:7], s91 offen offset:1536 sc1
  buffer_load_dwordx4 v[128:131], v5, s[4:7], s91 offen offset:0 sc1
  buffer_load_dwordx4 v[132:135], v5, s[4:7], s91 offen offset:1024 sc1
  s_add_u32 s92, s92, 262144
  s_add_u32 s93, s93, 262144
  s_add_u32 s94, s94, 262144
  s_add_u32 s91, s91, 65536
  buffer_load_dwordx4 a[0:3], v2, s[4:7], s94 offen offset:0 sc1
  buffer_load_dwordx4 a[4:7], v2, s[4:7], s94 offen offset:1024 sc1
  buffer_load_dwordx4 a[8:11], v2, s[4:7], s94 offen offset:2048 sc1
  buffer_load_dwordx4 a[12:15], v2, s[4:7], s94 offen offset:3072 sc1
  buffer_load_dwordx4 a[16:19], v3, s[4:7], s94 offen offset:0 sc1
  buffer_load_dwordx4 a[20:23], v3, s[4:7], s94 offen offset:1024 sc1
  buffer_load_dwordx4 a[24:27], v3, s[4:7], s94 offen offset:2048 sc1
  buffer_load_dwordx4 a[28:31], v3, s[4:7], s94 offen offset:3072 sc1
  buffer_load_dwordx4 a[32:35], v2, s[4:7], s92 offen offset:0 sc1
  buffer_load_dwordx4 a[36:39], v2, s[4:7], s92 offen offset:1024 sc1
  buffer_load_dwordx4 a[40:43], v2, s[4:7], s92 offen offset:2048 sc1
  buffer_load_dwordx4 a[44:47], v2, s[4:7], s92 offen offset:3072 sc1
  buffer_load_dwordx4 a[48:51], v3, s[4:7], s92 offen offset:0 sc1
  buffer_load_dwordx4 a[52:55], v3, s[4:7], s92 offen offset:1024 sc1
  buffer_load_dwordx4 a[56:59], v3, s[4:7], s92 offen offset:2048 sc1
  buffer_load_dwordx4 a[60:63], v3, s[4:7], s92 offen offset:3072 sc1
  buffer_load_dwordx4 a[64:67], v8, s[4:7], s93 offen offset:0 sc1
  buffer_load_dwordx4 a[68:71], v8, s[4:7], s93 offen offset:128 sc1
  buffer_load_dwordx4 a[72:75], v8, s[4:7], s93 offen offset:1024 sc1
  buffer_load_dwordx4 a[76:79], v8, s[4:7], s93 offen offset:1152 sc1
  buffer_load_dwordx4 a[80:83], v9, s[4:7], s93 offen offset:0 sc1
  buffer_load_dwordx4 a[84:87], v9, s[4:7], s93 offen offset:128 sc1
  buffer_load_dwordx4 a[88:91], v9, s[4:7], s93 offen offset:1024 sc1
  buffer_load_dwordx4 a[92:95], v9, s[4:7], s93 offen offset:1152 sc1
  buffer_load_dwordx4 a[96:99], v4, s[4:7], s91 offen offset:0 sc1
  buffer_load_dwordx4 a[100:103], v4, s[4:7], s91 offen offset:512 sc1
  buffer_load_dwordx4 a[104:107], v4, s[4:7], s91 offen offset:1024 sc1
  buffer_load_dwordx4 a[108:111], v4, s[4:7], s91 offen offset:1536 sc1
  buffer_load_dwordx4 a[112:115], v5, s[4:7], s91 offen offset:0 sc1
  buffer_load_dwordx4 a[116:119], v5, s[4:7], s91 offen offset:1024 sc1
  s_add_u32 s92, s92, 262144
  s_add_u32 s93, s93, 262144
  s_add_u32 s94, s94, 262144
  s_add_u32 s91, s91, 65536
  s_mov_b32 s40, 0xfff0ffff
  s_mov_b32 s41, 0xf000ff00
  s_mov_b32 s42, 0xffe0fffe
  s_mov_b32 s43, 0xe000fe00
  s_mov_b32 s44, 0xffc0fffc
  s_mov_b32 s45, 0xc000fc00
  s_mov_b32 s46, 0xff80fff8
  s_mov_b32 s47, 0x8000f800
  s_mov_b32 s50, 0x3e0293ee
  v_mov_b32 v6, 0xd028965f
  s_waitcnt vmcnt(30)
  v_mfma_f32_16x16x32_bf16 v[136:139], v[112:115], v[16:19], 0
  v_mfma_f32_16x16x32_bf16 v[140:143], v[48:51], v[16:19], 0
  v_mfma_f32_16x16x32_bf16 v[144:147], v[112:115], v[32:35], 0
  v_mfma_f32_16x16x32_bf16 v[148:151], v[48:51], v[32:35], 0
  v_mfma_f32_16x16x32_bf16 v[152:155], v[64:67], v[32:35], 0
  v_mfma_f32_16x16x32_bf16 v[136:139], v[116:119], v[20:23], v[136:139]
  v_mfma_f32_16x16x32_bf16 v[140:143], v[52:55], v[20:23], v[140:143]
  v_mfma_f32_16x16x32_bf16 v[144:147], v[116:119], v[36:39], v[144:147]
  v_mfma_f32_16x16x32_bf16 v[148:151], v[52:55], v[36:39], v[148:151]
  v_mfma_f32_16x16x32_bf16 v[152:155], v[68:71], v[36:39], v[152:155]
  v_mfma_f32_16x16x32_bf16 v[136:139], v[120:123], v[24:27], v[136:139]
  v_mfma_f32_16x16x32_bf16 v[140:143], v[56:59], v[24:27], v[140:143]
  v_mfma_f32_16x16x32_bf16 v[144:147], v[120:123], v[40:43], v[144:147]
  v_mfma_f32_16x16x32_bf16 v[148:151], v[56:59], v[40:43], v[148:151]
  v_mfma_f32_16x16x32_bf16 v[152:155], v[72:75], v[40:43], v[152:155]
  v_mfma_f32_16x16x32_bf16 v[136:139], v[124:127], v[28:31], v[136:139]
  v_mfma_f32_16x16x32_bf16 v[140:143], v[60:63], v[28:31], v[140:143]
  v_mfma_f32_16x16x32_bf16 v[144:147], v[124:127], v[44:47], v[144:147]
  v_mfma_f32_16x16x32_bf16 v[148:151], v[60:63], v[44:47], v[148:151]
  v_mfma_f32_16x16x32_bf16 v[152:155], v[76:79], v[44:47], v[152:155]
  s_nop 4
  v_cndmask_b32 v140, v6, v140, s[40:41]
  v_cndmask_b32 v141, v6, v141, s[42:43]
  v_cndmask_b32 v142, v6, v142, s[44:45]
  v_cndmask_b32 v143, v6, v143, s[46:47]
  v_max3_f32 v12, v136, v137, v140
  v_max3_f32 v12, v12, v141, v142
  v_max_f32 v12, v12, v143
  v_mov_b32 v13, v12
  s_nop 1
  v_permlane32_swap_b32 v12, v13
  v_max_f32 v12, v12, v13
  v_mov_b32 v13, v12
  s_nop 1
  v_permlane16_swap_b32 v12, v13
  v_max_f32 v12, v12, v13
  v_mul_f32 v12, s50, v12
  v_fma_f32 v136, v136, s50, -v12
  v_fma_f32 v137, v137, s50, -v12
  v_fma_f32 v140, v140, s50, -v12
  v_fma_f32 v141, v141, s50, -v12
  v_fma_f32 v142, v142, s50, -v12
  v_fma_f32 v143, v143, s50, -v12
  v_exp_f32 v136, v136
  v_exp_f32 v137, v137
  v_exp_f32 v140, v140
  v_exp_f32 v141, v141
  v_exp_f32 v142, v142
  v_exp_f32 v143, v143
  v_add_f32 v12, v136, v137
  v_add_f32 v12, v12, v140
  v_add_f32 v12, v12, v141
  v_add_f32 v12, v12, v142
  v_add_f32 v12, v12, v143
  v_mov_b32 v13, v12
  s_nop 1
  v_permlane32_swap_b32 v12, v13
  v_add_f32 v12, v12, v13
  v_mov_b32 v13, v12
  s_nop 1
  v_permlane16_swap_b32 v12, v13
  v_add_f32 v12, v12, v13
  v_rcp_f32 v12, v12
  s_nop 0
  v_mul_f32 v136, v136, v12
  v_mul_f32 v137, v137, v12
  v_mul_f32 v140, v140, v12
  v_mul_f32 v141, v141, v12
  v_mul_f32 v142, v142, v12
  v_mul_f32 v143, v143, v12
  v_cvt_pk_bf16_f32 v160, v136, v137
  v_mov_b32 v161, 0
  v_mov_b32 v162, 0
  v_mov_b32 v163, v160
  v_cvt_pk_bf16_f32 v156, v140, v141
  v_cvt_pk_bf16_f32 v157, v142, v143
  v_mov_b32 v158, 0
  v_mov_b32 v159, 0
  v_cndmask_b32 v152, v6, v152, s[40:41]
  v_cndmask_b32 v153, v6, v153, s[42:43]
  v_cndmask_b32 v154, v6, v154, s[44:45]
  v_cndmask_b32 v155, v6, v155, s[46:47]
  v_max3_f32 v12, v144, v145, v148
  v_max3_f32 v12, v12, v149, v150
  v_max3_f32 v12, v12, v151, v152
  v_max3_f32 v12, v12, v153, v154
  v_max_f32 v12, v12, v155
  v_mov_b32 v13, v12
  s_nop 1
  v_permlane32_swap_b32 v12, v13
  v_max_f32 v12, v12, v13
  v_mov_b32 v13, v12
  s_nop 1
  v_permlane16_swap_b32 v12, v13
  v_max_f32 v12, v12, v13
  v_mul_f32 v12, s50, v12
  v_fma_f32 v144, v144, s50, -v12
  v_fma_f32 v145, v145, s50, -v12
  v_fma_f32 v148, v148, s50, -v12
  v_fma_f32 v149, v149, s50, -v12
  v_fma_f32 v150, v150, s50, -v12
  v_fma_f32 v151, v151, s50, -v12
  v_fma_f32 v152, v152, s50, -v12
  v_fma_f32 v153, v153, s50, -v12
  v_fma_f32 v154, v154, s50, -v12
  v_fma_f32 v155, v155, s50, -v12
  v_exp_f32 v144, v144
  v_exp_f32 v145, v145
  v_exp_f32 v148, v148
  v_exp_f32 v149, v149
  v_exp_f32 v150, v150
  v_exp_f32 v151, v151
  v_exp_f32 v152, v152
  v_exp_f32 v153, v153
  v_exp_f32 v154, v154
  v_exp_f32 v155, v155
  v_add_f32 v12, v144, v145
  v_add_f32 v12, v12, v148
  v_add_f32 v12, v12, v149
  v_add_f32 v12, v12, v150
  v_add_f32 v12, v12, v151
  v_add_f32 v12, v12, v152
  v_add_f32 v12, v12, v153
  v_add_f32 v12, v12, v154
  v_add_f32 v12, v12, v155
  v_mov_b32 v13, v12
  s_nop 1
  v_permlane32_swap_b32 v12, v13
  v_add_f32 v12, v12, v13
  v_mov_b32 v13, v12
  s_nop 1
  v_permlane16_swap_b32 v12, v13
  v_add_f32 v12, v12, v13
  v_rcp_f32 v12, v12
  s_nop 0
  v_mul_f32 v144, v144, v12
  v_mul_f32 v145, v145, v12
  v_mul_f32 v148, v148, v12
  v_mul_f32 v149, v149, v12
  v_mul_f32 v150, v150, v12
  v_mul_f32 v151, v151, v12
  v_mul_f32 v152, v152, v12
  v_mul_f32 v153, v153, v12
  v_mul_f32 v154, v154, v12
  v_mul_f32 v155, v155, v12
  v_cvt_pk_bf16_f32 v168, v144, v145
  v_mov_b32 v169, 0
  v_mov_b32 v170, 0
  v_mov_b32 v171, v168
  v_cvt_pk_bf16_f32 v164, v148, v149
  v_cvt_pk_bf16_f32 v165, v150, v151
  v_cvt_pk_bf16_f32 v166, v152, v153
  v_cvt_pk_bf16_f32 v167, v154, v155
  v_mfma_f32_16x16x32_bf16 v[176:179], v[80:83], v[156:159], 0
  v_mfma_f32_16x16x32_bf16 v[180:183], v[84:87], v[156:159], 0
  v_mfma_f32_16x16x32_bf16 v[184:187], v[88:91], v[156:159], 0
  v_mfma_f32_16x16x32_bf16 v[188:191], v[92:95], v[156:159], 0
  v_mfma_f32_16x16x32_bf16 v[192:195], v[96:99], v[156:159], 0
  v_mfma_f32_16x16x32_bf16 v[196:199], v[100:103], v[156:159], 0
  v_mfma_f32_16x16x32_bf16 v[200:203], v[104:107], v[156:159], 0
  v_mfma_f32_16x16x32_bf16 v[204:207], v[108:111], v[156:159], 0
  v_mfma_f32_16x16x16_bf16 v[176:179], v[128:129], v[160:161], v[176:179]
  v_mfma_f32_16x16x16_bf16 v[180:183], v[128:129], v[162:163], v[180:183]
  v_mfma_f32_16x16x16_bf16 v[184:187], v[130:131], v[160:161], v[184:187]
  v_mfma_f32_16x16x16_bf16 v[188:191], v[130:131], v[162:163], v[188:191]
  v_mfma_f32_16x16x16_bf16 v[192:195], v[132:133], v[160:161], v[192:195]
  v_mfma_f32_16x16x16_bf16 v[196:199], v[132:133], v[162:163], v[196:199]
  v_mfma_f32_16x16x16_bf16 v[200:203], v[134:135], v[160:161], v[200:203]
  v_mfma_f32_16x16x16_bf16 v[204:207], v[134:135], v[162:163], v[204:207]
  v_mfma_f32_16x16x32_bf16 v[208:211], v[80:83], v[164:167], 0
  v_mfma_f32_16x16x32_bf16 v[212:215], v[84:87], v[164:167], 0
  v_mfma_f32_16x16x32_bf16 v[216:219], v[88:91], v[164:167], 0
  v_mfma_f32_16x16x32_bf16 v[220:223], v[92:95], v[164:167], 0
  v_mfma_f32_16x16x32_bf16 v[224:227], v[96:99], v[164:167], 0
  v_mfma_f32_16x16x32_bf16 v[228:231], v[100:103], v[164:167], 0
  v_mfma_f32_16x16x32_bf16 v[232:235], v[104:107], v[164:167], 0
  v_mfma_f32_16x16x32_bf16 v[236:239], v[108:111], v[164:167], 0
  v_mfma_f32_16x16x16_bf16 v[208:211], v[128:129], v[168:169], v[208:211]
  v_mfma_f32_16x16x16_bf16 v[212:215], v[128:129], v[170:171], v[212:215]
  v_mfma_f32_16x16x16_bf16 v[216:219], v[130:131], v[168:169], v[216:219]
  v_mfma_f32_16x16x16_bf16 v[220:223], v[130:131], v[170:171], v[220:223]
  v_mfma_f32_16x16x16_bf16 v[224:227], v[132:133], v[168:169], v[224:227]
  v_mfma_f32_16x16x16_bf16 v[228:231], v[132:133], v[170:171], v[228:231]
  v_mfma_f32_16x16x16_bf16 v[232:235], v[134:135], v[168:169], v[232:235]
  v_mfma_f32_16x16x16_bf16 v[236:239], v[134:135], v[170:171], v[236:239]
  buffer_load_dwordx4 v[16:19], v2, s[4:7], s94 offen offset:0 sc1
  buffer_load_dwordx4 v[20:23], v2, s[4:7], s94 offen offset:1024 sc1
  buffer_load_dwordx4 v[24:27], v2, s[4:7], s94 offen offset:2048 sc1
  buffer_load_dwordx4 v[28:31], v2, s[4:7], s94 offen offset:3072 sc1
  buffer_load_dwordx4 v[32:35], v3, s[4:7], s94 offen offset:0 sc1
  buffer_load_dwordx4 v[36:39], v3, s[4:7], s94 offen offset:1024 sc1
  buffer_load_dwordx4 v[40:43], v3, s[4:7], s94 offen offset:2048 sc1
  buffer_load_dwordx4 v[44:47], v3, s[4:7], s94 offen offset:3072 sc1
  buffer_load_dwordx4 v[48:51], v2, s[4:7], s92 offen offset:0 sc1
  buffer_load_dwordx4 v[52:55], v2, s[4:7], s92 offen offset:1024 sc1
  buffer_load_dwordx4 v[56:59], v2, s[4:7], s92 offen offset:2048 sc1
  buffer_load_dwordx4 v[60:63], v2, s[4:7], s92 offen offset:3072 sc1
  buffer_load_dwordx4 v[64:67], v3, s[4:7], s92 offen offset:0 sc1
  buffer_load_dwordx4 v[68:71], v3, s[4:7], s92 offen offset:1024 sc1
  buffer_load_dwordx4 v[72:75], v3, s[4:7], s92 offen offset:2048 sc1
  buffer_load_dwordx4 v[76:79], v3, s[4:7], s92 offen offset:3072 sc1
  buffer_load_dwordx4 v[80:83], v8, s[4:7], s93 offen offset:0 sc1
  buffer_load_dwordx4 v[84:87], v8, s[4:7], s93 offen offset:128 sc1
  buffer_load_dwordx4 v[88:91], v8, s[4:7], s93 offen offset:1024 sc1
  buffer_load_dwordx4 v[92:95], v8, s[4:7], s93 offen offset:1152 sc1
  buffer_load_dwordx4 v[96:99], v9, s[4:7], s93 offen offset:0 sc1
  buffer_load_dwordx4 v[100:103], v9, s[4:7], s93 offen offset:128 sc1
  buffer_load_dwordx4 v[104:107], v9, s[4:7], s93 offen offset:1024 sc1
  buffer_load_dwordx4 v[108:111], v9, s[4:7], s93 offen offset:1152 sc1
  buffer_load_dwordx4 v[112:115], v4, s[4:7], s91 offen offset:0 sc1
  buffer_load_dwordx4 v[116:119], v4, s[4:7], s91 offen offset:512 sc1
  buffer_load_dwordx4 v[120:123], v4, s[4:7], s91 offen offset:1024 sc1
  buffer_load_dwordx4 v[124:127], v4, s[4:7], s91 offen offset:1536 sc1
  buffer_load_dwordx4 v[128:131], v5, s[4:7], s91 offen offset:0 sc1
  buffer_load_dwordx4 v[132:135], v5, s[4:7], s91 offen offset:1024 sc1
  s_add_u32 s92, s92, 262144
  s_add_u32 s93, s93, 262144
  s_add_u32 s94, s94, 262144
  s_add_u32 s91, s91, 65536
  v_cvt_pk_bf16_f32 v136, v176, v177
  v_cvt_pk_bf16_f32 v137, v178, v179
  v_cvt_pk_bf16_f32 v138, v184, v185
  v_cvt_pk_bf16_f32 v139, v186, v187
  buffer_store_dwordx4 v[136:139], v10, s[4:7], s95 offen offset:0 sc1
  v_cvt_pk_bf16_f32 v140, v180, v181
  v_cvt_pk_bf16_f32 v141, v182, v183
  v_cvt_pk_bf16_f32 v142, v188, v189
  v_cvt_pk_bf16_f32 v143, v190, v191
  buffer_store_dwordx4 v[140:143], v10, s[4:7], s95 offen offset:512 sc1
  v_cvt_pk_bf16_f32 v144, v192, v193
  v_cvt_pk_bf16_f32 v145, v194, v195
  v_cvt_pk_bf16_f32 v146, v200, v201
  v_cvt_pk_bf16_f32 v147, v202, v203
  buffer_store_dwordx4 v[144:147], v10, s[4:7], s95 offen offset:2048 sc1
  v_cvt_pk_bf16_f32 v148, v196, v197
  v_cvt_pk_bf16_f32 v149, v198, v199
  v_cvt_pk_bf16_f32 v150, v204, v205
  v_cvt_pk_bf16_f32 v151, v206, v207
  buffer_store_dwordx4 v[148:151], v10, s[4:7], s95 offen offset:2560 sc1
  v_cvt_pk_bf16_f32 v136, v208, v209
  v_cvt_pk_bf16_f32 v137, v210, v211
  v_cvt_pk_bf16_f32 v138, v216, v217
  v_cvt_pk_bf16_f32 v139, v218, v219
  buffer_store_dwordx4 v[136:139], v11, s[4:7], s95 offen offset:0 sc1
  v_cvt_pk_bf16_f32 v140, v212, v213
  v_cvt_pk_bf16_f32 v141, v214, v215
  v_cvt_pk_bf16_f32 v142, v220, v221
  v_cvt_pk_bf16_f32 v143, v222, v223
  buffer_store_dwordx4 v[140:143], v11, s[4:7], s95 offen offset:512 sc1
  v_cvt_pk_bf16_f32 v144, v224, v225
  v_cvt_pk_bf16_f32 v145, v226, v227
  v_cvt_pk_bf16_f32 v146, v232, v233
  v_cvt_pk_bf16_f32 v147, v234, v235
  buffer_store_dwordx4 v[144:147], v11, s[4:7], s95 offen offset:2048 sc1
  v_cvt_pk_bf16_f32 v148, v228, v229
  v_cvt_pk_bf16_f32 v149, v230, v231
  v_cvt_pk_bf16_f32 v150, v236, v237
  v_cvt_pk_bf16_f32 v151, v238, v239
  buffer_store_dwordx4 v[148:151], v11, s[4:7], s95 offen offset:2560 sc1
  s_add_u32 s95, s95, 262144
  s_waitcnt vmcnt(38)
  v_mfma_f32_16x16x32_bf16 v[136:139], a[96:99], a[0:3], 0
  v_mfma_f32_16x16x32_bf16 v[140:143], a[32:35], a[0:3], 0
  v_mfma_f32_16x16x32_bf16 v[144:147], a[96:99], a[16:19], 0
  v_mfma_f32_16x16x32_bf16 v[148:151], a[32:35], a[16:19], 0
  v_mfma_f32_16x16x32_bf16 v[152:155], a[48:51], a[16:19], 0
  v_mfma_f32_16x16x32_bf16 v[136:139], a[100:103], a[4:7], v[136:139]
  v_mfma_f32_16x16x32_bf16 v[140:143], a[36:39], a[4:7], v[140:143]
  v_mfma_f32_16x16x32_bf16 v[144:147], a[100:103], a[20:23], v[144:147]
  v_mfma_f32_16x16x32_bf16 v[148:151], a[36:39], a[20:23], v[148:151]
  v_mfma_f32_16x16x32_bf16 v[152:155], a[52:55], a[20:23], v[152:155]
  v_mfma_f32_16x16x32_bf16 v[136:139], a[104:107], a[8:11], v[136:139]
  v_mfma_f32_16x16x32_bf16 v[140:143], a[40:43], a[8:11], v[140:143]
  v_mfma_f32_16x16x32_bf16 v[144:147], a[104:107], a[24:27], v[144:147]
  v_mfma_f32_16x16x32_bf16 v[148:151], a[40:43], a[24:27], v[148:151]
  v_mfma_f32_16x16x32_bf16 v[152:155], a[56:59], a[24:27], v[152:155]
  v_mfma_f32_16x16x32_bf16 v[136:139], a[108:111], a[12:15], v[136:139]
  v_mfma_f32_16x16x32_bf16 v[140:143], a[44:47], a[12:15], v[140:143]
  v_mfma_f32_16x16x32_bf16 v[144:147], a[108:111], a[28:31], v[144:147]
  v_mfma_f32_16x16x32_bf16 v[148:151], a[44:47], a[28:31], v[148:151]
  v_mfma_f32_16x16x32_bf16 v[152:155], a[60:63], a[28:31], v[152:155]
  s_nop 4
  v_cndmask_b32 v140, v6, v140, s[40:41]
  v_cndmask_b32 v141, v6, v141, s[42:43]
  v_cndmask_b32 v142, v6, v142, s[44:45]
  v_cndmask_b32 v143, v6, v143, s[46:47]
  v_max3_f32 v12, v136, v137, v140
  v_max3_f32 v12, v12, v141, v142
  v_max_f32 v12, v12, v143
  v_mov_b32 v13, v12
  s_nop 1
  v_permlane32_swap_b32 v12, v13
  v_max_f32 v12, v12, v13
  v_mov_b32 v13, v12
  s_nop 1
  v_permlane16_swap_b32 v12, v13
  v_max_f32 v12, v12, v13
  v_mul_f32 v12, s50, v12
  v_fma_f32 v136, v136, s50, -v12
  v_fma_f32 v137, v137, s50, -v12
  v_fma_f32 v140, v140, s50, -v12
  v_fma_f32 v141, v141, s50, -v12
  v_fma_f32 v142, v142, s50, -v12
  v_fma_f32 v143, v143, s50, -v12
  v_exp_f32 v136, v136
  v_exp_f32 v137, v137
  v_exp_f32 v140, v140
  v_exp_f32 v141, v141
  v_exp_f32 v142, v142
  v_exp_f32 v143, v143
  v_add_f32 v12, v136, v137
  v_add_f32 v12, v12, v140
  v_add_f32 v12, v12, v141
  v_add_f32 v12, v12, v142
  v_add_f32 v12, v12, v143
  v_mov_b32 v13, v12
  s_nop 1
  v_permlane32_swap_b32 v12, v13
  v_add_f32 v12, v12, v13
  v_mov_b32 v13, v12
  s_nop 1
  v_permlane16_swap_b32 v12, v13
  v_add_f32 v12, v12, v13
  v_rcp_f32 v12, v12
  s_nop 0
  v_mul_f32 v136, v136, v12
  v_mul_f32 v137, v137, v12
  v_mul_f32 v140, v140, v12
  v_mul_f32 v141, v141, v12
  v_mul_f32 v142, v142, v12
  v_mul_f32 v143, v143, v12
  v_cvt_pk_bf16_f32 v160, v136, v137
  v_mov_b32 v161, 0
  v_mov_b32 v162, 0
  v_mov_b32 v163, v160
  v_cvt_pk_bf16_f32 v156, v140, v141
  v_cvt_pk_bf16_f32 v157, v142, v143
  v_mov_b32 v158, 0
  v_mov_b32 v159, 0
  v_cndmask_b32 v152, v6, v152, s[40:41]
  v_cndmask_b32 v153, v6, v153, s[42:43]
  v_cndmask_b32 v154, v6, v154, s[44:45]
  v_cndmask_b32 v155, v6, v155, s[46:47]
  v_max3_f32 v12, v144, v145, v148
  v_max3_f32 v12, v12, v149, v150
  v_max3_f32 v12, v12, v151, v152
  v_max3_f32 v12, v12, v153, v154
  v_max_f32 v12, v12, v155
  v_mov_b32 v13, v12
  s_nop 1
  v_permlane32_swap_b32 v12, v13
  v_max_f32 v12, v12, v13
  v_mov_b32 v13, v12
  s_nop 1
  v_permlane16_swap_b32 v12, v13
  v_max_f32 v12, v12, v13
  v_mul_f32 v12, s50, v12
  v_fma_f32 v144, v144, s50, -v12
  v_fma_f32 v145, v145, s50, -v12
  v_fma_f32 v148, v148, s50, -v12
  v_fma_f32 v149, v149, s50, -v12
  v_fma_f32 v150, v150, s50, -v12
  v_fma_f32 v151, v151, s50, -v12
  v_fma_f32 v152, v152, s50, -v12
  v_fma_f32 v153, v153, s50, -v12
  v_fma_f32 v154, v154, s50, -v12
  v_fma_f32 v155, v155, s50, -v12
  v_exp_f32 v144, v144
  v_exp_f32 v145, v145
  v_exp_f32 v148, v148
  v_exp_f32 v149, v149
  v_exp_f32 v150, v150
  v_exp_f32 v151, v151
  v_exp_f32 v152, v152
  v_exp_f32 v153, v153
  v_exp_f32 v154, v154
  v_exp_f32 v155, v155
  v_add_f32 v12, v144, v145
  v_add_f32 v12, v12, v148
  v_add_f32 v12, v12, v149
  v_add_f32 v12, v12, v150
  v_add_f32 v12, v12, v151
  v_add_f32 v12, v12, v152
  v_add_f32 v12, v12, v153
  v_add_f32 v12, v12, v154
  v_add_f32 v12, v12, v155
  v_mov_b32 v13, v12
  s_nop 1
  v_permlane32_swap_b32 v12, v13
  v_add_f32 v12, v12, v13
  v_mov_b32 v13, v12
  s_nop 1
  v_permlane16_swap_b32 v12, v13
  v_add_f32 v12, v12, v13
  v_rcp_f32 v12, v12
  s_nop 0
  v_mul_f32 v144, v144, v12
  v_mul_f32 v145, v145, v12
  v_mul_f32 v148, v148, v12
  v_mul_f32 v149, v149, v12
  v_mul_f32 v150, v150, v12
  v_mul_f32 v151, v151, v12
  v_mul_f32 v152, v152, v12
  v_mul_f32 v153, v153, v12
  v_mul_f32 v154, v154, v12
  v_mul_f32 v155, v155, v12
  v_cvt_pk_bf16_f32 v168, v144, v145
  v_mov_b32 v169, 0
  v_mov_b32 v170, 0
  v_mov_b32 v171, v168
  v_cvt_pk_bf16_f32 v164, v148, v149
  v_cvt_pk_bf16_f32 v165, v150, v151
  v_cvt_pk_bf16_f32 v166, v152, v153
  v_cvt_pk_bf16_f32 v167, v154, v155
  v_mfma_f32_16x16x32_bf16 v[176:179], a[64:67], v[156:159], 0
  v_mfma_f32_16x16x32_bf16 v[180:183], a[68:71], v[156:159], 0
  v_mfma_f32_16x16x32_bf16 v[184:187], a[72:75], v[156:159], 0
  v_mfma_f32_16x16x32_bf16 v[188:191], a[76:79], v[156:159], 0
  v_mfma_f32_16x16x32_bf16 v[192:195], a[80:83], v[156:159], 0
  v_mfma_f32_16x16x32_bf16 v[196:199], a[84:87], v[156:159], 0
  v_mfma_f32_16x16x32_bf16 v[200:203], a[88:91], v[156:159], 0
  v_mfma_f32_16x16x32_bf16 v[204:207], a[92:95], v[156:159], 0
  v_mfma_f32_16x16x16_bf16 v[176:179], a[112:113], v[160:161], v[176:179]
  v_mfma_f32_16x16x16_bf16 v[180:183], a[112:113], v[162:163], v[180:183]
  v_mfma_f32_16x16x16_bf16 v[184:187], a[114:115], v[160:161], v[184:187]
  v_mfma_f32_16x16x16_bf16 v[188:191], a[114:115], v[162:163], v[188:191]
  v_mfma_f32_16x16x16_bf16 v[192:195], a[116:117], v[160:161], v[192:195]
  v_mfma_f32_16x16x16_bf16 v[196:199], a[116:117], v[162:163], v[196:199]
  v_mfma_f32_16x16x16_bf16 v[200:203], a[118:119], v[160:161], v[200:203]
  v_mfma_f32_16x16x16_bf16 v[204:207], a[118:119], v[162:163], v[204:207]
  v_mfma_f32_16x16x32_bf16 v[208:211], a[64:67], v[164:167], 0
  v_mfma_f32_16x16x32_bf16 v[212:215], a[68:71], v[164:167], 0
  v_mfma_f32_16x16x32_bf16 v[216:219], a[72:75], v[164:167], 0
  v_mfma_f32_16x16x32_bf16 v[220:223], a[76:79], v[164:167], 0
  v_mfma_f32_16x16x32_bf16 v[224:227], a[80:83], v[164:167], 0
  v_mfma_f32_16x16x32_bf16 v[228:231], a[84:87], v[164:167], 0
  v_mfma_f32_16x16x32_bf16 v[232:235], a[88:91], v[164:167], 0
  v_mfma_f32_16x16x32_bf16 v[236:239], a[92:95], v[164:167], 0
  v_mfma_f32_16x16x16_bf16 v[208:211], a[112:113], v[168:169], v[208:211]
  v_mfma_f32_16x16x16_bf16 v[212:215], a[112:113], v[170:171], v[212:215]
  v_mfma_f32_16x16x16_bf16 v[216:219], a[114:115], v[168:169], v[216:219]
  v_mfma_f32_16x16x16_bf16 v[220:223], a[114:115], v[170:171], v[220:223]
  v_mfma_f32_16x16x16_bf16 v[224:227], a[116:117], v[168:169], v[224:227]
  v_mfma_f32_16x16x16_bf16 v[228:231], a[116:117], v[170:171], v[228:231]
  v_mfma_f32_16x16x16_bf16 v[232:235], a[118:119], v[168:169], v[232:235]
  v_mfma_f32_16x16x16_bf16 v[236:239], a[118:119], v[170:171], v[236:239]
  buffer_load_dwordx4 a[0:3], v2, s[4:7], s94 offen offset:0 sc1
  buffer_load_dwordx4 a[4:7], v2, s[4:7], s94 offen offset:1024 sc1
  buffer_load_dwordx4 a[8:11], v2, s[4:7], s94 offen offset:2048 sc1
  buffer_load_dwordx4 a[12:15], v2, s[4:7], s94 offen offset:3072 sc1
  buffer_load_dwordx4 a[16:19], v3, s[4:7], s94 offen offset:0 sc1
  buffer_load_dwordx4 a[20:23], v3, s[4:7], s94 offen offset:1024 sc1
  buffer_load_dwordx4 a[24:27], v3, s[4:7], s94 offen offset:2048 sc1
  buffer_load_dwordx4 a[28:31], v3, s[4:7], s94 offen offset:3072 sc1
  buffer_load_dwordx4 a[32:35], v2, s[4:7], s92 offen offset:0 sc1
  buffer_load_dwordx4 a[36:39], v2, s[4:7], s92 offen offset:1024 sc1
  buffer_load_dwordx4 a[40:43], v2, s[4:7], s92 offen offset:2048 sc1
  buffer_load_dwordx4 a[44:47], v2, s[4:7], s92 offen offset:3072 sc1
  buffer_load_dwordx4 a[48:51], v3, s[4:7], s92 offen offset:0 sc1
  buffer_load_dwordx4 a[52:55], v3, s[4:7], s92 offen offset:1024 sc1
  buffer_load_dwordx4 a[56:59], v3, s[4:7], s92 offen offset:2048 sc1
  buffer_load_dwordx4 a[60:63], v3, s[4:7], s92 offen offset:3072 sc1
  buffer_load_dwordx4 a[64:67], v8, s[4:7], s93 offen offset:0 sc1
  buffer_load_dwordx4 a[68:71], v8, s[4:7], s93 offen offset:128 sc1
  buffer_load_dwordx4 a[72:75], v8, s[4:7], s93 offen offset:1024 sc1
  buffer_load_dwordx4 a[76:79], v8, s[4:7], s93 offen offset:1152 sc1
  buffer_load_dwordx4 a[80:83], v9, s[4:7], s93 offen offset:0 sc1
  buffer_load_dwordx4 a[84:87], v9, s[4:7], s93 offen offset:128 sc1
  buffer_load_dwordx4 a[88:91], v9, s[4:7], s93 offen offset:1024 sc1
  buffer_load_dwordx4 a[92:95], v9, s[4:7], s93 offen offset:1152 sc1
  buffer_load_dwordx4 a[96:99], v4, s[4:7], s91 offen offset:0 sc1
  buffer_load_dwordx4 a[100:103], v4, s[4:7], s91 offen offset:512 sc1
  buffer_load_dwordx4 a[104:107], v4, s[4:7], s91 offen offset:1024 sc1
  buffer_load_dwordx4 a[108:111], v4, s[4:7], s91 offen offset:1536 sc1
  buffer_load_dwordx4 a[112:115], v5, s[4:7], s91 offen offset:0 sc1
  buffer_load_dwordx4 a[116:119], v5, s[4:7], s91 offen offset:1024 sc1
  s_add_u32 s92, s92, 262144
  s_add_u32 s93, s93, 262144
  s_add_u32 s94, s94, 262144
  s_add_u32 s91, s91, 65536
  v_cvt_pk_bf16_f32 v136, v176, v177
  v_cvt_pk_bf16_f32 v137, v178, v179
  v_cvt_pk_bf16_f32 v138, v184, v185
  v_cvt_pk_bf16_f32 v139, v186, v187
  buffer_store_dwordx4 v[136:139], v10, s[4:7], s95 offen offset:0 sc1
  v_cvt_pk_bf16_f32 v140, v180, v181
  v_cvt_pk_bf16_f32 v141, v182, v183
  v_cvt_pk_bf16_f32 v142, v188, v189
  v_cvt_pk_bf16_f32 v143, v190, v191
  buffer_store_dwordx4 v[140:143], v10, s[4:7], s95 offen offset:512 sc1
  v_cvt_pk_bf16_f32 v144, v192, v193
  v_cvt_pk_bf16_f32 v145, v194, v195
  v_cvt_pk_bf16_f32 v146, v200, v201
  v_cvt_pk_bf16_f32 v147, v202, v203
  buffer_store_dwordx4 v[144:147], v10, s[4:7], s95 offen offset:2048 sc1
  v_cvt_pk_bf16_f32 v148, v196, v197
  v_cvt_pk_bf16_f32 v149, v198, v199
  v_cvt_pk_bf16_f32 v150, v204, v205
  v_cvt_pk_bf16_f32 v151, v206, v207
  buffer_store_dwordx4 v[148:151], v10, s[4:7], s95 offen offset:2560 sc1
  v_cvt_pk_bf16_f32 v136, v208, v209
  v_cvt_pk_bf16_f32 v137, v210, v211
  v_cvt_pk_bf16_f32 v138, v216, v217
  v_cvt_pk_bf16_f32 v139, v218, v219
  buffer_store_dwordx4 v[136:139], v11, s[4:7], s95 offen offset:0 sc1
  v_cvt_pk_bf16_f32 v140, v212, v213
  v_cvt_pk_bf16_f32 v141, v214, v215
  v_cvt_pk_bf16_f32 v142, v220, v221
  v_cvt_pk_bf16_f32 v143, v222, v223
  buffer_store_dwordx4 v[140:143], v11, s[4:7], s95 offen offset:512 sc1
  v_cvt_pk_bf16_f32 v144, v224, v225
  v_cvt_pk_bf16_f32 v145, v226, v227
  v_cvt_pk_bf16_f32 v146, v232, v233
  v_cvt_pk_bf16_f32 v147, v234, v235
  buffer_store_dwordx4 v[144:147], v11, s[4:7], s95 offen offset:2048 sc1
  v_cvt_pk_bf16_f32 v148, v228, v229
  v_cvt_pk_bf16_f32 v149, v230, v231
  v_cvt_pk_bf16_f32 v150, v236, v237
  v_cvt_pk_bf16_f32 v151, v238, v239
  buffer_store_dwordx4 v[148:151], v11, s[4:7], s95 offen offset:2560 sc1
  s_add_u32 s95, s95, 262144
  s_waitcnt vmcnt(46)
  v_mfma_f32_16x16x32_bf16 v[136:139], v[112:115], v[16:19], 0
  v_mfma_f32_16x16x32_bf16 v[140:143], v[48:51], v[16:19], 0
  v_mfma_f32_16x16x32_bf16 v[144:147], v[112:115], v[32:35], 0
  v_mfma_f32_16x16x32_bf16 v[148:151], v[48:51], v[32:35], 0
  v_mfma_f32_16x16x32_bf16 v[152:155], v[64:67], v[32:35], 0
  v_mfma_f32_16x16x32_bf16 v[136:139], v[116:119], v[20:23], v[136:139]
  v_mfma_f32_16x16x32_bf16 v[140:143], v[52:55], v[20:23], v[140:143]
  v_mfma_f32_16x16x32_bf16 v[144:147], v[116:119], v[36:39], v[144:147]
  v_mfma_f32_16x16x32_bf16 v[148:151], v[52:55], v[36:39], v[148:151]
  v_mfma_f32_16x16x32_bf16 v[152:155], v[68:71], v[36:39], v[152:155]
  v_mfma_f32_16x16x32_bf16 v[136:139], v[120:123], v[24:27], v[136:139]
  v_mfma_f32_16x16x32_bf16 v[140:143], v[56:59], v[24:27], v[140:143]
  v_mfma_f32_16x16x32_bf16 v[144:147], v[120:123], v[40:43], v[144:147]
  v_mfma_f32_16x16x32_bf16 v[148:151], v[56:59], v[40:43], v[148:151]
  v_mfma_f32_16x16x32_bf16 v[152:155], v[72:75], v[40:43], v[152:155]
  v_mfma_f32_16x16x32_bf16 v[136:139], v[124:127], v[28:31], v[136:139]
  v_mfma_f32_16x16x32_bf16 v[140:143], v[60:63], v[28:31], v[140:143]
  v_mfma_f32_16x16x32_bf16 v[144:147], v[124:127], v[44:47], v[144:147]
  v_mfma_f32_16x16x32_bf16 v[148:151], v[60:63], v[44:47], v[148:151]
  v_mfma_f32_16x16x32_bf16 v[152:155], v[76:79], v[44:47], v[152:155]
  s_nop 4
  v_cndmask_b32 v140, v6, v140, s[40:41]
  v_cndmask_b32 v141, v6, v141, s[42:43]
  v_cndmask_b32 v142, v6, v142, s[44:45]
  v_cndmask_b32 v143, v6, v143, s[46:47]
  v_max3_f32 v12, v136, v137, v140
  v_max3_f32 v12, v12, v141, v142
  v_max_f32 v12, v12, v143
  v_mov_b32 v13, v12
  s_nop 1
  v_permlane32_swap_b32 v12, v13
  v_max_f32 v12, v12, v13
  v_mov_b32 v13, v12
  s_nop 1
  v_permlane16_swap_b32 v12, v13
  v_max_f32 v12, v12, v13
  v_mul_f32 v12, s50, v12
  v_fma_f32 v136, v136, s50, -v12
  v_fma_f32 v137, v137, s50, -v12
  v_fma_f32 v140, v140, s50, -v12
  v_fma_f32 v141, v141, s50, -v12
  v_fma_f32 v142, v142, s50, -v12
  v_fma_f32 v143, v143, s50, -v12
  v_exp_f32 v136, v136
  v_exp_f32 v137, v137
  v_exp_f32 v140, v140
  v_exp_f32 v141, v141
  v_exp_f32 v142, v142
  v_exp_f32 v143, v143
  v_add_f32 v12, v136, v137
  v_add_f32 v12, v12, v140
  v_add_f32 v12, v12, v141
  v_add_f32 v12, v12, v142
  v_add_f32 v12, v12, v143
  v_mov_b32 v13, v12
  s_nop 1
  v_permlane32_swap_b32 v12, v13
  v_add_f32 v12, v12, v13
  v_mov_b32 v13, v12
  s_nop 1
  v_permlane16_swap_b32 v12, v13
  v_add_f32 v12, v12, v13
  v_rcp_f32 v12, v12
  s_nop 0
  v_mul_f32 v136, v136, v12
  v_mul_f32 v137, v137, v12
  v_mul_f32 v140, v140, v12
  v_mul_f32 v141, v141, v12
  v_mul_f32 v142, v142, v12
  v_mul_f32 v143, v143, v12
  v_cvt_pk_bf16_f32 v160, v136, v137
  v_mov_b32 v161, 0
  v_mov_b32 v162, 0
  v_mov_b32 v163, v160
  v_cvt_pk_bf16_f32 v156, v140, v141
  v_cvt_pk_bf16_f32 v157, v142, v143
  v_mov_b32 v158, 0
  v_mov_b32 v159, 0
  v_cndmask_b32 v152, v6, v152, s[40:41]
  v_cndmask_b32 v153, v6, v153, s[42:43]
  v_cndmask_b32 v154, v6, v154, s[44:45]
  v_cndmask_b32 v155, v6, v155, s[46:47]
  v_max3_f32 v12, v144, v145, v148
  v_max3_f32 v12, v12, v149, v150
  v_max3_f32 v12, v12, v151, v152
  v_max3_f32 v12, v12, v153, v154
  v_max_f32 v12, v12, v155
  v_mov_b32 v13, v12
  s_nop 1
  v_permlane32_swap_b32 v12, v13
  v_max_f32 v12, v12, v13
  v_mov_b32 v13, v12
  s_nop 1
  v_permlane16_swap_b32 v12, v13
  v_max_f32 v12, v12, v13
  v_mul_f32 v12, s50, v12
  v_fma_f32 v144, v144, s50, -v12
  v_fma_f32 v145, v145, s50, -v12
  v_fma_f32 v148, v148, s50, -v12
  v_fma_f32 v149, v149, s50, -v12
  v_fma_f32 v150, v150, s50, -v12
  v_fma_f32 v151, v151, s50, -v12
  v_fma_f32 v152, v152, s50, -v12
  v_fma_f32 v153, v153, s50, -v12
  v_fma_f32 v154, v154, s50, -v12
  v_fma_f32 v155, v155, s50, -v12
  v_exp_f32 v144, v144
  v_exp_f32 v145, v145
  v_exp_f32 v148, v148
  v_exp_f32 v149, v149
  v_exp_f32 v150, v150
  v_exp_f32 v151, v151
  v_exp_f32 v152, v152
  v_exp_f32 v153, v153
  v_exp_f32 v154, v154
  v_exp_f32 v155, v155
  v_add_f32 v12, v144, v145
  v_add_f32 v12, v12, v148
  v_add_f32 v12, v12, v149
  v_add_f32 v12, v12, v150
  v_add_f32 v12, v12, v151
  v_add_f32 v12, v12, v152
  v_add_f32 v12, v12, v153
  v_add_f32 v12, v12, v154
  v_add_f32 v12, v12, v155
  v_mov_b32 v13, v12
  s_nop 1
  v_permlane32_swap_b32 v12, v13
  v_add_f32 v12, v12, v13
  v_mov_b32 v13, v12
  s_nop 1
  v_permlane16_swap_b32 v12, v13
  v_add_f32 v12, v12, v13
  v_rcp_f32 v12, v12
  s_nop 0
  v_mul_f32 v144, v144, v12
  v_mul_f32 v145, v145, v12
  v_mul_f32 v148, v148, v12
  v_mul_f32 v149, v149, v12
  v_mul_f32 v150, v150, v12
  v_mul_f32 v151, v151, v12
  v_mul_f32 v152, v152, v12
  v_mul_f32 v153, v153, v12
  v_mul_f32 v154, v154, v12
  v_mul_f32 v155, v155, v12
  v_cvt_pk_bf16_f32 v168, v144, v145
  v_mov_b32 v169, 0
  v_mov_b32 v170, 0
  v_mov_b32 v171, v168
  v_cvt_pk_bf16_f32 v164, v148, v149
  v_cvt_pk_bf16_f32 v165, v150, v151
  v_cvt_pk_bf16_f32 v166, v152, v153
  v_cvt_pk_bf16_f32 v167, v154, v155
  v_mfma_f32_16x16x32_bf16 v[176:179], v[80:83], v[156:159], 0
  v_mfma_f32_16x16x32_bf16 v[180:183], v[84:87], v[156:159], 0
  v_mfma_f32_16x16x32_bf16 v[184:187], v[88:91], v[156:159], 0
  v_mfma_f32_16x16x32_bf16 v[188:191], v[92:95], v[156:159], 0
  v_mfma_f32_16x16x32_bf16 v[192:195], v[96:99], v[156:159], 0
  v_mfma_f32_16x16x32_bf16 v[196:199], v[100:103], v[156:159], 0
  v_mfma_f32_16x16x32_bf16 v[200:203], v[104:107], v[156:159], 0
  v_mfma_f32_16x16x32_bf16 v[204:207], v[108:111], v[156:159], 0
  v_mfma_f32_16x16x16_bf16 v[176:179], v[128:129], v[160:161], v[176:179]
  v_mfma_f32_16x16x16_bf16 v[180:183], v[128:129], v[162:163], v[180:183]
  v_mfma_f32_16x16x16_bf16 v[184:187], v[130:131], v[160:161], v[184:187]
  v_mfma_f32_16x16x16_bf16 v[188:191], v[130:131], v[162:163], v[188:191]
  v_mfma_f32_16x16x16_bf16 v[192:195], v[132:133], v[160:161], v[192:195]
  v_mfma_f32_16x16x16_bf16 v[196:199], v[132:133], v[162:163], v[196:199]
  v_mfma_f32_16x16x16_bf16 v[200:203], v[134:135], v[160:161], v[200:203]
  v_mfma_f32_16x16x16_bf16 v[204:207], v[134:135], v[162:163], v[204:207]
  v_mfma_f32_16x16x32_bf16 v[208:211], v[80:83], v[164:167], 0
  v_mfma_f32_16x16x32_bf16 v[212:215], v[84:87], v[164:167], 0
  v_mfma_f32_16x16x32_bf16 v[216:219], v[88:91], v[164:167], 0
  v_mfma_f32_16x16x32_bf16 v[220:223], v[92:95], v[164:167], 0
  v_mfma_f32_16x16x32_bf16 v[224:227], v[96:99], v[164:167], 0
  v_mfma_f32_16x16x32_bf16 v[228:231], v[100:103], v[164:167], 0
  v_mfma_f32_16x16x32_bf16 v[232:235], v[104:107], v[164:167], 0
  v_mfma_f32_16x16x32_bf16 v[236:239], v[108:111], v[164:167], 0
  v_mfma_f32_16x16x16_bf16 v[208:211], v[128:129], v[168:169], v[208:211]
  v_mfma_f32_16x16x16_bf16 v[212:215], v[128:129], v[170:171], v[212:215]
  v_mfma_f32_16x16x16_bf16 v[216:219], v[130:131], v[168:169], v[216:219]
  v_mfma_f32_16x16x16_bf16 v[220:223], v[130:131], v[170:171], v[220:223]
  v_mfma_f32_16x16x16_bf16 v[224:227], v[132:133], v[168:169], v[224:227]
  v_mfma_f32_16x16x16_bf16 v[228:231], v[132:133], v[170:171], v[228:231]
  v_mfma_f32_16x16x16_bf16 v[232:235], v[134:135], v[168:169], v[232:235]
  v_mfma_f32_16x16x16_bf16 v[236:239], v[134:135], v[170:171], v[236:239]
  v_cvt_pk_bf16_f32 v136, v176, v177
  v_cvt_pk_bf16_f32 v137, v178, v179
  v_cvt_pk_bf16_f32 v138, v184, v185
  v_cvt_pk_bf16_f32 v139, v186, v187
  buffer_store_dwordx4 v[136:139], v10, s[4:7], s95 offen offset:0 sc1
  v_cvt_pk_bf16_f32 v140, v180, v181
  v_cvt_pk_bf16_f32 v141, v182, v183
  v_cvt_pk_bf16_f32 v142, v188, v189
  v_cvt_pk_bf16_f32 v143, v190, v191
  buffer_store_dwordx4 v[140:143], v10, s[4:7], s95 offen offset:512 sc1
  v_cvt_pk_bf16_f32 v144, v192, v193
  v_cvt_pk_bf16_f32 v145, v194, v195
  v_cvt_pk_bf16_f32 v146, v200, v201
  v_cvt_pk_bf16_f32 v147, v202, v203
  buffer_store_dwordx4 v[144:147], v10, s[4:7], s95 offen offset:2048 sc1
  v_cvt_pk_bf16_f32 v148, v196, v197
  v_cvt_pk_bf16_f32 v149, v198, v199
  v_cvt_pk_bf16_f32 v150, v204, v205
  v_cvt_pk_bf16_f32 v151, v206, v207
  buffer_store_dwordx4 v[148:151], v10, s[4:7], s95 offen offset:2560 sc1
  v_cvt_pk_bf16_f32 v136, v208, v209
  v_cvt_pk_bf16_f32 v137, v210, v211
  v_cvt_pk_bf16_f32 v138, v216, v217
  v_cvt_pk_bf16_f32 v139, v218, v219
  buffer_store_dwordx4 v[136:139], v11, s[4:7], s95 offen offset:0 sc1
  v_cvt_pk_bf16_f32 v140, v212, v213
  v_cvt_pk_bf16_f32 v141, v214, v215
  v_cvt_pk_bf16_f32 v142, v220, v221
  v_cvt_pk_bf16_f32 v143, v222, v223
  buffer_store_dwordx4 v[140:143], v11, s[4:7], s95 offen offset:512 sc1
  v_cvt_pk_bf16_f32 v144, v224, v225
  v_cvt_pk_bf16_f32 v145, v226, v227
  v_cvt_pk_bf16_f32 v146, v232, v233
  v_cvt_pk_bf16_f32 v147, v234, v235
  buffer_store_dwordx4 v[144:147], v11, s[4:7], s95 offen offset:2048 sc1
  v_cvt_pk_bf16_f32 v148, v228, v229
  v_cvt_pk_bf16_f32 v149, v230, v231
  v_cvt_pk_bf16_f32 v150, v236, v237
  v_cvt_pk_bf16_f32 v151, v238, v239
  buffer_store_dwordx4 v[148:151], v11, s[4:7], s95 offen offset:2560 sc1
  s_add_u32 s95, s95, 262144
  s_waitcnt vmcnt(16)
  s_cmp_lg_u32 s32, 0
  s_cbranch_scc1 L_rq_97
  s_cmp_eq_u32 s39, 0
  s_cbranch_scc1 L_rq_97
  s_lshl_b32 s99, s33, 7
  s_add_u32 s99, s99, 0x3d00200
  v_mov_b32 v244, 1
  v_mov_b32 v245, 0
  s_mov_b64 exec, 1
  buffer_atomic_add v244, v245, s[4:7], s99 offen sc0 sc1
  s_mov_b64 exec, -1
L_rq_97:
  v_mfma_f32_16x16x32_bf16 v[136:139], a[96:99], a[0:3], 0
  v_mfma_f32_16x16x32_bf16 v[140:143], a[32:35], a[0:3], 0
  v_mfma_f32_16x16x32_bf16 v[144:147], a[96:99], a[16:19], 0
  v_mfma_f32_16x16x32_bf16 v[148:151], a[32:35], a[16:19], 0
  v_mfma_f32_16x16x32_bf16 v[152:155], a[48:51], a[16:19], 0
  v_mfma_f32_16x16x32_bf16 v[136:139], a[100:103], a[4:7], v[136:139]
  v_mfma_f32_16x16x32_bf16 v[140:143], a[36:39], a[4:7], v[140:143]
  v_mfma_f32_16x16x32_bf16 v[144:147], a[100:103], a[20:23], v[144:147]
  v_mfma_f32_16x16x32_bf16 v[148:151], a[36:39], a[20:23], v[148:151]
  v_mfma_f32_16x16x32_bf16 v[152:155], a[52:55], a[20:23], v[152:155]
  v_mfma_f32_16x16x32_bf16 v[136:139], a[104:107], a[8:11], v[136:139]
  v_mfma_f32_16x16x32_bf16 v[140:143], a[40:43], a[8:11], v[140:143]
  v_mfma_f32_16x16x32_bf16 v[144:147], a[104:107], a[24:27], v[144:147]
  v_mfma_f32_16x16x32_bf16 v[148:151], a[40:43], a[24:27], v[148:151]
  v_mfma_f32_16x16x32_bf16 v[152:155], a[56:59], a[24:27], v[152:155]
  v_mfma_f32_16x16x32_bf16 v[136:139], a[108:111], a[12:15], v[136:139]
  v_mfma_f32_16x16x32_bf16 v[140:143], a[44:47], a[12:15], v[140:143]
  v_mfma_f32_16x16x32_bf16 v[144:147], a[108:111], a[28:31], v[144:147]
  v_mfma_f32_16x16x32_bf16 v[148:151], a[44:47], a[28:31], v[148:151]
  v_mfma_f32_16x16x32_bf16 v[152:155], a[60:63], a[28:31], v[152:155]
  s_nop 4
  v_cndmask_b32 v140, v6, v140, s[40:41]
  v_cndmask_b32 v141, v6, v141, s[42:43]
  v_cndmask_b32 v142, v6, v142, s[44:45]
  v_cndmask_b32 v143, v6, v143, s[46:47]
  v_max3_f32 v12, v136, v137, v140
  v_max3_f32 v12, v12, v141, v142
  v_max_f32 v12, v12, v143
  v_mov_b32 v13, v12
  s_nop 1
  v_permlane32_swap_b32 v12, v13
  v_max_f32 v12, v12, v13
  v_mov_b32 v13, v12
  s_nop 1
  v_permlane16_swap_b32 v12, v13
  v_max_f32 v12, v12, v13
  v_mul_f32 v12, s50, v12
  v_fma_f32 v136, v136, s50, -v12
  v_fma_f32 v137, v137, s50, -v12
  v_fma_f32 v140, v140, s50, -v12
  v_fma_f32 v141, v141, s50, -v12
  v_fma_f32 v142, v142, s50, -v12
  v_fma_f32 v143, v143, s50, -v12
  v_exp_f32 v136, v136
  v_exp_f32 v137, v137
  v_exp_f32 v140, v140
  v_exp_f32 v141, v141
  v_exp_f32 v142, v142
  v_exp_f32 v143, v143
  v_add_f32 v12, v136, v137
  v_add_f32 v12, v12, v140
  v_add_f32 v12, v12, v141
  v_add_f32 v12, v12, v142
  v_add_f32 v12, v12, v143
  v_mov_b32 v13, v12
  s_nop 1
  v_permlane32_swap_b32 v12, v13
  v_add_f32 v12, v12, v13
  v_mov_b32 v13, v12
  s_nop 1
  v_permlane16_swap_b32 v12, v13
  v_add_f32 v12, v12, v13
  v_rcp_f32 v12, v12
  s_nop 0
  v_mul_f32 v136, v136, v12
  v_mul_f32 v137, v137, v12
  v_mul_f32 v140, v140, v12
  v_mul_f32 v141, v141, v12
  v_mul_f32 v142, v142, v12
  v_mul_f32 v143, v143, v12
  v_cvt_pk_bf16_f32 v160, v136, v137
  v_mov_b32 v161, 0
  v_mov_b32 v162, 0
  v_mov_b32 v163, v160
  v_cvt_pk_bf16_f32 v156, v140, v141
  v_cvt_pk_bf16_f32 v157, v142, v143
  v_mov_b32 v158, 0
  v_mov_b32 v159, 0
  v_cndmask_b32 v152, v6, v152, s[40:41]
  v_cndmask_b32 v153, v6, v153, s[42:43]
  v_cndmask_b32 v154, v6, v154, s[44:45]
  v_cndmask_b32 v155, v6, v155, s[46:47]
  v_max3_f32 v12, v144, v145, v148
  v_max3_f32 v12, v12, v149, v150
  v_max3_f32 v12, v12, v151, v152
  v_max3_f32 v12, v12, v153, v154
  v_max_f32 v12, v12, v155
  v_mov_b32 v13, v12
  s_nop 1
  v_permlane32_swap_b32 v12, v13
  v_max_f32 v12, v12, v13
  v_mov_b32 v13, v12
  s_nop 1
  v_permlane16_swap_b32 v12, v13
  v_max_f32 v12, v12, v13
  v_mul_f32 v12, s50, v12
  v_fma_f32 v144, v144, s50, -v12
  v_fma_f32 v145, v145, s50, -v12
  v_fma_f32 v148, v148, s50, -v12
  v_fma_f32 v149, v149, s50, -v12
  v_fma_f32 v150, v150, s50, -v12
  v_fma_f32 v151, v151, s50, -v12
  v_fma_f32 v152, v152, s50, -v12
  v_fma_f32 v153, v153, s50, -v12
  v_fma_f32 v154, v154, s50, -v12
  v_fma_f32 v155, v155, s50, -v12
  v_exp_f32 v144, v144
  v_exp_f32 v145, v145
  v_exp_f32 v148, v148
  v_exp_f32 v149, v149
  v_exp_f32 v150, v150
  v_exp_f32 v151, v151
  v_exp_f32 v152, v152
  v_exp_f32 v153, v153
  v_exp_f32 v154, v154
  v_exp_f32 v155, v155
  v_add_f32 v12, v144, v145
  v_add_f32 v12, v12, v148
  v_add_f32 v12, v12, v149
  v_add_f32 v12, v12, v150
  v_add_f32 v12, v12, v151
  v_add_f32 v12, v12, v152
  v_add_f32 v12, v12, v153
  v_add_f32 v12, v12, v154
  v_add_f32 v12, v12, v155
  v_mov_b32 v13, v12
  s_nop 1
  v_permlane32_swap_b32 v12, v13
  v_add_f32 v12, v12, v13
  v_mov_b32 v13, v12
  s_nop 1
  v_permlane16_swap_b32 v12, v13
  v_add_f32 v12, v12, v13
  v_rcp_f32 v12, v12
  s_nop 0
  v_mul_f32 v144, v144, v12
  v_mul_f32 v145, v145, v12
  v_mul_f32 v148, v148, v12
  v_mul_f32 v149, v149, v12
  v_mul_f32 v150, v150, v12
  v_mul_f32 v151, v151, v12
  v_mul_f32 v152, v152, v12
  v_mul_f32 v153, v153, v12
  v_mul_f32 v154, v154, v12
  v_mul_f32 v155, v155, v12
  v_cvt_pk_bf16_f32 v168, v144, v145
  v_mov_b32 v169, 0
  v_mov_b32 v170, 0
  v_mov_b32 v171, v168
  v_cvt_pk_bf16_f32 v164, v148, v149
  v_cvt_pk_bf16_f32 v165, v150, v151
  v_cvt_pk_bf16_f32 v166, v152, v153
  v_cvt_pk_bf16_f32 v167, v154, v155
  v_mfma_f32_16x16x32_bf16 v[176:179], a[64:67], v[156:159], 0
  v_mfma_f32_16x16x32_bf16 v[180:183], a[68:71], v[156:159], 0
  v_mfma_f32_16x16x32_bf16 v[184:187], a[72:75], v[156:159], 0
  v_mfma_f32_16x16x32_bf16 v[188:191], a[76:79], v[156:159], 0
  v_mfma_f32_16x16x32_bf16 v[192:195], a[80:83], v[156:159], 0
  v_mfma_f32_16x16x32_bf16 v[196:199], a[84:87], v[156:159], 0
  v_mfma_f32_16x16x32_bf16 v[200:203], a[88:91], v[156:159], 0
  v_mfma_f32_16x16x32_bf16 v[204:207], a[92:95], v[156:159], 0
  v_mfma_f32_16x16x16_bf16 v[176:179], a[112:113], v[160:161], v[176:179]
  v_mfma_f32_16x16x16_bf16 v[180:183], a[112:113], v[162:163], v[180:183]
  v_mfma_f32_16x16x16_bf16 v[184:187], a[114:115], v[160:161], v[184:187]
  v_mfma_f32_16x16x16_bf16 v[188:191], a[114:115], v[162:163], v[188:191]
  v_mfma_f32_16x16x16_bf16 v[192:195], a[116:117], v[160:161], v[192:195]
  v_mfma_f32_16x16x16_bf16 v[196:199], a[116:117], v[162:163], v[196:199]
  v_mfma_f32_16x16x16_bf16 v[200:203], a[118:119], v[160:161], v[200:203]
  v_mfma_f32_16x16x16_bf16 v[204:207], a[118:119], v[162:163], v[204:207]
  v_mfma_f32_16x16x32_bf16 v[208:211], a[64:67], v[164:167], 0
  v_mfma_f32_16x16x32_bf16 v[212:215], a[68:71], v[164:167], 0
  v_mfma_f32_16x16x32_bf16 v[216:219], a[72:75], v[164:167], 0
  v_mfma_f32_16x16x32_bf16 v[220:223], a[76:79], v[164:167], 0
  v_mfma_f32_16x16x32_bf16 v[224:227], a[80:83], v[164:167], 0
  v_mfma_f32_16x16x32_bf16 v[228:231], a[84:87], v[164:167], 0
  v_mfma_f32_16x16x32_bf16 v[232:235], a[88:91], v[164:167], 0
  v_mfma_f32_16x16x32_bf16 v[236:239], a[92:95], v[164:167], 0
  v_mfma_f32_16x16x16_bf16 v[208:211], a[112:113], v[168:169], v[208:211]
  v_mfma_f32_16x16x16_bf16 v[212:215], a[112:113], v[170:171], v[212:215]
  v_mfma_f32_16x16x16_bf16 v[216:219], a[114:115], v[168:169], v[216:219]
  v_mfma_f32_16x16x16_bf16 v[220:223], a[114:115], v[170:171], v[220:223]
  v_mfma_f32_16x16x16_bf16 v[224:227], a[116:117], v[168:169], v[224:227]
  v_mfma_f32_16x16x16_bf16 v[228:231], a[116:117], v[170:171], v[228:231]
  v_mfma_f32_16x16x16_bf16 v[232:235], a[118:119], v[168:169], v[232:235]
  v_mfma_f32_16x16x16_bf16 v[236:239], a[118:119], v[170:171], v[236:239]
  v_cvt_pk_bf16_f32 v136, v176, v177
  v_cvt_pk_bf16_f32 v137, v178, v179
  v_cvt_pk_bf16_f32 v138, v184, v185
  v_cvt_pk_bf16_f32 v139, v186, v187
  buffer_store_dwordx4 v[136:139], v10, s[4:7], s95 offen offset:0 sc1
  v_cvt_pk_bf16_f32 v140, v180, v181
  v_cvt_pk_bf16_f32 v141, v182, v183
  v_cvt_pk_bf16_f32 v142, v188, v189
  v_cvt_pk_bf16_f32 v143, v190, v191
  buffer_store_dwordx4 v[140:143], v10, s[4:7], s95 offen offset:512 sc1
  v_cvt_pk_bf16_f32 v144, v192, v193
  v_cvt_pk_bf16_f32 v145, v194, v195
  v_cvt_pk_bf16_f32 v146, v200, v201
  v_cvt_pk_bf16_f32 v147, v202, v203
  buffer_store_dwordx4 v[144:147], v10, s[4:7], s95 offen offset:2048 sc1
  v_cvt_pk_bf16_f32 v148, v196, v197
  v_cvt_pk_bf16_f32 v149, v198, v199
  v_cvt_pk_bf16_f32 v150, v204, v205
  v_cvt_pk_bf16_f32 v151, v206, v207
  buffer_store_dwordx4 v[148:151], v10, s[4:7], s95 offen offset:2560 sc1
  v_cvt_pk_bf16_f32 v136, v208, v209
  v_cvt_pk_bf16_f32 v137, v210, v211
  v_cvt_pk_bf16_f32 v138, v216, v217
  v_cvt_pk_bf16_f32 v139, v218, v219
  buffer_store_dwordx4 v[136:139], v11, s[4:7], s95 offen offset:0 sc1
  v_cvt_pk_bf16_f32 v140, v212, v213
  v_cvt_pk_bf16_f32 v141, v214, v215
  v_cvt_pk_bf16_f32 v142, v220, v221
  v_cvt_pk_bf16_f32 v143, v222, v223
  buffer_store_dwordx4 v[140:143], v11, s[4:7], s95 offen offset:512 sc1
  v_cvt_pk_bf16_f32 v144, v224, v225
  v_cvt_pk_bf16_f32 v145, v226, v227
  v_cvt_pk_bf16_f32 v146, v232, v233
  v_cvt_pk_bf16_f32 v147, v234, v235
  buffer_store_dwordx4 v[144:147], v11, s[4:7], s95 offen offset:2048 sc1
  v_cvt_pk_bf16_f32 v148, v228, v229
  v_cvt_pk_bf16_f32 v149, v230, v231
  v_cvt_pk_bf16_f32 v150, v236, v237
  v_cvt_pk_bf16_f32 v151, v238, v239
  buffer_store_dwordx4 v[148:151], v11, s[4:7], s95 offen offset:2560 sc1
  s_add_u32 s95, s95, 262144
  s_branch L_done
L_bo:
  s_lshr_b32 s40, s36, 1
  s_lshl_b32 s40, s40, 7
  s_add_u32 s40, s40, 1024
  s_mov_b32 s41, 16
  s_mov_b32 s12, s82
  s_and_b32 s13, s83, 0xffff
  s_mov_b32 s14, 0x200000
  s_mov_b32 s15, 0x20000
  s_mov_b32 s23, 65536
  s_mov_b32 s25, 4
  s_lshl_b32 s20, s36, 18
  s_add_u32 s20, s20, 0x6000000
  s_mov_b32 s22, 2048
  s_branch L_g3
L_aos:
  s_mov_b32 s12, s74
  s_and_b32 s13, s75, 0xffff
  s_mov_b32 s14, 0x800000
  s_mov_b32 s15, 0x20000
  s_and_b32 s48, s37, 7
  s_lshr_b32 s37, s37, 3
  s_sub_u32 s40, s36, 12
  s_lshl_b32 s40, s40, 4
  s_add_u32 s40, s40, s48
  s_lshl_b32 s40, s40, 7
  s_add_u32 s40, s40, 20480
  s_mov_b32 s41, 2
  s_add_u32 s42, s40, 1024
  s_mov_b32 s23, 262144
  s_mov_b32 s25, 2
  s_lshl_b32 s20, s36, 20
  s_add_u32 s20, s20, 0x5000000
  s_lshl_b32 s90, s48, 15
  s_add_u32 s20, s20, s90
  s_mov_b32 s22, 0
  s_lshl_b32 s49, s48, 20
  s_branch L_g3b
L_ao4:
  s_lshl_b32 s40, s36, 7
  s_add_u32 s40, s40, 2048
  s_mov_b32 s41, 32
  s_mov_b32 s42, s40
  s_mov_b32 s12, s74
  s_and_b32 s13, s75, 0xffff
  s_mov_b32 s14, 0x800000
  s_mov_b32 s15, 0x20000
  s_and_b32 s48, s37, 3
  s_lshr_b32 s37, s37, 2
  s_mov_b32 s23, 262144
  s_mov_b32 s25, 4
  s_lshl_b32 s20, s36, 20
  s_add_u32 s20, s20, 0x5000000
  s_lshl_b32 s90, s48, 16
  s_add_u32 s20, s20, s90
  s_mov_b32 s22, 0
  s_lshl_b32 s49, s48, 21
  s_branch L_g3b
L_ao:
  s_lshl_b32 s40, s36, 7
  s_add_u32 s40, s40, 2048
  s_mov_b32 s41, 32
  s_mov_b32 s12, s74
  s_and_b32 s13, s75, 0xffff
  s_mov_b32 s14, 0x800000
  s_mov_b32 s15, 0x20000
  s_mov_b32 s23, 262144
  s_mov_b32 s25, 16
  s_lshl_b32 s20, s36, 20
  s_add_u32 s20, s20, 0x5000000
  s_mov_b32 s22, 0
L_g3:
  s_mov_b32 s49, 0
  s_cmp_eq_u32 s35, 16
  s_cselect_b32 s42, 128, 0
  s_add_u32 s42, s42, s40
L_g3b:
  s_mov_b32 s8, s4
  s_and_b32 s9, s5, 0xffff
  s_mov_b32 s10, 0x10000000
  s_mov_b32 s11, 0x20000
  s_lshl_b32 s91, s33, 1
  s_add_u32 s91, s91, s37
  s_mov_b32 s24, 2048
  s_mov_b32 s26, 4096
  s_lshl_b32 s21, s91, 8
  s_add_u32 s22, s22, s21
  s_lshl_b32 s90, s36, 19
  s_add_u32 s22, s22, s90
  s_add_u32 s21, s21, s49
  s_mov_b32 s50, s91
  s_cmp_lt_u32 s35, 16
  s_cbranch_scc1 L_g3c
  s_cmp_eq_u32 s35, 16
  s_cselect_b32 s25, 21, 5
  s_mov_b32 s48, 2048
  v_and_b32 v1, 63, v0
  v_lshrrev_b32 v23, 6, v0
  s_nop 0
  v_readfirstlane_b32 s27, v23
  s_mul_i32 s90, s27, 2
  s_mul_i32 s90, s90, s23
  v_mov_b32 v2, 0x0
  v_bfe_u32 v24, v1, 0, 6
  v_lshl_add_u32 v2, v24, 4, v2
  v_add_u32 v2, s90, v2
  v_mov_b32 v3, 0x400
  v_bfe_u32 v24, v1, 0, 6
  v_lshl_add_u32 v3, v24, 4, v3
  v_add_u32 v3, s90, v3
  v_mov_b32 v4, 0x1000
  v_bfe_u32 v24, v1, 0, 6
  v_lshl_add_u32 v4, v24, 4, v4
  v_add_u32 v4, s90, v4
  v_mov_b32 v5, 0x1400
  v_bfe_u32 v24, v1, 0, 6
  v_lshl_add_u32 v5, v24, 4, v5
  v_add_u32 v5, s90, v5
  s_add_u32 s90, s90, s23
  v_mov_b32 v6, 0x0
  v_bfe_u32 v24, v1, 0, 6
  v_lshl_add_u32 v6, v24, 4, v6
  v_add_u32 v6, s90, v6
  v_mov_b32 v7, 0x400
  v_bfe_u32 v24, v1, 0, 6
  v_lshl_add_u32 v7, v24, 4, v7
  v_add_u32 v7, s90, v7
  v_mov_b32 v8, 0x1000
  v_bfe_u32 v24, v1, 0, 6
  v_lshl_add_u32 v8, v24, 4, v8
  v_add_u32 v8, s90, v8
  v_mov_b32 v9, 0x1400
  v_bfe_u32 v24, v1, 0, 6
  v_lshl_add_u32 v9, v24, 4, v9
  v_add_u32 v9, s90, v9
  s_mul_i32 s90, s27, 16
  v_lshrrev_b32 v23, 4, v1
  v_add_u32 v23, 0, v23
  v_add_u32 v23, s90, v23
  v_and_b32 v24, 7, v23
  v_lshlrev_b32 v24, 1, v24
  v_xor_b32 v24, v24, v1
  v_and_b32 v24, 15, v24
  v_mul_lo_u32 v23, v23, s24
  v_lshl_add_u32 v10, v24, 4, v23
  v_lshrrev_b32 v23, 4, v1
  v_add_u32 v23, 4, v23
  v_add_u32 v23, s90, v23
  v_and_b32 v24, 7, v23
  v_lshlrev_b32 v24, 1, v24
  v_xor_b32 v24, v24, v1
  v_and_b32 v24, 15, v24
  v_mul_lo_u32 v23, v23, s24
  v_lshl_add_u32 v11, v24, 4, v23
  v_lshrrev_b32 v23, 4, v1
  v_add_u32 v23, 8, v23
  v_add_u32 v23, s90, v23
  v_and_b32 v24, 7, v23
  v_lshlrev_b32 v24, 1, v24
  v_xor_b32 v24, v24, v1
  v_and_b32 v24, 15, v24
  v_mul_lo_u32 v23, v23, s24
  v_lshl_add_u32 v12, v24, 4, v23
  v_lshrrev_b32 v23, 4, v1
  v_add_u32 v23, 12, v23
  v_add_u32 v23, s90, v23
  v_and_b32 v24, 7, v23
  v_lshlrev_b32 v24, 1, v24
  v_xor_b32 v24, v24, v1
  v_and_b32 v24, 15, v24
  v_mul_lo_u32 v23, v23, s24
  v_lshl_add_u32 v13, v24, 4, v23
  s_mul_i32 s51, s24, 64
  s_mul_i32 s52, s27, 8192
  s_mul_i32 s53, s27, 4096
  s_add_u32 s53, s53, 32768
  s_add_u32 m0, s53, 0
  s_nop 0
  buffer_load_dwordx4 v10, s[12:15], s21 offen  lds
  s_add_u32 m0, s53, 1024
  s_nop 0
  buffer_load_dwordx4 v11, s[12:15], s21 offen  lds
  s_add_u32 m0, s53, 2048
  s_nop 0
  buffer_load_dwordx4 v12, s[12:15], s21 offen  lds
  s_add_u32 m0, s53, 3072
  s_nop 0
  buffer_load_dwordx4 v13, s[12:15], s21 offen  lds
  s_add_u32 s21, s21, s51
  s_add_u32 m0, s53, 49152
  s_nop 0
  buffer_load_dwordx4 v10, s[12:15], s21 offen  lds
  s_add_u32 m0, s53, 50176
  s_nop 0
  buffer_load_dwordx4 v11, s[12:15], s21 offen  lds
  s_add_u32 m0, s53, 51200
  s_nop 0
  buffer_load_dwordx4 v12, s[12:15], s21 offen  lds
  s_add_u32 m0, s53, 52224
  s_nop 0
  buffer_load_dwordx4 v13, s[12:15], s21 offen  lds
  s_add_u32 s21, s21, s51
  s_add_u32 m0, s53, 98304
  s_nop 0
  buffer_load_dwordx4 v10, s[12:15], s21 offen  lds
  s_add_u32 m0, s53, 99328
  s_nop 0
  buffer_load_dwordx4 v11, s[12:15], s21 offen  lds
  s_add_u32 m0, s53, 100352
  s_nop 0
  buffer_load_dwordx4 v12, s[12:15], s21 offen  lds
  s_add_u32 m0, s53, 101376
  s_nop 0
  buffer_load_dwordx4 v13, s[12:15], s21 offen  lds
  s_add_u32 s21, s21, s51
  s_cmp_lg_u32 s32, 0
  s_cbranch_scc1 L_dd_99
  v_mov_b32 v228, 0x3d00000
L_dw_98:
  buffer_load_dword v234, v228, s[4:7], s40 offen offset:0 sc1
  buffer_load_dword v235, v228, s[4:7], s42 offen offset:0 sc1
  s_waitcnt vmcnt(0)
  s_mov_b32 s44, 1
  v_readfirstlane_b32 s45, v234
  s_cmp_ge_u32 s45, s41
  s_cselect_b32 s44, s44, 0
  v_readfirstlane_b32 s45, v235
  s_cmp_ge_u32 s45, s41
  s_cselect_b32 s44, s44, 0
  s_cmp_eq_u32 s44, 1
  s_cbranch_scc1 L_dd_99
  s_sleep 3
  s_add_u32 s3, s3, 1
  s_cmp_lt_u32 s3, 131072
  s_cbranch_scc1 L_dw_98
L_dd_99:
  s_barrier
  s_add_u32 m0, s52, 0
  s_nop 0
  buffer_load_dwordx4 v2, s[8:11], s20 offen sc1 lds
  s_add_u32 m0, s52, 1024
  s_nop 0
  buffer_load_dwordx4 v3, s[8:11], s20 offen sc1 lds
  s_add_u32 m0, s52, 2048
  s_nop 0
  buffer_load_dwordx4 v4, s[8:11], s20 offen sc1 lds
  s_add_u32 m0, s52, 3072
  s_nop 0
  buffer_load_dwordx4 v5, s[8:11], s20 offen sc1 lds
  s_add_u32 m0, s52, 4096
  s_nop 0
  buffer_load_dwordx4 v6, s[8:11], s20 offen sc1 lds
  s_add_u32 m0, s52, 5120
  s_nop 0
  buffer_load_dwordx4 v7, s[8:11], s20 offen sc1 lds
  s_add_u32 m0, s52, 6144
  s_nop 0
  buffer_load_dwordx4 v8, s[8:11], s20 offen sc1 lds
  s_add_u32 m0, s52, 7168
  s_nop 0
  buffer_load_dwordx4 v9, s[8:11], s20 offen sc1 lds
  s_add_u32 s20, s20, s48
  s_xor_b32 s48, s48, 4096
  s_add_u32 m0, s52, 49152
  s_nop 0
  buffer_load_dwordx4 v2, s[8:11], s20 offen sc1 lds
  s_add_u32 m0, s52, 50176
  s_nop 0
  buffer_load_dwordx4 v3, s[8:11], s20 offen sc1 lds
  s_add_u32 m0, s52, 51200
  s_nop 0
  buffer_load_dwordx4 v4, s[8:11], s20 offen sc1 lds
  s_add_u32 m0, s52, 52224
  s_nop 0
  buffer_load_dwordx4 v5, s[8:11], s20 offen sc1 lds
  s_add_u32 m0, s52, 53248
  s_nop 0
  buffer_load_dwordx4 v6, s[8:11], s20 offen sc1 lds
  s_add_u32 m0, s52, 54272
  s_nop 0
  buffer_load_dwordx4 v7, s[8:11], s20 offen sc1 lds
  s_add_u32 m0, s52, 55296
  s_nop 0
  buffer_load_dwordx4 v8, s[8:11], s20 offen sc1 lds
  s_add_u32 m0, s52, 56320
  s_nop 0
  buffer_load_dwordx4 v9, s[8:11], s20 offen sc1 lds
  s_add_u32 s20, s20, s48
  s_xor_b32 s48, s48, 4096
  s_add_u32 m0, s52, 98304
  s_nop 0
  buffer_load_dwordx4 v2, s[8:11], s20 offen sc1 lds
  s_add_u32 m0, s52, 99328
  s_nop 0
  buffer_load_dwordx4 v3, s[8:11], s20 offen sc1 lds
  s_add_u32 m0, s52, 100352
  s_nop 0
  buffer_load_dwordx4 v4, s[8:11], s20 offen sc1 lds
  s_add_u32 m0, s52, 101376
  s_nop 0
  buffer_load_dwordx4 v5, s[8:11], s20 offen sc1 lds
  s_add_u32 m0, s52, 102400
  s_nop 0
  buffer_load_dwordx4 v6, s[8:11], s20 offen sc1 lds
  s_add_u32 m0, s52, 103424
  s_nop 0
  buffer_load_dwordx4 v7, s[8:11], s20 offen sc1 lds
  s_add_u32 m0, s52, 104448
  s_nop 0
  buffer_load_dwordx4 v8, s[8:11], s20 offen sc1 lds
  s_add_u32 m0, s52, 105472
  s_nop 0
  buffer_load_dwordx4 v9, s[8:11], s20 offen sc1 lds
  s_add_u32 s20, s20, s48
  s_xor_b32 s48, s48, 4096
  s_lshr_b32 s90, s27, 1
  s_and_b32 s91, s27, 1
  s_mul_i32 s92, s90, 16384
  v_mov_b32 v14, 0x0
  v_bfe_u32 v24, v1, 0, 6
  v_lshl_add_u32 v14, v24, 4, v14
  v_add_u32 v14, s92, v14
  v_add_u32 v15, 65536, v14
  v_add_u32 v16, 131072, v14
  v_mov_b32 v23, 0x0
  v_bfe_u32 v24, v1, 2, 2
  v_lshl_add_u32 v23, v24, 8, v23
  v_bfe_u32 v24, v1, 4, 2
  v_lshl_add_u32 v23, v24, 10, v23
  v_bfe_u32 v24, v1, 0, 1
  v_lshl_add_u32 v23, v24, 4, v23
  v_bfe_u32 v25, v1, 2, 3
  v_bfe_u32 v24, v1, 1, 1
  v_xor_b32 v25, v25, v24
  s_mul_i32 s92, s91, 4
  s_add_u32 s93, s92, 0
  v_xor_b32 v24, s93, v25
  v_lshl_add_u32 v17, v24, 5, v23
  v_add_u32 v19, 65536, v17
  v_add_u32 v21, 131072, v17
  s_add_u32 s93, s92, 2
  v_xor_b32 v24, s93, v25
  v_lshl_add_u32 v18, v24, 5, v23
  v_add_u32 v20, 65536, v18
  v_add_u32 v22, 131072, v18
  s_waitcnt vmcnt(16)
  s_barrier
  ds_read_b128 v[28:31], v14 offset:0
  ds_read_b64_tr_b16 v[92:93], v17 offset:32768
  ds_read_b64_tr_b16 v[94:95], v17 offset:36864
  ds_read_b128 v[32:35], v14 offset:2048
  ds_read_b64_tr_b16 v[96:97], v17 offset:32776
  ds_read_b64_tr_b16 v[98:99], v17 offset:36872
  ds_read_b128 v[36:39], v14 offset:4096
  ds_read_b64_tr_b16 v[100:101], v18 offset:32768
  ds_read_b64_tr_b16 v[102:103], v18 offset:36864
  ds_read_b128 v[40:43], v14 offset:6144
  ds_read_b64_tr_b16 v[104:105], v18 offset:32776
  ds_read_b64_tr_b16 v[106:107], v18 offset:36872
  ds_read_b128 v[44:47], v14 offset:8192
  ds_read_b128 v[48:51], v14 offset:10240
  ds_read_b128 v[52:55], v14 offset:12288
  ds_read_b128 v[56:59], v14 offset:14336
  s_sub_u32 s25, s25, 1
  s_waitcnt lgkmcnt(0)
  v_mfma_f32_16x16x32_bf16 a[0:3], v[92:95], v[28:31], 0
  ds_read_b128 v[60:63], v14 offset:1024
  v_mfma_f32_16x16x32_bf16 a[4:7], v[96:99], v[28:31], 0
  ds_read_b64_tr_b16 v[108:109], v17 offset:40960
  v_mfma_f32_16x16x32_bf16 a[8:11], v[100:103], v[28:31], 0
  ds_read_b64_tr_b16 v[110:111], v17 offset:45056
  v_mfma_f32_16x16x32_bf16 a[12:15], v[104:107], v[28:31], 0
  ds_read_b128 v[64:67], v14 offset:3072
  v_mfma_f32_16x16x32_bf16 a[16:19], v[92:95], v[32:35], 0
  ds_read_b64_tr_b16 v[112:113], v17 offset:40968
  v_mfma_f32_16x16x32_bf16 a[20:23], v[96:99], v[32:35], 0
  ds_read_b64_tr_b16 v[114:115], v17 offset:45064
  v_mfma_f32_16x16x32_bf16 a[24:27], v[100:103], v[32:35], 0
  ds_read_b128 v[68:71], v14 offset:5120
  v_mfma_f32_16x16x32_bf16 a[28:31], v[104:107], v[32:35], 0
  ds_read_b64_tr_b16 v[116:117], v18 offset:40960
  v_mfma_f32_16x16x32_bf16 a[32:35], v[92:95], v[36:39], 0
  ds_read_b64_tr_b16 v[118:119], v18 offset:45056
  v_mfma_f32_16x16x32_bf16 a[36:39], v[96:99], v[36:39], 0
  ds_read_b128 v[72:75], v14 offset:7168
  v_mfma_f32_16x16x32_bf16 a[40:43], v[100:103], v[36:39], 0
  ds_read_b64_tr_b16 v[120:121], v18 offset:40968
  v_mfma_f32_16x16x32_bf16 a[44:47], v[104:107], v[36:39], 0
  ds_read_b64_tr_b16 v[122:123], v18 offset:45064
  v_mfma_f32_16x16x32_bf16 a[48:51], v[92:95], v[40:43], 0
  ds_read_b128 v[76:79], v14 offset:9216
  v_mfma_f32_16x16x32_bf16 a[52:55], v[96:99], v[40:43], 0
  ds_read_b128 v[80:83], v14 offset:11264
  v_mfma_f32_16x16x32_bf16 a[56:59], v[100:103], v[40:43], 0
  ds_read_b128 v[84:87], v14 offset:13312
  v_mfma_f32_16x16x32_bf16 a[60:63], v[104:107], v[40:43], 0
  ds_read_b128 v[88:91], v14 offset:15360
  v_mfma_f32_16x16x32_bf16 a[64:67], v[92:95], v[44:47], 0
  v_mfma_f32_16x16x32_bf16 a[68:71], v[96:99], v[44:47], 0
  v_mfma_f32_16x16x32_bf16 a[72:75], v[100:103], v[44:47], 0
  v_mfma_f32_16x16x32_bf16 a[76:79], v[104:107], v[44:47], 0
  v_mfma_f32_16x16x32_bf16 a[80:83], v[92:95], v[48:51], 0
  v_mfma_f32_16x16x32_bf16 a[84:87], v[96:99], v[48:51], 0
  v_mfma_f32_16x16x32_bf16 a[88:91], v[100:103], v[48:51], 0
  v_mfma_f32_16x16x32_bf16 a[92:95], v[104:107], v[48:51], 0
  v_mfma_f32_16x16x32_bf16 a[96:99], v[92:95], v[52:55], 0
  v_mfma_f32_16x16x32_bf16 a[100:103], v[96:99], v[52:55], 0
  v_mfma_f32_16x16x32_bf16 a[104:107], v[100:103], v[52:55], 0
  v_mfma_f32_16x16x32_bf16 a[108:111], v[104:107], v[52:55], 0
  v_mfma_f32_16x16x32_bf16 a[112:115], v[92:95], v[56:59], 0
  v_mfma_f32_16x16x32_bf16 a[116:119], v[96:99], v[56:59], 0
  v_mfma_f32_16x16x32_bf16 a[120:123], v[100:103], v[56:59], 0
  v_mfma_f32_16x16x32_bf16 a[124:127], v[104:107], v[56:59], 0
  s_waitcnt lgkmcnt(0)
  v_mfma_f32_16x16x32_bf16 a[0:3], v[108:111], v[60:63], a[0:3]
  s_waitcnt vmcnt(8)
  s_barrier
  s_add_u32 m0, s52, 0
  v_mfma_f32_16x16x32_bf16 a[4:7], v[112:115], v[60:63], a[4:7]
  buffer_load_dwordx4 v2, s[8:11], s20 offen sc1 lds
  ds_read_b128 v[28:31], v14 offset:49152
  v_mfma_f32_16x16x32_bf16 a[8:11], v[116:119], v[60:63], a[8:11]
  ds_read_b64_tr_b16 v[92:93], v19 offset:16384
  v_mfma_f32_16x16x32_bf16 a[12:15], v[120:123], v[60:63], a[12:15]
  ds_read_b64_tr_b16 v[94:95], v19 offset:20480
  v_mfma_f32_16x16x32_bf16 a[16:19], v[108:111], v[64:67], a[16:19]
  ds_read_b128 v[32:35], v14 offset:51200
  s_add_u32 m0, s53, 0
  v_mfma_f32_16x16x32_bf16 a[20:23], v[112:115], v[64:67], a[20:23]
  buffer_load_dwordx4 v10, s[12:15], s21 offen  lds
  ds_read_b64_tr_b16 v[96:97], v19 offset:16392
  v_mfma_f32_16x16x32_bf16 a[24:27], v[116:119], v[64:67], a[24:27]
  ds_read_b64_tr_b16 v[98:99], v19 offset:20488
  v_mfma_f32_16x16x32_bf16 a[28:31], v[120:123], v[64:67], a[28:31]
  ds_read_b128 v[36:39], v14 offset:53248
  v_mfma_f32_16x16x32_bf16 a[32:35], v[108:111], v[68:71], a[32:35]
  ds_read_b64_tr_b16 v[100:101], v20 offset:16384
  s_add_u32 m0, s52, 1024
  v_mfma_f32_16x16x32_bf16 a[36:39], v[112:115], v[68:71], a[36:39]
  buffer_load_dwordx4 v3, s[8:11], s20 offen sc1 lds
  ds_read_b64_tr_b16 v[102:103], v20 offset:20480
  v_mfma_f32_16x16x32_bf16 a[40:43], v[116:119], v[68:71], a[40:43]
  ds_read_b128 v[40:43], v14 offset:55296
  v_mfma_f32_16x16x32_bf16 a[44:47], v[120:123], v[68:71], a[44:47]
  ds_read_b64_tr_b16 v[104:105], v20 offset:16392
  v_mfma_f32_16x16x32_bf16 a[48:51], v[108:111], v[72:75], a[48:51]
  ds_read_b64_tr_b16 v[106:107], v20 offset:20488
  v_mfma_f32_16x16x32_bf16 a[52:55], v[112:115], v[72:75], a[52:55]
  ds_read_b128 v[44:47], v14 offset:57344
  s_add_u32 m0, s53, 1024
  v_mfma_f32_16x16x32_bf16 a[56:59], v[116:119], v[72:75], a[56:59]
  buffer_load_dwordx4 v11, s[12:15], s21 offen  lds
  ds_read_b128 v[48:51], v14 offset:59392
  v_mfma_f32_16x16x32_bf16 a[60:63], v[120:123], v[72:75], a[60:63]
  ds_read_b128 v[52:55], v14 offset:61440
  v_mfma_f32_16x16x32_bf16 a[64:67], v[108:111], v[76:79], a[64:67]
  ds_read_b128 v[56:59], v14 offset:63488
  v_mfma_f32_16x16x32_bf16 a[68:71], v[112:115], v[76:79], a[68:71]
  s_add_u32 m0, s52, 2048
  v_mfma_f32_16x16x32_bf16 a[72:75], v[116:119], v[76:79], a[72:75]
  buffer_load_dwordx4 v4, s[8:11], s20 offen sc1 lds
  v_mfma_f32_16x16x32_bf16 a[76:79], v[120:123], v[76:79], a[76:79]
  v_mfma_f32_16x16x32_bf16 a[80:83], v[108:111], v[80:83], a[80:83]
  v_mfma_f32_16x16x32_bf16 a[84:87], v[112:115], v[80:83], a[84:87]
  v_mfma_f32_16x16x32_bf16 a[88:91], v[116:119], v[80:83], a[88:91]
  s_add_u32 m0, s53, 2048
  v_mfma_f32_16x16x32_bf16 a[92:95], v[120:123], v[80:83], a[92:95]
  buffer_load_dwordx4 v12, s[12:15], s21 offen  lds
  v_mfma_f32_16x16x32_bf16 a[96:99], v[108:111], v[84:87], a[96:99]
  v_mfma_f32_16x16x32_bf16 a[100:103], v[112:115], v[84:87], a[100:103]
  v_mfma_f32_16x16x32_bf16 a[104:107], v[116:119], v[84:87], a[104:107]
  s_add_u32 m0, s52, 3072
  v_mfma_f32_16x16x32_bf16 a[108:111], v[120:123], v[84:87], a[108:111]
  buffer_load_dwordx4 v5, s[8:11], s20 offen sc1 lds
  v_mfma_f32_16x16x32_bf16 a[112:115], v[108:111], v[88:91], a[112:115]
  v_mfma_f32_16x16x32_bf16 a[116:119], v[112:115], v[88:91], a[116:119]
  v_mfma_f32_16x16x32_bf16 a[120:123], v[116:119], v[88:91], a[120:123]
  v_mfma_f32_16x16x32_bf16 a[124:127], v[120:123], v[88:91], a[124:127]
  s_waitcnt lgkmcnt(0)
  s_add_u32 m0, s53, 3072
  v_mfma_f32_16x16x32_bf16 a[0:3], v[92:95], v[28:31], a[0:3]
  buffer_load_dwordx4 v13, s[12:15], s21 offen  lds
  ds_read_b128 v[60:63], v14 offset:50176
  v_mfma_f32_16x16x32_bf16 a[4:7], v[96:99], v[28:31], a[4:7]
  ds_read_b64_tr_b16 v[108:109], v19 offset:24576
  v_mfma_f32_16x16x32_bf16 a[8:11], v[100:103], v[28:31], a[8:11]
  ds_read_b64_tr_b16 v[110:111], v19 offset:28672
  v_mfma_f32_16x16x32_bf16 a[12:15], v[104:107], v[28:31], a[12:15]
  ds_read_b128 v[64:67], v14 offset:52224
  v_mfma_f32_16x16x32_bf16 a[16:19], v[92:95], v[32:35], a[16:19]
  ds_read_b64_tr_b16 v[112:113], v19 offset:24584
  s_add_u32 m0, s52, 4096
  v_mfma_f32_16x16x32_bf16 a[20:23], v[96:99], v[32:35], a[20:23]
  buffer_load_dwordx4 v6, s[8:11], s20 offen sc1 lds
  ds_read_b64_tr_b16 v[114:115], v19 offset:28680
  v_mfma_f32_16x16x32_bf16 a[24:27], v[100:103], v[32:35], a[24:27]
  ds_read_b128 v[68:71], v14 offset:54272
  v_mfma_f32_16x16x32_bf16 a[28:31], v[104:107], v[32:35], a[28:31]
  ds_read_b64_tr_b16 v[116:117], v20 offset:24576
  v_mfma_f32_16x16x32_bf16 a[32:35], v[92:95], v[36:39], a[32:35]
  ds_read_b64_tr_b16 v[118:119], v20 offset:28672
  v_mfma_f32_16x16x32_bf16 a[36:39], v[96:99], v[36:39], a[36:39]
  ds_read_b128 v[72:75], v14 offset:56320
  s_add_u32 m0, s52, 5120
  v_mfma_f32_16x16x32_bf16 a[40:43], v[100:103], v[36:39], a[40:43]
  buffer_load_dwordx4 v7, s[8:11], s20 offen sc1 lds
  ds_read_b64_tr_b16 v[120:121], v20 offset:24584
  v_mfma_f32_16x16x32_bf16 a[44:47], v[104:107], v[36:39], a[44:47]
  ds_read_b64_tr_b16 v[122:123], v20 offset:28680
  v_mfma_f32_16x16x32_bf16 a[48:51], v[92:95], v[40:43], a[48:51]
  ds_read_b128 v[76:79], v14 offset:58368
  v_mfma_f32_16x16x32_bf16 a[52:55], v[96:99], v[40:43], a[52:55]
  ds_read_b128 v[80:83], v14 offset:60416
  v_mfma_f32_16x16x32_bf16 a[56:59], v[100:103], v[40:43], a[56:59]
  ds_read_b128 v[84:87], v14 offset:62464
  v_mfma_f32_16x16x32_bf16 a[60:63], v[104:107], v[40:43], a[60:63]
  ds_read_b128 v[88:91], v14 offset:64512
  s_add_u32 m0, s52, 6144
  v_mfma_f32_16x16x32_bf16 a[64:67], v[92:95], v[44:47], a[64:67]
  buffer_load_dwordx4 v8, s[8:11], s20 offen sc1 lds
  v_mfma_f32_16x16x32_bf16 a[68:71], v[96:99], v[44:47], a[68:71]
  v_mfma_f32_16x16x32_bf16 a[72:75], v[100:103], v[44:47], a[72:75]
  v_mfma_f32_16x16x32_bf16 a[76:79], v[104:107], v[44:47], a[76:79]
  v_mfma_f32_16x16x32_bf16 a[80:83], v[92:95], v[48:51], a[80:83]
  s_add_u32 m0, s52, 7168
  v_mfma_f32_16x16x32_bf16 a[84:87], v[96:99], v[48:51], a[84:87]
  buffer_load_dwordx4 v9, s[8:11], s20 offen sc1 lds
  v_mfma_f32_16x16x32_bf16 a[88:91], v[100:103], v[48:51], a[88:91]
  v_mfma_f32_16x16x32_bf16 a[92:95], v[104:107], v[48:51], a[92:95]
  v_mfma_f32_16x16x32_bf16 a[96:99], v[92:95], v[52:55], a[96:99]
  v_mfma_f32_16x16x32_bf16 a[100:103], v[96:99], v[52:55], a[100:103]
  s_add_u32 s20, s20, s48
  s_xor_b32 s48, s48, 4096
  v_mfma_f32_16x16x32_bf16 a[104:107], v[100:103], v[52:55], a[104:107]
  s_add_u32 s21, s21, s51
  v_mfma_f32_16x16x32_bf16 a[108:111], v[104:107], v[52:55], a[108:111]
  v_mfma_f32_16x16x32_bf16 a[112:115], v[92:95], v[56:59], a[112:115]
  v_mfma_f32_16x16x32_bf16 a[116:119], v[96:99], v[56:59], a[116:119]
  v_mfma_f32_16x16x32_bf16 a[120:123], v[100:103], v[56:59], a[120:123]
  v_mfma_f32_16x16x32_bf16 a[124:127], v[104:107], v[56:59], a[124:127]
  s_waitcnt lgkmcnt(0)
  v_mfma_f32_16x16x32_bf16 a[0:3], v[108:111], v[60:63], a[0:3]
  s_waitcnt vmcnt(12)
  s_barrier
  s_add_u32 m0, s52, 49152
  v_mfma_f32_16x16x32_bf16 a[4:7], v[112:115], v[60:63], a[4:7]
  buffer_load_dwordx4 v2, s[8:11], s20 offen sc1 lds
  ds_read_b128 v[28:31], v15 offset:32768
  v_mfma_f32_16x16x32_bf16 a[8:11], v[116:119], v[60:63], a[8:11]
  ds_read_b64_tr_b16 v[92:93], v21 offset:0
  v_mfma_f32_16x16x32_bf16 a[12:15], v[120:123], v[60:63], a[12:15]
  ds_read_b64_tr_b16 v[94:95], v21 offset:4096
  v_mfma_f32_16x16x32_bf16 a[16:19], v[108:111], v[64:67], a[16:19]
  ds_read_b128 v[32:35], v15 offset:34816
  s_add_u32 m0, s53, 49152
  v_mfma_f32_16x16x32_bf16 a[20:23], v[112:115], v[64:67], a[20:23]
  buffer_load_dwordx4 v10, s[12:15], s21 offen  lds
  ds_read_b64_tr_b16 v[96:97], v21 offset:8
  v_mfma_f32_16x16x32_bf16 a[24:27], v[116:119], v[64:67], a[24:27]
  ds_read_b64_tr_b16 v[98:99], v21 offset:4104
  v_mfma_f32_16x16x32_bf16 a[28:31], v[120:123], v[64:67], a[28:31]
  ds_read_b128 v[36:39], v15 offset:36864
  v_mfma_f32_16x16x32_bf16 a[32:35], v[108:111], v[68:71], a[32:35]
  ds_read_b64_tr_b16 v[100:101], v22 offset:0
  s_add_u32 m0, s52, 50176
  v_mfma_f32_16x16x32_bf16 a[36:39], v[112:115], v[68:71], a[36:39]
  buffer_load_dwordx4 v3, s[8:11], s20 offen sc1 lds
  ds_read_b64_tr_b16 v[102:103], v22 offset:4096
  v_mfma_f32_16x16x32_bf16 a[40:43], v[116:119], v[68:71], a[40:43]
  ds_read_b128 v[40:43], v15 offset:38912
  v_mfma_f32_16x16x32_bf16 a[44:47], v[120:123], v[68:71], a[44:47]
  ds_read_b64_tr_b16 v[104:105], v22 offset:8
  v_mfma_f32_16x16x32_bf16 a[48:51], v[108:111], v[72:75], a[48:51]
  ds_read_b64_tr_b16 v[106:107], v22 offset:4104
  v_mfma_f32_16x16x32_bf16 a[52:55], v[112:115], v[72:75], a[52:55]
  ds_read_b128 v[44:47], v15 offset:40960
  s_add_u32 m0, s53, 50176
  v_mfma_f32_16x16x32_bf16 a[56:59], v[116:119], v[72:75], a[56:59]
  buffer_load_dwordx4 v11, s[12:15], s21 offen  lds
  ds_read_b128 v[48:51], v15 offset:43008
  v_mfma_f32_16x16x32_bf16 a[60:63], v[120:123], v[72:75], a[60:63]
  ds_read_b128 v[52:55], v15 offset:45056
  v_mfma_f32_16x16x32_bf16 a[64:67], v[108:111], v[76:79], a[64:67]
  ds_read_b128 v[56:59], v15 offset:47104
  v_mfma_f32_16x16x32_bf16 a[68:71], v[112:115], v[76:79], a[68:71]
  s_add_u32 m0, s52, 51200
  v_mfma_f32_16x16x32_bf16 a[72:75], v[116:119], v[76:79], a[72:75]
  buffer_load_dwordx4 v4, s[8:11], s20 offen sc1 lds
  v_mfma_f32_16x16x32_bf16 a[76:79], v[120:123], v[76:79], a[76:79]
  v_mfma_f32_16x16x32_bf16 a[80:83], v[108:111], v[80:83], a[80:83]
  v_mfma_f32_16x16x32_bf16 a[84:87], v[112:115], v[80:83], a[84:87]
  v_mfma_f32_16x16x32_bf16 a[88:91], v[116:119], v[80:83], a[88:91]
  s_add_u32 m0, s53, 51200
  v_mfma_f32_16x16x32_bf16 a[92:95], v[120:123], v[80:83], a[92:95]
  buffer_load_dwordx4 v12, s[12:15], s21 offen  lds
  v_mfma_f32_16x16x32_bf16 a[96:99], v[108:111], v[84:87], a[96:99]
  v_mfma_f32_16x16x32_bf16 a[100:103], v[112:115], v[84:87], a[100:103]
  v_mfma_f32_16x16x32_bf16 a[104:107], v[116:119], v[84:87], a[104:107]
  s_add_u32 m0, s52, 52224
  v_mfma_f32_16x16x32_bf16 a[108:111], v[120:123], v[84:87], a[108:111]
  buffer_load_dwordx4 v5, s[8:11], s20 offen sc1 lds
  v_mfma_f32_16x16x32_bf16 a[112:115], v[108:111], v[88:91], a[112:115]
  v_mfma_f32_16x16x32_bf16 a[116:119], v[112:115], v[88:91], a[116:119]
  v_mfma_f32_16x16x32_bf16 a[120:123], v[116:119], v[88:91], a[120:123]
  v_mfma_f32_16x16x32_bf16 a[124:127], v[120:123], v[88:91], a[124:127]
  s_waitcnt lgkmcnt(0)
  s_add_u32 m0, s53, 52224
  v_mfma_f32_16x16x32_bf16 a[0:3], v[92:95], v[28:31], a[0:3]
  buffer_load_dwordx4 v13, s[12:15], s21 offen  lds
  ds_read_b128 v[60:63], v15 offset:33792
  v_mfma_f32_16x16x32_bf16 a[4:7], v[96:99], v[28:31], a[4:7]
  ds_read_b64_tr_b16 v[108:109], v21 offset:8192
  v_mfma_f32_16x16x32_bf16 a[8:11], v[100:103], v[28:31], a[8:11]
  ds_read_b64_tr_b16 v[110:111], v21 offset:12288
  v_mfma_f32_16x16x32_bf16 a[12:15], v[104:107], v[28:31], a[12:15]
  ds_read_b128 v[64:67], v15 offset:35840
  v_mfma_f32_16x16x32_bf16 a[16:19], v[92:95], v[32:35], a[16:19]
  ds_read_b64_tr_b16 v[112:113], v21 offset:8200
  s_add_u32 m0, s52, 53248
  v_mfma_f32_16x16x32_bf16 a[20:23], v[96:99], v[32:35], a[20:23]
  buffer_load_dwordx4 v6, s[8:11], s20 offen sc1 lds
  ds_read_b64_tr_b16 v[114:115], v21 offset:12296
  v_mfma_f32_16x16x32_bf16 a[24:27], v[100:103], v[32:35], a[24:27]
  ds_read_b128 v[68:71], v15 offset:37888
  v_mfma_f32_16x16x32_bf16 a[28:31], v[104:107], v[32:35], a[28:31]
  ds_read_b64_tr_b16 v[116:117], v22 offset:8192
  v_mfma_f32_16x16x32_bf16 a[32:35], v[92:95], v[36:39], a[32:35]
  ds_read_b64_tr_b16 v[118:119], v22 offset:12288
  v_mfma_f32_16x16x32_bf16 a[36:39], v[96:99], v[36:39], a[36:39]
  ds_read_b128 v[72:75], v15 offset:39936
  s_add_u32 m0, s52, 54272
  v_mfma_f32_16x16x32_bf16 a[40:43], v[100:103], v[36:39], a[40:43]
  buffer_load_dwordx4 v7, s[8:11], s20 offen sc1 lds
  ds_read_b64_tr_b16 v[120:121], v22 offset:8200
  v_mfma_f32_16x16x32_bf16 a[44:47], v[104:107], v[36:39], a[44:47]
  ds_read_b64_tr_b16 v[122:123], v22 offset:12296
  v_mfma_f32_16x16x32_bf16 a[48:51], v[92:95], v[40:43], a[48:51]
  ds_read_b128 v[76:79], v15 offset:41984
  v_mfma_f32_16x16x32_bf16 a[52:55], v[96:99], v[40:43], a[52:55]
  ds_read_b128 v[80:83], v15 offset:44032
  v_mfma_f32_16x16x32_bf16 a[56:59], v[100:103], v[40:43], a[56:59]
  ds_read_b128 v[84:87], v15 offset:46080
  v_mfma_f32_16x16x32_bf16 a[60:63], v[104:107], v[40:43], a[60:63]
  ds_read_b128 v[88:91], v15 offset:48128
  s_add_u32 m0, s52, 55296
  v_mfma_f32_16x16x32_bf16 a[64:67], v[92:95], v[44:47], a[64:67]
  buffer_load_dwordx4 v8, s[8:11], s20 offen sc1 lds
  v_mfma_f32_16x16x32_bf16 a[68:71], v[96:99], v[44:47], a[68:71]
  v_mfma_f32_16x16x32_bf16 a[72:75], v[100:103], v[44:47], a[72:75]
  v_mfma_f32_16x16x32_bf16 a[76:79], v[104:107], v[44:47], a[76:79]
  v_mfma_f32_16x16x32_bf16 a[80:83], v[92:95], v[48:51], a[80:83]
  s_add_u32 m0, s52, 56320
  v_mfma_f32_16x16x32_bf16 a[84:87], v[96:99], v[48:51], a[84:87]
  buffer_load_dwordx4 v9, s[8:11], s20 offen sc1 lds
  v_mfma_f32_16x16x32_bf16 a[88:91], v[100:103], v[48:51], a[88:91]
  v_mfma_f32_16x16x32_bf16 a[92:95], v[104:107], v[48:51], a[92:95]
  v_mfma_f32_16x16x32_bf16 a[96:99], v[92:95], v[52:55], a[96:99]
  v_mfma_f32_16x16x32_bf16 a[100:103], v[96:99], v[52:55], a[100:103]
  s_add_u32 s20, s20, s48
  s_xor_b32 s48, s48, 4096
  v_mfma_f32_16x16x32_bf16 a[104:107], v[100:103], v[52:55], a[104:107]
  s_add_u32 s21, s21, s51
  v_mfma_f32_16x16x32_bf16 a[108:111], v[104:107], v[52:55], a[108:111]
  v_mfma_f32_16x16x32_bf16 a[112:115], v[92:95], v[56:59], a[112:115]
  v_mfma_f32_16x16x32_bf16 a[116:119], v[96:99], v[56:59], a[116:119]
  v_mfma_f32_16x16x32_bf16 a[120:123], v[100:103], v[56:59], a[120:123]
  v_mfma_f32_16x16x32_bf16 a[124:127], v[104:107], v[56:59], a[124:127]
  s_waitcnt lgkmcnt(0)
  v_mfma_f32_16x16x32_bf16 a[0:3], v[108:111], v[60:63], a[0:3]
  s_waitcnt vmcnt(12)
  s_barrier
  s_add_u32 m0, s52, 98304
  v_mfma_f32_16x16x32_bf16 a[4:7], v[112:115], v[60:63], a[4:7]
  buffer_load_dwordx4 v2, s[8:11], s20 offen sc1 lds
  ds_read_b128 v[28:31], v14 offset:0
  v_mfma_f32_16x16x32_bf16 a[8:11], v[116:119], v[60:63], a[8:11]
  ds_read_b64_tr_b16 v[92:93], v17 offset:32768
  v_mfma_f32_16x16x32_bf16 a[12:15], v[120:123], v[60:63], a[12:15]
  ds_read_b64_tr_b16 v[94:95], v17 offset:36864
  v_mfma_f32_16x16x32_bf16 a[16:19], v[108:111], v[64:67], a[16:19]
  ds_read_b128 v[32:35], v14 offset:2048
  s_add_u32 m0, s53, 98304
  v_mfma_f32_16x16x32_bf16 a[20:23], v[112:115], v[64:67], a[20:23]
  buffer_load_dwordx4 v10, s[12:15], s21 offen  lds
  ds_read_b64_tr_b16 v[96:97], v17 offset:32776
  v_mfma_f32_16x16x32_bf16 a[24:27], v[116:119], v[64:67], a[24:27]
  ds_read_b64_tr_b16 v[98:99], v17 offset:36872
  v_mfma_f32_16x16x32_bf16 a[28:31], v[120:123], v[64:67], a[28:31]
  ds_read_b128 v[36:39], v14 offset:4096
  v_mfma_f32_16x16x32_bf16 a[32:35], v[108:111], v[68:71], a[32:35]
  ds_read_b64_tr_b16 v[100:101], v18 offset:32768
  s_add_u32 m0, s52, 99328
  v_mfma_f32_16x16x32_bf16 a[36:39], v[112:115], v[68:71], a[36:39]
  buffer_load_dwordx4 v3, s[8:11], s20 offen sc1 lds
  ds_read_b64_tr_b16 v[102:103], v18 offset:36864
  v_mfma_f32_16x16x32_bf16 a[40:43], v[116:119], v[68:71], a[40:43]
  ds_read_b128 v[40:43], v14 offset:6144
  v_mfma_f32_16x16x32_bf16 a[44:47], v[120:123], v[68:71], a[44:47]
  ds_read_b64_tr_b16 v[104:105], v18 offset:32776
  v_mfma_f32_16x16x32_bf16 a[48:51], v[108:111], v[72:75], a[48:51]
  ds_read_b64_tr_b16 v[106:107], v18 offset:36872
  v_mfma_f32_16x16x32_bf16 a[52:55], v[112:115], v[72:75], a[52:55]
  ds_read_b128 v[44:47], v14 offset:8192
  s_add_u32 m0, s53, 99328
  v_mfma_f32_16x16x32_bf16 a[56:59], v[116:119], v[72:75], a[56:59]
  buffer_load_dwordx4 v11, s[12:15], s21 offen  lds
  ds_read_b128 v[48:51], v14 offset:10240
  v_mfma_f32_16x16x32_bf16 a[60:63], v[120:123], v[72:75], a[60:63]
  ds_read_b128 v[52:55], v14 offset:12288
  v_mfma_f32_16x16x32_bf16 a[64:67], v[108:111], v[76:79], a[64:67]
  ds_read_b128 v[56:59], v14 offset:14336
  v_mfma_f32_16x16x32_bf16 a[68:71], v[112:115], v[76:79], a[68:71]
  s_add_u32 m0, s52, 100352
  v_mfma_f32_16x16x32_bf16 a[72:75], v[116:119], v[76:79], a[72:75]
  buffer_load_dwordx4 v4, s[8:11], s20 offen sc1 lds
  v_mfma_f32_16x16x32_bf16 a[76:79], v[120:123], v[76:79], a[76:79]
  v_mfma_f32_16x16x32_bf16 a[80:83], v[108:111], v[80:83], a[80:83]
  v_mfma_f32_16x16x32_bf16 a[84:87], v[112:115], v[80:83], a[84:87]
  v_mfma_f32_16x16x32_bf16 a[88:91], v[116:119], v[80:83], a[88:91]
  s_add_u32 m0, s53, 100352
  v_mfma_f32_16x16x32_bf16 a[92:95], v[120:123], v[80:83], a[92:95]
  buffer_load_dwordx4 v12, s[12:15], s21 offen  lds
  v_mfma_f32_16x16x32_bf16 a[96:99], v[108:111], v[84:87], a[96:99]
  v_mfma_f32_16x16x32_bf16 a[100:103], v[112:115], v[84:87], a[100:103]
  v_mfma_f32_16x16x32_bf16 a[104:107], v[116:119], v[84:87], a[104:107]
  s_add_u32 m0, s52, 101376
  v_mfma_f32_16x16x32_bf16 a[108:111], v[120:123], v[84:87], a[108:111]
  buffer_load_dwordx4 v5, s[8:11], s20 offen sc1 lds
  v_mfma_f32_16x16x32_bf16 a[112:115], v[108:111], v[88:91], a[112:115]
  v_mfma_f32_16x16x32_bf16 a[116:119], v[112:115], v[88:91], a[116:119]
  v_mfma_f32_16x16x32_bf16 a[120:123], v[116:119], v[88:91], a[120:123]
  v_mfma_f32_16x16x32_bf16 a[124:127], v[120:123], v[88:91], a[124:127]
L_g6_loop:
  s_sub_u32 s25, s25, 1
  s_cmp_eq_u32 s25, 0
  s_cbranch_scc1 L_g6_fin
  s_waitcnt lgkmcnt(0)
  s_add_u32 m0, s53, 101376
  v_mfma_f32_16x16x32_bf16 a[0:3], v[92:95], v[28:31], a[0:3]
  buffer_load_dwordx4 v13, s[12:15], s21 offen  lds
  ds_read_b128 v[60:63], v14 offset:1024
  v_mfma_f32_16x16x32_bf16 a[4:7], v[96:99], v[28:31], a[4:7]
  ds_read_b64_tr_b16 v[108:109], v17 offset:40960
  v_mfma_f32_16x16x32_bf16 a[8:11], v[100:103], v[28:31], a[8:11]
  ds_read_b64_tr_b16 v[110:111], v17 offset:45056
  v_mfma_f32_16x16x32_bf16 a[12:15], v[104:107], v[28:31], a[12:15]
  ds_read_b128 v[64:67], v14 offset:3072
  v_mfma_f32_16x16x32_bf16 a[16:19], v[92:95], v[32:35], a[16:19]
  ds_read_b64_tr_b16 v[112:113], v17 offset:40968
  s_add_u32 m0, s52, 102400
  v_mfma_f32_16x16x32_bf16 a[20:23], v[96:99], v[32:35], a[20:23]
  buffer_load_dwordx4 v6, s[8:11], s20 offen sc1 lds
  ds_read_b64_tr_b16 v[114:115], v17 offset:45064
  v_mfma_f32_16x16x32_bf16 a[24:27], v[100:103], v[32:35], a[24:27]
  ds_read_b128 v[68:71], v14 offset:5120
  v_mfma_f32_16x16x32_bf16 a[28:31], v[104:107], v[32:35], a[28:31]
  ds_read_b64_tr_b16 v[116:117], v18 offset:40960
  v_mfma_f32_16x16x32_bf16 a[32:35], v[92:95], v[36:39], a[32:35]
  ds_read_b64_tr_b16 v[118:119], v18 offset:45056
  v_mfma_f32_16x16x32_bf16 a[36:39], v[96:99], v[36:39], a[36:39]
  ds_read_b128 v[72:75], v14 offset:7168
  s_add_u32 m0, s52, 103424
  v_mfma_f32_16x16x32_bf16 a[40:43], v[100:103], v[36:39], a[40:43]
  buffer_load_dwordx4 v7, s[8:11], s20 offen sc1 lds
  ds_read_b64_tr_b16 v[120:121], v18 offset:40968
  v_mfma_f32_16x16x32_bf16 a[44:47], v[104:107], v[36:39], a[44:47]
  ds_read_b64_tr_b16 v[122:123], v18 offset:45064
  v_mfma_f32_16x16x32_bf16 a[48:51], v[92:95], v[40:43], a[48:51]
  ds_read_b128 v[76:79], v14 offset:9216
  v_mfma_f32_16x16x32_bf16 a[52:55], v[96:99], v[40:43], a[52:55]
  ds_read_b128 v[80:83], v14 offset:11264
  v_mfma_f32_16x16x32_bf16 a[56:59], v[100:103], v[40:43], a[56:59]
  ds_read_b128 v[84:87], v14 offset:13312
  v_mfma_f32_16x16x32_bf16 a[60:63], v[104:107], v[40:43], a[60:63]
  ds_read_b128 v[88:91], v14 offset:15360
  s_add_u32 m0, s52, 104448
  v_mfma_f32_16x16x32_bf16 a[64:67], v[92:95], v[44:47], a[64:67]
  buffer_load_dwordx4 v8, s[8:11], s20 offen sc1 lds
  v_mfma_f32_16x16x32_bf16 a[68:71], v[96:99], v[44:47], a[68:71]
  v_mfma_f32_16x16x32_bf16 a[72:75], v[100:103], v[44:47], a[72:75]
  v_mfma_f32_16x16x32_bf16 a[76:79], v[104:107], v[44:47], a[76:79]
  v_mfma_f32_16x16x32_bf16 a[80:83], v[92:95], v[48:51], a[80:83]
  s_add_u32 m0, s52, 105472
  v_mfma_f32_16x16x32_bf16 a[84:87], v[96:99], v[48:51], a[84:87]
  buffer_load_dwordx4 v9, s[8:11], s20 offen sc1 lds
  v_mfma_f32_16x16x32_bf16 a[88:91], v[100:103], v[48:51], a[88:91]
  v_mfma_f32_16x16x32_bf16 a[92:95], v[104:107], v[48:51], a[92:95]
  v_mfma_f32_16x16x32_bf16 a[96:99], v[92:95], v[52:55], a[96:99]
  v_mfma_f32_16x16x32_bf16 a[100:103], v[96:99], v[52:55], a[100:103]
  s_add_u32 s20, s20, s48
  s_xor_b32 s48, s48, 4096
  v_mfma_f32_16x16x32_bf16 a[104:107], v[100:103], v[52:55], a[104:107]
  s_add_u32 s21, s21, s51
  v_mfma_f32_16x16x32_bf16 a[108:111], v[104:107], v[52:55], a[108:111]
  v_mfma_f32_16x16x32_bf16 a[112:115], v[92:95], v[56:59], a[112:115]
  v_mfma_f32_16x16x32_bf16 a[116:119], v[96:99], v[56:59], a[116:119]
  v_mfma_f32_16x16x32_bf16 a[120:123], v[100:103], v[56:59], a[120:123]
  v_mfma_f32_16x16x32_bf16 a[124:127], v[104:107], v[56:59], a[124:127]
  s_waitcnt lgkmcnt(0)
  v_mfma_f32_16x16x32_bf16 a[0:3], v[108:111], v[60:63], a[0:3]
  s_waitcnt vmcnt(12)
  s_barrier
  s_add_u32 m0, s52, 0
  v_mfma_f32_16x16x32_bf16 a[4:7], v[112:115], v[60:63], a[4:7]
  buffer_load_dwordx4 v2, s[8:11], s20 offen sc1 lds
  ds_read_b128 v[28:31], v14 offset:49152
  v_mfma_f32_16x16x32_bf16 a[8:11], v[116:119], v[60:63], a[8:11]
  ds_read_b64_tr_b16 v[92:93], v19 offset:16384
  v_mfma_f32_16x16x32_bf16 a[12:15], v[120:123], v[60:63], a[12:15]
  ds_read_b64_tr_b16 v[94:95], v19 offset:20480
  v_mfma_f32_16x16x32_bf16 a[16:19], v[108:111], v[64:67], a[16:19]
  ds_read_b128 v[32:35], v14 offset:51200
  s_add_u32 m0, s53, 0
  v_mfma_f32_16x16x32_bf16 a[20:23], v[112:115], v[64:67], a[20:23]
  buffer_load_dwordx4 v10, s[12:15], s21 offen  lds
  ds_read_b64_tr_b16 v[96:97], v19 offset:16392
  v_mfma_f32_16x16x32_bf16 a[24:27], v[116:119], v[64:67], a[24:27]
  ds_read_b64_tr_b16 v[98:99], v19 offset:20488
  v_mfma_f32_16x16x32_bf16 a[28:31], v[120:123], v[64:67], a[28:31]
  ds_read_b128 v[36:39], v14 offset:53248
  v_mfma_f32_16x16x32_bf16 a[32:35], v[108:111], v[68:71], a[32:35]
  ds_read_b64_tr_b16 v[100:101], v20 offset:16384
  s_add_u32 m0, s52, 1024
  v_mfma_f32_16x16x32_bf16 a[36:39], v[112:115], v[68:71], a[36:39]
  buffer_load_dwordx4 v3, s[8:11], s20 offen sc1 lds
  ds_read_b64_tr_b16 v[102:103], v20 offset:20480
  v_mfma_f32_16x16x32_bf16 a[40:43], v[116:119], v[68:71], a[40:43]
  ds_read_b128 v[40:43], v14 offset:55296
  v_mfma_f32_16x16x32_bf16 a[44:47], v[120:123], v[68:71], a[44:47]
  ds_read_b64_tr_b16 v[104:105], v20 offset:16392
  v_mfma_f32_16x16x32_bf16 a[48:51], v[108:111], v[72:75], a[48:51]
  ds_read_b64_tr_b16 v[106:107], v20 offset:20488
  v_mfma_f32_16x16x32_bf16 a[52:55], v[112:115], v[72:75], a[52:55]
  ds_read_b128 v[44:47], v14 offset:57344
  s_add_u32 m0, s53, 1024
  v_mfma_f32_16x16x32_bf16 a[56:59], v[116:119], v[72:75], a[56:59]
  buffer_load_dwordx4 v11, s[12:15], s21 offen  lds
  ds_read_b128 v[48:51], v14 offset:59392
  v_mfma_f32_16x16x32_bf16 a[60:63], v[120:123], v[72:75], a[60:63]
  ds_read_b128 v[52:55], v14 offset:61440
  v_mfma_f32_16x16x32_bf16 a[64:67], v[108:111], v[76:79], a[64:67]
  ds_read_b128 v[56:59], v14 offset:63488
  v_mfma_f32_16x16x32_bf16 a[68:71], v[112:115], v[76:79], a[68:71]
  s_add_u32 m0, s52, 2048
  v_mfma_f32_16x16x32_bf16 a[72:75], v[116:119], v[76:79], a[72:75]
  buffer_load_dwordx4 v4, s[8:11], s20 offen sc1 lds
  v_mfma_f32_16x16x32_bf16 a[76:79], v[120:123], v[76:79], a[76:79]
  v_mfma_f32_16x16x32_bf16 a[80:83], v[108:111], v[80:83], a[80:83]
  v_mfma_f32_16x16x32_bf16 a[84:87], v[112:115], v[80:83], a[84:87]
  v_mfma_f32_16x16x32_bf16 a[88:91], v[116:119], v[80:83], a[88:91]
  s_add_u32 m0, s53, 2048
  v_mfma_f32_16x16x32_bf16 a[92:95], v[120:123], v[80:83], a[92:95]
  buffer_load_dwordx4 v12, s[12:15], s21 offen  lds
  v_mfma_f32_16x16x32_bf16 a[96:99], v[108:111], v[84:87], a[96:99]
  v_mfma_f32_16x16x32_bf16 a[100:103], v[112:115], v[84:87], a[100:103]
  v_mfma_f32_16x16x32_bf16 a[104:107], v[116:119], v[84:87], a[104:107]
  s_add_u32 m0, s52, 3072
  v_mfma_f32_16x16x32_bf16 a[108:111], v[120:123], v[84:87], a[108:111]
  buffer_load_dwordx4 v5, s[8:11], s20 offen sc1 lds
  v_mfma_f32_16x16x32_bf16 a[112:115], v[108:111], v[88:91], a[112:115]
  v_mfma_f32_16x16x32_bf16 a[116:119], v[112:115], v[88:91], a[116:119]
  v_mfma_f32_16x16x32_bf16 a[120:123], v[116:119], v[88:91], a[120:123]
  v_mfma_f32_16x16x32_bf16 a[124:127], v[120:123], v[88:91], a[124:127]
  s_waitcnt lgkmcnt(0)
  s_add_u32 m0, s53, 3072
  v_mfma_f32_16x16x32_bf16 a[0:3], v[92:95], v[28:31], a[0:3]
  buffer_load_dwordx4 v13, s[12:15], s21 offen  lds
  ds_read_b128 v[60:63], v14 offset:50176
  v_mfma_f32_16x16x32_bf16 a[4:7], v[96:99], v[28:31], a[4:7]
  ds_read_b64_tr_b16 v[108:109], v19 offset:24576
  v_mfma_f32_16x16x32_bf16 a[8:11], v[100:103], v[28:31], a[8:11]
  ds_read_b64_tr_b16 v[110:111], v19 offset:28672
  v_mfma_f32_16x16x32_bf16 a[12:15], v[104:107], v[28:31], a[12:15]
  ds_read_b128 v[64:67], v14 offset:52224
  v_mfma_f32_16x16x32_bf16 a[16:19], v[92:95], v[32:35], a[16:19]
  ds_read_b64_tr_b16 v[112:113], v19 offset:24584
  s_add_u32 m0, s52, 4096
  v_mfma_f32_16x16x32_bf16 a[20:23], v[96:99], v[32:35], a[20:23]
  buffer_load_dwordx4 v6, s[8:11], s20 offen sc1 lds
  ds_read_b64_tr_b16 v[114:115], v19 offset:28680
  v_mfma_f32_16x16x32_bf16 a[24:27], v[100:103], v[32:35], a[24:27]
  ds_read_b128 v[68:71], v14 offset:54272
  v_mfma_f32_16x16x32_bf16 a[28:31], v[104:107], v[32:35], a[28:31]
  ds_read_b64_tr_b16 v[116:117], v20 offset:24576
  v_mfma_f32_16x16x32_bf16 a[32:35], v[92:95], v[36:39], a[32:35]
  ds_read_b64_tr_b16 v[118:119], v20 offset:28672
  v_mfma_f32_16x16x32_bf16 a[36:39], v[96:99], v[36:39], a[36:39]
  ds_read_b128 v[72:75], v14 offset:56320
  s_add_u32 m0, s52, 5120
  v_mfma_f32_16x16x32_bf16 a[40:43], v[100:103], v[36:39], a[40:43]
  buffer_load_dwordx4 v7, s[8:11], s20 offen sc1 lds
  ds_read_b64_tr_b16 v[120:121], v20 offset:24584
  v_mfma_f32_16x16x32_bf16 a[44:47], v[104:107], v[36:39], a[44:47]
  ds_read_b64_tr_b16 v[122:123], v20 offset:28680
  v_mfma_f32_16x16x32_bf16 a[48:51], v[92:95], v[40:43], a[48:51]
  ds_read_b128 v[76:79], v14 offset:58368
  v_mfma_f32_16x16x32_bf16 a[52:55], v[96:99], v[40:43], a[52:55]
  ds_read_b128 v[80:83], v14 offset:60416
  v_mfma_f32_16x16x32_bf16 a[56:59], v[100:103], v[40:43], a[56:59]
  ds_read_b128 v[84:87], v14 offset:62464
  v_mfma_f32_16x16x32_bf16 a[60:63], v[104:107], v[40:43], a[60:63]
  ds_read_b128 v[88:91], v14 offset:64512
  s_add_u32 m0, s52, 6144
  v_mfma_f32_16x16x32_bf16 a[64:67], v[92:95], v[44:47], a[64:67]
  buffer_load_dwordx4 v8, s[8:11], s20 offen sc1 lds
  v_mfma_f32_16x16x32_bf16 a[68:71], v[96:99], v[44:47], a[68:71]
  v_mfma_f32_16x16x32_bf16 a[72:75], v[100:103], v[44:47], a[72:75]
  v_mfma_f32_16x16x32_bf16 a[76:79], v[104:107], v[44:47], a[76:79]
  v_mfma_f32_16x16x32_bf16 a[80:83], v[92:95], v[48:51], a[80:83]
  s_add_u32 m0, s52, 7168
  v_mfma_f32_16x16x32_bf16 a[84:87], v[96:99], v[48:51], a[84:87]
  buffer_load_dwordx4 v9, s[8:11], s20 offen sc1 lds
  v_mfma_f32_16x16x32_bf16 a[88:91], v[100:103], v[48:51], a[88:91]
  v_mfma_f32_16x16x32_bf16 a[92:95], v[104:107], v[48:51], a[92:95]
  v_mfma_f32_16x16x32_bf16 a[96:99], v[92:95], v[52:55], a[96:99]
  v_mfma_f32_16x16x32_bf16 a[100:103], v[96:99], v[52:55], a[100:103]
  s_add_u32 s20, s20, s48
  s_xor_b32 s48, s48, 4096
  v_mfma_f32_16x16x32_bf16 a[104:107], v[100:103], v[52:55], a[104:107]
  s_add_u32 s21, s21, s51
  v_mfma_f32_16x16x32_bf16 a[108:111], v[104:107], v[52:55], a[108:111]
  v_mfma_f32_16x16x32_bf16 a[112:115], v[92:95], v[56:59], a[112:115]
  v_mfma_f32_16x16x32_bf16 a[116:119], v[96:99], v[56:59], a[116:119]
  v_mfma_f32_16x16x32_bf16 a[120:123], v[100:103], v[56:59], a[120:123]
  v_mfma_f32_16x16x32_bf16 a[124:127], v[104:107], v[56:59], a[124:127]
  s_waitcnt lgkmcnt(0)
  v_mfma_f32_16x16x32_bf16 a[0:3], v[108:111], v[60:63], a[0:3]
  s_waitcnt vmcnt(12)
  s_barrier
  s_add_u32 m0, s52, 49152
  v_mfma_f32_16x16x32_bf16 a[4:7], v[112:115], v[60:63], a[4:7]
  buffer_load_dwordx4 v2, s[8:11], s20 offen sc1 lds
  ds_read_b128 v[28:31], v15 offset:32768
  v_mfma_f32_16x16x32_bf16 a[8:11], v[116:119], v[60:63], a[8:11]
  ds_read_b64_tr_b16 v[92:93], v21 offset:0
  v_mfma_f32_16x16x32_bf16 a[12:15], v[120:123], v[60:63], a[12:15]
  ds_read_b64_tr_b16 v[94:95], v21 offset:4096
  v_mfma_f32_16x16x32_bf16 a[16:19], v[108:111], v[64:67], a[16:19]
  ds_read_b128 v[32:35], v15 offset:34816
  s_add_u32 m0, s53, 49152
  v_mfma_f32_16x16x32_bf16 a[20:23], v[112:115], v[64:67], a[20:23]
  buffer_load_dwordx4 v10, s[12:15], s21 offen  lds
  ds_read_b64_tr_b16 v[96:97], v21 offset:8
  v_mfma_f32_16x16x32_bf16 a[24:27], v[116:119], v[64:67], a[24:27]
  ds_read_b64_tr_b16 v[98:99], v21 offset:4104
  v_mfma_f32_16x16x32_bf16 a[28:31], v[120:123], v[64:67], a[28:31]
  ds_read_b128 v[36:39], v15 offset:36864
  v_mfma_f32_16x16x32_bf16 a[32:35], v[108:111], v[68:71], a[32:35]
  ds_read_b64_tr_b16 v[100:101], v22 offset:0
  s_add_u32 m0, s52, 50176
  v_mfma_f32_16x16x32_bf16 a[36:39], v[112:115], v[68:71], a[36:39]
  buffer_load_dwordx4 v3, s[8:11], s20 offen sc1 lds
  ds_read_b64_tr_b16 v[102:103], v22 offset:4096
  v_mfma_f32_16x16x32_bf16 a[40:43], v[116:119], v[68:71], a[40:43]
  ds_read_b128 v[40:43], v15 offset:38912
  v_mfma_f32_16x16x32_bf16 a[44:47], v[120:123], v[68:71], a[44:47]
  ds_read_b64_tr_b16 v[104:105], v22 offset:8
  v_mfma_f32_16x16x32_bf16 a[48:51], v[108:111], v[72:75], a[48:51]
  ds_read_b64_tr_b16 v[106:107], v22 offset:4104
  v_mfma_f32_16x16x32_bf16 a[52:55], v[112:115], v[72:75], a[52:55]
  ds_read_b128 v[44:47], v15 offset:40960
  s_add_u32 m0, s53, 50176
  v_mfma_f32_16x16x32_bf16 a[56:59], v[116:119], v[72:75], a[56:59]
  buffer_load_dwordx4 v11, s[12:15], s21 offen  lds
  ds_read_b128 v[48:51], v15 offset:43008
  v_mfma_f32_16x16x32_bf16 a[60:63], v[120:123], v[72:75], a[60:63]
  ds_read_b128 v[52:55], v15 offset:45056
  v_mfma_f32_16x16x32_bf16 a[64:67], v[108:111], v[76:79], a[64:67]
  ds_read_b128 v[56:59], v15 offset:47104
  v_mfma_f32_16x16x32_bf16 a[68:71], v[112:115], v[76:79], a[68:71]
  s_add_u32 m0, s52, 51200
  v_mfma_f32_16x16x32_bf16 a[72:75], v[116:119], v[76:79], a[72:75]
  buffer_load_dwordx4 v4, s[8:11], s20 offen sc1 lds
  v_mfma_f32_16x16x32_bf16 a[76:79], v[120:123], v[76:79], a[76:79]
  v_mfma_f32_16x16x32_bf16 a[80:83], v[108:111], v[80:83], a[80:83]
  v_mfma_f32_16x16x32_bf16 a[84:87], v[112:115], v[80:83], a[84:87]
  v_mfma_f32_16x16x32_bf16 a[88:91], v[116:119], v[80:83], a[88:91]
  s_add_u32 m0, s53, 51200
  v_mfma_f32_16x16x32_bf16 a[92:95], v[120:123], v[80:83], a[92:95]
  buffer_load_dwordx4 v12, s[12:15], s21 offen  lds
  v_mfma_f32_16x16x32_bf16 a[96:99], v[108:111], v[84:87], a[96:99]
  v_mfma_f32_16x16x32_bf16 a[100:103], v[112:115], v[84:87], a[100:103]
  v_mfma_f32_16x16x32_bf16 a[104:107], v[116:119], v[84:87], a[104:107]
  s_add_u32 m0, s52, 52224
  v_mfma_f32_16x16x32_bf16 a[108:111], v[120:123], v[84:87], a[108:111]
  buffer_load_dwordx4 v5, s[8:11], s20 offen sc1 lds
  v_mfma_f32_16x16x32_bf16 a[112:115], v[108:111], v[88:91], a[112:115]
  v_mfma_f32_16x16x32_bf16 a[116:119], v[112:115], v[88:91], a[116:119]
  v_mfma_f32_16x16x32_bf16 a[120:123], v[116:119], v[88:91], a[120:123]
  v_mfma_f32_16x16x32_bf16 a[124:127], v[120:123], v[88:91], a[124:127]
  s_waitcnt lgkmcnt(0)
  s_add_u32 m0, s53, 52224
  v_mfma_f32_16x16x32_bf16 a[0:3], v[92:95], v[28:31], a[0:3]
  buffer_load_dwordx4 v13, s[12:15], s21 offen  lds
  ds_read_b128 v[60:63], v15 offset:33792
  v_mfma_f32_16x16x32_bf16 a[4:7], v[96:99], v[28:31], a[4:7]
  ds_read_b64_tr_b16 v[108:109], v21 offset:8192
  v_mfma_f32_16x16x32_bf16 a[8:11], v[100:103], v[28:31], a[8:11]
  ds_read_b64_tr_b16 v[110:111], v21 offset:12288
  v_mfma_f32_16x16x32_bf16 a[12:15], v[104:107], v[28:31], a[12:15]
  ds_read_b128 v[64:67], v15 offset:35840
  v_mfma_f32_16x16x32_bf16 a[16:19], v[92:95], v[32:35], a[16:19]
  ds_read_b64_tr_b16 v[112:113], v21 offset:8200
  s_add_u32 m0, s52, 53248
  v_mfma_f32_16x16x32_bf16 a[20:23], v[96:99], v[32:35], a[20:23]
  buffer_load_dwordx4 v6, s[8:11], s20 offen sc1 lds
  ds_read_b64_tr_b16 v[114:115], v21 offset:12296
  v_mfma_f32_16x16x32_bf16 a[24:27], v[100:103], v[32:35], a[24:27]
  ds_read_b128 v[68:71], v15 offset:37888
  v_mfma_f32_16x16x32_bf16 a[28:31], v[104:107], v[32:35], a[28:31]
  ds_read_b64_tr_b16 v[116:117], v22 offset:8192
  v_mfma_f32_16x16x32_bf16 a[32:35], v[92:95], v[36:39], a[32:35]
  ds_read_b64_tr_b16 v[118:119], v22 offset:12288
  v_mfma_f32_16x16x32_bf16 a[36:39], v[96:99], v[36:39], a[36:39]
  ds_read_b128 v[72:75], v15 offset:39936
  s_add_u32 m0, s52, 54272
  v_mfma_f32_16x16x32_bf16 a[40:43], v[100:103], v[36:39], a[40:43]
  buffer_load_dwordx4 v7, s[8:11], s20 offen sc1 lds
  ds_read_b64_tr_b16 v[120:121], v22 offset:8200
  v_mfma_f32_16x16x32_bf16 a[44:47], v[104:107], v[36:39], a[44:47]
  ds_read_b64_tr_b16 v[122:123], v22 offset:12296
  v_mfma_f32_16x16x32_bf16 a[48:51], v[92:95], v[40:43], a[48:51]
  ds_read_b128 v[76:79], v15 offset:41984
  v_mfma_f32_16x16x32_bf16 a[52:55], v[96:99], v[40:43], a[52:55]
  ds_read_b128 v[80:83], v15 offset:44032
  v_mfma_f32_16x16x32_bf16 a[56:59], v[100:103], v[40:43], a[56:59]
  ds_read_b128 v[84:87], v15 offset:46080
  v_mfma_f32_16x16x32_bf16 a[60:63], v[104:107], v[40:43], a[60:63]
  ds_read_b128 v[88:91], v15 offset:48128
  s_add_u32 m0, s52, 55296
  v_mfma_f32_16x16x32_bf16 a[64:67], v[92:95], v[44:47], a[64:67]
  buffer_load_dwordx4 v8, s[8:11], s20 offen sc1 lds
  v_mfma_f32_16x16x32_bf16 a[68:71], v[96:99], v[44:47], a[68:71]
  v_mfma_f32_16x16x32_bf16 a[72:75], v[100:103], v[44:47], a[72:75]
  v_mfma_f32_16x16x32_bf16 a[76:79], v[104:107], v[44:47], a[76:79]
  v_mfma_f32_16x16x32_bf16 a[80:83], v[92:95], v[48:51], a[80:83]
  s_add_u32 m0, s52, 56320
  v_mfma_f32_16x16x32_bf16 a[84:87], v[96:99], v[48:51], a[84:87]
  buffer_load_dwordx4 v9, s[8:11], s20 offen sc1 lds
  v_mfma_f32_16x16x32_bf16 a[88:91], v[100:103], v[48:51], a[88:91]
  v_mfma_f32_16x16x32_bf16 a[92:95], v[104:107], v[48:51], a[92:95]
  v_mfma_f32_16x16x32_bf16 a[96:99], v[92:95], v[52:55], a[96:99]
  v_mfma_f32_16x16x32_bf16 a[100:103], v[96:99], v[52:55], a[100:103]
  s_add_u32 s20, s20, s48
  s_xor_b32 s48, s48, 4096
  v_mfma_f32_16x16x32_bf16 a[104:107], v[100:103], v[52:55], a[104:107]
  s_add_u32 s21, s21, s51
  v_mfma_f32_16x16x32_bf16 a[108:111], v[104:107], v[52:55], a[108:111]
  v_mfma_f32_16x16x32_bf16 a[112:115], v[92:95], v[56:59], a[112:115]
  v_mfma_f32_16x16x32_bf16 a[116:119], v[96:99], v[56:59], a[116:119]
  v_mfma_f32_16x16x32_bf16 a[120:123], v[100:103], v[56:59], a[120:123]
  v_mfma_f32_16x16x32_bf16 a[124:127], v[104:107], v[56:59], a[124:127]
  s_waitcnt lgkmcnt(0)
  v_mfma_f32_16x16x32_bf16 a[0:3], v[108:111], v[60:63], a[0:3]
  s_waitcnt vmcnt(12)
  s_barrier
  s_add_u32 m0, s52, 98304
  v_mfma_f32_16x16x32_bf16 a[4:7], v[112:115], v[60:63], a[4:7]
  buffer_load_dwordx4 v2, s[8:11], s20 offen sc1 lds
  ds_read_b128 v[28:31], v14 offset:0
  v_mfma_f32_16x16x32_bf16 a[8:11], v[116:119], v[60:63], a[8:11]
  ds_read_b64_tr_b16 v[92:93], v17 offset:32768
  v_mfma_f32_16x16x32_bf16 a[12:15], v[120:123], v[60:63], a[12:15]
  ds_read_b64_tr_b16 v[94:95], v17 offset:36864
  v_mfma_f32_16x16x32_bf16 a[16:19], v[108:111], v[64:67], a[16:19]
  ds_read_b128 v[32:35], v14 offset:2048
  s_add_u32 m0, s53, 98304
  v_mfma_f32_16x16x32_bf16 a[20:23], v[112:115], v[64:67], a[20:23]
  buffer_load_dwordx4 v10, s[12:15], s21 offen  lds
  ds_read_b64_tr_b16 v[96:97], v17 offset:32776
  v_mfma_f32_16x16x32_bf16 a[24:27], v[116:119], v[64:67], a[24:27]
  ds_read_b64_tr_b16 v[98:99], v17 offset:36872
  v_mfma_f32_16x16x32_bf16 a[28:31], v[120:123], v[64:67], a[28:31]
  ds_read_b128 v[36:39], v14 offset:4096
  v_mfma_f32_16x16x32_bf16 a[32:35], v[108:111], v[68:71], a[32:35]
  ds_read_b64_tr_b16 v[100:101], v18 offset:32768
  s_add_u32 m0, s52, 99328
  v_mfma_f32_16x16x32_bf16 a[36:39], v[112:115], v[68:71], a[36:39]
  buffer_load_dwordx4 v3, s[8:11], s20 offen sc1 lds
  ds_read_b64_tr_b16 v[102:103], v18 offset:36864
  v_mfma_f32_16x16x32_bf16 a[40:43], v[116:119], v[68:71], a[40:43]
  ds_read_b128 v[40:43], v14 offset:6144
  v_mfma_f32_16x16x32_bf16 a[44:47], v[120:123], v[68:71], a[44:47]
  ds_read_b64_tr_b16 v[104:105], v18 offset:32776
  v_mfma_f32_16x16x32_bf16 a[48:51], v[108:111], v[72:75], a[48:51]
  ds_read_b64_tr_b16 v[106:107], v18 offset:36872
  v_mfma_f32_16x16x32_bf16 a[52:55], v[112:115], v[72:75], a[52:55]
  ds_read_b128 v[44:47], v14 offset:8192
  s_add_u32 m0, s53, 99328
  v_mfma_f32_16x16x32_bf16 a[56:59], v[116:119], v[72:75], a[56:59]
  buffer_load_dwordx4 v11, s[12:15], s21 offen  lds
  ds_read_b128 v[48:51], v14 offset:10240
  v_mfma_f32_16x16x32_bf16 a[60:63], v[120:123], v[72:75], a[60:63]
  ds_read_b128 v[52:55], v14 offset:12288
  v_mfma_f32_16x16x32_bf16 a[64:67], v[108:111], v[76:79], a[64:67]
  ds_read_b128 v[56:59], v14 offset:14336
  v_mfma_f32_16x16x32_bf16 a[68:71], v[112:115], v[76:79], a[68:71]
  s_add_u32 m0, s52, 100352
  v_mfma_f32_16x16x32_bf16 a[72:75], v[116:119], v[76:79], a[72:75]
  buffer_load_dwordx4 v4, s[8:11], s20 offen sc1 lds
  v_mfma_f32_16x16x32_bf16 a[76:79], v[120:123], v[76:79], a[76:79]
  v_mfma_f32_16x16x32_bf16 a[80:83], v[108:111], v[80:83], a[80:83]
  v_mfma_f32_16x16x32_bf16 a[84:87], v[112:115], v[80:83], a[84:87]
  v_mfma_f32_16x16x32_bf16 a[88:91], v[116:119], v[80:83], a[88:91]
  s_add_u32 m0, s53, 100352
  v_mfma_f32_16x16x32_bf16 a[92:95], v[120:123], v[80:83], a[92:95]
  buffer_load_dwordx4 v12, s[12:15], s21 offen  lds
  v_mfma_f32_16x16x32_bf16 a[96:99], v[108:111], v[84:87], a[96:99]
  v_mfma_f32_16x16x32_bf16 a[100:103], v[112:115], v[84:87], a[100:103]
  v_mfma_f32_16x16x32_bf16 a[104:107], v[116:119], v[84:87], a[104:107]
  s_add_u32 m0, s52, 101376
  v_mfma_f32_16x16x32_bf16 a[108:111], v[120:123], v[84:87], a[108:111]
  buffer_load_dwordx4 v5, s[8:11], s20 offen sc1 lds
  v_mfma_f32_16x16x32_bf16 a[112:115], v[108:111], v[88:91], a[112:115]
  v_mfma_f32_16x16x32_bf16 a[116:119], v[112:115], v[88:91], a[116:119]
  v_mfma_f32_16x16x32_bf16 a[120:123], v[116:119], v[88:91], a[120:123]
  v_mfma_f32_16x16x32_bf16 a[124:127], v[120:123], v[88:91], a[124:127]
  s_branch L_g6_loop
L_g6_fin:
  s_cmp_eq_u32 s35, 16
  s_cselect_b32 s90, 999, s34
  s_cmp_lt_u32 s90, 242
  s_cbranch_scc0 L_re_100
  s_cmp_lg_u32 s32, 0
  s_cbranch_scc1 L_rq_101
  s_cmp_eq_u32 s39, 0
  s_cbranch_scc1 L_rq_101
  s_lshl_b32 s99, s33, 7
  s_add_u32 s99, s99, 0x3d00200
  v_mov_b32 v244, 1
  v_mov_b32 v245, 0
  s_mov_b64 exec, 1
  buffer_atomic_add v244, v245, s[4:7], s99 offen sc0 sc1
  s_mov_b64 exec, -1
L_rq_101:
L_re_100:
  s_waitcnt lgkmcnt(0)
  s_add_u32 m0, s53, 101376
  v_mfma_f32_16x16x32_bf16 a[0:3], v[92:95], v[28:31], a[0:3]
  buffer_load_dwordx4 v13, s[12:15], s21 offen  lds
  ds_read_b128 v[60:63], v14 offset:1024
  v_mfma_f32_16x16x32_bf16 a[4:7], v[96:99], v[28:31], a[4:7]
  ds_read_b64_tr_b16 v[108:109], v17 offset:40960
  v_mfma_f32_16x16x32_bf16 a[8:11], v[100:103], v[28:31], a[8:11]
  ds_read_b64_tr_b16 v[110:111], v17 offset:45056
  v_mfma_f32_16x16x32_bf16 a[12:15], v[104:107], v[28:31], a[12:15]
  ds_read_b128 v[64:67], v14 offset:3072
  v_mfma_f32_16x16x32_bf16 a[16:19], v[92:95], v[32:35], a[16:19]
  ds_read_b64_tr_b16 v[112:113], v17 offset:40968
  s_add_u32 m0, s52, 102400
  v_mfma_f32_16x16x32_bf16 a[20:23], v[96:99], v[32:35], a[20:23]
  buffer_load_dwordx4 v6, s[8:11], s20 offen sc1 lds
  ds_read_b64_tr_b16 v[114:115], v17 offset:45064
  v_mfma_f32_16x16x32_bf16 a[24:27], v[100:103], v[32:35], a[24:27]
  ds_read_b128 v[68:71], v14 offset:5120
  v_mfma_f32_16x16x32_bf16 a[28:31], v[104:107], v[32:35], a[28:31]
  ds_read_b64_tr_b16 v[116:117], v18 offset:40960
  v_mfma_f32_16x16x32_bf16 a[32:35], v[92:95], v[36:39], a[32:35]
  ds_read_b64_tr_b16 v[118:119], v18 offset:45056
  v_mfma_f32_16x16x32_bf16 a[36:39], v[96:99], v[36:39], a[36:39]
  ds_read_b128 v[72:75], v14 offset:7168
  s_add_u32 m0, s52, 103424
  v_mfma_f32_16x16x32_bf16 a[40:43], v[100:103], v[36:39], a[40:43]
  buffer_load_dwordx4 v7, s[8:11], s20 offen sc1 lds
  ds_read_b64_tr_b16 v[120:121], v18 offset:40968
  v_mfma_f32_16x16x32_bf16 a[44:47], v[104:107], v[36:39], a[44:47]
  ds_read_b64_tr_b16 v[122:123], v18 offset:45064
  v_mfma_f32_16x16x32_bf16 a[48:51], v[92:95], v[40:43], a[48:51]
  ds_read_b128 v[76:79], v14 offset:9216
  v_mfma_f32_16x16x32_bf16 a[52:55], v[96:99], v[40:43], a[52:55]
  ds_read_b128 v[80:83], v14 offset:11264
  v_mfma_f32_16x16x32_bf16 a[56:59], v[100:103], v[40:43], a[56:59]
  ds_read_b128 v[84:87], v14 offset:13312
  v_mfma_f32_16x16x32_bf16 a[60:63], v[104:107], v[40:43], a[60:63]
  ds_read_b128 v[88:91], v14 offset:15360
  s_add_u32 m0, s52, 104448
  v_mfma_f32_16x16x32_bf16 a[64:67], v[92:95], v[44:47], a[64:67]
  buffer_load_dwordx4 v8, s[8:11], s20 offen sc1 lds
  v_mfma_f32_16x16x32_bf16 a[68:71], v[96:99], v[44:47], a[68:71]
  v_mfma_f32_16x16x32_bf16 a[72:75], v[100:103], v[44:47], a[72:75]
  v_mfma_f32_16x16x32_bf16 a[76:79], v[104:107], v[44:47], a[76:79]
  v_mfma_f32_16x16x32_bf16 a[80:83], v[92:95], v[48:51], a[80:83]
  s_add_u32 m0, s52, 105472
  v_mfma_f32_16x16x32_bf16 a[84:87], v[96:99], v[48:51], a[84:87]
  buffer_load_dwordx4 v9, s[8:11], s20 offen sc1 lds
  v_mfma_f32_16x16x32_bf16 a[88:91], v[100:103], v[48:51], a[88:91]
  v_mfma_f32_16x16x32_bf16 a[92:95], v[104:107], v[48:51], a[92:95]
  v_mfma_f32_16x16x32_bf16 a[96:99], v[92:95], v[52:55], a[96:99]
  v_mfma_f32_16x16x32_bf16 a[100:103], v[96:99], v[52:55], a[100:103]
  s_add_u32 s20, s20, s48
  s_xor_b32 s48, s48, 4096
  v_mfma_f32_16x16x32_bf16 a[104:107], v[100:103], v[52:55], a[104:107]
  s_add_u32 s21, s21, s51
  v_mfma_f32_16x16x32_bf16 a[108:111], v[104:107], v[52:55], a[108:111]
  v_mfma_f32_16x16x32_bf16 a[112:115], v[92:95], v[56:59], a[112:115]
  v_mfma_f32_16x16x32_bf16 a[116:119], v[96:99], v[56:59], a[116:119]
  v_mfma_f32_16x16x32_bf16 a[120:123], v[100:103], v[56:59], a[120:123]
  v_mfma_f32_16x16x32_bf16 a[124:127], v[104:107], v[56:59], a[124:127]
  s_waitcnt lgkmcnt(0)
  v_mfma_f32_16x16x32_bf16 a[0:3], v[108:111], v[60:63], a[0:3]
  s_waitcnt vmcnt(12)
  s_barrier
  s_add_u32 m0, s52, 0
  v_mfma_f32_16x16x32_bf16 a[4:7], v[112:115], v[60:63], a[4:7]
  buffer_load_dwordx4 v2, s[8:11], s20 offen sc1 lds
  ds_read_b128 v[28:31], v14 offset:49152
  v_mfma_f32_16x16x32_bf16 a[8:11], v[116:119], v[60:63], a[8:11]
  ds_read_b64_tr_b16 v[92:93], v19 offset:16384
  v_mfma_f32_16x16x32_bf16 a[12:15], v[120:123], v[60:63], a[12:15]
  ds_read_b64_tr_b16 v[94:95], v19 offset:20480
  v_mfma_f32_16x16x32_bf16 a[16:19], v[108:111], v[64:67], a[16:19]
  ds_read_b128 v[32:35], v14 offset:51200
  s_add_u32 m0, s53, 0
  v_mfma_f32_16x16x32_bf16 a[20:23], v[112:115], v[64:67], a[20:23]
  buffer_load_dwordx4 v10, s[12:15], s21 offen  lds
  ds_read_b64_tr_b16 v[96:97], v19 offset:16392
  v_mfma_f32_16x16x32_bf16 a[24:27], v[116:119], v[64:67], a[24:27]
  ds_read_b64_tr_b16 v[98:99], v19 offset:20488
  v_mfma_f32_16x16x32_bf16 a[28:31], v[120:123], v[64:67], a[28:31]
  ds_read_b128 v[36:39], v14 offset:53248
  v_mfma_f32_16x16x32_bf16 a[32:35], v[108:111], v[68:71], a[32:35]
  ds_read_b64_tr_b16 v[100:101], v20 offset:16384
  s_add_u32 m0, s52, 1024
  v_mfma_f32_16x16x32_bf16 a[36:39], v[112:115], v[68:71], a[36:39]
  buffer_load_dwordx4 v3, s[8:11], s20 offen sc1 lds
  ds_read_b64_tr_b16 v[102:103], v20 offset:20480
  v_mfma_f32_16x16x32_bf16 a[40:43], v[116:119], v[68:71], a[40:43]
  ds_read_b128 v[40:43], v14 offset:55296
  v_mfma_f32_16x16x32_bf16 a[44:47], v[120:123], v[68:71], a[44:47]
  ds_read_b64_tr_b16 v[104:105], v20 offset:16392
  v_mfma_f32_16x16x32_bf16 a[48:51], v[108:111], v[72:75], a[48:51]
  ds_read_b64_tr_b16 v[106:107], v20 offset:20488
  v_mfma_f32_16x16x32_bf16 a[52:55], v[112:115], v[72:75], a[52:55]
  ds_read_b128 v[44:47], v14 offset:57344
  s_add_u32 m0, s53, 1024
  v_mfma_f32_16x16x32_bf16 a[56:59], v[116:119], v[72:75], a[56:59]
  buffer_load_dwordx4 v11, s[12:15], s21 offen  lds
  ds_read_b128 v[48:51], v14 offset:59392
  v_mfma_f32_16x16x32_bf16 a[60:63], v[120:123], v[72:75], a[60:63]
  ds_read_b128 v[52:55], v14 offset:61440
  v_mfma_f32_16x16x32_bf16 a[64:67], v[108:111], v[76:79], a[64:67]
  ds_read_b128 v[56:59], v14 offset:63488
  v_mfma_f32_16x16x32_bf16 a[68:71], v[112:115], v[76:79], a[68:71]
  s_add_u32 m0, s52, 2048
  v_mfma_f32_16x16x32_bf16 a[72:75], v[116:119], v[76:79], a[72:75]
  buffer_load_dwordx4 v4, s[8:11], s20 offen sc1 lds
  v_mfma_f32_16x16x32_bf16 a[76:79], v[120:123], v[76:79], a[76:79]
  v_mfma_f32_16x16x32_bf16 a[80:83], v[108:111], v[80:83], a[80:83]
  v_mfma_f32_16x16x32_bf16 a[84:87], v[112:115], v[80:83], a[84:87]
  v_mfma_f32_16x16x32_bf16 a[88:91], v[116:119], v[80:83], a[88:91]
  s_add_u32 m0, s53, 2048
  v_mfma_f32_16x16x32_bf16 a[92:95], v[120:123], v[80:83], a[92:95]
  buffer_load_dwordx4 v12, s[12:15], s21 offen  lds
  v_mfma_f32_16x16x32_bf16 a[96:99], v[108:111], v[84:87], a[96:99]
  v_mfma_f32_16x16x32_bf16 a[100:103], v[112:115], v[84:87], a[100:103]
  v_mfma_f32_16x16x32_bf16 a[104:107], v[116:119], v[84:87], a[104:107]
  s_add_u32 m0, s52, 3072
  v_mfma_f32_16x16x32_bf16 a[108:111], v[120:123], v[84:87], a[108:111]
  buffer_load_dwordx4 v5, s[8:11], s20 offen sc1 lds
  v_mfma_f32_16x16x32_bf16 a[112:115], v[108:111], v[88:91], a[112:115]
  v_mfma_f32_16x16x32_bf16 a[116:119], v[112:115], v[88:91], a[116:119]
  v_mfma_f32_16x16x32_bf16 a[120:123], v[116:119], v[88:91], a[120:123]
  v_mfma_f32_16x16x32_bf16 a[124:127], v[120:123], v[88:91], a[124:127]
  s_waitcnt lgkmcnt(0)
  s_add_u32 m0, s53, 3072
  v_mfma_f32_16x16x32_bf16 a[0:3], v[92:95], v[28:31], a[0:3]
  buffer_load_dwordx4 v13, s[12:15], s21 offen  lds
  ds_read_b128 v[60:63], v14 offset:50176
  v_mfma_f32_16x16x32_bf16 a[4:7], v[96:99], v[28:31], a[4:7]
  ds_read_b64_tr_b16 v[108:109], v19 offset:24576
  v_mfma_f32_16x16x32_bf16 a[8:11], v[100:103], v[28:31], a[8:11]
  ds_read_b64_tr_b16 v[110:111], v19 offset:28672
  v_mfma_f32_16x16x32_bf16 a[12:15], v[104:107], v[28:31], a[12:15]
  ds_read_b128 v[64:67], v14 offset:52224
  v_mfma_f32_16x16x32_bf16 a[16:19], v[92:95], v[32:35], a[16:19]
  ds_read_b64_tr_b16 v[112:113], v19 offset:24584
  s_add_u32 m0, s52, 4096
  v_mfma_f32_16x16x32_bf16 a[20:23], v[96:99], v[32:35], a[20:23]
  buffer_load_dwordx4 v6, s[8:11], s20 offen sc1 lds
  ds_read_b64_tr_b16 v[114:115], v19 offset:28680
  v_mfma_f32_16x16x32_bf16 a[24:27], v[100:103], v[32:35], a[24:27]
  ds_read_b128 v[68:71], v14 offset:54272
  v_mfma_f32_16x16x32_bf16 a[28:31], v[104:107], v[32:35], a[28:31]
  ds_read_b64_tr_b16 v[116:117], v20 offset:24576
  v_mfma_f32_16x16x32_bf16 a[32:35], v[92:95], v[36:39], a[32:35]
  ds_read_b64_tr_b16 v[118:119], v20 offset:28672
  v_mfma_f32_16x16x32_bf16 a[36:39], v[96:99], v[36:39], a[36:39]
  ds_read_b128 v[72:75], v14 offset:56320
  s_add_u32 m0, s52, 5120
  v_mfma_f32_16x16x32_bf16 a[40:43], v[100:103], v[36:39], a[40:43]
  buffer_load_dwordx4 v7, s[8:11], s20 offen sc1 lds
  ds_read_b64_tr_b16 v[120:121], v20 offset:24584
  v_mfma_f32_16x16x32_bf16 a[44:47], v[104:107], v[36:39], a[44:47]
  ds_read_b64_tr_b16 v[122:123], v20 offset:28680
  v_mfma_f32_16x16x32_bf16 a[48:51], v[92:95], v[40:43], a[48:51]
  ds_read_b128 v[76:79], v14 offset:58368
  v_mfma_f32_16x16x32_bf16 a[52:55], v[96:99], v[40:43], a[52:55]
  ds_read_b128 v[80:83], v14 offset:60416
  v_mfma_f32_16x16x32_bf16 a[56:59], v[100:103], v[40:43], a[56:59]
  ds_read_b128 v[84:87], v14 offset:62464
  v_mfma_f32_16x16x32_bf16 a[60:63], v[104:107], v[40:43], a[60:63]
  ds_read_b128 v[88:91], v14 offset:64512
  s_add_u32 m0, s52, 6144
  v_mfma_f32_16x16x32_bf16 a[64:67], v[92:95], v[44:47], a[64:67]
  buffer_load_dwordx4 v8, s[8:11], s20 offen sc1 lds
  v_mfma_f32_16x16x32_bf16 a[68:71], v[96:99], v[44:47], a[68:71]
  v_mfma_f32_16x16x32_bf16 a[72:75], v[100:103], v[44:47], a[72:75]
  v_mfma_f32_16x16x32_bf16 a[76:79], v[104:107], v[44:47], a[76:79]
  v_mfma_f32_16x16x32_bf16 a[80:83], v[92:95], v[48:51], a[80:83]
  s_add_u32 m0, s52, 7168
  v_mfma_f32_16x16x32_bf16 a[84:87], v[96:99], v[48:51], a[84:87]
  buffer_load_dwordx4 v9, s[8:11], s20 offen sc1 lds
  v_mfma_f32_16x16x32_bf16 a[88:91], v[100:103], v[48:51], a[88:91]
  v_mfma_f32_16x16x32_bf16 a[92:95], v[104:107], v[48:51], a[92:95]
  v_mfma_f32_16x16x32_bf16 a[96:99], v[92:95], v[52:55], a[96:99]
  v_mfma_f32_16x16x32_bf16 a[100:103], v[96:99], v[52:55], a[100:103]
  s_add_u32 s20, s20, s48
  s_xor_b32 s48, s48, 4096
  v_mfma_f32_16x16x32_bf16 a[104:107], v[100:103], v[52:55], a[104:107]
  s_add_u32 s21, s21, s51
  v_mfma_f32_16x16x32_bf16 a[108:111], v[104:107], v[52:55], a[108:111]
  v_mfma_f32_16x16x32_bf16 a[112:115], v[92:95], v[56:59], a[112:115]
  v_mfma_f32_16x16x32_bf16 a[116:119], v[96:99], v[56:59], a[116:119]
  v_mfma_f32_16x16x32_bf16 a[120:123], v[100:103], v[56:59], a[120:123]
  v_mfma_f32_16x16x32_bf16 a[124:127], v[104:107], v[56:59], a[124:127]
  s_waitcnt lgkmcnt(0)
  v_mfma_f32_16x16x32_bf16 a[0:3], v[108:111], v[60:63], a[0:3]
  s_waitcnt vmcnt(12)
  s_barrier
  v_mfma_f32_16x16x32_bf16 a[4:7], v[112:115], v[60:63], a[4:7]
  ds_read_b128 v[28:31], v15 offset:32768
  v_mfma_f32_16x16x32_bf16 a[8:11], v[116:119], v[60:63], a[8:11]
  ds_read_b64_tr_b16 v[92:93], v21 offset:0
  v_mfma_f32_16x16x32_bf16 a[12:15], v[120:123], v[60:63], a[12:15]
  ds_read_b64_tr_b16 v[94:95], v21 offset:4096
  v_mfma_f32_16x16x32_bf16 a[16:19], v[108:111], v[64:67], a[16:19]
  ds_read_b128 v[32:35], v15 offset:34816
  v_mfma_f32_16x16x32_bf16 a[20:23], v[112:115], v[64:67], a[20:23]
  ds_read_b64_tr_b16 v[96:97], v21 offset:8
  v_mfma_f32_16x16x32_bf16 a[24:27], v[116:119], v[64:67], a[24:27]
  ds_read_b64_tr_b16 v[98:99], v21 offset:4104
  v_mfma_f32_16x16x32_bf16 a[28:31], v[120:123], v[64:67], a[28:31]
  ds_read_b128 v[36:39], v15 offset:36864
  v_mfma_f32_16x16x32_bf16 a[32:35], v[108:111], v[68:71], a[32:35]
  ds_read_b64_tr_b16 v[100:101], v22 offset:0
  v_mfma_f32_16x16x32_bf16 a[36:39], v[112:115], v[68:71], a[36:39]
  ds_read_b64_tr_b16 v[102:103], v22 offset:4096
  v_mfma_f32_16x16x32_bf16 a[40:43], v[116:119], v[68:71], a[40:43]
  ds_read_b128 v[40:43], v15 offset:38912
  v_mfma_f32_16x16x32_bf16 a[44:47], v[120:123], v[68:71], a[44:47]
  ds_read_b64_tr_b16 v[104:105], v22 offset:8
  v_mfma_f32_16x16x32_bf16 a[48:51], v[108:111], v[72:75], a[48:51]
  ds_read_b64_tr_b16 v[106:107], v22 offset:4104
  v_mfma_f32_16x16x32_bf16 a[52:55], v[112:115], v[72:75], a[52:55]
  ds_read_b128 v[44:47], v15 offset:40960
  v_mfma_f32_16x16x32_bf16 a[56:59], v[116:119], v[72:75], a[56:59]
  ds_read_b128 v[48:51], v15 offset:43008
  v_mfma_f32_16x16x32_bf16 a[60:63], v[120:123], v[72:75], a[60:63]
  ds_read_b128 v[52:55], v15 offset:45056
  v_mfma_f32_16x16x32_bf16 a[64:67], v[108:111], v[76:79], a[64:67]
  ds_read_b128 v[56:59], v15 offset:47104
  v_mfma_f32_16x16x32_bf16 a[68:71], v[112:115], v[76:79], a[68:71]
  v_mfma_f32_16x16x32_bf16 a[72:75], v[116:119], v[76:79], a[72:75]
  v_mfma_f32_16x16x32_bf16 a[76:79], v[120:123], v[76:79], a[76:79]
  v_mfma_f32_16x16x32_bf16 a[80:83], v[108:111], v[80:83], a[80:83]
  v_mfma_f32_16x16x32_bf16 a[84:87], v[112:115], v[80:83], a[84:87]
  v_mfma_f32_16x16x32_bf16 a[88:91], v[116:119], v[80:83], a[88:91]
  v_mfma_f32_16x16x32_bf16 a[92:95], v[120:123], v[80:83], a[92:95]
  v_mfma_f32_16x16x32_bf16 a[96:99], v[108:111], v[84:87], a[96:99]
  v_mfma_f32_16x16x32_bf16 a[100:103], v[112:115], v[84:87], a[100:103]
  v_mfma_f32_16x16x32_bf16 a[104:107], v[116:119], v[84:87], a[104:107]
  v_mfma_f32_16x16x32_bf16 a[108:111], v[120:123], v[84:87], a[108:111]
  v_mfma_f32_16x16x32_bf16 a[112:115], v[108:111], v[88:91], a[112:115]
  v_mfma_f32_16x16x32_bf16 a[116:119], v[112:115], v[88:91], a[116:119]
  v_mfma_f32_16x16x32_bf16 a[120:123], v[116:119], v[88:91], a[120:123]
  v_mfma_f32_16x16x32_bf16 a[124:127], v[120:123], v[88:91], a[124:127]
  s_waitcnt lgkmcnt(0)
  v_mfma_f32_16x16x32_bf16 a[0:3], v[92:95], v[28:31], a[0:3]
  ds_read_b128 v[60:63], v15 offset:33792
  v_mfma_f32_16x16x32_bf16 a[4:7], v[96:99], v[28:31], a[4:7]
  ds_read_b64_tr_b16 v[108:109], v21 offset:8192
  v_mfma_f32_16x16x32_bf16 a[8:11], v[100:103], v[28:31], a[8:11]
  ds_read_b64_tr_b16 v[110:111], v21 offset:12288
  v_mfma_f32_16x16x32_bf16 a[12:15], v[104:107], v[28:31], a[12:15]
  ds_read_b128 v[64:67], v15 offset:35840
  v_mfma_f32_16x16x32_bf16 a[16:19], v[92:95], v[32:35], a[16:19]
  ds_read_b64_tr_b16 v[112:113], v21 offset:8200
  v_mfma_f32_16x16x32_bf16 a[20:23], v[96:99], v[32:35], a[20:23]
  ds_read_b64_tr_b16 v[114:115], v21 offset:12296
  v_mfma_f32_16x16x32_bf16 a[24:27], v[100:103], v[32:35], a[24:27]
  ds_read_b128 v[68:71], v15 offset:37888
  v_mfma_f32_16x16x32_bf16 a[28:31], v[104:107], v[32:35], a[28:31]
  ds_read_b64_tr_b16 v[116:117], v22 offset:8192
  v_mfma_f32_16x16x32_bf16 a[32:35], v[92:95], v[36:39], a[32:35]
  ds_read_b64_tr_b16 v[118:119], v22 offset:12288
  v_mfma_f32_16x16x32_bf16 a[36:39], v[96:99], v[36:39], a[36:39]
  ds_read_b128 v[72:75], v15 offset:39936
  v_mfma_f32_16x16x32_bf16 a[40:43], v[100:103], v[36:39], a[40:43]
  ds_read_b64_tr_b16 v[120:121], v22 offset:8200
  v_mfma_f32_16x16x32_bf16 a[44:47], v[104:107], v[36:39], a[44:47]
  ds_read_b64_tr_b16 v[122:123], v22 offset:12296
  v_mfma_f32_16x16x32_bf16 a[48:51], v[92:95], v[40:43], a[48:51]
  ds_read_b128 v[76:79], v15 offset:41984
  v_mfma_f32_16x16x32_bf16 a[52:55], v[96:99], v[40:43], a[52:55]
  ds_read_b128 v[80:83], v15 offset:44032
  v_mfma_f32_16x16x32_bf16 a[56:59], v[100:103], v[40:43], a[56:59]
  ds_read_b128 v[84:87], v15 offset:46080
  v_mfma_f32_16x16x32_bf16 a[60:63], v[104:107], v[40:43], a[60:63]
  ds_read_b128 v[88:91], v15 offset:48128
  v_mfma_f32_16x16x32_bf16 a[64:67], v[92:95], v[44:47], a[64:67]
  v_mfma_f32_16x16x32_bf16 a[68:71], v[96:99], v[44:47], a[68:71]
  v_mfma_f32_16x16x32_bf16 a[72:75], v[100:103], v[44:47], a[72:75]
  v_mfma_f32_16x16x32_bf16 a[76:79], v[104:107], v[44:47], a[76:79]
  v_mfma_f32_16x16x32_bf16 a[80:83], v[92:95], v[48:51], a[80:83]
  v_mfma_f32_16x16x32_bf16 a[84:87], v[96:99], v[48:51], a[84:87]
  v_mfma_f32_16x16x32_bf16 a[88:91], v[100:103], v[48:51], a[88:91]
  v_mfma_f32_16x16x32_bf16 a[92:95], v[104:107], v[48:51], a[92:95]
  v_mfma_f32_16x16x32_bf16 a[96:99], v[92:95], v[52:55], a[96:99]
  v_mfma_f32_16x16x32_bf16 a[100:103], v[96:99], v[52:55], a[100:103]
  v_mfma_f32_16x16x32_bf16 a[104:107], v[100:103], v[52:55], a[104:107]
  v_mfma_f32_16x16x32_bf16 a[108:111], v[104:107], v[52:55], a[108:111]
  v_mfma_f32_16x16x32_bf16 a[112:115], v[92:95], v[56:59], a[112:115]
  v_mfma_f32_16x16x32_bf16 a[116:119], v[96:99], v[56:59], a[116:119]
  v_mfma_f32_16x16x32_bf16 a[120:123], v[100:103], v[56:59], a[120:123]
  v_mfma_f32_16x16x32_bf16 a[124:127], v[104:107], v[56:59], a[124:127]
  s_waitcnt lgkmcnt(0)
  v_mfma_f32_16x16x32_bf16 a[0:3], v[108:111], v[60:63], a[0:3]
  s_waitcnt vmcnt(0)
  s_barrier
  v_mfma_f32_16x16x32_bf16 a[4:7], v[112:115], v[60:63], a[4:7]
  ds_read_b128 v[28:31], v14 offset:0
  v_mfma_f32_16x16x32_bf16 a[8:11], v[116:119], v[60:63], a[8:11]
  ds_read_b64_tr_b16 v[92:93], v17 offset:32768
  v_mfma_f32_16x16x32_bf16 a[12:15], v[120:123], v[60:63], a[12:15]
  ds_read_b64_tr_b16 v[94:95], v17 offset:36864
  v_mfma_f32_16x16x32_bf16 a[16:19], v[108:111], v[64:67], a[16:19]
  ds_read_b128 v[32:35], v14 offset:2048
  v_mfma_f32_16x16x32_bf16 a[20:23], v[112:115], v[64:67], a[20:23]
  ds_read_b64_tr_b16 v[96:97], v17 offset:32776
  v_mfma_f32_16x16x32_bf16 a[24:27], v[116:119], v[64:67], a[24:27]
  ds_read_b64_tr_b16 v[98:99], v17 offset:36872
  v_mfma_f32_16x16x32_bf16 a[28:31], v[120:123], v[64:67], a[28:31]
  ds_read_b128 v[36:39], v14 offset:4096
  v_mfma_f32_16x16x32_bf16 a[32:35], v[108:111], v[68:71], a[32:35]
  ds_read_b64_tr_b16 v[100:101], v18 offset:32768
  v_mfma_f32_16x16x32_bf16 a[36:39], v[112:115], v[68:71], a[36:39]
  ds_read_b64_tr_b16 v[102:103], v18 offset:36864
  v_mfma_f32_16x16x32_bf16 a[40:43], v[116:119], v[68:71], a[40:43]
  ds_read_b128 v[40:43], v14 offset:6144
  v_mfma_f32_16x16x32_bf16 a[44:47], v[120:123], v[68:71], a[44:47]
  ds_read_b64_tr_b16 v[104:105], v18 offset:32776
  v_mfma_f32_16x16x32_bf16 a[48:51], v[108:111], v[72:75], a[48:51]
  ds_read_b64_tr_b16 v[106:107], v18 offset:36872
  v_mfma_f32_16x16x32_bf16 a[52:55], v[112:115], v[72:75], a[52:55]
  ds_read_b128 v[44:47], v14 offset:8192
  v_mfma_f32_16x16x32_bf16 a[56:59], v[116:119], v[72:75], a[56:59]
  ds_read_b128 v[48:51], v14 offset:10240
  v_mfma_f32_16x16x32_bf16 a[60:63], v[120:123], v[72:75], a[60:63]
  ds_read_b128 v[52:55], v14 offset:12288
  v_mfma_f32_16x16x32_bf16 a[64:67], v[108:111], v[76:79], a[64:67]
  ds_read_b128 v[56:59], v14 offset:14336
  v_mfma_f32_16x16x32_bf16 a[68:71], v[112:115], v[76:79], a[68:71]
  v_mfma_f32_16x16x32_bf16 a[72:75], v[116:119], v[76:79], a[72:75]
  v_mfma_f32_16x16x32_bf16 a[76:79], v[120:123], v[76:79], a[76:79]
  v_mfma_f32_16x16x32_bf16 a[80:83], v[108:111], v[80:83], a[80:83]
  v_mfma_f32_16x16x32_bf16 a[84:87], v[112:115], v[80:83], a[84:87]
  v_mfma_f32_16x16x32_bf16 a[88:91], v[116:119], v[80:83], a[88:91]
  v_mfma_f32_16x16x32_bf16 a[92:95], v[120:123], v[80:83], a[92:95]
  v_mfma_f32_16x16x32_bf16 a[96:99], v[108:111], v[84:87], a[96:99]
  v_mfma_f32_16x16x32_bf16 a[100:103], v[112:115], v[84:87], a[100:103]
  v_mfma_f32_16x16x32_bf16 a[104:107], v[116:119], v[84:87], a[104:107]
  v_mfma_f32_16x16x32_bf16 a[108:111], v[120:123], v[84:87], a[108:111]
  v_mfma_f32_16x16x32_bf16 a[112:115], v[108:111], v[88:91], a[112:115]
  v_mfma_f32_16x16x32_bf16 a[116:119], v[112:115], v[88:91], a[116:119]
  v_mfma_f32_16x16x32_bf16 a[120:123], v[116:119], v[88:91], a[120:123]
  v_mfma_f32_16x16x32_bf16 a[124:127], v[120:123], v[88:91], a[124:127]
  s_waitcnt lgkmcnt(0)
  v_mfma_f32_16x16x32_bf16 a[0:3], v[92:95], v[28:31], a[0:3]
  ds_read_b128 v[60:63], v14 offset:1024
  v_mfma_f32_16x16x32_bf16 a[4:7], v[96:99], v[28:31], a[4:7]
  ds_read_b64_tr_b16 v[108:109], v17 offset:40960
  v_mfma_f32_16x16x32_bf16 a[8:11], v[100:103], v[28:31], a[8:11]
  ds_read_b64_tr_b16 v[110:111], v17 offset:45056
  v_mfma_f32_16x16x32_bf16 a[12:15], v[104:107], v[28:31], a[12:15]
  ds_read_b128 v[64:67], v14 offset:3072
  v_mfma_f32_16x16x32_bf16 a[16:19], v[92:95], v[32:35], a[16:19]
  ds_read_b64_tr_b16 v[112:113], v17 offset:40968
  v_mfma_f32_16x16x32_bf16 a[20:23], v[96:99], v[32:35], a[20:23]
  ds_read_b64_tr_b16 v[114:115], v17 offset:45064
  v_mfma_f32_16x16x32_bf16 a[24:27], v[100:103], v[32:35], a[24:27]
  ds_read_b128 v[68:71], v14 offset:5120
  v_mfma_f32_16x16x32_bf16 a[28:31], v[104:107], v[32:35], a[28:31]
  ds_read_b64_tr_b16 v[116:117], v18 offset:40960
  v_mfma_f32_16x16x32_bf16 a[32:35], v[92:95], v[36:39], a[32:35]
  ds_read_b64_tr_b16 v[118:119], v18 offset:45056
  v_mfma_f32_16x16x32_bf16 a[36:39], v[96:99], v[36:39], a[36:39]
  ds_read_b128 v[72:75], v14 offset:7168
  v_mfma_f32_16x16x32_bf16 a[40:43], v[100:103], v[36:39], a[40:43]
  ds_read_b64_tr_b16 v[120:121], v18 offset:40968
  v_mfma_f32_16x16x32_bf16 a[44:47], v[104:107], v[36:39], a[44:47]
  ds_read_b64_tr_b16 v[122:123], v18 offset:45064
  v_mfma_f32_16x16x32_bf16 a[48:51], v[92:95], v[40:43], a[48:51]
  ds_read_b128 v[76:79], v14 offset:9216
  v_mfma_f32_16x16x32_bf16 a[52:55], v[96:99], v[40:43], a[52:55]
  ds_read_b128 v[80:83], v14 offset:11264
  v_mfma_f32_16x16x32_bf16 a[56:59], v[100:103], v[40:43], a[56:59]
  ds_read_b128 v[84:87], v14 offset:13312
  v_mfma_f32_16x16x32_bf16 a[60:63], v[104:107], v[40:43], a[60:63]
  ds_read_b128 v[88:91], v14 offset:15360
  v_mfma_f32_16x16x32_bf16 a[64:67], v[92:95], v[44:47], a[64:67]
  v_mfma_f32_16x16x32_bf16 a[68:71], v[96:99], v[44:47], a[68:71]
  v_mfma_f32_16x16x32_bf16 a[72:75], v[100:103], v[44:47], a[72:75]
  v_mfma_f32_16x16x32_bf16 a[76:79], v[104:107], v[44:47], a[76:79]
  v_mfma_f32_16x16x32_bf16 a[80:83], v[92:95], v[48:51], a[80:83]
  v_mfma_f32_16x16x32_bf16 a[84:87], v[96:99], v[48:51], a[84:87]
  v_mfma_f32_16x16x32_bf16 a[88:91], v[100:103], v[48:51], a[88:91]
  v_mfma_f32_16x16x32_bf16 a[92:95], v[104:107], v[48:51], a[92:95]
  v_mfma_f32_16x16x32_bf16 a[96:99], v[92:95], v[52:55], a[96:99]
  v_mfma_f32_16x16x32_bf16 a[100:103], v[96:99], v[52:55], a[100:103]
  v_mfma_f32_16x16x32_bf16 a[104:107], v[100:103], v[52:55], a[104:107]
  v_mfma_f32_16x16x32_bf16 a[108:111], v[104:107], v[52:55], a[108:111]
  v_mfma_f32_16x16x32_bf16 a[112:115], v[92:95], v[56:59], a[112:115]
  v_mfma_f32_16x16x32_bf16 a[116:119], v[96:99], v[56:59], a[116:119]
  v_mfma_f32_16x16x32_bf16 a[120:123], v[100:103], v[56:59], a[120:123]
  v_mfma_f32_16x16x32_bf16 a[124:127], v[104:107], v[56:59], a[124:127]
  s_waitcnt lgkmcnt(0)
  v_mfma_f32_16x16x32_bf16 a[0:3], v[108:111], v[60:63], a[0:3]
  v_mfma_f32_16x16x32_bf16 a[4:7], v[112:115], v[60:63], a[4:7]
  v_mfma_f32_16x16x32_bf16 a[8:11], v[116:119], v[60:63], a[8:11]
  v_mfma_f32_16x16x32_bf16 a[12:15], v[120:123], v[60:63], a[12:15]
  v_mfma_f32_16x16x32_bf16 a[16:19], v[108:111], v[64:67], a[16:19]
  v_mfma_f32_16x16x32_bf16 a[20:23], v[112:115], v[64:67], a[20:23]
  v_mfma_f32_16x16x32_bf16 a[24:27], v[116:119], v[64:67], a[24:27]
  v_mfma_f32_16x16x32_bf16 a[28:31], v[120:123], v[64:67], a[28:31]
  v_mfma_f32_16x16x32_bf16 a[32:35], v[108:111], v[68:71], a[32:35]
  v_mfma_f32_16x16x32_bf16 a[36:39], v[112:115], v[68:71], a[36:39]
  v_mfma_f32_16x16x32_bf16 a[40:43], v[116:119], v[68:71], a[40:43]
  v_mfma_f32_16x16x32_bf16 a[44:47], v[120:123], v[68:71], a[44:47]
  v_mfma_f32_16x16x32_bf16 a[48:51], v[108:111], v[72:75], a[48:51]
  v_mfma_f32_16x16x32_bf16 a[52:55], v[112:115], v[72:75], a[52:55]
  v_mfma_f32_16x16x32_bf16 a[56:59], v[116:119], v[72:75], a[56:59]
  v_mfma_f32_16x16x32_bf16 a[60:63], v[120:123], v[72:75], a[60:63]
  v_mfma_f32_16x16x32_bf16 a[64:67], v[108:111], v[76:79], a[64:67]
  v_mfma_f32_16x16x32_bf16 a[68:71], v[112:115], v[76:79], a[68:71]
  v_mfma_f32_16x16x32_bf16 a[72:75], v[116:119], v[76:79], a[72:75]
  v_mfma_f32_16x16x32_bf16 a[76:79], v[120:123], v[76:79], a[76:79]
  v_mfma_f32_16x16x32_bf16 a[80:83], v[108:111], v[80:83], a[80:83]
  v_mfma_f32_16x16x32_bf16 a[84:87], v[112:115], v[80:83], a[84:87]
  v_mfma_f32_16x16x32_bf16 a[88:91], v[116:119], v[80:83], a[88:91]
  v_mfma_f32_16x16x32_bf16 a[92:95], v[120:123], v[80:83], a[92:95]
  v_mfma_f32_16x16x32_bf16 a[96:99], v[108:111], v[84:87], a[96:99]
  v_mfma_f32_16x16x32_bf16 a[100:103], v[112:115], v[84:87], a[100:103]
  v_mfma_f32_16x16x32_bf16 a[104:107], v[116:119], v[84:87], a[104:107]
  v_mfma_f32_16x16x32_bf16 a[108:111], v[120:123], v[84:87], a[108:111]
  v_mfma_f32_16x16x32_bf16 a[112:115], v[108:111], v[88:91], a[112:115]
  v_mfma_f32_16x16x32_bf16 a[116:119], v[112:115], v[88:91], a[116:119]
  v_mfma_f32_16x16x32_bf16 a[120:123], v[116:119], v[88:91], a[120:123]
  v_mfma_f32_16x16x32_bf16 a[124:127], v[120:123], v[88:91], a[124:127]
  s_mov_b32 s59, 6
  s_mov_b32 s60, s22
  s_mov_b32 s61, s26
  s_add_u32 s62, s38, 0x3d00000
  s_mov_b32 s63, s98
  s_cmp_eq_u32 s35, 16
  s_cselect_b32 s90, 999, s34
  s_cmp_lt_u32 s90, 242
  s_cbranch_scc1 L_got
  s_mov_b32 s58, 3
  s_branch L_epi
L_g3c:
  v_and_b32 v1, 63, v0
  v_lshrrev_b32 v16, 6, v0
  s_nop 0
  v_readfirstlane_b32 s27, v16
  s_mul_i32 s90, s27, 1
  s_mul_i32 s90, s90, s23
  v_mov_b32 v2, 0x0
  v_bfe_u32 v17, v1, 0, 6
  v_lshl_add_u32 v2, v17, 4, v2
  v_add_u32 v2, s90, v2
  v_mov_b32 v3, 0x400
  v_bfe_u32 v17, v1, 0, 6
  v_lshl_add_u32 v3, v17, 4, v3
  v_add_u32 v3, s90, v3
  v_mov_b32 v4, 0x1000
  v_bfe_u32 v17, v1, 0, 6
  v_lshl_add_u32 v4, v17, 4, v4
  v_add_u32 v4, s90, v4
  v_mov_b32 v5, 0x1400
  v_bfe_u32 v17, v1, 0, 6
  v_lshl_add_u32 v5, v17, 4, v5
  v_add_u32 v5, s90, v5
  s_mul_i32 s90, s27, 16
  v_lshrrev_b32 v16, 4, v1
  v_add_u32 v16, 0, v16
  v_add_u32 v16, s90, v16
  v_and_b32 v17, 7, v16
  v_lshlrev_b32 v17, 1, v17
  v_xor_b32 v17, v17, v1
  v_and_b32 v17, 15, v17
  v_mul_lo_u32 v16, v16, s24
  v_lshl_add_u32 v6, v17, 4, v16
  v_lshrrev_b32 v16, 4, v1
  v_add_u32 v16, 4, v16
  v_add_u32 v16, s90, v16
  v_and_b32 v17, 7, v16
  v_lshlrev_b32 v17, 1, v17
  v_xor_b32 v17, v17, v1
  v_and_b32 v17, 15, v17
  v_mul_lo_u32 v16, v16, s24
  v_lshl_add_u32 v7, v17, 4, v16
  v_lshrrev_b32 v16, 4, v1
  v_add_u32 v16, 8, v16
  v_add_u32 v16, s90, v16
  v_and_b32 v17, 7, v16
  v_lshlrev_b32 v17, 1, v17
  v_xor_b32 v17, v17, v1
  v_and_b32 v17, 15, v17
  v_mul_lo_u32 v16, v16, s24
  v_lshl_add_u32 v8, v17, 4, v16
  v_lshrrev_b32 v16, 4, v1
  v_add_u32 v16, 12, v16
  v_add_u32 v16, s90, v16
  v_and_b32 v17, 7, v16
  v_lshlrev_b32 v17, 1, v17
  v_xor_b32 v17, v17, v1
  v_and_b32 v17, 15, v17
  v_mul_lo_u32 v16, v16, s24
  v_lshl_add_u32 v9, v17, 4, v16
  s_mul_i32 s51, s24, 64
  s_mul_i32 s52, s27, 4096
  s_mul_i32 s53, s27, 4096
  s_add_u32 s53, s53, 16384
  s_add_u32 m0, s53, 0
  s_nop 0
  buffer_load_dwordx4 v6, s[12:15], s21 offen  lds
  s_add_u32 m0, s53, 1024
  s_nop 0
  buffer_load_dwordx4 v7, s[12:15], s21 offen  lds
  s_add_u32 m0, s53, 2048
  s_nop 0
  buffer_load_dwordx4 v8, s[12:15], s21 offen  lds
  s_add_u32 m0, s53, 3072
  s_nop 0
  buffer_load_dwordx4 v9, s[12:15], s21 offen  lds
  s_add_u32 s21, s21, s51
  s_add_u32 m0, s53, 32768
  s_nop 0
  buffer_load_dwordx4 v6, s[12:15], s21 offen  lds
  s_add_u32 m0, s53, 33792
  s_nop 0
  buffer_load_dwordx4 v7, s[12:15], s21 offen  lds
  s_add_u32 m0, s53, 34816
  s_nop 0
  buffer_load_dwordx4 v8, s[12:15], s21 offen  lds
  s_add_u32 m0, s53, 35840
  s_nop 0
  buffer_load_dwordx4 v9, s[12:15], s21 offen  lds
  s_add_u32 s21, s21, s51
  s_add_u32 m0, s53, 65536
  s_nop 0
  buffer_load_dwordx4 v6, s[12:15], s21 offen  lds
  s_add_u32 m0, s53, 66560
  s_nop 0
  buffer_load_dwordx4 v7, s[12:15], s21 offen  lds
  s_add_u32 m0, s53, 67584
  s_nop 0
  buffer_load_dwordx4 v8, s[12:15], s21 offen  lds
  s_add_u32 m0, s53, 68608
  s_nop 0
  buffer_load_dwordx4 v9, s[12:15], s21 offen  lds
  s_add_u32 s21, s21, s51
  s_add_u32 m0, s53, 98304
  s_nop 0
  buffer_load_dwordx4 v6, s[12:15], s21 offen  lds
  s_add_u32 m0, s53, 99328
  s_nop 0
  buffer_load_dwordx4 v7, s[12:15], s21 offen  lds
  s_add_u32 m0, s53, 100352
  s_nop 0
  buffer_load_dwordx4 v8, s[12:15], s21 offen  lds
  s_add_u32 m0, s53, 101376
  s_nop 0
  buffer_load_dwordx4 v9, s[12:15], s21 offen  lds
  s_add_u32 s21, s21, s51
  s_cmp_lg_u32 s32, 0
  s_cbranch_scc1 L_dd_103
  v_mov_b32 v228, 0x3d00000
  v_mov_b32 v229, 0x3d01000
L_dw_102:
  buffer_load_dword v234, v228, s[4:7], s40 offen offset:0 sc1
  buffer_load_dword v235, v228, s[4:7], s42 offen offset:0 sc1
  buffer_load_dword v236, v229, s[4:7], 0 offen offset:1024 sc1
  s_waitcnt vmcnt(0)
  s_mov_b32 s44, 1
  v_readfirstlane_b32 s45, v234
  s_cmp_ge_u32 s45, s41
  s_cselect_b32 s44, s44, 0
  v_readfirstlane_b32 s45, v235
  s_cmp_ge_u32 s45, s41
  s_cselect_b32 s44, s44, 0
  v_readfirstlane_b32 s45, v236
  s_cmp_ge_u32 s45, 16
  s_cselect_b32 s44, s44, 0
  s_cmp_eq_u32 s44, 1
  s_cbranch_scc1 L_dd_103
  s_sleep 3
  s_add_u32 s3, s3, 1
  s_cmp_lt_u32 s3, 131072
  s_cbranch_scc1 L_dw_102
L_dd_103:
  s_barrier
  s_add_u32 m0, s52, 0
  s_nop 0
  buffer_load_dwordx4 v2, s[8:11], s20 offen sc1 lds
  s_add_u32 m0, s52, 1024
  s_nop 0
  buffer_load_dwordx4 v3, s[8:11], s20 offen sc1 lds
  s_add_u32 m0, s52, 2048
  s_nop 0
  buffer_load_dwordx4 v4, s[8:11], s20 offen sc1 lds
  s_add_u32 m0, s52, 3072
  s_nop 0
  buffer_load_dwordx4 v5, s[8:11], s20 offen sc1 lds
  s_add_u32 s20, s20, 2048
  s_add_u32 m0, s52, 32768
  s_nop 0
  buffer_load_dwordx4 v2, s[8:11], s20 offen sc1 lds
  s_add_u32 m0, s52, 33792
  s_nop 0
  buffer_load_dwordx4 v3, s[8:11], s20 offen sc1 lds
  s_add_u32 m0, s52, 34816
  s_nop 0
  buffer_load_dwordx4 v4, s[8:11], s20 offen sc1 lds
  s_add_u32 m0, s52, 35840
  s_nop 0
  buffer_load_dwordx4 v5, s[8:11], s20 offen sc1 lds
  s_add_u32 s20, s20, 6144
  s_add_u32 m0, s52, 65536
  s_nop 0
  buffer_load_dwordx4 v2, s[8:11], s20 offen sc1 lds
  s_add_u32 m0, s52, 66560
  s_nop 0
  buffer_load_dwordx4 v3, s[8:11], s20 offen sc1 lds
  s_add_u32 m0, s52, 67584
  s_nop 0
  buffer_load_dwordx4 v4, s[8:11], s20 offen sc1 lds
  s_add_u32 m0, s52, 68608
  s_nop 0
  buffer_load_dwordx4 v5, s[8:11], s20 offen sc1 lds
  s_add_u32 s20, s20, 2048
  s_add_u32 m0, s52, 98304
  s_nop 0
  buffer_load_dwordx4 v2, s[8:11], s20 offen sc1 lds
  s_add_u32 m0, s52, 99328
  s_nop 0
  buffer_load_dwordx4 v3, s[8:11], s20 offen sc1 lds
  s_add_u32 m0, s52, 100352
  s_nop 0
  buffer_load_dwordx4 v4, s[8:11], s20 offen sc1 lds
  s_add_u32 m0, s52, 101376
  s_nop 0
  buffer_load_dwordx4 v5, s[8:11], s20 offen sc1 lds
  s_add_u32 s20, s20, 6144
  s_lshr_b32 s90, s27, 1
  s_and_b32 s91, s27, 1
  s_mul_i32 s92, s90, 8192
  v_mov_b32 v10, 0x0
  v_bfe_u32 v17, v1, 0, 6
  v_lshl_add_u32 v10, v17, 4, v10
  v_add_u32 v10, s92, v10
  v_add_u32 v11, 65536, v10
  v_mov_b32 v16, 0x0
  v_bfe_u32 v17, v1, 2, 2
  v_lshl_add_u32 v16, v17, 8, v16
  v_bfe_u32 v17, v1, 4, 2
  v_lshl_add_u32 v16, v17, 10, v16
  v_bfe_u32 v17, v1, 0, 1
  v_lshl_add_u32 v16, v17, 4, v16
  v_bfe_u32 v18, v1, 2, 3
  v_bfe_u32 v17, v1, 1, 1
  v_xor_b32 v18, v18, v17
  s_mul_i32 s92, s91, 4
  s_add_u32 s93, s92, 0
  v_xor_b32 v17, s93, v18
  v_lshl_add_u32 v12, v17, 5, v16
  v_add_u32 v14, 65536, v12
  s_add_u32 s93, s92, 2
  v_xor_b32 v17, s93, v18
  v_lshl_add_u32 v13, v17, 5, v16
  v_add_u32 v15, 65536, v13
  s_waitcnt vmcnt(12)
  s_barrier
  ds_read_b128 v[20:23], v10 offset:0
  ds_read_b64_tr_b16 v[52:53], v12 offset:16384
  ds_read_b64_tr_b16 v[54:55], v12 offset:20480
  ds_read_b128 v[24:27], v10 offset:2048
  ds_read_b64_tr_b16 v[56:57], v12 offset:16392
  ds_read_b64_tr_b16 v[58:59], v12 offset:20488
  ds_read_b128 v[28:31], v10 offset:4096
  ds_read_b64_tr_b16 v[60:61], v13 offset:16384
  ds_read_b64_tr_b16 v[62:63], v13 offset:20480
  ds_read_b128 v[32:35], v10 offset:6144
  ds_read_b64_tr_b16 v[64:65], v13 offset:16392
  ds_read_b64_tr_b16 v[66:67], v13 offset:20488
  s_sub_u32 s25, s25, 1
  s_waitcnt lgkmcnt(0)
  v_mfma_f32_16x16x32_bf16 a[0:3], v[52:55], v[20:23], 0
  ds_read_b128 v[36:39], v10 offset:1024
  v_mfma_f32_16x16x32_bf16 a[4:7], v[56:59], v[20:23], 0
  ds_read_b64_tr_b16 v[68:69], v12 offset:24576
  v_mfma_f32_16x16x32_bf16 a[8:11], v[60:63], v[20:23], 0
  ds_read_b64_tr_b16 v[70:71], v12 offset:28672
  v_mfma_f32_16x16x32_bf16 a[12:15], v[64:67], v[20:23], 0
  ds_read_b128 v[40:43], v10 offset:3072
  v_mfma_f32_16x16x32_bf16 a[16:19], v[52:55], v[24:27], 0
  ds_read_b64_tr_b16 v[72:73], v12 offset:24584
  v_mfma_f32_16x16x32_bf16 a[20:23], v[56:59], v[24:27], 0
  ds_read_b64_tr_b16 v[74:75], v12 offset:28680
  v_mfma_f32_16x16x32_bf16 a[24:27], v[60:63], v[24:27], 0
  ds_read_b128 v[44:47], v10 offset:5120
  v_mfma_f32_16x16x32_bf16 a[28:31], v[64:67], v[24:27], 0
  ds_read_b64_tr_b16 v[76:77], v13 offset:24576
  v_mfma_f32_16x16x32_bf16 a[32:35], v[52:55], v[28:31], 0
  ds_read_b64_tr_b16 v[78:79], v13 offset:28672
  v_mfma_f32_16x16x32_bf16 a[36:39], v[56:59], v[28:31], 0
  ds_read_b128 v[48:51], v10 offset:7168
  v_mfma_f32_16x16x32_bf16 a[40:43], v[60:63], v[28:31], 0
  ds_read_b64_tr_b16 v[80:81], v13 offset:24584
  v_mfma_f32_16x16x32_bf16 a[44:47], v[64:67], v[28:31], 0
  ds_read_b64_tr_b16 v[82:83], v13 offset:28680
  v_mfma_f32_16x16x32_bf16 a[48:51], v[52:55], v[32:35], 0
  v_mfma_f32_16x16x32_bf16 a[52:55], v[56:59], v[32:35], 0
  v_mfma_f32_16x16x32_bf16 a[56:59], v[60:63], v[32:35], 0
  v_mfma_f32_16x16x32_bf16 a[60:63], v[64:67], v[32:35], 0
  s_waitcnt lgkmcnt(0)
  v_mfma_f32_16x16x32_bf16 a[0:3], v[68:71], v[36:39], a[0:3]
  s_waitcnt vmcnt(8)
  s_barrier
  s_add_u32 m0, s52, 0
  v_mfma_f32_16x16x32_bf16 a[4:7], v[72:75], v[36:39], a[4:7]
  buffer_load_dwordx4 v2, s[8:11], s20 offen sc1 lds
  ds_read_b128 v[20:23], v10 offset:32768
  v_mfma_f32_16x16x32_bf16 a[8:11], v[76:79], v[36:39], a[8:11]
  ds_read_b64_tr_b16 v[52:53], v12 offset:49152
  v_mfma_f32_16x16x32_bf16 a[12:15], v[80:83], v[36:39], a[12:15]
  ds_read_b64_tr_b16 v[54:55], v12 offset:53248
  s_add_u32 m0, s53, 0
  v_mfma_f32_16x16x32_bf16 a[16:19], v[68:71], v[40:43], a[16:19]
  buffer_load_dwordx4 v6, s[12:15], s21 offen  lds
  ds_read_b128 v[24:27], v10 offset:34816
  v_mfma_f32_16x16x32_bf16 a[20:23], v[72:75], v[40:43], a[20:23]
  ds_read_b64_tr_b16 v[56:57], v12 offset:49160
  v_mfma_f32_16x16x32_bf16 a[24:27], v[76:79], v[40:43], a[24:27]
  ds_read_b64_tr_b16 v[58:59], v12 offset:53256
  s_add_u32 m0, s52, 1024
  v_mfma_f32_16x16x32_bf16 a[28:31], v[80:83], v[40:43], a[28:31]
  buffer_load_dwordx4 v3, s[8:11], s20 offen sc1 lds
  ds_read_b128 v[28:31], v10 offset:36864
  v_mfma_f32_16x16x32_bf16 a[32:35], v[68:71], v[44:47], a[32:35]
  ds_read_b64_tr_b16 v[60:61], v13 offset:49152
  v_mfma_f32_16x16x32_bf16 a[36:39], v[72:75], v[44:47], a[36:39]
  ds_read_b64_tr_b16 v[62:63], v13 offset:53248
  s_add_u32 m0, s53, 1024
  v_mfma_f32_16x16x32_bf16 a[40:43], v[76:79], v[44:47], a[40:43]
  buffer_load_dwordx4 v7, s[12:15], s21 offen  lds
  ds_read_b128 v[32:35], v10 offset:38912
  v_mfma_f32_16x16x32_bf16 a[44:47], v[80:83], v[44:47], a[44:47]
  ds_read_b64_tr_b16 v[64:65], v13 offset:49160
  v_mfma_f32_16x16x32_bf16 a[48:51], v[68:71], v[48:51], a[48:51]
  ds_read_b64_tr_b16 v[66:67], v13 offset:53256
  s_add_u32 m0, s52, 2048
  v_mfma_f32_16x16x32_bf16 a[52:55], v[72:75], v[48:51], a[52:55]
  buffer_load_dwordx4 v4, s[8:11], s20 offen sc1 lds
  v_mfma_f32_16x16x32_bf16 a[56:59], v[76:79], v[48:51], a[56:59]
  v_mfma_f32_16x16x32_bf16 a[60:63], v[80:83], v[48:51], a[60:63]
  s_waitcnt lgkmcnt(0)
  s_add_u32 m0, s53, 2048
  v_mfma_f32_16x16x32_bf16 a[0:3], v[52:55], v[20:23], a[0:3]
  buffer_load_dwordx4 v8, s[12:15], s21 offen  lds
  ds_read_b128 v[36:39], v10 offset:33792
  v_mfma_f32_16x16x32_bf16 a[4:7], v[56:59], v[20:23], a[4:7]
  ds_read_b64_tr_b16 v[68:69], v12 offset:57344
  v_mfma_f32_16x16x32_bf16 a[8:11], v[60:63], v[20:23], a[8:11]
  ds_read_b64_tr_b16 v[70:71], v12 offset:61440
  v_mfma_f32_16x16x32_bf16 a[12:15], v[64:67], v[20:23], a[12:15]
  ds_read_b128 v[40:43], v10 offset:35840
  s_add_u32 m0, s52, 3072
  v_mfma_f32_16x16x32_bf16 a[16:19], v[52:55], v[24:27], a[16:19]
  buffer_load_dwordx4 v5, s[8:11], s20 offen sc1 lds
  ds_read_b64_tr_b16 v[72:73], v12 offset:57352
  v_mfma_f32_16x16x32_bf16 a[20:23], v[56:59], v[24:27], a[20:23]
  ds_read_b64_tr_b16 v[74:75], v12 offset:61448
  v_mfma_f32_16x16x32_bf16 a[24:27], v[60:63], v[24:27], a[24:27]
  ds_read_b128 v[44:47], v10 offset:37888
  v_mfma_f32_16x16x32_bf16 a[28:31], v[64:67], v[24:27], a[28:31]
  ds_read_b64_tr_b16 v[76:77], v13 offset:57344
  s_add_u32 m0, s53, 3072
  v_mfma_f32_16x16x32_bf16 a[32:35], v[52:55], v[28:31], a[32:35]
  buffer_load_dwordx4 v9, s[12:15], s21 offen  lds
  ds_read_b64_tr_b16 v[78:79], v13 offset:61440
  v_mfma_f32_16x16x32_bf16 a[36:39], v[56:59], v[28:31], a[36:39]
  ds_read_b128 v[48:51], v10 offset:39936
  v_mfma_f32_16x16x32_bf16 a[40:43], v[60:63], v[28:31], a[40:43]
  ds_read_b64_tr_b16 v[80:81], v13 offset:57352
  v_mfma_f32_16x16x32_bf16 a[44:47], v[64:67], v[28:31], a[44:47]
  ds_read_b64_tr_b16 v[82:83], v13 offset:61448
  s_add_u32 s20, s20, 2048
  v_mfma_f32_16x16x32_bf16 a[48:51], v[52:55], v[32:35], a[48:51]
  s_add_u32 s21, s21, s51
  v_mfma_f32_16x16x32_bf16 a[52:55], v[56:59], v[32:35], a[52:55]
  v_mfma_f32_16x16x32_bf16 a[56:59], v[60:63], v[32:35], a[56:59]
  v_mfma_f32_16x16x32_bf16 a[60:63], v[64:67], v[32:35], a[60:63]
  s_waitcnt lgkmcnt(0)
  v_mfma_f32_16x16x32_bf16 a[0:3], v[68:71], v[36:39], a[0:3]
  s_waitcnt vmcnt(12)
  s_barrier
  s_add_u32 m0, s52, 32768
  v_mfma_f32_16x16x32_bf16 a[4:7], v[72:75], v[36:39], a[4:7]
  buffer_load_dwordx4 v2, s[8:11], s20 offen sc1 lds
  ds_read_b128 v[20:23], v11 offset:0
  v_mfma_f32_16x16x32_bf16 a[8:11], v[76:79], v[36:39], a[8:11]
  ds_read_b64_tr_b16 v[52:53], v14 offset:16384
  v_mfma_f32_16x16x32_bf16 a[12:15], v[80:83], v[36:39], a[12:15]
  ds_read_b64_tr_b16 v[54:55], v14 offset:20480
  s_add_u32 m0, s53, 32768
  v_mfma_f32_16x16x32_bf16 a[16:19], v[68:71], v[40:43], a[16:19]
  buffer_load_dwordx4 v6, s[12:15], s21 offen  lds
  ds_read_b128 v[24:27], v11 offset:2048
  v_mfma_f32_16x16x32_bf16 a[20:23], v[72:75], v[40:43], a[20:23]
  ds_read_b64_tr_b16 v[56:57], v14 offset:16392
  v_mfma_f32_16x16x32_bf16 a[24:27], v[76:79], v[40:43], a[24:27]
  ds_read_b64_tr_b16 v[58:59], v14 offset:20488
  s_add_u32 m0, s52, 33792
  v_mfma_f32_16x16x32_bf16 a[28:31], v[80:83], v[40:43], a[28:31]
  buffer_load_dwordx4 v3, s[8:11], s20 offen sc1 lds
  ds_read_b128 v[28:31], v11 offset:4096
  v_mfma_f32_16x16x32_bf16 a[32:35], v[68:71], v[44:47], a[32:35]
  ds_read_b64_tr_b16 v[60:61], v15 offset:16384
  v_mfma_f32_16x16x32_bf16 a[36:39], v[72:75], v[44:47], a[36:39]
  ds_read_b64_tr_b16 v[62:63], v15 offset:20480
  s_add_u32 m0, s53, 33792
  v_mfma_f32_16x16x32_bf16 a[40:43], v[76:79], v[44:47], a[40:43]
  buffer_load_dwordx4 v7, s[12:15], s21 offen  lds
  ds_read_b128 v[32:35], v11 offset:6144
  v_mfma_f32_16x16x32_bf16 a[44:47], v[80:83], v[44:47], a[44:47]
  ds_read_b64_tr_b16 v[64:65], v15 offset:16392
  v_mfma_f32_16x16x32_bf16 a[48:51], v[68:71], v[48:51], a[48:51]
  ds_read_b64_tr_b16 v[66:67], v15 offset:20488
  s_add_u32 m0, s52, 34816
  v_mfma_f32_16x16x32_bf16 a[52:55], v[72:75], v[48:51], a[52:55]
  buffer_load_dwordx4 v4, s[8:11], s20 offen sc1 lds
  v_mfma_f32_16x16x32_bf16 a[56:59], v[76:79], v[48:51], a[56:59]
  v_mfma_f32_16x16x32_bf16 a[60:63], v[80:83], v[48:51], a[60:63]
  s_waitcnt lgkmcnt(0)
  s_add_u32 m0, s53, 34816
  v_mfma_f32_16x16x32_bf16 a[0:3], v[52:55], v[20:23], a[0:3]
  buffer_load_dwordx4 v8, s[12:15], s21 offen  lds
  ds_read_b128 v[36:39], v11 offset:1024
  v_mfma_f32_16x16x32_bf16 a[4:7], v[56:59], v[20:23], a[4:7]
  ds_read_b64_tr_b16 v[68:69], v14 offset:24576
  v_mfma_f32_16x16x32_bf16 a[8:11], v[60:63], v[20:23], a[8:11]
  ds_read_b64_tr_b16 v[70:71], v14 offset:28672
  v_mfma_f32_16x16x32_bf16 a[12:15], v[64:67], v[20:23], a[12:15]
  ds_read_b128 v[40:43], v11 offset:3072
  s_add_u32 m0, s52, 35840
  v_mfma_f32_16x16x32_bf16 a[16:19], v[52:55], v[24:27], a[16:19]
  buffer_load_dwordx4 v5, s[8:11], s20 offen sc1 lds
  ds_read_b64_tr_b16 v[72:73], v14 offset:24584
  v_mfma_f32_16x16x32_bf16 a[20:23], v[56:59], v[24:27], a[20:23]
  ds_read_b64_tr_b16 v[74:75], v14 offset:28680
  v_mfma_f32_16x16x32_bf16 a[24:27], v[60:63], v[24:27], a[24:27]
  ds_read_b128 v[44:47], v11 offset:5120
  v_mfma_f32_16x16x32_bf16 a[28:31], v[64:67], v[24:27], a[28:31]
  ds_read_b64_tr_b16 v[76:77], v15 offset:24576
  s_add_u32 m0, s53, 35840
  v_mfma_f32_16x16x32_bf16 a[32:35], v[52:55], v[28:31], a[32:35]
  buffer_load_dwordx4 v9, s[12:15], s21 offen  lds
  ds_read_b64_tr_b16 v[78:79], v15 offset:28672
  v_mfma_f32_16x16x32_bf16 a[36:39], v[56:59], v[28:31], a[36:39]
  ds_read_b128 v[48:51], v11 offset:7168
  v_mfma_f32_16x16x32_bf16 a[40:43], v[60:63], v[28:31], a[40:43]
  ds_read_b64_tr_b16 v[80:81], v15 offset:24584
  v_mfma_f32_16x16x32_bf16 a[44:47], v[64:67], v[28:31], a[44:47]
  ds_read_b64_tr_b16 v[82:83], v15 offset:28680
  s_add_u32 s20, s20, 6144
  v_mfma_f32_16x16x32_bf16 a[48:51], v[52:55], v[32:35], a[48:51]
  s_add_u32 s21, s21, s51
  v_mfma_f32_16x16x32_bf16 a[52:55], v[56:59], v[32:35], a[52:55]
  v_mfma_f32_16x16x32_bf16 a[56:59], v[60:63], v[32:35], a[56:59]
  v_mfma_f32_16x16x32_bf16 a[60:63], v[64:67], v[32:35], a[60:63]
  s_waitcnt lgkmcnt(0)
  v_mfma_f32_16x16x32_bf16 a[0:3], v[68:71], v[36:39], a[0:3]
  s_waitcnt vmcnt(16)
  s_barrier
  s_add_u32 m0, s52, 65536
  v_mfma_f32_16x16x32_bf16 a[4:7], v[72:75], v[36:39], a[4:7]
  buffer_load_dwordx4 v2, s[8:11], s20 offen sc1 lds
  ds_read_b128 v[20:23], v11 offset:32768
  v_mfma_f32_16x16x32_bf16 a[8:11], v[76:79], v[36:39], a[8:11]
  ds_read_b64_tr_b16 v[52:53], v14 offset:49152
  v_mfma_f32_16x16x32_bf16 a[12:15], v[80:83], v[36:39], a[12:15]
  ds_read_b64_tr_b16 v[54:55], v14 offset:53248
  s_add_u32 m0, s53, 65536
  v_mfma_f32_16x16x32_bf16 a[16:19], v[68:71], v[40:43], a[16:19]
  buffer_load_dwordx4 v6, s[12:15], s21 offen  lds
  ds_read_b128 v[24:27], v11 offset:34816
  v_mfma_f32_16x16x32_bf16 a[20:23], v[72:75], v[40:43], a[20:23]
  ds_read_b64_tr_b16 v[56:57], v14 offset:49160
  v_mfma_f32_16x16x32_bf16 a[24:27], v[76:79], v[40:43], a[24:27]
  ds_read_b64_tr_b16 v[58:59], v14 offset:53256
  s_add_u32 m0, s52, 66560
  v_mfma_f32_16x16x32_bf16 a[28:31], v[80:83], v[40:43], a[28:31]
  buffer_load_dwordx4 v3, s[8:11], s20 offen sc1 lds
  ds_read_b128 v[28:31], v11 offset:36864
  v_mfma_f32_16x16x32_bf16 a[32:35], v[68:71], v[44:47], a[32:35]
  ds_read_b64_tr_b16 v[60:61], v15 offset:49152
  v_mfma_f32_16x16x32_bf16 a[36:39], v[72:75], v[44:47], a[36:39]
  ds_read_b64_tr_b16 v[62:63], v15 offset:53248
  s_add_u32 m0, s53, 66560
  v_mfma_f32_16x16x32_bf16 a[40:43], v[76:79], v[44:47], a[40:43]
  buffer_load_dwordx4 v7, s[12:15], s21 offen  lds
  ds_read_b128 v[32:35], v11 offset:38912
  v_mfma_f32_16x16x32_bf16 a[44:47], v[80:83], v[44:47], a[44:47]
  ds_read_b64_tr_b16 v[64:65], v15 offset:49160
  v_mfma_f32_16x16x32_bf16 a[48:51], v[68:71], v[48:51], a[48:51]
  ds_read_b64_tr_b16 v[66:67], v15 offset:53256
  s_add_u32 m0, s52, 67584
  v_mfma_f32_16x16x32_bf16 a[52:55], v[72:75], v[48:51], a[52:55]
  buffer_load_dwordx4 v4, s[8:11], s20 offen sc1 lds
  v_mfma_f32_16x16x32_bf16 a[56:59], v[76:79], v[48:51], a[56:59]
  v_mfma_f32_16x16x32_bf16 a[60:63], v[80:83], v[48:51], a[60:63]
  s_waitcnt lgkmcnt(0)
  s_add_u32 m0, s53, 67584
  v_mfma_f32_16x16x32_bf16 a[0:3], v[52:55], v[20:23], a[0:3]
  buffer_load_dwordx4 v8, s[12:15], s21 offen  lds
  ds_read_b128 v[36:39], v11 offset:33792
  v_mfma_f32_16x16x32_bf16 a[4:7], v[56:59], v[20:23], a[4:7]
  ds_read_b64_tr_b16 v[68:69], v14 offset:57344
  v_mfma_f32_16x16x32_bf16 a[8:11], v[60:63], v[20:23], a[8:11]
  ds_read_b64_tr_b16 v[70:71], v14 offset:61440
  v_mfma_f32_16x16x32_bf16 a[12:15], v[64:67], v[20:23], a[12:15]
  ds_read_b128 v[40:43], v11 offset:35840
  s_add_u32 m0, s52, 68608
  v_mfma_f32_16x16x32_bf16 a[16:19], v[52:55], v[24:27], a[16:19]
  buffer_load_dwordx4 v5, s[8:11], s20 offen sc1 lds
  ds_read_b64_tr_b16 v[72:73], v14 offset:57352
  v_mfma_f32_16x16x32_bf16 a[20:23], v[56:59], v[24:27], a[20:23]
  ds_read_b64_tr_b16 v[74:75], v14 offset:61448
  v_mfma_f32_16x16x32_bf16 a[24:27], v[60:63], v[24:27], a[24:27]
  ds_read_b128 v[44:47], v11 offset:37888
  v_mfma_f32_16x16x32_bf16 a[28:31], v[64:67], v[24:27], a[28:31]
  ds_read_b64_tr_b16 v[76:77], v15 offset:57344
  s_add_u32 m0, s53, 68608
  v_mfma_f32_16x16x32_bf16 a[32:35], v[52:55], v[28:31], a[32:35]
  buffer_load_dwordx4 v9, s[12:15], s21 offen  lds
  ds_read_b64_tr_b16 v[78:79], v15 offset:61440
  v_mfma_f32_16x16x32_bf16 a[36:39], v[56:59], v[28:31], a[36:39]
  ds_read_b128 v[48:51], v11 offset:39936
  v_mfma_f32_16x16x32_bf16 a[40:43], v[60:63], v[28:31], a[40:43]
  ds_read_b64_tr_b16 v[80:81], v15 offset:57352
  v_mfma_f32_16x16x32_bf16 a[44:47], v[64:67], v[28:31], a[44:47]
  ds_read_b64_tr_b16 v[82:83], v15 offset:61448
  s_add_u32 s20, s20, 2048
  v_mfma_f32_16x16x32_bf16 a[48:51], v[52:55], v[32:35], a[48:51]
  s_add_u32 s21, s21, s51
  v_mfma_f32_16x16x32_bf16 a[52:55], v[56:59], v[32:35], a[52:55]
  v_mfma_f32_16x16x32_bf16 a[56:59], v[60:63], v[32:35], a[56:59]
  v_mfma_f32_16x16x32_bf16 a[60:63], v[64:67], v[32:35], a[60:63]
  s_waitcnt lgkmcnt(0)
  v_mfma_f32_16x16x32_bf16 a[0:3], v[68:71], v[36:39], a[0:3]
  s_waitcnt vmcnt(16)
  s_barrier
  s_add_u32 m0, s52, 98304
  v_mfma_f32_16x16x32_bf16 a[4:7], v[72:75], v[36:39], a[4:7]
  buffer_load_dwordx4 v2, s[8:11], s20 offen sc1 lds
  ds_read_b128 v[20:23], v10 offset:0
  v_mfma_f32_16x16x32_bf16 a[8:11], v[76:79], v[36:39], a[8:11]
  ds_read_b64_tr_b16 v[52:53], v12 offset:16384
  v_mfma_f32_16x16x32_bf16 a[12:15], v[80:83], v[36:39], a[12:15]
  ds_read_b64_tr_b16 v[54:55], v12 offset:20480
  s_add_u32 m0, s53, 98304
  v_mfma_f32_16x16x32_bf16 a[16:19], v[68:71], v[40:43], a[16:19]
  buffer_load_dwordx4 v6, s[12:15], s21 offen  lds
  ds_read_b128 v[24:27], v10 offset:2048
  v_mfma_f32_16x16x32_bf16 a[20:23], v[72:75], v[40:43], a[20:23]
  ds_read_b64_tr_b16 v[56:57], v12 offset:16392
  v_mfma_f32_16x16x32_bf16 a[24:27], v[76:79], v[40:43], a[24:27]
  ds_read_b64_tr_b16 v[58:59], v12 offset:20488
  s_add_u32 m0, s52, 99328
  v_mfma_f32_16x16x32_bf16 a[28:31], v[80:83], v[40:43], a[28:31]
  buffer_load_dwordx4 v3, s[8:11], s20 offen sc1 lds
  ds_read_b128 v[28:31], v10 offset:4096
  v_mfma_f32_16x16x32_bf16 a[32:35], v[68:71], v[44:47], a[32:35]
  ds_read_b64_tr_b16 v[60:61], v13 offset:16384
  v_mfma_f32_16x16x32_bf16 a[36:39], v[72:75], v[44:47], a[36:39]
  ds_read_b64_tr_b16 v[62:63], v13 offset:20480
  s_add_u32 m0, s53, 99328
  v_mfma_f32_16x16x32_bf16 a[40:43], v[76:79], v[44:47], a[40:43]
  buffer_load_dwordx4 v7, s[12:15], s21 offen  lds
  ds_read_b128 v[32:35], v10 offset:6144
  v_mfma_f32_16x16x32_bf16 a[44:47], v[80:83], v[44:47], a[44:47]
  ds_read_b64_tr_b16 v[64:65], v13 offset:16392
  v_mfma_f32_16x16x32_bf16 a[48:51], v[68:71], v[48:51], a[48:51]
  ds_read_b64_tr_b16 v[66:67], v13 offset:20488
  s_add_u32 m0, s52, 100352
  v_mfma_f32_16x16x32_bf16 a[52:55], v[72:75], v[48:51], a[52:55]
  buffer_load_dwordx4 v4, s[8:11], s20 offen sc1 lds
  v_mfma_f32_16x16x32_bf16 a[56:59], v[76:79], v[48:51], a[56:59]
  v_mfma_f32_16x16x32_bf16 a[60:63], v[80:83], v[48:51], a[60:63]
L_g3_loop:
  s_sub_u32 s25, s25, 1
  s_cmp_eq_u32 s25, 0
  s_cbranch_scc1 L_g3_fin
  s_waitcnt lgkmcnt(0)
  s_add_u32 m0, s53, 100352
  v_mfma_f32_16x16x32_bf16 a[0:3], v[52:55], v[20:23], a[0:3]
  buffer_load_dwordx4 v8, s[12:15], s21 offen  lds
  ds_read_b128 v[36:39], v10 offset:1024
  v_mfma_f32_16x16x32_bf16 a[4:7], v[56:59], v[20:23], a[4:7]
  ds_read_b64_tr_b16 v[68:69], v12 offset:24576
  v_mfma_f32_16x16x32_bf16 a[8:11], v[60:63], v[20:23], a[8:11]
  ds_read_b64_tr_b16 v[70:71], v12 offset:28672
  v_mfma_f32_16x16x32_bf16 a[12:15], v[64:67], v[20:23], a[12:15]
  ds_read_b128 v[40:43], v10 offset:3072
  s_add_u32 m0, s52, 101376
  v_mfma_f32_16x16x32_bf16 a[16:19], v[52:55], v[24:27], a[16:19]
  buffer_load_dwordx4 v5, s[8:11], s20 offen sc1 lds
  ds_read_b64_tr_b16 v[72:73], v12 offset:24584
  v_mfma_f32_16x16x32_bf16 a[20:23], v[56:59], v[24:27], a[20:23]
  ds_read_b64_tr_b16 v[74:75], v12 offset:28680
  v_mfma_f32_16x16x32_bf16 a[24:27], v[60:63], v[24:27], a[24:27]
  ds_read_b128 v[44:47], v10 offset:5120
  v_mfma_f32_16x16x32_bf16 a[28:31], v[64:67], v[24:27], a[28:31]
  ds_read_b64_tr_b16 v[76:77], v13 offset:24576
  s_add_u32 m0, s53, 101376
  v_mfma_f32_16x16x32_bf16 a[32:35], v[52:55], v[28:31], a[32:35]
  buffer_load_dwordx4 v9, s[12:15], s21 offen  lds
  ds_read_b64_tr_b16 v[78:79], v13 offset:28672
  v_mfma_f32_16x16x32_bf16 a[36:39], v[56:59], v[28:31], a[36:39]
  ds_read_b128 v[48:51], v10 offset:7168
  v_mfma_f32_16x16x32_bf16 a[40:43], v[60:63], v[28:31], a[40:43]
  ds_read_b64_tr_b16 v[80:81], v13 offset:24584
  v_mfma_f32_16x16x32_bf16 a[44:47], v[64:67], v[28:31], a[44:47]
  ds_read_b64_tr_b16 v[82:83], v13 offset:28680
  s_add_u32 s20, s20, 6144
  v_mfma_f32_16x16x32_bf16 a[48:51], v[52:55], v[32:35], a[48:51]
  s_add_u32 s21, s21, s51
  v_mfma_f32_16x16x32_bf16 a[52:55], v[56:59], v[32:35], a[52:55]
  v_mfma_f32_16x16x32_bf16 a[56:59], v[60:63], v[32:35], a[56:59]
  v_mfma_f32_16x16x32_bf16 a[60:63], v[64:67], v[32:35], a[60:63]
  s_waitcnt lgkmcnt(0)
  v_mfma_f32_16x16x32_bf16 a[0:3], v[68:71], v[36:39], a[0:3]
  s_waitcnt vmcnt(16)
  s_barrier
  s_add_u32 m0, s52, 0
  v_mfma_f32_16x16x32_bf16 a[4:7], v[72:75], v[36:39], a[4:7]
  buffer_load_dwordx4 v2, s[8:11], s20 offen sc1 lds
  ds_read_b128 v[20:23], v10 offset:32768
  v_mfma_f32_16x16x32_bf16 a[8:11], v[76:79], v[36:39], a[8:11]
  ds_read_b64_tr_b16 v[52:53], v12 offset:49152
  v_mfma_f32_16x16x32_bf16 a[12:15], v[80:83], v[36:39], a[12:15]
  ds_read_b64_tr_b16 v[54:55], v12 offset:53248
  s_add_u32 m0, s53, 0
  v_mfma_f32_16x16x32_bf16 a[16:19], v[68:71], v[40:43], a[16:19]
  buffer_load_dwordx4 v6, s[12:15], s21 offen  lds
  ds_read_b128 v[24:27], v10 offset:34816
  v_mfma_f32_16x16x32_bf16 a[20:23], v[72:75], v[40:43], a[20:23]
  ds_read_b64_tr_b16 v[56:57], v12 offset:49160
  v_mfma_f32_16x16x32_bf16 a[24:27], v[76:79], v[40:43], a[24:27]
  ds_read_b64_tr_b16 v[58:59], v12 offset:53256
  s_add_u32 m0, s52, 1024
  v_mfma_f32_16x16x32_bf16 a[28:31], v[80:83], v[40:43], a[28:31]
  buffer_load_dwordx4 v3, s[8:11], s20 offen sc1 lds
  ds_read_b128 v[28:31], v10 offset:36864
  v_mfma_f32_16x16x32_bf16 a[32:35], v[68:71], v[44:47], a[32:35]
  ds_read_b64_tr_b16 v[60:61], v13 offset:49152
  v_mfma_f32_16x16x32_bf16 a[36:39], v[72:75], v[44:47], a[36:39]
  ds_read_b64_tr_b16 v[62:63], v13 offset:53248
  s_add_u32 m0, s53, 1024
  v_mfma_f32_16x16x32_bf16 a[40:43], v[76:79], v[44:47], a[40:43]
  buffer_load_dwordx4 v7, s[12:15], s21 offen  lds
  ds_read_b128 v[32:35], v10 offset:38912
  v_mfma_f32_16x16x32_bf16 a[44:47], v[80:83], v[44:47], a[44:47]
  ds_read_b64_tr_b16 v[64:65], v13 offset:49160
  v_mfma_f32_16x16x32_bf16 a[48:51], v[68:71], v[48:51], a[48:51]
  ds_read_b64_tr_b16 v[66:67], v13 offset:53256
  s_add_u32 m0, s52, 2048
  v_mfma_f32_16x16x32_bf16 a[52:55], v[72:75], v[48:51], a[52:55]
  buffer_load_dwordx4 v4, s[8:11], s20 offen sc1 lds
  v_mfma_f32_16x16x32_bf16 a[56:59], v[76:79], v[48:51], a[56:59]
  v_mfma_f32_16x16x32_bf16 a[60:63], v[80:83], v[48:51], a[60:63]
  s_waitcnt lgkmcnt(0)
  s_add_u32 m0, s53, 2048
  v_mfma_f32_16x16x32_bf16 a[0:3], v[52:55], v[20:23], a[0:3]
  buffer_load_dwordx4 v8, s[12:15], s21 offen  lds
  ds_read_b128 v[36:39], v10 offset:33792
  v_mfma_f32_16x16x32_bf16 a[4:7], v[56:59], v[20:23], a[4:7]
  ds_read_b64_tr_b16 v[68:69], v12 offset:57344
  v_mfma_f32_16x16x32_bf16 a[8:11], v[60:63], v[20:23], a[8:11]
  ds_read_b64_tr_b16 v[70:71], v12 offset:61440
  v_mfma_f32_16x16x32_bf16 a[12:15], v[64:67], v[20:23], a[12:15]
  ds_read_b128 v[40:43], v10 offset:35840
  s_add_u32 m0, s52, 3072
  v_mfma_f32_16x16x32_bf16 a[16:19], v[52:55], v[24:27], a[16:19]
  buffer_load_dwordx4 v5, s[8:11], s20 offen sc1 lds
  ds_read_b64_tr_b16 v[72:73], v12 offset:57352
  v_mfma_f32_16x16x32_bf16 a[20:23], v[56:59], v[24:27], a[20:23]
  ds_read_b64_tr_b16 v[74:75], v12 offset:61448
  v_mfma_f32_16x16x32_bf16 a[24:27], v[60:63], v[24:27], a[24:27]
  ds_read_b128 v[44:47], v10 offset:37888
  v_mfma_f32_16x16x32_bf16 a[28:31], v[64:67], v[24:27], a[28:31]
  ds_read_b64_tr_b16 v[76:77], v13 offset:57344
  s_add_u32 m0, s53, 3072
  v_mfma_f32_16x16x32_bf16 a[32:35], v[52:55], v[28:31], a[32:35]
  buffer_load_dwordx4 v9, s[12:15], s21 offen  lds
  ds_read_b64_tr_b16 v[78:79], v13 offset:61440
  v_mfma_f32_16x16x32_bf16 a[36:39], v[56:59], v[28:31], a[36:39]
  ds_read_b128 v[48:51], v10 offset:39936
  v_mfma_f32_16x16x32_bf16 a[40:43], v[60:63], v[28:31], a[40:43]
  ds_read_b64_tr_b16 v[80:81], v13 offset:57352
  v_mfma_f32_16x16x32_bf16 a[44:47], v[64:67], v[28:31], a[44:47]
  ds_read_b64_tr_b16 v[82:83], v13 offset:61448
  s_add_u32 s20, s20, 2048
  v_mfma_f32_16x16x32_bf16 a[48:51], v[52:55], v[32:35], a[48:51]
  s_add_u32 s21, s21, s51
  v_mfma_f32_16x16x32_bf16 a[52:55], v[56:59], v[32:35], a[52:55]
  v_mfma_f32_16x16x32_bf16 a[56:59], v[60:63], v[32:35], a[56:59]
  v_mfma_f32_16x16x32_bf16 a[60:63], v[64:67], v[32:35], a[60:63]
  s_waitcnt lgkmcnt(0)
  v_mfma_f32_16x16x32_bf16 a[0:3], v[68:71], v[36:39], a[0:3]
  s_waitcnt vmcnt(16)
  s_barrier
  s_add_u32 m0, s52, 32768
  v_mfma_f32_16x16x32_bf16 a[4:7], v[72:75], v[36:39], a[4:7]
  buffer_load_dwordx4 v2, s[8:11], s20 offen sc1 lds
  ds_read_b128 v[20:23], v11 offset:0
  v_mfma_f32_16x16x32_bf16 a[8:11], v[76:79], v[36:39], a[8:11]
  ds_read_b64_tr_b16 v[52:53], v14 offset:16384
  v_mfma_f32_16x16x32_bf16 a[12:15], v[80:83], v[36:39], a[12:15]
  ds_read_b64_tr_b16 v[54:55], v14 offset:20480
  s_add_u32 m0, s53, 32768
  v_mfma_f32_16x16x32_bf16 a[16:19], v[68:71], v[40:43], a[16:19]
  buffer_load_dwordx4 v6, s[12:15], s21 offen  lds
  ds_read_b128 v[24:27], v11 offset:2048
  v_mfma_f32_16x16x32_bf16 a[20:23], v[72:75], v[40:43], a[20:23]
  ds_read_b64_tr_b16 v[56:57], v14 offset:16392
  v_mfma_f32_16x16x32_bf16 a[24:27], v[76:79], v[40:43], a[24:27]
  ds_read_b64_tr_b16 v[58:59], v14 offset:20488
  s_add_u32 m0, s52, 33792
  v_mfma_f32_16x16x32_bf16 a[28:31], v[80:83], v[40:43], a[28:31]
  buffer_load_dwordx4 v3, s[8:11], s20 offen sc1 lds
  ds_read_b128 v[28:31], v11 offset:4096
  v_mfma_f32_16x16x32_bf16 a[32:35], v[68:71], v[44:47], a[32:35]
  ds_read_b64_tr_b16 v[60:61], v15 offset:16384
  v_mfma_f32_16x16x32_bf16 a[36:39], v[72:75], v[44:47], a[36:39]
  ds_read_b64_tr_b16 v[62:63], v15 offset:20480
  s_add_u32 m0, s53, 33792
  v_mfma_f32_16x16x32_bf16 a[40:43], v[76:79], v[44:47], a[40:43]
  buffer_load_dwordx4 v7, s[12:15], s21 offen  lds
  ds_read_b128 v[32:35], v11 offset:6144
  v_mfma_f32_16x16x32_bf16 a[44:47], v[80:83], v[44:47], a[44:47]
  ds_read_b64_tr_b16 v[64:65], v15 offset:16392
  v_mfma_f32_16x16x32_bf16 a[48:51], v[68:71], v[48:51], a[48:51]
  ds_read_b64_tr_b16 v[66:67], v15 offset:20488
  s_add_u32 m0, s52, 34816
  v_mfma_f32_16x16x32_bf16 a[52:55], v[72:75], v[48:51], a[52:55]
  buffer_load_dwordx4 v4, s[8:11], s20 offen sc1 lds
  v_mfma_f32_16x16x32_bf16 a[56:59], v[76:79], v[48:51], a[56:59]
  v_mfma_f32_16x16x32_bf16 a[60:63], v[80:83], v[48:51], a[60:63]
  s_waitcnt lgkmcnt(0)
  s_add_u32 m0, s53, 34816
  v_mfma_f32_16x16x32_bf16 a[0:3], v[52:55], v[20:23], a[0:3]
  buffer_load_dwordx4 v8, s[12:15], s21 offen  lds
  ds_read_b128 v[36:39], v11 offset:1024
  v_mfma_f32_16x16x32_bf16 a[4:7], v[56:59], v[20:23], a[4:7]
  ds_read_b64_tr_b16 v[68:69], v14 offset:24576
  v_mfma_f32_16x16x32_bf16 a[8:11], v[60:63], v[20:23], a[8:11]
  ds_read_b64_tr_b16 v[70:71], v14 offset:28672
  v_mfma_f32_16x16x32_bf16 a[12:15], v[64:67], v[20:23], a[12:15]
  ds_read_b128 v[40:43], v11 offset:3072
  s_add_u32 m0, s52, 35840
  v_mfma_f32_16x16x32_bf16 a[16:19], v[52:55], v[24:27], a[16:19]
  buffer_load_dwordx4 v5, s[8:11], s20 offen sc1 lds
  ds_read_b64_tr_b16 v[72:73], v14 offset:24584
  v_mfma_f32_16x16x32_bf16 a[20:23], v[56:59], v[24:27], a[20:23]
  ds_read_b64_tr_b16 v[74:75], v14 offset:28680
  v_mfma_f32_16x16x32_bf16 a[24:27], v[60:63], v[24:27], a[24:27]
  ds_read_b128 v[44:47], v11 offset:5120
  v_mfma_f32_16x16x32_bf16 a[28:31], v[64:67], v[24:27], a[28:31]
  ds_read_b64_tr_b16 v[76:77], v15 offset:24576
  s_add_u32 m0, s53, 35840
  v_mfma_f32_16x16x32_bf16 a[32:35], v[52:55], v[28:31], a[32:35]
  buffer_load_dwordx4 v9, s[12:15], s21 offen  lds
  ds_read_b64_tr_b16 v[78:79], v15 offset:28672
  v_mfma_f32_16x16x32_bf16 a[36:39], v[56:59], v[28:31], a[36:39]
  ds_read_b128 v[48:51], v11 offset:7168
  v_mfma_f32_16x16x32_bf16 a[40:43], v[60:63], v[28:31], a[40:43]
  ds_read_b64_tr_b16 v[80:81], v15 offset:24584
  v_mfma_f32_16x16x32_bf16 a[44:47], v[64:67], v[28:31], a[44:47]
  ds_read_b64_tr_b16 v[82:83], v15 offset:28680
  s_add_u32 s20, s20, 6144
  v_mfma_f32_16x16x32_bf16 a[48:51], v[52:55], v[32:35], a[48:51]
  s_add_u32 s21, s21, s51
  v_mfma_f32_16x16x32_bf16 a[52:55], v[56:59], v[32:35], a[52:55]
  v_mfma_f32_16x16x32_bf16 a[56:59], v[60:63], v[32:35], a[56:59]
  v_mfma_f32_16x16x32_bf16 a[60:63], v[64:67], v[32:35], a[60:63]
  s_waitcnt lgkmcnt(0)
  v_mfma_f32_16x16x32_bf16 a[0:3], v[68:71], v[36:39], a[0:3]
  s_waitcnt vmcnt(16)
  s_barrier
  s_add_u32 m0, s52, 65536
  v_mfma_f32_16x16x32_bf16 a[4:7], v[72:75], v[36:39], a[4:7]
  buffer_load_dwordx4 v2, s[8:11], s20 offen sc1 lds
  ds_read_b128 v[20:23], v11 offset:32768
  v_mfma_f32_16x16x32_bf16 a[8:11], v[76:79], v[36:39], a[8:11]
  ds_read_b64_tr_b16 v[52:53], v14 offset:49152
  v_mfma_f32_16x16x32_bf16 a[12:15], v[80:83], v[36:39], a[12:15]
  ds_read_b64_tr_b16 v[54:55], v14 offset:53248
  s_add_u32 m0, s53, 65536
  v_mfma_f32_16x16x32_bf16 a[16:19], v[68:71], v[40:43], a[16:19]
  buffer_load_dwordx4 v6, s[12:15], s21 offen  lds
  ds_read_b128 v[24:27], v11 offset:34816
  v_mfma_f32_16x16x32_bf16 a[20:23], v[72:75], v[40:43], a[20:23]
  ds_read_b64_tr_b16 v[56:57], v14 offset:49160
  v_mfma_f32_16x16x32_bf16 a[24:27], v[76:79], v[40:43], a[24:27]
  ds_read_b64_tr_b16 v[58:59], v14 offset:53256
  s_add_u32 m0, s52, 66560
  v_mfma_f32_16x16x32_bf16 a[28:31], v[80:83], v[40:43], a[28:31]
  buffer_load_dwordx4 v3, s[8:11], s20 offen sc1 lds
  ds_read_b128 v[28:31], v11 offset:36864
  v_mfma_f32_16x16x32_bf16 a[32:35], v[68:71], v[44:47], a[32:35]
  ds_read_b64_tr_b16 v[60:61], v15 offset:49152
  v_mfma_f32_16x16x32_bf16 a[36:39], v[72:75], v[44:47], a[36:39]
  ds_read_b64_tr_b16 v[62:63], v15 offset:53248
  s_add_u32 m0, s53, 66560
  v_mfma_f32_16x16x32_bf16 a[40:43], v[76:79], v[44:47], a[40:43]
  buffer_load_dwordx4 v7, s[12:15], s21 offen  lds
  ds_read_b128 v[32:35], v11 offset:38912
  v_mfma_f32_16x16x32_bf16 a[44:47], v[80:83], v[44:47], a[44:47]
  ds_read_b64_tr_b16 v[64:65], v15 offset:49160
  v_mfma_f32_16x16x32_bf16 a[48:51], v[68:71], v[48:51], a[48:51]
  ds_read_b64_tr_b16 v[66:67], v15 offset:53256
  s_add_u32 m0, s52, 67584
  v_mfma_f32_16x16x32_bf16 a[52:55], v[72:75], v[48:51], a[52:55]
  buffer_load_dwordx4 v4, s[8:11], s20 offen sc1 lds
  v_mfma_f32_16x16x32_bf16 a[56:59], v[76:79], v[48:51], a[56:59]
  v_mfma_f32_16x16x32_bf16 a[60:63], v[80:83], v[48:51], a[60:63]
  s_waitcnt lgkmcnt(0)
  s_add_u32 m0, s53, 67584
  v_mfma_f32_16x16x32_bf16 a[0:3], v[52:55], v[20:23], a[0:3]
  buffer_load_dwordx4 v8, s[12:15], s21 offen  lds
  ds_read_b128 v[36:39], v11 offset:33792
  v_mfma_f32_16x16x32_bf16 a[4:7], v[56:59], v[20:23], a[4:7]
  ds_read_b64_tr_b16 v[68:69], v14 offset:57344
  v_mfma_f32_16x16x32_bf16 a[8:11], v[60:63], v[20:23], a[8:11]
  ds_read_b64_tr_b16 v[70:71], v14 offset:61440
  v_mfma_f32_16x16x32_bf16 a[12:15], v[64:67], v[20:23], a[12:15]
  ds_read_b128 v[40:43], v11 offset:35840
  s_add_u32 m0, s52, 68608
  v_mfma_f32_16x16x32_bf16 a[16:19], v[52:55], v[24:27], a[16:19]
  buffer_load_dwordx4 v5, s[8:11], s20 offen sc1 lds
  ds_read_b64_tr_b16 v[72:73], v14 offset:57352
  v_mfma_f32_16x16x32_bf16 a[20:23], v[56:59], v[24:27], a[20:23]
  ds_read_b64_tr_b16 v[74:75], v14 offset:61448
  v_mfma_f32_16x16x32_bf16 a[24:27], v[60:63], v[24:27], a[24:27]
  ds_read_b128 v[44:47], v11 offset:37888
  v_mfma_f32_16x16x32_bf16 a[28:31], v[64:67], v[24:27], a[28:31]
  ds_read_b64_tr_b16 v[76:77], v15 offset:57344
  s_add_u32 m0, s53, 68608
  v_mfma_f32_16x16x32_bf16 a[32:35], v[52:55], v[28:31], a[32:35]
  buffer_load_dwordx4 v9, s[12:15], s21 offen  lds
  ds_read_b64_tr_b16 v[78:79], v15 offset:61440
  v_mfma_f32_16x16x32_bf16 a[36:39], v[56:59], v[28:31], a[36:39]
  ds_read_b128 v[48:51], v11 offset:39936
  v_mfma_f32_16x16x32_bf16 a[40:43], v[60:63], v[28:31], a[40:43]
  ds_read_b64_tr_b16 v[80:81], v15 offset:57352
  v_mfma_f32_16x16x32_bf16 a[44:47], v[64:67], v[28:31], a[44:47]
  ds_read_b64_tr_b16 v[82:83], v15 offset:61448
  s_add_u32 s20, s20, 2048
  v_mfma_f32_16x16x32_bf16 a[48:51], v[52:55], v[32:35], a[48:51]
  s_add_u32 s21, s21, s51
  v_mfma_f32_16x16x32_bf16 a[52:55], v[56:59], v[32:35], a[52:55]
  v_mfma_f32_16x16x32_bf16 a[56:59], v[60:63], v[32:35], a[56:59]
  v_mfma_f32_16x16x32_bf16 a[60:63], v[64:67], v[32:35], a[60:63]
  s_waitcnt lgkmcnt(0)
  v_mfma_f32_16x16x32_bf16 a[0:3], v[68:71], v[36:39], a[0:3]
  s_waitcnt vmcnt(16)
  s_barrier
  s_add_u32 m0, s52, 98304
  v_mfma_f32_16x16x32_bf16 a[4:7], v[72:75], v[36:39], a[4:7]
  buffer_load_dwordx4 v2, s[8:11], s20 offen sc1 lds
  ds_read_b128 v[20:23], v10 offset:0
  v_mfma_f32_16x16x32_bf16 a[8:11], v[76:79], v[36:39], a[8:11]
  ds_read_b64_tr_b16 v[52:53], v12 offset:16384
  v_mfma_f32_16x16x32_bf16 a[12:15], v[80:83], v[36:39], a[12:15]
  ds_read_b64_tr_b16 v[54:55], v12 offset:20480
  s_add_u32 m0, s53, 98304
  v_mfma_f32_16x16x32_bf16 a[16:19], v[68:71], v[40:43], a[16:19]
  buffer_load_dwordx4 v6, s[12:15], s21 offen  lds
  ds_read_b128 v[24:27], v10 offset:2048
  v_mfma_f32_16x16x32_bf16 a[20:23], v[72:75], v[40:43], a[20:23]
  ds_read_b64_tr_b16 v[56:57], v12 offset:16392
  v_mfma_f32_16x16x32_bf16 a[24:27], v[76:79], v[40:43], a[24:27]
  ds_read_b64_tr_b16 v[58:59], v12 offset:20488
  s_add_u32 m0, s52, 99328
  v_mfma_f32_16x16x32_bf16 a[28:31], v[80:83], v[40:43], a[28:31]
  buffer_load_dwordx4 v3, s[8:11], s20 offen sc1 lds
  ds_read_b128 v[28:31], v10 offset:4096
  v_mfma_f32_16x16x32_bf16 a[32:35], v[68:71], v[44:47], a[32:35]
  ds_read_b64_tr_b16 v[60:61], v13 offset:16384
  v_mfma_f32_16x16x32_bf16 a[36:39], v[72:75], v[44:47], a[36:39]
  ds_read_b64_tr_b16 v[62:63], v13 offset:20480
  s_add_u32 m0, s53, 99328
  v_mfma_f32_16x16x32_bf16 a[40:43], v[76:79], v[44:47], a[40:43]
  buffer_load_dwordx4 v7, s[12:15], s21 offen  lds
  ds_read_b128 v[32:35], v10 offset:6144
  v_mfma_f32_16x16x32_bf16 a[44:47], v[80:83], v[44:47], a[44:47]
  ds_read_b64_tr_b16 v[64:65], v13 offset:16392
  v_mfma_f32_16x16x32_bf16 a[48:51], v[68:71], v[48:51], a[48:51]
  ds_read_b64_tr_b16 v[66:67], v13 offset:20488
  s_add_u32 m0, s52, 100352
  v_mfma_f32_16x16x32_bf16 a[52:55], v[72:75], v[48:51], a[52:55]
  buffer_load_dwordx4 v4, s[8:11], s20 offen sc1 lds
  v_mfma_f32_16x16x32_bf16 a[56:59], v[76:79], v[48:51], a[56:59]
  v_mfma_f32_16x16x32_bf16 a[60:63], v[80:83], v[48:51], a[60:63]
  s_branch L_g3_loop
L_g3_fin:
  s_cmp_ge_u32 s35, 8
  s_cbranch_scc1 L_r3_104
  s_cmp_eq_u32 s35, 16
  s_cselect_b32 s90, 999, s34
  s_cmp_lt_u32 s90, 242
  s_cbranch_scc0 L_re_105
  s_cmp_lg_u32 s32, 0
  s_cbranch_scc1 L_rq_106
  s_cmp_eq_u32 s39, 0
  s_cbranch_scc1 L_rq_106
  s_lshl_b32 s99, s33, 7
  s_add_u32 s99, s99, 0x3d00200
  v_mov_b32 v244, 1
  v_mov_b32 v245, 0
  s_mov_b64 exec, 1
  buffer_atomic_add v244, v245, s[4:7], s99 offen sc0 sc1
  s_mov_b64 exec, -1
L_rq_106:
L_re_105:
L_r3_104:
  s_waitcnt lgkmcnt(0)
  s_add_u32 m0, s53, 100352
  v_mfma_f32_16x16x32_bf16 a[0:3], v[52:55], v[20:23], a[0:3]
  buffer_load_dwordx4 v8, s[12:15], s21 offen  lds
  ds_read_b128 v[36:39], v10 offset:1024
  v_mfma_f32_16x16x32_bf16 a[4:7], v[56:59], v[20:23], a[4:7]
  ds_read_b64_tr_b16 v[68:69], v12 offset:24576
  v_mfma_f32_16x16x32_bf16 a[8:11], v[60:63], v[20:23], a[8:11]
  ds_read_b64_tr_b16 v[70:71], v12 offset:28672
  v_mfma_f32_16x16x32_bf16 a[12:15], v[64:67], v[20:23], a[12:15]
  ds_read_b128 v[40:43], v10 offset:3072
  s_add_u32 m0, s52, 101376
  v_mfma_f32_16x16x32_bf16 a[16:19], v[52:55], v[24:27], a[16:19]
  buffer_load_dwordx4 v5, s[8:11], s20 offen sc1 lds
  ds_read_b64_tr_b16 v[72:73], v12 offset:24584
  v_mfma_f32_16x16x32_bf16 a[20:23], v[56:59], v[24:27], a[20:23]
  ds_read_b64_tr_b16 v[74:75], v12 offset:28680
  v_mfma_f32_16x16x32_bf16 a[24:27], v[60:63], v[24:27], a[24:27]
  ds_read_b128 v[44:47], v10 offset:5120
  v_mfma_f32_16x16x32_bf16 a[28:31], v[64:67], v[24:27], a[28:31]
  ds_read_b64_tr_b16 v[76:77], v13 offset:24576
  s_add_u32 m0, s53, 101376
  v_mfma_f32_16x16x32_bf16 a[32:35], v[52:55], v[28:31], a[32:35]
  buffer_load_dwordx4 v9, s[12:15], s21 offen  lds
  ds_read_b64_tr_b16 v[78:79], v13 offset:28672
  v_mfma_f32_16x16x32_bf16 a[36:39], v[56:59], v[28:31], a[36:39]
  ds_read_b128 v[48:51], v10 offset:7168
  v_mfma_f32_16x16x32_bf16 a[40:43], v[60:63], v[28:31], a[40:43]
  ds_read_b64_tr_b16 v[80:81], v13 offset:24584
  v_mfma_f32_16x16x32_bf16 a[44:47], v[64:67], v[28:31], a[44:47]
  ds_read_b64_tr_b16 v[82:83], v13 offset:28680
  s_add_u32 s20, s20, 6144
  v_mfma_f32_16x16x32_bf16 a[48:51], v[52:55], v[32:35], a[48:51]
  s_add_u32 s21, s21, s51
  v_mfma_f32_16x16x32_bf16 a[52:55], v[56:59], v[32:35], a[52:55]
  v_mfma_f32_16x16x32_bf16 a[56:59], v[60:63], v[32:35], a[56:59]
  v_mfma_f32_16x16x32_bf16 a[60:63], v[64:67], v[32:35], a[60:63]
  s_waitcnt lgkmcnt(0)
  v_mfma_f32_16x16x32_bf16 a[0:3], v[68:71], v[36:39], a[0:3]
  s_waitcnt vmcnt(16)
  s_barrier
  v_mfma_f32_16x16x32_bf16 a[4:7], v[72:75], v[36:39], a[4:7]
  ds_read_b128 v[20:23], v10 offset:32768
  v_mfma_f32_16x16x32_bf16 a[8:11], v[76:79], v[36:39], a[8:11]
  ds_read_b64_tr_b16 v[52:53], v12 offset:49152
  v_mfma_f32_16x16x32_bf16 a[12:15], v[80:83], v[36:39], a[12:15]
  ds_read_b64_tr_b16 v[54:55], v12 offset:53248
  v_mfma_f32_16x16x32_bf16 a[16:19], v[68:71], v[40:43], a[16:19]
  ds_read_b128 v[24:27], v10 offset:34816
  v_mfma_f32_16x16x32_bf16 a[20:23], v[72:75], v[40:43], a[20:23]
  ds_read_b64_tr_b16 v[56:57], v12 offset:49160
  v_mfma_f32_16x16x32_bf16 a[24:27], v[76:79], v[40:43], a[24:27]
  ds_read_b64_tr_b16 v[58:59], v12 offset:53256
  v_mfma_f32_16x16x32_bf16 a[28:31], v[80:83], v[40:43], a[28:31]
  ds_read_b128 v[28:31], v10 offset:36864
  v_mfma_f32_16x16x32_bf16 a[32:35], v[68:71], v[44:47], a[32:35]
  ds_read_b64_tr_b16 v[60:61], v13 offset:49152
  v_mfma_f32_16x16x32_bf16 a[36:39], v[72:75], v[44:47], a[36:39]
  ds_read_b64_tr_b16 v[62:63], v13 offset:53248
  v_mfma_f32_16x16x32_bf16 a[40:43], v[76:79], v[44:47], a[40:43]
  ds_read_b128 v[32:35], v10 offset:38912
  v_mfma_f32_16x16x32_bf16 a[44:47], v[80:83], v[44:47], a[44:47]
  ds_read_b64_tr_b16 v[64:65], v13 offset:49160
  v_mfma_f32_16x16x32_bf16 a[48:51], v[68:71], v[48:51], a[48:51]
  ds_read_b64_tr_b16 v[66:67], v13 offset:53256
  v_mfma_f32_16x16x32_bf16 a[52:55], v[72:75], v[48:51], a[52:55]
  v_mfma_f32_16x16x32_bf16 a[56:59], v[76:79], v[48:51], a[56:59]
  v_mfma_f32_16x16x32_bf16 a[60:63], v[80:83], v[48:51], a[60:63]
  s_waitcnt lgkmcnt(0)
  v_mfma_f32_16x16x32_bf16 a[0:3], v[52:55], v[20:23], a[0:3]
  ds_read_b128 v[36:39], v10 offset:33792
  v_mfma_f32_16x16x32_bf16 a[4:7], v[56:59], v[20:23], a[4:7]
  ds_read_b64_tr_b16 v[68:69], v12 offset:57344
  v_mfma_f32_16x16x32_bf16 a[8:11], v[60:63], v[20:23], a[8:11]
  ds_read_b64_tr_b16 v[70:71], v12 offset:61440
  v_mfma_f32_16x16x32_bf16 a[12:15], v[64:67], v[20:23], a[12:15]
  ds_read_b128 v[40:43], v10 offset:35840
  v_mfma_f32_16x16x32_bf16 a[16:19], v[52:55], v[24:27], a[16:19]
  ds_read_b64_tr_b16 v[72:73], v12 offset:57352
  v_mfma_f32_16x16x32_bf16 a[20:23], v[56:59], v[24:27], a[20:23]
  ds_read_b64_tr_b16 v[74:75], v12 offset:61448
  v_mfma_f32_16x16x32_bf16 a[24:27], v[60:63], v[24:27], a[24:27]
  ds_read_b128 v[44:47], v10 offset:37888
  v_mfma_f32_16x16x32_bf16 a[28:31], v[64:67], v[24:27], a[28:31]
  ds_read_b64_tr_b16 v[76:77], v13 offset:57344
  v_mfma_f32_16x16x32_bf16 a[32:35], v[52:55], v[28:31], a[32:35]
  ds_read_b64_tr_b16 v[78:79], v13 offset:61440
  v_mfma_f32_16x16x32_bf16 a[36:39], v[56:59], v[28:31], a[36:39]
  ds_read_b128 v[48:51], v10 offset:39936
  v_mfma_f32_16x16x32_bf16 a[40:43], v[60:63], v[28:31], a[40:43]
  ds_read_b64_tr_b16 v[80:81], v13 offset:57352
  v_mfma_f32_16x16x32_bf16 a[44:47], v[64:67], v[28:31], a[44:47]
  ds_read_b64_tr_b16 v[82:83], v13 offset:61448
  v_mfma_f32_16x16x32_bf16 a[48:51], v[52:55], v[32:35], a[48:51]
  v_mfma_f32_16x16x32_bf16 a[52:55], v[56:59], v[32:35], a[52:55]
  v_mfma_f32_16x16x32_bf16 a[56:59], v[60:63], v[32:35], a[56:59]
  v_mfma_f32_16x16x32_bf16 a[60:63], v[64:67], v[32:35], a[60:63]
  s_waitcnt lgkmcnt(0)
  v_mfma_f32_16x16x32_bf16 a[0:3], v[68:71], v[36:39], a[0:3]
  s_waitcnt vmcnt(8)
  s_barrier
  v_mfma_f32_16x16x32_bf16 a[4:7], v[72:75], v[36:39], a[4:7]
  ds_read_b128 v[20:23], v11 offset:0
  v_mfma_f32_16x16x32_bf16 a[8:11], v[76:79], v[36:39], a[8:11]
  ds_read_b64_tr_b16 v[52:53], v14 offset:16384
  v_mfma_f32_16x16x32_bf16 a[12:15], v[80:83], v[36:39], a[12:15]
  ds_read_b64_tr_b16 v[54:55], v14 offset:20480
  v_mfma_f32_16x16x32_bf16 a[16:19], v[68:71], v[40:43], a[16:19]
  ds_read_b128 v[24:27], v11 offset:2048
  v_mfma_f32_16x16x32_bf16 a[20:23], v[72:75], v[40:43], a[20:23]
  ds_read_b64_tr_b16 v[56:57], v14 offset:16392
  v_mfma_f32_16x16x32_bf16 a[24:27], v[76:79], v[40:43], a[24:27]
  ds_read_b64_tr_b16 v[58:59], v14 offset:20488
  v_mfma_f32_16x16x32_bf16 a[28:31], v[80:83], v[40:43], a[28:31]
  ds_read_b128 v[28:31], v11 offset:4096
  v_mfma_f32_16x16x32_bf16 a[32:35], v[68:71], v[44:47], a[32:35]
  ds_read_b64_tr_b16 v[60:61], v15 offset:16384
  v_mfma_f32_16x16x32_bf16 a[36:39], v[72:75], v[44:47], a[36:39]
  ds_read_b64_tr_b16 v[62:63], v15 offset:20480
  v_mfma_f32_16x16x32_bf16 a[40:43], v[76:79], v[44:47], a[40:43]
  ds_read_b128 v[32:35], v11 offset:6144
  v_mfma_f32_16x16x32_bf16 a[44:47], v[80:83], v[44:47], a[44:47]
  ds_read_b64_tr_b16 v[64:65], v15 offset:16392
  v_mfma_f32_16x16x32_bf16 a[48:51], v[68:71], v[48:51], a[48:51]
  ds_read_b64_tr_b16 v[66:67], v15 offset:20488
  v_mfma_f32_16x16x32_bf16 a[52:55], v[72:75], v[48:51], a[52:55]
  v_mfma_f32_16x16x32_bf16 a[56:59], v[76:79], v[48:51], a[56:59]
  v_mfma_f32_16x16x32_bf16 a[60:63], v[80:83], v[48:51], a[60:63]
  s_waitcnt lgkmcnt(0)
  v_mfma_f32_16x16x32_bf16 a[0:3], v[52:55], v[20:23], a[0:3]
  ds_read_b128 v[36:39], v11 offset:1024
  v_mfma_f32_16x16x32_bf16 a[4:7], v[56:59], v[20:23], a[4:7]
  ds_read_b64_tr_b16 v[68:69], v14 offset:24576
  v_mfma_f32_16x16x32_bf16 a[8:11], v[60:63], v[20:23], a[8:11]
  ds_read_b64_tr_b16 v[70:71], v14 offset:28672
  v_mfma_f32_16x16x32_bf16 a[12:15], v[64:67], v[20:23], a[12:15]
  ds_read_b128 v[40:43], v11 offset:3072
  v_mfma_f32_16x16x32_bf16 a[16:19], v[52:55], v[24:27], a[16:19]
  ds_read_b64_tr_b16 v[72:73], v14 offset:24584
  v_mfma_f32_16x16x32_bf16 a[20:23], v[56:59], v[24:27], a[20:23]
  ds_read_b64_tr_b16 v[74:75], v14 offset:28680
  v_mfma_f32_16x16x32_bf16 a[24:27], v[60:63], v[24:27], a[24:27]
  ds_read_b128 v[44:47], v11 offset:5120
  v_mfma_f32_16x16x32_bf16 a[28:31], v[64:67], v[24:27], a[28:31]
  ds_read_b64_tr_b16 v[76:77], v15 offset:24576
  v_mfma_f32_16x16x32_bf16 a[32:35], v[52:55], v[28:31], a[32:35]
  ds_read_b64_tr_b16 v[78:79], v15 offset:28672
  v_mfma_f32_16x16x32_bf16 a[36:39], v[56:59], v[28:31], a[36:39]
  ds_read_b128 v[48:51], v11 offset:7168
  v_mfma_f32_16x16x32_bf16 a[40:43], v[60:63], v[28:31], a[40:43]
  ds_read_b64_tr_b16 v[80:81], v15 offset:24584
  v_mfma_f32_16x16x32_bf16 a[44:47], v[64:67], v[28:31], a[44:47]
  ds_read_b64_tr_b16 v[82:83], v15 offset:28680
  v_mfma_f32_16x16x32_bf16 a[48:51], v[52:55], v[32:35], a[48:51]
  v_mfma_f32_16x16x32_bf16 a[52:55], v[56:59], v[32:35], a[52:55]
  v_mfma_f32_16x16x32_bf16 a[56:59], v[60:63], v[32:35], a[56:59]
  v_mfma_f32_16x16x32_bf16 a[60:63], v[64:67], v[32:35], a[60:63]
  s_waitcnt lgkmcnt(0)
  v_mfma_f32_16x16x32_bf16 a[0:3], v[68:71], v[36:39], a[0:3]
  s_waitcnt vmcnt(0)
  s_barrier
  v_mfma_f32_16x16x32_bf16 a[4:7], v[72:75], v[36:39], a[4:7]
  ds_read_b128 v[20:23], v11 offset:32768
  v_mfma_f32_16x16x32_bf16 a[8:11], v[76:79], v[36:39], a[8:11]
  ds_read_b64_tr_b16 v[52:53], v14 offset:49152
  v_mfma_f32_16x16x32_bf16 a[12:15], v[80:83], v[36:39], a[12:15]
  ds_read_b64_tr_b16 v[54:55], v14 offset:53248
  v_mfma_f32_16x16x32_bf16 a[16:19], v[68:71], v[40:43], a[16:19]
  ds_read_b128 v[24:27], v11 offset:34816
  v_mfma_f32_16x16x32_bf16 a[20:23], v[72:75], v[40:43], a[20:23]
  ds_read_b64_tr_b16 v[56:57], v14 offset:49160
  v_mfma_f32_16x16x32_bf16 a[24:27], v[76:79], v[40:43], a[24:27]
  ds_read_b64_tr_b16 v[58:59], v14 offset:53256
  v_mfma_f32_16x16x32_bf16 a[28:31], v[80:83], v[40:43], a[28:31]
  ds_read_b128 v[28:31], v11 offset:36864
  v_mfma_f32_16x16x32_bf16 a[32:35], v[68:71], v[44:47], a[32:35]
  ds_read_b64_tr_b16 v[60:61], v15 offset:49152
  v_mfma_f32_16x16x32_bf16 a[36:39], v[72:75], v[44:47], a[36:39]
  ds_read_b64_tr_b16 v[62:63], v15 offset:53248
  v_mfma_f32_16x16x32_bf16 a[40:43], v[76:79], v[44:47], a[40:43]
  ds_read_b128 v[32:35], v11 offset:38912
  v_mfma_f32_16x16x32_bf16 a[44:47], v[80:83], v[44:47], a[44:47]
  ds_read_b64_tr_b16 v[64:65], v15 offset:49160
  v_mfma_f32_16x16x32_bf16 a[48:51], v[68:71], v[48:51], a[48:51]
  ds_read_b64_tr_b16 v[66:67], v15 offset:53256
  v_mfma_f32_16x16x32_bf16 a[52:55], v[72:75], v[48:51], a[52:55]
  v_mfma_f32_16x16x32_bf16 a[56:59], v[76:79], v[48:51], a[56:59]
  v_mfma_f32_16x16x32_bf16 a[60:63], v[80:83], v[48:51], a[60:63]
  s_waitcnt lgkmcnt(0)
  v_mfma_f32_16x16x32_bf16 a[0:3], v[52:55], v[20:23], a[0:3]
  ds_read_b128 v[36:39], v11 offset:33792
  v_mfma_f32_16x16x32_bf16 a[4:7], v[56:59], v[20:23], a[4:7]
  ds_read_b64_tr_b16 v[68:69], v14 offset:57344
  v_mfma_f32_16x16x32_bf16 a[8:11], v[60:63], v[20:23], a[8:11]
  ds_read_b64_tr_b16 v[70:71], v14 offset:61440
  v_mfma_f32_16x16x32_bf16 a[12:15], v[64:67], v[20:23], a[12:15]
  ds_read_b128 v[40:43], v11 offset:35840
  v_mfma_f32_16x16x32_bf16 a[16:19], v[52:55], v[24:27], a[16:19]
  ds_read_b64_tr_b16 v[72:73], v14 offset:57352
  v_mfma_f32_16x16x32_bf16 a[20:23], v[56:59], v[24:27], a[20:23]
  ds_read_b64_tr_b16 v[74:75], v14 offset:61448
  v_mfma_f32_16x16x32_bf16 a[24:27], v[60:63], v[24:27], a[24:27]
  ds_read_b128 v[44:47], v11 offset:37888
  v_mfma_f32_16x16x32_bf16 a[28:31], v[64:67], v[24:27], a[28:31]
  ds_read_b64_tr_b16 v[76:77], v15 offset:57344
  v_mfma_f32_16x16x32_bf16 a[32:35], v[52:55], v[28:31], a[32:35]
  ds_read_b64_tr_b16 v[78:79], v15 offset:61440
  v_mfma_f32_16x16x32_bf16 a[36:39], v[56:59], v[28:31], a[36:39]
  ds_read_b128 v[48:51], v11 offset:39936
  v_mfma_f32_16x16x32_bf16 a[40:43], v[60:63], v[28:31], a[40:43]
  ds_read_b64_tr_b16 v[80:81], v15 offset:57352
  v_mfma_f32_16x16x32_bf16 a[44:47], v[64:67], v[28:31], a[44:47]
  ds_read_b64_tr_b16 v[82:83], v15 offset:61448
  v_mfma_f32_16x16x32_bf16 a[48:51], v[52:55], v[32:35], a[48:51]
  v_mfma_f32_16x16x32_bf16 a[52:55], v[56:59], v[32:35], a[52:55]
  v_mfma_f32_16x16x32_bf16 a[56:59], v[60:63], v[32:35], a[56:59]
  v_mfma_f32_16x16x32_bf16 a[60:63], v[64:67], v[32:35], a[60:63]
  s_waitcnt lgkmcnt(0)
  v_mfma_f32_16x16x32_bf16 a[0:3], v[68:71], v[36:39], a[0:3]
  v_mfma_f32_16x16x32_bf16 a[4:7], v[72:75], v[36:39], a[4:7]
  v_mfma_f32_16x16x32_bf16 a[8:11], v[76:79], v[36:39], a[8:11]
  v_mfma_f32_16x16x32_bf16 a[12:15], v[80:83], v[36:39], a[12:15]
  v_mfma_f32_16x16x32_bf16 a[16:19], v[68:71], v[40:43], a[16:19]
  v_mfma_f32_16x16x32_bf16 a[20:23], v[72:75], v[40:43], a[20:23]
  v_mfma_f32_16x16x32_bf16 a[24:27], v[76:79], v[40:43], a[24:27]
  v_mfma_f32_16x16x32_bf16 a[28:31], v[80:83], v[40:43], a[28:31]
  v_mfma_f32_16x16x32_bf16 a[32:35], v[68:71], v[44:47], a[32:35]
  v_mfma_f32_16x16x32_bf16 a[36:39], v[72:75], v[44:47], a[36:39]
  v_mfma_f32_16x16x32_bf16 a[40:43], v[76:79], v[44:47], a[40:43]
  v_mfma_f32_16x16x32_bf16 a[44:47], v[80:83], v[44:47], a[44:47]
  v_mfma_f32_16x16x32_bf16 a[48:51], v[68:71], v[48:51], a[48:51]
  v_mfma_f32_16x16x32_bf16 a[52:55], v[72:75], v[48:51], a[52:55]
  v_mfma_f32_16x16x32_bf16 a[56:59], v[76:79], v[48:51], a[56:59]
  v_mfma_f32_16x16x32_bf16 a[60:63], v[80:83], v[48:51], a[60:63]
  s_cmp_ge_u32 s35, 8
  s_cbranch_scc1 L_part
  s_mov_b32 s59, 5
  s_mov_b32 s60, s22
  s_mov_b32 s61, s26
  s_add_u32 s62, s38, 0x3d00000
  s_mov_b32 s63, s98
  s_cmp_eq_u32 s35, 16
  s_cselect_b32 s90, 999, s34
  s_cmp_lt_u32 s90, 242
  s_cbranch_scc1 L_got
  s_mov_b32 s58, 3
  s_branch L_epi
L_part:
  s_sub_u32 s40, s36, 12
  s_lshl_b32 s40, s40, 3
  s_add_u32 s40, s40, s50
  s_lshl_b32 s41, s40, 19
  s_add_u32 s41, s41, 0x6400000
  s_lshl_b32 s90, s32, 14
  s_add_u32 s41, s41, s90
  s_lshl_b32 s90, s48, 16
  s_add_u32 s42, s41, s90
  v_lshlrev_b32 v2, 4, v1
  buffer_store_dwordx4 a[0:3], v2, s[4:7], s42 offen offset:0 sc1
  buffer_store_dwordx4 a[4:7], v2, s[4:7], s42 offen offset:1024 sc1
  buffer_store_dwordx4 a[8:11], v2, s[4:7], s42 offen offset:2048 sc1
  buffer_store_dwordx4 a[12:15], v2, s[4:7], s42 offen offset:3072 sc1
  s_add_u32 s42, s42, 4096
  buffer_store_dwordx4 a[16:19], v2, s[4:7], s42 offen offset:0 sc1
  buffer_store_dwordx4 a[20:23], v2, s[4:7], s42 offen offset:1024 sc1
  buffer_store_dwordx4 a[24:27], v2, s[4:7], s42 offen offset:2048 sc1
  buffer_store_dwordx4 a[28:31], v2, s[4:7], s42 offen offset:3072 sc1
  s_add_u32 s42, s42, 4096
  buffer_store_dwordx4 a[32:35], v2, s[4:7], s42 offen offset:0 sc1
  buffer_store_dwordx4 a[36:39], v2, s[4:7], s42 offen offset:1024 sc1
  buffer_store_dwordx4 a[40:43], v2, s[4:7], s42 offen offset:2048 sc1
  buffer_store_dwordx4 a[44:47], v2, s[4:7], s42 offen offset:3072 sc1
  s_add_u32 s42, s42, 4096
  buffer_store_dwordx4 a[48:51], v2, s[4:7], s42 offen offset:0 sc1
  buffer_store_dwordx4 a[52:55], v2, s[4:7], s42 offen offset:1024 sc1
  buffer_store_dwordx4 a[56:59], v2, s[4:7], s42 offen offset:2048 sc1
  buffer_store_dwordx4 a[60:63], v2, s[4:7], s42 offen offset:3072 sc1
  s_lshl_b32 s40, s40, 7
  s_add_u32 s43, s40, 0x3d04000
  s_waitcnt vmcnt(0)
  s_cmp_eq_u32 s35, 8
  s_cbranch_scc1 L_part8
  s_waitcnt vmcnt(0)
  s_barrier
  s_cmp_lg_u32 s32, 0
  s_cbranch_scc1 L_sig_107
  v_mov_b32 v254, 1
  v_mov_b32 v255, 0
  s_mov_b64 exec, 1
  buffer_atomic_add v254, v255, s[4:7], s43 offen offset:0 sc1
  s_mov_b64 exec, -1
L_sig_107:
  s_cmp_eq_u32 s35, 8
  s_cselect_b32 s43, 8, 4
  s_cmp_lg_u32 s32, 0
  s_cbranch_scc1 L_dd_109
  v_mov_b32 v228, 0x3d00000
  v_mov_b32 v232, 0x3d04000
L_dw_108:
  buffer_load_dword v234, v232, s[4:7], s40 offen offset:0 sc1
  s_waitcnt vmcnt(0)
  s_mov_b32 s44, 1
  v_readfirstlane_b32 s45, v234
  s_cmp_ge_u32 s45, s43
  s_cselect_b32 s44, s44, 0
  s_cmp_eq_u32 s44, 1
  s_cbranch_scc1 L_dd_109
  s_sleep 1
  s_add_u32 s3, s3, 1
  s_cmp_lt_u32 s3, 131072
  s_cbranch_scc1 L_dw_108
L_dd_109:
  s_barrier
  s_cmp_lg_u32 s32, 0
  s_cbranch_scc1 L_rq_110
  s_cmp_eq_u32 s39, 0
  s_cbranch_scc1 L_rq_110
  s_lshl_b32 s99, s33, 7
  s_add_u32 s99, s99, 0x3d00200
  v_mov_b32 v244, 1
  v_mov_b32 v245, 0
  s_mov_b64 exec, 1
  buffer_atomic_add v244, v245, s[4:7], s99 offen sc0 sc1
  s_mov_b64 exec, -1
L_rq_110:
  s_cmp_eq_u32 s35, 14
  s_cbranch_scc1 L_part4
L_part8:
  s_lshl_b32 s90, s48, 11
  s_add_u32 s42, s41, s90
  v_mov_b32 v3, 0x0
  v_bfe_u32 v4, v1, 0, 4
  v_lshl_add_u32 v3, v4, 12, v3
  v_bfe_u32 v4, v1, 4, 2
  v_lshl_add_u32 v3, v4, 4, v3
  s_lshr_b32 s90, s32, 1
  s_lshl_b32 s90, s90, 18
  s_add_u32 s22, s22, s90
  s_and_b32 s90, s32, 1
  s_lshl_b32 s90, s90, 7
  s_add_u32 s22, s22, s90
  s_lshr_b32 s90, s48, 1
  s_lshl_b32 s90, s90, 16
  s_add_u32 s22, s22, s90
  s_and_b32 s90, s48, 1
  s_lshl_b32 s90, s90, 6
  s_add_u32 s22, s22, s90
L_part8r:
  s_mov_b32 s41, s42
  buffer_load_dwordx4 v[16:19], v2, s[4:7], s41 offen offset:0 sc1
  buffer_load_dwordx4 v[20:23], v2, s[4:7], s41 offen offset:1024 sc1
  s_add_u32 s41, s41, 0x10000
  buffer_load_dwordx4 v[24:27], v2, s[4:7], s41 offen offset:0 sc1
  buffer_load_dwordx4 v[28:31], v2, s[4:7], s41 offen offset:1024 sc1
  s_add_u32 s41, s41, 0x10000
  buffer_load_dwordx4 v[32:35], v2, s[4:7], s41 offen offset:0 sc1
  buffer_load_dwordx4 v[36:39], v2, s[4:7], s41 offen offset:1024 sc1
  s_add_u32 s41, s41, 0x10000
  buffer_load_dwordx4 v[40:43], v2, s[4:7], s41 offen offset:0 sc1
  buffer_load_dwordx4 v[44:47], v2, s[4:7], s41 offen offset:1024 sc1
  s_add_u32 s41, s41, 0x10000
  buffer_load_dwordx4 v[48:51], v2, s[4:7], s41 offen offset:0 sc1
  buffer_load_dwordx4 v[52:55], v2, s[4:7], s41 offen offset:1024 sc1
  s_add_u32 s41, s41, 0x10000
  buffer_load_dwordx4 v[56:59], v2, s[4:7], s41 offen offset:0 sc1
  buffer_load_dwordx4 v[60:63], v2, s[4:7], s41 offen offset:1024 sc1
  s_add_u32 s41, s41, 0x10000
  buffer_load_dwordx4 v[64:67], v2, s[4:7], s41 offen offset:0 sc1
  buffer_load_dwordx4 v[68:71], v2, s[4:7], s41 offen offset:1024 sc1
  s_add_u32 s41, s41, 0x10000
  buffer_load_dwordx4 v[72:75], v2, s[4:7], s41 offen offset:0 sc1
  buffer_load_dwordx4 v[76:79], v2, s[4:7], s41 offen offset:1024 sc1
  s_add_u32 s41, s41, 0x10000
  v_mov_b32 v5, 0
  s_waitcnt vmcnt(14)
  v_max3_u32 v5, v5, v16, v17
  v_max3_u32 v5, v5, v18, v19
  v_max3_u32 v5, v5, v20, v21
  v_max3_u32 v5, v5, v22, v23
  s_waitcnt vmcnt(12)
  v_max3_u32 v5, v5, v24, v25
  v_max3_u32 v5, v5, v26, v27
  v_max3_u32 v5, v5, v28, v29
  v_max3_u32 v5, v5, v30, v31
  s_waitcnt vmcnt(10)
  v_max3_u32 v5, v5, v32, v33
  v_max3_u32 v5, v5, v34, v35
  v_max3_u32 v5, v5, v36, v37
  v_max3_u32 v5, v5, v38, v39
  s_waitcnt vmcnt(8)
  v_max3_u32 v5, v5, v40, v41
  v_max3_u32 v5, v5, v42, v43
  v_max3_u32 v5, v5, v44, v45
  v_max3_u32 v5, v5, v46, v47
  s_waitcnt vmcnt(6)
  v_max3_u32 v5, v5, v48, v49
  v_max3_u32 v5, v5, v50, v51
  v_max3_u32 v5, v5, v52, v53
  v_max3_u32 v5, v5, v54, v55
  s_waitcnt vmcnt(4)
  v_max3_u32 v5, v5, v56, v57
  v_max3_u32 v5, v5, v58, v59
  v_max3_u32 v5, v5, v60, v61
  v_max3_u32 v5, v5, v62, v63
  s_waitcnt vmcnt(2)
  v_max3_u32 v5, v5, v64, v65
  v_max3_u32 v5, v5, v66, v67
  v_max3_u32 v5, v5, v68, v69
  v_max3_u32 v5, v5, v70, v71
  s_waitcnt vmcnt(0)
  v_max3_u32 v5, v5, v72, v73
  v_max3_u32 v5, v5, v74, v75
  v_max3_u32 v5, v5, v76, v77
  v_max3_u32 v5, v5, v78, v79
  v_cmp_eq_u32 vcc, -1, v5
  s_add_u32 s3, s3, 1
  s_cmp_ge_u32 s3, 131072
  s_cbranch_scc1 L_part8k
  s_cbranch_vccnz L_part8r
L_part8k:
  s_waitcnt vmcnt(12)
  v_pk_add_f32 v[16:17], v[16:17], v[24:25]
  v_pk_add_f32 v[18:19], v[18:19], v[26:27]
  v_pk_add_f32 v[20:21], v[20:21], v[28:29]
  v_pk_add_f32 v[22:23], v[22:23], v[30:31]
  s_waitcnt vmcnt(10)
  v_pk_add_f32 v[16:17], v[16:17], v[32:33]
  v_pk_add_f32 v[18:19], v[18:19], v[34:35]
  v_pk_add_f32 v[20:21], v[20:21], v[36:37]
  v_pk_add_f32 v[22:23], v[22:23], v[38:39]
  s_waitcnt vmcnt(8)
  v_pk_add_f32 v[16:17], v[16:17], v[40:41]
  v_pk_add_f32 v[18:19], v[18:19], v[42:43]
  v_pk_add_f32 v[20:21], v[20:21], v[44:45]
  v_pk_add_f32 v[22:23], v[22:23], v[46:47]
  s_waitcnt vmcnt(6)
  v_pk_add_f32 v[16:17], v[16:17], v[48:49]
  v_pk_add_f32 v[18:19], v[18:19], v[50:51]
  v_pk_add_f32 v[20:21], v[20:21], v[52:53]
  v_pk_add_f32 v[22:23], v[22:23], v[54:55]
  s_waitcnt vmcnt(4)
  v_pk_add_f32 v[16:17], v[16:17], v[56:57]
  v_pk_add_f32 v[18:19], v[18:19], v[58:59]
  v_pk_add_f32 v[20:21], v[20:21], v[60:61]
  v_pk_add_f32 v[22:23], v[22:23], v[62:63]
  s_waitcnt vmcnt(2)
  v_pk_add_f32 v[16:17], v[16:17], v[64:65]
  v_pk_add_f32 v[18:19], v[18:19], v[66:67]
  v_pk_add_f32 v[20:21], v[20:21], v[68:69]
  v_pk_add_f32 v[22:23], v[22:23], v[70:71]
  s_waitcnt vmcnt(0)
  v_pk_add_f32 v[16:17], v[16:17], v[72:73]
  v_pk_add_f32 v[18:19], v[18:19], v[74:75]
  v_pk_add_f32 v[20:21], v[20:21], v[76:77]
  v_pk_add_f32 v[22:23], v[22:23], v[78:79]
  v_cvt_pk_bf16_f32 v8, v16, v17
  v_cvt_pk_bf16_f32 v9, v18, v19
  v_cvt_pk_bf16_f32 v10, v20, v21
  v_cvt_pk_bf16_f32 v11, v22, v23
  buffer_store_dwordx4 v[8:11], v3, s[16:19], s22 offen sc1
  s_branch L_exit
L_part4:
  s_lshl_b32 s90, s48, 12
  s_add_u32 s41, s41, s90
  buffer_load_dwordx4 v[16:19], v2, s[4:7], s41 offen offset:0 sc1
  buffer_load_dwordx4 v[20:23], v2, s[4:7], s41 offen offset:1024 sc1
  buffer_load_dwordx4 v[24:27], v2, s[4:7], s41 offen offset:2048 sc1
  buffer_load_dwordx4 v[28:31], v2, s[4:7], s41 offen offset:3072 sc1
  s_add_u32 s41, s41, 0x10000
  buffer_load_dwordx4 v[32:35], v2, s[4:7], s41 offen offset:0 sc1
  buffer_load_dwordx4 v[36:39], v2, s[4:7], s41 offen offset:1024 sc1
  buffer_load_dwordx4 v[40:43], v2, s[4:7], s41 offen offset:2048 sc1
  buffer_load_dwordx4 v[44:47], v2, s[4:7], s41 offen offset:3072 sc1
  s_add_u32 s41, s41, 0x10000
  buffer_load_dwordx4 v[48:51], v2, s[4:7], s41 offen offset:0 sc1
  buffer_load_dwordx4 v[52:55], v2, s[4:7], s41 offen offset:1024 sc1
  buffer_load_dwordx4 v[56:59], v2, s[4:7], s41 offen offset:2048 sc1
  buffer_load_dwordx4 v[60:63], v2, s[4:7], s41 offen offset:3072 sc1
  s_add_u32 s41, s41, 0x10000
  buffer_load_dwordx4 v[64:67], v2, s[4:7], s41 offen offset:0 sc1
  buffer_load_dwordx4 v[68:71], v2, s[4:7], s41 offen offset:1024 sc1
  buffer_load_dwordx4 v[72:75], v2, s[4:7], s41 offen offset:2048 sc1
  buffer_load_dwordx4 v[76:79], v2, s[4:7], s41 offen offset:3072 sc1
  s_add_u32 s41, s41, 0x10000
  v_mov_b32 v3, 0x0
  v_bfe_u32 v4, v1, 0, 4
  v_lshl_add_u32 v3, v4, 12, v3
  v_bfe_u32 v4, v1, 4, 2
  v_lshl_add_u32 v3, v4, 4, v3
  s_lshr_b32 s90, s32, 1
  s_lshl_b32 s90, s90, 18
  s_add_u32 s22, s22, s90
  s_and_b32 s90, s32, 1
  s_lshl_b32 s90, s90, 7
  s_add_u32 s22, s22, s90
  s_lshl_b32 s90, s48, 16
  s_add_u32 s22, s22, s90
  s_waitcnt vmcnt(8)
  v_pk_add_f32 v[16:17], v[16:17], v[32:33]
  v_pk_add_f32 v[18:19], v[18:19], v[34:35]
  v_pk_add_f32 v[20:21], v[20:21], v[36:37]
  v_pk_add_f32 v[22:23], v[22:23], v[38:39]
  v_pk_add_f32 v[24:25], v[24:25], v[40:41]
  v_pk_add_f32 v[26:27], v[26:27], v[42:43]
  v_pk_add_f32 v[28:29], v[28:29], v[44:45]
  v_pk_add_f32 v[30:31], v[30:31], v[46:47]
  s_waitcnt vmcnt(4)
  v_pk_add_f32 v[16:17], v[16:17], v[48:49]
  v_pk_add_f32 v[18:19], v[18:19], v[50:51]
  v_pk_add_f32 v[20:21], v[20:21], v[52:53]
  v_pk_add_f32 v[22:23], v[22:23], v[54:55]
  v_pk_add_f32 v[24:25], v[24:25], v[56:57]
  v_pk_add_f32 v[26:27], v[26:27], v[58:59]
  v_pk_add_f32 v[28:29], v[28:29], v[60:61]
  v_pk_add_f32 v[30:31], v[30:31], v[62:63]
  s_waitcnt vmcnt(0)
  v_pk_add_f32 v[16:17], v[16:17], v[64:65]
  v_pk_add_f32 v[18:19], v[18:19], v[66:67]
  v_pk_add_f32 v[20:21], v[20:21], v[68:69]
  v_pk_add_f32 v[22:23], v[22:23], v[70:71]
  v_pk_add_f32 v[24:25], v[24:25], v[72:73]
  v_pk_add_f32 v[26:27], v[26:27], v[74:75]
  v_pk_add_f32 v[28:29], v[28:29], v[76:77]
  v_pk_add_f32 v[30:31], v[30:31], v[78:79]
  v_cvt_pk_bf16_f32 v8, v16, v17
  v_cvt_pk_bf16_f32 v9, v18, v19
  v_cvt_pk_bf16_f32 v10, v20, v21
  v_cvt_pk_bf16_f32 v11, v22, v23
  v_cvt_pk_bf16_f32 v12, v24, v25
  v_cvt_pk_bf16_f32 v13, v26, v27
  v_cvt_pk_bf16_f32 v14, v28, v29
  v_cvt_pk_bf16_f32 v15, v30, v31
  buffer_store_dwordx4 v[8:11], v3, s[16:19], s22 offen offset:0 sc1
  buffer_store_dwordx4 v[12:15], v3, s[16:19], s22 offen offset:64 sc1
  s_branch L_got
L_done:
  s_waitcnt vmcnt(0)
  s_barrier
  s_add_u32 s38, s38, 0x3d00000
  s_cmp_lg_u32 s32, 0
  s_cbranch_scc1 L_sig_111
  v_mov_b32 v254, s98
  v_mov_b32 v255, 0
  s_mov_b64 exec, 1
  buffer_atomic_add v254, v255, s[4:7], s38 offen offset:0 sc1
  s_mov_b64 exec, -1
L_sig_111:
  s_mov_b32 s59, 0
  s_cmp_lg_u32 s35, 6
  s_cbranch_scc1 L_got
  s_add_u32 s36, s36, 2
  s_and_b32 s50, s36, 7
  s_cmp_lt_u32 s36, 62
  s_cbranch_scc1 L_ata_c
  s_branch L_got
L_exit:
  s_endpgm
.p2align 3
L_table:
.long 0x9
.long 0xa
.long 0x10009
.long 0x1000a
.long 0x20009
.long 0x2000a
.long 0x30009
.long 0x3000a
.long 0x40009
.long 0x4000a
.long 0x50009
.long 0x5000a
.long 0x60009
.long 0x6000a
.long 0x70009
.long 0x7000a
.long 0x109
.long 0x10a
.long 0x10109
.long 0x1010a
.long 0x20109
.long 0x2010a
.long 0x30109
.long 0x3010a
.long 0x40109
.long 0x4010a
.long 0x50109
.long 0x5010a
.long 0x60109
.long 0x6010a
.long 0x70109
.long 0x7010a
.long 0x209
.long 0x20a
.long 0x10209
.long 0x1020a
.long 0x20209
.long 0x2020a
.long 0x30209
.long 0x3020a
.long 0x40209
.long 0x4020a
.long 0x50209
.long 0x5020a
.long 0x60209
.long 0x6020a
.long 0x70209
.long 0x7020a
.long 0x201
.long 0x202
.long 0x10201
.long 0x10202
.long 0x20201
.long 0x20202
.long 0x30201
.long 0x30202
.long 0x301
.long 0x302
.long 0x10301
.long 0x10302
.long 0x20301
.long 0x20302
.long 0x30301
.long 0x30302
.long 0x309
.long 0x30a
.long 0x10309
.long 0x1030a
.long 0x20309
.long 0x2030a
.long 0x30309
.long 0x3030a
.long 0x40309
.long 0x4030a
.long 0x50309
.long 0x5030a
.long 0x60309
.long 0x6030a
.long 0x70309
.long 0x7030a
.long 0xc
.long 0x10c
.long 0x20c
.long 0x30c
.long 0x0
.long 0x10000
.long 0x20000
.long 0x30000
.long 0x100
.long 0x10100
.long 0x20100
.long 0x30100
.long 0x200
.long 0x10200
.long 0x20200
.long 0x30200
.long 0x401
.long 0x402
.long 0x10401
.long 0x10402
.long 0x20401
.long 0x20402
.long 0x30401
.long 0x30402
.long 0x501
.long 0x502
.long 0x10501
.long 0x10502
.long 0x20501
.long 0x20502
.long 0x30501
.long 0x30502
.long 0x300
.long 0x10300
.long 0x20300
.long 0x30300
.long 0x3
.long 0x10003
.long 0x20003
.long 0x103
.long 0x10103
.long 0x20103
.long 0x203
.long 0x10203
.long 0x20203
.long 0x303
.long 0x10303
.long 0x20303
.long 0x400
.long 0x10400
.long 0x20400
.long 0x30400
.long 0x500
.long 0x10500
.long 0x20500
.long 0x30500
.long 0x600
.long 0x10600
.long 0x20600
.long 0x30600
.long 0x700
.long 0x10700
.long 0x20700
.long 0x30700
.long 0xb
.long 0x1000b
.long 0x40b
.long 0x1040b
.long 0x80b
.long 0x1080b
.long 0xc0b
.long 0x10c0b
.long 0x403
.long 0x10403
.long 0x20403
.long 0x503
.long 0x10503
.long 0x20503
.long 0x603
.long 0x10603
.long 0x601
.long 0x602
.long 0x10601
.long 0x10602
.long 0x20601
.long 0x20602
.long 0x30601
.long 0x30602
.long 0x701
.long 0x702
.long 0x10701
.long 0x10702
.long 0x20701
.long 0x20702
.long 0x30701
.long 0x30702
.long 0x100b
.long 0x1100b
.long 0x140b
.long 0x1140b
.long 0x180b
.long 0x1180b
.long 0x1c0b
.long 0x11c0b
.long 0x20603
.long 0x703
.long 0x10703
.long 0x20703
.long 0x200b
.long 0x1200b
.long 0x240b
.long 0x1240b
.long 0x10
.long 0x10010
.long 0x210
.long 0x10210
.long 0x410
.long 0x10410
.long 0x610
.long 0x10610
.long 0x404
.long 0x10404
.long 0x20404
.long 0x30404
.long 0x304
.long 0x10304
.long 0x20304
.long 0x30304
.long 0x2806
.long 0x12806
.long 0x2906
.long 0x12906
.long 0x4
.long 0x10004
.long 0x20004
.long 0x30004
.long 0x104
.long 0x10104
.long 0x20104
.long 0x30104
.long 0x204
.long 0x10204
.long 0x20204
.long 0x30204
.long 0x11
.long 0x10011
.long 0x211
.long 0x10211
.long 0x504
.long 0x10504
.long 0x20504
.long 0x30504
.long 0x411
.long 0x10411
.long 0x611
.long 0x10611
.long 0x807
.long 0x10807
.long 0x907
.long 0x10907
.long 0xa07
.long 0x10a07
.long 0x811
.long 0x10811
.long 0xb07
.long 0x10b07
.long 0xa11
.long 0x10a11
.long 0xc07
.long 0x10c07
.long 0x604
.long 0x10604
.long 0x20604
.long 0x30604
.long 0x704
.long 0x10704
.long 0x20704
.long 0x30704
.long 0xc05
.long 0x10c05
.long 0xd05
.long 0x10d05
.long 0xe05
.long 0x10e05
.long 0xf05
.long 0x10f05
.long 0xd0e
.long 0x10d0e
.long 0x20d0e
.long 0x30d0e
.long 0x40d0e
.long 0x50d0e
.long 0x60d0e
.long 0x70d0e
.long 0x3e06
.long 0x13e06
.long 0x3f06
.long 0x13f06
.long 0xe0e
.long 0x10e0e
.long 0x20e0e
.long 0x30e0e
.long 0x40e0e
.long 0x50e0e
.long 0x60e0e
.long 0x70e0e
.long 0xf08
.long 0x10f08
.long 0x20f08
.long 0x30f08
.long 0x40f08
.long 0x50f08
.long 0x60f08
.long 0x70f08
.long 0x80f08
.long 0x90f08
.long 0xa0f08
.long 0xb0f08
.long 0xc0f08
.long 0xd0f08
.long 0xe0f08
.long 0xf0f08
.long 0xf
.long 0x0
.long 0x0
.long 0x0
.fill 206, 4, 0
.section .rodata,"a"
.p2align 6
.amdhsa_kernel concat_heads__memory_aug_recurrent_mem_tr__sliding_local_dilated__prompt_kernel
  .amdhsa_next_free_vgpr 512
  .amdhsa_next_free_sgpr 102
  .amdhsa_accum_offset 256
  .amdhsa_group_segment_fixed_size 0
  .amdhsa_kernarg_size 104
  .amdhsa_user_sgpr_count 2
  .amdhsa_user_sgpr_kernarg_segment_ptr 1
  .amdhsa_system_sgpr_workgroup_id_x 1
  .amdhsa_float_denorm_mode_32 3
  .amdhsa_float_denorm_mode_16_64 3
.end_amdhsa_kernel
```

```asm
; @launch grid=(256,1,1) block=(256,1,1) lds=149568
.amdgcn_target "amdgcn-amd-amdhsa--gfx950"
.text
.globl concat_heads__memory_aug_recurrent_mem_tr__sliding_local_dilated__prompt_kernel
.p2align 8
.type concat_heads__memory_aug_recurrent_mem_tr__sliding_local_dilated__prompt_kernel,@function
concat_heads__memory_aug_recurrent_mem_tr__sliding_local_dilated__prompt_kernel:
  s_cmp_ge_u32 s2, 256
  s_cbranch_scc1 L_exit
  s_load_dwordx4 s[92:95], s[0:1], 88
  s_load_dwordx16 s[64:79], s[0:1], 0
  s_getreg_b32 s39, hwreg(HW_REG_XCC_ID, 0, 3)
  v_lshrrev_b32 v2, 6, v0
  s_nop 0
  v_readfirstlane_b32 s32, v2
  s_mov_b32 s3, 0
  s_getpc_b64 s[86:87]
L_pc0:
  s_lshr_b32 s90, s2, 3
  s_lshl_b32 s90, s90, 2
  s_add_u32 s90, s90, s32
  s_and_b32 s90, s90, 31
  s_lshl_b32 s90, s90, 12
  v_and_b32 v1, 63, v0
  v_lshlrev_b32 v1, 6, v1
  v_add_u32 v1, s90, v1
  v_min_u32 v1, L_table-L_pc0, v1
  global_load_dword v199, v1, s[86:87]
  v_lshlrev_b32 v1, 3, v0
  v_add_u32 v1, L_table-L_pc0, v1
  global_load_dwordx2 v[248:249], v1, s[86:87]
  s_waitcnt lgkmcnt(0)
  s_mov_b32 s4, s94
  s_and_b32 s5, s95, 0xffff
  s_mov_b32 s6, 0x10000000
  s_mov_b32 s7, 0x20000
  s_mov_b32 s28, s92
  s_and_b32 s29, s93, 0xffff
  s_mov_b32 s30, 0x100
  s_mov_b32 s31, 0x20000
  s_mov_b32 s100, 0
  s_lshr_b32 s41, s2, 3
  s_lshl_b32 s101, 1, s41
  s_cmp_lg_u32 s32, 0
  s_cbranch_scc1 L_sweep
  s_lshl_b32 s90, s39, 2
  v_mov_b32 v247, s101
  v_mov_b32 v2, 0
  s_mov_b64 exec, 1
  buffer_atomic_or v247, v2, s[28:31], s90 offen offset:0 sc0 sc1
  s_mov_b64 exec, -1
L_sweep:
  s_lshl_b32 s40, s39, 5
  s_add_u32 s40, s40, s41
  s_mov_b32 s43, 1
  s_branch L_role
L_fallback:
  s_load_dwordx4 s[92:95], s[0:1], 88
  s_load_dwordx16 s[64:79], s[0:1], 0
  s_getreg_b32 s39, hwreg(HW_REG_XCC_ID, 0, 3)
  s_mov_b32 s100, 4
  v_mbcnt_lo_u32_b32 v0, -1, 0
  v_mbcnt_hi_u32_b32 v0, -1, v0
  s_lshl_b32 s90, s32, 6
  v_add_u32 v0, s90, v0
  s_waitcnt vmcnt(0) lgkmcnt(0)
  s_barrier
  s_cmp_lg_u32 s32, 0
  s_cbranch_scc1 L_tkd
  s_lshl_b32 s90, s39, 2
  v_mov_b32 v1, 1
  v_mov_b32 v2, 0
  v_lshlrev_b32 v3, 2, v0
  s_mov_b64 exec, 1
  buffer_atomic_add v1, v2, s[28:31], s90 offen offset:192 sc0 sc1
  s_mov_b64 exec, 0xff
L_tkw:
  buffer_load_dword v4, v3, s[28:31], 0 offen offset:192 sc1
  s_waitcnt vmcnt(0)
  v_readfirstlane_b32 s40, v1
  s_mov_b32 s41, 0
  s_mov_b32 s42, 0
  s_mov_b32 s43, 1
  v_readlane_b32 s44, v4, 0
  s_add_u32 s41, s41, s44
  s_cmp_gt_u32 s39, 0
  s_cselect_b32 s45, s44, 0
  s_add_u32 s42, s42, s45
  s_cmp_eq_u32 s44, 32
  s_cselect_b32 s43, s43, 0
  v_readlane_b32 s44, v4, 1
  s_add_u32 s41, s41, s44
  s_cmp_gt_u32 s39, 1
  s_cselect_b32 s45, s44, 0
  s_add_u32 s42, s42, s45
  s_cmp_eq_u32 s44, 32
  s_cselect_b32 s43, s43, 0
  v_readlane_b32 s44, v4, 2
  s_add_u32 s41, s41, s44
  s_cmp_gt_u32 s39, 2
  s_cselect_b32 s45, s44, 0
  s_add_u32 s42, s42, s45
  s_cmp_eq_u32 s44, 32
  s_cselect_b32 s43, s43, 0
  v_readlane_b32 s44, v4, 3
  s_add_u32 s41, s41, s44
  s_cmp_gt_u32 s39, 3
  s_cselect_b32 s45, s44, 0
  s_add_u32 s42, s42, s45
  s_cmp_eq_u32 s44, 32
  s_cselect_b32 s43, s43, 0
  v_readlane_b32 s44, v4, 4
  s_add_u32 s41, s41, s44
  s_cmp_gt_u32 s39, 4
  s_cselect_b32 s45, s44, 0
  s_add_u32 s42, s42, s45
  v_readlane_b32 s44, v4, 5
  s_add_u32 s41, s41, s44
  s_cmp_gt_u32 s39, 5
  s_cselect_b32 s45, s44, 0
  s_add_u32 s42, s42, s45
  v_readlane_b32 s44, v4, 6
  s_add_u32 s41, s41, s44
  s_cmp_gt_u32 s39, 6
  s_cselect_b32 s45, s44, 0
  s_add_u32 s42, s42, s45
  v_readlane_b32 s44, v4, 7
  s_add_u32 s41, s41, s44
  s_cmp_gt_u32 s39, 7
  s_cselect_b32 s45, s44, 0
  s_add_u32 s42, s42, s45
  s_add_u32 s3, s3, 1
  s_cmp_ge_u32 s3, 131072
  s_cbranch_scc1 L_tkbad
  s_sleep 4
  s_cmp_lt_u32 s41, 256
  s_cbranch_scc1 L_tkw
  s_add_u32 s40, s40, s42
  s_lshl_b32 s43, s43, 16
  s_or_b32 s40, s40, s43
  s_branch L_tkok
L_tkbad:
  s_mov_b32 s40, 0xffff
L_tkok:
  s_mov_b64 exec, -1
  v_mov_b32 v1, s40
  v_mov_b32 v2, 147456
  ds_write_b32 v2, v1
  s_waitcnt lgkmcnt(0)
L_tkd:
  s_barrier
  v_mov_b32 v2, 147456
  ds_read_b32 v1, v2
  s_waitcnt lgkmcnt(0)
  v_readfirstlane_b32 s40, v1
  s_barrier
  s_lshr_b32 s43, s40, 16
  s_and_b32 s40, s40, 0xffff
  s_cmp_ge_u32 s40, 256
  s_cbranch_scc1 L_exit
L_role:
  s_cmp_ge_u32 s40, 128
  s_cbranch_scc1 L_worker
  s_lshr_b32 s33, s40, 5
  s_and_b32 s34, s40, 31
  s_cmp_eq_u32 s43, 0
  s_cbranch_scc1 L_recslow
  s_load_dwordx4 s[80:83], s[0:1], 8
  s_load_dwordx4 s[84:87], s[0:1], 24
  s_load_dwordx2 s[88:89], s[0:1], 40
  v_lshrrev_b32 v31, 6, v0
  s_nop 0
  v_readfirstlane_b32 s32, v31
  v_and_b32 v0, 63, v0
  s_lshr_b32 s35, s34, 4
  s_lshl_b32 s90, s33, 1
  s_add_u32 s35, s35, s90
  s_and_b32 s36, s34, 15
  s_lshr_b32 s37, s36, 2
  s_lshl_b32 s90, s35, 2
  s_add_u32 s37, s37, s90
  s_and_b32 s38, s36, 3
  s_waitcnt lgkmcnt(0)
  s_mov_b32 s24, s80
  s_and_b32 s25, s81, 0xffff
  s_mov_b32 s26, 0x4000
  s_mov_b32 s27, 0x20000
  s_mov_b32 s8, s82
  s_and_b32 s9, s83, 0xffff
  s_mov_b32 s10, 0x800000
  s_mov_b32 s11, 0x20000
  s_mov_b32 s12, s84
  s_and_b32 s13, s85, 0xffff
  s_mov_b32 s14, 0x800000
  s_mov_b32 s15, 0x20000
  s_mov_b32 s16, s86
  s_and_b32 s17, s87, 0xffff
  s_mov_b32 s18, 0x800000
  s_mov_b32 s19, 0x20000
  s_mov_b32 s20, s88
  s_and_b32 s21, s89, 0xffff
  s_mov_b32 s22, 0x800000
  s_mov_b32 s23, 0x20000
  s_lshl_b32 s90, s32, 21
  s_lshl_b32 s91, s37, 8
  s_add_u32 s90, s90, s91
  s_lshr_b32 s91, s38, 1
  s_lshl_b32 s91, s91, 7
  s_add_u32 s90, s90, s91
  v_mov_b32 v180, 0x0
  v_bfe_u32 v31, v0, 3, 3
  v_lshl_add_u32 v180, v31, 13, v180
  v_bfe_u32 v31, v0, 0, 3
  v_lshl_add_u32 v180, v31, 4, v180
  v_add_u32 v180, s90, v180
  v_xor_b32 v185, 128, v180
  s_lshl_b32 s90, s35, 2
  s_add_u32 s90, s90, s32
  s_lshl_b32 s90, s90, 18
  s_lshl_b32 s91, s36, 7
  s_add_u32 s90, s90, s91
  v_mov_b32 v181, 0x0
  v_bfe_u32 v31, v0, 3, 3
  v_lshl_add_u32 v181, v31, 11, v181
  v_bfe_u32 v31, v0, 0, 3
  v_lshl_add_u32 v181, v31, 4, v181
  v_add_u32 v181, s90, v181
  s_lshl_b32 s96, s32, 15
  s_and_b32 s91, s38, 1
  s_lshl_b32 s91, s91, 6
  s_add_u32 s91, s91, s96
  v_mov_b32 v182, 0x0
  v_bfe_u32 v31, v0, 5, 1
  v_lshl_add_u32 v182, v31, 11, v182
  v_bfe_u32 v31, v0, 4, 1
  v_lshl_add_u32 v182, v31, 10, v182
  v_bfe_u32 v31, v0, 2, 2
  v_lshl_add_u32 v182, v31, 7, v182
  v_bfe_u32 v31, v0, 0, 2
  v_lshl_add_u32 v182, v31, 3, v182
  v_add_u32 v182, s91, v182
  s_lshl_b32 s91, s32, 5
  v_mov_b32 v183, 0x0
  v_bfe_u32 v31, v0, 4, 1
  v_lshl_add_u32 v183, v31, 13, v183
  v_bfe_u32 v31, v0, 5, 1
  v_lshl_add_u32 v183, v31, 8, v183
  v_bfe_u32 v31, v0, 2, 1
  v_lshl_add_u32 v183, v31, 10, v183
  v_bfe_u32 v31, v0, 3, 1
  v_lshl_add_u32 v183, v31, 7, v183
  v_bfe_u32 v31, v0, 0, 2
  v_lshl_add_u32 v183, v31, 3, v183
  v_add_u32 v183, s91, v183
  v_add_u32 v184, 0x10000, v183
  s_lshl_b32 s97, s34, 2
  s_add_u32 s97, s97, s32
  s_lshl_b32 s98, s97, 14
  s_lshl_b32 s91, s33, 21
  s_add_u32 s98, s98, s91
  s_lshl_b32 s97, s97, 16
  s_lshl_b32 s91, s33, 11
  s_add_u32 s97, s97, s91
  v_mov_b32 v16, 0x0
  v_bfe_u32 v31, v0, 0, 4
  v_lshl_add_u32 v16, v31, 7, v16
  v_bfe_u32 v31, v0, 4, 2
  v_lshl_add_u32 v16, v31, 13, v16
  v_add_u32 v17, 0x8000, v16
  v_lshlrev_b32 v18, 7, v0
  v_add_u32 v19, 0x2000, v18
  s_lshl_b32 s97, s34, 2
  s_add_u32 s97, s97, s32
  s_lshl_b32 s98, s97, 14
  s_lshl_b32 s91, s33, 21
  s_add_u32 s98, s98, s91
  s_lshl_b32 s97, s97, 16
  s_lshl_b32 s91, s33, 11
  s_add_u32 s97, s97, s91
  v_mov_b32 v16, 0x180
  v_bfe_u32 v31, v0, 0, 1
  v_lshl_add_u32 v16, v31, 10, v16
  v_bfe_u32 v31, v0, 1, 3
  v_lshl_add_u32 v16, v31, 13, v16
  v_mov_b32 v17, 0x180
  v_bfe_u32 v31, v0, 0, 4
  v_lshl_add_u32 v17, v31, 10, v17
  s_mov_b64 exec, 0xffff
  buffer_load_dword v201, v16, s[12:15], s97 offen
  buffer_load_dword v202, v16, s[16:19], s97 offen
  buffer_load_dword v200, v16, s[8:11], s97 offen
  buffer_load_dword v203, v17, s[20:23], s98 offen
  s_mov_b64 exec, -1
  s_lshl_b32 s58, s33, 5
  s_add_u32 s58, s58, s34
  s_lshl_b32 s59, s32, 19
  s_add_u32 s59, s59, 0x3800000
  s_lshl_b32 s90, s58, 11
  s_add_u32 s90, s90, s59
  s_mul_i32 s91, s58, 3072
  s_add_u32 s91, s91, s59
  s_add_u32 s91, s91, 0x200000
  v_lshlrev_b32 v6, 4, v0
  v_mov_b32 v8, -1
  v_mov_b32 v12, 0
  v_mov_b32 v9, -1
  v_mov_b32 v13, 0
  v_mov_b32 v10, -1
  v_mov_b32 v14, 0
  v_mov_b32 v11, -1
  v_mov_b32 v15, 0
  buffer_store_dwordx4 v[8:11], v6, s[4:7], s90 offen offset:0 sc1
  buffer_store_dwordx4 v[8:11], v6, s[4:7], s90 offen offset:1024 sc1
  buffer_store_dwordx4 v[8:11], v6, s[4:7], s91 offen offset:0 sc1
  buffer_store_dwordx4 v[8:11], v6, s[4:7], s91 offen offset:1024 sc1
  buffer_store_dwordx4 v[8:11], v6, s[4:7], s91 offen offset:2048 sc1
  s_lshl_b32 s58, s58, 2
  s_add_u32 s58, s58, s32
  s_cmp_ge_u32 s58, 36
  s_cbranch_scc1 FL_nz_1
  s_lshl_b32 s90, s58, 10
  s_add_u32 s90, s90, 0x3d00000
  buffer_store_dwordx4 v[12:15], v6, s[4:7], s90 offen sc1
FL_nz_1:
  s_cmp_lg_u32 s58, 3
  s_cbranch_scc1 FL_np_2
  v_mov_b32 v6, 0x3840000
  v_bfe_u32 v31, v0, 0, 1
  v_lshl_add_u32 v6, v31, 13, v6
  v_bfe_u32 v31, v0, 1, 1
  s_mov_b32 s99, 4352
  v_mad_u32_u24 v6, v31, s99, v6
  v_bfe_u32 v31, v0, 2, 2
  s_mov_b32 s99, 82432
  v_mad_u32_u24 v6, v31, s99, v6
  v_mov_b32 v7, -1
  s_mov_b64 exec, 0xffff
  buffer_store_dword v7, v6, s[4:7], 0 offen sc1
  s_mov_b64 exec, -1
  s_waitcnt vmcnt(0)
FL_np_2:
  s_add_u32 m0, s96, 0
  s_mov_b32 s90, 0x0
  buffer_load_dwordx4 v180, s[12:15], s90 offen  lds
  s_add_u32 m0, s96, 1024
  s_mov_b32 s90, 0x10000
  buffer_load_dwordx4 v180, s[12:15], s90 offen  lds
  s_add_u32 m0, s96, 2048
  s_mov_b32 s90, 0x20000
  buffer_load_dwordx4 v180, s[12:15], s90 offen  lds
  s_add_u32 m0, s96, 3072
  s_mov_b32 s90, 0x30000
  buffer_load_dwordx4 v180, s[12:15], s90 offen  lds
  s_add_u32 m0, s96, 4096
  s_mov_b32 s90, 0x0
  buffer_load_dwordx4 v185, s[16:19], s90 offen  lds
  s_add_u32 m0, s96, 5120
  s_mov_b32 s90, 0x10000
  buffer_load_dwordx4 v185, s[16:19], s90 offen  lds
  s_add_u32 m0, s96, 6144
  s_mov_b32 s90, 0x20000
  buffer_load_dwordx4 v185, s[16:19], s90 offen  lds
  s_add_u32 m0, s96, 7168
  s_mov_b32 s90, 0x30000
  buffer_load_dwordx4 v185, s[16:19], s90 offen  lds
  s_add_u32 m0, s96, 8192
  s_mov_b32 s90, 0x40000
  buffer_load_dwordx4 v180, s[12:15], s90 offen  lds
  s_add_u32 m0, s96, 9216
  s_mov_b32 s90, 0x50000
  buffer_load_dwordx4 v180, s[12:15], s90 offen  lds
  s_add_u32 m0, s96, 10240
  s_mov_b32 s90, 0x60000
  buffer_load_dwordx4 v180, s[12:15], s90 offen  lds
  s_add_u32 m0, s96, 11264
  s_mov_b32 s90, 0x70000
  buffer_load_dwordx4 v180, s[12:15], s90 offen  lds
  s_add_u32 m0, s96, 12288
  s_mov_b32 s90, 0x40000
  buffer_load_dwordx4 v185, s[16:19], s90 offen  lds
  s_add_u32 m0, s96, 13312
  s_mov_b32 s90, 0x50000
  buffer_load_dwordx4 v185, s[16:19], s90 offen  lds
  s_add_u32 m0, s96, 14336
  s_mov_b32 s90, 0x60000
  buffer_load_dwordx4 v185, s[16:19], s90 offen  lds
  s_add_u32 m0, s96, 15360
  s_mov_b32 s90, 0x70000
  buffer_load_dwordx4 v185, s[16:19], s90 offen  lds
  s_add_u32 m0, s96, 16384
  s_mov_b32 s90, 0x80000
  buffer_load_dwordx4 v180, s[12:15], s90 offen  lds
  s_add_u32 m0, s96, 17408
  s_mov_b32 s90, 0x90000
  buffer_load_dwordx4 v180, s[12:15], s90 offen  lds
  s_add_u32 m0, s96, 18432
  s_mov_b32 s90, 0xa0000
  buffer_load_dwordx4 v180, s[12:15], s90 offen  lds
  s_add_u32 m0, s96, 19456
  s_mov_b32 s90, 0xb0000
  buffer_load_dwordx4 v180, s[12:15], s90 offen  lds
  s_add_u32 m0, s96, 20480
  s_mov_b32 s90, 0x80000
  buffer_load_dwordx4 v185, s[16:19], s90 offen  lds
  s_add_u32 m0, s96, 21504
  s_mov_b32 s90, 0x90000
  buffer_load_dwordx4 v185, s[16:19], s90 offen  lds
  s_add_u32 m0, s96, 22528
  s_mov_b32 s90, 0xa0000
  buffer_load_dwordx4 v185, s[16:19], s90 offen  lds
  s_add_u32 m0, s96, 23552
  s_mov_b32 s90, 0xb0000
  buffer_load_dwordx4 v185, s[16:19], s90 offen  lds
  s_add_u32 m0, s96, 24576
  s_mov_b32 s90, 0xc0000
  buffer_load_dwordx4 v180, s[12:15], s90 offen  lds
  s_add_u32 m0, s96, 25600
  s_mov_b32 s90, 0xd0000
  buffer_load_dwordx4 v180, s[12:15], s90 offen  lds
  s_add_u32 m0, s96, 26624
  s_mov_b32 s90, 0xe0000
  buffer_load_dwordx4 v180, s[12:15], s90 offen  lds
  s_add_u32 m0, s96, 27648
  s_mov_b32 s90, 0xf0000
  buffer_load_dwordx4 v180, s[12:15], s90 offen  lds
  s_add_u32 m0, s96, 28672
  s_mov_b32 s90, 0xc0000
  buffer_load_dwordx4 v185, s[16:19], s90 offen  lds
  s_add_u32 m0, s96, 29696
  s_mov_b32 s90, 0xd0000
  buffer_load_dwordx4 v185, s[16:19], s90 offen  lds
  s_add_u32 m0, s96, 30720
  s_mov_b32 s90, 0xe0000
  buffer_load_dwordx4 v185, s[16:19], s90 offen  lds
  s_add_u32 m0, s96, 31744
  s_mov_b32 s90, 0xf0000
  buffer_load_dwordx4 v185, s[16:19], s90 offen  lds
  s_cmp_lg_u32 s58, 3
  s_cbranch_scc1 FL_np_3
  s_add_u32 s92, s94, 0x3840000
  s_addc_u32 s93, s95, 0
  s_mov_b32 s62, -1
  s_mov_b32 s63, -1
  s_memtime s[56:57]
  s_waitcnt lgkmcnt(0)
  s_load_dword s60, s[92:93], 0x0
  s_waitcnt lgkmcnt(0)
  s_memtime s[58:59]
  s_waitcnt lgkmcnt(0)
  s_sub_u32 s58, s58, s56
  s_min_u32 s62, s62, s58
  s_memtime s[56:57]
  s_waitcnt lgkmcnt(0)
  s_load_dword s60, s[92:93], 0x2000
  s_waitcnt lgkmcnt(0)
  s_memtime s[58:59]
  s_waitcnt lgkmcnt(0)
  s_sub_u32 s58, s58, s56
  s_min_u32 s63, s63, s58
  s_memtime s[56:57]
  s_waitcnt lgkmcnt(0)
  s_load_dword s60, s[92:93], 0x1100
  s_waitcnt lgkmcnt(0)
  s_memtime s[58:59]
  s_waitcnt lgkmcnt(0)
  s_sub_u32 s58, s58, s56
  s_min_u32 s62, s62, s58
  s_memtime s[56:57]
  s_waitcnt lgkmcnt(0)
  s_load_dword s60, s[92:93], 0x3100
  s_waitcnt lgkmcnt(0)
  s_memtime s[58:59]
  s_waitcnt lgkmcnt(0)
  s_sub_u32 s58, s58, s56
  s_min_u32 s63, s63, s58
  s_memtime s[56:57]
  s_waitcnt lgkmcnt(0)
  s_load_dword s60, s[92:93], 0x14200
  s_waitcnt lgkmcnt(0)
  s_memtime s[58:59]
  s_waitcnt lgkmcnt(0)
  s_sub_u32 s58, s58, s56
  s_min_u32 s62, s62, s58
  s_memtime s[56:57]
  s_waitcnt lgkmcnt(0)
  s_load_dword s60, s[92:93], 0x16200
  s_waitcnt lgkmcnt(0)
  s_memtime s[58:59]
  s_waitcnt lgkmcnt(0)
  s_sub_u32 s58, s58, s56
  s_min_u32 s63, s63, s58
  s_memtime s[56:57]
  s_waitcnt lgkmcnt(0)
  s_load_dword s60, s[92:93], 0x15300
  s_waitcnt lgkmcnt(0)
  s_memtime s[58:59]
  s_waitcnt lgkmcnt(0)
  s_sub_u32 s58, s58, s56
  s_min_u32 s62, s62, s58
  s_memtime s[56:57]
  s_waitcnt lgkmcnt(0)
  s_load_dword s60, s[92:93], 0x17300
  s_waitcnt lgkmcnt(0)
  s_memtime s[58:59]
  s_waitcnt lgkmcnt(0)
  s_sub_u32 s58, s58, s56
  s_min_u32 s63, s63, s58
  s_cmp_lt_u32 s63, s62
  s_cselect_b32 s60, 2, 1
  v_mov_b32 v6, s60
  v_mov_b32 v7, s62
  v_mov_b32 v8, s63
  v_mov_b32 v9, 0
  s_mov_b64 exec, 1
  buffer_store_dword v6, v9, s[28:31], 0 offen offset:128 sc1
  s_mov_b64 exec, -1
FL_np_3:
  s_lshl_b32 s90, s34, 2
  s_add_u32 s90, s90, s32
  s_lshr_b32 s91, s90, 3
  s_lshl_b32 s91, s91, 14
  s_and_b32 s92, s90, 7
  s_lshl_b32 s92, s92, 10
  s_add_u32 s91, s91, s92
  v_mov_b32 v1, 0x0
  v_bfe_u32 v31, v0, 0, 6
  v_lshl_add_u32 v1, v31, 4, v1
  v_add_u32 v1, s91, v1
  v_lshrrev_b32 v30, 4, v0
  v_cmp_eq_u32 vcc, s33, v30
  v_xor_b32 v29, 0x2000, v1
  s_nop 0
  v_cndmask_b32 v1, v1, v29, vcc
  s_lshl_b32 s91, s33, 14
  s_lshl_b32 s92, s90, 7
  s_add_u32 s91, s91, s92
  v_mov_b32 v2, 0x200000
  v_bfe_u32 v31, v0, 0, 2
  v_lshl_add_u32 v2, v31, 2, v2
  v_bfe_u32 v31, v0, 2, 1
  v_lshl_add_u32 v2, v31, 6, v2
  v_bfe_u32 v31, v0, 4, 1
  v_lshl_add_u32 v2, v31, 4, v2
  v_bfe_u32 v31, v0, 5, 1
  v_lshl_add_u32 v2, v31, 5, v2
  v_bfe_u32 v31, v0, 3, 1
  v_lshl_add_u32 v2, v31, 31, v2
  v_add_u32 v2, s91, v2
  s_lshr_b32 s92, s90, 1
  s_lshl_b32 s92, s92, 5
  s_and_b32 s91, s90, 1
  s_lshl_b32 s91, s91, 13
  s_add_u32 s92, s92, s91
  v_mov_b32 v30, 0x0
  v_bfe_u32 v31, v0, 2, 1
  v_lshl_add_u32 v30, v31, 12, v30
  v_bfe_u32 v31, v0, 4, 1
  v_lshl_add_u32 v30, v31, 11, v30
  v_bfe_u32 v31, v0, 0, 2
  v_lshl_add_u32 v30, v31, 3, v30
  v_bfe_u32 v31, v0, 5, 1
  v_lshl_add_u32 v30, v31, 2, v30
  v_add_u32 v30, s92, v30
  buffer_load_dword v44, v30, s[24:27], 0 offen
  s_lshl_b32 s91, s33, 14
  s_lshl_b32 s92, s32, 12
  s_add_u32 s91, s91, s92
  v_mov_b32 v3, 0x200000
  v_bfe_u32 v31, v0, 0, 6
  v_lshl_add_u32 v3, v31, 4, v3
  v_add_u32 v3, s91, v3
  s_mul_i32 s91, s32, 3264
  v_mov_b32 v4, 0x0
  v_bfe_u32 v31, v0, 0, 6
  v_lshl_add_u32 v4, v31, 4, v4
  v_add_u32 v4, s91, v4
  s_lshl_b32 s91, s32, 6
  v_mov_b32 v6, 0x0
  v_bfe_u32 v31, v0, 0, 2
  v_lshl_add_u32 v6, v31, 4, v6
  v_bfe_u32 v31, v0, 2, 1
  v_lshl_add_u32 v6, v31, 2, v6
  v_bfe_u32 v31, v0, 3, 1
  s_mov_b32 s99, 1088
  v_mad_u32_u24 v6, v31, s99, v6
  v_bfe_u32 v31, v0, 4, 2
  v_lshl_add_u32 v6, v31, 8, v6
  v_add_u32 v6, s91, v6
  v_add_u32 v240, 3264, v6
  v_add_u32 v241, 6528, v6
  v_add_u32 v242, 9792, v6
  s_lshl_b32 s93, s37, 13
  s_lshl_b32 s91, s38, 10
  s_add_u32 s91, s91, s93
  s_lshl_b32 s92, s32, 8
  s_add_u32 s91, s91, s92
  v_mov_b32 v7, 0x210000
  v_bfe_u32 v31, v0, 0, 6
  v_lshl_add_u32 v7, v31, 2, v7
  v_add_u32 v7, s91, v7
  s_lshl_b32 s91, s37, 11
  s_lshl_b32 s92, s38, 9
  s_add_u32 s59, s91, s92
  s_lshl_b32 s92, s32, 7
  s_add_u32 s91, s59, s92
  v_mov_b32 v19, 0x83000000
  v_bfe_u32 v31, v0, 0, 3
  v_lshl_add_u32 v19, v31, 2, v19
  v_bfe_u32 v31, v0, 4, 2
  v_lshl_add_u32 v19, v31, 5, v19
  v_bfe_u32 v31, v0, 3, 1
  v_lshl_add_u32 v19, v31, 31, v19
  v_add_u32 v19, s91, v19
  s_lshl_b32 s91, s32, 8
  v_mov_b32 v5, 0x880
  v_bfe_u32 v31, v0, 0, 1
  v_lshl_add_u32 v5, v31, 7, v5
  v_bfe_u32 v31, v0, 1, 1
  v_lshl_add_u32 v5, v31, 3, v5
  v_bfe_u32 v31, v0, 2, 3
  v_lshl_add_u32 v5, v31, 4, v5
  v_add_u32 v5, s91, v5
  s_lshr_b32 s92, s38, 1
  s_xor_b32 s92, s92, 1
  s_lshl_b32 s92, s92, 10
  s_add_u32 s91, s91, s92
  s_add_u32 s91, s91, s93
  s_and_b32 s92, s38, 1
  s_lshl_b32 s92, s92, 7
  s_add_u32 s91, s91, s92
  v_mov_b32 v8, 0x211000
  v_bfe_u32 v31, v0, 0, 5
  v_lshl_add_u32 v8, v31, 2, v8
  v_bfe_u32 v31, v0, 5, 1
  v_lshl_add_u32 v8, v31, 31, v8
  v_add_u32 v8, s91, v8
  s_sub_u32 s91, s91, s93
  s_lshl_b32 s92, s37, 11
  s_add_u32 s91, s91, s92
  v_mov_b32 v20, 0x3400000
  v_bfe_u32 v31, v0, 0, 5
  v_lshl_add_u32 v20, v31, 2, v20
  v_bfe_u32 v31, v0, 5, 1
  v_lshl_add_u32 v20, v31, 31, v20
  v_add_u32 v20, s91, v20
  s_lshl_b32 s97, s35, 2
  s_add_u32 s97, s97, s32
  s_lshl_b32 s97, s97, 13
  v_mov_b32 v9, 0x210000
  v_bfe_u32 v31, v0, 0, 6
  v_lshl_add_u32 v9, v31, 4, v9
  v_add_u32 v9, s97, v9
  v_add_u32 v10, 4096, v9
  v_mov_b32 v11, 0x1000000
  v_bfe_u32 v31, v0, 0, 2
  v_lshl_add_u32 v11, v31, 4, v11
  v_bfe_u32 v31, v0, 2, 1
  v_lshl_add_u32 v11, v31, 7, v11
  v_bfe_u32 v31, v0, 3, 1
  v_lshl_add_u32 v11, v31, 12, v11
  v_bfe_u32 v31, v0, 4, 2
  v_lshl_add_u32 v11, v31, 8, v11
  v_add_u32 v11, s97, v11
  v_mov_b32 v12, 0x2000000
  v_bfe_u32 v31, v0, 0, 3
  v_lshl_add_u32 v12, v31, 4, v12
  v_bfe_u32 v31, v0, 3, 1
  v_lshl_add_u32 v12, v31, 11, v12
  v_bfe_u32 v31, v0, 4, 2
  v_lshl_add_u32 v12, v31, 8, v12
  v_add_u32 v12, s97, v12
  v_add_u32 v13, 4096, v12
  s_lshl_b32 s91, s36, 9
  s_add_u32 s91, s91, s97
  s_add_u32 s63, s91, 0x1000000
  v_mov_b32 v21, 0x1000000
  v_bfe_u32 v31, v0, 0, 2
  v_lshl_add_u32 v21, v31, 7, v21
  v_bfe_u32 v31, v0, 2, 1
  v_lshl_add_u32 v21, v31, 24, v21
  v_add_u32 v21, s91, v21
  v_cmp_gt_u32 vcc, 8, v0
  v_mov_b32 v30, 0x80000000
  s_nop 0
  v_cndmask_b32 v21, v30, v21, vcc
  s_lshl_b32 s91, s32, 11
  v_mov_b32 v30, 0x0
  v_bfe_u32 v31, v0, 2, 1
  v_lshl_add_u32 v30, v31, 6, v30
  v_bfe_u32 v31, v0, 0, 1
  v_lshl_add_u32 v30, v31, 5, v30
  v_bfe_u32 v31, v0, 1, 1
  v_lshl_add_u32 v30, v31, 4, v30
  v_mov_b32 v29, 0x0
  v_bfe_u32 v31, v0, 4, 2
  v_lshl_add_u32 v29, v31, 5, v29
  v_xor_b32 v30, v30, v29
  v_mov_b32 v14, 0x3400
  v_bfe_u32 v31, v0, 0, 4
  v_lshl_add_u32 v14, v31, 7, v14
  v_add_u32 v14, s91, v14
  v_add_u32 v14, v14, v30
  v_xor_b32 v15, 16, v14
  v_mov_b32 v30, 0x0
  v_bfe_u32 v31, v0, 5, 1
  v_lshl_add_u32 v30, v31, 6, v30
  v_bfe_u32 v31, v0, 1, 1
  v_lshl_add_u32 v30, v31, 5, v30
  v_bfe_u32 v31, v0, 4, 1
  v_lshl_add_u32 v30, v31, 4, v30
  v_mov_b32 v29, 0x0
  v_bfe_u32 v31, v0, 2, 2
  v_lshl_add_u32 v29, v31, 5, v29
  v_bfe_u32 v31, v0, 0, 1
  v_lshl_add_u32 v29, v31, 4, v29
  v_xor_b32 v30, v30, v29
  v_mov_b32 v16, 0x3400
  v_bfe_u32 v31, v0, 4, 2
  v_lshl_add_u32 v16, v31, 8, v16
  v_bfe_u32 v31, v0, 1, 1
  v_lshl_add_u32 v16, v31, 7, v16
  v_add_u32 v16, v16, v30
  s_lshl_b32 s98, s36, 14
  s_lshl_b32 s92, s35, 7
  s_add_u32 s98, s98, s92
  s_lshl_b32 s92, s32, 11
  s_add_u32 s91, s98, s92
  v_mov_b32 v17, 0x0
  v_bfe_u32 v31, v0, 0, 5
  v_lshl_add_u32 v17, v31, 2, v17
  v_bfe_u32 v31, v0, 5, 1
  v_lshl_add_u32 v17, v31, 10, v17
  v_add_u32 v17, s91, v17
  v_xor_b32 v18, 0x2000, v17
  s_mov_b32 s48, 0x33333333
  s_mov_b32 s49, 0x33333333
  s_mov_b32 s50, 0xffff0000
  s_mov_b32 s51, 0xffff0000
  s_mov_b32 s52, 0x0000ffff
  s_mov_b32 s53, 0x0000ffff
  s_mov_b32 s54, 0xfffffffe
  s_mov_b32 s47, 0x3e0293ee
  v_mov_b32 v30, 0x4444
  v_mov_b32 v31, 0xeeee
  v_cndmask_b32 v23, v31, v30, s[48:49]
  v_mov_b32 v22, -1
  v_mov_b32 v232, 0
  v_mov_b32 v233, 0
  v_mov_b32 v234, 0
  v_mov_b32 v235, 0
  v_mov_b32 v112, 0
  v_mov_b32 v113, 0
  s_mov_b32 s56, 0xf0f0f0f0
  s_mov_b32 s57, 0xf0f0f0f0
  v_mov_b32 v30, 0x3f80
  v_mov_b32 v31, 1.0
  v_cndmask_b32 v30, v30, v31, s[56:57]
  s_mov_b32 s56, 0x110011
  s_mov_b32 s57, 0x110011
  v_cndmask_b32 v24, 0, v30, s[56:57]
  s_mov_b32 s56, 0x220022
  s_mov_b32 s57, 0x220022
  v_cndmask_b32 v25, 0, v30, s[56:57]
  s_mov_b32 s56, 0x11001100
  s_mov_b32 s57, 0x11001100
  v_cndmask_b32 v26, 0, v30, s[56:57]
  s_mov_b32 s56, 0x22002200
  s_mov_b32 s57, 0x22002200
  v_cndmask_b32 v27, 0, v30, s[56:57]
  s_mov_b32 s40, 0
  s_mov_b32 s41, 0x3800000
  s_mov_b32 s43, 0x3900000
  s_mov_b32 s44, 0
  s_mov_b32 s55, 0x40000
  s_mov_b32 s45, 0
  s_waitcnt vmcnt(33)
  s_barrier
  s_cmp_lg_u32 s32, 0
  s_cbranch_scc1 FL_sig_4
  v_mov_b32 v254, 1
  v_mov_b32 v255, 0
  s_mov_b64 exec, 1
  buffer_atomic_add v254, v255, s[28:31], s100 offen offset:132 sc1
  s_mov_b64 exec, -1
FL_sig_4:
  s_mov_b32 s90, 0x3e0000
  buffer_store_dword v22, v19, s[4:7], s90 offen sc1
  buffer_store_dword v22, v20, s[4:7], s90 offen sc1
  s_mov_b32 s90, 0x3f0000
  buffer_store_dword v22, v19, s[4:7], s90 offen sc1
  buffer_store_dword v22, v20, s[4:7], s90 offen sc1
  s_waitcnt vmcnt(28)
  ds_read_b64_tr_b16 a[16:17], v182 offset:0
  ds_read_b64_tr_b16 a[18:19], v182 offset:512
  ds_read_b64_tr_b16 a[24:25], v182 offset:32
  ds_read_b64_tr_b16 a[26:27], v182 offset:544
  s_waitcnt lgkmcnt(0)
  s_add_u32 m0, s96, 0
  s_mov_b32 s90, 0x100000
  buffer_load_dwordx4 v180, s[12:15], s90 offen  lds
  s_add_u32 m0, s96, 1024
  s_mov_b32 s90, 0x110000
  buffer_load_dwordx4 v180, s[12:15], s90 offen  lds
  s_add_u32 m0, s96, 2048
  s_mov_b32 s90, 0x120000
  buffer_load_dwordx4 v180, s[12:15], s90 offen  lds
  s_add_u32 m0, s96, 3072
  s_mov_b32 s90, 0x130000
  buffer_load_dwordx4 v180, s[12:15], s90 offen  lds
  s_waitcnt vmcnt(28)
  ds_read_b64_tr_b16 a[32:33], v182 offset:4096
  ds_read_b64_tr_b16 a[34:35], v182 offset:4608
  ds_read_b64_tr_b16 a[40:41], v182 offset:4128
  ds_read_b64_tr_b16 a[42:43], v182 offset:4640
  s_waitcnt lgkmcnt(0)
  s_add_u32 m0, s96, 4096
  s_mov_b32 s90, 0x100000
  buffer_load_dwordx4 v185, s[16:19], s90 offen  lds
  s_add_u32 m0, s96, 5120
  s_mov_b32 s90, 0x110000
  buffer_load_dwordx4 v185, s[16:19], s90 offen  lds
  s_add_u32 m0, s96, 6144
  s_mov_b32 s90, 0x120000
  buffer_load_dwordx4 v185, s[16:19], s90 offen  lds
  s_add_u32 m0, s96, 7168
  s_mov_b32 s90, 0x130000
  buffer_load_dwordx4 v185, s[16:19], s90 offen  lds
  s_waitcnt vmcnt(28)
  ds_read_b64_tr_b16 a[20:21], v182 offset:8192
  ds_read_b64_tr_b16 a[22:23], v182 offset:8704
  ds_read_b64_tr_b16 a[28:29], v182 offset:8224
  ds_read_b64_tr_b16 a[30:31], v182 offset:8736
  s_waitcnt lgkmcnt(0)
  s_add_u32 m0, s96, 8192
  s_mov_b32 s90, 0x140000
  buffer_load_dwordx4 v180, s[12:15], s90 offen  lds
  s_add_u32 m0, s96, 9216
  s_mov_b32 s90, 0x150000
  buffer_load_dwordx4 v180, s[12:15], s90 offen  lds
  s_add_u32 m0, s96, 10240
  s_mov_b32 s90, 0x160000
  buffer_load_dwordx4 v180, s[12:15], s90 offen  lds
  s_add_u32 m0, s96, 11264
  s_mov_b32 s90, 0x170000
  buffer_load_dwordx4 v180, s[12:15], s90 offen  lds
  s_waitcnt vmcnt(28)
  ds_read_b64_tr_b16 a[36:37], v182 offset:12288
  ds_read_b64_tr_b16 a[38:39], v182 offset:12800
  ds_read_b64_tr_b16 a[44:45], v182 offset:12320
  ds_read_b64_tr_b16 a[46:47], v182 offset:12832
  s_waitcnt lgkmcnt(0)
  s_add_u32 m0, s96, 12288
  s_mov_b32 s90, 0x140000
  buffer_load_dwordx4 v185, s[16:19], s90 offen  lds
  s_add_u32 m0, s96, 13312
  s_mov_b32 s90, 0x150000
  buffer_load_dwordx4 v185, s[16:19], s90 offen  lds
  s_add_u32 m0, s96, 14336
  s_mov_b32 s90, 0x160000
  buffer_load_dwordx4 v185, s[16:19], s90 offen  lds
  s_add_u32 m0, s96, 15360
  s_mov_b32 s90, 0x170000
  buffer_load_dwordx4 v185, s[16:19], s90 offen  lds
  s_waitcnt vmcnt(28)
  ds_read_b64_tr_b16 a[64:65], v182 offset:16384
  ds_read_b64_tr_b16 a[66:67], v182 offset:16896
  ds_read_b64_tr_b16 a[72:73], v182 offset:16416
  ds_read_b64_tr_b16 a[74:75], v182 offset:16928
  s_waitcnt lgkmcnt(0)
  s_add_u32 m0, s96, 16384
  s_mov_b32 s90, 0x180000
  buffer_load_dwordx4 v180, s[12:15], s90 offen  lds
  s_add_u32 m0, s96, 17408
  s_mov_b32 s90, 0x190000
  buffer_load_dwordx4 v180, s[12:15], s90 offen  lds
  s_add_u32 m0, s96, 18432
  s_mov_b32 s90, 0x1a0000
  buffer_load_dwordx4 v180, s[12:15], s90 offen  lds
  s_add_u32 m0, s96, 19456
  s_mov_b32 s90, 0x1b0000
  buffer_load_dwordx4 v180, s[12:15], s90 offen  lds
  s_waitcnt vmcnt(28)
  ds_read_b64_tr_b16 a[80:81], v182 offset:20480
  ds_read_b64_tr_b16 a[82:83], v182 offset:20992
  ds_read_b64_tr_b16 a[88:89], v182 offset:20512
  ds_read_b64_tr_b16 a[90:91], v182 offset:21024
  s_waitcnt lgkmcnt(0)
  s_add_u32 m0, s96, 20480
  s_mov_b32 s90, 0x180000
  buffer_load_dwordx4 v185, s[16:19], s90 offen  lds
  s_add_u32 m0, s96, 21504
  s_mov_b32 s90, 0x190000
  buffer_load_dwordx4 v185, s[16:19], s90 offen  lds
  s_add_u32 m0, s96, 22528
  s_mov_b32 s90, 0x1a0000
  buffer_load_dwordx4 v185, s[16:19], s90 offen  lds
  s_add_u32 m0, s96, 23552
  s_mov_b32 s90, 0x1b0000
  buffer_load_dwordx4 v185, s[16:19], s90 offen  lds
  s_waitcnt vmcnt(28)
  ds_read_b64_tr_b16 a[68:69], v182 offset:24576
  ds_read_b64_tr_b16 a[70:71], v182 offset:25088
  ds_read_b64_tr_b16 a[76:77], v182 offset:24608
  ds_read_b64_tr_b16 a[78:79], v182 offset:25120
  s_waitcnt lgkmcnt(0)
  s_add_u32 m0, s96, 24576
  s_mov_b32 s90, 0x1c0000
  buffer_load_dwordx4 v180, s[12:15], s90 offen  lds
  s_add_u32 m0, s96, 25600
  s_mov_b32 s90, 0x1d0000
  buffer_load_dwordx4 v180, s[12:15], s90 offen  lds
  s_add_u32 m0, s96, 26624
  s_mov_b32 s90, 0x1e0000
  buffer_load_dwordx4 v180, s[12:15], s90 offen  lds
  s_add_u32 m0, s96, 27648
  s_mov_b32 s90, 0x1f0000
  buffer_load_dwordx4 v180, s[12:15], s90 offen  lds
  s_waitcnt vmcnt(28)
  ds_read_b64_tr_b16 a[84:85], v182 offset:28672
  ds_read_b64_tr_b16 a[86:87], v182 offset:29184
  ds_read_b64_tr_b16 a[92:93], v182 offset:28704
  ds_read_b64_tr_b16 a[94:95], v182 offset:29216
  s_waitcnt lgkmcnt(0)
  s_add_u32 m0, s96, 28672
  s_mov_b32 s90, 0x1c0000
  buffer_load_dwordx4 v185, s[16:19], s90 offen  lds
  s_add_u32 m0, s96, 29696
  s_mov_b32 s90, 0x1d0000
  buffer_load_dwordx4 v185, s[16:19], s90 offen  lds
  s_add_u32 m0, s96, 30720
  s_mov_b32 s90, 0x1e0000
  buffer_load_dwordx4 v185, s[16:19], s90 offen  lds
  s_add_u32 m0, s96, 31744
  s_mov_b32 s90, 0x1f0000
  buffer_load_dwordx4 v185, s[16:19], s90 offen  lds
  s_waitcnt vmcnt(28)
  ds_read_b64_tr_b16 a[112:113], v182 offset:0
  ds_read_b64_tr_b16 a[114:115], v182 offset:512
  ds_read_b64_tr_b16 a[120:121], v182 offset:32
  ds_read_b64_tr_b16 a[122:123], v182 offset:544
  s_waitcnt lgkmcnt(0)
  s_add_u32 m0, s96, 0
  s_mov_b32 s90, 0x0
  buffer_load_dwordx4 v180, s[8:11], s90 offen  lds
  s_add_u32 m0, s96, 1024
  s_mov_b32 s90, 0x10000
  buffer_load_dwordx4 v180, s[8:11], s90 offen  lds
  s_add_u32 m0, s96, 2048
  s_mov_b32 s90, 0x20000
  buffer_load_dwordx4 v180, s[8:11], s90 offen  lds
  s_add_u32 m0, s96, 3072
  s_mov_b32 s90, 0x30000
  buffer_load_dwordx4 v180, s[8:11], s90 offen  lds
  s_waitcnt vmcnt(28)
  ds_read_b64_tr_b16 a[128:129], v182 offset:4096
  ds_read_b64_tr_b16 a[130:131], v182 offset:4608
  ds_read_b64_tr_b16 a[136:137], v182 offset:4128
  ds_read_b64_tr_b16 a[138:139], v182 offset:4640
  s_waitcnt lgkmcnt(0)
  s_add_u32 m0, s96, 4096
  s_mov_b32 s90, 0x40000
  buffer_load_dwordx4 v180, s[8:11], s90 offen  lds
  s_add_u32 m0, s96, 5120
  s_mov_b32 s90, 0x50000
  buffer_load_dwordx4 v180, s[8:11], s90 offen  lds
  s_add_u32 m0, s96, 6144
  s_mov_b32 s90, 0x60000
  buffer_load_dwordx4 v180, s[8:11], s90 offen  lds
  s_add_u32 m0, s96, 7168
  s_mov_b32 s90, 0x70000
  buffer_load_dwordx4 v180, s[8:11], s90 offen  lds
  s_waitcnt vmcnt(28)
  ds_read_b64_tr_b16 a[116:117], v182 offset:8192
  ds_read_b64_tr_b16 a[118:119], v182 offset:8704
  ds_read_b64_tr_b16 a[124:125], v182 offset:8224
  ds_read_b64_tr_b16 a[126:127], v182 offset:8736
  s_waitcnt lgkmcnt(0)
  s_add_u32 m0, s96, 8192
  s_mov_b32 s90, 0x80000
  buffer_load_dwordx4 v180, s[8:11], s90 offen  lds
  s_add_u32 m0, s96, 9216
  s_mov_b32 s90, 0x90000
  buffer_load_dwordx4 v180, s[8:11], s90 offen  lds
  s_add_u32 m0, s96, 10240
  s_mov_b32 s90, 0xa0000
  buffer_load_dwordx4 v180, s[8:11], s90 offen  lds
  s_add_u32 m0, s96, 11264
  s_mov_b32 s90, 0xb0000
  buffer_load_dwordx4 v180, s[8:11], s90 offen  lds
  s_waitcnt vmcnt(28)
  ds_read_b64_tr_b16 a[132:133], v182 offset:12288
  ds_read_b64_tr_b16 a[134:135], v182 offset:12800
  ds_read_b64_tr_b16 a[140:141], v182 offset:12320
  ds_read_b64_tr_b16 a[142:143], v182 offset:12832
  s_waitcnt lgkmcnt(0)
  s_add_u32 m0, s96, 12288
  s_mov_b32 s90, 0xc0000
  buffer_load_dwordx4 v180, s[8:11], s90 offen  lds
  s_add_u32 m0, s96, 13312
  s_mov_b32 s90, 0xd0000
  buffer_load_dwordx4 v180, s[8:11], s90 offen  lds
  s_add_u32 m0, s96, 14336
  s_mov_b32 s90, 0xe0000
  buffer_load_dwordx4 v180, s[8:11], s90 offen  lds
  s_add_u32 m0, s96, 15360
  s_mov_b32 s90, 0xf0000
  buffer_load_dwordx4 v180, s[8:11], s90 offen  lds
  s_waitcnt vmcnt(28)
  ds_read_b64_tr_b16 a[160:161], v182 offset:16384
  ds_read_b64_tr_b16 a[162:163], v182 offset:16896
  ds_read_b64_tr_b16 a[168:169], v182 offset:16416
  ds_read_b64_tr_b16 a[170:171], v182 offset:16928
  s_waitcnt lgkmcnt(0)
  s_add_u32 m0, s96, 16384
  s_mov_b32 s90, 0x100000
  buffer_load_dwordx4 v180, s[8:11], s90 offen  lds
  s_add_u32 m0, s96, 17408
  s_mov_b32 s90, 0x110000
  buffer_load_dwordx4 v180, s[8:11], s90 offen  lds
  s_add_u32 m0, s96, 18432
  s_mov_b32 s90, 0x120000
  buffer_load_dwordx4 v180, s[8:11], s90 offen  lds
  s_add_u32 m0, s96, 19456
  s_mov_b32 s90, 0x130000
  buffer_load_dwordx4 v180, s[8:11], s90 offen  lds
  s_waitcnt vmcnt(28)
  ds_read_b64_tr_b16 a[176:177], v182 offset:20480
  ds_read_b64_tr_b16 a[178:179], v182 offset:20992
  ds_read_b64_tr_b16 a[184:185], v182 offset:20512
  ds_read_b64_tr_b16 a[186:187], v182 offset:21024
  s_waitcnt lgkmcnt(0)
  s_add_u32 m0, s96, 20480
  s_mov_b32 s90, 0x140000
  buffer_load_dwordx4 v180, s[8:11], s90 offen  lds
  s_add_u32 m0, s96, 21504
  s_mov_b32 s90, 0x150000
  buffer_load_dwordx4 v180, s[8:11], s90 offen  lds
  s_add_u32 m0, s96, 22528
  s_mov_b32 s90, 0x160000
  buffer_load_dwordx4 v180, s[8:11], s90 offen  lds
  s_add_u32 m0, s96, 23552
  s_mov_b32 s90, 0x170000
  buffer_load_dwordx4 v180, s[8:11], s90 offen  lds
  s_waitcnt vmcnt(28)
  ds_read_b64_tr_b16 a[164:165], v182 offset:24576
  ds_read_b64_tr_b16 a[166:167], v182 offset:25088
  ds_read_b64_tr_b16 a[172:173], v182 offset:24608
  ds_read_b64_tr_b16 a[174:175], v182 offset:25120
  s_waitcnt lgkmcnt(0)
  s_add_u32 m0, s96, 24576
  s_mov_b32 s90, 0x180000
  buffer_load_dwordx4 v180, s[8:11], s90 offen  lds
  s_add_u32 m0, s96, 25600
  s_mov_b32 s90, 0x190000
  buffer_load_dwordx4 v180, s[8:11], s90 offen  lds
  s_add_u32 m0, s96, 26624
  s_mov_b32 s90, 0x1a0000
  buffer_load_dwordx4 v180, s[8:11], s90 offen  lds
  s_add_u32 m0, s96, 27648
  s_mov_b32 s90, 0x1b0000
  buffer_load_dwordx4 v180, s[8:11], s90 offen  lds
  s_waitcnt vmcnt(28)
  ds_read_b64_tr_b16 a[180:181], v182 offset:28672
  ds_read_b64_tr_b16 a[182:183], v182 offset:29184
  ds_read_b64_tr_b16 a[188:189], v182 offset:28704
  ds_read_b64_tr_b16 a[190:191], v182 offset:29216
  s_waitcnt lgkmcnt(0)
  s_add_u32 m0, s96, 28672
  s_mov_b32 s90, 0x1c0000
  buffer_load_dwordx4 v180, s[8:11], s90 offen  lds
  s_add_u32 m0, s96, 29696
  s_mov_b32 s90, 0x1d0000
  buffer_load_dwordx4 v180, s[8:11], s90 offen  lds
  s_add_u32 m0, s96, 30720
  s_mov_b32 s90, 0x1e0000
  buffer_load_dwordx4 v180, s[8:11], s90 offen  lds
  s_add_u32 m0, s96, 31744
  s_mov_b32 s90, 0x1f0000
  buffer_load_dwordx4 v180, s[8:11], s90 offen  lds
  s_waitcnt vmcnt(28)
  ds_read_b64_tr_b16 a[0:1], v182 offset:0
  ds_read_b64_tr_b16 a[2:3], v182 offset:512
  ds_read_b64_tr_b16 a[8:9], v182 offset:32
  ds_read_b64_tr_b16 a[10:11], v182 offset:544
  s_waitcnt lgkmcnt(0)
  s_add_u32 m0, s96, 0
  s_mov_b32 s90, 0x0
  buffer_load_dwordx4 v181, s[20:23], s90 offen  lds
  s_add_u32 m0, s96, 1024
  s_mov_b32 s90, 0x4000
  buffer_load_dwordx4 v181, s[20:23], s90 offen  lds
  s_add_u32 m0, s96, 2048
  s_mov_b32 s90, 0x8000
  buffer_load_dwordx4 v181, s[20:23], s90 offen  lds
  s_add_u32 m0, s96, 3072
  s_mov_b32 s90, 0xc000
  buffer_load_dwordx4 v181, s[20:23], s90 offen  lds
  s_waitcnt vmcnt(28)
  ds_read_b64_tr_b16 a[4:5], v182 offset:4096
  ds_read_b64_tr_b16 a[6:7], v182 offset:4608
  ds_read_b64_tr_b16 a[12:13], v182 offset:4128
  ds_read_b64_tr_b16 a[14:15], v182 offset:4640
  s_waitcnt lgkmcnt(0)
  s_add_u32 m0, s96, 4096
  s_mov_b32 s90, 0x10000
  buffer_load_dwordx4 v181, s[20:23], s90 offen  lds
  s_add_u32 m0, s96, 5120
  s_mov_b32 s90, 0x14000
  buffer_load_dwordx4 v181, s[20:23], s90 offen  lds
  s_add_u32 m0, s96, 6144
  s_mov_b32 s90, 0x18000
  buffer_load_dwordx4 v181, s[20:23], s90 offen  lds
  s_add_u32 m0, s96, 7168
  s_mov_b32 s90, 0x1c000
  buffer_load_dwordx4 v181, s[20:23], s90 offen  lds
  s_waitcnt vmcnt(28)
  ds_read_b64_tr_b16 a[48:49], v182 offset:8192
  ds_read_b64_tr_b16 a[50:51], v182 offset:8704
  ds_read_b64_tr_b16 a[56:57], v182 offset:8224
  ds_read_b64_tr_b16 a[58:59], v182 offset:8736
  s_waitcnt lgkmcnt(0)
  s_add_u32 m0, s96, 8192
  s_mov_b32 s90, 0x20000
  buffer_load_dwordx4 v181, s[20:23], s90 offen  lds
  s_add_u32 m0, s96, 9216
  s_mov_b32 s90, 0x24000
  buffer_load_dwordx4 v181, s[20:23], s90 offen  lds
  s_add_u32 m0, s96, 10240
  s_mov_b32 s90, 0x28000
  buffer_load_dwordx4 v181, s[20:23], s90 offen  lds
  s_add_u32 m0, s96, 11264
  s_mov_b32 s90, 0x2c000
  buffer_load_dwordx4 v181, s[20:23], s90 offen  lds
  s_waitcnt vmcnt(28)
  ds_read_b64_tr_b16 a[52:53], v182 offset:12288
  ds_read_b64_tr_b16 a[54:55], v182 offset:12800
  ds_read_b64_tr_b16 a[60:61], v182 offset:12320
  ds_read_b64_tr_b16 a[62:63], v182 offset:12832
  s_waitcnt lgkmcnt(0)
  s_add_u32 m0, s96, 12288
  s_mov_b32 s90, 0x30000
  buffer_load_dwordx4 v181, s[20:23], s90 offen  lds
  s_add_u32 m0, s96, 13312
  s_mov_b32 s90, 0x34000
  buffer_load_dwordx4 v181, s[20:23], s90 offen  lds
  s_add_u32 m0, s96, 14336
  s_mov_b32 s90, 0x38000
  buffer_load_dwordx4 v181, s[20:23], s90 offen  lds
  s_add_u32 m0, s96, 15360
  s_mov_b32 s90, 0x3c000
  buffer_load_dwordx4 v181, s[20:23], s90 offen  lds
  s_mov_b32 s90, 0x3800000
  buffer_load_dword v204, v2, s[4:7], s90 offen sc1
  buffer_load_dword v204, v7, s[4:7], s90 offen sc1
  buffer_load_dword v204, v8, s[4:7], s90 offen sc1
  s_mov_b32 s90, 0x3880000
  buffer_load_dword v204, v2, s[4:7], s90 offen sc1
  buffer_load_dword v204, v7, s[4:7], s90 offen sc1
  buffer_load_dword v204, v8, s[4:7], s90 offen sc1
  s_mov_b32 s90, 0x3900000
  buffer_load_dword v204, v2, s[4:7], s90 offen sc1
  buffer_load_dword v204, v7, s[4:7], s90 offen sc1
  buffer_load_dword v204, v8, s[4:7], s90 offen sc1
  s_mov_b32 s90, 0x3980000
  buffer_load_dword v204, v2, s[4:7], s90 offen sc1
  buffer_load_dword v204, v7, s[4:7], s90 offen sc1
  buffer_load_dword v204, v8, s[4:7], s90 offen sc1
  s_waitcnt vmcnt(28)
  ds_read_b64_tr_b16 a[96:97], v182 offset:16384
  ds_read_b64_tr_b16 a[98:99], v182 offset:16896
  ds_read_b64_tr_b16 a[104:105], v182 offset:16416
  ds_read_b64_tr_b16 a[106:107], v182 offset:16928
  s_waitcnt vmcnt(24)
  ds_read_b64_tr_b16 a[100:101], v182 offset:20480
  ds_read_b64_tr_b16 a[102:103], v182 offset:20992
  ds_read_b64_tr_b16 a[108:109], v182 offset:20512
  ds_read_b64_tr_b16 a[110:111], v182 offset:21024
  s_waitcnt vmcnt(20)
  ds_read_b64_tr_b16 a[144:145], v182 offset:24576
  ds_read_b64_tr_b16 a[146:147], v182 offset:25088
  ds_read_b64_tr_b16 a[152:153], v182 offset:24608
  ds_read_b64_tr_b16 a[154:155], v182 offset:25120
  s_waitcnt vmcnt(16)
  ds_read_b64_tr_b16 a[148:149], v182 offset:28672
  ds_read_b64_tr_b16 a[150:151], v182 offset:29184
  ds_read_b64_tr_b16 a[156:157], v182 offset:28704
  ds_read_b64_tr_b16 a[158:159], v182 offset:29216
  v_mbcnt_lo_u32_b32 v250, -1, 0
  v_mbcnt_hi_u32_b32 v250, -1, v250
  s_lshl_b32 s90, s32, 9
  s_add_u32 s90, s90, 147520
  v_lshl_add_u32 v251, v250, 3, s90
  ds_write_b64 v251, v[248:249]
  s_waitcnt lgkmcnt(0)
  s_cmp_lg_u32 s32, 0
  s_cbranch_scc1 FL_vd_6
  v_lshlrev_b32 v250, 2, v250
  s_cmp_lg_u32 s100, 0
  s_cbranch_scc1 FL_vw_5
  v_readfirstlane_b32 s90, v247
  s_and_b32 s90, s90, s101
  s_cbranch_scc0 FL_vw_5
  v_mov_b32 v251, 1
  s_mov_b64 exec, 1
  buffer_store_dword v251, v250, s[28:31], 0 offen offset:32 sc1
  s_mov_b64 exec, -1
FL_vw_5:
  buffer_load_dword v251, v250, s[28:31], 0 offen sc1
  s_waitcnt vmcnt(0)
  v_cmp_eq_u32 vcc, -1, v251
  v_readlane_b32 s91, v251, 8
  v_readlane_b32 s92, v251, 32
  v_readlane_b32 s93, v251, 33
  v_readlane_b32 s90, v251, 34
  s_cmp_lg_u32 s100, 0
  s_cselect_b32 s93, s90, s93
  s_cselect_b32 s91, 0, s91
  s_cselect_b32 s92, 1, s92
  s_cselect_b32 s90, 0xff, vcc_lo
  s_cmp_lg_u32 s91, 0
  s_cselect_b32 s92, 3, s92
  s_cbranch_scc1 FL_vk_7
  s_add_u32 s3, s3, 1
  s_cmp_ge_u32 s3, 131072
  s_cselect_b32 s92, 4, s92
  s_cbranch_scc1 FL_vk_7
  s_sleep 8
  s_and_b32 s90, s90, 0xff
  s_cmp_lg_u32 s90, 0xff
  s_cbranch_scc1 FL_vw_5
  s_cmp_lt_u32 s93, 128
  s_cbranch_scc1 FL_vw_5
  s_cmp_eq_u32 s92, 0
  s_cbranch_scc1 FL_vw_5
FL_vk_7:
  v_mov_b32 v251, s92
  v_mov_b32 v250, 147456
  ds_write_b32 v250, v251
  s_waitcnt lgkmcnt(0)
FL_vd_6:
  s_barrier
  v_mov_b32 v250, 147456
  ds_read_b32 v251, v250
  s_waitcnt lgkmcnt(0)
  v_readfirstlane_b32 s92, v251
  s_barrier
  s_cmp_eq_u32 s92, 3
  s_cbranch_scc1 L_fallback
  s_cmp_eq_u32 s92, 4
  s_cbranch_scc1 L_exit
  s_sub_u32 s39, s92, 1
  s_and_b32 s39, s39, 1
  s_lshl_b32 s39, s39, 13
  s_waitcnt vmcnt(0)
  s_barrier
  ds_read_b64_tr_b16 a[192:193], v183 offset:0
  ds_read_b64_tr_b16 a[194:195], v183 offset:2048
  ds_read_b64_tr_b16 a[196:197], v183 offset:512
  ds_read_b64_tr_b16 a[198:199], v183 offset:2560
  ds_read_b64_tr_b16 a[200:201], v183 offset:4096
  ds_read_b64_tr_b16 a[202:203], v183 offset:6144
  ds_read_b64_tr_b16 a[204:205], v183 offset:4608
  ds_read_b64_tr_b16 a[206:207], v183 offset:6656
  s_waitcnt lgkmcnt(0)
  ds_read_b64_tr_b16 a[208:209], v183 offset:32768
  ds_read_b64_tr_b16 a[210:211], v183 offset:34816
  ds_read_b64_tr_b16 a[212:213], v183 offset:33280
  ds_read_b64_tr_b16 a[214:215], v183 offset:35328
  ds_read_b64_tr_b16 a[216:217], v183 offset:36864
  ds_read_b64_tr_b16 a[218:219], v183 offset:38912
  ds_read_b64_tr_b16 a[220:221], v183 offset:37376
  ds_read_b64_tr_b16 a[222:223], v183 offset:39424
  s_waitcnt lgkmcnt(0)
  ds_read_b64_tr_b16 a[224:225], v184 offset:0
  ds_read_b64_tr_b16 a[226:227], v184 offset:2048
  ds_read_b64_tr_b16 a[228:229], v184 offset:512
  ds_read_b64_tr_b16 a[230:231], v184 offset:2560
  ds_read_b64_tr_b16 a[232:233], v184 offset:4096
  ds_read_b64_tr_b16 a[234:235], v184 offset:6144
  ds_read_b64_tr_b16 a[236:237], v184 offset:4608
  ds_read_b64_tr_b16 a[238:239], v184 offset:6656
  s_waitcnt lgkmcnt(0)
  ds_read_b64_tr_b16 a[240:241], v184 offset:32768
  ds_read_b64_tr_b16 a[242:243], v184 offset:34816
  ds_read_b64_tr_b16 a[244:245], v184 offset:33280
  ds_read_b64_tr_b16 a[246:247], v184 offset:35328
  ds_read_b64_tr_b16 a[248:249], v184 offset:36864
  ds_read_b64_tr_b16 a[250:251], v184 offset:38912
  ds_read_b64_tr_b16 a[252:253], v184 offset:37376
  ds_read_b64_tr_b16 a[254:255], v184 offset:39424
  s_waitcnt lgkmcnt(0)
  s_barrier
  s_mov_b32 s46, 0
  v_xor_b32 v1, s39, v1
  v_xor_b32 v17, s39, v17
  v_xor_b32 v18, s39, v18
  s_mov_b32 s12, s63
  s_mov_b32 s90, 0x3800000
  s_mov_b32 s90, 0x3880000
  s_mov_b32 s90, 0x3900000
  s_mov_b32 s90, 0x3980000
  v_mov_b32 v248, 0x3f803f80
  v_mov_b32 v249, 0x3f803f80
  v_mov_b32 v250, 0x3f803f80
  v_mov_b32 v251, 0x3f803f80
  v_mov_b32 v252, 0x3f803f80
  v_mov_b32 v253, 0x3f803f80
  v_mov_b32 v254, 0x3f803f80
  v_mov_b32 v255, 0x3f803f80
  s_cmp_lg_u32 s32, 0
  s_cbranch_scc1 FL_kv0d
  s_lshl_b32 s90, s33, 7
  s_add_u32 s90, s90, 0x3d07000
  v_mov_b32 v30, s90
FL_kv0:
  buffer_load_dword v31, v30, s[4:7], 0 offen sc1
  s_waitcnt vmcnt(0)
  v_readfirstlane_b32 s90, v31
  s_add_u32 s46, s46, 1
  s_cmp_ge_u32 s46, 131072
  s_cbranch_scc1 FL_rec_abort
  s_sleep 2
  s_cmp_lt_u32 s90, 16
  s_cbranch_scc1 FL_kv0
FL_kv0d:
  s_barrier
  buffer_load_dwordx4 v[180:183], v12, s[4:7], s44 offen offset:0
  buffer_load_dwordx4 v[184:187], v12, s[4:7], s44 offen offset:128
  buffer_load_dwordx4 v[188:191], v12, s[4:7], s44 offen offset:1024
  buffer_load_dwordx4 v[192:195], v12, s[4:7], s44 offen offset:1152
  buffer_load_dwordx4 v[196:199], v13, s[4:7], s44 offen offset:0
  buffer_load_dwordx4 v[200:203], v13, s[4:7], s44 offen offset:128
  buffer_load_dwordx4 v[204:207], v13, s[4:7], s44 offen offset:1024
  buffer_load_dwordx4 v[208:211], v13, s[4:7], s44 offen offset:1152
  buffer_load_dwordx4 v[116:119], v11, s[4:7], s44 offen offset:0
  buffer_load_dwordx4 v[132:135], v11, s[4:7], s44 offen offset:64
  buffer_load_dwordx4 v[120:123], v11, s[4:7], s44 offen offset:1024
  buffer_load_dwordx4 v[136:139], v11, s[4:7], s44 offen offset:1088
  buffer_load_dwordx4 v[124:127], v11, s[4:7], s44 offen offset:2048
  buffer_load_dwordx4 v[140:143], v11, s[4:7], s44 offen offset:2112
  buffer_load_dwordx4 v[128:131], v11, s[4:7], s44 offen offset:3072
  buffer_load_dwordx4 v[144:147], v11, s[4:7], s44 offen offset:3136
  s_add_u32 s44, s44, 0x40000
  v_mov_b64 v[64:65], 0
  v_mov_b64 v[66:67], 0
  v_mov_b64 v[68:69], 0
  v_mov_b64 v[70:71], 0
  v_mov_b64 v[72:73], 0
  v_mov_b64 v[74:75], 0
  v_mov_b64 v[76:77], 0
  v_mov_b64 v[78:79], 0
  v_mov_b64 v[80:81], 0
  v_mov_b64 v[82:83], 0
  v_mov_b64 v[84:85], 0
  v_mov_b64 v[86:87], 0
  v_mov_b64 v[32:33], 0
  v_mov_b64 v[34:35], 0
  v_mov_b64 v[212:213], 0
  v_mov_b64 v[214:215], 0
  v_mov_b64 v[216:217], 0
  v_mov_b64 v[218:219], 0
  v_mov_b64 v[220:221], 0
  v_mov_b64 v[222:223], 0
  v_mov_b64 v[224:225], 0
  v_mov_b64 v[226:227], 0
  v_mov_b64 v[228:229], 0
  v_mov_b64 v[230:231], 0
  s_waitcnt vmcnt(0)
  v_min_u32 v44, s54, v44
  s_lshl_b32 s90, s33, 7
  s_add_u32 s90, s90, 0x3d07000
  v_mov_b32 v244, s90
  s_lshl_b32 s90, s34, 2
  s_add_u32 s90, s90, s32
  s_lshl_b32 s91, s33, 7
  s_add_u32 s91, s91, 0x3d00000
  v_mbcnt_lo_u32_b32 v30, -1, 0
  v_mbcnt_hi_u32_b32 v30, -1, v30
  v_add_u32 v30, s90, v30
  v_cmp_eq_u32 vcc, 0, v30
  v_mov_b32 v30, 0x80000000
  v_mov_b32 v31, s91
  v_cndmask_b32 v245, v30, v31, vcc
  s_mov_b64 s[8:9], s[94:95]
  s_mov_b64 s[10:11], s[94:95]
  s_branch FL_pubmem
FL_step:
  s_load_dword s16, s[8:9], 256
  s_load_dword s17, s[10:11], 256
  s_load_dword s18, s[8:9], 320
  s_load_dword s19, s[10:11], 320
  s_load_dword s20, s[8:9], 384
  s_load_dword s21, s[10:11], 384
  s_load_dword s22, s[8:9], 448
  s_load_dword s23, s[10:11], 448
  buffer_load_dwordx4 v[200:203], v13, s[4:7], s44 offen offset:128
  buffer_load_dwordx4 v[204:207], v13, s[4:7], s44 offen offset:1024
  buffer_load_dwordx4 v[208:211], v13, s[4:7], s44 offen offset:1152
  buffer_load_dwordx4 v[128:131], v11, s[4:7], s44 offen offset:3072
  buffer_load_dwordx4 v[144:147], v11, s[4:7], s44 offen offset:3136
  v_mov_b64 v[64:65], 0
  v_mov_b64 v[66:67], 0
  v_mov_b64 v[68:69], 0
  v_mov_b64 v[70:71], 0
  v_mov_b64 v[72:73], 0
  v_mov_b64 v[74:75], 0
  v_mov_b64 v[76:77], 0
  v_mov_b64 v[78:79], 0
  v_mov_b64 v[80:81], 0
  v_mov_b64 v[82:83], 0
  v_mov_b64 v[84:85], 0
  v_mov_b64 v[86:87], 0
  v_mov_b64 v[32:33], 0
  v_mov_b64 v[34:35], 0
  buffer_load_dwordx4 v[36:39], v1, s[4:7], s42 offen sc1
  buffer_store_dword v22, v18, s[4:7], s13 offen
  buffer_store_dword v22, v2, s[4:7], s13 offen
  buffer_store_dword v22, v7, s[4:7], s13 offen
  buffer_store_dword v22, v8, s[4:7], s13 offen
  s_add_u32 s44, s44, 0x40000
  s_min_u32 s44, s44, 0xfc0000
  s_add_u32 s45, s45, 0x10000
  s_waitcnt vmcnt(12)
FL_kv_chk:
  v_readfirstlane_b32 s90, v243
  s_cmp_lt_u32 s90, 16
  s_cbranch_scc1 FL_kv_f
  s_waitcnt vmcnt(4)
FL_g_chk:
  v_max3_u32 v31, v36, v37, v38
  v_max_u32 v31, v31, v39
  v_cmp_eq_u32 vcc, -1, v31
  v_mfma_f32_16x16x32_bf16 v[40:43], v[24:27], v[36:39], 0
  s_cbranch_vccnz FL_g_f
  s_nop 6
  v_add_f32_dpp v45, v40, v40 row_ror:8 row_mask:0xf bank_mask:0xf
  v_add_f32_dpp v46, v41, v41 row_ror:8 row_mask:0xf bank_mask:0xf
  v_cvt_pk_bf16_f32 v44, v45, v46
  v_min_u32 v44, s54, v44
FL_pubmem:
  buffer_store_dword v44, v2, s[4:7], s41 offen
  v_mov_b32 v148, v180
  v_mov_b32 v150, v181
  v_mov_b32 v152, v182
  v_mov_b32 v154, v183
  v_mov_b32 v149, v184
  v_mov_b32 v151, v185
  v_mov_b32 v153, v186
  v_mov_b32 v155, v187
  v_mov_b32 v156, v188
  v_mov_b32 v158, v189
  v_mov_b32 v160, v190
  v_mov_b32 v162, v191
  v_mov_b32 v157, v192
  v_mov_b32 v159, v193
  v_mov_b32 v161, v194
  v_mov_b32 v163, v195
  v_mov_b32 v164, v196
  v_mov_b32 v166, v197
  v_mov_b32 v168, v198
  v_mov_b32 v170, v199
  v_mov_b32 v165, v200
  v_mov_b32 v167, v201
  v_mov_b32 v169, v202
  v_mov_b32 v171, v203
  buffer_load_dwordx4 v[48:51], v3, s[4:7], s41 offen offset:0 sc1
  v_mov_b32 v172, v204
  v_mov_b32 v174, v205
  buffer_load_dwordx4 v[52:55], v3, s[4:7], s41 offen offset:1024 sc1
  v_mov_b32 v176, v206
  v_mov_b32 v178, v207
  buffer_load_dwordx4 v[56:59], v3, s[4:7], s41 offen offset:2048 sc1
  v_mov_b32 v173, v208
  v_mov_b32 v175, v209
  buffer_load_dwordx4 v[60:63], v3, s[4:7], s41 offen offset:3072 sc1
  v_mov_b32 v177, v210
  v_mov_b32 v179, v211
  s_waitcnt vmcnt(3)
  v_max3_u32 v31, v48, v49, v50
  v_max_u32 v31, v31, v51
  v_cmp_eq_u32 vcc, -1, v31
  s_cbranch_vccnz FL_m_f0
  v_smfmac_f32_16x16x64_bf16 v[64:67], v[48:51], a[0:7], v23
  s_waitcnt vmcnt(2)
  v_max3_u32 v31, v52, v53, v54
  v_max_u32 v31, v31, v55
  v_cmp_eq_u32 vcc, -1, v31
  v_smfmac_f32_16x16x64_bf16 v[68:71], v[48:51], a[8:15], v23
  v_smfmac_f32_16x16x64_bf16 v[72:75], v[48:51], a[16:23], v23
  v_smfmac_f32_16x16x64_bf16 v[76:79], v[48:51], a[24:31], v23
  s_cbranch_vccnz FL_m_f1
  v_smfmac_f32_16x16x64_bf16 v[64:67], v[52:55], a[48:55], v23
  s_waitcnt vmcnt(1)
  v_max3_u32 v31, v56, v57, v58
  v_max_u32 v31, v31, v59
  v_cmp_eq_u32 vcc, -1, v31
  v_smfmac_f32_16x16x64_bf16 v[68:71], v[52:55], a[56:63], v23
  v_smfmac_f32_16x16x64_bf16 v[72:75], v[52:55], a[64:71], v23
  v_smfmac_f32_16x16x64_bf16 v[76:79], v[52:55], a[72:79], v23
  s_cbranch_vccnz FL_m_f2
  v_smfmac_f32_16x16x64_bf16 v[64:67], v[56:59], a[96:103], v23
  s_waitcnt vmcnt(0)
  v_max3_u32 v31, v60, v61, v62
  v_max_u32 v31, v31, v63
  v_cmp_eq_u32 vcc, -1, v31
  v_smfmac_f32_16x16x64_bf16 v[68:71], v[56:59], a[104:111], v23
  v_smfmac_f32_16x16x64_bf16 v[72:75], v[56:59], a[112:119], v23
  v_smfmac_f32_16x16x64_bf16 v[76:79], v[56:59], a[120:127], v23
  s_cbranch_vccnz FL_m_f3
  v_smfmac_f32_16x16x64_bf16 v[64:67], v[60:63], a[144:151], v23
  v_smfmac_f32_16x16x64_bf16 v[68:71], v[60:63], a[152:159], v23
  v_smfmac_f32_16x16x64_bf16 v[72:75], v[60:63], a[160:167], v23
  v_smfmac_f32_16x16x64_bf16 v[76:79], v[60:63], a[168:175], v23
FL_m_done:
  s_nop 4
  v_pk_add_f32 v[88:89], v[64:65], v[66:67]
  v_pk_add_f32 v[90:91], v[68:69], v[70:71]
  ds_write_b128 v4, v[88:91] offset:0
  v_pk_add_f32 v[92:93], v[72:73], v[74:75]
  v_pk_add_f32 v[94:95], v[76:77], v[78:79]
  ds_write_b128 v4, v[92:95] offset:1088
  v_smfmac_f32_16x16x64_bf16 v[80:83], v[48:51], a[32:39], v23
  buffer_load_dwordx4 v[180:183], v12, s[4:7], s44 offen offset:0
  v_mov_b32 v36, 0
  v_smfmac_f32_16x16x64_bf16 v[84:87], v[48:51], a[40:47], v23
  buffer_load_dwordx4 v[184:187], v12, s[4:7], s44 offen offset:128
  v_mov_b32 v37, 0
  v_smfmac_f32_16x16x64_bf16 v[80:83], v[52:55], a[80:87], v23
  buffer_load_dwordx4 v[188:191], v12, s[4:7], s44 offen offset:1024
  v_mov_b32 v38, 0
  v_smfmac_f32_16x16x64_bf16 v[84:87], v[52:55], a[88:95], v23
  buffer_load_dwordx4 v[192:195], v12, s[4:7], s44 offen offset:1152
  v_mov_b32 v39, 0
  v_smfmac_f32_16x16x64_bf16 v[80:83], v[56:59], a[128:135], v23
  buffer_load_dwordx4 v[196:199], v13, s[4:7], s44 offen offset:0
  v_mov_b32 v40, 0
  s_waitcnt lgkmcnt(0)
  s_barrier
  ds_read2_b32 v[100:101], v6 offset0:0 offset1:2
  ds_read2_b32 v[102:103], v240 offset0:0 offset1:2
  ds_read2_b32 v[104:105], v241 offset0:0 offset1:2
  ds_read2_b32 v[106:107], v242 offset0:0 offset1:2
  v_smfmac_f32_16x16x64_bf16 v[84:87], v[56:59], a[136:143], v23
  v_mov_b32 v41, 0
  v_smfmac_f32_16x16x64_bf16 v[80:83], v[60:63], a[176:183], v23
  v_mov_b32 v42, 0
  v_smfmac_f32_16x16x64_bf16 v[84:87], v[60:63], a[184:191], v23
  v_mov_b32 v43, 0
  v_mov_b32 v44, 0
  v_mov_b32 v45, 0
  v_mov_b32 v46, 0
  v_mov_b32 v47, 0
  s_waitcnt lgkmcnt(2)
  v_pk_add_f32 v[100:101], v[100:101], v[102:103]
  s_waitcnt lgkmcnt(0)
  v_pk_add_f32 v[104:105], v[104:105], v[106:107]
  v_pk_add_f32 v[100:101], v[100:101], v[104:105]
  v_cvt_pk_bf16_f32 v112, v100, v101
  v_min_u32 v112, s54, v112
  buffer_store_dword v112, v7, s[4:7], s41 offen
  v_pk_add_f32 v[96:97], v[80:81], v[82:83]
  v_pk_add_f32 v[98:99], v[84:85], v[86:87]
  ds_write_b128 v4, v[96:99] offset:2176
  v_mov_b64 v[212:213], 0
  v_mov_b64 v[214:215], 0
  v_mov_b64 v[216:217], 0
  v_mov_b64 v[218:219], 0
  v_mov_b64 v[220:221], 0
  v_mov_b64 v[222:223], 0
  v_mov_b64 v[224:225], 0
  v_mov_b64 v[226:227], 0
  v_mov_b64 v[228:229], 0
  v_mov_b64 v[230:231], 0
  s_waitcnt lgkmcnt(0)
  s_barrier
  ds_read_b64 v[88:89], v5 offset:0
  buffer_load_dwordx4 v[64:67], v9, s[4:7], s41 offen offset:0 sc1
  s_mov_b32 s42, s41
  s_add_u32 s90, s40, 1
  ds_read_b64 v[90:91], v5 offset:3264
  buffer_load_dwordx4 v[68:71], v9, s[4:7], s41 offen offset:1024 sc1
  s_and_b32 s90, s90, 3
  s_lshl_b32 s90, s90, 19
  ds_read_b64 v[92:93], v5 offset:6528
  buffer_load_dwordx4 v[72:75], v9, s[4:7], s41 offen offset:2048 sc1
  s_add_u32 s91, s90, 0x3800000
  s_add_u32 s55, s55, 0x40000
  ds_read_b64 v[94:95], v5 offset:9792
  buffer_load_dwordx4 v[76:79], v9, s[4:7], s41 offen offset:3072 sc1
  s_min_u32 s55, s55, 0xfc0000
  s_nop 0
  s_waitcnt lgkmcnt(2)
  v_pk_add_f32 v[88:89], v[88:89], v[90:91]
  s_waitcnt lgkmcnt(0)
  v_pk_add_f32 v[92:93], v[92:93], v[94:95]
  v_pk_add_f32 v[88:89], v[88:89], v[92:93]
  v_cvt_pk_bf16_f32 v113, v88, v89
  v_min_u32 v113, s54, v113
  buffer_store_dword v113, v8, s[4:7], s41 offen
  s_add_u32 s8, s94, s55
  s_addc_u32 s9, s95, 0
  s_add_u32 s8, s8, s12
  s_addc_u32 s9, s9, 0
  s_add_u32 s10, s8, 0x1000000
  s_addc_u32 s11, s9, 0
  s_load_dword s16, s[8:9], 0
  s_load_dword s17, s[10:11], 0
  s_load_dword s18, s[8:9], 64
  s_load_dword s19, s[10:11], 64
  s_load_dword s20, s[8:9], 128
  s_load_dword s21, s[10:11], 128
  s_load_dword s22, s[8:9], 192
  s_load_dword s23, s[10:11], 192
  s_cmp_eq_u32 s40, 63
  s_cbranch_scc1 FL_last
  s_waitcnt vmcnt(4)
  v_max3_u32 v31, v64, v65, v66
  v_max_u32 v31, v31, v67
  v_cmp_eq_u32 vcc, -1, v31
  s_cbranch_vccnz FL_x_f0
  v_mfma_f32_16x16x32_bf16 v[44:47], v[64:67], v[64:67], v[44:47]
  s_waitcnt vmcnt(3)
  v_max3_u32 v31, v68, v69, v70
  v_max_u32 v31, v31, v71
  v_cmp_eq_u32 vcc, -1, v31
  v_mfma_f32_16x16x32_bf16 v[36:39], v[116:119], v[64:67], v[36:39]
  v_mfma_f32_16x16x32_bf16 v[40:43], v[132:135], v[64:67], v[40:43]
  s_cbranch_vccnz FL_x_f1
  v_mfma_f32_16x16x32_bf16 v[44:47], v[68:71], v[68:71], v[44:47]
  s_waitcnt vmcnt(2)
  v_max3_u32 v31, v72, v73, v74
  v_max_u32 v31, v31, v75
  v_cmp_eq_u32 vcc, -1, v31
  v_mfma_f32_16x16x32_bf16 v[36:39], v[120:123], v[68:71], v[36:39]
  v_mfma_f32_16x16x32_bf16 v[40:43], v[136:139], v[68:71], v[40:43]
  s_cbranch_vccnz FL_x_f2
  v_mfma_f32_16x16x32_bf16 v[44:47], v[72:75], v[72:75], v[44:47]
  s_waitcnt vmcnt(1)
  v_max3_u32 v31, v76, v77, v78
  v_max_u32 v31, v31, v79
  v_cmp_eq_u32 vcc, -1, v31
  v_mfma_f32_16x16x32_bf16 v[36:39], v[124:127], v[72:75], v[36:39]
  v_mfma_f32_16x16x32_bf16 v[40:43], v[140:143], v[72:75], v[40:43]
  s_cbranch_vccnz FL_x_f3
  v_mfma_f32_16x16x32_bf16 v[44:47], v[76:79], v[76:79], v[44:47]
  v_mfma_f32_16x16x32_bf16 v[36:39], v[128:131], v[76:79], v[36:39]
  v_mfma_f32_16x16x32_bf16 v[40:43], v[144:147], v[76:79], v[40:43]
FL_x_done:
  buffer_load_dwordx4 v[88:91], v10, s[4:7], s41 offen offset:0 sc1
  buffer_load_dwordx4 v[92:95], v10, s[4:7], s41 offen offset:1024 sc1
  s_mov_b64 vcc, s[48:49]
  s_nop 2
  v_max_f32 v30, v46, v47
  s_nop 0
  v_cndmask_b32_dpp v96, v40, v36, vcc quad_perm:[0,1,0,1] row_mask:0xf bank_mask:0xf
  v_cndmask_b32_dpp v97, v41, v37, vcc quad_perm:[0,1,0,1] row_mask:0xf bank_mask:0xf
  v_cndmask_b32_dpp v98, v42, v38, vcc quad_perm:[0,1,0,1] row_mask:0xf bank_mask:0xf
  v_cndmask_b32_dpp v99, v43, v39, vcc quad_perm:[0,1,0,1] row_mask:0xf bank_mask:0xf
  v_max3_f32 v29, v96, v97, v98
  s_nop 0
  v_max_f32_dpp v28, v30, v99 quad_perm:[0,1,0,1] row_mask:0xf bank_mask:0xf
  v_max_f32 v29, v29, v28
  s_nop 1
  v_max_f32_dpp v28, v29, v29 quad_perm:[2,3,0,1] row_mask:0xf bank_mask:0xf
  v_mov_b32 v29, v28
  s_nop 1
  v_permlane32_swap_b32 v28, v29
  v_max_f32 v28, v28, v29
  v_mov_b32 v29, v28
  s_nop 1
  v_permlane16_swap_b32 v28, v29
  v_max_f32 v28, v28, v29
  v_mul_f32 v28, s47, v28
  v_fma_f32 v96, v96, s47, -v28
  v_fma_f32 v97, v97, s47, -v28
  v_fma_f32 v98, v98, s47, -v28
  v_fma_f32 v99, v99, s47, -v28
  v_fma_f32 v46, v46, s47, -v28
  v_fma_f32 v47, v47, s47, -v28
  v_exp_f32 v96, v96
  v_exp_f32 v97, v97
  v_exp_f32 v98, v98
  v_exp_f32 v99, v99
  v_cvt_pk_bf16_f32 v236, v96, v97
  v_cvt_pk_bf16_f32 v237, v98, v99
  v_exp_f32 v46, v46
  v_mov_b32_dpp v100, v236 quad_perm:[0,1,0,1] row_mask:0xf bank_mask:0xf
  v_mov_b32_dpp v102, v236 quad_perm:[2,3,2,3] row_mask:0xf bank_mask:0xf
  v_mov_b32_dpp v101, v237 quad_perm:[0,1,0,1] row_mask:0xf bank_mask:0xf
  v_mov_b32_dpp v103, v237 quad_perm:[2,3,2,3] row_mask:0xf bank_mask:0xf
  v_exp_f32 v47, v47
  s_nop 0
  v_smfmac_f32_16x16x64_bf16 v[228:231], v[100:103], v[248:255], v23
  v_cvt_pk_bf16_f32 v238, v46, v47
  buffer_load_dwordx4 v[116:119], v11, s[4:7], s44 offen offset:0
  v_smfmac_f32_16x16x64_bf16 v[212:215], v[100:103], v[148:155], v23
  buffer_load_dwordx4 v[132:135], v11, s[4:7], s44 offen offset:64
  v_mov_b32_dpp v232, v238 quad_perm:[0,1,0,1] row_mask:0xf bank_mask:0xf
  v_smfmac_f32_16x16x64_bf16 v[216:219], v[100:103], v[156:163], v23
  buffer_load_dwordx4 v[120:123], v11, s[4:7], s44 offen offset:1024
  v_mov_b32_dpp v235, v238 quad_perm:[0,1,0,1] row_mask:0xf bank_mask:0xf
  v_smfmac_f32_16x16x64_bf16 v[220:223], v[100:103], v[164:171], v23
  buffer_load_dwordx4 v[136:139], v11, s[4:7], s44 offen offset:1088
  s_waitcnt vmcnt(4)
  v_max3_u32 v31, v88, v89, v90
  v_max3_u32 v31, v31, v91, v92
  v_smfmac_f32_16x16x32_bf16 v[228:231], v[232:233], v[248:251], v23
  v_max3_u32 v31, v31, v93, v94
  v_max_u32 v31, v31, v95
  v_cmp_eq_u32 vcc, -1, v31
  v_smfmac_f32_16x16x64_bf16 v[224:227], v[100:103], v[172:179], v23
  s_cbranch_vccnz FL_v_f
FL_v_ok:
  v_smfmac_f32_16x16x32_bf16 v[212:215], v[232:233], v[88:91], v23
  buffer_load_dwordx4 v[124:127], v11, s[4:7], s44 offen offset:2048
  buffer_load_dwordx4 v[140:143], v11, s[4:7], s44 offen offset:2112
  v_smfmac_f32_16x16x32_bf16 v[216:219], v[234:235], v[88:91], v23
  v_rcp_f32 v28, v228
  v_smfmac_f32_16x16x32_bf16 v[220:223], v[232:233], v[92:95], v23
  v_rcp_f32 v29, v229
  v_smfmac_f32_16x16x32_bf16 v[224:227], v[234:235], v[92:95], v23
  s_nop 0
  v_pk_mul_f32 v[212:213], v[212:213], v[28:29]
  v_pk_mul_f32 v[214:215], v[214:215], v[28:29]
  v_cvt_pk_bf16_f32 v104, v212, v214
  v_cvt_pk_bf16_f32 v108, v213, v215
  v_pk_mul_f32 v[216:217], v[216:217], v[28:29]
  v_pk_mul_f32 v[218:219], v[218:219], v[28:29]
  v_cvt_pk_bf16_f32 v105, v216, v218
  v_cvt_pk_bf16_f32 v109, v217, v219
  v_pk_mul_f32 v[220:221], v[220:221], v[28:29]
  v_pk_mul_f32 v[222:223], v[222:223], v[28:29]
  v_cvt_pk_bf16_f32 v106, v220, v222
  v_cvt_pk_bf16_f32 v110, v221, v223
  v_pk_mul_f32 v[224:225], v[224:225], v[28:29]
  v_pk_mul_f32 v[226:227], v[226:227], v[28:29]
  v_cvt_pk_bf16_f32 v107, v224, v226
  v_cvt_pk_bf16_f32 v111, v225, v227
  ds_write_b128 v14, v[104:107]
  ds_write_b128 v15, v[108:111]
  s_add_u32 s92, s40, 3
  s_min_u32 s92, s92, 63
  s_lshr_b32 s92, s92, 2
  s_lshl_b32 s92, s92, 9
  v_mov_b32 v246, s40
  s_waitcnt lgkmcnt(0)
  s_barrier
  ds_read_b128 v[48:51], v16 offset:0
  ds_read_b128 v[52:55], v16 offset:1024
  ds_read_b128 v[56:59], v16 offset:2048
  ds_read_b128 v[60:63], v16 offset:3072
  ds_read_b128 v[64:67], v16 offset:4096
  buffer_store_dword v22, v17, s[4:7], s43 offen sc1
  buffer_store_dword v112, v19, s[4:7], s45 offen sc1
  s_waitcnt lgkmcnt(4)
  v_smfmac_f32_16x16x64_bf16 v[32:35], v[48:51], a[192:199], v23
  ds_read_b128 v[68:71], v16 offset:5120
  buffer_store_dword v113, v20, s[4:7], s45 offen sc1
  s_waitcnt lgkmcnt(4)
  v_smfmac_f32_16x16x64_bf16 v[32:35], v[52:55], a[200:207], v23
  ds_read_b128 v[72:75], v16 offset:6144
  buffer_store_dword v246, v245, s[4:7], 0 offen sc1
  s_waitcnt lgkmcnt(4)
  v_smfmac_f32_16x16x64_bf16 v[32:35], v[56:59], a[208:215], v23
  ds_read_b128 v[76:79], v16 offset:7168
  buffer_load_dword v243, v244, s[4:7], s92 offen sc1
  s_waitcnt lgkmcnt(4)
  v_smfmac_f32_16x16x64_bf16 v[32:35], v[60:63], a[216:223], v23
  s_mov_b32 s13, s43
  s_waitcnt lgkmcnt(3)
  v_smfmac_f32_16x16x64_bf16 v[32:35], v[64:67], a[224:231], v23
  s_add_u32 s40, s40, 1
  s_waitcnt lgkmcnt(2)
  v_smfmac_f32_16x16x64_bf16 v[32:35], v[68:71], a[232:239], v23
  s_mov_b32 s41, s91
  s_waitcnt lgkmcnt(1)
  v_smfmac_f32_16x16x64_bf16 v[32:35], v[72:75], a[240:247], v23
  s_xor_b32 s43, s91, 0x100000
  s_waitcnt lgkmcnt(0)
  v_smfmac_f32_16x16x64_bf16 v[32:35], v[76:79], a[248:255], v23
  s_nop 7
  v_pk_add_f32 v[28:29], v[32:33], v[34:35]
  v_cvt_pk_bf16_f32 v28, v28, v29
  v_min_u32 v28, s54, v28
  buffer_store_dword v28, v17, s[4:7], s42 offen sc1
  buffer_store_dword v28, v18, s[4:7], s42 offen
  s_branch FL_step
FL_last:
  buffer_store_dword v112, v19, s[4:7], s45 offen sc1
  buffer_store_dword v113, v20, s[4:7], s45 offen sc1
  s_branch L_join
FL_kv_f:
  s_sleep 8
  buffer_load_dword v243, v244, s[4:7], s92 offen sc1
  s_add_u32 s46, s46, 1
  s_cmp_ge_u32 s46, 131072
  s_cbranch_scc1 FL_rec_abort
  s_waitcnt vmcnt(0)
  s_branch FL_kv_chk
FL_g_f:
  s_mov_b64 exec, vcc
  buffer_load_dwordx4 v[36:39], v1, s[4:7], s42 offen sc1
  s_mov_b64 exec, -1
  s_add_u32 s46, s46, 1
  s_cmp_ge_u32 s46, 131072
  s_cbranch_scc1 FL_rec_abort
  s_waitcnt vmcnt(0)
  s_branch FL_g_chk
FL_m_f0:
  s_mov_b64 exec, vcc
  buffer_load_dwordx4 v[48:51], v3, s[4:7], s41 offen offset:0 sc1
  s_mov_b64 exec, -1
  s_waitcnt vmcnt(1)
  s_branch FL_m_0123_c1
FL_m_f1:
  s_mov_b64 exec, vcc
  buffer_load_dwordx4 v[52:55], v3, s[4:7], s41 offen offset:1024 sc1
  s_mov_b64 exec, -1
  s_waitcnt vmcnt(1)
  s_branch FL_m_123_c2
FL_m_f2:
  s_mov_b64 exec, vcc
  buffer_load_dwordx4 v[56:59], v3, s[4:7], s41 offen offset:2048 sc1
  s_mov_b64 exec, -1
  s_waitcnt vmcnt(1)
  s_branch FL_m_23_c3
FL_m_f3:
  s_mov_b64 exec, vcc
  buffer_load_dwordx4 v[60:63], v3, s[4:7], s41 offen offset:3072 sc1
  s_mov_b64 exec, -1
  s_nop 7
  s_branch FL_m_3_c3
FL_m_0_c0:
  v_max3_u32 v31, v48, v49, v50
  v_max_u32 v31, v31, v51
  v_cmp_eq_u32 vcc, -1, v31
  s_cbranch_vccz FL_m_0_ok0
FL_m_0_x0:
  s_mov_b64 exec, vcc
  buffer_load_dwordx4 v[48:51], v3, s[4:7], s41 offen offset:0 sc1
  s_mov_b64 exec, -1
  s_add_u32 s46, s46, 1
  s_cmp_ge_u32 s46, 131072
  s_cbranch_scc1 FL_rec_abort
  s_waitcnt vmcnt(2)
  s_branch FL_m_0_c0
FL_m_0_ok0:
  v_smfmac_f32_16x16x64_bf16 v[64:67], v[48:51], a[0:7], v23
  v_smfmac_f32_16x16x64_bf16 v[68:71], v[48:51], a[8:15], v23
  v_smfmac_f32_16x16x64_bf16 v[72:75], v[48:51], a[16:23], v23
  v_smfmac_f32_16x16x64_bf16 v[76:79], v[48:51], a[24:31], v23
  s_branch FL_m_done
FL_m_1_c1:
  v_max3_u32 v31, v52, v53, v54
  v_max_u32 v31, v31, v55
  v_cmp_eq_u32 vcc, -1, v31
  s_cbranch_vccz FL_m_1_ok1
FL_m_1_x1:
  s_mov_b64 exec, vcc
  buffer_load_dwordx4 v[52:55], v3, s[4:7], s41 offen offset:1024 sc1
  s_mov_b64 exec, -1
  s_add_u32 s46, s46, 1
  s_cmp_ge_u32 s46, 131072
  s_cbranch_scc1 FL_rec_abort
  s_waitcnt vmcnt(2)
  s_branch FL_m_1_c1
FL_m_1_ok1:
  v_smfmac_f32_16x16x64_bf16 v[64:67], v[52:55], a[48:55], v23
  v_smfmac_f32_16x16x64_bf16 v[68:71], v[52:55], a[56:63], v23
  v_smfmac_f32_16x16x64_bf16 v[72:75], v[52:55], a[64:71], v23
  v_smfmac_f32_16x16x64_bf16 v[76:79], v[52:55], a[72:79], v23
  s_branch FL_m_done
FL_m_2_c2:
  v_max3_u32 v31, v56, v57, v58
  v_max_u32 v31, v31, v59
  v_cmp_eq_u32 vcc, -1, v31
  s_cbranch_vccz FL_m_2_ok2
FL_m_2_x2:
  s_mov_b64 exec, vcc
  buffer_load_dwordx4 v[56:59], v3, s[4:7], s41 offen offset:2048 sc1
  s_mov_b64 exec, -1
  s_add_u32 s46, s46, 1
  s_cmp_ge_u32 s46, 131072
  s_cbranch_scc1 FL_rec_abort
  s_waitcnt vmcnt(2)
  s_branch FL_m_2_c2
FL_m_2_ok2:
  v_smfmac_f32_16x16x64_bf16 v[64:67], v[56:59], a[96:103], v23
  v_smfmac_f32_16x16x64_bf16 v[68:71], v[56:59], a[104:111], v23
  v_smfmac_f32_16x16x64_bf16 v[72:75], v[56:59], a[112:119], v23
  v_smfmac_f32_16x16x64_bf16 v[76:79], v[56:59], a[120:127], v23
  s_branch FL_m_done
FL_m_3_c3:
  v_max3_u32 v31, v60, v61, v62
  v_max_u32 v31, v31, v63
  v_cmp_eq_u32 vcc, -1, v31
  s_cbranch_vccz FL_m_3_ok3
FL_m_3_x3:
  s_mov_b64 exec, vcc
  buffer_load_dwordx4 v[60:63], v3, s[4:7], s41 offen offset:3072 sc1
  s_mov_b64 exec, -1
  s_add_u32 s46, s46, 1
  s_cmp_ge_u32 s46, 131072
  s_cbranch_scc1 FL_rec_abort
  s_waitcnt vmcnt(2)
  s_branch FL_m_3_c3
FL_m_3_ok3:
  v_smfmac_f32_16x16x64_bf16 v[64:67], v[60:63], a[144:151], v23
  v_smfmac_f32_16x16x64_bf16 v[68:71], v[60:63], a[152:159], v23
  v_smfmac_f32_16x16x64_bf16 v[72:75], v[60:63], a[160:167], v23
  v_smfmac_f32_16x16x64_bf16 v[76:79], v[60:63], a[168:175], v23
  s_branch FL_m_done
FL_m_01_c0:
  v_max3_u32 v31, v48, v49, v50
  v_max_u32 v31, v31, v51
  v_cmp_eq_u32 vcc, -1, v31
  s_cbranch_vccz FL_m_01_ok0
FL_m_01_x0:
  s_mov_b64 exec, vcc
  buffer_load_dwordx4 v[48:51], v3, s[4:7], s41 offen offset:0 sc1
  s_mov_b64 exec, -1
FL_m_01_c1:
  v_max3_u32 v31, v52, v53, v54
  v_max_u32 v31, v31, v55
  v_cmp_eq_u32 vcc, -1, v31
  s_cbranch_vccz FL_m_01_ok1
FL_m_01_x1:
  s_mov_b64 exec, vcc
  buffer_load_dwordx4 v[52:55], v3, s[4:7], s41 offen offset:1024 sc1
  s_mov_b64 exec, -1
  s_add_u32 s46, s46, 1
  s_cmp_ge_u32 s46, 131072
  s_cbranch_scc1 FL_rec_abort
  s_waitcnt vmcnt(4)
  s_branch FL_m_01_c0
FL_m_01_ok0:
  v_smfmac_f32_16x16x64_bf16 v[64:67], v[48:51], a[0:7], v23
  v_max3_u32 v31, v52, v53, v54
  v_max_u32 v31, v31, v55
  v_cmp_eq_u32 vcc, -1, v31
  v_smfmac_f32_16x16x64_bf16 v[68:71], v[48:51], a[8:15], v23
  v_smfmac_f32_16x16x64_bf16 v[72:75], v[48:51], a[16:23], v23
  v_smfmac_f32_16x16x64_bf16 v[76:79], v[48:51], a[24:31], v23
  s_cbranch_vccz FL_m_1_ok1
  s_branch FL_m_1_x1
FL_m_01_ok1:
  v_smfmac_f32_16x16x64_bf16 v[64:67], v[52:55], a[48:55], v23
  v_max3_u32 v31, v48, v49, v50
  v_max_u32 v31, v31, v51
  v_cmp_eq_u32 vcc, -1, v31
  v_smfmac_f32_16x16x64_bf16 v[68:71], v[52:55], a[56:63], v23
  v_smfmac_f32_16x16x64_bf16 v[72:75], v[52:55], a[64:71], v23
  v_smfmac_f32_16x16x64_bf16 v[76:79], v[52:55], a[72:79], v23
  s_cbranch_vccz FL_m_0_ok0
  s_branch FL_m_0_x0
FL_m_02_c0:
  v_max3_u32 v31, v48, v49, v50
  v_max_u32 v31, v31, v51
  v_cmp_eq_u32 vcc, -1, v31
  s_cbranch_vccz FL_m_02_ok0
FL_m_02_x0:
  s_mov_b64 exec, vcc
  buffer_load_dwordx4 v[48:51], v3, s[4:7], s41 offen offset:0 sc1
  s_mov_b64 exec, -1
FL_m_02_c2:
  v_max3_u32 v31, v56, v57, v58
  v_max_u32 v31, v31, v59
  v_cmp_eq_u32 vcc, -1, v31
  s_cbranch_vccz FL_m_02_ok2
FL_m_02_x2:
  s_mov_b64 exec, vcc
  buffer_load_dwordx4 v[56:59], v3, s[4:7], s41 offen offset:2048 sc1
  s_mov_b64 exec, -1
  s_add_u32 s46, s46, 1
  s_cmp_ge_u32 s46, 131072
  s_cbranch_scc1 FL_rec_abort
  s_waitcnt vmcnt(4)
  s_branch FL_m_02_c0
FL_m_02_ok0:
  v_smfmac_f32_16x16x64_bf16 v[64:67], v[48:51], a[0:7], v23
  v_max3_u32 v31, v56, v57, v58
  v_max_u32 v31, v31, v59
  v_cmp_eq_u32 vcc, -1, v31
  v_smfmac_f32_16x16x64_bf16 v[68:71], v[48:51], a[8:15], v23
  v_smfmac_f32_16x16x64_bf16 v[72:75], v[48:51], a[16:23], v23
  v_smfmac_f32_16x16x64_bf16 v[76:79], v[48:51], a[24:31], v23
  s_cbranch_vccz FL_m_2_ok2
  s_branch FL_m_2_x2
FL_m_02_ok2:
  v_smfmac_f32_16x16x64_bf16 v[64:67], v[56:59], a[96:103], v23
  v_max3_u32 v31, v48, v49, v50
  v_max_u32 v31, v31, v51
  v_cmp_eq_u32 vcc, -1, v31
  v_smfmac_f32_16x16x64_bf16 v[68:71], v[56:59], a[104:111], v23
  v_smfmac_f32_16x16x64_bf16 v[72:75], v[56:59], a[112:119], v23
  v_smfmac_f32_16x16x64_bf16 v[76:79], v[56:59], a[120:127], v23
  s_cbranch_vccz FL_m_0_ok0
  s_branch FL_m_0_x0
FL_m_03_c0:
  v_max3_u32 v31, v48, v49, v50
  v_max_u32 v31, v31, v51
  v_cmp_eq_u32 vcc, -1, v31
  s_cbranch_vccz FL_m_03_ok0
FL_m_03_x0:
  s_mov_b64 exec, vcc
  buffer_load_dwordx4 v[48:51], v3, s[4:7], s41 offen offset:0 sc1
  s_mov_b64 exec, -1
FL_m_03_c3:
  v_max3_u32 v31, v60, v61, v62
  v_max_u32 v31, v31, v63
  v_cmp_eq_u32 vcc, -1, v31
  s_cbranch_vccz FL_m_03_ok3
FL_m_03_x3:
  s_mov_b64 exec, vcc
  buffer_load_dwordx4 v[60:63], v3, s[4:7], s41 offen offset:3072 sc1
  s_mov_b64 exec, -1
  s_add_u32 s46, s46, 1
  s_cmp_ge_u32 s46, 131072
  s_cbranch_scc1 FL_rec_abort
  s_waitcnt vmcnt(4)
  s_branch FL_m_03_c0
FL_m_03_ok0:
  v_smfmac_f32_16x16x64_bf16 v[64:67], v[48:51], a[0:7], v23
  v_max3_u32 v31, v60, v61, v62
  v_max_u32 v31, v31, v63
  v_cmp_eq_u32 vcc, -1, v31
  v_smfmac_f32_16x16x64_bf16 v[68:71], v[48:51], a[8:15], v23
  v_smfmac_f32_16x16x64_bf16 v[72:75], v[48:51], a[16:23], v23
  v_smfmac_f32_16x16x64_bf16 v[76:79], v[48:51], a[24:31], v23
  s_cbranch_vccz FL_m_3_ok3
  s_branch FL_m_3_x3
FL_m_03_ok3:
  v_smfmac_f32_16x16x64_bf16 v[64:67], v[60:63], a[144:151], v23
  v_max3_u32 v31, v48, v49, v50
  v_max_u32 v31, v31, v51
  v_cmp_eq_u32 vcc, -1, v31
  v_smfmac_f32_16x16x64_bf16 v[68:71], v[60:63], a[152:159], v23
  v_smfmac_f32_16x16x64_bf16 v[72:75], v[60:63], a[160:167], v23
  v_smfmac_f32_16x16x64_bf16 v[76:79], v[60:63], a[168:175], v23
  s_cbranch_vccz FL_m_0_ok0
  s_branch FL_m_0_x0
FL_m_12_c1:
  v_max3_u32 v31, v52, v53, v54
  v_max_u32 v31, v31, v55
  v_cmp_eq_u32 vcc, -1, v31
  s_cbranch_vccz FL_m_12_ok1
FL_m_12_x1:
  s_mov_b64 exec, vcc
  buffer_load_dwordx4 v[52:55], v3, s[4:7], s41 offen offset:1024 sc1
  s_mov_b64 exec, -1
FL_m_12_c2:
  v_max3_u32 v31, v56, v57, v58
  v_max_u32 v31, v31, v59
  v_cmp_eq_u32 vcc, -1, v31
  s_cbranch_vccz FL_m_12_ok2
FL_m_12_x2:
  s_mov_b64 exec, vcc
  buffer_load_dwordx4 v[56:59], v3, s[4:7], s41 offen offset:2048 sc1
  s_mov_b64 exec, -1
  s_add_u32 s46, s46, 1
  s_cmp_ge_u32 s46, 131072
  s_cbranch_scc1 FL_rec_abort
  s_waitcnt vmcnt(4)
  s_branch FL_m_12_c1
FL_m_12_ok1:
  v_smfmac_f32_16x16x64_bf16 v[64:67], v[52:55], a[48:55], v23
  v_max3_u32 v31, v56, v57, v58
  v_max_u32 v31, v31, v59
  v_cmp_eq_u32 vcc, -1, v31
  v_smfmac_f32_16x16x64_bf16 v[68:71], v[52:55], a[56:63], v23
  v_smfmac_f32_16x16x64_bf16 v[72:75], v[52:55], a[64:71], v23
  v_smfmac_f32_16x16x64_bf16 v[76:79], v[52:55], a[72:79], v23
  s_cbranch_vccz FL_m_2_ok2
  s_branch FL_m_2_x2
FL_m_12_ok2:
  v_smfmac_f32_16x16x64_bf16 v[64:67], v[56:59], a[96:103], v23
  v_max3_u32 v31, v52, v53, v54
  v_max_u32 v31, v31, v55
  v_cmp_eq_u32 vcc, -1, v31
  v_smfmac_f32_16x16x64_bf16 v[68:71], v[56:59], a[104:111], v23
  v_smfmac_f32_16x16x64_bf16 v[72:75], v[56:59], a[112:119], v23
  v_smfmac_f32_16x16x64_bf16 v[76:79], v[56:59], a[120:127], v23
  s_cbranch_vccz FL_m_1_ok1
  s_branch FL_m_1_x1
FL_m_13_c1:
  v_max3_u32 v31, v52, v53, v54
  v_max_u32 v31, v31, v55
  v_cmp_eq_u32 vcc, -1, v31
  s_cbranch_vccz FL_m_13_ok1
FL_m_13_x1:
  s_mov_b64 exec, vcc
  buffer_load_dwordx4 v[52:55], v3, s[4:7], s41 offen offset:1024 sc1
  s_mov_b64 exec, -1
FL_m_13_c3:
  v_max3_u32 v31, v60, v61, v62
  v_max_u32 v31, v31, v63
  v_cmp_eq_u32 vcc, -1, v31
  s_cbranch_vccz FL_m_13_ok3
FL_m_13_x3:
  s_mov_b64 exec, vcc
  buffer_load_dwordx4 v[60:63], v3, s[4:7], s41 offen offset:3072 sc1
  s_mov_b64 exec, -1
  s_add_u32 s46, s46, 1
  s_cmp_ge_u32 s46, 131072
  s_cbranch_scc1 FL_rec_abort
  s_waitcnt vmcnt(4)
  s_branch FL_m_13_c1
FL_m_13_ok1:
  v_smfmac_f32_16x16x64_bf16 v[64:67], v[52:55], a[48:55], v23
  v_max3_u32 v31, v60, v61, v62
  v_max_u32 v31, v31, v63
  v_cmp_eq_u32 vcc, -1, v31
  v_smfmac_f32_16x16x64_bf16 v[68:71], v[52:55], a[56:63], v23
  v_smfmac_f32_16x16x64_bf16 v[72:75], v[52:55], a[64:71], v23
  v_smfmac_f32_16x16x64_bf16 v[76:79], v[52:55], a[72:79], v23
  s_cbranch_vccz FL_m_3_ok3
  s_branch FL_m_3_x3
FL_m_13_ok3:
  v_smfmac_f32_16x16x64_bf16 v[64:67], v[60:63], a[144:151], v23
  v_max3_u32 v31, v52, v53, v54
  v_max_u32 v31, v31, v55
  v_cmp_eq_u32 vcc, -1, v31
  v_smfmac_f32_16x16x64_bf16 v[68:71], v[60:63], a[152:159], v23
  v_smfmac_f32_16x16x64_bf16 v[72:75], v[60:63], a[160:167], v23
  v_smfmac_f32_16x16x64_bf16 v[76:79], v[60:63], a[168:175], v23
  s_cbranch_vccz FL_m_1_ok1
  s_branch FL_m_1_x1
FL_m_23_c2:
  v_max3_u32 v31, v56, v57, v58
  v_max_u32 v31, v31, v59
  v_cmp_eq_u32 vcc, -1, v31
  s_cbranch_vccz FL_m_23_ok2
FL_m_23_x2:
  s_mov_b64 exec, vcc
  buffer_load_dwordx4 v[56:59], v3, s[4:7], s41 offen offset:2048 sc1
  s_mov_b64 exec, -1
FL_m_23_c3:
  v_max3_u32 v31, v60, v61, v62
  v_max_u32 v31, v31, v63
  v_cmp_eq_u32 vcc, -1, v31
  s_cbranch_vccz FL_m_23_ok3
FL_m_23_x3:
  s_mov_b64 exec, vcc
  buffer_load_dwordx4 v[60:63], v3, s[4:7], s41 offen offset:3072 sc1
  s_mov_b64 exec, -1
  s_add_u32 s46, s46, 1
  s_cmp_ge_u32 s46, 131072
  s_cbranch_scc1 FL_rec_abort
  s_waitcnt vmcnt(4)
  s_branch FL_m_23_c2
FL_m_23_ok2:
  v_smfmac_f32_16x16x64_bf16 v[64:67], v[56:59], a[96:103], v23
  v_max3_u32 v31, v60, v61, v62
  v_max_u32 v31, v31, v63
  v_cmp_eq_u32 vcc, -1, v31
  v_smfmac_f32_16x16x64_bf16 v[68:71], v[56:59], a[104:111], v23
  v_smfmac_f32_16x16x64_bf16 v[72:75], v[56:59], a[112:119], v23
  v_smfmac_f32_16x16x64_bf16 v[76:79], v[56:59], a[120:127], v23
  s_cbranch_vccz FL_m_3_ok3
  s_branch FL_m_3_x3
FL_m_23_ok3:
  v_smfmac_f32_16x16x64_bf16 v[64:67], v[60:63], a[144:151], v23
  v_max3_u32 v31, v56, v57, v58
  v_max_u32 v31, v31, v59
  v_cmp_eq_u32 vcc, -1, v31
  v_smfmac_f32_16x16x64_bf16 v[68:71], v[60:63], a[152:159], v23
  v_smfmac_f32_16x16x64_bf16 v[72:75], v[60:63], a[160:167], v23
  v_smfmac_f32_16x16x64_bf16 v[76:79], v[60:63], a[168:175], v23
  s_cbranch_vccz FL_m_2_ok2
  s_branch FL_m_2_x2
FL_m_012_c0:
  v_max3_u32 v31, v48, v49, v50
  v_max_u32 v31, v31, v51
  v_cmp_eq_u32 vcc, -1, v31
  s_cbranch_vccz FL_m_012_ok0
FL_m_012_x0:
  s_mov_b64 exec, vcc
  buffer_load_dwordx4 v[48:51], v3, s[4:7], s41 offen offset:0 sc1
  s_mov_b64 exec, -1
FL_m_012_c1:
  v_max3_u32 v31, v52, v53, v54
  v_max_u32 v31, v31, v55
  v_cmp_eq_u32 vcc, -1, v31
  s_cbranch_vccz FL_m_012_ok1
FL_m_012_x1:
  s_mov_b64 exec, vcc
  buffer_load_dwordx4 v[52:55], v3, s[4:7], s41 offen offset:1024 sc1
  s_mov_b64 exec, -1
FL_m_012_c2:
  v_max3_u32 v31, v56, v57, v58
  v_max_u32 v31, v31, v59
  v_cmp_eq_u32 vcc, -1, v31
  s_cbranch_vccz FL_m_012_ok2
FL_m_012_x2:
  s_mov_b64 exec, vcc
  buffer_load_dwordx4 v[56:59], v3, s[4:7], s41 offen offset:2048 sc1
  s_mov_b64 exec, -1
  s_add_u32 s46, s46, 1
  s_cmp_ge_u32 s46, 131072
  s_cbranch_scc1 FL_rec_abort
  s_waitcnt vmcnt(4)
  s_branch FL_m_012_c0
FL_m_012_ok0:
  v_smfmac_f32_16x16x64_bf16 v[64:67], v[48:51], a[0:7], v23
  v_max3_u32 v31, v52, v53, v54
  v_max_u32 v31, v31, v55
  v_cmp_eq_u32 vcc, -1, v31
  v_smfmac_f32_16x16x64_bf16 v[68:71], v[48:51], a[8:15], v23
  v_smfmac_f32_16x16x64_bf16 v[72:75], v[48:51], a[16:23], v23
  v_smfmac_f32_16x16x64_bf16 v[76:79], v[48:51], a[24:31], v23
  s_cbranch_vccz FL_m_12_ok1
  s_branch FL_m_12_x1
FL_m_012_ok1:
  v_smfmac_f32_16x16x64_bf16 v[64:67], v[52:55], a[48:55], v23
  v_max3_u32 v31, v56, v57, v58
  v_max_u32 v31, v31, v59
  v_cmp_eq_u32 vcc, -1, v31
  v_smfmac_f32_16x16x64_bf16 v[68:71], v[52:55], a[56:63], v23
  v_smfmac_f32_16x16x64_bf16 v[72:75], v[52:55], a[64:71], v23
  v_smfmac_f32_16x16x64_bf16 v[76:79], v[52:55], a[72:79], v23
  s_cbranch_vccz FL_m_02_ok2
  s_branch FL_m_02_x2
FL_m_012_ok2:
  v_smfmac_f32_16x16x64_bf16 v[64:67], v[56:59], a[96:103], v23
  v_max3_u32 v31, v48, v49, v50
  v_max_u32 v31, v31, v51
  v_cmp_eq_u32 vcc, -1, v31
  v_smfmac_f32_16x16x64_bf16 v[68:71], v[56:59], a[104:111], v23
  v_smfmac_f32_16x16x64_bf16 v[72:75], v[56:59], a[112:119], v23
  v_smfmac_f32_16x16x64_bf16 v[76:79], v[56:59], a[120:127], v23
  s_cbranch_vccz FL_m_01_ok0
  s_branch FL_m_01_x0
FL_m_013_c0:
  v_max3_u32 v31, v48, v49, v50
  v_max_u32 v31, v31, v51
  v_cmp_eq_u32 vcc, -1, v31
  s_cbranch_vccz FL_m_013_ok0
FL_m_013_x0:
  s_mov_b64 exec, vcc
  buffer_load_dwordx4 v[48:51], v3, s[4:7], s41 offen offset:0 sc1
  s_mov_b64 exec, -1
FL_m_013_c1:
  v_max3_u32 v31, v52, v53, v54
  v_max_u32 v31, v31, v55
  v_cmp_eq_u32 vcc, -1, v31
  s_cbranch_vccz FL_m_013_ok1
FL_m_013_x1:
  s_mov_b64 exec, vcc
  buffer_load_dwordx4 v[52:55], v3, s[4:7], s41 offen offset:1024 sc1
  s_mov_b64 exec, -1
FL_m_013_c3:
  v_max3_u32 v31, v60, v61, v62
  v_max_u32 v31, v31, v63
  v_cmp_eq_u32 vcc, -1, v31
  s_cbranch_vccz FL_m_013_ok3
FL_m_013_x3:
  s_mov_b64 exec, vcc
  buffer_load_dwordx4 v[60:63], v3, s[4:7], s41 offen offset:3072 sc1
  s_mov_b64 exec, -1
  s_add_u32 s46, s46, 1
  s_cmp_ge_u32 s46, 131072
  s_cbranch_scc1 FL_rec_abort
  s_waitcnt vmcnt(4)
  s_branch FL_m_013_c0
FL_m_013_ok0:
  v_smfmac_f32_16x16x64_bf16 v[64:67], v[48:51], a[0:7], v23
  v_max3_u32 v31, v52, v53, v54
  v_max_u32 v31, v31, v55
  v_cmp_eq_u32 vcc, -1, v31
  v_smfmac_f32_16x16x64_bf16 v[68:71], v[48:51], a[8:15], v23
  v_smfmac_f32_16x16x64_bf16 v[72:75], v[48:51], a[16:23], v23
  v_smfmac_f32_16x16x64_bf16 v[76:79], v[48:51], a[24:31], v23
  s_cbranch_vccz FL_m_13_ok1
  s_branch FL_m_13_x1
FL_m_013_ok1:
  v_smfmac_f32_16x16x64_bf16 v[64:67], v[52:55], a[48:55], v23
  v_max3_u32 v31, v60, v61, v62
  v_max_u32 v31, v31, v63
  v_cmp_eq_u32 vcc, -1, v31
  v_smfmac_f32_16x16x64_bf16 v[68:71], v[52:55], a[56:63], v23
  v_smfmac_f32_16x16x64_bf16 v[72:75], v[52:55], a[64:71], v23
  v_smfmac_f32_16x16x64_bf16 v[76:79], v[52:55], a[72:79], v23
  s_cbranch_vccz FL_m_03_ok3
  s_branch FL_m_03_x3
FL_m_013_ok3:
  v_smfmac_f32_16x16x64_bf16 v[64:67], v[60:63], a[144:151], v23
  v_max3_u32 v31, v48, v49, v50
  v_max_u32 v31, v31, v51
  v_cmp_eq_u32 vcc, -1, v31
  v_smfmac_f32_16x16x64_bf16 v[68:71], v[60:63], a[152:159], v23
  v_smfmac_f32_16x16x64_bf16 v[72:75], v[60:63], a[160:167], v23
  v_smfmac_f32_16x16x64_bf16 v[76:79], v[60:63], a[168:175], v23
  s_cbranch_vccz FL_m_01_ok0
  s_branch FL_m_01_x0
FL_m_023_c0:
  v_max3_u32 v31, v48, v49, v50
  v_max_u32 v31, v31, v51
  v_cmp_eq_u32 vcc, -1, v31
  s_cbranch_vccz FL_m_023_ok0
FL_m_023_x0:
  s_mov_b64 exec, vcc
  buffer_load_dwordx4 v[48:51], v3, s[4:7], s41 offen offset:0 sc1
  s_mov_b64 exec, -1
FL_m_023_c2:
  v_max3_u32 v31, v56, v57, v58
  v_max_u32 v31, v31, v59
  v_cmp_eq_u32 vcc, -1, v31
  s_cbranch_vccz FL_m_023_ok2
FL_m_023_x2:
  s_mov_b64 exec, vcc
  buffer_load_dwordx4 v[56:59], v3, s[4:7], s41 offen offset:2048 sc1
  s_mov_b64 exec, -1
FL_m_023_c3:
  v_max3_u32 v31, v60, v61, v62
  v_max_u32 v31, v31, v63
  v_cmp_eq_u32 vcc, -1, v31
  s_cbranch_vccz FL_m_023_ok3
FL_m_023_x3:
  s_mov_b64 exec, vcc
  buffer_load_dwordx4 v[60:63], v3, s[4:7], s41 offen offset:3072 sc1
  s_mov_b64 exec, -1
  s_add_u32 s46, s46, 1
  s_cmp_ge_u32 s46, 131072
  s_cbranch_scc1 FL_rec_abort
  s_waitcnt vmcnt(4)
  s_branch FL_m_023_c0
FL_m_023_ok0:
  v_smfmac_f32_16x16x64_bf16 v[64:67], v[48:51], a[0:7], v23
  v_max3_u32 v31, v56, v57, v58
  v_max_u32 v31, v31, v59
  v_cmp_eq_u32 vcc, -1, v31
  v_smfmac_f32_16x16x64_bf16 v[68:71], v[48:51], a[8:15], v23
  v_smfmac_f32_16x16x64_bf16 v[72:75], v[48:51], a[16:23], v23
  v_smfmac_f32_16x16x64_bf16 v[76:79], v[48:51], a[24:31], v23
  s_cbranch_vccz FL_m_23_ok2
  s_branch FL_m_23_x2
FL_m_023_ok2:
  v_smfmac_f32_16x16x64_bf16 v[64:67], v[56:59], a[96:103], v23
  v_max3_u32 v31, v60, v61, v62
  v_max_u32 v31, v31, v63
  v_cmp_eq_u32 vcc, -1, v31
  v_smfmac_f32_16x16x64_bf16 v[68:71], v[56:59], a[104:111], v23
  v_smfmac_f32_16x16x64_bf16 v[72:75], v[56:59], a[112:119], v23
  v_smfmac_f32_16x16x64_bf16 v[76:79], v[56:59], a[120:127], v23
  s_cbranch_vccz FL_m_03_ok3
  s_branch FL_m_03_x3
FL_m_023_ok3:
  v_smfmac_f32_16x16x64_bf16 v[64:67], v[60:63], a[144:151], v23
  v_max3_u32 v31, v48, v49, v50
  v_max_u32 v31, v31, v51
  v_cmp_eq_u32 vcc, -1, v31
  v_smfmac_f32_16x16x64_bf16 v[68:71], v[60:63], a[152:159], v23
  v_smfmac_f32_16x16x64_bf16 v[72:75], v[60:63], a[160:167], v23
  v_smfmac_f32_16x16x64_bf16 v[76:79], v[60:63], a[168:175], v23
  s_cbranch_vccz FL_m_02_ok0
  s_branch FL_m_02_x0
FL_m_123_c1:
  v_max3_u32 v31, v52, v53, v54
  v_max_u32 v31, v31, v55
  v_cmp_eq_u32 vcc, -1, v31
  s_cbranch_vccz FL_m_123_ok1
FL_m_123_x1:
  s_mov_b64 exec, vcc
  buffer_load_dwordx4 v[52:55], v3, s[4:7], s41 offen offset:1024 sc1
  s_mov_b64 exec, -1
FL_m_123_c2:
  v_max3_u32 v31, v56, v57, v58
  v_max_u32 v31, v31, v59
  v_cmp_eq_u32 vcc, -1, v31
  s_cbranch_vccz FL_m_123_ok2
FL_m_123_x2:
  s_mov_b64 exec, vcc
  buffer_load_dwordx4 v[56:59], v3, s[4:7], s41 offen offset:2048 sc1
  s_mov_b64 exec, -1
FL_m_123_c3:
  v_max3_u32 v31, v60, v61, v62
  v_max_u32 v31, v31, v63
  v_cmp_eq_u32 vcc, -1, v31
  s_cbranch_vccz FL_m_123_ok3
FL_m_123_x3:
  s_mov_b64 exec, vcc
  buffer_load_dwordx4 v[60:63], v3, s[4:7], s41 offen offset:3072 sc1
  s_mov_b64 exec, -1
  s_add_u32 s46, s46, 1
  s_cmp_ge_u32 s46, 131072
  s_cbranch_scc1 FL_rec_abort
  s_waitcnt vmcnt(4)
  s_branch FL_m_123_c1
FL_m_123_ok1:
  v_smfmac_f32_16x16x64_bf16 v[64:67], v[52:55], a[48:55], v23
  v_max3_u32 v31, v56, v57, v58
  v_max_u32 v31, v31, v59
  v_cmp_eq_u32 vcc, -1, v31
  v_smfmac_f32_16x16x64_bf16 v[68:71], v[52:55], a[56:63], v23
  v_smfmac_f32_16x16x64_bf16 v[72:75], v[52:55], a[64:71], v23
  v_smfmac_f32_16x16x64_bf16 v[76:79], v[52:55], a[72:79], v23
  s_cbranch_vccz FL_m_23_ok2
  s_branch FL_m_23_x2
FL_m_123_ok2:
  v_smfmac_f32_16x16x64_bf16 v[64:67], v[56:59], a[96:103], v23
  v_max3_u32 v31, v60, v61, v62
  v_max_u32 v31, v31, v63
  v_cmp_eq_u32 vcc, -1, v31
  v_smfmac_f32_16x16x64_bf16 v[68:71], v[56:59], a[104:111], v23
  v_smfmac_f32_16x16x64_bf16 v[72:75], v[56:59], a[112:119], v23
  v_smfmac_f32_16x16x64_bf16 v[76:79], v[56:59], a[120:127], v23
  s_cbranch_vccz FL_m_13_ok3
  s_branch FL_m_13_x3
FL_m_123_ok3:
  v_smfmac_f32_16x16x64_bf16 v[64:67], v[60:63], a[144:151], v23
  v_max3_u32 v31, v52, v53, v54
  v_max_u32 v31, v31, v55
  v_cmp_eq_u32 vcc, -1, v31
  v_smfmac_f32_16x16x64_bf16 v[68:71], v[60:63], a[152:159], v23
  v_smfmac_f32_16x16x64_bf16 v[72:75], v[60:63], a[160:167], v23
  v_smfmac_f32_16x16x64_bf16 v[76:79], v[60:63], a[168:175], v23
  s_cbranch_vccz FL_m_12_ok1
  s_branch FL_m_12_x1
FL_m_0123_c0:
  v_max3_u32 v31, v48, v49, v50
  v_max_u32 v31, v31, v51
  v_cmp_eq_u32 vcc, -1, v31
  s_cbranch_vccz FL_m_0123_ok0
FL_m_0123_x0:
  s_mov_b64 exec, vcc
  buffer_load_dwordx4 v[48:51], v3, s[4:7], s41 offen offset:0 sc1
  s_mov_b64 exec, -1
FL_m_0123_c1:
  v_max3_u32 v31, v52, v53, v54
  v_max_u32 v31, v31, v55
  v_cmp_eq_u32 vcc, -1, v31
  s_cbranch_vccz FL_m_0123_ok1
FL_m_0123_x1:
  s_mov_b64 exec, vcc
  buffer_load_dwordx4 v[52:55], v3, s[4:7], s41 offen offset:1024 sc1
  s_mov_b64 exec, -1
FL_m_0123_c2:
  v_max3_u32 v31, v56, v57, v58
  v_max_u32 v31, v31, v59
  v_cmp_eq_u32 vcc, -1, v31
  s_cbranch_vccz FL_m_0123_ok2
FL_m_0123_x2:
  s_mov_b64 exec, vcc
  buffer_load_dwordx4 v[56:59], v3, s[4:7], s41 offen offset:2048 sc1
  s_mov_b64 exec, -1
FL_m_0123_c3:
  v_max3_u32 v31, v60, v61, v62
  v_max_u32 v31, v31, v63
  v_cmp_eq_u32 vcc, -1, v31
  s_cbranch_vccz FL_m_0123_ok3
FL_m_0123_x3:
  s_mov_b64 exec, vcc
  buffer_load_dwordx4 v[60:63], v3, s[4:7], s41 offen offset:3072 sc1
  s_mov_b64 exec, -1
  s_add_u32 s46, s46, 1
  s_cmp_ge_u32 s46, 131072
  s_cbranch_scc1 FL_rec_abort
  s_waitcnt vmcnt(4)
  s_branch FL_m_0123_c0
FL_m_0123_ok0:
  v_smfmac_f32_16x16x64_bf16 v[64:67], v[48:51], a[0:7], v23
  v_max3_u32 v31, v52, v53, v54
  v_max_u32 v31, v31, v55
  v_cmp_eq_u32 vcc, -1, v31
  v_smfmac_f32_16x16x64_bf16 v[68:71], v[48:51], a[8:15], v23
  v_smfmac_f32_16x16x64_bf16 v[72:75], v[48:51], a[16:23], v23
  v_smfmac_f32_16x16x64_bf16 v[76:79], v[48:51], a[24:31], v23
  s_cbranch_vccz FL_m_123_ok1
  s_branch FL_m_123_x1
FL_m_0123_ok1:
  v_smfmac_f32_16x16x64_bf16 v[64:67], v[52:55], a[48:55], v23
  v_max3_u32 v31, v56, v57, v58
  v_max_u32 v31, v31, v59
  v_cmp_eq_u32 vcc, -1, v31
  v_smfmac_f32_16x16x64_bf16 v[68:71], v[52:55], a[56:63], v23
  v_smfmac_f32_16x16x64_bf16 v[72:75], v[52:55], a[64:71], v23
  v_smfmac_f32_16x16x64_bf16 v[76:79], v[52:55], a[72:79], v23
  s_cbranch_vccz FL_m_023_ok2
  s_branch FL_m_023_x2
FL_m_0123_ok2:
  v_smfmac_f32_16x16x64_bf16 v[64:67], v[56:59], a[96:103], v23
  v_max3_u32 v31, v60, v61, v62
  v_max_u32 v31, v31, v63
  v_cmp_eq_u32 vcc, -1, v31
  v_smfmac_f32_16x16x64_bf16 v[68:71], v[56:59], a[104:111], v23
  v_smfmac_f32_16x16x64_bf16 v[72:75], v[56:59], a[112:119], v23
  v_smfmac_f32_16x16x64_bf16 v[76:79], v[56:59], a[120:127], v23
  s_cbranch_vccz FL_m_013_ok3
  s_branch FL_m_013_x3
FL_m_0123_ok3:
  v_smfmac_f32_16x16x64_bf16 v[64:67], v[60:63], a[144:151], v23
  v_max3_u32 v31, v48, v49, v50
  v_max_u32 v31, v31, v51
  v_cmp_eq_u32 vcc, -1, v31
  v_smfmac_f32_16x16x64_bf16 v[68:71], v[60:63], a[152:159], v23
  v_smfmac_f32_16x16x64_bf16 v[72:75], v[60:63], a[160:167], v23
  v_smfmac_f32_16x16x64_bf16 v[76:79], v[60:63], a[168:175], v23
  s_cbranch_vccz FL_m_012_ok0
  s_branch FL_m_012_x0
FL_x_f0:
  s_mov_b64 exec, vcc
  buffer_load_dwordx4 v[64:67], v9, s[4:7], s41 offen offset:0 sc1
  s_mov_b64 exec, -1
  s_waitcnt vmcnt(2)
  s_branch FL_x_0123_c1
FL_x_f1:
  s_mov_b64 exec, vcc
  buffer_load_dwordx4 v[68:71], v9, s[4:7], s41 offen offset:1024 sc1
  s_mov_b64 exec, -1
  s_waitcnt vmcnt(2)
  s_branch FL_x_123_c2
FL_x_f2:
  s_mov_b64 exec, vcc
  buffer_load_dwordx4 v[72:75], v9, s[4:7], s41 offen offset:2048 sc1
  s_mov_b64 exec, -1
  s_waitcnt vmcnt(2)
  s_branch FL_x_23_c3
FL_x_f3:
  s_mov_b64 exec, vcc
  buffer_load_dwordx4 v[76:79], v9, s[4:7], s41 offen offset:3072 sc1
  s_mov_b64 exec, -1
  s_nop 7
  s_branch FL_x_3_c3
FL_x_0_c0:
  v_max3_u32 v31, v64, v65, v66
  v_max_u32 v31, v31, v67
  v_cmp_eq_u32 vcc, -1, v31
  s_cbranch_vccz FL_x_0_ok0
FL_x_0_x0:
  s_mov_b64 exec, vcc
  buffer_load_dwordx4 v[64:67], v9, s[4:7], s41 offen offset:0 sc1
  s_mov_b64 exec, -1
  s_add_u32 s46, s46, 1
  s_cmp_ge_u32 s46, 131072
  s_cbranch_scc1 FL_rec_abort
  s_waitcnt vmcnt(2)
  s_branch FL_x_0_c0
FL_x_0_ok0:
  v_mfma_f32_16x16x32_bf16 v[44:47], v[64:67], v[64:67], v[44:47]
  v_mfma_f32_16x16x32_bf16 v[36:39], v[116:119], v[64:67], v[36:39]
  v_mfma_f32_16x16x32_bf16 v[40:43], v[132:135], v[64:67], v[40:43]
  s_branch FL_x_done
FL_x_1_c1:
  v_max3_u32 v31, v68, v69, v70
  v_max_u32 v31, v31, v71
  v_cmp_eq_u32 vcc, -1, v31
  s_cbranch_vccz FL_x_1_ok1
FL_x_1_x1:
  s_mov_b64 exec, vcc
  buffer_load_dwordx4 v[68:71], v9, s[4:7], s41 offen offset:1024 sc1
  s_mov_b64 exec, -1
  s_add_u32 s46, s46, 1
  s_cmp_ge_u32 s46, 131072
  s_cbranch_scc1 FL_rec_abort
  s_waitcnt vmcnt(2)
  s_branch FL_x_1_c1
FL_x_1_ok1:
  v_mfma_f32_16x16x32_bf16 v[44:47], v[68:71], v[68:71], v[44:47]
  v_mfma_f32_16x16x32_bf16 v[36:39], v[120:123], v[68:71], v[36:39]
  v_mfma_f32_16x16x32_bf16 v[40:43], v[136:139], v[68:71], v[40:43]
  s_branch FL_x_done
FL_x_2_c2:
  v_max3_u32 v31, v72, v73, v74
  v_max_u32 v31, v31, v75
  v_cmp_eq_u32 vcc, -1, v31
  s_cbranch_vccz FL_x_2_ok2
FL_x_2_x2:
  s_mov_b64 exec, vcc
  buffer_load_dwordx4 v[72:75], v9, s[4:7], s41 offen offset:2048 sc1
  s_mov_b64 exec, -1
  s_add_u32 s46, s46, 1
  s_cmp_ge_u32 s46, 131072
  s_cbranch_scc1 FL_rec_abort
  s_waitcnt vmcnt(2)
  s_branch FL_x_2_c2
FL_x_2_ok2:
  v_mfma_f32_16x16x32_bf16 v[44:47], v[72:75], v[72:75], v[44:47]
  v_mfma_f32_16x16x32_bf16 v[36:39], v[124:127], v[72:75], v[36:39]
  v_mfma_f32_16x16x32_bf16 v[40:43], v[140:143], v[72:75], v[40:43]
  s_branch FL_x_done
FL_x_3_c3:
  v_max3_u32 v31, v76, v77, v78
  v_max_u32 v31, v31, v79
  v_cmp_eq_u32 vcc, -1, v31
  s_cbranch_vccz FL_x_3_ok3
FL_x_3_x3:
  s_mov_b64 exec, vcc
  buffer_load_dwordx4 v[76:79], v9, s[4:7], s41 offen offset:3072 sc1
  s_mov_b64 exec, -1
  s_add_u32 s46, s46, 1
  s_cmp_ge_u32 s46, 131072
  s_cbranch_scc1 FL_rec_abort
  s_waitcnt vmcnt(2)
  s_branch FL_x_3_c3
FL_x_3_ok3:
  v_mfma_f32_16x16x32_bf16 v[44:47], v[76:79], v[76:79], v[44:47]
  v_mfma_f32_16x16x32_bf16 v[36:39], v[128:131], v[76:79], v[36:39]
  v_mfma_f32_16x16x32_bf16 v[40:43], v[144:147], v[76:79], v[40:43]
  s_branch FL_x_done
FL_x_01_c0:
  v_max3_u32 v31, v64, v65, v66
  v_max_u32 v31, v31, v67
  v_cmp_eq_u32 vcc, -1, v31
  s_cbranch_vccz FL_x_01_ok0
FL_x_01_x0:
  s_mov_b64 exec, vcc
  buffer_load_dwordx4 v[64:67], v9, s[4:7], s41 offen offset:0 sc1
  s_mov_b64 exec, -1
FL_x_01_c1:
  v_max3_u32 v31, v68, v69, v70
  v_max_u32 v31, v31, v71
  v_cmp_eq_u32 vcc, -1, v31
  s_cbranch_vccz FL_x_01_ok1
FL_x_01_x1:
  s_mov_b64 exec, vcc
  buffer_load_dwordx4 v[68:71], v9, s[4:7], s41 offen offset:1024 sc1
  s_mov_b64 exec, -1
  s_add_u32 s46, s46, 1
  s_cmp_ge_u32 s46, 131072
  s_cbranch_scc1 FL_rec_abort
  s_waitcnt vmcnt(4)
  s_branch FL_x_01_c0
FL_x_01_ok0:
  v_mfma_f32_16x16x32_bf16 v[44:47], v[64:67], v[64:67], v[44:47]
  v_max3_u32 v31, v68, v69, v70
  v_max_u32 v31, v31, v71
  v_cmp_eq_u32 vcc, -1, v31
  v_mfma_f32_16x16x32_bf16 v[36:39], v[116:119], v[64:67], v[36:39]
  v_mfma_f32_16x16x32_bf16 v[40:43], v[132:135], v[64:67], v[40:43]
  s_cbranch_vccz FL_x_1_ok1
  s_branch FL_x_1_x1
FL_x_01_ok1:
  v_mfma_f32_16x16x32_bf16 v[44:47], v[68:71], v[68:71], v[44:47]
  v_max3_u32 v31, v64, v65, v66
  v_max_u32 v31, v31, v67
  v_cmp_eq_u32 vcc, -1, v31
  v_mfma_f32_16x16x32_bf16 v[36:39], v[120:123], v[68:71], v[36:39]
  v_mfma_f32_16x16x32_bf16 v[40:43], v[136:139], v[68:71], v[40:43]
  s_cbranch_vccz FL_x_0_ok0
  s_branch FL_x_0_x0
FL_x_02_c0:
  v_max3_u32 v31, v64, v65, v66
  v_max_u32 v31, v31, v67
  v_cmp_eq_u32 vcc, -1, v31
  s_cbranch_vccz FL_x_02_ok0
FL_x_02_x0:
  s_mov_b64 exec, vcc
  buffer_load_dwordx4 v[64:67], v9, s[4:7], s41 offen offset:0 sc1
  s_mov_b64 exec, -1
FL_x_02_c2:
  v_max3_u32 v31, v72, v73, v74
  v_max_u32 v31, v31, v75
  v_cmp_eq_u32 vcc, -1, v31
  s_cbranch_vccz FL_x_02_ok2
FL_x_02_x2:
  s_mov_b64 exec, vcc
  buffer_load_dwordx4 v[72:75], v9, s[4:7], s41 offen offset:2048 sc1
  s_mov_b64 exec, -1
  s_add_u32 s46, s46, 1
  s_cmp_ge_u32 s46, 131072
  s_cbranch_scc1 FL_rec_abort
  s_waitcnt vmcnt(4)
  s_branch FL_x_02_c0
FL_x_02_ok0:
  v_mfma_f32_16x16x32_bf16 v[44:47], v[64:67], v[64:67], v[44:47]
  v_max3_u32 v31, v72, v73, v74
  v_max_u32 v31, v31, v75
  v_cmp_eq_u32 vcc, -1, v31
  v_mfma_f32_16x16x32_bf16 v[36:39], v[116:119], v[64:67], v[36:39]
  v_mfma_f32_16x16x32_bf16 v[40:43], v[132:135], v[64:67], v[40:43]
  s_cbranch_vccz FL_x_2_ok2
  s_branch FL_x_2_x2
FL_x_02_ok2:
  v_mfma_f32_16x16x32_bf16 v[44:47], v[72:75], v[72:75], v[44:47]
  v_max3_u32 v31, v64, v65, v66
  v_max_u32 v31, v31, v67
  v_cmp_eq_u32 vcc, -1, v31
  v_mfma_f32_16x16x32_bf16 v[36:39], v[124:127], v[72:75], v[36:39]
  v_mfma_f32_16x16x32_bf16 v[40:43], v[140:143], v[72:75], v[40:43]
  s_cbranch_vccz FL_x_0_ok0
  s_branch FL_x_0_x0
FL_x_03_c0:
  v_max3_u32 v31, v64, v65, v66
  v_max_u32 v31, v31, v67
  v_cmp_eq_u32 vcc, -1, v31
  s_cbranch_vccz FL_x_03_ok0
FL_x_03_x0:
  s_mov_b64 exec, vcc
  buffer_load_dwordx4 v[64:67], v9, s[4:7], s41 offen offset:0 sc1
  s_mov_b64 exec, -1
FL_x_03_c3:
  v_max3_u32 v31, v76, v77, v78
  v_max_u32 v31, v31, v79
  v_cmp_eq_u32 vcc, -1, v31
  s_cbranch_vccz FL_x_03_ok3
FL_x_03_x3:
  s_mov_b64 exec, vcc
  buffer_load_dwordx4 v[76:79], v9, s[4:7], s41 offen offset:3072 sc1
  s_mov_b64 exec, -1
  s_add_u32 s46, s46, 1
  s_cmp_ge_u32 s46, 131072
  s_cbranch_scc1 FL_rec_abort
  s_waitcnt vmcnt(4)
  s_branch FL_x_03_c0
FL_x_03_ok0:
  v_mfma_f32_16x16x32_bf16 v[44:47], v[64:67], v[64:67], v[44:47]
  v_max3_u32 v31, v76, v77, v78
  v_max_u32 v31, v31, v79
  v_cmp_eq_u32 vcc, -1, v31
  v_mfma_f32_16x16x32_bf16 v[36:39], v[116:119], v[64:67], v[36:39]
  v_mfma_f32_16x16x32_bf16 v[40:43], v[132:135], v[64:67], v[40:43]
  s_cbranch_vccz FL_x_3_ok3
  s_branch FL_x_3_x3
FL_x_03_ok3:
  v_mfma_f32_16x16x32_bf16 v[44:47], v[76:79], v[76:79], v[44:47]
  v_max3_u32 v31, v64, v65, v66
  v_max_u32 v31, v31, v67
  v_cmp_eq_u32 vcc, -1, v31
  v_mfma_f32_16x16x32_bf16 v[36:39], v[128:131], v[76:79], v[36:39]
  v_mfma_f32_16x16x32_bf16 v[40:43], v[144:147], v[76:79], v[40:43]
  s_cbranch_vccz FL_x_0_ok0
  s_branch FL_x_0_x0
FL_x_12_c1:
  v_max3_u32 v31, v68, v69, v70
  v_max_u32 v31, v31, v71
  v_cmp_eq_u32 vcc, -1, v31
  s_cbranch_vccz FL_x_12_ok1
FL_x_12_x1:
  s_mov_b64 exec, vcc
  buffer_load_dwordx4 v[68:71], v9, s[4:7], s41 offen offset:1024 sc1
  s_mov_b64 exec, -1
FL_x_12_c2:
  v_max3_u32 v31, v72, v73, v74
  v_max_u32 v31, v31, v75
  v_cmp_eq_u32 vcc, -1, v31
  s_cbranch_vccz FL_x_12_ok2
FL_x_12_x2:
  s_mov_b64 exec, vcc
  buffer_load_dwordx4 v[72:75], v9, s[4:7], s41 offen offset:2048 sc1
  s_mov_b64 exec, -1
  s_add_u32 s46, s46, 1
  s_cmp_ge_u32 s46, 131072
  s_cbranch_scc1 FL_rec_abort
  s_waitcnt vmcnt(4)
  s_branch FL_x_12_c1
FL_x_12_ok1:
  v_mfma_f32_16x16x32_bf16 v[44:47], v[68:71], v[68:71], v[44:47]
  v_max3_u32 v31, v72, v73, v74
  v_max_u32 v31, v31, v75
  v_cmp_eq_u32 vcc, -1, v31
  v_mfma_f32_16x16x32_bf16 v[36:39], v[120:123], v[68:71], v[36:39]
  v_mfma_f32_16x16x32_bf16 v[40:43], v[136:139], v[68:71], v[40:43]
  s_cbranch_vccz FL_x_2_ok2
  s_branch FL_x_2_x2
FL_x_12_ok2:
  v_mfma_f32_16x16x32_bf16 v[44:47], v[72:75], v[72:75], v[44:47]
  v_max3_u32 v31, v68, v69, v70
  v_max_u32 v31, v31, v71
  v_cmp_eq_u32 vcc, -1, v31
  v_mfma_f32_16x16x32_bf16 v[36:39], v[124:127], v[72:75], v[36:39]
  v_mfma_f32_16x16x32_bf16 v[40:43], v[140:143], v[72:75], v[40:43]
  s_cbranch_vccz FL_x_1_ok1
  s_branch FL_x_1_x1
FL_x_13_c1:
  v_max3_u32 v31, v68, v69, v70
  v_max_u32 v31, v31, v71
  v_cmp_eq_u32 vcc, -1, v31
  s_cbranch_vccz FL_x_13_ok1
FL_x_13_x1:
  s_mov_b64 exec, vcc
  buffer_load_dwordx4 v[68:71], v9, s[4:7], s41 offen offset:1024 sc1
  s_mov_b64 exec, -1
FL_x_13_c3:
  v_max3_u32 v31, v76, v77, v78
  v_max_u32 v31, v31, v79
  v_cmp_eq_u32 vcc, -1, v31
  s_cbranch_vccz FL_x_13_ok3
FL_x_13_x3:
  s_mov_b64 exec, vcc
  buffer_load_dwordx4 v[76:79], v9, s[4:7], s41 offen offset:3072 sc1
  s_mov_b64 exec, -1
  s_add_u32 s46, s46, 1
  s_cmp_ge_u32 s46, 131072
  s_cbranch_scc1 FL_rec_abort
  s_waitcnt vmcnt(4)
  s_branch FL_x_13_c1
FL_x_13_ok1:
  v_mfma_f32_16x16x32_bf16 v[44:47], v[68:71], v[68:71], v[44:47]
  v_max3_u32 v31, v76, v77, v78
  v_max_u32 v31, v31, v79
  v_cmp_eq_u32 vcc, -1, v31
  v_mfma_f32_16x16x32_bf16 v[36:39], v[120:123], v[68:71], v[36:39]
  v_mfma_f32_16x16x32_bf16 v[40:43], v[136:139], v[68:71], v[40:43]
  s_cbranch_vccz FL_x_3_ok3
  s_branch FL_x_3_x3
FL_x_13_ok3:
  v_mfma_f32_16x16x32_bf16 v[44:47], v[76:79], v[76:79], v[44:47]
  v_max3_u32 v31, v68, v69, v70
  v_max_u32 v31, v31, v71
  v_cmp_eq_u32 vcc, -1, v31
  v_mfma_f32_16x16x32_bf16 v[36:39], v[128:131], v[76:79], v[36:39]
  v_mfma_f32_16x16x32_bf16 v[40:43], v[144:147], v[76:79], v[40:43]
  s_cbranch_vccz FL_x_1_ok1
  s_branch FL_x_1_x1
FL_x_23_c2:
  v_max3_u32 v31, v72, v73, v74
  v_max_u32 v31, v31, v75
  v_cmp_eq_u32 vcc, -1, v31
  s_cbranch_vccz FL_x_23_ok2
FL_x_23_x2:
  s_mov_b64 exec, vcc
  buffer_load_dwordx4 v[72:75], v9, s[4:7], s41 offen offset:2048 sc1
  s_mov_b64 exec, -1
FL_x_23_c3:
  v_max3_u32 v31, v76, v77, v78
  v_max_u32 v31, v31, v79
  v_cmp_eq_u32 vcc, -1, v31
  s_cbranch_vccz FL_x_23_ok3
FL_x_23_x3:
  s_mov_b64 exec, vcc
  buffer_load_dwordx4 v[76:79], v9, s[4:7], s41 offen offset:3072 sc1
  s_mov_b64 exec, -1
  s_add_u32 s46, s46, 1
  s_cmp_ge_u32 s46, 131072
  s_cbranch_scc1 FL_rec_abort
  s_waitcnt vmcnt(4)
  s_branch FL_x_23_c2
FL_x_23_ok2:
  v_mfma_f32_16x16x32_bf16 v[44:47], v[72:75], v[72:75], v[44:47]
  v_max3_u32 v31, v76, v77, v78
  v_max_u32 v31, v31, v79
  v_cmp_eq_u32 vcc, -1, v31
  v_mfma_f32_16x16x32_bf16 v[36:39], v[124:127], v[72:75], v[36:39]
  v_mfma_f32_16x16x32_bf16 v[40:43], v[140:143], v[72:75], v[40:43]
  s_cbranch_vccz FL_x_3_ok3
  s_branch FL_x_3_x3
FL_x_23_ok3:
  v_mfma_f32_16x16x32_bf16 v[44:47], v[76:79], v[76:79], v[44:47]
  v_max3_u32 v31, v72, v73, v74
  v_max_u32 v31, v31, v75
  v_cmp_eq_u32 vcc, -1, v31
  v_mfma_f32_16x16x32_bf16 v[36:39], v[128:131], v[76:79], v[36:39]
  v_mfma_f32_16x16x32_bf16 v[40:43], v[144:147], v[76:79], v[40:43]
  s_cbranch_vccz FL_x_2_ok2
  s_branch FL_x_2_x2
FL_x_012_c0:
  v_max3_u32 v31, v64, v65, v66
  v_max_u32 v31, v31, v67
  v_cmp_eq_u32 vcc, -1, v31
  s_cbranch_vccz FL_x_012_ok0
FL_x_012_x0:
  s_mov_b64 exec, vcc
  buffer_load_dwordx4 v[64:67], v9, s[4:7], s41 offen offset:0 sc1
  s_mov_b64 exec, -1
FL_x_012_c1:
  v_max3_u32 v31, v68, v69, v70
  v_max_u32 v31, v31, v71
  v_cmp_eq_u32 vcc, -1, v31
  s_cbranch_vccz FL_x_012_ok1
FL_x_012_x1:
  s_mov_b64 exec, vcc
  buffer_load_dwordx4 v[68:71], v9, s[4:7], s41 offen offset:1024 sc1
  s_mov_b64 exec, -1
FL_x_012_c2:
  v_max3_u32 v31, v72, v73, v74
  v_max_u32 v31, v31, v75
  v_cmp_eq_u32 vcc, -1, v31
  s_cbranch_vccz FL_x_012_ok2
FL_x_012_x2:
  s_mov_b64 exec, vcc
  buffer_load_dwordx4 v[72:75], v9, s[4:7], s41 offen offset:2048 sc1
  s_mov_b64 exec, -1
  s_add_u32 s46, s46, 1
  s_cmp_ge_u32 s46, 131072
  s_cbranch_scc1 FL_rec_abort
  s_waitcnt vmcnt(4)
  s_branch FL_x_012_c0
FL_x_012_ok0:
  v_mfma_f32_16x16x32_bf16 v[44:47], v[64:67], v[64:67], v[44:47]
  v_max3_u32 v31, v68, v69, v70
  v_max_u32 v31, v31, v71
  v_cmp_eq_u32 vcc, -1, v31
  v_mfma_f32_16x16x32_bf16 v[36:39], v[116:119], v[64:67], v[36:39]
  v_mfma_f32_16x16x32_bf16 v[40:43], v[132:135], v[64:67], v[40:43]
  s_cbranch_vccz FL_x_12_ok1
  s_branch FL_x_12_x1
FL_x_012_ok1:
  v_mfma_f32_16x16x32_bf16 v[44:47], v[68:71], v[68:71], v[44:47]
  v_max3_u32 v31, v72, v73, v74
  v_max_u32 v31, v31, v75
  v_cmp_eq_u32 vcc, -1, v31
  v_mfma_f32_16x16x32_bf16 v[36:39], v[120:123], v[68:71], v[36:39]
  v_mfma_f32_16x16x32_bf16 v[40:43], v[136:139], v[68:71], v[40:43]
  s_cbranch_vccz FL_x_02_ok2
  s_branch FL_x_02_x2
FL_x_012_ok2:
  v_mfma_f32_16x16x32_bf16 v[44:47], v[72:75], v[72:75], v[44:47]
  v_max3_u32 v31, v64, v65, v66
  v_max_u32 v31, v31, v67
  v_cmp_eq_u32 vcc, -1, v31
  v_mfma_f32_16x16x32_bf16 v[36:39], v[124:127], v[72:75], v[36:39]
  v_mfma_f32_16x16x32_bf16 v[40:43], v[140:143], v[72:75], v[40:43]
  s_cbranch_vccz FL_x_01_ok0
  s_branch FL_x_01_x0
FL_x_013_c0:
  v_max3_u32 v31, v64, v65, v66
  v_max_u32 v31, v31, v67
  v_cmp_eq_u32 vcc, -1, v31
  s_cbranch_vccz FL_x_013_ok0
FL_x_013_x0:
  s_mov_b64 exec, vcc
  buffer_load_dwordx4 v[64:67], v9, s[4:7], s41 offen offset:0 sc1
  s_mov_b64 exec, -1
FL_x_013_c1:
  v_max3_u32 v31, v68, v69, v70
  v_max_u32 v31, v31, v71
  v_cmp_eq_u32 vcc, -1, v31
  s_cbranch_vccz FL_x_013_ok1
FL_x_013_x1:
  s_mov_b64 exec, vcc
  buffer_load_dwordx4 v[68:71], v9, s[4:7], s41 offen offset:1024 sc1
  s_mov_b64 exec, -1
FL_x_013_c3:
  v_max3_u32 v31, v76, v77, v78
  v_max_u32 v31, v31, v79
  v_cmp_eq_u32 vcc, -1, v31
  s_cbranch_vccz FL_x_013_ok3
FL_x_013_x3:
  s_mov_b64 exec, vcc
  buffer_load_dwordx4 v[76:79], v9, s[4:7], s41 offen offset:3072 sc1
  s_mov_b64 exec, -1
  s_add_u32 s46, s46, 1
  s_cmp_ge_u32 s46, 131072
  s_cbranch_scc1 FL_rec_abort
  s_waitcnt vmcnt(4)
  s_branch FL_x_013_c0
FL_x_013_ok0:
  v_mfma_f32_16x16x32_bf16 v[44:47], v[64:67], v[64:67], v[44:47]
  v_max3_u32 v31, v68, v69, v70
  v_max_u32 v31, v31, v71
  v_cmp_eq_u32 vcc, -1, v31
  v_mfma_f32_16x16x32_bf16 v[36:39], v[116:119], v[64:67], v[36:39]
  v_mfma_f32_16x16x32_bf16 v[40:43], v[132:135], v[64:67], v[40:43]
  s_cbranch_vccz FL_x_13_ok1
  s_branch FL_x_13_x1
FL_x_013_ok1:
  v_mfma_f32_16x16x32_bf16 v[44:47], v[68:71], v[68:71], v[44:47]
  v_max3_u32 v31, v76, v77, v78
  v_max_u32 v31, v31, v79
  v_cmp_eq_u32 vcc, -1, v31
  v_mfma_f32_16x16x32_bf16 v[36:39], v[120:123], v[68:71], v[36:39]
  v_mfma_f32_16x16x32_bf16 v[40:43], v[136:139], v[68:71], v[40:43]
  s_cbranch_vccz FL_x_03_ok3
  s_branch FL_x_03_x3
FL_x_013_ok3:
  v_mfma_f32_16x16x32_bf16 v[44:47], v[76:79], v[76:79], v[44:47]
  v_max3_u32 v31, v64, v65, v66
  v_max_u32 v31, v31, v67
  v_cmp_eq_u32 vcc, -1, v31
  v_mfma_f32_16x16x32_bf16 v[36:39], v[128:131], v[76:79], v[36:39]
  v_mfma_f32_16x16x32_bf16 v[40:43], v[144:147], v[76:79], v[40:43]
  s_cbranch_vccz FL_x_01_ok0
  s_branch FL_x_01_x0
FL_x_023_c0:
  v_max3_u32 v31, v64, v65, v66
  v_max_u32 v31, v31, v67
  v_cmp_eq_u32 vcc, -1, v31
  s_cbranch_vccz FL_x_023_ok0
FL_x_023_x0:
  s_mov_b64 exec, vcc
  buffer_load_dwordx4 v[64:67], v9, s[4:7], s41 offen offset:0 sc1
  s_mov_b64 exec, -1
FL_x_023_c2:
  v_max3_u32 v31, v72, v73, v74
  v_max_u32 v31, v31, v75
  v_cmp_eq_u32 vcc, -1, v31
  s_cbranch_vccz FL_x_023_ok2
FL_x_023_x2:
  s_mov_b64 exec, vcc
  buffer_load_dwordx4 v[72:75], v9, s[4:7], s41 offen offset:2048 sc1
  s_mov_b64 exec, -1
FL_x_023_c3:
  v_max3_u32 v31, v76, v77, v78
  v_max_u32 v31, v31, v79
  v_cmp_eq_u32 vcc, -1, v31
  s_cbranch_vccz FL_x_023_ok3
FL_x_023_x3:
  s_mov_b64 exec, vcc
  buffer_load_dwordx4 v[76:79], v9, s[4:7], s41 offen offset:3072 sc1
  s_mov_b64 exec, -1
  s_add_u32 s46, s46, 1
  s_cmp_ge_u32 s46, 131072
  s_cbranch_scc1 FL_rec_abort
  s_waitcnt vmcnt(4)
  s_branch FL_x_023_c0
FL_x_023_ok0:
  v_mfma_f32_16x16x32_bf16 v[44:47], v[64:67], v[64:67], v[44:47]
  v_max3_u32 v31, v72, v73, v74
  v_max_u32 v31, v31, v75
  v_cmp_eq_u32 vcc, -1, v31
  v_mfma_f32_16x16x32_bf16 v[36:39], v[116:119], v[64:67], v[36:39]
  v_mfma_f32_16x16x32_bf16 v[40:43], v[132:135], v[64:67], v[40:43]
  s_cbranch_vccz FL_x_23_ok2
  s_branch FL_x_23_x2
FL_x_023_ok2:
  v_mfma_f32_16x16x32_bf16 v[44:47], v[72:75], v[72:75], v[44:47]
  v_max3_u32 v31, v76, v77, v78
  v_max_u32 v31, v31, v79
  v_cmp_eq_u32 vcc, -1, v31
  v_mfma_f32_16x16x32_bf16 v[36:39], v[124:127], v[72:75], v[36:39]
  v_mfma_f32_16x16x32_bf16 v[40:43], v[140:143], v[72:75], v[40:43]
  s_cbranch_vccz FL_x_03_ok3
  s_branch FL_x_03_x3
FL_x_023_ok3:
  v_mfma_f32_16x16x32_bf16 v[44:47], v[76:79], v[76:79], v[44:47]
  v_max3_u32 v31, v64, v65, v66
  v_max_u32 v31, v31, v67
  v_cmp_eq_u32 vcc, -1, v31
  v_mfma_f32_16x16x32_bf16 v[36:39], v[128:131], v[76:79], v[36:39]
  v_mfma_f32_16x16x32_bf16 v[40:43], v[144:147], v[76:79], v[40:43]
  s_cbranch_vccz FL_x_02_ok0
  s_branch FL_x_02_x0
FL_x_123_c1:
  v_max3_u32 v31, v68, v69, v70
  v_max_u32 v31, v31, v71
  v_cmp_eq_u32 vcc, -1, v31
  s_cbranch_vccz FL_x_123_ok1
FL_x_123_x1:
  s_mov_b64 exec, vcc
  buffer_load_dwordx4 v[68:71], v9, s[4:7], s41 offen offset:1024 sc1
  s_mov_b64 exec, -1
FL_x_123_c2:
  v_max3_u32 v31, v72, v73, v74
  v_max_u32 v31, v31, v75
  v_cmp_eq_u32 vcc, -1, v31
  s_cbranch_vccz FL_x_123_ok2
FL_x_123_x2:
  s_mov_b64 exec, vcc
  buffer_load_dwordx4 v[72:75], v9, s[4:7], s41 offen offset:2048 sc1
  s_mov_b64 exec, -1
FL_x_123_c3:
  v_max3_u32 v31, v76, v77, v78
  v_max_u32 v31, v31, v79
  v_cmp_eq_u32 vcc, -1, v31
  s_cbranch_vccz FL_x_123_ok3
FL_x_123_x3:
  s_mov_b64 exec, vcc
  buffer_load_dwordx4 v[76:79], v9, s[4:7], s41 offen offset:3072 sc1
  s_mov_b64 exec, -1
  s_add_u32 s46, s46, 1
  s_cmp_ge_u32 s46, 131072
  s_cbranch_scc1 FL_rec_abort
  s_waitcnt vmcnt(4)
  s_branch FL_x_123_c1
FL_x_123_ok1:
  v_mfma_f32_16x16x32_bf16 v[44:47], v[68:71], v[68:71], v[44:47]
  v_max3_u32 v31, v72, v73, v74
  v_max_u32 v31, v31, v75
  v_cmp_eq_u32 vcc, -1, v31
  v_mfma_f32_16x16x32_bf16 v[36:39], v[120:123], v[68:71], v[36:39]
  v_mfma_f32_16x16x32_bf16 v[40:43], v[136:139], v[68:71], v[40:43]
  s_cbranch_vccz FL_x_23_ok2
  s_branch FL_x_23_x2
FL_x_123_ok2:
  v_mfma_f32_16x16x32_bf16 v[44:47], v[72:75], v[72:75], v[44:47]
  v_max3_u32 v31, v76, v77, v78
  v_max_u32 v31, v31, v79
  v_cmp_eq_u32 vcc, -1, v31
  v_mfma_f32_16x16x32_bf16 v[36:39], v[124:127], v[72:75], v[36:39]
  v_mfma_f32_16x16x32_bf16 v[40:43], v[140:143], v[72:75], v[40:43]
  s_cbranch_vccz FL_x_13_ok3
  s_branch FL_x_13_x3
FL_x_123_ok3:
  v_mfma_f32_16x16x32_bf16 v[44:47], v[76:79], v[76:79], v[44:47]
  v_max3_u32 v31, v68, v69, v70
  v_max_u32 v31, v31, v71
  v_cmp_eq_u32 vcc, -1, v31
  v_mfma_f32_16x16x32_bf16 v[36:39], v[128:131], v[76:79], v[36:39]
  v_mfma_f32_16x16x32_bf16 v[40:43], v[144:147], v[76:79], v[40:43]
  s_cbranch_vccz FL_x_12_ok1
  s_branch FL_x_12_x1
FL_x_0123_c0:
  v_max3_u32 v31, v64, v65, v66
  v_max_u32 v31, v31, v67
  v_cmp_eq_u32 vcc, -1, v31
  s_cbranch_vccz FL_x_0123_ok0
FL_x_0123_x0:
  s_mov_b64 exec, vcc
  buffer_load_dwordx4 v[64:67], v9, s[4:7], s41 offen offset:0 sc1
  s_mov_b64 exec, -1
FL_x_0123_c1:
  v_max3_u32 v31, v68, v69, v70
  v_max_u32 v31, v31, v71
  v_cmp_eq_u32 vcc, -1, v31
  s_cbranch_vccz FL_x_0123_ok1
FL_x_0123_x1:
  s_mov_b64 exec, vcc
  buffer_load_dwordx4 v[68:71], v9, s[4:7], s41 offen offset:1024 sc1
  s_mov_b64 exec, -1
FL_x_0123_c2:
  v_max3_u32 v31, v72, v73, v74
  v_max_u32 v31, v31, v75
  v_cmp_eq_u32 vcc, -1, v31
  s_cbranch_vccz FL_x_0123_ok2
FL_x_0123_x2:
  s_mov_b64 exec, vcc
  buffer_load_dwordx4 v[72:75], v9, s[4:7], s41 offen offset:2048 sc1
  s_mov_b64 exec, -1
FL_x_0123_c3:
  v_max3_u32 v31, v76, v77, v78
  v_max_u32 v31, v31, v79
  v_cmp_eq_u32 vcc, -1, v31
  s_cbranch_vccz FL_x_0123_ok3
FL_x_0123_x3:
  s_mov_b64 exec, vcc
  buffer_load_dwordx4 v[76:79], v9, s[4:7], s41 offen offset:3072 sc1
  s_mov_b64 exec, -1
  s_add_u32 s46, s46, 1
  s_cmp_ge_u32 s46, 131072
  s_cbranch_scc1 FL_rec_abort
  s_waitcnt vmcnt(4)
  s_branch FL_x_0123_c0
FL_x_0123_ok0:
  v_mfma_f32_16x16x32_bf16 v[44:47], v[64:67], v[64:67], v[44:47]
  v_max3_u32 v31, v68, v69, v70
  v_max_u32 v31, v31, v71
  v_cmp_eq_u32 vcc, -1, v31
  v_mfma_f32_16x16x32_bf16 v[36:39], v[116:119], v[64:67], v[36:39]
  v_mfma_f32_16x16x32_bf16 v[40:43], v[132:135], v[64:67], v[40:43]
  s_cbranch_vccz FL_x_123_ok1
  s_branch FL_x_123_x1
FL_x_0123_ok1:
  v_mfma_f32_16x16x32_bf16 v[44:47], v[68:71], v[68:71], v[44:47]
  v_max3_u32 v31, v72, v73, v74
  v_max_u32 v31, v31, v75
  v_cmp_eq_u32 vcc, -1, v31
  v_mfma_f32_16x16x32_bf16 v[36:39], v[120:123], v[68:71], v[36:39]
  v_mfma_f32_16x16x32_bf16 v[40:43], v[136:139], v[68:71], v[40:43]
  s_cbranch_vccz FL_x_023_ok2
  s_branch FL_x_023_x2
FL_x_0123_ok2:
  v_mfma_f32_16x16x32_bf16 v[44:47], v[72:75], v[72:75], v[44:47]
  v_max3_u32 v31, v76, v77, v78
  v_max_u32 v31, v31, v79
  v_cmp_eq_u32 vcc, -1, v31
  v_mfma_f32_16x16x32_bf16 v[36:39], v[124:127], v[72:75], v[36:39]
  v_mfma_f32_16x16x32_bf16 v[40:43], v[140:143], v[72:75], v[40:43]
  s_cbranch_vccz FL_x_013_ok3
  s_branch FL_x_013_x3
FL_x_0123_ok3:
  v_mfma_f32_16x16x32_bf16 v[44:47], v[76:79], v[76:79], v[44:47]
  v_max3_u32 v31, v64, v65, v66
  v_max_u32 v31, v31, v67
  v_cmp_eq_u32 vcc, -1, v31
  v_mfma_f32_16x16x32_bf16 v[36:39], v[128:131], v[76:79], v[36:39]
  v_mfma_f32_16x16x32_bf16 v[40:43], v[144:147], v[76:79], v[40:43]
  s_cbranch_vccz FL_x_012_ok0
  s_branch FL_x_012_x0
FL_v_f:
  buffer_load_dwordx4 v[88:91], v10, s[4:7], s41 offen offset:0 sc1
  buffer_load_dwordx4 v[92:95], v10, s[4:7], s41 offen offset:1024 sc1
  s_add_u32 s46, s46, 1
  s_cmp_ge_u32 s46, 131072
  s_cbranch_scc1 FL_rec_abort
  s_waitcnt vmcnt(0)
  v_max3_u32 v31, v88, v89, v90
  v_max3_u32 v31, v31, v91, v92
  v_max3_u32 v31, v31, v93, v94
  v_max_u32 v31, v31, v95
  v_cmp_eq_u32 vcc, -1, v31
  s_cbranch_vccnz FL_v_f
  s_branch FL_v_ok
FL_rec_abort:
  s_waitcnt vmcnt(0)
  s_endpgm
L_recslow:
  s_load_dwordx4 s[80:83], s[0:1], 8
  s_load_dwordx4 s[84:87], s[0:1], 24
  s_load_dwordx2 s[88:89], s[0:1], 40
  v_lshrrev_b32 v31, 6, v0
  s_nop 0
  v_readfirstlane_b32 s32, v31
  v_and_b32 v0, 63, v0
  s_lshr_b32 s35, s34, 4
  s_lshl_b32 s90, s33, 1
  s_add_u32 s35, s35, s90
  s_and_b32 s36, s34, 15
  s_lshr_b32 s37, s36, 2
  s_lshl_b32 s90, s35, 2
  s_add_u32 s37, s37, s90
  s_and_b32 s38, s36, 3
  s_waitcnt lgkmcnt(0)
  s_mov_b32 s24, s80
  s_and_b32 s25, s81, 0xffff
  s_mov_b32 s26, 0x4000
  s_mov_b32 s27, 0x20000
  s_mov_b32 s8, s82
  s_and_b32 s9, s83, 0xffff
  s_mov_b32 s10, 0x800000
  s_mov_b32 s11, 0x20000
  s_mov_b32 s12, s84
  s_and_b32 s13, s85, 0xffff
  s_mov_b32 s14, 0x800000
  s_mov_b32 s15, 0x20000
  s_mov_b32 s16, s86
  s_and_b32 s17, s87, 0xffff
  s_mov_b32 s18, 0x800000
  s_mov_b32 s19, 0x20000
  s_mov_b32 s20, s88
  s_and_b32 s21, s89, 0xffff
  s_mov_b32 s22, 0x800000
  s_mov_b32 s23, 0x20000
  s_lshl_b32 s90, s32, 21
  s_lshl_b32 s91, s37, 8
  s_add_u32 s90, s90, s91
  s_lshr_b32 s91, s38, 1
  s_lshl_b32 s91, s91, 7
  s_add_u32 s90, s90, s91
  v_mov_b32 v180, 0x0
  v_bfe_u32 v31, v0, 3, 3
  v_lshl_add_u32 v180, v31, 13, v180
  v_bfe_u32 v31, v0, 0, 3
  v_lshl_add_u32 v180, v31, 4, v180
  v_add_u32 v180, s90, v180
  v_xor_b32 v185, 128, v180
  s_lshl_b32 s90, s35, 2
  s_add_u32 s90, s90, s32
  s_lshl_b32 s90, s90, 18
  s_lshl_b32 s91, s36, 7
  s_add_u32 s90, s90, s91
  v_mov_b32 v181, 0x0
  v_bfe_u32 v31, v0, 3, 3
  v_lshl_add_u32 v181, v31, 11, v181
  v_bfe_u32 v31, v0, 0, 3
  v_lshl_add_u32 v181, v31, 4, v181
  v_add_u32 v181, s90, v181
  s_lshl_b32 s96, s32, 15
  s_and_b32 s91, s38, 1
  s_lshl_b32 s91, s91, 6
  s_add_u32 s91, s91, s96
  v_mov_b32 v182, 0x0
  v_bfe_u32 v31, v0, 5, 1
  v_lshl_add_u32 v182, v31, 11, v182
  v_bfe_u32 v31, v0, 4, 1
  v_lshl_add_u32 v182, v31, 10, v182
  v_bfe_u32 v31, v0, 2, 2
  v_lshl_add_u32 v182, v31, 7, v182
  v_bfe_u32 v31, v0, 0, 2
  v_lshl_add_u32 v182, v31, 3, v182
  v_add_u32 v182, s91, v182
  s_lshl_b32 s91, s32, 5
  v_mov_b32 v183, 0x0
  v_bfe_u32 v31, v0, 4, 1
  v_lshl_add_u32 v183, v31, 13, v183
  v_bfe_u32 v31, v0, 5, 1
  v_lshl_add_u32 v183, v31, 8, v183
  v_bfe_u32 v31, v0, 2, 1
  v_lshl_add_u32 v183, v31, 10, v183
  v_bfe_u32 v31, v0, 3, 1
  v_lshl_add_u32 v183, v31, 7, v183
  v_bfe_u32 v31, v0, 0, 2
  v_lshl_add_u32 v183, v31, 3, v183
  v_add_u32 v183, s91, v183
  v_add_u32 v184, 0x10000, v183
  s_lshl_b32 s97, s34, 2
  s_add_u32 s97, s97, s32
  s_lshl_b32 s98, s97, 14
  s_lshl_b32 s91, s33, 21
  s_add_u32 s98, s98, s91
  s_lshl_b32 s97, s97, 16
  s_lshl_b32 s91, s33, 11
  s_add_u32 s97, s97, s91
  v_mov_b32 v16, 0x0
  v_bfe_u32 v31, v0, 0, 4
  v_lshl_add_u32 v16, v31, 7, v16
  v_bfe_u32 v31, v0, 4, 2
  v_lshl_add_u32 v16, v31, 13, v16
  v_add_u32 v17, 0x8000, v16
  v_lshlrev_b32 v18, 7, v0
  v_add_u32 v19, 0x2000, v18
  s_lshl_b32 s97, s34, 2
  s_add_u32 s97, s97, s32
  s_lshl_b32 s98, s97, 14
  s_lshl_b32 s91, s33, 21
  s_add_u32 s98, s98, s91
  s_lshl_b32 s97, s97, 16
  s_lshl_b32 s91, s33, 11
  s_add_u32 s97, s97, s91
  v_mov_b32 v16, 0x180
  v_bfe_u32 v31, v0, 0, 1
  v_lshl_add_u32 v16, v31, 10, v16
  v_bfe_u32 v31, v0, 1, 3
  v_lshl_add_u32 v16, v31, 13, v16
  v_mov_b32 v17, 0x180
  v_bfe_u32 v31, v0, 0, 4
  v_lshl_add_u32 v17, v31, 10, v17
  s_mov_b64 exec, 0xffff
  buffer_load_dword v201, v16, s[12:15], s97 offen
  buffer_load_dword v202, v16, s[16:19], s97 offen
  buffer_load_dword v200, v16, s[8:11], s97 offen
  buffer_load_dword v203, v17, s[20:23], s98 offen
  s_mov_b64 exec, -1
  s_lshl_b32 s58, s33, 5
  s_add_u32 s58, s58, s34
  s_lshl_b32 s59, s32, 19
  s_add_u32 s59, s59, 0x3800000
  s_lshl_b32 s90, s58, 11
  s_add_u32 s90, s90, s59
  s_mul_i32 s91, s58, 3072
  s_add_u32 s91, s91, s59
  s_add_u32 s91, s91, 0x200000
  v_lshlrev_b32 v6, 4, v0
  v_mov_b32 v8, -1
  v_mov_b32 v12, 0
  v_mov_b32 v9, -1
  v_mov_b32 v13, 0
  v_mov_b32 v10, -1
  v_mov_b32 v14, 0
  v_mov_b32 v11, -1
  v_mov_b32 v15, 0
  buffer_store_dwordx4 v[8:11], v6, s[4:7], s90 offen offset:0 sc1
  buffer_store_dwordx4 v[8:11], v6, s[4:7], s90 offen offset:1024 sc1
  buffer_store_dwordx4 v[8:11], v6, s[4:7], s91 offen offset:0 sc1
  buffer_store_dwordx4 v[8:11], v6, s[4:7], s91 offen offset:1024 sc1
  buffer_store_dwordx4 v[8:11], v6, s[4:7], s91 offen offset:2048 sc1
  s_lshl_b32 s58, s58, 2
  s_add_u32 s58, s58, s32
  s_cmp_ge_u32 s58, 36
  s_cbranch_scc1 SL_nz_1
  s_lshl_b32 s90, s58, 10
  s_add_u32 s90, s90, 0x3d00000
  buffer_store_dwordx4 v[12:15], v6, s[4:7], s90 offen sc1
SL_nz_1:
  s_add_u32 m0, s96, 0
  s_mov_b32 s90, 0x0
  buffer_load_dwordx4 v180, s[12:15], s90 offen  lds
  s_add_u32 m0, s96, 1024
  s_mov_b32 s90, 0x10000
  buffer_load_dwordx4 v180, s[12:15], s90 offen  lds
  s_add_u32 m0, s96, 2048
  s_mov_b32 s90, 0x20000
  buffer_load_dwordx4 v180, s[12:15], s90 offen  lds
  s_add_u32 m0, s96, 3072
  s_mov_b32 s90, 0x30000
  buffer_load_dwordx4 v180, s[12:15], s90 offen  lds
  s_add_u32 m0, s96, 4096
  s_mov_b32 s90, 0x0
  buffer_load_dwordx4 v185, s[16:19], s90 offen  lds
  s_add_u32 m0, s96, 5120
  s_mov_b32 s90, 0x10000
  buffer_load_dwordx4 v185, s[16:19], s90 offen  lds
  s_add_u32 m0, s96, 6144
  s_mov_b32 s90, 0x20000
  buffer_load_dwordx4 v185, s[16:19], s90 offen  lds
  s_add_u32 m0, s96, 7168
  s_mov_b32 s90, 0x30000
  buffer_load_dwordx4 v185, s[16:19], s90 offen  lds
  s_add_u32 m0, s96, 8192
  s_mov_b32 s90, 0x40000
  buffer_load_dwordx4 v180, s[12:15], s90 offen  lds
  s_add_u32 m0, s96, 9216
  s_mov_b32 s90, 0x50000
  buffer_load_dwordx4 v180, s[12:15], s90 offen  lds
  s_add_u32 m0, s96, 10240
  s_mov_b32 s90, 0x60000
  buffer_load_dwordx4 v180, s[12:15], s90 offen  lds
  s_add_u32 m0, s96, 11264
  s_mov_b32 s90, 0x70000
  buffer_load_dwordx4 v180, s[12:15], s90 offen  lds
  s_add_u32 m0, s96, 12288
  s_mov_b32 s90, 0x40000
  buffer_load_dwordx4 v185, s[16:19], s90 offen  lds
  s_add_u32 m0, s96, 13312
  s_mov_b32 s90, 0x50000
  buffer_load_dwordx4 v185, s[16:19], s90 offen  lds
  s_add_u32 m0, s96, 14336
  s_mov_b32 s90, 0x60000
  buffer_load_dwordx4 v185, s[16:19], s90 offen  lds
  s_add_u32 m0, s96, 15360
  s_mov_b32 s90, 0x70000
  buffer_load_dwordx4 v185, s[16:19], s90 offen  lds
  s_add_u32 m0, s96, 16384
  s_mov_b32 s90, 0x80000
  buffer_load_dwordx4 v180, s[12:15], s90 offen  lds
  s_add_u32 m0, s96, 17408
  s_mov_b32 s90, 0x90000
  buffer_load_dwordx4 v180, s[12:15], s90 offen  lds
  s_add_u32 m0, s96, 18432
  s_mov_b32 s90, 0xa0000
  buffer_load_dwordx4 v180, s[12:15], s90 offen  lds
  s_add_u32 m0, s96, 19456
  s_mov_b32 s90, 0xb0000
  buffer_load_dwordx4 v180, s[12:15], s90 offen  lds
  s_add_u32 m0, s96, 20480
  s_mov_b32 s90, 0x80000
  buffer_load_dwordx4 v185, s[16:19], s90 offen  lds
  s_add_u32 m0, s96, 21504
  s_mov_b32 s90, 0x90000
  buffer_load_dwordx4 v185, s[16:19], s90 offen  lds
  s_add_u32 m0, s96, 22528
  s_mov_b32 s90, 0xa0000
  buffer_load_dwordx4 v185, s[16:19], s90 offen  lds
  s_add_u32 m0, s96, 23552
  s_mov_b32 s90, 0xb0000
  buffer_load_dwordx4 v185, s[16:19], s90 offen  lds
  s_add_u32 m0, s96, 24576
  s_mov_b32 s90, 0xc0000
  buffer_load_dwordx4 v180, s[12:15], s90 offen  lds
  s_add_u32 m0, s96, 25600
  s_mov_b32 s90, 0xd0000
  buffer_load_dwordx4 v180, s[12:15], s90 offen  lds
  s_add_u32 m0, s96, 26624
  s_mov_b32 s90, 0xe0000
  buffer_load_dwordx4 v180, s[12:15], s90 offen  lds
  s_add_u32 m0, s96, 27648
  s_mov_b32 s90, 0xf0000
  buffer_load_dwordx4 v180, s[12:15], s90 offen  lds
  s_add_u32 m0, s96, 28672
  s_mov_b32 s90, 0xc0000
  buffer_load_dwordx4 v185, s[16:19], s90 offen  lds
  s_add_u32 m0, s96, 29696
  s_mov_b32 s90, 0xd0000
  buffer_load_dwordx4 v185, s[16:19], s90 offen  lds
  s_add_u32 m0, s96, 30720
  s_mov_b32 s90, 0xe0000
  buffer_load_dwordx4 v185, s[16:19], s90 offen  lds
  s_add_u32 m0, s96, 31744
  s_mov_b32 s90, 0xf0000
  buffer_load_dwordx4 v185, s[16:19], s90 offen  lds
  s_lshl_b32 s90, s34, 2
  s_add_u32 s90, s90, s32
  s_lshr_b32 s91, s90, 3
  s_lshl_b32 s91, s91, 14
  s_and_b32 s92, s90, 7
  s_lshl_b32 s92, s92, 10
  s_add_u32 s91, s91, s92
  v_mov_b32 v1, 0x0
  v_bfe_u32 v31, v0, 0, 6
  v_lshl_add_u32 v1, v31, 4, v1
  v_add_u32 v1, s91, v1
  v_lshrrev_b32 v30, 4, v0
  v_cmp_eq_u32 vcc, s33, v30
  v_xor_b32 v29, 0x2000, v1
  s_nop 0
  v_cndmask_b32 v1, v1, v29, vcc
  s_lshl_b32 s91, s33, 14
  s_lshl_b32 s92, s90, 7
  s_add_u32 s91, s91, s92
  v_mov_b32 v2, 0x200000
  v_bfe_u32 v31, v0, 0, 2
  v_lshl_add_u32 v2, v31, 2, v2
  v_bfe_u32 v31, v0, 2, 1
  v_lshl_add_u32 v2, v31, 6, v2
  v_bfe_u32 v31, v0, 4, 1
  v_lshl_add_u32 v2, v31, 4, v2
  v_bfe_u32 v31, v0, 5, 1
  v_lshl_add_u32 v2, v31, 5, v2
  v_bfe_u32 v31, v0, 3, 1
  v_lshl_add_u32 v2, v31, 31, v2
  v_add_u32 v2, s91, v2
  s_lshr_b32 s92, s90, 1
  s_lshl_b32 s92, s92, 5
  s_and_b32 s91, s90, 1
  s_lshl_b32 s91, s91, 13
  s_add_u32 s92, s92, s91
  v_mov_b32 v30, 0x0
  v_bfe_u32 v31, v0, 2, 1
  v_lshl_add_u32 v30, v31, 12, v30
  v_bfe_u32 v31, v0, 4, 1
  v_lshl_add_u32 v30, v31, 11, v30
  v_bfe_u32 v31, v0, 0, 2
  v_lshl_add_u32 v30, v31, 3, v30
  v_bfe_u32 v31, v0, 5, 1
  v_lshl_add_u32 v30, v31, 2, v30
  v_add_u32 v30, s92, v30
  buffer_load_dword v44, v30, s[24:27], 0 offen
  s_lshl_b32 s91, s33, 14
  s_lshl_b32 s92, s32, 12
  s_add_u32 s91, s91, s92
  v_mov_b32 v3, 0x200000
  v_bfe_u32 v31, v0, 0, 6
  v_lshl_add_u32 v3, v31, 4, v3
  v_add_u32 v3, s91, v3
  s_mul_i32 s91, s32, 3264
  v_mov_b32 v4, 0x0
  v_bfe_u32 v31, v0, 0, 6
  v_lshl_add_u32 v4, v31, 4, v4
  v_add_u32 v4, s91, v4
  s_lshl_b32 s91, s32, 6
  v_mov_b32 v6, 0x0
  v_bfe_u32 v31, v0, 0, 2
  v_lshl_add_u32 v6, v31, 4, v6
  v_bfe_u32 v31, v0, 2, 1
  v_lshl_add_u32 v6, v31, 2, v6
  v_bfe_u32 v31, v0, 3, 1
  s_mov_b32 s99, 1088
  v_mad_u32_u24 v6, v31, s99, v6
  v_bfe_u32 v31, v0, 4, 2
  v_lshl_add_u32 v6, v31, 8, v6
  v_add_u32 v6, s91, v6
  v_add_u32 v240, 3264, v6
  v_add_u32 v241, 6528, v6
  v_add_u32 v242, 9792, v6
  s_lshl_b32 s93, s37, 13
  s_lshl_b32 s91, s38, 10
  s_add_u32 s91, s91, s93
  s_lshl_b32 s92, s32, 8
  s_add_u32 s91, s91, s92
  v_mov_b32 v7, 0x210000
  v_bfe_u32 v31, v0, 0, 6
  v_lshl_add_u32 v7, v31, 2, v7
  v_add_u32 v7, s91, v7
  s_lshl_b32 s91, s37, 11
  s_lshl_b32 s92, s38, 9
  s_add_u32 s59, s91, s92
  s_lshl_b32 s92, s32, 7
  s_add_u32 s91, s59, s92
  v_mov_b32 v19, 0x83000000
  v_bfe_u32 v31, v0, 0, 3
  v_lshl_add_u32 v19, v31, 2, v19
  v_bfe_u32 v31, v0, 4, 2
  v_lshl_add_u32 v19, v31, 5, v19
  v_bfe_u32 v31, v0, 3, 1
  v_lshl_add_u32 v19, v31, 31, v19
  v_add_u32 v19, s91, v19
  s_lshl_b32 s91, s32, 8
  v_mov_b32 v5, 0x880
  v_bfe_u32 v31, v0, 0, 1
  v_lshl_add_u32 v5, v31, 7, v5
  v_bfe_u32 v31, v0, 1, 1
  v_lshl_add_u32 v5, v31, 3, v5
  v_bfe_u32 v31, v0, 2, 3
  v_lshl_add_u32 v5, v31, 4, v5
  v_add_u32 v5, s91, v5
  s_lshr_b32 s92, s38, 1
  s_xor_b32 s92, s92, 1
  s_lshl_b32 s92, s92, 10
  s_add_u32 s91, s91, s92
  s_add_u32 s91, s91, s93
  s_and_b32 s92, s38, 1
  s_lshl_b32 s92, s92, 7
  s_add_u32 s91, s91, s92
  v_mov_b32 v8, 0x211000
  v_bfe_u32 v31, v0, 0, 5
  v_lshl_add_u32 v8, v31, 2, v8
  v_bfe_u32 v31, v0, 5, 1
  v_lshl_add_u32 v8, v31, 31, v8
  v_add_u32 v8, s91, v8
  s_sub_u32 s91, s91, s93
  s_lshl_b32 s92, s37, 11
  s_add_u32 s91, s91, s92
  v_mov_b32 v20, 0x3400000
  v_bfe_u32 v31, v0, 0, 5
  v_lshl_add_u32 v20, v31, 2, v20
  v_bfe_u32 v31, v0, 5, 1
  v_lshl_add_u32 v20, v31, 31, v20
  v_add_u32 v20, s91, v20
  s_lshl_b32 s97, s35, 2
  s_add_u32 s97, s97, s32
  s_lshl_b32 s97, s97, 13
  v_mov_b32 v9, 0x210000
  v_bfe_u32 v31, v0, 0, 6
  v_lshl_add_u32 v9, v31, 4, v9
  v_add_u32 v9, s97, v9
  v_add_u32 v10, 4096, v9
  v_mov_b32 v11, 0x1000000
  v_bfe_u32 v31, v0, 0, 2
  v_lshl_add_u32 v11, v31, 4, v11
  v_bfe_u32 v31, v0, 2, 1
  v_lshl_add_u32 v11, v31, 7, v11
  v_bfe_u32 v31, v0, 3, 1
  v_lshl_add_u32 v11, v31, 12, v11
  v_bfe_u32 v31, v0, 4, 2
  v_lshl_add_u32 v11, v31, 8, v11
  v_add_u32 v11, s97, v11
  v_mov_b32 v12, 0x2000000
  v_bfe_u32 v31, v0, 0, 3
  v_lshl_add_u32 v12, v31, 4, v12
  v_bfe_u32 v31, v0, 3, 1
  v_lshl_add_u32 v12, v31, 11, v12
  v_bfe_u32 v31, v0, 4, 2
  v_lshl_add_u32 v12, v31, 8, v12
  v_add_u32 v12, s97, v12
  v_add_u32 v13, 4096, v12
  s_lshl_b32 s91, s36, 9
  s_add_u32 s91, s91, s97
  s_add_u32 s63, s91, 0x1000000
  v_mov_b32 v21, 0x1000000
  v_bfe_u32 v31, v0, 0, 2
  v_lshl_add_u32 v21, v31, 7, v21
  v_bfe_u32 v31, v0, 2, 1
  v_lshl_add_u32 v21, v31, 24, v21
  v_add_u32 v21, s91, v21
  v_cmp_gt_u32 vcc, 8, v0
  v_mov_b32 v30, 0x80000000
  s_nop 0
  v_cndmask_b32 v21, v30, v21, vcc
  s_lshl_b32 s91, s32, 11
  v_mov_b32 v30, 0x0
  v_bfe_u32 v31, v0, 2, 1
  v_lshl_add_u32 v30, v31, 6, v30
  v_bfe_u32 v31, v0, 0, 1
  v_lshl_add_u32 v30, v31, 5, v30
  v_bfe_u32 v31, v0, 1, 1
  v_lshl_add_u32 v30, v31, 4, v30
  v_mov_b32 v29, 0x0
  v_bfe_u32 v31, v0, 4, 2
  v_lshl_add_u32 v29, v31, 5, v29
  v_xor_b32 v30, v30, v29
  v_mov_b32 v14, 0x3400
  v_bfe_u32 v31, v0, 0, 4
  v_lshl_add_u32 v14, v31, 7, v14
  v_add_u32 v14, s91, v14
  v_add_u32 v14, v14, v30
  v_xor_b32 v15, 16, v14
  v_mov_b32 v30, 0x0
  v_bfe_u32 v31, v0, 5, 1
  v_lshl_add_u32 v30, v31, 6, v30
  v_bfe_u32 v31, v0, 1, 1
  v_lshl_add_u32 v30, v31, 5, v30
  v_bfe_u32 v31, v0, 4, 1
  v_lshl_add_u32 v30, v31, 4, v30
  v_mov_b32 v29, 0x0
  v_bfe_u32 v31, v0, 2, 2
  v_lshl_add_u32 v29, v31, 5, v29
  v_bfe_u32 v31, v0, 0, 1
  v_lshl_add_u32 v29, v31, 4, v29
  v_xor_b32 v30, v30, v29
  v_mov_b32 v16, 0x3400
  v_bfe_u32 v31, v0, 4, 2
  v_lshl_add_u32 v16, v31, 8, v16
  v_bfe_u32 v31, v0, 1, 1
  v_lshl_add_u32 v16, v31, 7, v16
  v_add_u32 v16, v16, v30
  s_lshl_b32 s98, s36, 14
  s_lshl_b32 s92, s35, 7
  s_add_u32 s98, s98, s92
  s_lshl_b32 s92, s32, 11
  s_add_u32 s91, s98, s92
  v_mov_b32 v17, 0x0
  v_bfe_u32 v31, v0, 0, 5
  v_lshl_add_u32 v17, v31, 2, v17
  v_bfe_u32 v31, v0, 5, 1
  v_lshl_add_u32 v17, v31, 10, v17
  v_add_u32 v17, s91, v17
  v_xor_b32 v18, 0x2000, v17
  s_mov_b32 s48, 0x33333333
  s_mov_b32 s49, 0x33333333
  s_mov_b32 s50, 0xffff0000
  s_mov_b32 s51, 0xffff0000
  s_mov_b32 s52, 0x0000ffff
  s_mov_b32 s53, 0x0000ffff
  s_mov_b32 s54, 0xfffffffe
  s_mov_b32 s47, 0x3e0293ee
  v_mov_b32 v30, 0x4444
  v_mov_b32 v31, 0xeeee
  v_cndmask_b32 v23, v31, v30, s[48:49]
  v_mov_b32 v22, -1
  v_mov_b32 v232, 0
  v_mov_b32 v233, 0
  v_mov_b32 v234, 0
  v_mov_b32 v235, 0
  v_mov_b32 v112, 0
  v_mov_b32 v113, 0
  s_mov_b32 s56, 0xf0f0f0f0
  s_mov_b32 s57, 0xf0f0f0f0
  v_mov_b32 v30, 0x3f80
  v_mov_b32 v31, 1.0
  v_cndmask_b32 v30, v30, v31, s[56:57]
  s_mov_b32 s56, 0x110011
  s_mov_b32 s57, 0x110011
  v_cndmask_b32 v24, 0, v30, s[56:57]
  s_mov_b32 s56, 0x220022
  s_mov_b32 s57, 0x220022
  v_cndmask_b32 v25, 0, v30, s[56:57]
  s_mov_b32 s56, 0x11001100
  s_mov_b32 s57, 0x11001100
  v_cndmask_b32 v26, 0, v30, s[56:57]
  s_mov_b32 s56, 0x22002200
  s_mov_b32 s57, 0x22002200
  v_cndmask_b32 v27, 0, v30, s[56:57]
  s_mov_b32 s40, 0
  s_mov_b32 s41, 0x3800000
  s_mov_b32 s43, 0x3900000
  s_mov_b32 s44, 0
  s_mov_b32 s55, 0x40000
  s_mov_b32 s45, 0
  s_waitcnt vmcnt(33)
  s_barrier
  s_cmp_lg_u32 s32, 0
  s_cbranch_scc1 SL_sig_2
  v_mov_b32 v254, 1
  v_mov_b32 v255, 0
  s_mov_b64 exec, 1
  buffer_atomic_add v254, v255, s[28:31], s100 offen offset:132 sc1
  s_mov_b64 exec, -1
SL_sig_2:
  s_mov_b32 s90, 0x3e0000
  buffer_store_dword v22, v19, s[4:7], s90 offen sc1
  buffer_store_dword v22, v20, s[4:7], s90 offen sc1
  s_mov_b32 s90, 0x3f0000
  buffer_store_dword v22, v19, s[4:7], s90 offen sc1
  buffer_store_dword v22, v20, s[4:7], s90 offen sc1
  s_waitcnt vmcnt(28)
  ds_read_b64_tr_b16 a[16:17], v182 offset:0
  ds_read_b64_tr_b16 a[18:19], v182 offset:512
  ds_read_b64_tr_b16 a[24:25], v182 offset:32
  ds_read_b64_tr_b16 a[26:27], v182 offset:544
  s_waitcnt lgkmcnt(0)
  s_add_u32 m0, s96, 0
  s_mov_b32 s90, 0x100000
  buffer_load_dwordx4 v180, s[12:15], s90 offen  lds
  s_add_u32 m0, s96, 1024
  s_mov_b32 s90, 0x110000
  buffer_load_dwordx4 v180, s[12:15], s90 offen  lds
  s_add_u32 m0, s96, 2048
  s_mov_b32 s90, 0x120000
  buffer_load_dwordx4 v180, s[12:15], s90 offen  lds
  s_add_u32 m0, s96, 3072
  s_mov_b32 s90, 0x130000
  buffer_load_dwordx4 v180, s[12:15], s90 offen  lds
  s_waitcnt vmcnt(28)
  ds_read_b64_tr_b16 a[32:33], v182 offset:4096
  ds_read_b64_tr_b16 a[34:35], v182 offset:4608
  ds_read_b64_tr_b16 a[40:41], v182 offset:4128
  ds_read_b64_tr_b16 a[42:43], v182 offset:4640
  s_waitcnt lgkmcnt(0)
  s_add_u32 m0, s96, 4096
  s_mov_b32 s90, 0x100000
  buffer_load_dwordx4 v185, s[16:19], s90 offen  lds
  s_add_u32 m0, s96, 5120
  s_mov_b32 s90, 0x110000
  buffer_load_dwordx4 v185, s[16:19], s90 offen  lds
  s_add_u32 m0, s96, 6144
  s_mov_b32 s90, 0x120000
  buffer_load_dwordx4 v185, s[16:19], s90 offen  lds
  s_add_u32 m0, s96, 7168
  s_mov_b32 s90, 0x130000
  buffer_load_dwordx4 v185, s[16:19], s90 offen  lds
  s_waitcnt vmcnt(28)
  ds_read_b64_tr_b16 a[20:21], v182 offset:8192
  ds_read_b64_tr_b16 a[22:23], v182 offset:8704
  ds_read_b64_tr_b16 a[28:29], v182 offset:8224
  ds_read_b64_tr_b16 a[30:31], v182 offset:8736
  s_waitcnt lgkmcnt(0)
  s_add_u32 m0, s96, 8192
  s_mov_b32 s90, 0x140000
  buffer_load_dwordx4 v180, s[12:15], s90 offen  lds
  s_add_u32 m0, s96, 9216
  s_mov_b32 s90, 0x150000
  buffer_load_dwordx4 v180, s[12:15], s90 offen  lds
  s_add_u32 m0, s96, 10240
  s_mov_b32 s90, 0x160000
  buffer_load_dwordx4 v180, s[12:15], s90 offen  lds
  s_add_u32 m0, s96, 11264
  s_mov_b32 s90, 0x170000
  buffer_load_dwordx4 v180, s[12:15], s90 offen  lds
  s_waitcnt vmcnt(28)
  ds_read_b64_tr_b16 a[36:37], v182 offset:12288
  ds_read_b64_tr_b16 a[38:39], v182 offset:12800
  ds_read_b64_tr_b16 a[44:45], v182 offset:12320
  ds_read_b64_tr_b16 a[46:47], v182 offset:12832
  s_waitcnt lgkmcnt(0)
  s_add_u32 m0, s96, 12288
  s_mov_b32 s90, 0x140000
  buffer_load_dwordx4 v185, s[16:19], s90 offen  lds
  s_add_u32 m0, s96, 13312
  s_mov_b32 s90, 0x150000
  buffer_load_dwordx4 v185, s[16:19], s90 offen  lds
  s_add_u32 m0, s96, 14336
  s_mov_b32 s90, 0x160000
  buffer_load_dwordx4 v185, s[16:19], s90 offen  lds
  s_add_u32 m0, s96, 15360
  s_mov_b32 s90, 0x170000
  buffer_load_dwordx4 v185, s[16:19], s90 offen  lds
  s_waitcnt vmcnt(28)
  ds_read_b64_tr_b16 a[64:65], v182 offset:16384
  ds_read_b64_tr_b16 a[66:67], v182 offset:16896
  ds_read_b64_tr_b16 a[72:73], v182 offset:16416
  ds_read_b64_tr_b16 a[74:75], v182 offset:16928
  s_waitcnt lgkmcnt(0)
  s_add_u32 m0, s96, 16384
  s_mov_b32 s90, 0x180000
  buffer_load_dwordx4 v180, s[12:15], s90 offen  lds
  s_add_u32 m0, s96, 17408
  s_mov_b32 s90, 0x190000
  buffer_load_dwordx4 v180, s[12:15], s90 offen  lds
  s_add_u32 m0, s96, 18432
  s_mov_b32 s90, 0x1a0000
  buffer_load_dwordx4 v180, s[12:15], s90 offen  lds
  s_add_u32 m0, s96, 19456
  s_mov_b32 s90, 0x1b0000
  buffer_load_dwordx4 v180, s[12:15], s90 offen  lds
  s_waitcnt vmcnt(28)
  ds_read_b64_tr_b16 a[80:81], v182 offset:20480
  ds_read_b64_tr_b16 a[82:83], v182 offset:20992
  ds_read_b64_tr_b16 a[88:89], v182 offset:20512
  ds_read_b64_tr_b16 a[90:91], v182 offset:21024
  s_waitcnt lgkmcnt(0)
  s_add_u32 m0, s96, 20480
  s_mov_b32 s90, 0x180000
  buffer_load_dwordx4 v185, s[16:19], s90 offen  lds
  s_add_u32 m0, s96, 21504
  s_mov_b32 s90, 0x190000
  buffer_load_dwordx4 v185, s[16:19], s90 offen  lds
  s_add_u32 m0, s96, 22528
  s_mov_b32 s90, 0x1a0000
  buffer_load_dwordx4 v185, s[16:19], s90 offen  lds
  s_add_u32 m0, s96, 23552
  s_mov_b32 s90, 0x1b0000
  buffer_load_dwordx4 v185, s[16:19], s90 offen  lds
  s_waitcnt vmcnt(28)
  ds_read_b64_tr_b16 a[68:69], v182 offset:24576
  ds_read_b64_tr_b16 a[70:71], v182 offset:25088
  ds_read_b64_tr_b16 a[76:77], v182 offset:24608
  ds_read_b64_tr_b16 a[78:79], v182 offset:25120
  s_waitcnt lgkmcnt(0)
  s_add_u32 m0, s96, 24576
  s_mov_b32 s90, 0x1c0000
  buffer_load_dwordx4 v180, s[12:15], s90 offen  lds
  s_add_u32 m0, s96, 25600
  s_mov_b32 s90, 0x1d0000
  buffer_load_dwordx4 v180, s[12:15], s90 offen  lds
  s_add_u32 m0, s96, 26624
  s_mov_b32 s90, 0x1e0000
  buffer_load_dwordx4 v180, s[12:15], s90 offen  lds
  s_add_u32 m0, s96, 27648
  s_mov_b32 s90, 0x1f0000
  buffer_load_dwordx4 v180, s[12:15], s90 offen  lds
  s_waitcnt vmcnt(28)
  ds_read_b64_tr_b16 a[84:85], v182 offset:28672
  ds_read_b64_tr_b16 a[86:87], v182 offset:29184
  ds_read_b64_tr_b16 a[92:93], v182 offset:28704
  ds_read_b64_tr_b16 a[94:95], v182 offset:29216
  s_waitcnt lgkmcnt(0)
  s_add_u32 m0, s96, 28672
  s_mov_b32 s90, 0x1c0000
  buffer_load_dwordx4 v185, s[16:19], s90 offen  lds
  s_add_u32 m0, s96, 29696
  s_mov_b32 s90, 0x1d0000
  buffer_load_dwordx4 v185, s[16:19], s90 offen  lds
  s_add_u32 m0, s96, 30720
  s_mov_b32 s90, 0x1e0000
  buffer_load_dwordx4 v185, s[16:19], s90 offen  lds
  s_add_u32 m0, s96, 31744
  s_mov_b32 s90, 0x1f0000
  buffer_load_dwordx4 v185, s[16:19], s90 offen  lds
  s_waitcnt vmcnt(28)
  ds_read_b64_tr_b16 a[112:113], v182 offset:0
  ds_read_b64_tr_b16 a[114:115], v182 offset:512
  ds_read_b64_tr_b16 a[120:121], v182 offset:32
  ds_read_b64_tr_b16 a[122:123], v182 offset:544
  s_waitcnt lgkmcnt(0)
  s_add_u32 m0, s96, 0
  s_mov_b32 s90, 0x0
  buffer_load_dwordx4 v180, s[8:11], s90 offen  lds
  s_add_u32 m0, s96, 1024
  s_mov_b32 s90, 0x10000
  buffer_load_dwordx4 v180, s[8:11], s90 offen  lds
  s_add_u32 m0, s96, 2048
  s_mov_b32 s90, 0x20000
  buffer_load_dwordx4 v180, s[8:11], s90 offen  lds
  s_add_u32 m0, s96, 3072
  s_mov_b32 s90, 0x30000
  buffer_load_dwordx4 v180, s[8:11], s90 offen  lds
  s_waitcnt vmcnt(28)
  ds_read_b64_tr_b16 a[128:129], v182 offset:4096
  ds_read_b64_tr_b16 a[130:131], v182 offset:4608
  ds_read_b64_tr_b16 a[136:137], v182 offset:4128
  ds_read_b64_tr_b16 a[138:139], v182 offset:4640
  s_waitcnt lgkmcnt(0)
  s_add_u32 m0, s96, 4096
  s_mov_b32 s90, 0x40000
  buffer_load_dwordx4 v180, s[8:11], s90 offen  lds
  s_add_u32 m0, s96, 5120
  s_mov_b32 s90, 0x50000
  buffer_load_dwordx4 v180, s[8:11], s90 offen  lds
  s_add_u32 m0, s96, 6144
  s_mov_b32 s90, 0x60000
  buffer_load_dwordx4 v180, s[8:11], s90 offen  lds
  s_add_u32 m0, s96, 7168
  s_mov_b32 s90, 0x70000
  buffer_load_dwordx4 v180, s[8:11], s90 offen  lds
  s_waitcnt vmcnt(28)
  ds_read_b64_tr_b16 a[116:117], v182 offset:8192
  ds_read_b64_tr_b16 a[118:119], v182 offset:8704
  ds_read_b64_tr_b16 a[124:125], v182 offset:8224
  ds_read_b64_tr_b16 a[126:127], v182 offset:8736
  s_waitcnt lgkmcnt(0)
  s_add_u32 m0, s96, 8192
  s_mov_b32 s90, 0x80000
  buffer_load_dwordx4 v180, s[8:11], s90 offen  lds
  s_add_u32 m0, s96, 9216
  s_mov_b32 s90, 0x90000
  buffer_load_dwordx4 v180, s[8:11], s90 offen  lds
  s_add_u32 m0, s96, 10240
  s_mov_b32 s90, 0xa0000
  buffer_load_dwordx4 v180, s[8:11], s90 offen  lds
  s_add_u32 m0, s96, 11264
  s_mov_b32 s90, 0xb0000
  buffer_load_dwordx4 v180, s[8:11], s90 offen  lds
  s_waitcnt vmcnt(28)
  ds_read_b64_tr_b16 a[132:133], v182 offset:12288
  ds_read_b64_tr_b16 a[134:135], v182 offset:12800
  ds_read_b64_tr_b16 a[140:141], v182 offset:12320
  ds_read_b64_tr_b16 a[142:143], v182 offset:12832
  s_waitcnt lgkmcnt(0)
  s_add_u32 m0, s96, 12288
  s_mov_b32 s90, 0xc0000
  buffer_load_dwordx4 v180, s[8:11], s90 offen  lds
  s_add_u32 m0, s96, 13312
  s_mov_b32 s90, 0xd0000
  buffer_load_dwordx4 v180, s[8:11], s90 offen  lds
  s_add_u32 m0, s96, 14336
  s_mov_b32 s90, 0xe0000
  buffer_load_dwordx4 v180, s[8:11], s90 offen  lds
  s_add_u32 m0, s96, 15360
  s_mov_b32 s90, 0xf0000
  buffer_load_dwordx4 v180, s[8:11], s90 offen  lds
  s_waitcnt vmcnt(28)
  ds_read_b64_tr_b16 a[160:161], v182 offset:16384
  ds_read_b64_tr_b16 a[162:163], v182 offset:16896
  ds_read_b64_tr_b16 a[168:169], v182 offset:16416
  ds_read_b64_tr_b16 a[170:171], v182 offset:16928
  s_waitcnt lgkmcnt(0)
  s_add_u32 m0, s96, 16384
  s_mov_b32 s90, 0x100000
  buffer_load_dwordx4 v180, s[8:11], s90 offen  lds
  s_add_u32 m0, s96, 17408
  s_mov_b32 s90, 0x110000
  buffer_load_dwordx4 v180, s[8:11], s90 offen  lds
  s_add_u32 m0, s96, 18432
  s_mov_b32 s90, 0x120000
  buffer_load_dwordx4 v180, s[8:11], s90 offen  lds
  s_add_u32 m0, s96, 19456
  s_mov_b32 s90, 0x130000
  buffer_load_dwordx4 v180, s[8:11], s90 offen  lds
  s_waitcnt vmcnt(28)
  ds_read_b64_tr_b16 a[176:177], v182 offset:20480
  ds_read_b64_tr_b16 a[178:179], v182 offset:20992
  ds_read_b64_tr_b16 a[184:185], v182 offset:20512
  ds_read_b64_tr_b16 a[186:187], v182 offset:21024
  s_waitcnt lgkmcnt(0)
  s_add_u32 m0, s96, 20480
  s_mov_b32 s90, 0x140000
  buffer_load_dwordx4 v180, s[8:11], s90 offen  lds
  s_add_u32 m0, s96, 21504
  s_mov_b32 s90, 0x150000
  buffer_load_dwordx4 v180, s[8:11], s90 offen  lds
  s_add_u32 m0, s96, 22528
  s_mov_b32 s90, 0x160000
  buffer_load_dwordx4 v180, s[8:11], s90 offen  lds
  s_add_u32 m0, s96, 23552
  s_mov_b32 s90, 0x170000
  buffer_load_dwordx4 v180, s[8:11], s90 offen  lds
  s_waitcnt vmcnt(28)
  ds_read_b64_tr_b16 a[164:165], v182 offset:24576
  ds_read_b64_tr_b16 a[166:167], v182 offset:25088
  ds_read_b64_tr_b16 a[172:173], v182 offset:24608
  ds_read_b64_tr_b16 a[174:175], v182 offset:25120
  s_waitcnt lgkmcnt(0)
  s_add_u32 m0, s96, 24576
  s_mov_b32 s90, 0x180000
  buffer_load_dwordx4 v180, s[8:11], s90 offen  lds
  s_add_u32 m0, s96, 25600
  s_mov_b32 s90, 0x190000
  buffer_load_dwordx4 v180, s[8:11], s90 offen  lds
  s_add_u32 m0, s96, 26624
  s_mov_b32 s90, 0x1a0000
  buffer_load_dwordx4 v180, s[8:11], s90 offen  lds
  s_add_u32 m0, s96, 27648
  s_mov_b32 s90, 0x1b0000
  buffer_load_dwordx4 v180, s[8:11], s90 offen  lds
  s_waitcnt vmcnt(28)
  ds_read_b64_tr_b16 a[180:181], v182 offset:28672
  ds_read_b64_tr_b16 a[182:183], v182 offset:29184
  ds_read_b64_tr_b16 a[188:189], v182 offset:28704
  ds_read_b64_tr_b16 a[190:191], v182 offset:29216
  s_waitcnt lgkmcnt(0)
  s_add_u32 m0, s96, 28672
  s_mov_b32 s90, 0x1c0000
  buffer_load_dwordx4 v180, s[8:11], s90 offen  lds
  s_add_u32 m0, s96, 29696
  s_mov_b32 s90, 0x1d0000
  buffer_load_dwordx4 v180, s[8:11], s90 offen  lds
  s_add_u32 m0, s96, 30720
  s_mov_b32 s90, 0x1e0000
  buffer_load_dwordx4 v180, s[8:11], s90 offen  lds
  s_add_u32 m0, s96, 31744
  s_mov_b32 s90, 0x1f0000
  buffer_load_dwordx4 v180, s[8:11], s90 offen  lds
  s_waitcnt vmcnt(28)
  ds_read_b64_tr_b16 a[0:1], v182 offset:0
  ds_read_b64_tr_b16 a[2:3], v182 offset:512
  ds_read_b64_tr_b16 a[8:9], v182 offset:32
  ds_read_b64_tr_b16 a[10:11], v182 offset:544
  s_waitcnt lgkmcnt(0)
  s_add_u32 m0, s96, 0
  s_mov_b32 s90, 0x0
  buffer_load_dwordx4 v181, s[20:23], s90 offen  lds
  s_add_u32 m0, s96, 1024
  s_mov_b32 s90, 0x4000
  buffer_load_dwordx4 v181, s[20:23], s90 offen  lds
  s_add_u32 m0, s96, 2048
  s_mov_b32 s90, 0x8000
  buffer_load_dwordx4 v181, s[20:23], s90 offen  lds
  s_add_u32 m0, s96, 3072
  s_mov_b32 s90, 0xc000
  buffer_load_dwordx4 v181, s[20:23], s90 offen  lds
  s_waitcnt vmcnt(28)
  ds_read_b64_tr_b16 a[4:5], v182 offset:4096
  ds_read_b64_tr_b16 a[6:7], v182 offset:4608
  ds_read_b64_tr_b16 a[12:13], v182 offset:4128
  ds_read_b64_tr_b16 a[14:15], v182 offset:4640
  s_waitcnt lgkmcnt(0)
  s_add_u32 m0, s96, 4096
  s_mov_b32 s90, 0x10000
  buffer_load_dwordx4 v181, s[20:23], s90 offen  lds
  s_add_u32 m0, s96, 5120
  s_mov_b32 s90, 0x14000
  buffer_load_dwordx4 v181, s[20:23], s90 offen  lds
  s_add_u32 m0, s96, 6144
  s_mov_b32 s90, 0x18000
  buffer_load_dwordx4 v181, s[20:23], s90 offen  lds
  s_add_u32 m0, s96, 7168
  s_mov_b32 s90, 0x1c000
  buffer_load_dwordx4 v181, s[20:23], s90 offen  lds
  s_waitcnt vmcnt(28)
  ds_read_b64_tr_b16 a[48:49], v182 offset:8192
  ds_read_b64_tr_b16 a[50:51], v182 offset:8704
  ds_read_b64_tr_b16 a[56:57], v182 offset:8224
  ds_read_b64_tr_b16 a[58:59], v182 offset:8736
  s_waitcnt lgkmcnt(0)
  s_add_u32 m0, s96, 8192
  s_mov_b32 s90, 0x20000
  buffer_load_dwordx4 v181, s[20:23], s90 offen  lds
  s_add_u32 m0, s96, 9216
  s_mov_b32 s90, 0x24000
  buffer_load_dwordx4 v181, s[20:23], s90 offen  lds
  s_add_u32 m0, s96, 10240
  s_mov_b32 s90, 0x28000
  buffer_load_dwordx4 v181, s[20:23], s90 offen  lds
  s_add_u32 m0, s96, 11264
  s_mov_b32 s90, 0x2c000
  buffer_load_dwordx4 v181, s[20:23], s90 offen  lds
  s_waitcnt vmcnt(28)
  ds_read_b64_tr_b16 a[52:53], v182 offset:12288
  ds_read_b64_tr_b16 a[54:55], v182 offset:12800
  ds_read_b64_tr_b16 a[60:61], v182 offset:12320
  ds_read_b64_tr_b16 a[62:63], v182 offset:12832
  s_waitcnt lgkmcnt(0)
  s_add_u32 m0, s96, 12288
  s_mov_b32 s90, 0x30000
  buffer_load_dwordx4 v181, s[20:23], s90 offen  lds
  s_add_u32 m0, s96, 13312
  s_mov_b32 s90, 0x34000
  buffer_load_dwordx4 v181, s[20:23], s90 offen  lds
  s_add_u32 m0, s96, 14336
  s_mov_b32 s90, 0x38000
  buffer_load_dwordx4 v181, s[20:23], s90 offen  lds
  s_add_u32 m0, s96, 15360
  s_mov_b32 s90, 0x3c000
  buffer_load_dwordx4 v181, s[20:23], s90 offen  lds
  s_mov_b32 s90, 0x3800000
  buffer_load_dword v204, v2, s[4:7], s90 offen sc1
  buffer_load_dword v204, v7, s[4:7], s90 offen sc1
  buffer_load_dword v204, v8, s[4:7], s90 offen sc1
  s_mov_b32 s90, 0x3880000
  buffer_load_dword v204, v2, s[4:7], s90 offen sc1
  buffer_load_dword v204, v7, s[4:7], s90 offen sc1
  buffer_load_dword v204, v8, s[4:7], s90 offen sc1
  s_mov_b32 s90, 0x3900000
  buffer_load_dword v204, v2, s[4:7], s90 offen sc1
  buffer_load_dword v204, v7, s[4:7], s90 offen sc1
  buffer_load_dword v204, v8, s[4:7], s90 offen sc1
  s_mov_b32 s90, 0x3980000
  buffer_load_dword v204, v2, s[4:7], s90 offen sc1
  buffer_load_dword v204, v7, s[4:7], s90 offen sc1
  buffer_load_dword v204, v8, s[4:7], s90 offen sc1
  s_waitcnt vmcnt(28)
  ds_read_b64_tr_b16 a[96:97], v182 offset:16384
  ds_read_b64_tr_b16 a[98:99], v182 offset:16896
  ds_read_b64_tr_b16 a[104:105], v182 offset:16416
  ds_read_b64_tr_b16 a[106:107], v182 offset:16928
  s_waitcnt vmcnt(24)
  ds_read_b64_tr_b16 a[100:101], v182 offset:20480
  ds_read_b64_tr_b16 a[102:103], v182 offset:20992
  ds_read_b64_tr_b16 a[108:109], v182 offset:20512
  ds_read_b64_tr_b16 a[110:111], v182 offset:21024
  s_waitcnt vmcnt(20)
  ds_read_b64_tr_b16 a[144:145], v182 offset:24576
  ds_read_b64_tr_b16 a[146:147], v182 offset:25088
  ds_read_b64_tr_b16 a[152:153], v182 offset:24608
  ds_read_b64_tr_b16 a[154:155], v182 offset:25120
  s_waitcnt vmcnt(16)
  ds_read_b64_tr_b16 a[148:149], v182 offset:28672
  ds_read_b64_tr_b16 a[150:151], v182 offset:29184
  ds_read_b64_tr_b16 a[156:157], v182 offset:28704
  ds_read_b64_tr_b16 a[158:159], v182 offset:29216
  v_mbcnt_lo_u32_b32 v250, -1, 0
  v_mbcnt_hi_u32_b32 v250, -1, v250
  s_lshl_b32 s90, s32, 9
  s_add_u32 s90, s90, 147520
  v_lshl_add_u32 v251, v250, 3, s90
  ds_write_b64 v251, v[248:249]
  s_waitcnt lgkmcnt(0)
  s_cmp_lg_u32 s32, 0
  s_cbranch_scc1 SL_vd_4
  v_lshlrev_b32 v250, 2, v250
  s_cmp_lg_u32 s100, 0
  s_cbranch_scc1 SL_vw_3
  v_readfirstlane_b32 s90, v247
  s_and_b32 s90, s90, s101
  s_cbranch_scc0 SL_vw_3
  v_mov_b32 v251, 1
  s_mov_b64 exec, 1
  buffer_store_dword v251, v250, s[28:31], 0 offen offset:32 sc1
  s_mov_b64 exec, -1
SL_vw_3:
  buffer_load_dword v251, v250, s[28:31], 0 offen sc1
  s_waitcnt vmcnt(0)
  v_cmp_eq_u32 vcc, -1, v251
  v_readlane_b32 s91, v251, 8
  v_readlane_b32 s92, v251, 32
  v_readlane_b32 s93, v251, 33
  v_readlane_b32 s90, v251, 34
  s_cmp_lg_u32 s100, 0
  s_cselect_b32 s93, s90, s93
  s_cselect_b32 s91, 0, s91
  s_cselect_b32 s92, 1, s92
  s_cselect_b32 s90, 0xff, vcc_lo
  s_cmp_lg_u32 s91, 0
  s_cselect_b32 s92, 3, s92
  s_cbranch_scc1 SL_vk_5
  s_add_u32 s3, s3, 1
  s_cmp_ge_u32 s3, 131072
  s_cselect_b32 s92, 4, s92
  s_cbranch_scc1 SL_vk_5
  s_sleep 8
  s_and_b32 s90, s90, 0xff
  s_cmp_lg_u32 s90, 0xff
  s_cbranch_scc1 SL_vw_3
  s_cmp_lt_u32 s93, 128
  s_cbranch_scc1 SL_vw_3
SL_vk_5:
  v_mov_b32 v251, s92
  v_mov_b32 v250, 147456
  ds_write_b32 v250, v251
  s_waitcnt lgkmcnt(0)
SL_vd_4:
  s_barrier
  v_mov_b32 v250, 147456
  ds_read_b32 v251, v250
  s_waitcnt lgkmcnt(0)
  v_readfirstlane_b32 s92, v251
  s_barrier
  s_cmp_eq_u32 s92, 3
  s_cbranch_scc1 L_fallback
  s_cmp_eq_u32 s92, 4
  s_cbranch_scc1 L_exit
  s_waitcnt vmcnt(0)
  s_barrier
  ds_read_b64_tr_b16 a[192:193], v183 offset:0
  ds_read_b64_tr_b16 a[194:195], v183 offset:2048
  ds_read_b64_tr_b16 a[196:197], v183 offset:512
  ds_read_b64_tr_b16 a[198:199], v183 offset:2560
  ds_read_b64_tr_b16 a[200:201], v183 offset:4096
  ds_read_b64_tr_b16 a[202:203], v183 offset:6144
  ds_read_b64_tr_b16 a[204:205], v183 offset:4608
  ds_read_b64_tr_b16 a[206:207], v183 offset:6656
  s_waitcnt lgkmcnt(0)
  ds_read_b64_tr_b16 a[208:209], v183 offset:32768
  ds_read_b64_tr_b16 a[210:211], v183 offset:34816
  ds_read_b64_tr_b16 a[212:213], v183 offset:33280
  ds_read_b64_tr_b16 a[214:215], v183 offset:35328
  ds_read_b64_tr_b16 a[216:217], v183 offset:36864
  ds_read_b64_tr_b16 a[218:219], v183 offset:38912
  ds_read_b64_tr_b16 a[220:221], v183 offset:37376
  ds_read_b64_tr_b16 a[222:223], v183 offset:39424
  s_waitcnt lgkmcnt(0)
  ds_read_b64_tr_b16 a[224:225], v184 offset:0
  ds_read_b64_tr_b16 a[226:227], v184 offset:2048
  ds_read_b64_tr_b16 a[228:229], v184 offset:512
  ds_read_b64_tr_b16 a[230:231], v184 offset:2560
  ds_read_b64_tr_b16 a[232:233], v184 offset:4096
  ds_read_b64_tr_b16 a[234:235], v184 offset:6144
  ds_read_b64_tr_b16 a[236:237], v184 offset:4608
  ds_read_b64_tr_b16 a[238:239], v184 offset:6656
  s_waitcnt lgkmcnt(0)
  ds_read_b64_tr_b16 a[240:241], v184 offset:32768
  ds_read_b64_tr_b16 a[242:243], v184 offset:34816
  ds_read_b64_tr_b16 a[244:245], v184 offset:33280
  ds_read_b64_tr_b16 a[246:247], v184 offset:35328
  ds_read_b64_tr_b16 a[248:249], v184 offset:36864
  ds_read_b64_tr_b16 a[250:251], v184 offset:38912
  ds_read_b64_tr_b16 a[252:253], v184 offset:37376
  ds_read_b64_tr_b16 a[254:255], v184 offset:39424
  s_waitcnt lgkmcnt(0)
  s_barrier
  s_mov_b32 s46, 0
  s_mov_b32 s39, 0
  v_xor_b32 v1, s39, v1
  v_xor_b32 v17, s39, v17
  v_xor_b32 v18, s39, v18
  s_mov_b32 s12, s63
  s_mov_b32 s90, 0x3800000
  s_mov_b32 s90, 0x3880000
  s_mov_b32 s90, 0x3900000
  s_mov_b32 s90, 0x3980000
  v_mov_b32 v248, 0x3f803f80
  v_mov_b32 v249, 0x3f803f80
  v_mov_b32 v250, 0x3f803f80
  v_mov_b32 v251, 0x3f803f80
  v_mov_b32 v252, 0x3f803f80
  v_mov_b32 v253, 0x3f803f80
  v_mov_b32 v254, 0x3f803f80
  v_mov_b32 v255, 0x3f803f80
  s_cmp_lg_u32 s32, 0
  s_cbranch_scc1 SL_kv0d
  s_lshl_b32 s90, s33, 7
  s_add_u32 s90, s90, 0x3d07000
  v_mov_b32 v30, s90
SL_kv0:
  buffer_load_dword v31, v30, s[4:7], 0 offen sc1
  s_waitcnt vmcnt(0)
  v_readfirstlane_b32 s90, v31
  s_add_u32 s46, s46, 1
  s_cmp_ge_u32 s46, 131072
  s_cbranch_scc1 SL_rec_abort
  s_sleep 2
  s_cmp_lt_u32 s90, 16
  s_cbranch_scc1 SL_kv0
SL_kv0d:
  s_barrier
  buffer_load_dwordx4 v[180:183], v12, s[4:7], s44 offen offset:0
  buffer_load_dwordx4 v[184:187], v12, s[4:7], s44 offen offset:128
  buffer_load_dwordx4 v[188:191], v12, s[4:7], s44 offen offset:1024
  buffer_load_dwordx4 v[192:195], v12, s[4:7], s44 offen offset:1152
  buffer_load_dwordx4 v[196:199], v13, s[4:7], s44 offen offset:0
  buffer_load_dwordx4 v[200:203], v13, s[4:7], s44 offen offset:128
  buffer_load_dwordx4 v[204:207], v13, s[4:7], s44 offen offset:1024
  buffer_load_dwordx4 v[208:211], v13, s[4:7], s44 offen offset:1152
  buffer_load_dwordx4 v[116:119], v11, s[4:7], s44 offen offset:0
  buffer_load_dwordx4 v[132:135], v11, s[4:7], s44 offen offset:64
  buffer_load_dwordx4 v[120:123], v11, s[4:7], s44 offen offset:1024
  buffer_load_dwordx4 v[136:139], v11, s[4:7], s44 offen offset:1088
  buffer_load_dwordx4 v[124:127], v11, s[4:7], s44 offen offset:2048
  buffer_load_dwordx4 v[140:143], v11, s[4:7], s44 offen offset:2112
  buffer_load_dwordx4 v[128:131], v11, s[4:7], s44 offen offset:3072
  buffer_load_dwordx4 v[144:147], v11, s[4:7], s44 offen offset:3136
  s_add_u32 s44, s44, 0x40000
  v_mov_b64 v[64:65], 0
  v_mov_b64 v[66:67], 0
  v_mov_b64 v[68:69], 0
  v_mov_b64 v[70:71], 0
  v_mov_b64 v[72:73], 0
  v_mov_b64 v[74:75], 0
  v_mov_b64 v[76:77], 0
  v_mov_b64 v[78:79], 0
  v_mov_b64 v[80:81], 0
  v_mov_b64 v[82:83], 0
  v_mov_b64 v[84:85], 0
  v_mov_b64 v[86:87], 0
  v_mov_b64 v[32:33], 0
  v_mov_b64 v[34:35], 0
  v_mov_b64 v[212:213], 0
  v_mov_b64 v[214:215], 0
  v_mov_b64 v[216:217], 0
  v_mov_b64 v[218:219], 0
  v_mov_b64 v[220:221], 0
  v_mov_b64 v[222:223], 0
  v_mov_b64 v[224:225], 0
  v_mov_b64 v[226:227], 0
  v_mov_b64 v[228:229], 0
  v_mov_b64 v[230:231], 0
  s_waitcnt vmcnt(0)
  v_min_u32 v44, s54, v44
  s_lshl_b32 s90, s33, 7
  s_add_u32 s90, s90, 0x3d07000
  v_mov_b32 v244, s90
  s_lshl_b32 s90, s34, 2
  s_add_u32 s90, s90, s32
  s_lshl_b32 s91, s33, 7
  s_add_u32 s91, s91, 0x3d00000
  v_mbcnt_lo_u32_b32 v30, -1, 0
  v_mbcnt_hi_u32_b32 v30, -1, v30
  v_add_u32 v30, s90, v30
  v_cmp_eq_u32 vcc, 0, v30
  v_mov_b32 v30, 0x80000000
  v_mov_b32 v31, s91
  v_cndmask_b32 v245, v30, v31, vcc
  s_mov_b64 s[8:9], s[94:95]
  s_mov_b64 s[10:11], s[94:95]
  s_branch SL_pubmem
SL_step:
  s_load_dword s16, s[8:9], 256
  s_load_dword s17, s[10:11], 256
  s_load_dword s18, s[8:9], 320
  s_load_dword s19, s[10:11], 320
  s_load_dword s20, s[8:9], 384
  s_load_dword s21, s[10:11], 384
  s_load_dword s22, s[8:9], 448
  s_load_dword s23, s[10:11], 448
  buffer_load_dwordx4 v[200:203], v13, s[4:7], s44 offen offset:128
  buffer_load_dwordx4 v[204:207], v13, s[4:7], s44 offen offset:1024
  buffer_load_dwordx4 v[208:211], v13, s[4:7], s44 offen offset:1152
  buffer_load_dwordx4 v[128:131], v11, s[4:7], s44 offen offset:3072
  buffer_load_dwordx4 v[144:147], v11, s[4:7], s44 offen offset:3136
  v_mov_b64 v[64:65], 0
  v_mov_b64 v[66:67], 0
  v_mov_b64 v[68:69], 0
  v_mov_b64 v[70:71], 0
  v_mov_b64 v[72:73], 0
  v_mov_b64 v[74:75], 0
  v_mov_b64 v[76:77], 0
  v_mov_b64 v[78:79], 0
  v_mov_b64 v[80:81], 0
  v_mov_b64 v[82:83], 0
  v_mov_b64 v[84:85], 0
  v_mov_b64 v[86:87], 0
  v_mov_b64 v[32:33], 0
  v_mov_b64 v[34:35], 0
  buffer_load_dwordx4 v[36:39], v1, s[4:7], s42 offen sc1
  buffer_store_dword v22, v18, s[4:7], s13 offen sc1
  buffer_store_dword v22, v2, s[4:7], s13 offen sc1
  buffer_store_dword v22, v7, s[4:7], s13 offen sc1
  buffer_store_dword v22, v8, s[4:7], s13 offen sc1
  s_add_u32 s44, s44, 0x40000
  s_min_u32 s44, s44, 0xfc0000
  s_add_u32 s45, s45, 0x10000
  s_waitcnt vmcnt(12)
SL_kv_chk:
  v_readfirstlane_b32 s90, v243
  s_cmp_lt_u32 s90, 16
  s_cbranch_scc1 SL_kv_f
  s_waitcnt vmcnt(4)
SL_g_chk:
  v_max3_u32 v31, v36, v37, v38
  v_max_u32 v31, v31, v39
  v_cmp_eq_u32 vcc, -1, v31
  v_mfma_f32_16x16x32_bf16 v[40:43], v[24:27], v[36:39], 0
  s_cbranch_vccnz SL_g_f
  s_nop 6
  v_add_f32_dpp v45, v40, v40 row_ror:8 row_mask:0xf bank_mask:0xf
  v_add_f32_dpp v46, v41, v41 row_ror:8 row_mask:0xf bank_mask:0xf
  v_cvt_pk_bf16_f32 v44, v45, v46
  v_min_u32 v44, s54, v44
SL_pubmem:
  buffer_store_dword v44, v2, s[4:7], s41 offen sc1
  v_mov_b32 v148, v180
  v_mov_b32 v150, v181
  v_mov_b32 v152, v182
  v_mov_b32 v154, v183
  v_mov_b32 v149, v184
  v_mov_b32 v151, v185
  v_mov_b32 v153, v186
  v_mov_b32 v155, v187
  v_mov_b32 v156, v188
  v_mov_b32 v158, v189
  v_mov_b32 v160, v190
  v_mov_b32 v162, v191
  v_mov_b32 v157, v192
  v_mov_b32 v159, v193
  v_mov_b32 v161, v194
  v_mov_b32 v163, v195
  v_mov_b32 v164, v196
  v_mov_b32 v166, v197
  v_mov_b32 v168, v198
  v_mov_b32 v170, v199
  v_mov_b32 v165, v200
  v_mov_b32 v167, v201
  v_mov_b32 v169, v202
  v_mov_b32 v171, v203
  buffer_load_dwordx4 v[48:51], v3, s[4:7], s41 offen offset:0 sc1
  v_mov_b32 v172, v204
  v_mov_b32 v174, v205
  buffer_load_dwordx4 v[52:55], v3, s[4:7], s41 offen offset:1024 sc1
  v_mov_b32 v176, v206
  v_mov_b32 v178, v207
  buffer_load_dwordx4 v[56:59], v3, s[4:7], s41 offen offset:2048 sc1
  v_mov_b32 v173, v208
  v_mov_b32 v175, v209
  buffer_load_dwordx4 v[60:63], v3, s[4:7], s41 offen offset:3072 sc1
  v_mov_b32 v177, v210
  v_mov_b32 v179, v211
  s_waitcnt vmcnt(3)
  v_max3_u32 v31, v48, v49, v50
  v_max_u32 v31, v31, v51
  v_cmp_eq_u32 vcc, -1, v31
  s_cbranch_vccnz SL_m_f0
  v_smfmac_f32_16x16x64_bf16 v[64:67], v[48:51], a[0:7], v23
  s_waitcnt vmcnt(2)
  v_max3_u32 v31, v52, v53, v54
  v_max_u32 v31, v31, v55
  v_cmp_eq_u32 vcc, -1, v31
  v_smfmac_f32_16x16x64_bf16 v[68:71], v[48:51], a[8:15], v23
  v_smfmac_f32_16x16x64_bf16 v[72:75], v[48:51], a[16:23], v23
  v_smfmac_f32_16x16x64_bf16 v[76:79], v[48:51], a[24:31], v23
  s_cbranch_vccnz SL_m_f1
  v_smfmac_f32_16x16x64_bf16 v[64:67], v[52:55], a[48:55], v23
  s_waitcnt vmcnt(1)
  v_max3_u32 v31, v56, v57, v58
  v_max_u32 v31, v31, v59
  v_cmp_eq_u32 vcc, -1, v31
  v_smfmac_f32_16x16x64_bf16 v[68:71], v[52:55], a[56:63], v23
  v_smfmac_f32_16x16x64_bf16 v[72:75], v[52:55], a[64:71], v23
  v_smfmac_f32_16x16x64_bf16 v[76:79], v[52:55], a[72:79], v23
  s_cbranch_vccnz SL_m_f2
  v_smfmac_f32_16x16x64_bf16 v[64:67], v[56:59], a[96:103], v23
  s_waitcnt vmcnt(0)
  v_max3_u32 v31, v60, v61, v62
  v_max_u32 v31, v31, v63
  v_cmp_eq_u32 vcc, -1, v31
  v_smfmac_f32_16x16x64_bf16 v[68:71], v[56:59], a[104:111], v23
  v_smfmac_f32_16x16x64_bf16 v[72:75], v[56:59], a[112:119], v23
  v_smfmac_f32_16x16x64_bf16 v[76:79], v[56:59], a[120:127], v23
  s_cbranch_vccnz SL_m_f3
  v_smfmac_f32_16x16x64_bf16 v[64:67], v[60:63], a[144:151], v23
  v_smfmac_f32_16x16x64_bf16 v[68:71], v[60:63], a[152:159], v23
  v_smfmac_f32_16x16x64_bf16 v[72:75], v[60:63], a[160:167], v23
  v_smfmac_f32_16x16x64_bf16 v[76:79], v[60:63], a[168:175], v23
SL_m_done:
  s_nop 4
  v_pk_add_f32 v[88:89], v[64:65], v[66:67]
  v_pk_add_f32 v[90:91], v[68:69], v[70:71]
  ds_write_b128 v4, v[88:91] offset:0
  v_pk_add_f32 v[92:93], v[72:73], v[74:75]
  v_pk_add_f32 v[94:95], v[76:77], v[78:79]
  ds_write_b128 v4, v[92:95] offset:1088
  v_smfmac_f32_16x16x64_bf16 v[80:83], v[48:51], a[32:39], v23
  buffer_load_dwordx4 v[180:183], v12, s[4:7], s44 offen offset:0
  v_mov_b32 v36, 0
  v_smfmac_f32_16x16x64_bf16 v[84:87], v[48:51], a[40:47], v23
  buffer_load_dwordx4 v[184:187], v12, s[4:7], s44 offen offset:128
  v_mov_b32 v37, 0
  v_smfmac_f32_16x16x64_bf16 v[80:83], v[52:55], a[80:87], v23
  buffer_load_dwordx4 v[188:191], v12, s[4:7], s44 offen offset:1024
  v_mov_b32 v38, 0
  v_smfmac_f32_16x16x64_bf16 v[84:87], v[52:55], a[88:95], v23
  buffer_load_dwordx4 v[192:195], v12, s[4:7], s44 offen offset:1152
  v_mov_b32 v39, 0
  v_smfmac_f32_16x16x64_bf16 v[80:83], v[56:59], a[128:135], v23
  buffer_load_dwordx4 v[196:199], v13, s[4:7], s44 offen offset:0
  v_mov_b32 v40, 0
  s_waitcnt lgkmcnt(0)
  s_barrier
  ds_read2_b32 v[100:101], v6 offset0:0 offset1:2
  ds_read2_b32 v[102:103], v240 offset0:0 offset1:2
  ds_read2_b32 v[104:105], v241 offset0:0 offset1:2
  ds_read2_b32 v[106:107], v242 offset0:0 offset1:2
  v_smfmac_f32_16x16x64_bf16 v[84:87], v[56:59], a[136:143], v23
  v_mov_b32 v41, 0
  v_smfmac_f32_16x16x64_bf16 v[80:83], v[60:63], a[176:183], v23
  v_mov_b32 v42, 0
  v_smfmac_f32_16x16x64_bf16 v[84:87], v[60:63], a[184:191], v23
  v_mov_b32 v43, 0
  v_mov_b32 v44, 0
  v_mov_b32 v45, 0
  v_mov_b32 v46, 0
  v_mov_b32 v47, 0
  s_waitcnt lgkmcnt(2)
  v_pk_add_f32 v[100:101], v[100:101], v[102:103]
  s_waitcnt lgkmcnt(0)
  v_pk_add_f32 v[104:105], v[104:105], v[106:107]
  v_pk_add_f32 v[100:101], v[100:101], v[104:105]
  v_cvt_pk_bf16_f32 v112, v100, v101
  v_min_u32 v112, s54, v112
  buffer_store_dword v112, v7, s[4:7], s41 offen sc1
  v_pk_add_f32 v[96:97], v[80:81], v[82:83]
  v_pk_add_f32 v[98:99], v[84:85], v[86:87]
  ds_write_b128 v4, v[96:99] offset:2176
  v_mov_b64 v[212:213], 0
  v_mov_b64 v[214:215], 0
  v_mov_b64 v[216:217], 0
  v_mov_b64 v[218:219], 0
  v_mov_b64 v[220:221], 0
  v_mov_b64 v[222:223], 0
  v_mov_b64 v[224:225], 0
  v_mov_b64 v[226:227], 0
  v_mov_b64 v[228:229], 0
  v_mov_b64 v[230:231], 0
  s_waitcnt lgkmcnt(0)
  s_barrier
  ds_read_b64 v[88:89], v5 offset:0
  buffer_load_dwordx4 v[64:67], v9, s[4:7], s41 offen offset:0 sc1
  s_mov_b32 s42, s41
  s_add_u32 s90, s40, 1
  ds_read_b64 v[90:91], v5 offset:3264
  buffer_load_dwordx4 v[68:71], v9, s[4:7], s41 offen offset:1024 sc1
  s_and_b32 s90, s90, 3
  s_lshl_b32 s90, s90, 19
  ds_read_b64 v[92:93], v5 offset:6528
  buffer_load_dwordx4 v[72:75], v9, s[4:7], s41 offen offset:2048 sc1
  s_add_u32 s91, s90, 0x3800000
  s_add_u32 s55, s55, 0x40000
  ds_read_b64 v[94:95], v5 offset:9792
  buffer_load_dwordx4 v[76:79], v9, s[4:7], s41 offen offset:3072 sc1
  s_min_u32 s55, s55, 0xfc0000
  s_nop 0
  s_waitcnt lgkmcnt(2)
  v_pk_add_f32 v[88:89], v[88:89], v[90:91]
  s_waitcnt lgkmcnt(0)
  v_pk_add_f32 v[92:93], v[92:93], v[94:95]
  v_pk_add_f32 v[88:89], v[88:89], v[92:93]
  v_cvt_pk_bf16_f32 v113, v88, v89
  v_min_u32 v113, s54, v113
  buffer_store_dword v113, v8, s[4:7], s41 offen sc1
  s_add_u32 s8, s94, s55
  s_addc_u32 s9, s95, 0
  s_add_u32 s8, s8, s12
  s_addc_u32 s9, s9, 0
  s_add_u32 s10, s8, 0x1000000
  s_addc_u32 s11, s9, 0
  s_load_dword s16, s[8:9], 0
  s_load_dword s17, s[10:11], 0
  s_load_dword s18, s[8:9], 64
  s_load_dword s19, s[10:11], 64
  s_load_dword s20, s[8:9], 128
  s_load_dword s21, s[10:11], 128
  s_load_dword s22, s[8:9], 192
  s_load_dword s23, s[10:11], 192
  s_cmp_eq_u32 s40, 63
  s_cbranch_scc1 SL_last
  s_waitcnt vmcnt(4)
  v_max3_u32 v31, v64, v65, v66
  v_max_u32 v31, v31, v67
  v_cmp_eq_u32 vcc, -1, v31
  s_cbranch_vccnz SL_x_f0
  v_mfma_f32_16x16x32_bf16 v[44:47], v[64:67], v[64:67], v[44:47]
  s_waitcnt vmcnt(3)
  v_max3_u32 v31, v68, v69, v70
  v_max_u32 v31, v31, v71
  v_cmp_eq_u32 vcc, -1, v31
  v_mfma_f32_16x16x32_bf16 v[36:39], v[116:119], v[64:67], v[36:39]
  v_mfma_f32_16x16x32_bf16 v[40:43], v[132:135], v[64:67], v[40:43]
  s_cbranch_vccnz SL_x_f1
  v_mfma_f32_16x16x32_bf16 v[44:47], v[68:71], v[68:71], v[44:47]
  s_waitcnt vmcnt(2)
  v_max3_u32 v31, v72, v73, v74
  v_max_u32 v31, v31, v75
  v_cmp_eq_u32 vcc, -1, v31
  v_mfma_f32_16x16x32_bf16 v[36:39], v[120:123], v[68:71], v[36:39]
  v_mfma_f32_16x16x32_bf16 v[40:43], v[136:139], v[68:71], v[40:43]
  s_cbranch_vccnz SL_x_f2
  v_mfma_f32_16x16x32_bf16 v[44:47], v[72:75], v[72:75], v[44:47]
  s_waitcnt vmcnt(1)
  v_max3_u32 v31, v76, v77, v78
  v_max_u32 v31, v31, v79
  v_cmp_eq_u32 vcc, -1, v31
  v_mfma_f32_16x16x32_bf16 v[36:39], v[124:127], v[72:75], v[36:39]
  v_mfma_f32_16x16x32_bf16 v[40:43], v[140:143], v[72:75], v[40:43]
  s_cbranch_vccnz SL_x_f3
  v_mfma_f32_16x16x32_bf16 v[44:47], v[76:79], v[76:79], v[44:47]
  v_mfma_f32_16x16x32_bf16 v[36:39], v[128:131], v[76:79], v[36:39]
  v_mfma_f32_16x16x32_bf16 v[40:43], v[144:147], v[76:79], v[40:43]
SL_x_done:
  buffer_load_dwordx4 v[88:91], v10, s[4:7], s41 offen offset:0 sc1
  buffer_load_dwordx4 v[92:95], v10, s[4:7], s41 offen offset:1024 sc1
  s_mov_b64 vcc, s[48:49]
  s_nop 2
  v_max_f32 v30, v46, v47
  s_nop 0
  v_cndmask_b32_dpp v96, v40, v36, vcc quad_perm:[0,1,0,1] row_mask:0xf bank_mask:0xf
  v_cndmask_b32_dpp v97, v41, v37, vcc quad_perm:[0,1,0,1] row_mask:0xf bank_mask:0xf
  v_cndmask_b32_dpp v98, v42, v38, vcc quad_perm:[0,1,0,1] row_mask:0xf bank_mask:0xf
  v_cndmask_b32_dpp v99, v43, v39, vcc quad_perm:[0,1,0,1] row_mask:0xf bank_mask:0xf
  v_max3_f32 v29, v96, v97, v98
  s_nop 0
  v_max_f32_dpp v28, v30, v99 quad_perm:[0,1,0,1] row_mask:0xf bank_mask:0xf
  v_max_f32 v29, v29, v28
  s_nop 1
  v_max_f32_dpp v28, v29, v29 quad_perm:[2,3,0,1] row_mask:0xf bank_mask:0xf
  v_mov_b32 v29, v28
  s_nop 1
  v_permlane32_swap_b32 v28, v29
  v_max_f32 v28, v28, v29
  v_mov_b32 v29, v28
  s_nop 1
  v_permlane16_swap_b32 v28, v29
  v_max_f32 v28, v28, v29
  v_mul_f32 v28, s47, v28
  v_fma_f32 v96, v96, s47, -v28
  v_fma_f32 v97, v97, s47, -v28
  v_fma_f32 v98, v98, s47, -v28
  v_fma_f32 v99, v99, s47, -v28
  v_fma_f32 v46, v46, s47, -v28
  v_fma_f32 v47, v47, s47, -v28
  v_exp_f32 v96, v96
  v_exp_f32 v97, v97
  v_exp_f32 v98, v98
  v_exp_f32 v99, v99
  v_cvt_pk_bf16_f32 v236, v96, v97
  v_cvt_pk_bf16_f32 v237, v98, v99
  v_exp_f32 v46, v46
  v_mov_b32_dpp v100, v236 quad_perm:[0,1,0,1] row_mask:0xf bank_mask:0xf
  v_mov_b32_dpp v102, v236 quad_perm:[2,3,2,3] row_mask:0xf bank_mask:0xf
  v_mov_b32_dpp v101, v237 quad_perm:[0,1,0,1] row_mask:0xf bank_mask:0xf
  v_mov_b32_dpp v103, v237 quad_perm:[2,3,2,3] row_mask:0xf bank_mask:0xf
  v_exp_f32 v47, v47
  s_nop 0
  v_smfmac_f32_16x16x64_bf16 v[228:231], v[100:103], v[248:255], v23
  v_cvt_pk_bf16_f32 v238, v46, v47
  buffer_load_dwordx4 v[116:119], v11, s[4:7], s44 offen offset:0
  v_smfmac_f32_16x16x64_bf16 v[212:215], v[100:103], v[148:155], v23
  buffer_load_dwordx4 v[132:135], v11, s[4:7], s44 offen offset:64
  v_mov_b32_dpp v232, v238 quad_perm:[0,1,0,1] row_mask:0xf bank_mask:0xf
  v_smfmac_f32_16x16x64_bf16 v[216:219], v[100:103], v[156:163], v23
  buffer_load_dwordx4 v[120:123], v11, s[4:7], s44 offen offset:1024
  v_mov_b32_dpp v235, v238 quad_perm:[0,1,0,1] row_mask:0xf bank_mask:0xf
  v_smfmac_f32_16x16x64_bf16 v[220:223], v[100:103], v[164:171], v23
  buffer_load_dwordx4 v[136:139], v11, s[4:7], s44 offen offset:1088
  s_waitcnt vmcnt(4)
  v_max3_u32 v31, v88, v89, v90
  v_max3_u32 v31, v31, v91, v92
  v_smfmac_f32_16x16x32_bf16 v[228:231], v[232:233], v[248:251], v23
  v_max3_u32 v31, v31, v93, v94
  v_max_u32 v31, v31, v95
  v_cmp_eq_u32 vcc, -1, v31
  v_smfmac_f32_16x16x64_bf16 v[224:227], v[100:103], v[172:179], v23
  s_cbranch_vccnz SL_v_f
SL_v_ok:
  v_smfmac_f32_16x16x32_bf16 v[212:215], v[232:233], v[88:91], v23
  buffer_load_dwordx4 v[124:127], v11, s[4:7], s44 offen offset:2048
  buffer_load_dwordx4 v[140:143], v11, s[4:7], s44 offen offset:2112
  v_smfmac_f32_16x16x32_bf16 v[216:219], v[234:235], v[88:91], v23
  v_rcp_f32 v28, v228
  v_smfmac_f32_16x16x32_bf16 v[220:223], v[232:233], v[92:95], v23
  v_rcp_f32 v29, v229
  v_smfmac_f32_16x16x32_bf16 v[224:227], v[234:235], v[92:95], v23
  s_nop 0
  v_pk_mul_f32 v[212:213], v[212:213], v[28:29]
  v_pk_mul_f32 v[214:215], v[214:215], v[28:29]
  v_cvt_pk_bf16_f32 v104, v212, v214
  v_cvt_pk_bf16_f32 v108, v213, v215
  v_pk_mul_f32 v[216:217], v[216:217], v[28:29]
  v_pk_mul_f32 v[218:219], v[218:219], v[28:29]
  v_cvt_pk_bf16_f32 v105, v216, v218
  v_cvt_pk_bf16_f32 v109, v217, v219
  v_pk_mul_f32 v[220:221], v[220:221], v[28:29]
  v_pk_mul_f32 v[222:223], v[222:223], v[28:29]
  v_cvt_pk_bf16_f32 v106, v220, v222
  v_cvt_pk_bf16_f32 v110, v221, v223
  v_pk_mul_f32 v[224:225], v[224:225], v[28:29]
  v_pk_mul_f32 v[226:227], v[226:227], v[28:29]
  v_cvt_pk_bf16_f32 v107, v224, v226
  v_cvt_pk_bf16_f32 v111, v225, v227
  ds_write_b128 v14, v[104:107]
  ds_write_b128 v15, v[108:111]
  s_add_u32 s92, s40, 3
  s_min_u32 s92, s92, 63
  s_lshr_b32 s92, s92, 2
  s_lshl_b32 s92, s92, 9
  v_mov_b32 v246, s40
  s_waitcnt lgkmcnt(0)
  s_barrier
  ds_read_b128 v[48:51], v16 offset:0
  ds_read_b128 v[52:55], v16 offset:1024
  ds_read_b128 v[56:59], v16 offset:2048
  ds_read_b128 v[60:63], v16 offset:3072
  ds_read_b128 v[64:67], v16 offset:4096
  buffer_store_dword v22, v17, s[4:7], s43 offen sc1
  buffer_store_dword v112, v19, s[4:7], s45 offen sc1
  s_waitcnt lgkmcnt(4)
  v_smfmac_f32_16x16x64_bf16 v[32:35], v[48:51], a[192:199], v23
  ds_read_b128 v[68:71], v16 offset:5120
  buffer_store_dword v113, v20, s[4:7], s45 offen sc1
  s_waitcnt lgkmcnt(4)
  v_smfmac_f32_16x16x64_bf16 v[32:35], v[52:55], a[200:207], v23
  ds_read_b128 v[72:75], v16 offset:6144
  buffer_store_dword v246, v245, s[4:7], 0 offen sc1
  s_waitcnt lgkmcnt(4)
  v_smfmac_f32_16x16x64_bf16 v[32:35], v[56:59], a[208:215], v23
  ds_read_b128 v[76:79], v16 offset:7168
  buffer_load_dword v243, v244, s[4:7], s92 offen sc1
  s_waitcnt lgkmcnt(4)
  v_smfmac_f32_16x16x64_bf16 v[32:35], v[60:63], a[216:223], v23
  s_mov_b32 s13, s43
  s_waitcnt lgkmcnt(3)
  v_smfmac_f32_16x16x64_bf16 v[32:35], v[64:67], a[224:231], v23
  s_add_u32 s40, s40, 1
  s_waitcnt lgkmcnt(2)
  v_smfmac_f32_16x16x64_bf16 v[32:35], v[68:71], a[232:239], v23
  s_mov_b32 s41, s91
  s_waitcnt lgkmcnt(1)
  v_smfmac_f32_16x16x64_bf16 v[32:35], v[72:75], a[240:247], v23
  s_xor_b32 s43, s91, 0x100000
  s_waitcnt lgkmcnt(0)
  v_smfmac_f32_16x16x64_bf16 v[32:35], v[76:79], a[248:255], v23
  s_nop 7
  v_pk_add_f32 v[28:29], v[32:33], v[34:35]
  v_cvt_pk_bf16_f32 v28, v28, v29
  v_min_u32 v28, s54, v28
  buffer_store_dword v28, v17, s[4:7], s42 offen sc1
  buffer_store_dword v28, v18, s[4:7], s42 offen sc1
  s_branch SL_step
SL_last:
  buffer_store_dword v112, v19, s[4:7], s45 offen sc1
  buffer_store_dword v113, v20, s[4:7], s45 offen sc1
  s_branch L_join
SL_kv_f:
  s_sleep 8
  buffer_load_dword v243, v244, s[4:7], s92 offen sc1
  s_add_u32 s46, s46, 1
  s_cmp_ge_u32 s46, 131072
  s_cbranch_scc1 SL_rec_abort
  s_waitcnt vmcnt(0)
  s_branch SL_kv_chk
SL_g_f:
  s_mov_b64 exec, vcc
  buffer_load_dwordx4 v[36:39], v1, s[4:7], s42 offen sc1
  s_mov_b64 exec, -1
  s_add_u32 s46, s46, 1
  s_cmp_ge_u32 s46, 131072
  s_cbranch_scc1 SL_rec_abort
  s_waitcnt vmcnt(0)
  s_branch SL_g_chk
SL_m_f0:
  s_mov_b64 exec, vcc
  buffer_load_dwordx4 v[48:51], v3, s[4:7], s41 offen offset:0 sc1
  s_mov_b64 exec, -1
  s_waitcnt vmcnt(1)
  s_branch SL_m_0123_c1
SL_m_f1:
  s_mov_b64 exec, vcc
  buffer_load_dwordx4 v[52:55], v3, s[4:7], s41 offen offset:1024 sc1
  s_mov_b64 exec, -1
  s_waitcnt vmcnt(1)
  s_branch SL_m_123_c2
SL_m_f2:
  s_mov_b64 exec, vcc
  buffer_load_dwordx4 v[56:59], v3, s[4:7], s41 offen offset:2048 sc1
  s_mov_b64 exec, -1
  s_waitcnt vmcnt(1)
  s_branch SL_m_23_c3
SL_m_f3:
  s_mov_b64 exec, vcc
  buffer_load_dwordx4 v[60:63], v3, s[4:7], s41 offen offset:3072 sc1
  s_mov_b64 exec, -1
  s_nop 7
  s_branch SL_m_3_c3
SL_m_0_c0:
  v_max3_u32 v31, v48, v49, v50
  v_max_u32 v31, v31, v51
  v_cmp_eq_u32 vcc, -1, v31
  s_cbranch_vccz SL_m_0_ok0
SL_m_0_x0:
  s_mov_b64 exec, vcc
  buffer_load_dwordx4 v[48:51], v3, s[4:7], s41 offen offset:0 sc1
  s_mov_b64 exec, -1
  s_add_u32 s46, s46, 1
  s_cmp_ge_u32 s46, 131072
  s_cbranch_scc1 SL_rec_abort
  s_waitcnt vmcnt(2)
  s_branch SL_m_0_c0
SL_m_0_ok0:
  v_smfmac_f32_16x16x64_bf16 v[64:67], v[48:51], a[0:7], v23
  v_smfmac_f32_16x16x64_bf16 v[68:71], v[48:51], a[8:15], v23
  v_smfmac_f32_16x16x64_bf16 v[72:75], v[48:51], a[16:23], v23
  v_smfmac_f32_16x16x64_bf16 v[76:79], v[48:51], a[24:31], v23
  s_branch SL_m_done
SL_m_1_c1:
  v_max3_u32 v31, v52, v53, v54
  v_max_u32 v31, v31, v55
  v_cmp_eq_u32 vcc, -1, v31
  s_cbranch_vccz SL_m_1_ok1
SL_m_1_x1:
  s_mov_b64 exec, vcc
  buffer_load_dwordx4 v[52:55], v3, s[4:7], s41 offen offset:1024 sc1
  s_mov_b64 exec, -1
  s_add_u32 s46, s46, 1
  s_cmp_ge_u32 s46, 131072
  s_cbranch_scc1 SL_rec_abort
  s_waitcnt vmcnt(2)
  s_branch SL_m_1_c1
SL_m_1_ok1:
  v_smfmac_f32_16x16x64_bf16 v[64:67], v[52:55], a[48:55], v23
  v_smfmac_f32_16x16x64_bf16 v[68:71], v[52:55], a[56:63], v23
  v_smfmac_f32_16x16x64_bf16 v[72:75], v[52:55], a[64:71], v23
  v_smfmac_f32_16x16x64_bf16 v[76:79], v[52:55], a[72:79], v23
  s_branch SL_m_done
SL_m_2_c2:
  v_max3_u32 v31, v56, v57, v58
  v_max_u32 v31, v31, v59
  v_cmp_eq_u32 vcc, -1, v31
  s_cbranch_vccz SL_m_2_ok2
SL_m_2_x2:
  s_mov_b64 exec, vcc
  buffer_load_dwordx4 v[56:59], v3, s[4:7], s41 offen offset:2048 sc1
  s_mov_b64 exec, -1
  s_add_u32 s46, s46, 1
  s_cmp_ge_u32 s46, 131072
  s_cbranch_scc1 SL_rec_abort
  s_waitcnt vmcnt(2)
  s_branch SL_m_2_c2
SL_m_2_ok2:
  v_smfmac_f32_16x16x64_bf16 v[64:67], v[56:59], a[96:103], v23
  v_smfmac_f32_16x16x64_bf16 v[68:71], v[56:59], a[104:111], v23
  v_smfmac_f32_16x16x64_bf16 v[72:75], v[56:59], a[112:119], v23
  v_smfmac_f32_16x16x64_bf16 v[76:79], v[56:59], a[120:127], v23
  s_branch SL_m_done
SL_m_3_c3:
  v_max3_u32 v31, v60, v61, v62
  v_max_u32 v31, v31, v63
  v_cmp_eq_u32 vcc, -1, v31
  s_cbranch_vccz SL_m_3_ok3
SL_m_3_x3:
  s_mov_b64 exec, vcc
  buffer_load_dwordx4 v[60:63], v3, s[4:7], s41 offen offset:3072 sc1
  s_mov_b64 exec, -1
  s_add_u32 s46, s46, 1
  s_cmp_ge_u32 s46, 131072
  s_cbranch_scc1 SL_rec_abort
  s_waitcnt vmcnt(2)
  s_branch SL_m_3_c3
SL_m_3_ok3:
  v_smfmac_f32_16x16x64_bf16 v[64:67], v[60:63], a[144:151], v23
  v_smfmac_f32_16x16x64_bf16 v[68:71], v[60:63], a[152:159], v23
  v_smfmac_f32_16x16x64_bf16 v[72:75], v[60:63], a[160:167], v23
  v_smfmac_f32_16x16x64_bf16 v[76:79], v[60:63], a[168:175], v23
  s_branch SL_m_done
SL_m_01_c0:
  v_max3_u32 v31, v48, v49, v50
  v_max_u32 v31, v31, v51
  v_cmp_eq_u32 vcc, -1, v31
  s_cbranch_vccz SL_m_01_ok0
SL_m_01_x0:
  s_mov_b64 exec, vcc
  buffer_load_dwordx4 v[48:51], v3, s[4:7], s41 offen offset:0 sc1
  s_mov_b64 exec, -1
SL_m_01_c1:
  v_max3_u32 v31, v52, v53, v54
  v_max_u32 v31, v31, v55
  v_cmp_eq_u32 vcc, -1, v31
  s_cbranch_vccz SL_m_01_ok1
SL_m_01_x1:
  s_mov_b64 exec, vcc
  buffer_load_dwordx4 v[52:55], v3, s[4:7], s41 offen offset:1024 sc1
  s_mov_b64 exec, -1
  s_add_u32 s46, s46, 1
  s_cmp_ge_u32 s46, 131072
  s_cbranch_scc1 SL_rec_abort
  s_waitcnt vmcnt(4)
  s_branch SL_m_01_c0
SL_m_01_ok0:
  v_smfmac_f32_16x16x64_bf16 v[64:67], v[48:51], a[0:7], v23
  v_max3_u32 v31, v52, v53, v54
  v_max_u32 v31, v31, v55
  v_cmp_eq_u32 vcc, -1, v31
  v_smfmac_f32_16x16x64_bf16 v[68:71], v[48:51], a[8:15], v23
  v_smfmac_f32_16x16x64_bf16 v[72:75], v[48:51], a[16:23], v23
  v_smfmac_f32_16x16x64_bf16 v[76:79], v[48:51], a[24:31], v23
  s_cbranch_vccz SL_m_1_ok1
  s_branch SL_m_1_x1
SL_m_01_ok1:
  v_smfmac_f32_16x16x64_bf16 v[64:67], v[52:55], a[48:55], v23
  v_max3_u32 v31, v48, v49, v50
  v_max_u32 v31, v31, v51
  v_cmp_eq_u32 vcc, -1, v31
  v_smfmac_f32_16x16x64_bf16 v[68:71], v[52:55], a[56:63], v23
  v_smfmac_f32_16x16x64_bf16 v[72:75], v[52:55], a[64:71], v23
  v_smfmac_f32_16x16x64_bf16 v[76:79], v[52:55], a[72:79], v23
  s_cbranch_vccz SL_m_0_ok0
  s_branch SL_m_0_x0
SL_m_02_c0:
  v_max3_u32 v31, v48, v49, v50
  v_max_u32 v31, v31, v51
  v_cmp_eq_u32 vcc, -1, v31
  s_cbranch_vccz SL_m_02_ok0
SL_m_02_x0:
  s_mov_b64 exec, vcc
  buffer_load_dwordx4 v[48:51], v3, s[4:7], s41 offen offset:0 sc1
  s_mov_b64 exec, -1
SL_m_02_c2:
  v_max3_u32 v31, v56, v57, v58
  v_max_u32 v31, v31, v59
  v_cmp_eq_u32 vcc, -1, v31
  s_cbranch_vccz SL_m_02_ok2
SL_m_02_x2:
  s_mov_b64 exec, vcc
  buffer_load_dwordx4 v[56:59], v3, s[4:7], s41 offen offset:2048 sc1
  s_mov_b64 exec, -1
  s_add_u32 s46, s46, 1
  s_cmp_ge_u32 s46, 131072
  s_cbranch_scc1 SL_rec_abort
  s_waitcnt vmcnt(4)
  s_branch SL_m_02_c0
SL_m_02_ok0:
  v_smfmac_f32_16x16x64_bf16 v[64:67], v[48:51], a[0:7], v23
  v_max3_u32 v31, v56, v57, v58
  v_max_u32 v31, v31, v59
  v_cmp_eq_u32 vcc, -1, v31
  v_smfmac_f32_16x16x64_bf16 v[68:71], v[48:51], a[8:15], v23
  v_smfmac_f32_16x16x64_bf16 v[72:75], v[48:51], a[16:23], v23
  v_smfmac_f32_16x16x64_bf16 v[76:79], v[48:51], a[24:31], v23
  s_cbranch_vccz SL_m_2_ok2
  s_branch SL_m_2_x2
SL_m_02_ok2:
  v_smfmac_f32_16x16x64_bf16 v[64:67], v[56:59], a[96:103], v23
  v_max3_u32 v31, v48, v49, v50
  v_max_u32 v31, v31, v51
  v_cmp_eq_u32 vcc, -1, v31
  v_smfmac_f32_16x16x64_bf16 v[68:71], v[56:59], a[104:111], v23
  v_smfmac_f32_16x16x64_bf16 v[72:75], v[56:59], a[112:119], v23
  v_smfmac_f32_16x16x64_bf16 v[76:79], v[56:59], a[120:127], v23
  s_cbranch_vccz SL_m_0_ok0
  s_branch SL_m_0_x0
SL_m_03_c0:
  v_max3_u32 v31, v48, v49, v50
  v_max_u32 v31, v31, v51
  v_cmp_eq_u32 vcc, -1, v31
  s_cbranch_vccz SL_m_03_ok0
SL_m_03_x0:
  s_mov_b64 exec, vcc
  buffer_load_dwordx4 v[48:51], v3, s[4:7], s41 offen offset:0 sc1
  s_mov_b64 exec, -1
SL_m_03_c3:
  v_max3_u32 v31, v60, v61, v62
  v_max_u32 v31, v31, v63
  v_cmp_eq_u32 vcc, -1, v31
  s_cbranch_vccz SL_m_03_ok3
SL_m_03_x3:
  s_mov_b64 exec, vcc
  buffer_load_dwordx4 v[60:63], v3, s[4:7], s41 offen offset:3072 sc1
  s_mov_b64 exec, -1
  s_add_u32 s46, s46, 1
  s_cmp_ge_u32 s46, 131072
  s_cbranch_scc1 SL_rec_abort
  s_waitcnt vmcnt(4)
  s_branch SL_m_03_c0
SL_m_03_ok0:
  v_smfmac_f32_16x16x64_bf16 v[64:67], v[48:51], a[0:7], v23
  v_max3_u32 v31, v60, v61, v62
  v_max_u32 v31, v31, v63
  v_cmp_eq_u32 vcc, -1, v31
  v_smfmac_f32_16x16x64_bf16 v[68:71], v[48:51], a[8:15], v23
  v_smfmac_f32_16x16x64_bf16 v[72:75], v[48:51], a[16:23], v23
  v_smfmac_f32_16x16x64_bf16 v[76:79], v[48:51], a[24:31], v23
  s_cbranch_vccz SL_m_3_ok3
  s_branch SL_m_3_x3
SL_m_03_ok3:
  v_smfmac_f32_16x16x64_bf16 v[64:67], v[60:63], a[144:151], v23
  v_max3_u32 v31, v48, v49, v50
  v_max_u32 v31, v31, v51
  v_cmp_eq_u32 vcc, -1, v31
  v_smfmac_f32_16x16x64_bf16 v[68:71], v[60:63], a[152:159], v23
  v_smfmac_f32_16x16x64_bf16 v[72:75], v[60:63], a[160:167], v23
  v_smfmac_f32_16x16x64_bf16 v[76:79], v[60:63], a[168:175], v23
  s_cbranch_vccz SL_m_0_ok0
  s_branch SL_m_0_x0
SL_m_12_c1:
  v_max3_u32 v31, v52, v53, v54
  v_max_u32 v31, v31, v55
  v_cmp_eq_u32 vcc, -1, v31
  s_cbranch_vccz SL_m_12_ok1
SL_m_12_x1:
  s_mov_b64 exec, vcc
  buffer_load_dwordx4 v[52:55], v3, s[4:7], s41 offen offset:1024 sc1
  s_mov_b64 exec, -1
SL_m_12_c2:
  v_max3_u32 v31, v56, v57, v58
  v_max_u32 v31, v31, v59
  v_cmp_eq_u32 vcc, -1, v31
  s_cbranch_vccz SL_m_12_ok2
SL_m_12_x2:
  s_mov_b64 exec, vcc
  buffer_load_dwordx4 v[56:59], v3, s[4:7], s41 offen offset:2048 sc1
  s_mov_b64 exec, -1
  s_add_u32 s46, s46, 1
  s_cmp_ge_u32 s46, 131072
  s_cbranch_scc1 SL_rec_abort
  s_waitcnt vmcnt(4)
  s_branch SL_m_12_c1
SL_m_12_ok1:
  v_smfmac_f32_16x16x64_bf16 v[64:67], v[52:55], a[48:55], v23
  v_max3_u32 v31, v56, v57, v58
  v_max_u32 v31, v31, v59
  v_cmp_eq_u32 vcc, -1, v31
  v_smfmac_f32_16x16x64_bf16 v[68:71], v[52:55], a[56:63], v23
  v_smfmac_f32_16x16x64_bf16 v[72:75], v[52:55], a[64:71], v23
  v_smfmac_f32_16x16x64_bf16 v[76:79], v[52:55], a[72:79], v23
  s_cbranch_vccz SL_m_2_ok2
  s_branch SL_m_2_x2
SL_m_12_ok2:
  v_smfmac_f32_16x16x64_bf16 v[64:67], v[56:59], a[96:103], v23
  v_max3_u32 v31, v52, v53, v54
  v_max_u32 v31, v31, v55
  v_cmp_eq_u32 vcc, -1, v31
  v_smfmac_f32_16x16x64_bf16 v[68:71], v[56:59], a[104:111], v23
  v_smfmac_f32_16x16x64_bf16 v[72:75], v[56:59], a[112:119], v23
  v_smfmac_f32_16x16x64_bf16 v[76:79], v[56:59], a[120:127], v23
  s_cbranch_vccz SL_m_1_ok1
  s_branch SL_m_1_x1
SL_m_13_c1:
  v_max3_u32 v31, v52, v53, v54
  v_max_u32 v31, v31, v55
  v_cmp_eq_u32 vcc, -1, v31
  s_cbranch_vccz SL_m_13_ok1
SL_m_13_x1:
  s_mov_b64 exec, vcc
  buffer_load_dwordx4 v[52:55], v3, s[4:7], s41 offen offset:1024 sc1
  s_mov_b64 exec, -1
SL_m_13_c3:
  v_max3_u32 v31, v60, v61, v62
  v_max_u32 v31, v31, v63
  v_cmp_eq_u32 vcc, -1, v31
  s_cbranch_vccz SL_m_13_ok3
SL_m_13_x3:
  s_mov_b64 exec, vcc
  buffer_load_dwordx4 v[60:63], v3, s[4:7], s41 offen offset:3072 sc1
  s_mov_b64 exec, -1
  s_add_u32 s46, s46, 1
  s_cmp_ge_u32 s46, 131072
  s_cbranch_scc1 SL_rec_abort
  s_waitcnt vmcnt(4)
  s_branch SL_m_13_c1
SL_m_13_ok1:
  v_smfmac_f32_16x16x64_bf16 v[64:67], v[52:55], a[48:55], v23
  v_max3_u32 v31, v60, v61, v62
  v_max_u32 v31, v31, v63
  v_cmp_eq_u32 vcc, -1, v31
  v_smfmac_f32_16x16x64_bf16 v[68:71], v[52:55], a[56:63], v23
  v_smfmac_f32_16x16x64_bf16 v[72:75], v[52:55], a[64:71], v23
  v_smfmac_f32_16x16x64_bf16 v[76:79], v[52:55], a[72:79], v23
  s_cbranch_vccz SL_m_3_ok3
  s_branch SL_m_3_x3
SL_m_13_ok3:
  v_smfmac_f32_16x16x64_bf16 v[64:67], v[60:63], a[144:151], v23
  v_max3_u32 v31, v52, v53, v54
  v_max_u32 v31, v31, v55
  v_cmp_eq_u32 vcc, -1, v31
  v_smfmac_f32_16x16x64_bf16 v[68:71], v[60:63], a[152:159], v23
  v_smfmac_f32_16x16x64_bf16 v[72:75], v[60:63], a[160:167], v23
  v_smfmac_f32_16x16x64_bf16 v[76:79], v[60:63], a[168:175], v23
  s_cbranch_vccz SL_m_1_ok1
  s_branch SL_m_1_x1
SL_m_23_c2:
  v_max3_u32 v31, v56, v57, v58
  v_max_u32 v31, v31, v59
  v_cmp_eq_u32 vcc, -1, v31
  s_cbranch_vccz SL_m_23_ok2
SL_m_23_x2:
  s_mov_b64 exec, vcc
  buffer_load_dwordx4 v[56:59], v3, s[4:7], s41 offen offset:2048 sc1
  s_mov_b64 exec, -1
SL_m_23_c3:
  v_max3_u32 v31, v60, v61, v62
  v_max_u32 v31, v31, v63
  v_cmp_eq_u32 vcc, -1, v31
  s_cbranch_vccz SL_m_23_ok3
SL_m_23_x3:
  s_mov_b64 exec, vcc
  buffer_load_dwordx4 v[60:63], v3, s[4:7], s41 offen offset:3072 sc1
  s_mov_b64 exec, -1
  s_add_u32 s46, s46, 1
  s_cmp_ge_u32 s46, 131072
  s_cbranch_scc1 SL_rec_abort
  s_waitcnt vmcnt(4)
  s_branch SL_m_23_c2
SL_m_23_ok2:
  v_smfmac_f32_16x16x64_bf16 v[64:67], v[56:59], a[96:103], v23
  v_max3_u32 v31, v60, v61, v62
  v_max_u32 v31, v31, v63
  v_cmp_eq_u32 vcc, -1, v31
  v_smfmac_f32_16x16x64_bf16 v[68:71], v[56:59], a[104:111], v23
  v_smfmac_f32_16x16x64_bf16 v[72:75], v[56:59], a[112:119], v23
  v_smfmac_f32_16x16x64_bf16 v[76:79], v[56:59], a[120:127], v23
  s_cbranch_vccz SL_m_3_ok3
  s_branch SL_m_3_x3
SL_m_23_ok3:
  v_smfmac_f32_16x16x64_bf16 v[64:67], v[60:63], a[144:151], v23
  v_max3_u32 v31, v56, v57, v58
  v_max_u32 v31, v31, v59
  v_cmp_eq_u32 vcc, -1, v31
  v_smfmac_f32_16x16x64_bf16 v[68:71], v[60:63], a[152:159], v23
  v_smfmac_f32_16x16x64_bf16 v[72:75], v[60:63], a[160:167], v23
  v_smfmac_f32_16x16x64_bf16 v[76:79], v[60:63], a[168:175], v23
  s_cbranch_vccz SL_m_2_ok2
  s_branch SL_m_2_x2
SL_m_012_c0:
  v_max3_u32 v31, v48, v49, v50
  v_max_u32 v31, v31, v51
  v_cmp_eq_u32 vcc, -1, v31
  s_cbranch_vccz SL_m_012_ok0
SL_m_012_x0:
  s_mov_b64 exec, vcc
  buffer_load_dwordx4 v[48:51], v3, s[4:7], s41 offen offset:0 sc1
  s_mov_b64 exec, -1
SL_m_012_c1:
  v_max3_u32 v31, v52, v53, v54
  v_max_u32 v31, v31, v55
  v_cmp_eq_u32 vcc, -1, v31
  s_cbranch_vccz SL_m_012_ok1
SL_m_012_x1:
  s_mov_b64 exec, vcc
  buffer_load_dwordx4 v[52:55], v3, s[4:7], s41 offen offset:1024 sc1
  s_mov_b64 exec, -1
SL_m_012_c2:
  v_max3_u32 v31, v56, v57, v58
  v_max_u32 v31, v31, v59
  v_cmp_eq_u32 vcc, -1, v31
  s_cbranch_vccz SL_m_012_ok2
SL_m_012_x2:
  s_mov_b64 exec, vcc
  buffer_load_dwordx4 v[56:59], v3, s[4:7], s41 offen offset:2048 sc1
  s_mov_b64 exec, -1
  s_add_u32 s46, s46, 1
  s_cmp_ge_u32 s46, 131072
  s_cbranch_scc1 SL_rec_abort
  s_waitcnt vmcnt(4)
  s_branch SL_m_012_c0
SL_m_012_ok0:
  v_smfmac_f32_16x16x64_bf16 v[64:67], v[48:51], a[0:7], v23
  v_max3_u32 v31, v52, v53, v54
  v_max_u32 v31, v31, v55
  v_cmp_eq_u32 vcc, -1, v31
  v_smfmac_f32_16x16x64_bf16 v[68:71], v[48:51], a[8:15], v23
  v_smfmac_f32_16x16x64_bf16 v[72:75], v[48:51], a[16:23], v23
  v_smfmac_f32_16x16x64_bf16 v[76:79], v[48:51], a[24:31], v23
  s_cbranch_vccz SL_m_12_ok1
  s_branch SL_m_12_x1
SL_m_012_ok1:
  v_smfmac_f32_16x16x64_bf16 v[64:67], v[52:55], a[48:55], v23
  v_max3_u32 v31, v56, v57, v58
  v_max_u32 v31, v31, v59
  v_cmp_eq_u32 vcc, -1, v31
  v_smfmac_f32_16x16x64_bf16 v[68:71], v[52:55], a[56:63], v23
  v_smfmac_f32_16x16x64_bf16 v[72:75], v[52:55], a[64:71], v23
  v_smfmac_f32_16x16x64_bf16 v[76:79], v[52:55], a[72:79], v23
  s_cbranch_vccz SL_m_02_ok2
  s_branch SL_m_02_x2
SL_m_012_ok2:
  v_smfmac_f32_16x16x64_bf16 v[64:67], v[56:59], a[96:103], v23
  v_max3_u32 v31, v48, v49, v50
  v_max_u32 v31, v31, v51
  v_cmp_eq_u32 vcc, -1, v31
  v_smfmac_f32_16x16x64_bf16 v[68:71], v[56:59], a[104:111], v23
  v_smfmac_f32_16x16x64_bf16 v[72:75], v[56:59], a[112:119], v23
  v_smfmac_f32_16x16x64_bf16 v[76:79], v[56:59], a[120:127], v23
  s_cbranch_vccz SL_m_01_ok0
  s_branch SL_m_01_x0
SL_m_013_c0:
  v_max3_u32 v31, v48, v49, v50
  v_max_u32 v31, v31, v51
  v_cmp_eq_u32 vcc, -1, v31
  s_cbranch_vccz SL_m_013_ok0
SL_m_013_x0:
  s_mov_b64 exec, vcc
  buffer_load_dwordx4 v[48:51], v3, s[4:7], s41 offen offset:0 sc1
  s_mov_b64 exec, -1
SL_m_013_c1:
  v_max3_u32 v31, v52, v53, v54
  v_max_u32 v31, v31, v55
  v_cmp_eq_u32 vcc, -1, v31
  s_cbranch_vccz SL_m_013_ok1
SL_m_013_x1:
  s_mov_b64 exec, vcc
  buffer_load_dwordx4 v[52:55], v3, s[4:7], s41 offen offset:1024 sc1
  s_mov_b64 exec, -1
SL_m_013_c3:
  v_max3_u32 v31, v60, v61, v62
  v_max_u32 v31, v31, v63
  v_cmp_eq_u32 vcc, -1, v31
  s_cbranch_vccz SL_m_013_ok3
SL_m_013_x3:
  s_mov_b64 exec, vcc
  buffer_load_dwordx4 v[60:63], v3, s[4:7], s41 offen offset:3072 sc1
  s_mov_b64 exec, -1
  s_add_u32 s46, s46, 1
  s_cmp_ge_u32 s46, 131072
  s_cbranch_scc1 SL_rec_abort
  s_waitcnt vmcnt(4)
  s_branch SL_m_013_c0
SL_m_013_ok0:
  v_smfmac_f32_16x16x64_bf16 v[64:67], v[48:51], a[0:7], v23
  v_max3_u32 v31, v52, v53, v54
  v_max_u32 v31, v31, v55
  v_cmp_eq_u32 vcc, -1, v31
  v_smfmac_f32_16x16x64_bf16 v[68:71], v[48:51], a[8:15], v23
  v_smfmac_f32_16x16x64_bf16 v[72:75], v[48:51], a[16:23], v23
  v_smfmac_f32_16x16x64_bf16 v[76:79], v[48:51], a[24:31], v23
  s_cbranch_vccz SL_m_13_ok1
  s_branch SL_m_13_x1
SL_m_013_ok1:
  v_smfmac_f32_16x16x64_bf16 v[64:67], v[52:55], a[48:55], v23
  v_max3_u32 v31, v60, v61, v62
  v_max_u32 v31, v31, v63
  v_cmp_eq_u32 vcc, -1, v31
  v_smfmac_f32_16x16x64_bf16 v[68:71], v[52:55], a[56:63], v23
  v_smfmac_f32_16x16x64_bf16 v[72:75], v[52:55], a[64:71], v23
  v_smfmac_f32_16x16x64_bf16 v[76:79], v[52:55], a[72:79], v23
  s_cbranch_vccz SL_m_03_ok3
  s_branch SL_m_03_x3
SL_m_013_ok3:
  v_smfmac_f32_16x16x64_bf16 v[64:67], v[60:63], a[144:151], v23
  v_max3_u32 v31, v48, v49, v50
  v_max_u32 v31, v31, v51
  v_cmp_eq_u32 vcc, -1, v31
  v_smfmac_f32_16x16x64_bf16 v[68:71], v[60:63], a[152:159], v23
  v_smfmac_f32_16x16x64_bf16 v[72:75], v[60:63], a[160:167], v23
  v_smfmac_f32_16x16x64_bf16 v[76:79], v[60:63], a[168:175], v23
  s_cbranch_vccz SL_m_01_ok0
  s_branch SL_m_01_x0
SL_m_023_c0:
  v_max3_u32 v31, v48, v49, v50
  v_max_u32 v31, v31, v51
  v_cmp_eq_u32 vcc, -1, v31
  s_cbranch_vccz SL_m_023_ok0
SL_m_023_x0:
  s_mov_b64 exec, vcc
  buffer_load_dwordx4 v[48:51], v3, s[4:7], s41 offen offset:0 sc1
  s_mov_b64 exec, -1
SL_m_023_c2:
  v_max3_u32 v31, v56, v57, v58
  v_max_u32 v31, v31, v59
  v_cmp_eq_u32 vcc, -1, v31
  s_cbranch_vccz SL_m_023_ok2
SL_m_023_x2:
  s_mov_b64 exec, vcc
  buffer_load_dwordx4 v[56:59], v3, s[4:7], s41 offen offset:2048 sc1
  s_mov_b64 exec, -1
SL_m_023_c3:
  v_max3_u32 v31, v60, v61, v62
  v_max_u32 v31, v31, v63
  v_cmp_eq_u32 vcc, -1, v31
  s_cbranch_vccz SL_m_023_ok3
SL_m_023_x3:
  s_mov_b64 exec, vcc
  buffer_load_dwordx4 v[60:63], v3, s[4:7], s41 offen offset:3072 sc1
  s_mov_b64 exec, -1
  s_add_u32 s46, s46, 1
  s_cmp_ge_u32 s46, 131072
  s_cbranch_scc1 SL_rec_abort
  s_waitcnt vmcnt(4)
  s_branch SL_m_023_c0
SL_m_023_ok0:
  v_smfmac_f32_16x16x64_bf16 v[64:67], v[48:51], a[0:7], v23
  v_max3_u32 v31, v56, v57, v58
  v_max_u32 v31, v31, v59
  v_cmp_eq_u32 vcc, -1, v31
  v_smfmac_f32_16x16x64_bf16 v[68:71], v[48:51], a[8:15], v23
  v_smfmac_f32_16x16x64_bf16 v[72:75], v[48:51], a[16:23], v23
  v_smfmac_f32_16x16x64_bf16 v[76:79], v[48:51], a[24:31], v23
  s_cbranch_vccz SL_m_23_ok2
  s_branch SL_m_23_x2
SL_m_023_ok2:
  v_smfmac_f32_16x16x64_bf16 v[64:67], v[56:59], a[96:103], v23
  v_max3_u32 v31, v60, v61, v62
  v_max_u32 v31, v31, v63
  v_cmp_eq_u32 vcc, -1, v31
  v_smfmac_f32_16x16x64_bf16 v[68:71], v[56:59], a[104:111], v23
  v_smfmac_f32_16x16x64_bf16 v[72:75], v[56:59], a[112:119], v23
  v_smfmac_f32_16x16x64_bf16 v[76:79], v[56:59], a[120:127], v23
  s_cbranch_vccz SL_m_03_ok3
  s_branch SL_m_03_x3
SL_m_023_ok3:
  v_smfmac_f32_16x16x64_bf16 v[64:67], v[60:63], a[144:151], v23
  v_max3_u32 v31, v48, v49, v50
  v_max_u32 v31, v31, v51
  v_cmp_eq_u32 vcc, -1, v31
  v_smfmac_f32_16x16x64_bf16 v[68:71], v[60:63], a[152:159], v23
  v_smfmac_f32_16x16x64_bf16 v[72:75], v[60:63], a[160:167], v23
  v_smfmac_f32_16x16x64_bf16 v[76:79], v[60:63], a[168:175], v23
  s_cbranch_vccz SL_m_02_ok0
  s_branch SL_m_02_x0
SL_m_123_c1:
  v_max3_u32 v31, v52, v53, v54
  v_max_u32 v31, v31, v55
  v_cmp_eq_u32 vcc, -1, v31
  s_cbranch_vccz SL_m_123_ok1
SL_m_123_x1:
  s_mov_b64 exec, vcc
  buffer_load_dwordx4 v[52:55], v3, s[4:7], s41 offen offset:1024 sc1
  s_mov_b64 exec, -1
SL_m_123_c2:
  v_max3_u32 v31, v56, v57, v58
  v_max_u32 v31, v31, v59
  v_cmp_eq_u32 vcc, -1, v31
  s_cbranch_vccz SL_m_123_ok2
SL_m_123_x2:
  s_mov_b64 exec, vcc
  buffer_load_dwordx4 v[56:59], v3, s[4:7], s41 offen offset:2048 sc1
  s_mov_b64 exec, -1
SL_m_123_c3:
  v_max3_u32 v31, v60, v61, v62
  v_max_u32 v31, v31, v63
  v_cmp_eq_u32 vcc, -1, v31
  s_cbranch_vccz SL_m_123_ok3
SL_m_123_x3:
  s_mov_b64 exec, vcc
  buffer_load_dwordx4 v[60:63], v3, s[4:7], s41 offen offset:3072 sc1
  s_mov_b64 exec, -1
  s_add_u32 s46, s46, 1
  s_cmp_ge_u32 s46, 131072
  s_cbranch_scc1 SL_rec_abort
  s_waitcnt vmcnt(4)
  s_branch SL_m_123_c1
SL_m_123_ok1:
  v_smfmac_f32_16x16x64_bf16 v[64:67], v[52:55], a[48:55], v23
  v_max3_u32 v31, v56, v57, v58
  v_max_u32 v31, v31, v59
  v_cmp_eq_u32 vcc, -1, v31
  v_smfmac_f32_16x16x64_bf16 v[68:71], v[52:55], a[56:63], v23
  v_smfmac_f32_16x16x64_bf16 v[72:75], v[52:55], a[64:71], v23
  v_smfmac_f32_16x16x64_bf16 v[76:79], v[52:55], a[72:79], v23
  s_cbranch_vccz SL_m_23_ok2
  s_branch SL_m_23_x2
SL_m_123_ok2:
  v_smfmac_f32_16x16x64_bf16 v[64:67], v[56:59], a[96:103], v23
  v_max3_u32 v31, v60, v61, v62
  v_max_u32 v31, v31, v63
  v_cmp_eq_u32 vcc, -1, v31
  v_smfmac_f32_16x16x64_bf16 v[68:71], v[56:59], a[104:111], v23
  v_smfmac_f32_16x16x64_bf16 v[72:75], v[56:59], a[112:119], v23
  v_smfmac_f32_16x16x64_bf16 v[76:79], v[56:59], a[120:127], v23
  s_cbranch_vccz SL_m_13_ok3
  s_branch SL_m_13_x3
SL_m_123_ok3:
  v_smfmac_f32_16x16x64_bf16 v[64:67], v[60:63], a[144:151], v23
  v_max3_u32 v31, v52, v53, v54
  v_max_u32 v31, v31, v55
  v_cmp_eq_u32 vcc, -1, v31
  v_smfmac_f32_16x16x64_bf16 v[68:71], v[60:63], a[152:159], v23
  v_smfmac_f32_16x16x64_bf16 v[72:75], v[60:63], a[160:167], v23
  v_smfmac_f32_16x16x64_bf16 v[76:79], v[60:63], a[168:175], v23
  s_cbranch_vccz SL_m_12_ok1
  s_branch SL_m_12_x1
SL_m_0123_c0:
  v_max3_u32 v31, v48, v49, v50
  v_max_u32 v31, v31, v51
  v_cmp_eq_u32 vcc, -1, v31
  s_cbranch_vccz SL_m_0123_ok0
SL_m_0123_x0:
  s_mov_b64 exec, vcc
  buffer_load_dwordx4 v[48:51], v3, s[4:7], s41 offen offset:0 sc1
  s_mov_b64 exec, -1
SL_m_0123_c1:
  v_max3_u32 v31, v52, v53, v54
  v_max_u32 v31, v31, v55
  v_cmp_eq_u32 vcc, -1, v31
  s_cbranch_vccz SL_m_0123_ok1
SL_m_0123_x1:
  s_mov_b64 exec, vcc
  buffer_load_dwordx4 v[52:55], v3, s[4:7], s41 offen offset:1024 sc1
  s_mov_b64 exec, -1
SL_m_0123_c2:
  v_max3_u32 v31, v56, v57, v58
  v_max_u32 v31, v31, v59
  v_cmp_eq_u32 vcc, -1, v31
  s_cbranch_vccz SL_m_0123_ok2
SL_m_0123_x2:
  s_mov_b64 exec, vcc
  buffer_load_dwordx4 v[56:59], v3, s[4:7], s41 offen offset:2048 sc1
  s_mov_b64 exec, -1
SL_m_0123_c3:
  v_max3_u32 v31, v60, v61, v62
  v_max_u32 v31, v31, v63
  v_cmp_eq_u32 vcc, -1, v31
  s_cbranch_vccz SL_m_0123_ok3
SL_m_0123_x3:
  s_mov_b64 exec, vcc
  buffer_load_dwordx4 v[60:63], v3, s[4:7], s41 offen offset:3072 sc1
  s_mov_b64 exec, -1
  s_add_u32 s46, s46, 1
  s_cmp_ge_u32 s46, 131072
  s_cbranch_scc1 SL_rec_abort
  s_waitcnt vmcnt(4)
  s_branch SL_m_0123_c0
SL_m_0123_ok0:
  v_smfmac_f32_16x16x64_bf16 v[64:67], v[48:51], a[0:7], v23
  v_max3_u32 v31, v52, v53, v54
  v_max_u32 v31, v31, v55
  v_cmp_eq_u32 vcc, -1, v31
  v_smfmac_f32_16x16x64_bf16 v[68:71], v[48:51], a[8:15], v23
  v_smfmac_f32_16x16x64_bf16 v[72:75], v[48:51], a[16:23], v23
  v_smfmac_f32_16x16x64_bf16 v[76:79], v[48:51], a[24:31], v23
  s_cbranch_vccz SL_m_123_ok1
  s_branch SL_m_123_x1
SL_m_0123_ok1:
  v_smfmac_f32_16x16x64_bf16 v[64:67], v[52:55], a[48:55], v23
  v_max3_u32 v31, v56, v57, v58
  v_max_u32 v31, v31, v59
  v_cmp_eq_u32 vcc, -1, v31
  v_smfmac_f32_16x16x64_bf16 v[68:71], v[52:55], a[56:63], v23
  v_smfmac_f32_16x16x64_bf16 v[72:75], v[52:55], a[64:71], v23
  v_smfmac_f32_16x16x64_bf16 v[76:79], v[52:55], a[72:79], v23
  s_cbranch_vccz SL_m_023_ok2
  s_branch SL_m_023_x2
SL_m_0123_ok2:
  v_smfmac_f32_16x16x64_bf16 v[64:67], v[56:59], a[96:103], v23
  v_max3_u32 v31, v60, v61, v62
  v_max_u32 v31, v31, v63
  v_cmp_eq_u32 vcc, -1, v31
  v_smfmac_f32_16x16x64_bf16 v[68:71], v[56:59], a[104:111], v23
  v_smfmac_f32_16x16x64_bf16 v[72:75], v[56:59], a[112:119], v23
  v_smfmac_f32_16x16x64_bf16 v[76:79], v[56:59], a[120:127], v23
  s_cbranch_vccz SL_m_013_ok3
  s_branch SL_m_013_x3
SL_m_0123_ok3:
  v_smfmac_f32_16x16x64_bf16 v[64:67], v[60:63], a[144:151], v23
  v_max3_u32 v31, v48, v49, v50
  v_max_u32 v31, v31, v51
  v_cmp_eq_u32 vcc, -1, v31
  v_smfmac_f32_16x16x64_bf16 v[68:71], v[60:63], a[152:159], v23
  v_smfmac_f32_16x16x64_bf16 v[72:75], v[60:63], a[160:167], v23
  v_smfmac_f32_16x16x64_bf16 v[76:79], v[60:63], a[168:175], v23
  s_cbranch_vccz SL_m_012_ok0
  s_branch SL_m_012_x0
SL_x_f0:
  s_mov_b64 exec, vcc
  buffer_load_dwordx4 v[64:67], v9, s[4:7], s41 offen offset:0 sc1
  s_mov_b64 exec, -1
  s_waitcnt vmcnt(2)
  s_branch SL_x_0123_c1
SL_x_f1:
  s_mov_b64 exec, vcc
  buffer_load_dwordx4 v[68:71], v9, s[4:7], s41 offen offset:1024 sc1
  s_mov_b64 exec, -1
  s_waitcnt vmcnt(2)
  s_branch SL_x_123_c2
SL_x_f2:
  s_mov_b64 exec, vcc
  buffer_load_dwordx4 v[72:75], v9, s[4:7], s41 offen offset:2048 sc1
  s_mov_b64 exec, -1
  s_waitcnt vmcnt(2)
  s_branch SL_x_23_c3
SL_x_f3:
  s_mov_b64 exec, vcc
  buffer_load_dwordx4 v[76:79], v9, s[4:7], s41 offen offset:3072 sc1
  s_mov_b64 exec, -1
  s_nop 7
  s_branch SL_x_3_c3
SL_x_0_c0:
  v_max3_u32 v31, v64, v65, v66
  v_max_u32 v31, v31, v67
  v_cmp_eq_u32 vcc, -1, v31
  s_cbranch_vccz SL_x_0_ok0
SL_x_0_x0:
  s_mov_b64 exec, vcc
  buffer_load_dwordx4 v[64:67], v9, s[4:7], s41 offen offset:0 sc1
  s_mov_b64 exec, -1
  s_add_u32 s46, s46, 1
  s_cmp_ge_u32 s46, 131072
  s_cbranch_scc1 SL_rec_abort
  s_waitcnt vmcnt(2)
  s_branch SL_x_0_c0
SL_x_0_ok0:
  v_mfma_f32_16x16x32_bf16 v[44:47], v[64:67], v[64:67], v[44:47]
  v_mfma_f32_16x16x32_bf16 v[36:39], v[116:119], v[64:67], v[36:39]
  v_mfma_f32_16x16x32_bf16 v[40:43], v[132:135], v[64:67], v[40:43]
  s_branch SL_x_done
SL_x_1_c1:
  v_max3_u32 v31, v68, v69, v70
  v_max_u32 v31, v31, v71
  v_cmp_eq_u32 vcc, -1, v31
  s_cbranch_vccz SL_x_1_ok1
SL_x_1_x1:
  s_mov_b64 exec, vcc
  buffer_load_dwordx4 v[68:71], v9, s[4:7], s41 offen offset:1024 sc1
  s_mov_b64 exec, -1
  s_add_u32 s46, s46, 1
  s_cmp_ge_u32 s46, 131072
  s_cbranch_scc1 SL_rec_abort
  s_waitcnt vmcnt(2)
  s_branch SL_x_1_c1
SL_x_1_ok1:
  v_mfma_f32_16x16x32_bf16 v[44:47], v[68:71], v[68:71], v[44:47]
  v_mfma_f32_16x16x32_bf16 v[36:39], v[120:123], v[68:71], v[36:39]
  v_mfma_f32_16x16x32_bf16 v[40:43], v[136:139], v[68:71], v[40:43]
  s_branch SL_x_done
SL_x_2_c2:
  v_max3_u32 v31, v72, v73, v74
  v_max_u32 v31, v31, v75
  v_cmp_eq_u32 vcc, -1, v31
  s_cbranch_vccz SL_x_2_ok2
SL_x_2_x2:
  s_mov_b64 exec, vcc
  buffer_load_dwordx4 v[72:75], v9, s[4:7], s41 offen offset:2048 sc1
  s_mov_b64 exec, -1
  s_add_u32 s46, s46, 1
  s_cmp_ge_u32 s46, 131072
  s_cbranch_scc1 SL_rec_abort
  s_waitcnt vmcnt(2)
  s_branch SL_x_2_c2
SL_x_2_ok2:
  v_mfma_f32_16x16x32_bf16 v[44:47], v[72:75], v[72:75], v[44:47]
  v_mfma_f32_16x16x32_bf16 v[36:39], v[124:127], v[72:75], v[36:39]
  v_mfma_f32_16x16x32_bf16 v[40:43], v[140:143], v[72:75], v[40:43]
  s_branch SL_x_done
SL_x_3_c3:
  v_max3_u32 v31, v76, v77, v78
  v_max_u32 v31, v31, v79
  v_cmp_eq_u32 vcc, -1, v31
  s_cbranch_vccz SL_x_3_ok3
SL_x_3_x3:
  s_mov_b64 exec, vcc
  buffer_load_dwordx4 v[76:79], v9, s[4:7], s41 offen offset:3072 sc1
  s_mov_b64 exec, -1
  s_add_u32 s46, s46, 1
  s_cmp_ge_u32 s46, 131072
  s_cbranch_scc1 SL_rec_abort
  s_waitcnt vmcnt(2)
  s_branch SL_x_3_c3
SL_x_3_ok3:
  v_mfma_f32_16x16x32_bf16 v[44:47], v[76:79], v[76:79], v[44:47]
  v_mfma_f32_16x16x32_bf16 v[36:39], v[128:131], v[76:79], v[36:39]
  v_mfma_f32_16x16x32_bf16 v[40:43], v[144:147], v[76:79], v[40:43]
  s_branch SL_x_done
SL_x_01_c0:
  v_max3_u32 v31, v64, v65, v66
  v_max_u32 v31, v31, v67
  v_cmp_eq_u32 vcc, -1, v31
  s_cbranch_vccz SL_x_01_ok0
SL_x_01_x0:
  s_mov_b64 exec, vcc
  buffer_load_dwordx4 v[64:67], v9, s[4:7], s41 offen offset:0 sc1
  s_mov_b64 exec, -1
SL_x_01_c1:
  v_max3_u32 v31, v68, v69, v70
  v_max_u32 v31, v31, v71
  v_cmp_eq_u32 vcc, -1, v31
  s_cbranch_vccz SL_x_01_ok1
SL_x_01_x1:
  s_mov_b64 exec, vcc
  buffer_load_dwordx4 v[68:71], v9, s[4:7], s41 offen offset:1024 sc1
  s_mov_b64 exec, -1
  s_add_u32 s46, s46, 1
  s_cmp_ge_u32 s46, 131072
  s_cbranch_scc1 SL_rec_abort
  s_waitcnt vmcnt(4)
  s_branch SL_x_01_c0
SL_x_01_ok0:
  v_mfma_f32_16x16x32_bf16 v[44:47], v[64:67], v[64:67], v[44:47]
  v_max3_u32 v31, v68, v69, v70
  v_max_u32 v31, v31, v71
  v_cmp_eq_u32 vcc, -1, v31
  v_mfma_f32_16x16x32_bf16 v[36:39], v[116:119], v[64:67], v[36:39]
  v_mfma_f32_16x16x32_bf16 v[40:43], v[132:135], v[64:67], v[40:43]
  s_cbranch_vccz SL_x_1_ok1
  s_branch SL_x_1_x1
SL_x_01_ok1:
  v_mfma_f32_16x16x32_bf16 v[44:47], v[68:71], v[68:71], v[44:47]
  v_max3_u32 v31, v64, v65, v66
  v_max_u32 v31, v31, v67
  v_cmp_eq_u32 vcc, -1, v31
  v_mfma_f32_16x16x32_bf16 v[36:39], v[120:123], v[68:71], v[36:39]
  v_mfma_f32_16x16x32_bf16 v[40:43], v[136:139], v[68:71], v[40:43]
  s_cbranch_vccz SL_x_0_ok0
  s_branch SL_x_0_x0
SL_x_02_c0:
  v_max3_u32 v31, v64, v65, v66
  v_max_u32 v31, v31, v67
  v_cmp_eq_u32 vcc, -1, v31
  s_cbranch_vccz SL_x_02_ok0
SL_x_02_x0:
  s_mov_b64 exec, vcc
  buffer_load_dwordx4 v[64:67], v9, s[4:7], s41 offen offset:0 sc1
  s_mov_b64 exec, -1
SL_x_02_c2:
  v_max3_u32 v31, v72, v73, v74
  v_max_u32 v31, v31, v75
  v_cmp_eq_u32 vcc, -1, v31
  s_cbranch_vccz SL_x_02_ok2
SL_x_02_x2:
  s_mov_b64 exec, vcc
  buffer_load_dwordx4 v[72:75], v9, s[4:7], s41 offen offset:2048 sc1
  s_mov_b64 exec, -1
  s_add_u32 s46, s46, 1
  s_cmp_ge_u32 s46, 131072
  s_cbranch_scc1 SL_rec_abort
  s_waitcnt vmcnt(4)
  s_branch SL_x_02_c0
SL_x_02_ok0:
  v_mfma_f32_16x16x32_bf16 v[44:47], v[64:67], v[64:67], v[44:47]
  v_max3_u32 v31, v72, v73, v74
  v_max_u32 v31, v31, v75
  v_cmp_eq_u32 vcc, -1, v31
  v_mfma_f32_16x16x32_bf16 v[36:39], v[116:119], v[64:67], v[36:39]
  v_mfma_f32_16x16x32_bf16 v[40:43], v[132:135], v[64:67], v[40:43]
  s_cbranch_vccz SL_x_2_ok2
  s_branch SL_x_2_x2
SL_x_02_ok2:
  v_mfma_f32_16x16x32_bf16 v[44:47], v[72:75], v[72:75], v[44:47]
  v_max3_u32 v31, v64, v65, v66
  v_max_u32 v31, v31, v67
  v_cmp_eq_u32 vcc, -1, v31
  v_mfma_f32_16x16x32_bf16 v[36:39], v[124:127], v[72:75], v[36:39]
  v_mfma_f32_16x16x32_bf16 v[40:43], v[140:143], v[72:75], v[40:43]
  s_cbranch_vccz SL_x_0_ok0
  s_branch SL_x_0_x0
SL_x_03_c0:
  v_max3_u32 v31, v64, v65, v66
  v_max_u32 v31, v31, v67
  v_cmp_eq_u32 vcc, -1, v31
  s_cbranch_vccz SL_x_03_ok0
SL_x_03_x0:
  s_mov_b64 exec, vcc
  buffer_load_dwordx4 v[64:67], v9, s[4:7], s41 offen offset:0 sc1
  s_mov_b64 exec, -1
SL_x_03_c3:
  v_max3_u32 v31, v76, v77, v78
  v_max_u32 v31, v31, v79
  v_cmp_eq_u32 vcc, -1, v31
  s_cbranch_vccz SL_x_03_ok3
SL_x_03_x3:
  s_mov_b64 exec, vcc
  buffer_load_dwordx4 v[76:79], v9, s[4:7], s41 offen offset:3072 sc1
  s_mov_b64 exec, -1
  s_add_u32 s46, s46, 1
  s_cmp_ge_u32 s46, 131072
  s_cbranch_scc1 SL_rec_abort
  s_waitcnt vmcnt(4)
  s_branch SL_x_03_c0
SL_x_03_ok0:
  v_mfma_f32_16x16x32_bf16 v[44:47], v[64:67], v[64:67], v[44:47]
  v_max3_u32 v31, v76, v77, v78
  v_max_u32 v31, v31, v79
  v_cmp_eq_u32 vcc, -1, v31
  v_mfma_f32_16x16x32_bf16 v[36:39], v[116:119], v[64:67], v[36:39]
  v_mfma_f32_16x16x32_bf16 v[40:43], v[132:135], v[64:67], v[40:43]
  s_cbranch_vccz SL_x_3_ok3
  s_branch SL_x_3_x3
SL_x_03_ok3:
  v_mfma_f32_16x16x32_bf16 v[44:47], v[76:79], v[76:79], v[44:47]
  v_max3_u32 v31, v64, v65, v66
  v_max_u32 v31, v31, v67
  v_cmp_eq_u32 vcc, -1, v31
  v_mfma_f32_16x16x32_bf16 v[36:39], v[128:131], v[76:79], v[36:39]
  v_mfma_f32_16x16x32_bf16 v[40:43], v[144:147], v[76:79], v[40:43]
  s_cbranch_vccz SL_x_0_ok0
  s_branch SL_x_0_x0
SL_x_12_c1:
  v_max3_u32 v31, v68, v69, v70
  v_max_u32 v31, v31, v71
  v_cmp_eq_u32 vcc, -1, v31
  s_cbranch_vccz SL_x_12_ok1
SL_x_12_x1:
  s_mov_b64 exec, vcc
  buffer_load_dwordx4 v[68:71], v9, s[4:7], s41 offen offset:1024 sc1
  s_mov_b64 exec, -1
SL_x_12_c2:
  v_max3_u32 v31, v72, v73, v74
  v_max_u32 v31, v31, v75
  v_cmp_eq_u32 vcc, -1, v31
  s_cbranch_vccz SL_x_12_ok2
SL_x_12_x2:
  s_mov_b64 exec, vcc
  buffer_load_dwordx4 v[72:75], v9, s[4:7], s41 offen offset:2048 sc1
  s_mov_b64 exec, -1
  s_add_u32 s46, s46, 1
  s_cmp_ge_u32 s46, 131072
  s_cbranch_scc1 SL_rec_abort
  s_waitcnt vmcnt(4)
  s_branch SL_x_12_c1
SL_x_12_ok1:
  v_mfma_f32_16x16x32_bf16 v[44:47], v[68:71], v[68:71], v[44:47]
  v_max3_u32 v31, v72, v73, v74
  v_max_u32 v31, v31, v75
  v_cmp_eq_u32 vcc, -1, v31
  v_mfma_f32_16x16x32_bf16 v[36:39], v[120:123], v[68:71], v[36:39]
  v_mfma_f32_16x16x32_bf16 v[40:43], v[136:139], v[68:71], v[40:43]
  s_cbranch_vccz SL_x_2_ok2
  s_branch SL_x_2_x2
SL_x_12_ok2:
  v_mfma_f32_16x16x32_bf16 v[44:47], v[72:75], v[72:75], v[44:47]
  v_max3_u32 v31, v68, v69, v70
  v_max_u32 v31, v31, v71
  v_cmp_eq_u32 vcc, -1, v31
  v_mfma_f32_16x16x32_bf16 v[36:39], v[124:127], v[72:75], v[36:39]
  v_mfma_f32_16x16x32_bf16 v[40:43], v[140:143], v[72:75], v[40:43]
  s_cbranch_vccz SL_x_1_ok1
  s_branch SL_x_1_x1
SL_x_13_c1:
  v_max3_u32 v31, v68, v69, v70
  v_max_u32 v31, v31, v71
  v_cmp_eq_u32 vcc, -1, v31
  s_cbranch_vccz SL_x_13_ok1
SL_x_13_x1:
  s_mov_b64 exec, vcc
  buffer_load_dwordx4 v[68:71], v9, s[4:7], s41 offen offset:1024 sc1
  s_mov_b64 exec, -1
SL_x_13_c3:
  v_max3_u32 v31, v76, v77, v78
  v_max_u32 v31, v31, v79
  v_cmp_eq_u32 vcc, -1, v31
  s_cbranch_vccz SL_x_13_ok3
SL_x_13_x3:
  s_mov_b64 exec, vcc
  buffer_load_dwordx4 v[76:79], v9, s[4:7], s41 offen offset:3072 sc1
  s_mov_b64 exec, -1
  s_add_u32 s46, s46, 1
  s_cmp_ge_u32 s46, 131072
  s_cbranch_scc1 SL_rec_abort
  s_waitcnt vmcnt(4)
  s_branch SL_x_13_c1
SL_x_13_ok1:
  v_mfma_f32_16x16x32_bf16 v[44:47], v[68:71], v[68:71], v[44:47]
  v_max3_u32 v31, v76, v77, v78
  v_max_u32 v31, v31, v79
  v_cmp_eq_u32 vcc, -1, v31
  v_mfma_f32_16x16x32_bf16 v[36:39], v[120:123], v[68:71], v[36:39]
  v_mfma_f32_16x16x32_bf16 v[40:43], v[136:139], v[68:71], v[40:43]
  s_cbranch_vccz SL_x_3_ok3
  s_branch SL_x_3_x3
SL_x_13_ok3:
  v_mfma_f32_16x16x32_bf16 v[44:47], v[76:79], v[76:79], v[44:47]
  v_max3_u32 v31, v68, v69, v70
  v_max_u32 v31, v31, v71
  v_cmp_eq_u32 vcc, -1, v31
  v_mfma_f32_16x16x32_bf16 v[36:39], v[128:131], v[76:79], v[36:39]
  v_mfma_f32_16x16x32_bf16 v[40:43], v[144:147], v[76:79], v[40:43]
  s_cbranch_vccz SL_x_1_ok1
  s_branch SL_x_1_x1
SL_x_23_c2:
  v_max3_u32 v31, v72, v73, v74
  v_max_u32 v31, v31, v75
  v_cmp_eq_u32 vcc, -1, v31
  s_cbranch_vccz SL_x_23_ok2
SL_x_23_x2:
  s_mov_b64 exec, vcc
  buffer_load_dwordx4 v[72:75], v9, s[4:7], s41 offen offset:2048 sc1
  s_mov_b64 exec, -1
SL_x_23_c3:
  v_max3_u32 v31, v76, v77, v78
  v_max_u32 v31, v31, v79
  v_cmp_eq_u32 vcc, -1, v31
  s_cbranch_vccz SL_x_23_ok3
SL_x_23_x3:
  s_mov_b64 exec, vcc
  buffer_load_dwordx4 v[76:79], v9, s[4:7], s41 offen offset:3072 sc1
  s_mov_b64 exec, -1
  s_add_u32 s46, s46, 1
  s_cmp_ge_u32 s46, 131072
  s_cbranch_scc1 SL_rec_abort
  s_waitcnt vmcnt(4)
  s_branch SL_x_23_c2
SL_x_23_ok2:
  v_mfma_f32_16x16x32_bf16 v[44:47], v[72:75], v[72:75], v[44:47]
  v_max3_u32 v31, v76, v77, v78
  v_max_u32 v31, v31, v79
  v_cmp_eq_u32 vcc, -1, v31
  v_mfma_f32_16x16x32_bf16 v[36:39], v[124:127], v[72:75], v[36:39]
  v_mfma_f32_16x16x32_bf16 v[40:43], v[140:143], v[72:75], v[40:43]
  s_cbranch_vccz SL_x_3_ok3
  s_branch SL_x_3_x3
SL_x_23_ok3:
  v_mfma_f32_16x16x32_bf16 v[44:47], v[76:79], v[76:79], v[44:47]
  v_max3_u32 v31, v72, v73, v74
  v_max_u32 v31, v31, v75
  v_cmp_eq_u32 vcc, -1, v31
  v_mfma_f32_16x16x32_bf16 v[36:39], v[128:131], v[76:79], v[36:39]
  v_mfma_f32_16x16x32_bf16 v[40:43], v[144:147], v[76:79], v[40:43]
  s_cbranch_vccz SL_x_2_ok2
  s_branch SL_x_2_x2
SL_x_012_c0:
  v_max3_u32 v31, v64, v65, v66
  v_max_u32 v31, v31, v67
  v_cmp_eq_u32 vcc, -1, v31
  s_cbranch_vccz SL_x_012_ok0
SL_x_012_x0:
  s_mov_b64 exec, vcc
  buffer_load_dwordx4 v[64:67], v9, s[4:7], s41 offen offset:0 sc1
  s_mov_b64 exec, -1
SL_x_012_c1:
  v_max3_u32 v31, v68, v69, v70
  v_max_u32 v31, v31, v71
  v_cmp_eq_u32 vcc, -1, v31
  s_cbranch_vccz SL_x_012_ok1
SL_x_012_x1:
  s_mov_b64 exec, vcc
  buffer_load_dwordx4 v[68:71], v9, s[4:7], s41 offen offset:1024 sc1
  s_mov_b64 exec, -1
SL_x_012_c2:
  v_max3_u32 v31, v72, v73, v74
  v_max_u32 v31, v31, v75
  v_cmp_eq_u32 vcc, -1, v31
  s_cbranch_vccz SL_x_012_ok2
SL_x_012_x2:
  s_mov_b64 exec, vcc
  buffer_load_dwordx4 v[72:75], v9, s[4:7], s41 offen offset:2048 sc1
  s_mov_b64 exec, -1
  s_add_u32 s46, s46, 1
  s_cmp_ge_u32 s46, 131072
  s_cbranch_scc1 SL_rec_abort
  s_waitcnt vmcnt(4)
  s_branch SL_x_012_c0
SL_x_012_ok0:
  v_mfma_f32_16x16x32_bf16 v[44:47], v[64:67], v[64:67], v[44:47]
  v_max3_u32 v31, v68, v69, v70
  v_max_u32 v31, v31, v71
  v_cmp_eq_u32 vcc, -1, v31
  v_mfma_f32_16x16x32_bf16 v[36:39], v[116:119], v[64:67], v[36:39]
  v_mfma_f32_16x16x32_bf16 v[40:43], v[132:135], v[64:67], v[40:43]
  s_cbranch_vccz SL_x_12_ok1
  s_branch SL_x_12_x1
SL_x_012_ok1:
  v_mfma_f32_16x16x32_bf16 v[44:47], v[68:71], v[68:71], v[44:47]
  v_max3_u32 v31, v72, v73, v74
  v_max_u32 v31, v31, v75
  v_cmp_eq_u32 vcc, -1, v31
  v_mfma_f32_16x16x32_bf16 v[36:39], v[120:123], v[68:71], v[36:39]
  v_mfma_f32_16x16x32_bf16 v[40:43], v[136:139], v[68:71], v[40:43]
  s_cbranch_vccz SL_x_02_ok2
  s_branch SL_x_02_x2
SL_x_012_ok2:
  v_mfma_f32_16x16x32_bf16 v[44:47], v[72:75], v[72:75], v[44:47]
  v_max3_u32 v31, v64, v65, v66
  v_max_u32 v31, v31, v67
  v_cmp_eq_u32 vcc, -1, v31
  v_mfma_f32_16x16x32_bf16 v[36:39], v[124:127], v[72:75], v[36:39]
  v_mfma_f32_16x16x32_bf16 v[40:43], v[140:143], v[72:75], v[40:43]
  s_cbranch_vccz SL_x_01_ok0
  s_branch SL_x_01_x0
SL_x_013_c0:
  v_max3_u32 v31, v64, v65, v66
  v_max_u32 v31, v31, v67
  v_cmp_eq_u32 vcc, -1, v31
  s_cbranch_vccz SL_x_013_ok0
SL_x_013_x0:
  s_mov_b64 exec, vcc
  buffer_load_dwordx4 v[64:67], v9, s[4:7], s41 offen offset:0 sc1
  s_mov_b64 exec, -1
SL_x_013_c1:
  v_max3_u32 v31, v68, v69, v70
  v_max_u32 v31, v31, v71
  v_cmp_eq_u32 vcc, -1, v31
  s_cbranch_vccz SL_x_013_ok1
SL_x_013_x1:
  s_mov_b64 exec, vcc
  buffer_load_dwordx4 v[68:71], v9, s[4:7], s41 offen offset:1024 sc1
  s_mov_b64 exec, -1
SL_x_013_c3:
  v_max3_u32 v31, v76, v77, v78
  v_max_u32 v31, v31, v79
  v_cmp_eq_u32 vcc, -1, v31
  s_cbranch_vccz SL_x_013_ok3
SL_x_013_x3:
  s_mov_b64 exec, vcc
  buffer_load_dwordx4 v[76:79], v9, s[4:7], s41 offen offset:3072 sc1
  s_mov_b64 exec, -1
  s_add_u32 s46, s46, 1
  s_cmp_ge_u32 s46, 131072
  s_cbranch_scc1 SL_rec_abort
  s_waitcnt vmcnt(4)
  s_branch SL_x_013_c0
SL_x_013_ok0:
  v_mfma_f32_16x16x32_bf16 v[44:47], v[64:67], v[64:67], v[44:47]
  v_max3_u32 v31, v68, v69, v70
  v_max_u32 v31, v31, v71
  v_cmp_eq_u32 vcc, -1, v31
  v_mfma_f32_16x16x32_bf16 v[36:39], v[116:119], v[64:67], v[36:39]
  v_mfma_f32_16x16x32_bf16 v[40:43], v[132:135], v[64:67], v[40:43]
  s_cbranch_vccz SL_x_13_ok1
  s_branch SL_x_13_x1
SL_x_013_ok1:
  v_mfma_f32_16x16x32_bf16 v[44:47], v[68:71], v[68:71], v[44:47]
  v_max3_u32 v31, v76, v77, v78
  v_max_u32 v31, v31, v79
  v_cmp_eq_u32 vcc, -1, v31
  v_mfma_f32_16x16x32_bf16 v[36:39], v[120:123], v[68:71], v[36:39]
  v_mfma_f32_16x16x32_bf16 v[40:43], v[136:139], v[68:71], v[40:43]
  s_cbranch_vccz SL_x_03_ok3
  s_branch SL_x_03_x3
SL_x_013_ok3:
  v_mfma_f32_16x16x32_bf16 v[44:47], v[76:79], v[76:79], v[44:47]
  v_max3_u32 v31, v64, v65, v66
  v_max_u32 v31, v31, v67
  v_cmp_eq_u32 vcc, -1, v31
  v_mfma_f32_16x16x32_bf16 v[36:39], v[128:131], v[76:79], v[36:39]
  v_mfma_f32_16x16x32_bf16 v[40:43], v[144:147], v[76:79], v[40:43]
  s_cbranch_vccz SL_x_01_ok0
  s_branch SL_x_01_x0
SL_x_023_c0:
  v_max3_u32 v31, v64, v65, v66
  v_max_u32 v31, v31, v67
  v_cmp_eq_u32 vcc, -1, v31
  s_cbranch_vccz SL_x_023_ok0
SL_x_023_x0:
  s_mov_b64 exec, vcc
  buffer_load_dwordx4 v[64:67], v9, s[4:7], s41 offen offset:0 sc1
  s_mov_b64 exec, -1
SL_x_023_c2:
  v_max3_u32 v31, v72, v73, v74
  v_max_u32 v31, v31, v75
  v_cmp_eq_u32 vcc, -1, v31
  s_cbranch_vccz SL_x_023_ok2
SL_x_023_x2:
  s_mov_b64 exec, vcc
  buffer_load_dwordx4 v[72:75], v9, s[4:7], s41 offen offset:2048 sc1
  s_mov_b64 exec, -1
SL_x_023_c3:
  v_max3_u32 v31, v76, v77, v78
  v_max_u32 v31, v31, v79
  v_cmp_eq_u32 vcc, -1, v31
  s_cbranch_vccz SL_x_023_ok3
SL_x_023_x3:
  s_mov_b64 exec, vcc
  buffer_load_dwordx4 v[76:79], v9, s[4:7], s41 offen offset:3072 sc1
  s_mov_b64 exec, -1
  s_add_u32 s46, s46, 1
  s_cmp_ge_u32 s46, 131072
  s_cbranch_scc1 SL_rec_abort
  s_waitcnt vmcnt(4)
  s_branch SL_x_023_c0
SL_x_023_ok0:
  v_mfma_f32_16x16x32_bf16 v[44:47], v[64:67], v[64:67], v[44:47]
  v_max3_u32 v31, v72, v73, v74
  v_max_u32 v31, v31, v75
  v_cmp_eq_u32 vcc, -1, v31
  v_mfma_f32_16x16x32_bf16 v[36:39], v[116:119], v[64:67], v[36:39]
  v_mfma_f32_16x16x32_bf16 v[40:43], v[132:135], v[64:67], v[40:43]
  s_cbranch_vccz SL_x_23_ok2
  s_branch SL_x_23_x2
SL_x_023_ok2:
  v_mfma_f32_16x16x32_bf16 v[44:47], v[72:75], v[72:75], v[44:47]
  v_max3_u32 v31, v76, v77, v78
  v_max_u32 v31, v31, v79
  v_cmp_eq_u32 vcc, -1, v31
  v_mfma_f32_16x16x32_bf16 v[36:39], v[124:127], v[72:75], v[36:39]
  v_mfma_f32_16x16x32_bf16 v[40:43], v[140:143], v[72:75], v[40:43]
  s_cbranch_vccz SL_x_03_ok3
  s_branch SL_x_03_x3
SL_x_023_ok3:
  v_mfma_f32_16x16x32_bf16 v[44:47], v[76:79], v[76:79], v[44:47]
  v_max3_u32 v31, v64, v65, v66
  v_max_u32 v31, v31, v67
  v_cmp_eq_u32 vcc, -1, v31
  v_mfma_f32_16x16x32_bf16 v[36:39], v[128:131], v[76:79], v[36:39]
  v_mfma_f32_16x16x32_bf16 v[40:43], v[144:147], v[76:79], v[40:43]
  s_cbranch_vccz SL_x_02_ok0
  s_branch SL_x_02_x0
SL_x_123_c1:
  v_max3_u32 v31, v68, v69, v70
  v_max_u32 v31, v31, v71
  v_cmp_eq_u32 vcc, -1, v31
  s_cbranch_vccz SL_x_123_ok1
SL_x_123_x1:
  s_mov_b64 exec, vcc
  buffer_load_dwordx4 v[68:71], v9, s[4:7], s41 offen offset:1024 sc1
  s_mov_b64 exec, -1
SL_x_123_c2:
  v_max3_u32 v31, v72, v73, v74
  v_max_u32 v31, v31, v75
  v_cmp_eq_u32 vcc, -1, v31
  s_cbranch_vccz SL_x_123_ok2
SL_x_123_x2:
  s_mov_b64 exec, vcc
  buffer_load_dwordx4 v[72:75], v9, s[4:7], s41 offen offset:2048 sc1
  s_mov_b64 exec, -1
SL_x_123_c3:
  v_max3_u32 v31, v76, v77, v78
  v_max_u32 v31, v31, v79
  v_cmp_eq_u32 vcc, -1, v31
  s_cbranch_vccz SL_x_123_ok3
SL_x_123_x3:
  s_mov_b64 exec, vcc
  buffer_load_dwordx4 v[76:79], v9, s[4:7], s41 offen offset:3072 sc1
  s_mov_b64 exec, -1
  s_add_u32 s46, s46, 1
  s_cmp_ge_u32 s46, 131072
  s_cbranch_scc1 SL_rec_abort
  s_waitcnt vmcnt(4)
  s_branch SL_x_123_c1
SL_x_123_ok1:
  v_mfma_f32_16x16x32_bf16 v[44:47], v[68:71], v[68:71], v[44:47]
  v_max3_u32 v31, v72, v73, v74
  v_max_u32 v31, v31, v75
  v_cmp_eq_u32 vcc, -1, v31
  v_mfma_f32_16x16x32_bf16 v[36:39], v[120:123], v[68:71], v[36:39]
  v_mfma_f32_16x16x32_bf16 v[40:43], v[136:139], v[68:71], v[40:43]
  s_cbranch_vccz SL_x_23_ok2
  s_branch SL_x_23_x2
SL_x_123_ok2:
  v_mfma_f32_16x16x32_bf16 v[44:47], v[72:75], v[72:75], v[44:47]
  v_max3_u32 v31, v76, v77, v78
  v_max_u32 v31, v31, v79
  v_cmp_eq_u32 vcc, -1, v31
  v_mfma_f32_16x16x32_bf16 v[36:39], v[124:127], v[72:75], v[36:39]
  v_mfma_f32_16x16x32_bf16 v[40:43], v[140:143], v[72:75], v[40:43]
  s_cbranch_vccz SL_x_13_ok3
  s_branch SL_x_13_x3
SL_x_123_ok3:
  v_mfma_f32_16x16x32_bf16 v[44:47], v[76:79], v[76:79], v[44:47]
  v_max3_u32 v31, v68, v69, v70
  v_max_u32 v31, v31, v71
  v_cmp_eq_u32 vcc, -1, v31
  v_mfma_f32_16x16x32_bf16 v[36:39], v[128:131], v[76:79], v[36:39]
  v_mfma_f32_16x16x32_bf16 v[40:43], v[144:147], v[76:79], v[40:43]
  s_cbranch_vccz SL_x_12_ok1
  s_branch SL_x_12_x1
SL_x_0123_c0:
  v_max3_u32 v31, v64, v65, v66
  v_max_u32 v31, v31, v67
  v_cmp_eq_u32 vcc, -1, v31
  s_cbranch_vccz SL_x_0123_ok0
SL_x_0123_x0:
  s_mov_b64 exec, vcc
  buffer_load_dwordx4 v[64:67], v9, s[4:7], s41 offen offset:0 sc1
  s_mov_b64 exec, -1
SL_x_0123_c1:
  v_max3_u32 v31, v68, v69, v70
  v_max_u32 v31, v31, v71
  v_cmp_eq_u32 vcc, -1, v31
  s_cbranch_vccz SL_x_0123_ok1
SL_x_0123_x1:
  s_mov_b64 exec, vcc
  buffer_load_dwordx4 v[68:71], v9, s[4:7], s41 offen offset:1024 sc1
  s_mov_b64 exec, -1
SL_x_0123_c2:
  v_max3_u32 v31, v72, v73, v74
  v_max_u32 v31, v31, v75
  v_cmp_eq_u32 vcc, -1, v31
  s_cbranch_vccz SL_x_0123_ok2
SL_x_0123_x2:
  s_mov_b64 exec, vcc
  buffer_load_dwordx4 v[72:75], v9, s[4:7], s41 offen offset:2048 sc1
  s_mov_b64 exec, -1
SL_x_0123_c3:
  v_max3_u32 v31, v76, v77, v78
  v_max_u32 v31, v31, v79
  v_cmp_eq_u32 vcc, -1, v31
  s_cbranch_vccz SL_x_0123_ok3
SL_x_0123_x3:
  s_mov_b64 exec, vcc
  buffer_load_dwordx4 v[76:79], v9, s[4:7], s41 offen offset:3072 sc1
  s_mov_b64 exec, -1
  s_add_u32 s46, s46, 1
  s_cmp_ge_u32 s46, 131072
  s_cbranch_scc1 SL_rec_abort
  s_waitcnt vmcnt(4)
  s_branch SL_x_0123_c0
SL_x_0123_ok0:
  v_mfma_f32_16x16x32_bf16 v[44:47], v[64:67], v[64:67], v[44:47]
  v_max3_u32 v31, v68, v69, v70
  v_max_u32 v31, v31, v71
  v_cmp_eq_u32 vcc, -1, v31
  v_mfma_f32_16x16x32_bf16 v[36:39], v[116:119], v[64:67], v[36:39]
  v_mfma_f32_16x16x32_bf16 v[40:43], v[132:135], v[64:67], v[40:43]
  s_cbranch_vccz SL_x_123_ok1
  s_branch SL_x_123_x1
SL_x_0123_ok1:
  v_mfma_f32_16x16x32_bf16 v[44:47], v[68:71], v[68:71], v[44:47]
  v_max3_u32 v31, v72, v73, v74
  v_max_u32 v31, v31, v75
  v_cmp_eq_u32 vcc, -1, v31
  v_mfma_f32_16x16x32_bf16 v[36:39], v[120:123], v[68:71], v[36:39]
  v_mfma_f32_16x16x32_bf16 v[40:43], v[136:139], v[68:71], v[40:43]
  s_cbranch_vccz SL_x_023_ok2
  s_branch SL_x_023_x2
SL_x_0123_ok2:
  v_mfma_f32_16x16x32_bf16 v[44:47], v[72:75], v[72:75], v[44:47]
  v_max3_u32 v31, v76, v77, v78
  v_max_u32 v31, v31, v79
  v_cmp_eq_u32 vcc, -1, v31
  v_mfma_f32_16x16x32_bf16 v[36:39], v[124:127], v[72:75], v[36:39]
  v_mfma_f32_16x16x32_bf16 v[40:43], v[140:143], v[72:75], v[40:43]
  s_cbranch_vccz SL_x_013_ok3
  s_branch SL_x_013_x3
SL_x_0123_ok3:
  v_mfma_f32_16x16x32_bf16 v[44:47], v[76:79], v[76:79], v[44:47]
  v_max3_u32 v31, v64, v65, v66
  v_max_u32 v31, v31, v67
  v_cmp_eq_u32 vcc, -1, v31
  v_mfma_f32_16x16x32_bf16 v[36:39], v[128:131], v[76:79], v[36:39]
  v_mfma_f32_16x16x32_bf16 v[40:43], v[144:147], v[76:79], v[40:43]
  s_cbranch_vccz SL_x_012_ok0
  s_branch SL_x_012_x0
SL_v_f:
  buffer_load_dwordx4 v[88:91], v10, s[4:7], s41 offen offset:0 sc1
  buffer_load_dwordx4 v[92:95], v10, s[4:7], s41 offen offset:1024 sc1
  s_add_u32 s46, s46, 1
  s_cmp_ge_u32 s46, 131072
  s_cbranch_scc1 SL_rec_abort
  s_waitcnt vmcnt(0)
  v_max3_u32 v31, v88, v89, v90
  v_max3_u32 v31, v31, v91, v92
  v_max3_u32 v31, v31, v93, v94
  v_max_u32 v31, v31, v95
  v_cmp_eq_u32 vcc, -1, v31
  s_cbranch_vccnz SL_v_f
  s_branch SL_v_ok
SL_rec_abort:
  s_waitcnt vmcnt(0)
  s_endpgm
L_join:
  s_load_dwordx16 s[64:79], s[0:1], 0
  s_mov_b32 s39, 1
  s_cmp_lg_u32 s32, 0
  s_cbranch_scc1 L_rq_1
  s_cmp_eq_u32 s39, 0
  s_cbranch_scc1 L_rq_1
  s_lshl_b32 s99, s33, 7
  s_add_u32 s99, s99, 0x3d00200
  v_mov_b32 v244, 1
  v_mov_b32 v245, 0
  s_mov_b64 exec, 1
  buffer_atomic_add v244, v245, s[4:7], s99 offen sc0 sc1
  s_mov_b64 exec, -1
L_rq_1:
  s_getpc_b64 s[86:87]
L_pc1:
  s_lshl_b32 s90, s34, 2
  s_add_u32 s90, s90, s32
  s_and_b32 s90, s90, 31
  s_lshl_b32 s90, s90, 12
  v_mbcnt_lo_u32_b32 v1, -1, 0
  v_mbcnt_hi_u32_b32 v1, -1, v1
  v_lshlrev_b32 v1, 6, v1
  v_add_u32 v1, s90, v1
  v_min_u32 v1, L_table-L_pc1, v1
  global_load_dword v199, v1, s[86:87]
  v_mbcnt_lo_u32_b32 v0, -1, 0
  v_mbcnt_hi_u32_b32 v0, -1, v0
  s_lshl_b32 s90, s32, 6
  v_add_u32 v0, s90, v0
  s_lshl_b32 s40, s33, 5
  s_add_u32 s40, s40, 128
  s_mov_b32 s39, 1
  s_barrier
  s_branch L_worker1
L_worker:
  s_mov_b32 s39, 0
L_worker1:
  s_load_dwordx4 s[80:83], s[0:1], 64
  s_load_dwordx2 s[84:85], s[0:1], 80
  s_sub_u32 s33, s40, 128
  s_lshr_b32 s33, s33, 5
  s_and_b32 s34, s40, 31
  s_getpc_b64 s[86:87]
L_pc:
  s_add_u32 s86, s86, L_table-L_pc
  s_addc_u32 s87, s87, 0
  s_waitcnt lgkmcnt(0)
  s_mov_b32 s16, s84
  s_and_b32 s17, s85, 0xffff
  s_mov_b32 s18, 0x800000
  s_mov_b32 s19, 0x20000
  s_mov_b32 s8, s64
  s_and_b32 s9, s65, 0xffff
  s_mov_b32 s10, 0x400000
  s_mov_b32 s11, 0x20000
  s_mov_b32 s12, s70
  s_and_b32 s13, s71, 0xffff
  s_mov_b32 s14, 0x800000
  s_mov_b32 s15, 0x20000
  v_mov_b32 v1, 0
  v_mov_b32 v2, 0
  v_mov_b32 v3, 0
  v_mov_b32 v4, 0
  v_mov_b32 v5, 0
  v_mov_b32 v6, 0
  v_mov_b32 v7, 0
  v_mov_b32 v8, 0
  v_mov_b32 v9, 0
  v_mov_b32 v10, 0
  v_mov_b32 v11, 0
  v_mov_b32 v12, 0
  v_mov_b32 v13, 0
  v_mov_b32 v14, 0
  v_mov_b32 v15, 0
  v_mov_b32 v16, 0
  v_mov_b32 v17, 0
  v_mov_b32 v172, 0
  v_mov_b32 v173, 0
  s_mov_b32 s59, 0
  s_cmp_eq_u32 s39, 0
  s_cbranch_scc1 L_have
  s_branch L_next1
L_next:
  s_cmp_lg_u32 s32, 0
  s_cbranch_scc1 L_rq_2
  s_cmp_eq_u32 s39, 0
  s_cbranch_scc1 L_rq_2
  s_lshl_b32 s99, s33, 7
  s_add_u32 s99, s99, 0x3d00200
  v_mov_b32 v244, 1
  v_mov_b32 v245, 0
  s_mov_b64 exec, 1
  buffer_atomic_add v244, v245, s[4:7], s99 offen sc0 sc1
  s_mov_b64 exec, -1
L_rq_2:
L_next1:
  s_waitcnt vmcnt(0)
L_got:
  s_cmp_lg_u32 s32, 0
  s_cbranch_scc1 L_nx1
  v_mov_b32 v245, 147456
  s_mov_b64 exec, 1
  ds_write_b32 v245, v244
  s_mov_b64 exec, -1
  s_waitcnt lgkmcnt(0)
L_nx1:
  s_barrier
  v_mov_b32 v245, 147456
  ds_read_b32 v246, v245
  s_waitcnt lgkmcnt(0)
  v_min_u32 v245, 270, v246
  v_lshlrev_b32 v245, 2, v245
  v_add_u32 v245, 147648, v245
  ds_read_b32 v245, v245
  v_readfirstlane_b32 s34, v246
  s_add_u32 s34, s34, 32
  s_waitcnt lgkmcnt(0)
  v_readfirstlane_b32 s91, v245
  s_branch L_have1
L_have:
  s_lshl_b32 s90, s34, 2
  s_load_dword s91, s[86:87], s90
  s_waitcnt lgkmcnt(0)
L_have1:
  s_mov_b32 s98, 1
  s_and_b32 s35, s91, 255
  s_lshr_b32 s36, s91, 8
  s_and_b32 s36, s36, 255
  s_lshr_b32 s37, s91, 16
  s_cmp_eq_u32 s35, 0
  s_cbranch_scc1 L_aqkv
  s_cmp_eq_u32 s35, 1
  s_cbranch_scc1 L_aqkv
  s_cmp_eq_u32 s35, 2
  s_cbranch_scc1 L_aqkv
  s_cmp_eq_u32 s35, 3
  s_cbranch_scc1 L_bqkv
  s_cmp_eq_u32 s35, 9
  s_cbranch_scc1 L_small
  s_cmp_eq_u32 s35, 10
  s_cbranch_scc1 L_small
  s_mov_b32 s58, 0
  s_getpc_b64 s[88:89]
L_pc2:
  s_lshl_b32 s90, s34, 2
  s_add_u32 s90, s90, s32
  s_and_b32 s90, s90, 31
  s_lshl_b32 s90, s90, 12
  v_mbcnt_lo_u32_b32 v246, -1, 0
  v_mbcnt_hi_u32_b32 v246, -1, v246
  v_lshlrev_b32 v246, 6, v246
  v_add_u32 v246, s90, v246
  v_min_u32 v246, L_table-L_pc2, v246
  global_load_dword v247, v246, s[88:89]
L_epi:
  s_mov_b32 s46, 0x40000000
  s_mov_b32 s47, 0x40000000
  s_mov_b32 s49, 0
  s_cmp_eq_u32 s58, 1
  s_cselect_b64 vcc, -1, 0
  s_cmp_eq_u32 s59, 0
  s_cbranch_scc1 L_epid
  s_cmp_lg_u32 s59, 1
  s_cbranch_scc1 L_e0
  s_lshr_b32 s90, s27, 1
  s_and_b32 s91, s27, 1
  v_mov_b32 v172, 0x0
  v_bfe_u32 v45, v1, 0, 6
  v_lshl_add_u32 v172, v45, 4, v172
  v_add_u32 v173, 4096, v172
  s_mul_i32 s92, s90, 4
  s_mul_i32 s92, s92, s61
  s_add_u32 s92, s92, s60
  s_mul_i32 s93, s91, 8192
  s_add_u32 s92, s92, s93
  v_accvgpr_read_b32 v52, a0
  v_accvgpr_read_b32 v53, a4
  v_accvgpr_read_b32 v54, a1
  v_accvgpr_read_b32 v55, a5
  v_accvgpr_read_b32 v56, a2
  v_accvgpr_read_b32 v57, a6
  v_accvgpr_read_b32 v58, a3
  v_accvgpr_read_b32 v59, a7
  v_cvt_pk_bf16_f32 v48, v52, v53
  v_cvt_pk_bf16_f32 v49, v54, v55
  v_cvt_pk_bf16_f32 v50, v56, v57
  v_cvt_pk_bf16_f32 v51, v58, v59
  buffer_store_dwordx4 v[48:51], v172, s[4:7], s92 offen offset:0 sc1
  v_accvgpr_read_b32 v64, a128
  v_accvgpr_read_b32 v65, a132
  v_accvgpr_read_b32 v66, a129
  v_accvgpr_read_b32 v67, a133
  v_accvgpr_read_b32 v68, a130
  v_accvgpr_read_b32 v69, a134
  v_accvgpr_read_b32 v70, a131
  v_accvgpr_read_b32 v71, a135
  v_cvt_pk_bf16_f32 v176, v64, v65
  v_cvt_pk_bf16_f32 v177, v66, v67
  v_cvt_pk_bf16_f32 v178, v68, v69
  v_cvt_pk_bf16_f32 v179, v70, v71
  v_accvgpr_read_b32 v76, a8
  v_accvgpr_read_b32 v77, a12
  v_accvgpr_read_b32 v78, a9
  v_accvgpr_read_b32 v79, a13
  v_accvgpr_read_b32 v80, a10
  v_accvgpr_read_b32 v81, a14
  v_accvgpr_read_b32 v82, a11
  v_accvgpr_read_b32 v83, a15
  v_cvt_pk_bf16_f32 v72, v76, v77
  v_cvt_pk_bf16_f32 v73, v78, v79
  v_cvt_pk_bf16_f32 v74, v80, v81
  v_cvt_pk_bf16_f32 v75, v82, v83
  buffer_store_dwordx4 v[72:75], v172, s[4:7], s92 offen offset:1024 sc1
  v_accvgpr_read_b32 v88, a136
  v_accvgpr_read_b32 v89, a140
  v_accvgpr_read_b32 v90, a137
  v_accvgpr_read_b32 v91, a141
  v_accvgpr_read_b32 v92, a138
  v_accvgpr_read_b32 v93, a142
  v_accvgpr_read_b32 v94, a139
  v_accvgpr_read_b32 v95, a143
  v_cvt_pk_bf16_f32 v180, v88, v89
  v_cvt_pk_bf16_f32 v181, v90, v91
  v_cvt_pk_bf16_f32 v182, v92, v93
  v_cvt_pk_bf16_f32 v183, v94, v95
  v_accvgpr_read_b32 v52, a16
  v_accvgpr_read_b32 v53, a20
  v_accvgpr_read_b32 v54, a17
  v_accvgpr_read_b32 v55, a21
  v_accvgpr_read_b32 v56, a18
  v_accvgpr_read_b32 v57, a22
  v_accvgpr_read_b32 v58, a19
  v_accvgpr_read_b32 v59, a23
  v_cvt_pk_bf16_f32 v48, v52, v53
  v_cvt_pk_bf16_f32 v49, v54, v55
  v_cvt_pk_bf16_f32 v50, v56, v57
  v_cvt_pk_bf16_f32 v51, v58, v59
  buffer_store_dwordx4 v[48:51], v172, s[4:7], s92 offen offset:2048 sc1
  v_accvgpr_read_b32 v64, a144
  v_accvgpr_read_b32 v65, a148
  v_accvgpr_read_b32 v66, a145
  v_accvgpr_read_b32 v67, a149
  v_accvgpr_read_b32 v68, a146
  v_accvgpr_read_b32 v69, a150
  v_accvgpr_read_b32 v70, a147
  v_accvgpr_read_b32 v71, a151
  v_cvt_pk_bf16_f32 v184, v64, v65
  v_cvt_pk_bf16_f32 v185, v66, v67
  v_cvt_pk_bf16_f32 v186, v68, v69
  v_cvt_pk_bf16_f32 v187, v70, v71
  v_accvgpr_read_b32 v76, a24
  v_accvgpr_read_b32 v77, a28
  v_accvgpr_read_b32 v78, a25
  v_accvgpr_read_b32 v79, a29
  v_accvgpr_read_b32 v80, a26
  v_accvgpr_read_b32 v81, a30
  v_accvgpr_read_b32 v82, a27
  v_accvgpr_read_b32 v83, a31
  v_cvt_pk_bf16_f32 v72, v76, v77
  v_cvt_pk_bf16_f32 v73, v78, v79
  v_cvt_pk_bf16_f32 v74, v80, v81
  v_cvt_pk_bf16_f32 v75, v82, v83
  buffer_store_dwordx4 v[72:75], v172, s[4:7], s92 offen offset:3072 sc1
  v_accvgpr_read_b32 v88, a152
  v_accvgpr_read_b32 v89, a156
  v_accvgpr_read_b32 v90, a153
  v_accvgpr_read_b32 v91, a157
  v_accvgpr_read_b32 v92, a154
  v_accvgpr_read_b32 v93, a158
  v_accvgpr_read_b32 v94, a155
  v_accvgpr_read_b32 v95, a159
  v_cvt_pk_bf16_f32 v188, v88, v89
  v_cvt_pk_bf16_f32 v189, v90, v91
  v_cvt_pk_bf16_f32 v190, v92, v93
  v_cvt_pk_bf16_f32 v191, v94, v95
  v_accvgpr_read_b32 v52, a32
  v_accvgpr_read_b32 v53, a36
  v_accvgpr_read_b32 v54, a33
  v_accvgpr_read_b32 v55, a37
  v_accvgpr_read_b32 v56, a34
  v_accvgpr_read_b32 v57, a38
  v_accvgpr_read_b32 v58, a35
  v_accvgpr_read_b32 v59, a39
  v_cvt_pk_bf16_f32 v48, v52, v53
  v_cvt_pk_bf16_f32 v49, v54, v55
  v_cvt_pk_bf16_f32 v50, v56, v57
  v_cvt_pk_bf16_f32 v51, v58, v59
  buffer_store_dwordx4 v[48:51], v173, s[4:7], s92 offen offset:0 sc1
  v_accvgpr_read_b32 v64, a160
  v_accvgpr_read_b32 v65, a164
  v_accvgpr_read_b32 v66, a161
  v_accvgpr_read_b32 v67, a165
  v_accvgpr_read_b32 v68, a162
  v_accvgpr_read_b32 v69, a166
  v_accvgpr_read_b32 v70, a163
  v_accvgpr_read_b32 v71, a167
  v_cvt_pk_bf16_f32 v192, v64, v65
  v_cvt_pk_bf16_f32 v193, v66, v67
  v_cvt_pk_bf16_f32 v194, v68, v69
  v_cvt_pk_bf16_f32 v195, v70, v71
  v_accvgpr_read_b32 v76, a40
  v_accvgpr_read_b32 v77, a44
  v_accvgpr_read_b32 v78, a41
  v_accvgpr_read_b32 v79, a45
  v_accvgpr_read_b32 v80, a42
  v_accvgpr_read_b32 v81, a46
  v_accvgpr_read_b32 v82, a43
  v_accvgpr_read_b32 v83, a47
  v_cvt_pk_bf16_f32 v72, v76, v77
  v_cvt_pk_bf16_f32 v73, v78, v79
  v_cvt_pk_bf16_f32 v74, v80, v81
  v_cvt_pk_bf16_f32 v75, v82, v83
  buffer_store_dwordx4 v[72:75], v173, s[4:7], s92 offen offset:1024 sc1
  v_accvgpr_read_b32 v88, a168
  v_accvgpr_read_b32 v89, a172
  v_accvgpr_read_b32 v90, a169
  v_accvgpr_read_b32 v91, a173
  v_accvgpr_read_b32 v92, a170
  v_accvgpr_read_b32 v93, a174
  v_accvgpr_read_b32 v94, a171
  v_accvgpr_read_b32 v95, a175
  v_cvt_pk_bf16_f32 v196, v88, v89
  v_cvt_pk_bf16_f32 v197, v90, v91
  v_cvt_pk_bf16_f32 v198, v92, v93
  v_cvt_pk_bf16_f32 v199, v94, v95
  v_accvgpr_read_b32 v52, a48
  v_accvgpr_read_b32 v53, a52
  v_accvgpr_read_b32 v54, a49
  v_accvgpr_read_b32 v55, a53
  v_accvgpr_read_b32 v56, a50
  v_accvgpr_read_b32 v57, a54
  v_accvgpr_read_b32 v58, a51
  v_accvgpr_read_b32 v59, a55
  v_cvt_pk_bf16_f32 v48, v52, v53
  v_cvt_pk_bf16_f32 v49, v54, v55
  v_cvt_pk_bf16_f32 v50, v56, v57
  v_cvt_pk_bf16_f32 v51, v58, v59
  buffer_store_dwordx4 v[48:51], v173, s[4:7], s92 offen offset:2048 sc1
  v_accvgpr_read_b32 v64, a176
  v_accvgpr_read_b32 v65, a180
  v_accvgpr_read_b32 v66, a177
  v_accvgpr_read_b32 v67, a181
  v_accvgpr_read_b32 v68, a178
  v_accvgpr_read_b32 v69, a182
  v_accvgpr_read_b32 v70, a179
  v_accvgpr_read_b32 v71, a183
  v_cvt_pk_bf16_f32 v200, v64, v65
  v_cvt_pk_bf16_f32 v201, v66, v67
  v_cvt_pk_bf16_f32 v202, v68, v69
  v_cvt_pk_bf16_f32 v203, v70, v71
  v_accvgpr_read_b32 v76, a56
  v_accvgpr_read_b32 v77, a60
  v_accvgpr_read_b32 v78, a57
  v_accvgpr_read_b32 v79, a61
  v_accvgpr_read_b32 v80, a58
  v_accvgpr_read_b32 v81, a62
  v_accvgpr_read_b32 v82, a59
  v_accvgpr_read_b32 v83, a63
  v_cvt_pk_bf16_f32 v72, v76, v77
  v_cvt_pk_bf16_f32 v73, v78, v79
  v_cvt_pk_bf16_f32 v74, v80, v81
  v_cvt_pk_bf16_f32 v75, v82, v83
  buffer_store_dwordx4 v[72:75], v173, s[4:7], s92 offen offset:3072 sc1
  v_accvgpr_read_b32 v88, a184
  v_accvgpr_read_b32 v89, a188
  v_accvgpr_read_b32 v90, a185
  v_accvgpr_read_b32 v91, a189
  v_accvgpr_read_b32 v92, a186
  v_accvgpr_read_b32 v93, a190
  v_accvgpr_read_b32 v94, a187
  v_accvgpr_read_b32 v95, a191
  v_cvt_pk_bf16_f32 v204, v88, v89
  v_cvt_pk_bf16_f32 v205, v90, v91
  v_cvt_pk_bf16_f32 v206, v92, v93
  v_cvt_pk_bf16_f32 v207, v94, v95
  s_add_u32 s92, s92, s61
  v_accvgpr_read_b32 v52, a64
  v_accvgpr_read_b32 v53, a68
  v_accvgpr_read_b32 v54, a65
  v_accvgpr_read_b32 v55, a69
  v_accvgpr_read_b32 v56, a66
  v_accvgpr_read_b32 v57, a70
  v_accvgpr_read_b32 v58, a67
  v_accvgpr_read_b32 v59, a71
  v_cvt_pk_bf16_f32 v48, v52, v53
  v_cvt_pk_bf16_f32 v49, v54, v55
  v_cvt_pk_bf16_f32 v50, v56, v57
  v_cvt_pk_bf16_f32 v51, v58, v59
  buffer_store_dwordx4 v[48:51], v172, s[4:7], s92 offen offset:0 sc1
  v_accvgpr_read_b32 v64, a192
  v_accvgpr_read_b32 v65, a196
  v_accvgpr_read_b32 v66, a193
  v_accvgpr_read_b32 v67, a197
  v_accvgpr_read_b32 v68, a194
  v_accvgpr_read_b32 v69, a198
  v_accvgpr_read_b32 v70, a195
  v_accvgpr_read_b32 v71, a199
  v_cvt_pk_bf16_f32 v208, v64, v65
  v_cvt_pk_bf16_f32 v209, v66, v67
  v_cvt_pk_bf16_f32 v210, v68, v69
  v_cvt_pk_bf16_f32 v211, v70, v71
  v_accvgpr_read_b32 v76, a72
  v_accvgpr_read_b32 v77, a76
  v_accvgpr_read_b32 v78, a73
  v_accvgpr_read_b32 v79, a77
  v_accvgpr_read_b32 v80, a74
  v_accvgpr_read_b32 v81, a78
  v_accvgpr_read_b32 v82, a75
  v_accvgpr_read_b32 v83, a79
  v_cvt_pk_bf16_f32 v72, v76, v77
  v_cvt_pk_bf16_f32 v73, v78, v79
  v_cvt_pk_bf16_f32 v74, v80, v81
  v_cvt_pk_bf16_f32 v75, v82, v83
  buffer_store_dwordx4 v[72:75], v172, s[4:7], s92 offen offset:1024 sc1
  v_accvgpr_read_b32 v88, a200
  v_accvgpr_read_b32 v89, a204
  v_accvgpr_read_b32 v90, a201
  v_accvgpr_read_b32 v91, a205
  v_accvgpr_read_b32 v92, a202
  v_accvgpr_read_b32 v93, a206
  v_accvgpr_read_b32 v94, a203
  v_accvgpr_read_b32 v95, a207
  v_cvt_pk_bf16_f32 v212, v88, v89
  v_cvt_pk_bf16_f32 v213, v90, v91
  v_cvt_pk_bf16_f32 v214, v92, v93
  v_cvt_pk_bf16_f32 v215, v94, v95
  v_accvgpr_read_b32 v52, a80
  v_accvgpr_read_b32 v53, a84
  v_accvgpr_read_b32 v54, a81
  v_accvgpr_read_b32 v55, a85
  v_accvgpr_read_b32 v56, a82
  v_accvgpr_read_b32 v57, a86
  v_accvgpr_read_b32 v58, a83
  v_accvgpr_read_b32 v59, a87
  v_cvt_pk_bf16_f32 v48, v52, v53
  v_cvt_pk_bf16_f32 v49, v54, v55
  v_cvt_pk_bf16_f32 v50, v56, v57
  v_cvt_pk_bf16_f32 v51, v58, v59
  buffer_store_dwordx4 v[48:51], v172, s[4:7], s92 offen offset:2048 sc1
  v_accvgpr_read_b32 v64, a208
  v_accvgpr_read_b32 v65, a212
  v_accvgpr_read_b32 v66, a209
  v_accvgpr_read_b32 v67, a213
  v_accvgpr_read_b32 v68, a210
  v_accvgpr_read_b32 v69, a214
  v_accvgpr_read_b32 v70, a211
  v_accvgpr_read_b32 v71, a215
  v_cvt_pk_bf16_f32 v216, v64, v65
  v_cvt_pk_bf16_f32 v217, v66, v67
  v_cvt_pk_bf16_f32 v218, v68, v69
  v_cvt_pk_bf16_f32 v219, v70, v71
  v_accvgpr_read_b32 v76, a88
  v_accvgpr_read_b32 v77, a92
  v_accvgpr_read_b32 v78, a89
  v_accvgpr_read_b32 v79, a93
  v_accvgpr_read_b32 v80, a90
  v_accvgpr_read_b32 v81, a94
  v_accvgpr_read_b32 v82, a91
  v_accvgpr_read_b32 v83, a95
  v_cvt_pk_bf16_f32 v72, v76, v77
  v_cvt_pk_bf16_f32 v73, v78, v79
  v_cvt_pk_bf16_f32 v74, v80, v81
  v_cvt_pk_bf16_f32 v75, v82, v83
  buffer_store_dwordx4 v[72:75], v172, s[4:7], s92 offen offset:3072 sc1
  v_accvgpr_read_b32 v88, a216
  v_accvgpr_read_b32 v89, a220
  v_accvgpr_read_b32 v90, a217
  v_accvgpr_read_b32 v91, a221
  v_accvgpr_read_b32 v92, a218
  v_accvgpr_read_b32 v93, a222
  v_accvgpr_read_b32 v94, a219
  v_accvgpr_read_b32 v95, a223
  v_cvt_pk_bf16_f32 v220, v88, v89
  v_cvt_pk_bf16_f32 v221, v90, v91
  v_cvt_pk_bf16_f32 v222, v92, v93
  v_cvt_pk_bf16_f32 v223, v94, v95
  v_accvgpr_read_b32 v52, a96
  v_accvgpr_read_b32 v53, a100
  v_accvgpr_read_b32 v54, a97
  v_accvgpr_read_b32 v55, a101
  v_accvgpr_read_b32 v56, a98
  v_accvgpr_read_b32 v57, a102
  v_accvgpr_read_b32 v58, a99
  v_accvgpr_read_b32 v59, a103
  v_cvt_pk_bf16_f32 v48, v52, v53
  v_cvt_pk_bf16_f32 v49, v54, v55
  v_cvt_pk_bf16_f32 v50, v56, v57
  v_cvt_pk_bf16_f32 v51, v58, v59
  buffer_store_dwordx4 v[48:51], v173, s[4:7], s92 offen offset:0 sc1
  v_accvgpr_read_b32 v64, a224
  v_accvgpr_read_b32 v65, a228
  v_accvgpr_read_b32 v66, a225
  v_accvgpr_read_b32 v67, a229
  v_accvgpr_read_b32 v68, a226
  v_accvgpr_read_b32 v69, a230
  v_accvgpr_read_b32 v70, a227
  v_accvgpr_read_b32 v71, a231
  v_cvt_pk_bf16_f32 v224, v64, v65
  v_cvt_pk_bf16_f32 v225, v66, v67
  v_cvt_pk_bf16_f32 v226, v68, v69
  v_cvt_pk_bf16_f32 v227, v70, v71
  v_accvgpr_read_b32 v76, a104
  v_accvgpr_read_b32 v77, a108
  v_accvgpr_read_b32 v78, a105
  v_accvgpr_read_b32 v79, a109
  v_accvgpr_read_b32 v80, a106
  v_accvgpr_read_b32 v81, a110
  v_accvgpr_read_b32 v82, a107
  v_accvgpr_read_b32 v83, a111
  v_cvt_pk_bf16_f32 v72, v76, v77
  v_cvt_pk_bf16_f32 v73, v78, v79
  v_cvt_pk_bf16_f32 v74, v80, v81
  v_cvt_pk_bf16_f32 v75, v82, v83
  buffer_store_dwordx4 v[72:75], v173, s[4:7], s92 offen offset:1024 sc1
  v_accvgpr_read_b32 v88, a232
  v_accvgpr_read_b32 v89, a236
  v_accvgpr_read_b32 v90, a233
  v_accvgpr_read_b32 v91, a237
  v_accvgpr_read_b32 v92, a234
  v_accvgpr_read_b32 v93, a238
  v_accvgpr_read_b32 v94, a235
  v_accvgpr_read_b32 v95, a239
  v_cvt_pk_bf16_f32 v228, v88, v89
  v_cvt_pk_bf16_f32 v229, v90, v91
  v_cvt_pk_bf16_f32 v230, v92, v93
  v_cvt_pk_bf16_f32 v231, v94, v95
  v_accvgpr_read_b32 v52, a112
  v_accvgpr_read_b32 v53, a116
  v_accvgpr_read_b32 v54, a113
  v_accvgpr_read_b32 v55, a117
  v_accvgpr_read_b32 v56, a114
  v_accvgpr_read_b32 v57, a118
  v_accvgpr_read_b32 v58, a115
  v_accvgpr_read_b32 v59, a119
  v_cvt_pk_bf16_f32 v48, v52, v53
  v_cvt_pk_bf16_f32 v49, v54, v55
  v_cvt_pk_bf16_f32 v50, v56, v57
  v_cvt_pk_bf16_f32 v51, v58, v59
  buffer_store_dwordx4 v[48:51], v173, s[4:7], s92 offen offset:2048 sc1
  v_accvgpr_read_b32 v64, a240
  v_accvgpr_read_b32 v65, a244
  v_accvgpr_read_b32 v66, a241
  v_accvgpr_read_b32 v67, a245
  v_accvgpr_read_b32 v68, a242
  v_accvgpr_read_b32 v69, a246
  v_accvgpr_read_b32 v70, a243
  v_accvgpr_read_b32 v71, a247
  v_cvt_pk_bf16_f32 v232, v64, v65
  v_cvt_pk_bf16_f32 v233, v66, v67
  v_cvt_pk_bf16_f32 v234, v68, v69
  v_cvt_pk_bf16_f32 v235, v70, v71
  v_accvgpr_read_b32 v76, a120
  v_accvgpr_read_b32 v77, a124
  v_accvgpr_read_b32 v78, a121
  v_accvgpr_read_b32 v79, a125
  v_accvgpr_read_b32 v80, a122
  v_accvgpr_read_b32 v81, a126
  v_accvgpr_read_b32 v82, a123
  v_accvgpr_read_b32 v83, a127
  v_cvt_pk_bf16_f32 v72, v76, v77
  v_cvt_pk_bf16_f32 v73, v78, v79
  v_cvt_pk_bf16_f32 v74, v80, v81
  v_cvt_pk_bf16_f32 v75, v82, v83
  buffer_store_dwordx4 v[72:75], v173, s[4:7], s92 offen offset:3072 sc1
  v_accvgpr_read_b32 v88, a248
  v_accvgpr_read_b32 v89, a252
  v_accvgpr_read_b32 v90, a249
  v_accvgpr_read_b32 v91, a253
  v_accvgpr_read_b32 v92, a250
  v_accvgpr_read_b32 v93, a254
  v_accvgpr_read_b32 v94, a251
  v_accvgpr_read_b32 v95, a255
  v_cvt_pk_bf16_f32 v236, v88, v89
  v_cvt_pk_bf16_f32 v237, v90, v91
  v_cvt_pk_bf16_f32 v238, v92, v93
  v_cvt_pk_bf16_f32 v239, v94, v95
  s_add_u32 s92, s92, s61
  s_mov_b32 s46, s92
  s_add_u32 s47, s92, s61
  s_branch L_edef
L_e0:
  s_cmp_lg_u32 s59, 2
  s_cbranch_scc1 L_e1
  s_lshr_b32 s90, s27, 1
  s_and_b32 s91, s27, 1
  v_mov_b32 v172, 0x0
  v_bfe_u32 v45, v1, 0, 6
  v_lshl_add_u32 v172, v45, 4, v172
  v_add_u32 v173, 4096, v172
  s_mul_i32 s92, s90, 4
  s_mul_i32 s92, s92, s61
  s_add_u32 s92, s92, s60
  s_mul_i32 s93, s91, 8192
  s_add_u32 s92, s92, s93
  v_accvgpr_read_b32 v52, a0
  v_accvgpr_read_b32 v53, a1
  v_accvgpr_read_b32 v54, a2
  v_accvgpr_read_b32 v55, a3
  v_accvgpr_read_b32 v56, a32
  v_accvgpr_read_b32 v57, a33
  v_accvgpr_read_b32 v58, a34
  v_accvgpr_read_b32 v59, a35
  v_cvt_pk_bf16_f32 v48, v52, v53
  v_cvt_pk_bf16_f32 v49, v54, v55
  v_cvt_pk_bf16_f32 v50, v56, v57
  v_cvt_pk_bf16_f32 v51, v58, v59
  buffer_store_dwordx4 v[48:51], v172, s[4:7], s92 offen offset:0 sc1
  v_accvgpr_read_b32 v64, a128
  v_accvgpr_read_b32 v65, a129
  v_accvgpr_read_b32 v66, a130
  v_accvgpr_read_b32 v67, a131
  v_accvgpr_read_b32 v68, a160
  v_accvgpr_read_b32 v69, a161
  v_accvgpr_read_b32 v70, a162
  v_accvgpr_read_b32 v71, a163
  v_cvt_pk_bf16_f32 v176, v64, v65
  v_cvt_pk_bf16_f32 v177, v66, v67
  v_cvt_pk_bf16_f32 v178, v68, v69
  v_cvt_pk_bf16_f32 v179, v70, v71
  v_accvgpr_read_b32 v76, a4
  v_accvgpr_read_b32 v77, a5
  v_accvgpr_read_b32 v78, a6
  v_accvgpr_read_b32 v79, a7
  v_accvgpr_read_b32 v80, a36
  v_accvgpr_read_b32 v81, a37
  v_accvgpr_read_b32 v82, a38
  v_accvgpr_read_b32 v83, a39
  v_cvt_pk_bf16_f32 v72, v76, v77
  v_cvt_pk_bf16_f32 v73, v78, v79
  v_cvt_pk_bf16_f32 v74, v80, v81
  v_cvt_pk_bf16_f32 v75, v82, v83
  buffer_store_dwordx4 v[72:75], v172, s[4:7], s92 offen offset:1024 sc1
  v_accvgpr_read_b32 v88, a132
  v_accvgpr_read_b32 v89, a133
  v_accvgpr_read_b32 v90, a134
  v_accvgpr_read_b32 v91, a135
  v_accvgpr_read_b32 v92, a164
  v_accvgpr_read_b32 v93, a165
  v_accvgpr_read_b32 v94, a166
  v_accvgpr_read_b32 v95, a167
  v_cvt_pk_bf16_f32 v180, v88, v89
  v_cvt_pk_bf16_f32 v181, v90, v91
  v_cvt_pk_bf16_f32 v182, v92, v93
  v_cvt_pk_bf16_f32 v183, v94, v95
  v_accvgpr_read_b32 v52, a8
  v_accvgpr_read_b32 v53, a9
  v_accvgpr_read_b32 v54, a10
  v_accvgpr_read_b32 v55, a11
  v_accvgpr_read_b32 v56, a40
  v_accvgpr_read_b32 v57, a41
  v_accvgpr_read_b32 v58, a42
  v_accvgpr_read_b32 v59, a43
  v_cvt_pk_bf16_f32 v48, v52, v53
  v_cvt_pk_bf16_f32 v49, v54, v55
  v_cvt_pk_bf16_f32 v50, v56, v57
  v_cvt_pk_bf16_f32 v51, v58, v59
  buffer_store_dwordx4 v[48:51], v172, s[4:7], s92 offen offset:2048 sc1
  v_accvgpr_read_b32 v64, a136
  v_accvgpr_read_b32 v65, a137
  v_accvgpr_read_b32 v66, a138
  v_accvgpr_read_b32 v67, a139
  v_accvgpr_read_b32 v68, a168
  v_accvgpr_read_b32 v69, a169
  v_accvgpr_read_b32 v70, a170
  v_accvgpr_read_b32 v71, a171
  v_cvt_pk_bf16_f32 v184, v64, v65
  v_cvt_pk_bf16_f32 v185, v66, v67
  v_cvt_pk_bf16_f32 v186, v68, v69
  v_cvt_pk_bf16_f32 v187, v70, v71
  v_accvgpr_read_b32 v76, a12
  v_accvgpr_read_b32 v77, a13
  v_accvgpr_read_b32 v78, a14
  v_accvgpr_read_b32 v79, a15
  v_accvgpr_read_b32 v80, a44
  v_accvgpr_read_b32 v81, a45
  v_accvgpr_read_b32 v82, a46
  v_accvgpr_read_b32 v83, a47
  v_cvt_pk_bf16_f32 v72, v76, v77
  v_cvt_pk_bf16_f32 v73, v78, v79
  v_cvt_pk_bf16_f32 v74, v80, v81
  v_cvt_pk_bf16_f32 v75, v82, v83
  buffer_store_dwordx4 v[72:75], v172, s[4:7], s92 offen offset:3072 sc1
  v_accvgpr_read_b32 v88, a140
  v_accvgpr_read_b32 v89, a141
  v_accvgpr_read_b32 v90, a142
  v_accvgpr_read_b32 v91, a143
  v_accvgpr_read_b32 v92, a172
  v_accvgpr_read_b32 v93, a173
  v_accvgpr_read_b32 v94, a174
  v_accvgpr_read_b32 v95, a175
  v_cvt_pk_bf16_f32 v188, v88, v89
  v_cvt_pk_bf16_f32 v189, v90, v91
  v_cvt_pk_bf16_f32 v190, v92, v93
  v_cvt_pk_bf16_f32 v191, v94, v95
  v_accvgpr_read_b32 v52, a16
  v_accvgpr_read_b32 v53, a17
  v_accvgpr_read_b32 v54, a18
  v_accvgpr_read_b32 v55, a19
  v_accvgpr_read_b32 v56, a48
  v_accvgpr_read_b32 v57, a49
  v_accvgpr_read_b32 v58, a50
  v_accvgpr_read_b32 v59, a51
  v_cvt_pk_bf16_f32 v48, v52, v53
  v_cvt_pk_bf16_f32 v49, v54, v55
  v_cvt_pk_bf16_f32 v50, v56, v57
  v_cvt_pk_bf16_f32 v51, v58, v59
  buffer_store_dwordx4 v[48:51], v173, s[4:7], s92 offen offset:0 sc1
  v_accvgpr_read_b32 v64, a144
  v_accvgpr_read_b32 v65, a145
  v_accvgpr_read_b32 v66, a146
  v_accvgpr_read_b32 v67, a147
  v_accvgpr_read_b32 v68, a176
  v_accvgpr_read_b32 v69, a177
  v_accvgpr_read_b32 v70, a178
  v_accvgpr_read_b32 v71, a179
  v_cvt_pk_bf16_f32 v192, v64, v65
  v_cvt_pk_bf16_f32 v193, v66, v67
  v_cvt_pk_bf16_f32 v194, v68, v69
  v_cvt_pk_bf16_f32 v195, v70, v71
  v_accvgpr_read_b32 v76, a20
  v_accvgpr_read_b32 v77, a21
  v_accvgpr_read_b32 v78, a22
  v_accvgpr_read_b32 v79, a23
  v_accvgpr_read_b32 v80, a52
  v_accvgpr_read_b32 v81, a53
  v_accvgpr_read_b32 v82, a54
  v_accvgpr_read_b32 v83, a55
  v_cvt_pk_bf16_f32 v72, v76, v77
  v_cvt_pk_bf16_f32 v73, v78, v79
  v_cvt_pk_bf16_f32 v74, v80, v81
  v_cvt_pk_bf16_f32 v75, v82, v83
  buffer_store_dwordx4 v[72:75], v173, s[4:7], s92 offen offset:1024 sc1
  v_accvgpr_read_b32 v88, a148
  v_accvgpr_read_b32 v89, a149
  v_accvgpr_read_b32 v90, a150
  v_accvgpr_read_b32 v91, a151
  v_accvgpr_read_b32 v92, a180
  v_accvgpr_read_b32 v93, a181
  v_accvgpr_read_b32 v94, a182
  v_accvgpr_read_b32 v95, a183
  v_cvt_pk_bf16_f32 v196, v88, v89
  v_cvt_pk_bf16_f32 v197, v90, v91
  v_cvt_pk_bf16_f32 v198, v92, v93
  v_cvt_pk_bf16_f32 v199, v94, v95
  v_accvgpr_read_b32 v52, a24
  v_accvgpr_read_b32 v53, a25
  v_accvgpr_read_b32 v54, a26
  v_accvgpr_read_b32 v55, a27
  v_accvgpr_read_b32 v56, a56
  v_accvgpr_read_b32 v57, a57
  v_accvgpr_read_b32 v58, a58
  v_accvgpr_read_b32 v59, a59
  v_cvt_pk_bf16_f32 v48, v52, v53
  v_cvt_pk_bf16_f32 v49, v54, v55
  v_cvt_pk_bf16_f32 v50, v56, v57
  v_cvt_pk_bf16_f32 v51, v58, v59
  buffer_store_dwordx4 v[48:51], v173, s[4:7], s92 offen offset:2048 sc1
  v_accvgpr_read_b32 v64, a152
  v_accvgpr_read_b32 v65, a153
  v_accvgpr_read_b32 v66, a154
  v_accvgpr_read_b32 v67, a155
  v_accvgpr_read_b32 v68, a184
  v_accvgpr_read_b32 v69, a185
  v_accvgpr_read_b32 v70, a186
  v_accvgpr_read_b32 v71, a187
  v_cvt_pk_bf16_f32 v200, v64, v65
  v_cvt_pk_bf16_f32 v201, v66, v67
  v_cvt_pk_bf16_f32 v202, v68, v69
  v_cvt_pk_bf16_f32 v203, v70, v71
  v_accvgpr_read_b32 v76, a28
  v_accvgpr_read_b32 v77, a29
  v_accvgpr_read_b32 v78, a30
  v_accvgpr_read_b32 v79, a31
  v_accvgpr_read_b32 v80, a60
  v_accvgpr_read_b32 v81, a61
  v_accvgpr_read_b32 v82, a62
  v_accvgpr_read_b32 v83, a63
  v_cvt_pk_bf16_f32 v72, v76, v77
  v_cvt_pk_bf16_f32 v73, v78, v79
  v_cvt_pk_bf16_f32 v74, v80, v81
  v_cvt_pk_bf16_f32 v75, v82, v83
  buffer_store_dwordx4 v[72:75], v173, s[4:7], s92 offen offset:3072 sc1
  v_accvgpr_read_b32 v88, a156
  v_accvgpr_read_b32 v89, a157
  v_accvgpr_read_b32 v90, a158
  v_accvgpr_read_b32 v91, a159
  v_accvgpr_read_b32 v92, a188
  v_accvgpr_read_b32 v93, a189
  v_accvgpr_read_b32 v94, a190
  v_accvgpr_read_b32 v95, a191
  v_cvt_pk_bf16_f32 v204, v88, v89
  v_cvt_pk_bf16_f32 v205, v90, v91
  v_cvt_pk_bf16_f32 v206, v92, v93
  v_cvt_pk_bf16_f32 v207, v94, v95
  s_add_u32 s92, s92, s61
  v_accvgpr_read_b32 v52, a64
  v_accvgpr_read_b32 v53, a65
  v_accvgpr_read_b32 v54, a66
  v_accvgpr_read_b32 v55, a67
  v_accvgpr_read_b32 v56, a96
  v_accvgpr_read_b32 v57, a97
  v_accvgpr_read_b32 v58, a98
  v_accvgpr_read_b32 v59, a99
  v_cvt_pk_bf16_f32 v48, v52, v53
  v_cvt_pk_bf16_f32 v49, v54, v55
  v_cvt_pk_bf16_f32 v50, v56, v57
  v_cvt_pk_bf16_f32 v51, v58, v59
  buffer_store_dwordx4 v[48:51], v172, s[4:7], s92 offen offset:0 sc1
  v_accvgpr_read_b32 v64, a192
  v_accvgpr_read_b32 v65, a193
  v_accvgpr_read_b32 v66, a194
  v_accvgpr_read_b32 v67, a195
  v_accvgpr_read_b32 v68, a224
  v_accvgpr_read_b32 v69, a225
  v_accvgpr_read_b32 v70, a226
  v_accvgpr_read_b32 v71, a227
  v_cvt_pk_bf16_f32 v208, v64, v65
  v_cvt_pk_bf16_f32 v209, v66, v67
  v_cvt_pk_bf16_f32 v210, v68, v69
  v_cvt_pk_bf16_f32 v211, v70, v71
  v_accvgpr_read_b32 v76, a68
  v_accvgpr_read_b32 v77, a69
  v_accvgpr_read_b32 v78, a70
  v_accvgpr_read_b32 v79, a71
  v_accvgpr_read_b32 v80, a100
  v_accvgpr_read_b32 v81, a101
  v_accvgpr_read_b32 v82, a102
  v_accvgpr_read_b32 v83, a103
  v_cvt_pk_bf16_f32 v72, v76, v77
  v_cvt_pk_bf16_f32 v73, v78, v79
  v_cvt_pk_bf16_f32 v74, v80, v81
  v_cvt_pk_bf16_f32 v75, v82, v83
  buffer_store_dwordx4 v[72:75], v172, s[4:7], s92 offen offset:1024 sc1
  v_accvgpr_read_b32 v88, a196
  v_accvgpr_read_b32 v89, a197
  v_accvgpr_read_b32 v90, a198
  v_accvgpr_read_b32 v91, a199
  v_accvgpr_read_b32 v92, a228
  v_accvgpr_read_b32 v93, a229
  v_accvgpr_read_b32 v94, a230
  v_accvgpr_read_b32 v95, a231
  v_cvt_pk_bf16_f32 v212, v88, v89
  v_cvt_pk_bf16_f32 v213, v90, v91
  v_cvt_pk_bf16_f32 v214, v92, v93
  v_cvt_pk_bf16_f32 v215, v94, v95
  v_accvgpr_read_b32 v52, a72
  v_accvgpr_read_b32 v53, a73
  v_accvgpr_read_b32 v54, a74
  v_accvgpr_read_b32 v55, a75
  v_accvgpr_read_b32 v56, a104
  v_accvgpr_read_b32 v57, a105
  v_accvgpr_read_b32 v58, a106
  v_accvgpr_read_b32 v59, a107
  v_cvt_pk_bf16_f32 v48, v52, v53
  v_cvt_pk_bf16_f32 v49, v54, v55
  v_cvt_pk_bf16_f32 v50, v56, v57
  v_cvt_pk_bf16_f32 v51, v58, v59
  buffer_store_dwordx4 v[48:51], v172, s[4:7], s92 offen offset:2048 sc1
  v_accvgpr_read_b32 v64, a200
  v_accvgpr_read_b32 v65, a201
  v_accvgpr_read_b32 v66, a202
  v_accvgpr_read_b32 v67, a203
  v_accvgpr_read_b32 v68, a232
  v_accvgpr_read_b32 v69, a233
  v_accvgpr_read_b32 v70, a234
  v_accvgpr_read_b32 v71, a235
  v_cvt_pk_bf16_f32 v216, v64, v65
  v_cvt_pk_bf16_f32 v217, v66, v67
  v_cvt_pk_bf16_f32 v218, v68, v69
  v_cvt_pk_bf16_f32 v219, v70, v71
  v_accvgpr_read_b32 v76, a76
  v_accvgpr_read_b32 v77, a77
  v_accvgpr_read_b32 v78, a78
  v_accvgpr_read_b32 v79, a79
  v_accvgpr_read_b32 v80, a108
  v_accvgpr_read_b32 v81, a109
  v_accvgpr_read_b32 v82, a110
  v_accvgpr_read_b32 v83, a111
  v_cvt_pk_bf16_f32 v72, v76, v77
  v_cvt_pk_bf16_f32 v73, v78, v79
  v_cvt_pk_bf16_f32 v74, v80, v81
  v_cvt_pk_bf16_f32 v75, v82, v83
  buffer_store_dwordx4 v[72:75], v172, s[4:7], s92 offen offset:3072 sc1
  v_accvgpr_read_b32 v88, a204
  v_accvgpr_read_b32 v89, a205
  v_accvgpr_read_b32 v90, a206
  v_accvgpr_read_b32 v91, a207
  v_accvgpr_read_b32 v92, a236
  v_accvgpr_read_b32 v93, a237
  v_accvgpr_read_b32 v94, a238
  v_accvgpr_read_b32 v95, a239
  v_cvt_pk_bf16_f32 v220, v88, v89
  v_cvt_pk_bf16_f32 v221, v90, v91
  v_cvt_pk_bf16_f32 v222, v92, v93
  v_cvt_pk_bf16_f32 v223, v94, v95
  v_accvgpr_read_b32 v52, a80
  v_accvgpr_read_b32 v53, a81
  v_accvgpr_read_b32 v54, a82
  v_accvgpr_read_b32 v55, a83
  v_accvgpr_read_b32 v56, a112
  v_accvgpr_read_b32 v57, a113
  v_accvgpr_read_b32 v58, a114
  v_accvgpr_read_b32 v59, a115
  v_cvt_pk_bf16_f32 v48, v52, v53
  v_cvt_pk_bf16_f32 v49, v54, v55
  v_cvt_pk_bf16_f32 v50, v56, v57
  v_cvt_pk_bf16_f32 v51, v58, v59
  buffer_store_dwordx4 v[48:51], v173, s[4:7], s92 offen offset:0 sc1
  v_accvgpr_read_b32 v64, a208
  v_accvgpr_read_b32 v65, a209
  v_accvgpr_read_b32 v66, a210
  v_accvgpr_read_b32 v67, a211
  v_accvgpr_read_b32 v68, a240
  v_accvgpr_read_b32 v69, a241
  v_accvgpr_read_b32 v70, a242
  v_accvgpr_read_b32 v71, a243
  v_cvt_pk_bf16_f32 v224, v64, v65
  v_cvt_pk_bf16_f32 v225, v66, v67
  v_cvt_pk_bf16_f32 v226, v68, v69
  v_cvt_pk_bf16_f32 v227, v70, v71
  v_accvgpr_read_b32 v76, a84
  v_accvgpr_read_b32 v77, a85
  v_accvgpr_read_b32 v78, a86
  v_accvgpr_read_b32 v79, a87
  v_accvgpr_read_b32 v80, a116
  v_accvgpr_read_b32 v81, a117
  v_accvgpr_read_b32 v82, a118
  v_accvgpr_read_b32 v83, a119
  v_cvt_pk_bf16_f32 v72, v76, v77
  v_cvt_pk_bf16_f32 v73, v78, v79
  v_cvt_pk_bf16_f32 v74, v80, v81
  v_cvt_pk_bf16_f32 v75, v82, v83
  buffer_store_dwordx4 v[72:75], v173, s[4:7], s92 offen offset:1024 sc1
  v_accvgpr_read_b32 v88, a212
  v_accvgpr_read_b32 v89, a213
  v_accvgpr_read_b32 v90, a214
  v_accvgpr_read_b32 v91, a215
  v_accvgpr_read_b32 v92, a244
  v_accvgpr_read_b32 v93, a245
  v_accvgpr_read_b32 v94, a246
  v_accvgpr_read_b32 v95, a247
  v_cvt_pk_bf16_f32 v228, v88, v89
  v_cvt_pk_bf16_f32 v229, v90, v91
  v_cvt_pk_bf16_f32 v230, v92, v93
  v_cvt_pk_bf16_f32 v231, v94, v95
  v_accvgpr_read_b32 v52, a88
  v_accvgpr_read_b32 v53, a89
  v_accvgpr_read_b32 v54, a90
  v_accvgpr_read_b32 v55, a91
  v_accvgpr_read_b32 v56, a120
  v_accvgpr_read_b32 v57, a121
  v_accvgpr_read_b32 v58, a122
  v_accvgpr_read_b32 v59, a123
  v_cvt_pk_bf16_f32 v48, v52, v53
  v_cvt_pk_bf16_f32 v49, v54, v55
  v_cvt_pk_bf16_f32 v50, v56, v57
  v_cvt_pk_bf16_f32 v51, v58, v59
  buffer_store_dwordx4 v[48:51], v173, s[4:7], s92 offen offset:2048 sc1
  v_accvgpr_read_b32 v64, a216
  v_accvgpr_read_b32 v65, a217
  v_accvgpr_read_b32 v66, a218
  v_accvgpr_read_b32 v67, a219
  v_accvgpr_read_b32 v68, a248
  v_accvgpr_read_b32 v69, a249
  v_accvgpr_read_b32 v70, a250
  v_accvgpr_read_b32 v71, a251
  v_cvt_pk_bf16_f32 v232, v64, v65
  v_cvt_pk_bf16_f32 v233, v66, v67
  v_cvt_pk_bf16_f32 v234, v68, v69
  v_cvt_pk_bf16_f32 v235, v70, v71
  v_accvgpr_read_b32 v76, a92
  v_accvgpr_read_b32 v77, a93
  v_accvgpr_read_b32 v78, a94
  v_accvgpr_read_b32 v79, a95
  v_accvgpr_read_b32 v80, a124
  v_accvgpr_read_b32 v81, a125
  v_accvgpr_read_b32 v82, a126
  v_accvgpr_read_b32 v83, a127
  v_cvt_pk_bf16_f32 v72, v76, v77
  v_cvt_pk_bf16_f32 v73, v78, v79
  v_cvt_pk_bf16_f32 v74, v80, v81
  v_cvt_pk_bf16_f32 v75, v82, v83
  buffer_store_dwordx4 v[72:75], v173, s[4:7], s92 offen offset:3072 sc1
  v_accvgpr_read_b32 v88, a220
  v_accvgpr_read_b32 v89, a221
  v_accvgpr_read_b32 v90, a222
  v_accvgpr_read_b32 v91, a223
  v_accvgpr_read_b32 v92, a252
  v_accvgpr_read_b32 v93, a253
  v_accvgpr_read_b32 v94, a254
  v_accvgpr_read_b32 v95, a255
  v_cvt_pk_bf16_f32 v236, v88, v89
  v_cvt_pk_bf16_f32 v237, v90, v91
  v_cvt_pk_bf16_f32 v238, v92, v93
  v_cvt_pk_bf16_f32 v239, v94, v95
  s_add_u32 s92, s92, s61
  s_mov_b32 s46, s92
  s_add_u32 s47, s92, s61
  s_branch L_edef
L_e1:
  s_cmp_lg_u32 s59, 3
  s_cbranch_scc1 L_e2
  s_lshr_b32 s90, s27, 1
  s_and_b32 s91, s27, 1
  v_mov_b32 v178, 0x0
  v_bfe_u32 v177, v1, 0, 6
  v_lshl_add_u32 v178, v177, 4, v178
  v_add_u32 v176, 4096, v178
  s_mul_i32 s92, s90, 2
  s_mul_i32 s92, s92, s61
  s_add_u32 s92, s92, s60
  s_mul_i32 s93, s91, 2048
  s_add_u32 s92, s92, s93
  v_accvgpr_read_b32 v184, a0
  v_accvgpr_read_b32 v185, a4
  v_accvgpr_read_b32 v186, a1
  v_accvgpr_read_b32 v187, a5
  v_accvgpr_read_b32 v188, a2
  v_accvgpr_read_b32 v189, a6
  v_accvgpr_read_b32 v190, a3
  v_accvgpr_read_b32 v191, a7
  v_cvt_pk_bf16_f32 v180, v184, v185
  v_cvt_pk_bf16_f32 v181, v186, v187
  v_cvt_pk_bf16_f32 v182, v188, v189
  v_cvt_pk_bf16_f32 v183, v190, v191
  buffer_store_dwordx4 v[180:183], v178, s[4:7], s92 offen offset:0 sc1
  v_accvgpr_read_b32 v196, a8
  v_accvgpr_read_b32 v197, a12
  v_accvgpr_read_b32 v198, a9
  v_accvgpr_read_b32 v199, a13
  v_accvgpr_read_b32 v200, a10
  v_accvgpr_read_b32 v201, a14
  v_accvgpr_read_b32 v202, a11
  v_accvgpr_read_b32 v203, a15
  v_cvt_pk_bf16_f32 v192, v196, v197
  v_cvt_pk_bf16_f32 v193, v198, v199
  v_cvt_pk_bf16_f32 v194, v200, v201
  v_cvt_pk_bf16_f32 v195, v202, v203
  buffer_store_dwordx4 v[192:195], v178, s[4:7], s92 offen offset:1024 sc1
  v_accvgpr_read_b32 v208, a16
  v_accvgpr_read_b32 v209, a20
  v_accvgpr_read_b32 v210, a17
  v_accvgpr_read_b32 v211, a21
  v_accvgpr_read_b32 v212, a18
  v_accvgpr_read_b32 v213, a22
  v_accvgpr_read_b32 v214, a19
  v_accvgpr_read_b32 v215, a23
  v_cvt_pk_bf16_f32 v204, v208, v209
  v_cvt_pk_bf16_f32 v205, v210, v211
  v_cvt_pk_bf16_f32 v206, v212, v213
  v_cvt_pk_bf16_f32 v207, v214, v215
  buffer_store_dwordx4 v[204:207], v176, s[4:7], s92 offen offset:0 sc1
  v_accvgpr_read_b32 v220, a24
  v_accvgpr_read_b32 v221, a28
  v_accvgpr_read_b32 v222, a25
  v_accvgpr_read_b32 v223, a29
  v_accvgpr_read_b32 v224, a26
  v_accvgpr_read_b32 v225, a30
  v_accvgpr_read_b32 v226, a27
  v_accvgpr_read_b32 v227, a31
  v_cvt_pk_bf16_f32 v216, v220, v221
  v_cvt_pk_bf16_f32 v217, v222, v223
  v_cvt_pk_bf16_f32 v218, v224, v225
  v_cvt_pk_bf16_f32 v219, v226, v227
  buffer_store_dwordx4 v[216:219], v176, s[4:7], s92 offen offset:1024 sc1
  s_add_u32 s92, s92, s61
  v_accvgpr_read_b32 v184, a32
  v_accvgpr_read_b32 v185, a36
  v_accvgpr_read_b32 v186, a33
  v_accvgpr_read_b32 v187, a37
  v_accvgpr_read_b32 v188, a34
  v_accvgpr_read_b32 v189, a38
  v_accvgpr_read_b32 v190, a35
  v_accvgpr_read_b32 v191, a39
  v_cvt_pk_bf16_f32 v180, v184, v185
  v_cvt_pk_bf16_f32 v181, v186, v187
  v_cvt_pk_bf16_f32 v182, v188, v189
  v_cvt_pk_bf16_f32 v183, v190, v191
  buffer_store_dwordx4 v[180:183], v178, s[4:7], s92 offen offset:0 sc1
  v_accvgpr_read_b32 v196, a40
  v_accvgpr_read_b32 v197, a44
  v_accvgpr_read_b32 v198, a41
  v_accvgpr_read_b32 v199, a45
  v_accvgpr_read_b32 v200, a42
  v_accvgpr_read_b32 v201, a46
  v_accvgpr_read_b32 v202, a43
  v_accvgpr_read_b32 v203, a47
  v_cvt_pk_bf16_f32 v192, v196, v197
  v_cvt_pk_bf16_f32 v193, v198, v199
  v_cvt_pk_bf16_f32 v194, v200, v201
  v_cvt_pk_bf16_f32 v195, v202, v203
  buffer_store_dwordx4 v[192:195], v178, s[4:7], s92 offen offset:1024 sc1
  v_accvgpr_read_b32 v208, a48
  v_accvgpr_read_b32 v209, a52
  v_accvgpr_read_b32 v210, a49
  v_accvgpr_read_b32 v211, a53
  v_accvgpr_read_b32 v212, a50
  v_accvgpr_read_b32 v213, a54
  v_accvgpr_read_b32 v214, a51
  v_accvgpr_read_b32 v215, a55
  v_cvt_pk_bf16_f32 v204, v208, v209
  v_cvt_pk_bf16_f32 v205, v210, v211
  v_cvt_pk_bf16_f32 v206, v212, v213
  v_cvt_pk_bf16_f32 v207, v214, v215
  buffer_store_dwordx4 v[204:207], v176, s[4:7], s92 offen offset:0 sc1
  v_accvgpr_read_b32 v220, a56
  v_accvgpr_read_b32 v221, a60
  v_accvgpr_read_b32 v222, a57
  v_accvgpr_read_b32 v223, a61
  v_accvgpr_read_b32 v224, a58
  v_accvgpr_read_b32 v225, a62
  v_accvgpr_read_b32 v226, a59
  v_accvgpr_read_b32 v227, a63
  v_cvt_pk_bf16_f32 v216, v220, v221
  v_cvt_pk_bf16_f32 v217, v222, v223
  v_cvt_pk_bf16_f32 v218, v224, v225
  v_cvt_pk_bf16_f32 v219, v226, v227
  buffer_store_dwordx4 v[216:219], v176, s[4:7], s92 offen offset:1024 sc1
  s_add_u32 s92, s92, s61
  s_branch L_esig
L_e2:
  s_cmp_lg_u32 s59, 4
  s_cbranch_scc1 L_e3
  s_lshr_b32 s90, s27, 1
  s_and_b32 s91, s27, 1
  v_mov_b32 v178, 0x0
  v_bfe_u32 v177, v1, 0, 6
  v_lshl_add_u32 v178, v177, 4, v178
  v_add_u32 v176, 4096, v178
  s_mul_i32 s92, s90, 2
  s_mul_i32 s92, s92, s61
  s_add_u32 s92, s92, s60
  s_mul_i32 s93, s91, 4096
  s_add_u32 s92, s92, s93
  v_accvgpr_read_b32 v184, a0
  v_accvgpr_read_b32 v185, a1
  v_accvgpr_read_b32 v186, a2
  v_accvgpr_read_b32 v187, a3
  v_accvgpr_read_b32 v188, a16
  v_accvgpr_read_b32 v189, a17
  v_accvgpr_read_b32 v190, a18
  v_accvgpr_read_b32 v191, a19
  v_cvt_pk_bf16_f32 v180, v184, v185
  v_cvt_pk_bf16_f32 v181, v186, v187
  v_cvt_pk_bf16_f32 v182, v188, v189
  v_cvt_pk_bf16_f32 v183, v190, v191
  buffer_store_dwordx4 v[180:183], v178, s[4:7], s92 offen offset:0 sc1
  v_accvgpr_read_b32 v196, a4
  v_accvgpr_read_b32 v197, a5
  v_accvgpr_read_b32 v198, a6
  v_accvgpr_read_b32 v199, a7
  v_accvgpr_read_b32 v200, a20
  v_accvgpr_read_b32 v201, a21
  v_accvgpr_read_b32 v202, a22
  v_accvgpr_read_b32 v203, a23
  v_cvt_pk_bf16_f32 v192, v196, v197
  v_cvt_pk_bf16_f32 v193, v198, v199
  v_cvt_pk_bf16_f32 v194, v200, v201
  v_cvt_pk_bf16_f32 v195, v202, v203
  buffer_store_dwordx4 v[192:195], v178, s[4:7], s92 offen offset:1024 sc1
  v_accvgpr_read_b32 v208, a8
  v_accvgpr_read_b32 v209, a9
  v_accvgpr_read_b32 v210, a10
  v_accvgpr_read_b32 v211, a11
  v_accvgpr_read_b32 v212, a24
  v_accvgpr_read_b32 v213, a25
  v_accvgpr_read_b32 v214, a26
  v_accvgpr_read_b32 v215, a27
  v_cvt_pk_bf16_f32 v204, v208, v209
  v_cvt_pk_bf16_f32 v205, v210, v211
  v_cvt_pk_bf16_f32 v206, v212, v213
  v_cvt_pk_bf16_f32 v207, v214, v215
  buffer_store_dwordx4 v[204:207], v178, s[4:7], s92 offen offset:2048 sc1
  v_accvgpr_read_b32 v220, a12
  v_accvgpr_read_b32 v221, a13
  v_accvgpr_read_b32 v222, a14
  v_accvgpr_read_b32 v223, a15
  v_accvgpr_read_b32 v224, a28
  v_accvgpr_read_b32 v225, a29
  v_accvgpr_read_b32 v226, a30
  v_accvgpr_read_b32 v227, a31
  v_cvt_pk_bf16_f32 v216, v220, v221
  v_cvt_pk_bf16_f32 v217, v222, v223
  v_cvt_pk_bf16_f32 v218, v224, v225
  v_cvt_pk_bf16_f32 v219, v226, v227
  buffer_store_dwordx4 v[216:219], v178, s[4:7], s92 offen offset:3072 sc1
  s_add_u32 s92, s92, s61
  v_accvgpr_read_b32 v184, a32
  v_accvgpr_read_b32 v185, a33
  v_accvgpr_read_b32 v186, a34
  v_accvgpr_read_b32 v187, a35
  v_accvgpr_read_b32 v188, a48
  v_accvgpr_read_b32 v189, a49
  v_accvgpr_read_b32 v190, a50
  v_accvgpr_read_b32 v191, a51
  v_cvt_pk_bf16_f32 v180, v184, v185
  v_cvt_pk_bf16_f32 v181, v186, v187
  v_cvt_pk_bf16_f32 v182, v188, v189
  v_cvt_pk_bf16_f32 v183, v190, v191
  buffer_store_dwordx4 v[180:183], v178, s[4:7], s92 offen offset:0 sc1
  v_accvgpr_read_b32 v196, a36
  v_accvgpr_read_b32 v197, a37
  v_accvgpr_read_b32 v198, a38
  v_accvgpr_read_b32 v199, a39
  v_accvgpr_read_b32 v200, a52
  v_accvgpr_read_b32 v201, a53
  v_accvgpr_read_b32 v202, a54
  v_accvgpr_read_b32 v203, a55
  v_cvt_pk_bf16_f32 v192, v196, v197
  v_cvt_pk_bf16_f32 v193, v198, v199
  v_cvt_pk_bf16_f32 v194, v200, v201
  v_cvt_pk_bf16_f32 v195, v202, v203
  buffer_store_dwordx4 v[192:195], v178, s[4:7], s92 offen offset:1024 sc1
  v_accvgpr_read_b32 v208, a40
  v_accvgpr_read_b32 v209, a41
  v_accvgpr_read_b32 v210, a42
  v_accvgpr_read_b32 v211, a43
  v_accvgpr_read_b32 v212, a56
  v_accvgpr_read_b32 v213, a57
  v_accvgpr_read_b32 v214, a58
  v_accvgpr_read_b32 v215, a59
  v_cvt_pk_bf16_f32 v204, v208, v209
  v_cvt_pk_bf16_f32 v205, v210, v211
  v_cvt_pk_bf16_f32 v206, v212, v213
  v_cvt_pk_bf16_f32 v207, v214, v215
  buffer_store_dwordx4 v[204:207], v178, s[4:7], s92 offen offset:2048 sc1
  v_accvgpr_read_b32 v220, a44
  v_accvgpr_read_b32 v221, a45
  v_accvgpr_read_b32 v222, a46
  v_accvgpr_read_b32 v223, a47
  v_accvgpr_read_b32 v224, a60
  v_accvgpr_read_b32 v225, a61
  v_accvgpr_read_b32 v226, a62
  v_accvgpr_read_b32 v227, a63
  v_cvt_pk_bf16_f32 v216, v220, v221
  v_cvt_pk_bf16_f32 v217, v222, v223
  v_cvt_pk_bf16_f32 v218, v224, v225
  v_cvt_pk_bf16_f32 v219, v226, v227
  buffer_store_dwordx4 v[216:219], v178, s[4:7], s92 offen offset:3072 sc1
  s_add_u32 s92, s92, s61
  s_branch L_esig
L_e3:
  s_cmp_lg_u32 s59, 5
  s_cbranch_scc1 L_e4
  s_lshr_b32 s90, s27, 1
  s_and_b32 s91, s27, 1
  v_and_b32 v176, 15, v1
  v_mul_lo_u32 v176, v176, s61
  v_lshrrev_b32 v177, 4, v1
  v_lshl_add_u32 v178, v177, 4, v176
  s_mul_i32 s92, s90, 64
  s_mul_i32 s92, s92, s61
  s_add_u32 s92, s92, s60
  s_mul_i32 s93, s91, 128
  s_add_u32 s92, s92, s93
  s_lshl_b32 s94, s61, 4
  v_accvgpr_read_b32 v184, a0
  v_accvgpr_read_b32 v185, a1
  v_accvgpr_read_b32 v186, a2
  v_accvgpr_read_b32 v187, a3
  v_accvgpr_read_b32 v188, a4
  v_accvgpr_read_b32 v189, a5
  v_accvgpr_read_b32 v190, a6
  v_accvgpr_read_b32 v191, a7
  v_cvt_pk_bf16_f32 v180, v184, v185
  v_cvt_pk_bf16_f32 v181, v186, v187
  v_cvt_pk_bf16_f32 v182, v188, v189
  v_cvt_pk_bf16_f32 v183, v190, v191
  buffer_store_dwordx4 v[180:183], v178, s[16:19], s92 offen offset:0 sc1
  v_accvgpr_read_b32 v196, a8
  v_accvgpr_read_b32 v197, a9
  v_accvgpr_read_b32 v198, a10
  v_accvgpr_read_b32 v199, a11
  v_accvgpr_read_b32 v200, a12
  v_accvgpr_read_b32 v201, a13
  v_accvgpr_read_b32 v202, a14
  v_accvgpr_read_b32 v203, a15
  v_cvt_pk_bf16_f32 v192, v196, v197
  v_cvt_pk_bf16_f32 v193, v198, v199
  v_cvt_pk_bf16_f32 v194, v200, v201
  v_cvt_pk_bf16_f32 v195, v202, v203
  buffer_store_dwordx4 v[192:195], v178, s[16:19], s92 offen offset:64 sc1
  s_add_u32 s92, s92, s94
  v_accvgpr_read_b32 v208, a16
  v_accvgpr_read_b32 v209, a17
  v_accvgpr_read_b32 v210, a18
  v_accvgpr_read_b32 v211, a19
  v_accvgpr_read_b32 v212, a20
  v_accvgpr_read_b32 v213, a21
  v_accvgpr_read_b32 v214, a22
  v_accvgpr_read_b32 v215, a23
  v_cvt_pk_bf16_f32 v204, v208, v209
  v_cvt_pk_bf16_f32 v205, v210, v211
  v_cvt_pk_bf16_f32 v206, v212, v213
  v_cvt_pk_bf16_f32 v207, v214, v215
  buffer_store_dwordx4 v[204:207], v178, s[16:19], s92 offen offset:0 sc1
  v_accvgpr_read_b32 v220, a24
  v_accvgpr_read_b32 v221, a25
  v_accvgpr_read_b32 v222, a26
  v_accvgpr_read_b32 v223, a27
  v_accvgpr_read_b32 v224, a28
  v_accvgpr_read_b32 v225, a29
  v_accvgpr_read_b32 v226, a30
  v_accvgpr_read_b32 v227, a31
  v_cvt_pk_bf16_f32 v216, v220, v221
  v_cvt_pk_bf16_f32 v217, v222, v223
  v_cvt_pk_bf16_f32 v218, v224, v225
  v_cvt_pk_bf16_f32 v219, v226, v227
  buffer_store_dwordx4 v[216:219], v178, s[16:19], s92 offen offset:64 sc1
  s_add_u32 s92, s92, s94
  v_accvgpr_read_b32 v184, a32
  v_accvgpr_read_b32 v185, a33
  v_accvgpr_read_b32 v186, a34
  v_accvgpr_read_b32 v187, a35
  v_accvgpr_read_b32 v188, a36
  v_accvgpr_read_b32 v189, a37
  v_accvgpr_read_b32 v190, a38
  v_accvgpr_read_b32 v191, a39
  v_cvt_pk_bf16_f32 v180, v184, v185
  v_cvt_pk_bf16_f32 v181, v186, v187
  v_cvt_pk_bf16_f32 v182, v188, v189
  v_cvt_pk_bf16_f32 v183, v190, v191
  buffer_store_dwordx4 v[180:183], v178, s[16:19], s92 offen offset:0 sc1
  v_accvgpr_read_b32 v196, a40
  v_accvgpr_read_b32 v197, a41
  v_accvgpr_read_b32 v198, a42
  v_accvgpr_read_b32 v199, a43
  v_accvgpr_read_b32 v200, a44
  v_accvgpr_read_b32 v201, a45
  v_accvgpr_read_b32 v202, a46
  v_accvgpr_read_b32 v203, a47
  v_cvt_pk_bf16_f32 v192, v196, v197
  v_cvt_pk_bf16_f32 v193, v198, v199
  v_cvt_pk_bf16_f32 v194, v200, v201
  v_cvt_pk_bf16_f32 v195, v202, v203
  buffer_store_dwordx4 v[192:195], v178, s[16:19], s92 offen offset:64 sc1
  s_add_u32 s92, s92, s94
  v_accvgpr_read_b32 v208, a48
  v_accvgpr_read_b32 v209, a49
  v_accvgpr_read_b32 v210, a50
  v_accvgpr_read_b32 v211, a51
  v_accvgpr_read_b32 v212, a52
  v_accvgpr_read_b32 v213, a53
  v_accvgpr_read_b32 v214, a54
  v_accvgpr_read_b32 v215, a55
  v_cvt_pk_bf16_f32 v204, v208, v209
  v_cvt_pk_bf16_f32 v205, v210, v211
  v_cvt_pk_bf16_f32 v206, v212, v213
  v_cvt_pk_bf16_f32 v207, v214, v215
  buffer_store_dwordx4 v[204:207], v178, s[16:19], s92 offen offset:0 sc1
  v_accvgpr_read_b32 v220, a56
  v_accvgpr_read_b32 v221, a57
  v_accvgpr_read_b32 v222, a58
  v_accvgpr_read_b32 v223, a59
  v_accvgpr_read_b32 v224, a60
  v_accvgpr_read_b32 v225, a61
  v_accvgpr_read_b32 v226, a62
  v_accvgpr_read_b32 v227, a63
  v_cvt_pk_bf16_f32 v216, v220, v221
  v_cvt_pk_bf16_f32 v217, v222, v223
  v_cvt_pk_bf16_f32 v218, v224, v225
  v_cvt_pk_bf16_f32 v219, v226, v227
  buffer_store_dwordx4 v[216:219], v178, s[16:19], s92 offen offset:64 sc1
  s_add_u32 s92, s92, s94
  s_branch L_epid
L_e4:
  s_cmp_lg_u32 s59, 6
  s_cbranch_scc1 L_e5
  s_lshr_b32 s90, s27, 1
  s_and_b32 s91, s27, 1
  v_and_b32 v176, 15, v1
  v_mul_lo_u32 v176, v176, s61
  v_lshrrev_b32 v177, 4, v1
  v_lshl_add_u32 v178, v177, 4, v176
  s_mul_i32 s92, s90, 128
  s_mul_i32 s92, s92, s61
  s_add_u32 s92, s92, s60
  s_mul_i32 s93, s91, 128
  s_add_u32 s92, s92, s93
  s_lshl_b32 s94, s61, 4
  v_accvgpr_read_b32 v184, a0
  v_accvgpr_read_b32 v185, a1
  v_accvgpr_read_b32 v186, a2
  v_accvgpr_read_b32 v187, a3
  v_accvgpr_read_b32 v188, a4
  v_accvgpr_read_b32 v189, a5
  v_accvgpr_read_b32 v190, a6
  v_accvgpr_read_b32 v191, a7
  v_cvt_pk_bf16_f32 v180, v184, v185
  v_cvt_pk_bf16_f32 v181, v186, v187
  v_cvt_pk_bf16_f32 v182, v188, v189
  v_cvt_pk_bf16_f32 v183, v190, v191
  buffer_store_dwordx4 v[180:183], v178, s[16:19], s92 offen offset:0 sc1
  v_accvgpr_read_b32 v196, a8
  v_accvgpr_read_b32 v197, a9
  v_accvgpr_read_b32 v198, a10
  v_accvgpr_read_b32 v199, a11
  v_accvgpr_read_b32 v200, a12
  v_accvgpr_read_b32 v201, a13
  v_accvgpr_read_b32 v202, a14
  v_accvgpr_read_b32 v203, a15
  v_cvt_pk_bf16_f32 v192, v196, v197
  v_cvt_pk_bf16_f32 v193, v198, v199
  v_cvt_pk_bf16_f32 v194, v200, v201
  v_cvt_pk_bf16_f32 v195, v202, v203
  buffer_store_dwordx4 v[192:195], v178, s[16:19], s92 offen offset:64 sc1
  s_add_u32 s92, s92, s94
  v_accvgpr_read_b32 v208, a16
  v_accvgpr_read_b32 v209, a17
  v_accvgpr_read_b32 v210, a18
  v_accvgpr_read_b32 v211, a19
  v_accvgpr_read_b32 v212, a20
  v_accvgpr_read_b32 v213, a21
  v_accvgpr_read_b32 v214, a22
  v_accvgpr_read_b32 v215, a23
  v_cvt_pk_bf16_f32 v204, v208, v209
  v_cvt_pk_bf16_f32 v205, v210, v211
  v_cvt_pk_bf16_f32 v206, v212, v213
  v_cvt_pk_bf16_f32 v207, v214, v215
  buffer_store_dwordx4 v[204:207], v178, s[16:19], s92 offen offset:0 sc1
  v_accvgpr_read_b32 v220, a24
  v_accvgpr_read_b32 v221, a25
  v_accvgpr_read_b32 v222, a26
  v_accvgpr_read_b32 v223, a27
  v_accvgpr_read_b32 v224, a28
  v_accvgpr_read_b32 v225, a29
  v_accvgpr_read_b32 v226, a30
  v_accvgpr_read_b32 v227, a31
  v_cvt_pk_bf16_f32 v216, v220, v221
  v_cvt_pk_bf16_f32 v217, v222, v223
  v_cvt_pk_bf16_f32 v218, v224, v225
  v_cvt_pk_bf16_f32 v219, v226, v227
  buffer_store_dwordx4 v[216:219], v178, s[16:19], s92 offen offset:64 sc1
  s_add_u32 s92, s92, s94
  v_accvgpr_read_b32 v184, a32
  v_accvgpr_read_b32 v185, a33
  v_accvgpr_read_b32 v186, a34
  v_accvgpr_read_b32 v187, a35
  v_accvgpr_read_b32 v188, a36
  v_accvgpr_read_b32 v189, a37
  v_accvgpr_read_b32 v190, a38
  v_accvgpr_read_b32 v191, a39
  v_cvt_pk_bf16_f32 v180, v184, v185
  v_cvt_pk_bf16_f32 v181, v186, v187
  v_cvt_pk_bf16_f32 v182, v188, v189
  v_cvt_pk_bf16_f32 v183, v190, v191
  buffer_store_dwordx4 v[180:183], v178, s[16:19], s92 offen offset:0 sc1
  v_accvgpr_read_b32 v196, a40
  v_accvgpr_read_b32 v197, a41
  v_accvgpr_read_b32 v198, a42
  v_accvgpr_read_b32 v199, a43
  v_accvgpr_read_b32 v200, a44
  v_accvgpr_read_b32 v201, a45
  v_accvgpr_read_b32 v202, a46
  v_accvgpr_read_b32 v203, a47
  v_cvt_pk_bf16_f32 v192, v196, v197
  v_cvt_pk_bf16_f32 v193, v198, v199
  v_cvt_pk_bf16_f32 v194, v200, v201
  v_cvt_pk_bf16_f32 v195, v202, v203
  buffer_store_dwordx4 v[192:195], v178, s[16:19], s92 offen offset:64 sc1
  s_add_u32 s92, s92, s94
  v_accvgpr_read_b32 v208, a48
  v_accvgpr_read_b32 v209, a49
  v_accvgpr_read_b32 v210, a50
  v_accvgpr_read_b32 v211, a51
  v_accvgpr_read_b32 v212, a52
  v_accvgpr_read_b32 v213, a53
  v_accvgpr_read_b32 v214, a54
  v_accvgpr_read_b32 v215, a55
  v_cvt_pk_bf16_f32 v204, v208, v209
  v_cvt_pk_bf16_f32 v205, v210, v211
  v_cvt_pk_bf16_f32 v206, v212, v213
  v_cvt_pk_bf16_f32 v207, v214, v215
  buffer_store_dwordx4 v[204:207], v178, s[16:19], s92 offen offset:0 sc1
  v_accvgpr_read_b32 v220, a56
  v_accvgpr_read_b32 v221, a57
  v_accvgpr_read_b32 v222, a58
  v_accvgpr_read_b32 v223, a59
  v_accvgpr_read_b32 v224, a60
  v_accvgpr_read_b32 v225, a61
  v_accvgpr_read_b32 v226, a62
  v_accvgpr_read_b32 v227, a63
  v_cvt_pk_bf16_f32 v216, v220, v221
  v_cvt_pk_bf16_f32 v217, v222, v223
  v_cvt_pk_bf16_f32 v218, v224, v225
  v_cvt_pk_bf16_f32 v219, v226, v227
  buffer_store_dwordx4 v[216:219], v178, s[16:19], s92 offen offset:64 sc1
  s_add_u32 s92, s92, s94
  v_accvgpr_read_b32 v184, a64
  v_accvgpr_read_b32 v185, a65
  v_accvgpr_read_b32 v186, a66
  v_accvgpr_read_b32 v187, a67
  v_accvgpr_read_b32 v188, a68
  v_accvgpr_read_b32 v189, a69
  v_accvgpr_read_b32 v190, a70
  v_accvgpr_read_b32 v191, a71
  v_cvt_pk_bf16_f32 v180, v184, v185
  v_cvt_pk_bf16_f32 v181, v186, v187
  v_cvt_pk_bf16_f32 v182, v188, v189
  v_cvt_pk_bf16_f32 v183, v190, v191
  buffer_store_dwordx4 v[180:183], v178, s[16:19], s92 offen offset:0 sc1
  v_accvgpr_read_b32 v196, a72
  v_accvgpr_read_b32 v197, a73
  v_accvgpr_read_b32 v198, a74
  v_accvgpr_read_b32 v199, a75
  v_accvgpr_read_b32 v200, a76
  v_accvgpr_read_b32 v201, a77
  v_accvgpr_read_b32 v202, a78
  v_accvgpr_read_b32 v203, a79
  v_cvt_pk_bf16_f32 v192, v196, v197
  v_cvt_pk_bf16_f32 v193, v198, v199
  v_cvt_pk_bf16_f32 v194, v200, v201
  v_cvt_pk_bf16_f32 v195, v202, v203
  buffer_store_dwordx4 v[192:195], v178, s[16:19], s92 offen offset:64 sc1
  s_add_u32 s92, s92, s94
  v_accvgpr_read_b32 v208, a80
  v_accvgpr_read_b32 v209, a81
  v_accvgpr_read_b32 v210, a82
  v_accvgpr_read_b32 v211, a83
  v_accvgpr_read_b32 v212, a84
  v_accvgpr_read_b32 v213, a85
  v_accvgpr_read_b32 v214, a86
  v_accvgpr_read_b32 v215, a87
  v_cvt_pk_bf16_f32 v204, v208, v209
  v_cvt_pk_bf16_f32 v205, v210, v211
  v_cvt_pk_bf16_f32 v206, v212, v213
  v_cvt_pk_bf16_f32 v207, v214, v215
  buffer_store_dwordx4 v[204:207], v178, s[16:19], s92 offen offset:0 sc1
  v_accvgpr_read_b32 v220, a88
  v_accvgpr_read_b32 v221, a89
  v_accvgpr_read_b32 v222, a90
  v_accvgpr_read_b32 v223, a91
  v_accvgpr_read_b32 v224, a92
  v_accvgpr_read_b32 v225, a93
  v_accvgpr_read_b32 v226, a94
  v_accvgpr_read_b32 v227, a95
  v_cvt_pk_bf16_f32 v216, v220, v221
  v_cvt_pk_bf16_f32 v217, v222, v223
  v_cvt_pk_bf16_f32 v218, v224, v225
  v_cvt_pk_bf16_f32 v219, v226, v227
  buffer_store_dwordx4 v[216:219], v178, s[16:19], s92 offen offset:64 sc1
  s_add_u32 s92, s92, s94
  v_accvgpr_read_b32 v184, a96
  v_accvgpr_read_b32 v185, a97
  v_accvgpr_read_b32 v186, a98
  v_accvgpr_read_b32 v187, a99
  v_accvgpr_read_b32 v188, a100
  v_accvgpr_read_b32 v189, a101
  v_accvgpr_read_b32 v190, a102
  v_accvgpr_read_b32 v191, a103
  v_cvt_pk_bf16_f32 v180, v184, v185
  v_cvt_pk_bf16_f32 v181, v186, v187
  v_cvt_pk_bf16_f32 v182, v188, v189
  v_cvt_pk_bf16_f32 v183, v190, v191
  buffer_store_dwordx4 v[180:183], v178, s[16:19], s92 offen offset:0 sc1
  v_accvgpr_read_b32 v196, a104
  v_accvgpr_read_b32 v197, a105
  v_accvgpr_read_b32 v198, a106
  v_accvgpr_read_b32 v199, a107
  v_accvgpr_read_b32 v200, a108
  v_accvgpr_read_b32 v201, a109
  v_accvgpr_read_b32 v202, a110
  v_accvgpr_read_b32 v203, a111
  v_cvt_pk_bf16_f32 v192, v196, v197
  v_cvt_pk_bf16_f32 v193, v198, v199
  v_cvt_pk_bf16_f32 v194, v200, v201
  v_cvt_pk_bf16_f32 v195, v202, v203
  buffer_store_dwordx4 v[192:195], v178, s[16:19], s92 offen offset:64 sc1
  s_add_u32 s92, s92, s94
  v_accvgpr_read_b32 v208, a112
  v_accvgpr_read_b32 v209, a113
  v_accvgpr_read_b32 v210, a114
  v_accvgpr_read_b32 v211, a115
  v_accvgpr_read_b32 v212, a116
  v_accvgpr_read_b32 v213, a117
  v_accvgpr_read_b32 v214, a118
  v_accvgpr_read_b32 v215, a119
  v_cvt_pk_bf16_f32 v204, v208, v209
  v_cvt_pk_bf16_f32 v205, v210, v211
  v_cvt_pk_bf16_f32 v206, v212, v213
  v_cvt_pk_bf16_f32 v207, v214, v215
  buffer_store_dwordx4 v[204:207], v178, s[16:19], s92 offen offset:0 sc1
  v_accvgpr_read_b32 v220, a120
  v_accvgpr_read_b32 v221, a121
  v_accvgpr_read_b32 v222, a122
  v_accvgpr_read_b32 v223, a123
  v_accvgpr_read_b32 v224, a124
  v_accvgpr_read_b32 v225, a125
  v_accvgpr_read_b32 v226, a126
  v_accvgpr_read_b32 v227, a127
  v_cvt_pk_bf16_f32 v216, v220, v221
  v_cvt_pk_bf16_f32 v217, v222, v223
  v_cvt_pk_bf16_f32 v218, v224, v225
  v_cvt_pk_bf16_f32 v219, v226, v227
  buffer_store_dwordx4 v[216:219], v178, s[16:19], s92 offen offset:64 sc1
  s_add_u32 s92, s92, s94
  s_branch L_epid
L_e5:
L_edef:
  s_mov_b32 s49, 1
  s_cmp_eq_u32 s58, 1
  s_cbranch_scc1 L_epid
  s_mov_b32 s49, 0
  buffer_store_dwordx4 v[176:179], v172, s[4:7], s46 offen offset:0 sc1
  buffer_store_dwordx4 v[180:183], v172, s[4:7], s46 offen offset:1024 sc1
  buffer_store_dwordx4 v[184:187], v172, s[4:7], s46 offen offset:2048 sc1
  buffer_store_dwordx4 v[188:191], v172, s[4:7], s46 offen offset:3072 sc1
  buffer_store_dwordx4 v[192:195], v173, s[4:7], s46 offen offset:0 sc1
  buffer_store_dwordx4 v[196:199], v173, s[4:7], s46 offen offset:1024 sc1
  buffer_store_dwordx4 v[200:203], v173, s[4:7], s46 offen offset:2048 sc1
  buffer_store_dwordx4 v[204:207], v173, s[4:7], s46 offen offset:3072 sc1
  buffer_store_dwordx4 v[208:211], v172, s[4:7], s47 offen offset:0 sc1
  buffer_store_dwordx4 v[212:215], v172, s[4:7], s47 offen offset:1024 sc1
  buffer_store_dwordx4 v[216:219], v172, s[4:7], s47 offen offset:2048 sc1
  buffer_store_dwordx4 v[220:223], v172, s[4:7], s47 offen offset:3072 sc1
  buffer_store_dwordx4 v[224:227], v173, s[4:7], s47 offen offset:0 sc1
  buffer_store_dwordx4 v[228:231], v173, s[4:7], s47 offen offset:1024 sc1
  buffer_store_dwordx4 v[232:235], v173, s[4:7], s47 offen offset:2048 sc1
  buffer_store_dwordx4 v[236:239], v173, s[4:7], s47 offen offset:3072 sc1
  s_mov_b32 s46, 0x40000000
  s_mov_b32 s47, 0x40000000
L_esig:
  s_waitcnt vmcnt(0)
  s_cmp_lg_u32 s39, 0
  s_cbranch_scc1 L_vok
  v_mbcnt_lo_u32_b32 v250, -1, 0
  v_mbcnt_hi_u32_b32 v250, -1, v250
  s_lshl_b32 s90, s32, 9
  s_add_u32 s90, s90, 147520
  v_lshl_add_u32 v251, v250, 3, s90
  ds_write_b64 v251, v[248:249]
  s_waitcnt lgkmcnt(0)
  s_cmp_lg_u32 s32, 0
  s_cbranch_scc1 L_vd_4
  v_lshlrev_b32 v250, 2, v250
  s_cmp_lg_u32 s100, 0
  s_cbranch_scc1 L_vw_3
  v_readfirstlane_b32 s90, v247
  s_and_b32 s90, s90, s101
  s_cbranch_scc0 L_vw_3
  v_mov_b32 v251, 1
  s_mov_b64 exec, 1
  buffer_store_dword v251, v250, s[28:31], 0 offen offset:32 sc1
  s_mov_b64 exec, -1
L_vw_3:
  buffer_load_dword v251, v250, s[28:31], 0 offen sc1
  s_waitcnt vmcnt(0)
  v_cmp_eq_u32 vcc, -1, v251
  v_readlane_b32 s91, v251, 8
  v_readlane_b32 s92, v251, 32
  v_readlane_b32 s93, v251, 33
  v_readlane_b32 s90, v251, 34
  s_cmp_lg_u32 s100, 0
  s_cselect_b32 s93, s90, s93
  s_cselect_b32 s91, 0, s91
  s_cselect_b32 s92, 1, s92
  s_cselect_b32 s90, 0xff, vcc_lo
  s_cmp_lg_u32 s91, 0
  s_cselect_b32 s92, 3, s92
  s_cbranch_scc1 L_vk_5
  s_add_u32 s3, s3, 1
  s_cmp_ge_u32 s3, 131072
  s_cselect_b32 s92, 4, s92
  s_cbranch_scc1 L_vk_5
  s_sleep 8
  s_and_b32 s90, s90, 0xff
  s_cmp_lg_u32 s90, 0xff
  s_cbranch_scc1 L_vw_3
  s_cmp_lt_u32 s93, 128
  s_cbranch_scc1 L_vw_3
L_vk_5:
  v_mov_b32 v251, s92
  v_mov_b32 v250, 147456
  ds_write_b32 v250, v251
  s_waitcnt lgkmcnt(0)
L_vd_4:
  s_barrier
  v_mov_b32 v250, 147456
  ds_read_b32 v251, v250
  s_waitcnt lgkmcnt(0)
  v_readfirstlane_b32 s92, v251
  s_barrier
  s_cmp_eq_u32 s92, 3
  s_cbranch_scc1 L_fallback
  s_cmp_eq_u32 s92, 4
  s_cbranch_scc1 L_exit
  s_mov_b32 s39, 1
L_vok:
  s_barrier
  s_cmp_lg_u32 s32, 0
  s_cbranch_scc1 L_sig_6
  v_mov_b32 v254, s63
  v_mov_b32 v255, 0
  v_and_b32 v254, 3, v254
  v_mbcnt_lo_u32_b32 v255, -1, 0
  v_lshlrev_b32 v255, 9, v255
  s_cmp_ge_u32 s63, 2
  s_cselect_b64 exec, 3, 1
  buffer_atomic_add v254, v255, s[4:7], s62 offen offset:0 sc1
  s_mov_b64 exec, -1
L_sig_6:
L_epid:
  s_mov_b32 s59, 0
  s_cmp_eq_u32 s58, 1
  s_cbranch_scc1 L_r1
  s_cmp_eq_u32 s58, 2
  s_cbranch_scc1 L_r2
  s_cmp_eq_u32 s58, 3
  s_cbranch_scc1 L_next
  s_cmp_eq_u32 s35, 4
  s_cbranch_scc1 L_atb
  s_cmp_eq_u32 s35, 5
  s_cbranch_scc1 L_bo
  s_cmp_eq_u32 s35, 6
  s_cbranch_scc1 L_ata
  s_cmp_eq_u32 s35, 11
  s_cbranch_scc1 L_ata4
  s_cmp_eq_u32 s35, 7
  s_cbranch_scc1 L_ao
  s_cmp_eq_u32 s35, 8
  s_cbranch_scc1 L_aos
  s_cmp_eq_u32 s35, 12
  s_cbranch_scc1 L_swp
  s_cmp_eq_u32 s35, 14
  s_cbranch_scc1 L_ao4
  s_cmp_eq_u32 s35, 16
  s_cbranch_scc1 L_ao
  s_cmp_eq_u32 s35, 17
  s_cbranch_scc1 L_bo
  s_branch L_exit
L_aqkv:
  s_mov_b32 s8, s64
  s_and_b32 s9, s65, 0xffff
  s_mov_b32 s10, 0x400000
  s_mov_b32 s11, 0x20000
  s_cmp_eq_u32 s35, 0
  s_cselect_b64 s[88:89], s[68:69], s[70:71]
  s_cmp_eq_u32 s35, 2
  s_cselect_b64 s[88:89], s[72:73], s[88:89]
  s_mov_b32 s12, s88
  s_and_b32 s13, s89, 0xffff
  s_mov_b32 s14, 0x800000
  s_mov_b32 s15, 0x20000
  s_lshl_b32 s91, s33, 2
  s_add_u32 s91, s91, s37
  s_mov_b32 s24, 8192
  s_mov_b32 s26, 262144
  s_lshl_b32 s20, s36, 19
  s_lshl_b32 s21, s91, 9
  s_lshl_b32 s22, s35, 24
  s_lshl_b32 s90, s36, 21
  s_add_u32 s22, s22, s90
  s_lshl_b32 s90, s91, 14
  s_add_u32 s22, s22, s90
  s_lshl_b32 s38, s36, 9
  s_add_u32 s38, s38, 28672
  s_cmp_eq_u32 s35, 0
  s_cselect_b32 s38, 8192, s38
  s_cselect_b32 s98, 1, 2
  s_mov_b32 s48, s35
  s_branch L_g1
L_bqkv:
  s_mov_b32 s8, s78
  s_and_b32 s9, s79, 0xffff
  s_mov_b32 s10, 0x400000
  s_mov_b32 s11, 0x20000
  s_mov_b32 s12, s80
  s_and_b32 s13, s81, 0xffff
  s_mov_b32 s14, 0x600000
  s_mov_b32 s15, 0x20000
  s_lshl_b32 s91, s37, 2
  s_add_u32 s91, s91, s33
  s_mov_b32 s24, 6144
  s_mov_b32 s26, 65536
  s_lshl_b32 s20, s36, 19
  s_lshl_b32 s21, s91, 9
  s_lshl_b32 s22, s37, 22
  s_lshl_b32 s90, s36, 19
  s_add_u32 s22, s22, s90
  s_lshl_b32 s90, s33, 14
  s_add_u32 s22, s22, s90
  s_add_u32 s22, s22, 0x4000000
  s_mov_b32 s38, 12288
  s_mov_b32 s48, s37
  s_mov_b32 s98, 1
L_g1:
  s_lshl_b32 s90, s36, 9
  s_add_u32 s38, s38, s90
  s_lshl_b32 s90, s33, 7
  s_add_u32 s38, s38, s90
  s_mov_b32 s23, 2048
  s_mov_b32 s25, 8
  v_and_b32 v1, 63, v0
  v_lshrrev_b32 v38, 6, v0
  s_nop 0
  v_readfirstlane_b32 s27, v38
  s_mul_i32 s90, s27, 64
  v_lshrrev_b32 v38, 3, v1
  v_add_u32 v38, s90, v38
  v_mul_lo_u32 v38, v38, s23
  v_lshrrev_b32 v39, 4, v1
  v_xor_b32 v39, v39, v1
  v_and_b32 v39, 7, v39
  v_lshl_add_u32 v2, v39, 4, v38
  s_mul_i32 s91, s23, 8
  v_add_u32 v3, s91, v2
  v_xor_b32 v3, 64, v3
  v_add_u32 v4, s91, v3
  v_xor_b32 v4, 64, v4
  v_add_u32 v5, s91, v4
  v_xor_b32 v5, 64, v5
  v_add_u32 v6, s91, v5
  v_xor_b32 v6, 64, v6
  v_add_u32 v7, s91, v6
  v_xor_b32 v7, 64, v7
  v_add_u32 v8, s91, v7
  v_xor_b32 v8, 64, v8
  v_add_u32 v9, s91, v8
  v_xor_b32 v9, 64, v9
  s_mul_i32 s90, s27, 16
  v_lshrrev_b32 v38, 5, v1
  v_add_u32 v38, 0, v38
  v_add_u32 v38, s90, v38
  v_mov_b32 v174, v38
  v_and_b32 v39, 3, v38
  v_lshlrev_b32 v39, 1, v39
  v_and_b32 v40, 8, v38
  v_or_b32 v39, v39, v40
  v_xor_b32 v39, v39, v1
  v_and_b32 v39, 31, v39
  v_mul_lo_u32 v38, v38, s24
  v_lshl_add_u32 v10, v39, 4, v38
  v_lshrrev_b32 v38, 5, v1
  v_add_u32 v38, 2, v38
  v_add_u32 v38, s90, v38
  v_and_b32 v39, 3, v38
  v_lshlrev_b32 v39, 1, v39
  v_and_b32 v40, 8, v38
  v_or_b32 v39, v39, v40
  v_xor_b32 v39, v39, v1
  v_and_b32 v39, 31, v39
  v_mul_lo_u32 v38, v38, s24
  v_lshl_add_u32 v11, v39, 4, v38
  v_lshrrev_b32 v38, 5, v1
  v_add_u32 v38, 4, v38
  v_add_u32 v38, s90, v38
  v_and_b32 v39, 3, v38
  v_lshlrev_b32 v39, 1, v39
  v_and_b32 v40, 8, v38
  v_or_b32 v39, v39, v40
  v_xor_b32 v39, v39, v1
  v_and_b32 v39, 31, v39
  v_mul_lo_u32 v38, v38, s24
  v_lshl_add_u32 v12, v39, 4, v38
  v_lshrrev_b32 v38, 5, v1
  v_add_u32 v38, 6, v38
  v_add_u32 v38, s90, v38
  v_and_b32 v39, 3, v38
  v_lshlrev_b32 v39, 1, v39
  v_and_b32 v40, 8, v38
  v_or_b32 v39, v39, v40
  v_xor_b32 v39, v39, v1
  v_and_b32 v39, 31, v39
  v_mul_lo_u32 v38, v38, s24
  v_lshl_add_u32 v13, v39, 4, v38
  v_lshrrev_b32 v38, 5, v1
  v_add_u32 v38, 8, v38
  v_add_u32 v38, s90, v38
  v_and_b32 v39, 3, v38
  v_lshlrev_b32 v39, 1, v39
  v_and_b32 v40, 8, v38
  v_or_b32 v39, v39, v40
  v_xor_b32 v39, v39, v1
  v_and_b32 v39, 31, v39
  v_mul_lo_u32 v38, v38, s24
  v_lshl_add_u32 v14, v39, 4, v38
  v_lshrrev_b32 v38, 5, v1
  v_add_u32 v38, 10, v38
  v_add_u32 v38, s90, v38
  v_and_b32 v39, 3, v38
  v_lshlrev_b32 v39, 1, v39
  v_and_b32 v40, 8, v38
  v_or_b32 v39, v39, v40
  v_xor_b32 v39, v39, v1
  v_and_b32 v39, 31, v39
  v_mul_lo_u32 v38, v38, s24
  v_lshl_add_u32 v15, v39, 4, v38
  v_lshrrev_b32 v38, 5, v1
  v_add_u32 v38, 12, v38
  v_add_u32 v38, s90, v38
  v_and_b32 v39, 3, v38
  v_lshlrev_b32 v39, 1, v39
  v_and_b32 v40, 8, v38
  v_or_b32 v39, v39, v40
  v_xor_b32 v39, v39, v1
  v_and_b32 v39, 31, v39
  v_mul_lo_u32 v38, v38, s24
  v_lshl_add_u32 v16, v39, 4, v38
  v_lshrrev_b32 v38, 5, v1
  v_add_u32 v38, 14, v38
  v_add_u32 v38, s90, v38
  v_and_b32 v39, 3, v38
  v_lshlrev_b32 v39, 1, v39
  v_and_b32 v40, 8, v38
  v_or_b32 v39, v39, v40
  v_xor_b32 v39, v39, v1
  v_and_b32 v39, 31, v39
  v_mul_lo_u32 v38, v38, s24
  v_lshl_add_u32 v17, v39, 4, v38
  s_mul_i32 s51, s24, 64
  s_mul_i32 s52, s27, 8192
  s_mul_i32 s53, s27, 8192
  s_add_u32 s53, s53, 32768
  s_add_u32 m0, s52, 0
  s_nop 0
  buffer_load_dwordx4 v2, s[8:11], s20 offen  lds
  s_add_u32 m0, s53, 0
  s_nop 0
  buffer_load_dwordx4 v10, s[12:15], s21 offen  lds
  s_add_u32 m0, s52, 1024
  s_nop 0
  buffer_load_dwordx4 v3, s[8:11], s20 offen  lds
  s_add_u32 m0, s53, 1024
  s_nop 0
  buffer_load_dwordx4 v11, s[12:15], s21 offen  lds
  s_add_u32 m0, s52, 2048
  s_nop 0
  buffer_load_dwordx4 v4, s[8:11], s20 offen  lds
  s_add_u32 m0, s53, 2048
  s_nop 0
  buffer_load_dwordx4 v12, s[12:15], s21 offen  lds
  s_add_u32 m0, s52, 3072
  s_nop 0
  buffer_load_dwordx4 v5, s[8:11], s20 offen  lds
  s_add_u32 m0, s53, 3072
  s_nop 0
  buffer_load_dwordx4 v13, s[12:15], s21 offen  lds
  s_add_u32 m0, s52, 4096
  s_nop 0
  buffer_load_dwordx4 v6, s[8:11], s20 offen  lds
  s_add_u32 m0, s53, 4096
  s_nop 0
  buffer_load_dwordx4 v14, s[12:15], s21 offen  lds
  s_add_u32 m0, s52, 5120
  s_nop 0
  buffer_load_dwordx4 v7, s[8:11], s20 offen  lds
  s_add_u32 m0, s53, 5120
  s_nop 0
  buffer_load_dwordx4 v15, s[12:15], s21 offen  lds
  s_add_u32 m0, s52, 6144
  s_nop 0
  buffer_load_dwordx4 v8, s[8:11], s20 offen  lds
  s_add_u32 m0, s53, 6144
  s_nop 0
  buffer_load_dwordx4 v16, s[12:15], s21 offen  lds
  s_add_u32 m0, s52, 7168
  s_nop 0
  buffer_load_dwordx4 v9, s[8:11], s20 offen  lds
  s_add_u32 m0, s53, 7168
  s_nop 0
  buffer_load_dwordx4 v17, s[12:15], s21 offen  lds
  s_add_u32 s20, s20, 128
  s_add_u32 s21, s21, s51
  s_add_u32 m0, s52, 65536
  s_nop 0
  buffer_load_dwordx4 v2, s[8:11], s20 offen  lds
  s_add_u32 m0, s53, 65536
  s_nop 0
  buffer_load_dwordx4 v10, s[12:15], s21 offen  lds
  s_add_u32 m0, s52, 66560
  s_nop 0
  buffer_load_dwordx4 v3, s[8:11], s20 offen  lds
  s_add_u32 m0, s53, 66560
  s_nop 0
  buffer_load_dwordx4 v11, s[12:15], s21 offen  lds
  s_add_u32 m0, s52, 67584
  s_nop 0
  buffer_load_dwordx4 v4, s[8:11], s20 offen  lds
  s_add_u32 m0, s53, 67584
  s_nop 0
  buffer_load_dwordx4 v12, s[12:15], s21 offen  lds
  s_add_u32 m0, s52, 68608
  s_nop 0
  buffer_load_dwordx4 v5, s[8:11], s20 offen  lds
  s_add_u32 m0, s53, 68608
  s_nop 0
  buffer_load_dwordx4 v13, s[12:15], s21 offen  lds
  s_add_u32 m0, s52, 69632
  s_nop 0
  buffer_load_dwordx4 v6, s[8:11], s20 offen  lds
  s_add_u32 m0, s53, 69632
  s_nop 0
  buffer_load_dwordx4 v14, s[12:15], s21 offen  lds
  s_add_u32 m0, s52, 70656
  s_nop 0
  buffer_load_dwordx4 v7, s[8:11], s20 offen  lds
  s_add_u32 m0, s53, 70656
  s_nop 0
  buffer_load_dwordx4 v15, s[12:15], s21 offen  lds
  s_add_u32 m0, s52, 71680
  s_nop 0
  buffer_load_dwordx4 v8, s[8:11], s20 offen  lds
  s_add_u32 m0, s53, 71680
  s_nop 0
  buffer_load_dwordx4 v16, s[12:15], s21 offen  lds
  s_add_u32 m0, s52, 72704
  s_nop 0
  buffer_load_dwordx4 v9, s[8:11], s20 offen  lds
  s_add_u32 m0, s53, 72704
  s_nop 0
  buffer_load_dwordx4 v17, s[12:15], s21 offen  lds
  s_add_u32 s20, s20, 128
  s_add_u32 s21, s21, s51
  s_lshr_b32 s90, s27, 1
  s_and_b32 s91, s27, 1
  s_mul_i32 s92, s90, 16384
  v_mov_b32 v38, 0x0
  v_bfe_u32 v39, v1, 0, 4
  v_lshl_add_u32 v38, v39, 7, v38
  v_add_u32 v38, s92, v38
  v_lshrrev_b32 v39, 1, v1
  v_and_b32 v39, 7, v39
  v_lshrrev_b32 v40, 4, v1
  v_xor_b32 v39, v39, v40
  v_lshl_add_u32 v18, v39, 4, v38
  v_xor_b32 v19, 64, v18
  v_add_u32 v20, 65536, v18
  v_add_u32 v21, 65536, v19
  v_mov_b32 v38, 0x0
  v_bfe_u32 v39, v1, 2, 2
  v_lshl_add_u32 v38, v39, 9, v38
  v_bfe_u32 v39, v1, 4, 2
  v_lshl_add_u32 v38, v39, 12, v38
  v_bfe_u32 v39, v1, 0, 2
  v_lshl_add_u32 v38, v39, 3, v38
  v_bfe_u32 v40, v1, 2, 3
  s_mul_i32 s92, s91, 8
  s_add_u32 s93, s92, 0
  v_xor_b32 v39, s93, v40
  v_lshl_add_u32 v22, v39, 5, v38
  v_add_u32 v30, 65536, v22
  s_add_u32 s93, s92, 1
  v_xor_b32 v39, s93, v40
  v_lshl_add_u32 v23, v39, 5, v38
  v_add_u32 v31, 65536, v23
  s_add_u32 s93, s92, 2
  v_xor_b32 v39, s93, v40
  v_lshl_add_u32 v24, v39, 5, v38
  v_add_u32 v32, 65536, v24
  s_add_u32 s93, s92, 3
  v_xor_b32 v39, s93, v40
  v_lshl_add_u32 v25, v39, 5, v38
  v_add_u32 v33, 65536, v25
  s_add_u32 s93, s92, 4
  v_xor_b32 v39, s93, v40
  v_lshl_add_u32 v26, v39, 5, v38
  v_add_u32 v34, 65536, v26
  s_add_u32 s93, s92, 5
  v_xor_b32 v39, s93, v40
  v_lshl_add_u32 v27, v39, 5, v38
  v_add_u32 v35, 65536, v27
  s_add_u32 s93, s92, 6
  v_xor_b32 v39, s93, v40
  v_lshl_add_u32 v28, v39, 5, v38
  v_add_u32 v36, 65536, v28
  s_add_u32 s93, s92, 7
  v_xor_b32 v39, s93, v40
  v_lshl_add_u32 v29, v39, 5, v38
  v_add_u32 v37, 65536, v29
  v_mov_b32 v241, 147456
  v_lshrrev_b32 v175, 4, v0
  v_add_u32 v175, v175, v241
  s_mov_b32 s58, 1
  s_branch L_epi
L_r1:
  s_cmp_eq_u32 s49, 1
  s_cbranch_scc1 L_r1c
  s_waitcnt vmcnt(16)
L_r1c:
  s_cmp_eq_u32 s48, 2
  s_cbranch_scc1 L_g2
  s_waitcnt vmcnt(16)
  s_barrier
  ds_read_b128 v[44:47], v18 offset:0
  ds_read_b64_tr_b16 v[108:109], v22 offset:32768
  ds_read_b64_tr_b16 v[110:111], v22 offset:34816
  ds_read_b128 v[48:51], v18 offset:2048
  ds_read_b64_tr_b16 v[112:113], v23 offset:32768
  ds_read_b64_tr_b16 v[114:115], v23 offset:34816
  ds_read_b128 v[52:55], v18 offset:4096
  ds_read_b64_tr_b16 v[116:117], v24 offset:32768
  ds_read_b64_tr_b16 v[118:119], v24 offset:34816
  ds_read_b128 v[56:59], v18 offset:6144
  ds_read_b64_tr_b16 v[120:121], v25 offset:32768
  ds_read_b64_tr_b16 v[122:123], v25 offset:34816
  ds_read_b128 v[60:63], v18 offset:8192
  ds_read_b64_tr_b16 v[124:125], v26 offset:32768
  ds_read_b64_tr_b16 v[126:127], v26 offset:34816
  ds_read_b128 v[64:67], v18 offset:10240
  ds_read_b64_tr_b16 v[128:129], v27 offset:32768
  ds_read_b64_tr_b16 v[130:131], v27 offset:34816
  ds_read_b128 v[68:71], v18 offset:12288
  ds_read_b64_tr_b16 v[132:133], v28 offset:32768
  ds_read_b64_tr_b16 v[134:135], v28 offset:34816
  ds_read_b128 v[72:75], v18 offset:14336
  ds_read_b64_tr_b16 v[136:137], v29 offset:32768
  ds_read_b64_tr_b16 v[138:139], v29 offset:34816
  s_sub_u32 s25, s25, 1
  s_waitcnt lgkmcnt(0)
  s_nop 0
  v_mfma_f32_16x16x32_bf16 a[0:3], v[108:111], v[44:47], 0
  buffer_store_dwordx4 v[176:179], v172, s[4:7], s46 offen offset:0 sc1
  ds_read_b128 v[76:79], v19 offset:0
  v_mfma_f32_16x16x32_bf16 a[4:7], v[112:115], v[44:47], 0
  v_mfma_f32_16x16x32_bf16 a[8:11], v[116:119], v[44:47], 0
  ds_read_b64_tr_b16 v[140:141], v22 offset:49152
  v_mfma_f32_16x16x32_bf16 a[12:15], v[120:123], v[44:47], 0
  s_nop 0
  v_mfma_f32_16x16x32_bf16 a[16:19], v[124:127], v[44:47], 0
  buffer_store_dwordx4 v[180:183], v172, s[4:7], s46 offen offset:1024 sc1
  ds_read_b64_tr_b16 v[142:143], v22 offset:51200
  v_mfma_f32_16x16x32_bf16 a[20:23], v[128:131], v[44:47], 0
  v_mfma_f32_16x16x32_bf16 a[24:27], v[132:135], v[44:47], 0
  ds_read_b128 v[80:83], v19 offset:2048
  v_mfma_f32_16x16x32_bf16 a[28:31], v[136:139], v[44:47], 0
  s_nop 0
  v_mfma_f32_16x16x32_bf16 a[32:35], v[108:111], v[48:51], 0
  buffer_store_dwordx4 v[184:187], v172, s[4:7], s46 offen offset:2048 sc1
  ds_read_b64_tr_b16 v[144:145], v23 offset:49152
  v_mfma_f32_16x16x32_bf16 a[36:39], v[112:115], v[48:51], 0
  v_mfma_f32_16x16x32_bf16 a[40:43], v[116:119], v[48:51], 0
  ds_read_b64_tr_b16 v[146:147], v23 offset:51200
  v_mfma_f32_16x16x32_bf16 a[44:47], v[120:123], v[48:51], 0
  s_nop 0
  v_mfma_f32_16x16x32_bf16 a[48:51], v[124:127], v[48:51], 0
  buffer_store_dwordx4 v[188:191], v172, s[4:7], s46 offen offset:3072 sc1
  ds_read_b128 v[84:87], v19 offset:4096
  v_mfma_f32_16x16x32_bf16 a[52:55], v[128:131], v[48:51], 0
  v_mfma_f32_16x16x32_bf16 a[56:59], v[132:135], v[48:51], 0
  ds_read_b64_tr_b16 v[148:149], v24 offset:49152
  v_mfma_f32_16x16x32_bf16 a[60:63], v[136:139], v[48:51], 0
  s_nop 0
  v_mfma_f32_16x16x32_bf16 a[64:67], v[108:111], v[52:55], 0
  buffer_store_dwordx4 v[192:195], v173, s[4:7], s46 offen offset:0 sc1
  ds_read_b64_tr_b16 v[150:151], v24 offset:51200
  v_mfma_f32_16x16x32_bf16 a[68:71], v[112:115], v[52:55], 0
  v_mfma_f32_16x16x32_bf16 a[72:75], v[116:119], v[52:55], 0
  ds_read_b128 v[88:91], v19 offset:6144
  v_mfma_f32_16x16x32_bf16 a[76:79], v[120:123], v[52:55], 0
  s_nop 0
  v_mfma_f32_16x16x32_bf16 a[80:83], v[124:127], v[52:55], 0
  buffer_store_dwordx4 v[196:199], v173, s[4:7], s46 offen offset:1024 sc1
  ds_read_b64_tr_b16 v[152:153], v25 offset:49152
  v_mfma_f32_16x16x32_bf16 a[84:87], v[128:131], v[52:55], 0
  v_mfma_f32_16x16x32_bf16 a[88:91], v[132:135], v[52:55], 0
  ds_read_b64_tr_b16 v[154:155], v25 offset:51200
  v_mfma_f32_16x16x32_bf16 a[92:95], v[136:139], v[52:55], 0
  s_nop 0
  v_mfma_f32_16x16x32_bf16 a[96:99], v[108:111], v[56:59], 0
  buffer_store_dwordx4 v[200:203], v173, s[4:7], s46 offen offset:2048 sc1
  ds_read_b128 v[92:95], v19 offset:8192
  v_mfma_f32_16x16x32_bf16 a[100:103], v[112:115], v[56:59], 0
  v_mfma_f32_16x16x32_bf16 a[104:107], v[116:119], v[56:59], 0
  ds_read_b64_tr_b16 v[156:157], v26 offset:49152
  v_mfma_f32_16x16x32_bf16 a[108:111], v[120:123], v[56:59], 0
  s_nop 0
  v_mfma_f32_16x16x32_bf16 a[112:115], v[124:127], v[56:59], 0
  buffer_store_dwordx4 v[204:207], v173, s[4:7], s46 offen offset:3072 sc1
  ds_read_b64_tr_b16 v[158:159], v26 offset:51200
  v_mfma_f32_16x16x32_bf16 a[116:119], v[128:131], v[56:59], 0
  v_mfma_f32_16x16x32_bf16 a[120:123], v[132:135], v[56:59], 0
  ds_read_b128 v[96:99], v19 offset:10240
  v_mfma_f32_16x16x32_bf16 a[124:127], v[136:139], v[56:59], 0
  s_nop 0
  v_mfma_f32_16x16x32_bf16 a[128:131], v[108:111], v[60:63], 0
  buffer_store_dwordx4 v[208:211], v172, s[4:7], s47 offen offset:0 sc1
  ds_read_b64_tr_b16 v[160:161], v27 offset:49152
  v_mfma_f32_16x16x32_bf16 a[132:135], v[112:115], v[60:63], 0
  v_mfma_f32_16x16x32_bf16 a[136:139], v[116:119], v[60:63], 0
  ds_read_b64_tr_b16 v[162:163], v27 offset:51200
  v_mfma_f32_16x16x32_bf16 a[140:143], v[120:123], v[60:63], 0
  s_nop 0
  v_mfma_f32_16x16x32_bf16 a[144:147], v[124:127], v[60:63], 0
  buffer_store_dwordx4 v[212:215], v172, s[4:7], s47 offen offset:1024 sc1
  ds_read_b128 v[100:103], v19 offset:12288
  v_mfma_f32_16x16x32_bf16 a[148:151], v[128:131], v[60:63], 0
  v_mfma_f32_16x16x32_bf16 a[152:155], v[132:135], v[60:63], 0
  ds_read_b64_tr_b16 v[164:165], v28 offset:49152
  v_mfma_f32_16x16x32_bf16 a[156:159], v[136:139], v[60:63], 0
  s_nop 0
  v_mfma_f32_16x16x32_bf16 a[160:163], v[108:111], v[64:67], 0
  buffer_store_dwordx4 v[216:219], v172, s[4:7], s47 offen offset:2048 sc1
  ds_read_b64_tr_b16 v[166:167], v28 offset:51200
  v_mfma_f32_16x16x32_bf16 a[164:167], v[112:115], v[64:67], 0
  v_mfma_f32_16x16x32_bf16 a[168:171], v[116:119], v[64:67], 0
  ds_read_b128 v[104:107], v19 offset:14336
  v_mfma_f32_16x16x32_bf16 a[172:175], v[120:123], v[64:67], 0
  s_nop 0
  v_mfma_f32_16x16x32_bf16 a[176:179], v[124:127], v[64:67], 0
  buffer_store_dwordx4 v[220:223], v172, s[4:7], s47 offen offset:3072 sc1
  ds_read_b64_tr_b16 v[168:169], v29 offset:49152
  v_mfma_f32_16x16x32_bf16 a[180:183], v[128:131], v[64:67], 0
  v_mfma_f32_16x16x32_bf16 a[184:187], v[132:135], v[64:67], 0
  ds_read_b64_tr_b16 v[170:171], v29 offset:51200
  v_mfma_f32_16x16x32_bf16 a[188:191], v[136:139], v[64:67], 0
  s_nop 0
  v_mfma_f32_16x16x32_bf16 a[192:195], v[108:111], v[68:71], 0
  buffer_store_dwordx4 v[224:227], v173, s[4:7], s47 offen offset:0 sc1
  v_mfma_f32_16x16x32_bf16 a[196:199], v[112:115], v[68:71], 0
  v_mfma_f32_16x16x32_bf16 a[200:203], v[116:119], v[68:71], 0
  v_mfma_f32_16x16x32_bf16 a[204:207], v[120:123], v[68:71], 0
  s_nop 0
  v_mfma_f32_16x16x32_bf16 a[208:211], v[124:127], v[68:71], 0
  buffer_store_dwordx4 v[228:231], v173, s[4:7], s47 offen offset:1024 sc1
  v_mfma_f32_16x16x32_bf16 a[212:215], v[128:131], v[68:71], 0
  v_mfma_f32_16x16x32_bf16 a[216:219], v[132:135], v[68:71], 0
  v_mfma_f32_16x16x32_bf16 a[220:223], v[136:139], v[68:71], 0
  s_nop 0
  v_mfma_f32_16x16x32_bf16 a[224:227], v[108:111], v[72:75], 0
  buffer_store_dwordx4 v[232:235], v173, s[4:7], s47 offen offset:2048 sc1
  v_mfma_f32_16x16x32_bf16 a[228:231], v[112:115], v[72:75], 0
  v_mfma_f32_16x16x32_bf16 a[232:235], v[116:119], v[72:75], 0
  v_mfma_f32_16x16x32_bf16 a[236:239], v[120:123], v[72:75], 0
  s_nop 0
  v_mfma_f32_16x16x32_bf16 a[240:243], v[124:127], v[72:75], 0
  buffer_store_dwordx4 v[236:239], v173, s[4:7], s47 offen offset:3072 sc1
  v_mfma_f32_16x16x32_bf16 a[244:247], v[128:131], v[72:75], 0
  v_mfma_f32_16x16x32_bf16 a[248:251], v[132:135], v[72:75], 0
  v_mfma_f32_16x16x32_bf16 a[252:255], v[136:139], v[72:75], 0
  s_waitcnt lgkmcnt(0)
  v_mfma_f32_16x16x32_bf16 a[0:3], v[140:143], v[76:79], a[0:3]
  s_waitcnt vmcnt(16)
  s_barrier
  s_add_u32 m0, s52, 0
  v_mfma_f32_16x16x32_bf16 a[4:7], v[144:147], v[76:79], a[4:7]
  buffer_load_dwordx4 v2, s[8:11], s20 offen  lds
  ds_read_b128 v[44:47], v20 offset:0
  v_mfma_f32_16x16x32_bf16 a[8:11], v[148:151], v[76:79], a[8:11]
  v_mfma_f32_16x16x32_bf16 a[12:15], v[152:155], v[76:79], a[12:15]
  ds_read_b64_tr_b16 v[108:109], v30 offset:32768
  s_add_u32 m0, s53, 0
  v_mfma_f32_16x16x32_bf16 a[16:19], v[156:159], v[76:79], a[16:19]
  buffer_load_dwordx4 v10, s[12:15], s21 offen  lds
  v_mfma_f32_16x16x32_bf16 a[20:23], v[160:163], v[76:79], a[20:23]
  ds_read_b64_tr_b16 v[110:111], v30 offset:34816
  v_mfma_f32_16x16x32_bf16 a[24:27], v[164:167], v[76:79], a[24:27]
  v_mfma_f32_16x16x32_bf16 a[28:31], v[168:171], v[76:79], a[28:31]
  ds_read_b128 v[48:51], v20 offset:2048
  s_add_u32 m0, s52, 1024
  v_mfma_f32_16x16x32_bf16 a[32:35], v[140:143], v[80:83], a[32:35]
  buffer_load_dwordx4 v3, s[8:11], s20 offen  lds
  v_mfma_f32_16x16x32_bf16 a[36:39], v[144:147], v[80:83], a[36:39]
  ds_read_b64_tr_b16 v[112:113], v31 offset:32768
  v_mfma_f32_16x16x32_bf16 a[40:43], v[148:151], v[80:83], a[40:43]
  v_mfma_f32_16x16x32_bf16 a[44:47], v[152:155], v[80:83], a[44:47]
  ds_read_b64_tr_b16 v[114:115], v31 offset:34816
  s_add_u32 m0, s53, 1024
  v_mfma_f32_16x16x32_bf16 a[48:51], v[156:159], v[80:83], a[48:51]
  buffer_load_dwordx4 v11, s[12:15], s21 offen  lds
  v_mfma_f32_16x16x32_bf16 a[52:55], v[160:163], v[80:83], a[52:55]
  ds_read_b128 v[52:55], v20 offset:4096
  v_mfma_f32_16x16x32_bf16 a[56:59], v[164:167], v[80:83], a[56:59]
  s_add_u32 m0, s52, 2048
  v_mfma_f32_16x16x32_bf16 a[60:63], v[168:171], v[80:83], a[60:63]
  buffer_load_dwordx4 v4, s[8:11], s20 offen  lds
  ds_read_b64_tr_b16 v[116:117], v32 offset:32768
  v_mfma_f32_16x16x32_bf16 a[64:67], v[140:143], v[84:87], a[64:67]
  v_mfma_f32_16x16x32_bf16 a[68:71], v[144:147], v[84:87], a[68:71]
  ds_read_b64_tr_b16 v[118:119], v32 offset:34816
  v_mfma_f32_16x16x32_bf16 a[72:75], v[148:151], v[84:87], a[72:75]
  s_add_u32 m0, s53, 2048
  v_mfma_f32_16x16x32_bf16 a[76:79], v[152:155], v[84:87], a[76:79]
  buffer_load_dwordx4 v12, s[12:15], s21 offen  lds
  ds_read_b128 v[56:59], v20 offset:6144
  v_mfma_f32_16x16x32_bf16 a[80:83], v[156:159], v[84:87], a[80:83]
  v_mfma_f32_16x16x32_bf16 a[84:87], v[160:163], v[84:87], a[84:87]
  ds_read_b64_tr_b16 v[120:121], v33 offset:32768
  v_mfma_f32_16x16x32_bf16 a[88:91], v[164:167], v[84:87], a[88:91]
  s_add_u32 m0, s52, 3072
  v_mfma_f32_16x16x32_bf16 a[92:95], v[168:171], v[84:87], a[92:95]
  buffer_load_dwordx4 v5, s[8:11], s20 offen  lds
  ds_read_b64_tr_b16 v[122:123], v33 offset:34816
  v_mfma_f32_16x16x32_bf16 a[96:99], v[140:143], v[88:91], a[96:99]
  v_mfma_f32_16x16x32_bf16 a[100:103], v[144:147], v[88:91], a[100:103]
  ds_read_b128 v[60:63], v20 offset:8192
  s_add_u32 m0, s53, 3072
  v_mfma_f32_16x16x32_bf16 a[104:107], v[148:151], v[88:91], a[104:107]
  buffer_load_dwordx4 v13, s[12:15], s21 offen  lds
  v_mfma_f32_16x16x32_bf16 a[108:111], v[152:155], v[88:91], a[108:111]
  ds_read_b64_tr_b16 v[124:125], v34 offset:32768
  v_mfma_f32_16x16x32_bf16 a[112:115], v[156:159], v[88:91], a[112:115]
  v_mfma_f32_16x16x32_bf16 a[116:119], v[160:163], v[88:91], a[116:119]
  ds_read_b64_tr_b16 v[126:127], v34 offset:34816
  s_add_u32 m0, s52, 4096
  v_mfma_f32_16x16x32_bf16 a[120:123], v[164:167], v[88:91], a[120:123]
  buffer_load_dwordx4 v6, s[8:11], s20 offen  lds
  v_mfma_f32_16x16x32_bf16 a[124:127], v[168:171], v[88:91], a[124:127]
  ds_read_b128 v[64:67], v20 offset:10240
  v_mfma_f32_16x16x32_bf16 a[128:131], v[140:143], v[92:95], a[128:131]
  v_mfma_f32_16x16x32_bf16 a[132:135], v[144:147], v[92:95], a[132:135]
  ds_read_b64_tr_b16 v[128:129], v35 offset:32768
  s_add_u32 m0, s53, 4096
  v_mfma_f32_16x16x32_bf16 a[136:139], v[148:151], v[92:95], a[136:139]
  buffer_load_dwordx4 v14, s[12:15], s21 offen  lds
  v_mfma_f32_16x16x32_bf16 a[140:143], v[152:155], v[92:95], a[140:143]
  ds_read_b64_tr_b16 v[130:131], v35 offset:34816
  v_mfma_f32_16x16x32_bf16 a[144:147], v[156:159], v[92:95], a[144:147]
  v_mfma_f32_16x16x32_bf16 a[148:151], v[160:163], v[92:95], a[148:151]
  ds_read_b128 v[68:71], v20 offset:12288
  s_add_u32 m0, s52, 5120
  v_mfma_f32_16x16x32_bf16 a[152:155], v[164:167], v[92:95], a[152:155]
  buffer_load_dwordx4 v7, s[8:11], s20 offen  lds
  v_mfma_f32_16x16x32_bf16 a[156:159], v[168:171], v[92:95], a[156:159]
  ds_read_b64_tr_b16 v[132:133], v36 offset:32768
  v_mfma_f32_16x16x32_bf16 a[160:163], v[140:143], v[96:99], a[160:163]
  s_add_u32 m0, s53, 5120
  v_mfma_f32_16x16x32_bf16 a[164:167], v[144:147], v[96:99], a[164:167]
  buffer_load_dwordx4 v15, s[12:15], s21 offen  lds
  ds_read_b64_tr_b16 v[134:135], v36 offset:34816
  v_mfma_f32_16x16x32_bf16 a[168:171], v[148:151], v[96:99], a[168:171]
  v_mfma_f32_16x16x32_bf16 a[172:175], v[152:155], v[96:99], a[172:175]
  ds_read_b128 v[72:75], v20 offset:14336
  v_mfma_f32_16x16x32_bf16 a[176:179], v[156:159], v[96:99], a[176:179]
  s_add_u32 m0, s52, 6144
  v_mfma_f32_16x16x32_bf16 a[180:183], v[160:163], v[96:99], a[180:183]
  buffer_load_dwordx4 v8, s[8:11], s20 offen  lds
  ds_read_b64_tr_b16 v[136:137], v37 offset:32768
  v_mfma_f32_16x16x32_bf16 a[184:187], v[164:167], v[96:99], a[184:187]
  v_mfma_f32_16x16x32_bf16 a[188:191], v[168:171], v[96:99], a[188:191]
  ds_read_b64_tr_b16 v[138:139], v37 offset:34816
  v_mfma_f32_16x16x32_bf16 a[192:195], v[140:143], v[100:103], a[192:195]
  s_add_u32 m0, s53, 6144
  v_mfma_f32_16x16x32_bf16 a[196:199], v[144:147], v[100:103], a[196:199]
  buffer_load_dwordx4 v16, s[12:15], s21 offen  lds
  v_mfma_f32_16x16x32_bf16 a[200:203], v[148:151], v[100:103], a[200:203]
  v_mfma_f32_16x16x32_bf16 a[204:207], v[152:155], v[100:103], a[204:207]
  s_add_u32 m0, s52, 7168
  v_mfma_f32_16x16x32_bf16 a[208:211], v[156:159], v[100:103], a[208:211]
  buffer_load_dwordx4 v9, s[8:11], s20 offen  lds
  v_mfma_f32_16x16x32_bf16 a[212:215], v[160:163], v[100:103], a[212:215]
  v_mfma_f32_16x16x32_bf16 a[216:219], v[164:167], v[100:103], a[216:219]
  v_mfma_f32_16x16x32_bf16 a[220:223], v[168:171], v[100:103], a[220:223]
  s_add_u32 m0, s53, 7168
  v_mfma_f32_16x16x32_bf16 a[224:227], v[140:143], v[104:107], a[224:227]
  buffer_load_dwordx4 v17, s[12:15], s21 offen  lds
  v_mfma_f32_16x16x32_bf16 a[228:231], v[144:147], v[104:107], a[228:231]
  v_mfma_f32_16x16x32_bf16 a[232:235], v[148:151], v[104:107], a[232:235]
  v_mfma_f32_16x16x32_bf16 a[236:239], v[152:155], v[104:107], a[236:239]
  s_add_u32 s20, s20, 128
  v_mfma_f32_16x16x32_bf16 a[240:243], v[156:159], v[104:107], a[240:243]
  s_add_u32 s21, s21, s51
  v_mfma_f32_16x16x32_bf16 a[244:247], v[160:163], v[104:107], a[244:247]
  v_mfma_f32_16x16x32_bf16 a[248:251], v[164:167], v[104:107], a[248:251]
  v_mfma_f32_16x16x32_bf16 a[252:255], v[168:171], v[104:107], a[252:255]
  s_waitcnt lgkmcnt(0)
  v_mfma_f32_16x16x32_bf16 a[0:3], v[108:111], v[44:47], a[0:3]
  ds_read_b128 v[76:79], v21 offset:0
  v_mfma_f32_16x16x32_bf16 a[4:7], v[112:115], v[44:47], a[4:7]
  v_mfma_f32_16x16x32_bf16 a[8:11], v[116:119], v[44:47], a[8:11]
  ds_read_b64_tr_b16 v[140:141], v30 offset:49152
  v_mfma_f32_16x16x32_bf16 a[12:15], v[120:123], v[44:47], a[12:15]
  v_mfma_f32_16x16x32_bf16 a[16:19], v[124:127], v[44:47], a[16:19]
  ds_read_b64_tr_b16 v[142:143], v30 offset:51200
  v_mfma_f32_16x16x32_bf16 a[20:23], v[128:131], v[44:47], a[20:23]
  v_mfma_f32_16x16x32_bf16 a[24:27], v[132:135], v[44:47], a[24:27]
  ds_read_b128 v[80:83], v21 offset:2048
  v_mfma_f32_16x16x32_bf16 a[28:31], v[136:139], v[44:47], a[28:31]
  v_mfma_f32_16x16x32_bf16 a[32:35], v[108:111], v[48:51], a[32:35]
  ds_read_b64_tr_b16 v[144:145], v31 offset:49152
  v_mfma_f32_16x16x32_bf16 a[36:39], v[112:115], v[48:51], a[36:39]
  v_mfma_f32_16x16x32_bf16 a[40:43], v[116:119], v[48:51], a[40:43]
  ds_read_b64_tr_b16 v[146:147], v31 offset:51200
  v_mfma_f32_16x16x32_bf16 a[44:47], v[120:123], v[48:51], a[44:47]
  v_mfma_f32_16x16x32_bf16 a[48:51], v[124:127], v[48:51], a[48:51]
  ds_read_b128 v[84:87], v21 offset:4096
  v_mfma_f32_16x16x32_bf16 a[52:55], v[128:131], v[48:51], a[52:55]
  v_mfma_f32_16x16x32_bf16 a[56:59], v[132:135], v[48:51], a[56:59]
  ds_read_b64_tr_b16 v[148:149], v32 offset:49152
  v_mfma_f32_16x16x32_bf16 a[60:63], v[136:139], v[48:51], a[60:63]
  v_mfma_f32_16x16x32_bf16 a[64:67], v[108:111], v[52:55], a[64:67]
  ds_read_b64_tr_b16 v[150:151], v32 offset:51200
  v_mfma_f32_16x16x32_bf16 a[68:71], v[112:115], v[52:55], a[68:71]
  v_mfma_f32_16x16x32_bf16 a[72:75], v[116:119], v[52:55], a[72:75]
  ds_read_b128 v[88:91], v21 offset:6144
  v_mfma_f32_16x16x32_bf16 a[76:79], v[120:123], v[52:55], a[76:79]
  v_mfma_f32_16x16x32_bf16 a[80:83], v[124:127], v[52:55], a[80:83]
  ds_read_b64_tr_b16 v[152:153], v33 offset:49152
  v_mfma_f32_16x16x32_bf16 a[84:87], v[128:131], v[52:55], a[84:87]
  v_mfma_f32_16x16x32_bf16 a[88:91], v[132:135], v[52:55], a[88:91]
  ds_read_b64_tr_b16 v[154:155], v33 offset:51200
  v_mfma_f32_16x16x32_bf16 a[92:95], v[136:139], v[52:55], a[92:95]
  v_mfma_f32_16x16x32_bf16 a[96:99], v[108:111], v[56:59], a[96:99]
  ds_read_b128 v[92:95], v21 offset:8192
  v_mfma_f32_16x16x32_bf16 a[100:103], v[112:115], v[56:59], a[100:103]
  v_mfma_f32_16x16x32_bf16 a[104:107], v[116:119], v[56:59], a[104:107]
  ds_read_b64_tr_b16 v[156:157], v34 offset:49152
  v_mfma_f32_16x16x32_bf16 a[108:111], v[120:123], v[56:59], a[108:111]
  v_mfma_f32_16x16x32_bf16 a[112:115], v[124:127], v[56:59], a[112:115]
  ds_read_b64_tr_b16 v[158:159], v34 offset:51200
  v_mfma_f32_16x16x32_bf16 a[116:119], v[128:131], v[56:59], a[116:119]
  v_mfma_f32_16x16x32_bf16 a[120:123], v[132:135], v[56:59], a[120:123]
  ds_read_b128 v[96:99], v21 offset:10240
  v_mfma_f32_16x16x32_bf16 a[124:127], v[136:139], v[56:59], a[124:127]
  v_mfma_f32_16x16x32_bf16 a[128:131], v[108:111], v[60:63], a[128:131]
  ds_read_b64_tr_b16 v[160:161], v35 offset:49152
  v_mfma_f32_16x16x32_bf16 a[132:135], v[112:115], v[60:63], a[132:135]
  v_mfma_f32_16x16x32_bf16 a[136:139], v[116:119], v[60:63], a[136:139]
  ds_read_b64_tr_b16 v[162:163], v35 offset:51200
  v_mfma_f32_16x16x32_bf16 a[140:143], v[120:123], v[60:63], a[140:143]
  v_mfma_f32_16x16x32_bf16 a[144:147], v[124:127], v[60:63], a[144:147]
  ds_read_b128 v[100:103], v21 offset:12288
  v_mfma_f32_16x16x32_bf16 a[148:151], v[128:131], v[60:63], a[148:151]
  v_mfma_f32_16x16x32_bf16 a[152:155], v[132:135], v[60:63], a[152:155]
  ds_read_b64_tr_b16 v[164:165], v36 offset:49152
  v_mfma_f32_16x16x32_bf16 a[156:159], v[136:139], v[60:63], a[156:159]
  v_mfma_f32_16x16x32_bf16 a[160:163], v[108:111], v[64:67], a[160:163]
  ds_read_b64_tr_b16 v[166:167], v36 offset:51200
  v_mfma_f32_16x16x32_bf16 a[164:167], v[112:115], v[64:67], a[164:167]
  v_mfma_f32_16x16x32_bf16 a[168:171], v[116:119], v[64:67], a[168:171]
  ds_read_b128 v[104:107], v21 offset:14336
  v_mfma_f32_16x16x32_bf16 a[172:175], v[120:123], v[64:67], a[172:175]
  v_mfma_f32_16x16x32_bf16 a[176:179], v[124:127], v[64:67], a[176:179]
  ds_read_b64_tr_b16 v[168:169], v37 offset:49152
  v_mfma_f32_16x16x32_bf16 a[180:183], v[128:131], v[64:67], a[180:183]
  v_mfma_f32_16x16x32_bf16 a[184:187], v[132:135], v[64:67], a[184:187]
  ds_read_b64_tr_b16 v[170:171], v37 offset:51200
  v_mfma_f32_16x16x32_bf16 a[188:191], v[136:139], v[64:67], a[188:191]
  v_mfma_f32_16x16x32_bf16 a[192:195], v[108:111], v[68:71], a[192:195]
  v_mfma_f32_16x16x32_bf16 a[196:199], v[112:115], v[68:71], a[196:199]
  v_mfma_f32_16x16x32_bf16 a[200:203], v[116:119], v[68:71], a[200:203]
  v_mfma_f32_16x16x32_bf16 a[204:207], v[120:123], v[68:71], a[204:207]
  v_mfma_f32_16x16x32_bf16 a[208:211], v[124:127], v[68:71], a[208:211]
  v_mfma_f32_16x16x32_bf16 a[212:215], v[128:131], v[68:71], a[212:215]
  v_mfma_f32_16x16x32_bf16 a[216:219], v[132:135], v[68:71], a[216:219]
  v_mfma_f32_16x16x32_bf16 a[220:223], v[136:139], v[68:71], a[220:223]
  v_mfma_f32_16x16x32_bf16 a[224:227], v[108:111], v[72:75], a[224:227]
  v_mfma_f32_16x16x32_bf16 a[228:231], v[112:115], v[72:75], a[228:231]
  v_mfma_f32_16x16x32_bf16 a[232:235], v[116:119], v[72:75], a[232:235]
  v_mfma_f32_16x16x32_bf16 a[236:239], v[120:123], v[72:75], a[236:239]
  v_mfma_f32_16x16x32_bf16 a[240:243], v[124:127], v[72:75], a[240:243]
  v_mfma_f32_16x16x32_bf16 a[244:247], v[128:131], v[72:75], a[244:247]
  v_mfma_f32_16x16x32_bf16 a[248:251], v[132:135], v[72:75], a[248:251]
  v_mfma_f32_16x16x32_bf16 a[252:255], v[136:139], v[72:75], a[252:255]
  s_waitcnt lgkmcnt(0)
  v_mfma_f32_16x16x32_bf16 a[0:3], v[140:143], v[76:79], a[0:3]
  s_waitcnt vmcnt(0)
  s_barrier
  s_cmp_eq_u32 s49, 0
  s_cbranch_scc1 L_hs_7
  s_cmp_lg_u32 s32, 0
  s_cbranch_scc1 L_sig_8
  v_mov_b32 v254, s63
  v_mov_b32 v255, 0
  v_and_b32 v254, 3, v254
  v_mbcnt_lo_u32_b32 v255, -1, 0
  v_lshlrev_b32 v255, 9, v255
  s_cmp_ge_u32 s63, 2
  s_cselect_b64 exec, 3, 1
  buffer_atomic_add v254, v255, s[4:7], s62 offen offset:0 sc1
  s_mov_b64 exec, -1
L_sig_8:
L_hs_7:
  s_add_u32 m0, s52, 65536
  v_mfma_f32_16x16x32_bf16 a[4:7], v[144:147], v[76:79], a[4:7]
  buffer_load_dwordx4 v2, s[8:11], s20 offen  lds
  ds_read_b128 v[44:47], v18 offset:0
  v_mfma_f32_16x16x32_bf16 a[8:11], v[148:151], v[76:79], a[8:11]
  v_mfma_f32_16x16x32_bf16 a[12:15], v[152:155], v[76:79], a[12:15]
  ds_read_b64_tr_b16 v[108:109], v22 offset:32768
  s_add_u32 m0, s53, 65536
  v_mfma_f32_16x16x32_bf16 a[16:19], v[156:159], v[76:79], a[16:19]
  buffer_load_dwordx4 v10, s[12:15], s21 offen  lds
  v_mfma_f32_16x16x32_bf16 a[20:23], v[160:163], v[76:79], a[20:23]
  ds_read_b64_tr_b16 v[110:111], v22 offset:34816
  v_mfma_f32_16x16x32_bf16 a[24:27], v[164:167], v[76:79], a[24:27]
  v_mfma_f32_16x16x32_bf16 a[28:31], v[168:171], v[76:79], a[28:31]
  ds_read_b128 v[48:51], v18 offset:2048
  s_add_u32 m0, s52, 66560
  v_mfma_f32_16x16x32_bf16 a[32:35], v[140:143], v[80:83], a[32:35]
  buffer_load_dwordx4 v3, s[8:11], s20 offen  lds
  v_mfma_f32_16x16x32_bf16 a[36:39], v[144:147], v[80:83], a[36:39]
  ds_read_b64_tr_b16 v[112:113], v23 offset:32768
  v_mfma_f32_16x16x32_bf16 a[40:43], v[148:151], v[80:83], a[40:43]
  v_mfma_f32_16x16x32_bf16 a[44:47], v[152:155], v[80:83], a[44:47]
  ds_read_b64_tr_b16 v[114:115], v23 offset:34816
  s_add_u32 m0, s53, 66560
  v_mfma_f32_16x16x32_bf16 a[48:51], v[156:159], v[80:83], a[48:51]
  buffer_load_dwordx4 v11, s[12:15], s21 offen  lds
  v_mfma_f32_16x16x32_bf16 a[52:55], v[160:163], v[80:83], a[52:55]
  ds_read_b128 v[52:55], v18 offset:4096
  v_mfma_f32_16x16x32_bf16 a[56:59], v[164:167], v[80:83], a[56:59]
  s_add_u32 m0, s52, 67584
  v_mfma_f32_16x16x32_bf16 a[60:63], v[168:171], v[80:83], a[60:63]
  buffer_load_dwordx4 v4, s[8:11], s20 offen  lds
  ds_read_b64_tr_b16 v[116:117], v24 offset:32768
  v_mfma_f32_16x16x32_bf16 a[64:67], v[140:143], v[84:87], a[64:67]
  v_mfma_f32_16x16x32_bf16 a[68:71], v[144:147], v[84:87], a[68:71]
  ds_read_b64_tr_b16 v[118:119], v24 offset:34816
  v_mfma_f32_16x16x32_bf16 a[72:75], v[148:151], v[84:87], a[72:75]
  s_add_u32 m0, s53, 67584
  v_mfma_f32_16x16x32_bf16 a[76:79], v[152:155], v[84:87], a[76:79]
  buffer_load_dwordx4 v12, s[12:15], s21 offen  lds
  ds_read_b128 v[56:59], v18 offset:6144
  v_mfma_f32_16x16x32_bf16 a[80:83], v[156:159], v[84:87], a[80:83]
  v_mfma_f32_16x16x32_bf16 a[84:87], v[160:163], v[84:87], a[84:87]
  ds_read_b64_tr_b16 v[120:121], v25 offset:32768
  v_mfma_f32_16x16x32_bf16 a[88:91], v[164:167], v[84:87], a[88:91]
  s_add_u32 m0, s52, 68608
  v_mfma_f32_16x16x32_bf16 a[92:95], v[168:171], v[84:87], a[92:95]
  buffer_load_dwordx4 v5, s[8:11], s20 offen  lds
  ds_read_b64_tr_b16 v[122:123], v25 offset:34816
  v_mfma_f32_16x16x32_bf16 a[96:99], v[140:143], v[88:91], a[96:99]
  v_mfma_f32_16x16x32_bf16 a[100:103], v[144:147], v[88:91], a[100:103]
  ds_read_b128 v[60:63], v18 offset:8192
  s_add_u32 m0, s53, 68608
  v_mfma_f32_16x16x32_bf16 a[104:107], v[148:151], v[88:91], a[104:107]
  buffer_load_dwordx4 v13, s[12:15], s21 offen  lds
  v_mfma_f32_16x16x32_bf16 a[108:111], v[152:155], v[88:91], a[108:111]
  ds_read_b64_tr_b16 v[124:125], v26 offset:32768
  v_mfma_f32_16x16x32_bf16 a[112:115], v[156:159], v[88:91], a[112:115]
  v_mfma_f32_16x16x32_bf16 a[116:119], v[160:163], v[88:91], a[116:119]
  ds_read_b64_tr_b16 v[126:127], v26 offset:34816
  s_add_u32 m0, s52, 69632
  v_mfma_f32_16x16x32_bf16 a[120:123], v[164:167], v[88:91], a[120:123]
  buffer_load_dwordx4 v6, s[8:11], s20 offen  lds
  v_mfma_f32_16x16x32_bf16 a[124:127], v[168:171], v[88:91], a[124:127]
  ds_read_b128 v[64:67], v18 offset:10240
  v_mfma_f32_16x16x32_bf16 a[128:131], v[140:143], v[92:95], a[128:131]
  v_mfma_f32_16x16x32_bf16 a[132:135], v[144:147], v[92:95], a[132:135]
  ds_read_b64_tr_b16 v[128:129], v27 offset:32768
  s_add_u32 m0, s53, 69632
  v_mfma_f32_16x16x32_bf16 a[136:139], v[148:151], v[92:95], a[136:139]
  buffer_load_dwordx4 v14, s[12:15], s21 offen  lds
  v_mfma_f32_16x16x32_bf16 a[140:143], v[152:155], v[92:95], a[140:143]
  ds_read_b64_tr_b16 v[130:131], v27 offset:34816
  v_mfma_f32_16x16x32_bf16 a[144:147], v[156:159], v[92:95], a[144:147]
  v_mfma_f32_16x16x32_bf16 a[148:151], v[160:163], v[92:95], a[148:151]
  ds_read_b128 v[68:71], v18 offset:12288
  s_add_u32 m0, s52, 70656
  v_mfma_f32_16x16x32_bf16 a[152:155], v[164:167], v[92:95], a[152:155]
  buffer_load_dwordx4 v7, s[8:11], s20 offen  lds
  v_mfma_f32_16x16x32_bf16 a[156:159], v[168:171], v[92:95], a[156:159]
  ds_read_b64_tr_b16 v[132:133], v28 offset:32768
  v_mfma_f32_16x16x32_bf16 a[160:163], v[140:143], v[96:99], a[160:163]
  s_add_u32 m0, s53, 70656
  v_mfma_f32_16x16x32_bf16 a[164:167], v[144:147], v[96:99], a[164:167]
  buffer_load_dwordx4 v15, s[12:15], s21 offen  lds
  ds_read_b64_tr_b16 v[134:135], v28 offset:34816
  v_mfma_f32_16x16x32_bf16 a[168:171], v[148:151], v[96:99], a[168:171]
  v_mfma_f32_16x16x32_bf16 a[172:175], v[152:155], v[96:99], a[172:175]
  ds_read_b128 v[72:75], v18 offset:14336
  v_mfma_f32_16x16x32_bf16 a[176:179], v[156:159], v[96:99], a[176:179]
  s_add_u32 m0, s52, 71680
  v_mfma_f32_16x16x32_bf16 a[180:183], v[160:163], v[96:99], a[180:183]
  buffer_load_dwordx4 v8, s[8:11], s20 offen  lds
  ds_read_b64_tr_b16 v[136:137], v29 offset:32768
  v_mfma_f32_16x16x32_bf16 a[184:187], v[164:167], v[96:99], a[184:187]
  v_mfma_f32_16x16x32_bf16 a[188:191], v[168:171], v[96:99], a[188:191]
  ds_read_b64_tr_b16 v[138:139], v29 offset:34816
  v_mfma_f32_16x16x32_bf16 a[192:195], v[140:143], v[100:103], a[192:195]
  s_add_u32 m0, s53, 71680
  v_mfma_f32_16x16x32_bf16 a[196:199], v[144:147], v[100:103], a[196:199]
  buffer_load_dwordx4 v16, s[12:15], s21 offen  lds
  v_mfma_f32_16x16x32_bf16 a[200:203], v[148:151], v[100:103], a[200:203]
  v_mfma_f32_16x16x32_bf16 a[204:207], v[152:155], v[100:103], a[204:207]
  s_add_u32 m0, s52, 72704
  v_mfma_f32_16x16x32_bf16 a[208:211], v[156:159], v[100:103], a[208:211]
  buffer_load_dwordx4 v9, s[8:11], s20 offen  lds
  v_mfma_f32_16x16x32_bf16 a[212:215], v[160:163], v[100:103], a[212:215]
  v_mfma_f32_16x16x32_bf16 a[216:219], v[164:167], v[100:103], a[216:219]
  v_mfma_f32_16x16x32_bf16 a[220:223], v[168:171], v[100:103], a[220:223]
  s_add_u32 m0, s53, 72704
  v_mfma_f32_16x16x32_bf16 a[224:227], v[140:143], v[104:107], a[224:227]
  buffer_load_dwordx4 v17, s[12:15], s21 offen  lds
  v_mfma_f32_16x16x32_bf16 a[228:231], v[144:147], v[104:107], a[228:231]
  v_mfma_f32_16x16x32_bf16 a[232:235], v[148:151], v[104:107], a[232:235]
  v_mfma_f32_16x16x32_bf16 a[236:239], v[152:155], v[104:107], a[236:239]
  s_add_u32 s20, s20, 128
  v_mfma_f32_16x16x32_bf16 a[240:243], v[156:159], v[104:107], a[240:243]
  s_add_u32 s21, s21, s51
  v_mfma_f32_16x16x32_bf16 a[244:247], v[160:163], v[104:107], a[244:247]
  v_mfma_f32_16x16x32_bf16 a[248:251], v[164:167], v[104:107], a[248:251]
  v_mfma_f32_16x16x32_bf16 a[252:255], v[168:171], v[104:107], a[252:255]
L_g1_loop:
  s_sub_u32 s25, s25, 1
  s_cmp_eq_u32 s25, 0
  s_cbranch_scc1 L_g1_fin
  s_waitcnt lgkmcnt(0)
  v_mfma_f32_16x16x32_bf16 a[0:3], v[108:111], v[44:47], a[0:3]
  ds_read_b128 v[76:79], v19 offset:0
  v_mfma_f32_16x16x32_bf16 a[4:7], v[112:115], v[44:47], a[4:7]
  v_mfma_f32_16x16x32_bf16 a[8:11], v[116:119], v[44:47], a[8:11]
  ds_read_b64_tr_b16 v[140:141], v22 offset:49152
  v_mfma_f32_16x16x32_bf16 a[12:15], v[120:123], v[44:47], a[12:15]
  v_mfma_f32_16x16x32_bf16 a[16:19], v[124:127], v[44:47], a[16:19]
  ds_read_b64_tr_b16 v[142:143], v22 offset:51200
  v_mfma_f32_16x16x32_bf16 a[20:23], v[128:131], v[44:47], a[20:23]
  v_mfma_f32_16x16x32_bf16 a[24:27], v[132:135], v[44:47], a[24:27]
  ds_read_b128 v[80:83], v19 offset:2048
  v_mfma_f32_16x16x32_bf16 a[28:31], v[136:139], v[44:47], a[28:31]
  v_mfma_f32_16x16x32_bf16 a[32:35], v[108:111], v[48:51], a[32:35]
  ds_read_b64_tr_b16 v[144:145], v23 offset:49152
  v_mfma_f32_16x16x32_bf16 a[36:39], v[112:115], v[48:51], a[36:39]
  v_mfma_f32_16x16x32_bf16 a[40:43], v[116:119], v[48:51], a[40:43]
  ds_read_b64_tr_b16 v[146:147], v23 offset:51200
  v_mfma_f32_16x16x32_bf16 a[44:47], v[120:123], v[48:51], a[44:47]
  v_mfma_f32_16x16x32_bf16 a[48:51], v[124:127], v[48:51], a[48:51]
  ds_read_b128 v[84:87], v19 offset:4096
  v_mfma_f32_16x16x32_bf16 a[52:55], v[128:131], v[48:51], a[52:55]
  v_mfma_f32_16x16x32_bf16 a[56:59], v[132:135], v[48:51], a[56:59]
  ds_read_b64_tr_b16 v[148:149], v24 offset:49152
  v_mfma_f32_16x16x32_bf16 a[60:63], v[136:139], v[48:51], a[60:63]
  v_mfma_f32_16x16x32_bf16 a[64:67], v[108:111], v[52:55], a[64:67]
  ds_read_b64_tr_b16 v[150:151], v24 offset:51200
  v_mfma_f32_16x16x32_bf16 a[68:71], v[112:115], v[52:55], a[68:71]
  v_mfma_f32_16x16x32_bf16 a[72:75], v[116:119], v[52:55], a[72:75]
  ds_read_b128 v[88:91], v19 offset:6144
  v_mfma_f32_16x16x32_bf16 a[76:79], v[120:123], v[52:55], a[76:79]
  v_mfma_f32_16x16x32_bf16 a[80:83], v[124:127], v[52:55], a[80:83]
  ds_read_b64_tr_b16 v[152:153], v25 offset:49152
  v_mfma_f32_16x16x32_bf16 a[84:87], v[128:131], v[52:55], a[84:87]
  v_mfma_f32_16x16x32_bf16 a[88:91], v[132:135], v[52:55], a[88:91]
  ds_read_b64_tr_b16 v[154:155], v25 offset:51200
  v_mfma_f32_16x16x32_bf16 a[92:95], v[136:139], v[52:55], a[92:95]
  v_mfma_f32_16x16x32_bf16 a[96:99], v[108:111], v[56:59], a[96:99]
  ds_read_b128 v[92:95], v19 offset:8192
  v_mfma_f32_16x16x32_bf16 a[100:103], v[112:115], v[56:59], a[100:103]
  v_mfma_f32_16x16x32_bf16 a[104:107], v[116:119], v[56:59], a[104:107]
  ds_read_b64_tr_b16 v[156:157], v26 offset:49152
  v_mfma_f32_16x16x32_bf16 a[108:111], v[120:123], v[56:59], a[108:111]
  v_mfma_f32_16x16x32_bf16 a[112:115], v[124:127], v[56:59], a[112:115]
  ds_read_b64_tr_b16 v[158:159], v26 offset:51200
  v_mfma_f32_16x16x32_bf16 a[116:119], v[128:131], v[56:59], a[116:119]
  v_mfma_f32_16x16x32_bf16 a[120:123], v[132:135], v[56:59], a[120:123]
  ds_read_b128 v[96:99], v19 offset:10240
  v_mfma_f32_16x16x32_bf16 a[124:127], v[136:139], v[56:59], a[124:127]
  v_mfma_f32_16x16x32_bf16 a[128:131], v[108:111], v[60:63], a[128:131]
  ds_read_b64_tr_b16 v[160:161], v27 offset:49152
  v_mfma_f32_16x16x32_bf16 a[132:135], v[112:115], v[60:63], a[132:135]
  v_mfma_f32_16x16x32_bf16 a[136:139], v[116:119], v[60:63], a[136:139]
  ds_read_b64_tr_b16 v[162:163], v27 offset:51200
  v_mfma_f32_16x16x32_bf16 a[140:143], v[120:123], v[60:63], a[140:143]
  v_mfma_f32_16x16x32_bf16 a[144:147], v[124:127], v[60:63], a[144:147]
  ds_read_b128 v[100:103], v19 offset:12288
  v_mfma_f32_16x16x32_bf16 a[148:151], v[128:131], v[60:63], a[148:151]
  v_mfma_f32_16x16x32_bf16 a[152:155], v[132:135], v[60:63], a[152:155]
  ds_read_b64_tr_b16 v[164:165], v28 offset:49152
  v_mfma_f32_16x16x32_bf16 a[156:159], v[136:139], v[60:63], a[156:159]
  v_mfma_f32_16x16x32_bf16 a[160:163], v[108:111], v[64:67], a[160:163]
  ds_read_b64_tr_b16 v[166:167], v28 offset:51200
  v_mfma_f32_16x16x32_bf16 a[164:167], v[112:115], v[64:67], a[164:167]
  v_mfma_f32_16x16x32_bf16 a[168:171], v[116:119], v[64:67], a[168:171]
  ds_read_b128 v[104:107], v19 offset:14336
  v_mfma_f32_16x16x32_bf16 a[172:175], v[120:123], v[64:67], a[172:175]
  v_mfma_f32_16x16x32_bf16 a[176:179], v[124:127], v[64:67], a[176:179]
  ds_read_b64_tr_b16 v[168:169], v29 offset:49152
  v_mfma_f32_16x16x32_bf16 a[180:183], v[128:131], v[64:67], a[180:183]
  v_mfma_f32_16x16x32_bf16 a[184:187], v[132:135], v[64:67], a[184:187]
  ds_read_b64_tr_b16 v[170:171], v29 offset:51200
  v_mfma_f32_16x16x32_bf16 a[188:191], v[136:139], v[64:67], a[188:191]
  v_mfma_f32_16x16x32_bf16 a[192:195], v[108:111], v[68:71], a[192:195]
  v_mfma_f32_16x16x32_bf16 a[196:199], v[112:115], v[68:71], a[196:199]
  v_mfma_f32_16x16x32_bf16 a[200:203], v[116:119], v[68:71], a[200:203]
  v_mfma_f32_16x16x32_bf16 a[204:207], v[120:123], v[68:71], a[204:207]
  v_mfma_f32_16x16x32_bf16 a[208:211], v[124:127], v[68:71], a[208:211]
  v_mfma_f32_16x16x32_bf16 a[212:215], v[128:131], v[68:71], a[212:215]
  v_mfma_f32_16x16x32_bf16 a[216:219], v[132:135], v[68:71], a[216:219]
  v_mfma_f32_16x16x32_bf16 a[220:223], v[136:139], v[68:71], a[220:223]
  v_mfma_f32_16x16x32_bf16 a[224:227], v[108:111], v[72:75], a[224:227]
  v_mfma_f32_16x16x32_bf16 a[228:231], v[112:115], v[72:75], a[228:231]
  v_mfma_f32_16x16x32_bf16 a[232:235], v[116:119], v[72:75], a[232:235]
  v_mfma_f32_16x16x32_bf16 a[236:239], v[120:123], v[72:75], a[236:239]
  v_mfma_f32_16x16x32_bf16 a[240:243], v[124:127], v[72:75], a[240:243]
  v_mfma_f32_16x16x32_bf16 a[244:247], v[128:131], v[72:75], a[244:247]
  v_mfma_f32_16x16x32_bf16 a[248:251], v[132:135], v[72:75], a[248:251]
  v_mfma_f32_16x16x32_bf16 a[252:255], v[136:139], v[72:75], a[252:255]
  s_waitcnt lgkmcnt(0)
  v_mfma_f32_16x16x32_bf16 a[0:3], v[140:143], v[76:79], a[0:3]
  s_waitcnt vmcnt(0)
  s_barrier
  s_add_u32 m0, s52, 0
  v_mfma_f32_16x16x32_bf16 a[4:7], v[144:147], v[76:79], a[4:7]
  buffer_load_dwordx4 v2, s[8:11], s20 offen  lds
  ds_read_b128 v[44:47], v20 offset:0
  v_mfma_f32_16x16x32_bf16 a[8:11], v[148:151], v[76:79], a[8:11]
  v_mfma_f32_16x16x32_bf16 a[12:15], v[152:155], v[76:79], a[12:15]
  ds_read_b64_tr_b16 v[108:109], v30 offset:32768
  s_add_u32 m0, s53, 0
  v_mfma_f32_16x16x32_bf16 a[16:19], v[156:159], v[76:79], a[16:19]
  buffer_load_dwordx4 v10, s[12:15], s21 offen  lds
  v_mfma_f32_16x16x32_bf16 a[20:23], v[160:163], v[76:79], a[20:23]
  ds_read_b64_tr_b16 v[110:111], v30 offset:34816
  v_mfma_f32_16x16x32_bf16 a[24:27], v[164:167], v[76:79], a[24:27]
  v_mfma_f32_16x16x32_bf16 a[28:31], v[168:171], v[76:79], a[28:31]
  ds_read_b128 v[48:51], v20 offset:2048
  s_add_u32 m0, s52, 1024
  v_mfma_f32_16x16x32_bf16 a[32:35], v[140:143], v[80:83], a[32:35]
  buffer_load_dwordx4 v3, s[8:11], s20 offen  lds
  v_mfma_f32_16x16x32_bf16 a[36:39], v[144:147], v[80:83], a[36:39]
  ds_read_b64_tr_b16 v[112:113], v31 offset:32768
  v_mfma_f32_16x16x32_bf16 a[40:43], v[148:151], v[80:83], a[40:43]
  v_mfma_f32_16x16x32_bf16 a[44:47], v[152:155], v[80:83], a[44:47]
  ds_read_b64_tr_b16 v[114:115], v31 offset:34816
  s_add_u32 m0, s53, 1024
  v_mfma_f32_16x16x32_bf16 a[48:51], v[156:159], v[80:83], a[48:51]
  buffer_load_dwordx4 v11, s[12:15], s21 offen  lds
  v_mfma_f32_16x16x32_bf16 a[52:55], v[160:163], v[80:83], a[52:55]
  ds_read_b128 v[52:55], v20 offset:4096
  v_mfma_f32_16x16x32_bf16 a[56:59], v[164:167], v[80:83], a[56:59]
  s_add_u32 m0, s52, 2048
  v_mfma_f32_16x16x32_bf16 a[60:63], v[168:171], v[80:83], a[60:63]
  buffer_load_dwordx4 v4, s[8:11], s20 offen  lds
  ds_read_b64_tr_b16 v[116:117], v32 offset:32768
  v_mfma_f32_16x16x32_bf16 a[64:67], v[140:143], v[84:87], a[64:67]
  v_mfma_f32_16x16x32_bf16 a[68:71], v[144:147], v[84:87], a[68:71]
  ds_read_b64_tr_b16 v[118:119], v32 offset:34816
  v_mfma_f32_16x16x32_bf16 a[72:75], v[148:151], v[84:87], a[72:75]
  s_add_u32 m0, s53, 2048
  v_mfma_f32_16x16x32_bf16 a[76:79], v[152:155], v[84:87], a[76:79]
  buffer_load_dwordx4 v12, s[12:15], s21 offen  lds
  ds_read_b128 v[56:59], v20 offset:6144
  v_mfma_f32_16x16x32_bf16 a[80:83], v[156:159], v[84:87], a[80:83]
  v_mfma_f32_16x16x32_bf16 a[84:87], v[160:163], v[84:87], a[84:87]
  ds_read_b64_tr_b16 v[120:121], v33 offset:32768
  v_mfma_f32_16x16x32_bf16 a[88:91], v[164:167], v[84:87], a[88:91]
  s_add_u32 m0, s52, 3072
  v_mfma_f32_16x16x32_bf16 a[92:95], v[168:171], v[84:87], a[92:95]
  buffer_load_dwordx4 v5, s[8:11], s20 offen  lds
  ds_read_b64_tr_b16 v[122:123], v33 offset:34816
  v_mfma_f32_16x16x32_bf16 a[96:99], v[140:143], v[88:91], a[96:99]
  v_mfma_f32_16x16x32_bf16 a[100:103], v[144:147], v[88:91], a[100:103]
  ds_read_b128 v[60:63], v20 offset:8192
  s_add_u32 m0, s53, 3072
  v_mfma_f32_16x16x32_bf16 a[104:107], v[148:151], v[88:91], a[104:107]
  buffer_load_dwordx4 v13, s[12:15], s21 offen  lds
  v_mfma_f32_16x16x32_bf16 a[108:111], v[152:155], v[88:91], a[108:111]
  ds_read_b64_tr_b16 v[124:125], v34 offset:32768
  v_mfma_f32_16x16x32_bf16 a[112:115], v[156:159], v[88:91], a[112:115]
  v_mfma_f32_16x16x32_bf16 a[116:119], v[160:163], v[88:91], a[116:119]
  ds_read_b64_tr_b16 v[126:127], v34 offset:34816
  s_add_u32 m0, s52, 4096
  v_mfma_f32_16x16x32_bf16 a[120:123], v[164:167], v[88:91], a[120:123]
  buffer_load_dwordx4 v6, s[8:11], s20 offen  lds
  v_mfma_f32_16x16x32_bf16 a[124:127], v[168:171], v[88:91], a[124:127]
  ds_read_b128 v[64:67], v20 offset:10240
  v_mfma_f32_16x16x32_bf16 a[128:131], v[140:143], v[92:95], a[128:131]
  v_mfma_f32_16x16x32_bf16 a[132:135], v[144:147], v[92:95], a[132:135]
  ds_read_b64_tr_b16 v[128:129], v35 offset:32768
  s_add_u32 m0, s53, 4096
  v_mfma_f32_16x16x32_bf16 a[136:139], v[148:151], v[92:95], a[136:139]
  buffer_load_dwordx4 v14, s[12:15], s21 offen  lds
  v_mfma_f32_16x16x32_bf16 a[140:143], v[152:155], v[92:95], a[140:143]
  ds_read_b64_tr_b16 v[130:131], v35 offset:34816
  v_mfma_f32_16x16x32_bf16 a[144:147], v[156:159], v[92:95], a[144:147]
  v_mfma_f32_16x16x32_bf16 a[148:151], v[160:163], v[92:95], a[148:151]
  ds_read_b128 v[68:71], v20 offset:12288
  s_add_u32 m0, s52, 5120
  v_mfma_f32_16x16x32_bf16 a[152:155], v[164:167], v[92:95], a[152:155]
  buffer_load_dwordx4 v7, s[8:11], s20 offen  lds
  v_mfma_f32_16x16x32_bf16 a[156:159], v[168:171], v[92:95], a[156:159]
  ds_read_b64_tr_b16 v[132:133], v36 offset:32768
  v_mfma_f32_16x16x32_bf16 a[160:163], v[140:143], v[96:99], a[160:163]
  s_add_u32 m0, s53, 5120
  v_mfma_f32_16x16x32_bf16 a[164:167], v[144:147], v[96:99], a[164:167]
  buffer_load_dwordx4 v15, s[12:15], s21 offen  lds
  ds_read_b64_tr_b16 v[134:135], v36 offset:34816
  v_mfma_f32_16x16x32_bf16 a[168:171], v[148:151], v[96:99], a[168:171]
  v_mfma_f32_16x16x32_bf16 a[172:175], v[152:155], v[96:99], a[172:175]
  ds_read_b128 v[72:75], v20 offset:14336
  v_mfma_f32_16x16x32_bf16 a[176:179], v[156:159], v[96:99], a[176:179]
  s_add_u32 m0, s52, 6144
  v_mfma_f32_16x16x32_bf16 a[180:183], v[160:163], v[96:99], a[180:183]
  buffer_load_dwordx4 v8, s[8:11], s20 offen  lds
  ds_read_b64_tr_b16 v[136:137], v37 offset:32768
  v_mfma_f32_16x16x32_bf16 a[184:187], v[164:167], v[96:99], a[184:187]
  v_mfma_f32_16x16x32_bf16 a[188:191], v[168:171], v[96:99], a[188:191]
  ds_read_b64_tr_b16 v[138:139], v37 offset:34816
  v_mfma_f32_16x16x32_bf16 a[192:195], v[140:143], v[100:103], a[192:195]
  s_add_u32 m0, s53, 6144
  v_mfma_f32_16x16x32_bf16 a[196:199], v[144:147], v[100:103], a[196:199]
  buffer_load_dwordx4 v16, s[12:15], s21 offen  lds
  v_mfma_f32_16x16x32_bf16 a[200:203], v[148:151], v[100:103], a[200:203]
  v_mfma_f32_16x16x32_bf16 a[204:207], v[152:155], v[100:103], a[204:207]
  s_add_u32 m0, s52, 7168
  v_mfma_f32_16x16x32_bf16 a[208:211], v[156:159], v[100:103], a[208:211]
  buffer_load_dwordx4 v9, s[8:11], s20 offen  lds
  v_mfma_f32_16x16x32_bf16 a[212:215], v[160:163], v[100:103], a[212:215]
  v_mfma_f32_16x16x32_bf16 a[216:219], v[164:167], v[100:103], a[216:219]
  v_mfma_f32_16x16x32_bf16 a[220:223], v[168:171], v[100:103], a[220:223]
  s_add_u32 m0, s53, 7168
  v_mfma_f32_16x16x32_bf16 a[224:227], v[140:143], v[104:107], a[224:227]
  buffer_load_dwordx4 v17, s[12:15], s21 offen  lds
  v_mfma_f32_16x16x32_bf16 a[228:231], v[144:147], v[104:107], a[228:231]
  v_mfma_f32_16x16x32_bf16 a[232:235], v[148:151], v[104:107], a[232:235]
  v_mfma_f32_16x16x32_bf16 a[236:239], v[152:155], v[104:107], a[236:239]
  s_add_u32 s20, s20, 128
  v_mfma_f32_16x16x32_bf16 a[240:243], v[156:159], v[104:107], a[240:243]
  s_add_u32 s21, s21, s51
  v_mfma_f32_16x16x32_bf16 a[244:247], v[160:163], v[104:107], a[244:247]
  v_mfma_f32_16x16x32_bf16 a[248:251], v[164:167], v[104:107], a[248:251]
  v_mfma_f32_16x16x32_bf16 a[252:255], v[168:171], v[104:107], a[252:255]
  s_waitcnt lgkmcnt(0)
  s_cmp_eq_u32 s25, 1
  s_cbranch_scc1 L_g1_cw
L_g1_cwb:
  v_mfma_f32_16x16x32_bf16 a[0:3], v[108:111], v[44:47], a[0:3]
  ds_read_b128 v[76:79], v21 offset:0
  v_mfma_f32_16x16x32_bf16 a[4:7], v[112:115], v[44:47], a[4:7]
  v_mfma_f32_16x16x32_bf16 a[8:11], v[116:119], v[44:47], a[8:11]
  ds_read_b64_tr_b16 v[140:141], v30 offset:49152
  v_mfma_f32_16x16x32_bf16 a[12:15], v[120:123], v[44:47], a[12:15]
  v_mfma_f32_16x16x32_bf16 a[16:19], v[124:127], v[44:47], a[16:19]
  ds_read_b64_tr_b16 v[142:143], v30 offset:51200
  v_mfma_f32_16x16x32_bf16 a[20:23], v[128:131], v[44:47], a[20:23]
  v_mfma_f32_16x16x32_bf16 a[24:27], v[132:135], v[44:47], a[24:27]
  ds_read_b128 v[80:83], v21 offset:2048
  v_mfma_f32_16x16x32_bf16 a[28:31], v[136:139], v[44:47], a[28:31]
  v_mfma_f32_16x16x32_bf16 a[32:35], v[108:111], v[48:51], a[32:35]
  ds_read_b64_tr_b16 v[144:145], v31 offset:49152
  v_mfma_f32_16x16x32_bf16 a[36:39], v[112:115], v[48:51], a[36:39]
  v_mfma_f32_16x16x32_bf16 a[40:43], v[116:119], v[48:51], a[40:43]
  ds_read_b64_tr_b16 v[146:147], v31 offset:51200
  v_mfma_f32_16x16x32_bf16 a[44:47], v[120:123], v[48:51], a[44:47]
  v_mfma_f32_16x16x32_bf16 a[48:51], v[124:127], v[48:51], a[48:51]
  ds_read_b128 v[84:87], v21 offset:4096
  v_mfma_f32_16x16x32_bf16 a[52:55], v[128:131], v[48:51], a[52:55]
  v_mfma_f32_16x16x32_bf16 a[56:59], v[132:135], v[48:51], a[56:59]
  ds_read_b64_tr_b16 v[148:149], v32 offset:49152
  v_mfma_f32_16x16x32_bf16 a[60:63], v[136:139], v[48:51], a[60:63]
  v_mfma_f32_16x16x32_bf16 a[64:67], v[108:111], v[52:55], a[64:67]
  ds_read_b64_tr_b16 v[150:151], v32 offset:51200
  v_mfma_f32_16x16x32_bf16 a[68:71], v[112:115], v[52:55], a[68:71]
  v_mfma_f32_16x16x32_bf16 a[72:75], v[116:119], v[52:55], a[72:75]
  ds_read_b128 v[88:91], v21 offset:6144
  v_mfma_f32_16x16x32_bf16 a[76:79], v[120:123], v[52:55], a[76:79]
  v_mfma_f32_16x16x32_bf16 a[80:83], v[124:127], v[52:55], a[80:83]
  ds_read_b64_tr_b16 v[152:153], v33 offset:49152
  v_mfma_f32_16x16x32_bf16 a[84:87], v[128:131], v[52:55], a[84:87]
  v_mfma_f32_16x16x32_bf16 a[88:91], v[132:135], v[52:55], a[88:91]
  ds_read_b64_tr_b16 v[154:155], v33 offset:51200
  v_mfma_f32_16x16x32_bf16 a[92:95], v[136:139], v[52:55], a[92:95]
  v_mfma_f32_16x16x32_bf16 a[96:99], v[108:111], v[56:59], a[96:99]
  ds_read_b128 v[92:95], v21 offset:8192
  v_mfma_f32_16x16x32_bf16 a[100:103], v[112:115], v[56:59], a[100:103]
  v_mfma_f32_16x16x32_bf16 a[104:107], v[116:119], v[56:59], a[104:107]
  ds_read_b64_tr_b16 v[156:157], v34 offset:49152
  v_mfma_f32_16x16x32_bf16 a[108:111], v[120:123], v[56:59], a[108:111]
  v_mfma_f32_16x16x32_bf16 a[112:115], v[124:127], v[56:59], a[112:115]
  ds_read_b64_tr_b16 v[158:159], v34 offset:51200
  v_mfma_f32_16x16x32_bf16 a[116:119], v[128:131], v[56:59], a[116:119]
  v_mfma_f32_16x16x32_bf16 a[120:123], v[132:135], v[56:59], a[120:123]
  ds_read_b128 v[96:99], v21 offset:10240
  v_mfma_f32_16x16x32_bf16 a[124:127], v[136:139], v[56:59], a[124:127]
  v_mfma_f32_16x16x32_bf16 a[128:131], v[108:111], v[60:63], a[128:131]
  ds_read_b64_tr_b16 v[160:161], v35 offset:49152
  v_mfma_f32_16x16x32_bf16 a[132:135], v[112:115], v[60:63], a[132:135]
  v_mfma_f32_16x16x32_bf16 a[136:139], v[116:119], v[60:63], a[136:139]
  ds_read_b64_tr_b16 v[162:163], v35 offset:51200
  v_mfma_f32_16x16x32_bf16 a[140:143], v[120:123], v[60:63], a[140:143]
  v_mfma_f32_16x16x32_bf16 a[144:147], v[124:127], v[60:63], a[144:147]
  ds_read_b128 v[100:103], v21 offset:12288
  v_mfma_f32_16x16x32_bf16 a[148:151], v[128:131], v[60:63], a[148:151]
  v_mfma_f32_16x16x32_bf16 a[152:155], v[132:135], v[60:63], a[152:155]
  ds_read_b64_tr_b16 v[164:165], v36 offset:49152
  v_mfma_f32_16x16x32_bf16 a[156:159], v[136:139], v[60:63], a[156:159]
  v_mfma_f32_16x16x32_bf16 a[160:163], v[108:111], v[64:67], a[160:163]
  ds_read_b64_tr_b16 v[166:167], v36 offset:51200
  v_mfma_f32_16x16x32_bf16 a[164:167], v[112:115], v[64:67], a[164:167]
  v_mfma_f32_16x16x32_bf16 a[168:171], v[116:119], v[64:67], a[168:171]
  ds_read_b128 v[104:107], v21 offset:14336
  v_mfma_f32_16x16x32_bf16 a[172:175], v[120:123], v[64:67], a[172:175]
  v_mfma_f32_16x16x32_bf16 a[176:179], v[124:127], v[64:67], a[176:179]
  ds_read_b64_tr_b16 v[168:169], v37 offset:49152
  v_mfma_f32_16x16x32_bf16 a[180:183], v[128:131], v[64:67], a[180:183]
  v_mfma_f32_16x16x32_bf16 a[184:187], v[132:135], v[64:67], a[184:187]
  ds_read_b64_tr_b16 v[170:171], v37 offset:51200
  v_mfma_f32_16x16x32_bf16 a[188:191], v[136:139], v[64:67], a[188:191]
  v_mfma_f32_16x16x32_bf16 a[192:195], v[108:111], v[68:71], a[192:195]
  v_mfma_f32_16x16x32_bf16 a[196:199], v[112:115], v[68:71], a[196:199]
  v_mfma_f32_16x16x32_bf16 a[200:203], v[116:119], v[68:71], a[200:203]
  v_mfma_f32_16x16x32_bf16 a[204:207], v[120:123], v[68:71], a[204:207]
  v_mfma_f32_16x16x32_bf16 a[208:211], v[124:127], v[68:71], a[208:211]
  v_mfma_f32_16x16x32_bf16 a[212:215], v[128:131], v[68:71], a[212:215]
  v_mfma_f32_16x16x32_bf16 a[216:219], v[132:135], v[68:71], a[216:219]
  v_mfma_f32_16x16x32_bf16 a[220:223], v[136:139], v[68:71], a[220:223]
  v_mfma_f32_16x16x32_bf16 a[224:227], v[108:111], v[72:75], a[224:227]
  v_mfma_f32_16x16x32_bf16 a[228:231], v[112:115], v[72:75], a[228:231]
  v_mfma_f32_16x16x32_bf16 a[232:235], v[116:119], v[72:75], a[232:235]
  v_mfma_f32_16x16x32_bf16 a[236:239], v[120:123], v[72:75], a[236:239]
  v_mfma_f32_16x16x32_bf16 a[240:243], v[124:127], v[72:75], a[240:243]
  v_mfma_f32_16x16x32_bf16 a[244:247], v[128:131], v[72:75], a[244:247]
  v_mfma_f32_16x16x32_bf16 a[248:251], v[132:135], v[72:75], a[248:251]
  v_mfma_f32_16x16x32_bf16 a[252:255], v[136:139], v[72:75], a[252:255]
  s_waitcnt lgkmcnt(0)
  v_mfma_f32_16x16x32_bf16 a[0:3], v[140:143], v[76:79], a[0:3]
  s_waitcnt vmcnt(0)
  s_barrier
  s_cmp_le_u32 s25, 2
  s_cbranch_scc1 L_g1_cr
L_g1_crb:
  s_add_u32 m0, s52, 65536
  v_mfma_f32_16x16x32_bf16 a[4:7], v[144:147], v[76:79], a[4:7]
  buffer_load_dwordx4 v2, s[8:11], s20 offen  lds
  ds_read_b128 v[44:47], v18 offset:0
  v_mfma_f32_16x16x32_bf16 a[8:11], v[148:151], v[76:79], a[8:11]
  v_mfma_f32_16x16x32_bf16 a[12:15], v[152:155], v[76:79], a[12:15]
  ds_read_b64_tr_b16 v[108:109], v22 offset:32768
  s_add_u32 m0, s53, 65536
  v_mfma_f32_16x16x32_bf16 a[16:19], v[156:159], v[76:79], a[16:19]
  buffer_load_dwordx4 v10, s[12:15], s21 offen  lds
  v_mfma_f32_16x16x32_bf16 a[20:23], v[160:163], v[76:79], a[20:23]
  ds_read_b64_tr_b16 v[110:111], v22 offset:34816
  v_mfma_f32_16x16x32_bf16 a[24:27], v[164:167], v[76:79], a[24:27]
  v_mfma_f32_16x16x32_bf16 a[28:31], v[168:171], v[76:79], a[28:31]
  ds_read_b128 v[48:51], v18 offset:2048
  s_add_u32 m0, s52, 66560
  v_mfma_f32_16x16x32_bf16 a[32:35], v[140:143], v[80:83], a[32:35]
  buffer_load_dwordx4 v3, s[8:11], s20 offen  lds
  v_mfma_f32_16x16x32_bf16 a[36:39], v[144:147], v[80:83], a[36:39]
  ds_read_b64_tr_b16 v[112:113], v23 offset:32768
  v_mfma_f32_16x16x32_bf16 a[40:43], v[148:151], v[80:83], a[40:43]
  v_mfma_f32_16x16x32_bf16 a[44:47], v[152:155], v[80:83], a[44:47]
  ds_read_b64_tr_b16 v[114:115], v23 offset:34816
  s_add_u32 m0, s53, 66560
  v_mfma_f32_16x16x32_bf16 a[48:51], v[156:159], v[80:83], a[48:51]
  buffer_load_dwordx4 v11, s[12:15], s21 offen  lds
  v_mfma_f32_16x16x32_bf16 a[52:55], v[160:163], v[80:83], a[52:55]
  ds_read_b128 v[52:55], v18 offset:4096
  v_mfma_f32_16x16x32_bf16 a[56:59], v[164:167], v[80:83], a[56:59]
  s_add_u32 m0, s52, 67584
  v_mfma_f32_16x16x32_bf16 a[60:63], v[168:171], v[80:83], a[60:63]
  buffer_load_dwordx4 v4, s[8:11], s20 offen  lds
  ds_read_b64_tr_b16 v[116:117], v24 offset:32768
  v_mfma_f32_16x16x32_bf16 a[64:67], v[140:143], v[84:87], a[64:67]
  v_mfma_f32_16x16x32_bf16 a[68:71], v[144:147], v[84:87], a[68:71]
  ds_read_b64_tr_b16 v[118:119], v24 offset:34816
  v_mfma_f32_16x16x32_bf16 a[72:75], v[148:151], v[84:87], a[72:75]
  s_add_u32 m0, s53, 67584
  v_mfma_f32_16x16x32_bf16 a[76:79], v[152:155], v[84:87], a[76:79]
  buffer_load_dwordx4 v12, s[12:15], s21 offen  lds
  ds_read_b128 v[56:59], v18 offset:6144
  v_mfma_f32_16x16x32_bf16 a[80:83], v[156:159], v[84:87], a[80:83]
  v_mfma_f32_16x16x32_bf16 a[84:87], v[160:163], v[84:87], a[84:87]
  ds_read_b64_tr_b16 v[120:121], v25 offset:32768
  v_mfma_f32_16x16x32_bf16 a[88:91], v[164:167], v[84:87], a[88:91]
  s_add_u32 m0, s52, 68608
  v_mfma_f32_16x16x32_bf16 a[92:95], v[168:171], v[84:87], a[92:95]
  buffer_load_dwordx4 v5, s[8:11], s20 offen  lds
  ds_read_b64_tr_b16 v[122:123], v25 offset:34816
  v_mfma_f32_16x16x32_bf16 a[96:99], v[140:143], v[88:91], a[96:99]
  v_mfma_f32_16x16x32_bf16 a[100:103], v[144:147], v[88:91], a[100:103]
  ds_read_b128 v[60:63], v18 offset:8192
  s_add_u32 m0, s53, 68608
  v_mfma_f32_16x16x32_bf16 a[104:107], v[148:151], v[88:91], a[104:107]
  buffer_load_dwordx4 v13, s[12:15], s21 offen  lds
  v_mfma_f32_16x16x32_bf16 a[108:111], v[152:155], v[88:91], a[108:111]
  ds_read_b64_tr_b16 v[124:125], v26 offset:32768
  v_mfma_f32_16x16x32_bf16 a[112:115], v[156:159], v[88:91], a[112:115]
  v_mfma_f32_16x16x32_bf16 a[116:119], v[160:163], v[88:91], a[116:119]
  ds_read_b64_tr_b16 v[126:127], v26 offset:34816
  s_add_u32 m0, s52, 69632
  v_mfma_f32_16x16x32_bf16 a[120:123], v[164:167], v[88:91], a[120:123]
  buffer_load_dwordx4 v6, s[8:11], s20 offen  lds
  v_mfma_f32_16x16x32_bf16 a[124:127], v[168:171], v[88:91], a[124:127]
  ds_read_b128 v[64:67], v18 offset:10240
  v_mfma_f32_16x16x32_bf16 a[128:131], v[140:143], v[92:95], a[128:131]
  v_mfma_f32_16x16x32_bf16 a[132:135], v[144:147], v[92:95], a[132:135]
  ds_read_b64_tr_b16 v[128:129], v27 offset:32768
  s_add_u32 m0, s53, 69632
  v_mfma_f32_16x16x32_bf16 a[136:139], v[148:151], v[92:95], a[136:139]
  buffer_load_dwordx4 v14, s[12:15], s21 offen  lds
  v_mfma_f32_16x16x32_bf16 a[140:143], v[152:155], v[92:95], a[140:143]
  ds_read_b64_tr_b16 v[130:131], v27 offset:34816
  v_mfma_f32_16x16x32_bf16 a[144:147], v[156:159], v[92:95], a[144:147]
  v_mfma_f32_16x16x32_bf16 a[148:151], v[160:163], v[92:95], a[148:151]
  ds_read_b128 v[68:71], v18 offset:12288
  s_add_u32 m0, s52, 70656
  v_mfma_f32_16x16x32_bf16 a[152:155], v[164:167], v[92:95], a[152:155]
  buffer_load_dwordx4 v7, s[8:11], s20 offen  lds
  v_mfma_f32_16x16x32_bf16 a[156:159], v[168:171], v[92:95], a[156:159]
  ds_read_b64_tr_b16 v[132:133], v28 offset:32768
  v_mfma_f32_16x16x32_bf16 a[160:163], v[140:143], v[96:99], a[160:163]
  s_add_u32 m0, s53, 70656
  v_mfma_f32_16x16x32_bf16 a[164:167], v[144:147], v[96:99], a[164:167]
  buffer_load_dwordx4 v15, s[12:15], s21 offen  lds
  ds_read_b64_tr_b16 v[134:135], v28 offset:34816
  v_mfma_f32_16x16x32_bf16 a[168:171], v[148:151], v[96:99], a[168:171]
  v_mfma_f32_16x16x32_bf16 a[172:175], v[152:155], v[96:99], a[172:175]
  ds_read_b128 v[72:75], v18 offset:14336
  v_mfma_f32_16x16x32_bf16 a[176:179], v[156:159], v[96:99], a[176:179]
  s_add_u32 m0, s52, 71680
  v_mfma_f32_16x16x32_bf16 a[180:183], v[160:163], v[96:99], a[180:183]
  buffer_load_dwordx4 v8, s[8:11], s20 offen  lds
  ds_read_b64_tr_b16 v[136:137], v29 offset:32768
  v_mfma_f32_16x16x32_bf16 a[184:187], v[164:167], v[96:99], a[184:187]
  v_mfma_f32_16x16x32_bf16 a[188:191], v[168:171], v[96:99], a[188:191]
  ds_read_b64_tr_b16 v[138:139], v29 offset:34816
  v_mfma_f32_16x16x32_bf16 a[192:195], v[140:143], v[100:103], a[192:195]
  s_add_u32 m0, s53, 71680
  v_mfma_f32_16x16x32_bf16 a[196:199], v[144:147], v[100:103], a[196:199]
  buffer_load_dwordx4 v16, s[12:15], s21 offen  lds
  v_mfma_f32_16x16x32_bf16 a[200:203], v[148:151], v[100:103], a[200:203]
  v_mfma_f32_16x16x32_bf16 a[204:207], v[152:155], v[100:103], a[204:207]
  s_add_u32 m0, s52, 72704
  v_mfma_f32_16x16x32_bf16 a[208:211], v[156:159], v[100:103], a[208:211]
  buffer_load_dwordx4 v9, s[8:11], s20 offen  lds
  v_mfma_f32_16x16x32_bf16 a[212:215], v[160:163], v[100:103], a[212:215]
  v_mfma_f32_16x16x32_bf16 a[216:219], v[164:167], v[100:103], a[216:219]
  v_mfma_f32_16x16x32_bf16 a[220:223], v[168:171], v[100:103], a[220:223]
  s_add_u32 m0, s53, 72704
  v_mfma_f32_16x16x32_bf16 a[224:227], v[140:143], v[104:107], a[224:227]
  buffer_load_dwordx4 v17, s[12:15], s21 offen  lds
  v_mfma_f32_16x16x32_bf16 a[228:231], v[144:147], v[104:107], a[228:231]
  v_mfma_f32_16x16x32_bf16 a[232:235], v[148:151], v[104:107], a[232:235]
  v_mfma_f32_16x16x32_bf16 a[236:239], v[152:155], v[104:107], a[236:239]
  s_add_u32 s20, s20, 128
  v_mfma_f32_16x16x32_bf16 a[240:243], v[156:159], v[104:107], a[240:243]
  s_add_u32 s21, s21, s51
  v_mfma_f32_16x16x32_bf16 a[244:247], v[160:163], v[104:107], a[244:247]
  v_mfma_f32_16x16x32_bf16 a[248:251], v[164:167], v[104:107], a[248:251]
  v_mfma_f32_16x16x32_bf16 a[252:255], v[168:171], v[104:107], a[252:255]
  s_branch L_g1_loop
L_g1_fin:
  s_mov_b32 s59, 1
  s_mov_b32 s60, s22
  s_mov_b32 s61, s26
  s_add_u32 s62, s38, 0x3d00000
  s_mov_b32 s63, s98
  s_waitcnt lgkmcnt(0)
  v_min_u32 v245, 270, v246
  v_lshlrev_b32 v245, 2, v245
  v_add_u32 v245, 147648, v245
  ds_read_b32 v245, v245
  v_readfirstlane_b32 s34, v246
  s_add_u32 s34, s34, 32
  v_mfma_f32_16x16x32_bf16 a[0:3], v[108:111], v[44:47], a[0:3]
  ds_read_b128 v[76:79], v19 offset:0
  v_mfma_f32_16x16x32_bf16 a[4:7], v[112:115], v[44:47], a[4:7]
  v_mfma_f32_16x16x32_bf16 a[8:11], v[116:119], v[44:47], a[8:11]
  ds_read_b64_tr_b16 v[140:141], v22 offset:49152
  v_mfma_f32_16x16x32_bf16 a[12:15], v[120:123], v[44:47], a[12:15]
  v_mfma_f32_16x16x32_bf16 a[16:19], v[124:127], v[44:47], a[16:19]
  ds_read_b64_tr_b16 v[142:143], v22 offset:51200
  v_mfma_f32_16x16x32_bf16 a[20:23], v[128:131], v[44:47], a[20:23]
  v_mfma_f32_16x16x32_bf16 a[24:27], v[132:135], v[44:47], a[24:27]
  ds_read_b128 v[80:83], v19 offset:2048
  v_mfma_f32_16x16x32_bf16 a[28:31], v[136:139], v[44:47], a[28:31]
  v_mfma_f32_16x16x32_bf16 a[32:35], v[108:111], v[48:51], a[32:35]
  ds_read_b64_tr_b16 v[144:145], v23 offset:49152
  v_mfma_f32_16x16x32_bf16 a[36:39], v[112:115], v[48:51], a[36:39]
  v_mfma_f32_16x16x32_bf16 a[40:43], v[116:119], v[48:51], a[40:43]
  ds_read_b64_tr_b16 v[146:147], v23 offset:51200
  v_mfma_f32_16x16x32_bf16 a[44:47], v[120:123], v[48:51], a[44:47]
  v_mfma_f32_16x16x32_bf16 a[48:51], v[124:127], v[48:51], a[48:51]
  ds_read_b128 v[84:87], v19 offset:4096
  v_mfma_f32_16x16x32_bf16 a[52:55], v[128:131], v[48:51], a[52:55]
  v_mfma_f32_16x16x32_bf16 a[56:59], v[132:135], v[48:51], a[56:59]
  ds_read_b64_tr_b16 v[148:149], v24 offset:49152
  v_mfma_f32_16x16x32_bf16 a[60:63], v[136:139], v[48:51], a[60:63]
  v_mfma_f32_16x16x32_bf16 a[64:67], v[108:111], v[52:55], a[64:67]
  ds_read_b64_tr_b16 v[150:151], v24 offset:51200
  v_mfma_f32_16x16x32_bf16 a[68:71], v[112:115], v[52:55], a[68:71]
  v_mfma_f32_16x16x32_bf16 a[72:75], v[116:119], v[52:55], a[72:75]
  ds_read_b128 v[88:91], v19 offset:6144
  v_mfma_f32_16x16x32_bf16 a[76:79], v[120:123], v[52:55], a[76:79]
  v_mfma_f32_16x16x32_bf16 a[80:83], v[124:127], v[52:55], a[80:83]
  ds_read_b64_tr_b16 v[152:153], v25 offset:49152
  v_mfma_f32_16x16x32_bf16 a[84:87], v[128:131], v[52:55], a[84:87]
  v_mfma_f32_16x16x32_bf16 a[88:91], v[132:135], v[52:55], a[88:91]
  ds_read_b64_tr_b16 v[154:155], v25 offset:51200
  v_mfma_f32_16x16x32_bf16 a[92:95], v[136:139], v[52:55], a[92:95]
  v_mfma_f32_16x16x32_bf16 a[96:99], v[108:111], v[56:59], a[96:99]
  ds_read_b128 v[92:95], v19 offset:8192
  v_mfma_f32_16x16x32_bf16 a[100:103], v[112:115], v[56:59], a[100:103]
  v_mfma_f32_16x16x32_bf16 a[104:107], v[116:119], v[56:59], a[104:107]
  ds_read_b64_tr_b16 v[156:157], v26 offset:49152
  v_mfma_f32_16x16x32_bf16 a[108:111], v[120:123], v[56:59], a[108:111]
  v_mfma_f32_16x16x32_bf16 a[112:115], v[124:127], v[56:59], a[112:115]
  ds_read_b64_tr_b16 v[158:159], v26 offset:51200
  v_mfma_f32_16x16x32_bf16 a[116:119], v[128:131], v[56:59], a[116:119]
  v_mfma_f32_16x16x32_bf16 a[120:123], v[132:135], v[56:59], a[120:123]
  ds_read_b128 v[96:99], v19 offset:10240
  v_mfma_f32_16x16x32_bf16 a[124:127], v[136:139], v[56:59], a[124:127]
  v_mfma_f32_16x16x32_bf16 a[128:131], v[108:111], v[60:63], a[128:131]
  ds_read_b64_tr_b16 v[160:161], v27 offset:49152
  v_mfma_f32_16x16x32_bf16 a[132:135], v[112:115], v[60:63], a[132:135]
  v_mfma_f32_16x16x32_bf16 a[136:139], v[116:119], v[60:63], a[136:139]
  ds_read_b64_tr_b16 v[162:163], v27 offset:51200
  v_mfma_f32_16x16x32_bf16 a[140:143], v[120:123], v[60:63], a[140:143]
  v_mfma_f32_16x16x32_bf16 a[144:147], v[124:127], v[60:63], a[144:147]
  ds_read_b128 v[100:103], v19 offset:12288
  v_mfma_f32_16x16x32_bf16 a[148:151], v[128:131], v[60:63], a[148:151]
  v_mfma_f32_16x16x32_bf16 a[152:155], v[132:135], v[60:63], a[152:155]
  ds_read_b64_tr_b16 v[164:165], v28 offset:49152
  v_mfma_f32_16x16x32_bf16 a[156:159], v[136:139], v[60:63], a[156:159]
  v_mfma_f32_16x16x32_bf16 a[160:163], v[108:111], v[64:67], a[160:163]
  ds_read_b64_tr_b16 v[166:167], v28 offset:51200
  v_mfma_f32_16x16x32_bf16 a[164:167], v[112:115], v[64:67], a[164:167]
  v_mfma_f32_16x16x32_bf16 a[168:171], v[116:119], v[64:67], a[168:171]
  ds_read_b128 v[104:107], v19 offset:14336
  v_mfma_f32_16x16x32_bf16 a[172:175], v[120:123], v[64:67], a[172:175]
  v_mfma_f32_16x16x32_bf16 a[176:179], v[124:127], v[64:67], a[176:179]
  ds_read_b64_tr_b16 v[168:169], v29 offset:49152
  v_mfma_f32_16x16x32_bf16 a[180:183], v[128:131], v[64:67], a[180:183]
  v_mfma_f32_16x16x32_bf16 a[184:187], v[132:135], v[64:67], a[184:187]
  ds_read_b64_tr_b16 v[170:171], v29 offset:51200
  v_mfma_f32_16x16x32_bf16 a[188:191], v[136:139], v[64:67], a[188:191]
  v_mfma_f32_16x16x32_bf16 a[192:195], v[108:111], v[68:71], a[192:195]
  v_mfma_f32_16x16x32_bf16 a[196:199], v[112:115], v[68:71], a[196:199]
  v_mfma_f32_16x16x32_bf16 a[200:203], v[116:119], v[68:71], a[200:203]
  v_mfma_f32_16x16x32_bf16 a[204:207], v[120:123], v[68:71], a[204:207]
  v_mfma_f32_16x16x32_bf16 a[208:211], v[124:127], v[68:71], a[208:211]
  v_mfma_f32_16x16x32_bf16 a[212:215], v[128:131], v[68:71], a[212:215]
  v_mfma_f32_16x16x32_bf16 a[216:219], v[132:135], v[68:71], a[216:219]
  v_mfma_f32_16x16x32_bf16 a[220:223], v[136:139], v[68:71], a[220:223]
  v_mfma_f32_16x16x32_bf16 a[224:227], v[108:111], v[72:75], a[224:227]
  v_mfma_f32_16x16x32_bf16 a[228:231], v[112:115], v[72:75], a[228:231]
  v_mfma_f32_16x16x32_bf16 a[232:235], v[116:119], v[72:75], a[232:235]
  v_mfma_f32_16x16x32_bf16 a[236:239], v[120:123], v[72:75], a[236:239]
  v_mfma_f32_16x16x32_bf16 a[240:243], v[124:127], v[72:75], a[240:243]
  v_mfma_f32_16x16x32_bf16 a[244:247], v[128:131], v[72:75], a[244:247]
  v_mfma_f32_16x16x32_bf16 a[248:251], v[132:135], v[72:75], a[248:251]
  v_mfma_f32_16x16x32_bf16 a[252:255], v[136:139], v[72:75], a[252:255]
  s_waitcnt lgkmcnt(0)
  v_mfma_f32_16x16x32_bf16 a[0:3], v[140:143], v[76:79], a[0:3]
  s_waitcnt vmcnt(0)
  s_barrier
  v_readfirstlane_b32 s91, v245
  s_and_b32 s35, s91, 255
  s_lshr_b32 s36, s91, 8
  s_and_b32 s36, s36, 255
  s_lshr_b32 s37, s91, 16
  s_mov_b32 s92, s24
  s_cmp_gt_u32 s35, 3
  s_cbranch_scc1 L_cd_11
  s_cmp_eq_u32 s35, 3
  s_cbranch_scc1 L_cd_9
  s_mov_b32 s8, s64
  s_and_b32 s9, s65, 0xffff
  s_mov_b32 s10, 0x400000
  s_mov_b32 s11, 0x20000
  s_cmp_eq_u32 s35, 0
  s_cselect_b64 s[88:89], s[68:69], s[70:71]
  s_cmp_eq_u32 s35, 2
  s_cselect_b64 s[88:89], s[72:73], s[88:89]
  s_mov_b32 s12, s88
  s_and_b32 s13, s89, 0xffff
  s_mov_b32 s14, 0x800000
  s_mov_b32 s15, 0x20000
  s_lshl_b32 s91, s33, 2
  s_add_u32 s91, s91, s37
  s_mov_b32 s24, 8192
  s_mov_b32 s26, 262144
  s_lshl_b32 s20, s36, 19
  s_lshl_b32 s21, s91, 9
  s_lshl_b32 s22, s35, 24
  s_lshl_b32 s90, s36, 21
  s_add_u32 s22, s22, s90
  s_lshl_b32 s90, s91, 14
  s_add_u32 s22, s22, s90
  s_lshl_b32 s38, s36, 9
  s_add_u32 s38, s38, 28672
  s_cmp_eq_u32 s35, 0
  s_cselect_b32 s38, 8192, s38
  s_cselect_b32 s98, 1, 2
  s_mov_b32 s48, s35
  s_branch L_cd_10
L_cd_11:
  s_mov_b64 vcc, 0
  s_mov_b32 s58, 0
  s_branch L_cd_12
L_cd_9:
  s_mov_b32 s8, s78
  s_and_b32 s9, s79, 0xffff
  s_mov_b32 s10, 0x400000
  s_mov_b32 s11, 0x20000
  s_mov_b32 s12, s80
  s_and_b32 s13, s81, 0xffff
  s_mov_b32 s14, 0x600000
  s_mov_b32 s15, 0x20000
  s_lshl_b32 s91, s37, 2
  s_add_u32 s91, s91, s33
  s_mov_b32 s24, 6144
  s_mov_b32 s26, 65536
  s_lshl_b32 s20, s36, 19
  s_lshl_b32 s21, s91, 9
  s_lshl_b32 s22, s37, 22
  s_lshl_b32 s90, s36, 19
  s_add_u32 s22, s22, s90
  s_lshl_b32 s90, s33, 14
  s_add_u32 s22, s22, s90
  s_add_u32 s22, s22, 0x4000000
  s_mov_b32 s38, 12288
  s_mov_b32 s48, s37
  s_mov_b32 s98, 1
L_cd_10:
  s_lshl_b32 s90, s36, 9
  s_add_u32 s38, s38, s90
  s_lshl_b32 s90, s33, 7
  s_add_u32 s38, s38, s90
  s_mov_b32 s23, 2048
  s_mov_b32 s25, 8
  s_mov_b64 vcc, -1
  s_sub_i32 s92, s24, s92
  s_lshl_b32 s51, s24, 6
  v_mul_i32_i24 v38, s92, v174
  s_mul_i32 s92, s92, 2
  s_mov_b32 s93, 0
  v_add3_u32 v10, v10, v38, s93
  s_add_u32 s93, s93, s92
  v_add3_u32 v11, v11, v38, s93
  s_add_u32 s93, s93, s92
  v_add3_u32 v12, v12, v38, s93
  s_add_u32 s93, s93, s92
  v_add3_u32 v13, v13, v38, s93
  s_add_u32 s93, s93, s92
  v_add3_u32 v14, v14, v38, s93
  s_add_u32 s93, s93, s92
  v_add3_u32 v15, v15, v38, s93
  s_add_u32 s93, s93, s92
  v_add3_u32 v16, v16, v38, s93
  s_add_u32 s93, s93, s92
  v_add3_u32 v17, v17, v38, s93
  s_add_u32 s93, s93, s92
L_cd_12:
  s_add_u32 m0, s52, 0
  v_mfma_f32_16x16x32_bf16 a[4:7], v[144:147], v[76:79], a[4:7]
  s_cbranch_vccz L_gd_13
  buffer_load_dwordx4 v2, s[8:11], s20 offen  lds
L_gd_13:
  ds_read_b128 v[44:47], v20 offset:0
  v_mfma_f32_16x16x32_bf16 a[8:11], v[148:151], v[76:79], a[8:11]
  v_mfma_f32_16x16x32_bf16 a[12:15], v[152:155], v[76:79], a[12:15]
  ds_read_b64_tr_b16 v[108:109], v30 offset:32768
  s_add_u32 m0, s53, 0
  v_mfma_f32_16x16x32_bf16 a[16:19], v[156:159], v[76:79], a[16:19]
  s_cbranch_vccz L_gd_14
  buffer_load_dwordx4 v10, s[12:15], s21 offen  lds
L_gd_14:
  v_mfma_f32_16x16x32_bf16 a[20:23], v[160:163], v[76:79], a[20:23]
  ds_read_b64_tr_b16 v[110:111], v30 offset:34816
  v_mfma_f32_16x16x32_bf16 a[24:27], v[164:167], v[76:79], a[24:27]
  v_mfma_f32_16x16x32_bf16 a[28:31], v[168:171], v[76:79], a[28:31]
  ds_read_b128 v[48:51], v20 offset:2048
  s_add_u32 m0, s52, 1024
  v_mfma_f32_16x16x32_bf16 a[32:35], v[140:143], v[80:83], a[32:35]
  s_cbranch_vccz L_gd_15
  buffer_load_dwordx4 v3, s[8:11], s20 offen  lds
L_gd_15:
  v_mfma_f32_16x16x32_bf16 a[36:39], v[144:147], v[80:83], a[36:39]
  ds_read_b64_tr_b16 v[112:113], v31 offset:32768
  v_mfma_f32_16x16x32_bf16 a[40:43], v[148:151], v[80:83], a[40:43]
  v_mfma_f32_16x16x32_bf16 a[44:47], v[152:155], v[80:83], a[44:47]
  ds_read_b64_tr_b16 v[114:115], v31 offset:34816
  s_add_u32 m0, s53, 1024
  v_mfma_f32_16x16x32_bf16 a[48:51], v[156:159], v[80:83], a[48:51]
  s_cbranch_vccz L_gd_16
  buffer_load_dwordx4 v11, s[12:15], s21 offen  lds
L_gd_16:
  v_mfma_f32_16x16x32_bf16 a[52:55], v[160:163], v[80:83], a[52:55]
  ds_read_b128 v[52:55], v20 offset:4096
  v_mfma_f32_16x16x32_bf16 a[56:59], v[164:167], v[80:83], a[56:59]
  v_mfma_f32_16x16x32_bf16 a[60:63], v[168:171], v[80:83], a[60:63]
  ds_read_b64_tr_b16 v[116:117], v32 offset:32768
  s_add_u32 m0, s52, 2048
  v_mfma_f32_16x16x32_bf16 a[64:67], v[140:143], v[84:87], a[64:67]
  s_cbranch_vccz L_gd_17
  buffer_load_dwordx4 v4, s[8:11], s20 offen  lds
L_gd_17:
  v_mfma_f32_16x16x32_bf16 a[68:71], v[144:147], v[84:87], a[68:71]
  ds_read_b64_tr_b16 v[118:119], v32 offset:34816
  v_mfma_f32_16x16x32_bf16 a[72:75], v[148:151], v[84:87], a[72:75]
  v_mfma_f32_16x16x32_bf16 a[76:79], v[152:155], v[84:87], a[76:79]
  ds_read_b128 v[56:59], v20 offset:6144
  s_add_u32 m0, s53, 2048
  v_mfma_f32_16x16x32_bf16 a[80:83], v[156:159], v[84:87], a[80:83]
  s_cbranch_vccz L_gd_18
  buffer_load_dwordx4 v12, s[12:15], s21 offen  lds
L_gd_18:
  v_mfma_f32_16x16x32_bf16 a[84:87], v[160:163], v[84:87], a[84:87]
  ds_read_b64_tr_b16 v[120:121], v33 offset:32768
  v_mfma_f32_16x16x32_bf16 a[88:91], v[164:167], v[84:87], a[88:91]
  v_mfma_f32_16x16x32_bf16 a[92:95], v[168:171], v[84:87], a[92:95]
  ds_read_b64_tr_b16 v[122:123], v33 offset:34816
  s_add_u32 m0, s52, 3072
  v_mfma_f32_16x16x32_bf16 a[96:99], v[140:143], v[88:91], a[96:99]
  s_cbranch_vccz L_gd_19
  buffer_load_dwordx4 v5, s[8:11], s20 offen  lds
L_gd_19:
  v_mfma_f32_16x16x32_bf16 a[100:103], v[144:147], v[88:91], a[100:103]
  ds_read_b128 v[60:63], v20 offset:8192
  v_mfma_f32_16x16x32_bf16 a[104:107], v[148:151], v[88:91], a[104:107]
  v_mfma_f32_16x16x32_bf16 a[108:111], v[152:155], v[88:91], a[108:111]
  ds_read_b64_tr_b16 v[124:125], v34 offset:32768
  s_add_u32 m0, s53, 3072
  v_mfma_f32_16x16x32_bf16 a[112:115], v[156:159], v[88:91], a[112:115]
  s_cbranch_vccz L_gd_20
  buffer_load_dwordx4 v13, s[12:15], s21 offen  lds
L_gd_20:
  v_mfma_f32_16x16x32_bf16 a[116:119], v[160:163], v[88:91], a[116:119]
  ds_read_b64_tr_b16 v[126:127], v34 offset:34816
  v_mfma_f32_16x16x32_bf16 a[120:123], v[164:167], v[88:91], a[120:123]
  v_mfma_f32_16x16x32_bf16 a[124:127], v[168:171], v[88:91], a[124:127]
  ds_read_b128 v[64:67], v20 offset:10240
  s_add_u32 m0, s52, 4096
  v_mfma_f32_16x16x32_bf16 a[128:131], v[140:143], v[92:95], a[128:131]
  s_cbranch_vccz L_gd_21
  buffer_load_dwordx4 v6, s[8:11], s20 offen  lds
L_gd_21:
  v_mfma_f32_16x16x32_bf16 a[132:135], v[144:147], v[92:95], a[132:135]
  ds_read_b64_tr_b16 v[128:129], v35 offset:32768
  v_mfma_f32_16x16x32_bf16 a[136:139], v[148:151], v[92:95], a[136:139]
  v_mfma_f32_16x16x32_bf16 a[140:143], v[152:155], v[92:95], a[140:143]
  ds_read_b64_tr_b16 v[130:131], v35 offset:34816
  s_add_u32 m0, s53, 4096
  v_mfma_f32_16x16x32_bf16 a[144:147], v[156:159], v[92:95], a[144:147]
  s_cbranch_vccz L_gd_22
  buffer_load_dwordx4 v14, s[12:15], s21 offen  lds
L_gd_22:
  v_mfma_f32_16x16x32_bf16 a[148:151], v[160:163], v[92:95], a[148:151]
  ds_read_b128 v[68:71], v20 offset:12288
  v_mfma_f32_16x16x32_bf16 a[152:155], v[164:167], v[92:95], a[152:155]
  v_mfma_f32_16x16x32_bf16 a[156:159], v[168:171], v[92:95], a[156:159]
  ds_read_b64_tr_b16 v[132:133], v36 offset:32768
  s_add_u32 m0, s52, 5120
  v_mfma_f32_16x16x32_bf16 a[160:163], v[140:143], v[96:99], a[160:163]
  s_cbranch_vccz L_gd_23
  buffer_load_dwordx4 v7, s[8:11], s20 offen  lds
L_gd_23:
  v_mfma_f32_16x16x32_bf16 a[164:167], v[144:147], v[96:99], a[164:167]
  ds_read_b64_tr_b16 v[134:135], v36 offset:34816
  v_mfma_f32_16x16x32_bf16 a[168:171], v[148:151], v[96:99], a[168:171]
  v_mfma_f32_16x16x32_bf16 a[172:175], v[152:155], v[96:99], a[172:175]
  ds_read_b128 v[72:75], v20 offset:14336
  s_add_u32 m0, s53, 5120
  v_mfma_f32_16x16x32_bf16 a[176:179], v[156:159], v[96:99], a[176:179]
  s_cbranch_vccz L_gd_24
  buffer_load_dwordx4 v15, s[12:15], s21 offen  lds
L_gd_24:
  v_mfma_f32_16x16x32_bf16 a[180:183], v[160:163], v[96:99], a[180:183]
  ds_read_b64_tr_b16 v[136:137], v37 offset:32768
  v_mfma_f32_16x16x32_bf16 a[184:187], v[164:167], v[96:99], a[184:187]
  v_mfma_f32_16x16x32_bf16 a[188:191], v[168:171], v[96:99], a[188:191]
  ds_read_b64_tr_b16 v[138:139], v37 offset:34816
  s_add_u32 m0, s52, 6144
  v_mfma_f32_16x16x32_bf16 a[192:195], v[140:143], v[100:103], a[192:195]
  s_cbranch_vccz L_gd_25
  buffer_load_dwordx4 v8, s[8:11], s20 offen  lds
L_gd_25:
  v_mfma_f32_16x16x32_bf16 a[196:199], v[144:147], v[100:103], a[196:199]
  v_mfma_f32_16x16x32_bf16 a[200:203], v[148:151], v[100:103], a[200:203]
  v_mfma_f32_16x16x32_bf16 a[204:207], v[152:155], v[100:103], a[204:207]
  s_add_u32 m0, s53, 6144
  v_mfma_f32_16x16x32_bf16 a[208:211], v[156:159], v[100:103], a[208:211]
  s_cbranch_vccz L_gd_26
  buffer_load_dwordx4 v16, s[12:15], s21 offen  lds
L_gd_26:
  v_mfma_f32_16x16x32_bf16 a[212:215], v[160:163], v[100:103], a[212:215]
  v_mfma_f32_16x16x32_bf16 a[216:219], v[164:167], v[100:103], a[216:219]
  v_mfma_f32_16x16x32_bf16 a[220:223], v[168:171], v[100:103], a[220:223]
  s_add_u32 m0, s52, 7168
  v_mfma_f32_16x16x32_bf16 a[224:227], v[140:143], v[104:107], a[224:227]
  s_cbranch_vccz L_gd_27
  buffer_load_dwordx4 v9, s[8:11], s20 offen  lds
L_gd_27:
  v_mfma_f32_16x16x32_bf16 a[228:231], v[144:147], v[104:107], a[228:231]
  v_mfma_f32_16x16x32_bf16 a[232:235], v[148:151], v[104:107], a[232:235]
  v_mfma_f32_16x16x32_bf16 a[236:239], v[152:155], v[104:107], a[236:239]
  s_add_u32 m0, s53, 7168
  v_mfma_f32_16x16x32_bf16 a[240:243], v[156:159], v[104:107], a[240:243]
  s_cbranch_vccz L_gd_28
  buffer_load_dwordx4 v17, s[12:15], s21 offen  lds
  s_add_u32 s20, s20, 128
  s_add_u32 s21, s21, s51
L_gd_28:
  v_mfma_f32_16x16x32_bf16 a[244:247], v[160:163], v[104:107], a[244:247]
  v_mfma_f32_16x16x32_bf16 a[248:251], v[164:167], v[104:107], a[248:251]
  v_mfma_f32_16x16x32_bf16 a[252:255], v[168:171], v[104:107], a[252:255]
  s_waitcnt lgkmcnt(0)
  v_mfma_f32_16x16x32_bf16 a[0:3], v[108:111], v[44:47], a[0:3]
  ds_read_b128 v[76:79], v21 offset:0
  v_mfma_f32_16x16x32_bf16 a[4:7], v[112:115], v[44:47], a[4:7]
  v_mfma_f32_16x16x32_bf16 a[8:11], v[116:119], v[44:47], a[8:11]
  ds_read_b64_tr_b16 v[140:141], v30 offset:49152
  v_mfma_f32_16x16x32_bf16 a[12:15], v[120:123], v[44:47], a[12:15]
  v_mfma_f32_16x16x32_bf16 a[16:19], v[124:127], v[44:47], a[16:19]
  ds_read_b64_tr_b16 v[142:143], v30 offset:51200
  v_mfma_f32_16x16x32_bf16 a[20:23], v[128:131], v[44:47], a[20:23]
  v_mfma_f32_16x16x32_bf16 a[24:27], v[132:135], v[44:47], a[24:27]
  ds_read_b128 v[80:83], v21 offset:2048
  v_mfma_f32_16x16x32_bf16 a[28:31], v[136:139], v[44:47], a[28:31]
  v_mfma_f32_16x16x32_bf16 a[32:35], v[108:111], v[48:51], a[32:35]
  ds_read_b64_tr_b16 v[144:145], v31 offset:49152
  v_mfma_f32_16x16x32_bf16 a[36:39], v[112:115], v[48:51], a[36:39]
  v_mfma_f32_16x16x32_bf16 a[40:43], v[116:119], v[48:51], a[40:43]
  ds_read_b64_tr_b16 v[146:147], v31 offset:51200
  v_mfma_f32_16x16x32_bf16 a[44:47], v[120:123], v[48:51], a[44:47]
  v_mfma_f32_16x16x32_bf16 a[48:51], v[124:127], v[48:51], a[48:51]
  ds_read_b128 v[84:87], v21 offset:4096
  v_mfma_f32_16x16x32_bf16 a[52:55], v[128:131], v[48:51], a[52:55]
  v_mfma_f32_16x16x32_bf16 a[56:59], v[132:135], v[48:51], a[56:59]
  ds_read_b64_tr_b16 v[148:149], v32 offset:49152
  v_mfma_f32_16x16x32_bf16 a[60:63], v[136:139], v[48:51], a[60:63]
  v_mfma_f32_16x16x32_bf16 a[64:67], v[108:111], v[52:55], a[64:67]
  ds_read_b64_tr_b16 v[150:151], v32 offset:51200
  v_mfma_f32_16x16x32_bf16 a[68:71], v[112:115], v[52:55], a[68:71]
  v_mfma_f32_16x16x32_bf16 a[72:75], v[116:119], v[52:55], a[72:75]
  ds_read_b128 v[88:91], v21 offset:6144
  v_mfma_f32_16x16x32_bf16 a[76:79], v[120:123], v[52:55], a[76:79]
  v_mfma_f32_16x16x32_bf16 a[80:83], v[124:127], v[52:55], a[80:83]
  ds_read_b64_tr_b16 v[152:153], v33 offset:49152
  v_mfma_f32_16x16x32_bf16 a[84:87], v[128:131], v[52:55], a[84:87]
  v_mfma_f32_16x16x32_bf16 a[88:91], v[132:135], v[52:55], a[88:91]
  ds_read_b64_tr_b16 v[154:155], v33 offset:51200
  v_mfma_f32_16x16x32_bf16 a[92:95], v[136:139], v[52:55], a[92:95]
  v_mfma_f32_16x16x32_bf16 a[96:99], v[108:111], v[56:59], a[96:99]
  ds_read_b128 v[92:95], v21 offset:8192
  v_mfma_f32_16x16x32_bf16 a[100:103], v[112:115], v[56:59], a[100:103]
  v_mfma_f32_16x16x32_bf16 a[104:107], v[116:119], v[56:59], a[104:107]
  ds_read_b64_tr_b16 v[156:157], v34 offset:49152
  v_mfma_f32_16x16x32_bf16 a[108:111], v[120:123], v[56:59], a[108:111]
  v_mfma_f32_16x16x32_bf16 a[112:115], v[124:127], v[56:59], a[112:115]
  ds_read_b64_tr_b16 v[158:159], v34 offset:51200
  v_mfma_f32_16x16x32_bf16 a[116:119], v[128:131], v[56:59], a[116:119]
  v_mfma_f32_16x16x32_bf16 a[120:123], v[132:135], v[56:59], a[120:123]
  ds_read_b128 v[96:99], v21 offset:10240
  v_mfma_f32_16x16x32_bf16 a[124:127], v[136:139], v[56:59], a[124:127]
  v_mfma_f32_16x16x32_bf16 a[128:131], v[108:111], v[60:63], a[128:131]
  ds_read_b64_tr_b16 v[160:161], v35 offset:49152
  v_mfma_f32_16x16x32_bf16 a[132:135], v[112:115], v[60:63], a[132:135]
  v_mfma_f32_16x16x32_bf16 a[136:139], v[116:119], v[60:63], a[136:139]
  ds_read_b64_tr_b16 v[162:163], v35 offset:51200
  v_mfma_f32_16x16x32_bf16 a[140:143], v[120:123], v[60:63], a[140:143]
  v_mfma_f32_16x16x32_bf16 a[144:147], v[124:127], v[60:63], a[144:147]
  ds_read_b128 v[100:103], v21 offset:12288
  v_mfma_f32_16x16x32_bf16 a[148:151], v[128:131], v[60:63], a[148:151]
  v_mfma_f32_16x16x32_bf16 a[152:155], v[132:135], v[60:63], a[152:155]
  ds_read_b64_tr_b16 v[164:165], v36 offset:49152
  v_mfma_f32_16x16x32_bf16 a[156:159], v[136:139], v[60:63], a[156:159]
  v_mfma_f32_16x16x32_bf16 a[160:163], v[108:111], v[64:67], a[160:163]
  ds_read_b64_tr_b16 v[166:167], v36 offset:51200
  v_mfma_f32_16x16x32_bf16 a[164:167], v[112:115], v[64:67], a[164:167]
  v_mfma_f32_16x16x32_bf16 a[168:171], v[116:119], v[64:67], a[168:171]
  ds_read_b128 v[104:107], v21 offset:14336
  v_mfma_f32_16x16x32_bf16 a[172:175], v[120:123], v[64:67], a[172:175]
  v_mfma_f32_16x16x32_bf16 a[176:179], v[124:127], v[64:67], a[176:179]
  ds_read_b64_tr_b16 v[168:169], v37 offset:49152
  v_mfma_f32_16x16x32_bf16 a[180:183], v[128:131], v[64:67], a[180:183]
  v_mfma_f32_16x16x32_bf16 a[184:187], v[132:135], v[64:67], a[184:187]
  ds_read_b64_tr_b16 v[170:171], v37 offset:51200
  v_mfma_f32_16x16x32_bf16 a[188:191], v[136:139], v[64:67], a[188:191]
  v_mfma_f32_16x16x32_bf16 a[192:195], v[108:111], v[68:71], a[192:195]
  v_mfma_f32_16x16x32_bf16 a[196:199], v[112:115], v[68:71], a[196:199]
  v_mfma_f32_16x16x32_bf16 a[200:203], v[116:119], v[68:71], a[200:203]
  v_mfma_f32_16x16x32_bf16 a[204:207], v[120:123], v[68:71], a[204:207]
  v_mfma_f32_16x16x32_bf16 a[208:211], v[124:127], v[68:71], a[208:211]
  v_mfma_f32_16x16x32_bf16 a[212:215], v[128:131], v[68:71], a[212:215]
  v_mfma_f32_16x16x32_bf16 a[216:219], v[132:135], v[68:71], a[216:219]
  v_mfma_f32_16x16x32_bf16 a[220:223], v[136:139], v[68:71], a[220:223]
  v_mfma_f32_16x16x32_bf16 a[224:227], v[108:111], v[72:75], a[224:227]
  v_mfma_f32_16x16x32_bf16 a[228:231], v[112:115], v[72:75], a[228:231]
  v_mfma_f32_16x16x32_bf16 a[232:235], v[116:119], v[72:75], a[232:235]
  v_mfma_f32_16x16x32_bf16 a[236:239], v[120:123], v[72:75], a[236:239]
  v_mfma_f32_16x16x32_bf16 a[240:243], v[124:127], v[72:75], a[240:243]
  v_mfma_f32_16x16x32_bf16 a[244:247], v[128:131], v[72:75], a[244:247]
  v_mfma_f32_16x16x32_bf16 a[248:251], v[132:135], v[72:75], a[248:251]
  v_mfma_f32_16x16x32_bf16 a[252:255], v[136:139], v[72:75], a[252:255]
  s_waitcnt lgkmcnt(0)
  v_mfma_f32_16x16x32_bf16 a[0:3], v[140:143], v[76:79], a[0:3]
  s_barrier
  s_add_u32 m0, s52, 65536
  v_mfma_f32_16x16x32_bf16 a[4:7], v[144:147], v[76:79], a[4:7]
  s_cbranch_vccz L_gd_29
  buffer_load_dwordx4 v2, s[8:11], s20 offen  lds
L_gd_29:
  v_mfma_f32_16x16x32_bf16 a[8:11], v[148:151], v[76:79], a[8:11]
  v_mfma_f32_16x16x32_bf16 a[12:15], v[152:155], v[76:79], a[12:15]
  s_add_u32 m0, s53, 65536
  v_mfma_f32_16x16x32_bf16 a[16:19], v[156:159], v[76:79], a[16:19]
  s_cbranch_vccz L_gd_30
  buffer_load_dwordx4 v10, s[12:15], s21 offen  lds
L_gd_30:
  v_mfma_f32_16x16x32_bf16 a[20:23], v[160:163], v[76:79], a[20:23]
  v_mfma_f32_16x16x32_bf16 a[24:27], v[164:167], v[76:79], a[24:27]
  v_mfma_f32_16x16x32_bf16 a[28:31], v[168:171], v[76:79], a[28:31]
  s_add_u32 m0, s52, 66560
  v_mfma_f32_16x16x32_bf16 a[32:35], v[140:143], v[80:83], a[32:35]
  s_cbranch_vccz L_gd_31
  buffer_load_dwordx4 v3, s[8:11], s20 offen  lds
L_gd_31:
  v_mfma_f32_16x16x32_bf16 a[36:39], v[144:147], v[80:83], a[36:39]
  v_mfma_f32_16x16x32_bf16 a[40:43], v[148:151], v[80:83], a[40:43]
  v_mfma_f32_16x16x32_bf16 a[44:47], v[152:155], v[80:83], a[44:47]
  s_add_u32 m0, s53, 66560
  v_mfma_f32_16x16x32_bf16 a[48:51], v[156:159], v[80:83], a[48:51]
  s_cbranch_vccz L_gd_32
  buffer_load_dwordx4 v11, s[12:15], s21 offen  lds
L_gd_32:
  v_mfma_f32_16x16x32_bf16 a[52:55], v[160:163], v[80:83], a[52:55]
  v_mfma_f32_16x16x32_bf16 a[56:59], v[164:167], v[80:83], a[56:59]
  v_mfma_f32_16x16x32_bf16 a[60:63], v[168:171], v[80:83], a[60:63]
  s_add_u32 m0, s52, 67584
  v_mfma_f32_16x16x32_bf16 a[64:67], v[140:143], v[84:87], a[64:67]
  s_cbranch_vccz L_gd_33
  buffer_load_dwordx4 v4, s[8:11], s20 offen  lds
L_gd_33:
  v_mfma_f32_16x16x32_bf16 a[68:71], v[144:147], v[84:87], a[68:71]
  v_mfma_f32_16x16x32_bf16 a[72:75], v[148:151], v[84:87], a[72:75]
  v_mfma_f32_16x16x32_bf16 a[76:79], v[152:155], v[84:87], a[76:79]
  s_add_u32 m0, s53, 67584
  v_mfma_f32_16x16x32_bf16 a[80:83], v[156:159], v[84:87], a[80:83]
  s_cbranch_vccz L_gd_34
  buffer_load_dwordx4 v12, s[12:15], s21 offen  lds
L_gd_34:
  v_mfma_f32_16x16x32_bf16 a[84:87], v[160:163], v[84:87], a[84:87]
  v_mfma_f32_16x16x32_bf16 a[88:91], v[164:167], v[84:87], a[88:91]
  v_mfma_f32_16x16x32_bf16 a[92:95], v[168:171], v[84:87], a[92:95]
  s_add_u32 m0, s52, 68608
  v_mfma_f32_16x16x32_bf16 a[96:99], v[140:143], v[88:91], a[96:99]
  s_cbranch_vccz L_gd_35
  buffer_load_dwordx4 v5, s[8:11], s20 offen  lds
L_gd_35:
  v_mfma_f32_16x16x32_bf16 a[100:103], v[144:147], v[88:91], a[100:103]
  v_mfma_f32_16x16x32_bf16 a[104:107], v[148:151], v[88:91], a[104:107]
  v_mfma_f32_16x16x32_bf16 a[108:111], v[152:155], v[88:91], a[108:111]
  s_add_u32 m0, s53, 68608
  v_mfma_f32_16x16x32_bf16 a[112:115], v[156:159], v[88:91], a[112:115]
  s_cbranch_vccz L_gd_36
  buffer_load_dwordx4 v13, s[12:15], s21 offen  lds
L_gd_36:
  v_mfma_f32_16x16x32_bf16 a[116:119], v[160:163], v[88:91], a[116:119]
  v_mfma_f32_16x16x32_bf16 a[120:123], v[164:167], v[88:91], a[120:123]
  v_mfma_f32_16x16x32_bf16 a[124:127], v[168:171], v[88:91], a[124:127]
  s_add_u32 m0, s52, 69632
  v_mfma_f32_16x16x32_bf16 a[128:131], v[140:143], v[92:95], a[128:131]
  s_cbranch_vccz L_gd_37
  buffer_load_dwordx4 v6, s[8:11], s20 offen  lds
L_gd_37:
  v_mfma_f32_16x16x32_bf16 a[132:135], v[144:147], v[92:95], a[132:135]
  v_mfma_f32_16x16x32_bf16 a[136:139], v[148:151], v[92:95], a[136:139]
  v_mfma_f32_16x16x32_bf16 a[140:143], v[152:155], v[92:95], a[140:143]
  s_add_u32 m0, s53, 69632
  v_mfma_f32_16x16x32_bf16 a[144:147], v[156:159], v[92:95], a[144:147]
  s_cbranch_vccz L_gd_38
  buffer_load_dwordx4 v14, s[12:15], s21 offen  lds
L_gd_38:
  v_mfma_f32_16x16x32_bf16 a[148:151], v[160:163], v[92:95], a[148:151]
  v_mfma_f32_16x16x32_bf16 a[152:155], v[164:167], v[92:95], a[152:155]
  v_mfma_f32_16x16x32_bf16 a[156:159], v[168:171], v[92:95], a[156:159]
  s_add_u32 m0, s52, 70656
  v_mfma_f32_16x16x32_bf16 a[160:163], v[140:143], v[96:99], a[160:163]
  s_cbranch_vccz L_gd_39
  buffer_load_dwordx4 v7, s[8:11], s20 offen  lds
L_gd_39:
  v_mfma_f32_16x16x32_bf16 a[164:167], v[144:147], v[96:99], a[164:167]
  v_mfma_f32_16x16x32_bf16 a[168:171], v[148:151], v[96:99], a[168:171]
  v_mfma_f32_16x16x32_bf16 a[172:175], v[152:155], v[96:99], a[172:175]
  s_add_u32 m0, s53, 70656
  v_mfma_f32_16x16x32_bf16 a[176:179], v[156:159], v[96:99], a[176:179]
  s_cbranch_vccz L_gd_40
  buffer_load_dwordx4 v15, s[12:15], s21 offen  lds
L_gd_40:
  v_mfma_f32_16x16x32_bf16 a[180:183], v[160:163], v[96:99], a[180:183]
  v_mfma_f32_16x16x32_bf16 a[184:187], v[164:167], v[96:99], a[184:187]
  v_mfma_f32_16x16x32_bf16 a[188:191], v[168:171], v[96:99], a[188:191]
  s_add_u32 m0, s52, 71680
  v_mfma_f32_16x16x32_bf16 a[192:195], v[140:143], v[100:103], a[192:195]
  s_cbranch_vccz L_gd_41
  buffer_load_dwordx4 v8, s[8:11], s20 offen  lds
L_gd_41:
  v_mfma_f32_16x16x32_bf16 a[196:199], v[144:147], v[100:103], a[196:199]
  v_mfma_f32_16x16x32_bf16 a[200:203], v[148:151], v[100:103], a[200:203]
  v_mfma_f32_16x16x32_bf16 a[204:207], v[152:155], v[100:103], a[204:207]
  s_add_u32 m0, s53, 71680
  v_mfma_f32_16x16x32_bf16 a[208:211], v[156:159], v[100:103], a[208:211]
  s_cbranch_vccz L_gd_42
  buffer_load_dwordx4 v16, s[12:15], s21 offen  lds
L_gd_42:
  v_mfma_f32_16x16x32_bf16 a[212:215], v[160:163], v[100:103], a[212:215]
  v_mfma_f32_16x16x32_bf16 a[216:219], v[164:167], v[100:103], a[216:219]
  v_mfma_f32_16x16x32_bf16 a[220:223], v[168:171], v[100:103], a[220:223]
  s_add_u32 m0, s52, 72704
  v_mfma_f32_16x16x32_bf16 a[224:227], v[140:143], v[104:107], a[224:227]
  s_cbranch_vccz L_gd_43
  buffer_load_dwordx4 v9, s[8:11], s20 offen  lds
L_gd_43:
  v_mfma_f32_16x16x32_bf16 a[228:231], v[144:147], v[104:107], a[228:231]
  v_mfma_f32_16x16x32_bf16 a[232:235], v[148:151], v[104:107], a[232:235]
  v_mfma_f32_16x16x32_bf16 a[236:239], v[152:155], v[104:107], a[236:239]
  s_add_u32 m0, s53, 72704
  v_mfma_f32_16x16x32_bf16 a[240:243], v[156:159], v[104:107], a[240:243]
  s_cbranch_vccz L_gd_44
  buffer_load_dwordx4 v17, s[12:15], s21 offen  lds
  s_add_u32 s20, s20, 128
  s_add_u32 s21, s21, s51
L_gd_44:
  v_mfma_f32_16x16x32_bf16 a[244:247], v[160:163], v[104:107], a[244:247]
  v_mfma_f32_16x16x32_bf16 a[248:251], v[164:167], v[104:107], a[248:251]
  v_mfma_f32_16x16x32_bf16 a[252:255], v[168:171], v[104:107], a[252:255]
  s_cmp_eq_u32 s58, 1
  s_cbranch_scc1 L_epi
  s_branch L_have1
L_g1_cw:
  s_mov_b64 exec, 1
  ds_write_b32 v175, v244
  s_mov_b64 exec, -1
  s_branch L_g1_cwb
L_g1_cr:
  ds_read_b32 v246, v241
  s_cmp_eq_u32 s25, 1
  s_cbranch_scc1 L_g1_crb
  s_cmp_lg_u32 s32, 0
  s_cbranch_scc1 L_rq_45
  s_cmp_eq_u32 s39, 0
  s_cbranch_scc1 L_rq_45
  s_lshl_b32 s99, s33, 7
  s_add_u32 s99, s99, 0x3d00200
  v_mov_b32 v244, 1
  v_mov_b32 v245, 0
  s_mov_b64 exec, 1
  buffer_atomic_add v244, v245, s[4:7], s99 offen sc0 sc1
  s_mov_b64 exec, -1
L_rq_45:
  s_branch L_g1_crb
L_g2:
  s_waitcnt vmcnt(16)
  s_barrier
  ds_read_b128 v[44:47], v18 offset:0
  ds_read_b64_tr_b16 v[108:109], v22 offset:32768
  ds_read_b64_tr_b16 v[110:111], v22 offset:34816
  ds_read_b128 v[48:51], v18 offset:2048
  ds_read_b64_tr_b16 v[112:113], v23 offset:32768
  ds_read_b64_tr_b16 v[114:115], v23 offset:34816
  ds_read_b128 v[52:55], v18 offset:4096
  ds_read_b64_tr_b16 v[116:117], v24 offset:32768
  ds_read_b64_tr_b16 v[118:119], v24 offset:34816
  ds_read_b128 v[56:59], v18 offset:6144
  ds_read_b64_tr_b16 v[120:121], v25 offset:32768
  ds_read_b64_tr_b16 v[122:123], v25 offset:34816
  ds_read_b128 v[60:63], v18 offset:8192
  ds_read_b64_tr_b16 v[124:125], v26 offset:32768
  ds_read_b64_tr_b16 v[126:127], v26 offset:34816
  ds_read_b128 v[64:67], v18 offset:10240
  ds_read_b64_tr_b16 v[128:129], v27 offset:32768
  ds_read_b64_tr_b16 v[130:131], v27 offset:34816
  ds_read_b128 v[68:71], v18 offset:12288
  ds_read_b64_tr_b16 v[132:133], v28 offset:32768
  ds_read_b64_tr_b16 v[134:135], v28 offset:34816
  ds_read_b128 v[72:75], v18 offset:14336
  ds_read_b64_tr_b16 v[136:137], v29 offset:32768
  ds_read_b64_tr_b16 v[138:139], v29 offset:34816
  s_sub_u32 s25, s25, 1
  s_waitcnt lgkmcnt(0)
  s_nop 0
  v_mfma_f32_16x16x32_bf16 a[0:3], v[44:47], v[108:111], 0
  buffer_store_dwordx4 v[176:179], v172, s[4:7], s46 offen offset:0 sc1
  ds_read_b128 v[76:79], v19 offset:0
  v_mfma_f32_16x16x32_bf16 a[4:7], v[44:47], v[112:115], 0
  v_mfma_f32_16x16x32_bf16 a[8:11], v[44:47], v[116:119], 0
  ds_read_b64_tr_b16 v[140:141], v22 offset:49152
  v_mfma_f32_16x16x32_bf16 a[12:15], v[44:47], v[120:123], 0
  s_nop 0
  v_mfma_f32_16x16x32_bf16 a[16:19], v[44:47], v[124:127], 0
  buffer_store_dwordx4 v[180:183], v172, s[4:7], s46 offen offset:1024 sc1
  ds_read_b64_tr_b16 v[142:143], v22 offset:51200
  v_mfma_f32_16x16x32_bf16 a[20:23], v[44:47], v[128:131], 0
  v_mfma_f32_16x16x32_bf16 a[24:27], v[44:47], v[132:135], 0
  ds_read_b128 v[80:83], v19 offset:2048
  v_mfma_f32_16x16x32_bf16 a[28:31], v[44:47], v[136:139], 0
  s_nop 0
  v_mfma_f32_16x16x32_bf16 a[32:35], v[48:51], v[108:111], 0
  buffer_store_dwordx4 v[184:187], v172, s[4:7], s46 offen offset:2048 sc1
  ds_read_b64_tr_b16 v[144:145], v23 offset:49152
  v_mfma_f32_16x16x32_bf16 a[36:39], v[48:51], v[112:115], 0
  v_mfma_f32_16x16x32_bf16 a[40:43], v[48:51], v[116:119], 0
  ds_read_b64_tr_b16 v[146:147], v23 offset:51200
  v_mfma_f32_16x16x32_bf16 a[44:47], v[48:51], v[120:123], 0
  s_nop 0
  v_mfma_f32_16x16x32_bf16 a[48:51], v[48:51], v[124:127], 0
  buffer_store_dwordx4 v[188:191], v172, s[4:7], s46 offen offset:3072 sc1
  ds_read_b128 v[84:87], v19 offset:4096
  v_mfma_f32_16x16x32_bf16 a[52:55], v[48:51], v[128:131], 0
  v_mfma_f32_16x16x32_bf16 a[56:59], v[48:51], v[132:135], 0
  ds_read_b64_tr_b16 v[148:149], v24 offset:49152
  v_mfma_f32_16x16x32_bf16 a[60:63], v[48:51], v[136:139], 0
  s_nop 0
  v_mfma_f32_16x16x32_bf16 a[64:67], v[52:55], v[108:111], 0
  buffer_store_dwordx4 v[192:195], v173, s[4:7], s46 offen offset:0 sc1
  ds_read_b64_tr_b16 v[150:151], v24 offset:51200
  v_mfma_f32_16x16x32_bf16 a[68:71], v[52:55], v[112:115], 0
  v_mfma_f32_16x16x32_bf16 a[72:75], v[52:55], v[116:119], 0
  ds_read_b128 v[88:91], v19 offset:6144
  v_mfma_f32_16x16x32_bf16 a[76:79], v[52:55], v[120:123], 0
  s_nop 0
  v_mfma_f32_16x16x32_bf16 a[80:83], v[52:55], v[124:127], 0
  buffer_store_dwordx4 v[196:199], v173, s[4:7], s46 offen offset:1024 sc1
  ds_read_b64_tr_b16 v[152:153], v25 offset:49152
  v_mfma_f32_16x16x32_bf16 a[84:87], v[52:55], v[128:131], 0
  v_mfma_f32_16x16x32_bf16 a[88:91], v[52:55], v[132:135], 0
  ds_read_b64_tr_b16 v[154:155], v25 offset:51200
  v_mfma_f32_16x16x32_bf16 a[92:95], v[52:55], v[136:139], 0
  s_nop 0
  v_mfma_f32_16x16x32_bf16 a[96:99], v[56:59], v[108:111], 0
  buffer_store_dwordx4 v[200:203], v173, s[4:7], s46 offen offset:2048 sc1
  ds_read_b128 v[92:95], v19 offset:8192
  v_mfma_f32_16x16x32_bf16 a[100:103], v[56:59], v[112:115], 0
  v_mfma_f32_16x16x32_bf16 a[104:107], v[56:59], v[116:119], 0
  ds_read_b64_tr_b16 v[156:157], v26 offset:49152
  v_mfma_f32_16x16x32_bf16 a[108:111], v[56:59], v[120:123], 0
  s_nop 0
  v_mfma_f32_16x16x32_bf16 a[112:115], v[56:59], v[124:127], 0
  buffer_store_dwordx4 v[204:207], v173, s[4:7], s46 offen offset:3072 sc1
  ds_read_b64_tr_b16 v[158:159], v26 offset:51200
  v_mfma_f32_16x16x32_bf16 a[116:119], v[56:59], v[128:131], 0
  v_mfma_f32_16x16x32_bf16 a[120:123], v[56:59], v[132:135], 0
  ds_read_b128 v[96:99], v19 offset:10240
  v_mfma_f32_16x16x32_bf16 a[124:127], v[56:59], v[136:139], 0
  s_nop 0
  v_mfma_f32_16x16x32_bf16 a[128:131], v[60:63], v[108:111], 0
  buffer_store_dwordx4 v[208:211], v172, s[4:7], s47 offen offset:0 sc1
  ds_read_b64_tr_b16 v[160:161], v27 offset:49152
  v_mfma_f32_16x16x32_bf16 a[132:135], v[60:63], v[112:115], 0
  v_mfma_f32_16x16x32_bf16 a[136:139], v[60:63], v[116:119], 0
  ds_read_b64_tr_b16 v[162:163], v27 offset:51200
  v_mfma_f32_16x16x32_bf16 a[140:143], v[60:63], v[120:123], 0
  s_nop 0
  v_mfma_f32_16x16x32_bf16 a[144:147], v[60:63], v[124:127], 0
  buffer_store_dwordx4 v[212:215], v172, s[4:7], s47 offen offset:1024 sc1
  ds_read_b128 v[100:103], v19 offset:12288
  v_mfma_f32_16x16x32_bf16 a[148:151], v[60:63], v[128:131], 0
  v_mfma_f32_16x16x32_bf16 a[152:155], v[60:63], v[132:135], 0
  ds_read_b64_tr_b16 v[164:165], v28 offset:49152
  v_mfma_f32_16x16x32_bf16 a[156:159], v[60:63], v[136:139], 0
  s_nop 0
  v_mfma_f32_16x16x32_bf16 a[160:163], v[64:67], v[108:111], 0
  buffer_store_dwordx4 v[216:219], v172, s[4:7], s47 offen offset:2048 sc1
  ds_read_b64_tr_b16 v[166:167], v28 offset:51200
  v_mfma_f32_16x16x32_bf16 a[164:167], v[64:67], v[112:115], 0
  v_mfma_f32_16x16x32_bf16 a[168:171], v[64:67], v[116:119], 0
  ds_read_b128 v[104:107], v19 offset:14336
  v_mfma_f32_16x16x32_bf16 a[172:175], v[64:67], v[120:123], 0
  s_nop 0
  v_mfma_f32_16x16x32_bf16 a[176:179], v[64:67], v[124:127], 0
  buffer_store_dwordx4 v[220:223], v172, s[4:7], s47 offen offset:3072 sc1
  ds_read_b64_tr_b16 v[168:169], v29 offset:49152
  v_mfma_f32_16x16x32_bf16 a[180:183], v[64:67], v[128:131], 0
  v_mfma_f32_16x16x32_bf16 a[184:187], v[64:67], v[132:135], 0
  ds_read_b64_tr_b16 v[170:171], v29 offset:51200
  v_mfma_f32_16x16x32_bf16 a[188:191], v[64:67], v[136:139], 0
  s_nop 0
  v_mfma_f32_16x16x32_bf16 a[192:195], v[68:71], v[108:111], 0
  buffer_store_dwordx4 v[224:227], v173, s[4:7], s47 offen offset:0 sc1
  v_mfma_f32_16x16x32_bf16 a[196:199], v[68:71], v[112:115], 0
  v_mfma_f32_16x16x32_bf16 a[200:203], v[68:71], v[116:119], 0
  v_mfma_f32_16x16x32_bf16 a[204:207], v[68:71], v[120:123], 0
  s_nop 0
  v_mfma_f32_16x16x32_bf16 a[208:211], v[68:71], v[124:127], 0
  buffer_store_dwordx4 v[228:231], v173, s[4:7], s47 offen offset:1024 sc1
  v_mfma_f32_16x16x32_bf16 a[212:215], v[68:71], v[128:131], 0
  v_mfma_f32_16x16x32_bf16 a[216:219], v[68:71], v[132:135], 0
  v_mfma_f32_16x16x32_bf16 a[220:223], v[68:71], v[136:139], 0
  s_nop 0
  v_mfma_f32_16x16x32_bf16 a[224:227], v[72:75], v[108:111], 0
  buffer_store_dwordx4 v[232:235], v173, s[4:7], s47 offen offset:2048 sc1
  v_mfma_f32_16x16x32_bf16 a[228:231], v[72:75], v[112:115], 0
  v_mfma_f32_16x16x32_bf16 a[232:235], v[72:75], v[116:119], 0
  v_mfma_f32_16x16x32_bf16 a[236:239], v[72:75], v[120:123], 0
  s_nop 0
  v_mfma_f32_16x16x32_bf16 a[240:243], v[72:75], v[124:127], 0
  buffer_store_dwordx4 v[236:239], v173, s[4:7], s47 offen offset:3072 sc1
  v_mfma_f32_16x16x32_bf16 a[244:247], v[72:75], v[128:131], 0
  v_mfma_f32_16x16x32_bf16 a[248:251], v[72:75], v[132:135], 0
  v_mfma_f32_16x16x32_bf16 a[252:255], v[72:75], v[136:139], 0
  s_waitcnt lgkmcnt(0)
  v_mfma_f32_16x16x32_bf16 a[0:3], v[76:79], v[140:143], a[0:3]
  s_waitcnt vmcnt(16)
  s_barrier
  s_add_u32 m0, s52, 0
  v_mfma_f32_16x16x32_bf16 a[4:7], v[76:79], v[144:147], a[4:7]
  buffer_load_dwordx4 v2, s[8:11], s20 offen  lds
  ds_read_b128 v[44:47], v20 offset:0
  v_mfma_f32_16x16x32_bf16 a[8:11], v[76:79], v[148:151], a[8:11]
  v_mfma_f32_16x16x32_bf16 a[12:15], v[76:79], v[152:155], a[12:15]
  ds_read_b64_tr_b16 v[108:109], v30 offset:32768
  s_add_u32 m0, s53, 0
  v_mfma_f32_16x16x32_bf16 a[16:19], v[76:79], v[156:159], a[16:19]
  buffer_load_dwordx4 v10, s[12:15], s21 offen  lds
  v_mfma_f32_16x16x32_bf16 a[20:23], v[76:79], v[160:163], a[20:23]
  ds_read_b64_tr_b16 v[110:111], v30 offset:34816
  v_mfma_f32_16x16x32_bf16 a[24:27], v[76:79], v[164:167], a[24:27]
  v_mfma_f32_16x16x32_bf16 a[28:31], v[76:79], v[168:171], a[28:31]
  ds_read_b128 v[48:51], v20 offset:2048
  s_add_u32 m0, s52, 1024
  v_mfma_f32_16x16x32_bf16 a[32:35], v[80:83], v[140:143], a[32:35]
  buffer_load_dwordx4 v3, s[8:11], s20 offen  lds
  v_mfma_f32_16x16x32_bf16 a[36:39], v[80:83], v[144:147], a[36:39]
  ds_read_b64_tr_b16 v[112:113], v31 offset:32768
  v_mfma_f32_16x16x32_bf16 a[40:43], v[80:83], v[148:151], a[40:43]
  v_mfma_f32_16x16x32_bf16 a[44:47], v[80:83], v[152:155], a[44:47]
  ds_read_b64_tr_b16 v[114:115], v31 offset:34816
  s_add_u32 m0, s53, 1024
  v_mfma_f32_16x16x32_bf16 a[48:51], v[80:83], v[156:159], a[48:51]
  buffer_load_dwordx4 v11, s[12:15], s21 offen  lds
  v_mfma_f32_16x16x32_bf16 a[52:55], v[80:83], v[160:163], a[52:55]
  ds_read_b128 v[52:55], v20 offset:4096
  v_mfma_f32_16x16x32_bf16 a[56:59], v[80:83], v[164:167], a[56:59]
  s_add_u32 m0, s52, 2048
  v_mfma_f32_16x16x32_bf16 a[60:63], v[80:83], v[168:171], a[60:63]
  buffer_load_dwordx4 v4, s[8:11], s20 offen  lds
  ds_read_b64_tr_b16 v[116:117], v32 offset:32768
  v_mfma_f32_16x16x32_bf16 a[64:67], v[84:87], v[140:143], a[64:67]
  v_mfma_f32_16x16x32_bf16 a[68:71], v[84:87], v[144:147], a[68:71]
  ds_read_b64_tr_b16 v[118:119], v32 offset:34816
  v_mfma_f32_16x16x32_bf16 a[72:75], v[84:87], v[148:151], a[72:75]
  s_add_u32 m0, s53, 2048
  v_mfma_f32_16x16x32_bf16 a[76:79], v[84:87], v[152:155], a[76:79]
  buffer_load_dwordx4 v12, s[12:15], s21 offen  lds
  ds_read_b128 v[56:59], v20 offset:6144
  v_mfma_f32_16x16x32_bf16 a[80:83], v[84:87], v[156:159], a[80:83]
  v_mfma_f32_16x16x32_bf16 a[84:87], v[84:87], v[160:163], a[84:87]
  ds_read_b64_tr_b16 v[120:121], v33 offset:32768
  v_mfma_f32_16x16x32_bf16 a[88:91], v[84:87], v[164:167], a[88:91]
  s_add_u32 m0, s52, 3072
  v_mfma_f32_16x16x32_bf16 a[92:95], v[84:87], v[168:171], a[92:95]
  buffer_load_dwordx4 v5, s[8:11], s20 offen  lds
  ds_read_b64_tr_b16 v[122:123], v33 offset:34816
  v_mfma_f32_16x16x32_bf16 a[96:99], v[88:91], v[140:143], a[96:99]
  v_mfma_f32_16x16x32_bf16 a[100:103], v[88:91], v[144:147], a[100:103]
  ds_read_b128 v[60:63], v20 offset:8192
  s_add_u32 m0, s53, 3072
  v_mfma_f32_16x16x32_bf16 a[104:107], v[88:91], v[148:151], a[104:107]
  buffer_load_dwordx4 v13, s[12:15], s21 offen  lds
  v_mfma_f32_16x16x32_bf16 a[108:111], v[88:91], v[152:155], a[108:111]
  ds_read_b64_tr_b16 v[124:125], v34 offset:32768
  v_mfma_f32_16x16x32_bf16 a[112:115], v[88:91], v[156:159], a[112:115]
  v_mfma_f32_16x16x32_bf16 a[116:119], v[88:91], v[160:163], a[116:119]
  ds_read_b64_tr_b16 v[126:127], v34 offset:34816
  s_add_u32 m0, s52, 4096
  v_mfma_f32_16x16x32_bf16 a[120:123], v[88:91], v[164:167], a[120:123]
  buffer_load_dwordx4 v6, s[8:11], s20 offen  lds
  v_mfma_f32_16x16x32_bf16 a[124:127], v[88:91], v[168:171], a[124:127]
  ds_read_b128 v[64:67], v20 offset:10240
  v_mfma_f32_16x16x32_bf16 a[128:131], v[92:95], v[140:143], a[128:131]
  v_mfma_f32_16x16x32_bf16 a[132:135], v[92:95], v[144:147], a[132:135]
  ds_read_b64_tr_b16 v[128:129], v35 offset:32768
  s_add_u32 m0, s53, 4096
  v_mfma_f32_16x16x32_bf16 a[136:139], v[92:95], v[148:151], a[136:139]
  buffer_load_dwordx4 v14, s[12:15], s21 offen  lds
  v_mfma_f32_16x16x32_bf16 a[140:143], v[92:95], v[152:155], a[140:143]
  ds_read_b64_tr_b16 v[130:131], v35 offset:34816
  v_mfma_f32_16x16x32_bf16 a[144:147], v[92:95], v[156:159], a[144:147]
  v_mfma_f32_16x16x32_bf16 a[148:151], v[92:95], v[160:163], a[148:151]
  ds_read_b128 v[68:71], v20 offset:12288
  s_add_u32 m0, s52, 5120
  v_mfma_f32_16x16x32_bf16 a[152:155], v[92:95], v[164:167], a[152:155]
  buffer_load_dwordx4 v7, s[8:11], s20 offen  lds
  v_mfma_f32_16x16x32_bf16 a[156:159], v[92:95], v[168:171], a[156:159]
  ds_read_b64_tr_b16 v[132:133], v36 offset:32768
  v_mfma_f32_16x16x32_bf16 a[160:163], v[96:99], v[140:143], a[160:163]
  s_add_u32 m0, s53, 5120
  v_mfma_f32_16x16x32_bf16 a[164:167], v[96:99], v[144:147], a[164:167]
  buffer_load_dwordx4 v15, s[12:15], s21 offen  lds
  ds_read_b64_tr_b16 v[134:135], v36 offset:34816
  v_mfma_f32_16x16x32_bf16 a[168:171], v[96:99], v[148:151], a[168:171]
  v_mfma_f32_16x16x32_bf16 a[172:175], v[96:99], v[152:155], a[172:175]
  ds_read_b128 v[72:75], v20 offset:14336
  v_mfma_f32_16x16x32_bf16 a[176:179], v[96:99], v[156:159], a[176:179]
  s_add_u32 m0, s52, 6144
  v_mfma_f32_16x16x32_bf16 a[180:183], v[96:99], v[160:163], a[180:183]
  buffer_load_dwordx4 v8, s[8:11], s20 offen  lds
  ds_read_b64_tr_b16 v[136:137], v37 offset:32768
  v_mfma_f32_16x16x32_bf16 a[184:187], v[96:99], v[164:167], a[184:187]
  v_mfma_f32_16x16x32_bf16 a[188:191], v[96:99], v[168:171], a[188:191]
  ds_read_b64_tr_b16 v[138:139], v37 offset:34816
  v_mfma_f32_16x16x32_bf16 a[192:195], v[100:103], v[140:143], a[192:195]
  s_add_u32 m0, s53, 6144
  v_mfma_f32_16x16x32_bf16 a[196:199], v[100:103], v[144:147], a[196:199]
  buffer_load_dwordx4 v16, s[12:15], s21 offen  lds
  v_mfma_f32_16x16x32_bf16 a[200:203], v[100:103], v[148:151], a[200:203]
  v_mfma_f32_16x16x32_bf16 a[204:207], v[100:103], v[152:155], a[204:207]
  s_add_u32 m0, s52, 7168
  v_mfma_f32_16x16x32_bf16 a[208:211], v[100:103], v[156:159], a[208:211]
  buffer_load_dwordx4 v9, s[8:11], s20 offen  lds
  v_mfma_f32_16x16x32_bf16 a[212:215], v[100:103], v[160:163], a[212:215]
  v_mfma_f32_16x16x32_bf16 a[216:219], v[100:103], v[164:167], a[216:219]
  v_mfma_f32_16x16x32_bf16 a[220:223], v[100:103], v[168:171], a[220:223]
  s_add_u32 m0, s53, 7168
  v_mfma_f32_16x16x32_bf16 a[224:227], v[104:107], v[140:143], a[224:227]
  buffer_load_dwordx4 v17, s[12:15], s21 offen  lds
  v_mfma_f32_16x16x32_bf16 a[228:231], v[104:107], v[144:147], a[228:231]
  v_mfma_f32_16x16x32_bf16 a[232:235], v[104:107], v[148:151], a[232:235]
  v_mfma_f32_16x16x32_bf16 a[236:239], v[104:107], v[152:155], a[236:239]
  s_add_u32 s20, s20, 128
  v_mfma_f32_16x16x32_bf16 a[240:243], v[104:107], v[156:159], a[240:243]
  s_add_u32 s21, s21, s51
  v_mfma_f32_16x16x32_bf16 a[244:247], v[104:107], v[160:163], a[244:247]
  v_mfma_f32_16x16x32_bf16 a[248:251], v[104:107], v[164:167], a[248:251]
  v_mfma_f32_16x16x32_bf16 a[252:255], v[104:107], v[168:171], a[252:255]
  s_waitcnt lgkmcnt(0)
  v_mfma_f32_16x16x32_bf16 a[0:3], v[44:47], v[108:111], a[0:3]
  ds_read_b128 v[76:79], v21 offset:0
  v_mfma_f32_16x16x32_bf16 a[4:7], v[44:47], v[112:115], a[4:7]
  v_mfma_f32_16x16x32_bf16 a[8:11], v[44:47], v[116:119], a[8:11]
  ds_read_b64_tr_b16 v[140:141], v30 offset:49152
  v_mfma_f32_16x16x32_bf16 a[12:15], v[44:47], v[120:123], a[12:15]
  v_mfma_f32_16x16x32_bf16 a[16:19], v[44:47], v[124:127], a[16:19]
  ds_read_b64_tr_b16 v[142:143], v30 offset:51200
  v_mfma_f32_16x16x32_bf16 a[20:23], v[44:47], v[128:131], a[20:23]
  v_mfma_f32_16x16x32_bf16 a[24:27], v[44:47], v[132:135], a[24:27]
  ds_read_b128 v[80:83], v21 offset:2048
  v_mfma_f32_16x16x32_bf16 a[28:31], v[44:47], v[136:139], a[28:31]
  v_mfma_f32_16x16x32_bf16 a[32:35], v[48:51], v[108:111], a[32:35]
  ds_read_b64_tr_b16 v[144:145], v31 offset:49152
  v_mfma_f32_16x16x32_bf16 a[36:39], v[48:51], v[112:115], a[36:39]
  v_mfma_f32_16x16x32_bf16 a[40:43], v[48:51], v[116:119], a[40:43]
  ds_read_b64_tr_b16 v[146:147], v31 offset:51200
  v_mfma_f32_16x16x32_bf16 a[44:47], v[48:51], v[120:123], a[44:47]
  v_mfma_f32_16x16x32_bf16 a[48:51], v[48:51], v[124:127], a[48:51]
  ds_read_b128 v[84:87], v21 offset:4096
  v_mfma_f32_16x16x32_bf16 a[52:55], v[48:51], v[128:131], a[52:55]
  v_mfma_f32_16x16x32_bf16 a[56:59], v[48:51], v[132:135], a[56:59]
  ds_read_b64_tr_b16 v[148:149], v32 offset:49152
  v_mfma_f32_16x16x32_bf16 a[60:63], v[48:51], v[136:139], a[60:63]
  v_mfma_f32_16x16x32_bf16 a[64:67], v[52:55], v[108:111], a[64:67]
  ds_read_b64_tr_b16 v[150:151], v32 offset:51200
  v_mfma_f32_16x16x32_bf16 a[68:71], v[52:55], v[112:115], a[68:71]
  v_mfma_f32_16x16x32_bf16 a[72:75], v[52:55], v[116:119], a[72:75]
  ds_read_b128 v[88:91], v21 offset:6144
  v_mfma_f32_16x16x32_bf16 a[76:79], v[52:55], v[120:123], a[76:79]
  v_mfma_f32_16x16x32_bf16 a[80:83], v[52:55], v[124:127], a[80:83]
  ds_read_b64_tr_b16 v[152:153], v33 offset:49152
  v_mfma_f32_16x16x32_bf16 a[84:87], v[52:55], v[128:131], a[84:87]
  v_mfma_f32_16x16x32_bf16 a[88:91], v[52:55], v[132:135], a[88:91]
  ds_read_b64_tr_b16 v[154:155], v33 offset:51200
  v_mfma_f32_16x16x32_bf16 a[92:95], v[52:55], v[136:139], a[92:95]
  v_mfma_f32_16x16x32_bf16 a[96:99], v[56:59], v[108:111], a[96:99]
  ds_read_b128 v[92:95], v21 offset:8192
  v_mfma_f32_16x16x32_bf16 a[100:103], v[56:59], v[112:115], a[100:103]
  v_mfma_f32_16x16x32_bf16 a[104:107], v[56:59], v[116:119], a[104:107]
  ds_read_b64_tr_b16 v[156:157], v34 offset:49152
  v_mfma_f32_16x16x32_bf16 a[108:111], v[56:59], v[120:123], a[108:111]
  v_mfma_f32_16x16x32_bf16 a[112:115], v[56:59], v[124:127], a[112:115]
  ds_read_b64_tr_b16 v[158:159], v34 offset:51200
  v_mfma_f32_16x16x32_bf16 a[116:119], v[56:59], v[128:131], a[116:119]
  v_mfma_f32_16x16x32_bf16 a[120:123], v[56:59], v[132:135], a[120:123]
  ds_read_b128 v[96:99], v21 offset:10240
  v_mfma_f32_16x16x32_bf16 a[124:127], v[56:59], v[136:139], a[124:127]
  v_mfma_f32_16x16x32_bf16 a[128:131], v[60:63], v[108:111], a[128:131]
  ds_read_b64_tr_b16 v[160:161], v35 offset:49152
  v_mfma_f32_16x16x32_bf16 a[132:135], v[60:63], v[112:115], a[132:135]
  v_mfma_f32_16x16x32_bf16 a[136:139], v[60:63], v[116:119], a[136:139]
  ds_read_b64_tr_b16 v[162:163], v35 offset:51200
  v_mfma_f32_16x16x32_bf16 a[140:143], v[60:63], v[120:123], a[140:143]
  v_mfma_f32_16x16x32_bf16 a[144:147], v[60:63], v[124:127], a[144:147]
  ds_read_b128 v[100:103], v21 offset:12288
  v_mfma_f32_16x16x32_bf16 a[148:151], v[60:63], v[128:131], a[148:151]
  v_mfma_f32_16x16x32_bf16 a[152:155], v[60:63], v[132:135], a[152:155]
  ds_read_b64_tr_b16 v[164:165], v36 offset:49152
  v_mfma_f32_16x16x32_bf16 a[156:159], v[60:63], v[136:139], a[156:159]
  v_mfma_f32_16x16x32_bf16 a[160:163], v[64:67], v[108:111], a[160:163]
  ds_read_b64_tr_b16 v[166:167], v36 offset:51200
  v_mfma_f32_16x16x32_bf16 a[164:167], v[64:67], v[112:115], a[164:167]
  v_mfma_f32_16x16x32_bf16 a[168:171], v[64:67], v[116:119], a[168:171]
  ds_read_b128 v[104:107], v21 offset:14336
  v_mfma_f32_16x16x32_bf16 a[172:175], v[64:67], v[120:123], a[172:175]
  v_mfma_f32_16x16x32_bf16 a[176:179], v[64:67], v[124:127], a[176:179]
  ds_read_b64_tr_b16 v[168:169], v37 offset:49152
  v_mfma_f32_16x16x32_bf16 a[180:183], v[64:67], v[128:131], a[180:183]
  v_mfma_f32_16x16x32_bf16 a[184:187], v[64:67], v[132:135], a[184:187]
  ds_read_b64_tr_b16 v[170:171], v37 offset:51200
  v_mfma_f32_16x16x32_bf16 a[188:191], v[64:67], v[136:139], a[188:191]
  v_mfma_f32_16x16x32_bf16 a[192:195], v[68:71], v[108:111], a[192:195]
  v_mfma_f32_16x16x32_bf16 a[196:199], v[68:71], v[112:115], a[196:199]
  v_mfma_f32_16x16x32_bf16 a[200:203], v[68:71], v[116:119], a[200:203]
  v_mfma_f32_16x16x32_bf16 a[204:207], v[68:71], v[120:123], a[204:207]
  v_mfma_f32_16x16x32_bf16 a[208:211], v[68:71], v[124:127], a[208:211]
  v_mfma_f32_16x16x32_bf16 a[212:215], v[68:71], v[128:131], a[212:215]
  v_mfma_f32_16x16x32_bf16 a[216:219], v[68:71], v[132:135], a[216:219]
  v_mfma_f32_16x16x32_bf16 a[220:223], v[68:71], v[136:139], a[220:223]
  v_mfma_f32_16x16x32_bf16 a[224:227], v[72:75], v[108:111], a[224:227]
  v_mfma_f32_16x16x32_bf16 a[228:231], v[72:75], v[112:115], a[228:231]
  v_mfma_f32_16x16x32_bf16 a[232:235], v[72:75], v[116:119], a[232:235]
  v_mfma_f32_16x16x32_bf16 a[236:239], v[72:75], v[120:123], a[236:239]
  v_mfma_f32_16x16x32_bf16 a[240:243], v[72:75], v[124:127], a[240:243]
  v_mfma_f32_16x16x32_bf16 a[244:247], v[72:75], v[128:131], a[244:247]
  v_mfma_f32_16x16x32_bf16 a[248:251], v[72:75], v[132:135], a[248:251]
  v_mfma_f32_16x16x32_bf16 a[252:255], v[72:75], v[136:139], a[252:255]
  s_waitcnt lgkmcnt(0)
  v_mfma_f32_16x16x32_bf16 a[0:3], v[76:79], v[140:143], a[0:3]
  s_waitcnt vmcnt(0)
  s_barrier
  s_cmp_eq_u32 s49, 0
  s_cbranch_scc1 L_hs_46
  s_cmp_lg_u32 s32, 0
  s_cbranch_scc1 L_sig_47
  v_mov_b32 v254, s63
  v_mov_b32 v255, 0
  v_and_b32 v254, 3, v254
  v_mbcnt_lo_u32_b32 v255, -1, 0
  v_lshlrev_b32 v255, 9, v255
  s_cmp_ge_u32 s63, 2
  s_cselect_b64 exec, 3, 1
  buffer_atomic_add v254, v255, s[4:7], s62 offen offset:0 sc1
  s_mov_b64 exec, -1
L_sig_47:
L_hs_46:
  s_add_u32 m0, s52, 65536
  v_mfma_f32_16x16x32_bf16 a[4:7], v[76:79], v[144:147], a[4:7]
  buffer_load_dwordx4 v2, s[8:11], s20 offen  lds
  ds_read_b128 v[44:47], v18 offset:0
  v_mfma_f32_16x16x32_bf16 a[8:11], v[76:79], v[148:151], a[8:11]
  v_mfma_f32_16x16x32_bf16 a[12:15], v[76:79], v[152:155], a[12:15]
  ds_read_b64_tr_b16 v[108:109], v22 offset:32768
  s_add_u32 m0, s53, 65536
  v_mfma_f32_16x16x32_bf16 a[16:19], v[76:79], v[156:159], a[16:19]
  buffer_load_dwordx4 v10, s[12:15], s21 offen  lds
  v_mfma_f32_16x16x32_bf16 a[20:23], v[76:79], v[160:163], a[20:23]
  ds_read_b64_tr_b16 v[110:111], v22 offset:34816
  v_mfma_f32_16x16x32_bf16 a[24:27], v[76:79], v[164:167], a[24:27]
  v_mfma_f32_16x16x32_bf16 a[28:31], v[76:79], v[168:171], a[28:31]
  ds_read_b128 v[48:51], v18 offset:2048
  s_add_u32 m0, s52, 66560
  v_mfma_f32_16x16x32_bf16 a[32:35], v[80:83], v[140:143], a[32:35]
  buffer_load_dwordx4 v3, s[8:11], s20 offen  lds
  v_mfma_f32_16x16x32_bf16 a[36:39], v[80:83], v[144:147], a[36:39]
  ds_read_b64_tr_b16 v[112:113], v23 offset:32768
  v_mfma_f32_16x16x32_bf16 a[40:43], v[80:83], v[148:151], a[40:43]
  v_mfma_f32_16x16x32_bf16 a[44:47], v[80:83], v[152:155], a[44:47]
  ds_read_b64_tr_b16 v[114:115], v23 offset:34816
  s_add_u32 m0, s53, 66560
  v_mfma_f32_16x16x32_bf16 a[48:51], v[80:83], v[156:159], a[48:51]
  buffer_load_dwordx4 v11, s[12:15], s21 offen  lds
  v_mfma_f32_16x16x32_bf16 a[52:55], v[80:83], v[160:163], a[52:55]
  ds_read_b128 v[52:55], v18 offset:4096
  v_mfma_f32_16x16x32_bf16 a[56:59], v[80:83], v[164:167], a[56:59]
  s_add_u32 m0, s52, 67584
  v_mfma_f32_16x16x32_bf16 a[60:63], v[80:83], v[168:171], a[60:63]
  buffer_load_dwordx4 v4, s[8:11], s20 offen  lds
  ds_read_b64_tr_b16 v[116:117], v24 offset:32768
  v_mfma_f32_16x16x32_bf16 a[64:67], v[84:87], v[140:143], a[64:67]
  v_mfma_f32_16x16x32_bf16 a[68:71], v[84:87], v[144:147], a[68:71]
  ds_read_b64_tr_b16 v[118:119], v24 offset:34816
  v_mfma_f32_16x16x32_bf16 a[72:75], v[84:87], v[148:151], a[72:75]
  s_add_u32 m0, s53, 67584
  v_mfma_f32_16x16x32_bf16 a[76:79], v[84:87], v[152:155], a[76:79]
  buffer_load_dwordx4 v12, s[12:15], s21 offen  lds
  ds_read_b128 v[56:59], v18 offset:6144
  v_mfma_f32_16x16x32_bf16 a[80:83], v[84:87], v[156:159], a[80:83]
  v_mfma_f32_16x16x32_bf16 a[84:87], v[84:87], v[160:163], a[84:87]
  ds_read_b64_tr_b16 v[120:121], v25 offset:32768
  v_mfma_f32_16x16x32_bf16 a[88:91], v[84:87], v[164:167], a[88:91]
  s_add_u32 m0, s52, 68608
  v_mfma_f32_16x16x32_bf16 a[92:95], v[84:87], v[168:171], a[92:95]
  buffer_load_dwordx4 v5, s[8:11], s20 offen  lds
  ds_read_b64_tr_b16 v[122:123], v25 offset:34816
  v_mfma_f32_16x16x32_bf16 a[96:99], v[88:91], v[140:143], a[96:99]
  v_mfma_f32_16x16x32_bf16 a[100:103], v[88:91], v[144:147], a[100:103]
  ds_read_b128 v[60:63], v18 offset:8192
  s_add_u32 m0, s53, 68608
  v_mfma_f32_16x16x32_bf16 a[104:107], v[88:91], v[148:151], a[104:107]
  buffer_load_dwordx4 v13, s[12:15], s21 offen  lds
  v_mfma_f32_16x16x32_bf16 a[108:111], v[88:91], v[152:155], a[108:111]
  ds_read_b64_tr_b16 v[124:125], v26 offset:32768
  v_mfma_f32_16x16x32_bf16 a[112:115], v[88:91], v[156:159], a[112:115]
  v_mfma_f32_16x16x32_bf16 a[116:119], v[88:91], v[160:163], a[116:119]
  ds_read_b64_tr_b16 v[126:127], v26 offset:34816
  s_add_u32 m0, s52, 69632
  v_mfma_f32_16x16x32_bf16 a[120:123], v[88:91], v[164:167], a[120:123]
  buffer_load_dwordx4 v6, s[8:11], s20 offen  lds
  v_mfma_f32_16x16x32_bf16 a[124:127], v[88:91], v[168:171], a[124:127]
  ds_read_b128 v[64:67], v18 offset:10240
  v_mfma_f32_16x16x32_bf16 a[128:131], v[92:95], v[140:143], a[128:131]
  v_mfma_f32_16x16x32_bf16 a[132:135], v[92:95], v[144:147], a[132:135]
  ds_read_b64_tr_b16 v[128:129], v27 offset:32768
  s_add_u32 m0, s53, 69632
  v_mfma_f32_16x16x32_bf16 a[136:139], v[92:95], v[148:151], a[136:139]
  buffer_load_dwordx4 v14, s[12:15], s21 offen  lds
  v_mfma_f32_16x16x32_bf16 a[140:143], v[92:95], v[152:155], a[140:143]
  ds_read_b64_tr_b16 v[130:131], v27 offset:34816
  v_mfma_f32_16x16x32_bf16 a[144:147], v[92:95], v[156:159], a[144:147]
  v_mfma_f32_16x16x32_bf16 a[148:151], v[92:95], v[160:163], a[148:151]
  ds_read_b128 v[68:71], v18 offset:12288
  s_add_u32 m0, s52, 70656
  v_mfma_f32_16x16x32_bf16 a[152:155], v[92:95], v[164:167], a[152:155]
  buffer_load_dwordx4 v7, s[8:11], s20 offen  lds
  v_mfma_f32_16x16x32_bf16 a[156:159], v[92:95], v[168:171], a[156:159]
  ds_read_b64_tr_b16 v[132:133], v28 offset:32768
  v_mfma_f32_16x16x32_bf16 a[160:163], v[96:99], v[140:143], a[160:163]
  s_add_u32 m0, s53, 70656
  v_mfma_f32_16x16x32_bf16 a[164:167], v[96:99], v[144:147], a[164:167]
  buffer_load_dwordx4 v15, s[12:15], s21 offen  lds
  ds_read_b64_tr_b16 v[134:135], v28 offset:34816
  v_mfma_f32_16x16x32_bf16 a[168:171], v[96:99], v[148:151], a[168:171]
  v_mfma_f32_16x16x32_bf16 a[172:175], v[96:99], v[152:155], a[172:175]
  ds_read_b128 v[72:75], v18 offset:14336
  v_mfma_f32_16x16x32_bf16 a[176:179], v[96:99], v[156:159], a[176:179]
  s_add_u32 m0, s52, 71680
  v_mfma_f32_16x16x32_bf16 a[180:183], v[96:99], v[160:163], a[180:183]
  buffer_load_dwordx4 v8, s[8:11], s20 offen  lds
  ds_read_b64_tr_b16 v[136:137], v29 offset:32768
  v_mfma_f32_16x16x32_bf16 a[184:187], v[96:99], v[164:167], a[184:187]
  v_mfma_f32_16x16x32_bf16 a[188:191], v[96:99], v[168:171], a[188:191]
  ds_read_b64_tr_b16 v[138:139], v29 offset:34816
  v_mfma_f32_16x16x32_bf16 a[192:195], v[100:103], v[140:143], a[192:195]
  s_add_u32 m0, s53, 71680
  v_mfma_f32_16x16x32_bf16 a[196:199], v[100:103], v[144:147], a[196:199]
  buffer_load_dwordx4 v16, s[12:15], s21 offen  lds
  v_mfma_f32_16x16x32_bf16 a[200:203], v[100:103], v[148:151], a[200:203]
  v_mfma_f32_16x16x32_bf16 a[204:207], v[100:103], v[152:155], a[204:207]
  s_add_u32 m0, s52, 72704
  v_mfma_f32_16x16x32_bf16 a[208:211], v[100:103], v[156:159], a[208:211]
  buffer_load_dwordx4 v9, s[8:11], s20 offen  lds
  v_mfma_f32_16x16x32_bf16 a[212:215], v[100:103], v[160:163], a[212:215]
  v_mfma_f32_16x16x32_bf16 a[216:219], v[100:103], v[164:167], a[216:219]
  v_mfma_f32_16x16x32_bf16 a[220:223], v[100:103], v[168:171], a[220:223]
  s_add_u32 m0, s53, 72704
  v_mfma_f32_16x16x32_bf16 a[224:227], v[104:107], v[140:143], a[224:227]
  buffer_load_dwordx4 v17, s[12:15], s21 offen  lds
  v_mfma_f32_16x16x32_bf16 a[228:231], v[104:107], v[144:147], a[228:231]
  v_mfma_f32_16x16x32_bf16 a[232:235], v[104:107], v[148:151], a[232:235]
  v_mfma_f32_16x16x32_bf16 a[236:239], v[104:107], v[152:155], a[236:239]
  s_add_u32 s20, s20, 128
  v_mfma_f32_16x16x32_bf16 a[240:243], v[104:107], v[156:159], a[240:243]
  s_add_u32 s21, s21, s51
  v_mfma_f32_16x16x32_bf16 a[244:247], v[104:107], v[160:163], a[244:247]
  v_mfma_f32_16x16x32_bf16 a[248:251], v[104:107], v[164:167], a[248:251]
  v_mfma_f32_16x16x32_bf16 a[252:255], v[104:107], v[168:171], a[252:255]
L_g2_loop:
  s_sub_u32 s25, s25, 1
  s_cmp_eq_u32 s25, 0
  s_cbranch_scc1 L_g2_fin
  s_waitcnt lgkmcnt(0)
  v_mfma_f32_16x16x32_bf16 a[0:3], v[44:47], v[108:111], a[0:3]
  ds_read_b128 v[76:79], v19 offset:0
  v_mfma_f32_16x16x32_bf16 a[4:7], v[44:47], v[112:115], a[4:7]
  v_mfma_f32_16x16x32_bf16 a[8:11], v[44:47], v[116:119], a[8:11]
  ds_read_b64_tr_b16 v[140:141], v22 offset:49152
  v_mfma_f32_16x16x32_bf16 a[12:15], v[44:47], v[120:123], a[12:15]
  v_mfma_f32_16x16x32_bf16 a[16:19], v[44:47], v[124:127], a[16:19]
  ds_read_b64_tr_b16 v[142:143], v22 offset:51200
  v_mfma_f32_16x16x32_bf16 a[20:23], v[44:47], v[128:131], a[20:23]
  v_mfma_f32_16x16x32_bf16 a[24:27], v[44:47], v[132:135], a[24:27]
  ds_read_b128 v[80:83], v19 offset:2048
  v_mfma_f32_16x16x32_bf16 a[28:31], v[44:47], v[136:139], a[28:31]
  v_mfma_f32_16x16x32_bf16 a[32:35], v[48:51], v[108:111], a[32:35]
  ds_read_b64_tr_b16 v[144:145], v23 offset:49152
  v_mfma_f32_16x16x32_bf16 a[36:39], v[48:51], v[112:115], a[36:39]
  v_mfma_f32_16x16x32_bf16 a[40:43], v[48:51], v[116:119], a[40:43]
  ds_read_b64_tr_b16 v[146:147], v23 offset:51200
  v_mfma_f32_16x16x32_bf16 a[44:47], v[48:51], v[120:123], a[44:47]
  v_mfma_f32_16x16x32_bf16 a[48:51], v[48:51], v[124:127], a[48:51]
  ds_read_b128 v[84:87], v19 offset:4096
  v_mfma_f32_16x16x32_bf16 a[52:55], v[48:51], v[128:131], a[52:55]
  v_mfma_f32_16x16x32_bf16 a[56:59], v[48:51], v[132:135], a[56:59]
  ds_read_b64_tr_b16 v[148:149], v24 offset:49152
  v_mfma_f32_16x16x32_bf16 a[60:63], v[48:51], v[136:139], a[60:63]
  v_mfma_f32_16x16x32_bf16 a[64:67], v[52:55], v[108:111], a[64:67]
  ds_read_b64_tr_b16 v[150:151], v24 offset:51200
  v_mfma_f32_16x16x32_bf16 a[68:71], v[52:55], v[112:115], a[68:71]
  v_mfma_f32_16x16x32_bf16 a[72:75], v[52:55], v[116:119], a[72:75]
  ds_read_b128 v[88:91], v19 offset:6144
  v_mfma_f32_16x16x32_bf16 a[76:79], v[52:55], v[120:123], a[76:79]
  v_mfma_f32_16x16x32_bf16 a[80:83], v[52:55], v[124:127], a[80:83]
  ds_read_b64_tr_b16 v[152:153], v25 offset:49152
  v_mfma_f32_16x16x32_bf16 a[84:87], v[52:55], v[128:131], a[84:87]
  v_mfma_f32_16x16x32_bf16 a[88:91], v[52:55], v[132:135], a[88:91]
  ds_read_b64_tr_b16 v[154:155], v25 offset:51200
  v_mfma_f32_16x16x32_bf16 a[92:95], v[52:55], v[136:139], a[92:95]
  v_mfma_f32_16x16x32_bf16 a[96:99], v[56:59], v[108:111], a[96:99]
  ds_read_b128 v[92:95], v19 offset:8192
  v_mfma_f32_16x16x32_bf16 a[100:103], v[56:59], v[112:115], a[100:103]
  v_mfma_f32_16x16x32_bf16 a[104:107], v[56:59], v[116:119], a[104:107]
  ds_read_b64_tr_b16 v[156:157], v26 offset:49152
  v_mfma_f32_16x16x32_bf16 a[108:111], v[56:59], v[120:123], a[108:111]
  v_mfma_f32_16x16x32_bf16 a[112:115], v[56:59], v[124:127], a[112:115]
  ds_read_b64_tr_b16 v[158:159], v26 offset:51200
  v_mfma_f32_16x16x32_bf16 a[116:119], v[56:59], v[128:131], a[116:119]
  v_mfma_f32_16x16x32_bf16 a[120:123], v[56:59], v[132:135], a[120:123]
  ds_read_b128 v[96:99], v19 offset:10240
  v_mfma_f32_16x16x32_bf16 a[124:127], v[56:59], v[136:139], a[124:127]
  v_mfma_f32_16x16x32_bf16 a[128:131], v[60:63], v[108:111], a[128:131]
  ds_read_b64_tr_b16 v[160:161], v27 offset:49152
  v_mfma_f32_16x16x32_bf16 a[132:135], v[60:63], v[112:115], a[132:135]
  v_mfma_f32_16x16x32_bf16 a[136:139], v[60:63], v[116:119], a[136:139]
  ds_read_b64_tr_b16 v[162:163], v27 offset:51200
  v_mfma_f32_16x16x32_bf16 a[140:143], v[60:63], v[120:123], a[140:143]
  v_mfma_f32_16x16x32_bf16 a[144:147], v[60:63], v[124:127], a[144:147]
  ds_read_b128 v[100:103], v19 offset:12288
  v_mfma_f32_16x16x32_bf16 a[148:151], v[60:63], v[128:131], a[148:151]
  v_mfma_f32_16x16x32_bf16 a[152:155], v[60:63], v[132:135], a[152:155]
  ds_read_b64_tr_b16 v[164:165], v28 offset:49152
  v_mfma_f32_16x16x32_bf16 a[156:159], v[60:63], v[136:139], a[156:159]
  v_mfma_f32_16x16x32_bf16 a[160:163], v[64:67], v[108:111], a[160:163]
  ds_read_b64_tr_b16 v[166:167], v28 offset:51200
  v_mfma_f32_16x16x32_bf16 a[164:167], v[64:67], v[112:115], a[164:167]
  v_mfma_f32_16x16x32_bf16 a[168:171], v[64:67], v[116:119], a[168:171]
  ds_read_b128 v[104:107], v19 offset:14336
  v_mfma_f32_16x16x32_bf16 a[172:175], v[64:67], v[120:123], a[172:175]
  v_mfma_f32_16x16x32_bf16 a[176:179], v[64:67], v[124:127], a[176:179]
  ds_read_b64_tr_b16 v[168:169], v29 offset:49152
  v_mfma_f32_16x16x32_bf16 a[180:183], v[64:67], v[128:131], a[180:183]
  v_mfma_f32_16x16x32_bf16 a[184:187], v[64:67], v[132:135], a[184:187]
  ds_read_b64_tr_b16 v[170:171], v29 offset:51200
  v_mfma_f32_16x16x32_bf16 a[188:191], v[64:67], v[136:139], a[188:191]
  v_mfma_f32_16x16x32_bf16 a[192:195], v[68:71], v[108:111], a[192:195]
  v_mfma_f32_16x16x32_bf16 a[196:199], v[68:71], v[112:115], a[196:199]
  v_mfma_f32_16x16x32_bf16 a[200:203], v[68:71], v[116:119], a[200:203]
  v_mfma_f32_16x16x32_bf16 a[204:207], v[68:71], v[120:123], a[204:207]
  v_mfma_f32_16x16x32_bf16 a[208:211], v[68:71], v[124:127], a[208:211]
  v_mfma_f32_16x16x32_bf16 a[212:215], v[68:71], v[128:131], a[212:215]
  v_mfma_f32_16x16x32_bf16 a[216:219], v[68:71], v[132:135], a[216:219]
  v_mfma_f32_16x16x32_bf16 a[220:223], v[68:71], v[136:139], a[220:223]
  v_mfma_f32_16x16x32_bf16 a[224:227], v[72:75], v[108:111], a[224:227]
  v_mfma_f32_16x16x32_bf16 a[228:231], v[72:75], v[112:115], a[228:231]
  v_mfma_f32_16x16x32_bf16 a[232:235], v[72:75], v[116:119], a[232:235]
  v_mfma_f32_16x16x32_bf16 a[236:239], v[72:75], v[120:123], a[236:239]
  v_mfma_f32_16x16x32_bf16 a[240:243], v[72:75], v[124:127], a[240:243]
  v_mfma_f32_16x16x32_bf16 a[244:247], v[72:75], v[128:131], a[244:247]
  v_mfma_f32_16x16x32_bf16 a[248:251], v[72:75], v[132:135], a[248:251]
  v_mfma_f32_16x16x32_bf16 a[252:255], v[72:75], v[136:139], a[252:255]
  s_waitcnt lgkmcnt(0)
  v_mfma_f32_16x16x32_bf16 a[0:3], v[76:79], v[140:143], a[0:3]
  s_waitcnt vmcnt(0)
  s_barrier
  s_add_u32 m0, s52, 0
  v_mfma_f32_16x16x32_bf16 a[4:7], v[76:79], v[144:147], a[4:7]
  buffer_load_dwordx4 v2, s[8:11], s20 offen  lds
  ds_read_b128 v[44:47], v20 offset:0
  v_mfma_f32_16x16x32_bf16 a[8:11], v[76:79], v[148:151], a[8:11]
  v_mfma_f32_16x16x32_bf16 a[12:15], v[76:79], v[152:155], a[12:15]
  ds_read_b64_tr_b16 v[108:109], v30 offset:32768
  s_add_u32 m0, s53, 0
  v_mfma_f32_16x16x32_bf16 a[16:19], v[76:79], v[156:159], a[16:19]
  buffer_load_dwordx4 v10, s[12:15], s21 offen  lds
  v_mfma_f32_16x16x32_bf16 a[20:23], v[76:79], v[160:163], a[20:23]
  ds_read_b64_tr_b16 v[110:111], v30 offset:34816
  v_mfma_f32_16x16x32_bf16 a[24:27], v[76:79], v[164:167], a[24:27]
  v_mfma_f32_16x16x32_bf16 a[28:31], v[76:79], v[168:171], a[28:31]
  ds_read_b128 v[48:51], v20 offset:2048
  s_add_u32 m0, s52, 1024
  v_mfma_f32_16x16x32_bf16 a[32:35], v[80:83], v[140:143], a[32:35]
  buffer_load_dwordx4 v3, s[8:11], s20 offen  lds
  v_mfma_f32_16x16x32_bf16 a[36:39], v[80:83], v[144:147], a[36:39]
  ds_read_b64_tr_b16 v[112:113], v31 offset:32768
  v_mfma_f32_16x16x32_bf16 a[40:43], v[80:83], v[148:151], a[40:43]
  v_mfma_f32_16x16x32_bf16 a[44:47], v[80:83], v[152:155], a[44:47]
  ds_read_b64_tr_b16 v[114:115], v31 offset:34816
  s_add_u32 m0, s53, 1024
  v_mfma_f32_16x16x32_bf16 a[48:51], v[80:83], v[156:159], a[48:51]
  buffer_load_dwordx4 v11, s[12:15], s21 offen  lds
  v_mfma_f32_16x16x32_bf16 a[52:55], v[80:83], v[160:163], a[52:55]
  ds_read_b128 v[52:55], v20 offset:4096
  v_mfma_f32_16x16x32_bf16 a[56:59], v[80:83], v[164:167], a[56:59]
  s_add_u32 m0, s52, 2048
  v_mfma_f32_16x16x32_bf16 a[60:63], v[80:83], v[168:171], a[60:63]
  buffer_load_dwordx4 v4, s[8:11], s20 offen  lds
  ds_read_b64_tr_b16 v[116:117], v32 offset:32768
  v_mfma_f32_16x16x32_bf16 a[64:67], v[84:87], v[140:143], a[64:67]
  v_mfma_f32_16x16x32_bf16 a[68:71], v[84:87], v[144:147], a[68:71]
  ds_read_b64_tr_b16 v[118:119], v32 offset:34816
  v_mfma_f32_16x16x32_bf16 a[72:75], v[84:87], v[148:151], a[72:75]
  s_add_u32 m0, s53, 2048
  v_mfma_f32_16x16x32_bf16 a[76:79], v[84:87], v[152:155], a[76:79]
  buffer_load_dwordx4 v12, s[12:15], s21 offen  lds
  ds_read_b128 v[56:59], v20 offset:6144
  v_mfma_f32_16x16x32_bf16 a[80:83], v[84:87], v[156:159], a[80:83]
  v_mfma_f32_16x16x32_bf16 a[84:87], v[84:87], v[160:163], a[84:87]
  ds_read_b64_tr_b16 v[120:121], v33 offset:32768
  v_mfma_f32_16x16x32_bf16 a[88:91], v[84:87], v[164:167], a[88:91]
  s_add_u32 m0, s52, 3072
  v_mfma_f32_16x16x32_bf16 a[92:95], v[84:87], v[168:171], a[92:95]
  buffer_load_dwordx4 v5, s[8:11], s20 offen  lds
  ds_read_b64_tr_b16 v[122:123], v33 offset:34816
  v_mfma_f32_16x16x32_bf16 a[96:99], v[88:91], v[140:143], a[96:99]
  v_mfma_f32_16x16x32_bf16 a[100:103], v[88:91], v[144:147], a[100:103]
  ds_read_b128 v[60:63], v20 offset:8192
  s_add_u32 m0, s53, 3072
  v_mfma_f32_16x16x32_bf16 a[104:107], v[88:91], v[148:151], a[104:107]
  buffer_load_dwordx4 v13, s[12:15], s21 offen  lds
  v_mfma_f32_16x16x32_bf16 a[108:111], v[88:91], v[152:155], a[108:111]
  ds_read_b64_tr_b16 v[124:125], v34 offset:32768
  v_mfma_f32_16x16x32_bf16 a[112:115], v[88:91], v[156:159], a[112:115]
  v_mfma_f32_16x16x32_bf16 a[116:119], v[88:91], v[160:163], a[116:119]
  ds_read_b64_tr_b16 v[126:127], v34 offset:34816
  s_add_u32 m0, s52, 4096
  v_mfma_f32_16x16x32_bf16 a[120:123], v[88:91], v[164:167], a[120:123]
  buffer_load_dwordx4 v6, s[8:11], s20 offen  lds
  v_mfma_f32_16x16x32_bf16 a[124:127], v[88:91], v[168:171], a[124:127]
  ds_read_b128 v[64:67], v20 offset:10240
  v_mfma_f32_16x16x32_bf16 a[128:131], v[92:95], v[140:143], a[128:131]
  v_mfma_f32_16x16x32_bf16 a[132:135], v[92:95], v[144:147], a[132:135]
  ds_read_b64_tr_b16 v[128:129], v35 offset:32768
  s_add_u32 m0, s53, 4096
  v_mfma_f32_16x16x32_bf16 a[136:139], v[92:95], v[148:151], a[136:139]
  buffer_load_dwordx4 v14, s[12:15], s21 offen  lds
  v_mfma_f32_16x16x32_bf16 a[140:143], v[92:95], v[152:155], a[140:143]
  ds_read_b64_tr_b16 v[130:131], v35 offset:34816
  v_mfma_f32_16x16x32_bf16 a[144:147], v[92:95], v[156:159], a[144:147]
  v_mfma_f32_16x16x32_bf16 a[148:151], v[92:95], v[160:163], a[148:151]
  ds_read_b128 v[68:71], v20 offset:12288
  s_add_u32 m0, s52, 5120
  v_mfma_f32_16x16x32_bf16 a[152:155], v[92:95], v[164:167], a[152:155]
  buffer_load_dwordx4 v7, s[8:11], s20 offen  lds
  v_mfma_f32_16x16x32_bf16 a[156:159], v[92:95], v[168:171], a[156:159]
  ds_read_b64_tr_b16 v[132:133], v36 offset:32768
  v_mfma_f32_16x16x32_bf16 a[160:163], v[96:99], v[140:143], a[160:163]
  s_add_u32 m0, s53, 5120
  v_mfma_f32_16x16x32_bf16 a[164:167], v[96:99], v[144:147], a[164:167]
  buffer_load_dwordx4 v15, s[12:15], s21 offen  lds
  ds_read_b64_tr_b16 v[134:135], v36 offset:34816
  v_mfma_f32_16x16x32_bf16 a[168:171], v[96:99], v[148:151], a[168:171]
  v_mfma_f32_16x16x32_bf16 a[172:175], v[96:99], v[152:155], a[172:175]
  ds_read_b128 v[72:75], v20 offset:14336
  v_mfma_f32_16x16x32_bf16 a[176:179], v[96:99], v[156:159], a[176:179]
  s_add_u32 m0, s52, 6144
  v_mfma_f32_16x16x32_bf16 a[180:183], v[96:99], v[160:163], a[180:183]
  buffer_load_dwordx4 v8, s[8:11], s20 offen  lds
  ds_read_b64_tr_b16 v[136:137], v37 offset:32768
  v_mfma_f32_16x16x32_bf16 a[184:187], v[96:99], v[164:167], a[184:187]
  v_mfma_f32_16x16x32_bf16 a[188:191], v[96:99], v[168:171], a[188:191]
  ds_read_b64_tr_b16 v[138:139], v37 offset:34816
  v_mfma_f32_16x16x32_bf16 a[192:195], v[100:103], v[140:143], a[192:195]
  s_add_u32 m0, s53, 6144
  v_mfma_f32_16x16x32_bf16 a[196:199], v[100:103], v[144:147], a[196:199]
  buffer_load_dwordx4 v16, s[12:15], s21 offen  lds
  v_mfma_f32_16x16x32_bf16 a[200:203], v[100:103], v[148:151], a[200:203]
  v_mfma_f32_16x16x32_bf16 a[204:207], v[100:103], v[152:155], a[204:207]
  s_add_u32 m0, s52, 7168
  v_mfma_f32_16x16x32_bf16 a[208:211], v[100:103], v[156:159], a[208:211]
  buffer_load_dwordx4 v9, s[8:11], s20 offen  lds
  v_mfma_f32_16x16x32_bf16 a[212:215], v[100:103], v[160:163], a[212:215]
  v_mfma_f32_16x16x32_bf16 a[216:219], v[100:103], v[164:167], a[216:219]
  v_mfma_f32_16x16x32_bf16 a[220:223], v[100:103], v[168:171], a[220:223]
  s_add_u32 m0, s53, 7168
  v_mfma_f32_16x16x32_bf16 a[224:227], v[104:107], v[140:143], a[224:227]
  buffer_load_dwordx4 v17, s[12:15], s21 offen  lds
  v_mfma_f32_16x16x32_bf16 a[228:231], v[104:107], v[144:147], a[228:231]
  v_mfma_f32_16x16x32_bf16 a[232:235], v[104:107], v[148:151], a[232:235]
  v_mfma_f32_16x16x32_bf16 a[236:239], v[104:107], v[152:155], a[236:239]
  s_add_u32 s20, s20, 128
  v_mfma_f32_16x16x32_bf16 a[240:243], v[104:107], v[156:159], a[240:243]
  s_add_u32 s21, s21, s51
  v_mfma_f32_16x16x32_bf16 a[244:247], v[104:107], v[160:163], a[244:247]
  v_mfma_f32_16x16x32_bf16 a[248:251], v[104:107], v[164:167], a[248:251]
  v_mfma_f32_16x16x32_bf16 a[252:255], v[104:107], v[168:171], a[252:255]
  s_waitcnt lgkmcnt(0)
  s_cmp_eq_u32 s25, 1
  s_cbranch_scc1 L_g2_cw
L_g2_cwb:
  v_mfma_f32_16x16x32_bf16 a[0:3], v[44:47], v[108:111], a[0:3]
  ds_read_b128 v[76:79], v21 offset:0
  v_mfma_f32_16x16x32_bf16 a[4:7], v[44:47], v[112:115], a[4:7]
  v_mfma_f32_16x16x32_bf16 a[8:11], v[44:47], v[116:119], a[8:11]
  ds_read_b64_tr_b16 v[140:141], v30 offset:49152
  v_mfma_f32_16x16x32_bf16 a[12:15], v[44:47], v[120:123], a[12:15]
  v_mfma_f32_16x16x32_bf16 a[16:19], v[44:47], v[124:127], a[16:19]
  ds_read_b64_tr_b16 v[142:143], v30 offset:51200
  v_mfma_f32_16x16x32_bf16 a[20:23], v[44:47], v[128:131], a[20:23]
  v_mfma_f32_16x16x32_bf16 a[24:27], v[44:47], v[132:135], a[24:27]
  ds_read_b128 v[80:83], v21 offset:2048
  v_mfma_f32_16x16x32_bf16 a[28:31], v[44:47], v[136:139], a[28:31]
  v_mfma_f32_16x16x32_bf16 a[32:35], v[48:51], v[108:111], a[32:35]
  ds_read_b64_tr_b16 v[144:145], v31 offset:49152
  v_mfma_f32_16x16x32_bf16 a[36:39], v[48:51], v[112:115], a[36:39]
  v_mfma_f32_16x16x32_bf16 a[40:43], v[48:51], v[116:119], a[40:43]
  ds_read_b64_tr_b16 v[146:147], v31 offset:51200
  v_mfma_f32_16x16x32_bf16 a[44:47], v[48:51], v[120:123], a[44:47]
  v_mfma_f32_16x16x32_bf16 a[48:51], v[48:51], v[124:127], a[48:51]
  ds_read_b128 v[84:87], v21 offset:4096
  v_mfma_f32_16x16x32_bf16 a[52:55], v[48:51], v[128:131], a[52:55]
  v_mfma_f32_16x16x32_bf16 a[56:59], v[48:51], v[132:135], a[56:59]
  ds_read_b64_tr_b16 v[148:149], v32 offset:49152
  v_mfma_f32_16x16x32_bf16 a[60:63], v[48:51], v[136:139], a[60:63]
  v_mfma_f32_16x16x32_bf16 a[64:67], v[52:55], v[108:111], a[64:67]
  ds_read_b64_tr_b16 v[150:151], v32 offset:51200
  v_mfma_f32_16x16x32_bf16 a[68:71], v[52:55], v[112:115], a[68:71]
  v_mfma_f32_16x16x32_bf16 a[72:75], v[52:55], v[116:119], a[72:75]
  ds_read_b128 v[88:91], v21 offset:6144
  v_mfma_f32_16x16x32_bf16 a[76:79], v[52:55], v[120:123], a[76:79]
  v_mfma_f32_16x16x32_bf16 a[80:83], v[52:55], v[124:127], a[80:83]
  ds_read_b64_tr_b16 v[152:153], v33 offset:49152
  v_mfma_f32_16x16x32_bf16 a[84:87], v[52:55], v[128:131], a[84:87]
  v_mfma_f32_16x16x32_bf16 a[88:91], v[52:55], v[132:135], a[88:91]
  ds_read_b64_tr_b16 v[154:155], v33 offset:51200
  v_mfma_f32_16x16x32_bf16 a[92:95], v[52:55], v[136:139], a[92:95]
  v_mfma_f32_16x16x32_bf16 a[96:99], v[56:59], v[108:111], a[96:99]
  ds_read_b128 v[92:95], v21 offset:8192
  v_mfma_f32_16x16x32_bf16 a[100:103], v[56:59], v[112:115], a[100:103]
  v_mfma_f32_16x16x32_bf16 a[104:107], v[56:59], v[116:119], a[104:107]
  ds_read_b64_tr_b16 v[156:157], v34 offset:49152
  v_mfma_f32_16x16x32_bf16 a[108:111], v[56:59], v[120:123], a[108:111]
  v_mfma_f32_16x16x32_bf16 a[112:115], v[56:59], v[124:127], a[112:115]
  ds_read_b64_tr_b16 v[158:159], v34 offset:51200
  v_mfma_f32_16x16x32_bf16 a[116:119], v[56:59], v[128:131], a[116:119]
  v_mfma_f32_16x16x32_bf16 a[120:123], v[56:59], v[132:135], a[120:123]
  ds_read_b128 v[96:99], v21 offset:10240
  v_mfma_f32_16x16x32_bf16 a[124:127], v[56:59], v[136:139], a[124:127]
  v_mfma_f32_16x16x32_bf16 a[128:131], v[60:63], v[108:111], a[128:131]
  ds_read_b64_tr_b16 v[160:161], v35 offset:49152
  v_mfma_f32_16x16x32_bf16 a[132:135], v[60:63], v[112:115], a[132:135]
  v_mfma_f32_16x16x32_bf16 a[136:139], v[60:63], v[116:119], a[136:139]
  ds_read_b64_tr_b16 v[162:163], v35 offset:51200
  v_mfma_f32_16x16x32_bf16 a[140:143], v[60:63], v[120:123], a[140:143]
  v_mfma_f32_16x16x32_bf16 a[144:147], v[60:63], v[124:127], a[144:147]
  ds_read_b128 v[100:103], v21 offset:12288
  v_mfma_f32_16x16x32_bf16 a[148:151], v[60:63], v[128:131], a[148:151]
  v_mfma_f32_16x16x32_bf16 a[152:155], v[60:63], v[132:135], a[152:155]
  ds_read_b64_tr_b16 v[164:165], v36 offset:49152
  v_mfma_f32_16x16x32_bf16 a[156:159], v[60:63], v[136:139], a[156:159]
  v_mfma_f32_16x16x32_bf16 a[160:163], v[64:67], v[108:111], a[160:163]
  ds_read_b64_tr_b16 v[166:167], v36 offset:51200
  v_mfma_f32_16x16x32_bf16 a[164:167], v[64:67], v[112:115], a[164:167]
  v_mfma_f32_16x16x32_bf16 a[168:171], v[64:67], v[116:119], a[168:171]
  ds_read_b128 v[104:107], v21 offset:14336
  v_mfma_f32_16x16x32_bf16 a[172:175], v[64:67], v[120:123], a[172:175]
  v_mfma_f32_16x16x32_bf16 a[176:179], v[64:67], v[124:127], a[176:179]
  ds_read_b64_tr_b16 v[168:169], v37 offset:49152
  v_mfma_f32_16x16x32_bf16 a[180:183], v[64:67], v[128:131], a[180:183]
  v_mfma_f32_16x16x32_bf16 a[184:187], v[64:67], v[132:135], a[184:187]
  ds_read_b64_tr_b16 v[170:171], v37 offset:51200
  v_mfma_f32_16x16x32_bf16 a[188:191], v[64:67], v[136:139], a[188:191]
  v_mfma_f32_16x16x32_bf16 a[192:195], v[68:71], v[108:111], a[192:195]
  v_mfma_f32_16x16x32_bf16 a[196:199], v[68:71], v[112:115], a[196:199]
  v_mfma_f32_16x16x32_bf16 a[200:203], v[68:71], v[116:119], a[200:203]
  v_mfma_f32_16x16x32_bf16 a[204:207], v[68:71], v[120:123], a[204:207]
  v_mfma_f32_16x16x32_bf16 a[208:211], v[68:71], v[124:127], a[208:211]
  v_mfma_f32_16x16x32_bf16 a[212:215], v[68:71], v[128:131], a[212:215]
  v_mfma_f32_16x16x32_bf16 a[216:219], v[68:71], v[132:135], a[216:219]
  v_mfma_f32_16x16x32_bf16 a[220:223], v[68:71], v[136:139], a[220:223]
  v_mfma_f32_16x16x32_bf16 a[224:227], v[72:75], v[108:111], a[224:227]
  v_mfma_f32_16x16x32_bf16 a[228:231], v[72:75], v[112:115], a[228:231]
  v_mfma_f32_16x16x32_bf16 a[232:235], v[72:75], v[116:119], a[232:235]
  v_mfma_f32_16x16x32_bf16 a[236:239], v[72:75], v[120:123], a[236:239]
  v_mfma_f32_16x16x32_bf16 a[240:243], v[72:75], v[124:127], a[240:243]
  v_mfma_f32_16x16x32_bf16 a[244:247], v[72:75], v[128:131], a[244:247]
  v_mfma_f32_16x16x32_bf16 a[248:251], v[72:75], v[132:135], a[248:251]
  v_mfma_f32_16x16x32_bf16 a[252:255], v[72:75], v[136:139], a[252:255]
  s_waitcnt lgkmcnt(0)
  v_mfma_f32_16x16x32_bf16 a[0:3], v[76:79], v[140:143], a[0:3]
  s_waitcnt vmcnt(0)
  s_barrier
  s_cmp_le_u32 s25, 2
  s_cbranch_scc1 L_g2_cr
L_g2_crb:
  s_add_u32 m0, s52, 65536
  v_mfma_f32_16x16x32_bf16 a[4:7], v[76:79], v[144:147], a[4:7]
  buffer_load_dwordx4 v2, s[8:11], s20 offen  lds
  ds_read_b128 v[44:47], v18 offset:0
  v_mfma_f32_16x16x32_bf16 a[8:11], v[76:79], v[148:151], a[8:11]
  v_mfma_f32_16x16x32_bf16 a[12:15], v[76:79], v[152:155], a[12:15]
  ds_read_b64_tr_b16 v[108:109], v22 offset:32768
  s_add_u32 m0, s53, 65536
  v_mfma_f32_16x16x32_bf16 a[16:19], v[76:79], v[156:159], a[16:19]
  buffer_load_dwordx4 v10, s[12:15], s21 offen  lds
  v_mfma_f32_16x16x32_bf16 a[20:23], v[76:79], v[160:163], a[20:23]
  ds_read_b64_tr_b16 v[110:111], v22 offset:34816
  v_mfma_f32_16x16x32_bf16 a[24:27], v[76:79], v[164:167], a[24:27]
  v_mfma_f32_16x16x32_bf16 a[28:31], v[76:79], v[168:171], a[28:31]
  ds_read_b128 v[48:51], v18 offset:2048
  s_add_u32 m0, s52, 66560
  v_mfma_f32_16x16x32_bf16 a[32:35], v[80:83], v[140:143], a[32:35]
  buffer_load_dwordx4 v3, s[8:11], s20 offen  lds
  v_mfma_f32_16x16x32_bf16 a[36:39], v[80:83], v[144:147], a[36:39]
  ds_read_b64_tr_b16 v[112:113], v23 offset:32768
  v_mfma_f32_16x16x32_bf16 a[40:43], v[80:83], v[148:151], a[40:43]
  v_mfma_f32_16x16x32_bf16 a[44:47], v[80:83], v[152:155], a[44:47]
  ds_read_b64_tr_b16 v[114:115], v23 offset:34816
  s_add_u32 m0, s53, 66560
  v_mfma_f32_16x16x32_bf16 a[48:51], v[80:83], v[156:159], a[48:51]
  buffer_load_dwordx4 v11, s[12:15], s21 offen  lds
  v_mfma_f32_16x16x32_bf16 a[52:55], v[80:83], v[160:163], a[52:55]
  ds_read_b128 v[52:55], v18 offset:4096
  v_mfma_f32_16x16x32_bf16 a[56:59], v[80:83], v[164:167], a[56:59]
  s_add_u32 m0, s52, 67584
  v_mfma_f32_16x16x32_bf16 a[60:63], v[80:83], v[168:171], a[60:63]
  buffer_load_dwordx4 v4, s[8:11], s20 offen  lds
  ds_read_b64_tr_b16 v[116:117], v24 offset:32768
  v_mfma_f32_16x16x32_bf16 a[64:67], v[84:87], v[140:143], a[64:67]
  v_mfma_f32_16x16x32_bf16 a[68:71], v[84:87], v[144:147], a[68:71]
  ds_read_b64_tr_b16 v[118:119], v24 offset:34816
  v_mfma_f32_16x16x32_bf16 a[72:75], v[84:87], v[148:151], a[72:75]
  s_add_u32 m0, s53, 67584
  v_mfma_f32_16x16x32_bf16 a[76:79], v[84:87], v[152:155], a[76:79]
  buffer_load_dwordx4 v12, s[12:15], s21 offen  lds
  ds_read_b128 v[56:59], v18 offset:6144
  v_mfma_f32_16x16x32_bf16 a[80:83], v[84:87], v[156:159], a[80:83]
  v_mfma_f32_16x16x32_bf16 a[84:87], v[84:87], v[160:163], a[84:87]
  ds_read_b64_tr_b16 v[120:121], v25 offset:32768
  v_mfma_f32_16x16x32_bf16 a[88:91], v[84:87], v[164:167], a[88:91]
  s_add_u32 m0, s52, 68608
  v_mfma_f32_16x16x32_bf16 a[92:95], v[84:87], v[168:171], a[92:95]
  buffer_load_dwordx4 v5, s[8:11], s20 offen  lds
  ds_read_b64_tr_b16 v[122:123], v25 offset:34816
  v_mfma_f32_16x16x32_bf16 a[96:99], v[88:91], v[140:143], a[96:99]
  v_mfma_f32_16x16x32_bf16 a[100:103], v[88:91], v[144:147], a[100:103]
  ds_read_b128 v[60:63], v18 offset:8192
  s_add_u32 m0, s53, 68608
  v_mfma_f32_16x16x32_bf16 a[104:107], v[88:91], v[148:151], a[104:107]
  buffer_load_dwordx4 v13, s[12:15], s21 offen  lds
  v_mfma_f32_16x16x32_bf16 a[108:111], v[88:91], v[152:155], a[108:111]
  ds_read_b64_tr_b16 v[124:125], v26 offset:32768
  v_mfma_f32_16x16x32_bf16 a[112:115], v[88:91], v[156:159], a[112:115]
  v_mfma_f32_16x16x32_bf16 a[116:119], v[88:91], v[160:163], a[116:119]
  ds_read_b64_tr_b16 v[126:127], v26 offset:34816
  s_add_u32 m0, s52, 69632
  v_mfma_f32_16x16x32_bf16 a[120:123], v[88:91], v[164:167], a[120:123]
  buffer_load_dwordx4 v6, s[8:11], s20 offen  lds
  v_mfma_f32_16x16x32_bf16 a[124:127], v[88:91], v[168:171], a[124:127]
  ds_read_b128 v[64:67], v18 offset:10240
  v_mfma_f32_16x16x32_bf16 a[128:131], v[92:95], v[140:143], a[128:131]
  v_mfma_f32_16x16x32_bf16 a[132:135], v[92:95], v[144:147], a[132:135]
  ds_read_b64_tr_b16 v[128:129], v27 offset:32768
  s_add_u32 m0, s53, 69632
  v_mfma_f32_16x16x32_bf16 a[136:139], v[92:95], v[148:151], a[136:139]
  buffer_load_dwordx4 v14, s[12:15], s21 offen  lds
  v_mfma_f32_16x16x32_bf16 a[140:143], v[92:95], v[152:155], a[140:143]
  ds_read_b64_tr_b16 v[130:131], v27 offset:34816
  v_mfma_f32_16x16x32_bf16 a[144:147], v[92:95], v[156:159], a[144:147]
  v_mfma_f32_16x16x32_bf16 a[148:151], v[92:95], v[160:163], a[148:151]
  ds_read_b128 v[68:71], v18 offset:12288
  s_add_u32 m0, s52, 70656
  v_mfma_f32_16x16x32_bf16 a[152:155], v[92:95], v[164:167], a[152:155]
  buffer_load_dwordx4 v7, s[8:11], s20 offen  lds
  v_mfma_f32_16x16x32_bf16 a[156:159], v[92:95], v[168:171], a[156:159]
  ds_read_b64_tr_b16 v[132:133], v28 offset:32768
  v_mfma_f32_16x16x32_bf16 a[160:163], v[96:99], v[140:143], a[160:163]
  s_add_u32 m0, s53, 70656
  v_mfma_f32_16x16x32_bf16 a[164:167], v[96:99], v[144:147], a[164:167]
  buffer_load_dwordx4 v15, s[12:15], s21 offen  lds
  ds_read_b64_tr_b16 v[134:135], v28 offset:34816
  v_mfma_f32_16x16x32_bf16 a[168:171], v[96:99], v[148:151], a[168:171]
  v_mfma_f32_16x16x32_bf16 a[172:175], v[96:99], v[152:155], a[172:175]
  ds_read_b128 v[72:75], v18 offset:14336
  v_mfma_f32_16x16x32_bf16 a[176:179], v[96:99], v[156:159], a[176:179]
  s_add_u32 m0, s52, 71680
  v_mfma_f32_16x16x32_bf16 a[180:183], v[96:99], v[160:163], a[180:183]
  buffer_load_dwordx4 v8, s[8:11], s20 offen  lds
  ds_read_b64_tr_b16 v[136:137], v29 offset:32768
  v_mfma_f32_16x16x32_bf16 a[184:187], v[96:99], v[164:167], a[184:187]
  v_mfma_f32_16x16x32_bf16 a[188:191], v[96:99], v[168:171], a[188:191]
  ds_read_b64_tr_b16 v[138:139], v29 offset:34816
  v_mfma_f32_16x16x32_bf16 a[192:195], v[100:103], v[140:143], a[192:195]
  s_add_u32 m0, s53, 71680
  v_mfma_f32_16x16x32_bf16 a[196:199], v[100:103], v[144:147], a[196:199]
  buffer_load_dwordx4 v16, s[12:15], s21 offen  lds
  v_mfma_f32_16x16x32_bf16 a[200:203], v[100:103], v[148:151], a[200:203]
  v_mfma_f32_16x16x32_bf16 a[204:207], v[100:103], v[152:155], a[204:207]
  s_add_u32 m0, s52, 72704
  v_mfma_f32_16x16x32_bf16 a[208:211], v[100:103], v[156:159], a[208:211]
  buffer_load_dwordx4 v9, s[8:11], s20 offen  lds
  v_mfma_f32_16x16x32_bf16 a[212:215], v[100:103], v[160:163], a[212:215]
  v_mfma_f32_16x16x32_bf16 a[216:219], v[100:103], v[164:167], a[216:219]
  v_mfma_f32_16x16x32_bf16 a[220:223], v[100:103], v[168:171], a[220:223]
  s_add_u32 m0, s53, 72704
  v_mfma_f32_16x16x32_bf16 a[224:227], v[104:107], v[140:143], a[224:227]
  buffer_load_dwordx4 v17, s[12:15], s21 offen  lds
  v_mfma_f32_16x16x32_bf16 a[228:231], v[104:107], v[144:147], a[228:231]
  v_mfma_f32_16x16x32_bf16 a[232:235], v[104:107], v[148:151], a[232:235]
  v_mfma_f32_16x16x32_bf16 a[236:239], v[104:107], v[152:155], a[236:239]
  s_add_u32 s20, s20, 128
  v_mfma_f32_16x16x32_bf16 a[240:243], v[104:107], v[156:159], a[240:243]
  s_add_u32 s21, s21, s51
  v_mfma_f32_16x16x32_bf16 a[244:247], v[104:107], v[160:163], a[244:247]
  v_mfma_f32_16x16x32_bf16 a[248:251], v[104:107], v[164:167], a[248:251]
  v_mfma_f32_16x16x32_bf16 a[252:255], v[104:107], v[168:171], a[252:255]
  s_branch L_g2_loop
L_g2_fin:
  s_mov_b32 s59, 2
  s_mov_b32 s60, s22
  s_mov_b32 s61, s26
  s_add_u32 s62, s38, 0x3d00000
  s_mov_b32 s63, s98
  s_waitcnt lgkmcnt(0)
  v_min_u32 v245, 270, v246
  v_lshlrev_b32 v245, 2, v245
  v_add_u32 v245, 147648, v245
  ds_read_b32 v245, v245
  v_readfirstlane_b32 s34, v246
  s_add_u32 s34, s34, 32
  v_mfma_f32_16x16x32_bf16 a[0:3], v[44:47], v[108:111], a[0:3]
  ds_read_b128 v[76:79], v19 offset:0
  v_mfma_f32_16x16x32_bf16 a[4:7], v[44:47], v[112:115], a[4:7]
  v_mfma_f32_16x16x32_bf16 a[8:11], v[44:47], v[116:119], a[8:11]
  ds_read_b64_tr_b16 v[140:141], v22 offset:49152
  v_mfma_f32_16x16x32_bf16 a[12:15], v[44:47], v[120:123], a[12:15]
  v_mfma_f32_16x16x32_bf16 a[16:19], v[44:47], v[124:127], a[16:19]
  ds_read_b64_tr_b16 v[142:143], v22 offset:51200
  v_mfma_f32_16x16x32_bf16 a[20:23], v[44:47], v[128:131], a[20:23]
  v_mfma_f32_16x16x32_bf16 a[24:27], v[44:47], v[132:135], a[24:27]
  ds_read_b128 v[80:83], v19 offset:2048
  v_mfma_f32_16x16x32_bf16 a[28:31], v[44:47], v[136:139], a[28:31]
  v_mfma_f32_16x16x32_bf16 a[32:35], v[48:51], v[108:111], a[32:35]
  ds_read_b64_tr_b16 v[144:145], v23 offset:49152
  v_mfma_f32_16x16x32_bf16 a[36:39], v[48:51], v[112:115], a[36:39]
  v_mfma_f32_16x16x32_bf16 a[40:43], v[48:51], v[116:119], a[40:43]
  ds_read_b64_tr_b16 v[146:147], v23 offset:51200
  v_mfma_f32_16x16x32_bf16 a[44:47], v[48:51], v[120:123], a[44:47]
  v_mfma_f32_16x16x32_bf16 a[48:51], v[48:51], v[124:127], a[48:51]
  ds_read_b128 v[84:87], v19 offset:4096
  v_mfma_f32_16x16x32_bf16 a[52:55], v[48:51], v[128:131], a[52:55]
  v_mfma_f32_16x16x32_bf16 a[56:59], v[48:51], v[132:135], a[56:59]
  ds_read_b64_tr_b16 v[148:149], v24 offset:49152
  v_mfma_f32_16x16x32_bf16 a[60:63], v[48:51], v[136:139], a[60:63]
  v_mfma_f32_16x16x32_bf16 a[64:67], v[52:55], v[108:111], a[64:67]
  ds_read_b64_tr_b16 v[150:151], v24 offset:51200
  v_mfma_f32_16x16x32_bf16 a[68:71], v[52:55], v[112:115], a[68:71]
  v_mfma_f32_16x16x32_bf16 a[72:75], v[52:55], v[116:119], a[72:75]
  ds_read_b128 v[88:91], v19 offset:6144
  v_mfma_f32_16x16x32_bf16 a[76:79], v[52:55], v[120:123], a[76:79]
  v_mfma_f32_16x16x32_bf16 a[80:83], v[52:55], v[124:127], a[80:83]
  ds_read_b64_tr_b16 v[152:153], v25 offset:49152
  v_mfma_f32_16x16x32_bf16 a[84:87], v[52:55], v[128:131], a[84:87]
  v_mfma_f32_16x16x32_bf16 a[88:91], v[52:55], v[132:135], a[88:91]
  ds_read_b64_tr_b16 v[154:155], v25 offset:51200
  v_mfma_f32_16x16x32_bf16 a[92:95], v[52:55], v[136:139], a[92:95]
  v_mfma_f32_16x16x32_bf16 a[96:99], v[56:59], v[108:111], a[96:99]
  ds_read_b128 v[92:95], v19 offset:8192
  v_mfma_f32_16x16x32_bf16 a[100:103], v[56:59], v[112:115], a[100:103]
  v_mfma_f32_16x16x32_bf16 a[104:107], v[56:59], v[116:119], a[104:107]
  ds_read_b64_tr_b16 v[156:157], v26 offset:49152
  v_mfma_f32_16x16x32_bf16 a[108:111], v[56:59], v[120:123], a[108:111]
  v_mfma_f32_16x16x32_bf16 a[112:115], v[56:59], v[124:127], a[112:115]
  ds_read_b64_tr_b16 v[158:159], v26 offset:51200
  v_mfma_f32_16x16x32_bf16 a[116:119], v[56:59], v[128:131], a[116:119]
  v_mfma_f32_16x16x32_bf16 a[120:123], v[56:59], v[132:135], a[120:123]
  ds_read_b128 v[96:99], v19 offset:10240
  v_mfma_f32_16x16x32_bf16 a[124:127], v[56:59], v[136:139], a[124:127]
  v_mfma_f32_16x16x32_bf16 a[128:131], v[60:63], v[108:111], a[128:131]
  ds_read_b64_tr_b16 v[160:161], v27 offset:49152
  v_mfma_f32_16x16x32_bf16 a[132:135], v[60:63], v[112:115], a[132:135]
  v_mfma_f32_16x16x32_bf16 a[136:139], v[60:63], v[116:119], a[136:139]
  ds_read_b64_tr_b16 v[162:163], v27 offset:51200
  v_mfma_f32_16x16x32_bf16 a[140:143], v[60:63], v[120:123], a[140:143]
  v_mfma_f32_16x16x32_bf16 a[144:147], v[60:63], v[124:127], a[144:147]
  ds_read_b128 v[100:103], v19 offset:12288
  v_mfma_f32_16x16x32_bf16 a[148:151], v[60:63], v[128:131], a[148:151]
  v_mfma_f32_16x16x32_bf16 a[152:155], v[60:63], v[132:135], a[152:155]
  ds_read_b64_tr_b16 v[164:165], v28 offset:49152
  v_mfma_f32_16x16x32_bf16 a[156:159], v[60:63], v[136:139], a[156:159]
  v_mfma_f32_16x16x32_bf16 a[160:163], v[64:67], v[108:111], a[160:163]
  ds_read_b64_tr_b16 v[166:167], v28 offset:51200
  v_mfma_f32_16x16x32_bf16 a[164:167], v[64:67], v[112:115], a[164:167]
  v_mfma_f32_16x16x32_bf16 a[168:171], v[64:67], v[116:119], a[168:171]
  ds_read_b128 v[104:107], v19 offset:14336
  v_mfma_f32_16x16x32_bf16 a[172:175], v[64:67], v[120:123], a[172:175]
  v_mfma_f32_16x16x32_bf16 a[176:179], v[64:67], v[124:127], a[176:179]
  ds_read_b64_tr_b16 v[168:169], v29 offset:49152
  v_mfma_f32_16x16x32_bf16 a[180:183], v[64:67], v[128:131], a[180:183]
  v_mfma_f32_16x16x32_bf16 a[184:187], v[64:67], v[132:135], a[184:187]
  ds_read_b64_tr_b16 v[170:171], v29 offset:51200
  v_mfma_f32_16x16x32_bf16 a[188:191], v[64:67], v[136:139], a[188:191]
  v_mfma_f32_16x16x32_bf16 a[192:195], v[68:71], v[108:111], a[192:195]
  v_mfma_f32_16x16x32_bf16 a[196:199], v[68:71], v[112:115], a[196:199]
  v_mfma_f32_16x16x32_bf16 a[200:203], v[68:71], v[116:119], a[200:203]
  v_mfma_f32_16x16x32_bf16 a[204:207], v[68:71], v[120:123], a[204:207]
  v_mfma_f32_16x16x32_bf16 a[208:211], v[68:71], v[124:127], a[208:211]
  v_mfma_f32_16x16x32_bf16 a[212:215], v[68:71], v[128:131], a[212:215]
  v_mfma_f32_16x16x32_bf16 a[216:219], v[68:71], v[132:135], a[216:219]
  v_mfma_f32_16x16x32_bf16 a[220:223], v[68:71], v[136:139], a[220:223]
  v_mfma_f32_16x16x32_bf16 a[224:227], v[72:75], v[108:111], a[224:227]
  v_mfma_f32_16x16x32_bf16 a[228:231], v[72:75], v[112:115], a[228:231]
  v_mfma_f32_16x16x32_bf16 a[232:235], v[72:75], v[116:119], a[232:235]
  v_mfma_f32_16x16x32_bf16 a[236:239], v[72:75], v[120:123], a[236:239]
  v_mfma_f32_16x16x32_bf16 a[240:243], v[72:75], v[124:127], a[240:243]
  v_mfma_f32_16x16x32_bf16 a[244:247], v[72:75], v[128:131], a[244:247]
  v_mfma_f32_16x16x32_bf16 a[248:251], v[72:75], v[132:135], a[248:251]
  v_mfma_f32_16x16x32_bf16 a[252:255], v[72:75], v[136:139], a[252:255]
  s_waitcnt lgkmcnt(0)
  v_mfma_f32_16x16x32_bf16 a[0:3], v[76:79], v[140:143], a[0:3]
  s_waitcnt vmcnt(0)
  s_barrier
  v_readfirstlane_b32 s91, v245
  s_and_b32 s35, s91, 255
  s_lshr_b32 s36, s91, 8
  s_and_b32 s36, s36, 255
  s_lshr_b32 s37, s91, 16
  s_mov_b32 s92, s24
  s_cmp_gt_u32 s35, 3
  s_cbranch_scc1 L_cd_50
  s_cmp_eq_u32 s35, 3
  s_cbranch_scc1 L_cd_48
  s_mov_b32 s8, s64
  s_and_b32 s9, s65, 0xffff
  s_mov_b32 s10, 0x400000
  s_mov_b32 s11, 0x20000
  s_cmp_eq_u32 s35, 0
  s_cselect_b64 s[88:89], s[68:69], s[70:71]
  s_cmp_eq_u32 s35, 2
  s_cselect_b64 s[88:89], s[72:73], s[88:89]
  s_mov_b32 s12, s88
  s_and_b32 s13, s89, 0xffff
  s_mov_b32 s14, 0x800000
  s_mov_b32 s15, 0x20000
  s_lshl_b32 s91, s33, 2
  s_add_u32 s91, s91, s37
  s_mov_b32 s24, 8192
  s_mov_b32 s26, 262144
  s_lshl_b32 s20, s36, 19
  s_lshl_b32 s21, s91, 9
  s_lshl_b32 s22, s35, 24
  s_lshl_b32 s90, s36, 21
  s_add_u32 s22, s22, s90
  s_lshl_b32 s90, s91, 14
  s_add_u32 s22, s22, s90
  s_lshl_b32 s38, s36, 9
  s_add_u32 s38, s38, 28672
  s_cmp_eq_u32 s35, 0
  s_cselect_b32 s38, 8192, s38
  s_cselect_b32 s98, 1, 2
  s_mov_b32 s48, s35
  s_branch L_cd_49
L_cd_50:
  s_mov_b64 vcc, 0
  s_mov_b32 s58, 0
  s_branch L_cd_51
L_cd_48:
  s_mov_b32 s8, s78
  s_and_b32 s9, s79, 0xffff
  s_mov_b32 s10, 0x400000
  s_mov_b32 s11, 0x20000
  s_mov_b32 s12, s80
  s_and_b32 s13, s81, 0xffff
  s_mov_b32 s14, 0x600000
  s_mov_b32 s15, 0x20000
  s_lshl_b32 s91, s37, 2
  s_add_u32 s91, s91, s33
  s_mov_b32 s24, 6144
  s_mov_b32 s26, 65536
  s_lshl_b32 s20, s36, 19
  s_lshl_b32 s21, s91, 9
  s_lshl_b32 s22, s37, 22
  s_lshl_b32 s90, s36, 19
  s_add_u32 s22, s22, s90
  s_lshl_b32 s90, s33, 14
  s_add_u32 s22, s22, s90
  s_add_u32 s22, s22, 0x4000000
  s_mov_b32 s38, 12288
  s_mov_b32 s48, s37
  s_mov_b32 s98, 1
L_cd_49:
  s_lshl_b32 s90, s36, 9
  s_add_u32 s38, s38, s90
  s_lshl_b32 s90, s33, 7
  s_add_u32 s38, s38, s90
  s_mov_b32 s23, 2048
  s_mov_b32 s25, 8
  s_mov_b64 vcc, -1
  s_sub_i32 s92, s24, s92
  s_lshl_b32 s51, s24, 6
  v_mul_i32_i24 v38, s92, v174
  s_mul_i32 s92, s92, 2
  s_mov_b32 s93, 0
  v_add3_u32 v10, v10, v38, s93
  s_add_u32 s93, s93, s92
  v_add3_u32 v11, v11, v38, s93
  s_add_u32 s93, s93, s92
  v_add3_u32 v12, v12, v38, s93
  s_add_u32 s93, s93, s92
  v_add3_u32 v13, v13, v38, s93
  s_add_u32 s93, s93, s92
  v_add3_u32 v14, v14, v38, s93
  s_add_u32 s93, s93, s92
  v_add3_u32 v15, v15, v38, s93
  s_add_u32 s93, s93, s92
  v_add3_u32 v16, v16, v38, s93
  s_add_u32 s93, s93, s92
  v_add3_u32 v17, v17, v38, s93
  s_add_u32 s93, s93, s92
L_cd_51:
  s_add_u32 m0, s52, 0
  v_mfma_f32_16x16x32_bf16 a[4:7], v[76:79], v[144:147], a[4:7]
  s_cbranch_vccz L_gd_52
  buffer_load_dwordx4 v2, s[8:11], s20 offen  lds
L_gd_52:
  ds_read_b128 v[44:47], v20 offset:0
  v_mfma_f32_16x16x32_bf16 a[8:11], v[76:79], v[148:151], a[8:11]
  v_mfma_f32_16x16x32_bf16 a[12:15], v[76:79], v[152:155], a[12:15]
  ds_read_b64_tr_b16 v[108:109], v30 offset:32768
  s_add_u32 m0, s53, 0
  v_mfma_f32_16x16x32_bf16 a[16:19], v[76:79], v[156:159], a[16:19]
  s_cbranch_vccz L_gd_53
  buffer_load_dwordx4 v10, s[12:15], s21 offen  lds
L_gd_53:
  v_mfma_f32_16x16x32_bf16 a[20:23], v[76:79], v[160:163], a[20:23]
  ds_read_b64_tr_b16 v[110:111], v30 offset:34816
  v_mfma_f32_16x16x32_bf16 a[24:27], v[76:79], v[164:167], a[24:27]
  v_mfma_f32_16x16x32_bf16 a[28:31], v[76:79], v[168:171], a[28:31]
  ds_read_b128 v[48:51], v20 offset:2048
  s_add_u32 m0, s52, 1024
  v_mfma_f32_16x16x32_bf16 a[32:35], v[80:83], v[140:143], a[32:35]
  s_cbranch_vccz L_gd_54
  buffer_load_dwordx4 v3, s[8:11], s20 offen  lds
L_gd_54:
  v_mfma_f32_16x16x32_bf16 a[36:39], v[80:83], v[144:147], a[36:39]
  ds_read_b64_tr_b16 v[112:113], v31 offset:32768
  v_mfma_f32_16x16x32_bf16 a[40:43], v[80:83], v[148:151], a[40:43]
  v_mfma_f32_16x16x32_bf16 a[44:47], v[80:83], v[152:155], a[44:47]
  ds_read_b64_tr_b16 v[114:115], v31 offset:34816
  s_add_u32 m0, s53, 1024
  v_mfma_f32_16x16x32_bf16 a[48:51], v[80:83], v[156:159], a[48:51]
  s_cbranch_vccz L_gd_55
  buffer_load_dwordx4 v11, s[12:15], s21 offen  lds
L_gd_55:
  v_mfma_f32_16x16x32_bf16 a[52:55], v[80:83], v[160:163], a[52:55]
  ds_read_b128 v[52:55], v20 offset:4096
  v_mfma_f32_16x16x32_bf16 a[56:59], v[80:83], v[164:167], a[56:59]
  v_mfma_f32_16x16x32_bf16 a[60:63], v[80:83], v[168:171], a[60:63]
  ds_read_b64_tr_b16 v[116:117], v32 offset:32768
  s_add_u32 m0, s52, 2048
  v_mfma_f32_16x16x32_bf16 a[64:67], v[84:87], v[140:143], a[64:67]
  s_cbranch_vccz L_gd_56
  buffer_load_dwordx4 v4, s[8:11], s20 offen  lds
L_gd_56:
  v_mfma_f32_16x16x32_bf16 a[68:71], v[84:87], v[144:147], a[68:71]
  ds_read_b64_tr_b16 v[118:119], v32 offset:34816
  v_mfma_f32_16x16x32_bf16 a[72:75], v[84:87], v[148:151], a[72:75]
  v_mfma_f32_16x16x32_bf16 a[76:79], v[84:87], v[152:155], a[76:79]
  ds_read_b128 v[56:59], v20 offset:6144
  s_add_u32 m0, s53, 2048
  v_mfma_f32_16x16x32_bf16 a[80:83], v[84:87], v[156:159], a[80:83]
  s_cbranch_vccz L_gd_57
  buffer_load_dwordx4 v12, s[12:15], s21 offen  lds
L_gd_57:
  v_mfma_f32_16x16x32_bf16 a[84:87], v[84:87], v[160:163], a[84:87]
  ds_read_b64_tr_b16 v[120:121], v33 offset:32768
  v_mfma_f32_16x16x32_bf16 a[88:91], v[84:87], v[164:167], a[88:91]
  v_mfma_f32_16x16x32_bf16 a[92:95], v[84:87], v[168:171], a[92:95]
  ds_read_b64_tr_b16 v[122:123], v33 offset:34816
  s_add_u32 m0, s52, 3072
  v_mfma_f32_16x16x32_bf16 a[96:99], v[88:91], v[140:143], a[96:99]
  s_cbranch_vccz L_gd_58
  buffer_load_dwordx4 v5, s[8:11], s20 offen  lds
L_gd_58:
  v_mfma_f32_16x16x32_bf16 a[100:103], v[88:91], v[144:147], a[100:103]
  ds_read_b128 v[60:63], v20 offset:8192
  v_mfma_f32_16x16x32_bf16 a[104:107], v[88:91], v[148:151], a[104:107]
  v_mfma_f32_16x16x32_bf16 a[108:111], v[88:91], v[152:155], a[108:111]
  ds_read_b64_tr_b16 v[124:125], v34 offset:32768
  s_add_u32 m0, s53, 3072
  v_mfma_f32_16x16x32_bf16 a[112:115], v[88:91], v[156:159], a[112:115]
  s_cbranch_vccz L_gd_59
  buffer_load_dwordx4 v13, s[12:15], s21 offen  lds
L_gd_59:
  v_mfma_f32_16x16x32_bf16 a[116:119], v[88:91], v[160:163], a[116:119]
  ds_read_b64_tr_b16 v[126:127], v34 offset:34816
  v_mfma_f32_16x16x32_bf16 a[120:123], v[88:91], v[164:167], a[120:123]
  v_mfma_f32_16x16x32_bf16 a[124:127], v[88:91], v[168:171], a[124:127]
  ds_read_b128 v[64:67], v20 offset:10240
  s_add_u32 m0, s52, 4096
  v_mfma_f32_16x16x32_bf16 a[128:131], v[92:95], v[140:143], a[128:131]
  s_cbranch_vccz L_gd_60
  buffer_load_dwordx4 v6, s[8:11], s20 offen  lds
L_gd_60:
  v_mfma_f32_16x16x32_bf16 a[132:135], v[92:95], v[144:147], a[132:135]
  ds_read_b64_tr_b16 v[128:129], v35 offset:32768
  v_mfma_f32_16x16x32_bf16 a[136:139], v[92:95], v[148:151], a[136:139]
  v_mfma_f32_16x16x32_bf16 a[140:143], v[92:95], v[152:155], a[140:143]
  ds_read_b64_tr_b16 v[130:131], v35 offset:34816
  s_add_u32 m0, s53, 4096
  v_mfma_f32_16x16x32_bf16 a[144:147], v[92:95], v[156:159], a[144:147]
  s_cbranch_vccz L_gd_61
  buffer_load_dwordx4 v14, s[12:15], s21 offen  lds
L_gd_61:
  v_mfma_f32_16x16x32_bf16 a[148:151], v[92:95], v[160:163], a[148:151]
  ds_read_b128 v[68:71], v20 offset:12288
  v_mfma_f32_16x16x32_bf16 a[152:155], v[92:95], v[164:167], a[152:155]
  v_mfma_f32_16x16x32_bf16 a[156:159], v[92:95], v[168:171], a[156:159]
  ds_read_b64_tr_b16 v[132:133], v36 offset:32768
  s_add_u32 m0, s52, 5120
  v_mfma_f32_16x16x32_bf16 a[160:163], v[96:99], v[140:143], a[160:163]
  s_cbranch_vccz L_gd_62
  buffer_load_dwordx4 v7, s[8:11], s20 offen  lds
L_gd_62:
  v_mfma_f32_16x16x32_bf16 a[164:167], v[96:99], v[144:147], a[164:167]
  ds_read_b64_tr_b16 v[134:135], v36 offset:34816
  v_mfma_f32_16x16x32_bf16 a[168:171], v[96:99], v[148:151], a[168:171]
  v_mfma_f32_16x16x32_bf16 a[172:175], v[96:99], v[152:155], a[172:175]
  ds_read_b128 v[72:75], v20 offset:14336
  s_add_u32 m0, s53, 5120
  v_mfma_f32_16x16x32_bf16 a[176:179], v[96:99], v[156:159], a[176:179]
  s_cbranch_vccz L_gd_63
  buffer_load_dwordx4 v15, s[12:15], s21 offen  lds
L_gd_63:
  v_mfma_f32_16x16x32_bf16 a[180:183], v[96:99], v[160:163], a[180:183]
  ds_read_b64_tr_b16 v[136:137], v37 offset:32768
  v_mfma_f32_16x16x32_bf16 a[184:187], v[96:99], v[164:167], a[184:187]
  v_mfma_f32_16x16x32_bf16 a[188:191], v[96:99], v[168:171], a[188:191]
  ds_read_b64_tr_b16 v[138:139], v37 offset:34816
  s_add_u32 m0, s52, 6144
  v_mfma_f32_16x16x32_bf16 a[192:195], v[100:103], v[140:143], a[192:195]
  s_cbranch_vccz L_gd_64
  buffer_load_dwordx4 v8, s[8:11], s20 offen  lds
L_gd_64:
  v_mfma_f32_16x16x32_bf16 a[196:199], v[100:103], v[144:147], a[196:199]
  v_mfma_f32_16x16x32_bf16 a[200:203], v[100:103], v[148:151], a[200:203]
  v_mfma_f32_16x16x32_bf16 a[204:207], v[100:103], v[152:155], a[204:207]
  s_add_u32 m0, s53, 6144
  v_mfma_f32_16x16x32_bf16 a[208:211], v[100:103], v[156:159], a[208:211]
  s_cbranch_vccz L_gd_65
  buffer_load_dwordx4 v16, s[12:15], s21 offen  lds
L_gd_65:
  v_mfma_f32_16x16x32_bf16 a[212:215], v[100:103], v[160:163], a[212:215]
  v_mfma_f32_16x16x32_bf16 a[216:219], v[100:103], v[164:167], a[216:219]
  v_mfma_f32_16x16x32_bf16 a[220:223], v[100:103], v[168:171], a[220:223]
  s_add_u32 m0, s52, 7168
  v_mfma_f32_16x16x32_bf16 a[224:227], v[104:107], v[140:143], a[224:227]
  s_cbranch_vccz L_gd_66
  buffer_load_dwordx4 v9, s[8:11], s20 offen  lds
L_gd_66:
  v_mfma_f32_16x16x32_bf16 a[228:231], v[104:107], v[144:147], a[228:231]
  v_mfma_f32_16x16x32_bf16 a[232:235], v[104:107], v[148:151], a[232:235]
  v_mfma_f32_16x16x32_bf16 a[236:239], v[104:107], v[152:155], a[236:239]
  s_add_u32 m0, s53, 7168
  v_mfma_f32_16x16x32_bf16 a[240:243], v[104:107], v[156:159], a[240:243]
  s_cbranch_vccz L_gd_67
  buffer_load_dwordx4 v17, s[12:15], s21 offen  lds
  s_add_u32 s20, s20, 128
  s_add_u32 s21, s21, s51
L_gd_67:
  v_mfma_f32_16x16x32_bf16 a[244:247], v[104:107], v[160:163], a[244:247]
  v_mfma_f32_16x16x32_bf16 a[248:251], v[104:107], v[164:167], a[248:251]
  v_mfma_f32_16x16x32_bf16 a[252:255], v[104:107], v[168:171], a[252:255]
  s_waitcnt lgkmcnt(0)
  v_mfma_f32_16x16x32_bf16 a[0:3], v[44:47], v[108:111], a[0:3]
  ds_read_b128 v[76:79], v21 offset:0
  v_mfma_f32_16x16x32_bf16 a[4:7], v[44:47], v[112:115], a[4:7]
  v_mfma_f32_16x16x32_bf16 a[8:11], v[44:47], v[116:119], a[8:11]
  ds_read_b64_tr_b16 v[140:141], v30 offset:49152
  v_mfma_f32_16x16x32_bf16 a[12:15], v[44:47], v[120:123], a[12:15]
  v_mfma_f32_16x16x32_bf16 a[16:19], v[44:47], v[124:127], a[16:19]
  ds_read_b64_tr_b16 v[142:143], v30 offset:51200
  v_mfma_f32_16x16x32_bf16 a[20:23], v[44:47], v[128:131], a[20:23]
  v_mfma_f32_16x16x32_bf16 a[24:27], v[44:47], v[132:135], a[24:27]
  ds_read_b128 v[80:83], v21 offset:2048
  v_mfma_f32_16x16x32_bf16 a[28:31], v[44:47], v[136:139], a[28:31]
  v_mfma_f32_16x16x32_bf16 a[32:35], v[48:51], v[108:111], a[32:35]
  ds_read_b64_tr_b16 v[144:145], v31 offset:49152
  v_mfma_f32_16x16x32_bf16 a[36:39], v[48:51], v[112:115], a[36:39]
  v_mfma_f32_16x16x32_bf16 a[40:43], v[48:51], v[116:119], a[40:43]
  ds_read_b64_tr_b16 v[146:147], v31 offset:51200
  v_mfma_f32_16x16x32_bf16 a[44:47], v[48:51], v[120:123], a[44:47]
  v_mfma_f32_16x16x32_bf16 a[48:51], v[48:51], v[124:127], a[48:51]
  ds_read_b128 v[84:87], v21 offset:4096
  v_mfma_f32_16x16x32_bf16 a[52:55], v[48:51], v[128:131], a[52:55]
  v_mfma_f32_16x16x32_bf16 a[56:59], v[48:51], v[132:135], a[56:59]
  ds_read_b64_tr_b16 v[148:149], v32 offset:49152
  v_mfma_f32_16x16x32_bf16 a[60:63], v[48:51], v[136:139], a[60:63]
  v_mfma_f32_16x16x32_bf16 a[64:67], v[52:55], v[108:111], a[64:67]
  ds_read_b64_tr_b16 v[150:151], v32 offset:51200
  v_mfma_f32_16x16x32_bf16 a[68:71], v[52:55], v[112:115], a[68:71]
  v_mfma_f32_16x16x32_bf16 a[72:75], v[52:55], v[116:119], a[72:75]
  ds_read_b128 v[88:91], v21 offset:6144
  v_mfma_f32_16x16x32_bf16 a[76:79], v[52:55], v[120:123], a[76:79]
  v_mfma_f32_16x16x32_bf16 a[80:83], v[52:55], v[124:127], a[80:83]
  ds_read_b64_tr_b16 v[152:153], v33 offset:49152
  v_mfma_f32_16x16x32_bf16 a[84:87], v[52:55], v[128:131], a[84:87]
  v_mfma_f32_16x16x32_bf16 a[88:91], v[52:55], v[132:135], a[88:91]
  ds_read_b64_tr_b16 v[154:155], v33 offset:51200
  v_mfma_f32_16x16x32_bf16 a[92:95], v[52:55], v[136:139], a[92:95]
  v_mfma_f32_16x16x32_bf16 a[96:99], v[56:59], v[108:111], a[96:99]
  ds_read_b128 v[92:95], v21 offset:8192
  v_mfma_f32_16x16x32_bf16 a[100:103], v[56:59], v[112:115], a[100:103]
  v_mfma_f32_16x16x32_bf16 a[104:107], v[56:59], v[116:119], a[104:107]
  ds_read_b64_tr_b16 v[156:157], v34 offset:49152
  v_mfma_f32_16x16x32_bf16 a[108:111], v[56:59], v[120:123], a[108:111]
  v_mfma_f32_16x16x32_bf16 a[112:115], v[56:59], v[124:127], a[112:115]
  ds_read_b64_tr_b16 v[158:159], v34 offset:51200
  v_mfma_f32_16x16x32_bf16 a[116:119], v[56:59], v[128:131], a[116:119]
  v_mfma_f32_16x16x32_bf16 a[120:123], v[56:59], v[132:135], a[120:123]
  ds_read_b128 v[96:99], v21 offset:10240
  v_mfma_f32_16x16x32_bf16 a[124:127], v[56:59], v[136:139], a[124:127]
  v_mfma_f32_16x16x32_bf16 a[128:131], v[60:63], v[108:111], a[128:131]
  ds_read_b64_tr_b16 v[160:161], v35 offset:49152
  v_mfma_f32_16x16x32_bf16 a[132:135], v[60:63], v[112:115], a[132:135]
  v_mfma_f32_16x16x32_bf16 a[136:139], v[60:63], v[116:119], a[136:139]
  ds_read_b64_tr_b16 v[162:163], v35 offset:51200
  v_mfma_f32_16x16x32_bf16 a[140:143], v[60:63], v[120:123], a[140:143]
  v_mfma_f32_16x16x32_bf16 a[144:147], v[60:63], v[124:127], a[144:147]
  ds_read_b128 v[100:103], v21 offset:12288
  v_mfma_f32_16x16x32_bf16 a[148:151], v[60:63], v[128:131], a[148:151]
  v_mfma_f32_16x16x32_bf16 a[152:155], v[60:63], v[132:135], a[152:155]
  ds_read_b64_tr_b16 v[164:165], v36 offset:49152
  v_mfma_f32_16x16x32_bf16 a[156:159], v[60:63], v[136:139], a[156:159]
  v_mfma_f32_16x16x32_bf16 a[160:163], v[64:67], v[108:111], a[160:163]
  ds_read_b64_tr_b16 v[166:167], v36 offset:51200
  v_mfma_f32_16x16x32_bf16 a[164:167], v[64:67], v[112:115], a[164:167]
  v_mfma_f32_16x16x32_bf16 a[168:171], v[64:67], v[116:119], a[168:171]
  ds_read_b128 v[104:107], v21 offset:14336
  v_mfma_f32_16x16x32_bf16 a[172:175], v[64:67], v[120:123], a[172:175]
  v_mfma_f32_16x16x32_bf16 a[176:179], v[64:67], v[124:127], a[176:179]
  ds_read_b64_tr_b16 v[168:169], v37 offset:49152
  v_mfma_f32_16x16x32_bf16 a[180:183], v[64:67], v[128:131], a[180:183]
  v_mfma_f32_16x16x32_bf16 a[184:187], v[64:67], v[132:135], a[184:187]
  ds_read_b64_tr_b16 v[170:171], v37 offset:51200
  v_mfma_f32_16x16x32_bf16 a[188:191], v[64:67], v[136:139], a[188:191]
  v_mfma_f32_16x16x32_bf16 a[192:195], v[68:71], v[108:111], a[192:195]
  v_mfma_f32_16x16x32_bf16 a[196:199], v[68:71], v[112:115], a[196:199]
  v_mfma_f32_16x16x32_bf16 a[200:203], v[68:71], v[116:119], a[200:203]
  v_mfma_f32_16x16x32_bf16 a[204:207], v[68:71], v[120:123], a[204:207]
  v_mfma_f32_16x16x32_bf16 a[208:211], v[68:71], v[124:127], a[208:211]
  v_mfma_f32_16x16x32_bf16 a[212:215], v[68:71], v[128:131], a[212:215]
  v_mfma_f32_16x16x32_bf16 a[216:219], v[68:71], v[132:135], a[216:219]
  v_mfma_f32_16x16x32_bf16 a[220:223], v[68:71], v[136:139], a[220:223]
  v_mfma_f32_16x16x32_bf16 a[224:227], v[72:75], v[108:111], a[224:227]
  v_mfma_f32_16x16x32_bf16 a[228:231], v[72:75], v[112:115], a[228:231]
  v_mfma_f32_16x16x32_bf16 a[232:235], v[72:75], v[116:119], a[232:235]
  v_mfma_f32_16x16x32_bf16 a[236:239], v[72:75], v[120:123], a[236:239]
  v_mfma_f32_16x16x32_bf16 a[240:243], v[72:75], v[124:127], a[240:243]
  v_mfma_f32_16x16x32_bf16 a[244:247], v[72:75], v[128:131], a[244:247]
  v_mfma_f32_16x16x32_bf16 a[248:251], v[72:75], v[132:135], a[248:251]
  v_mfma_f32_16x16x32_bf16 a[252:255], v[72:75], v[136:139], a[252:255]
  s_waitcnt lgkmcnt(0)
  v_mfma_f32_16x16x32_bf16 a[0:3], v[76:79], v[140:143], a[0:3]
  s_barrier
  s_add_u32 m0, s52, 65536
  v_mfma_f32_16x16x32_bf16 a[4:7], v[76:79], v[144:147], a[4:7]
  s_cbranch_vccz L_gd_68
  buffer_load_dwordx4 v2, s[8:11], s20 offen  lds
L_gd_68:
  v_mfma_f32_16x16x32_bf16 a[8:11], v[76:79], v[148:151], a[8:11]
  v_mfma_f32_16x16x32_bf16 a[12:15], v[76:79], v[152:155], a[12:15]
  s_add_u32 m0, s53, 65536
  v_mfma_f32_16x16x32_bf16 a[16:19], v[76:79], v[156:159], a[16:19]
  s_cbranch_vccz L_gd_69
  buffer_load_dwordx4 v10, s[12:15], s21 offen  lds
L_gd_69:
  v_mfma_f32_16x16x32_bf16 a[20:23], v[76:79], v[160:163], a[20:23]
  v_mfma_f32_16x16x32_bf16 a[24:27], v[76:79], v[164:167], a[24:27]
  v_mfma_f32_16x16x32_bf16 a[28:31], v[76:79], v[168:171], a[28:31]
  s_add_u32 m0, s52, 66560
  v_mfma_f32_16x16x32_bf16 a[32:35], v[80:83], v[140:143], a[32:35]
  s_cbranch_vccz L_gd_70
  buffer_load_dwordx4 v3, s[8:11], s20 offen  lds
L_gd_70:
  v_mfma_f32_16x16x32_bf16 a[36:39], v[80:83], v[144:147], a[36:39]
  v_mfma_f32_16x16x32_bf16 a[40:43], v[80:83], v[148:151], a[40:43]
  v_mfma_f32_16x16x32_bf16 a[44:47], v[80:83], v[152:155], a[44:47]
  s_add_u32 m0, s53, 66560
  v_mfma_f32_16x16x32_bf16 a[48:51], v[80:83], v[156:159], a[48:51]
  s_cbranch_vccz L_gd_71
  buffer_load_dwordx4 v11, s[12:15], s21 offen  lds
L_gd_71:
  v_mfma_f32_16x16x32_bf16 a[52:55], v[80:83], v[160:163], a[52:55]
  v_mfma_f32_16x16x32_bf16 a[56:59], v[80:83], v[164:167], a[56:59]
  v_mfma_f32_16x16x32_bf16 a[60:63], v[80:83], v[168:171], a[60:63]
  s_add_u32 m0, s52, 67584
  v_mfma_f32_16x16x32_bf16 a[64:67], v[84:87], v[140:143], a[64:67]
  s_cbranch_vccz L_gd_72
  buffer_load_dwordx4 v4, s[8:11], s20 offen  lds
L_gd_72:
  v_mfma_f32_16x16x32_bf16 a[68:71], v[84:87], v[144:147], a[68:71]
  v_mfma_f32_16x16x32_bf16 a[72:75], v[84:87], v[148:151], a[72:75]
  v_mfma_f32_16x16x32_bf16 a[76:79], v[84:87], v[152:155], a[76:79]
  s_add_u32 m0, s53, 67584
  v_mfma_f32_16x16x32_bf16 a[80:83], v[84:87], v[156:159], a[80:83]
  s_cbranch_vccz L_gd_73
  buffer_load_dwordx4 v12, s[12:15], s21 offen  lds
L_gd_73:
  v_mfma_f32_16x16x32_bf16 a[84:87], v[84:87], v[160:163], a[84:87]
  v_mfma_f32_16x16x32_bf16 a[88:91], v[84:87], v[164:167], a[88:91]
  v_mfma_f32_16x16x32_bf16 a[92:95], v[84:87], v[168:171], a[92:95]
  s_add_u32 m0, s52, 68608
  v_mfma_f32_16x16x32_bf16 a[96:99], v[88:91], v[140:143], a[96:99]
  s_cbranch_vccz L_gd_74
  buffer_load_dwordx4 v5, s[8:11], s20 offen  lds
L_gd_74:
  v_mfma_f32_16x16x32_bf16 a[100:103], v[88:91], v[144:147], a[100:103]
  v_mfma_f32_16x16x32_bf16 a[104:107], v[88:91], v[148:151], a[104:107]
  v_mfma_f32_16x16x32_bf16 a[108:111], v[88:91], v[152:155], a[108:111]
  s_add_u32 m0, s53, 68608
  v_mfma_f32_16x16x32_bf16 a[112:115], v[88:91], v[156:159], a[112:115]
  s_cbranch_vccz L_gd_75
  buffer_load_dwordx4 v13, s[12:15], s21 offen  lds
L_gd_75:
  v_mfma_f32_16x16x32_bf16 a[116:119], v[88:91], v[160:163], a[116:119]
  v_mfma_f32_16x16x32_bf16 a[120:123], v[88:91], v[164:167], a[120:123]
  v_mfma_f32_16x16x32_bf16 a[124:127], v[88:91], v[168:171], a[124:127]
  s_add_u32 m0, s52, 69632
  v_mfma_f32_16x16x32_bf16 a[128:131], v[92:95], v[140:143], a[128:131]
  s_cbranch_vccz L_gd_76
  buffer_load_dwordx4 v6, s[8:11], s20 offen  lds
L_gd_76:
  v_mfma_f32_16x16x32_bf16 a[132:135], v[92:95], v[144:147], a[132:135]
  v_mfma_f32_16x16x32_bf16 a[136:139], v[92:95], v[148:151], a[136:139]
  v_mfma_f32_16x16x32_bf16 a[140:143], v[92:95], v[152:155], a[140:143]
  s_add_u32 m0, s53, 69632
  v_mfma_f32_16x16x32_bf16 a[144:147], v[92:95], v[156:159], a[144:147]
  s_cbranch_vccz L_gd_77
  buffer_load_dwordx4 v14, s[12:15], s21 offen  lds
L_gd_77:
  v_mfma_f32_16x16x32_bf16 a[148:151], v[92:95], v[160:163], a[148:151]
  v_mfma_f32_16x16x32_bf16 a[152:155], v[92:95], v[164:167], a[152:155]
  v_mfma_f32_16x16x32_bf16 a[156:159], v[92:95], v[168:171], a[156:159]
  s_add_u32 m0, s52, 70656
  v_mfma_f32_16x16x32_bf16 a[160:163], v[96:99], v[140:143], a[160:163]
  s_cbranch_vccz L_gd_78
  buffer_load_dwordx4 v7, s[8:11], s20 offen  lds
L_gd_78:
  v_mfma_f32_16x16x32_bf16 a[164:167], v[96:99], v[144:147], a[164:167]
  v_mfma_f32_16x16x32_bf16 a[168:171], v[96:99], v[148:151], a[168:171]
  v_mfma_f32_16x16x32_bf16 a[172:175], v[96:99], v[152:155], a[172:175]
  s_add_u32 m0, s53, 70656
  v_mfma_f32_16x16x32_bf16 a[176:179], v[96:99], v[156:159], a[176:179]
  s_cbranch_vccz L_gd_79
  buffer_load_dwordx4 v15, s[12:15], s21 offen  lds
L_gd_79:
  v_mfma_f32_16x16x32_bf16 a[180:183], v[96:99], v[160:163], a[180:183]
  v_mfma_f32_16x16x32_bf16 a[184:187], v[96:99], v[164:167], a[184:187]
  v_mfma_f32_16x16x32_bf16 a[188:191], v[96:99], v[168:171], a[188:191]
  s_add_u32 m0, s52, 71680
  v_mfma_f32_16x16x32_bf16 a[192:195], v[100:103], v[140:143], a[192:195]
  s_cbranch_vccz L_gd_80
  buffer_load_dwordx4 v8, s[8:11], s20 offen  lds
L_gd_80:
  v_mfma_f32_16x16x32_bf16 a[196:199], v[100:103], v[144:147], a[196:199]
  v_mfma_f32_16x16x32_bf16 a[200:203], v[100:103], v[148:151], a[200:203]
  v_mfma_f32_16x16x32_bf16 a[204:207], v[100:103], v[152:155], a[204:207]
  s_add_u32 m0, s53, 71680
  v_mfma_f32_16x16x32_bf16 a[208:211], v[100:103], v[156:159], a[208:211]
  s_cbranch_vccz L_gd_81
  buffer_load_dwordx4 v16, s[12:15], s21 offen  lds
L_gd_81:
  v_mfma_f32_16x16x32_bf16 a[212:215], v[100:103], v[160:163], a[212:215]
  v_mfma_f32_16x16x32_bf16 a[216:219], v[100:103], v[164:167], a[216:219]
  v_mfma_f32_16x16x32_bf16 a[220:223], v[100:103], v[168:171], a[220:223]
  s_add_u32 m0, s52, 72704
  v_mfma_f32_16x16x32_bf16 a[224:227], v[104:107], v[140:143], a[224:227]
  s_cbranch_vccz L_gd_82
  buffer_load_dwordx4 v9, s[8:11], s20 offen  lds
L_gd_82:
  v_mfma_f32_16x16x32_bf16 a[228:231], v[104:107], v[144:147], a[228:231]
  v_mfma_f32_16x16x32_bf16 a[232:235], v[104:107], v[148:151], a[232:235]
  v_mfma_f32_16x16x32_bf16 a[236:239], v[104:107], v[152:155], a[236:239]
  s_add_u32 m0, s53, 72704
  v_mfma_f32_16x16x32_bf16 a[240:243], v[104:107], v[156:159], a[240:243]
  s_cbranch_vccz L_gd_83
  buffer_load_dwordx4 v17, s[12:15], s21 offen  lds
  s_add_u32 s20, s20, 128
  s_add_u32 s21, s21, s51
L_gd_83:
  v_mfma_f32_16x16x32_bf16 a[244:247], v[104:107], v[160:163], a[244:247]
  v_mfma_f32_16x16x32_bf16 a[248:251], v[104:107], v[164:167], a[248:251]
  v_mfma_f32_16x16x32_bf16 a[252:255], v[104:107], v[168:171], a[252:255]
  s_cmp_eq_u32 s58, 1
  s_cbranch_scc1 L_epi
  s_branch L_have1
L_g2_cw:
  s_mov_b64 exec, 1
  ds_write_b32 v175, v244
  s_mov_b64 exec, -1
  s_branch L_g2_cwb
L_g2_cr:
  ds_read_b32 v246, v241
  s_cmp_eq_u32 s25, 1
  s_cbranch_scc1 L_g2_crb
  s_cmp_lg_u32 s32, 0
  s_cbranch_scc1 L_rq_84
  s_cmp_eq_u32 s39, 0
  s_cbranch_scc1 L_rq_84
  s_lshl_b32 s99, s33, 7
  s_add_u32 s99, s99, 0x3d00200
  v_mov_b32 v244, 1
  v_mov_b32 v245, 0
  s_mov_b64 exec, 1
  buffer_atomic_add v244, v245, s[4:7], s99 offen sc0 sc1
  s_mov_b64 exec, -1
L_rq_84:
  s_branch L_g2_crb
L_small:
  s_mov_b32 s8, s64
  s_and_b32 s9, s65, 0xffff
  s_mov_b32 s10, 0x400000
  s_mov_b32 s11, 0x20000
  s_cmp_eq_u32 s35, 9
  s_cselect_b64 s[88:89], s[70:71], s[72:73]
  s_mov_b32 s12, s88
  s_and_b32 s13, s89, 0xffff
  s_mov_b32 s14, 0x800000
  s_mov_b32 s15, 0x20000
  s_lshl_b32 s91, s33, 3
  s_add_u32 s91, s91, s37
  s_mov_b32 s24, 8192
  s_mov_b32 s26, 262144
  s_mov_b32 s23, 2048
  s_mov_b32 s25, 4
  s_lshl_b32 s20, s36, 18
  s_lshl_b32 s21, s91, 8
  s_sub_u32 s22, s35, 8
  s_lshl_b32 s22, s22, 24
  s_lshl_b32 s90, s36, 20
  s_add_u32 s22, s22, s90
  s_lshl_b32 s90, s91, 13
  s_add_u32 s22, s22, s90
  s_lshl_b32 s38, s36, 9
  s_add_u32 s38, s38, 28672
  s_lshl_b32 s90, s33, 7
  s_add_u32 s38, s38, s90
  v_and_b32 v1, 63, v0
  v_lshrrev_b32 v22, 6, v0
  s_nop 0
  v_readfirstlane_b32 s27, v22
  s_mul_i32 s90, s27, 32
  v_lshrrev_b32 v22, 3, v1
  v_add_u32 v22, s90, v22
  v_mul_lo_u32 v22, v22, s23
  v_lshrrev_b32 v23, 4, v1
  v_xor_b32 v23, v23, v1
  v_and_b32 v23, 7, v23
  v_lshl_add_u32 v2, v23, 4, v22
  s_mul_i32 s91, s23, 8
  v_add_u32 v3, s91, v2
  v_xor_b32 v3, 64, v3
  v_add_u32 v4, s91, v3
  v_xor_b32 v4, 64, v4
  v_add_u32 v5, s91, v4
  v_xor_b32 v5, 64, v5
  s_mul_i32 s90, s27, 16
  v_lshrrev_b32 v22, 4, v1
  v_add_u32 v22, 0, v22
  v_add_u32 v22, s90, v22
  v_and_b32 v23, 3, v22
  v_lshlrev_b32 v23, 1, v23
  v_and_b32 v24, 8, v22
  v_or_b32 v23, v23, v24
  v_xor_b32 v23, v23, v1
  v_and_b32 v23, 15, v23
  v_mul_lo_u32 v22, v22, s24
  v_lshl_add_u32 v6, v23, 4, v22
  v_lshrrev_b32 v22, 4, v1
  v_add_u32 v22, 4, v22
  v_add_u32 v22, s90, v22
  v_and_b32 v23, 3, v22
  v_lshlrev_b32 v23, 1, v23
  v_and_b32 v24, 8, v22
  v_or_b32 v23, v23, v24
  v_xor_b32 v23, v23, v1
  v_and_b32 v23, 15, v23
  v_mul_lo_u32 v22, v22, s24
  v_lshl_add_u32 v7, v23, 4, v22
  v_lshrrev_b32 v22, 4, v1
  v_add_u32 v22, 8, v22
  v_add_u32 v22, s90, v22
  v_and_b32 v23, 3, v22
  v_lshlrev_b32 v23, 1, v23
  v_and_b32 v24, 8, v22
  v_or_b32 v23, v23, v24
  v_xor_b32 v23, v23, v1
  v_and_b32 v23, 15, v23
  v_mul_lo_u32 v22, v22, s24
  v_lshl_add_u32 v8, v23, 4, v22
  v_lshrrev_b32 v22, 4, v1
  v_add_u32 v22, 12, v22
  v_add_u32 v22, s90, v22
  v_and_b32 v23, 3, v22
  v_lshlrev_b32 v23, 1, v23
  v_and_b32 v24, 8, v22
  v_or_b32 v23, v23, v24
  v_xor_b32 v23, v23, v1
  v_and_b32 v23, 15, v23
  v_mul_lo_u32 v22, v22, s24
  v_lshl_add_u32 v9, v23, 4, v22
  s_mul_i32 s51, s24, 64
  s_mul_i32 s52, s27, 4096
  s_mul_i32 s53, s27, 4096
  s_add_u32 s53, s53, 16384
  s_add_u32 m0, s52, 0
  s_nop 0
  buffer_load_dwordx4 v2, s[8:11], s20 offen  lds
  s_add_u32 m0, s53, 0
  s_nop 0
  buffer_load_dwordx4 v6, s[12:15], s21 offen  lds
  s_add_u32 m0, s52, 1024
  s_nop 0
  buffer_load_dwordx4 v3, s[8:11], s20 offen  lds
  s_add_u32 m0, s53, 1024
  s_nop 0
  buffer_load_dwordx4 v7, s[12:15], s21 offen  lds
  s_add_u32 m0, s52, 2048
  s_nop 0
  buffer_load_dwordx4 v4, s[8:11], s20 offen  lds
  s_add_u32 m0, s53, 2048
  s_nop 0
  buffer_load_dwordx4 v8, s[12:15], s21 offen  lds
  s_add_u32 m0, s52, 3072
  s_nop 0
  buffer_load_dwordx4 v5, s[8:11], s20 offen  lds
  s_add_u32 m0, s53, 3072
  s_nop 0
  buffer_load_dwordx4 v9, s[12:15], s21 offen  lds
  s_add_u32 s20, s20, 128
  s_add_u32 s21, s21, s51
  s_add_u32 m0, s52, 32768
  s_nop 0
  buffer_load_dwordx4 v2, s[8:11], s20 offen  lds
  s_add_u32 m0, s53, 32768
  s_nop 0
  buffer_load_dwordx4 v6, s[12:15], s21 offen  lds
  s_add_u32 m0, s52, 33792
  s_nop 0
  buffer_load_dwordx4 v3, s[8:11], s20 offen  lds
  s_add_u32 m0, s53, 33792
  s_nop 0
  buffer_load_dwordx4 v7, s[12:15], s21 offen  lds
  s_add_u32 m0, s52, 34816
  s_nop 0
  buffer_load_dwordx4 v4, s[8:11], s20 offen  lds
  s_add_u32 m0, s53, 34816
  s_nop 0
  buffer_load_dwordx4 v8, s[12:15], s21 offen  lds
  s_add_u32 m0, s52, 35840
  s_nop 0
  buffer_load_dwordx4 v5, s[8:11], s20 offen  lds
  s_add_u32 m0, s53, 35840
  s_nop 0
  buffer_load_dwordx4 v9, s[12:15], s21 offen  lds
  s_add_u32 s20, s20, 128
  s_add_u32 s21, s21, s51
  s_add_u32 m0, s52, 65536
  s_nop 0
  buffer_load_dwordx4 v2, s[8:11], s20 offen  lds
  s_add_u32 m0, s53, 65536
  s_nop 0
  buffer_load_dwordx4 v6, s[12:15], s21 offen  lds
  s_add_u32 m0, s52, 66560
  s_nop 0
  buffer_load_dwordx4 v3, s[8:11], s20 offen  lds
  s_add_u32 m0, s53, 66560
  s_nop 0
  buffer_load_dwordx4 v7, s[12:15], s21 offen  lds
  s_add_u32 m0, s52, 67584
  s_nop 0
  buffer_load_dwordx4 v4, s[8:11], s20 offen  lds
  s_add_u32 m0, s53, 67584
  s_nop 0
  buffer_load_dwordx4 v8, s[12:15], s21 offen  lds
  s_add_u32 m0, s52, 68608
  s_nop 0
  buffer_load_dwordx4 v5, s[8:11], s20 offen  lds
  s_add_u32 m0, s53, 68608
  s_nop 0
  buffer_load_dwordx4 v9, s[12:15], s21 offen  lds
  s_add_u32 s20, s20, 128
  s_add_u32 s21, s21, s51
  s_add_u32 m0, s52, 98304
  s_nop 0
  buffer_load_dwordx4 v2, s[8:11], s20 offen  lds
  s_add_u32 m0, s53, 98304
  s_nop 0
  buffer_load_dwordx4 v6, s[12:15], s21 offen  lds
  s_add_u32 m0, s52, 99328
  s_nop 0
  buffer_load_dwordx4 v3, s[8:11], s20 offen  lds
  s_add_u32 m0, s53, 99328
  s_nop 0
  buffer_load_dwordx4 v7, s[12:15], s21 offen  lds
  s_add_u32 m0, s52, 100352
  s_nop 0
  buffer_load_dwordx4 v4, s[8:11], s20 offen  lds
  s_add_u32 m0, s53, 100352
  s_nop 0
  buffer_load_dwordx4 v8, s[12:15], s21 offen  lds
  s_add_u32 m0, s52, 101376
  s_nop 0
  buffer_load_dwordx4 v5, s[8:11], s20 offen  lds
  s_add_u32 m0, s53, 101376
  s_nop 0
  buffer_load_dwordx4 v9, s[12:15], s21 offen  lds
  s_add_u32 s20, s20, 128
  s_add_u32 s21, s21, s51
  s_lshr_b32 s90, s27, 1
  s_and_b32 s91, s27, 1
  s_mul_i32 s92, s90, 8192
  v_mov_b32 v22, 0x0
  v_bfe_u32 v23, v1, 0, 4
  v_lshl_add_u32 v22, v23, 7, v22
  v_add_u32 v22, s92, v22
  v_lshrrev_b32 v23, 1, v1
  v_and_b32 v23, 7, v23
  v_lshrrev_b32 v24, 4, v1
  v_xor_b32 v23, v23, v24
  v_lshl_add_u32 v10, v23, 4, v22
  v_xor_b32 v11, 64, v10
  v_add_u32 v12, 65536, v10
  v_add_u32 v13, 65536, v11
  v_mov_b32 v22, 0x0
  v_bfe_u32 v23, v1, 2, 2
  v_lshl_add_u32 v22, v23, 8, v22
  v_bfe_u32 v23, v1, 4, 2
  v_lshl_add_u32 v22, v23, 11, v22
  v_bfe_u32 v23, v1, 0, 2
  v_lshl_add_u32 v22, v23, 3, v22
  v_bfe_u32 v24, v1, 2, 3
  s_mul_i32 s92, s91, 4
  s_add_u32 s93, s92, 0
  v_xor_b32 v23, s93, v24
  v_lshl_add_u32 v14, v23, 5, v22
  v_add_u32 v18, 65536, v14
  s_add_u32 s93, s92, 1
  v_xor_b32 v23, s93, v24
  v_lshl_add_u32 v15, v23, 5, v22
  v_add_u32 v19, 65536, v15
  s_add_u32 s93, s92, 2
  v_xor_b32 v23, s93, v24
  v_lshl_add_u32 v16, v23, 5, v22
  v_add_u32 v20, 65536, v16
  s_add_u32 s93, s92, 3
  v_xor_b32 v23, s93, v24
  v_lshl_add_u32 v17, v23, 5, v22
  v_add_u32 v21, 65536, v17
  s_mov_b32 s58, 2
  s_branch L_epi
L_r2:
  v_lshlrev_b32 v174, 7, v1
  s_sub_u32 s42, s34, 32
  s_lshl_b32 s40, s42, 2
  s_add_u32 s40, s40, s33
  s_lshl_b32 s40, s40, 2
  s_add_u32 s40, s40, s32
  s_lshl_b32 s40, s40, 13
  s_cmp_ge_u32 s42, 16
  s_cselect_b32 s40, 0x40000000, s40
  s_add_u32 s41, s40, 2097152
  s_mov_b32 s44, s64
  s_and_b32 s45, s65, 0xffff
  s_mov_b32 s46, 0x400000
  s_mov_b32 s47, 0x20000
  buffer_load_dword v175, v174, s[44:47], s40 offen
  s_mov_b32 s44, s64
  s_and_b32 s45, s65, 0xffff
  s_mov_b32 s46, 0x400000
  s_mov_b32 s47, 0x20000
  buffer_load_dword v175, v174, s[44:47], s41 offen
  s_cmp_eq_u32 s35, 10
  s_cbranch_scc1 L_g5
  s_waitcnt vmcnt(26)
  s_barrier
  ds_read_b128 v[28:31], v10 offset:0
  ds_read_b64_tr_b16 v[60:61], v14 offset:16384
  ds_read_b64_tr_b16 v[62:63], v14 offset:17408
  ds_read_b128 v[32:35], v10 offset:2048
  ds_read_b64_tr_b16 v[64:65], v15 offset:16384
  ds_read_b64_tr_b16 v[66:67], v15 offset:17408
  ds_read_b128 v[36:39], v10 offset:4096
  ds_read_b64_tr_b16 v[68:69], v16 offset:16384
  ds_read_b64_tr_b16 v[70:71], v16 offset:17408
  ds_read_b128 v[40:43], v10 offset:6144
  ds_read_b64_tr_b16 v[72:73], v17 offset:16384
  ds_read_b64_tr_b16 v[74:75], v17 offset:17408
  s_sub_u32 s25, s25, 1
  s_waitcnt lgkmcnt(0)
  v_mfma_f32_16x16x32_bf16 a[0:3], v[60:63], v[28:31], 0
  ds_read_b128 v[44:47], v11 offset:0
  v_mfma_f32_16x16x32_bf16 a[4:7], v[64:67], v[28:31], 0
  ds_read_b64_tr_b16 v[76:77], v14 offset:24576
  v_mfma_f32_16x16x32_bf16 a[8:11], v[68:71], v[28:31], 0
  ds_read_b64_tr_b16 v[78:79], v14 offset:25600
  v_mfma_f32_16x16x32_bf16 a[12:15], v[72:75], v[28:31], 0
  ds_read_b128 v[48:51], v11 offset:2048
  v_mfma_f32_16x16x32_bf16 a[16:19], v[60:63], v[32:35], 0
  ds_read_b64_tr_b16 v[80:81], v15 offset:24576
  v_mfma_f32_16x16x32_bf16 a[20:23], v[64:67], v[32:35], 0
  ds_read_b64_tr_b16 v[82:83], v15 offset:25600
  v_mfma_f32_16x16x32_bf16 a[24:27], v[68:71], v[32:35], 0
  ds_read_b128 v[52:55], v11 offset:4096
  v_mfma_f32_16x16x32_bf16 a[28:31], v[72:75], v[32:35], 0
  ds_read_b64_tr_b16 v[84:85], v16 offset:24576
  v_mfma_f32_16x16x32_bf16 a[32:35], v[60:63], v[36:39], 0
  ds_read_b64_tr_b16 v[86:87], v16 offset:25600
  v_mfma_f32_16x16x32_bf16 a[36:39], v[64:67], v[36:39], 0
  ds_read_b128 v[56:59], v11 offset:6144
  v_mfma_f32_16x16x32_bf16 a[40:43], v[68:71], v[36:39], 0
  ds_read_b64_tr_b16 v[88:89], v17 offset:24576
  v_mfma_f32_16x16x32_bf16 a[44:47], v[72:75], v[36:39], 0
  ds_read_b64_tr_b16 v[90:91], v17 offset:25600
  v_mfma_f32_16x16x32_bf16 a[48:51], v[60:63], v[40:43], 0
  v_mfma_f32_16x16x32_bf16 a[52:55], v[64:67], v[40:43], 0
  v_mfma_f32_16x16x32_bf16 a[56:59], v[68:71], v[40:43], 0
  v_mfma_f32_16x16x32_bf16 a[60:63], v[72:75], v[40:43], 0
  s_waitcnt lgkmcnt(0)
  v_mfma_f32_16x16x32_bf16 a[0:3], v[76:79], v[44:47], a[0:3]
  s_waitcnt vmcnt(18)
  s_barrier
  s_add_u32 m0, s52, 0
  v_mfma_f32_16x16x32_bf16 a[4:7], v[80:83], v[44:47], a[4:7]
  buffer_load_dwordx4 v2, s[8:11], s20 offen  lds
  ds_read_b128 v[28:31], v10 offset:32768
  v_mfma_f32_16x16x32_bf16 a[8:11], v[84:87], v[44:47], a[8:11]
  ds_read_b64_tr_b16 v[60:61], v14 offset:49152
  v_mfma_f32_16x16x32_bf16 a[12:15], v[88:91], v[44:47], a[12:15]
  ds_read_b64_tr_b16 v[62:63], v14 offset:50176
  s_add_u32 m0, s53, 0
  v_mfma_f32_16x16x32_bf16 a[16:19], v[76:79], v[48:51], a[16:19]
  buffer_load_dwordx4 v6, s[12:15], s21 offen  lds
  ds_read_b128 v[32:35], v10 offset:34816
  v_mfma_f32_16x16x32_bf16 a[20:23], v[80:83], v[48:51], a[20:23]
  ds_read_b64_tr_b16 v[64:65], v15 offset:49152
  v_mfma_f32_16x16x32_bf16 a[24:27], v[84:87], v[48:51], a[24:27]
  ds_read_b64_tr_b16 v[66:67], v15 offset:50176
  s_add_u32 m0, s52, 1024
  v_mfma_f32_16x16x32_bf16 a[28:31], v[88:91], v[48:51], a[28:31]
  buffer_load_dwordx4 v3, s[8:11], s20 offen  lds
  ds_read_b128 v[36:39], v10 offset:36864
  v_mfma_f32_16x16x32_bf16 a[32:35], v[76:79], v[52:55], a[32:35]
  ds_read_b64_tr_b16 v[68:69], v16 offset:49152
  v_mfma_f32_16x16x32_bf16 a[36:39], v[80:83], v[52:55], a[36:39]
  ds_read_b64_tr_b16 v[70:71], v16 offset:50176
  s_add_u32 m0, s53, 1024
  v_mfma_f32_16x16x32_bf16 a[40:43], v[84:87], v[52:55], a[40:43]
  buffer_load_dwordx4 v7, s[12:15], s21 offen  lds
  ds_read_b128 v[40:43], v10 offset:38912
  v_mfma_f32_16x16x32_bf16 a[44:47], v[88:91], v[52:55], a[44:47]
  ds_read_b64_tr_b16 v[72:73], v17 offset:49152
  v_mfma_f32_16x16x32_bf16 a[48:51], v[76:79], v[56:59], a[48:51]
  ds_read_b64_tr_b16 v[74:75], v17 offset:50176
  s_add_u32 m0, s52, 2048
  v_mfma_f32_16x16x32_bf16 a[52:55], v[80:83], v[56:59], a[52:55]
  buffer_load_dwordx4 v4, s[8:11], s20 offen  lds
  v_mfma_f32_16x16x32_bf16 a[56:59], v[84:87], v[56:59], a[56:59]
  v_mfma_f32_16x16x32_bf16 a[60:63], v[88:91], v[56:59], a[60:63]
  s_waitcnt lgkmcnt(0)
  s_add_u32 m0, s53, 2048
  v_mfma_f32_16x16x32_bf16 a[0:3], v[60:63], v[28:31], a[0:3]
  buffer_load_dwordx4 v8, s[12:15], s21 offen  lds
  ds_read_b128 v[44:47], v11 offset:32768
  v_mfma_f32_16x16x32_bf16 a[4:7], v[64:67], v[28:31], a[4:7]
  ds_read_b64_tr_b16 v[76:77], v14 offset:57344
  v_mfma_f32_16x16x32_bf16 a[8:11], v[68:71], v[28:31], a[8:11]
  ds_read_b64_tr_b16 v[78:79], v14 offset:58368
  v_mfma_f32_16x16x32_bf16 a[12:15], v[72:75], v[28:31], a[12:15]
  ds_read_b128 v[48:51], v11 offset:34816
  s_add_u32 m0, s52, 3072
  v_mfma_f32_16x16x32_bf16 a[16:19], v[60:63], v[32:35], a[16:19]
  buffer_load_dwordx4 v5, s[8:11], s20 offen  lds
  ds_read_b64_tr_b16 v[80:81], v15 offset:57344
  v_mfma_f32_16x16x32_bf16 a[20:23], v[64:67], v[32:35], a[20:23]
  ds_read_b64_tr_b16 v[82:83], v15 offset:58368
  v_mfma_f32_16x16x32_bf16 a[24:27], v[68:71], v[32:35], a[24:27]
  ds_read_b128 v[52:55], v11 offset:36864
  v_mfma_f32_16x16x32_bf16 a[28:31], v[72:75], v[32:35], a[28:31]
  ds_read_b64_tr_b16 v[84:85], v16 offset:57344
  s_add_u32 m0, s53, 3072
  v_mfma_f32_16x16x32_bf16 a[32:35], v[60:63], v[36:39], a[32:35]
  buffer_load_dwordx4 v9, s[12:15], s21 offen  lds
  ds_read_b64_tr_b16 v[86:87], v16 offset:58368
  v_mfma_f32_16x16x32_bf16 a[36:39], v[64:67], v[36:39], a[36:39]
  ds_read_b128 v[56:59], v11 offset:38912
  v_mfma_f32_16x16x32_bf16 a[40:43], v[68:71], v[36:39], a[40:43]
  ds_read_b64_tr_b16 v[88:89], v17 offset:57344
  v_mfma_f32_16x16x32_bf16 a[44:47], v[72:75], v[36:39], a[44:47]
  ds_read_b64_tr_b16 v[90:91], v17 offset:58368
  s_add_u32 s20, s20, 128
  v_mfma_f32_16x16x32_bf16 a[48:51], v[60:63], v[40:43], a[48:51]
  s_add_u32 s21, s21, s51
  v_mfma_f32_16x16x32_bf16 a[52:55], v[64:67], v[40:43], a[52:55]
  v_mfma_f32_16x16x32_bf16 a[56:59], v[68:71], v[40:43], a[56:59]
  v_mfma_f32_16x16x32_bf16 a[60:63], v[72:75], v[40:43], a[60:63]
  s_waitcnt lgkmcnt(0)
  v_mfma_f32_16x16x32_bf16 a[0:3], v[76:79], v[44:47], a[0:3]
  s_waitcnt vmcnt(18)
  s_barrier
  s_add_u32 m0, s52, 32768
  v_mfma_f32_16x16x32_bf16 a[4:7], v[80:83], v[44:47], a[4:7]
  buffer_load_dwordx4 v2, s[8:11], s20 offen  lds
  ds_read_b128 v[28:31], v12 offset:0
  v_mfma_f32_16x16x32_bf16 a[8:11], v[84:87], v[44:47], a[8:11]
  ds_read_b64_tr_b16 v[60:61], v18 offset:16384
  v_mfma_f32_16x16x32_bf16 a[12:15], v[88:91], v[44:47], a[12:15]
  ds_read_b64_tr_b16 v[62:63], v18 offset:17408
  s_add_u32 m0, s53, 32768
  v_mfma_f32_16x16x32_bf16 a[16:19], v[76:79], v[48:51], a[16:19]
  buffer_load_dwordx4 v6, s[12:15], s21 offen  lds
  ds_read_b128 v[32:35], v12 offset:2048
  v_mfma_f32_16x16x32_bf16 a[20:23], v[80:83], v[48:51], a[20:23]
  ds_read_b64_tr_b16 v[64:65], v19 offset:16384
  v_mfma_f32_16x16x32_bf16 a[24:27], v[84:87], v[48:51], a[24:27]
  ds_read_b64_tr_b16 v[66:67], v19 offset:17408
  s_add_u32 m0, s52, 33792
  v_mfma_f32_16x16x32_bf16 a[28:31], v[88:91], v[48:51], a[28:31]
  buffer_load_dwordx4 v3, s[8:11], s20 offen  lds
  ds_read_b128 v[36:39], v12 offset:4096
  v_mfma_f32_16x16x32_bf16 a[32:35], v[76:79], v[52:55], a[32:35]
  ds_read_b64_tr_b16 v[68:69], v20 offset:16384
  v_mfma_f32_16x16x32_bf16 a[36:39], v[80:83], v[52:55], a[36:39]
  ds_read_b64_tr_b16 v[70:71], v20 offset:17408
  s_add_u32 m0, s53, 33792
  v_mfma_f32_16x16x32_bf16 a[40:43], v[84:87], v[52:55], a[40:43]
  buffer_load_dwordx4 v7, s[12:15], s21 offen  lds
  ds_read_b128 v[40:43], v12 offset:6144
  v_mfma_f32_16x16x32_bf16 a[44:47], v[88:91], v[52:55], a[44:47]
  ds_read_b64_tr_b16 v[72:73], v21 offset:16384
  v_mfma_f32_16x16x32_bf16 a[48:51], v[76:79], v[56:59], a[48:51]
  ds_read_b64_tr_b16 v[74:75], v21 offset:17408
  s_add_u32 m0, s52, 34816
  v_mfma_f32_16x16x32_bf16 a[52:55], v[80:83], v[56:59], a[52:55]
  buffer_load_dwordx4 v4, s[8:11], s20 offen  lds
  v_mfma_f32_16x16x32_bf16 a[56:59], v[84:87], v[56:59], a[56:59]
  v_mfma_f32_16x16x32_bf16 a[60:63], v[88:91], v[56:59], a[60:63]
  s_waitcnt lgkmcnt(0)
  s_add_u32 m0, s53, 34816
  v_mfma_f32_16x16x32_bf16 a[0:3], v[60:63], v[28:31], a[0:3]
  buffer_load_dwordx4 v8, s[12:15], s21 offen  lds
  ds_read_b128 v[44:47], v13 offset:0
  v_mfma_f32_16x16x32_bf16 a[4:7], v[64:67], v[28:31], a[4:7]
  ds_read_b64_tr_b16 v[76:77], v18 offset:24576
  v_mfma_f32_16x16x32_bf16 a[8:11], v[68:71], v[28:31], a[8:11]
  ds_read_b64_tr_b16 v[78:79], v18 offset:25600
  v_mfma_f32_16x16x32_bf16 a[12:15], v[72:75], v[28:31], a[12:15]
  ds_read_b128 v[48:51], v13 offset:2048
  s_add_u32 m0, s52, 35840
  v_mfma_f32_16x16x32_bf16 a[16:19], v[60:63], v[32:35], a[16:19]
  buffer_load_dwordx4 v5, s[8:11], s20 offen  lds
  ds_read_b64_tr_b16 v[80:81], v19 offset:24576
  v_mfma_f32_16x16x32_bf16 a[20:23], v[64:67], v[32:35], a[20:23]
  ds_read_b64_tr_b16 v[82:83], v19 offset:25600
  v_mfma_f32_16x16x32_bf16 a[24:27], v[68:71], v[32:35], a[24:27]
  ds_read_b128 v[52:55], v13 offset:4096
  v_mfma_f32_16x16x32_bf16 a[28:31], v[72:75], v[32:35], a[28:31]
  ds_read_b64_tr_b16 v[84:85], v20 offset:24576
  s_add_u32 m0, s53, 35840
  v_mfma_f32_16x16x32_bf16 a[32:35], v[60:63], v[36:39], a[32:35]
  buffer_load_dwordx4 v9, s[12:15], s21 offen  lds
  ds_read_b64_tr_b16 v[86:87], v20 offset:25600
  v_mfma_f32_16x16x32_bf16 a[36:39], v[64:67], v[36:39], a[36:39]
  ds_read_b128 v[56:59], v13 offset:6144
  v_mfma_f32_16x16x32_bf16 a[40:43], v[68:71], v[36:39], a[40:43]
  ds_read_b64_tr_b16 v[88:89], v21 offset:24576
  v_mfma_f32_16x16x32_bf16 a[44:47], v[72:75], v[36:39], a[44:47]
  ds_read_b64_tr_b16 v[90:91], v21 offset:25600
  s_add_u32 s20, s20, 128
  v_mfma_f32_16x16x32_bf16 a[48:51], v[60:63], v[40:43], a[48:51]
  s_add_u32 s21, s21, s51
  v_mfma_f32_16x16x32_bf16 a[52:55], v[64:67], v[40:43], a[52:55]
  v_mfma_f32_16x16x32_bf16 a[56:59], v[68:71], v[40:43], a[56:59]
  v_mfma_f32_16x16x32_bf16 a[60:63], v[72:75], v[40:43], a[60:63]
  s_waitcnt lgkmcnt(0)
  v_mfma_f32_16x16x32_bf16 a[0:3], v[76:79], v[44:47], a[0:3]
  s_waitcnt vmcnt(18)
  s_barrier
  s_add_u32 m0, s52, 65536
  v_mfma_f32_16x16x32_bf16 a[4:7], v[80:83], v[44:47], a[4:7]
  buffer_load_dwordx4 v2, s[8:11], s20 offen  lds
  ds_read_b128 v[28:31], v12 offset:32768
  v_mfma_f32_16x16x32_bf16 a[8:11], v[84:87], v[44:47], a[8:11]
  ds_read_b64_tr_b16 v[60:61], v18 offset:49152
  v_mfma_f32_16x16x32_bf16 a[12:15], v[88:91], v[44:47], a[12:15]
  ds_read_b64_tr_b16 v[62:63], v18 offset:50176
  s_add_u32 m0, s53, 65536
  v_mfma_f32_16x16x32_bf16 a[16:19], v[76:79], v[48:51], a[16:19]
  buffer_load_dwordx4 v6, s[12:15], s21 offen  lds
  ds_read_b128 v[32:35], v12 offset:34816
  v_mfma_f32_16x16x32_bf16 a[20:23], v[80:83], v[48:51], a[20:23]
  ds_read_b64_tr_b16 v[64:65], v19 offset:49152
  v_mfma_f32_16x16x32_bf16 a[24:27], v[84:87], v[48:51], a[24:27]
  ds_read_b64_tr_b16 v[66:67], v19 offset:50176
  s_add_u32 m0, s52, 66560
  v_mfma_f32_16x16x32_bf16 a[28:31], v[88:91], v[48:51], a[28:31]
  buffer_load_dwordx4 v3, s[8:11], s20 offen  lds
  ds_read_b128 v[36:39], v12 offset:36864
  v_mfma_f32_16x16x32_bf16 a[32:35], v[76:79], v[52:55], a[32:35]
  ds_read_b64_tr_b16 v[68:69], v20 offset:49152
  v_mfma_f32_16x16x32_bf16 a[36:39], v[80:83], v[52:55], a[36:39]
  ds_read_b64_tr_b16 v[70:71], v20 offset:50176
  s_add_u32 m0, s53, 66560
  v_mfma_f32_16x16x32_bf16 a[40:43], v[84:87], v[52:55], a[40:43]
  buffer_load_dwordx4 v7, s[12:15], s21 offen  lds
  ds_read_b128 v[40:43], v12 offset:38912
  v_mfma_f32_16x16x32_bf16 a[44:47], v[88:91], v[52:55], a[44:47]
  ds_read_b64_tr_b16 v[72:73], v21 offset:49152
  v_mfma_f32_16x16x32_bf16 a[48:51], v[76:79], v[56:59], a[48:51]
  ds_read_b64_tr_b16 v[74:75], v21 offset:50176
  s_add_u32 m0, s52, 67584
  v_mfma_f32_16x16x32_bf16 a[52:55], v[80:83], v[56:59], a[52:55]
  buffer_load_dwordx4 v4, s[8:11], s20 offen  lds
  v_mfma_f32_16x16x32_bf16 a[56:59], v[84:87], v[56:59], a[56:59]
  v_mfma_f32_16x16x32_bf16 a[60:63], v[88:91], v[56:59], a[60:63]
  s_waitcnt lgkmcnt(0)
  s_add_u32 m0, s53, 67584
  v_mfma_f32_16x16x32_bf16 a[0:3], v[60:63], v[28:31], a[0:3]
  buffer_load_dwordx4 v8, s[12:15], s21 offen  lds
  ds_read_b128 v[44:47], v13 offset:32768
  v_mfma_f32_16x16x32_bf16 a[4:7], v[64:67], v[28:31], a[4:7]
  ds_read_b64_tr_b16 v[76:77], v18 offset:57344
  v_mfma_f32_16x16x32_bf16 a[8:11], v[68:71], v[28:31], a[8:11]
  ds_read_b64_tr_b16 v[78:79], v18 offset:58368
  v_mfma_f32_16x16x32_bf16 a[12:15], v[72:75], v[28:31], a[12:15]
  ds_read_b128 v[48:51], v13 offset:34816
  s_add_u32 m0, s52, 68608
  v_mfma_f32_16x16x32_bf16 a[16:19], v[60:63], v[32:35], a[16:19]
  buffer_load_dwordx4 v5, s[8:11], s20 offen  lds
  ds_read_b64_tr_b16 v[80:81], v19 offset:57344
  v_mfma_f32_16x16x32_bf16 a[20:23], v[64:67], v[32:35], a[20:23]
  ds_read_b64_tr_b16 v[82:83], v19 offset:58368
  v_mfma_f32_16x16x32_bf16 a[24:27], v[68:71], v[32:35], a[24:27]
  ds_read_b128 v[52:55], v13 offset:36864
  v_mfma_f32_16x16x32_bf16 a[28:31], v[72:75], v[32:35], a[28:31]
  ds_read_b64_tr_b16 v[84:85], v20 offset:57344
  s_add_u32 m0, s53, 68608
  v_mfma_f32_16x16x32_bf16 a[32:35], v[60:63], v[36:39], a[32:35]
  buffer_load_dwordx4 v9, s[12:15], s21 offen  lds
  ds_read_b64_tr_b16 v[86:87], v20 offset:58368
  v_mfma_f32_16x16x32_bf16 a[36:39], v[64:67], v[36:39], a[36:39]
  ds_read_b128 v[56:59], v13 offset:38912
  v_mfma_f32_16x16x32_bf16 a[40:43], v[68:71], v[36:39], a[40:43]
  ds_read_b64_tr_b16 v[88:89], v21 offset:57344
  v_mfma_f32_16x16x32_bf16 a[44:47], v[72:75], v[36:39], a[44:47]
  ds_read_b64_tr_b16 v[90:91], v21 offset:58368
  s_add_u32 s20, s20, 128
  v_mfma_f32_16x16x32_bf16 a[48:51], v[60:63], v[40:43], a[48:51]
  s_add_u32 s21, s21, s51
  v_mfma_f32_16x16x32_bf16 a[52:55], v[64:67], v[40:43], a[52:55]
  v_mfma_f32_16x16x32_bf16 a[56:59], v[68:71], v[40:43], a[56:59]
  v_mfma_f32_16x16x32_bf16 a[60:63], v[72:75], v[40:43], a[60:63]
  s_waitcnt lgkmcnt(0)
  v_mfma_f32_16x16x32_bf16 a[0:3], v[76:79], v[44:47], a[0:3]
  s_waitcnt vmcnt(16)
  s_barrier
  s_add_u32 m0, s52, 98304
  v_mfma_f32_16x16x32_bf16 a[4:7], v[80:83], v[44:47], a[4:7]
  buffer_load_dwordx4 v2, s[8:11], s20 offen  lds
  ds_read_b128 v[28:31], v10 offset:0
  v_mfma_f32_16x16x32_bf16 a[8:11], v[84:87], v[44:47], a[8:11]
  ds_read_b64_tr_b16 v[60:61], v14 offset:16384
  v_mfma_f32_16x16x32_bf16 a[12:15], v[88:91], v[44:47], a[12:15]
  ds_read_b64_tr_b16 v[62:63], v14 offset:17408
  s_add_u32 m0, s53, 98304
  v_mfma_f32_16x16x32_bf16 a[16:19], v[76:79], v[48:51], a[16:19]
  buffer_load_dwordx4 v6, s[12:15], s21 offen  lds
  ds_read_b128 v[32:35], v10 offset:2048
  v_mfma_f32_16x16x32_bf16 a[20:23], v[80:83], v[48:51], a[20:23]
  ds_read_b64_tr_b16 v[64:65], v15 offset:16384
  v_mfma_f32_16x16x32_bf16 a[24:27], v[84:87], v[48:51], a[24:27]
  ds_read_b64_tr_b16 v[66:67], v15 offset:17408
  s_add_u32 m0, s52, 99328
  v_mfma_f32_16x16x32_bf16 a[28:31], v[88:91], v[48:51], a[28:31]
  buffer_load_dwordx4 v3, s[8:11], s20 offen  lds
  ds_read_b128 v[36:39], v10 offset:4096
  v_mfma_f32_16x16x32_bf16 a[32:35], v[76:79], v[52:55], a[32:35]
  ds_read_b64_tr_b16 v[68:69], v16 offset:16384
  v_mfma_f32_16x16x32_bf16 a[36:39], v[80:83], v[52:55], a[36:39]
  ds_read_b64_tr_b16 v[70:71], v16 offset:17408
  s_add_u32 m0, s53, 99328
  v_mfma_f32_16x16x32_bf16 a[40:43], v[84:87], v[52:55], a[40:43]
  buffer_load_dwordx4 v7, s[12:15], s21 offen  lds
  ds_read_b128 v[40:43], v10 offset:6144
  v_mfma_f32_16x16x32_bf16 a[44:47], v[88:91], v[52:55], a[44:47]
  ds_read_b64_tr_b16 v[72:73], v17 offset:16384
  v_mfma_f32_16x16x32_bf16 a[48:51], v[76:79], v[56:59], a[48:51]
  ds_read_b64_tr_b16 v[74:75], v17 offset:17408
  s_add_u32 m0, s52, 100352
  v_mfma_f32_16x16x32_bf16 a[52:55], v[80:83], v[56:59], a[52:55]
  buffer_load_dwordx4 v4, s[8:11], s20 offen  lds
  v_mfma_f32_16x16x32_bf16 a[56:59], v[84:87], v[56:59], a[56:59]
  v_mfma_f32_16x16x32_bf16 a[60:63], v[88:91], v[56:59], a[60:63]
L_g4_loop:
  s_sub_u32 s25, s25, 1
  s_cmp_eq_u32 s25, 0
  s_cbranch_scc1 L_g4_fin
  s_waitcnt lgkmcnt(0)
  s_add_u32 m0, s53, 100352
  v_mfma_f32_16x16x32_bf16 a[0:3], v[60:63], v[28:31], a[0:3]
  buffer_load_dwordx4 v8, s[12:15], s21 offen  lds
  ds_read_b128 v[44:47], v11 offset:0
  v_mfma_f32_16x16x32_bf16 a[4:7], v[64:67], v[28:31], a[4:7]
  ds_read_b64_tr_b16 v[76:77], v14 offset:24576
  v_mfma_f32_16x16x32_bf16 a[8:11], v[68:71], v[28:31], a[8:11]
  ds_read_b64_tr_b16 v[78:79], v14 offset:25600
  v_mfma_f32_16x16x32_bf16 a[12:15], v[72:75], v[28:31], a[12:15]
  ds_read_b128 v[48:51], v11 offset:2048
  s_add_u32 m0, s52, 101376
  v_mfma_f32_16x16x32_bf16 a[16:19], v[60:63], v[32:35], a[16:19]
  buffer_load_dwordx4 v5, s[8:11], s20 offen  lds
  ds_read_b64_tr_b16 v[80:81], v15 offset:24576
  v_mfma_f32_16x16x32_bf16 a[20:23], v[64:67], v[32:35], a[20:23]
  ds_read_b64_tr_b16 v[82:83], v15 offset:25600
  v_mfma_f32_16x16x32_bf16 a[24:27], v[68:71], v[32:35], a[24:27]
  ds_read_b128 v[52:55], v11 offset:4096
  v_mfma_f32_16x16x32_bf16 a[28:31], v[72:75], v[32:35], a[28:31]
  ds_read_b64_tr_b16 v[84:85], v16 offset:24576
  s_add_u32 m0, s53, 101376
  v_mfma_f32_16x16x32_bf16 a[32:35], v[60:63], v[36:39], a[32:35]
  buffer_load_dwordx4 v9, s[12:15], s21 offen  lds
  ds_read_b64_tr_b16 v[86:87], v16 offset:25600
  v_mfma_f32_16x16x32_bf16 a[36:39], v[64:67], v[36:39], a[36:39]
  ds_read_b128 v[56:59], v11 offset:6144
  v_mfma_f32_16x16x32_bf16 a[40:43], v[68:71], v[36:39], a[40:43]
  ds_read_b64_tr_b16 v[88:89], v17 offset:24576
  v_mfma_f32_16x16x32_bf16 a[44:47], v[72:75], v[36:39], a[44:47]
  ds_read_b64_tr_b16 v[90:91], v17 offset:25600
  s_add_u32 s20, s20, 128
  v_mfma_f32_16x16x32_bf16 a[48:51], v[60:63], v[40:43], a[48:51]
  s_add_u32 s21, s21, s51
  v_mfma_f32_16x16x32_bf16 a[52:55], v[64:67], v[40:43], a[52:55]
  v_mfma_f32_16x16x32_bf16 a[56:59], v[68:71], v[40:43], a[56:59]
  v_mfma_f32_16x16x32_bf16 a[60:63], v[72:75], v[40:43], a[60:63]
  s_waitcnt lgkmcnt(0)
  v_mfma_f32_16x16x32_bf16 a[0:3], v[76:79], v[44:47], a[0:3]
  s_waitcnt vmcnt(16)
  s_barrier
  s_add_u32 m0, s52, 0
  v_mfma_f32_16x16x32_bf16 a[4:7], v[80:83], v[44:47], a[4:7]
  buffer_load_dwordx4 v2, s[8:11], s20 offen  lds
  ds_read_b128 v[28:31], v10 offset:32768
  v_mfma_f32_16x16x32_bf16 a[8:11], v[84:87], v[44:47], a[8:11]
  ds_read_b64_tr_b16 v[60:61], v14 offset:49152
  v_mfma_f32_16x16x32_bf16 a[12:15], v[88:91], v[44:47], a[12:15]
  ds_read_b64_tr_b16 v[62:63], v14 offset:50176
  s_add_u32 m0, s53, 0
  v_mfma_f32_16x16x32_bf16 a[16:19], v[76:79], v[48:51], a[16:19]
  buffer_load_dwordx4 v6, s[12:15], s21 offen  lds
  ds_read_b128 v[32:35], v10 offset:34816
  v_mfma_f32_16x16x32_bf16 a[20:23], v[80:83], v[48:51], a[20:23]
  ds_read_b64_tr_b16 v[64:65], v15 offset:49152
  v_mfma_f32_16x16x32_bf16 a[24:27], v[84:87], v[48:51], a[24:27]
  ds_read_b64_tr_b16 v[66:67], v15 offset:50176
  s_add_u32 m0, s52, 1024
  v_mfma_f32_16x16x32_bf16 a[28:31], v[88:91], v[48:51], a[28:31]
  buffer_load_dwordx4 v3, s[8:11], s20 offen  lds
  ds_read_b128 v[36:39], v10 offset:36864
  v_mfma_f32_16x16x32_bf16 a[32:35], v[76:79], v[52:55], a[32:35]
  ds_read_b64_tr_b16 v[68:69], v16 offset:49152
  v_mfma_f32_16x16x32_bf16 a[36:39], v[80:83], v[52:55], a[36:39]
  ds_read_b64_tr_b16 v[70:71], v16 offset:50176
  s_add_u32 m0, s53, 1024
  v_mfma_f32_16x16x32_bf16 a[40:43], v[84:87], v[52:55], a[40:43]
  buffer_load_dwordx4 v7, s[12:15], s21 offen  lds
  ds_read_b128 v[40:43], v10 offset:38912
  v_mfma_f32_16x16x32_bf16 a[44:47], v[88:91], v[52:55], a[44:47]
  ds_read_b64_tr_b16 v[72:73], v17 offset:49152
  v_mfma_f32_16x16x32_bf16 a[48:51], v[76:79], v[56:59], a[48:51]
  ds_read_b64_tr_b16 v[74:75], v17 offset:50176
  s_add_u32 m0, s52, 2048
  v_mfma_f32_16x16x32_bf16 a[52:55], v[80:83], v[56:59], a[52:55]
  buffer_load_dwordx4 v4, s[8:11], s20 offen  lds
  v_mfma_f32_16x16x32_bf16 a[56:59], v[84:87], v[56:59], a[56:59]
  v_mfma_f32_16x16x32_bf16 a[60:63], v[88:91], v[56:59], a[60:63]
  s_waitcnt lgkmcnt(0)
  s_add_u32 m0, s53, 2048
  v_mfma_f32_16x16x32_bf16 a[0:3], v[60:63], v[28:31], a[0:3]
  buffer_load_dwordx4 v8, s[12:15], s21 offen  lds
  ds_read_b128 v[44:47], v11 offset:32768
  v_mfma_f32_16x16x32_bf16 a[4:7], v[64:67], v[28:31], a[4:7]
  ds_read_b64_tr_b16 v[76:77], v14 offset:57344
  v_mfma_f32_16x16x32_bf16 a[8:11], v[68:71], v[28:31], a[8:11]
  ds_read_b64_tr_b16 v[78:79], v14 offset:58368
  v_mfma_f32_16x16x32_bf16 a[12:15], v[72:75], v[28:31], a[12:15]
  ds_read_b128 v[48:51], v11 offset:34816
  s_add_u32 m0, s52, 3072
  v_mfma_f32_16x16x32_bf16 a[16:19], v[60:63], v[32:35], a[16:19]
  buffer_load_dwordx4 v5, s[8:11], s20 offen  lds
  ds_read_b64_tr_b16 v[80:81], v15 offset:57344
  v_mfma_f32_16x16x32_bf16 a[20:23], v[64:67], v[32:35], a[20:23]
  ds_read_b64_tr_b16 v[82:83], v15 offset:58368
  v_mfma_f32_16x16x32_bf16 a[24:27], v[68:71], v[32:35], a[24:27]
  ds_read_b128 v[52:55], v11 offset:36864
  v_mfma_f32_16x16x32_bf16 a[28:31], v[72:75], v[32:35], a[28:31]
  ds_read_b64_tr_b16 v[84:85], v16 offset:57344
  s_add_u32 m0, s53, 3072
  v_mfma_f32_16x16x32_bf16 a[32:35], v[60:63], v[36:39], a[32:35]
  buffer_load_dwordx4 v9, s[12:15], s21 offen  lds
  ds_read_b64_tr_b16 v[86:87], v16 offset:58368
  v_mfma_f32_16x16x32_bf16 a[36:39], v[64:67], v[36:39], a[36:39]
  ds_read_b128 v[56:59], v11 offset:38912
  v_mfma_f32_16x16x32_bf16 a[40:43], v[68:71], v[36:39], a[40:43]
  ds_read_b64_tr_b16 v[88:89], v17 offset:57344
  v_mfma_f32_16x16x32_bf16 a[44:47], v[72:75], v[36:39], a[44:47]
  ds_read_b64_tr_b16 v[90:91], v17 offset:58368
  s_add_u32 s20, s20, 128
  v_mfma_f32_16x16x32_bf16 a[48:51], v[60:63], v[40:43], a[48:51]
  s_add_u32 s21, s21, s51
  v_mfma_f32_16x16x32_bf16 a[52:55], v[64:67], v[40:43], a[52:55]
  v_mfma_f32_16x16x32_bf16 a[56:59], v[68:71], v[40:43], a[56:59]
  v_mfma_f32_16x16x32_bf16 a[60:63], v[72:75], v[40:43], a[60:63]
  s_waitcnt lgkmcnt(0)
  v_mfma_f32_16x16x32_bf16 a[0:3], v[76:79], v[44:47], a[0:3]
  s_waitcnt vmcnt(16)
  s_barrier
  s_add_u32 m0, s52, 32768
  v_mfma_f32_16x16x32_bf16 a[4:7], v[80:83], v[44:47], a[4:7]
  buffer_load_dwordx4 v2, s[8:11], s20 offen  lds
  ds_read_b128 v[28:31], v12 offset:0
  v_mfma_f32_16x16x32_bf16 a[8:11], v[84:87], v[44:47], a[8:11]
  ds_read_b64_tr_b16 v[60:61], v18 offset:16384
  v_mfma_f32_16x16x32_bf16 a[12:15], v[88:91], v[44:47], a[12:15]
  ds_read_b64_tr_b16 v[62:63], v18 offset:17408
  s_add_u32 m0, s53, 32768
  v_mfma_f32_16x16x32_bf16 a[16:19], v[76:79], v[48:51], a[16:19]
  buffer_load_dwordx4 v6, s[12:15], s21 offen  lds
  ds_read_b128 v[32:35], v12 offset:2048
  v_mfma_f32_16x16x32_bf16 a[20:23], v[80:83], v[48:51], a[20:23]
  ds_read_b64_tr_b16 v[64:65], v19 offset:16384
  v_mfma_f32_16x16x32_bf16 a[24:27], v[84:87], v[48:51], a[24:27]
  ds_read_b64_tr_b16 v[66:67], v19 offset:17408
  s_add_u32 m0, s52, 33792
  v_mfma_f32_16x16x32_bf16 a[28:31], v[88:91], v[48:51], a[28:31]
  buffer_load_dwordx4 v3, s[8:11], s20 offen  lds
  ds_read_b128 v[36:39], v12 offset:4096
  v_mfma_f32_16x16x32_bf16 a[32:35], v[76:79], v[52:55], a[32:35]
  ds_read_b64_tr_b16 v[68:69], v20 offset:16384
  v_mfma_f32_16x16x32_bf16 a[36:39], v[80:83], v[52:55], a[36:39]
  ds_read_b64_tr_b16 v[70:71], v20 offset:17408
  s_add_u32 m0, s53, 33792
  v_mfma_f32_16x16x32_bf16 a[40:43], v[84:87], v[52:55], a[40:43]
  buffer_load_dwordx4 v7, s[12:15], s21 offen  lds
  ds_read_b128 v[40:43], v12 offset:6144
  v_mfma_f32_16x16x32_bf16 a[44:47], v[88:91], v[52:55], a[44:47]
  ds_read_b64_tr_b16 v[72:73], v21 offset:16384
  v_mfma_f32_16x16x32_bf16 a[48:51], v[76:79], v[56:59], a[48:51]
  ds_read_b64_tr_b16 v[74:75], v21 offset:17408
  s_add_u32 m0, s52, 34816
  v_mfma_f32_16x16x32_bf16 a[52:55], v[80:83], v[56:59], a[52:55]
  buffer_load_dwordx4 v4, s[8:11], s20 offen  lds
  v_mfma_f32_16x16x32_bf16 a[56:59], v[84:87], v[56:59], a[56:59]
  v_mfma_f32_16x16x32_bf16 a[60:63], v[88:91], v[56:59], a[60:63]
  s_waitcnt lgkmcnt(0)
  s_add_u32 m0, s53, 34816
  v_mfma_f32_16x16x32_bf16 a[0:3], v[60:63], v[28:31], a[0:3]
  buffer_load_dwordx4 v8, s[12:15], s21 offen  lds
  ds_read_b128 v[44:47], v13 offset:0
  v_mfma_f32_16x16x32_bf16 a[4:7], v[64:67], v[28:31], a[4:7]
  ds_read_b64_tr_b16 v[76:77], v18 offset:24576
  v_mfma_f32_16x16x32_bf16 a[8:11], v[68:71], v[28:31], a[8:11]
  ds_read_b64_tr_b16 v[78:79], v18 offset:25600
  v_mfma_f32_16x16x32_bf16 a[12:15], v[72:75], v[28:31], a[12:15]
  ds_read_b128 v[48:51], v13 offset:2048
  s_add_u32 m0, s52, 35840
  v_mfma_f32_16x16x32_bf16 a[16:19], v[60:63], v[32:35], a[16:19]
  buffer_load_dwordx4 v5, s[8:11], s20 offen  lds
  ds_read_b64_tr_b16 v[80:81], v19 offset:24576
  v_mfma_f32_16x16x32_bf16 a[20:23], v[64:67], v[32:35], a[20:23]
  ds_read_b64_tr_b16 v[82:83], v19 offset:25600
  v_mfma_f32_16x16x32_bf16 a[24:27], v[68:71], v[32:35], a[24:27]
  ds_read_b128 v[52:55], v13 offset:4096
  v_mfma_f32_16x16x32_bf16 a[28:31], v[72:75], v[32:35], a[28:31]
  ds_read_b64_tr_b16 v[84:85], v20 offset:24576
  s_add_u32 m0, s53, 35840
  v_mfma_f32_16x16x32_bf16 a[32:35], v[60:63], v[36:39], a[32:35]
  buffer_load_dwordx4 v9, s[12:15], s21 offen  lds
  ds_read_b64_tr_b16 v[86:87], v20 offset:25600
  v_mfma_f32_16x16x32_bf16 a[36:39], v[64:67], v[36:39], a[36:39]
  ds_read_b128 v[56:59], v13 offset:6144
  v_mfma_f32_16x16x32_bf16 a[40:43], v[68:71], v[36:39], a[40:43]
  ds_read_b64_tr_b16 v[88:89], v21 offset:24576
  v_mfma_f32_16x16x32_bf16 a[44:47], v[72:75], v[36:39], a[44:47]
  ds_read_b64_tr_b16 v[90:91], v21 offset:25600
  s_add_u32 s20, s20, 128
  v_mfma_f32_16x16x32_bf16 a[48:51], v[60:63], v[40:43], a[48:51]
  s_add_u32 s21, s21, s51
  v_mfma_f32_16x16x32_bf16 a[52:55], v[64:67], v[40:43], a[52:55]
  v_mfma_f32_16x16x32_bf16 a[56:59], v[68:71], v[40:43], a[56:59]
  v_mfma_f32_16x16x32_bf16 a[60:63], v[72:75], v[40:43], a[60:63]
  s_waitcnt lgkmcnt(0)
  v_mfma_f32_16x16x32_bf16 a[0:3], v[76:79], v[44:47], a[0:3]
  s_waitcnt vmcnt(16)
  s_barrier
  s_add_u32 m0, s52, 65536
  v_mfma_f32_16x16x32_bf16 a[4:7], v[80:83], v[44:47], a[4:7]
  buffer_load_dwordx4 v2, s[8:11], s20 offen  lds
  ds_read_b128 v[28:31], v12 offset:32768
  v_mfma_f32_16x16x32_bf16 a[8:11], v[84:87], v[44:47], a[8:11]
  ds_read_b64_tr_b16 v[60:61], v18 offset:49152
  v_mfma_f32_16x16x32_bf16 a[12:15], v[88:91], v[44:47], a[12:15]
  ds_read_b64_tr_b16 v[62:63], v18 offset:50176
  s_add_u32 m0, s53, 65536
  v_mfma_f32_16x16x32_bf16 a[16:19], v[76:79], v[48:51], a[16:19]
  buffer_load_dwordx4 v6, s[12:15], s21 offen  lds
  ds_read_b128 v[32:35], v12 offset:34816
  v_mfma_f32_16x16x32_bf16 a[20:23], v[80:83], v[48:51], a[20:23]
  ds_read_b64_tr_b16 v[64:65], v19 offset:49152
  v_mfma_f32_16x16x32_bf16 a[24:27], v[84:87], v[48:51], a[24:27]
  ds_read_b64_tr_b16 v[66:67], v19 offset:50176
  s_add_u32 m0, s52, 66560
  v_mfma_f32_16x16x32_bf16 a[28:31], v[88:91], v[48:51], a[28:31]
  buffer_load_dwordx4 v3, s[8:11], s20 offen  lds
  ds_read_b128 v[36:39], v12 offset:36864
  v_mfma_f32_16x16x32_bf16 a[32:35], v[76:79], v[52:55], a[32:35]
  ds_read_b64_tr_b16 v[68:69], v20 offset:49152
  v_mfma_f32_16x16x32_bf16 a[36:39], v[80:83], v[52:55], a[36:39]
  ds_read_b64_tr_b16 v[70:71], v20 offset:50176
  s_add_u32 m0, s53, 66560
  v_mfma_f32_16x16x32_bf16 a[40:43], v[84:87], v[52:55], a[40:43]
  buffer_load_dwordx4 v7, s[12:15], s21 offen  lds
  ds_read_b128 v[40:43], v12 offset:38912
  v_mfma_f32_16x16x32_bf16 a[44:47], v[88:91], v[52:55], a[44:47]
  ds_read_b64_tr_b16 v[72:73], v21 offset:49152
  v_mfma_f32_16x16x32_bf16 a[48:51], v[76:79], v[56:59], a[48:51]
  ds_read_b64_tr_b16 v[74:75], v21 offset:50176
  s_add_u32 m0, s52, 67584
  v_mfma_f32_16x16x32_bf16 a[52:55], v[80:83], v[56:59], a[52:55]
  buffer_load_dwordx4 v4, s[8:11], s20 offen  lds
  v_mfma_f32_16x16x32_bf16 a[56:59], v[84:87], v[56:59], a[56:59]
  v_mfma_f32_16x16x32_bf16 a[60:63], v[88:91], v[56:59], a[60:63]
  s_waitcnt lgkmcnt(0)
  s_add_u32 m0, s53, 67584
  v_mfma_f32_16x16x32_bf16 a[0:3], v[60:63], v[28:31], a[0:3]
  buffer_load_dwordx4 v8, s[12:15], s21 offen  lds
  ds_read_b128 v[44:47], v13 offset:32768
  v_mfma_f32_16x16x32_bf16 a[4:7], v[64:67], v[28:31], a[4:7]
  ds_read_b64_tr_b16 v[76:77], v18 offset:57344
  v_mfma_f32_16x16x32_bf16 a[8:11], v[68:71], v[28:31], a[8:11]
  ds_read_b64_tr_b16 v[78:79], v18 offset:58368
  v_mfma_f32_16x16x32_bf16 a[12:15], v[72:75], v[28:31], a[12:15]
  ds_read_b128 v[48:51], v13 offset:34816
  s_add_u32 m0, s52, 68608
  v_mfma_f32_16x16x32_bf16 a[16:19], v[60:63], v[32:35], a[16:19]
  buffer_load_dwordx4 v5, s[8:11], s20 offen  lds
  ds_read_b64_tr_b16 v[80:81], v19 offset:57344
  v_mfma_f32_16x16x32_bf16 a[20:23], v[64:67], v[32:35], a[20:23]
  ds_read_b64_tr_b16 v[82:83], v19 offset:58368
  v_mfma_f32_16x16x32_bf16 a[24:27], v[68:71], v[32:35], a[24:27]
  ds_read_b128 v[52:55], v13 offset:36864
  v_mfma_f32_16x16x32_bf16 a[28:31], v[72:75], v[32:35], a[28:31]
  ds_read_b64_tr_b16 v[84:85], v20 offset:57344
  s_add_u32 m0, s53, 68608
  v_mfma_f32_16x16x32_bf16 a[32:35], v[60:63], v[36:39], a[32:35]
  buffer_load_dwordx4 v9, s[12:15], s21 offen  lds
  ds_read_b64_tr_b16 v[86:87], v20 offset:58368
  v_mfma_f32_16x16x32_bf16 a[36:39], v[64:67], v[36:39], a[36:39]
  ds_read_b128 v[56:59], v13 offset:38912
  v_mfma_f32_16x16x32_bf16 a[40:43], v[68:71], v[36:39], a[40:43]
  ds_read_b64_tr_b16 v[88:89], v21 offset:57344
  v_mfma_f32_16x16x32_bf16 a[44:47], v[72:75], v[36:39], a[44:47]
  ds_read_b64_tr_b16 v[90:91], v21 offset:58368
  s_add_u32 s20, s20, 128
  v_mfma_f32_16x16x32_bf16 a[48:51], v[60:63], v[40:43], a[48:51]
  s_add_u32 s21, s21, s51
  v_mfma_f32_16x16x32_bf16 a[52:55], v[64:67], v[40:43], a[52:55]
  v_mfma_f32_16x16x32_bf16 a[56:59], v[68:71], v[40:43], a[56:59]
  v_mfma_f32_16x16x32_bf16 a[60:63], v[72:75], v[40:43], a[60:63]
  s_waitcnt lgkmcnt(0)
  v_mfma_f32_16x16x32_bf16 a[0:3], v[76:79], v[44:47], a[0:3]
  s_waitcnt vmcnt(16)
  s_barrier
  s_add_u32 m0, s52, 98304
  v_mfma_f32_16x16x32_bf16 a[4:7], v[80:83], v[44:47], a[4:7]
  buffer_load_dwordx4 v2, s[8:11], s20 offen  lds
  ds_read_b128 v[28:31], v10 offset:0
  v_mfma_f32_16x16x32_bf16 a[8:11], v[84:87], v[44:47], a[8:11]
  ds_read_b64_tr_b16 v[60:61], v14 offset:16384
  v_mfma_f32_16x16x32_bf16 a[12:15], v[88:91], v[44:47], a[12:15]
  ds_read_b64_tr_b16 v[62:63], v14 offset:17408
  s_add_u32 m0, s53, 98304
  v_mfma_f32_16x16x32_bf16 a[16:19], v[76:79], v[48:51], a[16:19]
  buffer_load_dwordx4 v6, s[12:15], s21 offen  lds
  ds_read_b128 v[32:35], v10 offset:2048
  v_mfma_f32_16x16x32_bf16 a[20:23], v[80:83], v[48:51], a[20:23]
  ds_read_b64_tr_b16 v[64:65], v15 offset:16384
  v_mfma_f32_16x16x32_bf16 a[24:27], v[84:87], v[48:51], a[24:27]
  ds_read_b64_tr_b16 v[66:67], v15 offset:17408
  s_add_u32 m0, s52, 99328
  v_mfma_f32_16x16x32_bf16 a[28:31], v[88:91], v[48:51], a[28:31]
  buffer_load_dwordx4 v3, s[8:11], s20 offen  lds
  ds_read_b128 v[36:39], v10 offset:4096
  v_mfma_f32_16x16x32_bf16 a[32:35], v[76:79], v[52:55], a[32:35]
  ds_read_b64_tr_b16 v[68:69], v16 offset:16384
  v_mfma_f32_16x16x32_bf16 a[36:39], v[80:83], v[52:55], a[36:39]
  ds_read_b64_tr_b16 v[70:71], v16 offset:17408
  s_add_u32 m0, s53, 99328
  v_mfma_f32_16x16x32_bf16 a[40:43], v[84:87], v[52:55], a[40:43]
  buffer_load_dwordx4 v7, s[12:15], s21 offen  lds
  ds_read_b128 v[40:43], v10 offset:6144
  v_mfma_f32_16x16x32_bf16 a[44:47], v[88:91], v[52:55], a[44:47]
  ds_read_b64_tr_b16 v[72:73], v17 offset:16384
  v_mfma_f32_16x16x32_bf16 a[48:51], v[76:79], v[56:59], a[48:51]
  ds_read_b64_tr_b16 v[74:75], v17 offset:17408
  s_add_u32 m0, s52, 100352
  v_mfma_f32_16x16x32_bf16 a[52:55], v[80:83], v[56:59], a[52:55]
  buffer_load_dwordx4 v4, s[8:11], s20 offen  lds
  v_mfma_f32_16x16x32_bf16 a[56:59], v[84:87], v[56:59], a[56:59]
  v_mfma_f32_16x16x32_bf16 a[60:63], v[88:91], v[56:59], a[60:63]
  s_branch L_g4_loop
L_g4_fin:
  s_cmp_lg_u32 s32, 0
  s_cbranch_scc1 L_rq_85
  s_cmp_eq_u32 s39, 0
  s_cbranch_scc1 L_rq_85
  s_lshl_b32 s99, s33, 7
  s_add_u32 s99, s99, 0x3d00200
  v_mov_b32 v244, 1
  v_mov_b32 v245, 0
  s_mov_b64 exec, 1
  buffer_atomic_add v244, v245, s[4:7], s99 offen sc0 sc1
  s_mov_b64 exec, -1
L_rq_85:
  s_waitcnt lgkmcnt(0)
  s_add_u32 m0, s53, 100352
  v_mfma_f32_16x16x32_bf16 a[0:3], v[60:63], v[28:31], a[0:3]
  buffer_load_dwordx4 v8, s[12:15], s21 offen  lds
  ds_read_b128 v[44:47], v11 offset:0
  v_mfma_f32_16x16x32_bf16 a[4:7], v[64:67], v[28:31], a[4:7]
  ds_read_b64_tr_b16 v[76:77], v14 offset:24576
  v_mfma_f32_16x16x32_bf16 a[8:11], v[68:71], v[28:31], a[8:11]
  ds_read_b64_tr_b16 v[78:79], v14 offset:25600
  v_mfma_f32_16x16x32_bf16 a[12:15], v[72:75], v[28:31], a[12:15]
  ds_read_b128 v[48:51], v11 offset:2048
  s_add_u32 m0, s52, 101376
  v_mfma_f32_16x16x32_bf16 a[16:19], v[60:63], v[32:35], a[16:19]
  buffer_load_dwordx4 v5, s[8:11], s20 offen  lds
  ds_read_b64_tr_b16 v[80:81], v15 offset:24576
  v_mfma_f32_16x16x32_bf16 a[20:23], v[64:67], v[32:35], a[20:23]
  ds_read_b64_tr_b16 v[82:83], v15 offset:25600
  v_mfma_f32_16x16x32_bf16 a[24:27], v[68:71], v[32:35], a[24:27]
  ds_read_b128 v[52:55], v11 offset:4096
  v_mfma_f32_16x16x32_bf16 a[28:31], v[72:75], v[32:35], a[28:31]
  ds_read_b64_tr_b16 v[84:85], v16 offset:24576
  s_add_u32 m0, s53, 101376
  v_mfma_f32_16x16x32_bf16 a[32:35], v[60:63], v[36:39], a[32:35]
  buffer_load_dwordx4 v9, s[12:15], s21 offen  lds
  ds_read_b64_tr_b16 v[86:87], v16 offset:25600
  v_mfma_f32_16x16x32_bf16 a[36:39], v[64:67], v[36:39], a[36:39]
  ds_read_b128 v[56:59], v11 offset:6144
  v_mfma_f32_16x16x32_bf16 a[40:43], v[68:71], v[36:39], a[40:43]
  ds_read_b64_tr_b16 v[88:89], v17 offset:24576
  v_mfma_f32_16x16x32_bf16 a[44:47], v[72:75], v[36:39], a[44:47]
  ds_read_b64_tr_b16 v[90:91], v17 offset:25600
  s_add_u32 s20, s20, 128
  v_mfma_f32_16x16x32_bf16 a[48:51], v[60:63], v[40:43], a[48:51]
  s_add_u32 s21, s21, s51
  v_mfma_f32_16x16x32_bf16 a[52:55], v[64:67], v[40:43], a[52:55]
  v_mfma_f32_16x16x32_bf16 a[56:59], v[68:71], v[40:43], a[56:59]
  v_mfma_f32_16x16x32_bf16 a[60:63], v[72:75], v[40:43], a[60:63]
  s_waitcnt lgkmcnt(0)
  v_mfma_f32_16x16x32_bf16 a[0:3], v[76:79], v[44:47], a[0:3]
  s_waitcnt vmcnt(16)
  s_barrier
  v_mfma_f32_16x16x32_bf16 a[4:7], v[80:83], v[44:47], a[4:7]
  ds_read_b128 v[28:31], v10 offset:32768
  v_mfma_f32_16x16x32_bf16 a[8:11], v[84:87], v[44:47], a[8:11]
  ds_read_b64_tr_b16 v[60:61], v14 offset:49152
  v_mfma_f32_16x16x32_bf16 a[12:15], v[88:91], v[44:47], a[12:15]
  ds_read_b64_tr_b16 v[62:63], v14 offset:50176
  v_mfma_f32_16x16x32_bf16 a[16:19], v[76:79], v[48:51], a[16:19]
  ds_read_b128 v[32:35], v10 offset:34816
  v_mfma_f32_16x16x32_bf16 a[20:23], v[80:83], v[48:51], a[20:23]
  ds_read_b64_tr_b16 v[64:65], v15 offset:49152
  v_mfma_f32_16x16x32_bf16 a[24:27], v[84:87], v[48:51], a[24:27]
  ds_read_b64_tr_b16 v[66:67], v15 offset:50176
  v_mfma_f32_16x16x32_bf16 a[28:31], v[88:91], v[48:51], a[28:31]
  ds_read_b128 v[36:39], v10 offset:36864
  v_mfma_f32_16x16x32_bf16 a[32:35], v[76:79], v[52:55], a[32:35]
  ds_read_b64_tr_b16 v[68:69], v16 offset:49152
  v_mfma_f32_16x16x32_bf16 a[36:39], v[80:83], v[52:55], a[36:39]
  ds_read_b64_tr_b16 v[70:71], v16 offset:50176
  v_mfma_f32_16x16x32_bf16 a[40:43], v[84:87], v[52:55], a[40:43]
  ds_read_b128 v[40:43], v10 offset:38912
  v_mfma_f32_16x16x32_bf16 a[44:47], v[88:91], v[52:55], a[44:47]
  ds_read_b64_tr_b16 v[72:73], v17 offset:49152
  v_mfma_f32_16x16x32_bf16 a[48:51], v[76:79], v[56:59], a[48:51]
  ds_read_b64_tr_b16 v[74:75], v17 offset:50176
  v_mfma_f32_16x16x32_bf16 a[52:55], v[80:83], v[56:59], a[52:55]
  v_mfma_f32_16x16x32_bf16 a[56:59], v[84:87], v[56:59], a[56:59]
  v_mfma_f32_16x16x32_bf16 a[60:63], v[88:91], v[56:59], a[60:63]
  s_waitcnt lgkmcnt(0)
  v_mfma_f32_16x16x32_bf16 a[0:3], v[60:63], v[28:31], a[0:3]
  ds_read_b128 v[44:47], v11 offset:32768
  v_mfma_f32_16x16x32_bf16 a[4:7], v[64:67], v[28:31], a[4:7]
  ds_read_b64_tr_b16 v[76:77], v14 offset:57344
  v_mfma_f32_16x16x32_bf16 a[8:11], v[68:71], v[28:31], a[8:11]
  ds_read_b64_tr_b16 v[78:79], v14 offset:58368
  v_mfma_f32_16x16x32_bf16 a[12:15], v[72:75], v[28:31], a[12:15]
  ds_read_b128 v[48:51], v11 offset:34816
  v_mfma_f32_16x16x32_bf16 a[16:19], v[60:63], v[32:35], a[16:19]
  ds_read_b64_tr_b16 v[80:81], v15 offset:57344
  v_mfma_f32_16x16x32_bf16 a[20:23], v[64:67], v[32:35], a[20:23]
  ds_read_b64_tr_b16 v[82:83], v15 offset:58368
  v_mfma_f32_16x16x32_bf16 a[24:27], v[68:71], v[32:35], a[24:27]
  ds_read_b128 v[52:55], v11 offset:36864
  v_mfma_f32_16x16x32_bf16 a[28:31], v[72:75], v[32:35], a[28:31]
  ds_read_b64_tr_b16 v[84:85], v16 offset:57344
  v_mfma_f32_16x16x32_bf16 a[32:35], v[60:63], v[36:39], a[32:35]
  ds_read_b64_tr_b16 v[86:87], v16 offset:58368
  v_mfma_f32_16x16x32_bf16 a[36:39], v[64:67], v[36:39], a[36:39]
  ds_read_b128 v[56:59], v11 offset:38912
  v_mfma_f32_16x16x32_bf16 a[40:43], v[68:71], v[36:39], a[40:43]
  ds_read_b64_tr_b16 v[88:89], v17 offset:57344
  v_mfma_f32_16x16x32_bf16 a[44:47], v[72:75], v[36:39], a[44:47]
  ds_read_b64_tr_b16 v[90:91], v17 offset:58368
  v_mfma_f32_16x16x32_bf16 a[48:51], v[60:63], v[40:43], a[48:51]
  v_mfma_f32_16x16x32_bf16 a[52:55], v[64:67], v[40:43], a[52:55]
  v_mfma_f32_16x16x32_bf16 a[56:59], v[68:71], v[40:43], a[56:59]
  v_mfma_f32_16x16x32_bf16 a[60:63], v[72:75], v[40:43], a[60:63]
  s_waitcnt lgkmcnt(0)
  v_mfma_f32_16x16x32_bf16 a[0:3], v[76:79], v[44:47], a[0:3]
  s_waitcnt vmcnt(8)
  s_barrier
  v_mfma_f32_16x16x32_bf16 a[4:7], v[80:83], v[44:47], a[4:7]
  ds_read_b128 v[28:31], v12 offset:0
  v_mfma_f32_16x16x32_bf16 a[8:11], v[84:87], v[44:47], a[8:11]
  ds_read_b64_tr_b16 v[60:61], v18 offset:16384
  v_mfma_f32_16x16x32_bf16 a[12:15], v[88:91], v[44:47], a[12:15]
  ds_read_b64_tr_b16 v[62:63], v18 offset:17408
  v_mfma_f32_16x16x32_bf16 a[16:19], v[76:79], v[48:51], a[16:19]
  ds_read_b128 v[32:35], v12 offset:2048
  v_mfma_f32_16x16x32_bf16 a[20:23], v[80:83], v[48:51], a[20:23]
  ds_read_b64_tr_b16 v[64:65], v19 offset:16384
  v_mfma_f32_16x16x32_bf16 a[24:27], v[84:87], v[48:51], a[24:27]
  ds_read_b64_tr_b16 v[66:67], v19 offset:17408
  v_mfma_f32_16x16x32_bf16 a[28:31], v[88:91], v[48:51], a[28:31]
  ds_read_b128 v[36:39], v12 offset:4096
  v_mfma_f32_16x16x32_bf16 a[32:35], v[76:79], v[52:55], a[32:35]
  ds_read_b64_tr_b16 v[68:69], v20 offset:16384
  v_mfma_f32_16x16x32_bf16 a[36:39], v[80:83], v[52:55], a[36:39]
  ds_read_b64_tr_b16 v[70:71], v20 offset:17408
  v_mfma_f32_16x16x32_bf16 a[40:43], v[84:87], v[52:55], a[40:43]
  ds_read_b128 v[40:43], v12 offset:6144
  v_mfma_f32_16x16x32_bf16 a[44:47], v[88:91], v[52:55], a[44:47]
  ds_read_b64_tr_b16 v[72:73], v21 offset:16384
  v_mfma_f32_16x16x32_bf16 a[48:51], v[76:79], v[56:59], a[48:51]
  ds_read_b64_tr_b16 v[74:75], v21 offset:17408
  v_mfma_f32_16x16x32_bf16 a[52:55], v[80:83], v[56:59], a[52:55]
  v_mfma_f32_16x16x32_bf16 a[56:59], v[84:87], v[56:59], a[56:59]
  v_mfma_f32_16x16x32_bf16 a[60:63], v[88:91], v[56:59], a[60:63]
  s_waitcnt lgkmcnt(0)
  v_mfma_f32_16x16x32_bf16 a[0:3], v[60:63], v[28:31], a[0:3]
  ds_read_b128 v[44:47], v13 offset:0
  v_mfma_f32_16x16x32_bf16 a[4:7], v[64:67], v[28:31], a[4:7]
  ds_read_b64_tr_b16 v[76:77], v18 offset:24576
  v_mfma_f32_16x16x32_bf16 a[8:11], v[68:71], v[28:31], a[8:11]
  ds_read_b64_tr_b16 v[78:79], v18 offset:25600
  v_mfma_f32_16x16x32_bf16 a[12:15], v[72:75], v[28:31], a[12:15]
  ds_read_b128 v[48:51], v13 offset:2048
  v_mfma_f32_16x16x32_bf16 a[16:19], v[60:63], v[32:35], a[16:19]
  ds_read_b64_tr_b16 v[80:81], v19 offset:24576
  v_mfma_f32_16x16x32_bf16 a[20:23], v[64:67], v[32:35], a[20:23]
  ds_read_b64_tr_b16 v[82:83], v19 offset:25600
  v_mfma_f32_16x16x32_bf16 a[24:27], v[68:71], v[32:35], a[24:27]
  ds_read_b128 v[52:55], v13 offset:4096
  v_mfma_f32_16x16x32_bf16 a[28:31], v[72:75], v[32:35], a[28:31]
  ds_read_b64_tr_b16 v[84:85], v20 offset:24576
  v_mfma_f32_16x16x32_bf16 a[32:35], v[60:63], v[36:39], a[32:35]
  ds_read_b64_tr_b16 v[86:87], v20 offset:25600
  v_mfma_f32_16x16x32_bf16 a[36:39], v[64:67], v[36:39], a[36:39]
  ds_read_b128 v[56:59], v13 offset:6144
  v_mfma_f32_16x16x32_bf16 a[40:43], v[68:71], v[36:39], a[40:43]
  ds_read_b64_tr_b16 v[88:89], v21 offset:24576
  v_mfma_f32_16x16x32_bf16 a[44:47], v[72:75], v[36:39], a[44:47]
  ds_read_b64_tr_b16 v[90:91], v21 offset:25600
  v_mfma_f32_16x16x32_bf16 a[48:51], v[60:63], v[40:43], a[48:51]
  v_mfma_f32_16x16x32_bf16 a[52:55], v[64:67], v[40:43], a[52:55]
  v_mfma_f32_16x16x32_bf16 a[56:59], v[68:71], v[40:43], a[56:59]
  v_mfma_f32_16x16x32_bf16 a[60:63], v[72:75], v[40:43], a[60:63]
  s_waitcnt lgkmcnt(0)
  v_mfma_f32_16x16x32_bf16 a[0:3], v[76:79], v[44:47], a[0:3]
  s_waitcnt vmcnt(0)
  s_barrier
  v_mfma_f32_16x16x32_bf16 a[4:7], v[80:83], v[44:47], a[4:7]
  ds_read_b128 v[28:31], v12 offset:32768
  v_mfma_f32_16x16x32_bf16 a[8:11], v[84:87], v[44:47], a[8:11]
  ds_read_b64_tr_b16 v[60:61], v18 offset:49152
  v_mfma_f32_16x16x32_bf16 a[12:15], v[88:91], v[44:47], a[12:15]
  ds_read_b64_tr_b16 v[62:63], v18 offset:50176
  v_mfma_f32_16x16x32_bf16 a[16:19], v[76:79], v[48:51], a[16:19]
  ds_read_b128 v[32:35], v12 offset:34816
  v_mfma_f32_16x16x32_bf16 a[20:23], v[80:83], v[48:51], a[20:23]
  ds_read_b64_tr_b16 v[64:65], v19 offset:49152
  v_mfma_f32_16x16x32_bf16 a[24:27], v[84:87], v[48:51], a[24:27]
  ds_read_b64_tr_b16 v[66:67], v19 offset:50176
  v_mfma_f32_16x16x32_bf16 a[28:31], v[88:91], v[48:51], a[28:31]
  ds_read_b128 v[36:39], v12 offset:36864
  v_mfma_f32_16x16x32_bf16 a[32:35], v[76:79], v[52:55], a[32:35]
  ds_read_b64_tr_b16 v[68:69], v20 offset:49152
  v_mfma_f32_16x16x32_bf16 a[36:39], v[80:83], v[52:55], a[36:39]
  ds_read_b64_tr_b16 v[70:71], v20 offset:50176
  v_mfma_f32_16x16x32_bf16 a[40:43], v[84:87], v[52:55], a[40:43]
  ds_read_b128 v[40:43], v12 offset:38912
  v_mfma_f32_16x16x32_bf16 a[44:47], v[88:91], v[52:55], a[44:47]
  ds_read_b64_tr_b16 v[72:73], v21 offset:49152
  v_mfma_f32_16x16x32_bf16 a[48:51], v[76:79], v[56:59], a[48:51]
  ds_read_b64_tr_b16 v[74:75], v21 offset:50176
  v_mfma_f32_16x16x32_bf16 a[52:55], v[80:83], v[56:59], a[52:55]
  v_mfma_f32_16x16x32_bf16 a[56:59], v[84:87], v[56:59], a[56:59]
  v_mfma_f32_16x16x32_bf16 a[60:63], v[88:91], v[56:59], a[60:63]
  s_waitcnt lgkmcnt(0)
  v_mfma_f32_16x16x32_bf16 a[0:3], v[60:63], v[28:31], a[0:3]
  ds_read_b128 v[44:47], v13 offset:32768
  v_mfma_f32_16x16x32_bf16 a[4:7], v[64:67], v[28:31], a[4:7]
  ds_read_b64_tr_b16 v[76:77], v18 offset:57344
  v_mfma_f32_16x16x32_bf16 a[8:11], v[68:71], v[28:31], a[8:11]
  ds_read_b64_tr_b16 v[78:79], v18 offset:58368
  v_mfma_f32_16x16x32_bf16 a[12:15], v[72:75], v[28:31], a[12:15]
  ds_read_b128 v[48:51], v13 offset:34816
  v_mfma_f32_16x16x32_bf16 a[16:19], v[60:63], v[32:35], a[16:19]
  ds_read_b64_tr_b16 v[80:81], v19 offset:57344
  v_mfma_f32_16x16x32_bf16 a[20:23], v[64:67], v[32:35], a[20:23]
  ds_read_b64_tr_b16 v[82:83], v19 offset:58368
  v_mfma_f32_16x16x32_bf16 a[24:27], v[68:71], v[32:35], a[24:27]
  ds_read_b128 v[52:55], v13 offset:36864
  v_mfma_f32_16x16x32_bf16 a[28:31], v[72:75], v[32:35], a[28:31]
  ds_read_b64_tr_b16 v[84:85], v20 offset:57344
  v_mfma_f32_16x16x32_bf16 a[32:35], v[60:63], v[36:39], a[32:35]
  ds_read_b64_tr_b16 v[86:87], v20 offset:58368
  v_mfma_f32_16x16x32_bf16 a[36:39], v[64:67], v[36:39], a[36:39]
  ds_read_b128 v[56:59], v13 offset:38912
  v_mfma_f32_16x16x32_bf16 a[40:43], v[68:71], v[36:39], a[40:43]
  ds_read_b64_tr_b16 v[88:89], v21 offset:57344
  v_mfma_f32_16x16x32_bf16 a[44:47], v[72:75], v[36:39], a[44:47]
  ds_read_b64_tr_b16 v[90:91], v21 offset:58368
  v_mfma_f32_16x16x32_bf16 a[48:51], v[60:63], v[40:43], a[48:51]
  v_mfma_f32_16x16x32_bf16 a[52:55], v[64:67], v[40:43], a[52:55]
  v_mfma_f32_16x16x32_bf16 a[56:59], v[68:71], v[40:43], a[56:59]
  v_mfma_f32_16x16x32_bf16 a[60:63], v[72:75], v[40:43], a[60:63]
  s_waitcnt lgkmcnt(0)
  v_mfma_f32_16x16x32_bf16 a[0:3], v[76:79], v[44:47], a[0:3]
  v_mfma_f32_16x16x32_bf16 a[4:7], v[80:83], v[44:47], a[4:7]
  v_mfma_f32_16x16x32_bf16 a[8:11], v[84:87], v[44:47], a[8:11]
  v_mfma_f32_16x16x32_bf16 a[12:15], v[88:91], v[44:47], a[12:15]
  v_mfma_f32_16x16x32_bf16 a[16:19], v[76:79], v[48:51], a[16:19]
  v_mfma_f32_16x16x32_bf16 a[20:23], v[80:83], v[48:51], a[20:23]
  v_mfma_f32_16x16x32_bf16 a[24:27], v[84:87], v[48:51], a[24:27]
  v_mfma_f32_16x16x32_bf16 a[28:31], v[88:91], v[48:51], a[28:31]
  v_mfma_f32_16x16x32_bf16 a[32:35], v[76:79], v[52:55], a[32:35]
  v_mfma_f32_16x16x32_bf16 a[36:39], v[80:83], v[52:55], a[36:39]
  v_mfma_f32_16x16x32_bf16 a[40:43], v[84:87], v[52:55], a[40:43]
  v_mfma_f32_16x16x32_bf16 a[44:47], v[88:91], v[52:55], a[44:47]
  v_mfma_f32_16x16x32_bf16 a[48:51], v[76:79], v[56:59], a[48:51]
  v_mfma_f32_16x16x32_bf16 a[52:55], v[80:83], v[56:59], a[52:55]
  v_mfma_f32_16x16x32_bf16 a[56:59], v[84:87], v[56:59], a[56:59]
  v_mfma_f32_16x16x32_bf16 a[60:63], v[88:91], v[56:59], a[60:63]
  s_mov_b32 s59, 3
  s_mov_b32 s60, s22
  s_mov_b32 s61, s26
  s_add_u32 s62, s38, 0x3d00000
  s_mov_b32 s63, s98
  s_cmp_lg_u32 s39, 0
  s_cbranch_scc1 L_got
  s_mov_b32 s58, 3
  s_branch L_epi
L_g5:
  s_waitcnt vmcnt(26)
  s_barrier
  ds_read_b128 v[28:31], v10 offset:0
  ds_read_b64_tr_b16 v[60:61], v14 offset:16384
  ds_read_b64_tr_b16 v[62:63], v14 offset:17408
  ds_read_b128 v[32:35], v10 offset:2048
  ds_read_b64_tr_b16 v[64:65], v15 offset:16384
  ds_read_b64_tr_b16 v[66:67], v15 offset:17408
  ds_read_b128 v[36:39], v10 offset:4096
  ds_read_b64_tr_b16 v[68:69], v16 offset:16384
  ds_read_b64_tr_b16 v[70:71], v16 offset:17408
  ds_read_b128 v[40:43], v10 offset:6144
  ds_read_b64_tr_b16 v[72:73], v17 offset:16384
  ds_read_b64_tr_b16 v[74:75], v17 offset:17408
  s_sub_u32 s25, s25, 1
  s_waitcnt lgkmcnt(0)
  v_mfma_f32_16x16x32_bf16 a[0:3], v[28:31], v[60:63], 0
  ds_read_b128 v[44:47], v11 offset:0
  v_mfma_f32_16x16x32_bf16 a[4:7], v[28:31], v[64:67], 0
  ds_read_b64_tr_b16 v[76:77], v14 offset:24576
  v_mfma_f32_16x16x32_bf16 a[8:11], v[28:31], v[68:71], 0
  ds_read_b64_tr_b16 v[78:79], v14 offset:25600
  v_mfma_f32_16x16x32_bf16 a[12:15], v[28:31], v[72:75], 0
  ds_read_b128 v[48:51], v11 offset:2048
  v_mfma_f32_16x16x32_bf16 a[16:19], v[32:35], v[60:63], 0
  ds_read_b64_tr_b16 v[80:81], v15 offset:24576
  v_mfma_f32_16x16x32_bf16 a[20:23], v[32:35], v[64:67], 0
  ds_read_b64_tr_b16 v[82:83], v15 offset:25600
  v_mfma_f32_16x16x32_bf16 a[24:27], v[32:35], v[68:71], 0
  ds_read_b128 v[52:55], v11 offset:4096
  v_mfma_f32_16x16x32_bf16 a[28:31], v[32:35], v[72:75], 0
  ds_read_b64_tr_b16 v[84:85], v16 offset:24576
  v_mfma_f32_16x16x32_bf16 a[32:35], v[36:39], v[60:63], 0
  ds_read_b64_tr_b16 v[86:87], v16 offset:25600
  v_mfma_f32_16x16x32_bf16 a[36:39], v[36:39], v[64:67], 0
  ds_read_b128 v[56:59], v11 offset:6144
  v_mfma_f32_16x16x32_bf16 a[40:43], v[36:39], v[68:71], 0
  ds_read_b64_tr_b16 v[88:89], v17 offset:24576
  v_mfma_f32_16x16x32_bf16 a[44:47], v[36:39], v[72:75], 0
  ds_read_b64_tr_b16 v[90:91], v17 offset:25600
  v_mfma_f32_16x16x32_bf16 a[48:51], v[40:43], v[60:63], 0
  v_mfma_f32_16x16x32_bf16 a[52:55], v[40:43], v[64:67], 0
  v_mfma_f32_16x16x32_bf16 a[56:59], v[40:43], v[68:71], 0
  v_mfma_f32_16x16x32_bf16 a[60:63], v[40:43], v[72:75], 0
  s_waitcnt lgkmcnt(0)
  v_mfma_f32_16x16x32_bf16 a[0:3], v[44:47], v[76:79], a[0:3]
  s_waitcnt vmcnt(18)
  s_barrier
  s_add_u32 m0, s52, 0
  v_mfma_f32_16x16x32_bf16 a[4:7], v[44:47], v[80:83], a[4:7]
  buffer_load_dwordx4 v2, s[8:11], s20 offen  lds
  ds_read_b128 v[28:31], v10 offset:32768
  v_mfma_f32_16x16x32_bf16 a[8:11], v[44:47], v[84:87], a[8:11]
  ds_read_b64_tr_b16 v[60:61], v14 offset:49152
  v_mfma_f32_16x16x32_bf16 a[12:15], v[44:47], v[88:91], a[12:15]
  ds_read_b64_tr_b16 v[62:63], v14 offset:50176
  s_add_u32 m0, s53, 0
  v_mfma_f32_16x16x32_bf16 a[16:19], v[48:51], v[76:79], a[16:19]
  buffer_load_dwordx4 v6, s[12:15], s21 offen  lds
  ds_read_b128 v[32:35], v10 offset:34816
  v_mfma_f32_16x16x32_bf16 a[20:23], v[48:51], v[80:83], a[20:23]
  ds_read_b64_tr_b16 v[64:65], v15 offset:49152
  v_mfma_f32_16x16x32_bf16 a[24:27], v[48:51], v[84:87], a[24:27]
  ds_read_b64_tr_b16 v[66:67], v15 offset:50176
  s_add_u32 m0, s52, 1024
  v_mfma_f32_16x16x32_bf16 a[28:31], v[48:51], v[88:91], a[28:31]
  buffer_load_dwordx4 v3, s[8:11], s20 offen  lds
  ds_read_b128 v[36:39], v10 offset:36864
  v_mfma_f32_16x16x32_bf16 a[32:35], v[52:55], v[76:79], a[32:35]
  ds_read_b64_tr_b16 v[68:69], v16 offset:49152
  v_mfma_f32_16x16x32_bf16 a[36:39], v[52:55], v[80:83], a[36:39]
  ds_read_b64_tr_b16 v[70:71], v16 offset:50176
  s_add_u32 m0, s53, 1024
  v_mfma_f32_16x16x32_bf16 a[40:43], v[52:55], v[84:87], a[40:43]
  buffer_load_dwordx4 v7, s[12:15], s21 offen  lds
  ds_read_b128 v[40:43], v10 offset:38912
  v_mfma_f32_16x16x32_bf16 a[44:47], v[52:55], v[88:91], a[44:47]
  ds_read_b64_tr_b16 v[72:73], v17 offset:49152
  v_mfma_f32_16x16x32_bf16 a[48:51], v[56:59], v[76:79], a[48:51]
  ds_read_b64_tr_b16 v[74:75], v17 offset:50176
  s_add_u32 m0, s52, 2048
  v_mfma_f32_16x16x32_bf16 a[52:55], v[56:59], v[80:83], a[52:55]
  buffer_load_dwordx4 v4, s[8:11], s20 offen  lds
  v_mfma_f32_16x16x32_bf16 a[56:59], v[56:59], v[84:87], a[56:59]
  v_mfma_f32_16x16x32_bf16 a[60:63], v[56:59], v[88:91], a[60:63]
  s_waitcnt lgkmcnt(0)
  s_add_u32 m0, s53, 2048
  v_mfma_f32_16x16x32_bf16 a[0:3], v[28:31], v[60:63], a[0:3]
  buffer_load_dwordx4 v8, s[12:15], s21 offen  lds
  ds_read_b128 v[44:47], v11 offset:32768
  v_mfma_f32_16x16x32_bf16 a[4:7], v[28:31], v[64:67], a[4:7]
  ds_read_b64_tr_b16 v[76:77], v14 offset:57344
  v_mfma_f32_16x16x32_bf16 a[8:11], v[28:31], v[68:71], a[8:11]
  ds_read_b64_tr_b16 v[78:79], v14 offset:58368
  v_mfma_f32_16x16x32_bf16 a[12:15], v[28:31], v[72:75], a[12:15]
  ds_read_b128 v[48:51], v11 offset:34816
  s_add_u32 m0, s52, 3072
  v_mfma_f32_16x16x32_bf16 a[16:19], v[32:35], v[60:63], a[16:19]
  buffer_load_dwordx4 v5, s[8:11], s20 offen  lds
  ds_read_b64_tr_b16 v[80:81], v15 offset:57344
  v_mfma_f32_16x16x32_bf16 a[20:23], v[32:35], v[64:67], a[20:23]
  ds_read_b64_tr_b16 v[82:83], v15 offset:58368
  v_mfma_f32_16x16x32_bf16 a[24:27], v[32:35], v[68:71], a[24:27]
  ds_read_b128 v[52:55], v11 offset:36864
  v_mfma_f32_16x16x32_bf16 a[28:31], v[32:35], v[72:75], a[28:31]
  ds_read_b64_tr_b16 v[84:85], v16 offset:57344
  s_add_u32 m0, s53, 3072
  v_mfma_f32_16x16x32_bf16 a[32:35], v[36:39], v[60:63], a[32:35]
  buffer_load_dwordx4 v9, s[12:15], s21 offen  lds
  ds_read_b64_tr_b16 v[86:87], v16 offset:58368
  v_mfma_f32_16x16x32_bf16 a[36:39], v[36:39], v[64:67], a[36:39]
  ds_read_b128 v[56:59], v11 offset:38912
  v_mfma_f32_16x16x32_bf16 a[40:43], v[36:39], v[68:71], a[40:43]
  ds_read_b64_tr_b16 v[88:89], v17 offset:57344
  v_mfma_f32_16x16x32_bf16 a[44:47], v[36:39], v[72:75], a[44:47]
  ds_read_b64_tr_b16 v[90:91], v17 offset:58368
  s_add_u32 s20, s20, 128
  v_mfma_f32_16x16x32_bf16 a[48:51], v[40:43], v[60:63], a[48:51]
  s_add_u32 s21, s21, s51
  v_mfma_f32_16x16x32_bf16 a[52:55], v[40:43], v[64:67], a[52:55]
  v_mfma_f32_16x16x32_bf16 a[56:59], v[40:43], v[68:71], a[56:59]
  v_mfma_f32_16x16x32_bf16 a[60:63], v[40:43], v[72:75], a[60:63]
  s_waitcnt lgkmcnt(0)
  v_mfma_f32_16x16x32_bf16 a[0:3], v[44:47], v[76:79], a[0:3]
  s_waitcnt vmcnt(18)
  s_barrier
  s_add_u32 m0, s52, 32768
  v_mfma_f32_16x16x32_bf16 a[4:7], v[44:47], v[80:83], a[4:7]
  buffer_load_dwordx4 v2, s[8:11], s20 offen  lds
  ds_read_b128 v[28:31], v12 offset:0
  v_mfma_f32_16x16x32_bf16 a[8:11], v[44:47], v[84:87], a[8:11]
  ds_read_b64_tr_b16 v[60:61], v18 offset:16384
  v_mfma_f32_16x16x32_bf16 a[12:15], v[44:47], v[88:91], a[12:15]
  ds_read_b64_tr_b16 v[62:63], v18 offset:17408
  s_add_u32 m0, s53, 32768
  v_mfma_f32_16x16x32_bf16 a[16:19], v[48:51], v[76:79], a[16:19]
  buffer_load_dwordx4 v6, s[12:15], s21 offen  lds
  ds_read_b128 v[32:35], v12 offset:2048
  v_mfma_f32_16x16x32_bf16 a[20:23], v[48:51], v[80:83], a[20:23]
  ds_read_b64_tr_b16 v[64:65], v19 offset:16384
  v_mfma_f32_16x16x32_bf16 a[24:27], v[48:51], v[84:87], a[24:27]
  ds_read_b64_tr_b16 v[66:67], v19 offset:17408
  s_add_u32 m0, s52, 33792
  v_mfma_f32_16x16x32_bf16 a[28:31], v[48:51], v[88:91], a[28:31]
  buffer_load_dwordx4 v3, s[8:11], s20 offen  lds
  ds_read_b128 v[36:39], v12 offset:4096
  v_mfma_f32_16x16x32_bf16 a[32:35], v[52:55], v[76:79], a[32:35]
  ds_read_b64_tr_b16 v[68:69], v20 offset:16384
  v_mfma_f32_16x16x32_bf16 a[36:39], v[52:55], v[80:83], a[36:39]
  ds_read_b64_tr_b16 v[70:71], v20 offset:17408
  s_add_u32 m0, s53, 33792
  v_mfma_f32_16x16x32_bf16 a[40:43], v[52:55], v[84:87], a[40:43]
  buffer_load_dwordx4 v7, s[12:15], s21 offen  lds
  ds_read_b128 v[40:43], v12 offset:6144
  v_mfma_f32_16x16x32_bf16 a[44:47], v[52:55], v[88:91], a[44:47]
  ds_read_b64_tr_b16 v[72:73], v21 offset:16384
  v_mfma_f32_16x16x32_bf16 a[48:51], v[56:59], v[76:79], a[48:51]
  ds_read_b64_tr_b16 v[74:75], v21 offset:17408
  s_add_u32 m0, s52, 34816
  v_mfma_f32_16x16x32_bf16 a[52:55], v[56:59], v[80:83], a[52:55]
  buffer_load_dwordx4 v4, s[8:11], s20 offen  lds
  v_mfma_f32_16x16x32_bf16 a[56:59], v[56:59], v[84:87], a[56:59]
  v_mfma_f32_16x16x32_bf16 a[60:63], v[56:59], v[88:91], a[60:63]
  s_waitcnt lgkmcnt(0)
  s_add_u32 m0, s53, 34816
  v_mfma_f32_16x16x32_bf16 a[0:3], v[28:31], v[60:63], a[0:3]
  buffer_load_dwordx4 v8, s[12:15], s21 offen  lds
  ds_read_b128 v[44:47], v13 offset:0
  v_mfma_f32_16x16x32_bf16 a[4:7], v[28:31], v[64:67], a[4:7]
  ds_read_b64_tr_b16 v[76:77], v18 offset:24576
  v_mfma_f32_16x16x32_bf16 a[8:11], v[28:31], v[68:71], a[8:11]
  ds_read_b64_tr_b16 v[78:79], v18 offset:25600
  v_mfma_f32_16x16x32_bf16 a[12:15], v[28:31], v[72:75], a[12:15]
  ds_read_b128 v[48:51], v13 offset:2048
  s_add_u32 m0, s52, 35840
  v_mfma_f32_16x16x32_bf16 a[16:19], v[32:35], v[60:63], a[16:19]
  buffer_load_dwordx4 v5, s[8:11], s20 offen  lds
  ds_read_b64_tr_b16 v[80:81], v19 offset:24576
  v_mfma_f32_16x16x32_bf16 a[20:23], v[32:35], v[64:67], a[20:23]
  ds_read_b64_tr_b16 v[82:83], v19 offset:25600
  v_mfma_f32_16x16x32_bf16 a[24:27], v[32:35], v[68:71], a[24:27]
  ds_read_b128 v[52:55], v13 offset:4096
  v_mfma_f32_16x16x32_bf16 a[28:31], v[32:35], v[72:75], a[28:31]
  ds_read_b64_tr_b16 v[84:85], v20 offset:24576
  s_add_u32 m0, s53, 35840
  v_mfma_f32_16x16x32_bf16 a[32:35], v[36:39], v[60:63], a[32:35]
  buffer_load_dwordx4 v9, s[12:15], s21 offen  lds
  ds_read_b64_tr_b16 v[86:87], v20 offset:25600
  v_mfma_f32_16x16x32_bf16 a[36:39], v[36:39], v[64:67], a[36:39]
  ds_read_b128 v[56:59], v13 offset:6144
  v_mfma_f32_16x16x32_bf16 a[40:43], v[36:39], v[68:71], a[40:43]
  ds_read_b64_tr_b16 v[88:89], v21 offset:24576
  v_mfma_f32_16x16x32_bf16 a[44:47], v[36:39], v[72:75], a[44:47]
  ds_read_b64_tr_b16 v[90:91], v21 offset:25600
  s_add_u32 s20, s20, 128
  v_mfma_f32_16x16x32_bf16 a[48:51], v[40:43], v[60:63], a[48:51]
  s_add_u32 s21, s21, s51
  v_mfma_f32_16x16x32_bf16 a[52:55], v[40:43], v[64:67], a[52:55]
  v_mfma_f32_16x16x32_bf16 a[56:59], v[40:43], v[68:71], a[56:59]
  v_mfma_f32_16x16x32_bf16 a[60:63], v[40:43], v[72:75], a[60:63]
  s_waitcnt lgkmcnt(0)
  v_mfma_f32_16x16x32_bf16 a[0:3], v[44:47], v[76:79], a[0:3]
  s_waitcnt vmcnt(18)
  s_barrier
  s_add_u32 m0, s52, 65536
  v_mfma_f32_16x16x32_bf16 a[4:7], v[44:47], v[80:83], a[4:7]
  buffer_load_dwordx4 v2, s[8:11], s20 offen  lds
  ds_read_b128 v[28:31], v12 offset:32768
  v_mfma_f32_16x16x32_bf16 a[8:11], v[44:47], v[84:87], a[8:11]
  ds_read_b64_tr_b16 v[60:61], v18 offset:49152
  v_mfma_f32_16x16x32_bf16 a[12:15], v[44:47], v[88:91], a[12:15]
  ds_read_b64_tr_b16 v[62:63], v18 offset:50176
  s_add_u32 m0, s53, 65536
  v_mfma_f32_16x16x32_bf16 a[16:19], v[48:51], v[76:79], a[16:19]
  buffer_load_dwordx4 v6, s[12:15], s21 offen  lds
  ds_read_b128 v[32:35], v12 offset:34816
  v_mfma_f32_16x16x32_bf16 a[20:23], v[48:51], v[80:83], a[20:23]
  ds_read_b64_tr_b16 v[64:65], v19 offset:49152
  v_mfma_f32_16x16x32_bf16 a[24:27], v[48:51], v[84:87], a[24:27]
  ds_read_b64_tr_b16 v[66:67], v19 offset:50176
  s_add_u32 m0, s52, 66560
  v_mfma_f32_16x16x32_bf16 a[28:31], v[48:51], v[88:91], a[28:31]
  buffer_load_dwordx4 v3, s[8:11], s20 offen  lds
  ds_read_b128 v[36:39], v12 offset:36864
  v_mfma_f32_16x16x32_bf16 a[32:35], v[52:55], v[76:79], a[32:35]
  ds_read_b64_tr_b16 v[68:69], v20 offset:49152
  v_mfma_f32_16x16x32_bf16 a[36:39], v[52:55], v[80:83], a[36:39]
  ds_read_b64_tr_b16 v[70:71], v20 offset:50176
  s_add_u32 m0, s53, 66560
  v_mfma_f32_16x16x32_bf16 a[40:43], v[52:55], v[84:87], a[40:43]
  buffer_load_dwordx4 v7, s[12:15], s21 offen  lds
  ds_read_b128 v[40:43], v12 offset:38912
  v_mfma_f32_16x16x32_bf16 a[44:47], v[52:55], v[88:91], a[44:47]
  ds_read_b64_tr_b16 v[72:73], v21 offset:49152
  v_mfma_f32_16x16x32_bf16 a[48:51], v[56:59], v[76:79], a[48:51]
  ds_read_b64_tr_b16 v[74:75], v21 offset:50176
  s_add_u32 m0, s52, 67584
  v_mfma_f32_16x16x32_bf16 a[52:55], v[56:59], v[80:83], a[52:55]
  buffer_load_dwordx4 v4, s[8:11], s20 offen  lds
  v_mfma_f32_16x16x32_bf16 a[56:59], v[56:59], v[84:87], a[56:59]
  v_mfma_f32_16x16x32_bf16 a[60:63], v[56:59], v[88:91], a[60:63]
  s_waitcnt lgkmcnt(0)
  s_add_u32 m0, s53, 67584
  v_mfma_f32_16x16x32_bf16 a[0:3], v[28:31], v[60:63], a[0:3]
  buffer_load_dwordx4 v8, s[12:15], s21 offen  lds
  ds_read_b128 v[44:47], v13 offset:32768
  v_mfma_f32_16x16x32_bf16 a[4:7], v[28:31], v[64:67], a[4:7]
  ds_read_b64_tr_b16 v[76:77], v18 offset:57344
  v_mfma_f32_16x16x32_bf16 a[8:11], v[28:31], v[68:71], a[8:11]
  ds_read_b64_tr_b16 v[78:79], v18 offset:58368
  v_mfma_f32_16x16x32_bf16 a[12:15], v[28:31], v[72:75], a[12:15]
  ds_read_b128 v[48:51], v13 offset:34816
  s_add_u32 m0, s52, 68608
  v_mfma_f32_16x16x32_bf16 a[16:19], v[32:35], v[60:63], a[16:19]
  buffer_load_dwordx4 v5, s[8:11], s20 offen  lds
  ds_read_b64_tr_b16 v[80:81], v19 offset:57344
  v_mfma_f32_16x16x32_bf16 a[20:23], v[32:35], v[64:67], a[20:23]
  ds_read_b64_tr_b16 v[82:83], v19 offset:58368
  v_mfma_f32_16x16x32_bf16 a[24:27], v[32:35], v[68:71], a[24:27]
  ds_read_b128 v[52:55], v13 offset:36864
  v_mfma_f32_16x16x32_bf16 a[28:31], v[32:35], v[72:75], a[28:31]
  ds_read_b64_tr_b16 v[84:85], v20 offset:57344
  s_add_u32 m0, s53, 68608
  v_mfma_f32_16x16x32_bf16 a[32:35], v[36:39], v[60:63], a[32:35]
  buffer_load_dwordx4 v9, s[12:15], s21 offen  lds
  ds_read_b64_tr_b16 v[86:87], v20 offset:58368
  v_mfma_f32_16x16x32_bf16 a[36:39], v[36:39], v[64:67], a[36:39]
  ds_read_b128 v[56:59], v13 offset:38912
  v_mfma_f32_16x16x32_bf16 a[40:43], v[36:39], v[68:71], a[40:43]
  ds_read_b64_tr_b16 v[88:89], v21 offset:57344
  v_mfma_f32_16x16x32_bf16 a[44:47], v[36:39], v[72:75], a[44:47]
  ds_read_b64_tr_b16 v[90:91], v21 offset:58368
  s_add_u32 s20, s20, 128
  v_mfma_f32_16x16x32_bf16 a[48:51], v[40:43], v[60:63], a[48:51]
  s_add_u32 s21, s21, s51
  v_mfma_f32_16x16x32_bf16 a[52:55], v[40:43], v[64:67], a[52:55]
  v_mfma_f32_16x16x32_bf16 a[56:59], v[40:43], v[68:71], a[56:59]
  v_mfma_f32_16x16x32_bf16 a[60:63], v[40:43], v[72:75], a[60:63]
  s_waitcnt lgkmcnt(0)
  v_mfma_f32_16x16x32_bf16 a[0:3], v[44:47], v[76:79], a[0:3]
  s_waitcnt vmcnt(16)
  s_barrier
  s_add_u32 m0, s52, 98304
  v_mfma_f32_16x16x32_bf16 a[4:7], v[44:47], v[80:83], a[4:7]
  buffer_load_dwordx4 v2, s[8:11], s20 offen  lds
  ds_read_b128 v[28:31], v10 offset:0
  v_mfma_f32_16x16x32_bf16 a[8:11], v[44:47], v[84:87], a[8:11]
  ds_read_b64_tr_b16 v[60:61], v14 offset:16384
  v_mfma_f32_16x16x32_bf16 a[12:15], v[44:47], v[88:91], a[12:15]
  ds_read_b64_tr_b16 v[62:63], v14 offset:17408
  s_add_u32 m0, s53, 98304
  v_mfma_f32_16x16x32_bf16 a[16:19], v[48:51], v[76:79], a[16:19]
  buffer_load_dwordx4 v6, s[12:15], s21 offen  lds
  ds_read_b128 v[32:35], v10 offset:2048
  v_mfma_f32_16x16x32_bf16 a[20:23], v[48:51], v[80:83], a[20:23]
  ds_read_b64_tr_b16 v[64:65], v15 offset:16384
  v_mfma_f32_16x16x32_bf16 a[24:27], v[48:51], v[84:87], a[24:27]
  ds_read_b64_tr_b16 v[66:67], v15 offset:17408
  s_add_u32 m0, s52, 99328
  v_mfma_f32_16x16x32_bf16 a[28:31], v[48:51], v[88:91], a[28:31]
  buffer_load_dwordx4 v3, s[8:11], s20 offen  lds
  ds_read_b128 v[36:39], v10 offset:4096
  v_mfma_f32_16x16x32_bf16 a[32:35], v[52:55], v[76:79], a[32:35]
  ds_read_b64_tr_b16 v[68:69], v16 offset:16384
  v_mfma_f32_16x16x32_bf16 a[36:39], v[52:55], v[80:83], a[36:39]
  ds_read_b64_tr_b16 v[70:71], v16 offset:17408
  s_add_u32 m0, s53, 99328
  v_mfma_f32_16x16x32_bf16 a[40:43], v[52:55], v[84:87], a[40:43]
  buffer_load_dwordx4 v7, s[12:15], s21 offen  lds
  ds_read_b128 v[40:43], v10 offset:6144
  v_mfma_f32_16x16x32_bf16 a[44:47], v[52:55], v[88:91], a[44:47]
  ds_read_b64_tr_b16 v[72:73], v17 offset:16384
  v_mfma_f32_16x16x32_bf16 a[48:51], v[56:59], v[76:79], a[48:51]
  ds_read_b64_tr_b16 v[74:75], v17 offset:17408
  s_add_u32 m0, s52, 100352
  v_mfma_f32_16x16x32_bf16 a[52:55], v[56:59], v[80:83], a[52:55]
  buffer_load_dwordx4 v4, s[8:11], s20 offen  lds
  v_mfma_f32_16x16x32_bf16 a[56:59], v[56:59], v[84:87], a[56:59]
  v_mfma_f32_16x16x32_bf16 a[60:63], v[56:59], v[88:91], a[60:63]
L_g5_loop:
  s_sub_u32 s25, s25, 1
  s_cmp_eq_u32 s25, 0
  s_cbranch_scc1 L_g5_fin
  s_waitcnt lgkmcnt(0)
  s_add_u32 m0, s53, 100352
  v_mfma_f32_16x16x32_bf16 a[0:3], v[28:31], v[60:63], a[0:3]
  buffer_load_dwordx4 v8, s[12:15], s21 offen  lds
  ds_read_b128 v[44:47], v11 offset:0
  v_mfma_f32_16x16x32_bf16 a[4:7], v[28:31], v[64:67], a[4:7]
  ds_read_b64_tr_b16 v[76:77], v14 offset:24576
  v_mfma_f32_16x16x32_bf16 a[8:11], v[28:31], v[68:71], a[8:11]
  ds_read_b64_tr_b16 v[78:79], v14 offset:25600
  v_mfma_f32_16x16x32_bf16 a[12:15], v[28:31], v[72:75], a[12:15]
  ds_read_b128 v[48:51], v11 offset:2048
  s_add_u32 m0, s52, 101376
  v_mfma_f32_16x16x32_bf16 a[16:19], v[32:35], v[60:63], a[16:19]
  buffer_load_dwordx4 v5, s[8:11], s20 offen  lds
  ds_read_b64_tr_b16 v[80:81], v15 offset:24576
  v_mfma_f32_16x16x32_bf16 a[20:23], v[32:35], v[64:67], a[20:23]
  ds_read_b64_tr_b16 v[82:83], v15 offset:25600
  v_mfma_f32_16x16x32_bf16 a[24:27], v[32:35], v[68:71], a[24:27]
  ds_read_b128 v[52:55], v11 offset:4096
  v_mfma_f32_16x16x32_bf16 a[28:31], v[32:35], v[72:75], a[28:31]
  ds_read_b64_tr_b16 v[84:85], v16 offset:24576
  s_add_u32 m0, s53, 101376
  v_mfma_f32_16x16x32_bf16 a[32:35], v[36:39], v[60:63], a[32:35]
  buffer_load_dwordx4 v9, s[12:15], s21 offen  lds
  ds_read_b64_tr_b16 v[86:87], v16 offset:25600
  v_mfma_f32_16x16x32_bf16 a[36:39], v[36:39], v[64:67], a[36:39]
  ds_read_b128 v[56:59], v11 offset:6144
  v_mfma_f32_16x16x32_bf16 a[40:43], v[36:39], v[68:71], a[40:43]
  ds_read_b64_tr_b16 v[88:89], v17 offset:24576
  v_mfma_f32_16x16x32_bf16 a[44:47], v[36:39], v[72:75], a[44:47]
  ds_read_b64_tr_b16 v[90:91], v17 offset:25600
  s_add_u32 s20, s20, 128
  v_mfma_f32_16x16x32_bf16 a[48:51], v[40:43], v[60:63], a[48:51]
  s_add_u32 s21, s21, s51
  v_mfma_f32_16x16x32_bf16 a[52:55], v[40:43], v[64:67], a[52:55]
  v_mfma_f32_16x16x32_bf16 a[56:59], v[40:43], v[68:71], a[56:59]
  v_mfma_f32_16x16x32_bf16 a[60:63], v[40:43], v[72:75], a[60:63]
  s_waitcnt lgkmcnt(0)
  v_mfma_f32_16x16x32_bf16 a[0:3], v[44:47], v[76:79], a[0:3]
  s_waitcnt vmcnt(16)
  s_barrier
  s_add_u32 m0, s52, 0
  v_mfma_f32_16x16x32_bf16 a[4:7], v[44:47], v[80:83], a[4:7]
  buffer_load_dwordx4 v2, s[8:11], s20 offen  lds
  ds_read_b128 v[28:31], v10 offset:32768
  v_mfma_f32_16x16x32_bf16 a[8:11], v[44:47], v[84:87], a[8:11]
  ds_read_b64_tr_b16 v[60:61], v14 offset:49152
  v_mfma_f32_16x16x32_bf16 a[12:15], v[44:47], v[88:91], a[12:15]
  ds_read_b64_tr_b16 v[62:63], v14 offset:50176
  s_add_u32 m0, s53, 0
  v_mfma_f32_16x16x32_bf16 a[16:19], v[48:51], v[76:79], a[16:19]
  buffer_load_dwordx4 v6, s[12:15], s21 offen  lds
  ds_read_b128 v[32:35], v10 offset:34816
  v_mfma_f32_16x16x32_bf16 a[20:23], v[48:51], v[80:83], a[20:23]
  ds_read_b64_tr_b16 v[64:65], v15 offset:49152
  v_mfma_f32_16x16x32_bf16 a[24:27], v[48:51], v[84:87], a[24:27]
  ds_read_b64_tr_b16 v[66:67], v15 offset:50176
  s_add_u32 m0, s52, 1024
  v_mfma_f32_16x16x32_bf16 a[28:31], v[48:51], v[88:91], a[28:31]
  buffer_load_dwordx4 v3, s[8:11], s20 offen  lds
  ds_read_b128 v[36:39], v10 offset:36864
  v_mfma_f32_16x16x32_bf16 a[32:35], v[52:55], v[76:79], a[32:35]
  ds_read_b64_tr_b16 v[68:69], v16 offset:49152
  v_mfma_f32_16x16x32_bf16 a[36:39], v[52:55], v[80:83], a[36:39]
  ds_read_b64_tr_b16 v[70:71], v16 offset:50176
  s_add_u32 m0, s53, 1024
  v_mfma_f32_16x16x32_bf16 a[40:43], v[52:55], v[84:87], a[40:43]
  buffer_load_dwordx4 v7, s[12:15], s21 offen  lds
  ds_read_b128 v[40:43], v10 offset:38912
  v_mfma_f32_16x16x32_bf16 a[44:47], v[52:55], v[88:91], a[44:47]
  ds_read_b64_tr_b16 v[72:73], v17 offset:49152
  v_mfma_f32_16x16x32_bf16 a[48:51], v[56:59], v[76:79], a[48:51]
  ds_read_b64_tr_b16 v[74:75], v17 offset:50176
  s_add_u32 m0, s52, 2048
  v_mfma_f32_16x16x32_bf16 a[52:55], v[56:59], v[80:83], a[52:55]
  buffer_load_dwordx4 v4, s[8:11], s20 offen  lds
  v_mfma_f32_16x16x32_bf16 a[56:59], v[56:59], v[84:87], a[56:59]
  v_mfma_f32_16x16x32_bf16 a[60:63], v[56:59], v[88:91], a[60:63]
  s_waitcnt lgkmcnt(0)
  s_add_u32 m0, s53, 2048
  v_mfma_f32_16x16x32_bf16 a[0:3], v[28:31], v[60:63], a[0:3]
  buffer_load_dwordx4 v8, s[12:15], s21 offen  lds
  ds_read_b128 v[44:47], v11 offset:32768
  v_mfma_f32_16x16x32_bf16 a[4:7], v[28:31], v[64:67], a[4:7]
  ds_read_b64_tr_b16 v[76:77], v14 offset:57344
  v_mfma_f32_16x16x32_bf16 a[8:11], v[28:31], v[68:71], a[8:11]
  ds_read_b64_tr_b16 v[78:79], v14 offset:58368
  v_mfma_f32_16x16x32_bf16 a[12:15], v[28:31], v[72:75], a[12:15]
  ds_read_b128 v[48:51], v11 offset:34816
  s_add_u32 m0, s52, 3072
  v_mfma_f32_16x16x32_bf16 a[16:19], v[32:35], v[60:63], a[16:19]
  buffer_load_dwordx4 v5, s[8:11], s20 offen  lds
  ds_read_b64_tr_b16 v[80:81], v15 offset:57344
  v_mfma_f32_16x16x32_bf16 a[20:23], v[32:35], v[64:67], a[20:23]
  ds_read_b64_tr_b16 v[82:83], v15 offset:58368
  v_mfma_f32_16x16x32_bf16 a[24:27], v[32:35], v[68:71], a[24:27]
  ds_read_b128 v[52:55], v11 offset:36864
  v_mfma_f32_16x16x32_bf16 a[28:31], v[32:35], v[72:75], a[28:31]
  ds_read_b64_tr_b16 v[84:85], v16 offset:57344
  s_add_u32 m0, s53, 3072
  v_mfma_f32_16x16x32_bf16 a[32:35], v[36:39], v[60:63], a[32:35]
  buffer_load_dwordx4 v9, s[12:15], s21 offen  lds
  ds_read_b64_tr_b16 v[86:87], v16 offset:58368
  v_mfma_f32_16x16x32_bf16 a[36:39], v[36:39], v[64:67], a[36:39]
  ds_read_b128 v[56:59], v11 offset:38912
  v_mfma_f32_16x16x32_bf16 a[40:43], v[36:39], v[68:71], a[40:43]
  ds_read_b64_tr_b16 v[88:89], v17 offset:57344
  v_mfma_f32_16x16x32_bf16 a[44:47], v[36:39], v[72:75], a[44:47]
  ds_read_b64_tr_b16 v[90:91], v17 offset:58368
  s_add_u32 s20, s20, 128
  v_mfma_f32_16x16x32_bf16 a[48:51], v[40:43], v[60:63], a[48:51]
  s_add_u32 s21, s21, s51
  v_mfma_f32_16x16x32_bf16 a[52:55], v[40:43], v[64:67], a[52:55]
  v_mfma_f32_16x16x32_bf16 a[56:59], v[40:43], v[68:71], a[56:59]
  v_mfma_f32_16x16x32_bf16 a[60:63], v[40:43], v[72:75], a[60:63]
  s_waitcnt lgkmcnt(0)
  v_mfma_f32_16x16x32_bf16 a[0:3], v[44:47], v[76:79], a[0:3]
  s_waitcnt vmcnt(16)
  s_barrier
  s_add_u32 m0, s52, 32768
  v_mfma_f32_16x16x32_bf16 a[4:7], v[44:47], v[80:83], a[4:7]
  buffer_load_dwordx4 v2, s[8:11], s20 offen  lds
  ds_read_b128 v[28:31], v12 offset:0
  v_mfma_f32_16x16x32_bf16 a[8:11], v[44:47], v[84:87], a[8:11]
  ds_read_b64_tr_b16 v[60:61], v18 offset:16384
  v_mfma_f32_16x16x32_bf16 a[12:15], v[44:47], v[88:91], a[12:15]
  ds_read_b64_tr_b16 v[62:63], v18 offset:17408
  s_add_u32 m0, s53, 32768
  v_mfma_f32_16x16x32_bf16 a[16:19], v[48:51], v[76:79], a[16:19]
  buffer_load_dwordx4 v6, s[12:15], s21 offen  lds
  ds_read_b128 v[32:35], v12 offset:2048
  v_mfma_f32_16x16x32_bf16 a[20:23], v[48:51], v[80:83], a[20:23]
  ds_read_b64_tr_b16 v[64:65], v19 offset:16384
  v_mfma_f32_16x16x32_bf16 a[24:27], v[48:51], v[84:87], a[24:27]
  ds_read_b64_tr_b16 v[66:67], v19 offset:17408
  s_add_u32 m0, s52, 33792
  v_mfma_f32_16x16x32_bf16 a[28:31], v[48:51], v[88:91], a[28:31]
  buffer_load_dwordx4 v3, s[8:11], s20 offen  lds
  ds_read_b128 v[36:39], v12 offset:4096
  v_mfma_f32_16x16x32_bf16 a[32:35], v[52:55], v[76:79], a[32:35]
  ds_read_b64_tr_b16 v[68:69], v20 offset:16384
  v_mfma_f32_16x16x32_bf16 a[36:39], v[52:55], v[80:83], a[36:39]
  ds_read_b64_tr_b16 v[70:71], v20 offset:17408
  s_add_u32 m0, s53, 33792
  v_mfma_f32_16x16x32_bf16 a[40:43], v[52:55], v[84:87], a[40:43]
  buffer_load_dwordx4 v7, s[12:15], s21 offen  lds
  ds_read_b128 v[40:43], v12 offset:6144
  v_mfma_f32_16x16x32_bf16 a[44:47], v[52:55], v[88:91], a[44:47]
  ds_read_b64_tr_b16 v[72:73], v21 offset:16384
  v_mfma_f32_16x16x32_bf16 a[48:51], v[56:59], v[76:79], a[48:51]
  ds_read_b64_tr_b16 v[74:75], v21 offset:17408
  s_add_u32 m0, s52, 34816
  v_mfma_f32_16x16x32_bf16 a[52:55], v[56:59], v[80:83], a[52:55]
  buffer_load_dwordx4 v4, s[8:11], s20 offen  lds
  v_mfma_f32_16x16x32_bf16 a[56:59], v[56:59], v[84:87], a[56:59]
  v_mfma_f32_16x16x32_bf16 a[60:63], v[56:59], v[88:91], a[60:63]
  s_waitcnt lgkmcnt(0)
  s_add_u32 m0, s53, 34816
  v_mfma_f32_16x16x32_bf16 a[0:3], v[28:31], v[60:63], a[0:3]
  buffer_load_dwordx4 v8, s[12:15], s21 offen  lds
  ds_read_b128 v[44:47], v13 offset:0
  v_mfma_f32_16x16x32_bf16 a[4:7], v[28:31], v[64:67], a[4:7]
  ds_read_b64_tr_b16 v[76:77], v18 offset:24576
  v_mfma_f32_16x16x32_bf16 a[8:11], v[28:31], v[68:71], a[8:11]
  ds_read_b64_tr_b16 v[78:79], v18 offset:25600
  v_mfma_f32_16x16x32_bf16 a[12:15], v[28:31], v[72:75], a[12:15]
  ds_read_b128 v[48:51], v13 offset:2048
  s_add_u32 m0, s52, 35840
  v_mfma_f32_16x16x32_bf16 a[16:19], v[32:35], v[60:63], a[16:19]
  buffer_load_dwordx4 v5, s[8:11], s20 offen  lds
  ds_read_b64_tr_b16 v[80:81], v19 offset:24576
  v_mfma_f32_16x16x32_bf16 a[20:23], v[32:35], v[64:67], a[20:23]
  ds_read_b64_tr_b16 v[82:83], v19 offset:25600
  v_mfma_f32_16x16x32_bf16 a[24:27], v[32:35], v[68:71], a[24:27]
  ds_read_b128 v[52:55], v13 offset:4096
  v_mfma_f32_16x16x32_bf16 a[28:31], v[32:35], v[72:75], a[28:31]
  ds_read_b64_tr_b16 v[84:85], v20 offset:24576
  s_add_u32 m0, s53, 35840
  v_mfma_f32_16x16x32_bf16 a[32:35], v[36:39], v[60:63], a[32:35]
  buffer_load_dwordx4 v9, s[12:15], s21 offen  lds
  ds_read_b64_tr_b16 v[86:87], v20 offset:25600
  v_mfma_f32_16x16x32_bf16 a[36:39], v[36:39], v[64:67], a[36:39]
  ds_read_b128 v[56:59], v13 offset:6144
  v_mfma_f32_16x16x32_bf16 a[40:43], v[36:39], v[68:71], a[40:43]
  ds_read_b64_tr_b16 v[88:89], v21 offset:24576
  v_mfma_f32_16x16x32_bf16 a[44:47], v[36:39], v[72:75], a[44:47]
  ds_read_b64_tr_b16 v[90:91], v21 offset:25600
  s_add_u32 s20, s20, 128
  v_mfma_f32_16x16x32_bf16 a[48:51], v[40:43], v[60:63], a[48:51]
  s_add_u32 s21, s21, s51
  v_mfma_f32_16x16x32_bf16 a[52:55], v[40:43], v[64:67], a[52:55]
  v_mfma_f32_16x16x32_bf16 a[56:59], v[40:43], v[68:71], a[56:59]
  v_mfma_f32_16x16x32_bf16 a[60:63], v[40:43], v[72:75], a[60:63]
  s_waitcnt lgkmcnt(0)
  v_mfma_f32_16x16x32_bf16 a[0:3], v[44:47], v[76:79], a[0:3]
  s_waitcnt vmcnt(16)
  s_barrier
  s_add_u32 m0, s52, 65536
  v_mfma_f32_16x16x32_bf16 a[4:7], v[44:47], v[80:83], a[4:7]
  buffer_load_dwordx4 v2, s[8:11], s20 offen  lds
  ds_read_b128 v[28:31], v12 offset:32768
  v_mfma_f32_16x16x32_bf16 a[8:11], v[44:47], v[84:87], a[8:11]
  ds_read_b64_tr_b16 v[60:61], v18 offset:49152
  v_mfma_f32_16x16x32_bf16 a[12:15], v[44:47], v[88:91], a[12:15]
  ds_read_b64_tr_b16 v[62:63], v18 offset:50176
  s_add_u32 m0, s53, 65536
  v_mfma_f32_16x16x32_bf16 a[16:19], v[48:51], v[76:79], a[16:19]
  buffer_load_dwordx4 v6, s[12:15], s21 offen  lds
  ds_read_b128 v[32:35], v12 offset:34816
  v_mfma_f32_16x16x32_bf16 a[20:23], v[48:51], v[80:83], a[20:23]
  ds_read_b64_tr_b16 v[64:65], v19 offset:49152
  v_mfma_f32_16x16x32_bf16 a[24:27], v[48:51], v[84:87], a[24:27]
  ds_read_b64_tr_b16 v[66:67], v19 offset:50176
  s_add_u32 m0, s52, 66560
  v_mfma_f32_16x16x32_bf16 a[28:31], v[48:51], v[88:91], a[28:31]
  buffer_load_dwordx4 v3, s[8:11], s20 offen  lds
  ds_read_b128 v[36:39], v12 offset:36864
  v_mfma_f32_16x16x32_bf16 a[32:35], v[52:55], v[76:79], a[32:35]
  ds_read_b64_tr_b16 v[68:69], v20 offset:49152
  v_mfma_f32_16x16x32_bf16 a[36:39], v[52:55], v[80:83], a[36:39]
  ds_read_b64_tr_b16 v[70:71], v20 offset:50176
  s_add_u32 m0, s53, 66560
  v_mfma_f32_16x16x32_bf16 a[40:43], v[52:55], v[84:87], a[40:43]
  buffer_load_dwordx4 v7, s[12:15], s21 offen  lds
  ds_read_b128 v[40:43], v12 offset:38912
  v_mfma_f32_16x16x32_bf16 a[44:47], v[52:55], v[88:91], a[44:47]
  ds_read_b64_tr_b16 v[72:73], v21 offset:49152
  v_mfma_f32_16x16x32_bf16 a[48:51], v[56:59], v[76:79], a[48:51]
  ds_read_b64_tr_b16 v[74:75], v21 offset:50176
  s_add_u32 m0, s52, 67584
  v_mfma_f32_16x16x32_bf16 a[52:55], v[56:59], v[80:83], a[52:55]
  buffer_load_dwordx4 v4, s[8:11], s20 offen  lds
  v_mfma_f32_16x16x32_bf16 a[56:59], v[56:59], v[84:87], a[56:59]
  v_mfma_f32_16x16x32_bf16 a[60:63], v[56:59], v[88:91], a[60:63]
  s_waitcnt lgkmcnt(0)
  s_add_u32 m0, s53, 67584
  v_mfma_f32_16x16x32_bf16 a[0:3], v[28:31], v[60:63], a[0:3]
  buffer_load_dwordx4 v8, s[12:15], s21 offen  lds
  ds_read_b128 v[44:47], v13 offset:32768
  v_mfma_f32_16x16x32_bf16 a[4:7], v[28:31], v[64:67], a[4:7]
  ds_read_b64_tr_b16 v[76:77], v18 offset:57344
  v_mfma_f32_16x16x32_bf16 a[8:11], v[28:31], v[68:71], a[8:11]
  ds_read_b64_tr_b16 v[78:79], v18 offset:58368
  v_mfma_f32_16x16x32_bf16 a[12:15], v[28:31], v[72:75], a[12:15]
  ds_read_b128 v[48:51], v13 offset:34816
  s_add_u32 m0, s52, 68608
  v_mfma_f32_16x16x32_bf16 a[16:19], v[32:35], v[60:63], a[16:19]
  buffer_load_dwordx4 v5, s[8:11], s20 offen  lds
  ds_read_b64_tr_b16 v[80:81], v19 offset:57344
  v_mfma_f32_16x16x32_bf16 a[20:23], v[32:35], v[64:67], a[20:23]
  ds_read_b64_tr_b16 v[82:83], v19 offset:58368
  v_mfma_f32_16x16x32_bf16 a[24:27], v[32:35], v[68:71], a[24:27]
  ds_read_b128 v[52:55], v13 offset:36864
  v_mfma_f32_16x16x32_bf16 a[28:31], v[32:35], v[72:75], a[28:31]
  ds_read_b64_tr_b16 v[84:85], v20 offset:57344
  s_add_u32 m0, s53, 68608
  v_mfma_f32_16x16x32_bf16 a[32:35], v[36:39], v[60:63], a[32:35]
  buffer_load_dwordx4 v9, s[12:15], s21 offen  lds
  ds_read_b64_tr_b16 v[86:87], v20 offset:58368
  v_mfma_f32_16x16x32_bf16 a[36:39], v[36:39], v[64:67], a[36:39]
  ds_read_b128 v[56:59], v13 offset:38912
  v_mfma_f32_16x16x32_bf16 a[40:43], v[36:39], v[68:71], a[40:43]
  ds_read_b64_tr_b16 v[88:89], v21 offset:57344
  v_mfma_f32_16x16x32_bf16 a[44:47], v[36:39], v[72:75], a[44:47]
  ds_read_b64_tr_b16 v[90:91], v21 offset:58368
  s_add_u32 s20, s20, 128
  v_mfma_f32_16x16x32_bf16 a[48:51], v[40:43], v[60:63], a[48:51]
  s_add_u32 s21, s21, s51
  v_mfma_f32_16x16x32_bf16 a[52:55], v[40:43], v[64:67], a[52:55]
  v_mfma_f32_16x16x32_bf16 a[56:59], v[40:43], v[68:71], a[56:59]
  v_mfma_f32_16x16x32_bf16 a[60:63], v[40:43], v[72:75], a[60:63]
  s_waitcnt lgkmcnt(0)
  v_mfma_f32_16x16x32_bf16 a[0:3], v[44:47], v[76:79], a[0:3]
  s_waitcnt vmcnt(16)
  s_barrier
  s_add_u32 m0, s52, 98304
  v_mfma_f32_16x16x32_bf16 a[4:7], v[44:47], v[80:83], a[4:7]
  buffer_load_dwordx4 v2, s[8:11], s20 offen  lds
  ds_read_b128 v[28:31], v10 offset:0
  v_mfma_f32_16x16x32_bf16 a[8:11], v[44:47], v[84:87], a[8:11]
  ds_read_b64_tr_b16 v[60:61], v14 offset:16384
  v_mfma_f32_16x16x32_bf16 a[12:15], v[44:47], v[88:91], a[12:15]
  ds_read_b64_tr_b16 v[62:63], v14 offset:17408
  s_add_u32 m0, s53, 98304
  v_mfma_f32_16x16x32_bf16 a[16:19], v[48:51], v[76:79], a[16:19]
  buffer_load_dwordx4 v6, s[12:15], s21 offen  lds
  ds_read_b128 v[32:35], v10 offset:2048
  v_mfma_f32_16x16x32_bf16 a[20:23], v[48:51], v[80:83], a[20:23]
  ds_read_b64_tr_b16 v[64:65], v15 offset:16384
  v_mfma_f32_16x16x32_bf16 a[24:27], v[48:51], v[84:87], a[24:27]
  ds_read_b64_tr_b16 v[66:67], v15 offset:17408
  s_add_u32 m0, s52, 99328
  v_mfma_f32_16x16x32_bf16 a[28:31], v[48:51], v[88:91], a[28:31]
  buffer_load_dwordx4 v3, s[8:11], s20 offen  lds
  ds_read_b128 v[36:39], v10 offset:4096
  v_mfma_f32_16x16x32_bf16 a[32:35], v[52:55], v[76:79], a[32:35]
  ds_read_b64_tr_b16 v[68:69], v16 offset:16384
  v_mfma_f32_16x16x32_bf16 a[36:39], v[52:55], v[80:83], a[36:39]
  ds_read_b64_tr_b16 v[70:71], v16 offset:17408
  s_add_u32 m0, s53, 99328
  v_mfma_f32_16x16x32_bf16 a[40:43], v[52:55], v[84:87], a[40:43]
  buffer_load_dwordx4 v7, s[12:15], s21 offen  lds
  ds_read_b128 v[40:43], v10 offset:6144
  v_mfma_f32_16x16x32_bf16 a[44:47], v[52:55], v[88:91], a[44:47]
  ds_read_b64_tr_b16 v[72:73], v17 offset:16384
  v_mfma_f32_16x16x32_bf16 a[48:51], v[56:59], v[76:79], a[48:51]
  ds_read_b64_tr_b16 v[74:75], v17 offset:17408
  s_add_u32 m0, s52, 100352
  v_mfma_f32_16x16x32_bf16 a[52:55], v[56:59], v[80:83], a[52:55]
  buffer_load_dwordx4 v4, s[8:11], s20 offen  lds
  v_mfma_f32_16x16x32_bf16 a[56:59], v[56:59], v[84:87], a[56:59]
  v_mfma_f32_16x16x32_bf16 a[60:63], v[56:59], v[88:91], a[60:63]
  s_branch L_g5_loop
L_g5_fin:
  s_cmp_lg_u32 s32, 0
  s_cbranch_scc1 L_rq_86
  s_cmp_eq_u32 s39, 0
  s_cbranch_scc1 L_rq_86
  s_lshl_b32 s99, s33, 7
  s_add_u32 s99, s99, 0x3d00200
  v_mov_b32 v244, 1
  v_mov_b32 v245, 0
  s_mov_b64 exec, 1
  buffer_atomic_add v244, v245, s[4:7], s99 offen sc0 sc1
  s_mov_b64 exec, -1
L_rq_86:
  s_waitcnt lgkmcnt(0)
  s_add_u32 m0, s53, 100352
  v_mfma_f32_16x16x32_bf16 a[0:3], v[28:31], v[60:63], a[0:3]
  buffer_load_dwordx4 v8, s[12:15], s21 offen  lds
  ds_read_b128 v[44:47], v11 offset:0
  v_mfma_f32_16x16x32_bf16 a[4:7], v[28:31], v[64:67], a[4:7]
  ds_read_b64_tr_b16 v[76:77], v14 offset:24576
  v_mfma_f32_16x16x32_bf16 a[8:11], v[28:31], v[68:71], a[8:11]
  ds_read_b64_tr_b16 v[78:79], v14 offset:25600
  v_mfma_f32_16x16x32_bf16 a[12:15], v[28:31], v[72:75], a[12:15]
  ds_read_b128 v[48:51], v11 offset:2048
  s_add_u32 m0, s52, 101376
  v_mfma_f32_16x16x32_bf16 a[16:19], v[32:35], v[60:63], a[16:19]
  buffer_load_dwordx4 v5, s[8:11], s20 offen  lds
  ds_read_b64_tr_b16 v[80:81], v15 offset:24576
  v_mfma_f32_16x16x32_bf16 a[20:23], v[32:35], v[64:67], a[20:23]
  ds_read_b64_tr_b16 v[82:83], v15 offset:25600
  v_mfma_f32_16x16x32_bf16 a[24:27], v[32:35], v[68:71], a[24:27]
  ds_read_b128 v[52:55], v11 offset:4096
  v_mfma_f32_16x16x32_bf16 a[28:31], v[32:35], v[72:75], a[28:31]
  ds_read_b64_tr_b16 v[84:85], v16 offset:24576
  s_add_u32 m0, s53, 101376
  v_mfma_f32_16x16x32_bf16 a[32:35], v[36:39], v[60:63], a[32:35]
  buffer_load_dwordx4 v9, s[12:15], s21 offen  lds
  ds_read_b64_tr_b16 v[86:87], v16 offset:25600
  v_mfma_f32_16x16x32_bf16 a[36:39], v[36:39], v[64:67], a[36:39]
  ds_read_b128 v[56:59], v11 offset:6144
  v_mfma_f32_16x16x32_bf16 a[40:43], v[36:39], v[68:71], a[40:43]
  ds_read_b64_tr_b16 v[88:89], v17 offset:24576
  v_mfma_f32_16x16x32_bf16 a[44:47], v[36:39], v[72:75], a[44:47]
  ds_read_b64_tr_b16 v[90:91], v17 offset:25600
  s_add_u32 s20, s20, 128
  v_mfma_f32_16x16x32_bf16 a[48:51], v[40:43], v[60:63], a[48:51]
  s_add_u32 s21, s21, s51
  v_mfma_f32_16x16x32_bf16 a[52:55], v[40:43], v[64:67], a[52:55]
  v_mfma_f32_16x16x32_bf16 a[56:59], v[40:43], v[68:71], a[56:59]
  v_mfma_f32_16x16x32_bf16 a[60:63], v[40:43], v[72:75], a[60:63]
  s_waitcnt lgkmcnt(0)
  v_mfma_f32_16x16x32_bf16 a[0:3], v[44:47], v[76:79], a[0:3]
  s_waitcnt vmcnt(16)
  s_barrier
  v_mfma_f32_16x16x32_bf16 a[4:7], v[44:47], v[80:83], a[4:7]
  ds_read_b128 v[28:31], v10 offset:32768
  v_mfma_f32_16x16x32_bf16 a[8:11], v[44:47], v[84:87], a[8:11]
  ds_read_b64_tr_b16 v[60:61], v14 offset:49152
  v_mfma_f32_16x16x32_bf16 a[12:15], v[44:47], v[88:91], a[12:15]
  ds_read_b64_tr_b16 v[62:63], v14 offset:50176
  v_mfma_f32_16x16x32_bf16 a[16:19], v[48:51], v[76:79], a[16:19]
  ds_read_b128 v[32:35], v10 offset:34816
  v_mfma_f32_16x16x32_bf16 a[20:23], v[48:51], v[80:83], a[20:23]
  ds_read_b64_tr_b16 v[64:65], v15 offset:49152
  v_mfma_f32_16x16x32_bf16 a[24:27], v[48:51], v[84:87], a[24:27]
  ds_read_b64_tr_b16 v[66:67], v15 offset:50176
  v_mfma_f32_16x16x32_bf16 a[28:31], v[48:51], v[88:91], a[28:31]
  ds_read_b128 v[36:39], v10 offset:36864
  v_mfma_f32_16x16x32_bf16 a[32:35], v[52:55], v[76:79], a[32:35]
  ds_read_b64_tr_b16 v[68:69], v16 offset:49152
  v_mfma_f32_16x16x32_bf16 a[36:39], v[52:55], v[80:83], a[36:39]
  ds_read_b64_tr_b16 v[70:71], v16 offset:50176
  v_mfma_f32_16x16x32_bf16 a[40:43], v[52:55], v[84:87], a[40:43]
  ds_read_b128 v[40:43], v10 offset:38912
  v_mfma_f32_16x16x32_bf16 a[44:47], v[52:55], v[88:91], a[44:47]
  ds_read_b64_tr_b16 v[72:73], v17 offset:49152
  v_mfma_f32_16x16x32_bf16 a[48:51], v[56:59], v[76:79], a[48:51]
  ds_read_b64_tr_b16 v[74:75], v17 offset:50176
  v_mfma_f32_16x16x32_bf16 a[52:55], v[56:59], v[80:83], a[52:55]
  v_mfma_f32_16x16x32_bf16 a[56:59], v[56:59], v[84:87], a[56:59]
  v_mfma_f32_16x16x32_bf16 a[60:63], v[56:59], v[88:91], a[60:63]
  s_waitcnt lgkmcnt(0)
  v_mfma_f32_16x16x32_bf16 a[0:3], v[28:31], v[60:63], a[0:3]
  ds_read_b128 v[44:47], v11 offset:32768
  v_mfma_f32_16x16x32_bf16 a[4:7], v[28:31], v[64:67], a[4:7]
  ds_read_b64_tr_b16 v[76:77], v14 offset:57344
  v_mfma_f32_16x16x32_bf16 a[8:11], v[28:31], v[68:71], a[8:11]
  ds_read_b64_tr_b16 v[78:79], v14 offset:58368
  v_mfma_f32_16x16x32_bf16 a[12:15], v[28:31], v[72:75], a[12:15]
  ds_read_b128 v[48:51], v11 offset:34816
  v_mfma_f32_16x16x32_bf16 a[16:19], v[32:35], v[60:63], a[16:19]
  ds_read_b64_tr_b16 v[80:81], v15 offset:57344
  v_mfma_f32_16x16x32_bf16 a[20:23], v[32:35], v[64:67], a[20:23]
  ds_read_b64_tr_b16 v[82:83], v15 offset:58368
  v_mfma_f32_16x16x32_bf16 a[24:27], v[32:35], v[68:71], a[24:27]
  ds_read_b128 v[52:55], v11 offset:36864
  v_mfma_f32_16x16x32_bf16 a[28:31], v[32:35], v[72:75], a[28:31]
  ds_read_b64_tr_b16 v[84:85], v16 offset:57344
  v_mfma_f32_16x16x32_bf16 a[32:35], v[36:39], v[60:63], a[32:35]
  ds_read_b64_tr_b16 v[86:87], v16 offset:58368
  v_mfma_f32_16x16x32_bf16 a[36:39], v[36:39], v[64:67], a[36:39]
  ds_read_b128 v[56:59], v11 offset:38912
  v_mfma_f32_16x16x32_bf16 a[40:43], v[36:39], v[68:71], a[40:43]
  ds_read_b64_tr_b16 v[88:89], v17 offset:57344
  v_mfma_f32_16x16x32_bf16 a[44:47], v[36:39], v[72:75], a[44:47]
  ds_read_b64_tr_b16 v[90:91], v17 offset:58368
  v_mfma_f32_16x16x32_bf16 a[48:51], v[40:43], v[60:63], a[48:51]
  v_mfma_f32_16x16x32_bf16 a[52:55], v[40:43], v[64:67], a[52:55]
  v_mfma_f32_16x16x32_bf16 a[56:59], v[40:43], v[68:71], a[56:59]
  v_mfma_f32_16x16x32_bf16 a[60:63], v[40:43], v[72:75], a[60:63]
  s_waitcnt lgkmcnt(0)
  v_mfma_f32_16x16x32_bf16 a[0:3], v[44:47], v[76:79], a[0:3]
  s_waitcnt vmcnt(8)
  s_barrier
  v_mfma_f32_16x16x32_bf16 a[4:7], v[44:47], v[80:83], a[4:7]
  ds_read_b128 v[28:31], v12 offset:0
  v_mfma_f32_16x16x32_bf16 a[8:11], v[44:47], v[84:87], a[8:11]
  ds_read_b64_tr_b16 v[60:61], v18 offset:16384
  v_mfma_f32_16x16x32_bf16 a[12:15], v[44:47], v[88:91], a[12:15]
  ds_read_b64_tr_b16 v[62:63], v18 offset:17408
  v_mfma_f32_16x16x32_bf16 a[16:19], v[48:51], v[76:79], a[16:19]
  ds_read_b128 v[32:35], v12 offset:2048
  v_mfma_f32_16x16x32_bf16 a[20:23], v[48:51], v[80:83], a[20:23]
  ds_read_b64_tr_b16 v[64:65], v19 offset:16384
  v_mfma_f32_16x16x32_bf16 a[24:27], v[48:51], v[84:87], a[24:27]
  ds_read_b64_tr_b16 v[66:67], v19 offset:17408
  v_mfma_f32_16x16x32_bf16 a[28:31], v[48:51], v[88:91], a[28:31]
  ds_read_b128 v[36:39], v12 offset:4096
  v_mfma_f32_16x16x32_bf16 a[32:35], v[52:55], v[76:79], a[32:35]
  ds_read_b64_tr_b16 v[68:69], v20 offset:16384
  v_mfma_f32_16x16x32_bf16 a[36:39], v[52:55], v[80:83], a[36:39]
  ds_read_b64_tr_b16 v[70:71], v20 offset:17408
  v_mfma_f32_16x16x32_bf16 a[40:43], v[52:55], v[84:87], a[40:43]
  ds_read_b128 v[40:43], v12 offset:6144
  v_mfma_f32_16x16x32_bf16 a[44:47], v[52:55], v[88:91], a[44:47]
  ds_read_b64_tr_b16 v[72:73], v21 offset:16384
  v_mfma_f32_16x16x32_bf16 a[48:51], v[56:59], v[76:79], a[48:51]
  ds_read_b64_tr_b16 v[74:75], v21 offset:17408
  v_mfma_f32_16x16x32_bf16 a[52:55], v[56:59], v[80:83], a[52:55]
  v_mfma_f32_16x16x32_bf16 a[56:59], v[56:59], v[84:87], a[56:59]
  v_mfma_f32_16x16x32_bf16 a[60:63], v[56:59], v[88:91], a[60:63]
  s_waitcnt lgkmcnt(0)
  v_mfma_f32_16x16x32_bf16 a[0:3], v[28:31], v[60:63], a[0:3]
  ds_read_b128 v[44:47], v13 offset:0
  v_mfma_f32_16x16x32_bf16 a[4:7], v[28:31], v[64:67], a[4:7]
  ds_read_b64_tr_b16 v[76:77], v18 offset:24576
  v_mfma_f32_16x16x32_bf16 a[8:11], v[28:31], v[68:71], a[8:11]
  ds_read_b64_tr_b16 v[78:79], v18 offset:25600
  v_mfma_f32_16x16x32_bf16 a[12:15], v[28:31], v[72:75], a[12:15]
  ds_read_b128 v[48:51], v13 offset:2048
  v_mfma_f32_16x16x32_bf16 a[16:19], v[32:35], v[60:63], a[16:19]
  ds_read_b64_tr_b16 v[80:81], v19 offset:24576
  v_mfma_f32_16x16x32_bf16 a[20:23], v[32:35], v[64:67], a[20:23]
  ds_read_b64_tr_b16 v[82:83], v19 offset:25600
  v_mfma_f32_16x16x32_bf16 a[24:27], v[32:35], v[68:71], a[24:27]
  ds_read_b128 v[52:55], v13 offset:4096
  v_mfma_f32_16x16x32_bf16 a[28:31], v[32:35], v[72:75], a[28:31]
  ds_read_b64_tr_b16 v[84:85], v20 offset:24576
  v_mfma_f32_16x16x32_bf16 a[32:35], v[36:39], v[60:63], a[32:35]
  ds_read_b64_tr_b16 v[86:87], v20 offset:25600
  v_mfma_f32_16x16x32_bf16 a[36:39], v[36:39], v[64:67], a[36:39]
  ds_read_b128 v[56:59], v13 offset:6144
  v_mfma_f32_16x16x32_bf16 a[40:43], v[36:39], v[68:71], a[40:43]
  ds_read_b64_tr_b16 v[88:89], v21 offset:24576
  v_mfma_f32_16x16x32_bf16 a[44:47], v[36:39], v[72:75], a[44:47]
  ds_read_b64_tr_b16 v[90:91], v21 offset:25600
  v_mfma_f32_16x16x32_bf16 a[48:51], v[40:43], v[60:63], a[48:51]
  v_mfma_f32_16x16x32_bf16 a[52:55], v[40:43], v[64:67], a[52:55]
  v_mfma_f32_16x16x32_bf16 a[56:59], v[40:43], v[68:71], a[56:59]
  v_mfma_f32_16x16x32_bf16 a[60:63], v[40:43], v[72:75], a[60:63]
  s_waitcnt lgkmcnt(0)
  v_mfma_f32_16x16x32_bf16 a[0:3], v[44:47], v[76:79], a[0:3]
  s_waitcnt vmcnt(0)
  s_barrier
  v_mfma_f32_16x16x32_bf16 a[4:7], v[44:47], v[80:83], a[4:7]
  ds_read_b128 v[28:31], v12 offset:32768
  v_mfma_f32_16x16x32_bf16 a[8:11], v[44:47], v[84:87], a[8:11]
  ds_read_b64_tr_b16 v[60:61], v18 offset:49152
  v_mfma_f32_16x16x32_bf16 a[12:15], v[44:47], v[88:91], a[12:15]
  ds_read_b64_tr_b16 v[62:63], v18 offset:50176
  v_mfma_f32_16x16x32_bf16 a[16:19], v[48:51], v[76:79], a[16:19]
  ds_read_b128 v[32:35], v12 offset:34816
  v_mfma_f32_16x16x32_bf16 a[20:23], v[48:51], v[80:83], a[20:23]
  ds_read_b64_tr_b16 v[64:65], v19 offset:49152
  v_mfma_f32_16x16x32_bf16 a[24:27], v[48:51], v[84:87], a[24:27]
  ds_read_b64_tr_b16 v[66:67], v19 offset:50176
  v_mfma_f32_16x16x32_bf16 a[28:31], v[48:51], v[88:91], a[28:31]
  ds_read_b128 v[36:39], v12 offset:36864
  v_mfma_f32_16x16x32_bf16 a[32:35], v[52:55], v[76:79], a[32:35]
  ds_read_b64_tr_b16 v[68:69], v20 offset:49152
  v_mfma_f32_16x16x32_bf16 a[36:39], v[52:55], v[80:83], a[36:39]
  ds_read_b64_tr_b16 v[70:71], v20 offset:50176
  v_mfma_f32_16x16x32_bf16 a[40:43], v[52:55], v[84:87], a[40:43]
  ds_read_b128 v[40:43], v12 offset:38912
  v_mfma_f32_16x16x32_bf16 a[44:47], v[52:55], v[88:91], a[44:47]
  ds_read_b64_tr_b16 v[72:73], v21 offset:49152
  v_mfma_f32_16x16x32_bf16 a[48:51], v[56:59], v[76:79], a[48:51]
  ds_read_b64_tr_b16 v[74:75], v21 offset:50176
  v_mfma_f32_16x16x32_bf16 a[52:55], v[56:59], v[80:83], a[52:55]
  v_mfma_f32_16x16x32_bf16 a[56:59], v[56:59], v[84:87], a[56:59]
  v_mfma_f32_16x16x32_bf16 a[60:63], v[56:59], v[88:91], a[60:63]
  s_waitcnt lgkmcnt(0)
  v_mfma_f32_16x16x32_bf16 a[0:3], v[28:31], v[60:63], a[0:3]
  ds_read_b128 v[44:47], v13 offset:32768
  v_mfma_f32_16x16x32_bf16 a[4:7], v[28:31], v[64:67], a[4:7]
  ds_read_b64_tr_b16 v[76:77], v18 offset:57344
  v_mfma_f32_16x16x32_bf16 a[8:11], v[28:31], v[68:71], a[8:11]
  ds_read_b64_tr_b16 v[78:79], v18 offset:58368
  v_mfma_f32_16x16x32_bf16 a[12:15], v[28:31], v[72:75], a[12:15]
  ds_read_b128 v[48:51], v13 offset:34816
  v_mfma_f32_16x16x32_bf16 a[16:19], v[32:35], v[60:63], a[16:19]
  ds_read_b64_tr_b16 v[80:81], v19 offset:57344
  v_mfma_f32_16x16x32_bf16 a[20:23], v[32:35], v[64:67], a[20:23]
  ds_read_b64_tr_b16 v[82:83], v19 offset:58368
  v_mfma_f32_16x16x32_bf16 a[24:27], v[32:35], v[68:71], a[24:27]
  ds_read_b128 v[52:55], v13 offset:36864
  v_mfma_f32_16x16x32_bf16 a[28:31], v[32:35], v[72:75], a[28:31]
  ds_read_b64_tr_b16 v[84:85], v20 offset:57344
  v_mfma_f32_16x16x32_bf16 a[32:35], v[36:39], v[60:63], a[32:35]
  ds_read_b64_tr_b16 v[86:87], v20 offset:58368
  v_mfma_f32_16x16x32_bf16 a[36:39], v[36:39], v[64:67], a[36:39]
  ds_read_b128 v[56:59], v13 offset:38912
  v_mfma_f32_16x16x32_bf16 a[40:43], v[36:39], v[68:71], a[40:43]
  ds_read_b64_tr_b16 v[88:89], v21 offset:57344
  v_mfma_f32_16x16x32_bf16 a[44:47], v[36:39], v[72:75], a[44:47]
  ds_read_b64_tr_b16 v[90:91], v21 offset:58368
  v_mfma_f32_16x16x32_bf16 a[48:51], v[40:43], v[60:63], a[48:51]
  v_mfma_f32_16x16x32_bf16 a[52:55], v[40:43], v[64:67], a[52:55]
  v_mfma_f32_16x16x32_bf16 a[56:59], v[40:43], v[68:71], a[56:59]
  v_mfma_f32_16x16x32_bf16 a[60:63], v[40:43], v[72:75], a[60:63]
  s_waitcnt lgkmcnt(0)
  v_mfma_f32_16x16x32_bf16 a[0:3], v[44:47], v[76:79], a[0:3]
  v_mfma_f32_16x16x32_bf16 a[4:7], v[44:47], v[80:83], a[4:7]
  v_mfma_f32_16x16x32_bf16 a[8:11], v[44:47], v[84:87], a[8:11]
  v_mfma_f32_16x16x32_bf16 a[12:15], v[44:47], v[88:91], a[12:15]
  v_mfma_f32_16x16x32_bf16 a[16:19], v[48:51], v[76:79], a[16:19]
  v_mfma_f32_16x16x32_bf16 a[20:23], v[48:51], v[80:83], a[20:23]
  v_mfma_f32_16x16x32_bf16 a[24:27], v[48:51], v[84:87], a[24:27]
  v_mfma_f32_16x16x32_bf16 a[28:31], v[48:51], v[88:91], a[28:31]
  v_mfma_f32_16x16x32_bf16 a[32:35], v[52:55], v[76:79], a[32:35]
  v_mfma_f32_16x16x32_bf16 a[36:39], v[52:55], v[80:83], a[36:39]
  v_mfma_f32_16x16x32_bf16 a[40:43], v[52:55], v[84:87], a[40:43]
  v_mfma_f32_16x16x32_bf16 a[44:47], v[52:55], v[88:91], a[44:47]
  v_mfma_f32_16x16x32_bf16 a[48:51], v[56:59], v[76:79], a[48:51]
  v_mfma_f32_16x16x32_bf16 a[52:55], v[56:59], v[80:83], a[52:55]
  v_mfma_f32_16x16x32_bf16 a[56:59], v[56:59], v[84:87], a[56:59]
  v_mfma_f32_16x16x32_bf16 a[60:63], v[56:59], v[88:91], a[60:63]
  s_mov_b32 s59, 4
  s_mov_b32 s60, s22
  s_mov_b32 s61, s26
  s_add_u32 s62, s38, 0x3d00000
  s_mov_b32 s63, s98
  s_cmp_lg_u32 s39, 0
  s_cbranch_scc1 L_got
  s_mov_b32 s58, 3
  s_branch L_epi
L_swp:
  s_barrier
  v_and_b32 v1, 63, v0
  v_lshlrev_b32 v2, 7, v1
  s_lshl_b32 s40, s36, 2
  s_add_u32 s40, s40, s33
  s_lshl_b32 s40, s40, 2
  s_add_u32 s40, s40, s32
  s_lshl_b32 s40, s40, 13
  s_mov_b32 s44, s78
  s_and_b32 s45, s79, 0xffff
  s_mov_b32 s46, 0x400000
  s_mov_b32 s47, 0x20000
  s_mov_b32 s41, s40
  buffer_load_dword v4, v2, s[44:47], s41 offen
  s_add_u32 s41, s41, 524288
  buffer_load_dword v5, v2, s[44:47], s41 offen
  s_add_u32 s41, s41, 524288
  buffer_load_dword v6, v2, s[44:47], s41 offen
  s_add_u32 s41, s41, 524288
  buffer_load_dword v7, v2, s[44:47], s41 offen
  s_add_u32 s41, s41, 524288
  buffer_load_dword v8, v2, s[44:47], s41 offen
  s_add_u32 s41, s41, 524288
  buffer_load_dword v9, v2, s[44:47], s41 offen
  s_add_u32 s41, s41, 524288
  buffer_load_dword v10, v2, s[44:47], s41 offen
  s_add_u32 s41, s41, 524288
  buffer_load_dword v11, v2, s[44:47], s41 offen
  s_add_u32 s41, s41, 524288
  s_mov_b32 s44, s80
  s_and_b32 s45, s81, 0xffff
  s_mov_b32 s46, 0x600000
  s_mov_b32 s47, 0x20000
  s_mov_b32 s41, s40
  buffer_load_dword v4, v2, s[44:47], s41 offen
  s_add_u32 s41, s41, 524288
  buffer_load_dword v5, v2, s[44:47], s41 offen
  s_add_u32 s41, s41, 524288
  buffer_load_dword v6, v2, s[44:47], s41 offen
  s_add_u32 s41, s41, 524288
  buffer_load_dword v7, v2, s[44:47], s41 offen
  s_add_u32 s41, s41, 524288
  buffer_load_dword v8, v2, s[44:47], s41 offen
  s_add_u32 s41, s41, 524288
  buffer_load_dword v9, v2, s[44:47], s41 offen
  s_add_u32 s41, s41, 524288
  buffer_load_dword v10, v2, s[44:47], s41 offen
  s_add_u32 s41, s41, 524288
  buffer_load_dword v11, v2, s[44:47], s41 offen
  s_add_u32 s41, s41, 524288
  buffer_load_dword v12, v2, s[44:47], s41 offen
  s_add_u32 s41, s41, 524288
  buffer_load_dword v13, v2, s[44:47], s41 offen
  s_add_u32 s41, s41, 524288
  buffer_load_dword v14, v2, s[44:47], s41 offen
  s_add_u32 s41, s41, 524288
  buffer_load_dword v15, v2, s[44:47], s41 offen
  s_add_u32 s41, s41, 524288
  s_mov_b32 s44, s82
  s_and_b32 s45, s83, 0xffff
  s_mov_b32 s46, 0x200000
  s_mov_b32 s47, 0x20000
  s_mov_b32 s41, s40
  buffer_load_dword v4, v2, s[44:47], s41 offen
  s_add_u32 s41, s41, 524288
  buffer_load_dword v5, v2, s[44:47], s41 offen
  s_add_u32 s41, s41, 524288
  buffer_load_dword v6, v2, s[44:47], s41 offen
  s_add_u32 s41, s41, 524288
  buffer_load_dword v7, v2, s[44:47], s41 offen
  s_add_u32 s41, s41, 524288
  v_lshlrev_b32 v2, 4, v1
  v_mov_b32 v32, -1
  v_mov_b32 v33, -1
  v_mov_b32 v34, -1
  v_mov_b32 v35, -1
  s_lshl_b32 s41, s40, 3
  s_add_u32 s41, s41, 0x7000000
  s_mov_b32 s42, 16
L_swf:
  buffer_store_dwordx4 v[32:35], v2, s[4:7], s41 offen offset:0 sc1
  buffer_store_dwordx4 v[32:35], v2, s[4:7], s41 offen offset:1024 sc1
  buffer_store_dwordx4 v[32:35], v2, s[4:7], s41 offen offset:2048 sc1
  buffer_store_dwordx4 v[32:35], v2, s[4:7], s41 offen offset:3072 sc1
  s_add_u32 s41, s41, 4096
  s_sub_u32 s42, s42, 1
  s_cmp_lg_u32 s42, 0
  s_cbranch_scc1 L_swf
  s_waitcnt vmcnt(0)
  s_cmp_lg_u32 s32, 0
  s_cbranch_scc1 L_rq_87
  s_cmp_eq_u32 s39, 0
  s_cbranch_scc1 L_rq_87
  s_lshl_b32 s99, s33, 7
  s_add_u32 s99, s99, 0x3d00200
  v_mov_b32 v244, 1
  v_mov_b32 v245, 0
  s_mov_b64 exec, 1
  buffer_atomic_add v244, v245, s[4:7], s99 offen sc0 sc1
  s_mov_b64 exec, -1
L_rq_87:
  s_mov_b32 s38, 5120
  s_branch L_done
  s_branch L_next
L_atb:
  s_lshl_b32 s90, s33, 7
  s_lshl_b32 s40, s36, 9
  s_add_u32 s40, s40, s90
  s_max_u32 s41, s36, 1
  s_sub_u32 s41, s41, 1
  s_lshl_b32 s41, s41, 9
  s_add_u32 s41, s41, s90
  s_cmp_lg_u32 s32, 0
  s_cbranch_scc1 L_dd_89
  v_mov_b32 v228, 0x3d00000
  v_mov_b32 v231, 0x3d03000
L_dw_88:
  buffer_load_dword v234, v231, s[4:7], s40 offen offset:0 sc1
  buffer_load_dword v235, v231, s[4:7], s41 offen offset:0 sc1
  s_waitcnt vmcnt(0)
  s_mov_b32 s44, 1
  v_readfirstlane_b32 s45, v234
  s_cmp_ge_u32 s45, 3
  s_cselect_b32 s44, s44, 0
  v_readfirstlane_b32 s45, v235
  s_cmp_ge_u32 s45, 3
  s_cselect_b32 s44, s44, 0
  s_cmp_eq_u32 s44, 1
  s_cbranch_scc1 L_dd_89
  s_sleep 6
  s_add_u32 s3, s3, 1
  s_cmp_lt_u32 s3, 131072
  s_cbranch_scc1 L_dw_88
L_dd_89:
  s_barrier
  s_lshl_b32 s38, s36, 7
  s_add_u32 s38, s38, 1024
  s_lshl_b32 s46, s36, 3
  s_lshl_b32 s90, s37, 1
  s_add_u32 s99, s46, s90
  s_lshr_b32 s90, s32, 1
  s_add_u32 s99, s99, s90
  s_lshl_b32 s99, s99, 3
  s_lshl_b32 s90, s33, 1
  s_add_u32 s99, s99, s90
  s_and_b32 s90, s32, 1
  s_add_u32 s20, s99, s90
  v_and_b32 v1, 63, v0
  s_lshl_b32 s90, s20, 13
  s_sub_u32 s91, s90, 65536
  s_cmp_lt_u32 s20, 8
  s_cselect_b32 s91, s90, s91
  v_mov_b32 v2, 0x0
  v_bfe_u32 v7, v1, 0, 6
  v_lshl_add_u32 v2, v7, 4, v2
  v_add_u32 v3, 4096, v2
  s_add_u32 s92, s90, 67108864
  s_add_u32 s93, s90, 71303168
  s_add_u32 s94, s91, 71303168
  s_add_u32 s95, s90, 75497472
  s_add_u32 s96, s91, 75497472
  s_add_u32 s97, s90, 100663296
  buffer_load_dwordx4 v[8:11], v2, s[4:7], s92 offen offset:0 sc1
  buffer_load_dwordx4 v[12:15], v2, s[4:7], s92 offen offset:1024 sc1
  buffer_load_dwordx4 v[16:19], v2, s[4:7], s92 offen offset:2048 sc1
  buffer_load_dwordx4 v[20:23], v2, s[4:7], s92 offen offset:3072 sc1
  buffer_load_dwordx4 v[24:27], v3, s[4:7], s92 offen offset:0 sc1
  buffer_load_dwordx4 v[28:31], v3, s[4:7], s92 offen offset:1024 sc1
  buffer_load_dwordx4 v[32:35], v3, s[4:7], s92 offen offset:2048 sc1
  buffer_load_dwordx4 v[36:39], v3, s[4:7], s92 offen offset:3072 sc1
  buffer_load_dwordx4 v[40:43], v3, s[4:7], s94 offen offset:0 sc1
  buffer_load_dwordx4 v[44:47], v3, s[4:7], s94 offen offset:1024 sc1
  buffer_load_dwordx4 v[48:51], v3, s[4:7], s94 offen offset:2048 sc1
  buffer_load_dwordx4 v[52:55], v3, s[4:7], s94 offen offset:3072 sc1
  buffer_load_dwordx4 v[56:59], v2, s[4:7], s93 offen offset:0 sc1
  buffer_load_dwordx4 v[60:63], v2, s[4:7], s93 offen offset:1024 sc1
  buffer_load_dwordx4 v[64:67], v2, s[4:7], s93 offen offset:2048 sc1
  buffer_load_dwordx4 v[68:71], v2, s[4:7], s93 offen offset:3072 sc1
  buffer_load_dwordx4 v[72:75], v3, s[4:7], s93 offen offset:0 sc1
  buffer_load_dwordx4 v[76:79], v3, s[4:7], s93 offen offset:1024 sc1
  buffer_load_dwordx4 v[80:83], v3, s[4:7], s93 offen offset:2048 sc1
  buffer_load_dwordx4 v[84:87], v3, s[4:7], s93 offen offset:3072 sc1
  buffer_load_dwordx2 v[88:89], v2, s[4:7], s96 offen offset:8 sc1
  buffer_load_dwordx2 v[94:95], v2, s[4:7], s96 offen offset:1032 sc1
  buffer_load_dwordx2 v[100:101], v2, s[4:7], s96 offen offset:2056 sc1
  buffer_load_dwordx2 v[106:107], v2, s[4:7], s96 offen offset:3080 sc1
  buffer_load_dwordx2 v[112:113], v3, s[4:7], s96 offen offset:8 sc1
  buffer_load_dwordx2 v[118:119], v3, s[4:7], s96 offen offset:1032 sc1
  buffer_load_dwordx2 v[124:125], v3, s[4:7], s96 offen offset:2056 sc1
  buffer_load_dwordx2 v[130:131], v3, s[4:7], s96 offen offset:3080 sc1
  buffer_load_dwordx4 v[90:93], v2, s[4:7], s95 offen offset:0 sc1
  buffer_load_dwordx4 v[96:99], v2, s[4:7], s95 offen offset:1024 sc1
  buffer_load_dwordx4 v[102:105], v2, s[4:7], s95 offen offset:2048 sc1
  buffer_load_dwordx4 v[108:111], v2, s[4:7], s95 offen offset:3072 sc1
  buffer_load_dwordx4 v[114:117], v3, s[4:7], s95 offen offset:0 sc1
  buffer_load_dwordx4 v[120:123], v3, s[4:7], s95 offen offset:1024 sc1
  buffer_load_dwordx4 v[126:129], v3, s[4:7], s95 offen offset:2048 sc1
  buffer_load_dwordx4 v[132:135], v3, s[4:7], s95 offen offset:3072 sc1
  s_mov_b32 s40, 0x50000
  s_mov_b32 s41, 0x5550055
  s_mov_b32 s42, 0xa0000
  s_mov_b32 s43, 0xaaa00aa
  s_mov_b32 s44, 0x150001
  s_mov_b32 s45, 0x15550155
  s_mov_b32 s46, 0x2a0002
  s_mov_b32 s47, 0x2aaa02aa
  s_mov_b32 s48, 0x55505555
  s_mov_b32 s49, 0x50005500
  s_mov_b32 s50, 0xaaa0aaaa
  s_mov_b32 s51, 0xa000aa00
  s_mov_b32 s52, 0x55405554
  s_mov_b32 s53, 0x40005400
  s_mov_b32 s54, 0xaa80aaa8
  s_mov_b32 s55, 0x8000a800
  s_cmp_lt_u32 s20, 8
  s_cselect_b64 s[56:57], 0, s[40:41]
  s_cselect_b64 s[58:59], 0, s[42:43]
  s_cselect_b64 s[60:61], 0, s[44:45]
  s_cselect_b64 s[62:63], 0, s[46:47]
  s_mov_b32 s21, 0x3e8293ee
  v_mov_b32 v6, 0xcfa8965f
  s_waitcnt vmcnt(16)
  v_mfma_f32_16x16x32_bf16 v[136:139], v[40:43], v[8:11], 0
  v_mfma_f32_16x16x32_bf16 v[140:143], v[56:59], v[8:11], 0
  v_mfma_f32_16x16x32_bf16 v[144:147], v[44:47], v[12:15], 0
  v_mfma_f32_16x16x32_bf16 v[148:151], v[60:63], v[12:15], 0
  v_mfma_f32_16x16x32_bf16 v[152:155], v[48:51], v[16:19], 0
  v_mfma_f32_16x16x32_bf16 v[156:159], v[64:67], v[16:19], 0
  v_mfma_f32_16x16x32_bf16 v[160:163], v[52:55], v[20:23], 0
  v_mfma_f32_16x16x32_bf16 v[164:167], v[68:71], v[20:23], 0
  v_mfma_f32_16x16x32_bf16 v[168:171], v[56:59], v[24:27], 0
  v_mfma_f32_16x16x32_bf16 v[172:175], v[72:75], v[24:27], 0
  v_mfma_f32_16x16x32_bf16 v[176:179], v[60:63], v[28:31], 0
  v_mfma_f32_16x16x32_bf16 v[180:183], v[76:79], v[28:31], 0
  v_mfma_f32_16x16x32_bf16 v[184:187], v[64:67], v[32:35], 0
  v_mfma_f32_16x16x32_bf16 v[188:191], v[80:83], v[32:35], 0
  v_mfma_f32_16x16x32_bf16 v[192:195], v[68:71], v[36:39], 0
  v_mfma_f32_16x16x32_bf16 v[196:199], v[84:87], v[36:39], 0
  v_cndmask_b32 v136, v6, v136, s[56:57]
  v_cndmask_b32 v137, v6, v137, s[58:59]
  v_cndmask_b32 v138, v6, v138, s[60:61]
  v_cndmask_b32 v139, v6, v139, s[62:63]
  v_cndmask_b32 v140, v6, v140, s[48:49]
  v_cndmask_b32 v141, v6, v141, s[50:51]
  v_cndmask_b32 v142, v6, v142, s[52:53]
  v_cndmask_b32 v143, v6, v143, s[54:55]
  v_max3_f32 v4, v136, v137, v138
  v_max3_f32 v4, v4, v139, v140
  v_max3_f32 v4, v4, v141, v142
  v_max_f32 v4, v4, v143
  v_mov_b32 v5, v4
  s_nop 1
  v_permlane32_swap_b32 v4, v5
  v_max_f32 v4, v4, v5
  v_mov_b32 v5, v4
  s_nop 1
  v_permlane16_swap_b32 v4, v5
  v_max_f32 v4, v4, v5
  v_mul_f32 v4, s21, v4
  v_fma_f32 v136, v136, s21, -v4
  v_fma_f32 v137, v137, s21, -v4
  v_fma_f32 v138, v138, s21, -v4
  v_fma_f32 v139, v139, s21, -v4
  v_fma_f32 v140, v140, s21, -v4
  v_fma_f32 v141, v141, s21, -v4
  v_fma_f32 v142, v142, s21, -v4
  v_fma_f32 v143, v143, s21, -v4
  v_exp_f32 v136, v136
  v_exp_f32 v137, v137
  v_exp_f32 v138, v138
  v_exp_f32 v139, v139
  v_exp_f32 v140, v140
  v_exp_f32 v141, v141
  v_exp_f32 v142, v142
  v_exp_f32 v143, v143
  v_add_f32 v4, v136, v137
  v_add_f32 v4, v4, v138
  v_add_f32 v4, v4, v139
  v_add_f32 v4, v4, v140
  v_add_f32 v4, v4, v141
  v_add_f32 v4, v4, v142
  v_add_f32 v4, v4, v143
  v_mov_b32 v5, v4
  s_nop 1
  v_permlane32_swap_b32 v4, v5
  v_add_f32 v4, v4, v5
  v_mov_b32 v5, v4
  s_nop 1
  v_permlane16_swap_b32 v4, v5
  v_add_f32 v4, v4, v5
  v_rcp_f32 v4, v4
  s_nop 0
  v_mul_f32 v136, v136, v4
  v_mul_f32 v137, v137, v4
  v_mul_f32 v138, v138, v4
  v_mul_f32 v139, v139, v4
  v_mul_f32 v140, v140, v4
  v_mul_f32 v141, v141, v4
  v_mul_f32 v142, v142, v4
  v_mul_f32 v143, v143, v4
  v_cvt_pk_bf16_f32 v8, v136, v137
  v_cvt_pk_bf16_f32 v9, v138, v139
  v_cvt_pk_bf16_f32 v10, v140, v141
  v_cvt_pk_bf16_f32 v11, v142, v143
  v_cndmask_b32 v144, v6, v144, s[56:57]
  v_cndmask_b32 v145, v6, v145, s[58:59]
  v_cndmask_b32 v146, v6, v146, s[60:61]
  v_cndmask_b32 v147, v6, v147, s[62:63]
  v_cndmask_b32 v148, v6, v148, s[48:49]
  v_cndmask_b32 v149, v6, v149, s[50:51]
  v_cndmask_b32 v150, v6, v150, s[52:53]
  v_cndmask_b32 v151, v6, v151, s[54:55]
  v_max3_f32 v4, v144, v145, v146
  v_max3_f32 v4, v4, v147, v148
  v_max3_f32 v4, v4, v149, v150
  v_max_f32 v4, v4, v151
  v_mov_b32 v5, v4
  s_nop 1
  v_permlane32_swap_b32 v4, v5
  v_max_f32 v4, v4, v5
  v_mov_b32 v5, v4
  s_nop 1
  v_permlane16_swap_b32 v4, v5
  v_max_f32 v4, v4, v5
  v_mul_f32 v4, s21, v4
  v_fma_f32 v144, v144, s21, -v4
  v_fma_f32 v145, v145, s21, -v4
  v_fma_f32 v146, v146, s21, -v4
  v_fma_f32 v147, v147, s21, -v4
  v_fma_f32 v148, v148, s21, -v4
  v_fma_f32 v149, v149, s21, -v4
  v_fma_f32 v150, v150, s21, -v4
  v_fma_f32 v151, v151, s21, -v4
  v_exp_f32 v144, v144
  v_exp_f32 v145, v145
  v_exp_f32 v146, v146
  v_exp_f32 v147, v147
  v_exp_f32 v148, v148
  v_exp_f32 v149, v149
  v_exp_f32 v150, v150
  v_exp_f32 v151, v151
  v_add_f32 v4, v144, v145
  v_add_f32 v4, v4, v146
  v_add_f32 v4, v4, v147
  v_add_f32 v4, v4, v148
  v_add_f32 v4, v4, v149
  v_add_f32 v4, v4, v150
  v_add_f32 v4, v4, v151
  v_mov_b32 v5, v4
  s_nop 1
  v_permlane32_swap_b32 v4, v5
  v_add_f32 v4, v4, v5
  v_mov_b32 v5, v4
  s_nop 1
  v_permlane16_swap_b32 v4, v5
  v_add_f32 v4, v4, v5
  v_rcp_f32 v4, v4
  s_nop 0
  v_mul_f32 v144, v144, v4
  v_mul_f32 v145, v145, v4
  v_mul_f32 v146, v146, v4
  v_mul_f32 v147, v147, v4
  v_mul_f32 v148, v148, v4
  v_mul_f32 v149, v149, v4
  v_mul_f32 v150, v150, v4
  v_mul_f32 v151, v151, v4
  v_cvt_pk_bf16_f32 v12, v144, v145
  v_cvt_pk_bf16_f32 v13, v146, v147
  v_cvt_pk_bf16_f32 v14, v148, v149
  v_cvt_pk_bf16_f32 v15, v150, v151
  v_cndmask_b32 v152, v6, v152, s[56:57]
  v_cndmask_b32 v153, v6, v153, s[58:59]
  v_cndmask_b32 v154, v6, v154, s[60:61]
  v_cndmask_b32 v155, v6, v155, s[62:63]
  v_cndmask_b32 v156, v6, v156, s[48:49]
  v_cndmask_b32 v157, v6, v157, s[50:51]
  v_cndmask_b32 v158, v6, v158, s[52:53]
  v_cndmask_b32 v159, v6, v159, s[54:55]
  v_max3_f32 v4, v152, v153, v154
  v_max3_f32 v4, v4, v155, v156
  v_max3_f32 v4, v4, v157, v158
  v_max_f32 v4, v4, v159
  v_mov_b32 v5, v4
  s_nop 1
  v_permlane32_swap_b32 v4, v5
  v_max_f32 v4, v4, v5
  v_mov_b32 v5, v4
  s_nop 1
  v_permlane16_swap_b32 v4, v5
  v_max_f32 v4, v4, v5
  v_mul_f32 v4, s21, v4
  v_fma_f32 v152, v152, s21, -v4
  v_fma_f32 v153, v153, s21, -v4
  v_fma_f32 v154, v154, s21, -v4
  v_fma_f32 v155, v155, s21, -v4
  v_fma_f32 v156, v156, s21, -v4
  v_fma_f32 v157, v157, s21, -v4
  v_fma_f32 v158, v158, s21, -v4
  v_fma_f32 v159, v159, s21, -v4
  v_exp_f32 v152, v152
  v_exp_f32 v153, v153
  v_exp_f32 v154, v154
  v_exp_f32 v155, v155
  v_exp_f32 v156, v156
  v_exp_f32 v157, v157
  v_exp_f32 v158, v158
  v_exp_f32 v159, v159
  v_add_f32 v4, v152, v153
  v_add_f32 v4, v4, v154
  v_add_f32 v4, v4, v155
  v_add_f32 v4, v4, v156
  v_add_f32 v4, v4, v157
  v_add_f32 v4, v4, v158
  v_add_f32 v4, v4, v159
  v_mov_b32 v5, v4
  s_nop 1
  v_permlane32_swap_b32 v4, v5
  v_add_f32 v4, v4, v5
  v_mov_b32 v5, v4
  s_nop 1
  v_permlane16_swap_b32 v4, v5
  v_add_f32 v4, v4, v5
  v_rcp_f32 v4, v4
  s_nop 0
  v_mul_f32 v152, v152, v4
  v_mul_f32 v153, v153, v4
  v_mul_f32 v154, v154, v4
  v_mul_f32 v155, v155, v4
  v_mul_f32 v156, v156, v4
  v_mul_f32 v157, v157, v4
  v_mul_f32 v158, v158, v4
  v_mul_f32 v159, v159, v4
  v_cvt_pk_bf16_f32 v16, v152, v153
  v_cvt_pk_bf16_f32 v17, v154, v155
  v_cvt_pk_bf16_f32 v18, v156, v157
  v_cvt_pk_bf16_f32 v19, v158, v159
  v_cndmask_b32 v160, v6, v160, s[56:57]
  v_cndmask_b32 v161, v6, v161, s[58:59]
  v_cndmask_b32 v162, v6, v162, s[60:61]
  v_cndmask_b32 v163, v6, v163, s[62:63]
  v_cndmask_b32 v164, v6, v164, s[48:49]
  v_cndmask_b32 v165, v6, v165, s[50:51]
  v_cndmask_b32 v166, v6, v166, s[52:53]
  v_cndmask_b32 v167, v6, v167, s[54:55]
  v_max3_f32 v4, v160, v161, v162
  v_max3_f32 v4, v4, v163, v164
  v_max3_f32 v4, v4, v165, v166
  v_max_f32 v4, v4, v167
  v_mov_b32 v5, v4
  s_nop 1
  v_permlane32_swap_b32 v4, v5
  v_max_f32 v4, v4, v5
  v_mov_b32 v5, v4
  s_nop 1
  v_permlane16_swap_b32 v4, v5
  v_max_f32 v4, v4, v5
  v_mul_f32 v4, s21, v4
  v_fma_f32 v160, v160, s21, -v4
  v_fma_f32 v161, v161, s21, -v4
  v_fma_f32 v162, v162, s21, -v4
  v_fma_f32 v163, v163, s21, -v4
  v_fma_f32 v164, v164, s21, -v4
  v_fma_f32 v165, v165, s21, -v4
  v_fma_f32 v166, v166, s21, -v4
  v_fma_f32 v167, v167, s21, -v4
  v_exp_f32 v160, v160
  v_exp_f32 v161, v161
  v_exp_f32 v162, v162
  v_exp_f32 v163, v163
  v_exp_f32 v164, v164
  v_exp_f32 v165, v165
  v_exp_f32 v166, v166
  v_exp_f32 v167, v167
  v_add_f32 v4, v160, v161
  v_add_f32 v4, v4, v162
  v_add_f32 v4, v4, v163
  v_add_f32 v4, v4, v164
  v_add_f32 v4, v4, v165
  v_add_f32 v4, v4, v166
  v_add_f32 v4, v4, v167
  v_mov_b32 v5, v4
  s_nop 1
  v_permlane32_swap_b32 v4, v5
  v_add_f32 v4, v4, v5
  v_mov_b32 v5, v4
  s_nop 1
  v_permlane16_swap_b32 v4, v5
  v_add_f32 v4, v4, v5
  v_rcp_f32 v4, v4
  s_nop 0
  v_mul_f32 v160, v160, v4
  v_mul_f32 v161, v161, v4
  v_mul_f32 v162, v162, v4
  v_mul_f32 v163, v163, v4
  v_mul_f32 v164, v164, v4
  v_mul_f32 v165, v165, v4
  v_mul_f32 v166, v166, v4
  v_mul_f32 v167, v167, v4
  v_cvt_pk_bf16_f32 v20, v160, v161
  v_cvt_pk_bf16_f32 v21, v162, v163
  v_cvt_pk_bf16_f32 v22, v164, v165
  v_cvt_pk_bf16_f32 v23, v166, v167
  v_cndmask_b32 v168, v6, v168, s[40:41]
  v_cndmask_b32 v169, v6, v169, s[42:43]
  v_cndmask_b32 v170, v6, v170, s[44:45]
  v_cndmask_b32 v171, v6, v171, s[46:47]
  v_cndmask_b32 v172, v6, v172, s[48:49]
  v_cndmask_b32 v173, v6, v173, s[50:51]
  v_cndmask_b32 v174, v6, v174, s[52:53]
  v_cndmask_b32 v175, v6, v175, s[54:55]
  v_max3_f32 v4, v168, v169, v170
  v_max3_f32 v4, v4, v171, v172
  v_max3_f32 v4, v4, v173, v174
  v_max_f32 v4, v4, v175
  v_mov_b32 v5, v4
  s_nop 1
  v_permlane32_swap_b32 v4, v5
  v_max_f32 v4, v4, v5
  v_mov_b32 v5, v4
  s_nop 1
  v_permlane16_swap_b32 v4, v5
  v_max_f32 v4, v4, v5
  v_mul_f32 v4, s21, v4
  v_fma_f32 v168, v168, s21, -v4
  v_fma_f32 v169, v169, s21, -v4
  v_fma_f32 v170, v170, s21, -v4
  v_fma_f32 v171, v171, s21, -v4
  v_fma_f32 v172, v172, s21, -v4
  v_fma_f32 v173, v173, s21, -v4
  v_fma_f32 v174, v174, s21, -v4
  v_fma_f32 v175, v175, s21, -v4
  v_exp_f32 v168, v168
  v_exp_f32 v169, v169
  v_exp_f32 v170, v170
  v_exp_f32 v171, v171
  v_exp_f32 v172, v172
  v_exp_f32 v173, v173
  v_exp_f32 v174, v174
  v_exp_f32 v175, v175
  v_add_f32 v4, v168, v169
  v_add_f32 v4, v4, v170
  v_add_f32 v4, v4, v171
  v_add_f32 v4, v4, v172
  v_add_f32 v4, v4, v173
  v_add_f32 v4, v4, v174
  v_add_f32 v4, v4, v175
  v_mov_b32 v5, v4
  s_nop 1
  v_permlane32_swap_b32 v4, v5
  v_add_f32 v4, v4, v5
  v_mov_b32 v5, v4
  s_nop 1
  v_permlane16_swap_b32 v4, v5
  v_add_f32 v4, v4, v5
  v_rcp_f32 v4, v4
  s_nop 0
  v_mul_f32 v168, v168, v4
  v_mul_f32 v169, v169, v4
  v_mul_f32 v170, v170, v4
  v_mul_f32 v171, v171, v4
  v_mul_f32 v172, v172, v4
  v_mul_f32 v173, v173, v4
  v_mul_f32 v174, v174, v4
  v_mul_f32 v175, v175, v4
  v_cvt_pk_bf16_f32 v24, v168, v169
  v_cvt_pk_bf16_f32 v25, v170, v171
  v_cvt_pk_bf16_f32 v26, v172, v173
  v_cvt_pk_bf16_f32 v27, v174, v175
  v_cndmask_b32 v176, v6, v176, s[40:41]
  v_cndmask_b32 v177, v6, v177, s[42:43]
  v_cndmask_b32 v178, v6, v178, s[44:45]
  v_cndmask_b32 v179, v6, v179, s[46:47]
  v_cndmask_b32 v180, v6, v180, s[48:49]
  v_cndmask_b32 v181, v6, v181, s[50:51]
  v_cndmask_b32 v182, v6, v182, s[52:53]
  v_cndmask_b32 v183, v6, v183, s[54:55]
  v_max3_f32 v4, v176, v177, v178
  v_max3_f32 v4, v4, v179, v180
  v_max3_f32 v4, v4, v181, v182
  v_max_f32 v4, v4, v183
  v_mov_b32 v5, v4
  s_nop 1
  v_permlane32_swap_b32 v4, v5
  v_max_f32 v4, v4, v5
  v_mov_b32 v5, v4
  s_nop 1
  v_permlane16_swap_b32 v4, v5
  v_max_f32 v4, v4, v5
  v_mul_f32 v4, s21, v4
  v_fma_f32 v176, v176, s21, -v4
  v_fma_f32 v177, v177, s21, -v4
  v_fma_f32 v178, v178, s21, -v4
  v_fma_f32 v179, v179, s21, -v4
  v_fma_f32 v180, v180, s21, -v4
  v_fma_f32 v181, v181, s21, -v4
  v_fma_f32 v182, v182, s21, -v4
  v_fma_f32 v183, v183, s21, -v4
  v_exp_f32 v176, v176
  v_exp_f32 v177, v177
  v_exp_f32 v178, v178
  v_exp_f32 v179, v179
  v_exp_f32 v180, v180
  v_exp_f32 v181, v181
  v_exp_f32 v182, v182
  v_exp_f32 v183, v183
  v_add_f32 v4, v176, v177
  v_add_f32 v4, v4, v178
  v_add_f32 v4, v4, v179
  v_add_f32 v4, v4, v180
  v_add_f32 v4, v4, v181
  v_add_f32 v4, v4, v182
  v_add_f32 v4, v4, v183
  v_mov_b32 v5, v4
  s_nop 1
  v_permlane32_swap_b32 v4, v5
  v_add_f32 v4, v4, v5
  v_mov_b32 v5, v4
  s_nop 1
  v_permlane16_swap_b32 v4, v5
  v_add_f32 v4, v4, v5
  v_rcp_f32 v4, v4
  s_nop 0
  v_mul_f32 v176, v176, v4
  v_mul_f32 v177, v177, v4
  v_mul_f32 v178, v178, v4
  v_mul_f32 v179, v179, v4
  v_mul_f32 v180, v180, v4
  v_mul_f32 v181, v181, v4
  v_mul_f32 v182, v182, v4
  v_mul_f32 v183, v183, v4
  v_cvt_pk_bf16_f32 v28, v176, v177
  v_cvt_pk_bf16_f32 v29, v178, v179
  v_cvt_pk_bf16_f32 v30, v180, v181
  v_cvt_pk_bf16_f32 v31, v182, v183
  v_cndmask_b32 v184, v6, v184, s[40:41]
  v_cndmask_b32 v185, v6, v185, s[42:43]
  v_cndmask_b32 v186, v6, v186, s[44:45]
  v_cndmask_b32 v187, v6, v187, s[46:47]
  v_cndmask_b32 v188, v6, v188, s[48:49]
  v_cndmask_b32 v189, v6, v189, s[50:51]
  v_cndmask_b32 v190, v6, v190, s[52:53]
  v_cndmask_b32 v191, v6, v191, s[54:55]
  v_max3_f32 v4, v184, v185, v186
  v_max3_f32 v4, v4, v187, v188
  v_max3_f32 v4, v4, v189, v190
  v_max_f32 v4, v4, v191
  v_mov_b32 v5, v4
  s_nop 1
  v_permlane32_swap_b32 v4, v5
  v_max_f32 v4, v4, v5
  v_mov_b32 v5, v4
  s_nop 1
  v_permlane16_swap_b32 v4, v5
  v_max_f32 v4, v4, v5
  v_mul_f32 v4, s21, v4
  v_fma_f32 v184, v184, s21, -v4
  v_fma_f32 v185, v185, s21, -v4
  v_fma_f32 v186, v186, s21, -v4
  v_fma_f32 v187, v187, s21, -v4
  v_fma_f32 v188, v188, s21, -v4
  v_fma_f32 v189, v189, s21, -v4
  v_fma_f32 v190, v190, s21, -v4
  v_fma_f32 v191, v191, s21, -v4
  v_exp_f32 v184, v184
  v_exp_f32 v185, v185
  v_exp_f32 v186, v186
  v_exp_f32 v187, v187
  v_exp_f32 v188, v188
  v_exp_f32 v189, v189
  v_exp_f32 v190, v190
  v_exp_f32 v191, v191
  v_add_f32 v4, v184, v185
  v_add_f32 v4, v4, v186
  v_add_f32 v4, v4, v187
  v_add_f32 v4, v4, v188
  v_add_f32 v4, v4, v189
  v_add_f32 v4, v4, v190
  v_add_f32 v4, v4, v191
  v_mov_b32 v5, v4
  s_nop 1
  v_permlane32_swap_b32 v4, v5
  v_add_f32 v4, v4, v5
  v_mov_b32 v5, v4
  s_nop 1
  v_permlane16_swap_b32 v4, v5
  v_add_f32 v4, v4, v5
  v_rcp_f32 v4, v4
  s_nop 0
  v_mul_f32 v184, v184, v4
  v_mul_f32 v185, v185, v4
  v_mul_f32 v186, v186, v4
  v_mul_f32 v187, v187, v4
  v_mul_f32 v188, v188, v4
  v_mul_f32 v189, v189, v4
  v_mul_f32 v190, v190, v4
  v_mul_f32 v191, v191, v4
  v_cvt_pk_bf16_f32 v32, v184, v185
  v_cvt_pk_bf16_f32 v33, v186, v187
  v_cvt_pk_bf16_f32 v34, v188, v189
  v_cvt_pk_bf16_f32 v35, v190, v191
  v_cndmask_b32 v192, v6, v192, s[40:41]
  v_cndmask_b32 v193, v6, v193, s[42:43]
  v_cndmask_b32 v194, v6, v194, s[44:45]
  v_cndmask_b32 v195, v6, v195, s[46:47]
  v_cndmask_b32 v196, v6, v196, s[48:49]
  v_cndmask_b32 v197, v6, v197, s[50:51]
  v_cndmask_b32 v198, v6, v198, s[52:53]
  v_cndmask_b32 v199, v6, v199, s[54:55]
  v_max3_f32 v4, v192, v193, v194
  v_max3_f32 v4, v4, v195, v196
  v_max3_f32 v4, v4, v197, v198
  v_max_f32 v4, v4, v199
  v_mov_b32 v5, v4
  s_nop 1
  v_permlane32_swap_b32 v4, v5
  v_max_f32 v4, v4, v5
  v_mov_b32 v5, v4
  s_nop 1
  v_permlane16_swap_b32 v4, v5
  v_max_f32 v4, v4, v5
  v_mul_f32 v4, s21, v4
  v_fma_f32 v192, v192, s21, -v4
  v_fma_f32 v193, v193, s21, -v4
  v_fma_f32 v194, v194, s21, -v4
  v_fma_f32 v195, v195, s21, -v4
  v_fma_f32 v196, v196, s21, -v4
  v_fma_f32 v197, v197, s21, -v4
  v_fma_f32 v198, v198, s21, -v4
  v_fma_f32 v199, v199, s21, -v4
  v_exp_f32 v192, v192
  v_exp_f32 v193, v193
  v_exp_f32 v194, v194
  v_exp_f32 v195, v195
  v_exp_f32 v196, v196
  v_exp_f32 v197, v197
  v_exp_f32 v198, v198
  v_exp_f32 v199, v199
  v_add_f32 v4, v192, v193
  v_add_f32 v4, v4, v194
  v_add_f32 v4, v4, v195
  v_add_f32 v4, v4, v196
  v_add_f32 v4, v4, v197
  v_add_f32 v4, v4, v198
  v_add_f32 v4, v4, v199
  v_mov_b32 v5, v4
  s_nop 1
  v_permlane32_swap_b32 v4, v5
  v_add_f32 v4, v4, v5
  v_mov_b32 v5, v4
  s_nop 1
  v_permlane16_swap_b32 v4, v5
  v_add_f32 v4, v4, v5
  v_rcp_f32 v4, v4
  s_nop 0
  v_mul_f32 v192, v192, v4
  v_mul_f32 v193, v193, v4
  v_mul_f32 v194, v194, v4
  v_mul_f32 v195, v195, v4
  v_mul_f32 v196, v196, v4
  v_mul_f32 v197, v197, v4
  v_mul_f32 v198, v198, v4
  v_mul_f32 v199, v199, v4
  v_cvt_pk_bf16_f32 v36, v192, v193
  v_cvt_pk_bf16_f32 v37, v194, v195
  v_cvt_pk_bf16_f32 v38, v196, v197
  v_cvt_pk_bf16_f32 v39, v198, v199
  s_waitcnt vmcnt(0)
  s_cmp_lg_u32 s32, 0
  s_cbranch_scc1 L_rq_90
  s_cmp_eq_u32 s39, 0
  s_cbranch_scc1 L_rq_90
  s_lshl_b32 s99, s33, 7
  s_add_u32 s99, s99, 0x3d00200
  v_mov_b32 v244, 1
  v_mov_b32 v245, 0
  s_mov_b64 exec, 1
  buffer_atomic_add v244, v245, s[4:7], s99 offen sc0 sc1
  s_mov_b64 exec, -1
L_rq_90:
  v_mfma_f32_16x16x32_bf16 v[136:139], v[88:91], v[8:11], 0
  v_mfma_f32_16x16x32_bf16 v[140:143], v[94:97], v[8:11], 0
  v_mfma_f32_16x16x32_bf16 v[144:147], v[100:103], v[12:15], 0
  v_mfma_f32_16x16x32_bf16 v[148:151], v[106:109], v[12:15], 0
  v_mfma_f32_16x16x32_bf16 v[152:155], v[112:115], v[16:19], 0
  v_mfma_f32_16x16x32_bf16 v[156:159], v[118:121], v[16:19], 0
  v_mfma_f32_16x16x32_bf16 v[160:163], v[124:127], v[20:23], 0
  v_mfma_f32_16x16x32_bf16 v[164:167], v[130:133], v[20:23], 0
  v_mfma_f32_16x16x32_bf16 v[168:171], v[90:93], v[24:27], 0
  v_mfma_f32_16x16x32_bf16 v[172:175], v[96:99], v[24:27], 0
  v_mfma_f32_16x16x32_bf16 v[176:179], v[102:105], v[28:31], 0
  v_mfma_f32_16x16x32_bf16 v[180:183], v[108:111], v[28:31], 0
  v_mfma_f32_16x16x32_bf16 v[184:187], v[114:117], v[32:35], 0
  v_mfma_f32_16x16x32_bf16 v[188:191], v[120:123], v[32:35], 0
  v_mfma_f32_16x16x32_bf16 v[192:195], v[126:129], v[36:39], 0
  v_mfma_f32_16x16x32_bf16 v[196:199], v[132:135], v[36:39], 0
  v_cvt_pk_bf16_f32 v40, v136, v137
  v_cvt_pk_bf16_f32 v41, v138, v139
  v_cvt_pk_bf16_f32 v42, v140, v141
  v_cvt_pk_bf16_f32 v43, v142, v143
  buffer_store_dwordx4 v[40:43], v2, s[4:7], s97 offen offset:0 sc1
  v_cvt_pk_bf16_f32 v44, v144, v145
  v_cvt_pk_bf16_f32 v45, v146, v147
  v_cvt_pk_bf16_f32 v46, v148, v149
  v_cvt_pk_bf16_f32 v47, v150, v151
  buffer_store_dwordx4 v[44:47], v2, s[4:7], s97 offen offset:1024 sc1
  v_cvt_pk_bf16_f32 v48, v152, v153
  v_cvt_pk_bf16_f32 v49, v154, v155
  v_cvt_pk_bf16_f32 v50, v156, v157
  v_cvt_pk_bf16_f32 v51, v158, v159
  buffer_store_dwordx4 v[48:51], v2, s[4:7], s97 offen offset:2048 sc1
  v_cvt_pk_bf16_f32 v52, v160, v161
  v_cvt_pk_bf16_f32 v53, v162, v163
  v_cvt_pk_bf16_f32 v54, v164, v165
  v_cvt_pk_bf16_f32 v55, v166, v167
  buffer_store_dwordx4 v[52:55], v2, s[4:7], s97 offen offset:3072 sc1
  v_cvt_pk_bf16_f32 v56, v168, v169
  v_cvt_pk_bf16_f32 v57, v170, v171
  v_cvt_pk_bf16_f32 v58, v172, v173
  v_cvt_pk_bf16_f32 v59, v174, v175
  buffer_store_dwordx4 v[56:59], v3, s[4:7], s97 offen offset:0 sc1
  v_cvt_pk_bf16_f32 v60, v176, v177
  v_cvt_pk_bf16_f32 v61, v178, v179
  v_cvt_pk_bf16_f32 v62, v180, v181
  v_cvt_pk_bf16_f32 v63, v182, v183
  buffer_store_dwordx4 v[60:63], v3, s[4:7], s97 offen offset:1024 sc1
  v_cvt_pk_bf16_f32 v64, v184, v185
  v_cvt_pk_bf16_f32 v65, v186, v187
  v_cvt_pk_bf16_f32 v66, v188, v189
  v_cvt_pk_bf16_f32 v67, v190, v191
  buffer_store_dwordx4 v[64:67], v3, s[4:7], s97 offen offset:2048 sc1
  v_cvt_pk_bf16_f32 v68, v192, v193
  v_cvt_pk_bf16_f32 v69, v194, v195
  v_cvt_pk_bf16_f32 v70, v196, v197
  v_cvt_pk_bf16_f32 v71, v198, v199
  buffer_store_dwordx4 v[68:71], v3, s[4:7], s97 offen offset:3072 sc1
  s_branch L_done
L_ata:
  s_mov_b32 s50, 0
L_ata_c:
  s_lshr_b32 s40, s36, 3
  s_lshl_b32 s40, s40, 9
  s_lshl_b32 s90, s33, 7
  s_add_u32 s40, s40, s90
  s_add_u32 s41, s36, 1
  s_min_u32 s41, s41, 62
  s_lshr_b32 s43, s36, 2
  s_lshl_b32 s43, s43, 9
  s_add_u32 s43, s43, s90
  s_add_u32 s43, s43, 28672
  s_lshl_b32 s42, s33, 1
  s_add_u32 s42, s42, s37
  s_lshl_b32 s42, s42, 7
  s_add_u32 s42, s42, 4096
  s_cmp_ge_u32 s50, 2
  s_cbranch_scc1 L_ata_s
  s_cmp_lg_u32 s32, 0
  s_cbranch_scc1 L_dd_92
  v_mov_b32 v228, 0x3d00000
  v_mov_b32 v230, 0x3d02000
L_dw_91:
  buffer_load_dword v234, v230, s[4:7], s40 offen offset:0 sc1
  buffer_load_dword v235, v228, s[4:7], s43 offen offset:0 sc1
  s_waitcnt vmcnt(0)
  s_mov_b32 s44, 1
  v_readfirstlane_b32 s45, v234
  s_cmp_ge_u32 s45, 4
  s_cselect_b32 s44, s44, 0
  v_readfirstlane_b32 s45, v235
  s_cmp_ge_u32 s45, 16
  s_cselect_b32 s44, s44, 0
  s_cmp_eq_u32 s44, 1
  s_cbranch_scc1 L_dd_92
  s_sleep 6
  s_add_u32 s3, s3, 1
  s_cmp_lt_u32 s3, 131072
  s_cbranch_scc1 L_dw_91
L_dd_92:
  s_barrier
L_ata_s:
  s_mov_b32 s98, 1
  s_lshr_b32 s38, s36, 2
  s_lshl_b32 s38, s38, 7
  s_add_u32 s38, s38, 2048
  s_lshr_b32 s90, s36, 1
  s_sub_u32 s90, s90, 24
  s_lshl_b32 s90, s90, 2
  s_add_u32 s90, s90, s33
  s_lshl_b32 s90, s90, 1
  s_add_u32 s90, s90, s37
  s_lshl_b32 s90, s90, 7
  s_add_u32 s90, s90, 20480
  s_cmp_ge_u32 s36, 60
  s_cselect_b32 s38, s90, s38
  s_lshl_b32 s20, s36, 5
  s_lshl_b32 s90, s33, 3
  s_add_u32 s20, s20, s90
  s_lshl_b32 s90, s37, 2
  s_add_u32 s20, s20, s90
  s_add_u32 s20, s20, s32
  v_and_b32 v1, 63, v0
  v_mov_b32 v228, 0x3d00000
  s_lshl_b32 s45, s33, 7
  buffer_load_dword v238, v228, s[4:7], s45 offen offset:0 sc1
  s_lshl_b32 s90, s20, 13
  s_lshl_b32 s91, s20, 11
  v_mov_b32 v2, 0x0
  v_bfe_u32 v7, v1, 0, 6
  v_lshl_add_u32 v2, v7, 4, v2
  v_add_u32 v3, 4096, v2
  v_mov_b32 v4, 0x3000000
  v_bfe_u32 v7, v1, 0, 1
  v_lshl_add_u32 v4, v7, 4, v4
  v_bfe_u32 v7, v1, 2, 2
  v_lshl_add_u32 v4, v7, 5, v4
  v_bfe_u32 v7, v1, 4, 2
  v_lshl_add_u32 v4, v7, 7, v4
  v_add_u32 v5, 0x3400000, v2
  v_mov_b32 v8, 0x0
  v_bfe_u32 v7, v1, 0, 3
  v_lshl_add_u32 v8, v7, 4, v8
  v_bfe_u32 v7, v1, 3, 1
  v_lshl_add_u32 v8, v7, 11, v8
  v_bfe_u32 v7, v1, 4, 2
  v_lshl_add_u32 v8, v7, 8, v8
  v_add_u32 v9, 4096, v8
  v_mov_b32 v10, 0x0
  v_bfe_u32 v7, v1, 0, 4
  v_lshl_add_u32 v10, v7, 4, v10
  v_bfe_u32 v7, v1, 4, 1
  v_lshl_add_u32 v10, v7, 8, v10
  v_bfe_u32 v7, v1, 5, 1
  v_lshl_add_u32 v10, v7, 10, v10
  v_add_u32 v11, 4096, v10
  s_add_u32 s92, s90, 16777216
  s_add_u32 s93, s90, 33554432
  s_add_u32 s94, s90, 0
  s_add_u32 s95, s90, 83886080
  buffer_load_dwordx4 v[16:19], v2, s[4:7], s94 offen offset:0 sc1
  buffer_load_dwordx4 v[20:23], v2, s[4:7], s94 offen offset:1024 sc1
  buffer_load_dwordx4 v[24:27], v2, s[4:7], s94 offen offset:2048 sc1
  buffer_load_dwordx4 v[28:31], v2, s[4:7], s94 offen offset:3072 sc1
  buffer_load_dwordx4 v[32:35], v3, s[4:7], s94 offen offset:0 sc1
  buffer_load_dwordx4 v[36:39], v3, s[4:7], s94 offen offset:1024 sc1
  buffer_load_dwordx4 v[40:43], v3, s[4:7], s94 offen offset:2048 sc1
  buffer_load_dwordx4 v[44:47], v3, s[4:7], s94 offen offset:3072 sc1
  buffer_load_dwordx4 v[48:51], v2, s[4:7], s92 offen offset:0 sc1
  buffer_load_dwordx4 v[52:55], v2, s[4:7], s92 offen offset:1024 sc1
  buffer_load_dwordx4 v[56:59], v2, s[4:7], s92 offen offset:2048 sc1
  buffer_load_dwordx4 v[60:63], v2, s[4:7], s92 offen offset:3072 sc1
  buffer_load_dwordx4 v[64:67], v3, s[4:7], s92 offen offset:0 sc1
  buffer_load_dwordx4 v[68:71], v3, s[4:7], s92 offen offset:1024 sc1
  buffer_load_dwordx4 v[72:75], v3, s[4:7], s92 offen offset:2048 sc1
  buffer_load_dwordx4 v[76:79], v3, s[4:7], s92 offen offset:3072 sc1
  buffer_load_dwordx4 v[80:83], v8, s[4:7], s93 offen offset:0 sc1
  buffer_load_dwordx4 v[84:87], v8, s[4:7], s93 offen offset:128 sc1
  buffer_load_dwordx4 v[88:91], v8, s[4:7], s93 offen offset:1024 sc1
  buffer_load_dwordx4 v[92:95], v8, s[4:7], s93 offen offset:1152 sc1
  buffer_load_dwordx4 v[96:99], v9, s[4:7], s93 offen offset:0 sc1
  buffer_load_dwordx4 v[100:103], v9, s[4:7], s93 offen offset:128 sc1
  buffer_load_dwordx4 v[104:107], v9, s[4:7], s93 offen offset:1024 sc1
  buffer_load_dwordx4 v[108:111], v9, s[4:7], s93 offen offset:1152 sc1
  s_waitcnt vmcnt(24)
L_m1:
  v_readfirstlane_b32 s44, v238
  s_cmp_ge_u32 s44, s41
  s_cbranch_scc1 L_m1d
  s_add_u32 s3, s3, 1
  s_cmp_ge_u32 s3, 131072
  s_cbranch_scc1 L_m1d
  s_sleep 3
  buffer_load_dword v238, v228, s[4:7], s45 offen offset:0 sc1
  s_waitcnt vmcnt(0)
  s_branch L_m1
L_m1d:
  buffer_load_dwordx4 v[112:115], v4, s[4:7], s91 offen offset:0 sc1
  buffer_load_dwordx4 v[116:119], v4, s[4:7], s91 offen offset:512 sc1
  buffer_load_dwordx4 v[120:123], v4, s[4:7], s91 offen offset:1024 sc1
  buffer_load_dwordx4 v[124:127], v4, s[4:7], s91 offen offset:1536 sc1
  buffer_load_dwordx4 v[128:131], v5, s[4:7], s91 offen offset:0 sc1
  buffer_load_dwordx4 v[132:135], v5, s[4:7], s91 offen offset:1024 sc1
  s_mov_b32 s40, 0xfff0ffff
  s_mov_b32 s41, 0xf000ff00
  s_mov_b32 s42, 0xffe0fffe
  s_mov_b32 s43, 0xe000fe00
  s_mov_b32 s44, 0xffc0fffc
  s_mov_b32 s45, 0xc000fc00
  s_mov_b32 s46, 0xff80fff8
  s_mov_b32 s47, 0x8000f800
  s_mov_b32 s50, 0x3e0293ee
  v_mov_b32 v6, 0xd028965f
  s_waitcnt vmcnt(6)
  v_mfma_f32_16x16x32_bf16 v[140:143], v[48:51], v[16:19], 0
  v_mfma_f32_16x16x32_bf16 v[148:151], v[48:51], v[32:35], 0
  v_mfma_f32_16x16x32_bf16 v[152:155], v[64:67], v[32:35], 0
  v_mfma_f32_16x16x32_bf16 v[140:143], v[52:55], v[20:23], v[140:143]
  v_mfma_f32_16x16x32_bf16 v[148:151], v[52:55], v[36:39], v[148:151]
  v_mfma_f32_16x16x32_bf16 v[152:155], v[68:71], v[36:39], v[152:155]
  v_mfma_f32_16x16x32_bf16 v[140:143], v[56:59], v[24:27], v[140:143]
  v_mfma_f32_16x16x32_bf16 v[148:151], v[56:59], v[40:43], v[148:151]
  v_mfma_f32_16x16x32_bf16 v[152:155], v[72:75], v[40:43], v[152:155]
  v_mfma_f32_16x16x32_bf16 v[140:143], v[60:63], v[28:31], v[140:143]
  v_mfma_f32_16x16x32_bf16 v[148:151], v[60:63], v[44:47], v[148:151]
  v_mfma_f32_16x16x32_bf16 v[152:155], v[76:79], v[44:47], v[152:155]
L_av:
  s_waitcnt vmcnt(0)
  v_max3_u32 v12, v112, v113, v114
  v_max3_u32 v12, v12, v115, v116
  v_max3_u32 v12, v12, v117, v118
  v_max3_u32 v12, v12, v119, v120
  v_max3_u32 v12, v12, v121, v122
  v_max3_u32 v12, v12, v123, v124
  v_max3_u32 v12, v12, v125, v126
  v_max3_u32 v12, v12, v127, v128
  v_max3_u32 v12, v12, v129, v130
  v_max3_u32 v12, v12, v131, v132
  v_max3_u32 v12, v12, v133, v134
  v_max_u32 v12, v12, v135
  v_cmp_eq_u32 vcc, -1, v12
  s_cbranch_vccz L_avd
  s_add_u32 s3, s3, 1
  s_cmp_ge_u32 s3, 131072
  s_cbranch_scc1 L_avd
  buffer_load_dwordx4 v[112:115], v4, s[4:7], s91 offen offset:0 sc1
  buffer_load_dwordx4 v[116:119], v4, s[4:7], s91 offen offset:512 sc1
  buffer_load_dwordx4 v[120:123], v4, s[4:7], s91 offen offset:1024 sc1
  buffer_load_dwordx4 v[124:127], v4, s[4:7], s91 offen offset:1536 sc1
  buffer_load_dwordx4 v[128:131], v5, s[4:7], s91 offen offset:0 sc1
  buffer_load_dwordx4 v[132:135], v5, s[4:7], s91 offen offset:1024 sc1
  s_branch L_av
L_avd:
  s_waitcnt vmcnt(0)
  s_cmp_lt_u32 s36, 60
  s_cbranch_scc1 L_rf_93
  s_cmp_lg_u32 s32, 0
  s_cbranch_scc1 L_rq_94
  s_cmp_eq_u32 s39, 0
  s_cbranch_scc1 L_rq_94
  s_lshl_b32 s99, s33, 7
  s_add_u32 s99, s99, 0x3d00200
  v_mov_b32 v244, 1
  v_mov_b32 v245, 0
  s_mov_b64 exec, 1
  buffer_atomic_add v244, v245, s[4:7], s99 offen sc0 sc1
  s_mov_b64 exec, -1
L_rq_94:
L_rf_93:
  v_mfma_f32_16x16x32_bf16 v[136:139], v[112:115], v[16:19], 0
  v_mfma_f32_16x16x32_bf16 v[144:147], v[112:115], v[32:35], 0
  v_mfma_f32_16x16x32_bf16 v[136:139], v[116:119], v[20:23], v[136:139]
  v_mfma_f32_16x16x32_bf16 v[144:147], v[116:119], v[36:39], v[144:147]
  v_mfma_f32_16x16x32_bf16 v[136:139], v[120:123], v[24:27], v[136:139]
  v_mfma_f32_16x16x32_bf16 v[144:147], v[120:123], v[40:43], v[144:147]
  v_mfma_f32_16x16x32_bf16 v[136:139], v[124:127], v[28:31], v[136:139]
  v_mfma_f32_16x16x32_bf16 v[144:147], v[124:127], v[44:47], v[144:147]
  v_cndmask_b32 v140, v6, v140, s[40:41]
  v_cndmask_b32 v141, v6, v141, s[42:43]
  v_cndmask_b32 v142, v6, v142, s[44:45]
  v_cndmask_b32 v143, v6, v143, s[46:47]
  s_nop 2
  v_max3_f32 v12, v136, v137, v140
  v_max3_f32 v12, v12, v141, v142
  v_max_f32 v12, v12, v143
  v_mov_b32 v13, v12
  s_nop 1
  v_permlane32_swap_b32 v12, v13
  v_max_f32 v12, v12, v13
  v_mov_b32 v13, v12
  s_nop 1
  v_permlane16_swap_b32 v12, v13
  v_max_f32 v12, v12, v13
  v_mul_f32 v12, s50, v12
  v_fma_f32 v136, v136, s50, -v12
  v_fma_f32 v137, v137, s50, -v12
  v_fma_f32 v140, v140, s50, -v12
  v_fma_f32 v141, v141, s50, -v12
  v_fma_f32 v142, v142, s50, -v12
  v_fma_f32 v143, v143, s50, -v12
  v_exp_f32 v136, v136
  v_exp_f32 v137, v137
  v_exp_f32 v140, v140
  v_exp_f32 v141, v141
  v_exp_f32 v142, v142
  v_exp_f32 v143, v143
  v_add_f32 v12, v136, v137
  v_add_f32 v12, v12, v140
  v_add_f32 v12, v12, v141
  v_add_f32 v12, v12, v142
  v_add_f32 v12, v12, v143
  v_mov_b32 v13, v12
  s_nop 1
  v_permlane32_swap_b32 v12, v13
  v_add_f32 v12, v12, v13
  v_mov_b32 v13, v12
  s_nop 1
  v_permlane16_swap_b32 v12, v13
  v_add_f32 v12, v12, v13
  v_rcp_f32 v12, v12
  s_nop 0
  v_mul_f32 v136, v136, v12
  v_mul_f32 v137, v137, v12
  v_mul_f32 v140, v140, v12
  v_mul_f32 v141, v141, v12
  v_mul_f32 v142, v142, v12
  v_mul_f32 v143, v143, v12
  v_cvt_pk_bf16_f32 v160, v136, v137
  v_mov_b32 v161, 0
  v_mov_b32 v162, 0
  v_mov_b32 v163, v160
  v_cvt_pk_bf16_f32 v156, v140, v141
  v_cvt_pk_bf16_f32 v157, v142, v143
  v_mov_b32 v158, 0
  v_mov_b32 v159, 0
  v_cndmask_b32 v152, v6, v152, s[40:41]
  v_cndmask_b32 v153, v6, v153, s[42:43]
  v_cndmask_b32 v154, v6, v154, s[44:45]
  v_cndmask_b32 v155, v6, v155, s[46:47]
  v_max3_f32 v12, v144, v145, v148
  v_max3_f32 v12, v12, v149, v150
  v_max3_f32 v12, v12, v151, v152
  v_max3_f32 v12, v12, v153, v154
  v_max_f32 v12, v12, v155
  v_mov_b32 v13, v12
  s_nop 1
  v_permlane32_swap_b32 v12, v13
  v_max_f32 v12, v12, v13
  v_mov_b32 v13, v12
  s_nop 1
  v_permlane16_swap_b32 v12, v13
  v_max_f32 v12, v12, v13
  v_mul_f32 v12, s50, v12
  v_fma_f32 v144, v144, s50, -v12
  v_fma_f32 v145, v145, s50, -v12
  v_fma_f32 v148, v148, s50, -v12
  v_fma_f32 v149, v149, s50, -v12
  v_fma_f32 v150, v150, s50, -v12
  v_fma_f32 v151, v151, s50, -v12
  v_fma_f32 v152, v152, s50, -v12
  v_fma_f32 v153, v153, s50, -v12
  v_fma_f32 v154, v154, s50, -v12
  v_fma_f32 v155, v155, s50, -v12
  v_exp_f32 v144, v144
  v_exp_f32 v145, v145
  v_exp_f32 v148, v148
  v_exp_f32 v149, v149
  v_exp_f32 v150, v150
  v_exp_f32 v151, v151
  v_exp_f32 v152, v152
  v_exp_f32 v153, v153
  v_exp_f32 v154, v154
  v_exp_f32 v155, v155
  v_add_f32 v12, v144, v145
  v_add_f32 v12, v12, v148
  v_add_f32 v12, v12, v149
  v_add_f32 v12, v12, v150
  v_add_f32 v12, v12, v151
  v_add_f32 v12, v12, v152
  v_add_f32 v12, v12, v153
  v_add_f32 v12, v12, v154
  v_add_f32 v12, v12, v155
  v_mov_b32 v13, v12
  s_nop 1
  v_permlane32_swap_b32 v12, v13
  v_add_f32 v12, v12, v13
  v_mov_b32 v13, v12
  s_nop 1
  v_permlane16_swap_b32 v12, v13
  v_add_f32 v12, v12, v13
  v_rcp_f32 v12, v12
  s_nop 0
  v_mul_f32 v144, v144, v12
  v_mul_f32 v145, v145, v12
  v_mul_f32 v148, v148, v12
  v_mul_f32 v149, v149, v12
  v_mul_f32 v150, v150, v12
  v_mul_f32 v151, v151, v12
  v_mul_f32 v152, v152, v12
  v_mul_f32 v153, v153, v12
  v_mul_f32 v154, v154, v12
  v_mul_f32 v155, v155, v12
  v_cvt_pk_bf16_f32 v168, v144, v145
  v_mov_b32 v169, 0
  v_mov_b32 v170, 0
  v_mov_b32 v171, v168
  v_cvt_pk_bf16_f32 v164, v148, v149
  v_cvt_pk_bf16_f32 v165, v150, v151
  v_cvt_pk_bf16_f32 v166, v152, v153
  v_cvt_pk_bf16_f32 v167, v154, v155
  v_mfma_f32_16x16x32_bf16 v[176:179], v[80:83], v[156:159], 0
  v_mfma_f32_16x16x32_bf16 v[180:183], v[84:87], v[156:159], 0
  v_mfma_f32_16x16x32_bf16 v[184:187], v[88:91], v[156:159], 0
  v_mfma_f32_16x16x32_bf16 v[188:191], v[92:95], v[156:159], 0
  v_mfma_f32_16x16x32_bf16 v[192:195], v[96:99], v[156:159], 0
  v_mfma_f32_16x16x32_bf16 v[196:199], v[100:103], v[156:159], 0
  v_mfma_f32_16x16x32_bf16 v[200:203], v[104:107], v[156:159], 0
  v_mfma_f32_16x16x32_bf16 v[204:207], v[108:111], v[156:159], 0
  v_mfma_f32_16x16x16_bf16 v[176:179], v[128:129], v[160:161], v[176:179]
  v_mfma_f32_16x16x16_bf16 v[180:183], v[128:129], v[162:163], v[180:183]
  v_mfma_f32_16x16x16_bf16 v[184:187], v[130:131], v[160:161], v[184:187]
  v_mfma_f32_16x16x16_bf16 v[188:191], v[130:131], v[162:163], v[188:191]
  v_mfma_f32_16x16x16_bf16 v[192:195], v[132:133], v[160:161], v[192:195]
  v_mfma_f32_16x16x16_bf16 v[196:199], v[132:133], v[162:163], v[196:199]
  v_mfma_f32_16x16x16_bf16 v[200:203], v[134:135], v[160:161], v[200:203]
  v_mfma_f32_16x16x16_bf16 v[204:207], v[134:135], v[162:163], v[204:207]
  v_mfma_f32_16x16x32_bf16 v[208:211], v[80:83], v[164:167], 0
  v_mfma_f32_16x16x32_bf16 v[212:215], v[84:87], v[164:167], 0
  v_mfma_f32_16x16x32_bf16 v[216:219], v[88:91], v[164:167], 0
  v_mfma_f32_16x16x32_bf16 v[220:223], v[92:95], v[164:167], 0
  v_mfma_f32_16x16x32_bf16 v[224:227], v[96:99], v[164:167], 0
  v_mfma_f32_16x16x32_bf16 v[228:231], v[100:103], v[164:167], 0
  v_mfma_f32_16x16x32_bf16 v[232:235], v[104:107], v[164:167], 0
  v_mfma_f32_16x16x32_bf16 v[236:239], v[108:111], v[164:167], 0
  v_mfma_f32_16x16x16_bf16 v[208:211], v[128:129], v[168:169], v[208:211]
  v_mfma_f32_16x16x16_bf16 v[212:215], v[128:129], v[170:171], v[212:215]
  v_mfma_f32_16x16x16_bf16 v[216:219], v[130:131], v[168:169], v[216:219]
  v_mfma_f32_16x16x16_bf16 v[220:223], v[130:131], v[170:171], v[220:223]
  v_mfma_f32_16x16x16_bf16 v[224:227], v[132:133], v[168:169], v[224:227]
  v_mfma_f32_16x16x16_bf16 v[228:231], v[132:133], v[170:171], v[228:231]
  v_mfma_f32_16x16x16_bf16 v[232:235], v[134:135], v[168:169], v[232:235]
  v_mfma_f32_16x16x16_bf16 v[236:239], v[134:135], v[170:171], v[236:239]
  v_cvt_pk_bf16_f32 v136, v176, v177
  v_cvt_pk_bf16_f32 v137, v178, v179
  v_cvt_pk_bf16_f32 v138, v184, v185
  v_cvt_pk_bf16_f32 v139, v186, v187
  buffer_store_dwordx4 v[136:139], v10, s[4:7], s95 offen offset:0 sc1
  v_cvt_pk_bf16_f32 v140, v180, v181
  v_cvt_pk_bf16_f32 v141, v182, v183
  v_cvt_pk_bf16_f32 v142, v188, v189
  v_cvt_pk_bf16_f32 v143, v190, v191
  buffer_store_dwordx4 v[140:143], v10, s[4:7], s95 offen offset:512 sc1
  v_cvt_pk_bf16_f32 v144, v192, v193
  v_cvt_pk_bf16_f32 v145, v194, v195
  v_cvt_pk_bf16_f32 v146, v200, v201
  v_cvt_pk_bf16_f32 v147, v202, v203
  buffer_store_dwordx4 v[144:147], v10, s[4:7], s95 offen offset:2048 sc1
  v_cvt_pk_bf16_f32 v148, v196, v197
  v_cvt_pk_bf16_f32 v149, v198, v199
  v_cvt_pk_bf16_f32 v150, v204, v205
  v_cvt_pk_bf16_f32 v151, v206, v207
  buffer_store_dwordx4 v[148:151], v10, s[4:7], s95 offen offset:2560 sc1
  v_cvt_pk_bf16_f32 v136, v208, v209
  v_cvt_pk_bf16_f32 v137, v210, v211
  v_cvt_pk_bf16_f32 v138, v216, v217
  v_cvt_pk_bf16_f32 v139, v218, v219
  buffer_store_dwordx4 v[136:139], v11, s[4:7], s95 offen offset:0 sc1
  v_cvt_pk_bf16_f32 v140, v212, v213
  v_cvt_pk_bf16_f32 v141, v214, v215
  v_cvt_pk_bf16_f32 v142, v220, v221
  v_cvt_pk_bf16_f32 v143, v222, v223
  buffer_store_dwordx4 v[140:143], v11, s[4:7], s95 offen offset:512 sc1
  v_cvt_pk_bf16_f32 v144, v224, v225
  v_cvt_pk_bf16_f32 v145, v226, v227
  v_cvt_pk_bf16_f32 v146, v232, v233
  v_cvt_pk_bf16_f32 v147, v234, v235
  buffer_store_dwordx4 v[144:147], v11, s[4:7], s95 offen offset:2048 sc1
  v_cvt_pk_bf16_f32 v148, v228, v229
  v_cvt_pk_bf16_f32 v149, v230, v231
  v_cvt_pk_bf16_f32 v150, v236, v237
  v_cvt_pk_bf16_f32 v151, v238, v239
  buffer_store_dwordx4 v[148:151], v11, s[4:7], s95 offen offset:2560 sc1
  s_add_u32 s95, s95, 262144
  s_branch L_done
L_ata4:
  s_lshr_b32 s40, s36, 3
  s_lshl_b32 s40, s40, 9
  s_lshl_b32 s90, s33, 7
  s_add_u32 s40, s40, s90
  s_add_u32 s41, s36, 4
  s_lshr_b32 s43, s36, 2
  s_lshl_b32 s43, s43, 9
  s_add_u32 s43, s43, s90
  s_add_u32 s43, s43, 28672
  s_lshl_b32 s42, s33, 1
  s_add_u32 s42, s42, s37
  s_lshl_b32 s42, s42, 7
  s_add_u32 s42, s42, 4096
  s_cmp_lg_u32 s32, 0
  s_cbranch_scc1 L_dd_96
  v_mov_b32 v228, 0x3d00000
  v_mov_b32 v230, 0x3d02000
L_dw_95:
  buffer_load_dword v234, v230, s[4:7], s40 offen offset:0 sc1
  buffer_load_dword v235, v228, s[4:7], s43 offen offset:0 sc1
  s_lshl_b32 s45, s33, 7
  buffer_load_dword v238, v228, s[4:7], s45 offen offset:0 sc1
  buffer_load_dword v239, v228, s[4:7], s42 offen sc1
  s_waitcnt vmcnt(0)
  s_mov_b32 s44, 1
  v_readfirstlane_b32 s45, v234
  s_cmp_ge_u32 s45, 4
  s_cselect_b32 s44, s44, 0
  v_readfirstlane_b32 s45, v235
  s_cmp_ge_u32 s45, 16
  s_cselect_b32 s44, s44, 0
  v_readfirstlane_b32 s45, v238
  v_readfirstlane_b32 s47, v239
  s_cmp_ge_u32 s47, 16
  s_cselect_b32 s45, 64, s45
  s_cmp_ge_u32 s45, s41
  s_cselect_b32 s44, s44, 0
  s_cmp_eq_u32 s44, 1
  s_cbranch_scc1 L_dd_96
  s_sleep 6
  s_add_u32 s3, s3, 1
  s_cmp_lt_u32 s3, 131072
  s_cbranch_scc1 L_dw_95
L_dd_96:
  s_barrier
  s_mov_b32 s98, 4
  s_lshr_b32 s38, s36, 2
  s_lshl_b32 s38, s38, 7
  s_add_u32 s38, s38, 2048
  s_lshl_b32 s20, s36, 5
  s_lshl_b32 s90, s33, 3
  s_add_u32 s20, s20, s90
  s_lshl_b32 s90, s37, 2
  s_add_u32 s20, s20, s90
  s_add_u32 s20, s20, s32
  v_and_b32 v1, 63, v0
  s_lshl_b32 s90, s20, 13
  s_lshl_b32 s91, s20, 11
  v_mov_b32 v2, 0x0
  v_bfe_u32 v7, v1, 0, 6
  v_lshl_add_u32 v2, v7, 4, v2
  v_add_u32 v3, 4096, v2
  v_mov_b32 v4, 0x3000000
  v_bfe_u32 v7, v1, 0, 1
  v_lshl_add_u32 v4, v7, 4, v4
  v_bfe_u32 v7, v1, 2, 2
  v_lshl_add_u32 v4, v7, 5, v4
  v_bfe_u32 v7, v1, 4, 2
  v_lshl_add_u32 v4, v7, 7, v4
  v_add_u32 v5, 0x3400000, v2
  v_mov_b32 v8, 0x0
  v_bfe_u32 v7, v1, 0, 3
  v_lshl_add_u32 v8, v7, 4, v8
  v_bfe_u32 v7, v1, 3, 1
  v_lshl_add_u32 v8, v7, 11, v8
  v_bfe_u32 v7, v1, 4, 2
  v_lshl_add_u32 v8, v7, 8, v8
  v_add_u32 v9, 4096, v8
  v_mov_b32 v10, 0x0
  v_bfe_u32 v7, v1, 0, 4
  v_lshl_add_u32 v10, v7, 4, v10
  v_bfe_u32 v7, v1, 4, 1
  v_lshl_add_u32 v10, v7, 8, v10
  v_bfe_u32 v7, v1, 5, 1
  v_lshl_add_u32 v10, v7, 10, v10
  v_add_u32 v11, 4096, v10
  s_add_u32 s92, s90, 16777216
  s_add_u32 s93, s90, 33554432
  s_add_u32 s94, s90, 0
  s_add_u32 s95, s90, 83886080
  buffer_load_dwordx4 v[16:19], v2, s[4:7], s94 offen offset:0 sc1
  buffer_load_dwordx4 v[20:23], v2, s[4:7], s94 offen offset:1024 sc1
  buffer_load_dwordx4 v[24:27], v2, s[4:7], s94 offen offset:2048 sc1
  buffer_load_dwordx4 v[28:31], v2, s[4:7], s94 offen offset:3072 sc1
  buffer_load_dwordx4 v[32:35], v3, s[4:7], s94 offen offset:0 sc1
  buffer_load_dwordx4 v[36:39], v3, s[4:7], s94 offen offset:1024 sc1
  buffer_load_dwordx4 v[40:43], v3, s[4:7], s94 offen offset:2048 sc1
  buffer_load_dwordx4 v[44:47], v3, s[4:7], s94 offen offset:3072 sc1
  buffer_load_dwordx4 v[48:51], v2, s[4:7], s92 offen offset:0 sc1
  buffer_load_dwordx4 v[52:55], v2, s[4:7], s92 offen offset:1024 sc1
  buffer_load_dwordx4 v[56:59], v2, s[4:7], s92 offen offset:2048 sc1
  buffer_load_dwordx4 v[60:63], v2, s[4:7], s92 offen offset:3072 sc1
  buffer_load_dwordx4 v[64:67], v3, s[4:7], s92 offen offset:0 sc1
  buffer_load_dwordx4 v[68:71], v3, s[4:7], s92 offen offset:1024 sc1
  buffer_load_dwordx4 v[72:75], v3, s[4:7], s92 offen offset:2048 sc1
  buffer_load_dwordx4 v[76:79], v3, s[4:7], s92 offen offset:3072 sc1
  buffer_load_dwordx4 v[80:83], v8, s[4:7], s93 offen offset:0 sc1
  buffer_load_dwordx4 v[84:87], v8, s[4:7], s93 offen offset:128 sc1
  buffer_load_dwordx4 v[88:91], v8, s[4:7], s93 offen offset:1024 sc1
  buffer_load_dwordx4 v[92:95], v8, s[4:7], s93 offen offset:1152 sc1
  buffer_load_dwordx4 v[96:99], v9, s[4:7], s93 offen offset:0 sc1
  buffer_load_dwordx4 v[100:103], v9, s[4:7], s93 offen offset:128 sc1
  buffer_load_dwordx4 v[104:107], v9, s[4:7], s93 offen offset:1024 sc1
  buffer_load_dwordx4 v[108:111], v9, s[4:7], s93 offen offset:1152 sc1
  buffer_load_dwordx4 v[112:115], v4, s[4:7], s91 offen offset:0 sc1
  buffer_load_dwordx4 v[116:119], v4, s[4:7], s91 offen offset:512 sc1
  buffer_load_dwordx4 v[120:123], v4, s[4:7], s91 offen offset:1024 sc1
  buffer_load_dwordx4 v[124:127], v4, s[4:7], s91 offen offset:1536 sc1
  buffer_load_dwordx4 v[128:131], v5, s[4:7], s91 offen offset:0 sc1
  buffer_load_dwordx4 v[132:135], v5, s[4:7], s91 offen offset:1024 sc1
  s_add_u32 s92, s92, 262144
  s_add_u32 s93, s93, 262144
  s_add_u32 s94, s94, 262144
  s_add_u32 s91, s91, 65536
  buffer_load_dwordx4 a[0:3], v2, s[4:7], s94 offen offset:0 sc1
  buffer_load_dwordx4 a[4:7], v2, s[4:7], s94 offen offset:1024 sc1
  buffer_load_dwordx4 a[8:11], v2, s[4:7], s94 offen offset:2048 sc1
  buffer_load_dwordx4 a[12:15], v2, s[4:7], s94 offen offset:3072 sc1
  buffer_load_dwordx4 a[16:19], v3, s[4:7], s94 offen offset:0 sc1
  buffer_load_dwordx4 a[20:23], v3, s[4:7], s94 offen offset:1024 sc1
  buffer_load_dwordx4 a[24:27], v3, s[4:7], s94 offen offset:2048 sc1
  buffer_load_dwordx4 a[28:31], v3, s[4:7], s94 offen offset:3072 sc1
  buffer_load_dwordx4 a[32:35], v2, s[4:7], s92 offen offset:0 sc1
  buffer_load_dwordx4 a[36:39], v2, s[4:7], s92 offen offset:1024 sc1
  buffer_load_dwordx4 a[40:43], v2, s[4:7], s92 offen offset:2048 sc1
  buffer_load_dwordx4 a[44:47], v2, s[4:7], s92 offen offset:3072 sc1
  buffer_load_dwordx4 a[48:51], v3, s[4:7], s92 offen offset:0 sc1
  buffer_load_dwordx4 a[52:55], v3, s[4:7], s92 offen offset:1024 sc1
  buffer_load_dwordx4 a[56:59], v3, s[4:7], s92 offen offset:2048 sc1
  buffer_load_dwordx4 a[60:63], v3, s[4:7], s92 offen offset:3072 sc1
  buffer_load_dwordx4 a[64:67], v8, s[4:7], s93 offen offset:0 sc1
  buffer_load_dwordx4 a[68:71], v8, s[4:7], s93 offen offset:128 sc1
  buffer_load_dwordx4 a[72:75], v8, s[4:7], s93 offen offset:1024 sc1
  buffer_load_dwordx4 a[76:79], v8, s[4:7], s93 offen offset:1152 sc1
  buffer_load_dwordx4 a[80:83], v9, s[4:7], s93 offen offset:0 sc1
  buffer_load_dwordx4 a[84:87], v9, s[4:7], s93 offen offset:128 sc1
  buffer_load_dwordx4 a[88:91], v9, s[4:7], s93 offen offset:1024 sc1
  buffer_load_dwordx4 a[92:95], v9, s[4:7], s93 offen offset:1152 sc1
  buffer_load_dwordx4 a[96:99], v4, s[4:7], s91 offen offset:0 sc1
  buffer_load_dwordx4 a[100:103], v4, s[4:7], s91 offen offset:512 sc1
  buffer_load_dwordx4 a[104:107], v4, s[4:7], s91 offen offset:1024 sc1
  buffer_load_dwordx4 a[108:111], v4, s[4:7], s91 offen offset:1536 sc1
  buffer_load_dwordx4 a[112:115], v5, s[4:7], s91 offen offset:0 sc1
  buffer_load_dwordx4 a[116:119], v5, s[4:7], s91 offen offset:1024 sc1
  s_add_u32 s92, s92, 262144
  s_add_u32 s93, s93, 262144
  s_add_u32 s94, s94, 262144
  s_add_u32 s91, s91, 65536
  s_mov_b32 s40, 0xfff0ffff
  s_mov_b32 s41, 0xf000ff00
  s_mov_b32 s42, 0xffe0fffe
  s_mov_b32 s43, 0xe000fe00
  s_mov_b32 s44, 0xffc0fffc
  s_mov_b32 s45, 0xc000fc00
  s_mov_b32 s46, 0xff80fff8
  s_mov_b32 s47, 0x8000f800
  s_mov_b32 s50, 0x3e0293ee
  v_mov_b32 v6, 0xd028965f
  s_waitcnt vmcnt(30)
  v_mfma_f32_16x16x32_bf16 v[136:139], v[112:115], v[16:19], 0
  v_mfma_f32_16x16x32_bf16 v[140:143], v[48:51], v[16:19], 0
  v_mfma_f32_16x16x32_bf16 v[144:147], v[112:115], v[32:35], 0
  v_mfma_f32_16x16x32_bf16 v[148:151], v[48:51], v[32:35], 0
  v_mfma_f32_16x16x32_bf16 v[152:155], v[64:67], v[32:35], 0
  v_mfma_f32_16x16x32_bf16 v[136:139], v[116:119], v[20:23], v[136:139]
  v_mfma_f32_16x16x32_bf16 v[140:143], v[52:55], v[20:23], v[140:143]
  v_mfma_f32_16x16x32_bf16 v[144:147], v[116:119], v[36:39], v[144:147]
  v_mfma_f32_16x16x32_bf16 v[148:151], v[52:55], v[36:39], v[148:151]
  v_mfma_f32_16x16x32_bf16 v[152:155], v[68:71], v[36:39], v[152:155]
  v_mfma_f32_16x16x32_bf16 v[136:139], v[120:123], v[24:27], v[136:139]
  v_mfma_f32_16x16x32_bf16 v[140:143], v[56:59], v[24:27], v[140:143]
  v_mfma_f32_16x16x32_bf16 v[144:147], v[120:123], v[40:43], v[144:147]
  v_mfma_f32_16x16x32_bf16 v[148:151], v[56:59], v[40:43], v[148:151]
  v_mfma_f32_16x16x32_bf16 v[152:155], v[72:75], v[40:43], v[152:155]
  v_mfma_f32_16x16x32_bf16 v[136:139], v[124:127], v[28:31], v[136:139]
  v_mfma_f32_16x16x32_bf16 v[140:143], v[60:63], v[28:31], v[140:143]
  v_mfma_f32_16x16x32_bf16 v[144:147], v[124:127], v[44:47], v[144:147]
  v_mfma_f32_16x16x32_bf16 v[148:151], v[60:63], v[44:47], v[148:151]
  v_mfma_f32_16x16x32_bf16 v[152:155], v[76:79], v[44:47], v[152:155]
  s_nop 4
  v_cndmask_b32 v140, v6, v140, s[40:41]
  v_cndmask_b32 v141, v6, v141, s[42:43]
  v_cndmask_b32 v142, v6, v142, s[44:45]
  v_cndmask_b32 v143, v6, v143, s[46:47]
  v_max3_f32 v12, v136, v137, v140
  v_max3_f32 v12, v12, v141, v142
  v_max_f32 v12, v12, v143
  v_mov_b32 v13, v12
  s_nop 1
  v_permlane32_swap_b32 v12, v13
  v_max_f32 v12, v12, v13
  v_mov_b32 v13, v12
  s_nop 1
  v_permlane16_swap_b32 v12, v13
  v_max_f32 v12, v12, v13
  v_mul_f32 v12, s50, v12
  v_fma_f32 v136, v136, s50, -v12
  v_fma_f32 v137, v137, s50, -v12
  v_fma_f32 v140, v140, s50, -v12
  v_fma_f32 v141, v141, s50, -v12
  v_fma_f32 v142, v142, s50, -v12
  v_fma_f32 v143, v143, s50, -v12
  v_exp_f32 v136, v136
  v_exp_f32 v137, v137
  v_exp_f32 v140, v140
  v_exp_f32 v141, v141
  v_exp_f32 v142, v142
  v_exp_f32 v143, v143
  v_add_f32 v12, v136, v137
  v_add_f32 v12, v12, v140
  v_add_f32 v12, v12, v141
  v_add_f32 v12, v12, v142
  v_add_f32 v12, v12, v143
  v_mov_b32 v13, v12
  s_nop 1
  v_permlane32_swap_b32 v12, v13
  v_add_f32 v12, v12, v13
  v_mov_b32 v13, v12
  s_nop 1
  v_permlane16_swap_b32 v12, v13
  v_add_f32 v12, v12, v13
  v_rcp_f32 v12, v12
  s_nop 0
  v_mul_f32 v136, v136, v12
  v_mul_f32 v137, v137, v12
  v_mul_f32 v140, v140, v12
  v_mul_f32 v141, v141, v12
  v_mul_f32 v142, v142, v12
  v_mul_f32 v143, v143, v12
  v_cvt_pk_bf16_f32 v160, v136, v137
  v_mov_b32 v161, 0
  v_mov_b32 v162, 0
  v_mov_b32 v163, v160
  v_cvt_pk_bf16_f32 v156, v140, v141
  v_cvt_pk_bf16_f32 v157, v142, v143
  v_mov_b32 v158, 0
  v_mov_b32 v159, 0
  v_cndmask_b32 v152, v6, v152, s[40:41]
  v_cndmask_b32 v153, v6, v153, s[42:43]
  v_cndmask_b32 v154, v6, v154, s[44:45]
  v_cndmask_b32 v155, v6, v155, s[46:47]
  v_max3_f32 v12, v144, v145, v148
  v_max3_f32 v12, v12, v149, v150
  v_max3_f32 v12, v12, v151, v152
  v_max3_f32 v12, v12, v153, v154
  v_max_f32 v12, v12, v155
  v_mov_b32 v13, v12
  s_nop 1
  v_permlane32_swap_b32 v12, v13
  v_max_f32 v12, v12, v13
  v_mov_b32 v13, v12
  s_nop 1
  v_permlane16_swap_b32 v12, v13
  v_max_f32 v12, v12, v13
  v_mul_f32 v12, s50, v12
  v_fma_f32 v144, v144, s50, -v12
  v_fma_f32 v145, v145, s50, -v12
  v_fma_f32 v148, v148, s50, -v12
  v_fma_f32 v149, v149, s50, -v12
  v_fma_f32 v150, v150, s50, -v12
  v_fma_f32 v151, v151, s50, -v12
  v_fma_f32 v152, v152, s50, -v12
  v_fma_f32 v153, v153, s50, -v12
  v_fma_f32 v154, v154, s50, -v12
  v_fma_f32 v155, v155, s50, -v12
  v_exp_f32 v144, v144
  v_exp_f32 v145, v145
  v_exp_f32 v148, v148
  v_exp_f32 v149, v149
  v_exp_f32 v150, v150
  v_exp_f32 v151, v151
  v_exp_f32 v152, v152
  v_exp_f32 v153, v153
  v_exp_f32 v154, v154
  v_exp_f32 v155, v155
  v_add_f32 v12, v144, v145
  v_add_f32 v12, v12, v148
  v_add_f32 v12, v12, v149
  v_add_f32 v12, v12, v150
  v_add_f32 v12, v12, v151
  v_add_f32 v12, v12, v152
  v_add_f32 v12, v12, v153
  v_add_f32 v12, v12, v154
  v_add_f32 v12, v12, v155
  v_mov_b32 v13, v12
  s_nop 1
  v_permlane32_swap_b32 v12, v13
  v_add_f32 v12, v12, v13
  v_mov_b32 v13, v12
  s_nop 1
  v_permlane16_swap_b32 v12, v13
  v_add_f32 v12, v12, v13
  v_rcp_f32 v12, v12
  s_nop 0
  v_mul_f32 v144, v144, v12
  v_mul_f32 v145, v145, v12
  v_mul_f32 v148, v148, v12
  v_mul_f32 v149, v149, v12
  v_mul_f32 v150, v150, v12
  v_mul_f32 v151, v151, v12
  v_mul_f32 v152, v152, v12
  v_mul_f32 v153, v153, v12
  v_mul_f32 v154, v154, v12
  v_mul_f32 v155, v155, v12
  v_cvt_pk_bf16_f32 v168, v144, v145
  v_mov_b32 v169, 0
  v_mov_b32 v170, 0
  v_mov_b32 v171, v168
  v_cvt_pk_bf16_f32 v164, v148, v149
  v_cvt_pk_bf16_f32 v165, v150, v151
  v_cvt_pk_bf16_f32 v166, v152, v153
  v_cvt_pk_bf16_f32 v167, v154, v155
  v_mfma_f32_16x16x32_bf16 v[176:179], v[80:83], v[156:159], 0
  v_mfma_f32_16x16x32_bf16 v[180:183], v[84:87], v[156:159], 0
  v_mfma_f32_16x16x32_bf16 v[184:187], v[88:91], v[156:159], 0
  v_mfma_f32_16x16x32_bf16 v[188:191], v[92:95], v[156:159], 0
  v_mfma_f32_16x16x32_bf16 v[192:195], v[96:99], v[156:159], 0
  v_mfma_f32_16x16x32_bf16 v[196:199], v[100:103], v[156:159], 0
  v_mfma_f32_16x16x32_bf16 v[200:203], v[104:107], v[156:159], 0
  v_mfma_f32_16x16x32_bf16 v[204:207], v[108:111], v[156:159], 0
  v_mfma_f32_16x16x16_bf16 v[176:179], v[128:129], v[160:161], v[176:179]
  v_mfma_f32_16x16x16_bf16 v[180:183], v[128:129], v[162:163], v[180:183]
  v_mfma_f32_16x16x16_bf16 v[184:187], v[130:131], v[160:161], v[184:187]
  v_mfma_f32_16x16x16_bf16 v[188:191], v[130:131], v[162:163], v[188:191]
  v_mfma_f32_16x16x16_bf16 v[192:195], v[132:133], v[160:161], v[192:195]
  v_mfma_f32_16x16x16_bf16 v[196:199], v[132:133], v[162:163], v[196:199]
  v_mfma_f32_16x16x16_bf16 v[200:203], v[134:135], v[160:161], v[200:203]
  v_mfma_f32_16x16x16_bf16 v[204:207], v[134:135], v[162:163], v[204:207]
  v_mfma_f32_16x16x32_bf16 v[208:211], v[80:83], v[164:167], 0
  v_mfma_f32_16x16x32_bf16 v[212:215], v[84:87], v[164:167], 0
  v_mfma_f32_16x16x32_bf16 v[216:219], v[88:91], v[164:167], 0
  v_mfma_f32_16x16x32_bf16 v[220:223], v[92:95], v[164:167], 0
  v_mfma_f32_16x16x32_bf16 v[224:227], v[96:99], v[164:167], 0
  v_mfma_f32_16x16x32_bf16 v[228:231], v[100:103], v[164:167], 0
  v_mfma_f32_16x16x32_bf16 v[232:235], v[104:107], v[164:167], 0
  v_mfma_f32_16x16x32_bf16 v[236:239], v[108:111], v[164:167], 0
  v_mfma_f32_16x16x16_bf16 v[208:211], v[128:129], v[168:169], v[208:211]
  v_mfma_f32_16x16x16_bf16 v[212:215], v[128:129], v[170:171], v[212:215]
  v_mfma_f32_16x16x16_bf16 v[216:219], v[130:131], v[168:169], v[216:219]
  v_mfma_f32_16x16x16_bf16 v[220:223], v[130:131], v[170:171], v[220:223]
  v_mfma_f32_16x16x16_bf16 v[224:227], v[132:133], v[168:169], v[224:227]
  v_mfma_f32_16x16x16_bf16 v[228:231], v[132:133], v[170:171], v[228:231]
  v_mfma_f32_16x16x16_bf16 v[232:235], v[134:135], v[168:169], v[232:235]
  v_mfma_f32_16x16x16_bf16 v[236:239], v[134:135], v[170:171], v[236:239]
  buffer_load_dwordx4 v[16:19], v2, s[4:7], s94 offen offset:0 sc1
  buffer_load_dwordx4 v[20:23], v2, s[4:7], s94 offen offset:1024 sc1
  buffer_load_dwordx4 v[24:27], v2, s[4:7], s94 offen offset:2048 sc1
  buffer_load_dwordx4 v[28:31], v2, s[4:7], s94 offen offset:3072 sc1
  buffer_load_dwordx4 v[32:35], v3, s[4:7], s94 offen offset:0 sc1
  buffer_load_dwordx4 v[36:39], v3, s[4:7], s94 offen offset:1024 sc1
  buffer_load_dwordx4 v[40:43], v3, s[4:7], s94 offen offset:2048 sc1
  buffer_load_dwordx4 v[44:47], v3, s[4:7], s94 offen offset:3072 sc1
  buffer_load_dwordx4 v[48:51], v2, s[4:7], s92 offen offset:0 sc1
  buffer_load_dwordx4 v[52:55], v2, s[4:7], s92 offen offset:1024 sc1
  buffer_load_dwordx4 v[56:59], v2, s[4:7], s92 offen offset:2048 sc1
  buffer_load_dwordx4 v[60:63], v2, s[4:7], s92 offen offset:3072 sc1
  buffer_load_dwordx4 v[64:67], v3, s[4:7], s92 offen offset:0 sc1
  buffer_load_dwordx4 v[68:71], v3, s[4:7], s92 offen offset:1024 sc1
  buffer_load_dwordx4 v[72:75], v3, s[4:7], s92 offen offset:2048 sc1
  buffer_load_dwordx4 v[76:79], v3, s[4:7], s92 offen offset:3072 sc1
  buffer_load_dwordx4 v[80:83], v8, s[4:7], s93 offen offset:0 sc1
  buffer_load_dwordx4 v[84:87], v8, s[4:7], s93 offen offset:128 sc1
  buffer_load_dwordx4 v[88:91], v8, s[4:7], s93 offen offset:1024 sc1
  buffer_load_dwordx4 v[92:95], v8, s[4:7], s93 offen offset:1152 sc1
  buffer_load_dwordx4 v[96:99], v9, s[4:7], s93 offen offset:0 sc1
  buffer_load_dwordx4 v[100:103], v9, s[4:7], s93 offen offset:128 sc1
  buffer_load_dwordx4 v[104:107], v9, s[4:7], s93 offen offset:1024 sc1
  buffer_load_dwordx4 v[108:111], v9, s[4:7], s93 offen offset:1152 sc1
  buffer_load_dwordx4 v[112:115], v4, s[4:7], s91 offen offset:0 sc1
  buffer_load_dwordx4 v[116:119], v4, s[4:7], s91 offen offset:512 sc1
  buffer_load_dwordx4 v[120:123], v4, s[4:7], s91 offen offset:1024 sc1
  buffer_load_dwordx4 v[124:127], v4, s[4:7], s91 offen offset:1536 sc1
  buffer_load_dwordx4 v[128:131], v5, s[4:7], s91 offen offset:0 sc1
  buffer_load_dwordx4 v[132:135], v5, s[4:7], s91 offen offset:1024 sc1
  s_add_u32 s92, s92, 262144
  s_add_u32 s93, s93, 262144
  s_add_u32 s94, s94, 262144
  s_add_u32 s91, s91, 65536
  v_cvt_pk_bf16_f32 v136, v176, v177
  v_cvt_pk_bf16_f32 v137, v178, v179
  v_cvt_pk_bf16_f32 v138, v184, v185
  v_cvt_pk_bf16_f32 v139, v186, v187
  buffer_store_dwordx4 v[136:139], v10, s[4:7], s95 offen offset:0 sc1
  v_cvt_pk_bf16_f32 v140, v180, v181
  v_cvt_pk_bf16_f32 v141, v182, v183
  v_cvt_pk_bf16_f32 v142, v188, v189
  v_cvt_pk_bf16_f32 v143, v190, v191
  buffer_store_dwordx4 v[140:143], v10, s[4:7], s95 offen offset:512 sc1
  v_cvt_pk_bf16_f32 v144, v192, v193
  v_cvt_pk_bf16_f32 v145, v194, v195
  v_cvt_pk_bf16_f32 v146, v200, v201
  v_cvt_pk_bf16_f32 v147, v202, v203
  buffer_store_dwordx4 v[144:147], v10, s[4:7], s95 offen offset:2048 sc1
  v_cvt_pk_bf16_f32 v148, v196, v197
  v_cvt_pk_bf16_f32 v149, v198, v199
  v_cvt_pk_bf16_f32 v150, v204, v205
  v_cvt_pk_bf16_f32 v151, v206, v207
  buffer_store_dwordx4 v[148:151], v10, s[4:7], s95 offen offset:2560 sc1
  v_cvt_pk_bf16_f32 v136, v208, v209
  v_cvt_pk_bf16_f32 v137, v210, v211
  v_cvt_pk_bf16_f32 v138, v216, v217
  v_cvt_pk_bf16_f32 v139, v218, v219
  buffer_store_dwordx4 v[136:139], v11, s[4:7], s95 offen offset:0 sc1
  v_cvt_pk_bf16_f32 v140, v212, v213
  v_cvt_pk_bf16_f32 v141, v214, v215
  v_cvt_pk_bf16_f32 v142, v220, v221
  v_cvt_pk_bf16_f32 v143, v222, v223
  buffer_store_dwordx4 v[140:143], v11, s[4:7], s95 offen offset:512 sc1
  v_cvt_pk_bf16_f32 v144, v224, v225
  v_cvt_pk_bf16_f32 v145, v226, v227
  v_cvt_pk_bf16_f32 v146, v232, v233
  v_cvt_pk_bf16_f32 v147, v234, v235
  buffer_store_dwordx4 v[144:147], v11, s[4:7], s95 offen offset:2048 sc1
  v_cvt_pk_bf16_f32 v148, v228, v229
  v_cvt_pk_bf16_f32 v149, v230, v231
  v_cvt_pk_bf16_f32 v150, v236, v237
  v_cvt_pk_bf16_f32 v151, v238, v239
  buffer_store_dwordx4 v[148:151], v11, s[4:7], s95 offen offset:2560 sc1
  s_add_u32 s95, s95, 262144
  s_waitcnt vmcnt(38)
  v_mfma_f32_16x16x32_bf16 v[136:139], a[96:99], a[0:3], 0
  v_mfma_f32_16x16x32_bf16 v[140:143], a[32:35], a[0:3], 0
  v_mfma_f32_16x16x32_bf16 v[144:147], a[96:99], a[16:19], 0
  v_mfma_f32_16x16x32_bf16 v[148:151], a[32:35], a[16:19], 0
  v_mfma_f32_16x16x32_bf16 v[152:155], a[48:51], a[16:19], 0
  v_mfma_f32_16x16x32_bf16 v[136:139], a[100:103], a[4:7], v[136:139]
  v_mfma_f32_16x16x32_bf16 v[140:143], a[36:39], a[4:7], v[140:143]
  v_mfma_f32_16x16x32_bf16 v[144:147], a[100:103], a[20:23], v[144:147]
  v_mfma_f32_16x16x32_bf16 v[148:151], a[36:39], a[20:23], v[148:151]
  v_mfma_f32_16x16x32_bf16 v[152:155], a[52:55], a[20:23], v[152:155]
  v_mfma_f32_16x16x32_bf16 v[136:139], a[104:107], a[8:11], v[136:139]
  v_mfma_f32_16x16x32_bf16 v[140:143], a[40:43], a[8:11], v[140:143]
  v_mfma_f32_16x16x32_bf16 v[144:147], a[104:107], a[24:27], v[144:147]
  v_mfma_f32_16x16x32_bf16 v[148:151], a[40:43], a[24:27], v[148:151]
  v_mfma_f32_16x16x32_bf16 v[152:155], a[56:59], a[24:27], v[152:155]
  v_mfma_f32_16x16x32_bf16 v[136:139], a[108:111], a[12:15], v[136:139]
  v_mfma_f32_16x16x32_bf16 v[140:143], a[44:47], a[12:15], v[140:143]
  v_mfma_f32_16x16x32_bf16 v[144:147], a[108:111], a[28:31], v[144:147]
  v_mfma_f32_16x16x32_bf16 v[148:151], a[44:47], a[28:31], v[148:151]
  v_mfma_f32_16x16x32_bf16 v[152:155], a[60:63], a[28:31], v[152:155]
  s_nop 4
  v_cndmask_b32 v140, v6, v140, s[40:41]
  v_cndmask_b32 v141, v6, v141, s[42:43]
  v_cndmask_b32 v142, v6, v142, s[44:45]
  v_cndmask_b32 v143, v6, v143, s[46:47]
  v_max3_f32 v12, v136, v137, v140
  v_max3_f32 v12, v12, v141, v142
  v_max_f32 v12, v12, v143
  v_mov_b32 v13, v12
  s_nop 1
  v_permlane32_swap_b32 v12, v13
  v_max_f32 v12, v12, v13
  v_mov_b32 v13, v12
  s_nop 1
  v_permlane16_swap_b32 v12, v13
  v_max_f32 v12, v12, v13
  v_mul_f32 v12, s50, v12
  v_fma_f32 v136, v136, s50, -v12
  v_fma_f32 v137, v137, s50, -v12
  v_fma_f32 v140, v140, s50, -v12
  v_fma_f32 v141, v141, s50, -v12
  v_fma_f32 v142, v142, s50, -v12
  v_fma_f32 v143, v143, s50, -v12
  v_exp_f32 v136, v136
  v_exp_f32 v137, v137
  v_exp_f32 v140, v140
  v_exp_f32 v141, v141
  v_exp_f32 v142, v142
  v_exp_f32 v143, v143
  v_add_f32 v12, v136, v137
  v_add_f32 v12, v12, v140
  v_add_f32 v12, v12, v141
  v_add_f32 v12, v12, v142
  v_add_f32 v12, v12, v143
  v_mov_b32 v13, v12
  s_nop 1
  v_permlane32_swap_b32 v12, v13
  v_add_f32 v12, v12, v13
  v_mov_b32 v13, v12
  s_nop 1
  v_permlane16_swap_b32 v12, v13
  v_add_f32 v12, v12, v13
  v_rcp_f32 v12, v12
  s_nop 0
  v_mul_f32 v136, v136, v12
  v_mul_f32 v137, v137, v12
  v_mul_f32 v140, v140, v12
  v_mul_f32 v141, v141, v12
  v_mul_f32 v142, v142, v12
  v_mul_f32 v143, v143, v12
  v_cvt_pk_bf16_f32 v160, v136, v137
  v_mov_b32 v161, 0
  v_mov_b32 v162, 0
  v_mov_b32 v163, v160
  v_cvt_pk_bf16_f32 v156, v140, v141
  v_cvt_pk_bf16_f32 v157, v142, v143
  v_mov_b32 v158, 0
  v_mov_b32 v159, 0
  v_cndmask_b32 v152, v6, v152, s[40:41]
  v_cndmask_b32 v153, v6, v153, s[42:43]
  v_cndmask_b32 v154, v6, v154, s[44:45]
  v_cndmask_b32 v155, v6, v155, s[46:47]
  v_max3_f32 v12, v144, v145, v148
  v_max3_f32 v12, v12, v149, v150
  v_max3_f32 v12, v12, v151, v152
  v_max3_f32 v12, v12, v153, v154
  v_max_f32 v12, v12, v155
  v_mov_b32 v13, v12
  s_nop 1
  v_permlane32_swap_b32 v12, v13
  v_max_f32 v12, v12, v13
  v_mov_b32 v13, v12
  s_nop 1
  v_permlane16_swap_b32 v12, v13
  v_max_f32 v12, v12, v13
  v_mul_f32 v12, s50, v12
  v_fma_f32 v144, v144, s50, -v12
  v_fma_f32 v145, v145, s50, -v12
  v_fma_f32 v148, v148, s50, -v12
  v_fma_f32 v149, v149, s50, -v12
  v_fma_f32 v150, v150, s50, -v12
  v_fma_f32 v151, v151, s50, -v12
  v_fma_f32 v152, v152, s50, -v12
  v_fma_f32 v153, v153, s50, -v12
  v_fma_f32 v154, v154, s50, -v12
  v_fma_f32 v155, v155, s50, -v12
  v_exp_f32 v144, v144
  v_exp_f32 v145, v145
  v_exp_f32 v148, v148
  v_exp_f32 v149, v149
  v_exp_f32 v150, v150
  v_exp_f32 v151, v151
  v_exp_f32 v152, v152
  v_exp_f32 v153, v153
  v_exp_f32 v154, v154
  v_exp_f32 v155, v155
  v_add_f32 v12, v144, v145
  v_add_f32 v12, v12, v148
  v_add_f32 v12, v12, v149
  v_add_f32 v12, v12, v150
  v_add_f32 v12, v12, v151
  v_add_f32 v12, v12, v152
  v_add_f32 v12, v12, v153
  v_add_f32 v12, v12, v154
  v_add_f32 v12, v12, v155
  v_mov_b32 v13, v12
  s_nop 1
  v_permlane32_swap_b32 v12, v13
  v_add_f32 v12, v12, v13
  v_mov_b32 v13, v12
  s_nop 1
  v_permlane16_swap_b32 v12, v13
  v_add_f32 v12, v12, v13
  v_rcp_f32 v12, v12
  s_nop 0
  v_mul_f32 v144, v144, v12
  v_mul_f32 v145, v145, v12
  v_mul_f32 v148, v148, v12
  v_mul_f32 v149, v149, v12
  v_mul_f32 v150, v150, v12
  v_mul_f32 v151, v151, v12
  v_mul_f32 v152, v152, v12
  v_mul_f32 v153, v153, v12
  v_mul_f32 v154, v154, v12
  v_mul_f32 v155, v155, v12
  v_cvt_pk_bf16_f32 v168, v144, v145
  v_mov_b32 v169, 0
  v_mov_b32 v170, 0
  v_mov_b32 v171, v168
  v_cvt_pk_bf16_f32 v164, v148, v149
  v_cvt_pk_bf16_f32 v165, v150, v151
  v_cvt_pk_bf16_f32 v166, v152, v153
  v_cvt_pk_bf16_f32 v167, v154, v155
  v_mfma_f32_16x16x32_bf16 v[176:179], a[64:67], v[156:159], 0
  v_mfma_f32_16x16x32_bf16 v[180:183], a[68:71], v[156:159], 0
  v_mfma_f32_16x16x32_bf16 v[184:187], a[72:75], v[156:159], 0
  v_mfma_f32_16x16x32_bf16 v[188:191], a[76:79], v[156:159], 0
  v_mfma_f32_16x16x32_bf16 v[192:195], a[80:83], v[156:159], 0
  v_mfma_f32_16x16x32_bf16 v[196:199], a[84:87], v[156:159], 0
  v_mfma_f32_16x16x32_bf16 v[200:203], a[88:91], v[156:159], 0
  v_mfma_f32_16x16x32_bf16 v[204:207], a[92:95], v[156:159], 0
  v_mfma_f32_16x16x16_bf16 v[176:179], a[112:113], v[160:161], v[176:179]
  v_mfma_f32_16x16x16_bf16 v[180:183], a[112:113], v[162:163], v[180:183]
  v_mfma_f32_16x16x16_bf16 v[184:187], a[114:115], v[160:161], v[184:187]
  v_mfma_f32_16x16x16_bf16 v[188:191], a[114:115], v[162:163], v[188:191]
  v_mfma_f32_16x16x16_bf16 v[192:195], a[116:117], v[160:161], v[192:195]
  v_mfma_f32_16x16x16_bf16 v[196:199], a[116:117], v[162:163], v[196:199]
  v_mfma_f32_16x16x16_bf16 v[200:203], a[118:119], v[160:161], v[200:203]
  v_mfma_f32_16x16x16_bf16 v[204:207], a[118:119], v[162:163], v[204:207]
  v_mfma_f32_16x16x32_bf16 v[208:211], a[64:67], v[164:167], 0
  v_mfma_f32_16x16x32_bf16 v[212:215], a[68:71], v[164:167], 0
  v_mfma_f32_16x16x32_bf16 v[216:219], a[72:75], v[164:167], 0
  v_mfma_f32_16x16x32_bf16 v[220:223], a[76:79], v[164:167], 0
  v_mfma_f32_16x16x32_bf16 v[224:227], a[80:83], v[164:167], 0
  v_mfma_f32_16x16x32_bf16 v[228:231], a[84:87], v[164:167], 0
  v_mfma_f32_16x16x32_bf16 v[232:235], a[88:91], v[164:167], 0
  v_mfma_f32_16x16x32_bf16 v[236:239], a[92:95], v[164:167], 0
  v_mfma_f32_16x16x16_bf16 v[208:211], a[112:113], v[168:169], v[208:211]
  v_mfma_f32_16x16x16_bf16 v[212:215], a[112:113], v[170:171], v[212:215]
  v_mfma_f32_16x16x16_bf16 v[216:219], a[114:115], v[168:169], v[216:219]
  v_mfma_f32_16x16x16_bf16 v[220:223], a[114:115], v[170:171], v[220:223]
  v_mfma_f32_16x16x16_bf16 v[224:227], a[116:117], v[168:169], v[224:227]
  v_mfma_f32_16x16x16_bf16 v[228:231], a[116:117], v[170:171], v[228:231]
  v_mfma_f32_16x16x16_bf16 v[232:235], a[118:119], v[168:169], v[232:235]
  v_mfma_f32_16x16x16_bf16 v[236:239], a[118:119], v[170:171], v[236:239]
  buffer_load_dwordx4 a[0:3], v2, s[4:7], s94 offen offset:0 sc1
  buffer_load_dwordx4 a[4:7], v2, s[4:7], s94 offen offset:1024 sc1
  buffer_load_dwordx4 a[8:11], v2, s[4:7], s94 offen offset:2048 sc1
  buffer_load_dwordx4 a[12:15], v2, s[4:7], s94 offen offset:3072 sc1
  buffer_load_dwordx4 a[16:19], v3, s[4:7], s94 offen offset:0 sc1
  buffer_load_dwordx4 a[20:23], v3, s[4:7], s94 offen offset:1024 sc1
  buffer_load_dwordx4 a[24:27], v3, s[4:7], s94 offen offset:2048 sc1
  buffer_load_dwordx4 a[28:31], v3, s[4:7], s94 offen offset:3072 sc1
  buffer_load_dwordx4 a[32:35], v2, s[4:7], s92 offen offset:0 sc1
  buffer_load_dwordx4 a[36:39], v2, s[4:7], s92 offen offset:1024 sc1
  buffer_load_dwordx4 a[40:43], v2, s[4:7], s92 offen offset:2048 sc1
  buffer_load_dwordx4 a[44:47], v2, s[4:7], s92 offen offset:3072 sc1
  buffer_load_dwordx4 a[48:51], v3, s[4:7], s92 offen offset:0 sc1
  buffer_load_dwordx4 a[52:55], v3, s[4:7], s92 offen offset:1024 sc1
  buffer_load_dwordx4 a[56:59], v3, s[4:7], s92 offen offset:2048 sc1
  buffer_load_dwordx4 a[60:63], v3, s[4:7], s92 offen offset:3072 sc1
  buffer_load_dwordx4 a[64:67], v8, s[4:7], s93 offen offset:0 sc1
  buffer_load_dwordx4 a[68:71], v8, s[4:7], s93 offen offset:128 sc1
  buffer_load_dwordx4 a[72:75], v8, s[4:7], s93 offen offset:1024 sc1
  buffer_load_dwordx4 a[76:79], v8, s[4:7], s93 offen offset:1152 sc1
  buffer_load_dwordx4 a[80:83], v9, s[4:7], s93 offen offset:0 sc1
  buffer_load_dwordx4 a[84:87], v9, s[4:7], s93 offen offset:128 sc1
  buffer_load_dwordx4 a[88:91], v9, s[4:7], s93 offen offset:1024 sc1
  buffer_load_dwordx4 a[92:95], v9, s[4:7], s93 offen offset:1152 sc1
  buffer_load_dwordx4 a[96:99], v4, s[4:7], s91 offen offset:0 sc1
  buffer_load_dwordx4 a[100:103], v4, s[4:7], s91 offen offset:512 sc1
  buffer_load_dwordx4 a[104:107], v4, s[4:7], s91 offen offset:1024 sc1
  buffer_load_dwordx4 a[108:111], v4, s[4:7], s91 offen offset:1536 sc1
  buffer_load_dwordx4 a[112:115], v5, s[4:7], s91 offen offset:0 sc1
  buffer_load_dwordx4 a[116:119], v5, s[4:7], s91 offen offset:1024 sc1
  s_add_u32 s92, s92, 262144
  s_add_u32 s93, s93, 262144
  s_add_u32 s94, s94, 262144
  s_add_u32 s91, s91, 65536
  v_cvt_pk_bf16_f32 v136, v176, v177
  v_cvt_pk_bf16_f32 v137, v178, v179
  v_cvt_pk_bf16_f32 v138, v184, v185
  v_cvt_pk_bf16_f32 v139, v186, v187
  buffer_store_dwordx4 v[136:139], v10, s[4:7], s95 offen offset:0 sc1
  v_cvt_pk_bf16_f32 v140, v180, v181
  v_cvt_pk_bf16_f32 v141, v182, v183
  v_cvt_pk_bf16_f32 v142, v188, v189
  v_cvt_pk_bf16_f32 v143, v190, v191
  buffer_store_dwordx4 v[140:143], v10, s[4:7], s95 offen offset:512 sc1
  v_cvt_pk_bf16_f32 v144, v192, v193
  v_cvt_pk_bf16_f32 v145, v194, v195
  v_cvt_pk_bf16_f32 v146, v200, v201
  v_cvt_pk_bf16_f32 v147, v202, v203
  buffer_store_dwordx4 v[144:147], v10, s[4:7], s95 offen offset:2048 sc1
  v_cvt_pk_bf16_f32 v148, v196, v197
  v_cvt_pk_bf16_f32 v149, v198, v199
  v_cvt_pk_bf16_f32 v150, v204, v205
  v_cvt_pk_bf16_f32 v151, v206, v207
  buffer_store_dwordx4 v[148:151], v10, s[4:7], s95 offen offset:2560 sc1
  v_cvt_pk_bf16_f32 v136, v208, v209
  v_cvt_pk_bf16_f32 v137, v210, v211
  v_cvt_pk_bf16_f32 v138, v216, v217
  v_cvt_pk_bf16_f32 v139, v218, v219
  buffer_store_dwordx4 v[136:139], v11, s[4:7], s95 offen offset:0 sc1
  v_cvt_pk_bf16_f32 v140, v212, v213
  v_cvt_pk_bf16_f32 v141, v214, v215
  v_cvt_pk_bf16_f32 v142, v220, v221
  v_cvt_pk_bf16_f32 v143, v222, v223
  buffer_store_dwordx4 v[140:143], v11, s[4:7], s95 offen offset:512 sc1
  v_cvt_pk_bf16_f32 v144, v224, v225
  v_cvt_pk_bf16_f32 v145, v226, v227
  v_cvt_pk_bf16_f32 v146, v232, v233
  v_cvt_pk_bf16_f32 v147, v234, v235
  buffer_store_dwordx4 v[144:147], v11, s[4:7], s95 offen offset:2048 sc1
  v_cvt_pk_bf16_f32 v148, v228, v229
  v_cvt_pk_bf16_f32 v149, v230, v231
  v_cvt_pk_bf16_f32 v150, v236, v237
  v_cvt_pk_bf16_f32 v151, v238, v239
  buffer_store_dwordx4 v[148:151], v11, s[4:7], s95 offen offset:2560 sc1
  s_add_u32 s95, s95, 262144
  s_waitcnt vmcnt(46)
  v_mfma_f32_16x16x32_bf16 v[136:139], v[112:115], v[16:19], 0
  v_mfma_f32_16x16x32_bf16 v[140:143], v[48:51], v[16:19], 0
  v_mfma_f32_16x16x32_bf16 v[144:147], v[112:115], v[32:35], 0
  v_mfma_f32_16x16x32_bf16 v[148:151], v[48:51], v[32:35], 0
  v_mfma_f32_16x16x32_bf16 v[152:155], v[64:67], v[32:35], 0
  v_mfma_f32_16x16x32_bf16 v[136:139], v[116:119], v[20:23], v[136:139]
  v_mfma_f32_16x16x32_bf16 v[140:143], v[52:55], v[20:23], v[140:143]
  v_mfma_f32_16x16x32_bf16 v[144:147], v[116:119], v[36:39], v[144:147]
  v_mfma_f32_16x16x32_bf16 v[148:151], v[52:55], v[36:39], v[148:151]
  v_mfma_f32_16x16x32_bf16 v[152:155], v[68:71], v[36:39], v[152:155]
  v_mfma_f32_16x16x32_bf16 v[136:139], v[120:123], v[24:27], v[136:139]
  v_mfma_f32_16x16x32_bf16 v[140:143], v[56:59], v[24:27], v[140:143]
  v_mfma_f32_16x16x32_bf16 v[144:147], v[120:123], v[40:43], v[144:147]
  v_mfma_f32_16x16x32_bf16 v[148:151], v[56:59], v[40:43], v[148:151]
  v_mfma_f32_16x16x32_bf16 v[152:155], v[72:75], v[40:43], v[152:155]
  v_mfma_f32_16x16x32_bf16 v[136:139], v[124:127], v[28:31], v[136:139]
  v_mfma_f32_16x16x32_bf16 v[140:143], v[60:63], v[28:31], v[140:143]
  v_mfma_f32_16x16x32_bf16 v[144:147], v[124:127], v[44:47], v[144:147]
  v_mfma_f32_16x16x32_bf16 v[148:151], v[60:63], v[44:47], v[148:151]
  v_mfma_f32_16x16x32_bf16 v[152:155], v[76:79], v[44:47], v[152:155]
  s_nop 4
  v_cndmask_b32 v140, v6, v140, s[40:41]
  v_cndmask_b32 v141, v6, v141, s[42:43]
  v_cndmask_b32 v142, v6, v142, s[44:45]
  v_cndmask_b32 v143, v6, v143, s[46:47]
  v_max3_f32 v12, v136, v137, v140
  v_max3_f32 v12, v12, v141, v142
  v_max_f32 v12, v12, v143
  v_mov_b32 v13, v12
  s_nop 1
  v_permlane32_swap_b32 v12, v13
  v_max_f32 v12, v12, v13
  v_mov_b32 v13, v12
  s_nop 1
  v_permlane16_swap_b32 v12, v13
  v_max_f32 v12, v12, v13
  v_mul_f32 v12, s50, v12
  v_fma_f32 v136, v136, s50, -v12
  v_fma_f32 v137, v137, s50, -v12
  v_fma_f32 v140, v140, s50, -v12
  v_fma_f32 v141, v141, s50, -v12
  v_fma_f32 v142, v142, s50, -v12
  v_fma_f32 v143, v143, s50, -v12
  v_exp_f32 v136, v136
  v_exp_f32 v137, v137
  v_exp_f32 v140, v140
  v_exp_f32 v141, v141
  v_exp_f32 v142, v142
  v_exp_f32 v143, v143
  v_add_f32 v12, v136, v137
  v_add_f32 v12, v12, v140
  v_add_f32 v12, v12, v141
  v_add_f32 v12, v12, v142
  v_add_f32 v12, v12, v143
  v_mov_b32 v13, v12
  s_nop 1
  v_permlane32_swap_b32 v12, v13
  v_add_f32 v12, v12, v13
  v_mov_b32 v13, v12
  s_nop 1
  v_permlane16_swap_b32 v12, v13
  v_add_f32 v12, v12, v13
  v_rcp_f32 v12, v12
  s_nop 0
  v_mul_f32 v136, v136, v12
  v_mul_f32 v137, v137, v12
  v_mul_f32 v140, v140, v12
  v_mul_f32 v141, v141, v12
  v_mul_f32 v142, v142, v12
  v_mul_f32 v143, v143, v12
  v_cvt_pk_bf16_f32 v160, v136, v137
  v_mov_b32 v161, 0
  v_mov_b32 v162, 0
  v_mov_b32 v163, v160
  v_cvt_pk_bf16_f32 v156, v140, v141
  v_cvt_pk_bf16_f32 v157, v142, v143
  v_mov_b32 v158, 0
  v_mov_b32 v159, 0
  v_cndmask_b32 v152, v6, v152, s[40:41]
  v_cndmask_b32 v153, v6, v153, s[42:43]
  v_cndmask_b32 v154, v6, v154, s[44:45]
  v_cndmask_b32 v155, v6, v155, s[46:47]
  v_max3_f32 v12, v144, v145, v148
  v_max3_f32 v12, v12, v149, v150
  v_max3_f32 v12, v12, v151, v152
  v_max3_f32 v12, v12, v153, v154
  v_max_f32 v12, v12, v155
  v_mov_b32 v13, v12
  s_nop 1
  v_permlane32_swap_b32 v12, v13
  v_max_f32 v12, v12, v13
  v_mov_b32 v13, v12
  s_nop 1
  v_permlane16_swap_b32 v12, v13
  v_max_f32 v12, v12, v13
  v_mul_f32 v12, s50, v12
  v_fma_f32 v144, v144, s50, -v12
  v_fma_f32 v145, v145, s50, -v12
  v_fma_f32 v148, v148, s50, -v12
  v_fma_f32 v149, v149, s50, -v12
  v_fma_f32 v150, v150, s50, -v12
  v_fma_f32 v151, v151, s50, -v12
  v_fma_f32 v152, v152, s50, -v12
  v_fma_f32 v153, v153, s50, -v12
  v_fma_f32 v154, v154, s50, -v12
  v_fma_f32 v155, v155, s50, -v12
  v_exp_f32 v144, v144
  v_exp_f32 v145, v145
  v_exp_f32 v148, v148
  v_exp_f32 v149, v149
  v_exp_f32 v150, v150
  v_exp_f32 v151, v151
  v_exp_f32 v152, v152
  v_exp_f32 v153, v153
  v_exp_f32 v154, v154
  v_exp_f32 v155, v155
  v_add_f32 v12, v144, v145
  v_add_f32 v12, v12, v148
  v_add_f32 v12, v12, v149
  v_add_f32 v12, v12, v150
  v_add_f32 v12, v12, v151
  v_add_f32 v12, v12, v152
  v_add_f32 v12, v12, v153
  v_add_f32 v12, v12, v154
  v_add_f32 v12, v12, v155
  v_mov_b32 v13, v12
  s_nop 1
  v_permlane32_swap_b32 v12, v13
  v_add_f32 v12, v12, v13
  v_mov_b32 v13, v12
  s_nop 1
  v_permlane16_swap_b32 v12, v13
  v_add_f32 v12, v12, v13
  v_rcp_f32 v12, v12
  s_nop 0
  v_mul_f32 v144, v144, v12
  v_mul_f32 v145, v145, v12
  v_mul_f32 v148, v148, v12
  v_mul_f32 v149, v149, v12
  v_mul_f32 v150, v150, v12
  v_mul_f32 v151, v151, v12
  v_mul_f32 v152, v152, v12
  v_mul_f32 v153, v153, v12
  v_mul_f32 v154, v154, v12
  v_mul_f32 v155, v155, v12
  v_cvt_pk_bf16_f32 v168, v144, v145
  v_mov_b32 v169, 0
  v_mov_b32 v170, 0
  v_mov_b32 v171, v168
  v_cvt_pk_bf16_f32 v164, v148, v149
  v_cvt_pk_bf16_f32 v165, v150, v151
  v_cvt_pk_bf16_f32 v166, v152, v153
  v_cvt_pk_bf16_f32 v167, v154, v155
  v_mfma_f32_16x16x32_bf16 v[176:179], v[80:83], v[156:159], 0
  v_mfma_f32_16x16x32_bf16 v[180:183], v[84:87], v[156:159], 0
  v_mfma_f32_16x16x32_bf16 v[184:187], v[88:91], v[156:159], 0
  v_mfma_f32_16x16x32_bf16 v[188:191], v[92:95], v[156:159], 0
  v_mfma_f32_16x16x32_bf16 v[192:195], v[96:99], v[156:159], 0
  v_mfma_f32_16x16x32_bf16 v[196:199], v[100:103], v[156:159], 0
  v_mfma_f32_16x16x32_bf16 v[200:203], v[104:107], v[156:159], 0
  v_mfma_f32_16x16x32_bf16 v[204:207], v[108:111], v[156:159], 0
  v_mfma_f32_16x16x16_bf16 v[176:179], v[128:129], v[160:161], v[176:179]
  v_mfma_f32_16x16x16_bf16 v[180:183], v[128:129], v[162:163], v[180:183]
  v_mfma_f32_16x16x16_bf16 v[184:187], v[130:131], v[160:161], v[184:187]
  v_mfma_f32_16x16x16_bf16 v[188:191], v[130:131], v[162:163], v[188:191]
  v_mfma_f32_16x16x16_bf16 v[192:195], v[132:133], v[160:161], v[192:195]
  v_mfma_f32_16x16x16_bf16 v[196:199], v[132:133], v[162:163], v[196:199]
  v_mfma_f32_16x16x16_bf16 v[200:203], v[134:135], v[160:161], v[200:203]
  v_mfma_f32_16x16x16_bf16 v[204:207], v[134:135], v[162:163], v[204:207]
  v_mfma_f32_16x16x32_bf16 v[208:211], v[80:83], v[164:167], 0
  v_mfma_f32_16x16x32_bf16 v[212:215], v[84:87], v[164:167], 0
  v_mfma_f32_16x16x32_bf16 v[216:219], v[88:91], v[164:167], 0
  v_mfma_f32_16x16x32_bf16 v[220:223], v[92:95], v[164:167], 0
  v_mfma_f32_16x16x32_bf16 v[224:227], v[96:99], v[164:167], 0
  v_mfma_f32_16x16x32_bf16 v[228:231], v[100:103], v[164:167], 0
  v_mfma_f32_16x16x32_bf16 v[232:235], v[104:107], v[164:167], 0
  v_mfma_f32_16x16x32_bf16 v[236:239], v[108:111], v[164:167], 0
  v_mfma_f32_16x16x16_bf16 v[208:211], v[128:129], v[168:169], v[208:211]
  v_mfma_f32_16x16x16_bf16 v[212:215], v[128:129], v[170:171], v[212:215]
  v_mfma_f32_16x16x16_bf16 v[216:219], v[130:131], v[168:169], v[216:219]
  v_mfma_f32_16x16x16_bf16 v[220:223], v[130:131], v[170:171], v[220:223]
  v_mfma_f32_16x16x16_bf16 v[224:227], v[132:133], v[168:169], v[224:227]
  v_mfma_f32_16x16x16_bf16 v[228:231], v[132:133], v[170:171], v[228:231]
  v_mfma_f32_16x16x16_bf16 v[232:235], v[134:135], v[168:169], v[232:235]
  v_mfma_f32_16x16x16_bf16 v[236:239], v[134:135], v[170:171], v[236:239]
  v_cvt_pk_bf16_f32 v136, v176, v177
  v_cvt_pk_bf16_f32 v137, v178, v179
  v_cvt_pk_bf16_f32 v138, v184, v185
  v_cvt_pk_bf16_f32 v139, v186, v187
  buffer_store_dwordx4 v[136:139], v10, s[4:7], s95 offen offset:0 sc1
  v_cvt_pk_bf16_f32 v140, v180, v181
  v_cvt_pk_bf16_f32 v141, v182, v183
  v_cvt_pk_bf16_f32 v142, v188, v189
  v_cvt_pk_bf16_f32 v143, v190, v191
  buffer_store_dwordx4 v[140:143], v10, s[4:7], s95 offen offset:512 sc1
  v_cvt_pk_bf16_f32 v144, v192, v193
  v_cvt_pk_bf16_f32 v145, v194, v195
  v_cvt_pk_bf16_f32 v146, v200, v201
  v_cvt_pk_bf16_f32 v147, v202, v203
  buffer_store_dwordx4 v[144:147], v10, s[4:7], s95 offen offset:2048 sc1
  v_cvt_pk_bf16_f32 v148, v196, v197
  v_cvt_pk_bf16_f32 v149, v198, v199
  v_cvt_pk_bf16_f32 v150, v204, v205
  v_cvt_pk_bf16_f32 v151, v206, v207
  buffer_store_dwordx4 v[148:151], v10, s[4:7], s95 offen offset:2560 sc1
  v_cvt_pk_bf16_f32 v136, v208, v209
  v_cvt_pk_bf16_f32 v137, v210, v211
  v_cvt_pk_bf16_f32 v138, v216, v217
  v_cvt_pk_bf16_f32 v139, v218, v219
  buffer_store_dwordx4 v[136:139], v11, s[4:7], s95 offen offset:0 sc1
  v_cvt_pk_bf16_f32 v140, v212, v213
  v_cvt_pk_bf16_f32 v141, v214, v215
  v_cvt_pk_bf16_f32 v142, v220, v221
  v_cvt_pk_bf16_f32 v143, v222, v223
  buffer_store_dwordx4 v[140:143], v11, s[4:7], s95 offen offset:512 sc1
  v_cvt_pk_bf16_f32 v144, v224, v225
  v_cvt_pk_bf16_f32 v145, v226, v227
  v_cvt_pk_bf16_f32 v146, v232, v233
  v_cvt_pk_bf16_f32 v147, v234, v235
  buffer_store_dwordx4 v[144:147], v11, s[4:7], s95 offen offset:2048 sc1
  v_cvt_pk_bf16_f32 v148, v228, v229
  v_cvt_pk_bf16_f32 v149, v230, v231
  v_cvt_pk_bf16_f32 v150, v236, v237
  v_cvt_pk_bf16_f32 v151, v238, v239
  buffer_store_dwordx4 v[148:151], v11, s[4:7], s95 offen offset:2560 sc1
  s_add_u32 s95, s95, 262144
  s_waitcnt vmcnt(16)
  s_cmp_lg_u32 s32, 0
  s_cbranch_scc1 L_rq_97
  s_cmp_eq_u32 s39, 0
  s_cbranch_scc1 L_rq_97
  s_lshl_b32 s99, s33, 7
  s_add_u32 s99, s99, 0x3d00200
  v_mov_b32 v244, 1
  v_mov_b32 v245, 0
  s_mov_b64 exec, 1
  buffer_atomic_add v244, v245, s[4:7], s99 offen sc0 sc1
  s_mov_b64 exec, -1
L_rq_97:
  v_mfma_f32_16x16x32_bf16 v[136:139], a[96:99], a[0:3], 0
  v_mfma_f32_16x16x32_bf16 v[140:143], a[32:35], a[0:3], 0
  v_mfma_f32_16x16x32_bf16 v[144:147], a[96:99], a[16:19], 0
  v_mfma_f32_16x16x32_bf16 v[148:151], a[32:35], a[16:19], 0
  v_mfma_f32_16x16x32_bf16 v[152:155], a[48:51], a[16:19], 0
  v_mfma_f32_16x16x32_bf16 v[136:139], a[100:103], a[4:7], v[136:139]
  v_mfma_f32_16x16x32_bf16 v[140:143], a[36:39], a[4:7], v[140:143]
  v_mfma_f32_16x16x32_bf16 v[144:147], a[100:103], a[20:23], v[144:147]
  v_mfma_f32_16x16x32_bf16 v[148:151], a[36:39], a[20:23], v[148:151]
  v_mfma_f32_16x16x32_bf16 v[152:155], a[52:55], a[20:23], v[152:155]
  v_mfma_f32_16x16x32_bf16 v[136:139], a[104:107], a[8:11], v[136:139]
  v_mfma_f32_16x16x32_bf16 v[140:143], a[40:43], a[8:11], v[140:143]
  v_mfma_f32_16x16x32_bf16 v[144:147], a[104:107], a[24:27], v[144:147]
  v_mfma_f32_16x16x32_bf16 v[148:151], a[40:43], a[24:27], v[148:151]
  v_mfma_f32_16x16x32_bf16 v[152:155], a[56:59], a[24:27], v[152:155]
  v_mfma_f32_16x16x32_bf16 v[136:139], a[108:111], a[12:15], v[136:139]
  v_mfma_f32_16x16x32_bf16 v[140:143], a[44:47], a[12:15], v[140:143]
  v_mfma_f32_16x16x32_bf16 v[144:147], a[108:111], a[28:31], v[144:147]
  v_mfma_f32_16x16x32_bf16 v[148:151], a[44:47], a[28:31], v[148:151]
  v_mfma_f32_16x16x32_bf16 v[152:155], a[60:63], a[28:31], v[152:155]
  s_nop 4
  v_cndmask_b32 v140, v6, v140, s[40:41]
  v_cndmask_b32 v141, v6, v141, s[42:43]
  v_cndmask_b32 v142, v6, v142, s[44:45]
  v_cndmask_b32 v143, v6, v143, s[46:47]
  v_max3_f32 v12, v136, v137, v140
  v_max3_f32 v12, v12, v141, v142
  v_max_f32 v12, v12, v143
  v_mov_b32 v13, v12
  s_nop 1
  v_permlane32_swap_b32 v12, v13
  v_max_f32 v12, v12, v13
  v_mov_b32 v13, v12
  s_nop 1
  v_permlane16_swap_b32 v12, v13
  v_max_f32 v12, v12, v13
  v_mul_f32 v12, s50, v12
  v_fma_f32 v136, v136, s50, -v12
  v_fma_f32 v137, v137, s50, -v12
  v_fma_f32 v140, v140, s50, -v12
  v_fma_f32 v141, v141, s50, -v12
  v_fma_f32 v142, v142, s50, -v12
  v_fma_f32 v143, v143, s50, -v12
  v_exp_f32 v136, v136
  v_exp_f32 v137, v137
  v_exp_f32 v140, v140
  v_exp_f32 v141, v141
  v_exp_f32 v142, v142
  v_exp_f32 v143, v143
  v_add_f32 v12, v136, v137
  v_add_f32 v12, v12, v140
  v_add_f32 v12, v12, v141
  v_add_f32 v12, v12, v142
  v_add_f32 v12, v12, v143
  v_mov_b32 v13, v12
  s_nop 1
  v_permlane32_swap_b32 v12, v13
  v_add_f32 v12, v12, v13
  v_mov_b32 v13, v12
  s_nop 1
  v_permlane16_swap_b32 v12, v13
  v_add_f32 v12, v12, v13
  v_rcp_f32 v12, v12
  s_nop 0
  v_mul_f32 v136, v136, v12
  v_mul_f32 v137, v137, v12
  v_mul_f32 v140, v140, v12
  v_mul_f32 v141, v141, v12
  v_mul_f32 v142, v142, v12
  v_mul_f32 v143, v143, v12
  v_cvt_pk_bf16_f32 v160, v136, v137
  v_mov_b32 v161, 0
  v_mov_b32 v162, 0
  v_mov_b32 v163, v160
  v_cvt_pk_bf16_f32 v156, v140, v141
  v_cvt_pk_bf16_f32 v157, v142, v143
  v_mov_b32 v158, 0
  v_mov_b32 v159, 0
  v_cndmask_b32 v152, v6, v152, s[40:41]
  v_cndmask_b32 v153, v6, v153, s[42:43]
  v_cndmask_b32 v154, v6, v154, s[44:45]
  v_cndmask_b32 v155, v6, v155, s[46:47]
  v_max3_f32 v12, v144, v145, v148
  v_max3_f32 v12, v12, v149, v150
  v_max3_f32 v12, v12, v151, v152
  v_max3_f32 v12, v12, v153, v154
  v_max_f32 v12, v12, v155
  v_mov_b32 v13, v12
  s_nop 1
  v_permlane32_swap_b32 v12, v13
  v_max_f32 v12, v12, v13
  v_mov_b32 v13, v12
  s_nop 1
  v_permlane16_swap_b32 v12, v13
  v_max_f32 v12, v12, v13
  v_mul_f32 v12, s50, v12
  v_fma_f32 v144, v144, s50, -v12
  v_fma_f32 v145, v145, s50, -v12
  v_fma_f32 v148, v148, s50, -v12
  v_fma_f32 v149, v149, s50, -v12
  v_fma_f32 v150, v150, s50, -v12
  v_fma_f32 v151, v151, s50, -v12
  v_fma_f32 v152, v152, s50, -v12
  v_fma_f32 v153, v153, s50, -v12
  v_fma_f32 v154, v154, s50, -v12
  v_fma_f32 v155, v155, s50, -v12
  v_exp_f32 v144, v144
  v_exp_f32 v145, v145
  v_exp_f32 v148, v148
  v_exp_f32 v149, v149
  v_exp_f32 v150, v150
  v_exp_f32 v151, v151
  v_exp_f32 v152, v152
  v_exp_f32 v153, v153
  v_exp_f32 v154, v154
  v_exp_f32 v155, v155
  v_add_f32 v12, v144, v145
  v_add_f32 v12, v12, v148
  v_add_f32 v12, v12, v149
  v_add_f32 v12, v12, v150
  v_add_f32 v12, v12, v151
  v_add_f32 v12, v12, v152
  v_add_f32 v12, v12, v153
  v_add_f32 v12, v12, v154
  v_add_f32 v12, v12, v155
  v_mov_b32 v13, v12
  s_nop 1
  v_permlane32_swap_b32 v12, v13
  v_add_f32 v12, v12, v13
  v_mov_b32 v13, v12
  s_nop 1
  v_permlane16_swap_b32 v12, v13
  v_add_f32 v12, v12, v13
  v_rcp_f32 v12, v12
  s_nop 0
  v_mul_f32 v144, v144, v12
  v_mul_f32 v145, v145, v12
  v_mul_f32 v148, v148, v12
  v_mul_f32 v149, v149, v12
  v_mul_f32 v150, v150, v12
  v_mul_f32 v151, v151, v12
  v_mul_f32 v152, v152, v12
  v_mul_f32 v153, v153, v12
  v_mul_f32 v154, v154, v12
  v_mul_f32 v155, v155, v12
  v_cvt_pk_bf16_f32 v168, v144, v145
  v_mov_b32 v169, 0
  v_mov_b32 v170, 0
  v_mov_b32 v171, v168
  v_cvt_pk_bf16_f32 v164, v148, v149
  v_cvt_pk_bf16_f32 v165, v150, v151
  v_cvt_pk_bf16_f32 v166, v152, v153
  v_cvt_pk_bf16_f32 v167, v154, v155
  v_mfma_f32_16x16x32_bf16 v[176:179], a[64:67], v[156:159], 0
  v_mfma_f32_16x16x32_bf16 v[180:183], a[68:71], v[156:159], 0
  v_mfma_f32_16x16x32_bf16 v[184:187], a[72:75], v[156:159], 0
  v_mfma_f32_16x16x32_bf16 v[188:191], a[76:79], v[156:159], 0
  v_mfma_f32_16x16x32_bf16 v[192:195], a[80:83], v[156:159], 0
  v_mfma_f32_16x16x32_bf16 v[196:199], a[84:87], v[156:159], 0
  v_mfma_f32_16x16x32_bf16 v[200:203], a[88:91], v[156:159], 0
  v_mfma_f32_16x16x32_bf16 v[204:207], a[92:95], v[156:159], 0
  v_mfma_f32_16x16x16_bf16 v[176:179], a[112:113], v[160:161], v[176:179]
  v_mfma_f32_16x16x16_bf16 v[180:183], a[112:113], v[162:163], v[180:183]
  v_mfma_f32_16x16x16_bf16 v[184:187], a[114:115], v[160:161], v[184:187]
  v_mfma_f32_16x16x16_bf16 v[188:191], a[114:115], v[162:163], v[188:191]
  v_mfma_f32_16x16x16_bf16 v[192:195], a[116:117], v[160:161], v[192:195]
  v_mfma_f32_16x16x16_bf16 v[196:199], a[116:117], v[162:163], v[196:199]
  v_mfma_f32_16x16x16_bf16 v[200:203], a[118:119], v[160:161], v[200:203]
  v_mfma_f32_16x16x16_bf16 v[204:207], a[118:119], v[162:163], v[204:207]
  v_mfma_f32_16x16x32_bf16 v[208:211], a[64:67], v[164:167], 0
  v_mfma_f32_16x16x32_bf16 v[212:215], a[68:71], v[164:167], 0
  v_mfma_f32_16x16x32_bf16 v[216:219], a[72:75], v[164:167], 0
  v_mfma_f32_16x16x32_bf16 v[220:223], a[76:79], v[164:167], 0
  v_mfma_f32_16x16x32_bf16 v[224:227], a[80:83], v[164:167], 0
  v_mfma_f32_16x16x32_bf16 v[228:231], a[84:87], v[164:167], 0
  v_mfma_f32_16x16x32_bf16 v[232:235], a[88:91], v[164:167], 0
  v_mfma_f32_16x16x32_bf16 v[236:239], a[92:95], v[164:167], 0
  v_mfma_f32_16x16x16_bf16 v[208:211], a[112:113], v[168:169], v[208:211]
  v_mfma_f32_16x16x16_bf16 v[212:215], a[112:113], v[170:171], v[212:215]
  v_mfma_f32_16x16x16_bf16 v[216:219], a[114:115], v[168:169], v[216:219]
  v_mfma_f32_16x16x16_bf16 v[220:223], a[114:115], v[170:171], v[220:223]
  v_mfma_f32_16x16x16_bf16 v[224:227], a[116:117], v[168:169], v[224:227]
  v_mfma_f32_16x16x16_bf16 v[228:231], a[116:117], v[170:171], v[228:231]
  v_mfma_f32_16x16x16_bf16 v[232:235], a[118:119], v[168:169], v[232:235]
  v_mfma_f32_16x16x16_bf16 v[236:239], a[118:119], v[170:171], v[236:239]
  v_cvt_pk_bf16_f32 v136, v176, v177
  v_cvt_pk_bf16_f32 v137, v178, v179
  v_cvt_pk_bf16_f32 v138, v184, v185
  v_cvt_pk_bf16_f32 v139, v186, v187
  buffer_store_dwordx4 v[136:139], v10, s[4:7], s95 offen offset:0 sc1
  v_cvt_pk_bf16_f32 v140, v180, v181
  v_cvt_pk_bf16_f32 v141, v182, v183
  v_cvt_pk_bf16_f32 v142, v188, v189
  v_cvt_pk_bf16_f32 v143, v190, v191
  buffer_store_dwordx4 v[140:143], v10, s[4:7], s95 offen offset:512 sc1
  v_cvt_pk_bf16_f32 v144, v192, v193
  v_cvt_pk_bf16_f32 v145, v194, v195
  v_cvt_pk_bf16_f32 v146, v200, v201
  v_cvt_pk_bf16_f32 v147, v202, v203
  buffer_store_dwordx4 v[144:147], v10, s[4:7], s95 offen offset:2048 sc1
  v_cvt_pk_bf16_f32 v148, v196, v197
  v_cvt_pk_bf16_f32 v149, v198, v199
  v_cvt_pk_bf16_f32 v150, v204, v205
  v_cvt_pk_bf16_f32 v151, v206, v207
  buffer_store_dwordx4 v[148:151], v10, s[4:7], s95 offen offset:2560 sc1
  v_cvt_pk_bf16_f32 v136, v208, v209
  v_cvt_pk_bf16_f32 v137, v210, v211
  v_cvt_pk_bf16_f32 v138, v216, v217
  v_cvt_pk_bf16_f32 v139, v218, v219
  buffer_store_dwordx4 v[136:139], v11, s[4:7], s95 offen offset:0 sc1
  v_cvt_pk_bf16_f32 v140, v212, v213
  v_cvt_pk_bf16_f32 v141, v214, v215
  v_cvt_pk_bf16_f32 v142, v220, v221
  v_cvt_pk_bf16_f32 v143, v222, v223
  buffer_store_dwordx4 v[140:143], v11, s[4:7], s95 offen offset:512 sc1
  v_cvt_pk_bf16_f32 v144, v224, v225
  v_cvt_pk_bf16_f32 v145, v226, v227
  v_cvt_pk_bf16_f32 v146, v232, v233
  v_cvt_pk_bf16_f32 v147, v234, v235
  buffer_store_dwordx4 v[144:147], v11, s[4:7], s95 offen offset:2048 sc1
  v_cvt_pk_bf16_f32 v148, v228, v229
  v_cvt_pk_bf16_f32 v149, v230, v231
  v_cvt_pk_bf16_f32 v150, v236, v237
  v_cvt_pk_bf16_f32 v151, v238, v239
  buffer_store_dwordx4 v[148:151], v11, s[4:7], s95 offen offset:2560 sc1
  s_add_u32 s95, s95, 262144
  s_branch L_done
L_bo:
  s_lshr_b32 s40, s36, 1
  s_lshl_b32 s40, s40, 7
  s_add_u32 s40, s40, 1024
  s_mov_b32 s41, 16
  s_mov_b32 s12, s82
  s_and_b32 s13, s83, 0xffff
  s_mov_b32 s14, 0x200000
  s_mov_b32 s15, 0x20000
  s_mov_b32 s23, 65536
  s_mov_b32 s25, 4
  s_lshl_b32 s20, s36, 18
  s_add_u32 s20, s20, 0x6000000
  s_mov_b32 s22, 2048
  s_branch L_g3
L_aos:
  s_mov_b32 s12, s74
  s_and_b32 s13, s75, 0xffff
  s_mov_b32 s14, 0x800000
  s_mov_b32 s15, 0x20000
  s_and_b32 s48, s37, 7
  s_lshr_b32 s37, s37, 3
  s_sub_u32 s40, s36, 12
  s_lshl_b32 s40, s40, 4
  s_add_u32 s40, s40, s48
  s_lshl_b32 s40, s40, 7
  s_add_u32 s40, s40, 20480
  s_mov_b32 s41, 2
  s_add_u32 s42, s40, 1024
  s_mov_b32 s23, 262144
  s_mov_b32 s25, 2
  s_lshl_b32 s20, s36, 20
  s_add_u32 s20, s20, 0x5000000
  s_lshl_b32 s90, s48, 15
  s_add_u32 s20, s20, s90
  s_mov_b32 s22, 0
  s_lshl_b32 s49, s48, 20
  s_branch L_g3b
L_ao4:
  s_lshl_b32 s40, s36, 7
  s_add_u32 s40, s40, 2048
  s_mov_b32 s41, 32
  s_mov_b32 s42, s40
  s_mov_b32 s12, s74
  s_and_b32 s13, s75, 0xffff
  s_mov_b32 s14, 0x800000
  s_mov_b32 s15, 0x20000
  s_and_b32 s48, s37, 3
  s_lshr_b32 s37, s37, 2
  s_mov_b32 s23, 262144
  s_mov_b32 s25, 4
  s_lshl_b32 s20, s36, 20
  s_add_u32 s20, s20, 0x5000000
  s_lshl_b32 s90, s48, 16
  s_add_u32 s20, s20, s90
  s_mov_b32 s22, 0
  s_lshl_b32 s49, s48, 21
  s_branch L_g3b
L_ao:
  s_lshl_b32 s40, s36, 7
  s_add_u32 s40, s40, 2048
  s_mov_b32 s41, 32
  s_mov_b32 s12, s74
  s_and_b32 s13, s75, 0xffff
  s_mov_b32 s14, 0x800000
  s_mov_b32 s15, 0x20000
  s_mov_b32 s23, 262144
  s_mov_b32 s25, 16
  s_lshl_b32 s20, s36, 20
  s_add_u32 s20, s20, 0x5000000
  s_mov_b32 s22, 0
L_g3:
  s_mov_b32 s49, 0
  s_cmp_eq_u32 s35, 16
  s_cselect_b32 s42, 128, 0
  s_add_u32 s42, s42, s40
L_g3b:
  s_mov_b32 s8, s4
  s_and_b32 s9, s5, 0xffff
  s_mov_b32 s10, 0x10000000
  s_mov_b32 s11, 0x20000
  s_lshl_b32 s91, s33, 1
  s_add_u32 s91, s91, s37
  s_mov_b32 s24, 2048
  s_mov_b32 s26, 4096
  s_lshl_b32 s21, s91, 8
  s_add_u32 s22, s22, s21
  s_lshl_b32 s90, s36, 19
  s_add_u32 s22, s22, s90
  s_add_u32 s21, s21, s49
  s_mov_b32 s50, s91
  s_cmp_lt_u32 s35, 16
  s_cbranch_scc1 L_g3c
  s_cmp_eq_u32 s35, 16
  s_cselect_b32 s25, 21, 5
  s_mov_b32 s48, 2048
  v_and_b32 v1, 63, v0
  v_lshrrev_b32 v23, 6, v0
  s_nop 0
  v_readfirstlane_b32 s27, v23
  s_mul_i32 s90, s27, 2
  s_mul_i32 s90, s90, s23
  v_mov_b32 v2, 0x0
  v_bfe_u32 v24, v1, 0, 6
  v_lshl_add_u32 v2, v24, 4, v2
  v_add_u32 v2, s90, v2
  v_mov_b32 v3, 0x400
  v_bfe_u32 v24, v1, 0, 6
  v_lshl_add_u32 v3, v24, 4, v3
  v_add_u32 v3, s90, v3
  v_mov_b32 v4, 0x1000
  v_bfe_u32 v24, v1, 0, 6
  v_lshl_add_u32 v4, v24, 4, v4
  v_add_u32 v4, s90, v4
  v_mov_b32 v5, 0x1400
  v_bfe_u32 v24, v1, 0, 6
  v_lshl_add_u32 v5, v24, 4, v5
  v_add_u32 v5, s90, v5
  s_add_u32 s90, s90, s23
  v_mov_b32 v6, 0x0
  v_bfe_u32 v24, v1, 0, 6
  v_lshl_add_u32 v6, v24, 4, v6
  v_add_u32 v6, s90, v6
  v_mov_b32 v7, 0x400
  v_bfe_u32 v24, v1, 0, 6
  v_lshl_add_u32 v7, v24, 4, v7
  v_add_u32 v7, s90, v7
  v_mov_b32 v8, 0x1000
  v_bfe_u32 v24, v1, 0, 6
  v_lshl_add_u32 v8, v24, 4, v8
  v_add_u32 v8, s90, v8
  v_mov_b32 v9, 0x1400
  v_bfe_u32 v24, v1, 0, 6
  v_lshl_add_u32 v9, v24, 4, v9
  v_add_u32 v9, s90, v9
  s_mul_i32 s90, s27, 16
  v_lshrrev_b32 v23, 4, v1
  v_add_u32 v23, 0, v23
  v_add_u32 v23, s90, v23
  v_and_b32 v24, 7, v23
  v_lshlrev_b32 v24, 1, v24
  v_xor_b32 v24, v24, v1
  v_and_b32 v24, 15, v24
  v_mul_lo_u32 v23, v23, s24
  v_lshl_add_u32 v10, v24, 4, v23
  v_lshrrev_b32 v23, 4, v1
  v_add_u32 v23, 4, v23
  v_add_u32 v23, s90, v23
  v_and_b32 v24, 7, v23
  v_lshlrev_b32 v24, 1, v24
  v_xor_b32 v24, v24, v1
  v_and_b32 v24, 15, v24
  v_mul_lo_u32 v23, v23, s24
  v_lshl_add_u32 v11, v24, 4, v23
  v_lshrrev_b32 v23, 4, v1
  v_add_u32 v23, 8, v23
  v_add_u32 v23, s90, v23
  v_and_b32 v24, 7, v23
  v_lshlrev_b32 v24, 1, v24
  v_xor_b32 v24, v24, v1
  v_and_b32 v24, 15, v24
  v_mul_lo_u32 v23, v23, s24
  v_lshl_add_u32 v12, v24, 4, v23
  v_lshrrev_b32 v23, 4, v1
  v_add_u32 v23, 12, v23
  v_add_u32 v23, s90, v23
  v_and_b32 v24, 7, v23
  v_lshlrev_b32 v24, 1, v24
  v_xor_b32 v24, v24, v1
  v_and_b32 v24, 15, v24
  v_mul_lo_u32 v23, v23, s24
  v_lshl_add_u32 v13, v24, 4, v23
  s_mul_i32 s51, s24, 64
  s_mul_i32 s52, s27, 8192
  s_mul_i32 s53, s27, 4096
  s_add_u32 s53, s53, 32768
  s_add_u32 m0, s53, 0
  s_nop 0
  buffer_load_dwordx4 v10, s[12:15], s21 offen  lds
  s_add_u32 m0, s53, 1024
  s_nop 0
  buffer_load_dwordx4 v11, s[12:15], s21 offen  lds
  s_add_u32 m0, s53, 2048
  s_nop 0
  buffer_load_dwordx4 v12, s[12:15], s21 offen  lds
  s_add_u32 m0, s53, 3072
  s_nop 0
  buffer_load_dwordx4 v13, s[12:15], s21 offen  lds
  s_add_u32 s21, s21, s51
  s_add_u32 m0, s53, 49152
  s_nop 0
  buffer_load_dwordx4 v10, s[12:15], s21 offen  lds
  s_add_u32 m0, s53, 50176
  s_nop 0
  buffer_load_dwordx4 v11, s[12:15], s21 offen  lds
  s_add_u32 m0, s53, 51200
  s_nop 0
  buffer_load_dwordx4 v12, s[12:15], s21 offen  lds
  s_add_u32 m0, s53, 52224
  s_nop 0
  buffer_load_dwordx4 v13, s[12:15], s21 offen  lds
  s_add_u32 s21, s21, s51
  s_add_u32 m0, s53, 98304
  s_nop 0
  buffer_load_dwordx4 v10, s[12:15], s21 offen  lds
  s_add_u32 m0, s53, 99328
  s_nop 0
  buffer_load_dwordx4 v11, s[12:15], s21 offen  lds
  s_add_u32 m0, s53, 100352
  s_nop 0
  buffer_load_dwordx4 v12, s[12:15], s21 offen  lds
  s_add_u32 m0, s53, 101376
  s_nop 0
  buffer_load_dwordx4 v13, s[12:15], s21 offen  lds
  s_add_u32 s21, s21, s51
  s_cmp_lg_u32 s32, 0
  s_cbranch_scc1 L_dd_99
  v_mov_b32 v228, 0x3d00000
L_dw_98:
  buffer_load_dword v234, v228, s[4:7], s40 offen offset:0 sc1
  buffer_load_dword v235, v228, s[4:7], s42 offen offset:0 sc1
  s_waitcnt vmcnt(0)
  s_mov_b32 s44, 1
  v_readfirstlane_b32 s45, v234
  s_cmp_ge_u32 s45, s41
  s_cselect_b32 s44, s44, 0
  v_readfirstlane_b32 s45, v235
  s_cmp_ge_u32 s45, s41
  s_cselect_b32 s44, s44, 0
  s_cmp_eq_u32 s44, 1
  s_cbranch_scc1 L_dd_99
  s_sleep 3
  s_add_u32 s3, s3, 1
  s_cmp_lt_u32 s3, 131072
  s_cbranch_scc1 L_dw_98
L_dd_99:
  s_barrier
  s_add_u32 m0, s52, 0
  s_nop 0
  buffer_load_dwordx4 v2, s[8:11], s20 offen sc1 lds
  s_add_u32 m0, s52, 1024
  s_nop 0
  buffer_load_dwordx4 v3, s[8:11], s20 offen sc1 lds
  s_add_u32 m0, s52, 2048
  s_nop 0
  buffer_load_dwordx4 v4, s[8:11], s20 offen sc1 lds
  s_add_u32 m0, s52, 3072
  s_nop 0
  buffer_load_dwordx4 v5, s[8:11], s20 offen sc1 lds
  s_add_u32 m0, s52, 4096
  s_nop 0
  buffer_load_dwordx4 v6, s[8:11], s20 offen sc1 lds
  s_add_u32 m0, s52, 5120
  s_nop 0
  buffer_load_dwordx4 v7, s[8:11], s20 offen sc1 lds
  s_add_u32 m0, s52, 6144
  s_nop 0
  buffer_load_dwordx4 v8, s[8:11], s20 offen sc1 lds
  s_add_u32 m0, s52, 7168
  s_nop 0
  buffer_load_dwordx4 v9, s[8:11], s20 offen sc1 lds
  s_add_u32 s20, s20, s48
  s_xor_b32 s48, s48, 4096
  s_add_u32 m0, s52, 49152
  s_nop 0
  buffer_load_dwordx4 v2, s[8:11], s20 offen sc1 lds
  s_add_u32 m0, s52, 50176
  s_nop 0
  buffer_load_dwordx4 v3, s[8:11], s20 offen sc1 lds
  s_add_u32 m0, s52, 51200
  s_nop 0
  buffer_load_dwordx4 v4, s[8:11], s20 offen sc1 lds
  s_add_u32 m0, s52, 52224
  s_nop 0
  buffer_load_dwordx4 v5, s[8:11], s20 offen sc1 lds
  s_add_u32 m0, s52, 53248
  s_nop 0
  buffer_load_dwordx4 v6, s[8:11], s20 offen sc1 lds
  s_add_u32 m0, s52, 54272
  s_nop 0
  buffer_load_dwordx4 v7, s[8:11], s20 offen sc1 lds
  s_add_u32 m0, s52, 55296
  s_nop 0
  buffer_load_dwordx4 v8, s[8:11], s20 offen sc1 lds
  s_add_u32 m0, s52, 56320
  s_nop 0
  buffer_load_dwordx4 v9, s[8:11], s20 offen sc1 lds
  s_add_u32 s20, s20, s48
  s_xor_b32 s48, s48, 4096
  s_add_u32 m0, s52, 98304
  s_nop 0
  buffer_load_dwordx4 v2, s[8:11], s20 offen sc1 lds
  s_add_u32 m0, s52, 99328
  s_nop 0
  buffer_load_dwordx4 v3, s[8:11], s20 offen sc1 lds
  s_add_u32 m0, s52, 100352
  s_nop 0
  buffer_load_dwordx4 v4, s[8:11], s20 offen sc1 lds
  s_add_u32 m0, s52, 101376
  s_nop 0
  buffer_load_dwordx4 v5, s[8:11], s20 offen sc1 lds
  s_add_u32 m0, s52, 102400
  s_nop 0
  buffer_load_dwordx4 v6, s[8:11], s20 offen sc1 lds
  s_add_u32 m0, s52, 103424
  s_nop 0
  buffer_load_dwordx4 v7, s[8:11], s20 offen sc1 lds
  s_add_u32 m0, s52, 104448
  s_nop 0
  buffer_load_dwordx4 v8, s[8:11], s20 offen sc1 lds
  s_add_u32 m0, s52, 105472
  s_nop 0
  buffer_load_dwordx4 v9, s[8:11], s20 offen sc1 lds
  s_add_u32 s20, s20, s48
  s_xor_b32 s48, s48, 4096
  s_lshr_b32 s90, s27, 1
  s_and_b32 s91, s27, 1
  s_mul_i32 s92, s90, 16384
  v_mov_b32 v14, 0x0
  v_bfe_u32 v24, v1, 0, 6
  v_lshl_add_u32 v14, v24, 4, v14
  v_add_u32 v14, s92, v14
  v_add_u32 v15, 65536, v14
  v_add_u32 v16, 131072, v14
  v_mov_b32 v23, 0x0
  v_bfe_u32 v24, v1, 2, 2
  v_lshl_add_u32 v23, v24, 8, v23
  v_bfe_u32 v24, v1, 4, 2
  v_lshl_add_u32 v23, v24, 10, v23
  v_bfe_u32 v24, v1, 0, 1
  v_lshl_add_u32 v23, v24, 4, v23
  v_bfe_u32 v25, v1, 2, 3
  v_bfe_u32 v24, v1, 1, 1
  v_xor_b32 v25, v25, v24
  s_mul_i32 s92, s91, 4
  s_add_u32 s93, s92, 0
  v_xor_b32 v24, s93, v25
  v_lshl_add_u32 v17, v24, 5, v23
  v_add_u32 v19, 65536, v17
  v_add_u32 v21, 131072, v17
  s_add_u32 s93, s92, 2
  v_xor_b32 v24, s93, v25
  v_lshl_add_u32 v18, v24, 5, v23
  v_add_u32 v20, 65536, v18
  v_add_u32 v22, 131072, v18
  s_waitcnt vmcnt(16)
  s_barrier
  ds_read_b128 v[28:31], v14 offset:0
  ds_read_b64_tr_b16 v[92:93], v17 offset:32768
  ds_read_b64_tr_b16 v[94:95], v17 offset:36864
  ds_read_b128 v[32:35], v14 offset:2048
  ds_read_b64_tr_b16 v[96:97], v17 offset:32776
  ds_read_b64_tr_b16 v[98:99], v17 offset:36872
  ds_read_b128 v[36:39], v14 offset:4096
  ds_read_b64_tr_b16 v[100:101], v18 offset:32768
  ds_read_b64_tr_b16 v[102:103], v18 offset:36864
  ds_read_b128 v[40:43], v14 offset:6144
  ds_read_b64_tr_b16 v[104:105], v18 offset:32776
  ds_read_b64_tr_b16 v[106:107], v18 offset:36872
  ds_read_b128 v[44:47], v14 offset:8192
  ds_read_b128 v[48:51], v14 offset:10240
  ds_read_b128 v[52:55], v14 offset:12288
  ds_read_b128 v[56:59], v14 offset:14336
  s_sub_u32 s25, s25, 1
  s_waitcnt lgkmcnt(0)
  v_mfma_f32_16x16x32_bf16 a[0:3], v[92:95], v[28:31], 0
  ds_read_b128 v[60:63], v14 offset:1024
  v_mfma_f32_16x16x32_bf16 a[4:7], v[96:99], v[28:31], 0
  ds_read_b64_tr_b16 v[108:109], v17 offset:40960
  v_mfma_f32_16x16x32_bf16 a[8:11], v[100:103], v[28:31], 0
  ds_read_b64_tr_b16 v[110:111], v17 offset:45056
  v_mfma_f32_16x16x32_bf16 a[12:15], v[104:107], v[28:31], 0
  ds_read_b128 v[64:67], v14 offset:3072
  v_mfma_f32_16x16x32_bf16 a[16:19], v[92:95], v[32:35], 0
  ds_read_b64_tr_b16 v[112:113], v17 offset:40968
  v_mfma_f32_16x16x32_bf16 a[20:23], v[96:99], v[32:35], 0
  ds_read_b64_tr_b16 v[114:115], v17 offset:45064
  v_mfma_f32_16x16x32_bf16 a[24:27], v[100:103], v[32:35], 0
  ds_read_b128 v[68:71], v14 offset:5120
  v_mfma_f32_16x16x32_bf16 a[28:31], v[104:107], v[32:35], 0
  ds_read_b64_tr_b16 v[116:117], v18 offset:40960
  v_mfma_f32_16x16x32_bf16 a[32:35], v[92:95], v[36:39], 0
  ds_read_b64_tr_b16 v[118:119], v18 offset:45056
  v_mfma_f32_16x16x32_bf16 a[36:39], v[96:99], v[36:39], 0
  ds_read_b128 v[72:75], v14 offset:7168
  v_mfma_f32_16x16x32_bf16 a[40:43], v[100:103], v[36:39], 0
  ds_read_b64_tr_b16 v[120:121], v18 offset:40968
  v_mfma_f32_16x16x32_bf16 a[44:47], v[104:107], v[36:39], 0
  ds_read_b64_tr_b16 v[122:123], v18 offset:45064
  v_mfma_f32_16x16x32_bf16 a[48:51], v[92:95], v[40:43], 0
  ds_read_b128 v[76:79], v14 offset:9216
  v_mfma_f32_16x16x32_bf16 a[52:55], v[96:99], v[40:43], 0
  ds_read_b128 v[80:83], v14 offset:11264
  v_mfma_f32_16x16x32_bf16 a[56:59], v[100:103], v[40:43], 0
  ds_read_b128 v[84:87], v14 offset:13312
  v_mfma_f32_16x16x32_bf16 a[60:63], v[104:107], v[40:43], 0
  ds_read_b128 v[88:91], v14 offset:15360
  v_mfma_f32_16x16x32_bf16 a[64:67], v[92:95], v[44:47], 0
  v_mfma_f32_16x16x32_bf16 a[68:71], v[96:99], v[44:47], 0
  v_mfma_f32_16x16x32_bf16 a[72:75], v[100:103], v[44:47], 0
  v_mfma_f32_16x16x32_bf16 a[76:79], v[104:107], v[44:47], 0
  v_mfma_f32_16x16x32_bf16 a[80:83], v[92:95], v[48:51], 0
  v_mfma_f32_16x16x32_bf16 a[84:87], v[96:99], v[48:51], 0
  v_mfma_f32_16x16x32_bf16 a[88:91], v[100:103], v[48:51], 0
  v_mfma_f32_16x16x32_bf16 a[92:95], v[104:107], v[48:51], 0
  v_mfma_f32_16x16x32_bf16 a[96:99], v[92:95], v[52:55], 0
  v_mfma_f32_16x16x32_bf16 a[100:103], v[96:99], v[52:55], 0
  v_mfma_f32_16x16x32_bf16 a[104:107], v[100:103], v[52:55], 0
  v_mfma_f32_16x16x32_bf16 a[108:111], v[104:107], v[52:55], 0
  v_mfma_f32_16x16x32_bf16 a[112:115], v[92:95], v[56:59], 0
  v_mfma_f32_16x16x32_bf16 a[116:119], v[96:99], v[56:59], 0
  v_mfma_f32_16x16x32_bf16 a[120:123], v[100:103], v[56:59], 0
  v_mfma_f32_16x16x32_bf16 a[124:127], v[104:107], v[56:59], 0
  s_waitcnt lgkmcnt(0)
  v_mfma_f32_16x16x32_bf16 a[0:3], v[108:111], v[60:63], a[0:3]
  s_waitcnt vmcnt(8)
  s_barrier
  s_add_u32 m0, s52, 0
  v_mfma_f32_16x16x32_bf16 a[4:7], v[112:115], v[60:63], a[4:7]
  buffer_load_dwordx4 v2, s[8:11], s20 offen sc1 lds
  ds_read_b128 v[28:31], v14 offset:49152
  v_mfma_f32_16x16x32_bf16 a[8:11], v[116:119], v[60:63], a[8:11]
  ds_read_b64_tr_b16 v[92:93], v19 offset:16384
  v_mfma_f32_16x16x32_bf16 a[12:15], v[120:123], v[60:63], a[12:15]
  ds_read_b64_tr_b16 v[94:95], v19 offset:20480
  v_mfma_f32_16x16x32_bf16 a[16:19], v[108:111], v[64:67], a[16:19]
  ds_read_b128 v[32:35], v14 offset:51200
  s_add_u32 m0, s53, 0
  v_mfma_f32_16x16x32_bf16 a[20:23], v[112:115], v[64:67], a[20:23]
  buffer_load_dwordx4 v10, s[12:15], s21 offen  lds
  ds_read_b64_tr_b16 v[96:97], v19 offset:16392
  v_mfma_f32_16x16x32_bf16 a[24:27], v[116:119], v[64:67], a[24:27]
  ds_read_b64_tr_b16 v[98:99], v19 offset:20488
  v_mfma_f32_16x16x32_bf16 a[28:31], v[120:123], v[64:67], a[28:31]
  ds_read_b128 v[36:39], v14 offset:53248
  v_mfma_f32_16x16x32_bf16 a[32:35], v[108:111], v[68:71], a[32:35]
  ds_read_b64_tr_b16 v[100:101], v20 offset:16384
  s_add_u32 m0, s52, 1024
  v_mfma_f32_16x16x32_bf16 a[36:39], v[112:115], v[68:71], a[36:39]
  buffer_load_dwordx4 v3, s[8:11], s20 offen sc1 lds
  ds_read_b64_tr_b16 v[102:103], v20 offset:20480
  v_mfma_f32_16x16x32_bf16 a[40:43], v[116:119], v[68:71], a[40:43]
  ds_read_b128 v[40:43], v14 offset:55296
  v_mfma_f32_16x16x32_bf16 a[44:47], v[120:123], v[68:71], a[44:47]
  ds_read_b64_tr_b16 v[104:105], v20 offset:16392
  v_mfma_f32_16x16x32_bf16 a[48:51], v[108:111], v[72:75], a[48:51]
  ds_read_b64_tr_b16 v[106:107], v20 offset:20488
  v_mfma_f32_16x16x32_bf16 a[52:55], v[112:115], v[72:75], a[52:55]
  ds_read_b128 v[44:47], v14 offset:57344
  s_add_u32 m0, s53, 1024
  v_mfma_f32_16x16x32_bf16 a[56:59], v[116:119], v[72:75], a[56:59]
  buffer_load_dwordx4 v11, s[12:15], s21 offen  lds
  ds_read_b128 v[48:51], v14 offset:59392
  v_mfma_f32_16x16x32_bf16 a[60:63], v[120:123], v[72:75], a[60:63]
  ds_read_b128 v[52:55], v14 offset:61440
  v_mfma_f32_16x16x32_bf16 a[64:67], v[108:111], v[76:79], a[64:67]
  ds_read_b128 v[56:59], v14 offset:63488
  v_mfma_f32_16x16x32_bf16 a[68:71], v[112:115], v[76:79], a[68:71]
  s_add_u32 m0, s52, 2048
  v_mfma_f32_16x16x32_bf16 a[72:75], v[116:119], v[76:79], a[72:75]
  buffer_load_dwordx4 v4, s[8:11], s20 offen sc1 lds
  v_mfma_f32_16x16x32_bf16 a[76:79], v[120:123], v[76:79], a[76:79]
  v_mfma_f32_16x16x32_bf16 a[80:83], v[108:111], v[80:83], a[80:83]
  v_mfma_f32_16x16x32_bf16 a[84:87], v[112:115], v[80:83], a[84:87]
  v_mfma_f32_16x16x32_bf16 a[88:91], v[116:119], v[80:83], a[88:91]
  s_add_u32 m0, s53, 2048
  v_mfma_f32_16x16x32_bf16 a[92:95], v[120:123], v[80:83], a[92:95]
  buffer_load_dwordx4 v12, s[12:15], s21 offen  lds
  v_mfma_f32_16x16x32_bf16 a[96:99], v[108:111], v[84:87], a[96:99]
  v_mfma_f32_16x16x32_bf16 a[100:103], v[112:115], v[84:87], a[100:103]
  v_mfma_f32_16x16x32_bf16 a[104:107], v[116:119], v[84:87], a[104:107]
  s_add_u32 m0, s52, 3072
  v_mfma_f32_16x16x32_bf16 a[108:111], v[120:123], v[84:87], a[108:111]
  buffer_load_dwordx4 v5, s[8:11], s20 offen sc1 lds
  v_mfma_f32_16x16x32_bf16 a[112:115], v[108:111], v[88:91], a[112:115]
  v_mfma_f32_16x16x32_bf16 a[116:119], v[112:115], v[88:91], a[116:119]
  v_mfma_f32_16x16x32_bf16 a[120:123], v[116:119], v[88:91], a[120:123]
  v_mfma_f32_16x16x32_bf16 a[124:127], v[120:123], v[88:91], a[124:127]
  s_waitcnt lgkmcnt(0)
  s_add_u32 m0, s53, 3072
  v_mfma_f32_16x16x32_bf16 a[0:3], v[92:95], v[28:31], a[0:3]
  buffer_load_dwordx4 v13, s[12:15], s21 offen  lds
  ds_read_b128 v[60:63], v14 offset:50176
  v_mfma_f32_16x16x32_bf16 a[4:7], v[96:99], v[28:31], a[4:7]
  ds_read_b64_tr_b16 v[108:109], v19 offset:24576
  v_mfma_f32_16x16x32_bf16 a[8:11], v[100:103], v[28:31], a[8:11]
  ds_read_b64_tr_b16 v[110:111], v19 offset:28672
  v_mfma_f32_16x16x32_bf16 a[12:15], v[104:107], v[28:31], a[12:15]
  ds_read_b128 v[64:67], v14 offset:52224
  v_mfma_f32_16x16x32_bf16 a[16:19], v[92:95], v[32:35], a[16:19]
  ds_read_b64_tr_b16 v[112:113], v19 offset:24584
  s_add_u32 m0, s52, 4096
  v_mfma_f32_16x16x32_bf16 a[20:23], v[96:99], v[32:35], a[20:23]
  buffer_load_dwordx4 v6, s[8:11], s20 offen sc1 lds
  ds_read_b64_tr_b16 v[114:115], v19 offset:28680
  v_mfma_f32_16x16x32_bf16 a[24:27], v[100:103], v[32:35], a[24:27]
  ds_read_b128 v[68:71], v14 offset:54272
  v_mfma_f32_16x16x32_bf16 a[28:31], v[104:107], v[32:35], a[28:31]
  ds_read_b64_tr_b16 v[116:117], v20 offset:24576
  v_mfma_f32_16x16x32_bf16 a[32:35], v[92:95], v[36:39], a[32:35]
  ds_read_b64_tr_b16 v[118:119], v20 offset:28672
  v_mfma_f32_16x16x32_bf16 a[36:39], v[96:99], v[36:39], a[36:39]
  ds_read_b128 v[72:75], v14 offset:56320
  s_add_u32 m0, s52, 5120
  v_mfma_f32_16x16x32_bf16 a[40:43], v[100:103], v[36:39], a[40:43]
  buffer_load_dwordx4 v7, s[8:11], s20 offen sc1 lds
  ds_read_b64_tr_b16 v[120:121], v20 offset:24584
  v_mfma_f32_16x16x32_bf16 a[44:47], v[104:107], v[36:39], a[44:47]
  ds_read_b64_tr_b16 v[122:123], v20 offset:28680
  v_mfma_f32_16x16x32_bf16 a[48:51], v[92:95], v[40:43], a[48:51]
  ds_read_b128 v[76:79], v14 offset:58368
  v_mfma_f32_16x16x32_bf16 a[52:55], v[96:99], v[40:43], a[52:55]
  ds_read_b128 v[80:83], v14 offset:60416
  v_mfma_f32_16x16x32_bf16 a[56:59], v[100:103], v[40:43], a[56:59]
  ds_read_b128 v[84:87], v14 offset:62464
  v_mfma_f32_16x16x32_bf16 a[60:63], v[104:107], v[40:43], a[60:63]
  ds_read_b128 v[88:91], v14 offset:64512
  s_add_u32 m0, s52, 6144
  v_mfma_f32_16x16x32_bf16 a[64:67], v[92:95], v[44:47], a[64:67]
  buffer_load_dwordx4 v8, s[8:11], s20 offen sc1 lds
  v_mfma_f32_16x16x32_bf16 a[68:71], v[96:99], v[44:47], a[68:71]
  v_mfma_f32_16x16x32_bf16 a[72:75], v[100:103], v[44:47], a[72:75]
  v_mfma_f32_16x16x32_bf16 a[76:79], v[104:107], v[44:47], a[76:79]
  v_mfma_f32_16x16x32_bf16 a[80:83], v[92:95], v[48:51], a[80:83]
  s_add_u32 m0, s52, 7168
  v_mfma_f32_16x16x32_bf16 a[84:87], v[96:99], v[48:51], a[84:87]
  buffer_load_dwordx4 v9, s[8:11], s20 offen sc1 lds
  v_mfma_f32_16x16x32_bf16 a[88:91], v[100:103], v[48:51], a[88:91]
  v_mfma_f32_16x16x32_bf16 a[92:95], v[104:107], v[48:51], a[92:95]
  v_mfma_f32_16x16x32_bf16 a[96:99], v[92:95], v[52:55], a[96:99]
  v_mfma_f32_16x16x32_bf16 a[100:103], v[96:99], v[52:55], a[100:103]
  s_add_u32 s20, s20, s48
  s_xor_b32 s48, s48, 4096
  v_mfma_f32_16x16x32_bf16 a[104:107], v[100:103], v[52:55], a[104:107]
  s_add_u32 s21, s21, s51
  v_mfma_f32_16x16x32_bf16 a[108:111], v[104:107], v[52:55], a[108:111]
  v_mfma_f32_16x16x32_bf16 a[112:115], v[92:95], v[56:59], a[112:115]
  v_mfma_f32_16x16x32_bf16 a[116:119], v[96:99], v[56:59], a[116:119]
  v_mfma_f32_16x16x32_bf16 a[120:123], v[100:103], v[56:59], a[120:123]
  v_mfma_f32_16x16x32_bf16 a[124:127], v[104:107], v[56:59], a[124:127]
  s_waitcnt lgkmcnt(0)
  v_mfma_f32_16x16x32_bf16 a[0:3], v[108:111], v[60:63], a[0:3]
  s_waitcnt vmcnt(12)
  s_barrier
  s_add_u32 m0, s52, 49152
  v_mfma_f32_16x16x32_bf16 a[4:7], v[112:115], v[60:63], a[4:7]
  buffer_load_dwordx4 v2, s[8:11], s20 offen sc1 lds
  ds_read_b128 v[28:31], v15 offset:32768
  v_mfma_f32_16x16x32_bf16 a[8:11], v[116:119], v[60:63], a[8:11]
  ds_read_b64_tr_b16 v[92:93], v21 offset:0
  v_mfma_f32_16x16x32_bf16 a[12:15], v[120:123], v[60:63], a[12:15]
  ds_read_b64_tr_b16 v[94:95], v21 offset:4096
  v_mfma_f32_16x16x32_bf16 a[16:19], v[108:111], v[64:67], a[16:19]
  ds_read_b128 v[32:35], v15 offset:34816
  s_add_u32 m0, s53, 49152
  v_mfma_f32_16x16x32_bf16 a[20:23], v[112:115], v[64:67], a[20:23]
  buffer_load_dwordx4 v10, s[12:15], s21 offen  lds
  ds_read_b64_tr_b16 v[96:97], v21 offset:8
  v_mfma_f32_16x16x32_bf16 a[24:27], v[116:119], v[64:67], a[24:27]
  ds_read_b64_tr_b16 v[98:99], v21 offset:4104
  v_mfma_f32_16x16x32_bf16 a[28:31], v[120:123], v[64:67], a[28:31]
  ds_read_b128 v[36:39], v15 offset:36864
  v_mfma_f32_16x16x32_bf16 a[32:35], v[108:111], v[68:71], a[32:35]
  ds_read_b64_tr_b16 v[100:101], v22 offset:0
  s_add_u32 m0, s52, 50176
  v_mfma_f32_16x16x32_bf16 a[36:39], v[112:115], v[68:71], a[36:39]
  buffer_load_dwordx4 v3, s[8:11], s20 offen sc1 lds
  ds_read_b64_tr_b16 v[102:103], v22 offset:4096
  v_mfma_f32_16x16x32_bf16 a[40:43], v[116:119], v[68:71], a[40:43]
  ds_read_b128 v[40:43], v15 offset:38912
  v_mfma_f32_16x16x32_bf16 a[44:47], v[120:123], v[68:71], a[44:47]
  ds_read_b64_tr_b16 v[104:105], v22 offset:8
  v_mfma_f32_16x16x32_bf16 a[48:51], v[108:111], v[72:75], a[48:51]
  ds_read_b64_tr_b16 v[106:107], v22 offset:4104
  v_mfma_f32_16x16x32_bf16 a[52:55], v[112:115], v[72:75], a[52:55]
  ds_read_b128 v[44:47], v15 offset:40960
  s_add_u32 m0, s53, 50176
  v_mfma_f32_16x16x32_bf16 a[56:59], v[116:119], v[72:75], a[56:59]
  buffer_load_dwordx4 v11, s[12:15], s21 offen  lds
  ds_read_b128 v[48:51], v15 offset:43008
  v_mfma_f32_16x16x32_bf16 a[60:63], v[120:123], v[72:75], a[60:63]
  ds_read_b128 v[52:55], v15 offset:45056
  v_mfma_f32_16x16x32_bf16 a[64:67], v[108:111], v[76:79], a[64:67]
  ds_read_b128 v[56:59], v15 offset:47104
  v_mfma_f32_16x16x32_bf16 a[68:71], v[112:115], v[76:79], a[68:71]
  s_add_u32 m0, s52, 51200
  v_mfma_f32_16x16x32_bf16 a[72:75], v[116:119], v[76:79], a[72:75]
  buffer_load_dwordx4 v4, s[8:11], s20 offen sc1 lds
  v_mfma_f32_16x16x32_bf16 a[76:79], v[120:123], v[76:79], a[76:79]
  v_mfma_f32_16x16x32_bf16 a[80:83], v[108:111], v[80:83], a[80:83]
  v_mfma_f32_16x16x32_bf16 a[84:87], v[112:115], v[80:83], a[84:87]
  v_mfma_f32_16x16x32_bf16 a[88:91], v[116:119], v[80:83], a[88:91]
  s_add_u32 m0, s53, 51200
  v_mfma_f32_16x16x32_bf16 a[92:95], v[120:123], v[80:83], a[92:95]
  buffer_load_dwordx4 v12, s[12:15], s21 offen  lds
  v_mfma_f32_16x16x32_bf16 a[96:99], v[108:111], v[84:87], a[96:99]
  v_mfma_f32_16x16x32_bf16 a[100:103], v[112:115], v[84:87], a[100:103]
  v_mfma_f32_16x16x32_bf16 a[104:107], v[116:119], v[84:87], a[104:107]
  s_add_u32 m0, s52, 52224
  v_mfma_f32_16x16x32_bf16 a[108:111], v[120:123], v[84:87], a[108:111]
  buffer_load_dwordx4 v5, s[8:11], s20 offen sc1 lds
  v_mfma_f32_16x16x32_bf16 a[112:115], v[108:111], v[88:91], a[112:115]
  v_mfma_f32_16x16x32_bf16 a[116:119], v[112:115], v[88:91], a[116:119]
  v_mfma_f32_16x16x32_bf16 a[120:123], v[116:119], v[88:91], a[120:123]
  v_mfma_f32_16x16x32_bf16 a[124:127], v[120:123], v[88:91], a[124:127]
  s_waitcnt lgkmcnt(0)
  s_add_u32 m0, s53, 52224
  v_mfma_f32_16x16x32_bf16 a[0:3], v[92:95], v[28:31], a[0:3]
  buffer_load_dwordx4 v13, s[12:15], s21 offen  lds
  ds_read_b128 v[60:63], v15 offset:33792
  v_mfma_f32_16x16x32_bf16 a[4:7], v[96:99], v[28:31], a[4:7]
  ds_read_b64_tr_b16 v[108:109], v21 offset:8192
  v_mfma_f32_16x16x32_bf16 a[8:11], v[100:103], v[28:31], a[8:11]
  ds_read_b64_tr_b16 v[110:111], v21 offset:12288
  v_mfma_f32_16x16x32_bf16 a[12:15], v[104:107], v[28:31], a[12:15]
  ds_read_b128 v[64:67], v15 offset:35840
  v_mfma_f32_16x16x32_bf16 a[16:19], v[92:95], v[32:35], a[16:19]
  ds_read_b64_tr_b16 v[112:113], v21 offset:8200
  s_add_u32 m0, s52, 53248
  v_mfma_f32_16x16x32_bf16 a[20:23], v[96:99], v[32:35], a[20:23]
  buffer_load_dwordx4 v6, s[8:11], s20 offen sc1 lds
  ds_read_b64_tr_b16 v[114:115], v21 offset:12296
  v_mfma_f32_16x16x32_bf16 a[24:27], v[100:103], v[32:35], a[24:27]
  ds_read_b128 v[68:71], v15 offset:37888
  v_mfma_f32_16x16x32_bf16 a[28:31], v[104:107], v[32:35], a[28:31]
  ds_read_b64_tr_b16 v[116:117], v22 offset:8192
  v_mfma_f32_16x16x32_bf16 a[32:35], v[92:95], v[36:39], a[32:35]
  ds_read_b64_tr_b16 v[118:119], v22 offset:12288
  v_mfma_f32_16x16x32_bf16 a[36:39], v[96:99], v[36:39], a[36:39]
  ds_read_b128 v[72:75], v15 offset:39936
  s_add_u32 m0, s52, 54272
  v_mfma_f32_16x16x32_bf16 a[40:43], v[100:103], v[36:39], a[40:43]
  buffer_load_dwordx4 v7, s[8:11], s20 offen sc1 lds
  ds_read_b64_tr_b16 v[120:121], v22 offset:8200
  v_mfma_f32_16x16x32_bf16 a[44:47], v[104:107], v[36:39], a[44:47]
  ds_read_b64_tr_b16 v[122:123], v22 offset:12296
  v_mfma_f32_16x16x32_bf16 a[48:51], v[92:95], v[40:43], a[48:51]
  ds_read_b128 v[76:79], v15 offset:41984
  v_mfma_f32_16x16x32_bf16 a[52:55], v[96:99], v[40:43], a[52:55]
  ds_read_b128 v[80:83], v15 offset:44032
  v_mfma_f32_16x16x32_bf16 a[56:59], v[100:103], v[40:43], a[56:59]
  ds_read_b128 v[84:87], v15 offset:46080
  v_mfma_f32_16x16x32_bf16 a[60:63], v[104:107], v[40:43], a[60:63]
  ds_read_b128 v[88:91], v15 offset:48128
  s_add_u32 m0, s52, 55296
  v_mfma_f32_16x16x32_bf16 a[64:67], v[92:95], v[44:47], a[64:67]
  buffer_load_dwordx4 v8, s[8:11], s20 offen sc1 lds
  v_mfma_f32_16x16x32_bf16 a[68:71], v[96:99], v[44:47], a[68:71]
  v_mfma_f32_16x16x32_bf16 a[72:75], v[100:103], v[44:47], a[72:75]
  v_mfma_f32_16x16x32_bf16 a[76:79], v[104:107], v[44:47], a[76:79]
  v_mfma_f32_16x16x32_bf16 a[80:83], v[92:95], v[48:51], a[80:83]
  s_add_u32 m0, s52, 56320
  v_mfma_f32_16x16x32_bf16 a[84:87], v[96:99], v[48:51], a[84:87]
  buffer_load_dwordx4 v9, s[8:11], s20 offen sc1 lds
  v_mfma_f32_16x16x32_bf16 a[88:91], v[100:103], v[48:51], a[88:91]
  v_mfma_f32_16x16x32_bf16 a[92:95], v[104:107], v[48:51], a[92:95]
  v_mfma_f32_16x16x32_bf16 a[96:99], v[92:95], v[52:55], a[96:99]
  v_mfma_f32_16x16x32_bf16 a[100:103], v[96:99], v[52:55], a[100:103]
  s_add_u32 s20, s20, s48
  s_xor_b32 s48, s48, 4096
  v_mfma_f32_16x16x32_bf16 a[104:107], v[100:103], v[52:55], a[104:107]
  s_add_u32 s21, s21, s51
  v_mfma_f32_16x16x32_bf16 a[108:111], v[104:107], v[52:55], a[108:111]
  v_mfma_f32_16x16x32_bf16 a[112:115], v[92:95], v[56:59], a[112:115]
  v_mfma_f32_16x16x32_bf16 a[116:119], v[96:99], v[56:59], a[116:119]
  v_mfma_f32_16x16x32_bf16 a[120:123], v[100:103], v[56:59], a[120:123]
  v_mfma_f32_16x16x32_bf16 a[124:127], v[104:107], v[56:59], a[124:127]
  s_waitcnt lgkmcnt(0)
  v_mfma_f32_16x16x32_bf16 a[0:3], v[108:111], v[60:63], a[0:3]
  s_waitcnt vmcnt(12)
  s_barrier
  s_add_u32 m0, s52, 98304
  v_mfma_f32_16x16x32_bf16 a[4:7], v[112:115], v[60:63], a[4:7]
  buffer_load_dwordx4 v2, s[8:11], s20 offen sc1 lds
  ds_read_b128 v[28:31], v14 offset:0
  v_mfma_f32_16x16x32_bf16 a[8:11], v[116:119], v[60:63], a[8:11]
  ds_read_b64_tr_b16 v[92:93], v17 offset:32768
  v_mfma_f32_16x16x32_bf16 a[12:15], v[120:123], v[60:63], a[12:15]
  ds_read_b64_tr_b16 v[94:95], v17 offset:36864
  v_mfma_f32_16x16x32_bf16 a[16:19], v[108:111], v[64:67], a[16:19]
  ds_read_b128 v[32:35], v14 offset:2048
  s_add_u32 m0, s53, 98304
  v_mfma_f32_16x16x32_bf16 a[20:23], v[112:115], v[64:67], a[20:23]
  buffer_load_dwordx4 v10, s[12:15], s21 offen  lds
  ds_read_b64_tr_b16 v[96:97], v17 offset:32776
  v_mfma_f32_16x16x32_bf16 a[24:27], v[116:119], v[64:67], a[24:27]
  ds_read_b64_tr_b16 v[98:99], v17 offset:36872
  v_mfma_f32_16x16x32_bf16 a[28:31], v[120:123], v[64:67], a[28:31]
  ds_read_b128 v[36:39], v14 offset:4096
  v_mfma_f32_16x16x32_bf16 a[32:35], v[108:111], v[68:71], a[32:35]
  ds_read_b64_tr_b16 v[100:101], v18 offset:32768
  s_add_u32 m0, s52, 99328
  v_mfma_f32_16x16x32_bf16 a[36:39], v[112:115], v[68:71], a[36:39]
  buffer_load_dwordx4 v3, s[8:11], s20 offen sc1 lds
  ds_read_b64_tr_b16 v[102:103], v18 offset:36864
  v_mfma_f32_16x16x32_bf16 a[40:43], v[116:119], v[68:71], a[40:43]
  ds_read_b128 v[40:43], v14 offset:6144
  v_mfma_f32_16x16x32_bf16 a[44:47], v[120:123], v[68:71], a[44:47]
  ds_read_b64_tr_b16 v[104:105], v18 offset:32776
  v_mfma_f32_16x16x32_bf16 a[48:51], v[108:111], v[72:75], a[48:51]
  ds_read_b64_tr_b16 v[106:107], v18 offset:36872
  v_mfma_f32_16x16x32_bf16 a[52:55], v[112:115], v[72:75], a[52:55]
  ds_read_b128 v[44:47], v14 offset:8192
  s_add_u32 m0, s53, 99328
  v_mfma_f32_16x16x32_bf16 a[56:59], v[116:119], v[72:75], a[56:59]
  buffer_load_dwordx4 v11, s[12:15], s21 offen  lds
  ds_read_b128 v[48:51], v14 offset:10240
  v_mfma_f32_16x16x32_bf16 a[60:63], v[120:123], v[72:75], a[60:63]
  ds_read_b128 v[52:55], v14 offset:12288
  v_mfma_f32_16x16x32_bf16 a[64:67], v[108:111], v[76:79], a[64:67]
  ds_read_b128 v[56:59], v14 offset:14336
  v_mfma_f32_16x16x32_bf16 a[68:71], v[112:115], v[76:79], a[68:71]
  s_add_u32 m0, s52, 100352
  v_mfma_f32_16x16x32_bf16 a[72:75], v[116:119], v[76:79], a[72:75]
  buffer_load_dwordx4 v4, s[8:11], s20 offen sc1 lds
  v_mfma_f32_16x16x32_bf16 a[76:79], v[120:123], v[76:79], a[76:79]
  v_mfma_f32_16x16x32_bf16 a[80:83], v[108:111], v[80:83], a[80:83]
  v_mfma_f32_16x16x32_bf16 a[84:87], v[112:115], v[80:83], a[84:87]
  v_mfma_f32_16x16x32_bf16 a[88:91], v[116:119], v[80:83], a[88:91]
  s_add_u32 m0, s53, 100352
  v_mfma_f32_16x16x32_bf16 a[92:95], v[120:123], v[80:83], a[92:95]
  buffer_load_dwordx4 v12, s[12:15], s21 offen  lds
  v_mfma_f32_16x16x32_bf16 a[96:99], v[108:111], v[84:87], a[96:99]
  v_mfma_f32_16x16x32_bf16 a[100:103], v[112:115], v[84:87], a[100:103]
  v_mfma_f32_16x16x32_bf16 a[104:107], v[116:119], v[84:87], a[104:107]
  s_add_u32 m0, s52, 101376
  v_mfma_f32_16x16x32_bf16 a[108:111], v[120:123], v[84:87], a[108:111]
  buffer_load_dwordx4 v5, s[8:11], s20 offen sc1 lds
  v_mfma_f32_16x16x32_bf16 a[112:115], v[108:111], v[88:91], a[112:115]
  v_mfma_f32_16x16x32_bf16 a[116:119], v[112:115], v[88:91], a[116:119]
  v_mfma_f32_16x16x32_bf16 a[120:123], v[116:119], v[88:91], a[120:123]
  v_mfma_f32_16x16x32_bf16 a[124:127], v[120:123], v[88:91], a[124:127]
L_g6_loop:
  s_sub_u32 s25, s25, 1
  s_cmp_eq_u32 s25, 0
  s_cbranch_scc1 L_g6_fin
  s_waitcnt lgkmcnt(0)
  s_add_u32 m0, s53, 101376
  v_mfma_f32_16x16x32_bf16 a[0:3], v[92:95], v[28:31], a[0:3]
  buffer_load_dwordx4 v13, s[12:15], s21 offen  lds
  ds_read_b128 v[60:63], v14 offset:1024
  v_mfma_f32_16x16x32_bf16 a[4:7], v[96:99], v[28:31], a[4:7]
  ds_read_b64_tr_b16 v[108:109], v17 offset:40960
  v_mfma_f32_16x16x32_bf16 a[8:11], v[100:103], v[28:31], a[8:11]
  ds_read_b64_tr_b16 v[110:111], v17 offset:45056
  v_mfma_f32_16x16x32_bf16 a[12:15], v[104:107], v[28:31], a[12:15]
  ds_read_b128 v[64:67], v14 offset:3072
  v_mfma_f32_16x16x32_bf16 a[16:19], v[92:95], v[32:35], a[16:19]
  ds_read_b64_tr_b16 v[112:113], v17 offset:40968
  s_add_u32 m0, s52, 102400
  v_mfma_f32_16x16x32_bf16 a[20:23], v[96:99], v[32:35], a[20:23]
  buffer_load_dwordx4 v6, s[8:11], s20 offen sc1 lds
  ds_read_b64_tr_b16 v[114:115], v17 offset:45064
  v_mfma_f32_16x16x32_bf16 a[24:27], v[100:103], v[32:35], a[24:27]
  ds_read_b128 v[68:71], v14 offset:5120
  v_mfma_f32_16x16x32_bf16 a[28:31], v[104:107], v[32:35], a[28:31]
  ds_read_b64_tr_b16 v[116:117], v18 offset:40960
  v_mfma_f32_16x16x32_bf16 a[32:35], v[92:95], v[36:39], a[32:35]
  ds_read_b64_tr_b16 v[118:119], v18 offset:45056
  v_mfma_f32_16x16x32_bf16 a[36:39], v[96:99], v[36:39], a[36:39]
  ds_read_b128 v[72:75], v14 offset:7168
  s_add_u32 m0, s52, 103424
  v_mfma_f32_16x16x32_bf16 a[40:43], v[100:103], v[36:39], a[40:43]
  buffer_load_dwordx4 v7, s[8:11], s20 offen sc1 lds
  ds_read_b64_tr_b16 v[120:121], v18 offset:40968
  v_mfma_f32_16x16x32_bf16 a[44:47], v[104:107], v[36:39], a[44:47]
  ds_read_b64_tr_b16 v[122:123], v18 offset:45064
  v_mfma_f32_16x16x32_bf16 a[48:51], v[92:95], v[40:43], a[48:51]
  ds_read_b128 v[76:79], v14 offset:9216
  v_mfma_f32_16x16x32_bf16 a[52:55], v[96:99], v[40:43], a[52:55]
  ds_read_b128 v[80:83], v14 offset:11264
  v_mfma_f32_16x16x32_bf16 a[56:59], v[100:103], v[40:43], a[56:59]
  ds_read_b128 v[84:87], v14 offset:13312
  v_mfma_f32_16x16x32_bf16 a[60:63], v[104:107], v[40:43], a[60:63]
  ds_read_b128 v[88:91], v14 offset:15360
  s_add_u32 m0, s52, 104448
  v_mfma_f32_16x16x32_bf16 a[64:67], v[92:95], v[44:47], a[64:67]
  buffer_load_dwordx4 v8, s[8:11], s20 offen sc1 lds
  v_mfma_f32_16x16x32_bf16 a[68:71], v[96:99], v[44:47], a[68:71]
  v_mfma_f32_16x16x32_bf16 a[72:75], v[100:103], v[44:47], a[72:75]
  v_mfma_f32_16x16x32_bf16 a[76:79], v[104:107], v[44:47], a[76:79]
  v_mfma_f32_16x16x32_bf16 a[80:83], v[92:95], v[48:51], a[80:83]
  s_add_u32 m0, s52, 105472
  v_mfma_f32_16x16x32_bf16 a[84:87], v[96:99], v[48:51], a[84:87]
  buffer_load_dwordx4 v9, s[8:11], s20 offen sc1 lds
  v_mfma_f32_16x16x32_bf16 a[88:91], v[100:103], v[48:51], a[88:91]
  v_mfma_f32_16x16x32_bf16 a[92:95], v[104:107], v[48:51], a[92:95]
  v_mfma_f32_16x16x32_bf16 a[96:99], v[92:95], v[52:55], a[96:99]
  v_mfma_f32_16x16x32_bf16 a[100:103], v[96:99], v[52:55], a[100:103]
  s_add_u32 s20, s20, s48
  s_xor_b32 s48, s48, 4096
  v_mfma_f32_16x16x32_bf16 a[104:107], v[100:103], v[52:55], a[104:107]
  s_add_u32 s21, s21, s51
  v_mfma_f32_16x16x32_bf16 a[108:111], v[104:107], v[52:55], a[108:111]
  v_mfma_f32_16x16x32_bf16 a[112:115], v[92:95], v[56:59], a[112:115]
  v_mfma_f32_16x16x32_bf16 a[116:119], v[96:99], v[56:59], a[116:119]
  v_mfma_f32_16x16x32_bf16 a[120:123], v[100:103], v[56:59], a[120:123]
  v_mfma_f32_16x16x32_bf16 a[124:127], v[104:107], v[56:59], a[124:127]
  s_waitcnt lgkmcnt(0)
  v_mfma_f32_16x16x32_bf16 a[0:3], v[108:111], v[60:63], a[0:3]
  s_waitcnt vmcnt(12)
  s_barrier
  s_add_u32 m0, s52, 0
  v_mfma_f32_16x16x32_bf16 a[4:7], v[112:115], v[60:63], a[4:7]
  buffer_load_dwordx4 v2, s[8:11], s20 offen sc1 lds
  ds_read_b128 v[28:31], v14 offset:49152
  v_mfma_f32_16x16x32_bf16 a[8:11], v[116:119], v[60:63], a[8:11]
  ds_read_b64_tr_b16 v[92:93], v19 offset:16384
  v_mfma_f32_16x16x32_bf16 a[12:15], v[120:123], v[60:63], a[12:15]
  ds_read_b64_tr_b16 v[94:95], v19 offset:20480
  v_mfma_f32_16x16x32_bf16 a[16:19], v[108:111], v[64:67], a[16:19]
  ds_read_b128 v[32:35], v14 offset:51200
  s_add_u32 m0, s53, 0
  v_mfma_f32_16x16x32_bf16 a[20:23], v[112:115], v[64:67], a[20:23]
  buffer_load_dwordx4 v10, s[12:15], s21 offen  lds
  ds_read_b64_tr_b16 v[96:97], v19 offset:16392
  v_mfma_f32_16x16x32_bf16 a[24:27], v[116:119], v[64:67], a[24:27]
  ds_read_b64_tr_b16 v[98:99], v19 offset:20488
  v_mfma_f32_16x16x32_bf16 a[28:31], v[120:123], v[64:67], a[28:31]
  ds_read_b128 v[36:39], v14 offset:53248
  v_mfma_f32_16x16x32_bf16 a[32:35], v[108:111], v[68:71], a[32:35]
  ds_read_b64_tr_b16 v[100:101], v20 offset:16384
  s_add_u32 m0, s52, 1024
  v_mfma_f32_16x16x32_bf16 a[36:39], v[112:115], v[68:71], a[36:39]
  buffer_load_dwordx4 v3, s[8:11], s20 offen sc1 lds
  ds_read_b64_tr_b16 v[102:103], v20 offset:20480
  v_mfma_f32_16x16x32_bf16 a[40:43], v[116:119], v[68:71], a[40:43]
  ds_read_b128 v[40:43], v14 offset:55296
  v_mfma_f32_16x16x32_bf16 a[44:47], v[120:123], v[68:71], a[44:47]
  ds_read_b64_tr_b16 v[104:105], v20 offset:16392
  v_mfma_f32_16x16x32_bf16 a[48:51], v[108:111], v[72:75], a[48:51]
  ds_read_b64_tr_b16 v[106:107], v20 offset:20488
  v_mfma_f32_16x16x32_bf16 a[52:55], v[112:115], v[72:75], a[52:55]
  ds_read_b128 v[44:47], v14 offset:57344
  s_add_u32 m0, s53, 1024
  v_mfma_f32_16x16x32_bf16 a[56:59], v[116:119], v[72:75], a[56:59]
  buffer_load_dwordx4 v11, s[12:15], s21 offen  lds
  ds_read_b128 v[48:51], v14 offset:59392
  v_mfma_f32_16x16x32_bf16 a[60:63], v[120:123], v[72:75], a[60:63]
  ds_read_b128 v[52:55], v14 offset:61440
  v_mfma_f32_16x16x32_bf16 a[64:67], v[108:111], v[76:79], a[64:67]
  ds_read_b128 v[56:59], v14 offset:63488
  v_mfma_f32_16x16x32_bf16 a[68:71], v[112:115], v[76:79], a[68:71]
  s_add_u32 m0, s52, 2048
  v_mfma_f32_16x16x32_bf16 a[72:75], v[116:119], v[76:79], a[72:75]
  buffer_load_dwordx4 v4, s[8:11], s20 offen sc1 lds
  v_mfma_f32_16x16x32_bf16 a[76:79], v[120:123], v[76:79], a[76:79]
  v_mfma_f32_16x16x32_bf16 a[80:83], v[108:111], v[80:83], a[80:83]
  v_mfma_f32_16x16x32_bf16 a[84:87], v[112:115], v[80:83], a[84:87]
  v_mfma_f32_16x16x32_bf16 a[88:91], v[116:119], v[80:83], a[88:91]
  s_add_u32 m0, s53, 2048
  v_mfma_f32_16x16x32_bf16 a[92:95], v[120:123], v[80:83], a[92:95]
  buffer_load_dwordx4 v12, s[12:15], s21 offen  lds
  v_mfma_f32_16x16x32_bf16 a[96:99], v[108:111], v[84:87], a[96:99]
  v_mfma_f32_16x16x32_bf16 a[100:103], v[112:115], v[84:87], a[100:103]
  v_mfma_f32_16x16x32_bf16 a[104:107], v[116:119], v[84:87], a[104:107]
  s_add_u32 m0, s52, 3072
  v_mfma_f32_16x16x32_bf16 a[108:111], v[120:123], v[84:87], a[108:111]
  buffer_load_dwordx4 v5, s[8:11], s20 offen sc1 lds
  v_mfma_f32_16x16x32_bf16 a[112:115], v[108:111], v[88:91], a[112:115]
  v_mfma_f32_16x16x32_bf16 a[116:119], v[112:115], v[88:91], a[116:119]
  v_mfma_f32_16x16x32_bf16 a[120:123], v[116:119], v[88:91], a[120:123]
  v_mfma_f32_16x16x32_bf16 a[124:127], v[120:123], v[88:91], a[124:127]
  s_waitcnt lgkmcnt(0)
  s_add_u32 m0, s53, 3072
  v_mfma_f32_16x16x32_bf16 a[0:3], v[92:95], v[28:31], a[0:3]
  buffer_load_dwordx4 v13, s[12:15], s21 offen  lds
  ds_read_b128 v[60:63], v14 offset:50176
  v_mfma_f32_16x16x32_bf16 a[4:7], v[96:99], v[28:31], a[4:7]
  ds_read_b64_tr_b16 v[108:109], v19 offset:24576
  v_mfma_f32_16x16x32_bf16 a[8:11], v[100:103], v[28:31], a[8:11]
  ds_read_b64_tr_b16 v[110:111], v19 offset:28672
  v_mfma_f32_16x16x32_bf16 a[12:15], v[104:107], v[28:31], a[12:15]
  ds_read_b128 v[64:67], v14 offset:52224
  v_mfma_f32_16x16x32_bf16 a[16:19], v[92:95], v[32:35], a[16:19]
  ds_read_b64_tr_b16 v[112:113], v19 offset:24584
  s_add_u32 m0, s52, 4096
  v_mfma_f32_16x16x32_bf16 a[20:23], v[96:99], v[32:35], a[20:23]
  buffer_load_dwordx4 v6, s[8:11], s20 offen sc1 lds
  ds_read_b64_tr_b16 v[114:115], v19 offset:28680
  v_mfma_f32_16x16x32_bf16 a[24:27], v[100:103], v[32:35], a[24:27]
  ds_read_b128 v[68:71], v14 offset:54272
  v_mfma_f32_16x16x32_bf16 a[28:31], v[104:107], v[32:35], a[28:31]
  ds_read_b64_tr_b16 v[116:117], v20 offset:24576
  v_mfma_f32_16x16x32_bf16 a[32:35], v[92:95], v[36:39], a[32:35]
  ds_read_b64_tr_b16 v[118:119], v20 offset:28672
  v_mfma_f32_16x16x32_bf16 a[36:39], v[96:99], v[36:39], a[36:39]
  ds_read_b128 v[72:75], v14 offset:56320
  s_add_u32 m0, s52, 5120
  v_mfma_f32_16x16x32_bf16 a[40:43], v[100:103], v[36:39], a[40:43]
  buffer_load_dwordx4 v7, s[8:11], s20 offen sc1 lds
  ds_read_b64_tr_b16 v[120:121], v20 offset:24584
  v_mfma_f32_16x16x32_bf16 a[44:47], v[104:107], v[36:39], a[44:47]
  ds_read_b64_tr_b16 v[122:123], v20 offset:28680
  v_mfma_f32_16x16x32_bf16 a[48:51], v[92:95], v[40:43], a[48:51]
  ds_read_b128 v[76:79], v14 offset:58368
  v_mfma_f32_16x16x32_bf16 a[52:55], v[96:99], v[40:43], a[52:55]
  ds_read_b128 v[80:83], v14 offset:60416
  v_mfma_f32_16x16x32_bf16 a[56:59], v[100:103], v[40:43], a[56:59]
  ds_read_b128 v[84:87], v14 offset:62464
  v_mfma_f32_16x16x32_bf16 a[60:63], v[104:107], v[40:43], a[60:63]
  ds_read_b128 v[88:91], v14 offset:64512
  s_add_u32 m0, s52, 6144
  v_mfma_f32_16x16x32_bf16 a[64:67], v[92:95], v[44:47], a[64:67]
  buffer_load_dwordx4 v8, s[8:11], s20 offen sc1 lds
  v_mfma_f32_16x16x32_bf16 a[68:71], v[96:99], v[44:47], a[68:71]
  v_mfma_f32_16x16x32_bf16 a[72:75], v[100:103], v[44:47], a[72:75]
  v_mfma_f32_16x16x32_bf16 a[76:79], v[104:107], v[44:47], a[76:79]
  v_mfma_f32_16x16x32_bf16 a[80:83], v[92:95], v[48:51], a[80:83]
  s_add_u32 m0, s52, 7168
  v_mfma_f32_16x16x32_bf16 a[84:87], v[96:99], v[48:51], a[84:87]
  buffer_load_dwordx4 v9, s[8:11], s20 offen sc1 lds
  v_mfma_f32_16x16x32_bf16 a[88:91], v[100:103], v[48:51], a[88:91]
  v_mfma_f32_16x16x32_bf16 a[92:95], v[104:107], v[48:51], a[92:95]
  v_mfma_f32_16x16x32_bf16 a[96:99], v[92:95], v[52:55], a[96:99]
  v_mfma_f32_16x16x32_bf16 a[100:103], v[96:99], v[52:55], a[100:103]
  s_add_u32 s20, s20, s48
  s_xor_b32 s48, s48, 4096
  v_mfma_f32_16x16x32_bf16 a[104:107], v[100:103], v[52:55], a[104:107]
  s_add_u32 s21, s21, s51
  v_mfma_f32_16x16x32_bf16 a[108:111], v[104:107], v[52:55], a[108:111]
  v_mfma_f32_16x16x32_bf16 a[112:115], v[92:95], v[56:59], a[112:115]
  v_mfma_f32_16x16x32_bf16 a[116:119], v[96:99], v[56:59], a[116:119]
  v_mfma_f32_16x16x32_bf16 a[120:123], v[100:103], v[56:59], a[120:123]
  v_mfma_f32_16x16x32_bf16 a[124:127], v[104:107], v[56:59], a[124:127]
  s_waitcnt lgkmcnt(0)
  v_mfma_f32_16x16x32_bf16 a[0:3], v[108:111], v[60:63], a[0:3]
  s_waitcnt vmcnt(12)
  s_barrier
  s_add_u32 m0, s52, 49152
  v_mfma_f32_16x16x32_bf16 a[4:7], v[112:115], v[60:63], a[4:7]
  buffer_load_dwordx4 v2, s[8:11], s20 offen sc1 lds
  ds_read_b128 v[28:31], v15 offset:32768
  v_mfma_f32_16x16x32_bf16 a[8:11], v[116:119], v[60:63], a[8:11]
  ds_read_b64_tr_b16 v[92:93], v21 offset:0
  v_mfma_f32_16x16x32_bf16 a[12:15], v[120:123], v[60:63], a[12:15]
  ds_read_b64_tr_b16 v[94:95], v21 offset:4096
  v_mfma_f32_16x16x32_bf16 a[16:19], v[108:111], v[64:67], a[16:19]
  ds_read_b128 v[32:35], v15 offset:34816
  s_add_u32 m0, s53, 49152
  v_mfma_f32_16x16x32_bf16 a[20:23], v[112:115], v[64:67], a[20:23]
  buffer_load_dwordx4 v10, s[12:15], s21 offen  lds
  ds_read_b64_tr_b16 v[96:97], v21 offset:8
  v_mfma_f32_16x16x32_bf16 a[24:27], v[116:119], v[64:67], a[24:27]
  ds_read_b64_tr_b16 v[98:99], v21 offset:4104
  v_mfma_f32_16x16x32_bf16 a[28:31], v[120:123], v[64:67], a[28:31]
  ds_read_b128 v[36:39], v15 offset:36864
  v_mfma_f32_16x16x32_bf16 a[32:35], v[108:111], v[68:71], a[32:35]
  ds_read_b64_tr_b16 v[100:101], v22 offset:0
  s_add_u32 m0, s52, 50176
  v_mfma_f32_16x16x32_bf16 a[36:39], v[112:115], v[68:71], a[36:39]
  buffer_load_dwordx4 v3, s[8:11], s20 offen sc1 lds
  ds_read_b64_tr_b16 v[102:103], v22 offset:4096
  v_mfma_f32_16x16x32_bf16 a[40:43], v[116:119], v[68:71], a[40:43]
  ds_read_b128 v[40:43], v15 offset:38912
  v_mfma_f32_16x16x32_bf16 a[44:47], v[120:123], v[68:71], a[44:47]
  ds_read_b64_tr_b16 v[104:105], v22 offset:8
  v_mfma_f32_16x16x32_bf16 a[48:51], v[108:111], v[72:75], a[48:51]
  ds_read_b64_tr_b16 v[106:107], v22 offset:4104
  v_mfma_f32_16x16x32_bf16 a[52:55], v[112:115], v[72:75], a[52:55]
  ds_read_b128 v[44:47], v15 offset:40960
  s_add_u32 m0, s53, 50176
  v_mfma_f32_16x16x32_bf16 a[56:59], v[116:119], v[72:75], a[56:59]
  buffer_load_dwordx4 v11, s[12:15], s21 offen  lds
  ds_read_b128 v[48:51], v15 offset:43008
  v_mfma_f32_16x16x32_bf16 a[60:63], v[120:123], v[72:75], a[60:63]
  ds_read_b128 v[52:55], v15 offset:45056
  v_mfma_f32_16x16x32_bf16 a[64:67], v[108:111], v[76:79], a[64:67]
  ds_read_b128 v[56:59], v15 offset:47104
  v_mfma_f32_16x16x32_bf16 a[68:71], v[112:115], v[76:79], a[68:71]
  s_add_u32 m0, s52, 51200
  v_mfma_f32_16x16x32_bf16 a[72:75], v[116:119], v[76:79], a[72:75]
  buffer_load_dwordx4 v4, s[8:11], s20 offen sc1 lds
  v_mfma_f32_16x16x32_bf16 a[76:79], v[120:123], v[76:79], a[76:79]
  v_mfma_f32_16x16x32_bf16 a[80:83], v[108:111], v[80:83], a[80:83]
  v_mfma_f32_16x16x32_bf16 a[84:87], v[112:115], v[80:83], a[84:87]
  v_mfma_f32_16x16x32_bf16 a[88:91], v[116:119], v[80:83], a[88:91]
  s_add_u32 m0, s53, 51200
  v_mfma_f32_16x16x32_bf16 a[92:95], v[120:123], v[80:83], a[92:95]
  buffer_load_dwordx4 v12, s[12:15], s21 offen  lds
  v_mfma_f32_16x16x32_bf16 a[96:99], v[108:111], v[84:87], a[96:99]
  v_mfma_f32_16x16x32_bf16 a[100:103], v[112:115], v[84:87], a[100:103]
  v_mfma_f32_16x16x32_bf16 a[104:107], v[116:119], v[84:87], a[104:107]
  s_add_u32 m0, s52, 52224
  v_mfma_f32_16x16x32_bf16 a[108:111], v[120:123], v[84:87], a[108:111]
  buffer_load_dwordx4 v5, s[8:11], s20 offen sc1 lds
  v_mfma_f32_16x16x32_bf16 a[112:115], v[108:111], v[88:91], a[112:115]
  v_mfma_f32_16x16x32_bf16 a[116:119], v[112:115], v[88:91], a[116:119]
  v_mfma_f32_16x16x32_bf16 a[120:123], v[116:119], v[88:91], a[120:123]
  v_mfma_f32_16x16x32_bf16 a[124:127], v[120:123], v[88:91], a[124:127]
  s_waitcnt lgkmcnt(0)
  s_add_u32 m0, s53, 52224
  v_mfma_f32_16x16x32_bf16 a[0:3], v[92:95], v[28:31], a[0:3]
  buffer_load_dwordx4 v13, s[12:15], s21 offen  lds
  ds_read_b128 v[60:63], v15 offset:33792
  v_mfma_f32_16x16x32_bf16 a[4:7], v[96:99], v[28:31], a[4:7]
  ds_read_b64_tr_b16 v[108:109], v21 offset:8192
  v_mfma_f32_16x16x32_bf16 a[8:11], v[100:103], v[28:31], a[8:11]
  ds_read_b64_tr_b16 v[110:111], v21 offset:12288
  v_mfma_f32_16x16x32_bf16 a[12:15], v[104:107], v[28:31], a[12:15]
  ds_read_b128 v[64:67], v15 offset:35840
  v_mfma_f32_16x16x32_bf16 a[16:19], v[92:95], v[32:35], a[16:19]
  ds_read_b64_tr_b16 v[112:113], v21 offset:8200
  s_add_u32 m0, s52, 53248
  v_mfma_f32_16x16x32_bf16 a[20:23], v[96:99], v[32:35], a[20:23]
  buffer_load_dwordx4 v6, s[8:11], s20 offen sc1 lds
  ds_read_b64_tr_b16 v[114:115], v21 offset:12296
  v_mfma_f32_16x16x32_bf16 a[24:27], v[100:103], v[32:35], a[24:27]
  ds_read_b128 v[68:71], v15 offset:37888
  v_mfma_f32_16x16x32_bf16 a[28:31], v[104:107], v[32:35], a[28:31]
  ds_read_b64_tr_b16 v[116:117], v22 offset:8192
  v_mfma_f32_16x16x32_bf16 a[32:35], v[92:95], v[36:39], a[32:35]
  ds_read_b64_tr_b16 v[118:119], v22 offset:12288
  v_mfma_f32_16x16x32_bf16 a[36:39], v[96:99], v[36:39], a[36:39]
  ds_read_b128 v[72:75], v15 offset:39936
  s_add_u32 m0, s52, 54272
  v_mfma_f32_16x16x32_bf16 a[40:43], v[100:103], v[36:39], a[40:43]
  buffer_load_dwordx4 v7, s[8:11], s20 offen sc1 lds
  ds_read_b64_tr_b16 v[120:121], v22 offset:8200
  v_mfma_f32_16x16x32_bf16 a[44:47], v[104:107], v[36:39], a[44:47]
  ds_read_b64_tr_b16 v[122:123], v22 offset:12296
  v_mfma_f32_16x16x32_bf16 a[48:51], v[92:95], v[40:43], a[48:51]
  ds_read_b128 v[76:79], v15 offset:41984
  v_mfma_f32_16x16x32_bf16 a[52:55], v[96:99], v[40:43], a[52:55]
  ds_read_b128 v[80:83], v15 offset:44032
  v_mfma_f32_16x16x32_bf16 a[56:59], v[100:103], v[40:43], a[56:59]
  ds_read_b128 v[84:87], v15 offset:46080
  v_mfma_f32_16x16x32_bf16 a[60:63], v[104:107], v[40:43], a[60:63]
  ds_read_b128 v[88:91], v15 offset:48128
  s_add_u32 m0, s52, 55296
  v_mfma_f32_16x16x32_bf16 a[64:67], v[92:95], v[44:47], a[64:67]
  buffer_load_dwordx4 v8, s[8:11], s20 offen sc1 lds
  v_mfma_f32_16x16x32_bf16 a[68:71], v[96:99], v[44:47], a[68:71]
  v_mfma_f32_16x16x32_bf16 a[72:75], v[100:103], v[44:47], a[72:75]
  v_mfma_f32_16x16x32_bf16 a[76:79], v[104:107], v[44:47], a[76:79]
  v_mfma_f32_16x16x32_bf16 a[80:83], v[92:95], v[48:51], a[80:83]
  s_add_u32 m0, s52, 56320
  v_mfma_f32_16x16x32_bf16 a[84:87], v[96:99], v[48:51], a[84:87]
  buffer_load_dwordx4 v9, s[8:11], s20 offen sc1 lds
  v_mfma_f32_16x16x32_bf16 a[88:91], v[100:103], v[48:51], a[88:91]
  v_mfma_f32_16x16x32_bf16 a[92:95], v[104:107], v[48:51], a[92:95]
  v_mfma_f32_16x16x32_bf16 a[96:99], v[92:95], v[52:55], a[96:99]
  v_mfma_f32_16x16x32_bf16 a[100:103], v[96:99], v[52:55], a[100:103]
  s_add_u32 s20, s20, s48
  s_xor_b32 s48, s48, 4096
  v_mfma_f32_16x16x32_bf16 a[104:107], v[100:103], v[52:55], a[104:107]
  s_add_u32 s21, s21, s51
  v_mfma_f32_16x16x32_bf16 a[108:111], v[104:107], v[52:55], a[108:111]
  v_mfma_f32_16x16x32_bf16 a[112:115], v[92:95], v[56:59], a[112:115]
  v_mfma_f32_16x16x32_bf16 a[116:119], v[96:99], v[56:59], a[116:119]
  v_mfma_f32_16x16x32_bf16 a[120:123], v[100:103], v[56:59], a[120:123]
  v_mfma_f32_16x16x32_bf16 a[124:127], v[104:107], v[56:59], a[124:127]
  s_waitcnt lgkmcnt(0)
  v_mfma_f32_16x16x32_bf16 a[0:3], v[108:111], v[60:63], a[0:3]
  s_waitcnt vmcnt(12)
  s_barrier
  s_add_u32 m0, s52, 98304
  v_mfma_f32_16x16x32_bf16 a[4:7], v[112:115], v[60:63], a[4:7]
  buffer_load_dwordx4 v2, s[8:11], s20 offen sc1 lds
  ds_read_b128 v[28:31], v14 offset:0
  v_mfma_f32_16x16x32_bf16 a[8:11], v[116:119], v[60:63], a[8:11]
  ds_read_b64_tr_b16 v[92:93], v17 offset:32768
  v_mfma_f32_16x16x32_bf16 a[12:15], v[120:123], v[60:63], a[12:15]
  ds_read_b64_tr_b16 v[94:95], v17 offset:36864
  v_mfma_f32_16x16x32_bf16 a[16:19], v[108:111], v[64:67], a[16:19]
  ds_read_b128 v[32:35], v14 offset:2048
  s_add_u32 m0, s53, 98304
  v_mfma_f32_16x16x32_bf16 a[20:23], v[112:115], v[64:67], a[20:23]
  buffer_load_dwordx4 v10, s[12:15], s21 offen  lds
  ds_read_b64_tr_b16 v[96:97], v17 offset:32776
  v_mfma_f32_16x16x32_bf16 a[24:27], v[116:119], v[64:67], a[24:27]
  ds_read_b64_tr_b16 v[98:99], v17 offset:36872
  v_mfma_f32_16x16x32_bf16 a[28:31], v[120:123], v[64:67], a[28:31]
  ds_read_b128 v[36:39], v14 offset:4096
  v_mfma_f32_16x16x32_bf16 a[32:35], v[108:111], v[68:71], a[32:35]
  ds_read_b64_tr_b16 v[100:101], v18 offset:32768
  s_add_u32 m0, s52, 99328
  v_mfma_f32_16x16x32_bf16 a[36:39], v[112:115], v[68:71], a[36:39]
  buffer_load_dwordx4 v3, s[8:11], s20 offen sc1 lds
  ds_read_b64_tr_b16 v[102:103], v18 offset:36864
  v_mfma_f32_16x16x32_bf16 a[40:43], v[116:119], v[68:71], a[40:43]
  ds_read_b128 v[40:43], v14 offset:6144
  v_mfma_f32_16x16x32_bf16 a[44:47], v[120:123], v[68:71], a[44:47]
  ds_read_b64_tr_b16 v[104:105], v18 offset:32776
  v_mfma_f32_16x16x32_bf16 a[48:51], v[108:111], v[72:75], a[48:51]
  ds_read_b64_tr_b16 v[106:107], v18 offset:36872
  v_mfma_f32_16x16x32_bf16 a[52:55], v[112:115], v[72:75], a[52:55]
  ds_read_b128 v[44:47], v14 offset:8192
  s_add_u32 m0, s53, 99328
  v_mfma_f32_16x16x32_bf16 a[56:59], v[116:119], v[72:75], a[56:59]
  buffer_load_dwordx4 v11, s[12:15], s21 offen  lds
  ds_read_b128 v[48:51], v14 offset:10240
  v_mfma_f32_16x16x32_bf16 a[60:63], v[120:123], v[72:75], a[60:63]
  ds_read_b128 v[52:55], v14 offset:12288
  v_mfma_f32_16x16x32_bf16 a[64:67], v[108:111], v[76:79], a[64:67]
  ds_read_b128 v[56:59], v14 offset:14336
  v_mfma_f32_16x16x32_bf16 a[68:71], v[112:115], v[76:79], a[68:71]
  s_add_u32 m0, s52, 100352
  v_mfma_f32_16x16x32_bf16 a[72:75], v[116:119], v[76:79], a[72:75]
  buffer_load_dwordx4 v4, s[8:11], s20 offen sc1 lds
  v_mfma_f32_16x16x32_bf16 a[76:79], v[120:123], v[76:79], a[76:79]
  v_mfma_f32_16x16x32_bf16 a[80:83], v[108:111], v[80:83], a[80:83]
  v_mfma_f32_16x16x32_bf16 a[84:87], v[112:115], v[80:83], a[84:87]
  v_mfma_f32_16x16x32_bf16 a[88:91], v[116:119], v[80:83], a[88:91]
  s_add_u32 m0, s53, 100352
  v_mfma_f32_16x16x32_bf16 a[92:95], v[120:123], v[80:83], a[92:95]
  buffer_load_dwordx4 v12, s[12:15], s21 offen  lds
  v_mfma_f32_16x16x32_bf16 a[96:99], v[108:111], v[84:87], a[96:99]
  v_mfma_f32_16x16x32_bf16 a[100:103], v[112:115], v[84:87], a[100:103]
  v_mfma_f32_16x16x32_bf16 a[104:107], v[116:119], v[84:87], a[104:107]
  s_add_u32 m0, s52, 101376
  v_mfma_f32_16x16x32_bf16 a[108:111], v[120:123], v[84:87], a[108:111]
  buffer_load_dwordx4 v5, s[8:11], s20 offen sc1 lds
  v_mfma_f32_16x16x32_bf16 a[112:115], v[108:111], v[88:91], a[112:115]
  v_mfma_f32_16x16x32_bf16 a[116:119], v[112:115], v[88:91], a[116:119]
  v_mfma_f32_16x16x32_bf16 a[120:123], v[116:119], v[88:91], a[120:123]
  v_mfma_f32_16x16x32_bf16 a[124:127], v[120:123], v[88:91], a[124:127]
  s_branch L_g6_loop
L_g6_fin:
  s_cmp_eq_u32 s35, 16
  s_cselect_b32 s90, 999, s34
  s_cmp_lt_u32 s90, 242
  s_cbranch_scc0 L_re_100
  s_cmp_lg_u32 s32, 0
  s_cbranch_scc1 L_rq_101
  s_cmp_eq_u32 s39, 0
  s_cbranch_scc1 L_rq_101
  s_lshl_b32 s99, s33, 7
  s_add_u32 s99, s99, 0x3d00200
  v_mov_b32 v244, 1
  v_mov_b32 v245, 0
  s_mov_b64 exec, 1
  buffer_atomic_add v244, v245, s[4:7], s99 offen sc0 sc1
  s_mov_b64 exec, -1
L_rq_101:
L_re_100:
  s_waitcnt lgkmcnt(0)
  s_add_u32 m0, s53, 101376
  v_mfma_f32_16x16x32_bf16 a[0:3], v[92:95], v[28:31], a[0:3]
  buffer_load_dwordx4 v13, s[12:15], s21 offen  lds
  ds_read_b128 v[60:63], v14 offset:1024
  v_mfma_f32_16x16x32_bf16 a[4:7], v[96:99], v[28:31], a[4:7]
  ds_read_b64_tr_b16 v[108:109], v17 offset:40960
  v_mfma_f32_16x16x32_bf16 a[8:11], v[100:103], v[28:31], a[8:11]
  ds_read_b64_tr_b16 v[110:111], v17 offset:45056
  v_mfma_f32_16x16x32_bf16 a[12:15], v[104:107], v[28:31], a[12:15]
  ds_read_b128 v[64:67], v14 offset:3072
  v_mfma_f32_16x16x32_bf16 a[16:19], v[92:95], v[32:35], a[16:19]
  ds_read_b64_tr_b16 v[112:113], v17 offset:40968
  s_add_u32 m0, s52, 102400
  v_mfma_f32_16x16x32_bf16 a[20:23], v[96:99], v[32:35], a[20:23]
  buffer_load_dwordx4 v6, s[8:11], s20 offen sc1 lds
  ds_read_b64_tr_b16 v[114:115], v17 offset:45064
  v_mfma_f32_16x16x32_bf16 a[24:27], v[100:103], v[32:35], a[24:27]
  ds_read_b128 v[68:71], v14 offset:5120
  v_mfma_f32_16x16x32_bf16 a[28:31], v[104:107], v[32:35], a[28:31]
  ds_read_b64_tr_b16 v[116:117], v18 offset:40960
  v_mfma_f32_16x16x32_bf16 a[32:35], v[92:95], v[36:39], a[32:35]
  ds_read_b64_tr_b16 v[118:119], v18 offset:45056
  v_mfma_f32_16x16x32_bf16 a[36:39], v[96:99], v[36:39], a[36:39]
  ds_read_b128 v[72:75], v14 offset:7168
  s_add_u32 m0, s52, 103424
  v_mfma_f32_16x16x32_bf16 a[40:43], v[100:103], v[36:39], a[40:43]
  buffer_load_dwordx4 v7, s[8:11], s20 offen sc1 lds
  ds_read_b64_tr_b16 v[120:121], v18 offset:40968
  v_mfma_f32_16x16x32_bf16 a[44:47], v[104:107], v[36:39], a[44:47]
  ds_read_b64_tr_b16 v[122:123], v18 offset:45064
  v_mfma_f32_16x16x32_bf16 a[48:51], v[92:95], v[40:43], a[48:51]
  ds_read_b128 v[76:79], v14 offset:9216
  v_mfma_f32_16x16x32_bf16 a[52:55], v[96:99], v[40:43], a[52:55]
  ds_read_b128 v[80:83], v14 offset:11264
  v_mfma_f32_16x16x32_bf16 a[56:59], v[100:103], v[40:43], a[56:59]
  ds_read_b128 v[84:87], v14 offset:13312
  v_mfma_f32_16x16x32_bf16 a[60:63], v[104:107], v[40:43], a[60:63]
  ds_read_b128 v[88:91], v14 offset:15360
  s_add_u32 m0, s52, 104448
  v_mfma_f32_16x16x32_bf16 a[64:67], v[92:95], v[44:47], a[64:67]
  buffer_load_dwordx4 v8, s[8:11], s20 offen sc1 lds
  v_mfma_f32_16x16x32_bf16 a[68:71], v[96:99], v[44:47], a[68:71]
  v_mfma_f32_16x16x32_bf16 a[72:75], v[100:103], v[44:47], a[72:75]
  v_mfma_f32_16x16x32_bf16 a[76:79], v[104:107], v[44:47], a[76:79]
  v_mfma_f32_16x16x32_bf16 a[80:83], v[92:95], v[48:51], a[80:83]
  s_add_u32 m0, s52, 105472
  v_mfma_f32_16x16x32_bf16 a[84:87], v[96:99], v[48:51], a[84:87]
  buffer_load_dwordx4 v9, s[8:11], s20 offen sc1 lds
  v_mfma_f32_16x16x32_bf16 a[88:91], v[100:103], v[48:51], a[88:91]
  v_mfma_f32_16x16x32_bf16 a[92:95], v[104:107], v[48:51], a[92:95]
  v_mfma_f32_16x16x32_bf16 a[96:99], v[92:95], v[52:55], a[96:99]
  v_mfma_f32_16x16x32_bf16 a[100:103], v[96:99], v[52:55], a[100:103]
  s_add_u32 s20, s20, s48
  s_xor_b32 s48, s48, 4096
  v_mfma_f32_16x16x32_bf16 a[104:107], v[100:103], v[52:55], a[104:107]
  s_add_u32 s21, s21, s51
  v_mfma_f32_16x16x32_bf16 a[108:111], v[104:107], v[52:55], a[108:111]
  v_mfma_f32_16x16x32_bf16 a[112:115], v[92:95], v[56:59], a[112:115]
  v_mfma_f32_16x16x32_bf16 a[116:119], v[96:99], v[56:59], a[116:119]
  v_mfma_f32_16x16x32_bf16 a[120:123], v[100:103], v[56:59], a[120:123]
  v_mfma_f32_16x16x32_bf16 a[124:127], v[104:107], v[56:59], a[124:127]
  s_waitcnt lgkmcnt(0)
  v_mfma_f32_16x16x32_bf16 a[0:3], v[108:111], v[60:63], a[0:3]
  s_waitcnt vmcnt(12)
  s_barrier
  s_add_u32 m0, s52, 0
  v_mfma_f32_16x16x32_bf16 a[4:7], v[112:115], v[60:63], a[4:7]
  buffer_load_dwordx4 v2, s[8:11], s20 offen sc1 lds
  ds_read_b128 v[28:31], v14 offset:49152
  v_mfma_f32_16x16x32_bf16 a[8:11], v[116:119], v[60:63], a[8:11]
  ds_read_b64_tr_b16 v[92:93], v19 offset:16384
  v_mfma_f32_16x16x32_bf16 a[12:15], v[120:123], v[60:63], a[12:15]
  ds_read_b64_tr_b16 v[94:95], v19 offset:20480
  v_mfma_f32_16x16x32_bf16 a[16:19], v[108:111], v[64:67], a[16:19]
  ds_read_b128 v[32:35], v14 offset:51200
  s_add_u32 m0, s53, 0
  v_mfma_f32_16x16x32_bf16 a[20:23], v[112:115], v[64:67], a[20:23]
  buffer_load_dwordx4 v10, s[12:15], s21 offen  lds
  ds_read_b64_tr_b16 v[96:97], v19 offset:16392
  v_mfma_f32_16x16x32_bf16 a[24:27], v[116:119], v[64:67], a[24:27]
  ds_read_b64_tr_b16 v[98:99], v19 offset:20488
  v_mfma_f32_16x16x32_bf16 a[28:31], v[120:123], v[64:67], a[28:31]
  ds_read_b128 v[36:39], v14 offset:53248
  v_mfma_f32_16x16x32_bf16 a[32:35], v[108:111], v[68:71], a[32:35]
  ds_read_b64_tr_b16 v[100:101], v20 offset:16384
  s_add_u32 m0, s52, 1024
  v_mfma_f32_16x16x32_bf16 a[36:39], v[112:115], v[68:71], a[36:39]
  buffer_load_dwordx4 v3, s[8:11], s20 offen sc1 lds
  ds_read_b64_tr_b16 v[102:103], v20 offset:20480
  v_mfma_f32_16x16x32_bf16 a[40:43], v[116:119], v[68:71], a[40:43]
  ds_read_b128 v[40:43], v14 offset:55296
  v_mfma_f32_16x16x32_bf16 a[44:47], v[120:123], v[68:71], a[44:47]
  ds_read_b64_tr_b16 v[104:105], v20 offset:16392
  v_mfma_f32_16x16x32_bf16 a[48:51], v[108:111], v[72:75], a[48:51]
  ds_read_b64_tr_b16 v[106:107], v20 offset:20488
  v_mfma_f32_16x16x32_bf16 a[52:55], v[112:115], v[72:75], a[52:55]
  ds_read_b128 v[44:47], v14 offset:57344
  s_add_u32 m0, s53, 1024
  v_mfma_f32_16x16x32_bf16 a[56:59], v[116:119], v[72:75], a[56:59]
  buffer_load_dwordx4 v11, s[12:15], s21 offen  lds
  ds_read_b128 v[48:51], v14 offset:59392
  v_mfma_f32_16x16x32_bf16 a[60:63], v[120:123], v[72:75], a[60:63]
  ds_read_b128 v[52:55], v14 offset:61440
  v_mfma_f32_16x16x32_bf16 a[64:67], v[108:111], v[76:79], a[64:67]
  ds_read_b128 v[56:59], v14 offset:63488
  v_mfma_f32_16x16x32_bf16 a[68:71], v[112:115], v[76:79], a[68:71]
  s_add_u32 m0, s52, 2048
  v_mfma_f32_16x16x32_bf16 a[72:75], v[116:119], v[76:79], a[72:75]
  buffer_load_dwordx4 v4, s[8:11], s20 offen sc1 lds
  v_mfma_f32_16x16x32_bf16 a[76:79], v[120:123], v[76:79], a[76:79]
  v_mfma_f32_16x16x32_bf16 a[80:83], v[108:111], v[80:83], a[80:83]
  v_mfma_f32_16x16x32_bf16 a[84:87], v[112:115], v[80:83], a[84:87]
  v_mfma_f32_16x16x32_bf16 a[88:91], v[116:119], v[80:83], a[88:91]
  s_add_u32 m0, s53, 2048
  v_mfma_f32_16x16x32_bf16 a[92:95], v[120:123], v[80:83], a[92:95]
  buffer_load_dwordx4 v12, s[12:15], s21 offen  lds
  v_mfma_f32_16x16x32_bf16 a[96:99], v[108:111], v[84:87], a[96:99]
  v_mfma_f32_16x16x32_bf16 a[100:103], v[112:115], v[84:87], a[100:103]
  v_mfma_f32_16x16x32_bf16 a[104:107], v[116:119], v[84:87], a[104:107]
  s_add_u32 m0, s52, 3072
  v_mfma_f32_16x16x32_bf16 a[108:111], v[120:123], v[84:87], a[108:111]
  buffer_load_dwordx4 v5, s[8:11], s20 offen sc1 lds
  v_mfma_f32_16x16x32_bf16 a[112:115], v[108:111], v[88:91], a[112:115]
  v_mfma_f32_16x16x32_bf16 a[116:119], v[112:115], v[88:91], a[116:119]
  v_mfma_f32_16x16x32_bf16 a[120:123], v[116:119], v[88:91], a[120:123]
  v_mfma_f32_16x16x32_bf16 a[124:127], v[120:123], v[88:91], a[124:127]
  s_waitcnt lgkmcnt(0)
  s_add_u32 m0, s53, 3072
  v_mfma_f32_16x16x32_bf16 a[0:3], v[92:95], v[28:31], a[0:3]
  buffer_load_dwordx4 v13, s[12:15], s21 offen  lds
  ds_read_b128 v[60:63], v14 offset:50176
  v_mfma_f32_16x16x32_bf16 a[4:7], v[96:99], v[28:31], a[4:7]
  ds_read_b64_tr_b16 v[108:109], v19 offset:24576
  v_mfma_f32_16x16x32_bf16 a[8:11], v[100:103], v[28:31], a[8:11]
  ds_read_b64_tr_b16 v[110:111], v19 offset:28672
  v_mfma_f32_16x16x32_bf16 a[12:15], v[104:107], v[28:31], a[12:15]
  ds_read_b128 v[64:67], v14 offset:52224
  v_mfma_f32_16x16x32_bf16 a[16:19], v[92:95], v[32:35], a[16:19]
  ds_read_b64_tr_b16 v[112:113], v19 offset:24584
  s_add_u32 m0, s52, 4096
  v_mfma_f32_16x16x32_bf16 a[20:23], v[96:99], v[32:35], a[20:23]
  buffer_load_dwordx4 v6, s[8:11], s20 offen sc1 lds
  ds_read_b64_tr_b16 v[114:115], v19 offset:28680
  v_mfma_f32_16x16x32_bf16 a[24:27], v[100:103], v[32:35], a[24:27]
  ds_read_b128 v[68:71], v14 offset:54272
  v_mfma_f32_16x16x32_bf16 a[28:31], v[104:107], v[32:35], a[28:31]
  ds_read_b64_tr_b16 v[116:117], v20 offset:24576
  v_mfma_f32_16x16x32_bf16 a[32:35], v[92:95], v[36:39], a[32:35]
  ds_read_b64_tr_b16 v[118:119], v20 offset:28672
  v_mfma_f32_16x16x32_bf16 a[36:39], v[96:99], v[36:39], a[36:39]
  ds_read_b128 v[72:75], v14 offset:56320
  s_add_u32 m0, s52, 5120
  v_mfma_f32_16x16x32_bf16 a[40:43], v[100:103], v[36:39], a[40:43]
  buffer_load_dwordx4 v7, s[8:11], s20 offen sc1 lds
  ds_read_b64_tr_b16 v[120:121], v20 offset:24584
  v_mfma_f32_16x16x32_bf16 a[44:47], v[104:107], v[36:39], a[44:47]
  ds_read_b64_tr_b16 v[122:123], v20 offset:28680
  v_mfma_f32_16x16x32_bf16 a[48:51], v[92:95], v[40:43], a[48:51]
  ds_read_b128 v[76:79], v14 offset:58368
  v_mfma_f32_16x16x32_bf16 a[52:55], v[96:99], v[40:43], a[52:55]
  ds_read_b128 v[80:83], v14 offset:60416
  v_mfma_f32_16x16x32_bf16 a[56:59], v[100:103], v[40:43], a[56:59]
  ds_read_b128 v[84:87], v14 offset:62464
  v_mfma_f32_16x16x32_bf16 a[60:63], v[104:107], v[40:43], a[60:63]
  ds_read_b128 v[88:91], v14 offset:64512
  s_add_u32 m0, s52, 6144
  v_mfma_f32_16x16x32_bf16 a[64:67], v[92:95], v[44:47], a[64:67]
  buffer_load_dwordx4 v8, s[8:11], s20 offen sc1 lds
  v_mfma_f32_16x16x32_bf16 a[68:71], v[96:99], v[44:47], a[68:71]
  v_mfma_f32_16x16x32_bf16 a[72:75], v[100:103], v[44:47], a[72:75]
  v_mfma_f32_16x16x32_bf16 a[76:79], v[104:107], v[44:47], a[76:79]
  v_mfma_f32_16x16x32_bf16 a[80:83], v[92:95], v[48:51], a[80:83]
  s_add_u32 m0, s52, 7168
  v_mfma_f32_16x16x32_bf16 a[84:87], v[96:99], v[48:51], a[84:87]
  buffer_load_dwordx4 v9, s[8:11], s20 offen sc1 lds
  v_mfma_f32_16x16x32_bf16 a[88:91], v[100:103], v[48:51], a[88:91]
  v_mfma_f32_16x16x32_bf16 a[92:95], v[104:107], v[48:51], a[92:95]
  v_mfma_f32_16x16x32_bf16 a[96:99], v[92:95], v[52:55], a[96:99]
  v_mfma_f32_16x16x32_bf16 a[100:103], v[96:99], v[52:55], a[100:103]
  s_add_u32 s20, s20, s48
  s_xor_b32 s48, s48, 4096
  v_mfma_f32_16x16x32_bf16 a[104:107], v[100:103], v[52:55], a[104:107]
  s_add_u32 s21, s21, s51
  v_mfma_f32_16x16x32_bf16 a[108:111], v[104:107], v[52:55], a[108:111]
  v_mfma_f32_16x16x32_bf16 a[112:115], v[92:95], v[56:59], a[112:115]
  v_mfma_f32_16x16x32_bf16 a[116:119], v[96:99], v[56:59], a[116:119]
  v_mfma_f32_16x16x32_bf16 a[120:123], v[100:103], v[56:59], a[120:123]
  v_mfma_f32_16x16x32_bf16 a[124:127], v[104:107], v[56:59], a[124:127]
  s_waitcnt lgkmcnt(0)
  v_mfma_f32_16x16x32_bf16 a[0:3], v[108:111], v[60:63], a[0:3]
  s_waitcnt vmcnt(12)
  s_barrier
  v_mfma_f32_16x16x32_bf16 a[4:7], v[112:115], v[60:63], a[4:7]
  ds_read_b128 v[28:31], v15 offset:32768
  v_mfma_f32_16x16x32_bf16 a[8:11], v[116:119], v[60:63], a[8:11]
  ds_read_b64_tr_b16 v[92:93], v21 offset:0
  v_mfma_f32_16x16x32_bf16 a[12:15], v[120:123], v[60:63], a[12:15]
  ds_read_b64_tr_b16 v[94:95], v21 offset:4096
  v_mfma_f32_16x16x32_bf16 a[16:19], v[108:111], v[64:67], a[16:19]
  ds_read_b128 v[32:35], v15 offset:34816
  v_mfma_f32_16x16x32_bf16 a[20:23], v[112:115], v[64:67], a[20:23]
  ds_read_b64_tr_b16 v[96:97], v21 offset:8
  v_mfma_f32_16x16x32_bf16 a[24:27], v[116:119], v[64:67], a[24:27]
  ds_read_b64_tr_b16 v[98:99], v21 offset:4104
  v_mfma_f32_16x16x32_bf16 a[28:31], v[120:123], v[64:67], a[28:31]
  ds_read_b128 v[36:39], v15 offset:36864
  v_mfma_f32_16x16x32_bf16 a[32:35], v[108:111], v[68:71], a[32:35]
  ds_read_b64_tr_b16 v[100:101], v22 offset:0
  v_mfma_f32_16x16x32_bf16 a[36:39], v[112:115], v[68:71], a[36:39]
  ds_read_b64_tr_b16 v[102:103], v22 offset:4096
  v_mfma_f32_16x16x32_bf16 a[40:43], v[116:119], v[68:71], a[40:43]
  ds_read_b128 v[40:43], v15 offset:38912
  v_mfma_f32_16x16x32_bf16 a[44:47], v[120:123], v[68:71], a[44:47]
  ds_read_b64_tr_b16 v[104:105], v22 offset:8
  v_mfma_f32_16x16x32_bf16 a[48:51], v[108:111], v[72:75], a[48:51]
  ds_read_b64_tr_b16 v[106:107], v22 offset:4104
  v_mfma_f32_16x16x32_bf16 a[52:55], v[112:115], v[72:75], a[52:55]
  ds_read_b128 v[44:47], v15 offset:40960
  v_mfma_f32_16x16x32_bf16 a[56:59], v[116:119], v[72:75], a[56:59]
  ds_read_b128 v[48:51], v15 offset:43008
  v_mfma_f32_16x16x32_bf16 a[60:63], v[120:123], v[72:75], a[60:63]
  ds_read_b128 v[52:55], v15 offset:45056
  v_mfma_f32_16x16x32_bf16 a[64:67], v[108:111], v[76:79], a[64:67]
  ds_read_b128 v[56:59], v15 offset:47104
  v_mfma_f32_16x16x32_bf16 a[68:71], v[112:115], v[76:79], a[68:71]
  v_mfma_f32_16x16x32_bf16 a[72:75], v[116:119], v[76:79], a[72:75]
  v_mfma_f32_16x16x32_bf16 a[76:79], v[120:123], v[76:79], a[76:79]
  v_mfma_f32_16x16x32_bf16 a[80:83], v[108:111], v[80:83], a[80:83]
  v_mfma_f32_16x16x32_bf16 a[84:87], v[112:115], v[80:83], a[84:87]
  v_mfma_f32_16x16x32_bf16 a[88:91], v[116:119], v[80:83], a[88:91]
  v_mfma_f32_16x16x32_bf16 a[92:95], v[120:123], v[80:83], a[92:95]
  v_mfma_f32_16x16x32_bf16 a[96:99], v[108:111], v[84:87], a[96:99]
  v_mfma_f32_16x16x32_bf16 a[100:103], v[112:115], v[84:87], a[100:103]
  v_mfma_f32_16x16x32_bf16 a[104:107], v[116:119], v[84:87], a[104:107]
  v_mfma_f32_16x16x32_bf16 a[108:111], v[120:123], v[84:87], a[108:111]
  v_mfma_f32_16x16x32_bf16 a[112:115], v[108:111], v[88:91], a[112:115]
  v_mfma_f32_16x16x32_bf16 a[116:119], v[112:115], v[88:91], a[116:119]
  v_mfma_f32_16x16x32_bf16 a[120:123], v[116:119], v[88:91], a[120:123]
  v_mfma_f32_16x16x32_bf16 a[124:127], v[120:123], v[88:91], a[124:127]
  s_waitcnt lgkmcnt(0)
  v_mfma_f32_16x16x32_bf16 a[0:3], v[92:95], v[28:31], a[0:3]
  ds_read_b128 v[60:63], v15 offset:33792
  v_mfma_f32_16x16x32_bf16 a[4:7], v[96:99], v[28:31], a[4:7]
  ds_read_b64_tr_b16 v[108:109], v21 offset:8192
  v_mfma_f32_16x16x32_bf16 a[8:11], v[100:103], v[28:31], a[8:11]
  ds_read_b64_tr_b16 v[110:111], v21 offset:12288
  v_mfma_f32_16x16x32_bf16 a[12:15], v[104:107], v[28:31], a[12:15]
  ds_read_b128 v[64:67], v15 offset:35840
  v_mfma_f32_16x16x32_bf16 a[16:19], v[92:95], v[32:35], a[16:19]
  ds_read_b64_tr_b16 v[112:113], v21 offset:8200
  v_mfma_f32_16x16x32_bf16 a[20:23], v[96:99], v[32:35], a[20:23]
  ds_read_b64_tr_b16 v[114:115], v21 offset:12296
  v_mfma_f32_16x16x32_bf16 a[24:27], v[100:103], v[32:35], a[24:27]
  ds_read_b128 v[68:71], v15 offset:37888
  v_mfma_f32_16x16x32_bf16 a[28:31], v[104:107], v[32:35], a[28:31]
  ds_read_b64_tr_b16 v[116:117], v22 offset:8192
  v_mfma_f32_16x16x32_bf16 a[32:35], v[92:95], v[36:39], a[32:35]
  ds_read_b64_tr_b16 v[118:119], v22 offset:12288
  v_mfma_f32_16x16x32_bf16 a[36:39], v[96:99], v[36:39], a[36:39]
  ds_read_b128 v[72:75], v15 offset:39936
  v_mfma_f32_16x16x32_bf16 a[40:43], v[100:103], v[36:39], a[40:43]
  ds_read_b64_tr_b16 v[120:121], v22 offset:8200
  v_mfma_f32_16x16x32_bf16 a[44:47], v[104:107], v[36:39], a[44:47]
  ds_read_b64_tr_b16 v[122:123], v22 offset:12296
  v_mfma_f32_16x16x32_bf16 a[48:51], v[92:95], v[40:43], a[48:51]
  ds_read_b128 v[76:79], v15 offset:41984
  v_mfma_f32_16x16x32_bf16 a[52:55], v[96:99], v[40:43], a[52:55]
  ds_read_b128 v[80:83], v15 offset:44032
  v_mfma_f32_16x16x32_bf16 a[56:59], v[100:103], v[40:43], a[56:59]
  ds_read_b128 v[84:87], v15 offset:46080
  v_mfma_f32_16x16x32_bf16 a[60:63], v[104:107], v[40:43], a[60:63]
  ds_read_b128 v[88:91], v15 offset:48128
  v_mfma_f32_16x16x32_bf16 a[64:67], v[92:95], v[44:47], a[64:67]
  v_mfma_f32_16x16x32_bf16 a[68:71], v[96:99], v[44:47], a[68:71]
  v_mfma_f32_16x16x32_bf16 a[72:75], v[100:103], v[44:47], a[72:75]
  v_mfma_f32_16x16x32_bf16 a[76:79], v[104:107], v[44:47], a[76:79]
  v_mfma_f32_16x16x32_bf16 a[80:83], v[92:95], v[48:51], a[80:83]
  v_mfma_f32_16x16x32_bf16 a[84:87], v[96:99], v[48:51], a[84:87]
  v_mfma_f32_16x16x32_bf16 a[88:91], v[100:103], v[48:51], a[88:91]
  v_mfma_f32_16x16x32_bf16 a[92:95], v[104:107], v[48:51], a[92:95]
  v_mfma_f32_16x16x32_bf16 a[96:99], v[92:95], v[52:55], a[96:99]
  v_mfma_f32_16x16x32_bf16 a[100:103], v[96:99], v[52:55], a[100:103]
  v_mfma_f32_16x16x32_bf16 a[104:107], v[100:103], v[52:55], a[104:107]
  v_mfma_f32_16x16x32_bf16 a[108:111], v[104:107], v[52:55], a[108:111]
  v_mfma_f32_16x16x32_bf16 a[112:115], v[92:95], v[56:59], a[112:115]
  v_mfma_f32_16x16x32_bf16 a[116:119], v[96:99], v[56:59], a[116:119]
  v_mfma_f32_16x16x32_bf16 a[120:123], v[100:103], v[56:59], a[120:123]
  v_mfma_f32_16x16x32_bf16 a[124:127], v[104:107], v[56:59], a[124:127]
  s_waitcnt lgkmcnt(0)
  v_mfma_f32_16x16x32_bf16 a[0:3], v[108:111], v[60:63], a[0:3]
  s_waitcnt vmcnt(0)
  s_barrier
  v_mfma_f32_16x16x32_bf16 a[4:7], v[112:115], v[60:63], a[4:7]
  ds_read_b128 v[28:31], v14 offset:0
  v_mfma_f32_16x16x32_bf16 a[8:11], v[116:119], v[60:63], a[8:11]
  ds_read_b64_tr_b16 v[92:93], v17 offset:32768
  v_mfma_f32_16x16x32_bf16 a[12:15], v[120:123], v[60:63], a[12:15]
  ds_read_b64_tr_b16 v[94:95], v17 offset:36864
  v_mfma_f32_16x16x32_bf16 a[16:19], v[108:111], v[64:67], a[16:19]
  ds_read_b128 v[32:35], v14 offset:2048
  v_mfma_f32_16x16x32_bf16 a[20:23], v[112:115], v[64:67], a[20:23]
  ds_read_b64_tr_b16 v[96:97], v17 offset:32776
  v_mfma_f32_16x16x32_bf16 a[24:27], v[116:119], v[64:67], a[24:27]
  ds_read_b64_tr_b16 v[98:99], v17 offset:36872
  v_mfma_f32_16x16x32_bf16 a[28:31], v[120:123], v[64:67], a[28:31]
  ds_read_b128 v[36:39], v14 offset:4096
  v_mfma_f32_16x16x32_bf16 a[32:35], v[108:111], v[68:71], a[32:35]
  ds_read_b64_tr_b16 v[100:101], v18 offset:32768
  v_mfma_f32_16x16x32_bf16 a[36:39], v[112:115], v[68:71], a[36:39]
  ds_read_b64_tr_b16 v[102:103], v18 offset:36864
  v_mfma_f32_16x16x32_bf16 a[40:43], v[116:119], v[68:71], a[40:43]
  ds_read_b128 v[40:43], v14 offset:6144
  v_mfma_f32_16x16x32_bf16 a[44:47], v[120:123], v[68:71], a[44:47]
  ds_read_b64_tr_b16 v[104:105], v18 offset:32776
  v_mfma_f32_16x16x32_bf16 a[48:51], v[108:111], v[72:75], a[48:51]
  ds_read_b64_tr_b16 v[106:107], v18 offset:36872
  v_mfma_f32_16x16x32_bf16 a[52:55], v[112:115], v[72:75], a[52:55]
  ds_read_b128 v[44:47], v14 offset:8192
  v_mfma_f32_16x16x32_bf16 a[56:59], v[116:119], v[72:75], a[56:59]
  ds_read_b128 v[48:51], v14 offset:10240
  v_mfma_f32_16x16x32_bf16 a[60:63], v[120:123], v[72:75], a[60:63]
  ds_read_b128 v[52:55], v14 offset:12288
  v_mfma_f32_16x16x32_bf16 a[64:67], v[108:111], v[76:79], a[64:67]
  ds_read_b128 v[56:59], v14 offset:14336
  v_mfma_f32_16x16x32_bf16 a[68:71], v[112:115], v[76:79], a[68:71]
  v_mfma_f32_16x16x32_bf16 a[72:75], v[116:119], v[76:79], a[72:75]
  v_mfma_f32_16x16x32_bf16 a[76:79], v[120:123], v[76:79], a[76:79]
  v_mfma_f32_16x16x32_bf16 a[80:83], v[108:111], v[80:83], a[80:83]
  v_mfma_f32_16x16x32_bf16 a[84:87], v[112:115], v[80:83], a[84:87]
  v_mfma_f32_16x16x32_bf16 a[88:91], v[116:119], v[80:83], a[88:91]
  v_mfma_f32_16x16x32_bf16 a[92:95], v[120:123], v[80:83], a[92:95]
  v_mfma_f32_16x16x32_bf16 a[96:99], v[108:111], v[84:87], a[96:99]
  v_mfma_f32_16x16x32_bf16 a[100:103], v[112:115], v[84:87], a[100:103]
  v_mfma_f32_16x16x32_bf16 a[104:107], v[116:119], v[84:87], a[104:107]
  v_mfma_f32_16x16x32_bf16 a[108:111], v[120:123], v[84:87], a[108:111]
  v_mfma_f32_16x16x32_bf16 a[112:115], v[108:111], v[88:91], a[112:115]
  v_mfma_f32_16x16x32_bf16 a[116:119], v[112:115], v[88:91], a[116:119]
  v_mfma_f32_16x16x32_bf16 a[120:123], v[116:119], v[88:91], a[120:123]
  v_mfma_f32_16x16x32_bf16 a[124:127], v[120:123], v[88:91], a[124:127]
  s_waitcnt lgkmcnt(0)
  v_mfma_f32_16x16x32_bf16 a[0:3], v[92:95], v[28:31], a[0:3]
  ds_read_b128 v[60:63], v14 offset:1024
  v_mfma_f32_16x16x32_bf16 a[4:7], v[96:99], v[28:31], a[4:7]
  ds_read_b64_tr_b16 v[108:109], v17 offset:40960
  v_mfma_f32_16x16x32_bf16 a[8:11], v[100:103], v[28:31], a[8:11]
  ds_read_b64_tr_b16 v[110:111], v17 offset:45056
  v_mfma_f32_16x16x32_bf16 a[12:15], v[104:107], v[28:31], a[12:15]
  ds_read_b128 v[64:67], v14 offset:3072
  v_mfma_f32_16x16x32_bf16 a[16:19], v[92:95], v[32:35], a[16:19]
  ds_read_b64_tr_b16 v[112:113], v17 offset:40968
  v_mfma_f32_16x16x32_bf16 a[20:23], v[96:99], v[32:35], a[20:23]
  ds_read_b64_tr_b16 v[114:115], v17 offset:45064
  v_mfma_f32_16x16x32_bf16 a[24:27], v[100:103], v[32:35], a[24:27]
  ds_read_b128 v[68:71], v14 offset:5120
  v_mfma_f32_16x16x32_bf16 a[28:31], v[104:107], v[32:35], a[28:31]
  ds_read_b64_tr_b16 v[116:117], v18 offset:40960
  v_mfma_f32_16x16x32_bf16 a[32:35], v[92:95], v[36:39], a[32:35]
  ds_read_b64_tr_b16 v[118:119], v18 offset:45056
  v_mfma_f32_16x16x32_bf16 a[36:39], v[96:99], v[36:39], a[36:39]
  ds_read_b128 v[72:75], v14 offset:7168
  v_mfma_f32_16x16x32_bf16 a[40:43], v[100:103], v[36:39], a[40:43]
  ds_read_b64_tr_b16 v[120:121], v18 offset:40968
  v_mfma_f32_16x16x32_bf16 a[44:47], v[104:107], v[36:39], a[44:47]
  ds_read_b64_tr_b16 v[122:123], v18 offset:45064
  v_mfma_f32_16x16x32_bf16 a[48:51], v[92:95], v[40:43], a[48:51]
  ds_read_b128 v[76:79], v14 offset:9216
  v_mfma_f32_16x16x32_bf16 a[52:55], v[96:99], v[40:43], a[52:55]
  ds_read_b128 v[80:83], v14 offset:11264
  v_mfma_f32_16x16x32_bf16 a[56:59], v[100:103], v[40:43], a[56:59]
  ds_read_b128 v[84:87], v14 offset:13312
  v_mfma_f32_16x16x32_bf16 a[60:63], v[104:107], v[40:43], a[60:63]
  ds_read_b128 v[88:91], v14 offset:15360
  v_mfma_f32_16x16x32_bf16 a[64:67], v[92:95], v[44:47], a[64:67]
  v_mfma_f32_16x16x32_bf16 a[68:71], v[96:99], v[44:47], a[68:71]
  v_mfma_f32_16x16x32_bf16 a[72:75], v[100:103], v[44:47], a[72:75]
  v_mfma_f32_16x16x32_bf16 a[76:79], v[104:107], v[44:47], a[76:79]
  v_mfma_f32_16x16x32_bf16 a[80:83], v[92:95], v[48:51], a[80:83]
  v_mfma_f32_16x16x32_bf16 a[84:87], v[96:99], v[48:51], a[84:87]
  v_mfma_f32_16x16x32_bf16 a[88:91], v[100:103], v[48:51], a[88:91]
  v_mfma_f32_16x16x32_bf16 a[92:95], v[104:107], v[48:51], a[92:95]
  v_mfma_f32_16x16x32_bf16 a[96:99], v[92:95], v[52:55], a[96:99]
  v_mfma_f32_16x16x32_bf16 a[100:103], v[96:99], v[52:55], a[100:103]
  v_mfma_f32_16x16x32_bf16 a[104:107], v[100:103], v[52:55], a[104:107]
  v_mfma_f32_16x16x32_bf16 a[108:111], v[104:107], v[52:55], a[108:111]
  v_mfma_f32_16x16x32_bf16 a[112:115], v[92:95], v[56:59], a[112:115]
  v_mfma_f32_16x16x32_bf16 a[116:119], v[96:99], v[56:59], a[116:119]
  v_mfma_f32_16x16x32_bf16 a[120:123], v[100:103], v[56:59], a[120:123]
  v_mfma_f32_16x16x32_bf16 a[124:127], v[104:107], v[56:59], a[124:127]
  s_waitcnt lgkmcnt(0)
  v_mfma_f32_16x16x32_bf16 a[0:3], v[108:111], v[60:63], a[0:3]
  v_mfma_f32_16x16x32_bf16 a[4:7], v[112:115], v[60:63], a[4:7]
  v_mfma_f32_16x16x32_bf16 a[8:11], v[116:119], v[60:63], a[8:11]
  v_mfma_f32_16x16x32_bf16 a[12:15], v[120:123], v[60:63], a[12:15]
  v_mfma_f32_16x16x32_bf16 a[16:19], v[108:111], v[64:67], a[16:19]
  v_mfma_f32_16x16x32_bf16 a[20:23], v[112:115], v[64:67], a[20:23]
  v_mfma_f32_16x16x32_bf16 a[24:27], v[116:119], v[64:67], a[24:27]
  v_mfma_f32_16x16x32_bf16 a[28:31], v[120:123], v[64:67], a[28:31]
  v_mfma_f32_16x16x32_bf16 a[32:35], v[108:111], v[68:71], a[32:35]
  v_mfma_f32_16x16x32_bf16 a[36:39], v[112:115], v[68:71], a[36:39]
  v_mfma_f32_16x16x32_bf16 a[40:43], v[116:119], v[68:71], a[40:43]
  v_mfma_f32_16x16x32_bf16 a[44:47], v[120:123], v[68:71], a[44:47]
  v_mfma_f32_16x16x32_bf16 a[48:51], v[108:111], v[72:75], a[48:51]
  v_mfma_f32_16x16x32_bf16 a[52:55], v[112:115], v[72:75], a[52:55]
  v_mfma_f32_16x16x32_bf16 a[56:59], v[116:119], v[72:75], a[56:59]
  v_mfma_f32_16x16x32_bf16 a[60:63], v[120:123], v[72:75], a[60:63]
  v_mfma_f32_16x16x32_bf16 a[64:67], v[108:111], v[76:79], a[64:67]
  v_mfma_f32_16x16x32_bf16 a[68:71], v[112:115], v[76:79], a[68:71]
  v_mfma_f32_16x16x32_bf16 a[72:75], v[116:119], v[76:79], a[72:75]
  v_mfma_f32_16x16x32_bf16 a[76:79], v[120:123], v[76:79], a[76:79]
  v_mfma_f32_16x16x32_bf16 a[80:83], v[108:111], v[80:83], a[80:83]
  v_mfma_f32_16x16x32_bf16 a[84:87], v[112:115], v[80:83], a[84:87]
  v_mfma_f32_16x16x32_bf16 a[88:91], v[116:119], v[80:83], a[88:91]
  v_mfma_f32_16x16x32_bf16 a[92:95], v[120:123], v[80:83], a[92:95]
  v_mfma_f32_16x16x32_bf16 a[96:99], v[108:111], v[84:87], a[96:99]
  v_mfma_f32_16x16x32_bf16 a[100:103], v[112:115], v[84:87], a[100:103]
  v_mfma_f32_16x16x32_bf16 a[104:107], v[116:119], v[84:87], a[104:107]
  v_mfma_f32_16x16x32_bf16 a[108:111], v[120:123], v[84:87], a[108:111]
  v_mfma_f32_16x16x32_bf16 a[112:115], v[108:111], v[88:91], a[112:115]
  v_mfma_f32_16x16x32_bf16 a[116:119], v[112:115], v[88:91], a[116:119]
  v_mfma_f32_16x16x32_bf16 a[120:123], v[116:119], v[88:91], a[120:123]
  v_mfma_f32_16x16x32_bf16 a[124:127], v[120:123], v[88:91], a[124:127]
  s_mov_b32 s59, 6
  s_mov_b32 s60, s22
  s_mov_b32 s61, s26
  s_add_u32 s62, s38, 0x3d00000
  s_mov_b32 s63, s98
  s_cmp_eq_u32 s35, 16
  s_cselect_b32 s90, 999, s34
  s_cmp_lt_u32 s90, 242
  s_cbranch_scc1 L_got
  s_mov_b32 s58, 3
  s_branch L_epi
L_g3c:
  v_and_b32 v1, 63, v0
  v_lshrrev_b32 v16, 6, v0
  s_nop 0
  v_readfirstlane_b32 s27, v16
  s_mul_i32 s90, s27, 1
  s_mul_i32 s90, s90, s23
  v_mov_b32 v2, 0x0
  v_bfe_u32 v17, v1, 0, 6
  v_lshl_add_u32 v2, v17, 4, v2
  v_add_u32 v2, s90, v2
  v_mov_b32 v3, 0x400
  v_bfe_u32 v17, v1, 0, 6
  v_lshl_add_u32 v3, v17, 4, v3
  v_add_u32 v3, s90, v3
  v_mov_b32 v4, 0x1000
  v_bfe_u32 v17, v1, 0, 6
  v_lshl_add_u32 v4, v17, 4, v4
  v_add_u32 v4, s90, v4
  v_mov_b32 v5, 0x1400
  v_bfe_u32 v17, v1, 0, 6
  v_lshl_add_u32 v5, v17, 4, v5
  v_add_u32 v5, s90, v5
  s_mul_i32 s90, s27, 16
  v_lshrrev_b32 v16, 4, v1
  v_add_u32 v16, 0, v16
  v_add_u32 v16, s90, v16
  v_and_b32 v17, 7, v16
  v_lshlrev_b32 v17, 1, v17
  v_xor_b32 v17, v17, v1
  v_and_b32 v17, 15, v17
  v_mul_lo_u32 v16, v16, s24
  v_lshl_add_u32 v6, v17, 4, v16
  v_lshrrev_b32 v16, 4, v1
  v_add_u32 v16, 4, v16
  v_add_u32 v16, s90, v16
  v_and_b32 v17, 7, v16
  v_lshlrev_b32 v17, 1, v17
  v_xor_b32 v17, v17, v1
  v_and_b32 v17, 15, v17
  v_mul_lo_u32 v16, v16, s24
  v_lshl_add_u32 v7, v17, 4, v16
  v_lshrrev_b32 v16, 4, v1
  v_add_u32 v16, 8, v16
  v_add_u32 v16, s90, v16
  v_and_b32 v17, 7, v16
  v_lshlrev_b32 v17, 1, v17
  v_xor_b32 v17, v17, v1
  v_and_b32 v17, 15, v17
  v_mul_lo_u32 v16, v16, s24
  v_lshl_add_u32 v8, v17, 4, v16
  v_lshrrev_b32 v16, 4, v1
  v_add_u32 v16, 12, v16
  v_add_u32 v16, s90, v16
  v_and_b32 v17, 7, v16
  v_lshlrev_b32 v17, 1, v17
  v_xor_b32 v17, v17, v1
  v_and_b32 v17, 15, v17
  v_mul_lo_u32 v16, v16, s24
  v_lshl_add_u32 v9, v17, 4, v16
  s_mul_i32 s51, s24, 64
  s_mul_i32 s52, s27, 4096
  s_mul_i32 s53, s27, 4096
  s_add_u32 s53, s53, 16384
  s_add_u32 m0, s53, 0
  s_nop 0
  buffer_load_dwordx4 v6, s[12:15], s21 offen  lds
  s_add_u32 m0, s53, 1024
  s_nop 0
  buffer_load_dwordx4 v7, s[12:15], s21 offen  lds
  s_add_u32 m0, s53, 2048
  s_nop 0
  buffer_load_dwordx4 v8, s[12:15], s21 offen  lds
  s_add_u32 m0, s53, 3072
  s_nop 0
  buffer_load_dwordx4 v9, s[12:15], s21 offen  lds
  s_add_u32 s21, s21, s51
  s_add_u32 m0, s53, 32768
  s_nop 0
  buffer_load_dwordx4 v6, s[12:15], s21 offen  lds
  s_add_u32 m0, s53, 33792
  s_nop 0
  buffer_load_dwordx4 v7, s[12:15], s21 offen  lds
  s_add_u32 m0, s53, 34816
  s_nop 0
  buffer_load_dwordx4 v8, s[12:15], s21 offen  lds
  s_add_u32 m0, s53, 35840
  s_nop 0
  buffer_load_dwordx4 v9, s[12:15], s21 offen  lds
  s_add_u32 s21, s21, s51
  s_add_u32 m0, s53, 65536
  s_nop 0
  buffer_load_dwordx4 v6, s[12:15], s21 offen  lds
  s_add_u32 m0, s53, 66560
  s_nop 0
  buffer_load_dwordx4 v7, s[12:15], s21 offen  lds
  s_add_u32 m0, s53, 67584
  s_nop 0
  buffer_load_dwordx4 v8, s[12:15], s21 offen  lds
  s_add_u32 m0, s53, 68608
  s_nop 0
  buffer_load_dwordx4 v9, s[12:15], s21 offen  lds
  s_add_u32 s21, s21, s51
  s_add_u32 m0, s53, 98304
  s_nop 0
  buffer_load_dwordx4 v6, s[12:15], s21 offen  lds
  s_add_u32 m0, s53, 99328
  s_nop 0
  buffer_load_dwordx4 v7, s[12:15], s21 offen  lds
  s_add_u32 m0, s53, 100352
  s_nop 0
  buffer_load_dwordx4 v8, s[12:15], s21 offen  lds
  s_add_u32 m0, s53, 101376
  s_nop 0
  buffer_load_dwordx4 v9, s[12:15], s21 offen  lds
  s_add_u32 s21, s21, s51
  s_cmp_lg_u32 s32, 0
  s_cbranch_scc1 L_dd_103
  v_mov_b32 v228, 0x3d00000
  v_mov_b32 v229, 0x3d01000
L_dw_102:
  buffer_load_dword v234, v228, s[4:7], s40 offen offset:0 sc1
  buffer_load_dword v235, v228, s[4:7], s42 offen offset:0 sc1
  buffer_load_dword v236, v229, s[4:7], 0 offen offset:1024 sc1
  s_waitcnt vmcnt(0)
  s_mov_b32 s44, 1
  v_readfirstlane_b32 s45, v234
  s_cmp_ge_u32 s45, s41
  s_cselect_b32 s44, s44, 0
  v_readfirstlane_b32 s45, v235
  s_cmp_ge_u32 s45, s41
  s_cselect_b32 s44, s44, 0
  v_readfirstlane_b32 s45, v236
  s_cmp_ge_u32 s45, 16
  s_cselect_b32 s44, s44, 0
  s_cmp_eq_u32 s44, 1
  s_cbranch_scc1 L_dd_103
  s_sleep 3
  s_add_u32 s3, s3, 1
  s_cmp_lt_u32 s3, 131072
  s_cbranch_scc1 L_dw_102
L_dd_103:
  s_barrier
  s_add_u32 m0, s52, 0
  s_nop 0
  buffer_load_dwordx4 v2, s[8:11], s20 offen sc1 lds
  s_add_u32 m0, s52, 1024
  s_nop 0
  buffer_load_dwordx4 v3, s[8:11], s20 offen sc1 lds
  s_add_u32 m0, s52, 2048
  s_nop 0
  buffer_load_dwordx4 v4, s[8:11], s20 offen sc1 lds
  s_add_u32 m0, s52, 3072
  s_nop 0
  buffer_load_dwordx4 v5, s[8:11], s20 offen sc1 lds
  s_add_u32 s20, s20, 2048
  s_add_u32 m0, s52, 32768
  s_nop 0
  buffer_load_dwordx4 v2, s[8:11], s20 offen sc1 lds
  s_add_u32 m0, s52, 33792
  s_nop 0
  buffer_load_dwordx4 v3, s[8:11], s20 offen sc1 lds
  s_add_u32 m0, s52, 34816
  s_nop 0
  buffer_load_dwordx4 v4, s[8:11], s20 offen sc1 lds
  s_add_u32 m0, s52, 35840
  s_nop 0
  buffer_load_dwordx4 v5, s[8:11], s20 offen sc1 lds
  s_add_u32 s20, s20, 6144
  s_add_u32 m0, s52, 65536
  s_nop 0
  buffer_load_dwordx4 v2, s[8:11], s20 offen sc1 lds
  s_add_u32 m0, s52, 66560
  s_nop 0
  buffer_load_dwordx4 v3, s[8:11], s20 offen sc1 lds
  s_add_u32 m0, s52, 67584
  s_nop 0
  buffer_load_dwordx4 v4, s[8:11], s20 offen sc1 lds
  s_add_u32 m0, s52, 68608
  s_nop 0
  buffer_load_dwordx4 v5, s[8:11], s20 offen sc1 lds
  s_add_u32 s20, s20, 2048
  s_add_u32 m0, s52, 98304
  s_nop 0
  buffer_load_dwordx4 v2, s[8:11], s20 offen sc1 lds
  s_add_u32 m0, s52, 99328
  s_nop 0
  buffer_load_dwordx4 v3, s[8:11], s20 offen sc1 lds
  s_add_u32 m0, s52, 100352
  s_nop 0
  buffer_load_dwordx4 v4, s[8:11], s20 offen sc1 lds
  s_add_u32 m0, s52, 101376
  s_nop 0
  buffer_load_dwordx4 v5, s[8:11], s20 offen sc1 lds
  s_add_u32 s20, s20, 6144
  s_lshr_b32 s90, s27, 1
  s_and_b32 s91, s27, 1
  s_mul_i32 s92, s90, 8192
  v_mov_b32 v10, 0x0
  v_bfe_u32 v17, v1, 0, 6
  v_lshl_add_u32 v10, v17, 4, v10
  v_add_u32 v10, s92, v10
  v_add_u32 v11, 65536, v10
  v_mov_b32 v16, 0x0
  v_bfe_u32 v17, v1, 2, 2
  v_lshl_add_u32 v16, v17, 8, v16
  v_bfe_u32 v17, v1, 4, 2
  v_lshl_add_u32 v16, v17, 10, v16
  v_bfe_u32 v17, v1, 0, 1
  v_lshl_add_u32 v16, v17, 4, v16
  v_bfe_u32 v18, v1, 2, 3
  v_bfe_u32 v17, v1, 1, 1
  v_xor_b32 v18, v18, v17
  s_mul_i32 s92, s91, 4
  s_add_u32 s93, s92, 0
  v_xor_b32 v17, s93, v18
  v_lshl_add_u32 v12, v17, 5, v16
  v_add_u32 v14, 65536, v12
  s_add_u32 s93, s92, 2
  v_xor_b32 v17, s93, v18
  v_lshl_add_u32 v13, v17, 5, v16
  v_add_u32 v15, 65536, v13
  s_waitcnt vmcnt(12)
  s_barrier
  ds_read_b128 v[20:23], v10 offset:0
  ds_read_b64_tr_b16 v[52:53], v12 offset:16384
  ds_read_b64_tr_b16 v[54:55], v12 offset:20480
  ds_read_b128 v[24:27], v10 offset:2048
  ds_read_b64_tr_b16 v[56:57], v12 offset:16392
  ds_read_b64_tr_b16 v[58:59], v12 offset:20488
  ds_read_b128 v[28:31], v10 offset:4096
  ds_read_b64_tr_b16 v[60:61], v13 offset:16384
  ds_read_b64_tr_b16 v[62:63], v13 offset:20480
  ds_read_b128 v[32:35], v10 offset:6144
  ds_read_b64_tr_b16 v[64:65], v13 offset:16392
  ds_read_b64_tr_b16 v[66:67], v13 offset:20488
  s_sub_u32 s25, s25, 1
  s_waitcnt lgkmcnt(0)
  v_mfma_f32_16x16x32_bf16 a[0:3], v[52:55], v[20:23], 0
  ds_read_b128 v[36:39], v10 offset:1024
  v_mfma_f32_16x16x32_bf16 a[4:7], v[56:59], v[20:23], 0
  ds_read_b64_tr_b16 v[68:69], v12 offset:24576
  v_mfma_f32_16x16x32_bf16 a[8:11], v[60:63], v[20:23], 0
  ds_read_b64_tr_b16 v[70:71], v12 offset:28672
  v_mfma_f32_16x16x32_bf16 a[12:15], v[64:67], v[20:23], 0
  ds_read_b128 v[40:43], v10 offset:3072
  v_mfma_f32_16x16x32_bf16 a[16:19], v[52:55], v[24:27], 0
  ds_read_b64_tr_b16 v[72:73], v12 offset:24584
  v_mfma_f32_16x16x32_bf16 a[20:23], v[56:59], v[24:27], 0
  ds_read_b64_tr_b16 v[74:75], v12 offset:28680
  v_mfma_f32_16x16x32_bf16 a[24:27], v[60:63], v[24:27], 0
  ds_read_b128 v[44:47], v10 offset:5120
  v_mfma_f32_16x16x32_bf16 a[28:31], v[64:67], v[24:27], 0
  ds_read_b64_tr_b16 v[76:77], v13 offset:24576
  v_mfma_f32_16x16x32_bf16 a[32:35], v[52:55], v[28:31], 0
  ds_read_b64_tr_b16 v[78:79], v13 offset:28672
  v_mfma_f32_16x16x32_bf16 a[36:39], v[56:59], v[28:31], 0
  ds_read_b128 v[48:51], v10 offset:7168
  v_mfma_f32_16x16x32_bf16 a[40:43], v[60:63], v[28:31], 0
  ds_read_b64_tr_b16 v[80:81], v13 offset:24584
  v_mfma_f32_16x16x32_bf16 a[44:47], v[64:67], v[28:31], 0
  ds_read_b64_tr_b16 v[82:83], v13 offset:28680
  v_mfma_f32_16x16x32_bf16 a[48:51], v[52:55], v[32:35], 0
  v_mfma_f32_16x16x32_bf16 a[52:55], v[56:59], v[32:35], 0
  v_mfma_f32_16x16x32_bf16 a[56:59], v[60:63], v[32:35], 0
  v_mfma_f32_16x16x32_bf16 a[60:63], v[64:67], v[32:35], 0
  s_waitcnt lgkmcnt(0)
  v_mfma_f32_16x16x32_bf16 a[0:3], v[68:71], v[36:39], a[0:3]
  s_waitcnt vmcnt(8)
  s_barrier
  s_add_u32 m0, s52, 0
  v_mfma_f32_16x16x32_bf16 a[4:7], v[72:75], v[36:39], a[4:7]
  buffer_load_dwordx4 v2, s[8:11], s20 offen sc1 lds
  ds_read_b128 v[20:23], v10 offset:32768
  v_mfma_f32_16x16x32_bf16 a[8:11], v[76:79], v[36:39], a[8:11]
  ds_read_b64_tr_b16 v[52:53], v12 offset:49152
  v_mfma_f32_16x16x32_bf16 a[12:15], v[80:83], v[36:39], a[12:15]
  ds_read_b64_tr_b16 v[54:55], v12 offset:53248
  s_add_u32 m0, s53, 0
  v_mfma_f32_16x16x32_bf16 a[16:19], v[68:71], v[40:43], a[16:19]
  buffer_load_dwordx4 v6, s[12:15], s21 offen  lds
  ds_read_b128 v[24:27], v10 offset:34816
  v_mfma_f32_16x16x32_bf16 a[20:23], v[72:75], v[40:43], a[20:23]
  ds_read_b64_tr_b16 v[56:57], v12 offset:49160
  v_mfma_f32_16x16x32_bf16 a[24:27], v[76:79], v[40:43], a[24:27]
  ds_read_b64_tr_b16 v[58:59], v12 offset:53256
  s_add_u32 m0, s52, 1024
  v_mfma_f32_16x16x32_bf16 a[28:31], v[80:83], v[40:43], a[28:31]
  buffer_load_dwordx4 v3, s[8:11], s20 offen sc1 lds
  ds_read_b128 v[28:31], v10 offset:36864
  v_mfma_f32_16x16x32_bf16 a[32:35], v[68:71], v[44:47], a[32:35]
  ds_read_b64_tr_b16 v[60:61], v13 offset:49152
  v_mfma_f32_16x16x32_bf16 a[36:39], v[72:75], v[44:47], a[36:39]
  ds_read_b64_tr_b16 v[62:63], v13 offset:53248
  s_add_u32 m0, s53, 1024
  v_mfma_f32_16x16x32_bf16 a[40:43], v[76:79], v[44:47], a[40:43]
  buffer_load_dwordx4 v7, s[12:15], s21 offen  lds
  ds_read_b128 v[32:35], v10 offset:38912
  v_mfma_f32_16x16x32_bf16 a[44:47], v[80:83], v[44:47], a[44:47]
  ds_read_b64_tr_b16 v[64:65], v13 offset:49160
  v_mfma_f32_16x16x32_bf16 a[48:51], v[68:71], v[48:51], a[48:51]
  ds_read_b64_tr_b16 v[66:67], v13 offset:53256
  s_add_u32 m0, s52, 2048
  v_mfma_f32_16x16x32_bf16 a[52:55], v[72:75], v[48:51], a[52:55]
  buffer_load_dwordx4 v4, s[8:11], s20 offen sc1 lds
  v_mfma_f32_16x16x32_bf16 a[56:59], v[76:79], v[48:51], a[56:59]
  v_mfma_f32_16x16x32_bf16 a[60:63], v[80:83], v[48:51], a[60:63]
  s_waitcnt lgkmcnt(0)
  s_add_u32 m0, s53, 2048
  v_mfma_f32_16x16x32_bf16 a[0:3], v[52:55], v[20:23], a[0:3]
  buffer_load_dwordx4 v8, s[12:15], s21 offen  lds
  ds_read_b128 v[36:39], v10 offset:33792
  v_mfma_f32_16x16x32_bf16 a[4:7], v[56:59], v[20:23], a[4:7]
  ds_read_b64_tr_b16 v[68:69], v12 offset:57344
  v_mfma_f32_16x16x32_bf16 a[8:11], v[60:63], v[20:23], a[8:11]
  ds_read_b64_tr_b16 v[70:71], v12 offset:61440
  v_mfma_f32_16x16x32_bf16 a[12:15], v[64:67], v[20:23], a[12:15]
  ds_read_b128 v[40:43], v10 offset:35840
  s_add_u32 m0, s52, 3072
  v_mfma_f32_16x16x32_bf16 a[16:19], v[52:55], v[24:27], a[16:19]
  buffer_load_dwordx4 v5, s[8:11], s20 offen sc1 lds
  ds_read_b64_tr_b16 v[72:73], v12 offset:57352
  v_mfma_f32_16x16x32_bf16 a[20:23], v[56:59], v[24:27], a[20:23]
  ds_read_b64_tr_b16 v[74:75], v12 offset:61448
  v_mfma_f32_16x16x32_bf16 a[24:27], v[60:63], v[24:27], a[24:27]
  ds_read_b128 v[44:47], v10 offset:37888
  v_mfma_f32_16x16x32_bf16 a[28:31], v[64:67], v[24:27], a[28:31]
  ds_read_b64_tr_b16 v[76:77], v13 offset:57344
  s_add_u32 m0, s53, 3072
  v_mfma_f32_16x16x32_bf16 a[32:35], v[52:55], v[28:31], a[32:35]
  buffer_load_dwordx4 v9, s[12:15], s21 offen  lds
  ds_read_b64_tr_b16 v[78:79], v13 offset:61440
  v_mfma_f32_16x16x32_bf16 a[36:39], v[56:59], v[28:31], a[36:39]
  ds_read_b128 v[48:51], v10 offset:39936
  v_mfma_f32_16x16x32_bf16 a[40:43], v[60:63], v[28:31], a[40:43]
  ds_read_b64_tr_b16 v[80:81], v13 offset:57352
  v_mfma_f32_16x16x32_bf16 a[44:47], v[64:67], v[28:31], a[44:47]
  ds_read_b64_tr_b16 v[82:83], v13 offset:61448
  s_add_u32 s20, s20, 2048
  v_mfma_f32_16x16x32_bf16 a[48:51], v[52:55], v[32:35], a[48:51]
  s_add_u32 s21, s21, s51
  v_mfma_f32_16x16x32_bf16 a[52:55], v[56:59], v[32:35], a[52:55]
  v_mfma_f32_16x16x32_bf16 a[56:59], v[60:63], v[32:35], a[56:59]
  v_mfma_f32_16x16x32_bf16 a[60:63], v[64:67], v[32:35], a[60:63]
  s_waitcnt lgkmcnt(0)
  v_mfma_f32_16x16x32_bf16 a[0:3], v[68:71], v[36:39], a[0:3]
  s_waitcnt vmcnt(12)
  s_barrier
  s_add_u32 m0, s52, 32768
  v_mfma_f32_16x16x32_bf16 a[4:7], v[72:75], v[36:39], a[4:7]
  buffer_load_dwordx4 v2, s[8:11], s20 offen sc1 lds
  ds_read_b128 v[20:23], v11 offset:0
  v_mfma_f32_16x16x32_bf16 a[8:11], v[76:79], v[36:39], a[8:11]
  ds_read_b64_tr_b16 v[52:53], v14 offset:16384
  v_mfma_f32_16x16x32_bf16 a[12:15], v[80:83], v[36:39], a[12:15]
  ds_read_b64_tr_b16 v[54:55], v14 offset:20480
  s_add_u32 m0, s53, 32768
  v_mfma_f32_16x16x32_bf16 a[16:19], v[68:71], v[40:43], a[16:19]
  buffer_load_dwordx4 v6, s[12:15], s21 offen  lds
  ds_read_b128 v[24:27], v11 offset:2048
  v_mfma_f32_16x16x32_bf16 a[20:23], v[72:75], v[40:43], a[20:23]
  ds_read_b64_tr_b16 v[56:57], v14 offset:16392
  v_mfma_f32_16x16x32_bf16 a[24:27], v[76:79], v[40:43], a[24:27]
  ds_read_b64_tr_b16 v[58:59], v14 offset:20488
  s_add_u32 m0, s52, 33792
  v_mfma_f32_16x16x32_bf16 a[28:31], v[80:83], v[40:43], a[28:31]
  buffer_load_dwordx4 v3, s[8:11], s20 offen sc1 lds
  ds_read_b128 v[28:31], v11 offset:4096
  v_mfma_f32_16x16x32_bf16 a[32:35], v[68:71], v[44:47], a[32:35]
  ds_read_b64_tr_b16 v[60:61], v15 offset:16384
  v_mfma_f32_16x16x32_bf16 a[36:39], v[72:75], v[44:47], a[36:39]
  ds_read_b64_tr_b16 v[62:63], v15 offset:20480
  s_add_u32 m0, s53, 33792
  v_mfma_f32_16x16x32_bf16 a[40:43], v[76:79], v[44:47], a[40:43]
  buffer_load_dwordx4 v7, s[12:15], s21 offen  lds
  ds_read_b128 v[32:35], v11 offset:6144
  v_mfma_f32_16x16x32_bf16 a[44:47], v[80:83], v[44:47], a[44:47]
  ds_read_b64_tr_b16 v[64:65], v15 offset:16392
  v_mfma_f32_16x16x32_bf16 a[48:51], v[68:71], v[48:51], a[48:51]
  ds_read_b64_tr_b16 v[66:67], v15 offset:20488
  s_add_u32 m0, s52, 34816
  v_mfma_f32_16x16x32_bf16 a[52:55], v[72:75], v[48:51], a[52:55]
  buffer_load_dwordx4 v4, s[8:11], s20 offen sc1 lds
  v_mfma_f32_16x16x32_bf16 a[56:59], v[76:79], v[48:51], a[56:59]
  v_mfma_f32_16x16x32_bf16 a[60:63], v[80:83], v[48:51], a[60:63]
  s_waitcnt lgkmcnt(0)
  s_add_u32 m0, s53, 34816
  v_mfma_f32_16x16x32_bf16 a[0:3], v[52:55], v[20:23], a[0:3]
  buffer_load_dwordx4 v8, s[12:15], s21 offen  lds
  ds_read_b128 v[36:39], v11 offset:1024
  v_mfma_f32_16x16x32_bf16 a[4:7], v[56:59], v[20:23], a[4:7]
  ds_read_b64_tr_b16 v[68:69], v14 offset:24576
  v_mfma_f32_16x16x32_bf16 a[8:11], v[60:63], v[20:23], a[8:11]
  ds_read_b64_tr_b16 v[70:71], v14 offset:28672
  v_mfma_f32_16x16x32_bf16 a[12:15], v[64:67], v[20:23], a[12:15]
  ds_read_b128 v[40:43], v11 offset:3072
  s_add_u32 m0, s52, 35840
  v_mfma_f32_16x16x32_bf16 a[16:19], v[52:55], v[24:27], a[16:19]
  buffer_load_dwordx4 v5, s[8:11], s20 offen sc1 lds
  ds_read_b64_tr_b16 v[72:73], v14 offset:24584
  v_mfma_f32_16x16x32_bf16 a[20:23], v[56:59], v[24:27], a[20:23]
  ds_read_b64_tr_b16 v[74:75], v14 offset:28680
  v_mfma_f32_16x16x32_bf16 a[24:27], v[60:63], v[24:27], a[24:27]
  ds_read_b128 v[44:47], v11 offset:5120
  v_mfma_f32_16x16x32_bf16 a[28:31], v[64:67], v[24:27], a[28:31]
  ds_read_b64_tr_b16 v[76:77], v15 offset:24576
  s_add_u32 m0, s53, 35840
  v_mfma_f32_16x16x32_bf16 a[32:35], v[52:55], v[28:31], a[32:35]
  buffer_load_dwordx4 v9, s[12:15], s21 offen  lds
  ds_read_b64_tr_b16 v[78:79], v15 offset:28672
  v_mfma_f32_16x16x32_bf16 a[36:39], v[56:59], v[28:31], a[36:39]
  ds_read_b128 v[48:51], v11 offset:7168
  v_mfma_f32_16x16x32_bf16 a[40:43], v[60:63], v[28:31], a[40:43]
  ds_read_b64_tr_b16 v[80:81], v15 offset:24584
  v_mfma_f32_16x16x32_bf16 a[44:47], v[64:67], v[28:31], a[44:47]
  ds_read_b64_tr_b16 v[82:83], v15 offset:28680
  s_add_u32 s20, s20, 6144
  v_mfma_f32_16x16x32_bf16 a[48:51], v[52:55], v[32:35], a[48:51]
  s_add_u32 s21, s21, s51
  v_mfma_f32_16x16x32_bf16 a[52:55], v[56:59], v[32:35], a[52:55]
  v_mfma_f32_16x16x32_bf16 a[56:59], v[60:63], v[32:35], a[56:59]
  v_mfma_f32_16x16x32_bf16 a[60:63], v[64:67], v[32:35], a[60:63]
  s_waitcnt lgkmcnt(0)
  v_mfma_f32_16x16x32_bf16 a[0:3], v[68:71], v[36:39], a[0:3]
  s_waitcnt vmcnt(16)
  s_barrier
  s_add_u32 m0, s52, 65536
  v_mfma_f32_16x16x32_bf16 a[4:7], v[72:75], v[36:39], a[4:7]
  buffer_load_dwordx4 v2, s[8:11], s20 offen sc1 lds
  ds_read_b128 v[20:23], v11 offset:32768
  v_mfma_f32_16x16x32_bf16 a[8:11], v[76:79], v[36:39], a[8:11]
  ds_read_b64_tr_b16 v[52:53], v14 offset:49152
  v_mfma_f32_16x16x32_bf16 a[12:15], v[80:83], v[36:39], a[12:15]
  ds_read_b64_tr_b16 v[54:55], v14 offset:53248
  s_add_u32 m0, s53, 65536
  v_mfma_f32_16x16x32_bf16 a[16:19], v[68:71], v[40:43], a[16:19]
  buffer_load_dwordx4 v6, s[12:15], s21 offen  lds
  ds_read_b128 v[24:27], v11 offset:34816
  v_mfma_f32_16x16x32_bf16 a[20:23], v[72:75], v[40:43], a[20:23]
  ds_read_b64_tr_b16 v[56:57], v14 offset:49160
  v_mfma_f32_16x16x32_bf16 a[24:27], v[76:79], v[40:43], a[24:27]
  ds_read_b64_tr_b16 v[58:59], v14 offset:53256
  s_add_u32 m0, s52, 66560
  v_mfma_f32_16x16x32_bf16 a[28:31], v[80:83], v[40:43], a[28:31]
  buffer_load_dwordx4 v3, s[8:11], s20 offen sc1 lds
  ds_read_b128 v[28:31], v11 offset:36864
  v_mfma_f32_16x16x32_bf16 a[32:35], v[68:71], v[44:47], a[32:35]
  ds_read_b64_tr_b16 v[60:61], v15 offset:49152
  v_mfma_f32_16x16x32_bf16 a[36:39], v[72:75], v[44:47], a[36:39]
  ds_read_b64_tr_b16 v[62:63], v15 offset:53248
  s_add_u32 m0, s53, 66560
  v_mfma_f32_16x16x32_bf16 a[40:43], v[76:79], v[44:47], a[40:43]
  buffer_load_dwordx4 v7, s[12:15], s21 offen  lds
  ds_read_b128 v[32:35], v11 offset:38912
  v_mfma_f32_16x16x32_bf16 a[44:47], v[80:83], v[44:47], a[44:47]
  ds_read_b64_tr_b16 v[64:65], v15 offset:49160
  v_mfma_f32_16x16x32_bf16 a[48:51], v[68:71], v[48:51], a[48:51]
  ds_read_b64_tr_b16 v[66:67], v15 offset:53256
  s_add_u32 m0, s52, 67584
  v_mfma_f32_16x16x32_bf16 a[52:55], v[72:75], v[48:51], a[52:55]
  buffer_load_dwordx4 v4, s[8:11], s20 offen sc1 lds
  v_mfma_f32_16x16x32_bf16 a[56:59], v[76:79], v[48:51], a[56:59]
  v_mfma_f32_16x16x32_bf16 a[60:63], v[80:83], v[48:51], a[60:63]
  s_waitcnt lgkmcnt(0)
  s_add_u32 m0, s53, 67584
  v_mfma_f32_16x16x32_bf16 a[0:3], v[52:55], v[20:23], a[0:3]
  buffer_load_dwordx4 v8, s[12:15], s21 offen  lds
  ds_read_b128 v[36:39], v11 offset:33792
  v_mfma_f32_16x16x32_bf16 a[4:7], v[56:59], v[20:23], a[4:7]
  ds_read_b64_tr_b16 v[68:69], v14 offset:57344
  v_mfma_f32_16x16x32_bf16 a[8:11], v[60:63], v[20:23], a[8:11]
  ds_read_b64_tr_b16 v[70:71], v14 offset:61440
  v_mfma_f32_16x16x32_bf16 a[12:15], v[64:67], v[20:23], a[12:15]
  ds_read_b128 v[40:43], v11 offset:35840
  s_add_u32 m0, s52, 68608
  v_mfma_f32_16x16x32_bf16 a[16:19], v[52:55], v[24:27], a[16:19]
  buffer_load_dwordx4 v5, s[8:11], s20 offen sc1 lds
  ds_read_b64_tr_b16 v[72:73], v14 offset:57352
  v_mfma_f32_16x16x32_bf16 a[20:23], v[56:59], v[24:27], a[20:23]
  ds_read_b64_tr_b16 v[74:75], v14 offset:61448
  v_mfma_f32_16x16x32_bf16 a[24:27], v[60:63], v[24:27], a[24:27]
  ds_read_b128 v[44:47], v11 offset:37888
  v_mfma_f32_16x16x32_bf16 a[28:31], v[64:67], v[24:27], a[28:31]
  ds_read_b64_tr_b16 v[76:77], v15 offset:57344
  s_add_u32 m0, s53, 68608
  v_mfma_f32_16x16x32_bf16 a[32:35], v[52:55], v[28:31], a[32:35]
  buffer_load_dwordx4 v9, s[12:15], s21 offen  lds
  ds_read_b64_tr_b16 v[78:79], v15 offset:61440
  v_mfma_f32_16x16x32_bf16 a[36:39], v[56:59], v[28:31], a[36:39]
  ds_read_b128 v[48:51], v11 offset:39936
  v_mfma_f32_16x16x32_bf16 a[40:43], v[60:63], v[28:31], a[40:43]
  ds_read_b64_tr_b16 v[80:81], v15 offset:57352
  v_mfma_f32_16x16x32_bf16 a[44:47], v[64:67], v[28:31], a[44:47]
  ds_read_b64_tr_b16 v[82:83], v15 offset:61448
  s_add_u32 s20, s20, 2048
  v_mfma_f32_16x16x32_bf16 a[48:51], v[52:55], v[32:35], a[48:51]
  s_add_u32 s21, s21, s51
  v_mfma_f32_16x16x32_bf16 a[52:55], v[56:59], v[32:35], a[52:55]
  v_mfma_f32_16x16x32_bf16 a[56:59], v[60:63], v[32:35], a[56:59]
  v_mfma_f32_16x16x32_bf16 a[60:63], v[64:67], v[32:35], a[60:63]
  s_waitcnt lgkmcnt(0)
  v_mfma_f32_16x16x32_bf16 a[0:3], v[68:71], v[36:39], a[0:3]
  s_waitcnt vmcnt(16)
  s_barrier
  s_add_u32 m0, s52, 98304
  v_mfma_f32_16x16x32_bf16 a[4:7], v[72:75], v[36:39], a[4:7]
  buffer_load_dwordx4 v2, s[8:11], s20 offen sc1 lds
  ds_read_b128 v[20:23], v10 offset:0
  v_mfma_f32_16x16x32_bf16 a[8:11], v[76:79], v[36:39], a[8:11]
  ds_read_b64_tr_b16 v[52:53], v12 offset:16384
  v_mfma_f32_16x16x32_bf16 a[12:15], v[80:83], v[36:39], a[12:15]
  ds_read_b64_tr_b16 v[54:55], v12 offset:20480
  s_add_u32 m0, s53, 98304
  v_mfma_f32_16x16x32_bf16 a[16:19], v[68:71], v[40:43], a[16:19]
  buffer_load_dwordx4 v6, s[12:15], s21 offen  lds
  ds_read_b128 v[24:27], v10 offset:2048
  v_mfma_f32_16x16x32_bf16 a[20:23], v[72:75], v[40:43], a[20:23]
  ds_read_b64_tr_b16 v[56:57], v12 offset:16392
  v_mfma_f32_16x16x32_bf16 a[24:27], v[76:79], v[40:43], a[24:27]
  ds_read_b64_tr_b16 v[58:59], v12 offset:20488
  s_add_u32 m0, s52, 99328
  v_mfma_f32_16x16x32_bf16 a[28:31], v[80:83], v[40:43], a[28:31]
  buffer_load_dwordx4 v3, s[8:11], s20 offen sc1 lds
  ds_read_b128 v[28:31], v10 offset:4096
  v_mfma_f32_16x16x32_bf16 a[32:35], v[68:71], v[44:47], a[32:35]
  ds_read_b64_tr_b16 v[60:61], v13 offset:16384
  v_mfma_f32_16x16x32_bf16 a[36:39], v[72:75], v[44:47], a[36:39]
  ds_read_b64_tr_b16 v[62:63], v13 offset:20480
  s_add_u32 m0, s53, 99328
  v_mfma_f32_16x16x32_bf16 a[40:43], v[76:79], v[44:47], a[40:43]
  buffer_load_dwordx4 v7, s[12:15], s21 offen  lds
  ds_read_b128 v[32:35], v10 offset:6144
  v_mfma_f32_16x16x32_bf16 a[44:47], v[80:83], v[44:47], a[44:47]
  ds_read_b64_tr_b16 v[64:65], v13 offset:16392
  v_mfma_f32_16x16x32_bf16 a[48:51], v[68:71], v[48:51], a[48:51]
  ds_read_b64_tr_b16 v[66:67], v13 offset:20488
  s_add_u32 m0, s52, 100352
  v_mfma_f32_16x16x32_bf16 a[52:55], v[72:75], v[48:51], a[52:55]
  buffer_load_dwordx4 v4, s[8:11], s20 offen sc1 lds
  v_mfma_f32_16x16x32_bf16 a[56:59], v[76:79], v[48:51], a[56:59]
  v_mfma_f32_16x16x32_bf16 a[60:63], v[80:83], v[48:51], a[60:63]
L_g3_loop:
  s_sub_u32 s25, s25, 1
  s_cmp_eq_u32 s25, 0
  s_cbranch_scc1 L_g3_fin
  s_waitcnt lgkmcnt(0)
  s_add_u32 m0, s53, 100352
  v_mfma_f32_16x16x32_bf16 a[0:3], v[52:55], v[20:23], a[0:3]
  buffer_load_dwordx4 v8, s[12:15], s21 offen  lds
  ds_read_b128 v[36:39], v10 offset:1024
  v_mfma_f32_16x16x32_bf16 a[4:7], v[56:59], v[20:23], a[4:7]
  ds_read_b64_tr_b16 v[68:69], v12 offset:24576
  v_mfma_f32_16x16x32_bf16 a[8:11], v[60:63], v[20:23], a[8:11]
  ds_read_b64_tr_b16 v[70:71], v12 offset:28672
  v_mfma_f32_16x16x32_bf16 a[12:15], v[64:67], v[20:23], a[12:15]
  ds_read_b128 v[40:43], v10 offset:3072
  s_add_u32 m0, s52, 101376
  v_mfma_f32_16x16x32_bf16 a[16:19], v[52:55], v[24:27], a[16:19]
  buffer_load_dwordx4 v5, s[8:11], s20 offen sc1 lds
  ds_read_b64_tr_b16 v[72:73], v12 offset:24584
  v_mfma_f32_16x16x32_bf16 a[20:23], v[56:59], v[24:27], a[20:23]
  ds_read_b64_tr_b16 v[74:75], v12 offset:28680
  v_mfma_f32_16x16x32_bf16 a[24:27], v[60:63], v[24:27], a[24:27]
  ds_read_b128 v[44:47], v10 offset:5120
  v_mfma_f32_16x16x32_bf16 a[28:31], v[64:67], v[24:27], a[28:31]
  ds_read_b64_tr_b16 v[76:77], v13 offset:24576
  s_add_u32 m0, s53, 101376
  v_mfma_f32_16x16x32_bf16 a[32:35], v[52:55], v[28:31], a[32:35]
  buffer_load_dwordx4 v9, s[12:15], s21 offen  lds
  ds_read_b64_tr_b16 v[78:79], v13 offset:28672
  v_mfma_f32_16x16x32_bf16 a[36:39], v[56:59], v[28:31], a[36:39]
  ds_read_b128 v[48:51], v10 offset:7168
  v_mfma_f32_16x16x32_bf16 a[40:43], v[60:63], v[28:31], a[40:43]
  ds_read_b64_tr_b16 v[80:81], v13 offset:24584
  v_mfma_f32_16x16x32_bf16 a[44:47], v[64:67], v[28:31], a[44:47]
  ds_read_b64_tr_b16 v[82:83], v13 offset:28680
  s_add_u32 s20, s20, 6144
  v_mfma_f32_16x16x32_bf16 a[48:51], v[52:55], v[32:35], a[48:51]
  s_add_u32 s21, s21, s51
  v_mfma_f32_16x16x32_bf16 a[52:55], v[56:59], v[32:35], a[52:55]
  v_mfma_f32_16x16x32_bf16 a[56:59], v[60:63], v[32:35], a[56:59]
  v_mfma_f32_16x16x32_bf16 a[60:63], v[64:67], v[32:35], a[60:63]
  s_waitcnt lgkmcnt(0)
  v_mfma_f32_16x16x32_bf16 a[0:3], v[68:71], v[36:39], a[0:3]
  s_waitcnt vmcnt(16)
  s_barrier
  s_add_u32 m0, s52, 0
  v_mfma_f32_16x16x32_bf16 a[4:7], v[72:75], v[36:39], a[4:7]
  buffer_load_dwordx4 v2, s[8:11], s20 offen sc1 lds
  ds_read_b128 v[20:23], v10 offset:32768
  v_mfma_f32_16x16x32_bf16 a[8:11], v[76:79], v[36:39], a[8:11]
  ds_read_b64_tr_b16 v[52:53], v12 offset:49152
  v_mfma_f32_16x16x32_bf16 a[12:15], v[80:83], v[36:39], a[12:15]
  ds_read_b64_tr_b16 v[54:55], v12 offset:53248
  s_add_u32 m0, s53, 0
  v_mfma_f32_16x16x32_bf16 a[16:19], v[68:71], v[40:43], a[16:19]
  buffer_load_dwordx4 v6, s[12:15], s21 offen  lds
  ds_read_b128 v[24:27], v10 offset:34816
  v_mfma_f32_16x16x32_bf16 a[20:23], v[72:75], v[40:43], a[20:23]
  ds_read_b64_tr_b16 v[56:57], v12 offset:49160
  v_mfma_f32_16x16x32_bf16 a[24:27], v[76:79], v[40:43], a[24:27]
  ds_read_b64_tr_b16 v[58:59], v12 offset:53256
  s_add_u32 m0, s52, 1024
  v_mfma_f32_16x16x32_bf16 a[28:31], v[80:83], v[40:43], a[28:31]
  buffer_load_dwordx4 v3, s[8:11], s20 offen sc1 lds
  ds_read_b128 v[28:31], v10 offset:36864
  v_mfma_f32_16x16x32_bf16 a[32:35], v[68:71], v[44:47], a[32:35]
  ds_read_b64_tr_b16 v[60:61], v13 offset:49152
  v_mfma_f32_16x16x32_bf16 a[36:39], v[72:75], v[44:47], a[36:39]
  ds_read_b64_tr_b16 v[62:63], v13 offset:53248
  s_add_u32 m0, s53, 1024
  v_mfma_f32_16x16x32_bf16 a[40:43], v[76:79], v[44:47], a[40:43]
  buffer_load_dwordx4 v7, s[12:15], s21 offen  lds
  ds_read_b128 v[32:35], v10 offset:38912
  v_mfma_f32_16x16x32_bf16 a[44:47], v[80:83], v[44:47], a[44:47]
  ds_read_b64_tr_b16 v[64:65], v13 offset:49160
  v_mfma_f32_16x16x32_bf16 a[48:51], v[68:71], v[48:51], a[48:51]
  ds_read_b64_tr_b16 v[66:67], v13 offset:53256
  s_add_u32 m0, s52, 2048
  v_mfma_f32_16x16x32_bf16 a[52:55], v[72:75], v[48:51], a[52:55]
  buffer_load_dwordx4 v4, s[8:11], s20 offen sc1 lds
  v_mfma_f32_16x16x32_bf16 a[56:59], v[76:79], v[48:51], a[56:59]
  v_mfma_f32_16x16x32_bf16 a[60:63], v[80:83], v[48:51], a[60:63]
  s_waitcnt lgkmcnt(0)
  s_add_u32 m0, s53, 2048
  v_mfma_f32_16x16x32_bf16 a[0:3], v[52:55], v[20:23], a[0:3]
  buffer_load_dwordx4 v8, s[12:15], s21 offen  lds
  ds_read_b128 v[36:39], v10 offset:33792
  v_mfma_f32_16x16x32_bf16 a[4:7], v[56:59], v[20:23], a[4:7]
  ds_read_b64_tr_b16 v[68:69], v12 offset:57344
  v_mfma_f32_16x16x32_bf16 a[8:11], v[60:63], v[20:23], a[8:11]
  ds_read_b64_tr_b16 v[70:71], v12 offset:61440
  v_mfma_f32_16x16x32_bf16 a[12:15], v[64:67], v[20:23], a[12:15]
  ds_read_b128 v[40:43], v10 offset:35840
  s_add_u32 m0, s52, 3072
  v_mfma_f32_16x16x32_bf16 a[16:19], v[52:55], v[24:27], a[16:19]
  buffer_load_dwordx4 v5, s[8:11], s20 offen sc1 lds
  ds_read_b64_tr_b16 v[72:73], v12 offset:57352
  v_mfma_f32_16x16x32_bf16 a[20:23], v[56:59], v[24:27], a[20:23]
  ds_read_b64_tr_b16 v[74:75], v12 offset:61448
  v_mfma_f32_16x16x32_bf16 a[24:27], v[60:63], v[24:27], a[24:27]
  ds_read_b128 v[44:47], v10 offset:37888
  v_mfma_f32_16x16x32_bf16 a[28:31], v[64:67], v[24:27], a[28:31]
  ds_read_b64_tr_b16 v[76:77], v13 offset:57344
  s_add_u32 m0, s53, 3072
  v_mfma_f32_16x16x32_bf16 a[32:35], v[52:55], v[28:31], a[32:35]
  buffer_load_dwordx4 v9, s[12:15], s21 offen  lds
  ds_read_b64_tr_b16 v[78:79], v13 offset:61440
  v_mfma_f32_16x16x32_bf16 a[36:39], v[56:59], v[28:31], a[36:39]
  ds_read_b128 v[48:51], v10 offset:39936
  v_mfma_f32_16x16x32_bf16 a[40:43], v[60:63], v[28:31], a[40:43]
  ds_read_b64_tr_b16 v[80:81], v13 offset:57352
  v_mfma_f32_16x16x32_bf16 a[44:47], v[64:67], v[28:31], a[44:47]
  ds_read_b64_tr_b16 v[82:83], v13 offset:61448
  s_add_u32 s20, s20, 2048
  v_mfma_f32_16x16x32_bf16 a[48:51], v[52:55], v[32:35], a[48:51]
  s_add_u32 s21, s21, s51
  v_mfma_f32_16x16x32_bf16 a[52:55], v[56:59], v[32:35], a[52:55]
  v_mfma_f32_16x16x32_bf16 a[56:59], v[60:63], v[32:35], a[56:59]
  v_mfma_f32_16x16x32_bf16 a[60:63], v[64:67], v[32:35], a[60:63]
  s_waitcnt lgkmcnt(0)
  v_mfma_f32_16x16x32_bf16 a[0:3], v[68:71], v[36:39], a[0:3]
  s_waitcnt vmcnt(16)
  s_barrier
  s_add_u32 m0, s52, 32768
  v_mfma_f32_16x16x32_bf16 a[4:7], v[72:75], v[36:39], a[4:7]
  buffer_load_dwordx4 v2, s[8:11], s20 offen sc1 lds
  ds_read_b128 v[20:23], v11 offset:0
  v_mfma_f32_16x16x32_bf16 a[8:11], v[76:79], v[36:39], a[8:11]
  ds_read_b64_tr_b16 v[52:53], v14 offset:16384
  v_mfma_f32_16x16x32_bf16 a[12:15], v[80:83], v[36:39], a[12:15]
  ds_read_b64_tr_b16 v[54:55], v14 offset:20480
  s_add_u32 m0, s53, 32768
  v_mfma_f32_16x16x32_bf16 a[16:19], v[68:71], v[40:43], a[16:19]
  buffer_load_dwordx4 v6, s[12:15], s21 offen  lds
  ds_read_b128 v[24:27], v11 offset:2048
  v_mfma_f32_16x16x32_bf16 a[20:23], v[72:75], v[40:43], a[20:23]
  ds_read_b64_tr_b16 v[56:57], v14 offset:16392
  v_mfma_f32_16x16x32_bf16 a[24:27], v[76:79], v[40:43], a[24:27]
  ds_read_b64_tr_b16 v[58:59], v14 offset:20488
  s_add_u32 m0, s52, 33792
  v_mfma_f32_16x16x32_bf16 a[28:31], v[80:83], v[40:43], a[28:31]
  buffer_load_dwordx4 v3, s[8:11], s20 offen sc1 lds
  ds_read_b128 v[28:31], v11 offset:4096
  v_mfma_f32_16x16x32_bf16 a[32:35], v[68:71], v[44:47], a[32:35]
  ds_read_b64_tr_b16 v[60:61], v15 offset:16384
  v_mfma_f32_16x16x32_bf16 a[36:39], v[72:75], v[44:47], a[36:39]
  ds_read_b64_tr_b16 v[62:63], v15 offset:20480
  s_add_u32 m0, s53, 33792
  v_mfma_f32_16x16x32_bf16 a[40:43], v[76:79], v[44:47], a[40:43]
  buffer_load_dwordx4 v7, s[12:15], s21 offen  lds
  ds_read_b128 v[32:35], v11 offset:6144
  v_mfma_f32_16x16x32_bf16 a[44:47], v[80:83], v[44:47], a[44:47]
  ds_read_b64_tr_b16 v[64:65], v15 offset:16392
  v_mfma_f32_16x16x32_bf16 a[48:51], v[68:71], v[48:51], a[48:51]
  ds_read_b64_tr_b16 v[66:67], v15 offset:20488
  s_add_u32 m0, s52, 34816
  v_mfma_f32_16x16x32_bf16 a[52:55], v[72:75], v[48:51], a[52:55]
  buffer_load_dwordx4 v4, s[8:11], s20 offen sc1 lds
  v_mfma_f32_16x16x32_bf16 a[56:59], v[76:79], v[48:51], a[56:59]
  v_mfma_f32_16x16x32_bf16 a[60:63], v[80:83], v[48:51], a[60:63]
  s_waitcnt lgkmcnt(0)
  s_add_u32 m0, s53, 34816
  v_mfma_f32_16x16x32_bf16 a[0:3], v[52:55], v[20:23], a[0:3]
  buffer_load_dwordx4 v8, s[12:15], s21 offen  lds
  ds_read_b128 v[36:39], v11 offset:1024
  v_mfma_f32_16x16x32_bf16 a[4:7], v[56:59], v[20:23], a[4:7]
  ds_read_b64_tr_b16 v[68:69], v14 offset:24576
  v_mfma_f32_16x16x32_bf16 a[8:11], v[60:63], v[20:23], a[8:11]
  ds_read_b64_tr_b16 v[70:71], v14 offset:28672
  v_mfma_f32_16x16x32_bf16 a[12:15], v[64:67], v[20:23], a[12:15]
  ds_read_b128 v[40:43], v11 offset:3072
  s_add_u32 m0, s52, 35840
  v_mfma_f32_16x16x32_bf16 a[16:19], v[52:55], v[24:27], a[16:19]
  buffer_load_dwordx4 v5, s[8:11], s20 offen sc1 lds
  ds_read_b64_tr_b16 v[72:73], v14 offset:24584
  v_mfma_f32_16x16x32_bf16 a[20:23], v[56:59], v[24:27], a[20:23]
  ds_read_b64_tr_b16 v[74:75], v14 offset:28680
  v_mfma_f32_16x16x32_bf16 a[24:27], v[60:63], v[24:27], a[24:27]
  ds_read_b128 v[44:47], v11 offset:5120
  v_mfma_f32_16x16x32_bf16 a[28:31], v[64:67], v[24:27], a[28:31]
  ds_read_b64_tr_b16 v[76:77], v15 offset:24576
  s_add_u32 m0, s53, 35840
  v_mfma_f32_16x16x32_bf16 a[32:35], v[52:55], v[28:31], a[32:35]
  buffer_load_dwordx4 v9, s[12:15], s21 offen  lds
  ds_read_b64_tr_b16 v[78:79], v15 offset:28672
  v_mfma_f32_16x16x32_bf16 a[36:39], v[56:59], v[28:31], a[36:39]
  ds_read_b128 v[48:51], v11 offset:7168
  v_mfma_f32_16x16x32_bf16 a[40:43], v[60:63], v[28:31], a[40:43]
  ds_read_b64_tr_b16 v[80:81], v15 offset:24584
  v_mfma_f32_16x16x32_bf16 a[44:47], v[64:67], v[28:31], a[44:47]
  ds_read_b64_tr_b16 v[82:83], v15 offset:28680
  s_add_u32 s20, s20, 6144
  v_mfma_f32_16x16x32_bf16 a[48:51], v[52:55], v[32:35], a[48:51]
  s_add_u32 s21, s21, s51
  v_mfma_f32_16x16x32_bf16 a[52:55], v[56:59], v[32:35], a[52:55]
  v_mfma_f32_16x16x32_bf16 a[56:59], v[60:63], v[32:35], a[56:59]
  v_mfma_f32_16x16x32_bf16 a[60:63], v[64:67], v[32:35], a[60:63]
  s_waitcnt lgkmcnt(0)
  v_mfma_f32_16x16x32_bf16 a[0:3], v[68:71], v[36:39], a[0:3]
  s_waitcnt vmcnt(16)
  s_barrier
  s_add_u32 m0, s52, 65536
  v_mfma_f32_16x16x32_bf16 a[4:7], v[72:75], v[36:39], a[4:7]
  buffer_load_dwordx4 v2, s[8:11], s20 offen sc1 lds
  ds_read_b128 v[20:23], v11 offset:32768
  v_mfma_f32_16x16x32_bf16 a[8:11], v[76:79], v[36:39], a[8:11]
  ds_read_b64_tr_b16 v[52:53], v14 offset:49152
  v_mfma_f32_16x16x32_bf16 a[12:15], v[80:83], v[36:39], a[12:15]
  ds_read_b64_tr_b16 v[54:55], v14 offset:53248
  s_add_u32 m0, s53, 65536
  v_mfma_f32_16x16x32_bf16 a[16:19], v[68:71], v[40:43], a[16:19]
  buffer_load_dwordx4 v6, s[12:15], s21 offen  lds
  ds_read_b128 v[24:27], v11 offset:34816
  v_mfma_f32_16x16x32_bf16 a[20:23], v[72:75], v[40:43], a[20:23]
  ds_read_b64_tr_b16 v[56:57], v14 offset:49160
  v_mfma_f32_16x16x32_bf16 a[24:27], v[76:79], v[40:43], a[24:27]
  ds_read_b64_tr_b16 v[58:59], v14 offset:53256
  s_add_u32 m0, s52, 66560
  v_mfma_f32_16x16x32_bf16 a[28:31], v[80:83], v[40:43], a[28:31]
  buffer_load_dwordx4 v3, s[8:11], s20 offen sc1 lds
  ds_read_b128 v[28:31], v11 offset:36864
  v_mfma_f32_16x16x32_bf16 a[32:35], v[68:71], v[44:47], a[32:35]
  ds_read_b64_tr_b16 v[60:61], v15 offset:49152
  v_mfma_f32_16x16x32_bf16 a[36:39], v[72:75], v[44:47], a[36:39]
  ds_read_b64_tr_b16 v[62:63], v15 offset:53248
  s_add_u32 m0, s53, 66560
  v_mfma_f32_16x16x32_bf16 a[40:43], v[76:79], v[44:47], a[40:43]
  buffer_load_dwordx4 v7, s[12:15], s21 offen  lds
  ds_read_b128 v[32:35], v11 offset:38912
  v_mfma_f32_16x16x32_bf16 a[44:47], v[80:83], v[44:47], a[44:47]
  ds_read_b64_tr_b16 v[64:65], v15 offset:49160
  v_mfma_f32_16x16x32_bf16 a[48:51], v[68:71], v[48:51], a[48:51]
  ds_read_b64_tr_b16 v[66:67], v15 offset:53256
  s_add_u32 m0, s52, 67584
  v_mfma_f32_16x16x32_bf16 a[52:55], v[72:75], v[48:51], a[52:55]
  buffer_load_dwordx4 v4, s[8:11], s20 offen sc1 lds
  v_mfma_f32_16x16x32_bf16 a[56:59], v[76:79], v[48:51], a[56:59]
  v_mfma_f32_16x16x32_bf16 a[60:63], v[80:83], v[48:51], a[60:63]
  s_waitcnt lgkmcnt(0)
  s_add_u32 m0, s53, 67584
  v_mfma_f32_16x16x32_bf16 a[0:3], v[52:55], v[20:23], a[0:3]
  buffer_load_dwordx4 v8, s[12:15], s21 offen  lds
  ds_read_b128 v[36:39], v11 offset:33792
  v_mfma_f32_16x16x32_bf16 a[4:7], v[56:59], v[20:23], a[4:7]
  ds_read_b64_tr_b16 v[68:69], v14 offset:57344
  v_mfma_f32_16x16x32_bf16 a[8:11], v[60:63], v[20:23], a[8:11]
  ds_read_b64_tr_b16 v[70:71], v14 offset:61440
  v_mfma_f32_16x16x32_bf16 a[12:15], v[64:67], v[20:23], a[12:15]
  ds_read_b128 v[40:43], v11 offset:35840
  s_add_u32 m0, s52, 68608
  v_mfma_f32_16x16x32_bf16 a[16:19], v[52:55], v[24:27], a[16:19]
  buffer_load_dwordx4 v5, s[8:11], s20 offen sc1 lds
  ds_read_b64_tr_b16 v[72:73], v14 offset:57352
  v_mfma_f32_16x16x32_bf16 a[20:23], v[56:59], v[24:27], a[20:23]
  ds_read_b64_tr_b16 v[74:75], v14 offset:61448
  v_mfma_f32_16x16x32_bf16 a[24:27], v[60:63], v[24:27], a[24:27]
  ds_read_b128 v[44:47], v11 offset:37888
  v_mfma_f32_16x16x32_bf16 a[28:31], v[64:67], v[24:27], a[28:31]
  ds_read_b64_tr_b16 v[76:77], v15 offset:57344
  s_add_u32 m0, s53, 68608
  v_mfma_f32_16x16x32_bf16 a[32:35], v[52:55], v[28:31], a[32:35]
  buffer_load_dwordx4 v9, s[12:15], s21 offen  lds
  ds_read_b64_tr_b16 v[78:79], v15 offset:61440
  v_mfma_f32_16x16x32_bf16 a[36:39], v[56:59], v[28:31], a[36:39]
  ds_read_b128 v[48:51], v11 offset:39936
  v_mfma_f32_16x16x32_bf16 a[40:43], v[60:63], v[28:31], a[40:43]
  ds_read_b64_tr_b16 v[80:81], v15 offset:57352
  v_mfma_f32_16x16x32_bf16 a[44:47], v[64:67], v[28:31], a[44:47]
  ds_read_b64_tr_b16 v[82:83], v15 offset:61448
  s_add_u32 s20, s20, 2048
  v_mfma_f32_16x16x32_bf16 a[48:51], v[52:55], v[32:35], a[48:51]
  s_add_u32 s21, s21, s51
  v_mfma_f32_16x16x32_bf16 a[52:55], v[56:59], v[32:35], a[52:55]
  v_mfma_f32_16x16x32_bf16 a[56:59], v[60:63], v[32:35], a[56:59]
  v_mfma_f32_16x16x32_bf16 a[60:63], v[64:67], v[32:35], a[60:63]
  s_waitcnt lgkmcnt(0)
  v_mfma_f32_16x16x32_bf16 a[0:3], v[68:71], v[36:39], a[0:3]
  s_waitcnt vmcnt(16)
  s_barrier
  s_add_u32 m0, s52, 98304
  v_mfma_f32_16x16x32_bf16 a[4:7], v[72:75], v[36:39], a[4:7]
  buffer_load_dwordx4 v2, s[8:11], s20 offen sc1 lds
  ds_read_b128 v[20:23], v10 offset:0
  v_mfma_f32_16x16x32_bf16 a[8:11], v[76:79], v[36:39], a[8:11]
  ds_read_b64_tr_b16 v[52:53], v12 offset:16384
  v_mfma_f32_16x16x32_bf16 a[12:15], v[80:83], v[36:39], a[12:15]
  ds_read_b64_tr_b16 v[54:55], v12 offset:20480
  s_add_u32 m0, s53, 98304
  v_mfma_f32_16x16x32_bf16 a[16:19], v[68:71], v[40:43], a[16:19]
  buffer_load_dwordx4 v6, s[12:15], s21 offen  lds
  ds_read_b128 v[24:27], v10 offset:2048
  v_mfma_f32_16x16x32_bf16 a[20:23], v[72:75], v[40:43], a[20:23]
  ds_read_b64_tr_b16 v[56:57], v12 offset:16392
  v_mfma_f32_16x16x32_bf16 a[24:27], v[76:79], v[40:43], a[24:27]
  ds_read_b64_tr_b16 v[58:59], v12 offset:20488
  s_add_u32 m0, s52, 99328
  v_mfma_f32_16x16x32_bf16 a[28:31], v[80:83], v[40:43], a[28:31]
  buffer_load_dwordx4 v3, s[8:11], s20 offen sc1 lds
  ds_read_b128 v[28:31], v10 offset:4096
  v_mfma_f32_16x16x32_bf16 a[32:35], v[68:71], v[44:47], a[32:35]
  ds_read_b64_tr_b16 v[60:61], v13 offset:16384
  v_mfma_f32_16x16x32_bf16 a[36:39], v[72:75], v[44:47], a[36:39]
  ds_read_b64_tr_b16 v[62:63], v13 offset:20480
  s_add_u32 m0, s53, 99328
  v_mfma_f32_16x16x32_bf16 a[40:43], v[76:79], v[44:47], a[40:43]
  buffer_load_dwordx4 v7, s[12:15], s21 offen  lds
  ds_read_b128 v[32:35], v10 offset:6144
  v_mfma_f32_16x16x32_bf16 a[44:47], v[80:83], v[44:47], a[44:47]
  ds_read_b64_tr_b16 v[64:65], v13 offset:16392
  v_mfma_f32_16x16x32_bf16 a[48:51], v[68:71], v[48:51], a[48:51]
  ds_read_b64_tr_b16 v[66:67], v13 offset:20488
  s_add_u32 m0, s52, 100352
  v_mfma_f32_16x16x32_bf16 a[52:55], v[72:75], v[48:51], a[52:55]
  buffer_load_dwordx4 v4, s[8:11], s20 offen sc1 lds
  v_mfma_f32_16x16x32_bf16 a[56:59], v[76:79], v[48:51], a[56:59]
  v_mfma_f32_16x16x32_bf16 a[60:63], v[80:83], v[48:51], a[60:63]
  s_branch L_g3_loop
L_g3_fin:
  s_cmp_ge_u32 s35, 8
  s_cbranch_scc1 L_r3_104
  s_cmp_eq_u32 s35, 16
  s_cselect_b32 s90, 999, s34
  s_cmp_lt_u32 s90, 242
  s_cbranch_scc0 L_re_105
  s_cmp_lg_u32 s32, 0
  s_cbranch_scc1 L_rq_106
  s_cmp_eq_u32 s39, 0
  s_cbranch_scc1 L_rq_106
  s_lshl_b32 s99, s33, 7
  s_add_u32 s99, s99, 0x3d00200
  v_mov_b32 v244, 1
  v_mov_b32 v245, 0
  s_mov_b64 exec, 1
  buffer_atomic_add v244, v245, s[4:7], s99 offen sc0 sc1
  s_mov_b64 exec, -1
L_rq_106:
L_re_105:
L_r3_104:
  s_waitcnt lgkmcnt(0)
  s_add_u32 m0, s53, 100352
  v_mfma_f32_16x16x32_bf16 a[0:3], v[52:55], v[20:23], a[0:3]
  buffer_load_dwordx4 v8, s[12:15], s21 offen  lds
  ds_read_b128 v[36:39], v10 offset:1024
  v_mfma_f32_16x16x32_bf16 a[4:7], v[56:59], v[20:23], a[4:7]
  ds_read_b64_tr_b16 v[68:69], v12 offset:24576
  v_mfma_f32_16x16x32_bf16 a[8:11], v[60:63], v[20:23], a[8:11]
  ds_read_b64_tr_b16 v[70:71], v12 offset:28672
  v_mfma_f32_16x16x32_bf16 a[12:15], v[64:67], v[20:23], a[12:15]
  ds_read_b128 v[40:43], v10 offset:3072
  s_add_u32 m0, s52, 101376
  v_mfma_f32_16x16x32_bf16 a[16:19], v[52:55], v[24:27], a[16:19]
  buffer_load_dwordx4 v5, s[8:11], s20 offen sc1 lds
  ds_read_b64_tr_b16 v[72:73], v12 offset:24584
  v_mfma_f32_16x16x32_bf16 a[20:23], v[56:59], v[24:27], a[20:23]
  ds_read_b64_tr_b16 v[74:75], v12 offset:28680
  v_mfma_f32_16x16x32_bf16 a[24:27], v[60:63], v[24:27], a[24:27]
  ds_read_b128 v[44:47], v10 offset:5120
  v_mfma_f32_16x16x32_bf16 a[28:31], v[64:67], v[24:27], a[28:31]
  ds_read_b64_tr_b16 v[76:77], v13 offset:24576
  s_add_u32 m0, s53, 101376
  v_mfma_f32_16x16x32_bf16 a[32:35], v[52:55], v[28:31], a[32:35]
  buffer_load_dwordx4 v9, s[12:15], s21 offen  lds
  ds_read_b64_tr_b16 v[78:79], v13 offset:28672
  v_mfma_f32_16x16x32_bf16 a[36:39], v[56:59], v[28:31], a[36:39]
  ds_read_b128 v[48:51], v10 offset:7168
  v_mfma_f32_16x16x32_bf16 a[40:43], v[60:63], v[28:31], a[40:43]
  ds_read_b64_tr_b16 v[80:81], v13 offset:24584
  v_mfma_f32_16x16x32_bf16 a[44:47], v[64:67], v[28:31], a[44:47]
  ds_read_b64_tr_b16 v[82:83], v13 offset:28680
  s_add_u32 s20, s20, 6144
  v_mfma_f32_16x16x32_bf16 a[48:51], v[52:55], v[32:35], a[48:51]
  s_add_u32 s21, s21, s51
  v_mfma_f32_16x16x32_bf16 a[52:55], v[56:59], v[32:35], a[52:55]
  v_mfma_f32_16x16x32_bf16 a[56:59], v[60:63], v[32:35], a[56:59]
  v_mfma_f32_16x16x32_bf16 a[60:63], v[64:67], v[32:35], a[60:63]
  s_waitcnt lgkmcnt(0)
  v_mfma_f32_16x16x32_bf16 a[0:3], v[68:71], v[36:39], a[0:3]
  s_waitcnt vmcnt(16)
  s_barrier
  v_mfma_f32_16x16x32_bf16 a[4:7], v[72:75], v[36:39], a[4:7]
  ds_read_b128 v[20:23], v10 offset:32768
  v_mfma_f32_16x16x32_bf16 a[8:11], v[76:79], v[36:39], a[8:11]
  ds_read_b64_tr_b16 v[52:53], v12 offset:49152
  v_mfma_f32_16x16x32_bf16 a[12:15], v[80:83], v[36:39], a[12:15]
  ds_read_b64_tr_b16 v[54:55], v12 offset:53248
  v_mfma_f32_16x16x32_bf16 a[16:19], v[68:71], v[40:43], a[16:19]
  ds_read_b128 v[24:27], v10 offset:34816
  v_mfma_f32_16x16x32_bf16 a[20:23], v[72:75], v[40:43], a[20:23]
  ds_read_b64_tr_b16 v[56:57], v12 offset:49160
  v_mfma_f32_16x16x32_bf16 a[24:27], v[76:79], v[40:43], a[24:27]
  ds_read_b64_tr_b16 v[58:59], v12 offset:53256
  v_mfma_f32_16x16x32_bf16 a[28:31], v[80:83], v[40:43], a[28:31]
  ds_read_b128 v[28:31], v10 offset:36864
  v_mfma_f32_16x16x32_bf16 a[32:35], v[68:71], v[44:47], a[32:35]
  ds_read_b64_tr_b16 v[60:61], v13 offset:49152
  v_mfma_f32_16x16x32_bf16 a[36:39], v[72:75], v[44:47], a[36:39]
  ds_read_b64_tr_b16 v[62:63], v13 offset:53248
  v_mfma_f32_16x16x32_bf16 a[40:43], v[76:79], v[44:47], a[40:43]
  ds_read_b128 v[32:35], v10 offset:38912
  v_mfma_f32_16x16x32_bf16 a[44:47], v[80:83], v[44:47], a[44:47]
  ds_read_b64_tr_b16 v[64:65], v13 offset:49160
  v_mfma_f32_16x16x32_bf16 a[48:51], v[68:71], v[48:51], a[48:51]
  ds_read_b64_tr_b16 v[66:67], v13 offset:53256
  v_mfma_f32_16x16x32_bf16 a[52:55], v[72:75], v[48:51], a[52:55]
  v_mfma_f32_16x16x32_bf16 a[56:59], v[76:79], v[48:51], a[56:59]
  v_mfma_f32_16x16x32_bf16 a[60:63], v[80:83], v[48:51], a[60:63]
  s_waitcnt lgkmcnt(0)
  v_mfma_f32_16x16x32_bf16 a[0:3], v[52:55], v[20:23], a[0:3]
  ds_read_b128 v[36:39], v10 offset:33792
  v_mfma_f32_16x16x32_bf16 a[4:7], v[56:59], v[20:23], a[4:7]
  ds_read_b64_tr_b16 v[68:69], v12 offset:57344
  v_mfma_f32_16x16x32_bf16 a[8:11], v[60:63], v[20:23], a[8:11]
  ds_read_b64_tr_b16 v[70:71], v12 offset:61440
  v_mfma_f32_16x16x32_bf16 a[12:15], v[64:67], v[20:23], a[12:15]
  ds_read_b128 v[40:43], v10 offset:35840
  v_mfma_f32_16x16x32_bf16 a[16:19], v[52:55], v[24:27], a[16:19]
  ds_read_b64_tr_b16 v[72:73], v12 offset:57352
  v_mfma_f32_16x16x32_bf16 a[20:23], v[56:59], v[24:27], a[20:23]
  ds_read_b64_tr_b16 v[74:75], v12 offset:61448
  v_mfma_f32_16x16x32_bf16 a[24:27], v[60:63], v[24:27], a[24:27]
  ds_read_b128 v[44:47], v10 offset:37888
  v_mfma_f32_16x16x32_bf16 a[28:31], v[64:67], v[24:27], a[28:31]
  ds_read_b64_tr_b16 v[76:77], v13 offset:57344
  v_mfma_f32_16x16x32_bf16 a[32:35], v[52:55], v[28:31], a[32:35]
  ds_read_b64_tr_b16 v[78:79], v13 offset:61440
  v_mfma_f32_16x16x32_bf16 a[36:39], v[56:59], v[28:31], a[36:39]
  ds_read_b128 v[48:51], v10 offset:39936
  v_mfma_f32_16x16x32_bf16 a[40:43], v[60:63], v[28:31], a[40:43]
  ds_read_b64_tr_b16 v[80:81], v13 offset:57352
  v_mfma_f32_16x16x32_bf16 a[44:47], v[64:67], v[28:31], a[44:47]
  ds_read_b64_tr_b16 v[82:83], v13 offset:61448
  v_mfma_f32_16x16x32_bf16 a[48:51], v[52:55], v[32:35], a[48:51]
  v_mfma_f32_16x16x32_bf16 a[52:55], v[56:59], v[32:35], a[52:55]
  v_mfma_f32_16x16x32_bf16 a[56:59], v[60:63], v[32:35], a[56:59]
  v_mfma_f32_16x16x32_bf16 a[60:63], v[64:67], v[32:35], a[60:63]
  s_waitcnt lgkmcnt(0)
  v_mfma_f32_16x16x32_bf16 a[0:3], v[68:71], v[36:39], a[0:3]
  s_waitcnt vmcnt(8)
  s_barrier
  v_mfma_f32_16x16x32_bf16 a[4:7], v[72:75], v[36:39], a[4:7]
  ds_read_b128 v[20:23], v11 offset:0
  v_mfma_f32_16x16x32_bf16 a[8:11], v[76:79], v[36:39], a[8:11]
  ds_read_b64_tr_b16 v[52:53], v14 offset:16384
  v_mfma_f32_16x16x32_bf16 a[12:15], v[80:83], v[36:39], a[12:15]
  ds_read_b64_tr_b16 v[54:55], v14 offset:20480
  v_mfma_f32_16x16x32_bf16 a[16:19], v[68:71], v[40:43], a[16:19]
  ds_read_b128 v[24:27], v11 offset:2048
  v_mfma_f32_16x16x32_bf16 a[20:23], v[72:75], v[40:43], a[20:23]
  ds_read_b64_tr_b16 v[56:57], v14 offset:16392
  v_mfma_f32_16x16x32_bf16 a[24:27], v[76:79], v[40:43], a[24:27]
  ds_read_b64_tr_b16 v[58:59], v14 offset:20488
  v_mfma_f32_16x16x32_bf16 a[28:31], v[80:83], v[40:43], a[28:31]
  ds_read_b128 v[28:31], v11 offset:4096
  v_mfma_f32_16x16x32_bf16 a[32:35], v[68:71], v[44:47], a[32:35]
  ds_read_b64_tr_b16 v[60:61], v15 offset:16384
  v_mfma_f32_16x16x32_bf16 a[36:39], v[72:75], v[44:47], a[36:39]
  ds_read_b64_tr_b16 v[62:63], v15 offset:20480
  v_mfma_f32_16x16x32_bf16 a[40:43], v[76:79], v[44:47], a[40:43]
  ds_read_b128 v[32:35], v11 offset:6144
  v_mfma_f32_16x16x32_bf16 a[44:47], v[80:83], v[44:47], a[44:47]
  ds_read_b64_tr_b16 v[64:65], v15 offset:16392
  v_mfma_f32_16x16x32_bf16 a[48:51], v[68:71], v[48:51], a[48:51]
  ds_read_b64_tr_b16 v[66:67], v15 offset:20488
  v_mfma_f32_16x16x32_bf16 a[52:55], v[72:75], v[48:51], a[52:55]
  v_mfma_f32_16x16x32_bf16 a[56:59], v[76:79], v[48:51], a[56:59]
  v_mfma_f32_16x16x32_bf16 a[60:63], v[80:83], v[48:51], a[60:63]
  s_waitcnt lgkmcnt(0)
  v_mfma_f32_16x16x32_bf16 a[0:3], v[52:55], v[20:23], a[0:3]
  ds_read_b128 v[36:39], v11 offset:1024
  v_mfma_f32_16x16x32_bf16 a[4:7], v[56:59], v[20:23], a[4:7]
  ds_read_b64_tr_b16 v[68:69], v14 offset:24576
  v_mfma_f32_16x16x32_bf16 a[8:11], v[60:63], v[20:23], a[8:11]
  ds_read_b64_tr_b16 v[70:71], v14 offset:28672
  v_mfma_f32_16x16x32_bf16 a[12:15], v[64:67], v[20:23], a[12:15]
  ds_read_b128 v[40:43], v11 offset:3072
  v_mfma_f32_16x16x32_bf16 a[16:19], v[52:55], v[24:27], a[16:19]
  ds_read_b64_tr_b16 v[72:73], v14 offset:24584
  v_mfma_f32_16x16x32_bf16 a[20:23], v[56:59], v[24:27], a[20:23]
  ds_read_b64_tr_b16 v[74:75], v14 offset:28680
  v_mfma_f32_16x16x32_bf16 a[24:27], v[60:63], v[24:27], a[24:27]
  ds_read_b128 v[44:47], v11 offset:5120
  v_mfma_f32_16x16x32_bf16 a[28:31], v[64:67], v[24:27], a[28:31]
  ds_read_b64_tr_b16 v[76:77], v15 offset:24576
  v_mfma_f32_16x16x32_bf16 a[32:35], v[52:55], v[28:31], a[32:35]
  ds_read_b64_tr_b16 v[78:79], v15 offset:28672
  v_mfma_f32_16x16x32_bf16 a[36:39], v[56:59], v[28:31], a[36:39]
  ds_read_b128 v[48:51], v11 offset:7168
  v_mfma_f32_16x16x32_bf16 a[40:43], v[60:63], v[28:31], a[40:43]
  ds_read_b64_tr_b16 v[80:81], v15 offset:24584
  v_mfma_f32_16x16x32_bf16 a[44:47], v[64:67], v[28:31], a[44:47]
  ds_read_b64_tr_b16 v[82:83], v15 offset:28680
  v_mfma_f32_16x16x32_bf16 a[48:51], v[52:55], v[32:35], a[48:51]
  v_mfma_f32_16x16x32_bf16 a[52:55], v[56:59], v[32:35], a[52:55]
  v_mfma_f32_16x16x32_bf16 a[56:59], v[60:63], v[32:35], a[56:59]
  v_mfma_f32_16x16x32_bf16 a[60:63], v[64:67], v[32:35], a[60:63]
  s_waitcnt lgkmcnt(0)
  v_mfma_f32_16x16x32_bf16 a[0:3], v[68:71], v[36:39], a[0:3]
  s_waitcnt vmcnt(0)
  s_barrier
  v_mfma_f32_16x16x32_bf16 a[4:7], v[72:75], v[36:39], a[4:7]
  ds_read_b128 v[20:23], v11 offset:32768
  v_mfma_f32_16x16x32_bf16 a[8:11], v[76:79], v[36:39], a[8:11]
  ds_read_b64_tr_b16 v[52:53], v14 offset:49152
  v_mfma_f32_16x16x32_bf16 a[12:15], v[80:83], v[36:39], a[12:15]
  ds_read_b64_tr_b16 v[54:55], v14 offset:53248
  v_mfma_f32_16x16x32_bf16 a[16:19], v[68:71], v[40:43], a[16:19]
  ds_read_b128 v[24:27], v11 offset:34816
  v_mfma_f32_16x16x32_bf16 a[20:23], v[72:75], v[40:43], a[20:23]
  ds_read_b64_tr_b16 v[56:57], v14 offset:49160
  v_mfma_f32_16x16x32_bf16 a[24:27], v[76:79], v[40:43], a[24:27]
  ds_read_b64_tr_b16 v[58:59], v14 offset:53256
  v_mfma_f32_16x16x32_bf16 a[28:31], v[80:83], v[40:43], a[28:31]
  ds_read_b128 v[28:31], v11 offset:36864
  v_mfma_f32_16x16x32_bf16 a[32:35], v[68:71], v[44:47], a[32:35]
  ds_read_b64_tr_b16 v[60:61], v15 offset:49152
  v_mfma_f32_16x16x32_bf16 a[36:39], v[72:75], v[44:47], a[36:39]
  ds_read_b64_tr_b16 v[62:63], v15 offset:53248
  v_mfma_f32_16x16x32_bf16 a[40:43], v[76:79], v[44:47], a[40:43]
  ds_read_b128 v[32:35], v11 offset:38912
  v_mfma_f32_16x16x32_bf16 a[44:47], v[80:83], v[44:47], a[44:47]
  ds_read_b64_tr_b16 v[64:65], v15 offset:49160
  v_mfma_f32_16x16x32_bf16 a[48:51], v[68:71], v[48:51], a[48:51]
  ds_read_b64_tr_b16 v[66:67], v15 offset:53256
  v_mfma_f32_16x16x32_bf16 a[52:55], v[72:75], v[48:51], a[52:55]
  v_mfma_f32_16x16x32_bf16 a[56:59], v[76:79], v[48:51], a[56:59]
  v_mfma_f32_16x16x32_bf16 a[60:63], v[80:83], v[48:51], a[60:63]
  s_waitcnt lgkmcnt(0)
  v_mfma_f32_16x16x32_bf16 a[0:3], v[52:55], v[20:23], a[0:3]
  ds_read_b128 v[36:39], v11 offset:33792
  v_mfma_f32_16x16x32_bf16 a[4:7], v[56:59], v[20:23], a[4:7]
  ds_read_b64_tr_b16 v[68:69], v14 offset:57344
  v_mfma_f32_16x16x32_bf16 a[8:11], v[60:63], v[20:23], a[8:11]
  ds_read_b64_tr_b16 v[70:71], v14 offset:61440
  v_mfma_f32_16x16x32_bf16 a[12:15], v[64:67], v[20:23], a[12:15]
  ds_read_b128 v[40:43], v11 offset:35840
  v_mfma_f32_16x16x32_bf16 a[16:19], v[52:55], v[24:27], a[16:19]
  ds_read_b64_tr_b16 v[72:73], v14 offset:57352
  v_mfma_f32_16x16x32_bf16 a[20:23], v[56:59], v[24:27], a[20:23]
  ds_read_b64_tr_b16 v[74:75], v14 offset:61448
  v_mfma_f32_16x16x32_bf16 a[24:27], v[60:63], v[24:27], a[24:27]
  ds_read_b128 v[44:47], v11 offset:37888
  v_mfma_f32_16x16x32_bf16 a[28:31], v[64:67], v[24:27], a[28:31]
  ds_read_b64_tr_b16 v[76:77], v15 offset:57344
  v_mfma_f32_16x16x32_bf16 a[32:35], v[52:55], v[28:31], a[32:35]
  ds_read_b64_tr_b16 v[78:79], v15 offset:61440
  v_mfma_f32_16x16x32_bf16 a[36:39], v[56:59], v[28:31], a[36:39]
  ds_read_b128 v[48:51], v11 offset:39936
  v_mfma_f32_16x16x32_bf16 a[40:43], v[60:63], v[28:31], a[40:43]
  ds_read_b64_tr_b16 v[80:81], v15 offset:57352
  v_mfma_f32_16x16x32_bf16 a[44:47], v[64:67], v[28:31], a[44:47]
  ds_read_b64_tr_b16 v[82:83], v15 offset:61448
  v_mfma_f32_16x16x32_bf16 a[48:51], v[52:55], v[32:35], a[48:51]
  v_mfma_f32_16x16x32_bf16 a[52:55], v[56:59], v[32:35], a[52:55]
  v_mfma_f32_16x16x32_bf16 a[56:59], v[60:63], v[32:35], a[56:59]
  v_mfma_f32_16x16x32_bf16 a[60:63], v[64:67], v[32:35], a[60:63]
  s_waitcnt lgkmcnt(0)
  v_mfma_f32_16x16x32_bf16 a[0:3], v[68:71], v[36:39], a[0:3]
  v_mfma_f32_16x16x32_bf16 a[4:7], v[72:75], v[36:39], a[4:7]
  v_mfma_f32_16x16x32_bf16 a[8:11], v[76:79], v[36:39], a[8:11]
  v_mfma_f32_16x16x32_bf16 a[12:15], v[80:83], v[36:39], a[12:15]
  v_mfma_f32_16x16x32_bf16 a[16:19], v[68:71], v[40:43], a[16:19]
  v_mfma_f32_16x16x32_bf16 a[20:23], v[72:75], v[40:43], a[20:23]
  v_mfma_f32_16x16x32_bf16 a[24:27], v[76:79], v[40:43], a[24:27]
  v_mfma_f32_16x16x32_bf16 a[28:31], v[80:83], v[40:43], a[28:31]
  v_mfma_f32_16x16x32_bf16 a[32:35], v[68:71], v[44:47], a[32:35]
  v_mfma_f32_16x16x32_bf16 a[36:39], v[72:75], v[44:47], a[36:39]
  v_mfma_f32_16x16x32_bf16 a[40:43], v[76:79], v[44:47], a[40:43]
  v_mfma_f32_16x16x32_bf16 a[44:47], v[80:83], v[44:47], a[44:47]
  v_mfma_f32_16x16x32_bf16 a[48:51], v[68:71], v[48:51], a[48:51]
  v_mfma_f32_16x16x32_bf16 a[52:55], v[72:75], v[48:51], a[52:55]
  v_mfma_f32_16x16x32_bf16 a[56:59], v[76:79], v[48:51], a[56:59]
  v_mfma_f32_16x16x32_bf16 a[60:63], v[80:83], v[48:51], a[60:63]
  s_cmp_ge_u32 s35, 8
  s_cbranch_scc1 L_part
  s_mov_b32 s59, 5
  s_mov_b32 s60, s22
  s_mov_b32 s61, s26
  s_add_u32 s62, s38, 0x3d00000
  s_mov_b32 s63, s98
  s_cmp_eq_u32 s35, 16
  s_cselect_b32 s90, 999, s34
  s_cmp_lt_u32 s90, 242
  s_cbranch_scc1 L_got
  s_mov_b32 s58, 3
  s_branch L_epi
L_part:
  s_sub_u32 s40, s36, 12
  s_lshl_b32 s40, s40, 3
  s_add_u32 s40, s40, s50
  s_lshl_b32 s41, s40, 19
  s_add_u32 s41, s41, 0x6400000
  s_lshl_b32 s90, s32, 14
  s_add_u32 s41, s41, s90
  s_lshl_b32 s90, s48, 16
  s_add_u32 s42, s41, s90
  v_lshlrev_b32 v2, 4, v1
  buffer_store_dwordx4 a[0:3], v2, s[4:7], s42 offen offset:0 sc1
  buffer_store_dwordx4 a[4:7], v2, s[4:7], s42 offen offset:1024 sc1
  buffer_store_dwordx4 a[8:11], v2, s[4:7], s42 offen offset:2048 sc1
  buffer_store_dwordx4 a[12:15], v2, s[4:7], s42 offen offset:3072 sc1
  s_add_u32 s42, s42, 4096
  buffer_store_dwordx4 a[16:19], v2, s[4:7], s42 offen offset:0 sc1
  buffer_store_dwordx4 a[20:23], v2, s[4:7], s42 offen offset:1024 sc1
  buffer_store_dwordx4 a[24:27], v2, s[4:7], s42 offen offset:2048 sc1
  buffer_store_dwordx4 a[28:31], v2, s[4:7], s42 offen offset:3072 sc1
  s_add_u32 s42, s42, 4096
  buffer_store_dwordx4 a[32:35], v2, s[4:7], s42 offen offset:0 sc1
  buffer_store_dwordx4 a[36:39], v2, s[4:7], s42 offen offset:1024 sc1
  buffer_store_dwordx4 a[40:43], v2, s[4:7], s42 offen offset:2048 sc1
  buffer_store_dwordx4 a[44:47], v2, s[4:7], s42 offen offset:3072 sc1
  s_add_u32 s42, s42, 4096
  buffer_store_dwordx4 a[48:51], v2, s[4:7], s42 offen offset:0 sc1
  buffer_store_dwordx4 a[52:55], v2, s[4:7], s42 offen offset:1024 sc1
  buffer_store_dwordx4 a[56:59], v2, s[4:7], s42 offen offset:2048 sc1
  buffer_store_dwordx4 a[60:63], v2, s[4:7], s42 offen offset:3072 sc1
  s_lshl_b32 s40, s40, 7
  s_add_u32 s43, s40, 0x3d04000
  s_waitcnt vmcnt(0)
  s_cmp_eq_u32 s35, 8
  s_cbranch_scc1 L_part8
  s_waitcnt vmcnt(0)
  s_barrier
  s_cmp_lg_u32 s32, 0
  s_cbranch_scc1 L_sig_107
  v_mov_b32 v254, 1
  v_mov_b32 v255, 0
  s_mov_b64 exec, 1
  buffer_atomic_add v254, v255, s[4:7], s43 offen offset:0 sc1
  s_mov_b64 exec, -1
L_sig_107:
  s_cmp_eq_u32 s35, 8
  s_cselect_b32 s43, 8, 4
  s_cmp_lg_u32 s32, 0
  s_cbranch_scc1 L_dd_109
  v_mov_b32 v228, 0x3d00000
  v_mov_b32 v232, 0x3d04000
L_dw_108:
  buffer_load_dword v234, v232, s[4:7], s40 offen offset:0 sc1
  s_waitcnt vmcnt(0)
  s_mov_b32 s44, 1
  v_readfirstlane_b32 s45, v234
  s_cmp_ge_u32 s45, s43
  s_cselect_b32 s44, s44, 0
  s_cmp_eq_u32 s44, 1
  s_cbranch_scc1 L_dd_109
  s_sleep 1
  s_add_u32 s3, s3, 1
  s_cmp_lt_u32 s3, 131072
  s_cbranch_scc1 L_dw_108
L_dd_109:
  s_barrier
  s_cmp_lg_u32 s32, 0
  s_cbranch_scc1 L_rq_110
  s_cmp_eq_u32 s39, 0
  s_cbranch_scc1 L_rq_110
  s_lshl_b32 s99, s33, 7
  s_add_u32 s99, s99, 0x3d00200
  v_mov_b32 v244, 1
  v_mov_b32 v245, 0
  s_mov_b64 exec, 1
  buffer_atomic_add v244, v245, s[4:7], s99 offen sc0 sc1
  s_mov_b64 exec, -1
L_rq_110:
  s_cmp_eq_u32 s35, 14
  s_cbranch_scc1 L_part4
L_part8:
  s_lshl_b32 s90, s48, 11
  s_add_u32 s42, s41, s90
  v_mov_b32 v3, 0x0
  v_bfe_u32 v4, v1, 0, 4
  v_lshl_add_u32 v3, v4, 12, v3
  v_bfe_u32 v4, v1, 4, 2
  v_lshl_add_u32 v3, v4, 4, v3
  s_lshr_b32 s90, s32, 1
  s_lshl_b32 s90, s90, 18
  s_add_u32 s22, s22, s90
  s_and_b32 s90, s32, 1
  s_lshl_b32 s90, s90, 7
  s_add_u32 s22, s22, s90
  s_lshr_b32 s90, s48, 1
  s_lshl_b32 s90, s90, 16
  s_add_u32 s22, s22, s90
  s_and_b32 s90, s48, 1
  s_lshl_b32 s90, s90, 6
  s_add_u32 s22, s22, s90
L_part8r:
  s_mov_b32 s41, s42
  buffer_load_dwordx4 v[16:19], v2, s[4:7], s41 offen offset:0 sc1
  buffer_load_dwordx4 v[20:23], v2, s[4:7], s41 offen offset:1024 sc1
  s_add_u32 s41, s41, 0x10000
  buffer_load_dwordx4 v[24:27], v2, s[4:7], s41 offen offset:0 sc1
  buffer_load_dwordx4 v[28:31], v2, s[4:7], s41 offen offset:1024 sc1
  s_add_u32 s41, s41, 0x10000
  buffer_load_dwordx4 v[32:35], v2, s[4:7], s41 offen offset:0 sc1
  buffer_load_dwordx4 v[36:39], v2, s[4:7], s41 offen offset:1024 sc1
  s_add_u32 s41, s41, 0x10000
  buffer_load_dwordx4 v[40:43], v2, s[4:7], s41 offen offset:0 sc1
  buffer_load_dwordx4 v[44:47], v2, s[4:7], s41 offen offset:1024 sc1
  s_add_u32 s41, s41, 0x10000
  buffer_load_dwordx4 v[48:51], v2, s[4:7], s41 offen offset:0 sc1
  buffer_load_dwordx4 v[52:55], v2, s[4:7], s41 offen offset:1024 sc1
  s_add_u32 s41, s41, 0x10000
  buffer_load_dwordx4 v[56:59], v2, s[4:7], s41 offen offset:0 sc1
  buffer_load_dwordx4 v[60:63], v2, s[4:7], s41 offen offset:1024 sc1
  s_add_u32 s41, s41, 0x10000
  buffer_load_dwordx4 v[64:67], v2, s[4:7], s41 offen offset:0 sc1
  buffer_load_dwordx4 v[68:71], v2, s[4:7], s41 offen offset:1024 sc1
  s_add_u32 s41, s41, 0x10000
  buffer_load_dwordx4 v[72:75], v2, s[4:7], s41 offen offset:0 sc1
  buffer_load_dwordx4 v[76:79], v2, s[4:7], s41 offen offset:1024 sc1
  s_add_u32 s41, s41, 0x10000
  v_mov_b32 v5, 0
  s_waitcnt vmcnt(14)
  v_max3_u32 v5, v5, v16, v17
  v_max3_u32 v5, v5, v18, v19
  v_max3_u32 v5, v5, v20, v21
  v_max3_u32 v5, v5, v22, v23
  s_waitcnt vmcnt(12)
  v_max3_u32 v5, v5, v24, v25
  v_max3_u32 v5, v5, v26, v27
  v_max3_u32 v5, v5, v28, v29
  v_max3_u32 v5, v5, v30, v31
  s_waitcnt vmcnt(10)
  v_max3_u32 v5, v5, v32, v33
  v_max3_u32 v5, v5, v34, v35
  v_max3_u32 v5, v5, v36, v37
  v_max3_u32 v5, v5, v38, v39
  s_waitcnt vmcnt(8)
  v_max3_u32 v5, v5, v40, v41
  v_max3_u32 v5, v5, v42, v43
  v_max3_u32 v5, v5, v44, v45
  v_max3_u32 v5, v5, v46, v47
  s_waitcnt vmcnt(6)
  v_max3_u32 v5, v5, v48, v49
  v_max3_u32 v5, v5, v50, v51
  v_max3_u32 v5, v5, v52, v53
  v_max3_u32 v5, v5, v54, v55
  s_waitcnt vmcnt(4)
  v_max3_u32 v5, v5, v56, v57
  v_max3_u32 v5, v5, v58, v59
  v_max3_u32 v5, v5, v60, v61
  v_max3_u32 v5, v5, v62, v63
  s_waitcnt vmcnt(2)
  v_max3_u32 v5, v5, v64, v65
  v_max3_u32 v5, v5, v66, v67
  v_max3_u32 v5, v5, v68, v69
  v_max3_u32 v5, v5, v70, v71
  s_waitcnt vmcnt(0)
  v_max3_u32 v5, v5, v72, v73
  v_max3_u32 v5, v5, v74, v75
  v_max3_u32 v5, v5, v76, v77
  v_max3_u32 v5, v5, v78, v79
  v_cmp_eq_u32 vcc, -1, v5
  s_add_u32 s3, s3, 1
  s_cmp_ge_u32 s3, 131072
  s_cbranch_scc1 L_part8k
  s_cbranch_vccnz L_part8r
L_part8k:
  s_waitcnt vmcnt(12)
  v_pk_add_f32 v[16:17], v[16:17], v[24:25]
  v_pk_add_f32 v[18:19], v[18:19], v[26:27]
  v_pk_add_f32 v[20:21], v[20:21], v[28:29]
  v_pk_add_f32 v[22:23], v[22:23], v[30:31]
  s_waitcnt vmcnt(10)
  v_pk_add_f32 v[16:17], v[16:17], v[32:33]
  v_pk_add_f32 v[18:19], v[18:19], v[34:35]
  v_pk_add_f32 v[20:21], v[20:21], v[36:37]
  v_pk_add_f32 v[22:23], v[22:23], v[38:39]
  s_waitcnt vmcnt(8)
  v_pk_add_f32 v[16:17], v[16:17], v[40:41]
  v_pk_add_f32 v[18:19], v[18:19], v[42:43]
  v_pk_add_f32 v[20:21], v[20:21], v[44:45]
  v_pk_add_f32 v[22:23], v[22:23], v[46:47]
  s_waitcnt vmcnt(6)
  v_pk_add_f32 v[16:17], v[16:17], v[48:49]
  v_pk_add_f32 v[18:19], v[18:19], v[50:51]
  v_pk_add_f32 v[20:21], v[20:21], v[52:53]
  v_pk_add_f32 v[22:23], v[22:23], v[54:55]
  s_waitcnt vmcnt(4)
  v_pk_add_f32 v[16:17], v[16:17], v[56:57]
  v_pk_add_f32 v[18:19], v[18:19], v[58:59]
  v_pk_add_f32 v[20:21], v[20:21], v[60:61]
  v_pk_add_f32 v[22:23], v[22:23], v[62:63]
  s_waitcnt vmcnt(2)
  v_pk_add_f32 v[16:17], v[16:17], v[64:65]
  v_pk_add_f32 v[18:19], v[18:19], v[66:67]
  v_pk_add_f32 v[20:21], v[20:21], v[68:69]
  v_pk_add_f32 v[22:23], v[22:23], v[70:71]
  s_waitcnt vmcnt(0)
  v_pk_add_f32 v[16:17], v[16:17], v[72:73]
  v_pk_add_f32 v[18:19], v[18:19], v[74:75]
  v_pk_add_f32 v[20:21], v[20:21], v[76:77]
  v_pk_add_f32 v[22:23], v[22:23], v[78:79]
  v_cvt_pk_bf16_f32 v8, v16, v17
  v_cvt_pk_bf16_f32 v9, v18, v19
  v_cvt_pk_bf16_f32 v10, v20, v21
  v_cvt_pk_bf16_f32 v11, v22, v23
  buffer_store_dwordx4 v[8:11], v3, s[16:19], s22 offen sc1
  s_branch L_exit
L_part4:
  s_lshl_b32 s90, s48, 12
  s_add_u32 s41, s41, s90
  buffer_load_dwordx4 v[16:19], v2, s[4:7], s41 offen offset:0 sc1
  buffer_load_dwordx4 v[20:23], v2, s[4:7], s41 offen offset:1024 sc1
  buffer_load_dwordx4 v[24:27], v2, s[4:7], s41 offen offset:2048 sc1
  buffer_load_dwordx4 v[28:31], v2, s[4:7], s41 offen offset:3072 sc1
  s_add_u32 s41, s41, 0x10000
  buffer_load_dwordx4 v[32:35], v2, s[4:7], s41 offen offset:0 sc1
  buffer_load_dwordx4 v[36:39], v2, s[4:7], s41 offen offset:1024 sc1
  buffer_load_dwordx4 v[40:43], v2, s[4:7], s41 offen offset:2048 sc1
  buffer_load_dwordx4 v[44:47], v2, s[4:7], s41 offen offset:3072 sc1
  s_add_u32 s41, s41, 0x10000
  buffer_load_dwordx4 v[48:51], v2, s[4:7], s41 offen offset:0 sc1
  buffer_load_dwordx4 v[52:55], v2, s[4:7], s41 offen offset:1024 sc1
  buffer_load_dwordx4 v[56:59], v2, s[4:7], s41 offen offset:2048 sc1
  buffer_load_dwordx4 v[60:63], v2, s[4:7], s41 offen offset:3072 sc1
  s_add_u32 s41, s41, 0x10000
  buffer_load_dwordx4 v[64:67], v2, s[4:7], s41 offen offset:0 sc1
  buffer_load_dwordx4 v[68:71], v2, s[4:7], s41 offen offset:1024 sc1
  buffer_load_dwordx4 v[72:75], v2, s[4:7], s41 offen offset:2048 sc1
  buffer_load_dwordx4 v[76:79], v2, s[4:7], s41 offen offset:3072 sc1
  s_add_u32 s41, s41, 0x10000
  v_mov_b32 v3, 0x0
  v_bfe_u32 v4, v1, 0, 4
  v_lshl_add_u32 v3, v4, 12, v3
  v_bfe_u32 v4, v1, 4, 2
  v_lshl_add_u32 v3, v4, 4, v3
  s_lshr_b32 s90, s32, 1
  s_lshl_b32 s90, s90, 18
  s_add_u32 s22, s22, s90
  s_and_b32 s90, s32, 1
  s_lshl_b32 s90, s90, 7
  s_add_u32 s22, s22, s90
  s_lshl_b32 s90, s48, 16
  s_add_u32 s22, s22, s90
  s_waitcnt vmcnt(8)
  v_pk_add_f32 v[16:17], v[16:17], v[32:33]
  v_pk_add_f32 v[18:19], v[18:19], v[34:35]
  v_pk_add_f32 v[20:21], v[20:21], v[36:37]
  v_pk_add_f32 v[22:23], v[22:23], v[38:39]
  v_pk_add_f32 v[24:25], v[24:25], v[40:41]
  v_pk_add_f32 v[26:27], v[26:27], v[42:43]
  v_pk_add_f32 v[28:29], v[28:29], v[44:45]
  v_pk_add_f32 v[30:31], v[30:31], v[46:47]
  s_waitcnt vmcnt(4)
  v_pk_add_f32 v[16:17], v[16:17], v[48:49]
  v_pk_add_f32 v[18:19], v[18:19], v[50:51]
  v_pk_add_f32 v[20:21], v[20:21], v[52:53]
  v_pk_add_f32 v[22:23], v[22:23], v[54:55]
  v_pk_add_f32 v[24:25], v[24:25], v[56:57]
  v_pk_add_f32 v[26:27], v[26:27], v[58:59]
  v_pk_add_f32 v[28:29], v[28:29], v[60:61]
  v_pk_add_f32 v[30:31], v[30:31], v[62:63]
  s_waitcnt vmcnt(0)
  v_pk_add_f32 v[16:17], v[16:17], v[64:65]
  v_pk_add_f32 v[18:19], v[18:19], v[66:67]
  v_pk_add_f32 v[20:21], v[20:21], v[68:69]
  v_pk_add_f32 v[22:23], v[22:23], v[70:71]
  v_pk_add_f32 v[24:25], v[24:25], v[72:73]
  v_pk_add_f32 v[26:27], v[26:27], v[74:75]
  v_pk_add_f32 v[28:29], v[28:29], v[76:77]
  v_pk_add_f32 v[30:31], v[30:31], v[78:79]
  v_cvt_pk_bf16_f32 v8, v16, v17
  v_cvt_pk_bf16_f32 v9, v18, v19
  v_cvt_pk_bf16_f32 v10, v20, v21
  v_cvt_pk_bf16_f32 v11, v22, v23
  v_cvt_pk_bf16_f32 v12, v24, v25
  v_cvt_pk_bf16_f32 v13, v26, v27
  v_cvt_pk_bf16_f32 v14, v28, v29
  v_cvt_pk_bf16_f32 v15, v30, v31
  buffer_store_dwordx4 v[8:11], v3, s[16:19], s22 offen offset:0 sc1
  buffer_store_dwordx4 v[12:15], v3, s[16:19], s22 offen offset:64 sc1
  s_branch L_got
L_done:
  s_waitcnt vmcnt(0)
  s_barrier
  s_add_u32 s38, s38, 0x3d00000
  s_cmp_lg_u32 s32, 0
  s_cbranch_scc1 L_sig_111
  v_mov_b32 v254, s98
  v_mov_b32 v255, 0
  s_mov_b64 exec, 1
  buffer_atomic_add v254, v255, s[4:7], s38 offen offset:0 sc1
  s_mov_b64 exec, -1
L_sig_111:
  s_mov_b32 s59, 0
  s_cmp_lg_u32 s35, 6
  s_cbranch_scc1 L_got
  s_add_u32 s36, s36, 2
  s_and_b32 s50, s36, 7
  s_cmp_lt_u32 s36, 62
  s_cbranch_scc1 L_ata_c
  s_branch L_got
L_exit:
  s_endpgm
.p2align 3
L_table:
.long 0x9
.long 0xa
.long 0x10009
.long 0x1000a
.long 0x20009
.long 0x2000a
.long 0x30009
.long 0x3000a
.long 0x40009
.long 0x4000a
.long 0x50009
.long 0x5000a
.long 0x60009
.long 0x6000a
.long 0x70009
.long 0x7000a
.long 0x109
.long 0x10a
.long 0x10109
.long 0x1010a
.long 0x20109
.long 0x2010a
.long 0x30109
.long 0x3010a
.long 0x40109
.long 0x4010a
.long 0x50109
.long 0x5010a
.long 0x60109
.long 0x6010a
.long 0x70109
.long 0x7010a
.long 0x209
.long 0x20a
.long 0x10209
.long 0x1020a
.long 0x20209
.long 0x2020a
.long 0x30209
.long 0x3020a
.long 0x40209
.long 0x4020a
.long 0x50209
.long 0x5020a
.long 0x60209
.long 0x6020a
.long 0x70209
.long 0x7020a
.long 0x201
.long 0x202
.long 0x10201
.long 0x10202
.long 0x20201
.long 0x20202
.long 0x30201
.long 0x30202
.long 0x301
.long 0x302
.long 0x10301
.long 0x10302
.long 0x20301
.long 0x20302
.long 0x30301
.long 0x30302
.long 0x309
.long 0x30a
.long 0x10309
.long 0x1030a
.long 0x20309
.long 0x2030a
.long 0x30309
.long 0x3030a
.long 0x40309
.long 0x4030a
.long 0x50309
.long 0x5030a
.long 0x60309
.long 0x6030a
.long 0x70309
.long 0x7030a
.long 0xc
.long 0x10c
.long 0x20c
.long 0x30c
.long 0x0
.long 0x10000
.long 0x20000
.long 0x30000
.long 0x100
.long 0x10100
.long 0x20100
.long 0x30100
.long 0x200
.long 0x10200
.long 0x20200
.long 0x30200
.long 0x401
.long 0x402
.long 0x10401
.long 0x10402
.long 0x20401
.long 0x20402
.long 0x30401
.long 0x30402
.long 0x501
.long 0x502
.long 0x10501
.long 0x10502
.long 0x20501
.long 0x20502
.long 0x30501
.long 0x30502
.long 0x300
.long 0x10300
.long 0x20300
.long 0x30300
.long 0x3
.long 0x10003
.long 0x20003
.long 0x103
.long 0x10103
.long 0x20103
.long 0x203
.long 0x10203
.long 0x20203
.long 0x303
.long 0x10303
.long 0x20303
.long 0x400
.long 0x10400
.long 0x20400
.long 0x30400
.long 0x500
.long 0x10500
.long 0x20500
.long 0x30500
.long 0x600
.long 0x10600
.long 0x20600
.long 0x30600
.long 0x700
.long 0x10700
.long 0x20700
.long 0x30700
.long 0xb
.long 0x1000b
.long 0x40b
.long 0x1040b
.long 0x80b
.long 0x1080b
.long 0xc0b
.long 0x10c0b
.long 0x403
.long 0x10403
.long 0x20403
.long 0x503
.long 0x10503
.long 0x20503
.long 0x603
.long 0x10603
.long 0x601
.long 0x602
.long 0x10601
.long 0x10602
.long 0x20601
.long 0x20602
.long 0x30601
.long 0x30602
.long 0x701
.long 0x702
.long 0x10701
.long 0x10702
.long 0x20701
.long 0x20702
.long 0x30701
.long 0x30702
.long 0x100b
.long 0x1100b
.long 0x140b
.long 0x1140b
.long 0x180b
.long 0x1180b
.long 0x1c0b
.long 0x11c0b
.long 0x20603
.long 0x703
.long 0x10703
.long 0x20703
.long 0x200b
.long 0x1200b
.long 0x240b
.long 0x1240b
.long 0x10
.long 0x10010
.long 0x210
.long 0x10210
.long 0x410
.long 0x10410
.long 0x610
.long 0x10610
.long 0x404
.long 0x10404
.long 0x20404
.long 0x30404
.long 0x304
.long 0x10304
.long 0x20304
.long 0x30304
.long 0x2806
.long 0x12806
.long 0x2906
.long 0x12906
.long 0x4
.long 0x10004
.long 0x20004
.long 0x30004
.long 0x104
.long 0x10104
.long 0x20104
.long 0x30104
.long 0x204
.long 0x10204
.long 0x20204
.long 0x30204
.long 0x11
.long 0x10011
.long 0x211
.long 0x10211
.long 0x504
.long 0x10504
.long 0x20504
.long 0x30504
.long 0x411
.long 0x10411
.long 0x611
.long 0x10611
.long 0x807
.long 0x10807
.long 0x907
.long 0x10907
.long 0xa07
.long 0x10a07
.long 0x811
.long 0x10811
.long 0xb07
.long 0x10b07
.long 0xa11
.long 0x10a11
.long 0xc07
.long 0x10c07
.long 0x604
.long 0x10604
.long 0x20604
.long 0x30604
.long 0x704
.long 0x10704
.long 0x20704
.long 0x30704
.long 0xc05
.long 0x10c05
.long 0xd05
.long 0x10d05
.long 0xe05
.long 0x10e05
.long 0xf05
.long 0x10f05
.long 0xd0e
.long 0x10d0e
.long 0x20d0e
.long 0x30d0e
.long 0x40d0e
.long 0x50d0e
.long 0x60d0e
.long 0x70d0e
.long 0x3e06
.long 0x13e06
.long 0x3f06
.long 0x13f06
.long 0xe0e
.long 0x10e0e
.long 0x20e0e
.long 0x30e0e
.long 0x40e0e
.long 0x50e0e
.long 0x60e0e
.long 0x70e0e
.long 0xf08
.long 0x10f08
.long 0x20f08
.long 0x30f08
.long 0x40f08
.long 0x50f08
.long 0x60f08
.long 0x70f08
.long 0x80f08
.long 0x90f08
.long 0xa0f08
.long 0xb0f08
.long 0xc0f08
.long 0xd0f08
.long 0xe0f08
.long 0xf0f08
.long 0xf
.long 0x0
.long 0x0
.long 0x0
.fill 206, 4, 0
.section .rodata,"a"
.p2align 6
.amdhsa_kernel concat_heads__memory_aug_recurrent_mem_tr__sliding_local_dilated__prompt_kernel
  .amdhsa_next_free_vgpr 512
  .amdhsa_next_free_sgpr 102
  .amdhsa_accum_offset 256
  .amdhsa_group_segment_fixed_size 0
  .amdhsa_kernarg_size 104
  .amdhsa_user_sgpr_count 2
  .amdhsa_user_sgpr_kernarg_segment_ptr 1
  .amdhsa_system_sgpr_workgroup_id_x 1
  .amdhsa_float_denorm_mode_32 3
  .amdhsa_float_denorm_mode_16_64 3
.end_amdhsa_kernel
```
